```python
import torch

def _softmax(x, axis=-1):
    return torch.softmax(x, dim=axis)
def _gelu(x):
    return torch.nn.functional.gelu(x, approximate="tanh")
def _silu(x):
    return torch.nn.functional.silu(x)
def _sigmoid(x):
    return torch.sigmoid(x)
def _layernorm(x, axis=-1, eps=1e-5):
    m = x.mean(dim=axis, keepdim=True)
    v = x.var(dim=axis, keepdim=True, unbiased=False)
    return (x - m) / torch.sqrt(v + eps)
def _scatter_add(tgt, idx, src, axis=0):
    return tgt.clone().index_add_(axis, idx, src)
def _segment_sum(src, seg, n):
    out = torch.zeros((n,) + src.shape[1:], dtype=src.dtype)
    return out.index_add_(0, seg, src)
def _pad(x, pw):
    flat = tuple(v for pair in reversed(pw) for v in pair)
    return torch.nn.functional.pad(x, flat)

kernel_name = 'interleave_layers__sliding_local_dilated__glu_gated_geglu__prompt'

def setup_inputs():

    _w = (lambda a: (lambda t: t.to(torch.bfloat16) if t.is_floating_point() else t)(torch.as_tensor(a)))
    def _A_setup():
        B, S, D = 1, 2048, 576
        return {
            "x": _w((lambda *s: torch.randn(*s, dtype=torch.bfloat16) * 0.05)(B, S, D)),
            "wqkv": _w((lambda *s: torch.randn(*s, dtype=torch.bfloat16) * 0.05)(D, 3 * D)),
            "wo": _w((lambda *s: torch.randn(*s, dtype=torch.bfloat16) * 0.05)(D, D)),
        }
    _A_in = _A_setup()

    def _B_setup():
        B, S, Dm, Df = 1, 2048, 576, 4608
        return {
            "x": _w((lambda *s: torch.randn(*s, dtype=torch.bfloat16) * 0.05)(B, S, Dm)),
            "w_gate": _w((lambda *s: torch.randn(*s, dtype=torch.bfloat16) * 0.8)(Dm, Df) * (Dm ** -0.5)),
            "w_up": _w((lambda *s: torch.randn(*s, dtype=torch.bfloat16) * 0.8)(Dm, Df) * (Dm ** -0.5)),
            "w_down": _w((lambda *s: torch.randn(*s, dtype=torch.bfloat16) * 0.8)(Df, Dm) * (Df ** -0.5)),
        }
    _B_in = _B_setup()

    return {
        "A_x": _A_in["x"],
        "A_wqkv": _A_in["wqkv"],
        "A_wo": _A_in["wo"],
        "B_x": _B_in["x"],
        "B_w_gate": _B_in["w_gate"],
        "B_w_up": _B_in["w_up"],
        "B_w_down": _B_in["w_down"],
    }

def reference(A_x, A_wqkv, A_wo, B_x, B_w_gate, B_w_up, B_w_down):
    def _A_ref(x, wqkv, wo):
        B, S, D = x.shape
        H = 32; Dh = D // H
        W, dil = 8, 2
        qkv = (lambda x, *d: x.permute(*d))((x @ wqkv).reshape(B, S, 3, H, Dh), 2, 0, 3, 1, 4)
        q, k, v = qkv[0], qkv[1], qkv[2]
        scale = Dh ** -0.5
        pos = torch.arange(S)
        off = torch.arange(W) * dil
        idx = pos[:, None] - off[None, :]
        mask = idx >= 0
        idx_c = torch.where(mask, idx, 0).reshape(-1)
        kg = k[:, :, idx_c, :].reshape(B, H, S, W, Dh)
        vg = v[:, :, idx_c, :].reshape(B, H, S, W, Dh)
        logits = torch.einsum("bhsd,bhswd->bhsw", q, kg) * scale
        logits = torch.where(mask[None, None, :, :], logits, -1e9)
        attn = _softmax(logits, axis=-1)
        o = torch.einsum("bhsw,bhswd->bhsd", attn, vg)
        return (lambda x, *d: x.permute(*d))(o, 0, 2, 1, 3).reshape(B, S, D) @ wo

    def _B_ref(x, w_gate, w_up, w_down):
        g = torch.einsum("bsd,df->bsf", x, w_gate)
        u = torch.einsum("bsd,df->bsf", x, w_up)
        h = _gelu(g) * u
        return torch.einsum("bsf,fd->bsd", h, w_down)

    x = A_x
    x = x + _A_ref(_layernorm(x, axis=-1), A_wqkv, A_wo)
    x = x + _B_ref(_layernorm(x, axis=-1), B_w_gate, B_w_up, B_w_down)
    x = x + _A_ref(_layernorm(x, axis=-1), A_wqkv, A_wo)
    x = x + _B_ref(_layernorm(x, axis=-1), B_w_gate, B_w_up, B_w_down)
    return x
```

```asm
; @launch kernel=prep_kernel grid=(258,1,1) block=(256,1,1) lds=1024
; @launch kernel=a1l0_kernel grid=(256,1,1) block=(256,1,1) lds=159744
; @launch kernel=a2l0_kernel grid=(256,1,1) block=(256,1,1) lds=94208
; @launch kernel=fl0_kernel grid=(256,1,1) block=(256,1,1) lds=147456
; @launch kernel=rl0_kernel grid=(256,1,1) block=(192,1,1) lds=1024
; @launch kernel=a1l1_kernel grid=(256,1,1) block=(256,1,1) lds=159744
; @launch kernel=a2l1_kernel grid=(256,1,1) block=(256,1,1) lds=94208
; @launch kernel=fl1_kernel grid=(256,1,1) block=(256,1,1) lds=147456
; @launch kernel=rl1_kernel grid=(256,1,1) block=(192,1,1) lds=1024
.amdgcn_target "amdgcn-amd-amdhsa--gfx950"
.text
.p2align 8
.globl prep_kernel
.type prep_kernel,@function
prep_kernel:
s_cmp_ge_u32 s2, 258
s_cbranch_scc1 L_prep_end
s_load_dwordx2 s[12:13], s[0:1], 72
v_and_b32 v1, 63, v0
v_lshrrev_b32 v3, 6, v0
v_lshlrev_b32 v2, 4, v1
v_readfirstlane_b32 s4, v3
s_and_b32 s5, s2, 7
s_lshr_b32 s6, s2, 3
s_waitcnt lgkmcnt(0)
s_mov_b32 s8, s12
s_and_b32 s9, s13, 0xffff
s_mov_b32 s10, 268435456
s_mov_b32 s11, 0x20000
s_cmp_ge_u32 s2, 256
s_cbranch_scc1 L_prep_pack
s_lshl_b32 s20, s2, 10
s_add_u32 s20, s20, 0
v_lshlrev_b32 v4, 2, v0
v_mov_b32 v5, 0
buffer_store_dword v5, v4, s[8:11], s20 offen
s_cmp_eq_u32 s4, 3
s_cbranch_scc1 L_prep_idle
v_and_b32 v6, 7, v1
v_lshrrev_b32 v7, 3, v1
s_mul_i32 s22, s4, 24
v_add_u32 v7, s22, v7
s_and_b32 s23, s6, 1
s_lshl_b32 s23, s23, 3
v_add_u32 v8, s23, v6
v_lshlrev_b32 v8, 4, v8
v_lshl_add_u32 v4, v7, 8, v8
s_lshl_b32 s24, s5, 4
s_lshr_b32 s25, s6, 1
s_add_u32 s24, s24, s25
s_mul_i32 s20, s24, 18432
s_lshl_b32 s24, s5, 8
s_lshl_b32 s25, s6, 3
s_add_u32 s24, s24, s25
s_and_b32 s25, s24, 1023
s_lshl_b32 s25, s25, 1
s_lshr_b32 s24, s24, 10
s_add_u32 s24, s24, s25
s_mul_i32 s21, s24, 1152
v_mul_u32_u24 v8, 2304, v6
v_lshl_add_u32 v5, v7, 4, v8
s_load_dwordx2 s[12:13], s[0:1], 0
s_waitcnt lgkmcnt(0)
s_mov_b32 s16, s12
s_and_b32 s17, s13, 0xffff
s_mov_b32 s18, 2359296
s_mov_b32 s19, 0x20000
buffer_load_dwordx4 v[16:19], v5, s[16:19], s21 offen offset:0
buffer_load_dwordx4 v[20:23], v5, s[16:19], s21 offen offset:128
buffer_load_dwordx4 v[24:27], v5, s[16:19], s21 offen offset:256
s_waitcnt vmcnt(2)
v_lshlrev_b32 v128, 16, v16
v_and_b32 v129, 0xffff0000, v16
v_lshlrev_b32 v130, 16, v17
v_and_b32 v131, 0xffff0000, v17
v_lshlrev_b32 v132, 16, v18
v_and_b32 v133, 0xffff0000, v18
v_lshlrev_b32 v134, 16, v19
v_and_b32 v135, 0xffff0000, v19
s_waitcnt vmcnt(1)
v_lshlrev_b32 v136, 16, v20
v_and_b32 v137, 0xffff0000, v20
v_lshlrev_b32 v138, 16, v21
v_and_b32 v139, 0xffff0000, v21
v_lshlrev_b32 v140, 16, v22
v_and_b32 v141, 0xffff0000, v22
v_lshlrev_b32 v142, 16, v23
v_and_b32 v143, 0xffff0000, v23
s_waitcnt vmcnt(0)
v_lshlrev_b32 v144, 16, v24
v_and_b32 v145, 0xffff0000, v24
v_lshlrev_b32 v146, 16, v25
v_and_b32 v147, 0xffff0000, v25
v_lshlrev_b32 v148, 16, v26
v_and_b32 v149, 0xffff0000, v26
v_lshlrev_b32 v150, 16, v27
v_and_b32 v151, 0xffff0000, v27
s_add_u32 s24, s20, 24043520
s_add_u32 s25, s24, 4096
buffer_store_dwordx4 v[16:19], v4, s[8:11], s24 offen offset:0
buffer_store_dwordx4 v[20:23], v4, s[8:11], s24 offen offset:2048
buffer_store_dwordx4 v[24:27], v4, s[8:11], s25 offen offset:0
v_add_f32 v6, v128, v129
v_mul_f32 v7, v128, v128
v_mul_f32 v9, v129, v129
v_mov_b32 v8, 0
v_add_f32 v6, v6, v130
v_add_f32 v8, v8, v131
v_fmac_f32 v7, v130, v130
v_fmac_f32 v9, v131, v131
v_add_f32 v6, v6, v132
v_add_f32 v8, v8, v133
v_fmac_f32 v7, v132, v132
v_fmac_f32 v9, v133, v133
v_add_f32 v6, v6, v134
v_add_f32 v8, v8, v135
v_fmac_f32 v7, v134, v134
v_fmac_f32 v9, v135, v135
v_add_f32 v6, v6, v136
v_add_f32 v8, v8, v137
v_fmac_f32 v7, v136, v136
v_fmac_f32 v9, v137, v137
v_add_f32 v6, v6, v138
v_add_f32 v8, v8, v139
v_fmac_f32 v7, v138, v138
v_fmac_f32 v9, v139, v139
v_add_f32 v6, v6, v140
v_add_f32 v8, v8, v141
v_fmac_f32 v7, v140, v140
v_fmac_f32 v9, v141, v141
v_add_f32 v6, v6, v142
v_add_f32 v8, v8, v143
v_fmac_f32 v7, v142, v142
v_fmac_f32 v9, v143, v143
v_add_f32 v6, v6, v144
v_add_f32 v8, v8, v145
v_fmac_f32 v7, v144, v144
v_fmac_f32 v9, v145, v145
v_add_f32 v6, v6, v146
v_add_f32 v8, v8, v147
v_fmac_f32 v7, v146, v146
v_fmac_f32 v9, v147, v147
v_add_f32 v6, v6, v148
v_add_f32 v8, v8, v149
v_fmac_f32 v7, v148, v148
v_fmac_f32 v9, v149, v149
v_add_f32 v6, v6, v150
v_add_f32 v8, v8, v151
v_fmac_f32 v7, v150, v150
v_fmac_f32 v9, v151, v151
v_add_f32 v6, v6, v8
v_add_f32 v7, v7, v9
s_nop 0
v_add_f32_dpp v6, v6, v6 row_ror:8 row_mask:0xf bank_mask:0xf
v_add_f32_dpp v7, v7, v7 row_ror:8 row_mask:0xf bank_mask:0xf
v_mov_b32 v8, v6
v_mov_b32 v9, v7
s_nop 0
v_permlane16_swap_b32 v6, v8
v_permlane16_swap_b32 v7, v9
v_add_f32 v6, v6, v8
v_add_f32 v7, v7, v9
v_mov_b32 v8, v6
v_mov_b32 v9, v7
s_nop 0
v_permlane32_swap_b32 v6, v8
v_permlane32_swap_b32 v7, v9
v_add_f32 v6, v6, v8
v_add_f32 v7, v7, v9
v_and_b32 v10, 7, v1
v_lshlrev_b32 v10, 3, v10
s_lshl_b32 s24, s4, 6
v_add_u32 v11, s24, v10
ds_write_b64 v11, v[6:7]
s_waitcnt lgkmcnt(0)
s_barrier
ds_read_b64 v[6:7], v10
ds_read_b64 v[8:9], v10 offset:64
ds_read_b64 v[12:13], v10 offset:128
s_waitcnt lgkmcnt(0)
v_add_f32 v6, v6, v8
v_add_f32 v7, v7, v9
v_add_f32 v6, v6, v12
v_add_f32 v7, v7, v13
v_mul_f32 v6, 0x3ae38e39, v6
v_mul_f32 v7, 0x3ae38e39, v7
v_fma_f32 v7, -v6, v6, v7
v_max_f32 v7, 0, v7
v_add_f32 v7, 0x3727c5ac, v7
v_rsq_f32 v7, v7
s_nop 0
v_mul_f32 v6, v6, v7
v_fma_f32 v128, v128, v7, -v6
v_fma_f32 v129, v129, v7, -v6
v_fma_f32 v130, v130, v7, -v6
v_fma_f32 v131, v131, v7, -v6
v_fma_f32 v132, v132, v7, -v6
v_fma_f32 v133, v133, v7, -v6
v_fma_f32 v134, v134, v7, -v6
v_fma_f32 v135, v135, v7, -v6
v_fma_f32 v136, v136, v7, -v6
v_fma_f32 v137, v137, v7, -v6
v_fma_f32 v138, v138, v7, -v6
v_fma_f32 v139, v139, v7, -v6
v_fma_f32 v140, v140, v7, -v6
v_fma_f32 v141, v141, v7, -v6
v_fma_f32 v142, v142, v7, -v6
v_fma_f32 v143, v143, v7, -v6
v_fma_f32 v144, v144, v7, -v6
v_fma_f32 v145, v145, v7, -v6
v_fma_f32 v146, v146, v7, -v6
v_fma_f32 v147, v147, v7, -v6
v_fma_f32 v148, v148, v7, -v6
v_fma_f32 v149, v149, v7, -v6
v_fma_f32 v150, v150, v7, -v6
v_fma_f32 v151, v151, v7, -v6
v_cvt_pk_bf16_f32 v168, v128, v129
v_cvt_pk_bf16_f32 v169, v130, v131
v_cvt_pk_bf16_f32 v170, v132, v133
v_cvt_pk_bf16_f32 v171, v134, v135
v_cvt_pk_bf16_f32 v172, v136, v137
v_cvt_pk_bf16_f32 v173, v138, v139
v_cvt_pk_bf16_f32 v174, v140, v141
v_cvt_pk_bf16_f32 v175, v142, v143
v_cvt_pk_bf16_f32 v176, v144, v145
v_cvt_pk_bf16_f32 v177, v146, v147
v_cvt_pk_bf16_f32 v178, v148, v149
v_cvt_pk_bf16_f32 v179, v150, v151
s_add_u32 s24, s20, 19324928
s_add_u32 s25, s24, 4096
buffer_store_dwordx4 v[168:171], v4, s[8:11], s24 offen offset:0
buffer_store_dwordx4 v[172:175], v4, s[8:11], s24 offen offset:2048
buffer_store_dwordx4 v[176:179], v4, s[8:11], s25 offen offset:0
s_branch L_prep_pack
L_prep_idle:
s_barrier
L_prep_pack:
s_waitcnt vmcnt(0)
s_lshl_b32 s20, s2, 2
s_add_u32 s20, s20, s4
v_and_b32 v6, 15, v1
v_lshrrev_b32 v7, 4, v1
v_lshrrev_b32 v8, 2, v6
v_and_b32 v9, 3, v6
v_lshl_add_u32 v10, v8, 3, v9
s_cmp_ge_u32 s20, 992
s_cbranch_scc1 L_pack_o
s_cmp_ge_u32 s20, 864
s_cbranch_scc1 L_pack_q
s_cmp_ge_u32 s20, 576
s_cbranch_scc1 L_pack_d
s_mul_i32 s21, s2, 911
s_lshr_b32 s21, s21, 16
s_mul_i32 s22, s21, 72
s_sub_u32 s22, s2, s22
s_mul_i32 s23, s22, 7282
s_lshr_b32 s23, s23, 16
s_mul_i32 s24, s23, 9
s_sub_u32 s24, s22, s24
s_lshl_b32 s24, s24, 2
s_add_u32 s24, s24, s4
s_load_dwordx4 s[36:39], s[0:1], 32
s_waitcnt lgkmcnt(0)
s_cmp_eq_u32 s21, 0
s_cselect_b64 s[12:13], s[36:37], s[38:39]
s_mov_b32 s16, s12
s_and_b32 s17, s13, 0xffff
s_mov_b32 s18, 5308416
s_mov_b32 s19, 0x20000
s_lshr_b32 s26, s24, 1
s_lshl_b32 s26, s26, 5
s_and_b32 s27, s24, 1
s_lshl_b32 s27, s27, 2
s_add_u32 s26, s26, s27
s_mul_i32 s27, s23, 576
s_add_u32 s26, s26, s27
v_add_u32 v11, s26, v10
v_lshlrev_b32 v11, 1, v11
v_mul_u32_u24 v12, 73728, v7
v_add_u32 v4, v11, v12
s_mul_i32 s27, s24, 7282
s_lshr_b32 s27, s27, 16
s_mul_i32 s28, s27, 9
s_sub_u32 s28, s24, s28
s_add_u32 s29, s28, 1
s_cmp_eq_u32 s29, 9
s_cselect_b32 s29, 0, s29
s_and_b32 s30, s27, 1
s_cmp_eq_u32 s30, 0
s_cselect_b32 s28, s29, s28
s_lshl_b32 s29, s23, 2
s_add_u32 s29, s29, s27
s_mul_i32 s29, s29, 497664
s_mul_i32 s28, s28, 36864
s_add_u32 s29, s29, s28
s_lshl_b32 s21, s21, 11
s_add_u32 s29, s29, s21
s_add_u32 s29, s29, 3366912
s_mov_b32 s40, 0
buffer_load_ushort v16, v4, s[16:19], s40 offen
s_mov_b32 s40, 9216
buffer_load_ushort v17, v4, s[16:19], s40 offen
s_mov_b32 s40, 18432
buffer_load_ushort v18, v4, s[16:19], s40 offen
s_mov_b32 s40, 27648
buffer_load_ushort v19, v4, s[16:19], s40 offen
s_mov_b32 s40, 36864
buffer_load_ushort v20, v4, s[16:19], s40 offen
s_mov_b32 s40, 46080
buffer_load_ushort v21, v4, s[16:19], s40 offen
s_mov_b32 s40, 55296
buffer_load_ushort v22, v4, s[16:19], s40 offen
s_mov_b32 s40, 64512
buffer_load_ushort v23, v4, s[16:19], s40 offen
s_mov_b32 s40, 294912
buffer_load_ushort v24, v4, s[16:19], s40 offen
s_mov_b32 s40, 304128
buffer_load_ushort v25, v4, s[16:19], s40 offen
s_mov_b32 s40, 313344
buffer_load_ushort v26, v4, s[16:19], s40 offen
s_mov_b32 s40, 322560
buffer_load_ushort v27, v4, s[16:19], s40 offen
s_mov_b32 s40, 331776
buffer_load_ushort v28, v4, s[16:19], s40 offen
s_mov_b32 s40, 340992
buffer_load_ushort v29, v4, s[16:19], s40 offen
s_mov_b32 s40, 350208
buffer_load_ushort v30, v4, s[16:19], s40 offen
s_mov_b32 s40, 359424
buffer_load_ushort v31, v4, s[16:19], s40 offen
s_mov_b32 s40, 589824
buffer_load_ushort v32, v4, s[16:19], s40 offen
s_mov_b32 s40, 599040
buffer_load_ushort v33, v4, s[16:19], s40 offen
s_mov_b32 s40, 608256
buffer_load_ushort v34, v4, s[16:19], s40 offen
s_mov_b32 s40, 617472
buffer_load_ushort v35, v4, s[16:19], s40 offen
s_mov_b32 s40, 626688
buffer_load_ushort v36, v4, s[16:19], s40 offen
s_mov_b32 s40, 635904
buffer_load_ushort v37, v4, s[16:19], s40 offen
s_mov_b32 s40, 645120
buffer_load_ushort v38, v4, s[16:19], s40 offen
s_mov_b32 s40, 654336
buffer_load_ushort v39, v4, s[16:19], s40 offen
s_mov_b32 s40, 884736
buffer_load_ushort v40, v4, s[16:19], s40 offen
s_mov_b32 s40, 893952
buffer_load_ushort v41, v4, s[16:19], s40 offen
s_mov_b32 s40, 903168
buffer_load_ushort v42, v4, s[16:19], s40 offen
s_mov_b32 s40, 912384
buffer_load_ushort v43, v4, s[16:19], s40 offen
s_mov_b32 s40, 921600
buffer_load_ushort v44, v4, s[16:19], s40 offen
s_mov_b32 s40, 930816
buffer_load_ushort v45, v4, s[16:19], s40 offen
s_mov_b32 s40, 940032
buffer_load_ushort v46, v4, s[16:19], s40 offen
s_mov_b32 s40, 949248
buffer_load_ushort v47, v4, s[16:19], s40 offen
s_mov_b32 s40, 1179648
buffer_load_ushort v48, v4, s[16:19], s40 offen
s_mov_b32 s40, 1188864
buffer_load_ushort v49, v4, s[16:19], s40 offen
s_mov_b32 s40, 1198080
buffer_load_ushort v50, v4, s[16:19], s40 offen
s_mov_b32 s40, 1207296
buffer_load_ushort v51, v4, s[16:19], s40 offen
s_mov_b32 s40, 1216512
buffer_load_ushort v52, v4, s[16:19], s40 offen
s_mov_b32 s40, 1225728
buffer_load_ushort v53, v4, s[16:19], s40 offen
s_mov_b32 s40, 1234944
buffer_load_ushort v54, v4, s[16:19], s40 offen
s_mov_b32 s40, 1244160
buffer_load_ushort v55, v4, s[16:19], s40 offen
s_mov_b32 s40, 1474560
buffer_load_ushort v56, v4, s[16:19], s40 offen
s_mov_b32 s40, 1483776
buffer_load_ushort v57, v4, s[16:19], s40 offen
s_mov_b32 s40, 1492992
buffer_load_ushort v58, v4, s[16:19], s40 offen
s_mov_b32 s40, 1502208
buffer_load_ushort v59, v4, s[16:19], s40 offen
s_mov_b32 s40, 1511424
buffer_load_ushort v60, v4, s[16:19], s40 offen
s_mov_b32 s40, 1520640
buffer_load_ushort v61, v4, s[16:19], s40 offen
s_mov_b32 s40, 1529856
buffer_load_ushort v62, v4, s[16:19], s40 offen
s_mov_b32 s40, 1539072
buffer_load_ushort v63, v4, s[16:19], s40 offen
s_waitcnt vmcnt(40)
v_lshl_or_b32 v80, v17, 16, v16
v_lshl_or_b32 v81, v19, 16, v18
v_lshl_or_b32 v82, v21, 16, v20
v_lshl_or_b32 v83, v23, 16, v22
s_waitcnt vmcnt(32)
v_lshl_or_b32 v84, v25, 16, v24
v_lshl_or_b32 v85, v27, 16, v26
v_lshl_or_b32 v86, v29, 16, v28
v_lshl_or_b32 v87, v31, 16, v30
s_waitcnt vmcnt(24)
v_lshl_or_b32 v88, v33, 16, v32
v_lshl_or_b32 v89, v35, 16, v34
v_lshl_or_b32 v90, v37, 16, v36
v_lshl_or_b32 v91, v39, 16, v38
s_waitcnt vmcnt(16)
v_lshl_or_b32 v92, v41, 16, v40
v_lshl_or_b32 v93, v43, 16, v42
v_lshl_or_b32 v94, v45, 16, v44
v_lshl_or_b32 v95, v47, 16, v46
s_waitcnt vmcnt(8)
v_lshl_or_b32 v96, v49, 16, v48
v_lshl_or_b32 v97, v51, 16, v50
v_lshl_or_b32 v98, v53, 16, v52
v_lshl_or_b32 v99, v55, 16, v54
s_waitcnt vmcnt(0)
v_lshl_or_b32 v100, v57, 16, v56
v_lshl_or_b32 v101, v59, 16, v58
v_lshl_or_b32 v102, v61, 16, v60
v_lshl_or_b32 v103, v63, 16, v62
s_mov_b32 s40, 1769472
buffer_load_ushort v16, v4, s[16:19], s40 offen
s_mov_b32 s40, 1778688
buffer_load_ushort v17, v4, s[16:19], s40 offen
s_mov_b32 s40, 1787904
buffer_load_ushort v18, v4, s[16:19], s40 offen
s_mov_b32 s40, 1797120
buffer_load_ushort v19, v4, s[16:19], s40 offen
s_mov_b32 s40, 1806336
buffer_load_ushort v20, v4, s[16:19], s40 offen
s_mov_b32 s40, 1815552
buffer_load_ushort v21, v4, s[16:19], s40 offen
s_mov_b32 s40, 1824768
buffer_load_ushort v22, v4, s[16:19], s40 offen
s_mov_b32 s40, 1833984
buffer_load_ushort v23, v4, s[16:19], s40 offen
s_mov_b32 s40, 2064384
buffer_load_ushort v24, v4, s[16:19], s40 offen
s_mov_b32 s40, 2073600
buffer_load_ushort v25, v4, s[16:19], s40 offen
s_mov_b32 s40, 2082816
buffer_load_ushort v26, v4, s[16:19], s40 offen
s_mov_b32 s40, 2092032
buffer_load_ushort v27, v4, s[16:19], s40 offen
s_mov_b32 s40, 2101248
buffer_load_ushort v28, v4, s[16:19], s40 offen
s_mov_b32 s40, 2110464
buffer_load_ushort v29, v4, s[16:19], s40 offen
s_mov_b32 s40, 2119680
buffer_load_ushort v30, v4, s[16:19], s40 offen
s_mov_b32 s40, 2128896
buffer_load_ushort v31, v4, s[16:19], s40 offen
s_mov_b32 s40, 2359296
buffer_load_ushort v32, v4, s[16:19], s40 offen
s_mov_b32 s40, 2368512
buffer_load_ushort v33, v4, s[16:19], s40 offen
s_mov_b32 s40, 2377728
buffer_load_ushort v34, v4, s[16:19], s40 offen
s_mov_b32 s40, 2386944
buffer_load_ushort v35, v4, s[16:19], s40 offen
s_mov_b32 s40, 2396160
buffer_load_ushort v36, v4, s[16:19], s40 offen
s_mov_b32 s40, 2405376
buffer_load_ushort v37, v4, s[16:19], s40 offen
s_mov_b32 s40, 2414592
buffer_load_ushort v38, v4, s[16:19], s40 offen
s_mov_b32 s40, 2423808
buffer_load_ushort v39, v4, s[16:19], s40 offen
s_mov_b32 s40, 2654208
buffer_load_ushort v40, v4, s[16:19], s40 offen
s_mov_b32 s40, 2663424
buffer_load_ushort v41, v4, s[16:19], s40 offen
s_mov_b32 s40, 2672640
buffer_load_ushort v42, v4, s[16:19], s40 offen
s_mov_b32 s40, 2681856
buffer_load_ushort v43, v4, s[16:19], s40 offen
s_mov_b32 s40, 2691072
buffer_load_ushort v44, v4, s[16:19], s40 offen
s_mov_b32 s40, 2700288
buffer_load_ushort v45, v4, s[16:19], s40 offen
s_mov_b32 s40, 2709504
buffer_load_ushort v46, v4, s[16:19], s40 offen
s_mov_b32 s40, 2718720
buffer_load_ushort v47, v4, s[16:19], s40 offen
s_mov_b32 s40, 2949120
buffer_load_ushort v48, v4, s[16:19], s40 offen
s_mov_b32 s40, 2958336
buffer_load_ushort v49, v4, s[16:19], s40 offen
s_mov_b32 s40, 2967552
buffer_load_ushort v50, v4, s[16:19], s40 offen
s_mov_b32 s40, 2976768
buffer_load_ushort v51, v4, s[16:19], s40 offen
s_mov_b32 s40, 2985984
buffer_load_ushort v52, v4, s[16:19], s40 offen
s_mov_b32 s40, 2995200
buffer_load_ushort v53, v4, s[16:19], s40 offen
s_mov_b32 s40, 3004416
buffer_load_ushort v54, v4, s[16:19], s40 offen
s_mov_b32 s40, 3013632
buffer_load_ushort v55, v4, s[16:19], s40 offen
s_mov_b32 s40, 3244032
buffer_load_ushort v56, v4, s[16:19], s40 offen
s_mov_b32 s40, 3253248
buffer_load_ushort v57, v4, s[16:19], s40 offen
s_mov_b32 s40, 3262464
buffer_load_ushort v58, v4, s[16:19], s40 offen
s_mov_b32 s40, 3271680
buffer_load_ushort v59, v4, s[16:19], s40 offen
s_mov_b32 s40, 3280896
buffer_load_ushort v60, v4, s[16:19], s40 offen
s_mov_b32 s40, 3290112
buffer_load_ushort v61, v4, s[16:19], s40 offen
s_mov_b32 s40, 3299328
buffer_load_ushort v62, v4, s[16:19], s40 offen
s_mov_b32 s40, 3308544
buffer_load_ushort v63, v4, s[16:19], s40 offen
s_waitcnt vmcnt(40)
v_lshl_or_b32 v104, v17, 16, v16
v_lshl_or_b32 v105, v19, 16, v18
v_lshl_or_b32 v106, v21, 16, v20
v_lshl_or_b32 v107, v23, 16, v22
s_waitcnt vmcnt(32)
v_lshl_or_b32 v108, v25, 16, v24
v_lshl_or_b32 v109, v27, 16, v26
v_lshl_or_b32 v110, v29, 16, v28
v_lshl_or_b32 v111, v31, 16, v30
s_waitcnt vmcnt(24)
v_lshl_or_b32 v112, v33, 16, v32
v_lshl_or_b32 v113, v35, 16, v34
v_lshl_or_b32 v114, v37, 16, v36
v_lshl_or_b32 v115, v39, 16, v38
s_waitcnt vmcnt(16)
v_lshl_or_b32 v116, v41, 16, v40
v_lshl_or_b32 v117, v43, 16, v42
v_lshl_or_b32 v118, v45, 16, v44
v_lshl_or_b32 v119, v47, 16, v46
s_waitcnt vmcnt(8)
v_lshl_or_b32 v120, v49, 16, v48
v_lshl_or_b32 v121, v51, 16, v50
v_lshl_or_b32 v122, v53, 16, v52
v_lshl_or_b32 v123, v55, 16, v54
s_waitcnt vmcnt(0)
v_lshl_or_b32 v124, v57, 16, v56
v_lshl_or_b32 v125, v59, 16, v58
v_lshl_or_b32 v126, v61, 16, v60
v_lshl_or_b32 v127, v63, 16, v62
s_mov_b32 s40, 3538944
buffer_load_ushort v16, v4, s[16:19], s40 offen
s_mov_b32 s40, 3548160
buffer_load_ushort v17, v4, s[16:19], s40 offen
s_mov_b32 s40, 3557376
buffer_load_ushort v18, v4, s[16:19], s40 offen
s_mov_b32 s40, 3566592
buffer_load_ushort v19, v4, s[16:19], s40 offen
s_mov_b32 s40, 3575808
buffer_load_ushort v20, v4, s[16:19], s40 offen
s_mov_b32 s40, 3585024
buffer_load_ushort v21, v4, s[16:19], s40 offen
s_mov_b32 s40, 3594240
buffer_load_ushort v22, v4, s[16:19], s40 offen
s_mov_b32 s40, 3603456
buffer_load_ushort v23, v4, s[16:19], s40 offen
s_mov_b32 s40, 3833856
buffer_load_ushort v24, v4, s[16:19], s40 offen
s_mov_b32 s40, 3843072
buffer_load_ushort v25, v4, s[16:19], s40 offen
s_mov_b32 s40, 3852288
buffer_load_ushort v26, v4, s[16:19], s40 offen
s_mov_b32 s40, 3861504
buffer_load_ushort v27, v4, s[16:19], s40 offen
s_mov_b32 s40, 3870720
buffer_load_ushort v28, v4, s[16:19], s40 offen
s_mov_b32 s40, 3879936
buffer_load_ushort v29, v4, s[16:19], s40 offen
s_mov_b32 s40, 3889152
buffer_load_ushort v30, v4, s[16:19], s40 offen
s_mov_b32 s40, 3898368
buffer_load_ushort v31, v4, s[16:19], s40 offen
s_mov_b32 s40, 4128768
buffer_load_ushort v32, v4, s[16:19], s40 offen
s_mov_b32 s40, 4137984
buffer_load_ushort v33, v4, s[16:19], s40 offen
s_mov_b32 s40, 4147200
buffer_load_ushort v34, v4, s[16:19], s40 offen
s_mov_b32 s40, 4156416
buffer_load_ushort v35, v4, s[16:19], s40 offen
s_mov_b32 s40, 4165632
buffer_load_ushort v36, v4, s[16:19], s40 offen
s_mov_b32 s40, 4174848
buffer_load_ushort v37, v4, s[16:19], s40 offen
s_mov_b32 s40, 4184064
buffer_load_ushort v38, v4, s[16:19], s40 offen
s_mov_b32 s40, 4193280
buffer_load_ushort v39, v4, s[16:19], s40 offen
s_mov_b32 s40, 4423680
buffer_load_ushort v40, v4, s[16:19], s40 offen
s_mov_b32 s40, 4432896
buffer_load_ushort v41, v4, s[16:19], s40 offen
s_mov_b32 s40, 4442112
buffer_load_ushort v42, v4, s[16:19], s40 offen
s_mov_b32 s40, 4451328
buffer_load_ushort v43, v4, s[16:19], s40 offen
s_mov_b32 s40, 4460544
buffer_load_ushort v44, v4, s[16:19], s40 offen
s_mov_b32 s40, 4469760
buffer_load_ushort v45, v4, s[16:19], s40 offen
s_mov_b32 s40, 4478976
buffer_load_ushort v46, v4, s[16:19], s40 offen
s_mov_b32 s40, 4488192
buffer_load_ushort v47, v4, s[16:19], s40 offen
s_mov_b32 s40, 4718592
buffer_load_ushort v48, v4, s[16:19], s40 offen
s_mov_b32 s40, 4727808
buffer_load_ushort v49, v4, s[16:19], s40 offen
s_mov_b32 s40, 4737024
buffer_load_ushort v50, v4, s[16:19], s40 offen
s_mov_b32 s40, 4746240
buffer_load_ushort v51, v4, s[16:19], s40 offen
s_mov_b32 s40, 4755456
buffer_load_ushort v52, v4, s[16:19], s40 offen
s_mov_b32 s40, 4764672
buffer_load_ushort v53, v4, s[16:19], s40 offen
s_mov_b32 s40, 4773888
buffer_load_ushort v54, v4, s[16:19], s40 offen
s_mov_b32 s40, 4783104
buffer_load_ushort v55, v4, s[16:19], s40 offen
s_mov_b32 s40, 5013504
buffer_load_ushort v56, v4, s[16:19], s40 offen
s_mov_b32 s40, 5022720
buffer_load_ushort v57, v4, s[16:19], s40 offen
s_mov_b32 s40, 5031936
buffer_load_ushort v58, v4, s[16:19], s40 offen
s_mov_b32 s40, 5041152
buffer_load_ushort v59, v4, s[16:19], s40 offen
s_mov_b32 s40, 5050368
buffer_load_ushort v60, v4, s[16:19], s40 offen
s_mov_b32 s40, 5059584
buffer_load_ushort v61, v4, s[16:19], s40 offen
s_mov_b32 s40, 5068800
buffer_load_ushort v62, v4, s[16:19], s40 offen
s_mov_b32 s40, 5078016
buffer_load_ushort v63, v4, s[16:19], s40 offen
s_waitcnt vmcnt(40)
v_lshl_or_b32 v128, v17, 16, v16
v_lshl_or_b32 v129, v19, 16, v18
v_lshl_or_b32 v130, v21, 16, v20
v_lshl_or_b32 v131, v23, 16, v22
s_waitcnt vmcnt(32)
v_lshl_or_b32 v132, v25, 16, v24
v_lshl_or_b32 v133, v27, 16, v26
v_lshl_or_b32 v134, v29, 16, v28
v_lshl_or_b32 v135, v31, 16, v30
s_waitcnt vmcnt(24)
v_lshl_or_b32 v136, v33, 16, v32
v_lshl_or_b32 v137, v35, 16, v34
v_lshl_or_b32 v138, v37, 16, v36
v_lshl_or_b32 v139, v39, 16, v38
s_waitcnt vmcnt(16)
v_lshl_or_b32 v140, v41, 16, v40
v_lshl_or_b32 v141, v43, 16, v42
v_lshl_or_b32 v142, v45, 16, v44
v_lshl_or_b32 v143, v47, 16, v46
s_waitcnt vmcnt(8)
v_lshl_or_b32 v144, v49, 16, v48
v_lshl_or_b32 v145, v51, 16, v50
v_lshl_or_b32 v146, v53, 16, v52
v_lshl_or_b32 v147, v55, 16, v54
s_waitcnt vmcnt(0)
v_lshl_or_b32 v148, v57, 16, v56
v_lshl_or_b32 v149, v59, 16, v58
v_lshl_or_b32 v150, v61, 16, v60
v_lshl_or_b32 v151, v63, 16, v62
s_mov_b32 s31, 0x3f803f80
v_mov_b32 v12, 0
v_mov_b32 v13, 0
v_dot2_f32_bf16 v12, v80, s31, v12
v_dot2_f32_bf16 v13, v81, s31, v13
v_dot2_f32_bf16 v12, v82, s31, v12
v_dot2_f32_bf16 v13, v83, s31, v13
v_dot2_f32_bf16 v12, v84, s31, v12
v_dot2_f32_bf16 v13, v85, s31, v13
v_dot2_f32_bf16 v12, v86, s31, v12
v_dot2_f32_bf16 v13, v87, s31, v13
v_dot2_f32_bf16 v12, v88, s31, v12
v_dot2_f32_bf16 v13, v89, s31, v13
v_dot2_f32_bf16 v12, v90, s31, v12
v_dot2_f32_bf16 v13, v91, s31, v13
v_dot2_f32_bf16 v12, v92, s31, v12
v_dot2_f32_bf16 v13, v93, s31, v13
v_dot2_f32_bf16 v12, v94, s31, v12
v_dot2_f32_bf16 v13, v95, s31, v13
v_dot2_f32_bf16 v12, v96, s31, v12
v_dot2_f32_bf16 v13, v97, s31, v13
v_dot2_f32_bf16 v12, v98, s31, v12
v_dot2_f32_bf16 v13, v99, s31, v13
v_dot2_f32_bf16 v12, v100, s31, v12
v_dot2_f32_bf16 v13, v101, s31, v13
v_dot2_f32_bf16 v12, v102, s31, v12
v_dot2_f32_bf16 v13, v103, s31, v13
v_dot2_f32_bf16 v12, v104, s31, v12
v_dot2_f32_bf16 v13, v105, s31, v13
v_dot2_f32_bf16 v12, v106, s31, v12
v_dot2_f32_bf16 v13, v107, s31, v13
v_dot2_f32_bf16 v12, v108, s31, v12
v_dot2_f32_bf16 v13, v109, s31, v13
v_dot2_f32_bf16 v12, v110, s31, v12
v_dot2_f32_bf16 v13, v111, s31, v13
v_dot2_f32_bf16 v12, v112, s31, v12
v_dot2_f32_bf16 v13, v113, s31, v13
v_dot2_f32_bf16 v12, v114, s31, v12
v_dot2_f32_bf16 v13, v115, s31, v13
v_dot2_f32_bf16 v12, v116, s31, v12
v_dot2_f32_bf16 v13, v117, s31, v13
v_dot2_f32_bf16 v12, v118, s31, v12
v_dot2_f32_bf16 v13, v119, s31, v13
v_dot2_f32_bf16 v12, v120, s31, v12
v_dot2_f32_bf16 v13, v121, s31, v13
v_dot2_f32_bf16 v12, v122, s31, v12
v_dot2_f32_bf16 v13, v123, s31, v13
v_dot2_f32_bf16 v12, v124, s31, v12
v_dot2_f32_bf16 v13, v125, s31, v13
v_dot2_f32_bf16 v12, v126, s31, v12
v_dot2_f32_bf16 v13, v127, s31, v13
v_dot2_f32_bf16 v12, v128, s31, v12
v_dot2_f32_bf16 v13, v129, s31, v13
v_dot2_f32_bf16 v12, v130, s31, v12
v_dot2_f32_bf16 v13, v131, s31, v13
v_dot2_f32_bf16 v12, v132, s31, v12
v_dot2_f32_bf16 v13, v133, s31, v13
v_dot2_f32_bf16 v12, v134, s31, v12
v_dot2_f32_bf16 v13, v135, s31, v13
v_dot2_f32_bf16 v12, v136, s31, v12
v_dot2_f32_bf16 v13, v137, s31, v13
v_dot2_f32_bf16 v12, v138, s31, v12
v_dot2_f32_bf16 v13, v139, s31, v13
v_dot2_f32_bf16 v12, v140, s31, v12
v_dot2_f32_bf16 v13, v141, s31, v13
v_dot2_f32_bf16 v12, v142, s31, v12
v_dot2_f32_bf16 v13, v143, s31, v13
v_dot2_f32_bf16 v12, v144, s31, v12
v_dot2_f32_bf16 v13, v145, s31, v13
v_dot2_f32_bf16 v12, v146, s31, v12
v_dot2_f32_bf16 v13, v147, s31, v13
v_dot2_f32_bf16 v12, v148, s31, v12
v_dot2_f32_bf16 v13, v149, s31, v13
v_dot2_f32_bf16 v12, v150, s31, v12
v_dot2_f32_bf16 v13, v151, s31, v13
s_nop 2
v_add_f32 v12, v12, v13
v_mov_b32 v13, v12
s_nop 1
v_permlane16_swap_b32 v12, v13
v_add_f32 v12, v12, v13
v_mov_b32 v13, v12
s_nop 1
v_permlane32_swap_b32 v12, v13
v_add_f32 v12, v12, v13
v_mul_f32 v12, 0x3ae38e39, v12
v_lshlrev_b32 v16, 16, v80
v_and_b32 v17, 0xffff0000, v80
v_sub_f32 v16, v16, v12
v_sub_f32 v17, v17, v12
v_cvt_pk_bf16_f32 v80, v16, v17
v_lshlrev_b32 v18, 16, v81
v_and_b32 v19, 0xffff0000, v81
v_sub_f32 v18, v18, v12
v_sub_f32 v19, v19, v12
v_cvt_pk_bf16_f32 v81, v18, v19
v_lshlrev_b32 v20, 16, v82
v_and_b32 v21, 0xffff0000, v82
v_sub_f32 v20, v20, v12
v_sub_f32 v21, v21, v12
v_cvt_pk_bf16_f32 v82, v20, v21
v_lshlrev_b32 v22, 16, v83
v_and_b32 v23, 0xffff0000, v83
v_sub_f32 v22, v22, v12
v_sub_f32 v23, v23, v12
v_cvt_pk_bf16_f32 v83, v22, v23
v_lshlrev_b32 v16, 16, v84
v_and_b32 v17, 0xffff0000, v84
v_sub_f32 v16, v16, v12
v_sub_f32 v17, v17, v12
v_cvt_pk_bf16_f32 v84, v16, v17
v_lshlrev_b32 v18, 16, v85
v_and_b32 v19, 0xffff0000, v85
v_sub_f32 v18, v18, v12
v_sub_f32 v19, v19, v12
v_cvt_pk_bf16_f32 v85, v18, v19
v_lshlrev_b32 v20, 16, v86
v_and_b32 v21, 0xffff0000, v86
v_sub_f32 v20, v20, v12
v_sub_f32 v21, v21, v12
v_cvt_pk_bf16_f32 v86, v20, v21
v_lshlrev_b32 v22, 16, v87
v_and_b32 v23, 0xffff0000, v87
v_sub_f32 v22, v22, v12
v_sub_f32 v23, v23, v12
v_cvt_pk_bf16_f32 v87, v22, v23
v_lshlrev_b32 v16, 16, v88
v_and_b32 v17, 0xffff0000, v88
v_sub_f32 v16, v16, v12
v_sub_f32 v17, v17, v12
v_cvt_pk_bf16_f32 v88, v16, v17
v_lshlrev_b32 v18, 16, v89
v_and_b32 v19, 0xffff0000, v89
v_sub_f32 v18, v18, v12
v_sub_f32 v19, v19, v12
v_cvt_pk_bf16_f32 v89, v18, v19
v_lshlrev_b32 v20, 16, v90
v_and_b32 v21, 0xffff0000, v90
v_sub_f32 v20, v20, v12
v_sub_f32 v21, v21, v12
v_cvt_pk_bf16_f32 v90, v20, v21
v_lshlrev_b32 v22, 16, v91
v_and_b32 v23, 0xffff0000, v91
v_sub_f32 v22, v22, v12
v_sub_f32 v23, v23, v12
v_cvt_pk_bf16_f32 v91, v22, v23
v_lshlrev_b32 v16, 16, v92
v_and_b32 v17, 0xffff0000, v92
v_sub_f32 v16, v16, v12
v_sub_f32 v17, v17, v12
v_cvt_pk_bf16_f32 v92, v16, v17
v_lshlrev_b32 v18, 16, v93
v_and_b32 v19, 0xffff0000, v93
v_sub_f32 v18, v18, v12
v_sub_f32 v19, v19, v12
v_cvt_pk_bf16_f32 v93, v18, v19
v_lshlrev_b32 v20, 16, v94
v_and_b32 v21, 0xffff0000, v94
v_sub_f32 v20, v20, v12
v_sub_f32 v21, v21, v12
v_cvt_pk_bf16_f32 v94, v20, v21
v_lshlrev_b32 v22, 16, v95
v_and_b32 v23, 0xffff0000, v95
v_sub_f32 v22, v22, v12
v_sub_f32 v23, v23, v12
v_cvt_pk_bf16_f32 v95, v22, v23
v_lshlrev_b32 v16, 16, v96
v_and_b32 v17, 0xffff0000, v96
v_sub_f32 v16, v16, v12
v_sub_f32 v17, v17, v12
v_cvt_pk_bf16_f32 v96, v16, v17
v_lshlrev_b32 v18, 16, v97
v_and_b32 v19, 0xffff0000, v97
v_sub_f32 v18, v18, v12
v_sub_f32 v19, v19, v12
v_cvt_pk_bf16_f32 v97, v18, v19
v_lshlrev_b32 v20, 16, v98
v_and_b32 v21, 0xffff0000, v98
v_sub_f32 v20, v20, v12
v_sub_f32 v21, v21, v12
v_cvt_pk_bf16_f32 v98, v20, v21
v_lshlrev_b32 v22, 16, v99
v_and_b32 v23, 0xffff0000, v99
v_sub_f32 v22, v22, v12
v_sub_f32 v23, v23, v12
v_cvt_pk_bf16_f32 v99, v22, v23
v_lshlrev_b32 v16, 16, v100
v_and_b32 v17, 0xffff0000, v100
v_sub_f32 v16, v16, v12
v_sub_f32 v17, v17, v12
v_cvt_pk_bf16_f32 v100, v16, v17
v_lshlrev_b32 v18, 16, v101
v_and_b32 v19, 0xffff0000, v101
v_sub_f32 v18, v18, v12
v_sub_f32 v19, v19, v12
v_cvt_pk_bf16_f32 v101, v18, v19
v_lshlrev_b32 v20, 16, v102
v_and_b32 v21, 0xffff0000, v102
v_sub_f32 v20, v20, v12
v_sub_f32 v21, v21, v12
v_cvt_pk_bf16_f32 v102, v20, v21
v_lshlrev_b32 v22, 16, v103
v_and_b32 v23, 0xffff0000, v103
v_sub_f32 v22, v22, v12
v_sub_f32 v23, v23, v12
v_cvt_pk_bf16_f32 v103, v22, v23
v_lshlrev_b32 v16, 16, v104
v_and_b32 v17, 0xffff0000, v104
v_sub_f32 v16, v16, v12
v_sub_f32 v17, v17, v12
v_cvt_pk_bf16_f32 v104, v16, v17
v_lshlrev_b32 v18, 16, v105
v_and_b32 v19, 0xffff0000, v105
v_sub_f32 v18, v18, v12
v_sub_f32 v19, v19, v12
v_cvt_pk_bf16_f32 v105, v18, v19
v_lshlrev_b32 v20, 16, v106
v_and_b32 v21, 0xffff0000, v106
v_sub_f32 v20, v20, v12
v_sub_f32 v21, v21, v12
v_cvt_pk_bf16_f32 v106, v20, v21
v_lshlrev_b32 v22, 16, v107
v_and_b32 v23, 0xffff0000, v107
v_sub_f32 v22, v22, v12
v_sub_f32 v23, v23, v12
v_cvt_pk_bf16_f32 v107, v22, v23
v_lshlrev_b32 v16, 16, v108
v_and_b32 v17, 0xffff0000, v108
v_sub_f32 v16, v16, v12
v_sub_f32 v17, v17, v12
v_cvt_pk_bf16_f32 v108, v16, v17
v_lshlrev_b32 v18, 16, v109
v_and_b32 v19, 0xffff0000, v109
v_sub_f32 v18, v18, v12
v_sub_f32 v19, v19, v12
v_cvt_pk_bf16_f32 v109, v18, v19
v_lshlrev_b32 v20, 16, v110
v_and_b32 v21, 0xffff0000, v110
v_sub_f32 v20, v20, v12
v_sub_f32 v21, v21, v12
v_cvt_pk_bf16_f32 v110, v20, v21
v_lshlrev_b32 v22, 16, v111
v_and_b32 v23, 0xffff0000, v111
v_sub_f32 v22, v22, v12
v_sub_f32 v23, v23, v12
v_cvt_pk_bf16_f32 v111, v22, v23
v_lshlrev_b32 v16, 16, v112
v_and_b32 v17, 0xffff0000, v112
v_sub_f32 v16, v16, v12
v_sub_f32 v17, v17, v12
v_cvt_pk_bf16_f32 v112, v16, v17
v_lshlrev_b32 v18, 16, v113
v_and_b32 v19, 0xffff0000, v113
v_sub_f32 v18, v18, v12
v_sub_f32 v19, v19, v12
v_cvt_pk_bf16_f32 v113, v18, v19
v_lshlrev_b32 v20, 16, v114
v_and_b32 v21, 0xffff0000, v114
v_sub_f32 v20, v20, v12
v_sub_f32 v21, v21, v12
v_cvt_pk_bf16_f32 v114, v20, v21
v_lshlrev_b32 v22, 16, v115
v_and_b32 v23, 0xffff0000, v115
v_sub_f32 v22, v22, v12
v_sub_f32 v23, v23, v12
v_cvt_pk_bf16_f32 v115, v22, v23
v_lshlrev_b32 v16, 16, v116
v_and_b32 v17, 0xffff0000, v116
v_sub_f32 v16, v16, v12
v_sub_f32 v17, v17, v12
v_cvt_pk_bf16_f32 v116, v16, v17
v_lshlrev_b32 v18, 16, v117
v_and_b32 v19, 0xffff0000, v117
v_sub_f32 v18, v18, v12
v_sub_f32 v19, v19, v12
v_cvt_pk_bf16_f32 v117, v18, v19
v_lshlrev_b32 v20, 16, v118
v_and_b32 v21, 0xffff0000, v118
v_sub_f32 v20, v20, v12
v_sub_f32 v21, v21, v12
v_cvt_pk_bf16_f32 v118, v20, v21
v_lshlrev_b32 v22, 16, v119
v_and_b32 v23, 0xffff0000, v119
v_sub_f32 v22, v22, v12
v_sub_f32 v23, v23, v12
v_cvt_pk_bf16_f32 v119, v22, v23
v_lshlrev_b32 v16, 16, v120
v_and_b32 v17, 0xffff0000, v120
v_sub_f32 v16, v16, v12
v_sub_f32 v17, v17, v12
v_cvt_pk_bf16_f32 v120, v16, v17
v_lshlrev_b32 v18, 16, v121
v_and_b32 v19, 0xffff0000, v121
v_sub_f32 v18, v18, v12
v_sub_f32 v19, v19, v12
v_cvt_pk_bf16_f32 v121, v18, v19
v_lshlrev_b32 v20, 16, v122
v_and_b32 v21, 0xffff0000, v122
v_sub_f32 v20, v20, v12
v_sub_f32 v21, v21, v12
v_cvt_pk_bf16_f32 v122, v20, v21
v_lshlrev_b32 v22, 16, v123
v_and_b32 v23, 0xffff0000, v123
v_sub_f32 v22, v22, v12
v_sub_f32 v23, v23, v12
v_cvt_pk_bf16_f32 v123, v22, v23
v_lshlrev_b32 v16, 16, v124
v_and_b32 v17, 0xffff0000, v124
v_sub_f32 v16, v16, v12
v_sub_f32 v17, v17, v12
v_cvt_pk_bf16_f32 v124, v16, v17
v_lshlrev_b32 v18, 16, v125
v_and_b32 v19, 0xffff0000, v125
v_sub_f32 v18, v18, v12
v_sub_f32 v19, v19, v12
v_cvt_pk_bf16_f32 v125, v18, v19
v_lshlrev_b32 v20, 16, v126
v_and_b32 v21, 0xffff0000, v126
v_sub_f32 v20, v20, v12
v_sub_f32 v21, v21, v12
v_cvt_pk_bf16_f32 v126, v20, v21
v_lshlrev_b32 v22, 16, v127
v_and_b32 v23, 0xffff0000, v127
v_sub_f32 v22, v22, v12
v_sub_f32 v23, v23, v12
v_cvt_pk_bf16_f32 v127, v22, v23
v_lshlrev_b32 v16, 16, v128
v_and_b32 v17, 0xffff0000, v128
v_sub_f32 v16, v16, v12
v_sub_f32 v17, v17, v12
v_cvt_pk_bf16_f32 v128, v16, v17
v_lshlrev_b32 v18, 16, v129
v_and_b32 v19, 0xffff0000, v129
v_sub_f32 v18, v18, v12
v_sub_f32 v19, v19, v12
v_cvt_pk_bf16_f32 v129, v18, v19
v_lshlrev_b32 v20, 16, v130
v_and_b32 v21, 0xffff0000, v130
v_sub_f32 v20, v20, v12
v_sub_f32 v21, v21, v12
v_cvt_pk_bf16_f32 v130, v20, v21
v_lshlrev_b32 v22, 16, v131
v_and_b32 v23, 0xffff0000, v131
v_sub_f32 v22, v22, v12
v_sub_f32 v23, v23, v12
v_cvt_pk_bf16_f32 v131, v22, v23
v_lshlrev_b32 v16, 16, v132
v_and_b32 v17, 0xffff0000, v132
v_sub_f32 v16, v16, v12
v_sub_f32 v17, v17, v12
v_cvt_pk_bf16_f32 v132, v16, v17
v_lshlrev_b32 v18, 16, v133
v_and_b32 v19, 0xffff0000, v133
v_sub_f32 v18, v18, v12
v_sub_f32 v19, v19, v12
v_cvt_pk_bf16_f32 v133, v18, v19
v_lshlrev_b32 v20, 16, v134
v_and_b32 v21, 0xffff0000, v134
v_sub_f32 v20, v20, v12
v_sub_f32 v21, v21, v12
v_cvt_pk_bf16_f32 v134, v20, v21
v_lshlrev_b32 v22, 16, v135
v_and_b32 v23, 0xffff0000, v135
v_sub_f32 v22, v22, v12
v_sub_f32 v23, v23, v12
v_cvt_pk_bf16_f32 v135, v22, v23
v_lshlrev_b32 v16, 16, v136
v_and_b32 v17, 0xffff0000, v136
v_sub_f32 v16, v16, v12
v_sub_f32 v17, v17, v12
v_cvt_pk_bf16_f32 v136, v16, v17
v_lshlrev_b32 v18, 16, v137
v_and_b32 v19, 0xffff0000, v137
v_sub_f32 v18, v18, v12
v_sub_f32 v19, v19, v12
v_cvt_pk_bf16_f32 v137, v18, v19
v_lshlrev_b32 v20, 16, v138
v_and_b32 v21, 0xffff0000, v138
v_sub_f32 v20, v20, v12
v_sub_f32 v21, v21, v12
v_cvt_pk_bf16_f32 v138, v20, v21
v_lshlrev_b32 v22, 16, v139
v_and_b32 v23, 0xffff0000, v139
v_sub_f32 v22, v22, v12
v_sub_f32 v23, v23, v12
v_cvt_pk_bf16_f32 v139, v22, v23
v_lshlrev_b32 v16, 16, v140
v_and_b32 v17, 0xffff0000, v140
v_sub_f32 v16, v16, v12
v_sub_f32 v17, v17, v12
v_cvt_pk_bf16_f32 v140, v16, v17
v_lshlrev_b32 v18, 16, v141
v_and_b32 v19, 0xffff0000, v141
v_sub_f32 v18, v18, v12
v_sub_f32 v19, v19, v12
v_cvt_pk_bf16_f32 v141, v18, v19
v_lshlrev_b32 v20, 16, v142
v_and_b32 v21, 0xffff0000, v142
v_sub_f32 v20, v20, v12
v_sub_f32 v21, v21, v12
v_cvt_pk_bf16_f32 v142, v20, v21
v_lshlrev_b32 v22, 16, v143
v_and_b32 v23, 0xffff0000, v143
v_sub_f32 v22, v22, v12
v_sub_f32 v23, v23, v12
v_cvt_pk_bf16_f32 v143, v22, v23
v_lshlrev_b32 v16, 16, v144
v_and_b32 v17, 0xffff0000, v144
v_sub_f32 v16, v16, v12
v_sub_f32 v17, v17, v12
v_cvt_pk_bf16_f32 v144, v16, v17
v_lshlrev_b32 v18, 16, v145
v_and_b32 v19, 0xffff0000, v145
v_sub_f32 v18, v18, v12
v_sub_f32 v19, v19, v12
v_cvt_pk_bf16_f32 v145, v18, v19
v_lshlrev_b32 v20, 16, v146
v_and_b32 v21, 0xffff0000, v146
v_sub_f32 v20, v20, v12
v_sub_f32 v21, v21, v12
v_cvt_pk_bf16_f32 v146, v20, v21
v_lshlrev_b32 v22, 16, v147
v_and_b32 v23, 0xffff0000, v147
v_sub_f32 v22, v22, v12
v_sub_f32 v23, v23, v12
v_cvt_pk_bf16_f32 v147, v22, v23
v_lshlrev_b32 v16, 16, v148
v_and_b32 v17, 0xffff0000, v148
v_sub_f32 v16, v16, v12
v_sub_f32 v17, v17, v12
v_cvt_pk_bf16_f32 v148, v16, v17
v_lshlrev_b32 v18, 16, v149
v_and_b32 v19, 0xffff0000, v149
v_sub_f32 v18, v18, v12
v_sub_f32 v19, v19, v12
v_cvt_pk_bf16_f32 v149, v18, v19
v_lshlrev_b32 v20, 16, v150
v_and_b32 v21, 0xffff0000, v150
v_sub_f32 v20, v20, v12
v_sub_f32 v21, v21, v12
v_cvt_pk_bf16_f32 v150, v20, v21
v_lshlrev_b32 v22, 16, v151
v_and_b32 v23, 0xffff0000, v151
v_sub_f32 v22, v22, v12
v_sub_f32 v23, v23, v12
v_cvt_pk_bf16_f32 v151, v22, v23
s_add_u32 s40, s29, 0
buffer_store_dwordx4 v[80:83], v2, s[8:11], s40 offen
s_add_u32 s40, s29, 1024
buffer_store_dwordx4 v[84:87], v2, s[8:11], s40 offen
s_add_u32 s40, s29, 4096
buffer_store_dwordx4 v[88:91], v2, s[8:11], s40 offen
s_add_u32 s40, s29, 5120
buffer_store_dwordx4 v[92:95], v2, s[8:11], s40 offen
s_add_u32 s40, s29, 8192
buffer_store_dwordx4 v[96:99], v2, s[8:11], s40 offen
s_add_u32 s40, s29, 9216
buffer_store_dwordx4 v[100:103], v2, s[8:11], s40 offen
s_add_u32 s40, s29, 12288
buffer_store_dwordx4 v[104:107], v2, s[8:11], s40 offen
s_add_u32 s40, s29, 13312
buffer_store_dwordx4 v[108:111], v2, s[8:11], s40 offen
s_add_u32 s40, s29, 16384
buffer_store_dwordx4 v[112:115], v2, s[8:11], s40 offen
s_add_u32 s40, s29, 17408
buffer_store_dwordx4 v[116:119], v2, s[8:11], s40 offen
s_add_u32 s40, s29, 20480
buffer_store_dwordx4 v[120:123], v2, s[8:11], s40 offen
s_add_u32 s40, s29, 21504
buffer_store_dwordx4 v[124:127], v2, s[8:11], s40 offen
s_add_u32 s40, s29, 24576
buffer_store_dwordx4 v[128:131], v2, s[8:11], s40 offen
s_add_u32 s40, s29, 25600
buffer_store_dwordx4 v[132:135], v2, s[8:11], s40 offen
s_add_u32 s40, s29, 28672
buffer_store_dwordx4 v[136:139], v2, s[8:11], s40 offen
s_add_u32 s40, s29, 29696
buffer_store_dwordx4 v[140:143], v2, s[8:11], s40 offen
s_add_u32 s40, s29, 32768
buffer_store_dwordx4 v[144:147], v2, s[8:11], s40 offen
s_add_u32 s40, s29, 33792
buffer_store_dwordx4 v[148:151], v2, s[8:11], s40 offen
s_branch L_prep_end
L_pack_d:
s_sub_u32 s20, s20, 576
s_mul_i32 s21, s20, 7282
s_lshr_b32 s21, s21, 16
s_mul_i32 s22, s21, 9
s_sub_u32 s22, s20, s22
s_lshr_b32 s23, s21, 2
s_and_b32 s24, s21, 3
s_load_dwordx2 s[12:13], s[0:1], 48
s_waitcnt lgkmcnt(0)
s_mov_b32 s16, s12
s_and_b32 s17, s13, 0xffff
s_mov_b32 s18, 5308416
s_mov_b32 s19, 0x20000
s_lshr_b32 s25, s22, 1
s_lshl_b32 s25, s25, 5
s_and_b32 s26, s22, 1
s_lshl_b32 s26, s26, 2
s_add_u32 s25, s25, s26
s_mul_i32 s26, s24, 144
s_add_u32 s25, s25, s26
s_cmp_eq_u32 s22, 8
s_cselect_b64 vcc, -1, 0
v_cndmask_b32 v11, v10, v6, vcc
v_add_u32 v11, s25, v11
v_lshlrev_b32 v11, 1, v11
v_mul_u32_u24 v12, 9216, v7
v_add_u32 v4, v11, v12
s_mul_i32 s26, s23, 663552
s_add_u32 s27, s24, 0
s_and_b32 s27, s27, 3
s_mul_i32 s27, s27, 9
s_add_u32 s27, s27, 1
s_lshr_b32 s27, s27, 1
s_mul_i32 s27, s27, 36864
s_add_u32 s32, s26, s27
s_add_u32 s27, s24, 1
s_and_b32 s27, s27, 3
s_mul_i32 s27, s27, 9
s_add_u32 s27, s27, 1
s_lshr_b32 s27, s27, 1
s_mul_i32 s27, s27, 36864
s_add_u32 s33, s26, s27
s_add_u32 s27, s24, 2
s_and_b32 s27, s27, 3
s_mul_i32 s27, s27, 9
s_add_u32 s27, s27, 1
s_lshr_b32 s27, s27, 1
s_mul_i32 s27, s27, 36864
s_add_u32 s34, s26, s27
s_add_u32 s27, s24, 3
s_and_b32 s27, s27, 3
s_mul_i32 s27, s27, 9
s_add_u32 s27, s27, 1
s_lshr_b32 s27, s27, 1
s_mul_i32 s27, s27, 36864
s_add_u32 s35, s26, s27
s_add_u32 s40, s32, 0
buffer_load_ushort v16, v4, s[16:19], s40 offen
s_add_u32 s40, s32, 1152
buffer_load_ushort v17, v4, s[16:19], s40 offen
s_add_u32 s40, s32, 2304
buffer_load_ushort v18, v4, s[16:19], s40 offen
s_add_u32 s40, s32, 3456
buffer_load_ushort v19, v4, s[16:19], s40 offen
s_add_u32 s40, s32, 4608
buffer_load_ushort v20, v4, s[16:19], s40 offen
s_add_u32 s40, s32, 5760
buffer_load_ushort v21, v4, s[16:19], s40 offen
s_add_u32 s40, s32, 6912
buffer_load_ushort v22, v4, s[16:19], s40 offen
s_add_u32 s40, s32, 8064
buffer_load_ushort v23, v4, s[16:19], s40 offen
s_add_u32 s40, s32, 36864
buffer_load_ushort v24, v4, s[16:19], s40 offen
s_add_u32 s40, s32, 38016
buffer_load_ushort v25, v4, s[16:19], s40 offen
s_add_u32 s40, s32, 39168
buffer_load_ushort v26, v4, s[16:19], s40 offen
s_add_u32 s40, s32, 40320
buffer_load_ushort v27, v4, s[16:19], s40 offen
s_add_u32 s40, s32, 41472
buffer_load_ushort v28, v4, s[16:19], s40 offen
s_add_u32 s40, s32, 42624
buffer_load_ushort v29, v4, s[16:19], s40 offen
s_add_u32 s40, s32, 43776
buffer_load_ushort v30, v4, s[16:19], s40 offen
s_add_u32 s40, s32, 44928
buffer_load_ushort v31, v4, s[16:19], s40 offen
s_add_u32 s40, s32, 73728
buffer_load_ushort v32, v4, s[16:19], s40 offen
s_add_u32 s40, s32, 74880
buffer_load_ushort v33, v4, s[16:19], s40 offen
s_add_u32 s40, s32, 76032
buffer_load_ushort v34, v4, s[16:19], s40 offen
s_add_u32 s40, s32, 77184
buffer_load_ushort v35, v4, s[16:19], s40 offen
s_add_u32 s40, s32, 78336
buffer_load_ushort v36, v4, s[16:19], s40 offen
s_add_u32 s40, s32, 79488
buffer_load_ushort v37, v4, s[16:19], s40 offen
s_add_u32 s40, s32, 80640
buffer_load_ushort v38, v4, s[16:19], s40 offen
s_add_u32 s40, s32, 81792
buffer_load_ushort v39, v4, s[16:19], s40 offen
s_add_u32 s40, s33, 0
buffer_load_ushort v40, v4, s[16:19], s40 offen
s_add_u32 s40, s33, 1152
buffer_load_ushort v41, v4, s[16:19], s40 offen
s_add_u32 s40, s33, 2304
buffer_load_ushort v42, v4, s[16:19], s40 offen
s_add_u32 s40, s33, 3456
buffer_load_ushort v43, v4, s[16:19], s40 offen
s_add_u32 s40, s33, 4608
buffer_load_ushort v44, v4, s[16:19], s40 offen
s_add_u32 s40, s33, 5760
buffer_load_ushort v45, v4, s[16:19], s40 offen
s_add_u32 s40, s33, 6912
buffer_load_ushort v46, v4, s[16:19], s40 offen
s_add_u32 s40, s33, 8064
buffer_load_ushort v47, v4, s[16:19], s40 offen
s_add_u32 s40, s34, 0
buffer_load_ushort v48, v4, s[16:19], s40 offen
s_add_u32 s40, s34, 1152
buffer_load_ushort v49, v4, s[16:19], s40 offen
s_add_u32 s40, s34, 2304
buffer_load_ushort v50, v4, s[16:19], s40 offen
s_add_u32 s40, s34, 3456
buffer_load_ushort v51, v4, s[16:19], s40 offen
s_add_u32 s40, s34, 4608
buffer_load_ushort v52, v4, s[16:19], s40 offen
s_add_u32 s40, s34, 5760
buffer_load_ushort v53, v4, s[16:19], s40 offen
s_add_u32 s40, s34, 6912
buffer_load_ushort v54, v4, s[16:19], s40 offen
s_add_u32 s40, s34, 8064
buffer_load_ushort v55, v4, s[16:19], s40 offen
s_add_u32 s40, s35, 0
buffer_load_ushort v56, v4, s[16:19], s40 offen
s_add_u32 s40, s35, 1152
buffer_load_ushort v57, v4, s[16:19], s40 offen
s_add_u32 s40, s35, 2304
buffer_load_ushort v58, v4, s[16:19], s40 offen
s_add_u32 s40, s35, 3456
buffer_load_ushort v59, v4, s[16:19], s40 offen
s_add_u32 s40, s35, 4608
buffer_load_ushort v60, v4, s[16:19], s40 offen
s_add_u32 s40, s35, 5760
buffer_load_ushort v61, v4, s[16:19], s40 offen
s_add_u32 s40, s35, 6912
buffer_load_ushort v62, v4, s[16:19], s40 offen
s_add_u32 s40, s35, 8064
buffer_load_ushort v63, v4, s[16:19], s40 offen
s_waitcnt vmcnt(40)
v_lshl_or_b32 v80, v17, 16, v16
v_lshl_or_b32 v81, v19, 16, v18
v_lshl_or_b32 v82, v21, 16, v20
v_lshl_or_b32 v83, v23, 16, v22
s_waitcnt vmcnt(32)
v_lshl_or_b32 v84, v25, 16, v24
v_lshl_or_b32 v85, v27, 16, v26
v_lshl_or_b32 v86, v29, 16, v28
v_lshl_or_b32 v87, v31, 16, v30
s_waitcnt vmcnt(24)
v_lshl_or_b32 v88, v33, 16, v32
v_lshl_or_b32 v89, v35, 16, v34
v_lshl_or_b32 v90, v37, 16, v36
v_lshl_or_b32 v91, v39, 16, v38
s_waitcnt vmcnt(16)
v_lshl_or_b32 v92, v41, 16, v40
v_lshl_or_b32 v93, v43, 16, v42
v_lshl_or_b32 v94, v45, 16, v44
v_lshl_or_b32 v95, v47, 16, v46
s_waitcnt vmcnt(8)
v_lshl_or_b32 v96, v49, 16, v48
v_lshl_or_b32 v97, v51, 16, v50
v_lshl_or_b32 v98, v53, 16, v52
v_lshl_or_b32 v99, v55, 16, v54
s_waitcnt vmcnt(0)
v_lshl_or_b32 v100, v57, 16, v56
v_lshl_or_b32 v101, v59, 16, v58
v_lshl_or_b32 v102, v61, 16, v60
v_lshl_or_b32 v103, v63, 16, v62
s_add_u32 s40, s33, 36864
buffer_load_ushort v16, v4, s[16:19], s40 offen
s_add_u32 s40, s33, 38016
buffer_load_ushort v17, v4, s[16:19], s40 offen
s_add_u32 s40, s33, 39168
buffer_load_ushort v18, v4, s[16:19], s40 offen
s_add_u32 s40, s33, 40320
buffer_load_ushort v19, v4, s[16:19], s40 offen
s_add_u32 s40, s33, 41472
buffer_load_ushort v20, v4, s[16:19], s40 offen
s_add_u32 s40, s33, 42624
buffer_load_ushort v21, v4, s[16:19], s40 offen
s_add_u32 s40, s33, 43776
buffer_load_ushort v22, v4, s[16:19], s40 offen
s_add_u32 s40, s33, 44928
buffer_load_ushort v23, v4, s[16:19], s40 offen
s_add_u32 s40, s34, 36864
buffer_load_ushort v24, v4, s[16:19], s40 offen
s_add_u32 s40, s34, 38016
buffer_load_ushort v25, v4, s[16:19], s40 offen
s_add_u32 s40, s34, 39168
buffer_load_ushort v26, v4, s[16:19], s40 offen
s_add_u32 s40, s34, 40320
buffer_load_ushort v27, v4, s[16:19], s40 offen
s_add_u32 s40, s34, 41472
buffer_load_ushort v28, v4, s[16:19], s40 offen
s_add_u32 s40, s34, 42624
buffer_load_ushort v29, v4, s[16:19], s40 offen
s_add_u32 s40, s34, 43776
buffer_load_ushort v30, v4, s[16:19], s40 offen
s_add_u32 s40, s34, 44928
buffer_load_ushort v31, v4, s[16:19], s40 offen
s_add_u32 s40, s35, 36864
buffer_load_ushort v32, v4, s[16:19], s40 offen
s_add_u32 s40, s35, 38016
buffer_load_ushort v33, v4, s[16:19], s40 offen
s_add_u32 s40, s35, 39168
buffer_load_ushort v34, v4, s[16:19], s40 offen
s_add_u32 s40, s35, 40320
buffer_load_ushort v35, v4, s[16:19], s40 offen
s_add_u32 s40, s35, 41472
buffer_load_ushort v36, v4, s[16:19], s40 offen
s_add_u32 s40, s35, 42624
buffer_load_ushort v37, v4, s[16:19], s40 offen
s_add_u32 s40, s35, 43776
buffer_load_ushort v38, v4, s[16:19], s40 offen
s_add_u32 s40, s35, 44928
buffer_load_ushort v39, v4, s[16:19], s40 offen
s_add_u32 s40, s26, 147456
buffer_load_ushort v40, v4, s[16:19], s40 offen
s_add_u32 s40, s26, 148608
buffer_load_ushort v41, v4, s[16:19], s40 offen
s_add_u32 s40, s26, 149760
buffer_load_ushort v42, v4, s[16:19], s40 offen
s_add_u32 s40, s26, 150912
buffer_load_ushort v43, v4, s[16:19], s40 offen
s_add_u32 s40, s26, 152064
buffer_load_ushort v44, v4, s[16:19], s40 offen
s_add_u32 s40, s26, 153216
buffer_load_ushort v45, v4, s[16:19], s40 offen
s_add_u32 s40, s26, 154368
buffer_load_ushort v46, v4, s[16:19], s40 offen
s_add_u32 s40, s26, 155520
buffer_load_ushort v47, v4, s[16:19], s40 offen
s_add_u32 s40, s26, 479232
buffer_load_ushort v48, v4, s[16:19], s40 offen
s_add_u32 s40, s26, 480384
buffer_load_ushort v49, v4, s[16:19], s40 offen
s_add_u32 s40, s26, 481536
buffer_load_ushort v50, v4, s[16:19], s40 offen
s_add_u32 s40, s26, 482688
buffer_load_ushort v51, v4, s[16:19], s40 offen
s_add_u32 s40, s26, 483840
buffer_load_ushort v52, v4, s[16:19], s40 offen
s_add_u32 s40, s26, 484992
buffer_load_ushort v53, v4, s[16:19], s40 offen
s_add_u32 s40, s26, 486144
buffer_load_ushort v54, v4, s[16:19], s40 offen
s_add_u32 s40, s26, 487296
buffer_load_ushort v55, v4, s[16:19], s40 offen
s_add_u32 s40, s32, 110592
buffer_load_ushort v56, v4, s[16:19], s40 offen
s_add_u32 s40, s32, 111744
buffer_load_ushort v57, v4, s[16:19], s40 offen
s_add_u32 s40, s32, 112896
buffer_load_ushort v58, v4, s[16:19], s40 offen
s_add_u32 s40, s32, 114048
buffer_load_ushort v59, v4, s[16:19], s40 offen
s_add_u32 s40, s32, 115200
buffer_load_ushort v60, v4, s[16:19], s40 offen
s_add_u32 s40, s32, 116352
buffer_load_ushort v61, v4, s[16:19], s40 offen
s_add_u32 s40, s32, 117504
buffer_load_ushort v62, v4, s[16:19], s40 offen
s_add_u32 s40, s32, 118656
buffer_load_ushort v63, v4, s[16:19], s40 offen
s_waitcnt vmcnt(40)
v_lshl_or_b32 v104, v17, 16, v16
v_lshl_or_b32 v105, v19, 16, v18
v_lshl_or_b32 v106, v21, 16, v20
v_lshl_or_b32 v107, v23, 16, v22
s_waitcnt vmcnt(32)
v_lshl_or_b32 v108, v25, 16, v24
v_lshl_or_b32 v109, v27, 16, v26
v_lshl_or_b32 v110, v29, 16, v28
v_lshl_or_b32 v111, v31, 16, v30
s_waitcnt vmcnt(24)
v_lshl_or_b32 v112, v33, 16, v32
v_lshl_or_b32 v113, v35, 16, v34
v_lshl_or_b32 v114, v37, 16, v36
v_lshl_or_b32 v115, v39, 16, v38
s_waitcnt vmcnt(16)
v_lshl_or_b32 v116, v41, 16, v40
v_lshl_or_b32 v117, v43, 16, v42
v_lshl_or_b32 v118, v45, 16, v44
v_lshl_or_b32 v119, v47, 16, v46
s_waitcnt vmcnt(8)
v_lshl_or_b32 v120, v49, 16, v48
v_lshl_or_b32 v121, v51, 16, v50
v_lshl_or_b32 v122, v53, 16, v52
v_lshl_or_b32 v123, v55, 16, v54
s_waitcnt vmcnt(0)
v_lshl_or_b32 v124, v57, 16, v56
v_lshl_or_b32 v125, v59, 16, v58
v_lshl_or_b32 v126, v61, 16, v60
v_lshl_or_b32 v127, v63, 16, v62
s_add_u32 s40, s33, 73728
buffer_load_ushort v16, v4, s[16:19], s40 offen
s_add_u32 s40, s33, 74880
buffer_load_ushort v17, v4, s[16:19], s40 offen
s_add_u32 s40, s33, 76032
buffer_load_ushort v18, v4, s[16:19], s40 offen
s_add_u32 s40, s33, 77184
buffer_load_ushort v19, v4, s[16:19], s40 offen
s_add_u32 s40, s33, 78336
buffer_load_ushort v20, v4, s[16:19], s40 offen
s_add_u32 s40, s33, 79488
buffer_load_ushort v21, v4, s[16:19], s40 offen
s_add_u32 s40, s33, 80640
buffer_load_ushort v22, v4, s[16:19], s40 offen
s_add_u32 s40, s33, 81792
buffer_load_ushort v23, v4, s[16:19], s40 offen
s_add_u32 s40, s34, 73728
buffer_load_ushort v24, v4, s[16:19], s40 offen
s_add_u32 s40, s34, 74880
buffer_load_ushort v25, v4, s[16:19], s40 offen
s_add_u32 s40, s34, 76032
buffer_load_ushort v26, v4, s[16:19], s40 offen
s_add_u32 s40, s34, 77184
buffer_load_ushort v27, v4, s[16:19], s40 offen
s_add_u32 s40, s34, 78336
buffer_load_ushort v28, v4, s[16:19], s40 offen
s_add_u32 s40, s34, 79488
buffer_load_ushort v29, v4, s[16:19], s40 offen
s_add_u32 s40, s34, 80640
buffer_load_ushort v30, v4, s[16:19], s40 offen
s_add_u32 s40, s34, 81792
buffer_load_ushort v31, v4, s[16:19], s40 offen
s_add_u32 s40, s35, 73728
buffer_load_ushort v32, v4, s[16:19], s40 offen
s_add_u32 s40, s35, 74880
buffer_load_ushort v33, v4, s[16:19], s40 offen
s_add_u32 s40, s35, 76032
buffer_load_ushort v34, v4, s[16:19], s40 offen
s_add_u32 s40, s35, 77184
buffer_load_ushort v35, v4, s[16:19], s40 offen
s_add_u32 s40, s35, 78336
buffer_load_ushort v36, v4, s[16:19], s40 offen
s_add_u32 s40, s35, 79488
buffer_load_ushort v37, v4, s[16:19], s40 offen
s_add_u32 s40, s35, 80640
buffer_load_ushort v38, v4, s[16:19], s40 offen
s_add_u32 s40, s35, 81792
buffer_load_ushort v39, v4, s[16:19], s40 offen
s_add_u32 s40, s33, 110592
buffer_load_ushort v40, v4, s[16:19], s40 offen
s_add_u32 s40, s33, 111744
buffer_load_ushort v41, v4, s[16:19], s40 offen
s_add_u32 s40, s33, 112896
buffer_load_ushort v42, v4, s[16:19], s40 offen
s_add_u32 s40, s33, 114048
buffer_load_ushort v43, v4, s[16:19], s40 offen
s_add_u32 s40, s33, 115200
buffer_load_ushort v44, v4, s[16:19], s40 offen
s_add_u32 s40, s33, 116352
buffer_load_ushort v45, v4, s[16:19], s40 offen
s_add_u32 s40, s33, 117504
buffer_load_ushort v46, v4, s[16:19], s40 offen
s_add_u32 s40, s33, 118656
buffer_load_ushort v47, v4, s[16:19], s40 offen
s_add_u32 s40, s34, 110592
buffer_load_ushort v48, v4, s[16:19], s40 offen
s_add_u32 s40, s34, 111744
buffer_load_ushort v49, v4, s[16:19], s40 offen
s_add_u32 s40, s34, 112896
buffer_load_ushort v50, v4, s[16:19], s40 offen
s_add_u32 s40, s34, 114048
buffer_load_ushort v51, v4, s[16:19], s40 offen
s_add_u32 s40, s34, 115200
buffer_load_ushort v52, v4, s[16:19], s40 offen
s_add_u32 s40, s34, 116352
buffer_load_ushort v53, v4, s[16:19], s40 offen
s_add_u32 s40, s34, 117504
buffer_load_ushort v54, v4, s[16:19], s40 offen
s_add_u32 s40, s34, 118656
buffer_load_ushort v55, v4, s[16:19], s40 offen
s_add_u32 s40, s35, 110592
buffer_load_ushort v56, v4, s[16:19], s40 offen
s_add_u32 s40, s35, 111744
buffer_load_ushort v57, v4, s[16:19], s40 offen
s_add_u32 s40, s35, 112896
buffer_load_ushort v58, v4, s[16:19], s40 offen
s_add_u32 s40, s35, 114048
buffer_load_ushort v59, v4, s[16:19], s40 offen
s_add_u32 s40, s35, 115200
buffer_load_ushort v60, v4, s[16:19], s40 offen
s_add_u32 s40, s35, 116352
buffer_load_ushort v61, v4, s[16:19], s40 offen
s_add_u32 s40, s35, 117504
buffer_load_ushort v62, v4, s[16:19], s40 offen
s_add_u32 s40, s35, 118656
buffer_load_ushort v63, v4, s[16:19], s40 offen
s_waitcnt vmcnt(40)
v_lshl_or_b32 v128, v17, 16, v16
v_lshl_or_b32 v129, v19, 16, v18
v_lshl_or_b32 v130, v21, 16, v20
v_lshl_or_b32 v131, v23, 16, v22
s_waitcnt vmcnt(32)
v_lshl_or_b32 v132, v25, 16, v24
v_lshl_or_b32 v133, v27, 16, v26
v_lshl_or_b32 v134, v29, 16, v28
v_lshl_or_b32 v135, v31, 16, v30
s_waitcnt vmcnt(24)
v_lshl_or_b32 v136, v33, 16, v32
v_lshl_or_b32 v137, v35, 16, v34
v_lshl_or_b32 v138, v37, 16, v36
v_lshl_or_b32 v139, v39, 16, v38
s_waitcnt vmcnt(16)
v_lshl_or_b32 v140, v41, 16, v40
v_lshl_or_b32 v141, v43, 16, v42
v_lshl_or_b32 v142, v45, 16, v44
v_lshl_or_b32 v143, v47, 16, v46
s_waitcnt vmcnt(8)
v_lshl_or_b32 v144, v49, 16, v48
v_lshl_or_b32 v145, v51, 16, v50
v_lshl_or_b32 v146, v53, 16, v52
v_lshl_or_b32 v147, v55, 16, v54
s_waitcnt vmcnt(0)
v_lshl_or_b32 v148, v57, 16, v56
v_lshl_or_b32 v149, v59, 16, v58
v_lshl_or_b32 v150, v61, 16, v60
v_lshl_or_b32 v151, v63, 16, v62
s_mul_i32 s29, s21, 497664
s_add_u32 s29, s29, 3698688
s_lshl_b32 s30, s22, 11
s_add_u32 s30, s30, s29
s_lshl_b32 s31, s22, 12
s_add_u32 s31, s31, s29
s_add_u32 s40, s30, 0
buffer_store_dwordx4 v[80:83], v2, s[8:11], s40 offen
s_add_u32 s40, s30, 1024
buffer_store_dwordx4 v[84:87], v2, s[8:11], s40 offen
s_add_u32 s40, s30, 18432
buffer_store_dwordx4 v[88:91], v2, s[8:11], s40 offen
s_add_u32 s40, s30, 19456
buffer_store_dwordx4 v[92:95], v2, s[8:11], s40 offen
s_add_u32 s40, s30, 36864
buffer_store_dwordx4 v[96:99], v2, s[8:11], s40 offen
s_add_u32 s40, s30, 37888
buffer_store_dwordx4 v[100:103], v2, s[8:11], s40 offen
s_add_u32 s40, s30, 55296
buffer_store_dwordx4 v[104:107], v2, s[8:11], s40 offen
s_add_u32 s40, s30, 56320
buffer_store_dwordx4 v[108:111], v2, s[8:11], s40 offen
s_add_u32 s40, s30, 73728
buffer_store_dwordx4 v[112:115], v2, s[8:11], s40 offen
s_add_u32 s40, s30, 74752
buffer_store_dwordx4 v[116:119], v2, s[8:11], s40 offen
s_add_u32 s40, s30, 92160
buffer_store_dwordx4 v[120:123], v2, s[8:11], s40 offen
s_add_u32 s40, s30, 93184
buffer_store_dwordx4 v[124:127], v2, s[8:11], s40 offen
s_add_u32 s40, s30, 110592
buffer_store_dwordx4 v[128:131], v2, s[8:11], s40 offen
s_add_u32 s40, s30, 111616
buffer_store_dwordx4 v[132:135], v2, s[8:11], s40 offen
s_add_u32 s40, s31, 129024
buffer_store_dwordx4 v[136:139], v2, s[8:11], s40 offen
s_add_u32 s40, s31, 130048
buffer_store_dwordx4 v[140:143], v2, s[8:11], s40 offen
s_add_u32 s40, s31, 131072
buffer_store_dwordx4 v[144:147], v2, s[8:11], s40 offen
s_add_u32 s40, s31, 132096
buffer_store_dwordx4 v[148:151], v2, s[8:11], s40 offen
s_branch L_prep_end
L_pack_q:
s_sub_u32 s20, s20, 864
s_lshr_b32 s21, s20, 3
s_and_b32 s22, s20, 7
s_load_dwordx2 s[12:13], s[0:1], 8
s_waitcnt lgkmcnt(0)
s_mov_b32 s16, s12
s_and_b32 s17, s13, 0xffff
s_mov_b32 s18, 1990656
s_mov_b32 s19, 0x20000
s_mov_b32 s23, 0
s_cmp_eq_u32 s22, 0
s_cselect_b32 s23, 0, s23
s_cmp_eq_u32 s22, 1
s_cselect_b32 s23, 18, s23
s_cmp_eq_u32 s22, 2
s_cselect_b32 s23, 576, s23
s_cmp_eq_u32 s22, 3
s_cselect_b32 s23, 594, s23
s_cmp_eq_u32 s22, 4
s_cselect_b32 s23, 16, s23
s_cmp_eq_u32 s22, 5
s_cselect_b32 s23, 1152, s23
s_cmp_eq_u32 s22, 6
s_cselect_b32 s23, 1170, s23
s_cmp_eq_u32 s22, 7
s_cselect_b32 s23, 1168, s23
s_mul_i32 s24, s21, 36
s_add_u32 s23, s23, s24
v_and_b32 v11, 1, v6
v_bfe_u32 v12, v6, 1, 1
v_mul_u32_u24 v12, 18, v12
v_add_u32 v11, v11, v12
v_mul_u32_u24 v12, 576, v8
v_add_u32 v11, v11, v12
s_mov_b32 s24, 16
s_cmp_eq_u32 s22, 4
s_cselect_b32 s24, 8, s24
s_cmp_eq_u32 s22, 7
s_cselect_b32 s24, 4, s24
s_cmp_lg_u32 s24, 16
s_cselect_b64 vcc, -1, 0
v_cndmask_b32 v11, v6, v11, vcc
v_add_u32 v11, s23, v11
v_lshlrev_b32 v11, 1, v11
v_mul_u32_u24 v12, 27648, v7
v_add_u32 v11, v11, v12
v_mov_b32 v12, 2146435072
v_cmp_gt_u32 vcc, s24, v6
s_nop 1
v_cndmask_b32 v4, v12, v11, vcc
s_mov_b32 s40, 0
buffer_load_ushort v16, v4, s[16:19], s40 offen
s_mov_b32 s40, 3456
buffer_load_ushort v17, v4, s[16:19], s40 offen
s_mov_b32 s40, 6912
buffer_load_ushort v18, v4, s[16:19], s40 offen
s_mov_b32 s40, 10368
buffer_load_ushort v19, v4, s[16:19], s40 offen
s_mov_b32 s40, 13824
buffer_load_ushort v20, v4, s[16:19], s40 offen
s_mov_b32 s40, 17280
buffer_load_ushort v21, v4, s[16:19], s40 offen
s_mov_b32 s40, 20736
buffer_load_ushort v22, v4, s[16:19], s40 offen
s_mov_b32 s40, 24192
buffer_load_ushort v23, v4, s[16:19], s40 offen
s_mov_b32 s40, 110592
buffer_load_ushort v24, v4, s[16:19], s40 offen
s_mov_b32 s40, 114048
buffer_load_ushort v25, v4, s[16:19], s40 offen
s_mov_b32 s40, 117504
buffer_load_ushort v26, v4, s[16:19], s40 offen
s_mov_b32 s40, 120960
buffer_load_ushort v27, v4, s[16:19], s40 offen
s_mov_b32 s40, 124416
buffer_load_ushort v28, v4, s[16:19], s40 offen
s_mov_b32 s40, 127872
buffer_load_ushort v29, v4, s[16:19], s40 offen
s_mov_b32 s40, 131328
buffer_load_ushort v30, v4, s[16:19], s40 offen
s_mov_b32 s40, 134784
buffer_load_ushort v31, v4, s[16:19], s40 offen
s_mov_b32 s40, 221184
buffer_load_ushort v32, v4, s[16:19], s40 offen
s_mov_b32 s40, 224640
buffer_load_ushort v33, v4, s[16:19], s40 offen
s_mov_b32 s40, 228096
buffer_load_ushort v34, v4, s[16:19], s40 offen
s_mov_b32 s40, 231552
buffer_load_ushort v35, v4, s[16:19], s40 offen
s_mov_b32 s40, 235008
buffer_load_ushort v36, v4, s[16:19], s40 offen
s_mov_b32 s40, 238464
buffer_load_ushort v37, v4, s[16:19], s40 offen
s_mov_b32 s40, 241920
buffer_load_ushort v38, v4, s[16:19], s40 offen
s_mov_b32 s40, 245376
buffer_load_ushort v39, v4, s[16:19], s40 offen
s_mov_b32 s40, 331776
buffer_load_ushort v40, v4, s[16:19], s40 offen
s_mov_b32 s40, 335232
buffer_load_ushort v41, v4, s[16:19], s40 offen
s_mov_b32 s40, 338688
buffer_load_ushort v42, v4, s[16:19], s40 offen
s_mov_b32 s40, 342144
buffer_load_ushort v43, v4, s[16:19], s40 offen
s_mov_b32 s40, 345600
buffer_load_ushort v44, v4, s[16:19], s40 offen
s_mov_b32 s40, 349056
buffer_load_ushort v45, v4, s[16:19], s40 offen
s_mov_b32 s40, 352512
buffer_load_ushort v46, v4, s[16:19], s40 offen
s_mov_b32 s40, 355968
buffer_load_ushort v47, v4, s[16:19], s40 offen
s_mov_b32 s40, 442368
buffer_load_ushort v48, v4, s[16:19], s40 offen
s_mov_b32 s40, 445824
buffer_load_ushort v49, v4, s[16:19], s40 offen
s_mov_b32 s40, 449280
buffer_load_ushort v50, v4, s[16:19], s40 offen
s_mov_b32 s40, 452736
buffer_load_ushort v51, v4, s[16:19], s40 offen
s_mov_b32 s40, 456192
buffer_load_ushort v52, v4, s[16:19], s40 offen
s_mov_b32 s40, 459648
buffer_load_ushort v53, v4, s[16:19], s40 offen
s_mov_b32 s40, 463104
buffer_load_ushort v54, v4, s[16:19], s40 offen
s_mov_b32 s40, 466560
buffer_load_ushort v55, v4, s[16:19], s40 offen
s_mov_b32 s40, 552960
buffer_load_ushort v56, v4, s[16:19], s40 offen
s_mov_b32 s40, 556416
buffer_load_ushort v57, v4, s[16:19], s40 offen
s_mov_b32 s40, 559872
buffer_load_ushort v58, v4, s[16:19], s40 offen
s_mov_b32 s40, 563328
buffer_load_ushort v59, v4, s[16:19], s40 offen
s_mov_b32 s40, 566784
buffer_load_ushort v60, v4, s[16:19], s40 offen
s_mov_b32 s40, 570240
buffer_load_ushort v61, v4, s[16:19], s40 offen
s_mov_b32 s40, 573696
buffer_load_ushort v62, v4, s[16:19], s40 offen
s_mov_b32 s40, 577152
buffer_load_ushort v63, v4, s[16:19], s40 offen
s_waitcnt vmcnt(40)
v_lshl_or_b32 v80, v17, 16, v16
v_lshl_or_b32 v81, v19, 16, v18
v_lshl_or_b32 v82, v21, 16, v20
v_lshl_or_b32 v83, v23, 16, v22
s_waitcnt vmcnt(32)
v_lshl_or_b32 v84, v25, 16, v24
v_lshl_or_b32 v85, v27, 16, v26
v_lshl_or_b32 v86, v29, 16, v28
v_lshl_or_b32 v87, v31, 16, v30
s_waitcnt vmcnt(24)
v_lshl_or_b32 v88, v33, 16, v32
v_lshl_or_b32 v89, v35, 16, v34
v_lshl_or_b32 v90, v37, 16, v36
v_lshl_or_b32 v91, v39, 16, v38
s_waitcnt vmcnt(16)
v_lshl_or_b32 v92, v41, 16, v40
v_lshl_or_b32 v93, v43, 16, v42
v_lshl_or_b32 v94, v45, 16, v44
v_lshl_or_b32 v95, v47, 16, v46
s_waitcnt vmcnt(8)
v_lshl_or_b32 v96, v49, 16, v48
v_lshl_or_b32 v97, v51, 16, v50
v_lshl_or_b32 v98, v53, 16, v52
v_lshl_or_b32 v99, v55, 16, v54
s_waitcnt vmcnt(0)
v_lshl_or_b32 v100, v57, 16, v56
v_lshl_or_b32 v101, v59, 16, v58
v_lshl_or_b32 v102, v61, 16, v60
v_lshl_or_b32 v103, v63, 16, v62
s_mov_b32 s40, 663552
buffer_load_ushort v16, v4, s[16:19], s40 offen
s_mov_b32 s40, 667008
buffer_load_ushort v17, v4, s[16:19], s40 offen
s_mov_b32 s40, 670464
buffer_load_ushort v18, v4, s[16:19], s40 offen
s_mov_b32 s40, 673920
buffer_load_ushort v19, v4, s[16:19], s40 offen
s_mov_b32 s40, 677376
buffer_load_ushort v20, v4, s[16:19], s40 offen
s_mov_b32 s40, 680832
buffer_load_ushort v21, v4, s[16:19], s40 offen
s_mov_b32 s40, 684288
buffer_load_ushort v22, v4, s[16:19], s40 offen
s_mov_b32 s40, 687744
buffer_load_ushort v23, v4, s[16:19], s40 offen
s_mov_b32 s40, 774144
buffer_load_ushort v24, v4, s[16:19], s40 offen
s_mov_b32 s40, 777600
buffer_load_ushort v25, v4, s[16:19], s40 offen
s_mov_b32 s40, 781056
buffer_load_ushort v26, v4, s[16:19], s40 offen
s_mov_b32 s40, 784512
buffer_load_ushort v27, v4, s[16:19], s40 offen
s_mov_b32 s40, 787968
buffer_load_ushort v28, v4, s[16:19], s40 offen
s_mov_b32 s40, 791424
buffer_load_ushort v29, v4, s[16:19], s40 offen
s_mov_b32 s40, 794880
buffer_load_ushort v30, v4, s[16:19], s40 offen
s_mov_b32 s40, 798336
buffer_load_ushort v31, v4, s[16:19], s40 offen
s_mov_b32 s40, 884736
buffer_load_ushort v32, v4, s[16:19], s40 offen
s_mov_b32 s40, 888192
buffer_load_ushort v33, v4, s[16:19], s40 offen
s_mov_b32 s40, 891648
buffer_load_ushort v34, v4, s[16:19], s40 offen
s_mov_b32 s40, 895104
buffer_load_ushort v35, v4, s[16:19], s40 offen
s_mov_b32 s40, 898560
buffer_load_ushort v36, v4, s[16:19], s40 offen
s_mov_b32 s40, 902016
buffer_load_ushort v37, v4, s[16:19], s40 offen
s_mov_b32 s40, 905472
buffer_load_ushort v38, v4, s[16:19], s40 offen
s_mov_b32 s40, 908928
buffer_load_ushort v39, v4, s[16:19], s40 offen
s_mov_b32 s40, 995328
buffer_load_ushort v40, v4, s[16:19], s40 offen
s_mov_b32 s40, 998784
buffer_load_ushort v41, v4, s[16:19], s40 offen
s_mov_b32 s40, 1002240
buffer_load_ushort v42, v4, s[16:19], s40 offen
s_mov_b32 s40, 1005696
buffer_load_ushort v43, v4, s[16:19], s40 offen
s_mov_b32 s40, 1009152
buffer_load_ushort v44, v4, s[16:19], s40 offen
s_mov_b32 s40, 1012608
buffer_load_ushort v45, v4, s[16:19], s40 offen
s_mov_b32 s40, 1016064
buffer_load_ushort v46, v4, s[16:19], s40 offen
s_mov_b32 s40, 1019520
buffer_load_ushort v47, v4, s[16:19], s40 offen
s_mov_b32 s40, 1105920
buffer_load_ushort v48, v4, s[16:19], s40 offen
s_mov_b32 s40, 1109376
buffer_load_ushort v49, v4, s[16:19], s40 offen
s_mov_b32 s40, 1112832
buffer_load_ushort v50, v4, s[16:19], s40 offen
s_mov_b32 s40, 1116288
buffer_load_ushort v51, v4, s[16:19], s40 offen
s_mov_b32 s40, 1119744
buffer_load_ushort v52, v4, s[16:19], s40 offen
s_mov_b32 s40, 1123200
buffer_load_ushort v53, v4, s[16:19], s40 offen
s_mov_b32 s40, 1126656
buffer_load_ushort v54, v4, s[16:19], s40 offen
s_mov_b32 s40, 1130112
buffer_load_ushort v55, v4, s[16:19], s40 offen
s_mov_b32 s40, 1216512
buffer_load_ushort v56, v4, s[16:19], s40 offen
s_mov_b32 s40, 1219968
buffer_load_ushort v57, v4, s[16:19], s40 offen
s_mov_b32 s40, 1223424
buffer_load_ushort v58, v4, s[16:19], s40 offen
s_mov_b32 s40, 1226880
buffer_load_ushort v59, v4, s[16:19], s40 offen
s_mov_b32 s40, 1230336
buffer_load_ushort v60, v4, s[16:19], s40 offen
s_mov_b32 s40, 1233792
buffer_load_ushort v61, v4, s[16:19], s40 offen
s_mov_b32 s40, 1237248
buffer_load_ushort v62, v4, s[16:19], s40 offen
s_mov_b32 s40, 1240704
buffer_load_ushort v63, v4, s[16:19], s40 offen
s_waitcnt vmcnt(40)
v_lshl_or_b32 v104, v17, 16, v16
v_lshl_or_b32 v105, v19, 16, v18
v_lshl_or_b32 v106, v21, 16, v20
v_lshl_or_b32 v107, v23, 16, v22
s_waitcnt vmcnt(32)
v_lshl_or_b32 v108, v25, 16, v24
v_lshl_or_b32 v109, v27, 16, v26
v_lshl_or_b32 v110, v29, 16, v28
v_lshl_or_b32 v111, v31, 16, v30
s_waitcnt vmcnt(24)
v_lshl_or_b32 v112, v33, 16, v32
v_lshl_or_b32 v113, v35, 16, v34
v_lshl_or_b32 v114, v37, 16, v36
v_lshl_or_b32 v115, v39, 16, v38
s_waitcnt vmcnt(16)
v_lshl_or_b32 v116, v41, 16, v40
v_lshl_or_b32 v117, v43, 16, v42
v_lshl_or_b32 v118, v45, 16, v44
v_lshl_or_b32 v119, v47, 16, v46
s_waitcnt vmcnt(8)
v_lshl_or_b32 v120, v49, 16, v48
v_lshl_or_b32 v121, v51, 16, v50
v_lshl_or_b32 v122, v53, 16, v52
v_lshl_or_b32 v123, v55, 16, v54
s_waitcnt vmcnt(0)
v_lshl_or_b32 v124, v57, 16, v56
v_lshl_or_b32 v125, v59, 16, v58
v_lshl_or_b32 v126, v61, 16, v60
v_lshl_or_b32 v127, v63, 16, v62
s_mov_b32 s40, 1327104
buffer_load_ushort v16, v4, s[16:19], s40 offen
s_mov_b32 s40, 1330560
buffer_load_ushort v17, v4, s[16:19], s40 offen
s_mov_b32 s40, 1334016
buffer_load_ushort v18, v4, s[16:19], s40 offen
s_mov_b32 s40, 1337472
buffer_load_ushort v19, v4, s[16:19], s40 offen
s_mov_b32 s40, 1340928
buffer_load_ushort v20, v4, s[16:19], s40 offen
s_mov_b32 s40, 1344384
buffer_load_ushort v21, v4, s[16:19], s40 offen
s_mov_b32 s40, 1347840
buffer_load_ushort v22, v4, s[16:19], s40 offen
s_mov_b32 s40, 1351296
buffer_load_ushort v23, v4, s[16:19], s40 offen
s_mov_b32 s40, 1437696
buffer_load_ushort v24, v4, s[16:19], s40 offen
s_mov_b32 s40, 1441152
buffer_load_ushort v25, v4, s[16:19], s40 offen
s_mov_b32 s40, 1444608
buffer_load_ushort v26, v4, s[16:19], s40 offen
s_mov_b32 s40, 1448064
buffer_load_ushort v27, v4, s[16:19], s40 offen
s_mov_b32 s40, 1451520
buffer_load_ushort v28, v4, s[16:19], s40 offen
s_mov_b32 s40, 1454976
buffer_load_ushort v29, v4, s[16:19], s40 offen
s_mov_b32 s40, 1458432
buffer_load_ushort v30, v4, s[16:19], s40 offen
s_mov_b32 s40, 1461888
buffer_load_ushort v31, v4, s[16:19], s40 offen
s_mov_b32 s40, 1548288
buffer_load_ushort v32, v4, s[16:19], s40 offen
s_mov_b32 s40, 1551744
buffer_load_ushort v33, v4, s[16:19], s40 offen
s_mov_b32 s40, 1555200
buffer_load_ushort v34, v4, s[16:19], s40 offen
s_mov_b32 s40, 1558656
buffer_load_ushort v35, v4, s[16:19], s40 offen
s_mov_b32 s40, 1562112
buffer_load_ushort v36, v4, s[16:19], s40 offen
s_mov_b32 s40, 1565568
buffer_load_ushort v37, v4, s[16:19], s40 offen
s_mov_b32 s40, 1569024
buffer_load_ushort v38, v4, s[16:19], s40 offen
s_mov_b32 s40, 1572480
buffer_load_ushort v39, v4, s[16:19], s40 offen
s_mov_b32 s40, 1658880
buffer_load_ushort v40, v4, s[16:19], s40 offen
s_mov_b32 s40, 1662336
buffer_load_ushort v41, v4, s[16:19], s40 offen
s_mov_b32 s40, 1665792
buffer_load_ushort v42, v4, s[16:19], s40 offen
s_mov_b32 s40, 1669248
buffer_load_ushort v43, v4, s[16:19], s40 offen
s_mov_b32 s40, 1672704
buffer_load_ushort v44, v4, s[16:19], s40 offen
s_mov_b32 s40, 1676160
buffer_load_ushort v45, v4, s[16:19], s40 offen
s_mov_b32 s40, 1679616
buffer_load_ushort v46, v4, s[16:19], s40 offen
s_mov_b32 s40, 1683072
buffer_load_ushort v47, v4, s[16:19], s40 offen
s_mov_b32 s40, 1769472
buffer_load_ushort v48, v4, s[16:19], s40 offen
s_mov_b32 s40, 1772928
buffer_load_ushort v49, v4, s[16:19], s40 offen
s_mov_b32 s40, 1776384
buffer_load_ushort v50, v4, s[16:19], s40 offen
s_mov_b32 s40, 1779840
buffer_load_ushort v51, v4, s[16:19], s40 offen
s_mov_b32 s40, 1783296
buffer_load_ushort v52, v4, s[16:19], s40 offen
s_mov_b32 s40, 1786752
buffer_load_ushort v53, v4, s[16:19], s40 offen
s_mov_b32 s40, 1790208
buffer_load_ushort v54, v4, s[16:19], s40 offen
s_mov_b32 s40, 1793664
buffer_load_ushort v55, v4, s[16:19], s40 offen
s_mov_b32 s40, 1880064
buffer_load_ushort v56, v4, s[16:19], s40 offen
s_mov_b32 s40, 1883520
buffer_load_ushort v57, v4, s[16:19], s40 offen
s_mov_b32 s40, 1886976
buffer_load_ushort v58, v4, s[16:19], s40 offen
s_mov_b32 s40, 1890432
buffer_load_ushort v59, v4, s[16:19], s40 offen
s_mov_b32 s40, 1893888
buffer_load_ushort v60, v4, s[16:19], s40 offen
s_mov_b32 s40, 1897344
buffer_load_ushort v61, v4, s[16:19], s40 offen
s_mov_b32 s40, 1900800
buffer_load_ushort v62, v4, s[16:19], s40 offen
s_mov_b32 s40, 1904256
buffer_load_ushort v63, v4, s[16:19], s40 offen
s_waitcnt vmcnt(40)
v_lshl_or_b32 v128, v17, 16, v16
v_lshl_or_b32 v129, v19, 16, v18
v_lshl_or_b32 v130, v21, 16, v20
v_lshl_or_b32 v131, v23, 16, v22
s_waitcnt vmcnt(32)
v_lshl_or_b32 v132, v25, 16, v24
v_lshl_or_b32 v133, v27, 16, v26
v_lshl_or_b32 v134, v29, 16, v28
v_lshl_or_b32 v135, v31, 16, v30
s_waitcnt vmcnt(24)
v_lshl_or_b32 v136, v33, 16, v32
v_lshl_or_b32 v137, v35, 16, v34
v_lshl_or_b32 v138, v37, 16, v36
v_lshl_or_b32 v139, v39, 16, v38
s_waitcnt vmcnt(16)
v_lshl_or_b32 v140, v41, 16, v40
v_lshl_or_b32 v141, v43, 16, v42
v_lshl_or_b32 v142, v45, 16, v44
v_lshl_or_b32 v143, v47, 16, v46
s_waitcnt vmcnt(8)
v_lshl_or_b32 v144, v49, 16, v48
v_lshl_or_b32 v145, v51, 16, v50
v_lshl_or_b32 v146, v53, 16, v52
v_lshl_or_b32 v147, v55, 16, v54
s_waitcnt vmcnt(0)
v_lshl_or_b32 v148, v57, 16, v56
v_lshl_or_b32 v149, v59, 16, v58
v_lshl_or_b32 v150, v61, 16, v60
v_lshl_or_b32 v151, v63, 16, v62
s_mul_i32 s29, s21, 147456
s_lshl_b32 s30, s22, 10
s_add_u32 s29, s29, s30
s_add_u32 s29, s29, 262144
s_add_u32 s40, s29, 0
buffer_store_dwordx4 v[80:83], v2, s[8:11], s40 offen
s_add_u32 s40, s29, 8192
buffer_store_dwordx4 v[84:87], v2, s[8:11], s40 offen
s_add_u32 s40, s29, 16384
buffer_store_dwordx4 v[88:91], v2, s[8:11], s40 offen
s_add_u32 s40, s29, 24576
buffer_store_dwordx4 v[92:95], v2, s[8:11], s40 offen
s_add_u32 s40, s29, 32768
buffer_store_dwordx4 v[96:99], v2, s[8:11], s40 offen
s_add_u32 s40, s29, 40960
buffer_store_dwordx4 v[100:103], v2, s[8:11], s40 offen
s_add_u32 s40, s29, 49152
buffer_store_dwordx4 v[104:107], v2, s[8:11], s40 offen
s_add_u32 s40, s29, 57344
buffer_store_dwordx4 v[108:111], v2, s[8:11], s40 offen
s_add_u32 s40, s29, 65536
buffer_store_dwordx4 v[112:115], v2, s[8:11], s40 offen
s_add_u32 s40, s29, 73728
buffer_store_dwordx4 v[116:119], v2, s[8:11], s40 offen
s_add_u32 s40, s29, 81920
buffer_store_dwordx4 v[120:123], v2, s[8:11], s40 offen
s_add_u32 s40, s29, 90112
buffer_store_dwordx4 v[124:127], v2, s[8:11], s40 offen
s_add_u32 s40, s29, 98304
buffer_store_dwordx4 v[128:131], v2, s[8:11], s40 offen
s_add_u32 s40, s29, 106496
buffer_store_dwordx4 v[132:135], v2, s[8:11], s40 offen
s_add_u32 s40, s29, 114688
buffer_store_dwordx4 v[136:139], v2, s[8:11], s40 offen
s_add_u32 s40, s29, 122880
buffer_store_dwordx4 v[140:143], v2, s[8:11], s40 offen
s_add_u32 s40, s29, 131072
buffer_store_dwordx4 v[144:147], v2, s[8:11], s40 offen
s_add_u32 s40, s29, 139264
buffer_store_dwordx4 v[148:151], v2, s[8:11], s40 offen
s_branch L_prep_end
L_pack_o:
s_sub_u32 s20, s20, 992
s_mul_i32 s21, s20, 13108
s_lshr_b32 s21, s21, 16
s_mul_i32 s22, s21, 5
s_sub_u32 s22, s20, s22
s_load_dwordx2 s[12:13], s[0:1], 16
s_waitcnt lgkmcnt(0)
s_mov_b32 s16, s12
s_and_b32 s17, s13, 0xffff
s_mov_b32 s18, 663552
s_mov_b32 s19, 0x20000
s_lshr_b32 s25, s22, 1
s_lshl_b32 s25, s25, 5
s_and_b32 s26, s22, 1
s_lshl_b32 s26, s26, 2
s_add_u32 s25, s25, s26
s_mul_i32 s26, s21, 72
s_add_u32 s25, s25, s26
s_cmp_eq_u32 s22, 4
s_cselect_b64 vcc, -1, 0
s_cselect_b32 s24, 8, 16
v_cndmask_b32 v11, v10, v6, vcc
v_add_u32 v11, s25, v11
v_lshlrev_b32 v11, 1, v11
v_mov_b32 v12, 2146435072
v_cmp_gt_u32 vcc, s24, v6
s_nop 1
v_cndmask_b32 v11, v12, v11, vcc
v_mul_u32_u24 v12, 4608, v7
v_add_u32 v4, v11, v12
v_mul_u32_u24 v12, 82944, v7
v_add_u32 v5, v11, v12
s_mov_b32 s40, 0
buffer_load_ushort v16, v4, s[16:19], s40 offen
s_mov_b32 s40, 1152
buffer_load_ushort v17, v4, s[16:19], s40 offen
s_mov_b32 s40, 2304
buffer_load_ushort v18, v4, s[16:19], s40 offen
s_mov_b32 s40, 3456
buffer_load_ushort v19, v4, s[16:19], s40 offen
s_mov_b32 s40, 20736
buffer_load_ushort v20, v4, s[16:19], s40 offen
s_mov_b32 s40, 21888
buffer_load_ushort v21, v4, s[16:19], s40 offen
s_mov_b32 s40, 23040
buffer_load_ushort v22, v4, s[16:19], s40 offen
s_mov_b32 s40, 24192
buffer_load_ushort v23, v4, s[16:19], s40 offen
s_mov_b32 s40, 41472
buffer_load_ushort v24, v4, s[16:19], s40 offen
s_mov_b32 s40, 42624
buffer_load_ushort v25, v4, s[16:19], s40 offen
s_mov_b32 s40, 43776
buffer_load_ushort v26, v4, s[16:19], s40 offen
s_mov_b32 s40, 44928
buffer_load_ushort v27, v4, s[16:19], s40 offen
s_mov_b32 s40, 62208
buffer_load_ushort v28, v4, s[16:19], s40 offen
s_mov_b32 s40, 63360
buffer_load_ushort v29, v4, s[16:19], s40 offen
s_mov_b32 s40, 64512
buffer_load_ushort v30, v4, s[16:19], s40 offen
s_mov_b32 s40, 65664
buffer_load_ushort v31, v4, s[16:19], s40 offen
s_mov_b32 s40, 82944
buffer_load_ushort v32, v4, s[16:19], s40 offen
s_mov_b32 s40, 84096
buffer_load_ushort v33, v4, s[16:19], s40 offen
s_mov_b32 s40, 85248
buffer_load_ushort v34, v4, s[16:19], s40 offen
s_mov_b32 s40, 86400
buffer_load_ushort v35, v4, s[16:19], s40 offen
s_mov_b32 s40, 103680
buffer_load_ushort v36, v4, s[16:19], s40 offen
s_mov_b32 s40, 104832
buffer_load_ushort v37, v4, s[16:19], s40 offen
s_mov_b32 s40, 105984
buffer_load_ushort v38, v4, s[16:19], s40 offen
s_mov_b32 s40, 107136
buffer_load_ushort v39, v4, s[16:19], s40 offen
s_mov_b32 s40, 124416
buffer_load_ushort v40, v4, s[16:19], s40 offen
s_mov_b32 s40, 125568
buffer_load_ushort v41, v4, s[16:19], s40 offen
s_mov_b32 s40, 126720
buffer_load_ushort v42, v4, s[16:19], s40 offen
s_mov_b32 s40, 127872
buffer_load_ushort v43, v4, s[16:19], s40 offen
s_mov_b32 s40, 145152
buffer_load_ushort v44, v4, s[16:19], s40 offen
s_mov_b32 s40, 146304
buffer_load_ushort v45, v4, s[16:19], s40 offen
s_mov_b32 s40, 147456
buffer_load_ushort v46, v4, s[16:19], s40 offen
s_mov_b32 s40, 148608
buffer_load_ushort v47, v4, s[16:19], s40 offen
s_mov_b32 s40, 165888
buffer_load_ushort v48, v4, s[16:19], s40 offen
s_mov_b32 s40, 167040
buffer_load_ushort v49, v4, s[16:19], s40 offen
s_mov_b32 s40, 168192
buffer_load_ushort v50, v4, s[16:19], s40 offen
s_mov_b32 s40, 169344
buffer_load_ushort v51, v4, s[16:19], s40 offen
s_mov_b32 s40, 186624
buffer_load_ushort v52, v4, s[16:19], s40 offen
s_mov_b32 s40, 187776
buffer_load_ushort v53, v4, s[16:19], s40 offen
s_mov_b32 s40, 188928
buffer_load_ushort v54, v4, s[16:19], s40 offen
s_mov_b32 s40, 190080
buffer_load_ushort v55, v4, s[16:19], s40 offen
s_mov_b32 s40, 207360
buffer_load_ushort v56, v4, s[16:19], s40 offen
s_mov_b32 s40, 208512
buffer_load_ushort v57, v4, s[16:19], s40 offen
s_mov_b32 s40, 209664
buffer_load_ushort v58, v4, s[16:19], s40 offen
s_mov_b32 s40, 210816
buffer_load_ushort v59, v4, s[16:19], s40 offen
s_mov_b32 s40, 228096
buffer_load_ushort v60, v4, s[16:19], s40 offen
s_mov_b32 s40, 229248
buffer_load_ushort v61, v4, s[16:19], s40 offen
s_mov_b32 s40, 230400
buffer_load_ushort v62, v4, s[16:19], s40 offen
s_mov_b32 s40, 231552
buffer_load_ushort v63, v4, s[16:19], s40 offen
s_waitcnt vmcnt(40)
v_lshl_or_b32 v80, v17, 16, v16
v_lshl_or_b32 v81, v19, 16, v18
v_lshl_or_b32 v82, v21, 16, v20
v_lshl_or_b32 v83, v23, 16, v22
s_waitcnt vmcnt(32)
v_lshl_or_b32 v84, v25, 16, v24
v_lshl_or_b32 v85, v27, 16, v26
v_lshl_or_b32 v86, v29, 16, v28
v_lshl_or_b32 v87, v31, 16, v30
s_waitcnt vmcnt(24)
v_lshl_or_b32 v88, v33, 16, v32
v_lshl_or_b32 v89, v35, 16, v34
v_lshl_or_b32 v90, v37, 16, v36
v_lshl_or_b32 v91, v39, 16, v38
s_waitcnt vmcnt(16)
v_lshl_or_b32 v92, v41, 16, v40
v_lshl_or_b32 v93, v43, 16, v42
v_lshl_or_b32 v94, v45, 16, v44
v_lshl_or_b32 v95, v47, 16, v46
s_waitcnt vmcnt(8)
v_lshl_or_b32 v96, v49, 16, v48
v_lshl_or_b32 v97, v51, 16, v50
v_lshl_or_b32 v98, v53, 16, v52
v_lshl_or_b32 v99, v55, 16, v54
s_waitcnt vmcnt(0)
v_lshl_or_b32 v100, v57, 16, v56
v_lshl_or_b32 v101, v59, 16, v58
v_lshl_or_b32 v102, v61, 16, v60
v_lshl_or_b32 v103, v63, 16, v62
s_mov_b32 s40, 248832
buffer_load_ushort v16, v4, s[16:19], s40 offen
s_mov_b32 s40, 249984
buffer_load_ushort v17, v4, s[16:19], s40 offen
s_mov_b32 s40, 251136
buffer_load_ushort v18, v4, s[16:19], s40 offen
s_mov_b32 s40, 252288
buffer_load_ushort v19, v4, s[16:19], s40 offen
s_mov_b32 s40, 269568
buffer_load_ushort v20, v4, s[16:19], s40 offen
s_mov_b32 s40, 270720
buffer_load_ushort v21, v4, s[16:19], s40 offen
s_mov_b32 s40, 271872
buffer_load_ushort v22, v4, s[16:19], s40 offen
s_mov_b32 s40, 273024
buffer_load_ushort v23, v4, s[16:19], s40 offen
s_mov_b32 s40, 290304
buffer_load_ushort v24, v4, s[16:19], s40 offen
s_mov_b32 s40, 291456
buffer_load_ushort v25, v4, s[16:19], s40 offen
s_mov_b32 s40, 292608
buffer_load_ushort v26, v4, s[16:19], s40 offen
s_mov_b32 s40, 293760
buffer_load_ushort v27, v4, s[16:19], s40 offen
s_mov_b32 s40, 311040
buffer_load_ushort v28, v4, s[16:19], s40 offen
s_mov_b32 s40, 312192
buffer_load_ushort v29, v4, s[16:19], s40 offen
s_mov_b32 s40, 313344
buffer_load_ushort v30, v4, s[16:19], s40 offen
s_mov_b32 s40, 314496
buffer_load_ushort v31, v4, s[16:19], s40 offen
s_mov_b32 s40, 331776
buffer_load_ushort v32, v4, s[16:19], s40 offen
s_mov_b32 s40, 332928
buffer_load_ushort v33, v4, s[16:19], s40 offen
s_mov_b32 s40, 334080
buffer_load_ushort v34, v4, s[16:19], s40 offen
s_mov_b32 s40, 335232
buffer_load_ushort v35, v4, s[16:19], s40 offen
s_mov_b32 s40, 352512
buffer_load_ushort v36, v4, s[16:19], s40 offen
s_mov_b32 s40, 353664
buffer_load_ushort v37, v4, s[16:19], s40 offen
s_mov_b32 s40, 354816
buffer_load_ushort v38, v4, s[16:19], s40 offen
s_mov_b32 s40, 355968
buffer_load_ushort v39, v4, s[16:19], s40 offen
s_mov_b32 s40, 373248
buffer_load_ushort v40, v4, s[16:19], s40 offen
s_mov_b32 s40, 374400
buffer_load_ushort v41, v4, s[16:19], s40 offen
s_mov_b32 s40, 375552
buffer_load_ushort v42, v4, s[16:19], s40 offen
s_mov_b32 s40, 376704
buffer_load_ushort v43, v4, s[16:19], s40 offen
s_mov_b32 s40, 393984
buffer_load_ushort v44, v4, s[16:19], s40 offen
s_mov_b32 s40, 395136
buffer_load_ushort v45, v4, s[16:19], s40 offen
s_mov_b32 s40, 396288
buffer_load_ushort v46, v4, s[16:19], s40 offen
s_mov_b32 s40, 397440
buffer_load_ushort v47, v4, s[16:19], s40 offen
s_mov_b32 s40, 414720
buffer_load_ushort v48, v4, s[16:19], s40 offen
s_mov_b32 s40, 415872
buffer_load_ushort v49, v4, s[16:19], s40 offen
s_mov_b32 s40, 417024
buffer_load_ushort v50, v4, s[16:19], s40 offen
s_mov_b32 s40, 418176
buffer_load_ushort v51, v4, s[16:19], s40 offen
s_mov_b32 s40, 435456
buffer_load_ushort v52, v4, s[16:19], s40 offen
s_mov_b32 s40, 436608
buffer_load_ushort v53, v4, s[16:19], s40 offen
s_mov_b32 s40, 437760
buffer_load_ushort v54, v4, s[16:19], s40 offen
s_mov_b32 s40, 438912
buffer_load_ushort v55, v4, s[16:19], s40 offen
s_mov_b32 s40, 456192
buffer_load_ushort v56, v4, s[16:19], s40 offen
s_mov_b32 s40, 457344
buffer_load_ushort v57, v4, s[16:19], s40 offen
s_mov_b32 s40, 458496
buffer_load_ushort v58, v4, s[16:19], s40 offen
s_mov_b32 s40, 459648
buffer_load_ushort v59, v4, s[16:19], s40 offen
s_mov_b32 s40, 476928
buffer_load_ushort v60, v4, s[16:19], s40 offen
s_mov_b32 s40, 478080
buffer_load_ushort v61, v4, s[16:19], s40 offen
s_mov_b32 s40, 479232
buffer_load_ushort v62, v4, s[16:19], s40 offen
s_mov_b32 s40, 480384
buffer_load_ushort v63, v4, s[16:19], s40 offen
s_waitcnt vmcnt(40)
v_lshl_or_b32 v104, v17, 16, v16
v_lshl_or_b32 v105, v19, 16, v18
v_lshl_or_b32 v106, v21, 16, v20
v_lshl_or_b32 v107, v23, 16, v22
s_waitcnt vmcnt(32)
v_lshl_or_b32 v108, v25, 16, v24
v_lshl_or_b32 v109, v27, 16, v26
v_lshl_or_b32 v110, v29, 16, v28
v_lshl_or_b32 v111, v31, 16, v30
s_waitcnt vmcnt(24)
v_lshl_or_b32 v112, v33, 16, v32
v_lshl_or_b32 v113, v35, 16, v34
v_lshl_or_b32 v114, v37, 16, v36
v_lshl_or_b32 v115, v39, 16, v38
s_waitcnt vmcnt(16)
v_lshl_or_b32 v116, v41, 16, v40
v_lshl_or_b32 v117, v43, 16, v42
v_lshl_or_b32 v118, v45, 16, v44
v_lshl_or_b32 v119, v47, 16, v46
s_waitcnt vmcnt(8)
v_lshl_or_b32 v120, v49, 16, v48
v_lshl_or_b32 v121, v51, 16, v50
v_lshl_or_b32 v122, v53, 16, v52
v_lshl_or_b32 v123, v55, 16, v54
s_waitcnt vmcnt(0)
v_lshl_or_b32 v124, v57, 16, v56
v_lshl_or_b32 v125, v59, 16, v58
v_lshl_or_b32 v126, v61, 16, v60
v_lshl_or_b32 v127, v63, 16, v62
s_mov_b32 s40, 497664
buffer_load_ushort v16, v4, s[16:19], s40 offen
s_mov_b32 s40, 498816
buffer_load_ushort v17, v4, s[16:19], s40 offen
s_mov_b32 s40, 499968
buffer_load_ushort v18, v4, s[16:19], s40 offen
s_mov_b32 s40, 501120
buffer_load_ushort v19, v4, s[16:19], s40 offen
s_mov_b32 s40, 518400
buffer_load_ushort v20, v4, s[16:19], s40 offen
s_mov_b32 s40, 519552
buffer_load_ushort v21, v4, s[16:19], s40 offen
s_mov_b32 s40, 520704
buffer_load_ushort v22, v4, s[16:19], s40 offen
s_mov_b32 s40, 521856
buffer_load_ushort v23, v4, s[16:19], s40 offen
s_mov_b32 s40, 539136
buffer_load_ushort v24, v4, s[16:19], s40 offen
s_mov_b32 s40, 540288
buffer_load_ushort v25, v4, s[16:19], s40 offen
s_mov_b32 s40, 541440
buffer_load_ushort v26, v4, s[16:19], s40 offen
s_mov_b32 s40, 542592
buffer_load_ushort v27, v4, s[16:19], s40 offen
s_mov_b32 s40, 559872
buffer_load_ushort v28, v4, s[16:19], s40 offen
s_mov_b32 s40, 561024
buffer_load_ushort v29, v4, s[16:19], s40 offen
s_mov_b32 s40, 562176
buffer_load_ushort v30, v4, s[16:19], s40 offen
s_mov_b32 s40, 563328
buffer_load_ushort v31, v4, s[16:19], s40 offen
s_mov_b32 s40, 580608
buffer_load_ushort v32, v4, s[16:19], s40 offen
s_mov_b32 s40, 581760
buffer_load_ushort v33, v4, s[16:19], s40 offen
s_mov_b32 s40, 582912
buffer_load_ushort v34, v4, s[16:19], s40 offen
s_mov_b32 s40, 584064
buffer_load_ushort v35, v4, s[16:19], s40 offen
s_mov_b32 s40, 601344
buffer_load_ushort v36, v4, s[16:19], s40 offen
s_mov_b32 s40, 602496
buffer_load_ushort v37, v4, s[16:19], s40 offen
s_mov_b32 s40, 603648
buffer_load_ushort v38, v4, s[16:19], s40 offen
s_mov_b32 s40, 604800
buffer_load_ushort v39, v4, s[16:19], s40 offen
s_mov_b32 s40, 622080
buffer_load_ushort v40, v4, s[16:19], s40 offen
s_mov_b32 s40, 623232
buffer_load_ushort v41, v4, s[16:19], s40 offen
s_mov_b32 s40, 624384
buffer_load_ushort v42, v4, s[16:19], s40 offen
s_mov_b32 s40, 625536
buffer_load_ushort v43, v4, s[16:19], s40 offen
s_mov_b32 s40, 642816
buffer_load_ushort v44, v4, s[16:19], s40 offen
s_mov_b32 s40, 643968
buffer_load_ushort v45, v4, s[16:19], s40 offen
s_mov_b32 s40, 645120
buffer_load_ushort v46, v4, s[16:19], s40 offen
s_mov_b32 s40, 646272
buffer_load_ushort v47, v4, s[16:19], s40 offen
s_mov_b32 s40, 18432
buffer_load_ushort v48, v5, s[16:19], s40 offen
s_mov_b32 s40, 19584
buffer_load_ushort v49, v5, s[16:19], s40 offen
s_mov_b32 s40, 39168
buffer_load_ushort v50, v5, s[16:19], s40 offen
s_mov_b32 s40, 40320
buffer_load_ushort v51, v5, s[16:19], s40 offen
s_mov_b32 s40, 59904
buffer_load_ushort v52, v5, s[16:19], s40 offen
s_mov_b32 s40, 61056
buffer_load_ushort v53, v5, s[16:19], s40 offen
s_mov_b32 s40, 80640
buffer_load_ushort v54, v5, s[16:19], s40 offen
s_mov_b32 s40, 81792
buffer_load_ushort v55, v5, s[16:19], s40 offen
s_mov_b32 s40, 350208
buffer_load_ushort v56, v5, s[16:19], s40 offen
s_mov_b32 s40, 351360
buffer_load_ushort v57, v5, s[16:19], s40 offen
s_mov_b32 s40, 370944
buffer_load_ushort v58, v5, s[16:19], s40 offen
s_mov_b32 s40, 372096
buffer_load_ushort v59, v5, s[16:19], s40 offen
s_mov_b32 s40, 391680
buffer_load_ushort v60, v5, s[16:19], s40 offen
s_mov_b32 s40, 392832
buffer_load_ushort v61, v5, s[16:19], s40 offen
s_mov_b32 s40, 412416
buffer_load_ushort v62, v5, s[16:19], s40 offen
s_mov_b32 s40, 413568
buffer_load_ushort v63, v5, s[16:19], s40 offen
s_waitcnt vmcnt(40)
v_lshl_or_b32 v128, v17, 16, v16
v_lshl_or_b32 v129, v19, 16, v18
v_lshl_or_b32 v130, v21, 16, v20
v_lshl_or_b32 v131, v23, 16, v22
s_waitcnt vmcnt(32)
v_lshl_or_b32 v132, v25, 16, v24
v_lshl_or_b32 v133, v27, 16, v26
v_lshl_or_b32 v134, v29, 16, v28
v_lshl_or_b32 v135, v31, 16, v30
s_waitcnt vmcnt(24)
v_lshl_or_b32 v136, v33, 16, v32
v_lshl_or_b32 v137, v35, 16, v34
v_lshl_or_b32 v138, v37, 16, v36
v_lshl_or_b32 v139, v39, 16, v38
s_waitcnt vmcnt(16)
v_lshl_or_b32 v140, v41, 16, v40
v_lshl_or_b32 v141, v43, 16, v42
v_lshl_or_b32 v142, v45, 16, v44
v_lshl_or_b32 v143, v47, 16, v46
s_waitcnt vmcnt(8)
v_lshl_or_b32 v144, v49, 16, v48
v_lshl_or_b32 v145, v51, 16, v50
v_lshl_or_b32 v146, v53, 16, v52
v_lshl_or_b32 v147, v55, 16, v54
s_waitcnt vmcnt(0)
v_lshl_or_b32 v148, v57, 16, v56
v_lshl_or_b32 v149, v59, 16, v58
v_lshl_or_b32 v150, v61, 16, v60
v_lshl_or_b32 v151, v63, 16, v62
s_mul_i32 s29, s21, 92160
s_lshl_b32 s30, s22, 10
s_add_u32 s29, s29, s30
s_add_u32 s29, s29, 2621440
s_add_u32 s40, s29, 0
buffer_store_dwordx4 v[80:83], v2, s[8:11], s40 offen
s_add_u32 s40, s29, 5120
buffer_store_dwordx4 v[84:87], v2, s[8:11], s40 offen
s_add_u32 s40, s29, 10240
buffer_store_dwordx4 v[88:91], v2, s[8:11], s40 offen
s_add_u32 s40, s29, 15360
buffer_store_dwordx4 v[92:95], v2, s[8:11], s40 offen
s_add_u32 s40, s29, 20480
buffer_store_dwordx4 v[96:99], v2, s[8:11], s40 offen
s_add_u32 s40, s29, 25600
buffer_store_dwordx4 v[100:103], v2, s[8:11], s40 offen
s_add_u32 s40, s29, 30720
buffer_store_dwordx4 v[104:107], v2, s[8:11], s40 offen
s_add_u32 s40, s29, 35840
buffer_store_dwordx4 v[108:111], v2, s[8:11], s40 offen
s_add_u32 s40, s29, 40960
buffer_store_dwordx4 v[112:115], v2, s[8:11], s40 offen
s_add_u32 s40, s29, 46080
buffer_store_dwordx4 v[116:119], v2, s[8:11], s40 offen
s_add_u32 s40, s29, 51200
buffer_store_dwordx4 v[120:123], v2, s[8:11], s40 offen
s_add_u32 s40, s29, 56320
buffer_store_dwordx4 v[124:127], v2, s[8:11], s40 offen
s_add_u32 s40, s29, 61440
buffer_store_dwordx4 v[128:131], v2, s[8:11], s40 offen
s_add_u32 s40, s29, 66560
buffer_store_dwordx4 v[132:135], v2, s[8:11], s40 offen
s_add_u32 s40, s29, 71680
buffer_store_dwordx4 v[136:139], v2, s[8:11], s40 offen
s_add_u32 s40, s29, 76800
buffer_store_dwordx4 v[140:143], v2, s[8:11], s40 offen
s_add_u32 s40, s29, 81920
buffer_store_dwordx4 v[144:147], v2, s[8:11], s40 offen
s_add_u32 s40, s29, 87040
buffer_store_dwordx4 v[148:151], v2, s[8:11], s40 offen
L_prep_end:
s_endpgm
.p2align 8
.globl a1l1_kernel
.type a1l1_kernel,@function
a1l1_kernel:
s_cmp_ge_u32 s2, 256
s_cbranch_scc1 L_a1l_end
s_mov_b32 s70, 21684224
s_mov_b32 s71, 26402816
s_mov_b32 s72, 31121408
s_mov_b32 s73, 35840000
s_mov_b32 s74, 38330368
s_mov_b32 s75, 57335808
s_mov_b32 s76, 95084544
s_mov_b32 s77, 16384
s_branch L_a1l_body
.p2align 8
.globl a1l0_kernel
.type a1l0_kernel,@function
a1l0_kernel:
s_cmp_ge_u32 s2, 256
s_cbranch_scc1 L_a1l_end
s_mov_b32 s70, 19324928
s_mov_b32 s71, 24043520
s_mov_b32 s72, 28762112
s_mov_b32 s73, 33480704
s_mov_b32 s74, 38199296
s_mov_b32 s75, 38461440
s_mov_b32 s76, 76210176
s_mov_b32 s77, 0
L_a1l_body:
s_load_dwordx2 s[12:13], s[0:1], 72
v_and_b32 v1, 63, v0
v_lshrrev_b32 v3, 6, v0
v_lshlrev_b32 v2, 4, v1
v_readfirstlane_b32 s4, v3
s_and_b32 s5, s2, 7
s_lshr_b32 s6, s2, 3
s_waitcnt lgkmcnt(0)
s_mov_b32 s8, s12
s_and_b32 s9, s13, 0xffff
s_mov_b32 s10, 268435456
s_mov_b32 s11, 0x20000
s_lshr_b32 s20, s6, 4
s_lshl_b32 s21, s5, 1
s_add_u32 s20, s20, s21
s_and_b32 s21, s6, 15
s_mul_i32 s22, s21, 147456
s_mul_i32 s23, s4, 36864
s_add_u32 s22, s22, s23
s_add_u32 s22, s22, 262144
s_add_u32 m0, s23, 0
s_add_u32 s40, s22, 0
buffer_load_dwordx4 v2, s[8:11], s40 offen offset:0 lds
buffer_load_dwordx4 v2, s[8:11], s40 offen offset:1024 lds
buffer_load_dwordx4 v2, s[8:11], s40 offen offset:2048 lds
buffer_load_dwordx4 v2, s[8:11], s40 offen offset:3072 lds
s_add_u32 m0, s23, 4096
s_add_u32 s40, s22, 4096
buffer_load_dwordx4 v2, s[8:11], s40 offen offset:0 lds
buffer_load_dwordx4 v2, s[8:11], s40 offen offset:1024 lds
buffer_load_dwordx4 v2, s[8:11], s40 offen offset:2048 lds
buffer_load_dwordx4 v2, s[8:11], s40 offen offset:3072 lds
s_add_u32 m0, s23, 8192
s_add_u32 s40, s22, 8192
buffer_load_dwordx4 v2, s[8:11], s40 offen offset:0 lds
buffer_load_dwordx4 v2, s[8:11], s40 offen offset:1024 lds
buffer_load_dwordx4 v2, s[8:11], s40 offen offset:2048 lds
buffer_load_dwordx4 v2, s[8:11], s40 offen offset:3072 lds
s_add_u32 m0, s23, 12288
s_add_u32 s40, s22, 12288
buffer_load_dwordx4 v2, s[8:11], s40 offen offset:0 lds
buffer_load_dwordx4 v2, s[8:11], s40 offen offset:1024 lds
buffer_load_dwordx4 v2, s[8:11], s40 offen offset:2048 lds
buffer_load_dwordx4 v2, s[8:11], s40 offen offset:3072 lds
s_add_u32 m0, s23, 16384
s_add_u32 s40, s22, 16384
buffer_load_dwordx4 v2, s[8:11], s40 offen offset:0 lds
buffer_load_dwordx4 v2, s[8:11], s40 offen offset:1024 lds
buffer_load_dwordx4 v2, s[8:11], s40 offen offset:2048 lds
buffer_load_dwordx4 v2, s[8:11], s40 offen offset:3072 lds
s_add_u32 m0, s23, 20480
s_add_u32 s40, s22, 20480
buffer_load_dwordx4 v2, s[8:11], s40 offen offset:0 lds
buffer_load_dwordx4 v2, s[8:11], s40 offen offset:1024 lds
buffer_load_dwordx4 v2, s[8:11], s40 offen offset:2048 lds
buffer_load_dwordx4 v2, s[8:11], s40 offen offset:3072 lds
s_add_u32 m0, s23, 24576
s_add_u32 s40, s22, 24576
buffer_load_dwordx4 v2, s[8:11], s40 offen offset:0 lds
buffer_load_dwordx4 v2, s[8:11], s40 offen offset:1024 lds
buffer_load_dwordx4 v2, s[8:11], s40 offen offset:2048 lds
buffer_load_dwordx4 v2, s[8:11], s40 offen offset:3072 lds
s_add_u32 m0, s23, 28672
s_add_u32 s40, s22, 28672
buffer_load_dwordx4 v2, s[8:11], s40 offen offset:0 lds
buffer_load_dwordx4 v2, s[8:11], s40 offen offset:1024 lds
buffer_load_dwordx4 v2, s[8:11], s40 offen offset:2048 lds
buffer_load_dwordx4 v2, s[8:11], s40 offen offset:3072 lds
s_add_u32 m0, s23, 32768
s_add_u32 s40, s22, 32768
buffer_load_dwordx4 v2, s[8:11], s40 offen offset:0 lds
buffer_load_dwordx4 v2, s[8:11], s40 offen offset:1024 lds
buffer_load_dwordx4 v2, s[8:11], s40 offen offset:2048 lds
buffer_load_dwordx4 v2, s[8:11], s40 offen offset:3072 lds
s_lshl_b32 s24, s20, 3
s_sub_u32 s25, s24, 1
s_max_i32 s25, s25, 0
s_mul_i32 s25, s25, 18432
s_lshl_b32 s26, s4, 1
s_add_u32 s24, s24, s26
s_mul_i32 s24, s24, 18432
s_add_u32 s26, s24, s70
s_add_u32 s27, s26, 18432
s_add_u32 s28, s25, s70
buffer_load_dwordx4 a[0:3], v2, s[8:11], s26 offen offset:0
buffer_load_dwordx4 a[72:75], v2, s[8:11], s27 offen offset:0
buffer_load_dwordx4 a[144:147], v2, s[8:11], s28 offen offset:0
buffer_load_dwordx4 a[4:7], v2, s[8:11], s26 offen offset:1024
buffer_load_dwordx4 a[76:79], v2, s[8:11], s27 offen offset:1024
buffer_load_dwordx4 a[148:151], v2, s[8:11], s28 offen offset:1024
buffer_load_dwordx4 a[8:11], v2, s[8:11], s26 offen offset:2048
buffer_load_dwordx4 a[80:83], v2, s[8:11], s27 offen offset:2048
buffer_load_dwordx4 a[152:155], v2, s[8:11], s28 offen offset:2048
buffer_load_dwordx4 a[12:15], v2, s[8:11], s26 offen offset:3072
buffer_load_dwordx4 a[84:87], v2, s[8:11], s27 offen offset:3072
buffer_load_dwordx4 a[156:159], v2, s[8:11], s28 offen offset:3072
s_add_u32 s26, s26, 4096
s_add_u32 s27, s27, 4096
s_add_u32 s28, s28, 4096
buffer_load_dwordx4 a[16:19], v2, s[8:11], s26 offen offset:0
buffer_load_dwordx4 a[88:91], v2, s[8:11], s27 offen offset:0
buffer_load_dwordx4 a[160:163], v2, s[8:11], s28 offen offset:0
buffer_load_dwordx4 a[20:23], v2, s[8:11], s26 offen offset:1024
buffer_load_dwordx4 a[92:95], v2, s[8:11], s27 offen offset:1024
buffer_load_dwordx4 a[164:167], v2, s[8:11], s28 offen offset:1024
buffer_load_dwordx4 a[24:27], v2, s[8:11], s26 offen offset:2048
buffer_load_dwordx4 a[96:99], v2, s[8:11], s27 offen offset:2048
buffer_load_dwordx4 a[168:171], v2, s[8:11], s28 offen offset:2048
buffer_load_dwordx4 a[28:31], v2, s[8:11], s26 offen offset:3072
buffer_load_dwordx4 a[100:103], v2, s[8:11], s27 offen offset:3072
buffer_load_dwordx4 a[172:175], v2, s[8:11], s28 offen offset:3072
s_add_u32 s26, s26, 4096
s_add_u32 s27, s27, 4096
s_add_u32 s28, s28, 4096
buffer_load_dwordx4 a[32:35], v2, s[8:11], s26 offen offset:0
buffer_load_dwordx4 a[104:107], v2, s[8:11], s27 offen offset:0
buffer_load_dwordx4 a[176:179], v2, s[8:11], s28 offen offset:0
buffer_load_dwordx4 a[36:39], v2, s[8:11], s26 offen offset:1024
buffer_load_dwordx4 a[108:111], v2, s[8:11], s27 offen offset:1024
buffer_load_dwordx4 a[180:183], v2, s[8:11], s28 offen offset:1024
buffer_load_dwordx4 a[40:43], v2, s[8:11], s26 offen offset:2048
buffer_load_dwordx4 a[112:115], v2, s[8:11], s27 offen offset:2048
buffer_load_dwordx4 a[184:187], v2, s[8:11], s28 offen offset:2048
buffer_load_dwordx4 a[44:47], v2, s[8:11], s26 offen offset:3072
buffer_load_dwordx4 a[116:119], v2, s[8:11], s27 offen offset:3072
buffer_load_dwordx4 a[188:191], v2, s[8:11], s28 offen offset:3072
s_add_u32 s26, s26, 4096
s_add_u32 s27, s27, 4096
s_add_u32 s28, s28, 4096
buffer_load_dwordx4 a[48:51], v2, s[8:11], s26 offen offset:0
buffer_load_dwordx4 a[120:123], v2, s[8:11], s27 offen offset:0
buffer_load_dwordx4 a[192:195], v2, s[8:11], s28 offen offset:0
buffer_load_dwordx4 a[52:55], v2, s[8:11], s26 offen offset:1024
buffer_load_dwordx4 a[124:127], v2, s[8:11], s27 offen offset:1024
buffer_load_dwordx4 a[196:199], v2, s[8:11], s28 offen offset:1024
buffer_load_dwordx4 a[56:59], v2, s[8:11], s26 offen offset:2048
buffer_load_dwordx4 a[128:131], v2, s[8:11], s27 offen offset:2048
buffer_load_dwordx4 a[200:203], v2, s[8:11], s28 offen offset:2048
buffer_load_dwordx4 a[60:63], v2, s[8:11], s26 offen offset:3072
buffer_load_dwordx4 a[132:135], v2, s[8:11], s27 offen offset:3072
buffer_load_dwordx4 a[204:207], v2, s[8:11], s28 offen offset:3072
s_add_u32 s26, s26, 4096
s_add_u32 s27, s27, 4096
s_add_u32 s28, s28, 4096
buffer_load_dwordx4 a[64:67], v2, s[8:11], s26 offen offset:0
buffer_load_dwordx4 a[136:139], v2, s[8:11], s27 offen offset:0
buffer_load_dwordx4 a[208:211], v2, s[8:11], s28 offen offset:0
buffer_load_dwordx4 a[68:71], v2, s[8:11], s26 offen offset:1024
buffer_load_dwordx4 a[140:143], v2, s[8:11], s27 offen offset:1024
buffer_load_dwordx4 a[212:215], v2, s[8:11], s28 offen offset:1024
v_add_u32 v4, 0x10000, v2
v_add_u32 v5, 0x20000, v2
s_cmp_eq_u32 s4, 3
s_cselect_b32 s29, 0, s4
s_lshl_b32 s30, s29, 10
s_add_u32 s31, s30, 2048
v_add_u32 v6, s31, v2
v_add_u32 v7, s31, v4
v_add_u32 v8, s31, v5
s_add_u32 s31, s30, 5120
v_add_u32 v9, s31, v2
v_add_u32 v10, s31, v4
v_add_u32 v11, s31, v5
v_and_b32 v12, 15, v1
v_lshrrev_b32 v13, 4, v1
v_lshlrev_b32 v14, 2, v13
v_sub_u32 v14, v12, v14
v_subrev_u32 v15, 0, v14
v_cmp_gt_u32 s[52:53], 8, v15
v_cmp_gt_i32 s[44:45], -8, v15
v_subrev_u32 v15, 1, v14
v_cmp_gt_u32 s[54:55], 8, v15
v_cmp_gt_i32 s[46:47], -8, v15
v_subrev_u32 v15, 2, v14
v_cmp_gt_u32 s[56:57], 8, v15
v_cmp_gt_i32 s[48:49], -8, v15
v_subrev_u32 v15, 3, v14
v_cmp_gt_u32 s[58:59], 8, v15
v_cmp_gt_i32 s[50:51], -8, v15
s_and_b32 s31, s20, 7
s_or_b32 s31, s31, s4
s_cmp_eq_u32 s31, 0
s_cselect_b64 s[60:61], 0, s[44:45]
s_cselect_b64 s[62:63], 0, s[46:47]
s_cselect_b64 s[64:65], 0, s[48:49]
s_cselect_b64 s[66:67], 0, s[50:51]
s_waitcnt vmcnt(54)
s_barrier
ds_read_b128 a[216:219], v2 offset:0
ds_read_b128 a[220:223], v2 offset:8192
ds_read_b128 a[224:227], v2 offset:1024
ds_read_b128 a[228:231], v2 offset:9216
ds_read_b128 a[232:235], v2 offset:2048
ds_read_b128 a[236:239], v2 offset:10240
s_waitcnt vmcnt(48)
s_waitcnt lgkmcnt(4)
v_mfma_f32_16x16x32_bf16 v[32:35], a[216:219], a[0:3], 0
v_mfma_f32_16x16x32_bf16 v[32:35], a[220:223], a[4:7], v[32:35]
ds_read_b128 a[240:243], v2 offset:3072
v_mfma_f32_16x16x32_bf16 v[36:39], a[216:219], a[72:75], 0
v_mfma_f32_16x16x32_bf16 v[36:39], a[220:223], a[76:79], v[36:39]
ds_read_b128 a[244:247], v2 offset:11264
s_waitcnt lgkmcnt(4)
v_mfma_f32_16x16x32_bf16 v[40:43], a[224:227], a[0:3], 0
v_mfma_f32_16x16x32_bf16 v[40:43], a[228:231], a[4:7], v[40:43]
ds_read_b128 a[216:219], v2 offset:4096
v_mfma_f32_16x16x32_bf16 v[44:47], a[224:227], a[72:75], 0
v_mfma_f32_16x16x32_bf16 v[44:47], a[228:231], a[76:79], v[44:47]
ds_read_b128 a[220:223], v2 offset:12288
s_waitcnt lgkmcnt(4)
v_mfma_f32_16x16x32_bf16 v[48:51], a[232:235], a[0:3], 0
v_mfma_f32_16x16x32_bf16 v[48:51], a[236:239], a[4:7], v[48:51]
ds_read_b128 a[224:227], v2 offset:5120
v_mfma_f32_16x16x32_bf16 v[52:55], a[232:235], a[72:75], 0
v_mfma_f32_16x16x32_bf16 v[52:55], a[236:239], a[76:79], v[52:55]
ds_read_b128 a[228:231], v2 offset:13312
s_waitcnt lgkmcnt(4)
v_mfma_f32_16x16x32_bf16 v[56:59], a[240:243], a[0:3], 0
v_mfma_f32_16x16x32_bf16 v[56:59], a[244:247], a[4:7], v[56:59]
ds_read_b128 a[232:235], v2 offset:6144
v_mfma_f32_16x16x32_bf16 v[60:63], a[240:243], a[72:75], 0
v_mfma_f32_16x16x32_bf16 v[60:63], a[244:247], a[76:79], v[60:63]
ds_read_b128 a[236:239], v2 offset:14336
s_waitcnt lgkmcnt(4)
v_mfma_f32_16x16x32_bf16 v[64:67], a[216:219], a[0:3], 0
v_mfma_f32_16x16x32_bf16 v[64:67], a[220:223], a[4:7], v[64:67]
ds_read_b128 a[240:243], v2 offset:7168
v_mfma_f32_16x16x32_bf16 v[68:71], a[216:219], a[72:75], 0
v_mfma_f32_16x16x32_bf16 v[68:71], a[220:223], a[76:79], v[68:71]
ds_read_b128 a[244:247], v2 offset:15360
s_waitcnt lgkmcnt(4)
v_mfma_f32_16x16x32_bf16 v[72:75], a[0:3], a[224:227], 0
v_mfma_f32_16x16x32_bf16 v[72:75], a[4:7], a[228:231], v[72:75]
ds_read_b128 a[216:219], v6 offset:0
v_mfma_f32_16x16x32_bf16 v[76:79], a[72:75], a[224:227], 0
v_mfma_f32_16x16x32_bf16 v[76:79], a[76:79], a[228:231], v[76:79]
ds_read_b128 a[220:223], v6 offset:8192
s_waitcnt lgkmcnt(4)
v_mfma_f32_16x16x32_bf16 v[80:83], a[0:3], a[232:235], 0
v_mfma_f32_16x16x32_bf16 v[80:83], a[4:7], a[236:239], v[80:83]
ds_read_b128 a[224:227], v9 offset:0
v_mfma_f32_16x16x32_bf16 v[84:87], a[72:75], a[232:235], 0
v_mfma_f32_16x16x32_bf16 v[84:87], a[76:79], a[236:239], v[84:87]
ds_read_b128 a[228:231], v9 offset:8192
s_waitcnt lgkmcnt(4)
v_mfma_f32_16x16x32_bf16 v[88:91], a[0:3], a[240:243], 0
v_mfma_f32_16x16x32_bf16 v[88:91], a[4:7], a[244:247], v[88:91]
ds_read_b128 a[232:235], v2 offset:16384
v_mfma_f32_16x16x32_bf16 v[92:95], a[72:75], a[240:243], 0
v_mfma_f32_16x16x32_bf16 v[92:95], a[76:79], a[244:247], v[92:95]
ds_read_b128 a[236:239], v2 offset:24576
s_waitcnt lgkmcnt(4)
v_mfma_f32_16x16x32_bf16 v[96:99], a[216:219], a[144:147], 0
ds_read_b128 a[240:243], v2 offset:17408
v_mfma_f32_16x16x32_bf16 v[96:99], a[220:223], a[148:151], v[96:99]
ds_read_b128 a[244:247], v2 offset:25600
s_waitcnt lgkmcnt(4)
v_mfma_f32_16x16x32_bf16 v[100:103], a[144:147], a[224:227], 0
ds_read_b128 a[216:219], v2 offset:18432
v_mfma_f32_16x16x32_bf16 v[100:103], a[148:151], a[228:231], v[100:103]
ds_read_b128 a[220:223], v2 offset:26624
s_waitcnt vmcnt(42)
s_waitcnt lgkmcnt(4)
v_mfma_f32_16x16x32_bf16 v[32:35], a[232:235], a[8:11], v[32:35]
v_mfma_f32_16x16x32_bf16 v[32:35], a[236:239], a[12:15], v[32:35]
ds_read_b128 a[224:227], v2 offset:19456
v_mfma_f32_16x16x32_bf16 v[36:39], a[232:235], a[80:83], v[36:39]
v_mfma_f32_16x16x32_bf16 v[36:39], a[236:239], a[84:87], v[36:39]
ds_read_b128 a[228:231], v2 offset:27648
s_waitcnt lgkmcnt(4)
v_mfma_f32_16x16x32_bf16 v[40:43], a[240:243], a[8:11], v[40:43]
v_mfma_f32_16x16x32_bf16 v[40:43], a[244:247], a[12:15], v[40:43]
ds_read_b128 a[232:235], v2 offset:20480
v_mfma_f32_16x16x32_bf16 v[44:47], a[240:243], a[80:83], v[44:47]
v_mfma_f32_16x16x32_bf16 v[44:47], a[244:247], a[84:87], v[44:47]
ds_read_b128 a[236:239], v2 offset:28672
s_waitcnt lgkmcnt(4)
v_mfma_f32_16x16x32_bf16 v[48:51], a[216:219], a[8:11], v[48:51]
v_mfma_f32_16x16x32_bf16 v[48:51], a[220:223], a[12:15], v[48:51]
ds_read_b128 a[240:243], v2 offset:21504
v_mfma_f32_16x16x32_bf16 v[52:55], a[216:219], a[80:83], v[52:55]
v_mfma_f32_16x16x32_bf16 v[52:55], a[220:223], a[84:87], v[52:55]
ds_read_b128 a[244:247], v2 offset:29696
s_waitcnt lgkmcnt(4)
v_mfma_f32_16x16x32_bf16 v[56:59], a[224:227], a[8:11], v[56:59]
v_mfma_f32_16x16x32_bf16 v[56:59], a[228:231], a[12:15], v[56:59]
ds_read_b128 a[216:219], v2 offset:22528
v_mfma_f32_16x16x32_bf16 v[60:63], a[224:227], a[80:83], v[60:63]
v_mfma_f32_16x16x32_bf16 v[60:63], a[228:231], a[84:87], v[60:63]
ds_read_b128 a[220:223], v2 offset:30720
s_waitcnt lgkmcnt(4)
v_mfma_f32_16x16x32_bf16 v[64:67], a[232:235], a[8:11], v[64:67]
v_mfma_f32_16x16x32_bf16 v[64:67], a[236:239], a[12:15], v[64:67]
ds_read_b128 a[224:227], v2 offset:23552
v_mfma_f32_16x16x32_bf16 v[68:71], a[232:235], a[80:83], v[68:71]
v_mfma_f32_16x16x32_bf16 v[68:71], a[236:239], a[84:87], v[68:71]
ds_read_b128 a[228:231], v2 offset:31744
s_waitcnt lgkmcnt(4)
v_mfma_f32_16x16x32_bf16 v[72:75], a[8:11], a[240:243], v[72:75]
v_mfma_f32_16x16x32_bf16 v[72:75], a[12:15], a[244:247], v[72:75]
ds_read_b128 a[232:235], v6 offset:16384
v_mfma_f32_16x16x32_bf16 v[76:79], a[80:83], a[240:243], v[76:79]
v_mfma_f32_16x16x32_bf16 v[76:79], a[84:87], a[244:247], v[76:79]
ds_read_b128 a[236:239], v6 offset:24576
s_waitcnt lgkmcnt(4)
v_mfma_f32_16x16x32_bf16 v[80:83], a[8:11], a[216:219], v[80:83]
v_mfma_f32_16x16x32_bf16 v[80:83], a[12:15], a[220:223], v[80:83]
ds_read_b128 a[240:243], v9 offset:16384
v_mfma_f32_16x16x32_bf16 v[84:87], a[80:83], a[216:219], v[84:87]
v_mfma_f32_16x16x32_bf16 v[84:87], a[84:87], a[220:223], v[84:87]
ds_read_b128 a[244:247], v9 offset:24576
s_waitcnt lgkmcnt(4)
v_mfma_f32_16x16x32_bf16 v[88:91], a[8:11], a[224:227], v[88:91]
v_mfma_f32_16x16x32_bf16 v[88:91], a[12:15], a[228:231], v[88:91]
ds_read_b128 a[216:219], v2 offset:32768
v_mfma_f32_16x16x32_bf16 v[92:95], a[80:83], a[224:227], v[92:95]
v_mfma_f32_16x16x32_bf16 v[92:95], a[84:87], a[228:231], v[92:95]
ds_read_b128 a[220:223], v2 offset:40960
s_waitcnt lgkmcnt(4)
v_mfma_f32_16x16x32_bf16 v[96:99], a[232:235], a[152:155], v[96:99]
ds_read_b128 a[224:227], v2 offset:33792
v_mfma_f32_16x16x32_bf16 v[96:99], a[236:239], a[156:159], v[96:99]
ds_read_b128 a[228:231], v2 offset:41984
s_waitcnt lgkmcnt(4)
v_mfma_f32_16x16x32_bf16 v[100:103], a[152:155], a[240:243], v[100:103]
ds_read_b128 a[232:235], v2 offset:34816
v_mfma_f32_16x16x32_bf16 v[100:103], a[156:159], a[244:247], v[100:103]
ds_read_b128 a[236:239], v2 offset:43008
s_waitcnt vmcnt(36)
s_waitcnt lgkmcnt(4)
v_mfma_f32_16x16x32_bf16 v[32:35], a[216:219], a[16:19], v[32:35]
v_mfma_f32_16x16x32_bf16 v[32:35], a[220:223], a[20:23], v[32:35]
ds_read_b128 a[240:243], v2 offset:35840
v_mfma_f32_16x16x32_bf16 v[36:39], a[216:219], a[88:91], v[36:39]
v_mfma_f32_16x16x32_bf16 v[36:39], a[220:223], a[92:95], v[36:39]
ds_read_b128 a[244:247], v2 offset:44032
s_waitcnt lgkmcnt(4)
v_mfma_f32_16x16x32_bf16 v[40:43], a[224:227], a[16:19], v[40:43]
v_mfma_f32_16x16x32_bf16 v[40:43], a[228:231], a[20:23], v[40:43]
ds_read_b128 a[216:219], v2 offset:36864
v_mfma_f32_16x16x32_bf16 v[44:47], a[224:227], a[88:91], v[44:47]
v_mfma_f32_16x16x32_bf16 v[44:47], a[228:231], a[92:95], v[44:47]
ds_read_b128 a[220:223], v2 offset:45056
s_waitcnt lgkmcnt(4)
v_mfma_f32_16x16x32_bf16 v[48:51], a[232:235], a[16:19], v[48:51]
v_mfma_f32_16x16x32_bf16 v[48:51], a[236:239], a[20:23], v[48:51]
ds_read_b128 a[224:227], v2 offset:37888
v_mfma_f32_16x16x32_bf16 v[52:55], a[232:235], a[88:91], v[52:55]
v_mfma_f32_16x16x32_bf16 v[52:55], a[236:239], a[92:95], v[52:55]
ds_read_b128 a[228:231], v2 offset:46080
s_waitcnt lgkmcnt(4)
v_mfma_f32_16x16x32_bf16 v[56:59], a[240:243], a[16:19], v[56:59]
v_mfma_f32_16x16x32_bf16 v[56:59], a[244:247], a[20:23], v[56:59]
ds_read_b128 a[232:235], v2 offset:38912
v_mfma_f32_16x16x32_bf16 v[60:63], a[240:243], a[88:91], v[60:63]
v_mfma_f32_16x16x32_bf16 v[60:63], a[244:247], a[92:95], v[60:63]
ds_read_b128 a[236:239], v2 offset:47104
s_waitcnt lgkmcnt(4)
v_mfma_f32_16x16x32_bf16 v[64:67], a[216:219], a[16:19], v[64:67]
v_mfma_f32_16x16x32_bf16 v[64:67], a[220:223], a[20:23], v[64:67]
ds_read_b128 a[240:243], v2 offset:39936
v_mfma_f32_16x16x32_bf16 v[68:71], a[216:219], a[88:91], v[68:71]
v_mfma_f32_16x16x32_bf16 v[68:71], a[220:223], a[92:95], v[68:71]
ds_read_b128 a[244:247], v2 offset:48128
s_waitcnt lgkmcnt(4)
v_mfma_f32_16x16x32_bf16 v[72:75], a[16:19], a[224:227], v[72:75]
v_mfma_f32_16x16x32_bf16 v[72:75], a[20:23], a[228:231], v[72:75]
ds_read_b128 a[216:219], v6 offset:32768
v_mfma_f32_16x16x32_bf16 v[76:79], a[88:91], a[224:227], v[76:79]
v_mfma_f32_16x16x32_bf16 v[76:79], a[92:95], a[228:231], v[76:79]
ds_read_b128 a[220:223], v6 offset:40960
s_waitcnt lgkmcnt(4)
v_mfma_f32_16x16x32_bf16 v[80:83], a[16:19], a[232:235], v[80:83]
v_mfma_f32_16x16x32_bf16 v[80:83], a[20:23], a[236:239], v[80:83]
ds_read_b128 a[224:227], v9 offset:32768
v_mfma_f32_16x16x32_bf16 v[84:87], a[88:91], a[232:235], v[84:87]
v_mfma_f32_16x16x32_bf16 v[84:87], a[92:95], a[236:239], v[84:87]
ds_read_b128 a[228:231], v9 offset:40960
s_waitcnt lgkmcnt(4)
v_mfma_f32_16x16x32_bf16 v[88:91], a[16:19], a[240:243], v[88:91]
v_mfma_f32_16x16x32_bf16 v[88:91], a[20:23], a[244:247], v[88:91]
ds_read_b128 a[232:235], v2 offset:49152
v_mfma_f32_16x16x32_bf16 v[92:95], a[88:91], a[240:243], v[92:95]
v_mfma_f32_16x16x32_bf16 v[92:95], a[92:95], a[244:247], v[92:95]
ds_read_b128 a[236:239], v2 offset:57344
s_waitcnt lgkmcnt(4)
v_mfma_f32_16x16x32_bf16 v[96:99], a[216:219], a[160:163], v[96:99]
ds_read_b128 a[240:243], v2 offset:50176
v_mfma_f32_16x16x32_bf16 v[96:99], a[220:223], a[164:167], v[96:99]
ds_read_b128 a[244:247], v2 offset:58368
s_waitcnt lgkmcnt(4)
v_mfma_f32_16x16x32_bf16 v[100:103], a[160:163], a[224:227], v[100:103]
ds_read_b128 a[216:219], v2 offset:51200
v_mfma_f32_16x16x32_bf16 v[100:103], a[164:167], a[228:231], v[100:103]
ds_read_b128 a[220:223], v2 offset:59392
s_waitcnt vmcnt(30)
s_waitcnt lgkmcnt(4)
v_mfma_f32_16x16x32_bf16 v[32:35], a[232:235], a[24:27], v[32:35]
v_mfma_f32_16x16x32_bf16 v[32:35], a[236:239], a[28:31], v[32:35]
ds_read_b128 a[224:227], v2 offset:52224
v_mfma_f32_16x16x32_bf16 v[36:39], a[232:235], a[96:99], v[36:39]
v_mfma_f32_16x16x32_bf16 v[36:39], a[236:239], a[100:103], v[36:39]
ds_read_b128 a[228:231], v2 offset:60416
s_waitcnt lgkmcnt(4)
v_mfma_f32_16x16x32_bf16 v[40:43], a[240:243], a[24:27], v[40:43]
v_mfma_f32_16x16x32_bf16 v[40:43], a[244:247], a[28:31], v[40:43]
ds_read_b128 a[232:235], v2 offset:53248
v_mfma_f32_16x16x32_bf16 v[44:47], a[240:243], a[96:99], v[44:47]
v_mfma_f32_16x16x32_bf16 v[44:47], a[244:247], a[100:103], v[44:47]
ds_read_b128 a[236:239], v2 offset:61440
s_waitcnt lgkmcnt(4)
v_mfma_f32_16x16x32_bf16 v[48:51], a[216:219], a[24:27], v[48:51]
v_mfma_f32_16x16x32_bf16 v[48:51], a[220:223], a[28:31], v[48:51]
ds_read_b128 a[240:243], v2 offset:54272
v_mfma_f32_16x16x32_bf16 v[52:55], a[216:219], a[96:99], v[52:55]
v_mfma_f32_16x16x32_bf16 v[52:55], a[220:223], a[100:103], v[52:55]
ds_read_b128 a[244:247], v2 offset:62464
s_waitcnt lgkmcnt(4)
v_mfma_f32_16x16x32_bf16 v[56:59], a[224:227], a[24:27], v[56:59]
v_mfma_f32_16x16x32_bf16 v[56:59], a[228:231], a[28:31], v[56:59]
ds_read_b128 a[216:219], v2 offset:55296
v_mfma_f32_16x16x32_bf16 v[60:63], a[224:227], a[96:99], v[60:63]
v_mfma_f32_16x16x32_bf16 v[60:63], a[228:231], a[100:103], v[60:63]
ds_read_b128 a[220:223], v2 offset:63488
s_waitcnt lgkmcnt(4)
v_mfma_f32_16x16x32_bf16 v[64:67], a[232:235], a[24:27], v[64:67]
v_mfma_f32_16x16x32_bf16 v[64:67], a[236:239], a[28:31], v[64:67]
ds_read_b128 a[224:227], v2 offset:56320
v_mfma_f32_16x16x32_bf16 v[68:71], a[232:235], a[96:99], v[68:71]
v_mfma_f32_16x16x32_bf16 v[68:71], a[236:239], a[100:103], v[68:71]
ds_read_b128 a[228:231], v2 offset:64512
s_waitcnt lgkmcnt(4)
v_mfma_f32_16x16x32_bf16 v[72:75], a[24:27], a[240:243], v[72:75]
v_mfma_f32_16x16x32_bf16 v[72:75], a[28:31], a[244:247], v[72:75]
ds_read_b128 a[232:235], v6 offset:49152
v_mfma_f32_16x16x32_bf16 v[76:79], a[96:99], a[240:243], v[76:79]
v_mfma_f32_16x16x32_bf16 v[76:79], a[100:103], a[244:247], v[76:79]
ds_read_b128 a[236:239], v6 offset:57344
s_waitcnt lgkmcnt(4)
v_mfma_f32_16x16x32_bf16 v[80:83], a[24:27], a[216:219], v[80:83]
v_mfma_f32_16x16x32_bf16 v[80:83], a[28:31], a[220:223], v[80:83]
ds_read_b128 a[240:243], v9 offset:49152
v_mfma_f32_16x16x32_bf16 v[84:87], a[96:99], a[216:219], v[84:87]
v_mfma_f32_16x16x32_bf16 v[84:87], a[100:103], a[220:223], v[84:87]
ds_read_b128 a[244:247], v9 offset:57344
s_waitcnt lgkmcnt(4)
v_mfma_f32_16x16x32_bf16 v[88:91], a[24:27], a[224:227], v[88:91]
v_mfma_f32_16x16x32_bf16 v[88:91], a[28:31], a[228:231], v[88:91]
ds_read_b128 a[216:219], v4 offset:0
v_mfma_f32_16x16x32_bf16 v[92:95], a[96:99], a[224:227], v[92:95]
v_mfma_f32_16x16x32_bf16 v[92:95], a[100:103], a[228:231], v[92:95]
ds_read_b128 a[220:223], v4 offset:8192
s_waitcnt lgkmcnt(4)
v_mfma_f32_16x16x32_bf16 v[96:99], a[232:235], a[168:171], v[96:99]
ds_read_b128 a[224:227], v4 offset:1024
v_mfma_f32_16x16x32_bf16 v[96:99], a[236:239], a[172:175], v[96:99]
ds_read_b128 a[228:231], v4 offset:9216
s_waitcnt lgkmcnt(4)
v_mfma_f32_16x16x32_bf16 v[100:103], a[168:171], a[240:243], v[100:103]
ds_read_b128 a[232:235], v4 offset:2048
v_mfma_f32_16x16x32_bf16 v[100:103], a[172:175], a[244:247], v[100:103]
ds_read_b128 a[236:239], v4 offset:10240
s_waitcnt vmcnt(24)
s_waitcnt lgkmcnt(4)
v_mfma_f32_16x16x32_bf16 v[32:35], a[216:219], a[32:35], v[32:35]
v_mfma_f32_16x16x32_bf16 v[32:35], a[220:223], a[36:39], v[32:35]
ds_read_b128 a[240:243], v4 offset:3072
v_mfma_f32_16x16x32_bf16 v[36:39], a[216:219], a[104:107], v[36:39]
v_mfma_f32_16x16x32_bf16 v[36:39], a[220:223], a[108:111], v[36:39]
ds_read_b128 a[244:247], v4 offset:11264
s_waitcnt lgkmcnt(4)
v_mfma_f32_16x16x32_bf16 v[40:43], a[224:227], a[32:35], v[40:43]
v_mfma_f32_16x16x32_bf16 v[40:43], a[228:231], a[36:39], v[40:43]
ds_read_b128 a[216:219], v4 offset:4096
v_mfma_f32_16x16x32_bf16 v[44:47], a[224:227], a[104:107], v[44:47]
v_mfma_f32_16x16x32_bf16 v[44:47], a[228:231], a[108:111], v[44:47]
ds_read_b128 a[220:223], v4 offset:12288
s_waitcnt lgkmcnt(4)
v_mfma_f32_16x16x32_bf16 v[48:51], a[232:235], a[32:35], v[48:51]
v_mfma_f32_16x16x32_bf16 v[48:51], a[236:239], a[36:39], v[48:51]
ds_read_b128 a[224:227], v4 offset:5120
v_mfma_f32_16x16x32_bf16 v[52:55], a[232:235], a[104:107], v[52:55]
v_mfma_f32_16x16x32_bf16 v[52:55], a[236:239], a[108:111], v[52:55]
ds_read_b128 a[228:231], v4 offset:13312
s_waitcnt lgkmcnt(4)
v_mfma_f32_16x16x32_bf16 v[56:59], a[240:243], a[32:35], v[56:59]
v_mfma_f32_16x16x32_bf16 v[56:59], a[244:247], a[36:39], v[56:59]
ds_read_b128 a[232:235], v4 offset:6144
v_mfma_f32_16x16x32_bf16 v[60:63], a[240:243], a[104:107], v[60:63]
v_mfma_f32_16x16x32_bf16 v[60:63], a[244:247], a[108:111], v[60:63]
ds_read_b128 a[236:239], v4 offset:14336
s_waitcnt lgkmcnt(4)
v_mfma_f32_16x16x32_bf16 v[64:67], a[216:219], a[32:35], v[64:67]
v_mfma_f32_16x16x32_bf16 v[64:67], a[220:223], a[36:39], v[64:67]
ds_read_b128 a[240:243], v4 offset:7168
v_mfma_f32_16x16x32_bf16 v[68:71], a[216:219], a[104:107], v[68:71]
v_mfma_f32_16x16x32_bf16 v[68:71], a[220:223], a[108:111], v[68:71]
ds_read_b128 a[244:247], v4 offset:15360
s_waitcnt lgkmcnt(4)
v_mfma_f32_16x16x32_bf16 v[72:75], a[32:35], a[224:227], v[72:75]
v_mfma_f32_16x16x32_bf16 v[72:75], a[36:39], a[228:231], v[72:75]
ds_read_b128 a[216:219], v7 offset:0
v_mfma_f32_16x16x32_bf16 v[76:79], a[104:107], a[224:227], v[76:79]
v_mfma_f32_16x16x32_bf16 v[76:79], a[108:111], a[228:231], v[76:79]
ds_read_b128 a[220:223], v7 offset:8192
s_waitcnt lgkmcnt(4)
v_mfma_f32_16x16x32_bf16 v[80:83], a[32:35], a[232:235], v[80:83]
v_mfma_f32_16x16x32_bf16 v[80:83], a[36:39], a[236:239], v[80:83]
ds_read_b128 a[224:227], v10 offset:0
v_mfma_f32_16x16x32_bf16 v[84:87], a[104:107], a[232:235], v[84:87]
v_mfma_f32_16x16x32_bf16 v[84:87], a[108:111], a[236:239], v[84:87]
ds_read_b128 a[228:231], v10 offset:8192
s_waitcnt lgkmcnt(4)
v_mfma_f32_16x16x32_bf16 v[88:91], a[32:35], a[240:243], v[88:91]
v_mfma_f32_16x16x32_bf16 v[88:91], a[36:39], a[244:247], v[88:91]
ds_read_b128 a[232:235], v4 offset:16384
v_mfma_f32_16x16x32_bf16 v[92:95], a[104:107], a[240:243], v[92:95]
v_mfma_f32_16x16x32_bf16 v[92:95], a[108:111], a[244:247], v[92:95]
ds_read_b128 a[236:239], v4 offset:24576
s_waitcnt lgkmcnt(4)
v_mfma_f32_16x16x32_bf16 v[96:99], a[216:219], a[176:179], v[96:99]
ds_read_b128 a[240:243], v4 offset:17408
v_mfma_f32_16x16x32_bf16 v[96:99], a[220:223], a[180:183], v[96:99]
ds_read_b128 a[244:247], v4 offset:25600
s_waitcnt lgkmcnt(4)
v_mfma_f32_16x16x32_bf16 v[100:103], a[176:179], a[224:227], v[100:103]
ds_read_b128 a[216:219], v4 offset:18432
v_mfma_f32_16x16x32_bf16 v[100:103], a[180:183], a[228:231], v[100:103]
ds_read_b128 a[220:223], v4 offset:26624
s_waitcnt vmcnt(18)
s_waitcnt lgkmcnt(4)
v_mfma_f32_16x16x32_bf16 v[32:35], a[232:235], a[40:43], v[32:35]
v_mfma_f32_16x16x32_bf16 v[32:35], a[236:239], a[44:47], v[32:35]
ds_read_b128 a[224:227], v4 offset:19456
v_mfma_f32_16x16x32_bf16 v[36:39], a[232:235], a[112:115], v[36:39]
v_mfma_f32_16x16x32_bf16 v[36:39], a[236:239], a[116:119], v[36:39]
ds_read_b128 a[228:231], v4 offset:27648
s_waitcnt lgkmcnt(4)
v_mfma_f32_16x16x32_bf16 v[40:43], a[240:243], a[40:43], v[40:43]
v_mfma_f32_16x16x32_bf16 v[40:43], a[244:247], a[44:47], v[40:43]
ds_read_b128 a[232:235], v4 offset:20480
v_mfma_f32_16x16x32_bf16 v[44:47], a[240:243], a[112:115], v[44:47]
v_mfma_f32_16x16x32_bf16 v[44:47], a[244:247], a[116:119], v[44:47]
ds_read_b128 a[236:239], v4 offset:28672
s_waitcnt lgkmcnt(4)
v_mfma_f32_16x16x32_bf16 v[48:51], a[216:219], a[40:43], v[48:51]
v_mfma_f32_16x16x32_bf16 v[48:51], a[220:223], a[44:47], v[48:51]
ds_read_b128 a[240:243], v4 offset:21504
v_mfma_f32_16x16x32_bf16 v[52:55], a[216:219], a[112:115], v[52:55]
v_mfma_f32_16x16x32_bf16 v[52:55], a[220:223], a[116:119], v[52:55]
ds_read_b128 a[244:247], v4 offset:29696
s_waitcnt lgkmcnt(4)
v_mfma_f32_16x16x32_bf16 v[56:59], a[224:227], a[40:43], v[56:59]
v_mfma_f32_16x16x32_bf16 v[56:59], a[228:231], a[44:47], v[56:59]
ds_read_b128 a[216:219], v4 offset:22528
v_mfma_f32_16x16x32_bf16 v[60:63], a[224:227], a[112:115], v[60:63]
v_mfma_f32_16x16x32_bf16 v[60:63], a[228:231], a[116:119], v[60:63]
ds_read_b128 a[220:223], v4 offset:30720
s_waitcnt lgkmcnt(4)
v_mfma_f32_16x16x32_bf16 v[64:67], a[232:235], a[40:43], v[64:67]
v_mfma_f32_16x16x32_bf16 v[64:67], a[236:239], a[44:47], v[64:67]
ds_read_b128 a[224:227], v4 offset:23552
v_mfma_f32_16x16x32_bf16 v[68:71], a[232:235], a[112:115], v[68:71]
v_mfma_f32_16x16x32_bf16 v[68:71], a[236:239], a[116:119], v[68:71]
ds_read_b128 a[228:231], v4 offset:31744
s_waitcnt lgkmcnt(4)
v_mfma_f32_16x16x32_bf16 v[72:75], a[40:43], a[240:243], v[72:75]
v_mfma_f32_16x16x32_bf16 v[72:75], a[44:47], a[244:247], v[72:75]
ds_read_b128 a[232:235], v7 offset:16384
v_mfma_f32_16x16x32_bf16 v[76:79], a[112:115], a[240:243], v[76:79]
v_mfma_f32_16x16x32_bf16 v[76:79], a[116:119], a[244:247], v[76:79]
ds_read_b128 a[236:239], v7 offset:24576
s_waitcnt lgkmcnt(4)
v_mfma_f32_16x16x32_bf16 v[80:83], a[40:43], a[216:219], v[80:83]
v_mfma_f32_16x16x32_bf16 v[80:83], a[44:47], a[220:223], v[80:83]
ds_read_b128 a[240:243], v10 offset:16384
v_mfma_f32_16x16x32_bf16 v[84:87], a[112:115], a[216:219], v[84:87]
v_mfma_f32_16x16x32_bf16 v[84:87], a[116:119], a[220:223], v[84:87]
ds_read_b128 a[244:247], v10 offset:24576
s_waitcnt lgkmcnt(4)
v_mfma_f32_16x16x32_bf16 v[88:91], a[40:43], a[224:227], v[88:91]
v_mfma_f32_16x16x32_bf16 v[88:91], a[44:47], a[228:231], v[88:91]
ds_read_b128 a[216:219], v4 offset:32768
v_mfma_f32_16x16x32_bf16 v[92:95], a[112:115], a[224:227], v[92:95]
v_mfma_f32_16x16x32_bf16 v[92:95], a[116:119], a[228:231], v[92:95]
ds_read_b128 a[220:223], v4 offset:40960
s_waitcnt lgkmcnt(4)
v_mfma_f32_16x16x32_bf16 v[96:99], a[232:235], a[184:187], v[96:99]
ds_read_b128 a[224:227], v4 offset:33792
v_mfma_f32_16x16x32_bf16 v[96:99], a[236:239], a[188:191], v[96:99]
ds_read_b128 a[228:231], v4 offset:41984
s_waitcnt lgkmcnt(4)
v_mfma_f32_16x16x32_bf16 v[100:103], a[184:187], a[240:243], v[100:103]
ds_read_b128 a[232:235], v4 offset:34816
v_mfma_f32_16x16x32_bf16 v[100:103], a[188:191], a[244:247], v[100:103]
ds_read_b128 a[236:239], v4 offset:43008
s_waitcnt vmcnt(12)
s_waitcnt lgkmcnt(4)
v_mfma_f32_16x16x32_bf16 v[32:35], a[216:219], a[48:51], v[32:35]
v_mfma_f32_16x16x32_bf16 v[32:35], a[220:223], a[52:55], v[32:35]
ds_read_b128 a[240:243], v4 offset:35840
v_mfma_f32_16x16x32_bf16 v[36:39], a[216:219], a[120:123], v[36:39]
v_mfma_f32_16x16x32_bf16 v[36:39], a[220:223], a[124:127], v[36:39]
ds_read_b128 a[244:247], v4 offset:44032
s_waitcnt lgkmcnt(4)
v_mfma_f32_16x16x32_bf16 v[40:43], a[224:227], a[48:51], v[40:43]
v_mfma_f32_16x16x32_bf16 v[40:43], a[228:231], a[52:55], v[40:43]
ds_read_b128 a[216:219], v4 offset:36864
v_mfma_f32_16x16x32_bf16 v[44:47], a[224:227], a[120:123], v[44:47]
v_mfma_f32_16x16x32_bf16 v[44:47], a[228:231], a[124:127], v[44:47]
ds_read_b128 a[220:223], v4 offset:45056
s_waitcnt lgkmcnt(4)
v_mfma_f32_16x16x32_bf16 v[48:51], a[232:235], a[48:51], v[48:51]
v_mfma_f32_16x16x32_bf16 v[48:51], a[236:239], a[52:55], v[48:51]
ds_read_b128 a[224:227], v4 offset:37888
v_mfma_f32_16x16x32_bf16 v[52:55], a[232:235], a[120:123], v[52:55]
v_mfma_f32_16x16x32_bf16 v[52:55], a[236:239], a[124:127], v[52:55]
ds_read_b128 a[228:231], v4 offset:46080
s_waitcnt lgkmcnt(4)
v_mfma_f32_16x16x32_bf16 v[56:59], a[240:243], a[48:51], v[56:59]
v_mfma_f32_16x16x32_bf16 v[56:59], a[244:247], a[52:55], v[56:59]
ds_read_b128 a[232:235], v4 offset:38912
v_mfma_f32_16x16x32_bf16 v[60:63], a[240:243], a[120:123], v[60:63]
v_mfma_f32_16x16x32_bf16 v[60:63], a[244:247], a[124:127], v[60:63]
ds_read_b128 a[236:239], v4 offset:47104
s_waitcnt lgkmcnt(4)
v_mfma_f32_16x16x32_bf16 v[64:67], a[216:219], a[48:51], v[64:67]
v_mfma_f32_16x16x32_bf16 v[64:67], a[220:223], a[52:55], v[64:67]
ds_read_b128 a[240:243], v4 offset:39936
v_mfma_f32_16x16x32_bf16 v[68:71], a[216:219], a[120:123], v[68:71]
v_mfma_f32_16x16x32_bf16 v[68:71], a[220:223], a[124:127], v[68:71]
ds_read_b128 a[244:247], v4 offset:48128
s_waitcnt lgkmcnt(4)
v_mfma_f32_16x16x32_bf16 v[72:75], a[48:51], a[224:227], v[72:75]
v_mfma_f32_16x16x32_bf16 v[72:75], a[52:55], a[228:231], v[72:75]
ds_read_b128 a[216:219], v7 offset:32768
v_mfma_f32_16x16x32_bf16 v[76:79], a[120:123], a[224:227], v[76:79]
v_mfma_f32_16x16x32_bf16 v[76:79], a[124:127], a[228:231], v[76:79]
ds_read_b128 a[220:223], v7 offset:40960
s_waitcnt lgkmcnt(4)
v_mfma_f32_16x16x32_bf16 v[80:83], a[48:51], a[232:235], v[80:83]
v_mfma_f32_16x16x32_bf16 v[80:83], a[52:55], a[236:239], v[80:83]
ds_read_b128 a[224:227], v10 offset:32768
v_mfma_f32_16x16x32_bf16 v[84:87], a[120:123], a[232:235], v[84:87]
v_mfma_f32_16x16x32_bf16 v[84:87], a[124:127], a[236:239], v[84:87]
ds_read_b128 a[228:231], v10 offset:40960
s_waitcnt lgkmcnt(4)
v_mfma_f32_16x16x32_bf16 v[88:91], a[48:51], a[240:243], v[88:91]
v_mfma_f32_16x16x32_bf16 v[88:91], a[52:55], a[244:247], v[88:91]
ds_read_b128 a[232:235], v4 offset:49152
v_mfma_f32_16x16x32_bf16 v[92:95], a[120:123], a[240:243], v[92:95]
v_mfma_f32_16x16x32_bf16 v[92:95], a[124:127], a[244:247], v[92:95]
ds_read_b128 a[236:239], v4 offset:57344
s_waitcnt lgkmcnt(4)
v_mfma_f32_16x16x32_bf16 v[96:99], a[216:219], a[192:195], v[96:99]
ds_read_b128 a[240:243], v4 offset:50176
v_mfma_f32_16x16x32_bf16 v[96:99], a[220:223], a[196:199], v[96:99]
ds_read_b128 a[244:247], v4 offset:58368
s_waitcnt lgkmcnt(4)
v_mfma_f32_16x16x32_bf16 v[100:103], a[192:195], a[224:227], v[100:103]
ds_read_b128 a[216:219], v4 offset:51200
v_mfma_f32_16x16x32_bf16 v[100:103], a[196:199], a[228:231], v[100:103]
ds_read_b128 a[220:223], v4 offset:59392
s_waitcnt vmcnt(6)
s_waitcnt lgkmcnt(4)
v_mfma_f32_16x16x32_bf16 v[32:35], a[232:235], a[56:59], v[32:35]
v_mfma_f32_16x16x32_bf16 v[32:35], a[236:239], a[60:63], v[32:35]
ds_read_b128 a[224:227], v4 offset:52224
v_mfma_f32_16x16x32_bf16 v[36:39], a[232:235], a[128:131], v[36:39]
v_mfma_f32_16x16x32_bf16 v[36:39], a[236:239], a[132:135], v[36:39]
ds_read_b128 a[228:231], v4 offset:60416
s_waitcnt lgkmcnt(4)
v_mfma_f32_16x16x32_bf16 v[40:43], a[240:243], a[56:59], v[40:43]
v_mfma_f32_16x16x32_bf16 v[40:43], a[244:247], a[60:63], v[40:43]
ds_read_b128 a[232:235], v4 offset:53248
v_mfma_f32_16x16x32_bf16 v[44:47], a[240:243], a[128:131], v[44:47]
v_mfma_f32_16x16x32_bf16 v[44:47], a[244:247], a[132:135], v[44:47]
ds_read_b128 a[236:239], v4 offset:61440
s_waitcnt lgkmcnt(4)
v_mfma_f32_16x16x32_bf16 v[48:51], a[216:219], a[56:59], v[48:51]
v_mfma_f32_16x16x32_bf16 v[48:51], a[220:223], a[60:63], v[48:51]
ds_read_b128 a[240:243], v4 offset:54272
v_mfma_f32_16x16x32_bf16 v[52:55], a[216:219], a[128:131], v[52:55]
v_mfma_f32_16x16x32_bf16 v[52:55], a[220:223], a[132:135], v[52:55]
ds_read_b128 a[244:247], v4 offset:62464
s_waitcnt lgkmcnt(4)
v_mfma_f32_16x16x32_bf16 v[56:59], a[224:227], a[56:59], v[56:59]
v_mfma_f32_16x16x32_bf16 v[56:59], a[228:231], a[60:63], v[56:59]
ds_read_b128 a[216:219], v4 offset:55296
v_mfma_f32_16x16x32_bf16 v[60:63], a[224:227], a[128:131], v[60:63]
v_mfma_f32_16x16x32_bf16 v[60:63], a[228:231], a[132:135], v[60:63]
ds_read_b128 a[220:223], v4 offset:63488
s_waitcnt lgkmcnt(4)
v_mfma_f32_16x16x32_bf16 v[64:67], a[232:235], a[56:59], v[64:67]
v_mfma_f32_16x16x32_bf16 v[64:67], a[236:239], a[60:63], v[64:67]
ds_read_b128 a[224:227], v4 offset:56320
v_mfma_f32_16x16x32_bf16 v[68:71], a[232:235], a[128:131], v[68:71]
v_mfma_f32_16x16x32_bf16 v[68:71], a[236:239], a[132:135], v[68:71]
ds_read_b128 a[228:231], v4 offset:64512
s_waitcnt lgkmcnt(4)
v_mfma_f32_16x16x32_bf16 v[72:75], a[56:59], a[240:243], v[72:75]
v_mfma_f32_16x16x32_bf16 v[72:75], a[60:63], a[244:247], v[72:75]
ds_read_b128 a[232:235], v7 offset:49152
v_mfma_f32_16x16x32_bf16 v[76:79], a[128:131], a[240:243], v[76:79]
v_mfma_f32_16x16x32_bf16 v[76:79], a[132:135], a[244:247], v[76:79]
ds_read_b128 a[236:239], v7 offset:57344
s_waitcnt lgkmcnt(4)
v_mfma_f32_16x16x32_bf16 v[80:83], a[56:59], a[216:219], v[80:83]
v_mfma_f32_16x16x32_bf16 v[80:83], a[60:63], a[220:223], v[80:83]
ds_read_b128 a[240:243], v10 offset:49152
v_mfma_f32_16x16x32_bf16 v[84:87], a[128:131], a[216:219], v[84:87]
v_mfma_f32_16x16x32_bf16 v[84:87], a[132:135], a[220:223], v[84:87]
ds_read_b128 a[244:247], v10 offset:57344
s_waitcnt lgkmcnt(4)
v_mfma_f32_16x16x32_bf16 v[88:91], a[56:59], a[224:227], v[88:91]
v_mfma_f32_16x16x32_bf16 v[88:91], a[60:63], a[228:231], v[88:91]
ds_read_b128 a[216:219], v5 offset:0
v_mfma_f32_16x16x32_bf16 v[92:95], a[128:131], a[224:227], v[92:95]
v_mfma_f32_16x16x32_bf16 v[92:95], a[132:135], a[228:231], v[92:95]
ds_read_b128 a[220:223], v5 offset:8192
s_waitcnt lgkmcnt(4)
v_mfma_f32_16x16x32_bf16 v[96:99], a[232:235], a[200:203], v[96:99]
ds_read_b128 a[224:227], v5 offset:1024
v_mfma_f32_16x16x32_bf16 v[96:99], a[236:239], a[204:207], v[96:99]
ds_read_b128 a[228:231], v5 offset:9216
s_waitcnt lgkmcnt(4)
v_mfma_f32_16x16x32_bf16 v[100:103], a[200:203], a[240:243], v[100:103]
ds_read_b128 a[232:235], v5 offset:2048
v_mfma_f32_16x16x32_bf16 v[100:103], a[204:207], a[244:247], v[100:103]
ds_read_b128 a[236:239], v5 offset:10240
s_waitcnt vmcnt(0)
s_waitcnt lgkmcnt(4)
v_mfma_f32_16x16x32_bf16 v[32:35], a[216:219], a[64:67], v[32:35]
v_mfma_f32_16x16x32_bf16 v[32:35], a[220:223], a[68:71], v[32:35]
ds_read_b128 a[240:243], v5 offset:3072
v_mfma_f32_16x16x32_bf16 v[36:39], a[216:219], a[136:139], v[36:39]
v_mfma_f32_16x16x32_bf16 v[36:39], a[220:223], a[140:143], v[36:39]
ds_read_b128 a[244:247], v5 offset:11264
s_waitcnt lgkmcnt(4)
v_mfma_f32_16x16x32_bf16 v[40:43], a[224:227], a[64:67], v[40:43]
v_mfma_f32_16x16x32_bf16 v[40:43], a[228:231], a[68:71], v[40:43]
ds_read_b128 a[216:219], v5 offset:4096
v_mfma_f32_16x16x32_bf16 v[44:47], a[224:227], a[136:139], v[44:47]
v_mfma_f32_16x16x32_bf16 v[44:47], a[228:231], a[140:143], v[44:47]
ds_read_b128 a[220:223], v5 offset:12288
s_waitcnt lgkmcnt(4)
v_mfma_f32_16x16x32_bf16 v[48:51], a[232:235], a[64:67], v[48:51]
v_mfma_f32_16x16x32_bf16 v[48:51], a[236:239], a[68:71], v[48:51]
ds_read_b128 a[224:227], v5 offset:5120
v_mfma_f32_16x16x32_bf16 v[52:55], a[232:235], a[136:139], v[52:55]
v_mfma_f32_16x16x32_bf16 v[52:55], a[236:239], a[140:143], v[52:55]
ds_read_b128 a[228:231], v5 offset:13312
s_waitcnt lgkmcnt(4)
v_mfma_f32_16x16x32_bf16 v[56:59], a[240:243], a[64:67], v[56:59]
v_mfma_f32_16x16x32_bf16 v[56:59], a[244:247], a[68:71], v[56:59]
ds_read_b128 a[232:235], v5 offset:6144
v_mfma_f32_16x16x32_bf16 v[60:63], a[240:243], a[136:139], v[60:63]
v_mfma_f32_16x16x32_bf16 v[60:63], a[244:247], a[140:143], v[60:63]
ds_read_b128 a[236:239], v5 offset:14336
s_waitcnt lgkmcnt(4)
v_mfma_f32_16x16x32_bf16 v[64:67], a[216:219], a[64:67], v[64:67]
v_mfma_f32_16x16x32_bf16 v[64:67], a[220:223], a[68:71], v[64:67]
ds_read_b128 a[240:243], v5 offset:7168
v_mfma_f32_16x16x32_bf16 v[68:71], a[216:219], a[136:139], v[68:71]
v_mfma_f32_16x16x32_bf16 v[68:71], a[220:223], a[140:143], v[68:71]
ds_read_b128 a[244:247], v5 offset:15360
s_waitcnt lgkmcnt(4)
v_mfma_f32_16x16x32_bf16 v[72:75], a[64:67], a[224:227], v[72:75]
v_mfma_f32_16x16x32_bf16 v[72:75], a[68:71], a[228:231], v[72:75]
ds_read_b128 a[216:219], v8 offset:0
v_mfma_f32_16x16x32_bf16 v[76:79], a[136:139], a[224:227], v[76:79]
v_mfma_f32_16x16x32_bf16 v[76:79], a[140:143], a[228:231], v[76:79]
ds_read_b128 a[220:223], v8 offset:8192
s_waitcnt lgkmcnt(4)
v_mfma_f32_16x16x32_bf16 v[80:83], a[64:67], a[232:235], v[80:83]
v_mfma_f32_16x16x32_bf16 v[80:83], a[68:71], a[236:239], v[80:83]
ds_read_b128 a[224:227], v11 offset:0
v_mfma_f32_16x16x32_bf16 v[84:87], a[136:139], a[232:235], v[84:87]
v_mfma_f32_16x16x32_bf16 v[84:87], a[140:143], a[236:239], v[84:87]
ds_read_b128 a[228:231], v11 offset:8192
s_waitcnt lgkmcnt(4)
v_mfma_f32_16x16x32_bf16 v[88:91], a[64:67], a[240:243], v[88:91]
v_mfma_f32_16x16x32_bf16 v[88:91], a[68:71], a[244:247], v[88:91]
v_mfma_f32_16x16x32_bf16 v[92:95], a[136:139], a[240:243], v[92:95]
v_mfma_f32_16x16x32_bf16 v[92:95], a[140:143], a[244:247], v[92:95]
s_waitcnt lgkmcnt(2)
v_mfma_f32_16x16x32_bf16 v[96:99], a[216:219], a[208:211], v[96:99]
v_mfma_f32_16x16x32_bf16 v[96:99], a[220:223], a[212:215], v[96:99]
s_waitcnt lgkmcnt(0)
v_mfma_f32_16x16x32_bf16 v[100:103], a[208:211], a[224:227], v[100:103]
v_mfma_f32_16x16x32_bf16 v[100:103], a[212:215], a[228:231], v[100:103]
v_cvt_pk_bf16_f32 v116, v52, v53
v_cvt_pk_bf16_f32 v117, v54, v55
v_cvt_pk_bf16_f32 v120, v60, v61
v_cvt_pk_bf16_f32 v121, v62, v63
v_cvt_pk_bf16_f32 v160, v68, v69
v_cvt_pk_bf16_f32 v161, v70, v71
v_cvt_pk_bf16_f32 v126, v76, v77
v_cvt_pk_bf16_f32 v127, v78, v79
v_cvt_pk_bf16_f32 v132, v84, v85
v_cvt_pk_bf16_f32 v133, v86, v87
v_cvt_pk_bf16_f32 v138, v92, v93
v_cvt_pk_bf16_f32 v139, v94, v95
v_cvt_pk_bf16_f32 v156, v96, v97
v_cvt_pk_bf16_f32 v157, v98, v99
v_cvt_pk_bf16_f32 v158, v100, v101
v_cvt_pk_bf16_f32 v159, v102, v103
v_lshlrev_b32 v14, 3, v1
s_mul_i32 s31, s4, 3072
s_add_u32 s32, s31, 147456
v_add_u32 v15, s32, v14
s_lshl_b32 s33, s29, 9
s_add_u32 s33, s33, 147456
v_add_u32 v16, s33, v14
ds_write_b64 v16, v[156:157]
ds_write_b64 v16, v[158:159] offset:1536
s_cmp_eq_u32 s4, 3
s_cbranch_scc1 L_a1_noxch
ds_write_b64 v15, v[116:117] offset:3072
ds_write_b64 v15, v[120:121] offset:3584
ds_write_b64 v15, v[160:161] offset:4096
ds_write_b64 v15, v[126:127] offset:4608
ds_write_b64 v15, v[132:133] offset:5120
ds_write_b64 v15, v[138:139] offset:5632
L_a1_noxch:
v_cvt_pk_bf16_f32 v110, v48, v49
v_cvt_pk_bf16_f32 v111, v50, v51
v_cvt_pk_bf16_f32 v114, v56, v57
v_cvt_pk_bf16_f32 v115, v58, v59
v_cvt_pk_bf16_f32 v124, v72, v73
v_cvt_pk_bf16_f32 v125, v74, v75
v_cvt_pk_bf16_f32 v130, v80, v81
v_cvt_pk_bf16_f32 v131, v82, v83
v_cvt_pk_bf16_f32 v136, v88, v89
v_cvt_pk_bf16_f32 v137, v90, v91
v_cvt_pk_bf16_f32 v140, v32, v33
v_cvt_pk_bf16_f32 v141, v34, v35
v_cvt_pk_bf16_f32 v146, v40, v41
v_cvt_pk_bf16_f32 v147, v42, v43
v_cvt_pk_bf16_f32 v142, v64, v65
v_cvt_pk_bf16_f32 v145, v66, v67
v_mov_b32 v143, 0
v_mov_b32 v144, 0
v_mov_b32 v112, 0
v_mov_b32 v113, 0
s_nop 0
v_permlane16_swap_b32 v142, v112
v_permlane16_swap_b32 v145, v113
v_cvt_pk_bf16_f32 v148, v36, v37
v_cvt_pk_bf16_f32 v149, v38, v39
v_cvt_pk_bf16_f32 v154, v44, v45
v_cvt_pk_bf16_f32 v155, v46, v47
v_cvt_pk_bf16_f32 v150, v68, v69
v_cvt_pk_bf16_f32 v153, v70, v71
v_mov_b32 v151, 0
v_mov_b32 v152, 0
v_mov_b32 v118, 0
v_mov_b32 v119, 0
s_nop 0
v_permlane16_swap_b32 v150, v118
v_permlane16_swap_b32 v153, v119
v_add_u32 v17, 16, v12
v_add_u32 v18, 32, v12
v_cmp_gt_u32 vcc, 16, v1
s_nop 1
v_cndmask_b32 v17, v18, v17, vcc
v_lshlrev_b32 v17, 3, v17
v_add_u32 v17, s32, v17
s_waitcnt lgkmcnt(0)
s_barrier
ds_read_b64 v[104:105], v15
ds_read_b64 v[108:109], v15 offset:512
ds_read_b64 v[106:107], v17 offset:1024
ds_read_b64 v[122:123], v15 offset:1536
ds_read_b64 v[128:129], v15 offset:2048
ds_read_b64 v[134:135], v15 offset:2560
v_mfma_f32_16x16x32_bf16 v[32:35], v[110:113], v[148:151], 0
v_mfma_f32_16x16x32_bf16 v[36:39], v[116:119], v[148:151], 0
v_mfma_f32_16x16x32_bf16 v[40:43], v[112:115], v[152:155], 0
v_mfma_f32_16x16x32_bf16 v[44:47], v[118:121], v[152:155], 0
s_waitcnt lgkmcnt(0)
v_mfma_f32_16x16x32_bf16 v[48:51], v[104:107], v[140:143], 0
v_mfma_f32_16x16x32_bf16 v[52:55], v[110:113], v[140:143], 0
v_mfma_f32_16x16x32_bf16 v[56:59], v[106:109], v[144:147], 0
v_mfma_f32_16x16x32_bf16 v[60:63], v[112:115], v[144:147], 0
v_mov_b32 v18, 0xff61b1e6
s_mov_b32 s34, 0x3eae1a93
v_cndmask_b32 v32, v18, v32, s[44:45]
v_cndmask_b32 v40, v18, v40, s[44:45]
s_nop 0
v_cndmask_b32 v48, v18, v48, s[60:61]
s_nop 0
v_cndmask_b32 v56, v18, v56, s[60:61]
v_cndmask_b32 v33, v18, v33, s[46:47]
v_cndmask_b32 v41, v18, v41, s[46:47]
v_cndmask_b32 v49, v18, v49, s[62:63]
v_cndmask_b32 v57, v18, v57, s[62:63]
v_cndmask_b32 v34, v18, v34, s[48:49]
v_cndmask_b32 v42, v18, v42, s[48:49]
v_cndmask_b32 v50, v18, v50, s[64:65]
v_cndmask_b32 v58, v18, v58, s[64:65]
v_cndmask_b32 v35, v18, v35, s[50:51]
v_cndmask_b32 v43, v18, v43, s[50:51]
v_cndmask_b32 v51, v18, v51, s[66:67]
v_cndmask_b32 v59, v18, v59, s[66:67]
v_cndmask_b32 v36, v18, v36, s[52:53]
v_cndmask_b32 v44, v18, v44, s[52:53]
v_cndmask_b32 v52, v18, v52, s[52:53]
v_cndmask_b32 v60, v18, v60, s[52:53]
v_cndmask_b32 v37, v18, v37, s[54:55]
v_cndmask_b32 v45, v18, v45, s[54:55]
v_cndmask_b32 v53, v18, v53, s[54:55]
v_cndmask_b32 v61, v18, v61, s[54:55]
v_cndmask_b32 v38, v18, v38, s[56:57]
v_cndmask_b32 v46, v18, v46, s[56:57]
v_cndmask_b32 v54, v18, v54, s[56:57]
v_cndmask_b32 v62, v18, v62, s[56:57]
v_cndmask_b32 v39, v18, v39, s[58:59]
v_cndmask_b32 v47, v18, v47, s[58:59]
v_cndmask_b32 v55, v18, v55, s[58:59]
v_cndmask_b32 v63, v18, v63, s[58:59]
v_max3_f32 v20, v32, v33, v34
v_max3_f32 v21, v40, v41, v42
v_max3_f32 v22, v48, v49, v50
v_max3_f32 v23, v56, v57, v58
v_max3_f32 v20, v20, v35, v36
v_max3_f32 v21, v21, v43, v44
v_max3_f32 v22, v22, v51, v52
v_max3_f32 v23, v23, v59, v60
v_max3_f32 v20, v20, v37, v38
v_max3_f32 v21, v21, v45, v46
v_max3_f32 v22, v22, v53, v54
v_max3_f32 v23, v23, v61, v62
v_max_f32 v20, v20, v39
v_max_f32 v21, v21, v47
v_max_f32 v22, v22, v55
v_max_f32 v23, v23, v63
v_mov_b32 v24, v20
v_mov_b32 v25, v21
v_mov_b32 v26, v22
v_mov_b32 v27, v23
v_permlane16_swap_b32 v20, v24
v_permlane16_swap_b32 v21, v25
v_permlane16_swap_b32 v22, v26
v_permlane16_swap_b32 v23, v27
v_max_f32 v20, v20, v24
v_max_f32 v21, v21, v25
v_max_f32 v22, v22, v26
v_max_f32 v23, v23, v27
v_mov_b32 v24, v20
v_mov_b32 v25, v21
v_mov_b32 v26, v22
v_mov_b32 v27, v23
v_permlane32_swap_b32 v20, v24
v_permlane32_swap_b32 v21, v25
v_permlane32_swap_b32 v22, v26
v_permlane32_swap_b32 v23, v27
v_max_f32 v20, v20, v24
v_max_f32 v21, v21, v25
v_max_f32 v22, v22, v26
v_max_f32 v23, v23, v27
v_mul_f32 v20, s34, v20
v_mul_f32 v21, s34, v21
v_mul_f32 v22, s34, v22
v_mul_f32 v23, s34, v23
v_fma_f32 v32, v32, s34, -v20
v_fma_f32 v40, v40, s34, -v21
v_fma_f32 v48, v48, s34, -v22
v_fma_f32 v56, v56, s34, -v23
v_exp_f32 v32, v32
v_exp_f32 v40, v40
v_exp_f32 v48, v48
v_exp_f32 v56, v56
v_fma_f32 v33, v33, s34, -v20
v_fma_f32 v41, v41, s34, -v21
v_fma_f32 v49, v49, s34, -v22
v_fma_f32 v57, v57, s34, -v23
v_exp_f32 v33, v33
v_exp_f32 v41, v41
v_exp_f32 v49, v49
v_exp_f32 v57, v57
v_fma_f32 v34, v34, s34, -v20
v_fma_f32 v42, v42, s34, -v21
v_fma_f32 v50, v50, s34, -v22
v_fma_f32 v58, v58, s34, -v23
v_exp_f32 v34, v34
v_exp_f32 v42, v42
v_exp_f32 v50, v50
v_exp_f32 v58, v58
v_fma_f32 v35, v35, s34, -v20
v_fma_f32 v43, v43, s34, -v21
v_fma_f32 v51, v51, s34, -v22
v_fma_f32 v59, v59, s34, -v23
v_exp_f32 v35, v35
v_exp_f32 v43, v43
v_exp_f32 v51, v51
v_exp_f32 v59, v59
v_fma_f32 v36, v36, s34, -v20
v_fma_f32 v44, v44, s34, -v21
v_fma_f32 v52, v52, s34, -v22
v_fma_f32 v60, v60, s34, -v23
v_exp_f32 v36, v36
v_exp_f32 v44, v44
v_exp_f32 v52, v52
v_exp_f32 v60, v60
v_fma_f32 v37, v37, s34, -v20
v_fma_f32 v45, v45, s34, -v21
v_fma_f32 v53, v53, s34, -v22
v_fma_f32 v61, v61, s34, -v23
v_exp_f32 v37, v37
v_exp_f32 v45, v45
v_exp_f32 v53, v53
v_exp_f32 v61, v61
v_fma_f32 v38, v38, s34, -v20
v_fma_f32 v46, v46, s34, -v21
v_fma_f32 v54, v54, s34, -v22
v_fma_f32 v62, v62, s34, -v23
v_exp_f32 v38, v38
v_exp_f32 v46, v46
v_exp_f32 v54, v54
v_exp_f32 v62, v62
v_fma_f32 v39, v39, s34, -v20
v_fma_f32 v47, v47, s34, -v21
v_fma_f32 v55, v55, s34, -v22
v_fma_f32 v63, v63, s34, -v23
v_exp_f32 v39, v39
v_exp_f32 v47, v47
v_exp_f32 v55, v55
v_exp_f32 v63, v63
v_add_f32 v28, v32, v33
v_add_f32 v29, v40, v41
v_add_f32 v30, v48, v49
v_add_f32 v31, v56, v57
v_add_f32 v28, v28, v34
v_add_f32 v29, v29, v42
v_add_f32 v30, v30, v50
v_add_f32 v31, v31, v58
v_add_f32 v28, v28, v35
v_add_f32 v29, v29, v43
v_add_f32 v30, v30, v51
v_add_f32 v31, v31, v59
v_add_f32 v28, v28, v36
v_add_f32 v29, v29, v44
v_add_f32 v30, v30, v52
v_add_f32 v31, v31, v60
v_add_f32 v28, v28, v37
v_add_f32 v29, v29, v45
v_add_f32 v30, v30, v53
v_add_f32 v31, v31, v61
v_add_f32 v28, v28, v38
v_add_f32 v29, v29, v46
v_add_f32 v30, v30, v54
v_add_f32 v31, v31, v62
v_add_f32 v28, v28, v39
v_add_f32 v29, v29, v47
v_add_f32 v30, v30, v55
v_add_f32 v31, v31, v63
v_mov_b32 v24, v28
v_mov_b32 v25, v29
v_mov_b32 v26, v30
v_mov_b32 v27, v31
v_permlane16_swap_b32 v28, v24
v_permlane16_swap_b32 v29, v25
v_permlane16_swap_b32 v30, v26
v_permlane16_swap_b32 v31, v27
v_add_f32 v28, v28, v24
v_add_f32 v29, v29, v25
v_add_f32 v30, v30, v26
v_add_f32 v31, v31, v27
v_mov_b32 v24, v28
v_mov_b32 v25, v29
v_mov_b32 v26, v30
v_mov_b32 v27, v31
v_permlane32_swap_b32 v28, v24
v_permlane32_swap_b32 v29, v25
v_permlane32_swap_b32 v30, v26
v_permlane32_swap_b32 v31, v27
v_add_f32 v28, v28, v24
v_add_f32 v29, v29, v25
v_add_f32 v30, v30, v26
v_add_f32 v31, v31, v27
v_rcp_f32 v28, v28
v_rcp_f32 v29, v29
v_rcp_f32 v30, v30
v_rcp_f32 v31, v31
v_mul_f32 v32, v32, v28
v_mul_f32 v40, v40, v29
v_mul_f32 v48, v48, v30
v_mul_f32 v56, v56, v31
v_mul_f32 v33, v33, v28
v_mul_f32 v41, v41, v29
v_mul_f32 v49, v49, v30
v_mul_f32 v57, v57, v31
v_mul_f32 v34, v34, v28
v_mul_f32 v42, v42, v29
v_mul_f32 v50, v50, v30
v_mul_f32 v58, v58, v31
v_mul_f32 v35, v35, v28
v_mul_f32 v43, v43, v29
v_mul_f32 v51, v51, v30
v_mul_f32 v59, v59, v31
v_mul_f32 v36, v36, v28
v_mul_f32 v44, v44, v29
v_mul_f32 v52, v52, v30
v_mul_f32 v60, v60, v31
v_mul_f32 v37, v37, v28
v_mul_f32 v45, v45, v29
v_mul_f32 v53, v53, v30
v_mul_f32 v61, v61, v31
v_mul_f32 v38, v38, v28
v_mul_f32 v46, v46, v29
v_mul_f32 v54, v54, v30
v_mul_f32 v62, v62, v31
v_mul_f32 v39, v39, v28
v_mul_f32 v47, v47, v29
v_mul_f32 v55, v55, v30
v_mul_f32 v63, v63, v31
v_cvt_pk_bf16_f32 v64, v32, v33
v_cvt_pk_bf16_f32 v65, v34, v35
v_cvt_pk_bf16_f32 v66, v36, v37
v_cvt_pk_bf16_f32 v67, v38, v39
v_cvt_pk_bf16_f32 v68, v40, v41
v_cvt_pk_bf16_f32 v69, v42, v43
v_cvt_pk_bf16_f32 v70, v44, v45
v_cvt_pk_bf16_f32 v71, v46, v47
v_cvt_pk_bf16_f32 v72, v48, v49
v_cvt_pk_bf16_f32 v73, v50, v51
v_cvt_pk_bf16_f32 v74, v52, v53
v_cvt_pk_bf16_f32 v75, v54, v55
v_cvt_pk_bf16_f32 v76, v56, v57
v_cvt_pk_bf16_f32 v77, v58, v59
v_cvt_pk_bf16_f32 v78, v60, v61
v_cvt_pk_bf16_f32 v79, v62, v63
v_mfma_f32_16x16x32_bf16 v[80:83], v[124:127], v[64:67], 0
v_mfma_f32_16x16x32_bf16 v[84:87], v[136:139], v[64:67], 0
v_mfma_f32_16x16x32_bf16 v[88:91], v[130:133], v[68:71], 0
v_mfma_f32_16x16x32_bf16 v[92:95], v[136:139], v[68:71], 0
v_mfma_f32_16x16x32_bf16 v[96:99], v[122:125], v[72:75], 0
v_mfma_f32_16x16x32_bf16 v[100:103], v[134:137], v[72:75], 0
v_mfma_f32_16x16x32_bf16 v[164:167], v[128:131], v[76:79], 0
v_mfma_f32_16x16x32_bf16 v[168:171], v[134:137], v[76:79], 0
v_lshlrev_b32 v14, 4, v12
v_mov_b32 v15, 2146435072
v_cmp_gt_u32 vcc, 16, v1
s_nop 1
v_cndmask_b32 v14, v15, v14, vcc
s_add_u32 s26, s24, s72
s_lshl_b32 s27, s21, 10
s_add_u32 s27, s27, s26
s_lshr_b32 s28, s21, 1
s_lshl_b32 s28, s28, 8
s_and_b32 s30, s21, 1
s_lshl_b32 s30, s30, 3
s_add_u32 s28, s28, s30
s_add_u32 s28, s28, 16384
s_add_u32 s28, s28, s26
s_add_u32 s30, s27, 18432
s_add_u32 s31, s28, 18432
v_cvt_pk_bf16_f32 v180, v80, v81
v_cvt_pk_bf16_f32 v181, v82, v83
v_cvt_pk_bf16_f32 v182, v88, v89
v_cvt_pk_bf16_f32 v183, v90, v91
v_cvt_pk_bf16_f32 v184, v84, v85
v_cvt_pk_bf16_f32 v185, v94, v95
buffer_store_dwordx4 v[180:183], v2, s[8:11], s30 offen
buffer_store_dwordx2 v[184:185], v14, s[8:11], s31 offen
v_cvt_pk_bf16_f32 v172, v96, v97
v_cvt_pk_bf16_f32 v173, v98, v99
v_cvt_pk_bf16_f32 v174, v164, v165
v_cvt_pk_bf16_f32 v175, v166, v167
v_cvt_pk_bf16_f32 v176, v100, v101
v_cvt_pk_bf16_f32 v177, v170, v171
buffer_store_dwordx4 v[172:175], v2, s[8:11], s27 offen
buffer_store_dwordx2 v[176:177], v14, s[8:11], s28 offen
L_a1l_end:
s_endpgm
.p2align 8
.globl a2l1_kernel
.type a2l1_kernel,@function
a2l1_kernel:
s_cmp_ge_u32 s2, 256
s_cbranch_scc1 L_a2l_end
s_mov_b32 s70, 21684224
s_mov_b32 s71, 26402816
s_mov_b32 s72, 31121408
s_mov_b32 s73, 35840000
s_mov_b32 s74, 38330368
s_mov_b32 s75, 57335808
s_mov_b32 s76, 95084544
s_mov_b32 s77, 16384
s_branch L_a2l_body
.p2align 8
.globl a2l0_kernel
.type a2l0_kernel,@function
a2l0_kernel:
s_cmp_ge_u32 s2, 256
s_cbranch_scc1 L_a2l_end
s_mov_b32 s70, 19324928
s_mov_b32 s71, 24043520
s_mov_b32 s72, 28762112
s_mov_b32 s73, 33480704
s_mov_b32 s74, 38199296
s_mov_b32 s75, 38461440
s_mov_b32 s76, 76210176
s_mov_b32 s77, 0
L_a2l_body:
s_load_dwordx2 s[12:13], s[0:1], 72
v_and_b32 v1, 63, v0
v_lshrrev_b32 v3, 6, v0
v_lshlrev_b32 v2, 4, v1
v_readfirstlane_b32 s4, v3
s_and_b32 s5, s2, 7
s_lshr_b32 s6, s2, 3
s_waitcnt lgkmcnt(0)
s_mov_b32 s8, s12
s_and_b32 s9, s13, 0xffff
s_mov_b32 s10, 268435456
s_mov_b32 s11, 0x20000
s_lshr_b32 s20, s6, 3
s_lshl_b32 s21, s5, 2
s_add_u32 s20, s20, s21
s_lshl_b32 s20, s20, 2
s_add_u32 s20, s20, s4
s_and_b32 s21, s6, 7
s_mul_i32 s22, s21, 92160
s_mul_i32 s23, s4, 23552
s_add_u32 s22, s22, s23
s_add_u32 s22, s22, 2621440
s_add_u32 m0, s23, 0
s_add_u32 s40, s22, 0
buffer_load_dwordx4 v2, s[8:11], s40 offen offset:0 lds
buffer_load_dwordx4 v2, s[8:11], s40 offen offset:1024 lds
buffer_load_dwordx4 v2, s[8:11], s40 offen offset:2048 lds
buffer_load_dwordx4 v2, s[8:11], s40 offen offset:3072 lds
s_add_u32 m0, s23, 4096
s_add_u32 s40, s22, 4096
buffer_load_dwordx4 v2, s[8:11], s40 offen offset:0 lds
buffer_load_dwordx4 v2, s[8:11], s40 offen offset:1024 lds
buffer_load_dwordx4 v2, s[8:11], s40 offen offset:2048 lds
buffer_load_dwordx4 v2, s[8:11], s40 offen offset:3072 lds
s_add_u32 m0, s23, 8192
s_add_u32 s40, s22, 8192
buffer_load_dwordx4 v2, s[8:11], s40 offen offset:0 lds
buffer_load_dwordx4 v2, s[8:11], s40 offen offset:1024 lds
buffer_load_dwordx4 v2, s[8:11], s40 offen offset:2048 lds
buffer_load_dwordx4 v2, s[8:11], s40 offen offset:3072 lds
s_add_u32 m0, s23, 12288
s_add_u32 s40, s22, 12288
buffer_load_dwordx4 v2, s[8:11], s40 offen offset:0 lds
buffer_load_dwordx4 v2, s[8:11], s40 offen offset:1024 lds
buffer_load_dwordx4 v2, s[8:11], s40 offen offset:2048 lds
buffer_load_dwordx4 v2, s[8:11], s40 offen offset:3072 lds
s_add_u32 m0, s23, 16384
s_add_u32 s40, s22, 16384
buffer_load_dwordx4 v2, s[8:11], s40 offen offset:0 lds
buffer_load_dwordx4 v2, s[8:11], s40 offen offset:1024 lds
buffer_load_dwordx4 v2, s[8:11], s40 offen offset:2048 lds
buffer_load_dwordx4 v2, s[8:11], s40 offen offset:3072 lds
s_add_u32 m0, s23, 20480
s_add_u32 s40, s22, 20480
buffer_load_dwordx4 v2, s[8:11], s40 offen offset:0 lds
buffer_load_dwordx4 v2, s[8:11], s40 offen offset:1024 lds
buffer_load_dwordx4 v2, s[8:11], s40 offen offset:2048 lds
s_mul_i32 s24, s20, 18432
s_add_u32 s25, s24, s72
buffer_load_dwordx4 a[0:3], v2, s[8:11], s25 offen offset:0
buffer_load_dwordx4 a[4:7], v2, s[8:11], s25 offen offset:1024
buffer_load_dwordx4 a[8:11], v2, s[8:11], s25 offen offset:2048
buffer_load_dwordx4 a[12:15], v2, s[8:11], s25 offen offset:3072
s_add_u32 s25, s25, 4096
buffer_load_dwordx4 a[16:19], v2, s[8:11], s25 offen offset:0
buffer_load_dwordx4 a[20:23], v2, s[8:11], s25 offen offset:1024
buffer_load_dwordx4 a[24:27], v2, s[8:11], s25 offen offset:2048
buffer_load_dwordx4 a[28:31], v2, s[8:11], s25 offen offset:3072
s_add_u32 s25, s25, 4096
buffer_load_dwordx4 a[32:35], v2, s[8:11], s25 offen offset:0
buffer_load_dwordx4 a[36:39], v2, s[8:11], s25 offen offset:1024
buffer_load_dwordx4 a[40:43], v2, s[8:11], s25 offen offset:2048
buffer_load_dwordx4 a[44:47], v2, s[8:11], s25 offen offset:3072
s_add_u32 s25, s25, 4096
buffer_load_dwordx4 a[48:51], v2, s[8:11], s25 offen offset:0
buffer_load_dwordx4 a[52:55], v2, s[8:11], s25 offen offset:1024
buffer_load_dwordx4 a[56:59], v2, s[8:11], s25 offen offset:2048
buffer_load_dwordx4 a[60:63], v2, s[8:11], s25 offen offset:3072
s_add_u32 s25, s25, 4096
buffer_load_dwordx4 a[64:67], v2, s[8:11], s25 offen offset:0
buffer_load_dwordx4 a[68:71], v2, s[8:11], s25 offen offset:1024
s_mul_i32 s26, s21, 2304
s_add_u32 s26, s26, s24
s_add_u32 s27, s26, s71
v_and_b32 v6, 15, v1
v_lshrrev_b32 v7, 4, v1
v_lshlrev_b32 v8, 4, v6
v_lshl_add_u32 v8, v7, 3, v8
v_add_u32 v8, 2048, v8
v_mov_b32 v9, 2146435072
v_cmp_gt_u32 vcc, 32, v1
s_nop 1
v_cndmask_b32 v4, v9, v8, vcc
buffer_load_dwordx4 v[56:59], v2, s[8:11], s27 offen
buffer_load_dwordx4 v[60:63], v2, s[8:11], s27 offen offset:1024
buffer_load_dwordx2 v[64:65], v4, s[8:11], s27 offen
v_add_u32 v5, 0x10000, v2
s_waitcnt vmcnt(21)
s_barrier
ds_read_b128 a[216:219], v2 offset:0
ds_read_b128 a[220:223], v2 offset:5120
ds_read_b128 a[224:227], v2 offset:1024
ds_read_b128 a[228:231], v2 offset:6144
ds_read_b128 a[232:235], v2 offset:2048
ds_read_b128 a[236:239], v2 offset:7168
s_waitcnt vmcnt(19)
s_waitcnt lgkmcnt(4)
v_mfma_f32_16x16x32_bf16 v[32:35], a[216:219], a[0:3], 0
ds_read_b128 a[240:243], v2 offset:3072
v_mfma_f32_16x16x32_bf16 v[32:35], a[220:223], a[4:7], v[32:35]
ds_read_b128 a[244:247], v2 offset:8192
s_waitcnt lgkmcnt(4)
v_mfma_f32_16x16x32_bf16 v[36:39], a[224:227], a[0:3], 0
ds_read_b128 a[216:219], v2 offset:4096
v_mfma_f32_16x16x32_bf16 v[36:39], a[228:231], a[4:7], v[36:39]
ds_read_b128 a[220:223], v2 offset:9216
s_waitcnt lgkmcnt(4)
v_mfma_f32_16x16x32_bf16 v[40:43], a[232:235], a[0:3], 0
ds_read_b128 a[224:227], v2 offset:10240
v_mfma_f32_16x16x32_bf16 v[40:43], a[236:239], a[4:7], v[40:43]
ds_read_b128 a[228:231], v2 offset:15360
s_waitcnt lgkmcnt(4)
v_mfma_f32_16x16x32_bf16 v[44:47], a[240:243], a[0:3], 0
ds_read_b128 a[232:235], v2 offset:11264
v_mfma_f32_16x16x32_bf16 v[44:47], a[244:247], a[4:7], v[44:47]
ds_read_b128 a[236:239], v2 offset:16384
s_waitcnt lgkmcnt(4)
v_mfma_f32_16x16x32_bf16 v[48:51], a[216:219], a[0:3], 0
ds_read_b128 a[240:243], v2 offset:12288
v_mfma_f32_16x16x32_bf16 v[48:51], a[220:223], a[4:7], v[48:51]
ds_read_b128 a[244:247], v2 offset:17408
s_waitcnt vmcnt(17)
s_waitcnt lgkmcnt(4)
v_mfma_f32_16x16x32_bf16 v[32:35], a[224:227], a[8:11], v[32:35]
ds_read_b128 a[216:219], v2 offset:13312
v_mfma_f32_16x16x32_bf16 v[32:35], a[228:231], a[12:15], v[32:35]
ds_read_b128 a[220:223], v2 offset:18432
s_waitcnt lgkmcnt(4)
v_mfma_f32_16x16x32_bf16 v[36:39], a[232:235], a[8:11], v[36:39]
ds_read_b128 a[224:227], v2 offset:14336
v_mfma_f32_16x16x32_bf16 v[36:39], a[236:239], a[12:15], v[36:39]
ds_read_b128 a[228:231], v2 offset:19456
s_waitcnt lgkmcnt(4)
v_mfma_f32_16x16x32_bf16 v[40:43], a[240:243], a[8:11], v[40:43]
ds_read_b128 a[232:235], v2 offset:20480
v_mfma_f32_16x16x32_bf16 v[40:43], a[244:247], a[12:15], v[40:43]
ds_read_b128 a[236:239], v2 offset:25600
s_waitcnt lgkmcnt(4)
v_mfma_f32_16x16x32_bf16 v[44:47], a[216:219], a[8:11], v[44:47]
ds_read_b128 a[240:243], v2 offset:21504
v_mfma_f32_16x16x32_bf16 v[44:47], a[220:223], a[12:15], v[44:47]
ds_read_b128 a[244:247], v2 offset:26624
s_waitcnt lgkmcnt(4)
v_mfma_f32_16x16x32_bf16 v[48:51], a[224:227], a[8:11], v[48:51]
ds_read_b128 a[216:219], v2 offset:22528
v_mfma_f32_16x16x32_bf16 v[48:51], a[228:231], a[12:15], v[48:51]
ds_read_b128 a[220:223], v2 offset:27648
s_waitcnt vmcnt(15)
s_waitcnt lgkmcnt(4)
v_mfma_f32_16x16x32_bf16 v[32:35], a[232:235], a[16:19], v[32:35]
ds_read_b128 a[224:227], v2 offset:23552
v_mfma_f32_16x16x32_bf16 v[32:35], a[236:239], a[20:23], v[32:35]
ds_read_b128 a[228:231], v2 offset:28672
s_waitcnt lgkmcnt(4)
v_mfma_f32_16x16x32_bf16 v[36:39], a[240:243], a[16:19], v[36:39]
ds_read_b128 a[232:235], v2 offset:24576
v_mfma_f32_16x16x32_bf16 v[36:39], a[244:247], a[20:23], v[36:39]
ds_read_b128 a[236:239], v2 offset:29696
s_waitcnt lgkmcnt(4)
v_mfma_f32_16x16x32_bf16 v[40:43], a[216:219], a[16:19], v[40:43]
ds_read_b128 a[240:243], v2 offset:30720
v_mfma_f32_16x16x32_bf16 v[40:43], a[220:223], a[20:23], v[40:43]
ds_read_b128 a[244:247], v2 offset:35840
s_waitcnt lgkmcnt(4)
v_mfma_f32_16x16x32_bf16 v[44:47], a[224:227], a[16:19], v[44:47]
ds_read_b128 a[216:219], v2 offset:31744
v_mfma_f32_16x16x32_bf16 v[44:47], a[228:231], a[20:23], v[44:47]
ds_read_b128 a[220:223], v2 offset:36864
s_waitcnt lgkmcnt(4)
v_mfma_f32_16x16x32_bf16 v[48:51], a[232:235], a[16:19], v[48:51]
ds_read_b128 a[224:227], v2 offset:32768
v_mfma_f32_16x16x32_bf16 v[48:51], a[236:239], a[20:23], v[48:51]
ds_read_b128 a[228:231], v2 offset:37888
s_waitcnt vmcnt(13)
s_waitcnt lgkmcnt(4)
v_mfma_f32_16x16x32_bf16 v[32:35], a[240:243], a[24:27], v[32:35]
ds_read_b128 a[232:235], v2 offset:33792
v_mfma_f32_16x16x32_bf16 v[32:35], a[244:247], a[28:31], v[32:35]
ds_read_b128 a[236:239], v2 offset:38912
s_waitcnt lgkmcnt(4)
v_mfma_f32_16x16x32_bf16 v[36:39], a[216:219], a[24:27], v[36:39]
ds_read_b128 a[240:243], v2 offset:34816
v_mfma_f32_16x16x32_bf16 v[36:39], a[220:223], a[28:31], v[36:39]
ds_read_b128 a[244:247], v2 offset:39936
s_waitcnt lgkmcnt(4)
v_mfma_f32_16x16x32_bf16 v[40:43], a[224:227], a[24:27], v[40:43]
ds_read_b128 a[216:219], v2 offset:40960
v_mfma_f32_16x16x32_bf16 v[40:43], a[228:231], a[28:31], v[40:43]
ds_read_b128 a[220:223], v2 offset:46080
s_waitcnt lgkmcnt(4)
v_mfma_f32_16x16x32_bf16 v[44:47], a[232:235], a[24:27], v[44:47]
ds_read_b128 a[224:227], v2 offset:41984
v_mfma_f32_16x16x32_bf16 v[44:47], a[236:239], a[28:31], v[44:47]
ds_read_b128 a[228:231], v2 offset:47104
s_waitcnt lgkmcnt(4)
v_mfma_f32_16x16x32_bf16 v[48:51], a[240:243], a[24:27], v[48:51]
ds_read_b128 a[232:235], v2 offset:43008
v_mfma_f32_16x16x32_bf16 v[48:51], a[244:247], a[28:31], v[48:51]
ds_read_b128 a[236:239], v2 offset:48128
s_waitcnt vmcnt(11)
s_waitcnt lgkmcnt(4)
v_mfma_f32_16x16x32_bf16 v[32:35], a[216:219], a[32:35], v[32:35]
ds_read_b128 a[240:243], v2 offset:44032
v_mfma_f32_16x16x32_bf16 v[32:35], a[220:223], a[36:39], v[32:35]
ds_read_b128 a[244:247], v2 offset:49152
s_waitcnt lgkmcnt(4)
v_mfma_f32_16x16x32_bf16 v[36:39], a[224:227], a[32:35], v[36:39]
ds_read_b128 a[216:219], v2 offset:45056
v_mfma_f32_16x16x32_bf16 v[36:39], a[228:231], a[36:39], v[36:39]
ds_read_b128 a[220:223], v2 offset:50176
s_waitcnt lgkmcnt(4)
v_mfma_f32_16x16x32_bf16 v[40:43], a[232:235], a[32:35], v[40:43]
ds_read_b128 a[224:227], v2 offset:51200
v_mfma_f32_16x16x32_bf16 v[40:43], a[236:239], a[36:39], v[40:43]
ds_read_b128 a[228:231], v2 offset:56320
s_waitcnt lgkmcnt(4)
v_mfma_f32_16x16x32_bf16 v[44:47], a[240:243], a[32:35], v[44:47]
ds_read_b128 a[232:235], v2 offset:52224
v_mfma_f32_16x16x32_bf16 v[44:47], a[244:247], a[36:39], v[44:47]
ds_read_b128 a[236:239], v2 offset:57344
s_waitcnt lgkmcnt(4)
v_mfma_f32_16x16x32_bf16 v[48:51], a[216:219], a[32:35], v[48:51]
ds_read_b128 a[240:243], v2 offset:53248
v_mfma_f32_16x16x32_bf16 v[48:51], a[220:223], a[36:39], v[48:51]
ds_read_b128 a[244:247], v2 offset:58368
s_waitcnt vmcnt(9)
s_waitcnt lgkmcnt(4)
v_mfma_f32_16x16x32_bf16 v[32:35], a[224:227], a[40:43], v[32:35]
ds_read_b128 a[216:219], v2 offset:54272
v_mfma_f32_16x16x32_bf16 v[32:35], a[228:231], a[44:47], v[32:35]
ds_read_b128 a[220:223], v2 offset:59392
s_waitcnt lgkmcnt(4)
v_mfma_f32_16x16x32_bf16 v[36:39], a[232:235], a[40:43], v[36:39]
ds_read_b128 a[224:227], v2 offset:55296
v_mfma_f32_16x16x32_bf16 v[36:39], a[236:239], a[44:47], v[36:39]
ds_read_b128 a[228:231], v2 offset:60416
s_waitcnt lgkmcnt(4)
v_mfma_f32_16x16x32_bf16 v[40:43], a[240:243], a[40:43], v[40:43]
ds_read_b128 a[232:235], v2 offset:61440
v_mfma_f32_16x16x32_bf16 v[40:43], a[244:247], a[44:47], v[40:43]
ds_read_b128 a[236:239], v5 offset:1024
s_waitcnt lgkmcnt(4)
v_mfma_f32_16x16x32_bf16 v[44:47], a[216:219], a[40:43], v[44:47]
ds_read_b128 a[240:243], v2 offset:62464
v_mfma_f32_16x16x32_bf16 v[44:47], a[220:223], a[44:47], v[44:47]
ds_read_b128 a[244:247], v5 offset:2048
s_waitcnt lgkmcnt(4)
v_mfma_f32_16x16x32_bf16 v[48:51], a[224:227], a[40:43], v[48:51]
ds_read_b128 a[216:219], v2 offset:63488
v_mfma_f32_16x16x32_bf16 v[48:51], a[228:231], a[44:47], v[48:51]
ds_read_b128 a[220:223], v5 offset:3072
s_waitcnt vmcnt(7)
s_waitcnt lgkmcnt(4)
v_mfma_f32_16x16x32_bf16 v[32:35], a[232:235], a[48:51], v[32:35]
ds_read_b128 a[224:227], v2 offset:64512
v_mfma_f32_16x16x32_bf16 v[32:35], a[236:239], a[52:55], v[32:35]
ds_read_b128 a[228:231], v5 offset:4096
s_waitcnt lgkmcnt(4)
v_mfma_f32_16x16x32_bf16 v[36:39], a[240:243], a[48:51], v[36:39]
ds_read_b128 a[232:235], v5 offset:0
v_mfma_f32_16x16x32_bf16 v[36:39], a[244:247], a[52:55], v[36:39]
ds_read_b128 a[236:239], v5 offset:5120
s_waitcnt lgkmcnt(4)
v_mfma_f32_16x16x32_bf16 v[40:43], a[216:219], a[48:51], v[40:43]
ds_read_b128 a[240:243], v5 offset:6144
v_mfma_f32_16x16x32_bf16 v[40:43], a[220:223], a[52:55], v[40:43]
ds_read_b128 a[244:247], v5 offset:11264
s_waitcnt lgkmcnt(4)
v_mfma_f32_16x16x32_bf16 v[44:47], a[224:227], a[48:51], v[44:47]
ds_read_b128 a[216:219], v5 offset:7168
v_mfma_f32_16x16x32_bf16 v[44:47], a[228:231], a[52:55], v[44:47]
ds_read_b128 a[220:223], v5 offset:12288
s_waitcnt lgkmcnt(4)
v_mfma_f32_16x16x32_bf16 v[48:51], a[232:235], a[48:51], v[48:51]
ds_read_b128 a[224:227], v5 offset:8192
v_mfma_f32_16x16x32_bf16 v[48:51], a[236:239], a[52:55], v[48:51]
ds_read_b128 a[228:231], v5 offset:13312
s_waitcnt vmcnt(5)
s_waitcnt lgkmcnt(4)
v_mfma_f32_16x16x32_bf16 v[32:35], a[240:243], a[56:59], v[32:35]
ds_read_b128 a[232:235], v5 offset:9216
v_mfma_f32_16x16x32_bf16 v[32:35], a[244:247], a[60:63], v[32:35]
ds_read_b128 a[236:239], v5 offset:14336
s_waitcnt lgkmcnt(4)
v_mfma_f32_16x16x32_bf16 v[36:39], a[216:219], a[56:59], v[36:39]
ds_read_b128 a[240:243], v5 offset:10240
v_mfma_f32_16x16x32_bf16 v[36:39], a[220:223], a[60:63], v[36:39]
ds_read_b128 a[244:247], v5 offset:15360
s_waitcnt lgkmcnt(4)
v_mfma_f32_16x16x32_bf16 v[40:43], a[224:227], a[56:59], v[40:43]
ds_read_b128 a[216:219], v5 offset:16384
v_mfma_f32_16x16x32_bf16 v[40:43], a[228:231], a[60:63], v[40:43]
ds_read_b128 a[220:223], v5 offset:21504
s_waitcnt lgkmcnt(4)
v_mfma_f32_16x16x32_bf16 v[44:47], a[232:235], a[56:59], v[44:47]
ds_read_b128 a[224:227], v5 offset:17408
v_mfma_f32_16x16x32_bf16 v[44:47], a[236:239], a[60:63], v[44:47]
ds_read_b128 a[228:231], v5 offset:22528
s_waitcnt lgkmcnt(4)
v_mfma_f32_16x16x32_bf16 v[48:51], a[240:243], a[56:59], v[48:51]
ds_read_b128 a[232:235], v5 offset:18432
v_mfma_f32_16x16x32_bf16 v[48:51], a[244:247], a[60:63], v[48:51]
ds_read_b128 a[236:239], v5 offset:23552
s_waitcnt vmcnt(3)
s_waitcnt lgkmcnt(4)
v_mfma_f32_16x16x32_bf16 v[32:35], a[216:219], a[64:67], v[32:35]
ds_read_b128 a[240:243], v5 offset:19456
v_mfma_f32_16x16x32_bf16 v[32:35], a[220:223], a[68:71], v[32:35]
ds_read_b128 a[244:247], v5 offset:24576
s_waitcnt lgkmcnt(4)
v_mfma_f32_16x16x32_bf16 v[36:39], a[224:227], a[64:67], v[36:39]
ds_read_b128 a[216:219], v5 offset:20480
v_mfma_f32_16x16x32_bf16 v[36:39], a[228:231], a[68:71], v[36:39]
ds_read_b128 a[220:223], v5 offset:25600
s_waitcnt lgkmcnt(4)
v_mfma_f32_16x16x32_bf16 v[40:43], a[232:235], a[64:67], v[40:43]
v_mfma_f32_16x16x32_bf16 v[40:43], a[236:239], a[68:71], v[40:43]
s_waitcnt lgkmcnt(2)
v_mfma_f32_16x16x32_bf16 v[44:47], a[240:243], a[64:67], v[44:47]
v_mfma_f32_16x16x32_bf16 v[44:47], a[244:247], a[68:71], v[44:47]
s_waitcnt lgkmcnt(0)
v_mfma_f32_16x16x32_bf16 v[48:51], a[216:219], a[64:67], v[48:51]
v_mfma_f32_16x16x32_bf16 v[48:51], a[220:223], a[68:71], v[48:51]
s_waitcnt vmcnt(0)
v_lshlrev_b32 v68, 16, v56
v_and_b32 v69, 0xffff0000, v56
v_add_f32 v32, v32, v68
v_add_f32 v33, v33, v69
v_lshlrev_b32 v70, 16, v57
v_and_b32 v71, 0xffff0000, v57
v_add_f32 v34, v34, v70
v_add_f32 v35, v35, v71
v_lshlrev_b32 v72, 16, v58
v_and_b32 v73, 0xffff0000, v58
v_add_f32 v36, v36, v72
v_add_f32 v37, v37, v73
v_lshlrev_b32 v74, 16, v59
v_and_b32 v75, 0xffff0000, v59
v_add_f32 v38, v38, v74
v_add_f32 v39, v39, v75
v_lshlrev_b32 v68, 16, v60
v_and_b32 v69, 0xffff0000, v60
v_add_f32 v40, v40, v68
v_add_f32 v41, v41, v69
v_lshlrev_b32 v70, 16, v61
v_and_b32 v71, 0xffff0000, v61
v_add_f32 v42, v42, v70
v_add_f32 v43, v43, v71
v_lshlrev_b32 v72, 16, v62
v_and_b32 v73, 0xffff0000, v62
v_add_f32 v44, v44, v72
v_add_f32 v45, v45, v73
v_lshlrev_b32 v74, 16, v63
v_and_b32 v75, 0xffff0000, v63
v_add_f32 v46, v46, v74
v_add_f32 v47, v47, v75
v_lshlrev_b32 v68, 16, v64
v_and_b32 v69, 0xffff0000, v64
v_add_f32 v48, v48, v68
v_add_f32 v49, v49, v69
v_lshlrev_b32 v70, 16, v65
v_and_b32 v71, 0xffff0000, v65
v_add_f32 v50, v50, v70
v_add_f32 v51, v51, v71
v_cvt_pk_bf16_f32 v80, v32, v33
v_cvt_pk_bf16_f32 v81, v34, v35
v_cvt_pk_bf16_f32 v82, v36, v37
v_cvt_pk_bf16_f32 v83, v38, v39
v_cvt_pk_bf16_f32 v84, v40, v41
v_cvt_pk_bf16_f32 v85, v42, v43
v_cvt_pk_bf16_f32 v86, v44, v45
v_cvt_pk_bf16_f32 v87, v46, v47
v_cvt_pk_bf16_f32 v88, v48, v49
v_cvt_pk_bf16_f32 v89, v50, v51
s_add_u32 s27, s26, s73
buffer_store_dwordx4 v[80:83], v2, s[8:11], s27 offen
buffer_store_dwordx4 v[84:87], v2, s[8:11], s27 offen offset:1024
buffer_store_dwordx2 v[88:89], v4, s[8:11], s27 offen
v_add_f32 v10, v32, v33
v_mul_f32 v11, v32, v32
v_mul_f32 v13, v33, v33
v_mov_b32 v12, 0
v_add_f32 v10, v10, v34
v_add_f32 v12, v12, v35
v_fmac_f32 v11, v34, v34
v_fmac_f32 v13, v35, v35
v_add_f32 v10, v10, v36
v_add_f32 v12, v12, v37
v_fmac_f32 v11, v36, v36
v_fmac_f32 v13, v37, v37
v_add_f32 v10, v10, v38
v_add_f32 v12, v12, v39
v_fmac_f32 v11, v38, v38
v_fmac_f32 v13, v39, v39
v_add_f32 v10, v10, v40
v_add_f32 v12, v12, v41
v_fmac_f32 v11, v40, v40
v_fmac_f32 v13, v41, v41
v_add_f32 v10, v10, v42
v_add_f32 v12, v12, v43
v_fmac_f32 v11, v42, v42
v_fmac_f32 v13, v43, v43
v_add_f32 v10, v10, v44
v_add_f32 v12, v12, v45
v_fmac_f32 v11, v44, v44
v_fmac_f32 v13, v45, v45
v_add_f32 v10, v10, v46
v_add_f32 v12, v12, v47
v_fmac_f32 v11, v46, v46
v_fmac_f32 v13, v47, v47
v_add_f32 v10, v10, v48
v_add_f32 v12, v12, v49
v_fmac_f32 v11, v48, v48
v_fmac_f32 v13, v49, v49
v_add_f32 v10, v10, v50
v_add_f32 v12, v12, v51
v_fmac_f32 v11, v50, v50
v_fmac_f32 v13, v51, v51
v_add_f32 v10, v10, v12
v_add_f32 v11, v11, v13
v_mov_b32 v12, v10
v_mov_b32 v13, v11
s_nop 0
v_permlane16_swap_b32 v10, v12
v_permlane16_swap_b32 v11, v13
v_add_f32 v10, v10, v12
v_add_f32 v11, v11, v13
v_mov_b32 v12, v10
v_mov_b32 v13, v11
s_nop 0
v_permlane32_swap_b32 v10, v12
v_permlane32_swap_b32 v11, v13
v_add_f32 v10, v10, v12
v_add_f32 v11, v11, v13
v_lshlrev_b32 v8, 3, v6
v_cmp_gt_u32 vcc, 16, v1
s_nop 1
v_cndmask_b32 v8, v9, v8, vcc
s_lshl_b32 s27, s20, 10
s_lshl_b32 s28, s21, 7
s_add_u32 s27, s27, s28
s_add_u32 s27, s27, s74
buffer_store_dwordx2 v[10:11], v8, s[8:11], s27 offen
L_a2l_end:
s_endpgm
.p2align 8
.globl fl1_kernel
.type fl1_kernel,@function
fl1_kernel:
s_cmp_ge_u32 s2, 256
s_cbranch_scc1 L_fl_end
s_mov_b32 s70, 21684224
s_mov_b32 s71, 26402816
s_mov_b32 s72, 31121408
s_mov_b32 s73, 35840000
s_mov_b32 s74, 38330368
s_mov_b32 s75, 57335808
s_mov_b32 s76, 95084544
s_mov_b32 s77, 16384
s_branch L_fl_body
.p2align 8
.globl fl0_kernel
.type fl0_kernel,@function
fl0_kernel:
s_cmp_ge_u32 s2, 256
s_cbranch_scc1 L_fl_end
s_mov_b32 s70, 19324928
s_mov_b32 s71, 24043520
s_mov_b32 s72, 28762112
s_mov_b32 s73, 33480704
s_mov_b32 s74, 38199296
s_mov_b32 s75, 38461440
s_mov_b32 s76, 76210176
s_mov_b32 s77, 0
L_fl_body:
s_load_dwordx2 s[12:13], s[0:1], 72
v_and_b32 v1, 63, v0
v_lshrrev_b32 v3, 6, v0
v_lshlrev_b32 v2, 4, v1
v_readfirstlane_b32 s4, v3
s_and_b32 s5, s2, 7
s_lshr_b32 s6, s2, 3
s_waitcnt lgkmcnt(0)
s_mov_b32 s8, s12
s_and_b32 s9, s13, 0xffff
s_mov_b32 s10, 268435456
s_mov_b32 s11, 0x20000
s_and_b32 s40, s5, 1
s_lshl_b32 s40, s40, 2
s_lshr_b32 s41, s6, 3
s_add_u32 s40, s40, s41
s_lshr_b32 s41, s5, 1
s_lshl_b32 s41, s41, 3
s_and_b32 s42, s6, 7
s_add_u32 s41, s41, s42
s_lshr_b32 s42, s41, 2
s_and_b32 s43, s41, 3
s_lshl_b32 s44, s40, 4
s_lshl_b32 s45, s4, 2
s_add_u32 s44, s44, s45
s_mul_i32 s46, s44, 18432
s_add_u32 s20, s46, s73
s_mul_i32 s22, s4, 6144
s_mul_i32 s21, s41, 497664
s_add_u32 s21, s21, s22
s_add_u32 s21, s21, 3366912
v_add_u32 v4, 18432, v2
v_add_u32 v5, 36864, v2
v_add_u32 v6, 55296, v2
v_and_b32 v13, 15, v1
v_lshrrev_b32 v14, 4, v1
v_lshlrev_b32 v15, 3, v13
v_lshl_add_u32 v15, v14, 8, v15
s_lshl_b32 s47, s44, 10
s_add_u32 s47, s47, s74
buffer_load_dwordx2 v[144:145], v15, s[8:11], s47 offen offset:0
buffer_load_dwordx2 v[146:147], v15, s[8:11], s47 offen offset:128
buffer_load_dwordx2 v[148:149], v15, s[8:11], s47 offen offset:1024
buffer_load_dwordx2 v[150:151], v15, s[8:11], s47 offen offset:1152
buffer_load_dwordx2 v[152:153], v15, s[8:11], s47 offen offset:2048
buffer_load_dwordx2 v[154:155], v15, s[8:11], s47 offen offset:2176
buffer_load_dwordx2 v[156:157], v15, s[8:11], s47 offen offset:3072
buffer_load_dwordx2 v[158:159], v15, s[8:11], s47 offen offset:3200
s_add_u32 m0, s22, 0
s_add_u32 s23, s21, 0
buffer_load_dwordx4 v2, s[8:11], s23 offen offset:0 lds
buffer_load_dwordx4 v2, s[8:11], s23 offen offset:1024 lds
buffer_load_dwordx4 v2, s[8:11], s23 offen offset:2048 lds
buffer_load_dwordx4 v2, s[8:11], s23 offen offset:3072 lds
s_add_u32 m0, s22, 4096
s_add_u32 s23, s21, 4096
buffer_load_dwordx4 v2, s[8:11], s23 offen offset:0 lds
buffer_load_dwordx4 v2, s[8:11], s23 offen offset:1024 lds
s_add_u32 s48, s20, 0
buffer_load_dwordx4 a[0:3], v2, s[8:11], s48 offen offset:0
buffer_load_dwordx4 a[4:7], v4, s[8:11], s48 offen offset:0
buffer_load_dwordx4 a[8:11], v5, s[8:11], s48 offen offset:0
buffer_load_dwordx4 a[12:15], v6, s[8:11], s48 offen offset:0
buffer_load_dwordx4 a[16:19], v2, s[8:11], s48 offen offset:1024
buffer_load_dwordx4 a[20:23], v4, s[8:11], s48 offen offset:1024
buffer_load_dwordx4 a[24:27], v5, s[8:11], s48 offen offset:1024
buffer_load_dwordx4 a[28:31], v6, s[8:11], s48 offen offset:1024
buffer_load_dwordx4 a[32:35], v2, s[8:11], s48 offen offset:2048
buffer_load_dwordx4 a[36:39], v4, s[8:11], s48 offen offset:2048
buffer_load_dwordx4 a[40:43], v5, s[8:11], s48 offen offset:2048
buffer_load_dwordx4 a[44:47], v6, s[8:11], s48 offen offset:2048
buffer_load_dwordx4 a[48:51], v2, s[8:11], s48 offen offset:3072
buffer_load_dwordx4 a[52:55], v4, s[8:11], s48 offen offset:3072
buffer_load_dwordx4 a[56:59], v5, s[8:11], s48 offen offset:3072
buffer_load_dwordx4 a[60:63], v6, s[8:11], s48 offen offset:3072
s_add_u32 s48, s20, 4096
buffer_load_dwordx4 a[64:67], v2, s[8:11], s48 offen offset:0
buffer_load_dwordx4 a[68:71], v4, s[8:11], s48 offen offset:0
buffer_load_dwordx4 a[72:75], v5, s[8:11], s48 offen offset:0
buffer_load_dwordx4 a[76:79], v6, s[8:11], s48 offen offset:0
buffer_load_dwordx4 a[80:83], v2, s[8:11], s48 offen offset:1024
buffer_load_dwordx4 a[84:87], v4, s[8:11], s48 offen offset:1024
buffer_load_dwordx4 a[88:91], v5, s[8:11], s48 offen offset:1024
buffer_load_dwordx4 a[92:95], v6, s[8:11], s48 offen offset:1024
s_add_u32 m0, s22, 24576
s_add_u32 s23, s21, 24576
buffer_load_dwordx4 v2, s[8:11], s23 offen offset:0 lds
buffer_load_dwordx4 v2, s[8:11], s23 offen offset:1024 lds
buffer_load_dwordx4 v2, s[8:11], s23 offen offset:2048 lds
buffer_load_dwordx4 v2, s[8:11], s23 offen offset:3072 lds
s_add_u32 m0, s22, 28672
s_add_u32 s23, s21, 28672
buffer_load_dwordx4 v2, s[8:11], s23 offen offset:0 lds
buffer_load_dwordx4 v2, s[8:11], s23 offen offset:1024 lds
buffer_load_dwordx4 a[96:99], v2, s[8:11], s48 offen offset:2048
buffer_load_dwordx4 a[100:103], v4, s[8:11], s48 offen offset:2048
buffer_load_dwordx4 a[104:107], v5, s[8:11], s48 offen offset:2048
buffer_load_dwordx4 a[108:111], v6, s[8:11], s48 offen offset:2048
buffer_load_dwordx4 a[112:115], v2, s[8:11], s48 offen offset:3072
buffer_load_dwordx4 a[116:119], v4, s[8:11], s48 offen offset:3072
buffer_load_dwordx4 a[120:123], v5, s[8:11], s48 offen offset:3072
buffer_load_dwordx4 a[124:127], v6, s[8:11], s48 offen offset:3072
s_add_u32 s48, s20, 8192
buffer_load_dwordx4 a[128:131], v2, s[8:11], s48 offen offset:0
buffer_load_dwordx4 a[132:135], v4, s[8:11], s48 offen offset:0
buffer_load_dwordx4 a[136:139], v5, s[8:11], s48 offen offset:0
buffer_load_dwordx4 a[140:143], v6, s[8:11], s48 offen offset:0
buffer_load_dwordx4 a[144:147], v2, s[8:11], s48 offen offset:1024
buffer_load_dwordx4 a[148:151], v4, s[8:11], s48 offen offset:1024
buffer_load_dwordx4 a[152:155], v5, s[8:11], s48 offen offset:1024
buffer_load_dwordx4 a[156:159], v6, s[8:11], s48 offen offset:1024
v_add_u32 v7, 0x10000, v2
v_add_u32 v8, 0x20000, v2
v_and_b32 v9, 1, v14
v_mul_u32_u24 v9, 18432, v9
v_lshrrev_b32 v15, 1, v14
v_lshlrev_b32 v15, 8, v15
v_lshl_add_u32 v15, v13, 4, v15
v_add_u32 v9, v9, v15
v_and_b32 v11, 3, v1
v_lshlrev_b32 v11, 2, v11
s_lshl_b32 s49, s43, 2
v_mov_b32 v10, 2146435072
v_mov_b32 v15, s49
v_cmp_eq_u32 vcc, 0, v1
s_nop 1
v_cndmask_b32 v10, v10, v15, vcc
s_lshl_b32 s49, s40, 3
s_add_u32 s49, s49, s42
s_lshl_b32 s50, s49, 2
s_add_u32 s50, s50, s4
s_lshl_b32 s50, s50, 6
s_add_u32 s34, s50, s77
s_lshl_b32 s49, s49, 4
s_add_u32 s49, s49, s45
s_mul_i32 s49, s49, 18432
s_add_u32 s49, s49, s75
s_add_u32 s50, s43, 0
s_and_b32 s50, s50, 3
s_mul_i32 s50, s50, 9
s_add_u32 s50, s50, 1
s_lshr_b32 s50, s50, 1
s_lshl_b32 s50, s50, 10
s_add_u32 s24, s49, s50
s_add_u32 s50, s43, 1
s_and_b32 s50, s50, 3
s_mul_i32 s50, s50, 9
s_add_u32 s50, s50, 1
s_lshr_b32 s50, s50, 1
s_lshl_b32 s50, s50, 10
s_add_u32 s25, s49, s50
s_add_u32 s50, s43, 2
s_and_b32 s50, s50, 3
s_mul_i32 s50, s50, 9
s_add_u32 s50, s50, 1
s_lshr_b32 s50, s50, 1
s_lshl_b32 s50, s50, 10
s_add_u32 s26, s49, s50
s_add_u32 s50, s43, 3
s_and_b32 s50, s50, 3
s_mul_i32 s50, s50, 9
s_add_u32 s50, s50, 1
s_lshr_b32 s50, s50, 1
s_lshl_b32 s50, s50, 10
s_add_u32 s27, s49, s50
s_add_u32 s28, s49, 4096
s_add_u32 s29, s49, 13312
s_cmp_ge_u32 s43, 2
s_cselect_b32 s50, s29, s28
s_and_b32 s51, s43, 1
s_lshl_b32 s51, s51, 3
s_add_u32 s30, s50, s51
s_mul_i32 s50, s42, 2359296
s_add_u32 s50, s50, s46
s_mul_i32 s51, s43, 4608
s_add_u32 s50, s50, s51
s_add_u32 s31, s50, s76
s_add_u32 s32, s31, 4096
s_add_u32 s33, s32, 36864
s_waitcnt vmcnt(52)
v_add_f32 v144, v144, v146
v_add_f32 v145, v145, v147
v_add_f32 v148, v148, v150
v_add_f32 v149, v149, v151
v_add_f32 v152, v152, v154
v_add_f32 v153, v153, v155
v_add_f32 v156, v156, v158
v_add_f32 v157, v157, v159
v_mov_b32 v160, v144
v_mov_b32 v161, v145
v_mov_b32 v162, v148
v_mov_b32 v163, v149
v_mov_b32 v164, v152
v_mov_b32 v165, v153
v_mov_b32 v166, v156
v_mov_b32 v167, v157
v_permlane16_swap_b32 v144, v160
v_permlane16_swap_b32 v145, v161
v_permlane16_swap_b32 v148, v162
v_permlane16_swap_b32 v149, v163
v_permlane16_swap_b32 v152, v164
v_permlane16_swap_b32 v153, v165
v_permlane16_swap_b32 v156, v166
v_permlane16_swap_b32 v157, v167
v_add_f32 v144, v144, v160
v_add_f32 v145, v145, v161
v_add_f32 v148, v148, v162
v_add_f32 v149, v149, v163
v_add_f32 v152, v152, v164
v_add_f32 v153, v153, v165
v_add_f32 v156, v156, v166
v_add_f32 v157, v157, v167
v_mov_b32 v160, v144
v_mov_b32 v161, v145
v_mov_b32 v162, v148
v_mov_b32 v163, v149
v_mov_b32 v164, v152
v_mov_b32 v165, v153
v_mov_b32 v166, v156
v_mov_b32 v167, v157
v_permlane32_swap_b32 v144, v160
v_permlane32_swap_b32 v145, v161
v_permlane32_swap_b32 v148, v162
v_permlane32_swap_b32 v149, v163
v_permlane32_swap_b32 v152, v164
v_permlane32_swap_b32 v153, v165
v_permlane32_swap_b32 v156, v166
v_permlane32_swap_b32 v157, v167
v_add_f32 v144, v144, v160
v_add_f32 v145, v145, v161
v_add_f32 v148, v148, v162
v_add_f32 v149, v149, v163
v_add_f32 v152, v152, v164
v_add_f32 v153, v153, v165
v_add_f32 v156, v156, v166
v_add_f32 v157, v157, v167
v_mul_f32 v144, 0x3ae38e39, v144
v_mul_f32 v145, 0x3ae38e39, v145
v_fma_f32 v145, -v144, v144, v145
v_max_f32 v145, 0, v145
v_add_f32 v234, 0x3727c5ac, v145
v_rsq_f32 v144, v234
v_mul_f32 v148, 0x3ae38e39, v148
v_mul_f32 v149, 0x3ae38e39, v149
v_fma_f32 v149, -v148, v148, v149
v_max_f32 v149, 0, v149
v_add_f32 v237, 0x3727c5ac, v149
v_rsq_f32 v148, v237
v_mul_f32 v152, 0x3ae38e39, v152
v_mul_f32 v153, 0x3ae38e39, v153
v_fma_f32 v153, -v152, v152, v153
v_max_f32 v153, 0, v153
v_add_f32 v240, 0x3727c5ac, v153
v_rsq_f32 v152, v240
v_mul_f32 v156, 0x3ae38e39, v156
v_mul_f32 v157, 0x3ae38e39, v157
v_fma_f32 v157, -v156, v156, v157
v_max_f32 v157, 0, v157
v_add_f32 v243, 0x3727c5ac, v157
v_rsq_f32 v156, v243
v_mul_f32 v232, 0xc0135761, v144
v_mul_f32 v145, v144, v144
v_mul_f32 v145, v145, v144
v_mul_f32 v233, 0xbdd2d3e8, v145
v_mul_f32 v235, 0xc0135761, v148
v_mul_f32 v149, v148, v148
v_mul_f32 v149, v149, v148
v_mul_f32 v236, 0xbdd2d3e8, v149
v_mul_f32 v238, 0xc0135761, v152
v_mul_f32 v153, v152, v152
v_mul_f32 v153, v153, v152
v_mul_f32 v239, 0xbdd2d3e8, v153
v_mul_f32 v241, 0xc0135761, v156
v_mul_f32 v157, v156, v156
v_mul_f32 v157, v157, v156
v_mul_f32 v242, 0xbdd2d3e8, v157
s_waitcnt vmcnt(46)
s_barrier
ds_read_b128 v[48:51], v2 offset:0
ds_read_b128 v[52:55], v2 offset:1024
ds_read_b128 v[56:59], v2 offset:2048
ds_read_b128 v[60:63], v2 offset:3072
ds_read_b128 v[64:67], v2 offset:4096
ds_read_b128 v[68:71], v2 offset:5120
s_waitcnt vmcnt(38)
s_waitcnt lgkmcnt(4)
v_mfma_f32_16x16x32_bf16 v[80:83], v[48:51], a[0:3], 0
s_add_u32 s48, s20, 8192
buffer_load_dwordx4 a[160:163], v2, s[8:11], s48 offen offset:2048
v_mfma_f32_16x16x32_bf16 v[80:83], v[52:55], a[16:19], v[80:83]
buffer_load_dwordx4 a[164:167], v4, s[8:11], s48 offen offset:2048
buffer_load_dwordx4 a[168:171], v5, s[8:11], s48 offen offset:2048
v_mfma_f32_16x16x32_bf16 v[84:87], v[48:51], a[4:7], 0
ds_read_b128 v[72:75], v2 offset:6144
buffer_load_dwordx4 a[172:175], v6, s[8:11], s48 offen offset:2048
buffer_load_dwordx4 a[176:179], v2, s[8:11], s48 offen offset:3072
v_mfma_f32_16x16x32_bf16 v[84:87], v[52:55], a[20:23], v[84:87]
buffer_load_dwordx4 a[180:183], v4, s[8:11], s48 offen offset:3072
buffer_load_dwordx4 a[184:187], v5, s[8:11], s48 offen offset:3072
v_mfma_f32_16x16x32_bf16 v[88:91], v[48:51], a[8:11], 0
buffer_load_dwordx4 a[188:191], v6, s[8:11], s48 offen offset:3072
s_add_u32 s48, s20, 12288
v_mfma_f32_16x16x32_bf16 v[88:91], v[52:55], a[24:27], v[88:91]
buffer_load_dwordx4 a[192:195], v2, s[8:11], s48 offen offset:0
buffer_load_dwordx4 a[196:199], v4, s[8:11], s48 offen offset:0
v_mfma_f32_16x16x32_bf16 v[92:95], v[48:51], a[12:15], 0
ds_read_b128 v[76:79], v2 offset:7168
buffer_load_dwordx4 a[200:203], v5, s[8:11], s48 offen offset:0
buffer_load_dwordx4 a[204:207], v6, s[8:11], s48 offen offset:0
v_mfma_f32_16x16x32_bf16 v[92:95], v[52:55], a[28:31], v[92:95]
buffer_load_dwordx4 a[208:211], v2, s[8:11], s48 offen offset:1024
buffer_load_dwordx4 a[212:215], v4, s[8:11], s48 offen offset:1024
s_waitcnt lgkmcnt(4)
v_mfma_f32_16x16x32_bf16 v[96:99], v[56:59], a[0:3], 0
buffer_load_dwordx4 a[216:219], v5, s[8:11], s48 offen offset:1024
buffer_load_dwordx4 a[220:223], v6, s[8:11], s48 offen offset:1024
v_mfma_f32_16x16x32_bf16 v[96:99], v[60:63], a[16:19], v[96:99]
buffer_load_dwordx4 a[224:227], v2, s[8:11], s48 offen offset:2048
buffer_load_dwordx4 a[228:231], v4, s[8:11], s48 offen offset:2048
v_mfma_f32_16x16x32_bf16 v[100:103], v[56:59], a[4:7], 0
ds_read_b128 v[48:51], v2 offset:8192
buffer_load_dwordx4 a[232:235], v5, s[8:11], s48 offen offset:2048
buffer_load_dwordx4 a[236:239], v6, s[8:11], s48 offen offset:2048
v_mfma_f32_16x16x32_bf16 v[100:103], v[60:63], a[20:23], v[100:103]
buffer_load_dwordx4 a[240:243], v2, s[8:11], s48 offen offset:3072
buffer_load_dwordx4 a[244:247], v4, s[8:11], s48 offen offset:3072
v_mfma_f32_16x16x32_bf16 v[104:107], v[56:59], a[8:11], 0
buffer_load_dwordx4 a[248:251], v5, s[8:11], s48 offen offset:3072
buffer_load_dwordx4 a[252:255], v6, s[8:11], s48 offen offset:3072
v_mfma_f32_16x16x32_bf16 v[104:107], v[60:63], a[24:27], v[104:107]
s_add_u32 s48, s20, 16384
buffer_load_dwordx4 v[16:19], v2, s[8:11], s48 offen offset:0
v_mfma_f32_16x16x32_bf16 v[108:111], v[56:59], a[12:15], 0
ds_read_b128 v[52:55], v2 offset:9216
buffer_load_dwordx4 v[20:23], v4, s[8:11], s48 offen offset:0
buffer_load_dwordx4 v[24:27], v5, s[8:11], s48 offen offset:0
v_mfma_f32_16x16x32_bf16 v[108:111], v[60:63], a[28:31], v[108:111]
buffer_load_dwordx4 v[28:31], v6, s[8:11], s48 offen offset:0
buffer_load_dwordx4 v[32:35], v2, s[8:11], s48 offen offset:1024
s_waitcnt vmcnt(59)
s_waitcnt lgkmcnt(4)
v_mfma_f32_16x16x32_bf16 v[80:83], v[64:67], a[32:35], v[80:83]
buffer_load_dwordx4 v[36:39], v4, s[8:11], s48 offen offset:1024
buffer_load_dwordx4 v[40:43], v5, s[8:11], s48 offen offset:1024
v_mfma_f32_16x16x32_bf16 v[80:83], v[68:71], a[48:51], v[80:83]
buffer_load_dwordx4 v[44:47], v6, s[8:11], s48 offen offset:1024
s_add_u32 m0, s22, 49152
v_mfma_f32_16x16x32_bf16 v[84:87], v[64:67], a[36:39], v[84:87]
ds_read_b128 v[56:59], v2 offset:10240
s_add_u32 s23, s21, 49152
buffer_load_dwordx4 v2, s[8:11], s23 offen offset:0 lds
v_mfma_f32_16x16x32_bf16 v[84:87], v[68:71], a[52:55], v[84:87]
buffer_load_dwordx4 v2, s[8:11], s23 offen offset:1024 lds
buffer_load_dwordx4 v2, s[8:11], s23 offen offset:2048 lds
v_mfma_f32_16x16x32_bf16 v[88:91], v[64:67], a[40:43], v[88:91]
buffer_load_dwordx4 v2, s[8:11], s23 offen offset:3072 lds
s_add_u32 m0, s22, 53248
v_mfma_f32_16x16x32_bf16 v[88:91], v[68:71], a[56:59], v[88:91]
s_add_u32 s23, s21, 53248
buffer_load_dwordx4 v2, s[8:11], s23 offen offset:0 lds
v_mfma_f32_16x16x32_bf16 v[92:95], v[64:67], a[44:47], v[92:95]
ds_read_b128 v[60:63], v2 offset:11264
buffer_load_dwordx4 v2, s[8:11], s23 offen offset:1024 lds
s_add_u32 m0, s22, 73728
v_mfma_f32_16x16x32_bf16 v[92:95], v[68:71], a[60:63], v[92:95]
s_add_u32 s23, s21, 73728
buffer_load_dwordx4 v2, s[8:11], s23 offen offset:0 lds
s_waitcnt lgkmcnt(4)
v_mfma_f32_16x16x32_bf16 v[96:99], v[72:75], a[32:35], v[96:99]
buffer_load_dwordx4 v2, s[8:11], s23 offen offset:1024 lds
buffer_load_dwordx4 v2, s[8:11], s23 offen offset:2048 lds
v_mfma_f32_16x16x32_bf16 v[96:99], v[76:79], a[48:51], v[96:99]
buffer_load_dwordx4 v2, s[8:11], s23 offen offset:3072 lds
s_add_u32 m0, s22, 77824
v_mfma_f32_16x16x32_bf16 v[100:103], v[72:75], a[36:39], v[100:103]
ds_read_b128 v[64:67], v2 offset:12288
s_add_u32 s23, s21, 77824
buffer_load_dwordx4 v2, s[8:11], s23 offen offset:0 lds
v_mfma_f32_16x16x32_bf16 v[100:103], v[76:79], a[52:55], v[100:103]
buffer_load_dwordx4 v2, s[8:11], s23 offen offset:1024 lds
s_add_u32 m0, s22, 98304
v_mfma_f32_16x16x32_bf16 v[104:107], v[72:75], a[40:43], v[104:107]
s_add_u32 s23, s21, 98304
buffer_load_dwordx4 v2, s[8:11], s23 offen offset:0 lds
v_mfma_f32_16x16x32_bf16 v[104:107], v[76:79], a[56:59], v[104:107]
buffer_load_dwordx4 v2, s[8:11], s23 offen offset:1024 lds
buffer_load_dwordx4 v2, s[8:11], s23 offen offset:2048 lds
v_mfma_f32_16x16x32_bf16 v[108:111], v[72:75], a[44:47], v[108:111]
ds_read_b128 v[68:71], v2 offset:13312
buffer_load_dwordx4 v2, s[8:11], s23 offen offset:3072 lds
s_add_u32 m0, s22, 102400
v_mfma_f32_16x16x32_bf16 v[108:111], v[76:79], a[60:63], v[108:111]
s_add_u32 s23, s21, 102400
buffer_load_dwordx4 v2, s[8:11], s23 offen offset:0 lds
s_waitcnt vmcnt(63)
s_waitcnt lgkmcnt(4)
v_mfma_f32_16x16x32_bf16 v[80:83], v[48:51], a[64:67], v[80:83]
buffer_load_dwordx4 v2, s[8:11], s23 offen offset:1024 lds
v_mfma_f32_16x16x32_bf16 v[80:83], v[52:55], a[80:83], v[80:83]
v_mfma_f32_16x16x32_bf16 v[84:87], v[48:51], a[68:71], v[84:87]
ds_read_b128 v[72:75], v2 offset:14336
v_mfma_f32_16x16x32_bf16 v[84:87], v[52:55], a[84:87], v[84:87]
v_mfma_f32_16x16x32_bf16 v[88:91], v[48:51], a[72:75], v[88:91]
v_mfma_f32_16x16x32_bf16 v[88:91], v[52:55], a[88:91], v[88:91]
v_mfma_f32_16x16x32_bf16 v[92:95], v[48:51], a[76:79], v[92:95]
ds_read_b128 v[76:79], v2 offset:15360
v_mfma_f32_16x16x32_bf16 v[92:95], v[52:55], a[92:95], v[92:95]
s_waitcnt lgkmcnt(4)
v_mfma_f32_16x16x32_bf16 v[96:99], v[56:59], a[64:67], v[96:99]
v_mfma_f32_16x16x32_bf16 v[96:99], v[60:63], a[80:83], v[96:99]
v_mfma_f32_16x16x32_bf16 v[100:103], v[56:59], a[68:71], v[100:103]
ds_read_b128 v[48:51], v2 offset:16384
v_mfma_f32_16x16x32_bf16 v[100:103], v[60:63], a[84:87], v[100:103]
v_mfma_f32_16x16x32_bf16 v[104:107], v[56:59], a[72:75], v[104:107]
v_mfma_f32_16x16x32_bf16 v[104:107], v[60:63], a[88:91], v[104:107]
v_mfma_f32_16x16x32_bf16 v[108:111], v[56:59], a[76:79], v[108:111]
ds_read_b128 v[52:55], v2 offset:17408
v_mfma_f32_16x16x32_bf16 v[108:111], v[60:63], a[92:95], v[108:111]
s_waitcnt vmcnt(58)
s_waitcnt lgkmcnt(4)
v_mfma_f32_16x16x32_bf16 v[80:83], v[64:67], a[96:99], v[80:83]
v_mfma_f32_16x16x32_bf16 v[80:83], v[68:71], a[112:115], v[80:83]
v_mfma_f32_16x16x32_bf16 v[84:87], v[64:67], a[100:103], v[84:87]
ds_read_b128 v[56:59], v2 offset:18432
v_mfma_f32_16x16x32_bf16 v[84:87], v[68:71], a[116:119], v[84:87]
v_mfma_f32_16x16x32_bf16 v[88:91], v[64:67], a[104:107], v[88:91]
v_mfma_f32_16x16x32_bf16 v[88:91], v[68:71], a[120:123], v[88:91]
v_mfma_f32_16x16x32_bf16 v[92:95], v[64:67], a[108:111], v[92:95]
ds_read_b128 v[60:63], v2 offset:19456
v_mfma_f32_16x16x32_bf16 v[92:95], v[68:71], a[124:127], v[92:95]
s_waitcnt lgkmcnt(4)
v_mfma_f32_16x16x32_bf16 v[96:99], v[72:75], a[96:99], v[96:99]
v_mfma_f32_16x16x32_bf16 v[96:99], v[76:79], a[112:115], v[96:99]
v_mfma_f32_16x16x32_bf16 v[100:103], v[72:75], a[100:103], v[100:103]
ds_read_b128 v[64:67], v2 offset:20480
v_mfma_f32_16x16x32_bf16 v[100:103], v[76:79], a[116:119], v[100:103]
v_mfma_f32_16x16x32_bf16 v[104:107], v[72:75], a[104:107], v[104:107]
v_mfma_f32_16x16x32_bf16 v[104:107], v[76:79], a[120:123], v[104:107]
v_mfma_f32_16x16x32_bf16 v[108:111], v[72:75], a[108:111], v[108:111]
ds_read_b128 v[68:71], v2 offset:21504
v_mfma_f32_16x16x32_bf16 v[108:111], v[76:79], a[124:127], v[108:111]
s_waitcnt vmcnt(50)
s_waitcnt lgkmcnt(4)
v_mfma_f32_16x16x32_bf16 v[80:83], v[48:51], a[128:131], v[80:83]
v_mfma_f32_16x16x32_bf16 v[80:83], v[52:55], a[144:147], v[80:83]
v_mfma_f32_16x16x32_bf16 v[84:87], v[48:51], a[132:135], v[84:87]
ds_read_b128 v[72:75], v2 offset:22528
v_mfma_f32_16x16x32_bf16 v[84:87], v[52:55], a[148:151], v[84:87]
v_mfma_f32_16x16x32_bf16 v[88:91], v[48:51], a[136:139], v[88:91]
v_mfma_f32_16x16x32_bf16 v[88:91], v[52:55], a[152:155], v[88:91]
v_mfma_f32_16x16x32_bf16 v[92:95], v[48:51], a[140:143], v[92:95]
ds_read_b128 v[76:79], v2 offset:23552
v_mfma_f32_16x16x32_bf16 v[92:95], v[52:55], a[156:159], v[92:95]
s_waitcnt lgkmcnt(4)
v_mfma_f32_16x16x32_bf16 v[96:99], v[56:59], a[128:131], v[96:99]
v_mfma_f32_16x16x32_bf16 v[96:99], v[60:63], a[144:147], v[96:99]
v_mfma_f32_16x16x32_bf16 v[100:103], v[56:59], a[132:135], v[100:103]
s_waitcnt vmcnt(63)
s_barrier
ds_read_b128 v[48:51], v2 offset:24576
v_mfma_f32_16x16x32_bf16 v[100:103], v[60:63], a[148:151], v[100:103]
s_add_u32 m0, s22, 122880
v_mfma_f32_16x16x32_bf16 v[104:107], v[56:59], a[136:139], v[104:107]
v_mfma_f32_16x16x32_bf16 v[104:107], v[60:63], a[152:155], v[104:107]
s_add_u32 s23, s21, 122880
v_mfma_f32_16x16x32_bf16 v[108:111], v[56:59], a[140:143], v[108:111]
ds_read_b128 v[52:55], v2 offset:25600
v_mfma_f32_16x16x32_bf16 v[108:111], v[60:63], a[156:159], v[108:111]
buffer_load_dwordx4 v2, s[8:11], s23 offen offset:0 lds
s_waitcnt vmcnt(43)
s_waitcnt lgkmcnt(4)
v_mfma_f32_16x16x32_bf16 v[80:83], v[64:67], a[160:163], v[80:83]
v_mfma_f32_16x16x32_bf16 v[80:83], v[68:71], a[176:179], v[80:83]
buffer_load_dwordx4 v2, s[8:11], s23 offen offset:1024 lds
v_mfma_f32_16x16x32_bf16 v[84:87], v[64:67], a[164:167], v[84:87]
ds_read_b128 v[56:59], v2 offset:26624
v_mfma_f32_16x16x32_bf16 v[84:87], v[68:71], a[180:183], v[84:87]
buffer_load_dwordx4 v2, s[8:11], s23 offen offset:2048 lds
v_mfma_f32_16x16x32_bf16 v[88:91], v[64:67], a[168:171], v[88:91]
v_mfma_f32_16x16x32_bf16 v[88:91], v[68:71], a[184:187], v[88:91]
buffer_load_dwordx4 v2, s[8:11], s23 offen offset:3072 lds
v_mfma_f32_16x16x32_bf16 v[92:95], v[64:67], a[172:175], v[92:95]
ds_read_b128 v[60:63], v2 offset:27648
v_mfma_f32_16x16x32_bf16 v[92:95], v[68:71], a[188:191], v[92:95]
s_add_u32 m0, s22, 126976
s_waitcnt lgkmcnt(4)
v_mfma_f32_16x16x32_bf16 v[96:99], v[72:75], a[160:163], v[96:99]
v_mfma_f32_16x16x32_bf16 v[96:99], v[76:79], a[176:179], v[96:99]
s_add_u32 s23, s21, 126976
v_mfma_f32_16x16x32_bf16 v[100:103], v[72:75], a[164:167], v[100:103]
ds_read_b128 v[64:67], v2 offset:28672
v_mfma_f32_16x16x32_bf16 v[100:103], v[76:79], a[180:183], v[100:103]
buffer_load_dwordx4 v2, s[8:11], s23 offen offset:0 lds
v_mfma_f32_16x16x32_bf16 v[104:107], v[72:75], a[168:171], v[104:107]
v_mfma_f32_16x16x32_bf16 v[104:107], v[76:79], a[184:187], v[104:107]
buffer_load_dwordx4 v2, s[8:11], s23 offen offset:1024 lds
v_mfma_f32_16x16x32_bf16 v[108:111], v[72:75], a[172:175], v[108:111]
ds_read_b128 v[68:71], v2 offset:29696
v_mfma_f32_16x16x32_bf16 v[108:111], v[76:79], a[188:191], v[108:111]
s_waitcnt vmcnt(40)
s_waitcnt lgkmcnt(4)
v_mfma_f32_16x16x32_bf16 v[80:83], v[48:51], a[192:195], v[80:83]
v_mfma_f32_16x16x32_bf16 v[80:83], v[52:55], a[208:211], v[80:83]
v_mfma_f32_16x16x32_bf16 v[84:87], v[48:51], a[196:199], v[84:87]
ds_read_b128 v[72:75], v2 offset:30720
v_mfma_f32_16x16x32_bf16 v[84:87], v[52:55], a[212:215], v[84:87]
v_mfma_f32_16x16x32_bf16 v[88:91], v[48:51], a[200:203], v[88:91]
v_mfma_f32_16x16x32_bf16 v[88:91], v[52:55], a[216:219], v[88:91]
v_mfma_f32_16x16x32_bf16 v[92:95], v[48:51], a[204:207], v[92:95]
ds_read_b128 v[76:79], v2 offset:31744
v_mfma_f32_16x16x32_bf16 v[92:95], v[52:55], a[220:223], v[92:95]
s_waitcnt lgkmcnt(4)
v_mfma_f32_16x16x32_bf16 v[96:99], v[56:59], a[192:195], v[96:99]
v_mfma_f32_16x16x32_bf16 v[96:99], v[60:63], a[208:211], v[96:99]
v_mfma_f32_16x16x32_bf16 v[100:103], v[56:59], a[196:199], v[100:103]
ds_read_b128 v[48:51], v2 offset:32768
v_mfma_f32_16x16x32_bf16 v[100:103], v[60:63], a[212:215], v[100:103]
v_mfma_f32_16x16x32_bf16 v[104:107], v[56:59], a[200:203], v[104:107]
v_mfma_f32_16x16x32_bf16 v[104:107], v[60:63], a[216:219], v[104:107]
v_mfma_f32_16x16x32_bf16 v[108:111], v[56:59], a[204:207], v[108:111]
ds_read_b128 v[52:55], v2 offset:33792
v_mfma_f32_16x16x32_bf16 v[108:111], v[60:63], a[220:223], v[108:111]
s_waitcnt vmcnt(32)
s_waitcnt lgkmcnt(4)
v_mfma_f32_16x16x32_bf16 v[80:83], v[64:67], a[224:227], v[80:83]
v_mfma_f32_16x16x32_bf16 v[80:83], v[68:71], a[240:243], v[80:83]
v_mfma_f32_16x16x32_bf16 v[84:87], v[64:67], a[228:231], v[84:87]
ds_read_b128 v[56:59], v2 offset:34816
v_mfma_f32_16x16x32_bf16 v[84:87], v[68:71], a[244:247], v[84:87]
v_mfma_f32_16x16x32_bf16 v[88:91], v[64:67], a[232:235], v[88:91]
v_mfma_f32_16x16x32_bf16 v[88:91], v[68:71], a[248:251], v[88:91]
v_mfma_f32_16x16x32_bf16 v[92:95], v[64:67], a[236:239], v[92:95]
ds_read_b128 v[60:63], v2 offset:35840
v_mfma_f32_16x16x32_bf16 v[92:95], v[68:71], a[252:255], v[92:95]
s_waitcnt lgkmcnt(4)
v_mfma_f32_16x16x32_bf16 v[96:99], v[72:75], a[224:227], v[96:99]
v_mfma_f32_16x16x32_bf16 v[96:99], v[76:79], a[240:243], v[96:99]
v_mfma_f32_16x16x32_bf16 v[100:103], v[72:75], a[228:231], v[100:103]
ds_read_b128 v[64:67], v2 offset:36864
v_mfma_f32_16x16x32_bf16 v[100:103], v[76:79], a[244:247], v[100:103]
v_mfma_f32_16x16x32_bf16 v[104:107], v[72:75], a[232:235], v[104:107]
v_mfma_f32_16x16x32_bf16 v[104:107], v[76:79], a[248:251], v[104:107]
v_mfma_f32_16x16x32_bf16 v[108:111], v[72:75], a[236:239], v[108:111]
ds_read_b128 v[68:71], v2 offset:37888
v_mfma_f32_16x16x32_bf16 v[108:111], v[76:79], a[252:255], v[108:111]
s_waitcnt vmcnt(24)
s_waitcnt lgkmcnt(4)
v_mfma_f32_16x16x32_bf16 v[80:83], v[48:51], v[16:19], v[80:83]
v_mfma_f32_16x16x32_bf16 v[80:83], v[52:55], v[32:35], v[80:83]
v_mfma_f32_16x16x32_bf16 v[84:87], v[48:51], v[20:23], v[84:87]
ds_read_b128 v[72:75], v2 offset:38912
v_mfma_f32_16x16x32_bf16 v[84:87], v[52:55], v[36:39], v[84:87]
v_mfma_f32_16x16x32_bf16 v[88:91], v[48:51], v[24:27], v[88:91]
v_mfma_f32_16x16x32_bf16 v[88:91], v[52:55], v[40:43], v[88:91]
v_mfma_f32_16x16x32_bf16 v[92:95], v[48:51], v[28:31], v[92:95]
ds_read_b128 v[76:79], v2 offset:39936
v_mfma_f32_16x16x32_bf16 v[92:95], v[52:55], v[44:47], v[92:95]
s_waitcnt lgkmcnt(4)
v_mfma_f32_16x16x32_bf16 v[96:99], v[56:59], v[16:19], v[96:99]
v_mfma_f32_16x16x32_bf16 v[96:99], v[60:63], v[32:35], v[96:99]
v_mfma_f32_16x16x32_bf16 v[100:103], v[56:59], v[20:23], v[100:103]
ds_read_b128 v[48:51], v2 offset:40960
v_mfma_f32_16x16x32_bf16 v[100:103], v[60:63], v[36:39], v[100:103]
v_mfma_f32_16x16x32_bf16 v[104:107], v[56:59], v[24:27], v[104:107]
v_mfma_f32_16x16x32_bf16 v[104:107], v[60:63], v[40:43], v[104:107]
v_mfma_f32_16x16x32_bf16 v[108:111], v[56:59], v[28:31], v[108:111]
ds_read_b128 v[52:55], v2 offset:41984
v_mfma_f32_16x16x32_bf16 v[108:111], v[60:63], v[44:47], v[108:111]
s_waitcnt lgkmcnt(4)
v_mfma_f32_16x16x32_bf16 v[112:115], v[64:67], a[0:3], 0
v_mfma_f32_16x16x32_bf16 v[112:115], v[68:71], a[16:19], v[112:115]
v_mfma_f32_16x16x32_bf16 v[116:119], v[64:67], a[4:7], 0
ds_read_b128 v[56:59], v2 offset:43008
v_mfma_f32_16x16x32_bf16 v[116:119], v[68:71], a[20:23], v[116:119]
v_mul_f32 v208, v80, v80
v_mfma_f32_16x16x32_bf16 v[120:123], v[64:67], a[8:11], 0
v_mul_f32 v210, v81, v81
v_fma_f32 v208, v208, v233, v232
v_mfma_f32_16x16x32_bf16 v[120:123], v[68:71], a[24:27], v[120:123]
v_fma_f32 v210, v210, v233, v232
v_mfma_f32_16x16x32_bf16 v[124:127], v[64:67], a[12:15], 0
ds_read_b128 v[60:63], v2 offset:44032
v_mul_f32 v208, v208, v80
v_mfma_f32_16x16x32_bf16 v[124:127], v[68:71], a[28:31], v[124:127]
v_mul_f32 v210, v210, v81
s_waitcnt lgkmcnt(4)
v_mfma_f32_16x16x32_bf16 v[128:131], v[72:75], a[0:3], 0
v_exp_f32 v208, v208
v_mfma_f32_16x16x32_bf16 v[128:131], v[76:79], a[16:19], v[128:131]
v_mfma_f32_16x16x32_bf16 v[132:135], v[72:75], a[4:7], 0
ds_read_b128 v[64:67], v2 offset:45056
v_mfma_f32_16x16x32_bf16 v[132:135], v[76:79], a[20:23], v[132:135]
v_exp_f32 v210, v210
v_mfma_f32_16x16x32_bf16 v[136:139], v[72:75], a[8:11], 0
v_mul_f32 v209, v80, v96
v_mul_f32 v211, v81, v97
v_mfma_f32_16x16x32_bf16 v[136:139], v[76:79], a[24:27], v[136:139]
v_fma_f32 v208, v208, v234, v234
v_fma_f32 v210, v210, v234, v234
v_mfma_f32_16x16x32_bf16 v[140:143], v[72:75], a[12:15], 0
ds_read_b128 v[68:71], v2 offset:46080
v_mfma_f32_16x16x32_bf16 v[140:143], v[76:79], a[28:31], v[140:143]
s_waitcnt lgkmcnt(4)
v_mfma_f32_16x16x32_bf16 v[112:115], v[48:51], a[32:35], v[112:115]
v_rcp_f32 v208, v208
v_mfma_f32_16x16x32_bf16 v[112:115], v[52:55], a[48:51], v[112:115]
v_rcp_f32 v210, v210
v_mfma_f32_16x16x32_bf16 v[116:119], v[48:51], a[36:39], v[116:119]
ds_read_b128 v[72:75], v2 offset:47104
v_mul_f32 v209, v209, v208
v_mfma_f32_16x16x32_bf16 v[116:119], v[52:55], a[52:55], v[116:119]
v_mul_f32 v211, v211, v210
v_cvt_pk_bf16_f32 v224, v209, v211
v_mfma_f32_16x16x32_bf16 v[120:123], v[48:51], a[40:43], v[120:123]
v_mul_f32 v212, v82, v82
v_mul_f32 v214, v83, v83
v_mfma_f32_16x16x32_bf16 v[120:123], v[52:55], a[56:59], v[120:123]
v_fma_f32 v212, v212, v233, v232
v_mfma_f32_16x16x32_bf16 v[124:127], v[48:51], a[44:47], v[124:127]
ds_read_b128 v[76:79], v2 offset:48128
v_fma_f32 v214, v214, v233, v232
v_mfma_f32_16x16x32_bf16 v[124:127], v[52:55], a[60:63], v[124:127]
v_mul_f32 v212, v212, v82
s_waitcnt lgkmcnt(4)
v_mfma_f32_16x16x32_bf16 v[128:131], v[56:59], a[32:35], v[128:131]
v_mul_f32 v214, v214, v83
v_mfma_f32_16x16x32_bf16 v[128:131], v[60:63], a[48:51], v[128:131]
v_exp_f32 v212, v212
v_mfma_f32_16x16x32_bf16 v[132:135], v[56:59], a[36:39], v[132:135]
s_waitcnt vmcnt(18)
s_barrier
ds_read_b128 v[48:51], v2 offset:49152
v_mfma_f32_16x16x32_bf16 v[132:135], v[60:63], a[52:55], v[132:135]
s_add_u32 m0, s22, 0
v_mfma_f32_16x16x32_bf16 v[136:139], v[56:59], a[40:43], v[136:139]
v_exp_f32 v214, v214
v_mfma_f32_16x16x32_bf16 v[136:139], v[60:63], a[56:59], v[136:139]
s_add_u32 s23, s21, 147456
v_mul_f32 v213, v82, v98
v_mfma_f32_16x16x32_bf16 v[140:143], v[56:59], a[44:47], v[140:143]
ds_read_b128 v[52:55], v2 offset:50176
v_mul_f32 v215, v83, v99
v_mfma_f32_16x16x32_bf16 v[140:143], v[60:63], a[60:63], v[140:143]
buffer_load_dwordx4 v2, s[8:11], s23 offen offset:0 lds
v_fma_f32 v212, v212, v234, v234
s_waitcnt lgkmcnt(4)
v_mfma_f32_16x16x32_bf16 v[112:115], v[64:67], a[64:67], v[112:115]
v_fma_f32 v214, v214, v234, v234
v_mfma_f32_16x16x32_bf16 v[112:115], v[68:71], a[80:83], v[112:115]
buffer_load_dwordx4 v2, s[8:11], s23 offen offset:1024 lds
v_rcp_f32 v212, v212
v_mfma_f32_16x16x32_bf16 v[116:119], v[64:67], a[68:71], v[116:119]
ds_read_b128 v[56:59], v2 offset:51200
v_rcp_f32 v214, v214
v_mfma_f32_16x16x32_bf16 v[116:119], v[68:71], a[84:87], v[116:119]
buffer_load_dwordx4 v2, s[8:11], s23 offen offset:2048 lds
v_mul_f32 v213, v213, v212
v_mfma_f32_16x16x32_bf16 v[120:123], v[64:67], a[72:75], v[120:123]
v_mul_f32 v215, v215, v214
v_cvt_pk_bf16_f32 v225, v213, v215
v_mfma_f32_16x16x32_bf16 v[120:123], v[68:71], a[88:91], v[120:123]
buffer_load_dwordx4 v2, s[8:11], s23 offen offset:3072 lds
buffer_store_dwordx2 v[224:225], v2, s[8:11], s30 offen sc1
v_mfma_f32_16x16x32_bf16 v[124:127], v[64:67], a[76:79], v[124:127]
ds_read_b128 v[60:63], v2 offset:52224
v_mul_f32 v208, v84, v84
v_mfma_f32_16x16x32_bf16 v[124:127], v[68:71], a[92:95], v[124:127]
s_add_u32 m0, s22, 4096
s_waitcnt lgkmcnt(4)
v_mfma_f32_16x16x32_bf16 v[128:131], v[72:75], a[64:67], v[128:131]
v_mul_f32 v210, v85, v85
v_fma_f32 v208, v208, v236, v235
v_mfma_f32_16x16x32_bf16 v[128:131], v[76:79], a[80:83], v[128:131]
s_add_u32 s23, s21, 151552
v_fma_f32 v210, v210, v236, v235
v_mfma_f32_16x16x32_bf16 v[132:135], v[72:75], a[68:71], v[132:135]
ds_read_b128 v[64:67], v2 offset:53248
v_mul_f32 v208, v208, v84
v_mfma_f32_16x16x32_bf16 v[132:135], v[76:79], a[84:87], v[132:135]
buffer_load_dwordx4 v2, s[8:11], s23 offen offset:0 lds
v_mul_f32 v210, v210, v85
v_mfma_f32_16x16x32_bf16 v[136:139], v[72:75], a[72:75], v[136:139]
v_exp_f32 v208, v208
v_mfma_f32_16x16x32_bf16 v[136:139], v[76:79], a[88:91], v[136:139]
buffer_load_dwordx4 v2, s[8:11], s23 offen offset:1024 lds
v_exp_f32 v210, v210
v_mfma_f32_16x16x32_bf16 v[140:143], v[72:75], a[76:79], v[140:143]
ds_read_b128 v[68:71], v2 offset:54272
v_mul_f32 v209, v84, v100
v_mfma_f32_16x16x32_bf16 v[140:143], v[76:79], a[92:95], v[140:143]
v_mul_f32 v211, v85, v101
s_waitcnt lgkmcnt(4)
v_mfma_f32_16x16x32_bf16 v[112:115], v[48:51], a[96:99], v[112:115]
v_fma_f32 v208, v208, v237, v237
v_fma_f32 v210, v210, v237, v237
v_mfma_f32_16x16x32_bf16 v[112:115], v[52:55], a[112:115], v[112:115]
v_rcp_f32 v208, v208
v_mfma_f32_16x16x32_bf16 v[116:119], v[48:51], a[100:103], v[116:119]
ds_read_b128 v[72:75], v2 offset:55296
v_mfma_f32_16x16x32_bf16 v[116:119], v[52:55], a[116:119], v[116:119]
v_rcp_f32 v210, v210
v_mfma_f32_16x16x32_bf16 v[120:123], v[48:51], a[104:107], v[120:123]
v_mul_f32 v209, v209, v208
v_mul_f32 v211, v211, v210
v_mfma_f32_16x16x32_bf16 v[120:123], v[52:55], a[120:123], v[120:123]
v_cvt_pk_bf16_f32 v226, v209, v211
v_mfma_f32_16x16x32_bf16 v[124:127], v[48:51], a[108:111], v[124:127]
ds_read_b128 v[76:79], v2 offset:56320
v_mul_f32 v212, v86, v86
v_mfma_f32_16x16x32_bf16 v[124:127], v[52:55], a[124:127], v[124:127]
v_mul_f32 v214, v87, v87
s_waitcnt lgkmcnt(4)
v_mfma_f32_16x16x32_bf16 v[128:131], v[56:59], a[96:99], v[128:131]
v_fma_f32 v212, v212, v236, v235
v_fma_f32 v214, v214, v236, v235
v_mfma_f32_16x16x32_bf16 v[128:131], v[60:63], a[112:115], v[128:131]
v_mul_f32 v212, v212, v86
v_mul_f32 v214, v214, v87
v_mfma_f32_16x16x32_bf16 v[132:135], v[56:59], a[100:103], v[132:135]
ds_read_b128 v[48:51], v2 offset:57344
v_mfma_f32_16x16x32_bf16 v[132:135], v[60:63], a[116:119], v[132:135]
v_exp_f32 v212, v212
v_mfma_f32_16x16x32_bf16 v[136:139], v[56:59], a[104:107], v[136:139]
v_mfma_f32_16x16x32_bf16 v[136:139], v[60:63], a[120:123], v[136:139]
v_exp_f32 v214, v214
v_mfma_f32_16x16x32_bf16 v[140:143], v[56:59], a[108:111], v[140:143]
ds_read_b128 v[52:55], v2 offset:58368
v_mul_f32 v213, v86, v102
v_mfma_f32_16x16x32_bf16 v[140:143], v[60:63], a[124:127], v[140:143]
v_mul_f32 v215, v87, v103
s_waitcnt lgkmcnt(4)
v_mfma_f32_16x16x32_bf16 v[112:115], v[64:67], a[128:131], v[112:115]
v_fma_f32 v212, v212, v237, v237
v_fma_f32 v214, v214, v237, v237
v_mfma_f32_16x16x32_bf16 v[112:115], v[68:71], a[144:147], v[112:115]
v_rcp_f32 v212, v212
v_mfma_f32_16x16x32_bf16 v[116:119], v[64:67], a[132:135], v[116:119]
ds_read_b128 v[56:59], v2 offset:59392
v_mfma_f32_16x16x32_bf16 v[116:119], v[68:71], a[148:151], v[116:119]
v_rcp_f32 v214, v214
v_mfma_f32_16x16x32_bf16 v[120:123], v[64:67], a[136:139], v[120:123]
v_mul_f32 v213, v213, v212
v_mfma_f32_16x16x32_bf16 v[120:123], v[68:71], a[152:155], v[120:123]
v_mul_f32 v215, v215, v214
v_cvt_pk_bf16_f32 v227, v213, v215
v_mfma_f32_16x16x32_bf16 v[124:127], v[64:67], a[140:143], v[124:127]
ds_read_b128 v[60:63], v2 offset:60416
buffer_store_dwordx2 v[226:227], v4, s[8:11], s30 offen sc1
v_mfma_f32_16x16x32_bf16 v[124:127], v[68:71], a[156:159], v[124:127]
v_mul_f32 v208, v88, v88
s_waitcnt lgkmcnt(4)
v_mfma_f32_16x16x32_bf16 v[128:131], v[72:75], a[128:131], v[128:131]
v_mul_f32 v210, v89, v89
v_fma_f32 v208, v208, v239, v238
v_mfma_f32_16x16x32_bf16 v[128:131], v[76:79], a[144:147], v[128:131]
v_fma_f32 v210, v210, v239, v238
v_mfma_f32_16x16x32_bf16 v[132:135], v[72:75], a[132:135], v[132:135]
ds_read_b128 v[64:67], v2 offset:61440
v_mul_f32 v208, v208, v88
v_mfma_f32_16x16x32_bf16 v[132:135], v[76:79], a[148:151], v[132:135]
v_mul_f32 v210, v210, v89
v_mfma_f32_16x16x32_bf16 v[136:139], v[72:75], a[136:139], v[136:139]
v_exp_f32 v208, v208
v_mfma_f32_16x16x32_bf16 v[136:139], v[76:79], a[152:155], v[136:139]
v_mfma_f32_16x16x32_bf16 v[140:143], v[72:75], a[140:143], v[140:143]
ds_read_b128 v[68:71], v2 offset:62464
v_mfma_f32_16x16x32_bf16 v[140:143], v[76:79], a[156:159], v[140:143]
v_exp_f32 v210, v210
s_waitcnt lgkmcnt(4)
v_mfma_f32_16x16x32_bf16 v[112:115], v[48:51], a[160:163], v[112:115]
v_mul_f32 v209, v88, v104
v_mul_f32 v211, v89, v105
v_mfma_f32_16x16x32_bf16 v[112:115], v[52:55], a[176:179], v[112:115]
v_fma_f32 v208, v208, v240, v240
v_fma_f32 v210, v210, v240, v240
v_mfma_f32_16x16x32_bf16 v[116:119], v[48:51], a[164:167], v[116:119]
ds_read_b128 v[72:75], v2 offset:63488
v_mfma_f32_16x16x32_bf16 v[116:119], v[52:55], a[180:183], v[116:119]
v_rcp_f32 v208, v208
v_mfma_f32_16x16x32_bf16 v[120:123], v[48:51], a[168:171], v[120:123]
v_rcp_f32 v210, v210
v_mfma_f32_16x16x32_bf16 v[120:123], v[52:55], a[184:187], v[120:123]
v_mul_f32 v209, v209, v208
v_mfma_f32_16x16x32_bf16 v[124:127], v[48:51], a[172:175], v[124:127]
ds_read_b128 v[76:79], v2 offset:64512
v_mul_f32 v211, v211, v210
v_mfma_f32_16x16x32_bf16 v[124:127], v[52:55], a[188:191], v[124:127]
v_cvt_pk_bf16_f32 v228, v209, v211
s_waitcnt lgkmcnt(4)
v_mfma_f32_16x16x32_bf16 v[128:131], v[56:59], a[160:163], v[128:131]
v_mul_f32 v212, v90, v90
v_mul_f32 v214, v91, v91
v_mfma_f32_16x16x32_bf16 v[128:131], v[60:63], a[176:179], v[128:131]
v_fma_f32 v212, v212, v239, v238
v_mfma_f32_16x16x32_bf16 v[132:135], v[56:59], a[164:167], v[132:135]
ds_read_b128 v[48:51], v7 offset:0
v_fma_f32 v214, v214, v239, v238
v_mfma_f32_16x16x32_bf16 v[132:135], v[60:63], a[180:183], v[132:135]
v_mul_f32 v212, v212, v90
v_mul_f32 v214, v214, v91
v_mfma_f32_16x16x32_bf16 v[136:139], v[56:59], a[168:171], v[136:139]
v_mfma_f32_16x16x32_bf16 v[136:139], v[60:63], a[184:187], v[136:139]
v_exp_f32 v212, v212
v_mfma_f32_16x16x32_bf16 v[140:143], v[56:59], a[172:175], v[140:143]
ds_read_b128 v[52:55], v7 offset:1024
v_mfma_f32_16x16x32_bf16 v[140:143], v[60:63], a[188:191], v[140:143]
s_waitcnt lgkmcnt(4)
v_mfma_f32_16x16x32_bf16 v[112:115], v[64:67], a[192:195], v[112:115]
v_exp_f32 v214, v214
v_mfma_f32_16x16x32_bf16 v[112:115], v[68:71], a[208:211], v[112:115]
v_mul_f32 v213, v90, v106
v_mul_f32 v215, v91, v107
v_mfma_f32_16x16x32_bf16 v[116:119], v[64:67], a[196:199], v[116:119]
ds_read_b128 v[56:59], v7 offset:2048
v_fma_f32 v212, v212, v240, v240
v_mfma_f32_16x16x32_bf16 v[116:119], v[68:71], a[212:215], v[116:119]
v_fma_f32 v214, v214, v240, v240
v_mfma_f32_16x16x32_bf16 v[120:123], v[64:67], a[200:203], v[120:123]
v_rcp_f32 v212, v212
v_mfma_f32_16x16x32_bf16 v[120:123], v[68:71], a[216:219], v[120:123]
v_rcp_f32 v214, v214
v_mfma_f32_16x16x32_bf16 v[124:127], v[64:67], a[204:207], v[124:127]
ds_read_b128 v[60:63], v7 offset:3072
v_mul_f32 v213, v213, v212
v_mfma_f32_16x16x32_bf16 v[124:127], v[68:71], a[220:223], v[124:127]
v_mul_f32 v215, v215, v214
s_waitcnt lgkmcnt(4)
v_mfma_f32_16x16x32_bf16 v[128:131], v[72:75], a[192:195], v[128:131]
v_cvt_pk_bf16_f32 v229, v213, v215
buffer_store_dwordx2 v[228:229], v5, s[8:11], s30 offen sc1
v_mfma_f32_16x16x32_bf16 v[128:131], v[76:79], a[208:211], v[128:131]
v_mul_f32 v208, v92, v92
v_mfma_f32_16x16x32_bf16 v[132:135], v[72:75], a[196:199], v[132:135]
ds_read_b128 v[64:67], v7 offset:4096
v_mul_f32 v210, v93, v93
v_mfma_f32_16x16x32_bf16 v[132:135], v[76:79], a[212:215], v[132:135]
v_fma_f32 v208, v208, v242, v241
v_fma_f32 v210, v210, v242, v241
v_mfma_f32_16x16x32_bf16 v[136:139], v[72:75], a[200:203], v[136:139]
v_mul_f32 v208, v208, v92
v_mfma_f32_16x16x32_bf16 v[136:139], v[76:79], a[216:219], v[136:139]
v_mul_f32 v210, v210, v93
v_mfma_f32_16x16x32_bf16 v[140:143], v[72:75], a[204:207], v[140:143]
ds_read_b128 v[68:71], v7 offset:5120
v_mfma_f32_16x16x32_bf16 v[140:143], v[76:79], a[220:223], v[140:143]
s_waitcnt lgkmcnt(4)
v_mfma_f32_16x16x32_bf16 v[112:115], v[48:51], a[224:227], v[112:115]
v_exp_f32 v208, v208
v_mfma_f32_16x16x32_bf16 v[112:115], v[52:55], a[240:243], v[112:115]
v_exp_f32 v210, v210
v_mfma_f32_16x16x32_bf16 v[116:119], v[48:51], a[228:231], v[116:119]
ds_read_b128 v[72:75], v7 offset:6144
v_mul_f32 v209, v92, v108
v_mfma_f32_16x16x32_bf16 v[116:119], v[52:55], a[244:247], v[116:119]
v_mul_f32 v211, v93, v109
v_fma_f32 v208, v208, v243, v243
v_mfma_f32_16x16x32_bf16 v[120:123], v[48:51], a[232:235], v[120:123]
v_fma_f32 v210, v210, v243, v243
v_mfma_f32_16x16x32_bf16 v[120:123], v[52:55], a[248:251], v[120:123]
v_rcp_f32 v208, v208
v_mfma_f32_16x16x32_bf16 v[124:127], v[48:51], a[236:239], v[124:127]
ds_read_b128 v[76:79], v7 offset:7168
v_mfma_f32_16x16x32_bf16 v[124:127], v[52:55], a[252:255], v[124:127]
s_waitcnt lgkmcnt(4)
v_mfma_f32_16x16x32_bf16 v[128:131], v[56:59], a[224:227], v[128:131]
v_rcp_f32 v210, v210
v_mfma_f32_16x16x32_bf16 v[128:131], v[60:63], a[240:243], v[128:131]
v_mul_f32 v209, v209, v208
v_mul_f32 v211, v211, v210
v_mfma_f32_16x16x32_bf16 v[132:135], v[56:59], a[228:231], v[132:135]
s_waitcnt vmcnt(21)
s_barrier
ds_read_b128 v[48:51], v7 offset:8192
v_mfma_f32_16x16x32_bf16 v[132:135], v[60:63], a[244:247], v[132:135]
s_add_u32 m0, s22, 24576
v_cvt_pk_bf16_f32 v230, v209, v211
v_mul_f32 v212, v94, v94
v_mfma_f32_16x16x32_bf16 v[136:139], v[56:59], a[232:235], v[136:139]
v_mul_f32 v214, v95, v95
v_fma_f32 v212, v212, v242, v241
v_mfma_f32_16x16x32_bf16 v[136:139], v[60:63], a[248:251], v[136:139]
s_add_u32 s23, s21, 172032
v_fma_f32 v214, v214, v242, v241
v_mfma_f32_16x16x32_bf16 v[140:143], v[56:59], a[236:239], v[140:143]
ds_read_b128 v[52:55], v7 offset:9216
v_mul_f32 v212, v212, v94
v_mfma_f32_16x16x32_bf16 v[140:143], v[60:63], a[252:255], v[140:143]
buffer_load_dwordx4 v2, s[8:11], s23 offen offset:0 lds
v_mul_f32 v214, v214, v95
s_waitcnt lgkmcnt(4)
v_mfma_f32_16x16x32_bf16 v[112:115], v[64:67], v[16:19], v[112:115]
v_exp_f32 v212, v212
v_mfma_f32_16x16x32_bf16 v[112:115], v[68:71], v[32:35], v[112:115]
buffer_load_dwordx4 v2, s[8:11], s23 offen offset:1024 lds
v_mfma_f32_16x16x32_bf16 v[116:119], v[64:67], v[20:23], v[116:119]
ds_read_b128 v[56:59], v7 offset:10240
v_exp_f32 v214, v214
v_mfma_f32_16x16x32_bf16 v[116:119], v[68:71], v[36:39], v[116:119]
buffer_load_dwordx4 v2, s[8:11], s23 offen offset:2048 lds
v_mul_f32 v213, v94, v110
v_mfma_f32_16x16x32_bf16 v[120:123], v[64:67], v[24:27], v[120:123]
v_mul_f32 v215, v95, v111
v_fma_f32 v212, v212, v243, v243
v_mfma_f32_16x16x32_bf16 v[120:123], v[68:71], v[40:43], v[120:123]
buffer_load_dwordx4 v2, s[8:11], s23 offen offset:3072 lds
v_fma_f32 v214, v214, v243, v243
v_mfma_f32_16x16x32_bf16 v[124:127], v[64:67], v[28:31], v[124:127]
ds_read_b128 v[60:63], v7 offset:11264
v_mfma_f32_16x16x32_bf16 v[124:127], v[68:71], v[44:47], v[124:127]
s_add_u32 m0, s22, 28672
v_rcp_f32 v212, v212
s_waitcnt lgkmcnt(4)
v_mfma_f32_16x16x32_bf16 v[128:131], v[72:75], v[16:19], v[128:131]
v_rcp_f32 v214, v214
v_mfma_f32_16x16x32_bf16 v[128:131], v[76:79], v[32:35], v[128:131]
s_add_u32 s23, s21, 176128
v_mul_f32 v213, v213, v212
v_mfma_f32_16x16x32_bf16 v[132:135], v[72:75], v[20:23], v[132:135]
ds_read_b128 v[64:67], v7 offset:12288
v_mul_f32 v215, v215, v214
v_mfma_f32_16x16x32_bf16 v[132:135], v[76:79], v[36:39], v[132:135]
buffer_load_dwordx4 v2, s[8:11], s23 offen offset:0 lds
v_cvt_pk_bf16_f32 v231, v213, v215
v_mfma_f32_16x16x32_bf16 v[136:139], v[72:75], v[24:27], v[136:139]
buffer_store_dwordx2 v[230:231], v6, s[8:11], s30 offen sc1
v_mfma_f32_16x16x32_bf16 v[136:139], v[76:79], v[40:43], v[136:139]
buffer_load_dwordx4 v2, s[8:11], s23 offen offset:1024 lds
v_mfma_f32_16x16x32_bf16 v[140:143], v[72:75], v[28:31], v[140:143]
ds_read_b128 v[68:71], v7 offset:13312
v_mfma_f32_16x16x32_bf16 v[140:143], v[76:79], v[44:47], v[140:143]
s_waitcnt lgkmcnt(4)
v_mfma_f32_16x16x32_bf16 v[80:83], v[48:51], a[0:3], 0
v_mfma_f32_16x16x32_bf16 v[80:83], v[52:55], a[16:19], v[80:83]
v_mfma_f32_16x16x32_bf16 v[84:87], v[48:51], a[4:7], 0
ds_read_b128 v[72:75], v7 offset:14336
v_mfma_f32_16x16x32_bf16 v[84:87], v[52:55], a[20:23], v[84:87]
v_mul_f32 v208, v112, v112
v_mfma_f32_16x16x32_bf16 v[88:91], v[48:51], a[8:11], 0
v_mul_f32 v210, v113, v113
v_mfma_f32_16x16x32_bf16 v[88:91], v[52:55], a[24:27], v[88:91]
v_fma_f32 v208, v208, v233, v232
v_fma_f32 v210, v210, v233, v232
v_mfma_f32_16x16x32_bf16 v[92:95], v[48:51], a[12:15], 0
ds_read_b128 v[76:79], v7 offset:15360
v_mul_f32 v208, v208, v112
v_mfma_f32_16x16x32_bf16 v[92:95], v[52:55], a[28:31], v[92:95]
v_mul_f32 v210, v210, v113
s_waitcnt lgkmcnt(4)
v_mfma_f32_16x16x32_bf16 v[96:99], v[56:59], a[0:3], 0
v_mfma_f32_16x16x32_bf16 v[96:99], v[60:63], a[16:19], v[96:99]
v_exp_f32 v208, v208
v_mfma_f32_16x16x32_bf16 v[100:103], v[56:59], a[4:7], 0
ds_read_b128 v[48:51], v7 offset:16384
v_mfma_f32_16x16x32_bf16 v[100:103], v[60:63], a[20:23], v[100:103]
v_exp_f32 v210, v210
v_mfma_f32_16x16x32_bf16 v[104:107], v[56:59], a[8:11], 0
v_mul_f32 v209, v112, v128
v_mul_f32 v211, v113, v129
v_mfma_f32_16x16x32_bf16 v[104:107], v[60:63], a[24:27], v[104:107]
v_fma_f32 v208, v208, v234, v234
v_fma_f32 v210, v210, v234, v234
v_mfma_f32_16x16x32_bf16 v[108:111], v[56:59], a[12:15], 0
ds_read_b128 v[52:55], v7 offset:17408
v_mfma_f32_16x16x32_bf16 v[108:111], v[60:63], a[28:31], v[108:111]
s_waitcnt lgkmcnt(4)
v_mfma_f32_16x16x32_bf16 v[80:83], v[64:67], a[32:35], v[80:83]
v_rcp_f32 v208, v208
v_mfma_f32_16x16x32_bf16 v[80:83], v[68:71], a[48:51], v[80:83]
v_rcp_f32 v210, v210
v_mfma_f32_16x16x32_bf16 v[84:87], v[64:67], a[36:39], v[84:87]
ds_read_b128 v[56:59], v7 offset:18432
v_mul_f32 v209, v209, v208
v_mfma_f32_16x16x32_bf16 v[84:87], v[68:71], a[52:55], v[84:87]
v_mul_f32 v211, v211, v210
v_cvt_pk_bf16_f32 v144, v209, v211
v_mfma_f32_16x16x32_bf16 v[88:91], v[64:67], a[40:43], v[88:91]
v_mul_f32 v212, v114, v114
v_mfma_f32_16x16x32_bf16 v[88:91], v[68:71], a[56:59], v[88:91]
v_mul_f32 v214, v115, v115
v_mfma_f32_16x16x32_bf16 v[92:95], v[64:67], a[44:47], v[92:95]
ds_read_b128 v[60:63], v7 offset:19456
v_fma_f32 v212, v212, v233, v232
v_mfma_f32_16x16x32_bf16 v[92:95], v[68:71], a[60:63], v[92:95]
v_fma_f32 v214, v214, v233, v232
s_waitcnt lgkmcnt(4)
v_mfma_f32_16x16x32_bf16 v[96:99], v[72:75], a[32:35], v[96:99]
v_mul_f32 v212, v212, v114
v_mul_f32 v214, v214, v115
v_mfma_f32_16x16x32_bf16 v[96:99], v[76:79], a[48:51], v[96:99]
v_mfma_f32_16x16x32_bf16 v[100:103], v[72:75], a[36:39], v[100:103]
ds_read_b128 v[64:67], v7 offset:20480
v_mfma_f32_16x16x32_bf16 v[100:103], v[76:79], a[52:55], v[100:103]
v_exp_f32 v212, v212
v_mfma_f32_16x16x32_bf16 v[104:107], v[72:75], a[40:43], v[104:107]
v_exp_f32 v214, v214
v_mfma_f32_16x16x32_bf16 v[104:107], v[76:79], a[56:59], v[104:107]
v_mul_f32 v213, v114, v130
v_mul_f32 v215, v115, v131
v_mfma_f32_16x16x32_bf16 v[108:111], v[72:75], a[44:47], v[108:111]
ds_read_b128 v[68:71], v7 offset:21504
v_fma_f32 v212, v212, v234, v234
v_mfma_f32_16x16x32_bf16 v[108:111], v[76:79], a[60:63], v[108:111]
v_fma_f32 v214, v214, v234, v234
s_waitcnt lgkmcnt(4)
v_mfma_f32_16x16x32_bf16 v[80:83], v[48:51], a[64:67], v[80:83]
v_rcp_f32 v212, v212
v_mfma_f32_16x16x32_bf16 v[80:83], v[52:55], a[80:83], v[80:83]
v_mfma_f32_16x16x32_bf16 v[84:87], v[48:51], a[68:71], v[84:87]
ds_read_b128 v[72:75], v7 offset:22528
v_mfma_f32_16x16x32_bf16 v[84:87], v[52:55], a[84:87], v[84:87]
v_rcp_f32 v214, v214
v_mfma_f32_16x16x32_bf16 v[88:91], v[48:51], a[72:75], v[88:91]
v_mul_f32 v213, v213, v212
v_mul_f32 v215, v215, v214
v_mfma_f32_16x16x32_bf16 v[88:91], v[52:55], a[88:91], v[88:91]
v_cvt_pk_bf16_f32 v145, v213, v215
v_mul_f32 v208, v116, v116
v_mfma_f32_16x16x32_bf16 v[92:95], v[48:51], a[76:79], v[92:95]
ds_read_b128 v[76:79], v7 offset:23552
v_mul_f32 v210, v117, v117
v_mfma_f32_16x16x32_bf16 v[92:95], v[52:55], a[92:95], v[92:95]
v_fma_f32 v208, v208, v236, v235
s_waitcnt lgkmcnt(4)
v_mfma_f32_16x16x32_bf16 v[96:99], v[56:59], a[64:67], v[96:99]
v_fma_f32 v210, v210, v236, v235
v_mul_f32 v208, v208, v116
v_mfma_f32_16x16x32_bf16 v[96:99], v[60:63], a[80:83], v[96:99]
v_mul_f32 v210, v210, v117
v_mfma_f32_16x16x32_bf16 v[100:103], v[56:59], a[68:71], v[100:103]
ds_read_b128 v[48:51], v7 offset:24576
v_mfma_f32_16x16x32_bf16 v[100:103], v[60:63], a[84:87], v[100:103]
v_exp_f32 v208, v208
v_mfma_f32_16x16x32_bf16 v[104:107], v[56:59], a[72:75], v[104:107]
v_exp_f32 v210, v210
v_mfma_f32_16x16x32_bf16 v[104:107], v[60:63], a[88:91], v[104:107]
v_mul_f32 v209, v116, v132
v_mfma_f32_16x16x32_bf16 v[108:111], v[56:59], a[76:79], v[108:111]
ds_read_b128 v[52:55], v7 offset:25600
v_mul_f32 v211, v117, v133
v_mfma_f32_16x16x32_bf16 v[108:111], v[60:63], a[92:95], v[108:111]
v_fma_f32 v208, v208, v237, v237
s_waitcnt lgkmcnt(4)
v_mfma_f32_16x16x32_bf16 v[80:83], v[64:67], a[96:99], v[80:83]
v_fma_f32 v210, v210, v237, v237
v_mfma_f32_16x16x32_bf16 v[80:83], v[68:71], a[112:115], v[80:83]
v_rcp_f32 v208, v208
v_mfma_f32_16x16x32_bf16 v[84:87], v[64:67], a[100:103], v[84:87]
ds_read_b128 v[56:59], v7 offset:26624
v_mfma_f32_16x16x32_bf16 v[84:87], v[68:71], a[116:119], v[84:87]
v_rcp_f32 v210, v210
v_mfma_f32_16x16x32_bf16 v[88:91], v[64:67], a[104:107], v[88:91]
v_mul_f32 v209, v209, v208
v_mul_f32 v211, v211, v210
v_mfma_f32_16x16x32_bf16 v[88:91], v[68:71], a[120:123], v[88:91]
v_cvt_pk_bf16_f32 v148, v209, v211
v_mfma_f32_16x16x32_bf16 v[92:95], v[64:67], a[108:111], v[92:95]
ds_read_b128 v[60:63], v7 offset:27648
v_mul_f32 v212, v118, v118
v_mfma_f32_16x16x32_bf16 v[92:95], v[68:71], a[124:127], v[92:95]
v_mul_f32 v214, v119, v119
s_waitcnt lgkmcnt(4)
v_mfma_f32_16x16x32_bf16 v[96:99], v[72:75], a[96:99], v[96:99]
v_fma_f32 v212, v212, v236, v235
v_fma_f32 v214, v214, v236, v235
v_mfma_f32_16x16x32_bf16 v[96:99], v[76:79], a[112:115], v[96:99]
v_mul_f32 v212, v212, v118
v_mfma_f32_16x16x32_bf16 v[100:103], v[72:75], a[100:103], v[100:103]
ds_read_b128 v[64:67], v7 offset:28672
v_mul_f32 v214, v214, v119
v_mfma_f32_16x16x32_bf16 v[100:103], v[76:79], a[116:119], v[100:103]
v_mfma_f32_16x16x32_bf16 v[104:107], v[72:75], a[104:107], v[104:107]
v_exp_f32 v212, v212
v_mfma_f32_16x16x32_bf16 v[104:107], v[76:79], a[120:123], v[104:107]
v_exp_f32 v214, v214
v_mfma_f32_16x16x32_bf16 v[108:111], v[72:75], a[108:111], v[108:111]
ds_read_b128 v[68:71], v7 offset:29696
v_mul_f32 v213, v118, v134
v_mfma_f32_16x16x32_bf16 v[108:111], v[76:79], a[124:127], v[108:111]
v_mul_f32 v215, v119, v135
s_waitcnt lgkmcnt(4)
v_mfma_f32_16x16x32_bf16 v[80:83], v[48:51], a[128:131], v[80:83]
v_fma_f32 v212, v212, v237, v237
v_fma_f32 v214, v214, v237, v237
v_mfma_f32_16x16x32_bf16 v[80:83], v[52:55], a[144:147], v[80:83]
v_mfma_f32_16x16x32_bf16 v[84:87], v[48:51], a[132:135], v[84:87]
ds_read_b128 v[72:75], v7 offset:30720
v_mfma_f32_16x16x32_bf16 v[84:87], v[52:55], a[148:151], v[84:87]
v_rcp_f32 v212, v212
v_mfma_f32_16x16x32_bf16 v[88:91], v[48:51], a[136:139], v[88:91]
v_rcp_f32 v214, v214
v_mfma_f32_16x16x32_bf16 v[88:91], v[52:55], a[152:155], v[88:91]
v_mul_f32 v213, v213, v212
v_mul_f32 v215, v215, v214
v_mfma_f32_16x16x32_bf16 v[92:95], v[48:51], a[140:143], v[92:95]
ds_read_b128 v[76:79], v7 offset:31744
v_cvt_pk_bf16_f32 v149, v213, v215
v_mfma_f32_16x16x32_bf16 v[92:95], v[52:55], a[156:159], v[92:95]
v_mul_f32 v208, v120, v120
s_waitcnt lgkmcnt(4)
v_mfma_f32_16x16x32_bf16 v[96:99], v[56:59], a[128:131], v[96:99]
v_mul_f32 v210, v121, v121
v_mfma_f32_16x16x32_bf16 v[96:99], v[60:63], a[144:147], v[96:99]
v_fma_f32 v208, v208, v239, v238
v_fma_f32 v210, v210, v239, v238
v_mfma_f32_16x16x32_bf16 v[100:103], v[56:59], a[132:135], v[100:103]
s_waitcnt vmcnt(22)
s_barrier
ds_read_b128 v[48:51], v7 offset:32768
v_mfma_f32_16x16x32_bf16 v[100:103], v[60:63], a[148:151], v[100:103]
s_add_u32 m0, s22, 49152
v_mul_f32 v208, v208, v120
v_mfma_f32_16x16x32_bf16 v[104:107], v[56:59], a[136:139], v[104:107]
v_mul_f32 v210, v210, v121
v_mfma_f32_16x16x32_bf16 v[104:107], v[60:63], a[152:155], v[104:107]
s_add_u32 s23, s21, 196608
v_mfma_f32_16x16x32_bf16 v[108:111], v[56:59], a[140:143], v[108:111]
ds_read_b128 v[52:55], v7 offset:33792
v_exp_f32 v208, v208
v_mfma_f32_16x16x32_bf16 v[108:111], v[60:63], a[156:159], v[108:111]
buffer_load_dwordx4 v2, s[8:11], s23 offen offset:0 lds
v_exp_f32 v210, v210
s_waitcnt lgkmcnt(4)
v_mfma_f32_16x16x32_bf16 v[80:83], v[64:67], a[160:163], v[80:83]
v_mul_f32 v209, v120, v136
v_mul_f32 v211, v121, v137
v_mfma_f32_16x16x32_bf16 v[80:83], v[68:71], a[176:179], v[80:83]
buffer_load_dwordx4 v2, s[8:11], s23 offen offset:1024 lds
v_fma_f32 v208, v208, v240, v240
v_mfma_f32_16x16x32_bf16 v[84:87], v[64:67], a[164:167], v[84:87]
ds_read_b128 v[56:59], v7 offset:34816
v_fma_f32 v210, v210, v240, v240
v_mfma_f32_16x16x32_bf16 v[84:87], v[68:71], a[180:183], v[84:87]
buffer_load_dwordx4 v2, s[8:11], s23 offen offset:2048 lds
v_mfma_f32_16x16x32_bf16 v[88:91], v[64:67], a[168:171], v[88:91]
v_rcp_f32 v208, v208
v_mfma_f32_16x16x32_bf16 v[88:91], v[68:71], a[184:187], v[88:91]
buffer_load_dwordx4 v2, s[8:11], s23 offen offset:3072 lds
v_mfma_f32_16x16x32_bf16 v[92:95], v[64:67], a[172:175], v[92:95]
ds_read_b128 v[60:63], v7 offset:35840
v_rcp_f32 v210, v210
v_mfma_f32_16x16x32_bf16 v[92:95], v[68:71], a[188:191], v[92:95]
s_add_u32 m0, s22, 53248
v_mul_f32 v209, v209, v208
s_waitcnt lgkmcnt(4)
v_mfma_f32_16x16x32_bf16 v[96:99], v[72:75], a[160:163], v[96:99]
v_mul_f32 v211, v211, v210
v_cvt_pk_bf16_f32 v152, v209, v211
v_mfma_f32_16x16x32_bf16 v[96:99], v[76:79], a[176:179], v[96:99]
s_add_u32 s23, s21, 200704
v_mul_f32 v212, v122, v122
v_mfma_f32_16x16x32_bf16 v[100:103], v[72:75], a[164:167], v[100:103]
ds_read_b128 v[64:67], v7 offset:36864
v_mul_f32 v214, v123, v123
v_mfma_f32_16x16x32_bf16 v[100:103], v[76:79], a[180:183], v[100:103]
buffer_load_dwordx4 v2, s[8:11], s23 offen offset:0 lds
v_fma_f32 v212, v212, v239, v238
v_mfma_f32_16x16x32_bf16 v[104:107], v[72:75], a[168:171], v[104:107]
v_fma_f32 v214, v214, v239, v238
v_mul_f32 v212, v212, v122
v_mfma_f32_16x16x32_bf16 v[104:107], v[76:79], a[184:187], v[104:107]
buffer_load_dwordx4 v2, s[8:11], s23 offen offset:1024 lds
v_mul_f32 v214, v214, v123
v_mfma_f32_16x16x32_bf16 v[108:111], v[72:75], a[172:175], v[108:111]
ds_read_b128 v[68:71], v7 offset:37888
v_mfma_f32_16x16x32_bf16 v[108:111], v[76:79], a[188:191], v[108:111]
v_exp_f32 v212, v212
s_waitcnt lgkmcnt(4)
v_mfma_f32_16x16x32_bf16 v[80:83], v[48:51], a[192:195], v[80:83]
v_exp_f32 v214, v214
v_mfma_f32_16x16x32_bf16 v[80:83], v[52:55], a[208:211], v[80:83]
v_mul_f32 v213, v122, v138
v_mul_f32 v215, v123, v139
v_mfma_f32_16x16x32_bf16 v[84:87], v[48:51], a[196:199], v[84:87]
ds_read_b128 v[72:75], v7 offset:38912
v_fma_f32 v212, v212, v240, v240
v_mfma_f32_16x16x32_bf16 v[84:87], v[52:55], a[212:215], v[84:87]
v_fma_f32 v214, v214, v240, v240
v_mfma_f32_16x16x32_bf16 v[88:91], v[48:51], a[200:203], v[88:91]
v_rcp_f32 v212, v212
v_mfma_f32_16x16x32_bf16 v[88:91], v[52:55], a[216:219], v[88:91]
v_mfma_f32_16x16x32_bf16 v[92:95], v[48:51], a[204:207], v[92:95]
ds_read_b128 v[76:79], v7 offset:39936
v_mfma_f32_16x16x32_bf16 v[92:95], v[52:55], a[220:223], v[92:95]
v_rcp_f32 v214, v214
s_waitcnt lgkmcnt(4)
v_mfma_f32_16x16x32_bf16 v[96:99], v[56:59], a[192:195], v[96:99]
v_mul_f32 v213, v213, v212
v_mul_f32 v215, v215, v214
v_mfma_f32_16x16x32_bf16 v[96:99], v[60:63], a[208:211], v[96:99]
v_cvt_pk_bf16_f32 v153, v213, v215
v_mul_f32 v208, v124, v124
v_mfma_f32_16x16x32_bf16 v[100:103], v[56:59], a[196:199], v[100:103]
ds_read_b128 v[48:51], v7 offset:40960
v_mul_f32 v210, v125, v125
v_mfma_f32_16x16x32_bf16 v[100:103], v[60:63], a[212:215], v[100:103]
v_fma_f32 v208, v208, v242, v241
v_fma_f32 v210, v210, v242, v241
v_mfma_f32_16x16x32_bf16 v[104:107], v[56:59], a[200:203], v[104:107]
v_mul_f32 v208, v208, v124
v_mfma_f32_16x16x32_bf16 v[104:107], v[60:63], a[216:219], v[104:107]
v_mul_f32 v210, v210, v125
v_mfma_f32_16x16x32_bf16 v[108:111], v[56:59], a[204:207], v[108:111]
ds_read_b128 v[52:55], v7 offset:41984
v_mfma_f32_16x16x32_bf16 v[108:111], v[60:63], a[220:223], v[108:111]
s_waitcnt lgkmcnt(4)
v_mfma_f32_16x16x32_bf16 v[80:83], v[64:67], a[224:227], v[80:83]
v_exp_f32 v208, v208
v_mfma_f32_16x16x32_bf16 v[80:83], v[68:71], a[240:243], v[80:83]
v_exp_f32 v210, v210
v_mfma_f32_16x16x32_bf16 v[84:87], v[64:67], a[228:231], v[84:87]
ds_read_b128 v[56:59], v7 offset:43008
v_mul_f32 v209, v124, v140
v_mfma_f32_16x16x32_bf16 v[84:87], v[68:71], a[244:247], v[84:87]
v_mul_f32 v211, v125, v141
v_fma_f32 v208, v208, v243, v243
v_mfma_f32_16x16x32_bf16 v[88:91], v[64:67], a[232:235], v[88:91]
v_fma_f32 v210, v210, v243, v243
v_mfma_f32_16x16x32_bf16 v[88:91], v[68:71], a[248:251], v[88:91]
v_rcp_f32 v208, v208
v_mfma_f32_16x16x32_bf16 v[92:95], v[64:67], a[236:239], v[92:95]
ds_read_b128 v[60:63], v7 offset:44032
v_mfma_f32_16x16x32_bf16 v[92:95], v[68:71], a[252:255], v[92:95]
s_waitcnt lgkmcnt(4)
v_mfma_f32_16x16x32_bf16 v[96:99], v[72:75], a[224:227], v[96:99]
v_rcp_f32 v210, v210
v_mfma_f32_16x16x32_bf16 v[96:99], v[76:79], a[240:243], v[96:99]
v_mul_f32 v209, v209, v208
v_mul_f32 v211, v211, v210
v_mfma_f32_16x16x32_bf16 v[100:103], v[72:75], a[228:231], v[100:103]
ds_read_b128 v[64:67], v7 offset:45056
v_cvt_pk_bf16_f32 v156, v209, v211
v_mfma_f32_16x16x32_bf16 v[100:103], v[76:79], a[244:247], v[100:103]
v_mul_f32 v212, v126, v126
v_mul_f32 v214, v127, v127
v_mfma_f32_16x16x32_bf16 v[104:107], v[72:75], a[232:235], v[104:107]
v_fma_f32 v212, v212, v242, v241
v_fma_f32 v214, v214, v242, v241
v_mfma_f32_16x16x32_bf16 v[104:107], v[76:79], a[248:251], v[104:107]
v_mul_f32 v212, v212, v126
v_mfma_f32_16x16x32_bf16 v[108:111], v[72:75], a[236:239], v[108:111]
ds_read_b128 v[68:71], v7 offset:46080
v_mul_f32 v214, v214, v127
v_mfma_f32_16x16x32_bf16 v[108:111], v[76:79], a[252:255], v[108:111]
s_waitcnt lgkmcnt(4)
v_mfma_f32_16x16x32_bf16 v[80:83], v[48:51], v[16:19], v[80:83]
v_exp_f32 v212, v212
v_mfma_f32_16x16x32_bf16 v[80:83], v[52:55], v[32:35], v[80:83]
v_exp_f32 v214, v214
v_mfma_f32_16x16x32_bf16 v[84:87], v[48:51], v[20:23], v[84:87]
ds_read_b128 v[72:75], v7 offset:47104
v_mul_f32 v213, v126, v142
v_mfma_f32_16x16x32_bf16 v[84:87], v[52:55], v[36:39], v[84:87]
v_mul_f32 v215, v127, v143
v_mfma_f32_16x16x32_bf16 v[88:91], v[48:51], v[24:27], v[88:91]
v_fma_f32 v212, v212, v243, v243
v_fma_f32 v214, v214, v243, v243
v_mfma_f32_16x16x32_bf16 v[88:91], v[52:55], v[40:43], v[88:91]
v_mfma_f32_16x16x32_bf16 v[92:95], v[48:51], v[28:31], v[92:95]
ds_read_b128 v[76:79], v7 offset:48128
v_mfma_f32_16x16x32_bf16 v[92:95], v[52:55], v[44:47], v[92:95]
v_rcp_f32 v212, v212
s_waitcnt lgkmcnt(4)
v_mfma_f32_16x16x32_bf16 v[96:99], v[56:59], v[16:19], v[96:99]
v_rcp_f32 v214, v214
v_mfma_f32_16x16x32_bf16 v[96:99], v[60:63], v[32:35], v[96:99]
v_mul_f32 v213, v213, v212
v_mul_f32 v215, v215, v214
v_mfma_f32_16x16x32_bf16 v[100:103], v[56:59], v[20:23], v[100:103]
ds_read_b128 v[48:51], v7 offset:49152
v_cvt_pk_bf16_f32 v157, v213, v215
v_mfma_f32_16x16x32_bf16 v[100:103], v[60:63], v[36:39], v[100:103]
v_mfma_f32_16x16x32_bf16 v[104:107], v[56:59], v[24:27], v[104:107]
v_mfma_f32_16x16x32_bf16 v[104:107], v[60:63], v[40:43], v[104:107]
v_mfma_f32_16x16x32_bf16 v[108:111], v[56:59], v[28:31], v[108:111]
ds_read_b128 v[52:55], v7 offset:50176
v_mfma_f32_16x16x32_bf16 v[108:111], v[60:63], v[44:47], v[108:111]
s_waitcnt lgkmcnt(4)
v_mfma_f32_16x16x32_bf16 v[112:115], v[64:67], a[0:3], 0
v_mfma_f32_16x16x32_bf16 v[112:115], v[68:71], a[16:19], v[112:115]
v_mfma_f32_16x16x32_bf16 v[116:119], v[64:67], a[4:7], 0
ds_read_b128 v[56:59], v7 offset:51200
v_mfma_f32_16x16x32_bf16 v[116:119], v[68:71], a[20:23], v[116:119]
v_mul_f32 v208, v80, v80
v_mfma_f32_16x16x32_bf16 v[120:123], v[64:67], a[8:11], 0
v_mul_f32 v210, v81, v81
v_fma_f32 v208, v208, v233, v232
v_mfma_f32_16x16x32_bf16 v[120:123], v[68:71], a[24:27], v[120:123]
v_fma_f32 v210, v210, v233, v232
v_mfma_f32_16x16x32_bf16 v[124:127], v[64:67], a[12:15], 0
ds_read_b128 v[60:63], v7 offset:52224
v_mul_f32 v208, v208, v80
v_mfma_f32_16x16x32_bf16 v[124:127], v[68:71], a[28:31], v[124:127]
v_mul_f32 v210, v210, v81
s_waitcnt lgkmcnt(4)
v_mfma_f32_16x16x32_bf16 v[128:131], v[72:75], a[0:3], 0
v_exp_f32 v208, v208
v_mfma_f32_16x16x32_bf16 v[128:131], v[76:79], a[16:19], v[128:131]
v_mfma_f32_16x16x32_bf16 v[132:135], v[72:75], a[4:7], 0
ds_read_b128 v[64:67], v7 offset:53248
v_mfma_f32_16x16x32_bf16 v[132:135], v[76:79], a[20:23], v[132:135]
v_exp_f32 v210, v210
v_mfma_f32_16x16x32_bf16 v[136:139], v[72:75], a[8:11], 0
v_mul_f32 v209, v80, v96
v_mul_f32 v211, v81, v97
v_mfma_f32_16x16x32_bf16 v[136:139], v[76:79], a[24:27], v[136:139]
v_fma_f32 v208, v208, v234, v234
v_fma_f32 v210, v210, v234, v234
v_mfma_f32_16x16x32_bf16 v[140:143], v[72:75], a[12:15], 0
ds_read_b128 v[68:71], v7 offset:54272
v_mfma_f32_16x16x32_bf16 v[140:143], v[76:79], a[28:31], v[140:143]
s_waitcnt lgkmcnt(4)
v_mfma_f32_16x16x32_bf16 v[112:115], v[48:51], a[32:35], v[112:115]
v_rcp_f32 v208, v208
v_mfma_f32_16x16x32_bf16 v[112:115], v[52:55], a[48:51], v[112:115]
v_rcp_f32 v210, v210
v_mfma_f32_16x16x32_bf16 v[116:119], v[48:51], a[36:39], v[116:119]
ds_read_b128 v[72:75], v7 offset:55296
v_mul_f32 v209, v209, v208
v_mfma_f32_16x16x32_bf16 v[116:119], v[52:55], a[52:55], v[116:119]
v_mul_f32 v211, v211, v210
v_cvt_pk_bf16_f32 v146, v209, v211
v_mfma_f32_16x16x32_bf16 v[120:123], v[48:51], a[40:43], v[120:123]
v_mul_f32 v212, v82, v82
v_mul_f32 v214, v83, v83
v_mfma_f32_16x16x32_bf16 v[120:123], v[52:55], a[56:59], v[120:123]
v_fma_f32 v212, v212, v233, v232
v_mfma_f32_16x16x32_bf16 v[124:127], v[48:51], a[44:47], v[124:127]
ds_read_b128 v[76:79], v7 offset:56320
v_fma_f32 v214, v214, v233, v232
v_mfma_f32_16x16x32_bf16 v[124:127], v[52:55], a[60:63], v[124:127]
v_mul_f32 v212, v212, v82
s_waitcnt lgkmcnt(4)
v_mfma_f32_16x16x32_bf16 v[128:131], v[56:59], a[32:35], v[128:131]
v_mul_f32 v214, v214, v83
v_mfma_f32_16x16x32_bf16 v[128:131], v[60:63], a[48:51], v[128:131]
v_exp_f32 v212, v212
v_mfma_f32_16x16x32_bf16 v[132:135], v[56:59], a[36:39], v[132:135]
s_waitcnt vmcnt(22)
s_barrier
ds_read_b128 v[48:51], v7 offset:57344
v_mfma_f32_16x16x32_bf16 v[132:135], v[60:63], a[52:55], v[132:135]
s_add_u32 m0, s22, 73728
v_mfma_f32_16x16x32_bf16 v[136:139], v[56:59], a[40:43], v[136:139]
v_exp_f32 v214, v214
v_mfma_f32_16x16x32_bf16 v[136:139], v[60:63], a[56:59], v[136:139]
s_add_u32 s23, s21, 221184
v_mul_f32 v213, v82, v98
v_mfma_f32_16x16x32_bf16 v[140:143], v[56:59], a[44:47], v[140:143]
ds_read_b128 v[52:55], v7 offset:58368
v_mul_f32 v215, v83, v99
v_mfma_f32_16x16x32_bf16 v[140:143], v[60:63], a[60:63], v[140:143]
buffer_load_dwordx4 v2, s[8:11], s23 offen offset:0 lds
v_fma_f32 v212, v212, v234, v234
s_waitcnt lgkmcnt(4)
v_mfma_f32_16x16x32_bf16 v[112:115], v[64:67], a[64:67], v[112:115]
v_fma_f32 v214, v214, v234, v234
v_mfma_f32_16x16x32_bf16 v[112:115], v[68:71], a[80:83], v[112:115]
buffer_load_dwordx4 v2, s[8:11], s23 offen offset:1024 lds
v_rcp_f32 v212, v212
v_mfma_f32_16x16x32_bf16 v[116:119], v[64:67], a[68:71], v[116:119]
ds_read_b128 v[56:59], v7 offset:59392
v_rcp_f32 v214, v214
v_mfma_f32_16x16x32_bf16 v[116:119], v[68:71], a[84:87], v[116:119]
buffer_load_dwordx4 v2, s[8:11], s23 offen offset:2048 lds
v_mul_f32 v213, v213, v212
v_mfma_f32_16x16x32_bf16 v[120:123], v[64:67], a[72:75], v[120:123]
v_mul_f32 v215, v215, v214
v_cvt_pk_bf16_f32 v147, v213, v215
v_mfma_f32_16x16x32_bf16 v[120:123], v[68:71], a[88:91], v[120:123]
buffer_load_dwordx4 v2, s[8:11], s23 offen offset:3072 lds
buffer_store_dwordx4 v[144:147], v2, s[8:11], s24 offen offset:0 sc1
v_mfma_f32_16x16x32_bf16 v[124:127], v[64:67], a[76:79], v[124:127]
ds_read_b128 v[60:63], v7 offset:60416
v_mul_f32 v208, v84, v84
v_mfma_f32_16x16x32_bf16 v[124:127], v[68:71], a[92:95], v[124:127]
s_add_u32 m0, s22, 77824
s_waitcnt lgkmcnt(4)
v_mfma_f32_16x16x32_bf16 v[128:131], v[72:75], a[64:67], v[128:131]
v_mul_f32 v210, v85, v85
v_fma_f32 v208, v208, v236, v235
v_mfma_f32_16x16x32_bf16 v[128:131], v[76:79], a[80:83], v[128:131]
s_add_u32 s23, s21, 225280
v_fma_f32 v210, v210, v236, v235
v_mfma_f32_16x16x32_bf16 v[132:135], v[72:75], a[68:71], v[132:135]
ds_read_b128 v[64:67], v7 offset:61440
v_mul_f32 v208, v208, v84
v_mfma_f32_16x16x32_bf16 v[132:135], v[76:79], a[84:87], v[132:135]
buffer_load_dwordx4 v2, s[8:11], s23 offen offset:0 lds
v_mul_f32 v210, v210, v85
v_mfma_f32_16x16x32_bf16 v[136:139], v[72:75], a[72:75], v[136:139]
v_exp_f32 v208, v208
v_mfma_f32_16x16x32_bf16 v[136:139], v[76:79], a[88:91], v[136:139]
buffer_load_dwordx4 v2, s[8:11], s23 offen offset:1024 lds
v_exp_f32 v210, v210
v_mfma_f32_16x16x32_bf16 v[140:143], v[72:75], a[76:79], v[140:143]
ds_read_b128 v[68:71], v7 offset:62464
v_mul_f32 v209, v84, v100
v_mfma_f32_16x16x32_bf16 v[140:143], v[76:79], a[92:95], v[140:143]
v_mul_f32 v211, v85, v101
s_waitcnt lgkmcnt(4)
v_mfma_f32_16x16x32_bf16 v[112:115], v[48:51], a[96:99], v[112:115]
v_fma_f32 v208, v208, v237, v237
v_fma_f32 v210, v210, v237, v237
v_mfma_f32_16x16x32_bf16 v[112:115], v[52:55], a[112:115], v[112:115]
v_rcp_f32 v208, v208
v_mfma_f32_16x16x32_bf16 v[116:119], v[48:51], a[100:103], v[116:119]
ds_read_b128 v[72:75], v7 offset:63488
v_mfma_f32_16x16x32_bf16 v[116:119], v[52:55], a[116:119], v[116:119]
v_rcp_f32 v210, v210
v_mfma_f32_16x16x32_bf16 v[120:123], v[48:51], a[104:107], v[120:123]
v_mul_f32 v209, v209, v208
v_mul_f32 v211, v211, v210
v_mfma_f32_16x16x32_bf16 v[120:123], v[52:55], a[120:123], v[120:123]
v_cvt_pk_bf16_f32 v150, v209, v211
v_mfma_f32_16x16x32_bf16 v[124:127], v[48:51], a[108:111], v[124:127]
ds_read_b128 v[76:79], v7 offset:64512
v_mul_f32 v212, v86, v86
v_mfma_f32_16x16x32_bf16 v[124:127], v[52:55], a[124:127], v[124:127]
v_mul_f32 v214, v87, v87
s_waitcnt lgkmcnt(4)
v_mfma_f32_16x16x32_bf16 v[128:131], v[56:59], a[96:99], v[128:131]
v_fma_f32 v212, v212, v236, v235
v_fma_f32 v214, v214, v236, v235
v_mfma_f32_16x16x32_bf16 v[128:131], v[60:63], a[112:115], v[128:131]
v_mul_f32 v212, v212, v86
v_mul_f32 v214, v214, v87
v_mfma_f32_16x16x32_bf16 v[132:135], v[56:59], a[100:103], v[132:135]
ds_read_b128 v[48:51], v8 offset:0
v_mfma_f32_16x16x32_bf16 v[132:135], v[60:63], a[116:119], v[132:135]
v_exp_f32 v212, v212
v_mfma_f32_16x16x32_bf16 v[136:139], v[56:59], a[104:107], v[136:139]
v_mfma_f32_16x16x32_bf16 v[136:139], v[60:63], a[120:123], v[136:139]
v_exp_f32 v214, v214
v_mfma_f32_16x16x32_bf16 v[140:143], v[56:59], a[108:111], v[140:143]
ds_read_b128 v[52:55], v8 offset:1024
v_mul_f32 v213, v86, v102
v_mfma_f32_16x16x32_bf16 v[140:143], v[60:63], a[124:127], v[140:143]
v_mul_f32 v215, v87, v103
s_waitcnt lgkmcnt(4)
v_mfma_f32_16x16x32_bf16 v[112:115], v[64:67], a[128:131], v[112:115]
v_fma_f32 v212, v212, v237, v237
v_fma_f32 v214, v214, v237, v237
v_mfma_f32_16x16x32_bf16 v[112:115], v[68:71], a[144:147], v[112:115]
v_rcp_f32 v212, v212
v_mfma_f32_16x16x32_bf16 v[116:119], v[64:67], a[132:135], v[116:119]
ds_read_b128 v[56:59], v8 offset:2048
v_mfma_f32_16x16x32_bf16 v[116:119], v[68:71], a[148:151], v[116:119]
v_rcp_f32 v214, v214
v_mfma_f32_16x16x32_bf16 v[120:123], v[64:67], a[136:139], v[120:123]
v_mul_f32 v213, v213, v212
v_mfma_f32_16x16x32_bf16 v[120:123], v[68:71], a[152:155], v[120:123]
v_mul_f32 v215, v215, v214
v_cvt_pk_bf16_f32 v151, v213, v215
v_mfma_f32_16x16x32_bf16 v[124:127], v[64:67], a[140:143], v[124:127]
ds_read_b128 v[60:63], v8 offset:3072
buffer_store_dwordx4 v[148:151], v4, s[8:11], s24 offen offset:0 sc1
v_mfma_f32_16x16x32_bf16 v[124:127], v[68:71], a[156:159], v[124:127]
v_mul_f32 v208, v88, v88
s_waitcnt lgkmcnt(4)
v_mfma_f32_16x16x32_bf16 v[128:131], v[72:75], a[128:131], v[128:131]
v_mul_f32 v210, v89, v89
v_fma_f32 v208, v208, v239, v238
v_mfma_f32_16x16x32_bf16 v[128:131], v[76:79], a[144:147], v[128:131]
v_fma_f32 v210, v210, v239, v238
v_mfma_f32_16x16x32_bf16 v[132:135], v[72:75], a[132:135], v[132:135]
ds_read_b128 v[64:67], v8 offset:4096
v_mul_f32 v208, v208, v88
v_mfma_f32_16x16x32_bf16 v[132:135], v[76:79], a[148:151], v[132:135]
v_mul_f32 v210, v210, v89
v_mfma_f32_16x16x32_bf16 v[136:139], v[72:75], a[136:139], v[136:139]
v_exp_f32 v208, v208
v_mfma_f32_16x16x32_bf16 v[136:139], v[76:79], a[152:155], v[136:139]
v_mfma_f32_16x16x32_bf16 v[140:143], v[72:75], a[140:143], v[140:143]
ds_read_b128 v[68:71], v8 offset:5120
v_mfma_f32_16x16x32_bf16 v[140:143], v[76:79], a[156:159], v[140:143]
v_exp_f32 v210, v210
s_waitcnt lgkmcnt(4)
v_mfma_f32_16x16x32_bf16 v[112:115], v[48:51], a[160:163], v[112:115]
v_mul_f32 v209, v88, v104
v_mul_f32 v211, v89, v105
v_mfma_f32_16x16x32_bf16 v[112:115], v[52:55], a[176:179], v[112:115]
v_fma_f32 v208, v208, v240, v240
v_fma_f32 v210, v210, v240, v240
v_mfma_f32_16x16x32_bf16 v[116:119], v[48:51], a[164:167], v[116:119]
ds_read_b128 v[72:75], v8 offset:6144
v_mfma_f32_16x16x32_bf16 v[116:119], v[52:55], a[180:183], v[116:119]
v_rcp_f32 v208, v208
v_mfma_f32_16x16x32_bf16 v[120:123], v[48:51], a[168:171], v[120:123]
v_rcp_f32 v210, v210
v_mfma_f32_16x16x32_bf16 v[120:123], v[52:55], a[184:187], v[120:123]
v_mul_f32 v209, v209, v208
v_mfma_f32_16x16x32_bf16 v[124:127], v[48:51], a[172:175], v[124:127]
ds_read_b128 v[76:79], v8 offset:7168
v_mul_f32 v211, v211, v210
v_mfma_f32_16x16x32_bf16 v[124:127], v[52:55], a[188:191], v[124:127]
v_cvt_pk_bf16_f32 v154, v209, v211
s_waitcnt lgkmcnt(4)
v_mfma_f32_16x16x32_bf16 v[128:131], v[56:59], a[160:163], v[128:131]
v_mul_f32 v212, v90, v90
v_mul_f32 v214, v91, v91
v_mfma_f32_16x16x32_bf16 v[128:131], v[60:63], a[176:179], v[128:131]
v_fma_f32 v212, v212, v239, v238
v_mfma_f32_16x16x32_bf16 v[132:135], v[56:59], a[164:167], v[132:135]
ds_read_b128 v[48:51], v8 offset:8192
v_fma_f32 v214, v214, v239, v238
v_mfma_f32_16x16x32_bf16 v[132:135], v[60:63], a[180:183], v[132:135]
v_mul_f32 v212, v212, v90
v_mul_f32 v214, v214, v91
v_mfma_f32_16x16x32_bf16 v[136:139], v[56:59], a[168:171], v[136:139]
v_mfma_f32_16x16x32_bf16 v[136:139], v[60:63], a[184:187], v[136:139]
v_exp_f32 v212, v212
v_mfma_f32_16x16x32_bf16 v[140:143], v[56:59], a[172:175], v[140:143]
ds_read_b128 v[52:55], v8 offset:9216
v_mfma_f32_16x16x32_bf16 v[140:143], v[60:63], a[188:191], v[140:143]
s_waitcnt lgkmcnt(4)
v_mfma_f32_16x16x32_bf16 v[112:115], v[64:67], a[192:195], v[112:115]
v_exp_f32 v214, v214
v_mfma_f32_16x16x32_bf16 v[112:115], v[68:71], a[208:211], v[112:115]
v_mul_f32 v213, v90, v106
v_mul_f32 v215, v91, v107
v_mfma_f32_16x16x32_bf16 v[116:119], v[64:67], a[196:199], v[116:119]
ds_read_b128 v[56:59], v8 offset:10240
v_fma_f32 v212, v212, v240, v240
v_mfma_f32_16x16x32_bf16 v[116:119], v[68:71], a[212:215], v[116:119]
v_fma_f32 v214, v214, v240, v240
v_mfma_f32_16x16x32_bf16 v[120:123], v[64:67], a[200:203], v[120:123]
v_rcp_f32 v212, v212
v_mfma_f32_16x16x32_bf16 v[120:123], v[68:71], a[216:219], v[120:123]
v_rcp_f32 v214, v214
v_mfma_f32_16x16x32_bf16 v[124:127], v[64:67], a[204:207], v[124:127]
ds_read_b128 v[60:63], v8 offset:11264
v_mul_f32 v213, v213, v212
v_mfma_f32_16x16x32_bf16 v[124:127], v[68:71], a[220:223], v[124:127]
v_mul_f32 v215, v215, v214
s_waitcnt lgkmcnt(4)
v_mfma_f32_16x16x32_bf16 v[128:131], v[72:75], a[192:195], v[128:131]
v_cvt_pk_bf16_f32 v155, v213, v215
buffer_store_dwordx4 v[152:155], v5, s[8:11], s24 offen offset:0 sc1
v_mfma_f32_16x16x32_bf16 v[128:131], v[76:79], a[208:211], v[128:131]
v_mul_f32 v208, v92, v92
v_mfma_f32_16x16x32_bf16 v[132:135], v[72:75], a[196:199], v[132:135]
ds_read_b128 v[64:67], v8 offset:12288
v_mul_f32 v210, v93, v93
v_mfma_f32_16x16x32_bf16 v[132:135], v[76:79], a[212:215], v[132:135]
v_fma_f32 v208, v208, v242, v241
v_fma_f32 v210, v210, v242, v241
v_mfma_f32_16x16x32_bf16 v[136:139], v[72:75], a[200:203], v[136:139]
v_mul_f32 v208, v208, v92
v_mfma_f32_16x16x32_bf16 v[136:139], v[76:79], a[216:219], v[136:139]
v_mul_f32 v210, v210, v93
v_mfma_f32_16x16x32_bf16 v[140:143], v[72:75], a[204:207], v[140:143]
ds_read_b128 v[68:71], v8 offset:13312
v_mfma_f32_16x16x32_bf16 v[140:143], v[76:79], a[220:223], v[140:143]
s_waitcnt lgkmcnt(4)
v_mfma_f32_16x16x32_bf16 v[112:115], v[48:51], a[224:227], v[112:115]
v_exp_f32 v208, v208
v_mfma_f32_16x16x32_bf16 v[112:115], v[52:55], a[240:243], v[112:115]
v_exp_f32 v210, v210
v_mfma_f32_16x16x32_bf16 v[116:119], v[48:51], a[228:231], v[116:119]
ds_read_b128 v[72:75], v8 offset:14336
v_mul_f32 v209, v92, v108
v_mfma_f32_16x16x32_bf16 v[116:119], v[52:55], a[244:247], v[116:119]
v_mul_f32 v211, v93, v109
v_fma_f32 v208, v208, v243, v243
v_mfma_f32_16x16x32_bf16 v[120:123], v[48:51], a[232:235], v[120:123]
v_fma_f32 v210, v210, v243, v243
v_mfma_f32_16x16x32_bf16 v[120:123], v[52:55], a[248:251], v[120:123]
v_rcp_f32 v208, v208
v_mfma_f32_16x16x32_bf16 v[124:127], v[48:51], a[236:239], v[124:127]
ds_read_b128 v[76:79], v8 offset:15360
v_mfma_f32_16x16x32_bf16 v[124:127], v[52:55], a[252:255], v[124:127]
s_waitcnt lgkmcnt(4)
v_mfma_f32_16x16x32_bf16 v[128:131], v[56:59], a[224:227], v[128:131]
v_rcp_f32 v210, v210
v_mfma_f32_16x16x32_bf16 v[128:131], v[60:63], a[240:243], v[128:131]
v_mul_f32 v209, v209, v208
v_mul_f32 v211, v211, v210
v_mfma_f32_16x16x32_bf16 v[132:135], v[56:59], a[228:231], v[132:135]
s_waitcnt vmcnt(24)
s_barrier
ds_read_b128 v[48:51], v2 offset:0
v_mfma_f32_16x16x32_bf16 v[132:135], v[60:63], a[244:247], v[132:135]
s_add_u32 m0, s22, 98304
v_cvt_pk_bf16_f32 v158, v209, v211
v_mul_f32 v212, v94, v94
v_mfma_f32_16x16x32_bf16 v[136:139], v[56:59], a[232:235], v[136:139]
v_mul_f32 v214, v95, v95
v_fma_f32 v212, v212, v242, v241
v_mfma_f32_16x16x32_bf16 v[136:139], v[60:63], a[248:251], v[136:139]
s_add_u32 s23, s21, 245760
v_fma_f32 v214, v214, v242, v241
v_mfma_f32_16x16x32_bf16 v[140:143], v[56:59], a[236:239], v[140:143]
ds_read_b128 v[52:55], v2 offset:1024
v_mul_f32 v212, v212, v94
v_mfma_f32_16x16x32_bf16 v[140:143], v[60:63], a[252:255], v[140:143]
buffer_load_dwordx4 v2, s[8:11], s23 offen offset:0 lds
v_mul_f32 v214, v214, v95
s_waitcnt lgkmcnt(4)
v_mfma_f32_16x16x32_bf16 v[112:115], v[64:67], v[16:19], v[112:115]
v_exp_f32 v212, v212
v_mfma_f32_16x16x32_bf16 v[112:115], v[68:71], v[32:35], v[112:115]
buffer_load_dwordx4 v2, s[8:11], s23 offen offset:1024 lds
v_mfma_f32_16x16x32_bf16 v[116:119], v[64:67], v[20:23], v[116:119]
ds_read_b128 v[56:59], v2 offset:2048
v_exp_f32 v214, v214
v_mfma_f32_16x16x32_bf16 v[116:119], v[68:71], v[36:39], v[116:119]
buffer_load_dwordx4 v2, s[8:11], s23 offen offset:2048 lds
v_mul_f32 v213, v94, v110
v_mfma_f32_16x16x32_bf16 v[120:123], v[64:67], v[24:27], v[120:123]
v_mul_f32 v215, v95, v111
v_fma_f32 v212, v212, v243, v243
v_mfma_f32_16x16x32_bf16 v[120:123], v[68:71], v[40:43], v[120:123]
buffer_load_dwordx4 v2, s[8:11], s23 offen offset:3072 lds
v_fma_f32 v214, v214, v243, v243
v_mfma_f32_16x16x32_bf16 v[124:127], v[64:67], v[28:31], v[124:127]
ds_read_b128 v[60:63], v2 offset:3072
v_mfma_f32_16x16x32_bf16 v[124:127], v[68:71], v[44:47], v[124:127]
s_add_u32 m0, s22, 102400
v_rcp_f32 v212, v212
s_waitcnt lgkmcnt(4)
v_mfma_f32_16x16x32_bf16 v[128:131], v[72:75], v[16:19], v[128:131]
v_rcp_f32 v214, v214
v_mfma_f32_16x16x32_bf16 v[128:131], v[76:79], v[32:35], v[128:131]
s_add_u32 s23, s21, 249856
v_mul_f32 v213, v213, v212
v_mfma_f32_16x16x32_bf16 v[132:135], v[72:75], v[20:23], v[132:135]
ds_read_b128 v[64:67], v2 offset:4096
v_mul_f32 v215, v215, v214
v_mfma_f32_16x16x32_bf16 v[132:135], v[76:79], v[36:39], v[132:135]
buffer_load_dwordx4 v2, s[8:11], s23 offen offset:0 lds
v_cvt_pk_bf16_f32 v159, v213, v215
v_mfma_f32_16x16x32_bf16 v[136:139], v[72:75], v[24:27], v[136:139]
buffer_store_dwordx4 v[156:159], v6, s[8:11], s24 offen offset:0 sc1
v_mfma_f32_16x16x32_bf16 v[136:139], v[76:79], v[40:43], v[136:139]
buffer_load_dwordx4 v2, s[8:11], s23 offen offset:1024 lds
v_mfma_f32_16x16x32_bf16 v[140:143], v[72:75], v[28:31], v[140:143]
ds_read_b128 v[68:71], v2 offset:5120
v_mfma_f32_16x16x32_bf16 v[140:143], v[76:79], v[44:47], v[140:143]
s_waitcnt lgkmcnt(4)
v_mfma_f32_16x16x32_bf16 v[80:83], v[48:51], a[0:3], 0
v_mfma_f32_16x16x32_bf16 v[80:83], v[52:55], a[16:19], v[80:83]
v_mfma_f32_16x16x32_bf16 v[84:87], v[48:51], a[4:7], 0
ds_read_b128 v[72:75], v2 offset:6144
v_mfma_f32_16x16x32_bf16 v[84:87], v[52:55], a[20:23], v[84:87]
v_mul_f32 v208, v112, v112
v_mfma_f32_16x16x32_bf16 v[88:91], v[48:51], a[8:11], 0
v_mul_f32 v210, v113, v113
v_mfma_f32_16x16x32_bf16 v[88:91], v[52:55], a[24:27], v[88:91]
v_fma_f32 v208, v208, v233, v232
v_fma_f32 v210, v210, v233, v232
v_mfma_f32_16x16x32_bf16 v[92:95], v[48:51], a[12:15], 0
ds_read_b128 v[76:79], v2 offset:7168
v_mul_f32 v208, v208, v112
v_mfma_f32_16x16x32_bf16 v[92:95], v[52:55], a[28:31], v[92:95]
v_mul_f32 v210, v210, v113
s_waitcnt lgkmcnt(4)
v_mfma_f32_16x16x32_bf16 v[96:99], v[56:59], a[0:3], 0
v_mfma_f32_16x16x32_bf16 v[96:99], v[60:63], a[16:19], v[96:99]
v_exp_f32 v208, v208
v_mfma_f32_16x16x32_bf16 v[100:103], v[56:59], a[4:7], 0
ds_read_b128 v[48:51], v2 offset:8192
v_mfma_f32_16x16x32_bf16 v[100:103], v[60:63], a[20:23], v[100:103]
v_exp_f32 v210, v210
v_mfma_f32_16x16x32_bf16 v[104:107], v[56:59], a[8:11], 0
v_mul_f32 v209, v112, v128
v_mul_f32 v211, v113, v129
v_mfma_f32_16x16x32_bf16 v[104:107], v[60:63], a[24:27], v[104:107]
v_fma_f32 v208, v208, v234, v234
v_fma_f32 v210, v210, v234, v234
v_mfma_f32_16x16x32_bf16 v[108:111], v[56:59], a[12:15], 0
ds_read_b128 v[52:55], v2 offset:9216
v_mfma_f32_16x16x32_bf16 v[108:111], v[60:63], a[28:31], v[108:111]
s_waitcnt lgkmcnt(4)
v_mfma_f32_16x16x32_bf16 v[80:83], v[64:67], a[32:35], v[80:83]
v_rcp_f32 v208, v208
v_mfma_f32_16x16x32_bf16 v[80:83], v[68:71], a[48:51], v[80:83]
v_rcp_f32 v210, v210
v_mfma_f32_16x16x32_bf16 v[84:87], v[64:67], a[36:39], v[84:87]
ds_read_b128 v[56:59], v2 offset:10240
v_mul_f32 v209, v209, v208
v_mfma_f32_16x16x32_bf16 v[84:87], v[68:71], a[52:55], v[84:87]
v_mul_f32 v211, v211, v210
v_cvt_pk_bf16_f32 v160, v209, v211
v_mfma_f32_16x16x32_bf16 v[88:91], v[64:67], a[40:43], v[88:91]
v_mul_f32 v212, v114, v114
v_mfma_f32_16x16x32_bf16 v[88:91], v[68:71], a[56:59], v[88:91]
v_mul_f32 v214, v115, v115
v_mfma_f32_16x16x32_bf16 v[92:95], v[64:67], a[44:47], v[92:95]
ds_read_b128 v[60:63], v2 offset:11264
v_fma_f32 v212, v212, v233, v232
v_mfma_f32_16x16x32_bf16 v[92:95], v[68:71], a[60:63], v[92:95]
v_fma_f32 v214, v214, v233, v232
s_waitcnt lgkmcnt(4)
v_mfma_f32_16x16x32_bf16 v[96:99], v[72:75], a[32:35], v[96:99]
v_mul_f32 v212, v212, v114
v_mul_f32 v214, v214, v115
v_mfma_f32_16x16x32_bf16 v[96:99], v[76:79], a[48:51], v[96:99]
v_mfma_f32_16x16x32_bf16 v[100:103], v[72:75], a[36:39], v[100:103]
ds_read_b128 v[64:67], v2 offset:12288
v_mfma_f32_16x16x32_bf16 v[100:103], v[76:79], a[52:55], v[100:103]
v_exp_f32 v212, v212
v_mfma_f32_16x16x32_bf16 v[104:107], v[72:75], a[40:43], v[104:107]
v_exp_f32 v214, v214
v_mfma_f32_16x16x32_bf16 v[104:107], v[76:79], a[56:59], v[104:107]
v_mul_f32 v213, v114, v130
v_mul_f32 v215, v115, v131
v_mfma_f32_16x16x32_bf16 v[108:111], v[72:75], a[44:47], v[108:111]
ds_read_b128 v[68:71], v2 offset:13312
v_fma_f32 v212, v212, v234, v234
v_mfma_f32_16x16x32_bf16 v[108:111], v[76:79], a[60:63], v[108:111]
v_fma_f32 v214, v214, v234, v234
s_waitcnt lgkmcnt(4)
v_mfma_f32_16x16x32_bf16 v[80:83], v[48:51], a[64:67], v[80:83]
v_rcp_f32 v212, v212
v_mfma_f32_16x16x32_bf16 v[80:83], v[52:55], a[80:83], v[80:83]
v_mfma_f32_16x16x32_bf16 v[84:87], v[48:51], a[68:71], v[84:87]
ds_read_b128 v[72:75], v2 offset:14336
v_mfma_f32_16x16x32_bf16 v[84:87], v[52:55], a[84:87], v[84:87]
v_rcp_f32 v214, v214
v_mfma_f32_16x16x32_bf16 v[88:91], v[48:51], a[72:75], v[88:91]
v_mul_f32 v213, v213, v212
v_mul_f32 v215, v215, v214
v_mfma_f32_16x16x32_bf16 v[88:91], v[52:55], a[88:91], v[88:91]
v_cvt_pk_bf16_f32 v161, v213, v215
v_mul_f32 v208, v116, v116
v_mfma_f32_16x16x32_bf16 v[92:95], v[48:51], a[76:79], v[92:95]
ds_read_b128 v[76:79], v2 offset:15360
v_mul_f32 v210, v117, v117
v_mfma_f32_16x16x32_bf16 v[92:95], v[52:55], a[92:95], v[92:95]
v_fma_f32 v208, v208, v236, v235
s_waitcnt lgkmcnt(4)
v_mfma_f32_16x16x32_bf16 v[96:99], v[56:59], a[64:67], v[96:99]
v_fma_f32 v210, v210, v236, v235
v_mul_f32 v208, v208, v116
v_mfma_f32_16x16x32_bf16 v[96:99], v[60:63], a[80:83], v[96:99]
v_mul_f32 v210, v210, v117
v_mfma_f32_16x16x32_bf16 v[100:103], v[56:59], a[68:71], v[100:103]
ds_read_b128 v[48:51], v2 offset:16384
v_mfma_f32_16x16x32_bf16 v[100:103], v[60:63], a[84:87], v[100:103]
v_exp_f32 v208, v208
v_mfma_f32_16x16x32_bf16 v[104:107], v[56:59], a[72:75], v[104:107]
v_exp_f32 v210, v210
v_mfma_f32_16x16x32_bf16 v[104:107], v[60:63], a[88:91], v[104:107]
v_mul_f32 v209, v116, v132
v_mfma_f32_16x16x32_bf16 v[108:111], v[56:59], a[76:79], v[108:111]
ds_read_b128 v[52:55], v2 offset:17408
v_mul_f32 v211, v117, v133
v_mfma_f32_16x16x32_bf16 v[108:111], v[60:63], a[92:95], v[108:111]
v_fma_f32 v208, v208, v237, v237
s_waitcnt lgkmcnt(4)
v_mfma_f32_16x16x32_bf16 v[80:83], v[64:67], a[96:99], v[80:83]
v_fma_f32 v210, v210, v237, v237
v_mfma_f32_16x16x32_bf16 v[80:83], v[68:71], a[112:115], v[80:83]
v_rcp_f32 v208, v208
v_mfma_f32_16x16x32_bf16 v[84:87], v[64:67], a[100:103], v[84:87]
ds_read_b128 v[56:59], v2 offset:18432
v_mfma_f32_16x16x32_bf16 v[84:87], v[68:71], a[116:119], v[84:87]
v_rcp_f32 v210, v210
v_mfma_f32_16x16x32_bf16 v[88:91], v[64:67], a[104:107], v[88:91]
v_mul_f32 v209, v209, v208
v_mul_f32 v211, v211, v210
v_mfma_f32_16x16x32_bf16 v[88:91], v[68:71], a[120:123], v[88:91]
v_cvt_pk_bf16_f32 v164, v209, v211
v_mfma_f32_16x16x32_bf16 v[92:95], v[64:67], a[108:111], v[92:95]
ds_read_b128 v[60:63], v2 offset:19456
v_mul_f32 v212, v118, v118
v_mfma_f32_16x16x32_bf16 v[92:95], v[68:71], a[124:127], v[92:95]
v_mul_f32 v214, v119, v119
s_waitcnt lgkmcnt(4)
v_mfma_f32_16x16x32_bf16 v[96:99], v[72:75], a[96:99], v[96:99]
v_fma_f32 v212, v212, v236, v235
v_fma_f32 v214, v214, v236, v235
v_mfma_f32_16x16x32_bf16 v[96:99], v[76:79], a[112:115], v[96:99]
v_mul_f32 v212, v212, v118
v_mfma_f32_16x16x32_bf16 v[100:103], v[72:75], a[100:103], v[100:103]
ds_read_b128 v[64:67], v2 offset:20480
v_mul_f32 v214, v214, v119
v_mfma_f32_16x16x32_bf16 v[100:103], v[76:79], a[116:119], v[100:103]
v_mfma_f32_16x16x32_bf16 v[104:107], v[72:75], a[104:107], v[104:107]
v_exp_f32 v212, v212
v_mfma_f32_16x16x32_bf16 v[104:107], v[76:79], a[120:123], v[104:107]
v_exp_f32 v214, v214
v_mfma_f32_16x16x32_bf16 v[108:111], v[72:75], a[108:111], v[108:111]
ds_read_b128 v[68:71], v2 offset:21504
v_mul_f32 v213, v118, v134
v_mfma_f32_16x16x32_bf16 v[108:111], v[76:79], a[124:127], v[108:111]
v_mul_f32 v215, v119, v135
s_waitcnt lgkmcnt(4)
v_mfma_f32_16x16x32_bf16 v[80:83], v[48:51], a[128:131], v[80:83]
v_fma_f32 v212, v212, v237, v237
v_fma_f32 v214, v214, v237, v237
v_mfma_f32_16x16x32_bf16 v[80:83], v[52:55], a[144:147], v[80:83]
v_mfma_f32_16x16x32_bf16 v[84:87], v[48:51], a[132:135], v[84:87]
ds_read_b128 v[72:75], v2 offset:22528
v_mfma_f32_16x16x32_bf16 v[84:87], v[52:55], a[148:151], v[84:87]
v_rcp_f32 v212, v212
v_mfma_f32_16x16x32_bf16 v[88:91], v[48:51], a[136:139], v[88:91]
v_rcp_f32 v214, v214
v_mfma_f32_16x16x32_bf16 v[88:91], v[52:55], a[152:155], v[88:91]
v_mul_f32 v213, v213, v212
v_mul_f32 v215, v215, v214
v_mfma_f32_16x16x32_bf16 v[92:95], v[48:51], a[140:143], v[92:95]
ds_read_b128 v[76:79], v2 offset:23552
v_cvt_pk_bf16_f32 v165, v213, v215
v_mfma_f32_16x16x32_bf16 v[92:95], v[52:55], a[156:159], v[92:95]
v_mul_f32 v208, v120, v120
s_waitcnt lgkmcnt(4)
v_mfma_f32_16x16x32_bf16 v[96:99], v[56:59], a[128:131], v[96:99]
v_mul_f32 v210, v121, v121
v_mfma_f32_16x16x32_bf16 v[96:99], v[60:63], a[144:147], v[96:99]
v_fma_f32 v208, v208, v239, v238
v_fma_f32 v210, v210, v239, v238
v_mfma_f32_16x16x32_bf16 v[100:103], v[56:59], a[132:135], v[100:103]
s_waitcnt vmcnt(22)
s_barrier
ds_read_b128 v[48:51], v2 offset:24576
v_mfma_f32_16x16x32_bf16 v[100:103], v[60:63], a[148:151], v[100:103]
s_add_u32 m0, s22, 122880
v_mul_f32 v208, v208, v120
v_mfma_f32_16x16x32_bf16 v[104:107], v[56:59], a[136:139], v[104:107]
v_mul_f32 v210, v210, v121
v_mfma_f32_16x16x32_bf16 v[104:107], v[60:63], a[152:155], v[104:107]
s_add_u32 s23, s21, 270336
v_mfma_f32_16x16x32_bf16 v[108:111], v[56:59], a[140:143], v[108:111]
ds_read_b128 v[52:55], v2 offset:25600
v_exp_f32 v208, v208
v_mfma_f32_16x16x32_bf16 v[108:111], v[60:63], a[156:159], v[108:111]
buffer_load_dwordx4 v2, s[8:11], s23 offen offset:0 lds
v_exp_f32 v210, v210
s_waitcnt lgkmcnt(4)
v_mfma_f32_16x16x32_bf16 v[80:83], v[64:67], a[160:163], v[80:83]
v_mul_f32 v209, v120, v136
v_mul_f32 v211, v121, v137
v_mfma_f32_16x16x32_bf16 v[80:83], v[68:71], a[176:179], v[80:83]
buffer_load_dwordx4 v2, s[8:11], s23 offen offset:1024 lds
v_fma_f32 v208, v208, v240, v240
v_mfma_f32_16x16x32_bf16 v[84:87], v[64:67], a[164:167], v[84:87]
ds_read_b128 v[56:59], v2 offset:26624
v_fma_f32 v210, v210, v240, v240
v_mfma_f32_16x16x32_bf16 v[84:87], v[68:71], a[180:183], v[84:87]
buffer_load_dwordx4 v2, s[8:11], s23 offen offset:2048 lds
v_mfma_f32_16x16x32_bf16 v[88:91], v[64:67], a[168:171], v[88:91]
v_rcp_f32 v208, v208
v_mfma_f32_16x16x32_bf16 v[88:91], v[68:71], a[184:187], v[88:91]
buffer_load_dwordx4 v2, s[8:11], s23 offen offset:3072 lds
v_mfma_f32_16x16x32_bf16 v[92:95], v[64:67], a[172:175], v[92:95]
ds_read_b128 v[60:63], v2 offset:27648
v_rcp_f32 v210, v210
v_mfma_f32_16x16x32_bf16 v[92:95], v[68:71], a[188:191], v[92:95]
s_add_u32 m0, s22, 126976
v_mul_f32 v209, v209, v208
s_waitcnt lgkmcnt(4)
v_mfma_f32_16x16x32_bf16 v[96:99], v[72:75], a[160:163], v[96:99]
v_mul_f32 v211, v211, v210
v_cvt_pk_bf16_f32 v168, v209, v211
v_mfma_f32_16x16x32_bf16 v[96:99], v[76:79], a[176:179], v[96:99]
s_add_u32 s23, s21, 274432
v_mul_f32 v212, v122, v122
v_mfma_f32_16x16x32_bf16 v[100:103], v[72:75], a[164:167], v[100:103]
ds_read_b128 v[64:67], v2 offset:28672
v_mul_f32 v214, v123, v123
v_mfma_f32_16x16x32_bf16 v[100:103], v[76:79], a[180:183], v[100:103]
buffer_load_dwordx4 v2, s[8:11], s23 offen offset:0 lds
v_fma_f32 v212, v212, v239, v238
v_mfma_f32_16x16x32_bf16 v[104:107], v[72:75], a[168:171], v[104:107]
v_fma_f32 v214, v214, v239, v238
v_mul_f32 v212, v212, v122
v_mfma_f32_16x16x32_bf16 v[104:107], v[76:79], a[184:187], v[104:107]
buffer_load_dwordx4 v2, s[8:11], s23 offen offset:1024 lds
v_mul_f32 v214, v214, v123
v_mfma_f32_16x16x32_bf16 v[108:111], v[72:75], a[172:175], v[108:111]
ds_read_b128 v[68:71], v2 offset:29696
v_mfma_f32_16x16x32_bf16 v[108:111], v[76:79], a[188:191], v[108:111]
v_exp_f32 v212, v212
s_waitcnt lgkmcnt(4)
v_mfma_f32_16x16x32_bf16 v[80:83], v[48:51], a[192:195], v[80:83]
v_exp_f32 v214, v214
v_mfma_f32_16x16x32_bf16 v[80:83], v[52:55], a[208:211], v[80:83]
v_mul_f32 v213, v122, v138
v_mul_f32 v215, v123, v139
v_mfma_f32_16x16x32_bf16 v[84:87], v[48:51], a[196:199], v[84:87]
ds_read_b128 v[72:75], v2 offset:30720
v_fma_f32 v212, v212, v240, v240
v_mfma_f32_16x16x32_bf16 v[84:87], v[52:55], a[212:215], v[84:87]
v_fma_f32 v214, v214, v240, v240
v_mfma_f32_16x16x32_bf16 v[88:91], v[48:51], a[200:203], v[88:91]
v_rcp_f32 v212, v212
v_mfma_f32_16x16x32_bf16 v[88:91], v[52:55], a[216:219], v[88:91]
v_mfma_f32_16x16x32_bf16 v[92:95], v[48:51], a[204:207], v[92:95]
ds_read_b128 v[76:79], v2 offset:31744
v_mfma_f32_16x16x32_bf16 v[92:95], v[52:55], a[220:223], v[92:95]
v_rcp_f32 v214, v214
s_waitcnt lgkmcnt(4)
v_mfma_f32_16x16x32_bf16 v[96:99], v[56:59], a[192:195], v[96:99]
v_mul_f32 v213, v213, v212
v_mul_f32 v215, v215, v214
v_mfma_f32_16x16x32_bf16 v[96:99], v[60:63], a[208:211], v[96:99]
v_cvt_pk_bf16_f32 v169, v213, v215
v_mul_f32 v208, v124, v124
v_mfma_f32_16x16x32_bf16 v[100:103], v[56:59], a[196:199], v[100:103]
ds_read_b128 v[48:51], v2 offset:32768
v_mul_f32 v210, v125, v125
v_mfma_f32_16x16x32_bf16 v[100:103], v[60:63], a[212:215], v[100:103]
v_fma_f32 v208, v208, v242, v241
v_fma_f32 v210, v210, v242, v241
v_mfma_f32_16x16x32_bf16 v[104:107], v[56:59], a[200:203], v[104:107]
v_mul_f32 v208, v208, v124
v_mfma_f32_16x16x32_bf16 v[104:107], v[60:63], a[216:219], v[104:107]
v_mul_f32 v210, v210, v125
v_mfma_f32_16x16x32_bf16 v[108:111], v[56:59], a[204:207], v[108:111]
ds_read_b128 v[52:55], v2 offset:33792
v_mfma_f32_16x16x32_bf16 v[108:111], v[60:63], a[220:223], v[108:111]
s_waitcnt lgkmcnt(4)
v_mfma_f32_16x16x32_bf16 v[80:83], v[64:67], a[224:227], v[80:83]
v_exp_f32 v208, v208
v_mfma_f32_16x16x32_bf16 v[80:83], v[68:71], a[240:243], v[80:83]
v_exp_f32 v210, v210
v_mfma_f32_16x16x32_bf16 v[84:87], v[64:67], a[228:231], v[84:87]
ds_read_b128 v[56:59], v2 offset:34816
v_mul_f32 v209, v124, v140
v_mfma_f32_16x16x32_bf16 v[84:87], v[68:71], a[244:247], v[84:87]
v_mul_f32 v211, v125, v141
v_fma_f32 v208, v208, v243, v243
v_mfma_f32_16x16x32_bf16 v[88:91], v[64:67], a[232:235], v[88:91]
v_fma_f32 v210, v210, v243, v243
v_mfma_f32_16x16x32_bf16 v[88:91], v[68:71], a[248:251], v[88:91]
v_rcp_f32 v208, v208
v_mfma_f32_16x16x32_bf16 v[92:95], v[64:67], a[236:239], v[92:95]
ds_read_b128 v[60:63], v2 offset:35840
v_mfma_f32_16x16x32_bf16 v[92:95], v[68:71], a[252:255], v[92:95]
s_waitcnt lgkmcnt(4)
v_mfma_f32_16x16x32_bf16 v[96:99], v[72:75], a[224:227], v[96:99]
v_rcp_f32 v210, v210
v_mfma_f32_16x16x32_bf16 v[96:99], v[76:79], a[240:243], v[96:99]
v_mul_f32 v209, v209, v208
v_mul_f32 v211, v211, v210
v_mfma_f32_16x16x32_bf16 v[100:103], v[72:75], a[228:231], v[100:103]
ds_read_b128 v[64:67], v2 offset:36864
v_cvt_pk_bf16_f32 v172, v209, v211
v_mfma_f32_16x16x32_bf16 v[100:103], v[76:79], a[244:247], v[100:103]
v_mul_f32 v212, v126, v126
v_mul_f32 v214, v127, v127
v_mfma_f32_16x16x32_bf16 v[104:107], v[72:75], a[232:235], v[104:107]
v_fma_f32 v212, v212, v242, v241
v_fma_f32 v214, v214, v242, v241
v_mfma_f32_16x16x32_bf16 v[104:107], v[76:79], a[248:251], v[104:107]
v_mul_f32 v212, v212, v126
v_mfma_f32_16x16x32_bf16 v[108:111], v[72:75], a[236:239], v[108:111]
ds_read_b128 v[68:71], v2 offset:37888
v_mul_f32 v214, v214, v127
v_mfma_f32_16x16x32_bf16 v[108:111], v[76:79], a[252:255], v[108:111]
s_waitcnt lgkmcnt(4)
v_mfma_f32_16x16x32_bf16 v[80:83], v[48:51], v[16:19], v[80:83]
v_exp_f32 v212, v212
v_mfma_f32_16x16x32_bf16 v[80:83], v[52:55], v[32:35], v[80:83]
v_exp_f32 v214, v214
v_mfma_f32_16x16x32_bf16 v[84:87], v[48:51], v[20:23], v[84:87]
ds_read_b128 v[72:75], v2 offset:38912
v_mul_f32 v213, v126, v142
v_mfma_f32_16x16x32_bf16 v[84:87], v[52:55], v[36:39], v[84:87]
v_mul_f32 v215, v127, v143
v_mfma_f32_16x16x32_bf16 v[88:91], v[48:51], v[24:27], v[88:91]
v_fma_f32 v212, v212, v243, v243
v_fma_f32 v214, v214, v243, v243
v_mfma_f32_16x16x32_bf16 v[88:91], v[52:55], v[40:43], v[88:91]
v_mfma_f32_16x16x32_bf16 v[92:95], v[48:51], v[28:31], v[92:95]
ds_read_b128 v[76:79], v2 offset:39936
v_mfma_f32_16x16x32_bf16 v[92:95], v[52:55], v[44:47], v[92:95]
v_rcp_f32 v212, v212
s_waitcnt lgkmcnt(4)
v_mfma_f32_16x16x32_bf16 v[96:99], v[56:59], v[16:19], v[96:99]
v_rcp_f32 v214, v214
v_mfma_f32_16x16x32_bf16 v[96:99], v[60:63], v[32:35], v[96:99]
v_mul_f32 v213, v213, v212
v_mul_f32 v215, v215, v214
v_mfma_f32_16x16x32_bf16 v[100:103], v[56:59], v[20:23], v[100:103]
ds_read_b128 v[48:51], v2 offset:40960
v_cvt_pk_bf16_f32 v173, v213, v215
v_mfma_f32_16x16x32_bf16 v[100:103], v[60:63], v[36:39], v[100:103]
v_mfma_f32_16x16x32_bf16 v[104:107], v[56:59], v[24:27], v[104:107]
v_mfma_f32_16x16x32_bf16 v[104:107], v[60:63], v[40:43], v[104:107]
v_mfma_f32_16x16x32_bf16 v[108:111], v[56:59], v[28:31], v[108:111]
ds_read_b128 v[52:55], v2 offset:41984
v_mfma_f32_16x16x32_bf16 v[108:111], v[60:63], v[44:47], v[108:111]
s_waitcnt lgkmcnt(4)
v_mfma_f32_16x16x32_bf16 v[112:115], v[64:67], a[0:3], 0
v_mfma_f32_16x16x32_bf16 v[112:115], v[68:71], a[16:19], v[112:115]
v_mfma_f32_16x16x32_bf16 v[116:119], v[64:67], a[4:7], 0
ds_read_b128 v[56:59], v2 offset:43008
v_mfma_f32_16x16x32_bf16 v[116:119], v[68:71], a[20:23], v[116:119]
v_mul_f32 v208, v80, v80
v_mfma_f32_16x16x32_bf16 v[120:123], v[64:67], a[8:11], 0
v_mul_f32 v210, v81, v81
v_fma_f32 v208, v208, v233, v232
v_mfma_f32_16x16x32_bf16 v[120:123], v[68:71], a[24:27], v[120:123]
v_fma_f32 v210, v210, v233, v232
v_mfma_f32_16x16x32_bf16 v[124:127], v[64:67], a[12:15], 0
ds_read_b128 v[60:63], v2 offset:44032
v_mul_f32 v208, v208, v80
v_mfma_f32_16x16x32_bf16 v[124:127], v[68:71], a[28:31], v[124:127]
v_mul_f32 v210, v210, v81
s_waitcnt lgkmcnt(4)
v_mfma_f32_16x16x32_bf16 v[128:131], v[72:75], a[0:3], 0
v_exp_f32 v208, v208
v_mfma_f32_16x16x32_bf16 v[128:131], v[76:79], a[16:19], v[128:131]
v_mfma_f32_16x16x32_bf16 v[132:135], v[72:75], a[4:7], 0
ds_read_b128 v[64:67], v2 offset:45056
v_mfma_f32_16x16x32_bf16 v[132:135], v[76:79], a[20:23], v[132:135]
v_exp_f32 v210, v210
v_mfma_f32_16x16x32_bf16 v[136:139], v[72:75], a[8:11], 0
v_mul_f32 v209, v80, v96
v_mul_f32 v211, v81, v97
v_mfma_f32_16x16x32_bf16 v[136:139], v[76:79], a[24:27], v[136:139]
v_fma_f32 v208, v208, v234, v234
v_fma_f32 v210, v210, v234, v234
v_mfma_f32_16x16x32_bf16 v[140:143], v[72:75], a[12:15], 0
ds_read_b128 v[68:71], v2 offset:46080
v_mfma_f32_16x16x32_bf16 v[140:143], v[76:79], a[28:31], v[140:143]
s_waitcnt lgkmcnt(4)
v_mfma_f32_16x16x32_bf16 v[112:115], v[48:51], a[32:35], v[112:115]
v_rcp_f32 v208, v208
v_mfma_f32_16x16x32_bf16 v[112:115], v[52:55], a[48:51], v[112:115]
v_rcp_f32 v210, v210
v_mfma_f32_16x16x32_bf16 v[116:119], v[48:51], a[36:39], v[116:119]
ds_read_b128 v[72:75], v2 offset:47104
v_mul_f32 v209, v209, v208
v_mfma_f32_16x16x32_bf16 v[116:119], v[52:55], a[52:55], v[116:119]
v_mul_f32 v211, v211, v210
v_cvt_pk_bf16_f32 v162, v209, v211
v_mfma_f32_16x16x32_bf16 v[120:123], v[48:51], a[40:43], v[120:123]
v_mul_f32 v212, v82, v82
v_mul_f32 v214, v83, v83
v_mfma_f32_16x16x32_bf16 v[120:123], v[52:55], a[56:59], v[120:123]
v_fma_f32 v212, v212, v233, v232
v_mfma_f32_16x16x32_bf16 v[124:127], v[48:51], a[44:47], v[124:127]
ds_read_b128 v[76:79], v2 offset:48128
v_fma_f32 v214, v214, v233, v232
v_mfma_f32_16x16x32_bf16 v[124:127], v[52:55], a[60:63], v[124:127]
v_mul_f32 v212, v212, v82
s_waitcnt lgkmcnt(4)
v_mfma_f32_16x16x32_bf16 v[128:131], v[56:59], a[32:35], v[128:131]
v_mul_f32 v214, v214, v83
v_mfma_f32_16x16x32_bf16 v[128:131], v[60:63], a[48:51], v[128:131]
v_exp_f32 v212, v212
v_mfma_f32_16x16x32_bf16 v[132:135], v[56:59], a[36:39], v[132:135]
s_waitcnt vmcnt(22)
s_barrier
ds_read_b128 v[48:51], v2 offset:49152
v_mfma_f32_16x16x32_bf16 v[132:135], v[60:63], a[52:55], v[132:135]
s_add_u32 m0, s22, 0
v_mfma_f32_16x16x32_bf16 v[136:139], v[56:59], a[40:43], v[136:139]
v_exp_f32 v214, v214
v_mfma_f32_16x16x32_bf16 v[136:139], v[60:63], a[56:59], v[136:139]
s_add_u32 s23, s21, 294912
v_mul_f32 v213, v82, v98
v_mfma_f32_16x16x32_bf16 v[140:143], v[56:59], a[44:47], v[140:143]
ds_read_b128 v[52:55], v2 offset:50176
v_mul_f32 v215, v83, v99
v_mfma_f32_16x16x32_bf16 v[140:143], v[60:63], a[60:63], v[140:143]
buffer_load_dwordx4 v2, s[8:11], s23 offen offset:0 lds
v_fma_f32 v212, v212, v234, v234
s_waitcnt lgkmcnt(4)
v_mfma_f32_16x16x32_bf16 v[112:115], v[64:67], a[64:67], v[112:115]
v_fma_f32 v214, v214, v234, v234
v_mfma_f32_16x16x32_bf16 v[112:115], v[68:71], a[80:83], v[112:115]
buffer_load_dwordx4 v2, s[8:11], s23 offen offset:1024 lds
v_rcp_f32 v212, v212
v_mfma_f32_16x16x32_bf16 v[116:119], v[64:67], a[68:71], v[116:119]
ds_read_b128 v[56:59], v2 offset:51200
v_rcp_f32 v214, v214
v_mfma_f32_16x16x32_bf16 v[116:119], v[68:71], a[84:87], v[116:119]
buffer_load_dwordx4 v2, s[8:11], s23 offen offset:2048 lds
v_mul_f32 v213, v213, v212
v_mfma_f32_16x16x32_bf16 v[120:123], v[64:67], a[72:75], v[120:123]
v_mul_f32 v215, v215, v214
v_cvt_pk_bf16_f32 v163, v213, v215
v_mfma_f32_16x16x32_bf16 v[120:123], v[68:71], a[88:91], v[120:123]
buffer_load_dwordx4 v2, s[8:11], s23 offen offset:3072 lds
buffer_store_dwordx4 v[160:163], v2, s[8:11], s24 offen offset:1024 sc1
v_mfma_f32_16x16x32_bf16 v[124:127], v[64:67], a[76:79], v[124:127]
ds_read_b128 v[60:63], v2 offset:52224
v_mul_f32 v208, v84, v84
v_mfma_f32_16x16x32_bf16 v[124:127], v[68:71], a[92:95], v[124:127]
s_add_u32 m0, s22, 4096
s_waitcnt lgkmcnt(4)
v_mfma_f32_16x16x32_bf16 v[128:131], v[72:75], a[64:67], v[128:131]
v_mul_f32 v210, v85, v85
v_fma_f32 v208, v208, v236, v235
v_mfma_f32_16x16x32_bf16 v[128:131], v[76:79], a[80:83], v[128:131]
s_add_u32 s23, s21, 299008
v_fma_f32 v210, v210, v236, v235
v_mfma_f32_16x16x32_bf16 v[132:135], v[72:75], a[68:71], v[132:135]
ds_read_b128 v[64:67], v2 offset:53248
v_mul_f32 v208, v208, v84
v_mfma_f32_16x16x32_bf16 v[132:135], v[76:79], a[84:87], v[132:135]
buffer_load_dwordx4 v2, s[8:11], s23 offen offset:0 lds
v_mul_f32 v210, v210, v85
v_mfma_f32_16x16x32_bf16 v[136:139], v[72:75], a[72:75], v[136:139]
v_exp_f32 v208, v208
v_mfma_f32_16x16x32_bf16 v[136:139], v[76:79], a[88:91], v[136:139]
buffer_load_dwordx4 v2, s[8:11], s23 offen offset:1024 lds
v_exp_f32 v210, v210
v_mfma_f32_16x16x32_bf16 v[140:143], v[72:75], a[76:79], v[140:143]
ds_read_b128 v[68:71], v2 offset:54272
v_mul_f32 v209, v84, v100
v_mfma_f32_16x16x32_bf16 v[140:143], v[76:79], a[92:95], v[140:143]
v_mul_f32 v211, v85, v101
s_waitcnt lgkmcnt(4)
v_mfma_f32_16x16x32_bf16 v[112:115], v[48:51], a[96:99], v[112:115]
v_fma_f32 v208, v208, v237, v237
v_fma_f32 v210, v210, v237, v237
v_mfma_f32_16x16x32_bf16 v[112:115], v[52:55], a[112:115], v[112:115]
v_rcp_f32 v208, v208
v_mfma_f32_16x16x32_bf16 v[116:119], v[48:51], a[100:103], v[116:119]
ds_read_b128 v[72:75], v2 offset:55296
v_mfma_f32_16x16x32_bf16 v[116:119], v[52:55], a[116:119], v[116:119]
v_rcp_f32 v210, v210
v_mfma_f32_16x16x32_bf16 v[120:123], v[48:51], a[104:107], v[120:123]
v_mul_f32 v209, v209, v208
v_mul_f32 v211, v211, v210
v_mfma_f32_16x16x32_bf16 v[120:123], v[52:55], a[120:123], v[120:123]
v_cvt_pk_bf16_f32 v166, v209, v211
v_mfma_f32_16x16x32_bf16 v[124:127], v[48:51], a[108:111], v[124:127]
ds_read_b128 v[76:79], v2 offset:56320
v_mul_f32 v212, v86, v86
v_mfma_f32_16x16x32_bf16 v[124:127], v[52:55], a[124:127], v[124:127]
v_mul_f32 v214, v87, v87
s_waitcnt lgkmcnt(4)
v_mfma_f32_16x16x32_bf16 v[128:131], v[56:59], a[96:99], v[128:131]
v_fma_f32 v212, v212, v236, v235
v_fma_f32 v214, v214, v236, v235
v_mfma_f32_16x16x32_bf16 v[128:131], v[60:63], a[112:115], v[128:131]
v_mul_f32 v212, v212, v86
v_mul_f32 v214, v214, v87
v_mfma_f32_16x16x32_bf16 v[132:135], v[56:59], a[100:103], v[132:135]
ds_read_b128 v[48:51], v2 offset:57344
v_mfma_f32_16x16x32_bf16 v[132:135], v[60:63], a[116:119], v[132:135]
v_exp_f32 v212, v212
v_mfma_f32_16x16x32_bf16 v[136:139], v[56:59], a[104:107], v[136:139]
v_mfma_f32_16x16x32_bf16 v[136:139], v[60:63], a[120:123], v[136:139]
v_exp_f32 v214, v214
v_mfma_f32_16x16x32_bf16 v[140:143], v[56:59], a[108:111], v[140:143]
ds_read_b128 v[52:55], v2 offset:58368
v_mul_f32 v213, v86, v102
v_mfma_f32_16x16x32_bf16 v[140:143], v[60:63], a[124:127], v[140:143]
v_mul_f32 v215, v87, v103
s_waitcnt lgkmcnt(4)
v_mfma_f32_16x16x32_bf16 v[112:115], v[64:67], a[128:131], v[112:115]
v_fma_f32 v212, v212, v237, v237
v_fma_f32 v214, v214, v237, v237
v_mfma_f32_16x16x32_bf16 v[112:115], v[68:71], a[144:147], v[112:115]
v_rcp_f32 v212, v212
v_mfma_f32_16x16x32_bf16 v[116:119], v[64:67], a[132:135], v[116:119]
ds_read_b128 v[56:59], v2 offset:59392
v_mfma_f32_16x16x32_bf16 v[116:119], v[68:71], a[148:151], v[116:119]
v_rcp_f32 v214, v214
v_mfma_f32_16x16x32_bf16 v[120:123], v[64:67], a[136:139], v[120:123]
v_mul_f32 v213, v213, v212
v_mfma_f32_16x16x32_bf16 v[120:123], v[68:71], a[152:155], v[120:123]
v_mul_f32 v215, v215, v214
v_cvt_pk_bf16_f32 v167, v213, v215
v_mfma_f32_16x16x32_bf16 v[124:127], v[64:67], a[140:143], v[124:127]
ds_read_b128 v[60:63], v2 offset:60416
buffer_store_dwordx4 v[164:167], v4, s[8:11], s24 offen offset:1024 sc1
v_mfma_f32_16x16x32_bf16 v[124:127], v[68:71], a[156:159], v[124:127]
v_mul_f32 v208, v88, v88
s_waitcnt lgkmcnt(4)
v_mfma_f32_16x16x32_bf16 v[128:131], v[72:75], a[128:131], v[128:131]
v_mul_f32 v210, v89, v89
v_fma_f32 v208, v208, v239, v238
v_mfma_f32_16x16x32_bf16 v[128:131], v[76:79], a[144:147], v[128:131]
v_fma_f32 v210, v210, v239, v238
v_mfma_f32_16x16x32_bf16 v[132:135], v[72:75], a[132:135], v[132:135]
ds_read_b128 v[64:67], v2 offset:61440
v_mul_f32 v208, v208, v88
v_mfma_f32_16x16x32_bf16 v[132:135], v[76:79], a[148:151], v[132:135]
v_mul_f32 v210, v210, v89
v_mfma_f32_16x16x32_bf16 v[136:139], v[72:75], a[136:139], v[136:139]
v_exp_f32 v208, v208
v_mfma_f32_16x16x32_bf16 v[136:139], v[76:79], a[152:155], v[136:139]
v_mfma_f32_16x16x32_bf16 v[140:143], v[72:75], a[140:143], v[140:143]
ds_read_b128 v[68:71], v2 offset:62464
v_mfma_f32_16x16x32_bf16 v[140:143], v[76:79], a[156:159], v[140:143]
v_exp_f32 v210, v210
s_waitcnt lgkmcnt(4)
v_mfma_f32_16x16x32_bf16 v[112:115], v[48:51], a[160:163], v[112:115]
v_mul_f32 v209, v88, v104
v_mul_f32 v211, v89, v105
v_mfma_f32_16x16x32_bf16 v[112:115], v[52:55], a[176:179], v[112:115]
v_fma_f32 v208, v208, v240, v240
v_fma_f32 v210, v210, v240, v240
v_mfma_f32_16x16x32_bf16 v[116:119], v[48:51], a[164:167], v[116:119]
ds_read_b128 v[72:75], v2 offset:63488
v_mfma_f32_16x16x32_bf16 v[116:119], v[52:55], a[180:183], v[116:119]
v_rcp_f32 v208, v208
v_mfma_f32_16x16x32_bf16 v[120:123], v[48:51], a[168:171], v[120:123]
v_rcp_f32 v210, v210
v_mfma_f32_16x16x32_bf16 v[120:123], v[52:55], a[184:187], v[120:123]
v_mul_f32 v209, v209, v208
v_mfma_f32_16x16x32_bf16 v[124:127], v[48:51], a[172:175], v[124:127]
ds_read_b128 v[76:79], v2 offset:64512
v_mul_f32 v211, v211, v210
v_mfma_f32_16x16x32_bf16 v[124:127], v[52:55], a[188:191], v[124:127]
v_cvt_pk_bf16_f32 v170, v209, v211
s_waitcnt lgkmcnt(4)
v_mfma_f32_16x16x32_bf16 v[128:131], v[56:59], a[160:163], v[128:131]
v_mul_f32 v212, v90, v90
v_mul_f32 v214, v91, v91
v_mfma_f32_16x16x32_bf16 v[128:131], v[60:63], a[176:179], v[128:131]
v_fma_f32 v212, v212, v239, v238
v_mfma_f32_16x16x32_bf16 v[132:135], v[56:59], a[164:167], v[132:135]
ds_read_b128 v[48:51], v7 offset:0
v_fma_f32 v214, v214, v239, v238
v_mfma_f32_16x16x32_bf16 v[132:135], v[60:63], a[180:183], v[132:135]
v_mul_f32 v212, v212, v90
v_mul_f32 v214, v214, v91
v_mfma_f32_16x16x32_bf16 v[136:139], v[56:59], a[168:171], v[136:139]
v_mfma_f32_16x16x32_bf16 v[136:139], v[60:63], a[184:187], v[136:139]
v_exp_f32 v212, v212
v_mfma_f32_16x16x32_bf16 v[140:143], v[56:59], a[172:175], v[140:143]
ds_read_b128 v[52:55], v7 offset:1024
v_mfma_f32_16x16x32_bf16 v[140:143], v[60:63], a[188:191], v[140:143]
s_waitcnt lgkmcnt(4)
v_mfma_f32_16x16x32_bf16 v[112:115], v[64:67], a[192:195], v[112:115]
v_exp_f32 v214, v214
v_mfma_f32_16x16x32_bf16 v[112:115], v[68:71], a[208:211], v[112:115]
v_mul_f32 v213, v90, v106
v_mul_f32 v215, v91, v107
v_mfma_f32_16x16x32_bf16 v[116:119], v[64:67], a[196:199], v[116:119]
ds_read_b128 v[56:59], v7 offset:2048
v_fma_f32 v212, v212, v240, v240
v_mfma_f32_16x16x32_bf16 v[116:119], v[68:71], a[212:215], v[116:119]
v_fma_f32 v214, v214, v240, v240
v_mfma_f32_16x16x32_bf16 v[120:123], v[64:67], a[200:203], v[120:123]
v_rcp_f32 v212, v212
v_mfma_f32_16x16x32_bf16 v[120:123], v[68:71], a[216:219], v[120:123]
v_rcp_f32 v214, v214
v_mfma_f32_16x16x32_bf16 v[124:127], v[64:67], a[204:207], v[124:127]
ds_read_b128 v[60:63], v7 offset:3072
v_mul_f32 v213, v213, v212
v_mfma_f32_16x16x32_bf16 v[124:127], v[68:71], a[220:223], v[124:127]
v_mul_f32 v215, v215, v214
s_waitcnt lgkmcnt(4)
v_mfma_f32_16x16x32_bf16 v[128:131], v[72:75], a[192:195], v[128:131]
v_cvt_pk_bf16_f32 v171, v213, v215
buffer_store_dwordx4 v[168:171], v5, s[8:11], s24 offen offset:1024 sc1
v_mfma_f32_16x16x32_bf16 v[128:131], v[76:79], a[208:211], v[128:131]
v_mul_f32 v208, v92, v92
v_mfma_f32_16x16x32_bf16 v[132:135], v[72:75], a[196:199], v[132:135]
ds_read_b128 v[64:67], v7 offset:4096
v_mul_f32 v210, v93, v93
v_mfma_f32_16x16x32_bf16 v[132:135], v[76:79], a[212:215], v[132:135]
v_fma_f32 v208, v208, v242, v241
v_fma_f32 v210, v210, v242, v241
v_mfma_f32_16x16x32_bf16 v[136:139], v[72:75], a[200:203], v[136:139]
v_mul_f32 v208, v208, v92
v_mfma_f32_16x16x32_bf16 v[136:139], v[76:79], a[216:219], v[136:139]
v_mul_f32 v210, v210, v93
v_mfma_f32_16x16x32_bf16 v[140:143], v[72:75], a[204:207], v[140:143]
ds_read_b128 v[68:71], v7 offset:5120
v_mfma_f32_16x16x32_bf16 v[140:143], v[76:79], a[220:223], v[140:143]
s_waitcnt lgkmcnt(4)
v_mfma_f32_16x16x32_bf16 v[112:115], v[48:51], a[224:227], v[112:115]
v_exp_f32 v208, v208
v_mfma_f32_16x16x32_bf16 v[112:115], v[52:55], a[240:243], v[112:115]
v_exp_f32 v210, v210
v_mfma_f32_16x16x32_bf16 v[116:119], v[48:51], a[228:231], v[116:119]
ds_read_b128 v[72:75], v7 offset:6144
v_mul_f32 v209, v92, v108
v_mfma_f32_16x16x32_bf16 v[116:119], v[52:55], a[244:247], v[116:119]
v_mul_f32 v211, v93, v109
v_fma_f32 v208, v208, v243, v243
v_mfma_f32_16x16x32_bf16 v[120:123], v[48:51], a[232:235], v[120:123]
v_fma_f32 v210, v210, v243, v243
v_mfma_f32_16x16x32_bf16 v[120:123], v[52:55], a[248:251], v[120:123]
v_rcp_f32 v208, v208
v_mfma_f32_16x16x32_bf16 v[124:127], v[48:51], a[236:239], v[124:127]
ds_read_b128 v[76:79], v7 offset:7168
v_mfma_f32_16x16x32_bf16 v[124:127], v[52:55], a[252:255], v[124:127]
s_waitcnt lgkmcnt(4)
v_mfma_f32_16x16x32_bf16 v[128:131], v[56:59], a[224:227], v[128:131]
v_rcp_f32 v210, v210
v_mfma_f32_16x16x32_bf16 v[128:131], v[60:63], a[240:243], v[128:131]
v_mul_f32 v209, v209, v208
v_mul_f32 v211, v211, v210
v_mfma_f32_16x16x32_bf16 v[132:135], v[56:59], a[228:231], v[132:135]
s_waitcnt vmcnt(24)
s_barrier
ds_read_b128 v[48:51], v7 offset:8192
v_mfma_f32_16x16x32_bf16 v[132:135], v[60:63], a[244:247], v[132:135]
s_add_u32 m0, s22, 24576
v_cvt_pk_bf16_f32 v174, v209, v211
v_mul_f32 v212, v94, v94
v_mfma_f32_16x16x32_bf16 v[136:139], v[56:59], a[232:235], v[136:139]
v_mul_f32 v214, v95, v95
v_fma_f32 v212, v212, v242, v241
v_mfma_f32_16x16x32_bf16 v[136:139], v[60:63], a[248:251], v[136:139]
s_add_u32 s23, s21, 319488
v_fma_f32 v214, v214, v242, v241
v_mfma_f32_16x16x32_bf16 v[140:143], v[56:59], a[236:239], v[140:143]
ds_read_b128 v[52:55], v7 offset:9216
v_mul_f32 v212, v212, v94
v_mfma_f32_16x16x32_bf16 v[140:143], v[60:63], a[252:255], v[140:143]
buffer_load_dwordx4 v2, s[8:11], s23 offen offset:0 lds
v_mul_f32 v214, v214, v95
s_waitcnt lgkmcnt(4)
v_mfma_f32_16x16x32_bf16 v[112:115], v[64:67], v[16:19], v[112:115]
v_exp_f32 v212, v212
v_mfma_f32_16x16x32_bf16 v[112:115], v[68:71], v[32:35], v[112:115]
buffer_load_dwordx4 v2, s[8:11], s23 offen offset:1024 lds
v_mfma_f32_16x16x32_bf16 v[116:119], v[64:67], v[20:23], v[116:119]
ds_read_b128 v[56:59], v7 offset:10240
v_exp_f32 v214, v214
v_mfma_f32_16x16x32_bf16 v[116:119], v[68:71], v[36:39], v[116:119]
buffer_load_dwordx4 v2, s[8:11], s23 offen offset:2048 lds
v_mul_f32 v213, v94, v110
v_mfma_f32_16x16x32_bf16 v[120:123], v[64:67], v[24:27], v[120:123]
v_mul_f32 v215, v95, v111
v_fma_f32 v212, v212, v243, v243
v_mfma_f32_16x16x32_bf16 v[120:123], v[68:71], v[40:43], v[120:123]
buffer_load_dwordx4 v2, s[8:11], s23 offen offset:3072 lds
v_fma_f32 v214, v214, v243, v243
v_mfma_f32_16x16x32_bf16 v[124:127], v[64:67], v[28:31], v[124:127]
ds_read_b128 v[60:63], v7 offset:11264
v_mfma_f32_16x16x32_bf16 v[124:127], v[68:71], v[44:47], v[124:127]
s_add_u32 m0, s22, 28672
v_rcp_f32 v212, v212
s_waitcnt lgkmcnt(4)
v_mfma_f32_16x16x32_bf16 v[128:131], v[72:75], v[16:19], v[128:131]
v_rcp_f32 v214, v214
v_mfma_f32_16x16x32_bf16 v[128:131], v[76:79], v[32:35], v[128:131]
s_add_u32 s23, s21, 323584
v_mul_f32 v213, v213, v212
v_mfma_f32_16x16x32_bf16 v[132:135], v[72:75], v[20:23], v[132:135]
ds_read_b128 v[64:67], v7 offset:12288
v_mul_f32 v215, v215, v214
v_mfma_f32_16x16x32_bf16 v[132:135], v[76:79], v[36:39], v[132:135]
buffer_load_dwordx4 v2, s[8:11], s23 offen offset:0 lds
v_cvt_pk_bf16_f32 v175, v213, v215
v_mfma_f32_16x16x32_bf16 v[136:139], v[72:75], v[24:27], v[136:139]
buffer_store_dwordx4 v[172:175], v6, s[8:11], s24 offen offset:1024 sc1
v_mfma_f32_16x16x32_bf16 v[136:139], v[76:79], v[40:43], v[136:139]
buffer_load_dwordx4 v2, s[8:11], s23 offen offset:1024 lds
v_mfma_f32_16x16x32_bf16 v[140:143], v[72:75], v[28:31], v[140:143]
ds_read_b128 v[68:71], v7 offset:13312
v_mfma_f32_16x16x32_bf16 v[140:143], v[76:79], v[44:47], v[140:143]
s_waitcnt lgkmcnt(4)
v_mfma_f32_16x16x32_bf16 v[80:83], v[48:51], a[0:3], 0
v_mfma_f32_16x16x32_bf16 v[80:83], v[52:55], a[16:19], v[80:83]
v_mfma_f32_16x16x32_bf16 v[84:87], v[48:51], a[4:7], 0
ds_read_b128 v[72:75], v7 offset:14336
v_mfma_f32_16x16x32_bf16 v[84:87], v[52:55], a[20:23], v[84:87]
v_mul_f32 v208, v112, v112
v_mfma_f32_16x16x32_bf16 v[88:91], v[48:51], a[8:11], 0
v_mul_f32 v210, v113, v113
v_mfma_f32_16x16x32_bf16 v[88:91], v[52:55], a[24:27], v[88:91]
v_fma_f32 v208, v208, v233, v232
v_fma_f32 v210, v210, v233, v232
v_mfma_f32_16x16x32_bf16 v[92:95], v[48:51], a[12:15], 0
ds_read_b128 v[76:79], v7 offset:15360
v_mul_f32 v208, v208, v112
v_mfma_f32_16x16x32_bf16 v[92:95], v[52:55], a[28:31], v[92:95]
v_mul_f32 v210, v210, v113
s_waitcnt lgkmcnt(4)
v_mfma_f32_16x16x32_bf16 v[96:99], v[56:59], a[0:3], 0
v_mfma_f32_16x16x32_bf16 v[96:99], v[60:63], a[16:19], v[96:99]
v_exp_f32 v208, v208
v_mfma_f32_16x16x32_bf16 v[100:103], v[56:59], a[4:7], 0
ds_read_b128 v[48:51], v7 offset:16384
v_mfma_f32_16x16x32_bf16 v[100:103], v[60:63], a[20:23], v[100:103]
v_exp_f32 v210, v210
v_mfma_f32_16x16x32_bf16 v[104:107], v[56:59], a[8:11], 0
v_mul_f32 v209, v112, v128
v_mul_f32 v211, v113, v129
v_mfma_f32_16x16x32_bf16 v[104:107], v[60:63], a[24:27], v[104:107]
v_fma_f32 v208, v208, v234, v234
v_fma_f32 v210, v210, v234, v234
v_mfma_f32_16x16x32_bf16 v[108:111], v[56:59], a[12:15], 0
ds_read_b128 v[52:55], v7 offset:17408
v_mfma_f32_16x16x32_bf16 v[108:111], v[60:63], a[28:31], v[108:111]
s_waitcnt lgkmcnt(4)
v_mfma_f32_16x16x32_bf16 v[80:83], v[64:67], a[32:35], v[80:83]
v_rcp_f32 v208, v208
v_mfma_f32_16x16x32_bf16 v[80:83], v[68:71], a[48:51], v[80:83]
v_rcp_f32 v210, v210
v_mfma_f32_16x16x32_bf16 v[84:87], v[64:67], a[36:39], v[84:87]
ds_read_b128 v[56:59], v7 offset:18432
v_mul_f32 v209, v209, v208
v_mfma_f32_16x16x32_bf16 v[84:87], v[68:71], a[52:55], v[84:87]
v_mul_f32 v211, v211, v210
v_cvt_pk_bf16_f32 v176, v209, v211
v_mfma_f32_16x16x32_bf16 v[88:91], v[64:67], a[40:43], v[88:91]
v_mul_f32 v212, v114, v114
v_mfma_f32_16x16x32_bf16 v[88:91], v[68:71], a[56:59], v[88:91]
v_mul_f32 v214, v115, v115
v_mfma_f32_16x16x32_bf16 v[92:95], v[64:67], a[44:47], v[92:95]
ds_read_b128 v[60:63], v7 offset:19456
v_fma_f32 v212, v212, v233, v232
v_mfma_f32_16x16x32_bf16 v[92:95], v[68:71], a[60:63], v[92:95]
v_fma_f32 v214, v214, v233, v232
s_waitcnt lgkmcnt(4)
v_mfma_f32_16x16x32_bf16 v[96:99], v[72:75], a[32:35], v[96:99]
v_mul_f32 v212, v212, v114
v_mul_f32 v214, v214, v115
v_mfma_f32_16x16x32_bf16 v[96:99], v[76:79], a[48:51], v[96:99]
v_mfma_f32_16x16x32_bf16 v[100:103], v[72:75], a[36:39], v[100:103]
ds_read_b128 v[64:67], v7 offset:20480
v_mfma_f32_16x16x32_bf16 v[100:103], v[76:79], a[52:55], v[100:103]
v_exp_f32 v212, v212
v_mfma_f32_16x16x32_bf16 v[104:107], v[72:75], a[40:43], v[104:107]
v_exp_f32 v214, v214
v_mfma_f32_16x16x32_bf16 v[104:107], v[76:79], a[56:59], v[104:107]
v_mul_f32 v213, v114, v130
v_mul_f32 v215, v115, v131
v_mfma_f32_16x16x32_bf16 v[108:111], v[72:75], a[44:47], v[108:111]
ds_read_b128 v[68:71], v7 offset:21504
v_fma_f32 v212, v212, v234, v234
v_mfma_f32_16x16x32_bf16 v[108:111], v[76:79], a[60:63], v[108:111]
v_fma_f32 v214, v214, v234, v234
s_waitcnt lgkmcnt(4)
v_mfma_f32_16x16x32_bf16 v[80:83], v[48:51], a[64:67], v[80:83]
v_rcp_f32 v212, v212
v_mfma_f32_16x16x32_bf16 v[80:83], v[52:55], a[80:83], v[80:83]
v_mfma_f32_16x16x32_bf16 v[84:87], v[48:51], a[68:71], v[84:87]
ds_read_b128 v[72:75], v7 offset:22528
v_mfma_f32_16x16x32_bf16 v[84:87], v[52:55], a[84:87], v[84:87]
v_rcp_f32 v214, v214
v_mfma_f32_16x16x32_bf16 v[88:91], v[48:51], a[72:75], v[88:91]
v_mul_f32 v213, v213, v212
v_mul_f32 v215, v215, v214
v_mfma_f32_16x16x32_bf16 v[88:91], v[52:55], a[88:91], v[88:91]
v_cvt_pk_bf16_f32 v177, v213, v215
v_mul_f32 v208, v116, v116
v_mfma_f32_16x16x32_bf16 v[92:95], v[48:51], a[76:79], v[92:95]
ds_read_b128 v[76:79], v7 offset:23552
v_mul_f32 v210, v117, v117
v_mfma_f32_16x16x32_bf16 v[92:95], v[52:55], a[92:95], v[92:95]
v_fma_f32 v208, v208, v236, v235
s_waitcnt lgkmcnt(4)
v_mfma_f32_16x16x32_bf16 v[96:99], v[56:59], a[64:67], v[96:99]
v_fma_f32 v210, v210, v236, v235
v_mul_f32 v208, v208, v116
v_mfma_f32_16x16x32_bf16 v[96:99], v[60:63], a[80:83], v[96:99]
v_mul_f32 v210, v210, v117
v_mfma_f32_16x16x32_bf16 v[100:103], v[56:59], a[68:71], v[100:103]
ds_read_b128 v[48:51], v7 offset:24576
v_mfma_f32_16x16x32_bf16 v[100:103], v[60:63], a[84:87], v[100:103]
v_exp_f32 v208, v208
v_mfma_f32_16x16x32_bf16 v[104:107], v[56:59], a[72:75], v[104:107]
v_exp_f32 v210, v210
v_mfma_f32_16x16x32_bf16 v[104:107], v[60:63], a[88:91], v[104:107]
v_mul_f32 v209, v116, v132
v_mfma_f32_16x16x32_bf16 v[108:111], v[56:59], a[76:79], v[108:111]
ds_read_b128 v[52:55], v7 offset:25600
v_mul_f32 v211, v117, v133
v_mfma_f32_16x16x32_bf16 v[108:111], v[60:63], a[92:95], v[108:111]
v_fma_f32 v208, v208, v237, v237
s_waitcnt lgkmcnt(4)
v_mfma_f32_16x16x32_bf16 v[80:83], v[64:67], a[96:99], v[80:83]
v_fma_f32 v210, v210, v237, v237
v_mfma_f32_16x16x32_bf16 v[80:83], v[68:71], a[112:115], v[80:83]
v_rcp_f32 v208, v208
v_mfma_f32_16x16x32_bf16 v[84:87], v[64:67], a[100:103], v[84:87]
ds_read_b128 v[56:59], v7 offset:26624
v_mfma_f32_16x16x32_bf16 v[84:87], v[68:71], a[116:119], v[84:87]
v_rcp_f32 v210, v210
v_mfma_f32_16x16x32_bf16 v[88:91], v[64:67], a[104:107], v[88:91]
v_mul_f32 v209, v209, v208
v_mul_f32 v211, v211, v210
v_mfma_f32_16x16x32_bf16 v[88:91], v[68:71], a[120:123], v[88:91]
v_cvt_pk_bf16_f32 v180, v209, v211
v_mfma_f32_16x16x32_bf16 v[92:95], v[64:67], a[108:111], v[92:95]
ds_read_b128 v[60:63], v7 offset:27648
v_mul_f32 v212, v118, v118
v_mfma_f32_16x16x32_bf16 v[92:95], v[68:71], a[124:127], v[92:95]
v_mul_f32 v214, v119, v119
s_waitcnt lgkmcnt(4)
v_mfma_f32_16x16x32_bf16 v[96:99], v[72:75], a[96:99], v[96:99]
v_fma_f32 v212, v212, v236, v235
v_fma_f32 v214, v214, v236, v235
v_mfma_f32_16x16x32_bf16 v[96:99], v[76:79], a[112:115], v[96:99]
v_mul_f32 v212, v212, v118
v_mfma_f32_16x16x32_bf16 v[100:103], v[72:75], a[100:103], v[100:103]
ds_read_b128 v[64:67], v7 offset:28672
v_mul_f32 v214, v214, v119
v_mfma_f32_16x16x32_bf16 v[100:103], v[76:79], a[116:119], v[100:103]
v_mfma_f32_16x16x32_bf16 v[104:107], v[72:75], a[104:107], v[104:107]
v_exp_f32 v212, v212
v_mfma_f32_16x16x32_bf16 v[104:107], v[76:79], a[120:123], v[104:107]
v_exp_f32 v214, v214
v_mfma_f32_16x16x32_bf16 v[108:111], v[72:75], a[108:111], v[108:111]
ds_read_b128 v[68:71], v7 offset:29696
v_mul_f32 v213, v118, v134
v_mfma_f32_16x16x32_bf16 v[108:111], v[76:79], a[124:127], v[108:111]
v_mul_f32 v215, v119, v135
s_waitcnt lgkmcnt(4)
v_mfma_f32_16x16x32_bf16 v[80:83], v[48:51], a[128:131], v[80:83]
v_fma_f32 v212, v212, v237, v237
v_fma_f32 v214, v214, v237, v237
v_mfma_f32_16x16x32_bf16 v[80:83], v[52:55], a[144:147], v[80:83]
v_mfma_f32_16x16x32_bf16 v[84:87], v[48:51], a[132:135], v[84:87]
ds_read_b128 v[72:75], v7 offset:30720
v_mfma_f32_16x16x32_bf16 v[84:87], v[52:55], a[148:151], v[84:87]
v_rcp_f32 v212, v212
v_mfma_f32_16x16x32_bf16 v[88:91], v[48:51], a[136:139], v[88:91]
v_rcp_f32 v214, v214
v_mfma_f32_16x16x32_bf16 v[88:91], v[52:55], a[152:155], v[88:91]
v_mul_f32 v213, v213, v212
v_mul_f32 v215, v215, v214
v_mfma_f32_16x16x32_bf16 v[92:95], v[48:51], a[140:143], v[92:95]
ds_read_b128 v[76:79], v7 offset:31744
v_cvt_pk_bf16_f32 v181, v213, v215
v_mfma_f32_16x16x32_bf16 v[92:95], v[52:55], a[156:159], v[92:95]
v_mul_f32 v208, v120, v120
s_waitcnt lgkmcnt(4)
v_mfma_f32_16x16x32_bf16 v[96:99], v[56:59], a[128:131], v[96:99]
v_mul_f32 v210, v121, v121
v_mfma_f32_16x16x32_bf16 v[96:99], v[60:63], a[144:147], v[96:99]
v_fma_f32 v208, v208, v239, v238
v_fma_f32 v210, v210, v239, v238
v_mfma_f32_16x16x32_bf16 v[100:103], v[56:59], a[132:135], v[100:103]
s_waitcnt vmcnt(0)
s_barrier
v_mov_b32 v12, 1
buffer_store_dword v12, v10, s[8:11], s34 offen sc1
ds_read_b128 v[48:51], v7 offset:32768
v_mfma_f32_16x16x32_bf16 v[100:103], v[60:63], a[148:151], v[100:103]
s_add_u32 m0, s22, 49152
v_mul_f32 v208, v208, v120
v_mfma_f32_16x16x32_bf16 v[104:107], v[56:59], a[136:139], v[104:107]
v_mul_f32 v210, v210, v121
v_mfma_f32_16x16x32_bf16 v[104:107], v[60:63], a[152:155], v[104:107]
s_add_u32 s23, s21, 344064
v_mfma_f32_16x16x32_bf16 v[108:111], v[56:59], a[140:143], v[108:111]
ds_read_b128 v[52:55], v7 offset:33792
v_exp_f32 v208, v208
v_mfma_f32_16x16x32_bf16 v[108:111], v[60:63], a[156:159], v[108:111]
buffer_load_dwordx4 v2, s[8:11], s23 offen offset:0 lds
v_exp_f32 v210, v210
s_waitcnt lgkmcnt(4)
v_mfma_f32_16x16x32_bf16 v[80:83], v[64:67], a[160:163], v[80:83]
v_mul_f32 v209, v120, v136
v_mul_f32 v211, v121, v137
v_mfma_f32_16x16x32_bf16 v[80:83], v[68:71], a[176:179], v[80:83]
buffer_load_dwordx4 v2, s[8:11], s23 offen offset:1024 lds
v_fma_f32 v208, v208, v240, v240
v_mfma_f32_16x16x32_bf16 v[84:87], v[64:67], a[164:167], v[84:87]
ds_read_b128 v[56:59], v7 offset:34816
v_fma_f32 v210, v210, v240, v240
v_mfma_f32_16x16x32_bf16 v[84:87], v[68:71], a[180:183], v[84:87]
buffer_load_dwordx4 v2, s[8:11], s23 offen offset:2048 lds
v_mfma_f32_16x16x32_bf16 v[88:91], v[64:67], a[168:171], v[88:91]
v_rcp_f32 v208, v208
v_mfma_f32_16x16x32_bf16 v[88:91], v[68:71], a[184:187], v[88:91]
buffer_load_dwordx4 v2, s[8:11], s23 offen offset:3072 lds
v_mfma_f32_16x16x32_bf16 v[92:95], v[64:67], a[172:175], v[92:95]
ds_read_b128 v[60:63], v7 offset:35840
v_rcp_f32 v210, v210
v_mfma_f32_16x16x32_bf16 v[92:95], v[68:71], a[188:191], v[92:95]
s_add_u32 m0, s22, 53248
v_mul_f32 v209, v209, v208
s_waitcnt lgkmcnt(4)
v_mfma_f32_16x16x32_bf16 v[96:99], v[72:75], a[160:163], v[96:99]
v_mul_f32 v211, v211, v210
v_cvt_pk_bf16_f32 v184, v209, v211
v_mfma_f32_16x16x32_bf16 v[96:99], v[76:79], a[176:179], v[96:99]
s_add_u32 s23, s21, 348160
v_mul_f32 v212, v122, v122
v_mfma_f32_16x16x32_bf16 v[100:103], v[72:75], a[164:167], v[100:103]
ds_read_b128 v[64:67], v7 offset:36864
v_mul_f32 v214, v123, v123
v_mfma_f32_16x16x32_bf16 v[100:103], v[76:79], a[180:183], v[100:103]
buffer_load_dwordx4 v2, s[8:11], s23 offen offset:0 lds
v_fma_f32 v212, v212, v239, v238
v_mfma_f32_16x16x32_bf16 v[104:107], v[72:75], a[168:171], v[104:107]
v_fma_f32 v214, v214, v239, v238
v_mul_f32 v212, v212, v122
v_mfma_f32_16x16x32_bf16 v[104:107], v[76:79], a[184:187], v[104:107]
buffer_load_dwordx4 v2, s[8:11], s23 offen offset:1024 lds
v_mul_f32 v214, v214, v123
v_mfma_f32_16x16x32_bf16 v[108:111], v[72:75], a[172:175], v[108:111]
ds_read_b128 v[68:71], v7 offset:37888
v_mfma_f32_16x16x32_bf16 v[108:111], v[76:79], a[188:191], v[108:111]
v_exp_f32 v212, v212
s_waitcnt lgkmcnt(4)
v_mfma_f32_16x16x32_bf16 v[80:83], v[48:51], a[192:195], v[80:83]
v_exp_f32 v214, v214
v_mfma_f32_16x16x32_bf16 v[80:83], v[52:55], a[208:211], v[80:83]
v_mul_f32 v213, v122, v138
v_mul_f32 v215, v123, v139
v_mfma_f32_16x16x32_bf16 v[84:87], v[48:51], a[196:199], v[84:87]
ds_read_b128 v[72:75], v7 offset:38912
v_fma_f32 v212, v212, v240, v240
v_mfma_f32_16x16x32_bf16 v[84:87], v[52:55], a[212:215], v[84:87]
v_fma_f32 v214, v214, v240, v240
v_mfma_f32_16x16x32_bf16 v[88:91], v[48:51], a[200:203], v[88:91]
v_rcp_f32 v212, v212
v_mfma_f32_16x16x32_bf16 v[88:91], v[52:55], a[216:219], v[88:91]
v_mfma_f32_16x16x32_bf16 v[92:95], v[48:51], a[204:207], v[92:95]
ds_read_b128 v[76:79], v7 offset:39936
v_mfma_f32_16x16x32_bf16 v[92:95], v[52:55], a[220:223], v[92:95]
v_rcp_f32 v214, v214
s_waitcnt lgkmcnt(4)
v_mfma_f32_16x16x32_bf16 v[96:99], v[56:59], a[192:195], v[96:99]
v_mul_f32 v213, v213, v212
v_mul_f32 v215, v215, v214
v_mfma_f32_16x16x32_bf16 v[96:99], v[60:63], a[208:211], v[96:99]
v_cvt_pk_bf16_f32 v185, v213, v215
v_mul_f32 v208, v124, v124
v_mfma_f32_16x16x32_bf16 v[100:103], v[56:59], a[196:199], v[100:103]
ds_read_b128 v[48:51], v7 offset:40960
v_mul_f32 v210, v125, v125
v_mfma_f32_16x16x32_bf16 v[100:103], v[60:63], a[212:215], v[100:103]
v_fma_f32 v208, v208, v242, v241
v_fma_f32 v210, v210, v242, v241
v_mfma_f32_16x16x32_bf16 v[104:107], v[56:59], a[200:203], v[104:107]
v_mul_f32 v208, v208, v124
v_mfma_f32_16x16x32_bf16 v[104:107], v[60:63], a[216:219], v[104:107]
v_mul_f32 v210, v210, v125
v_mfma_f32_16x16x32_bf16 v[108:111], v[56:59], a[204:207], v[108:111]
ds_read_b128 v[52:55], v7 offset:41984
v_mfma_f32_16x16x32_bf16 v[108:111], v[60:63], a[220:223], v[108:111]
s_waitcnt lgkmcnt(4)
v_mfma_f32_16x16x32_bf16 v[80:83], v[64:67], a[224:227], v[80:83]
v_exp_f32 v208, v208
v_mfma_f32_16x16x32_bf16 v[80:83], v[68:71], a[240:243], v[80:83]
v_exp_f32 v210, v210
v_mfma_f32_16x16x32_bf16 v[84:87], v[64:67], a[228:231], v[84:87]
ds_read_b128 v[56:59], v7 offset:43008
v_mul_f32 v209, v124, v140
v_mfma_f32_16x16x32_bf16 v[84:87], v[68:71], a[244:247], v[84:87]
v_mul_f32 v211, v125, v141
v_fma_f32 v208, v208, v243, v243
v_mfma_f32_16x16x32_bf16 v[88:91], v[64:67], a[232:235], v[88:91]
v_fma_f32 v210, v210, v243, v243
v_mfma_f32_16x16x32_bf16 v[88:91], v[68:71], a[248:251], v[88:91]
v_rcp_f32 v208, v208
v_mfma_f32_16x16x32_bf16 v[92:95], v[64:67], a[236:239], v[92:95]
ds_read_b128 v[60:63], v7 offset:44032
v_mfma_f32_16x16x32_bf16 v[92:95], v[68:71], a[252:255], v[92:95]
s_waitcnt lgkmcnt(4)
v_mfma_f32_16x16x32_bf16 v[96:99], v[72:75], a[224:227], v[96:99]
v_rcp_f32 v210, v210
v_mfma_f32_16x16x32_bf16 v[96:99], v[76:79], a[240:243], v[96:99]
v_mul_f32 v209, v209, v208
v_mul_f32 v211, v211, v210
v_mfma_f32_16x16x32_bf16 v[100:103], v[72:75], a[228:231], v[100:103]
ds_read_b128 v[64:67], v7 offset:45056
v_cvt_pk_bf16_f32 v188, v209, v211
v_mfma_f32_16x16x32_bf16 v[100:103], v[76:79], a[244:247], v[100:103]
v_mul_f32 v212, v126, v126
v_mul_f32 v214, v127, v127
v_mfma_f32_16x16x32_bf16 v[104:107], v[72:75], a[232:235], v[104:107]
v_fma_f32 v212, v212, v242, v241
v_fma_f32 v214, v214, v242, v241
v_mfma_f32_16x16x32_bf16 v[104:107], v[76:79], a[248:251], v[104:107]
v_mul_f32 v212, v212, v126
v_mfma_f32_16x16x32_bf16 v[108:111], v[72:75], a[236:239], v[108:111]
ds_read_b128 v[68:71], v7 offset:46080
v_mul_f32 v214, v214, v127
v_mfma_f32_16x16x32_bf16 v[108:111], v[76:79], a[252:255], v[108:111]
s_waitcnt lgkmcnt(4)
v_mfma_f32_16x16x32_bf16 v[80:83], v[48:51], v[16:19], v[80:83]
v_exp_f32 v212, v212
v_mfma_f32_16x16x32_bf16 v[80:83], v[52:55], v[32:35], v[80:83]
v_exp_f32 v214, v214
v_mfma_f32_16x16x32_bf16 v[84:87], v[48:51], v[20:23], v[84:87]
ds_read_b128 v[72:75], v7 offset:47104
v_mul_f32 v213, v126, v142
v_mfma_f32_16x16x32_bf16 v[84:87], v[52:55], v[36:39], v[84:87]
v_mul_f32 v215, v127, v143
v_mfma_f32_16x16x32_bf16 v[88:91], v[48:51], v[24:27], v[88:91]
v_fma_f32 v212, v212, v243, v243
v_fma_f32 v214, v214, v243, v243
v_mfma_f32_16x16x32_bf16 v[88:91], v[52:55], v[40:43], v[88:91]
v_mfma_f32_16x16x32_bf16 v[92:95], v[48:51], v[28:31], v[92:95]
ds_read_b128 v[76:79], v7 offset:48128
v_mfma_f32_16x16x32_bf16 v[92:95], v[52:55], v[44:47], v[92:95]
v_rcp_f32 v212, v212
s_waitcnt lgkmcnt(4)
v_mfma_f32_16x16x32_bf16 v[96:99], v[56:59], v[16:19], v[96:99]
v_rcp_f32 v214, v214
v_mfma_f32_16x16x32_bf16 v[96:99], v[60:63], v[32:35], v[96:99]
v_mul_f32 v213, v213, v212
v_mul_f32 v215, v215, v214
v_mfma_f32_16x16x32_bf16 v[100:103], v[56:59], v[20:23], v[100:103]
ds_read_b128 v[48:51], v7 offset:49152
v_cvt_pk_bf16_f32 v189, v213, v215
v_mfma_f32_16x16x32_bf16 v[100:103], v[60:63], v[36:39], v[100:103]
v_mfma_f32_16x16x32_bf16 v[104:107], v[56:59], v[24:27], v[104:107]
v_mfma_f32_16x16x32_bf16 v[104:107], v[60:63], v[40:43], v[104:107]
v_mfma_f32_16x16x32_bf16 v[108:111], v[56:59], v[28:31], v[108:111]
ds_read_b128 v[52:55], v7 offset:50176
v_mfma_f32_16x16x32_bf16 v[108:111], v[60:63], v[44:47], v[108:111]
s_waitcnt lgkmcnt(4)
v_mfma_f32_16x16x32_bf16 v[112:115], v[64:67], a[0:3], 0
v_mfma_f32_16x16x32_bf16 v[112:115], v[68:71], a[16:19], v[112:115]
v_mfma_f32_16x16x32_bf16 v[116:119], v[64:67], a[4:7], 0
ds_read_b128 v[56:59], v7 offset:51200
v_mfma_f32_16x16x32_bf16 v[116:119], v[68:71], a[20:23], v[116:119]
v_mul_f32 v208, v80, v80
v_mfma_f32_16x16x32_bf16 v[120:123], v[64:67], a[8:11], 0
v_mul_f32 v210, v81, v81
v_fma_f32 v208, v208, v233, v232
v_mfma_f32_16x16x32_bf16 v[120:123], v[68:71], a[24:27], v[120:123]
v_fma_f32 v210, v210, v233, v232
v_mfma_f32_16x16x32_bf16 v[124:127], v[64:67], a[12:15], 0
ds_read_b128 v[60:63], v7 offset:52224
v_mul_f32 v208, v208, v80
v_mfma_f32_16x16x32_bf16 v[124:127], v[68:71], a[28:31], v[124:127]
v_mul_f32 v210, v210, v81
s_waitcnt lgkmcnt(4)
v_mfma_f32_16x16x32_bf16 v[128:131], v[72:75], a[0:3], 0
v_exp_f32 v208, v208
v_mfma_f32_16x16x32_bf16 v[128:131], v[76:79], a[16:19], v[128:131]
v_mfma_f32_16x16x32_bf16 v[132:135], v[72:75], a[4:7], 0
ds_read_b128 v[64:67], v7 offset:53248
v_mfma_f32_16x16x32_bf16 v[132:135], v[76:79], a[20:23], v[132:135]
v_exp_f32 v210, v210
v_mfma_f32_16x16x32_bf16 v[136:139], v[72:75], a[8:11], 0
v_mul_f32 v209, v80, v96
v_mul_f32 v211, v81, v97
v_mfma_f32_16x16x32_bf16 v[136:139], v[76:79], a[24:27], v[136:139]
v_fma_f32 v208, v208, v234, v234
v_fma_f32 v210, v210, v234, v234
v_mfma_f32_16x16x32_bf16 v[140:143], v[72:75], a[12:15], 0
ds_read_b128 v[68:71], v7 offset:54272
v_mfma_f32_16x16x32_bf16 v[140:143], v[76:79], a[28:31], v[140:143]
s_waitcnt lgkmcnt(4)
v_mfma_f32_16x16x32_bf16 v[112:115], v[48:51], a[32:35], v[112:115]
v_rcp_f32 v208, v208
v_mfma_f32_16x16x32_bf16 v[112:115], v[52:55], a[48:51], v[112:115]
v_rcp_f32 v210, v210
v_mfma_f32_16x16x32_bf16 v[116:119], v[48:51], a[36:39], v[116:119]
ds_read_b128 v[72:75], v7 offset:55296
v_mul_f32 v209, v209, v208
v_mfma_f32_16x16x32_bf16 v[116:119], v[52:55], a[52:55], v[116:119]
v_mul_f32 v211, v211, v210
v_cvt_pk_bf16_f32 v178, v209, v211
v_mfma_f32_16x16x32_bf16 v[120:123], v[48:51], a[40:43], v[120:123]
v_mul_f32 v212, v82, v82
v_mul_f32 v214, v83, v83
v_mfma_f32_16x16x32_bf16 v[120:123], v[52:55], a[56:59], v[120:123]
v_fma_f32 v212, v212, v233, v232
v_mfma_f32_16x16x32_bf16 v[124:127], v[48:51], a[44:47], v[124:127]
ds_read_b128 v[76:79], v7 offset:56320
v_fma_f32 v214, v214, v233, v232
v_mfma_f32_16x16x32_bf16 v[124:127], v[52:55], a[60:63], v[124:127]
v_mul_f32 v212, v212, v82
s_waitcnt lgkmcnt(4)
v_mfma_f32_16x16x32_bf16 v[128:131], v[56:59], a[32:35], v[128:131]
v_mul_f32 v214, v214, v83
v_mfma_f32_16x16x32_bf16 v[128:131], v[60:63], a[48:51], v[128:131]
v_exp_f32 v212, v212
v_mfma_f32_16x16x32_bf16 v[132:135], v[56:59], a[36:39], v[132:135]
s_waitcnt vmcnt(23)
s_barrier
buffer_load_dword v13, v11, s[8:11], s34 offen sc1
ds_read_b128 v[48:51], v7 offset:57344
v_mfma_f32_16x16x32_bf16 v[132:135], v[60:63], a[52:55], v[132:135]
s_add_u32 m0, s22, 73728
v_mfma_f32_16x16x32_bf16 v[136:139], v[56:59], a[40:43], v[136:139]
v_exp_f32 v214, v214
v_mfma_f32_16x16x32_bf16 v[136:139], v[60:63], a[56:59], v[136:139]
s_add_u32 s23, s21, 368640
v_mul_f32 v213, v82, v98
v_mfma_f32_16x16x32_bf16 v[140:143], v[56:59], a[44:47], v[140:143]
ds_read_b128 v[52:55], v7 offset:58368
v_mul_f32 v215, v83, v99
v_mfma_f32_16x16x32_bf16 v[140:143], v[60:63], a[60:63], v[140:143]
buffer_load_dwordx4 v2, s[8:11], s23 offen offset:0 lds
v_fma_f32 v212, v212, v234, v234
s_waitcnt lgkmcnt(4)
v_mfma_f32_16x16x32_bf16 v[112:115], v[64:67], a[64:67], v[112:115]
v_fma_f32 v214, v214, v234, v234
v_mfma_f32_16x16x32_bf16 v[112:115], v[68:71], a[80:83], v[112:115]
buffer_load_dwordx4 v2, s[8:11], s23 offen offset:1024 lds
v_rcp_f32 v212, v212
v_mfma_f32_16x16x32_bf16 v[116:119], v[64:67], a[68:71], v[116:119]
ds_read_b128 v[56:59], v7 offset:59392
v_rcp_f32 v214, v214
v_mfma_f32_16x16x32_bf16 v[116:119], v[68:71], a[84:87], v[116:119]
buffer_load_dwordx4 v2, s[8:11], s23 offen offset:2048 lds
v_mul_f32 v213, v213, v212
v_mfma_f32_16x16x32_bf16 v[120:123], v[64:67], a[72:75], v[120:123]
v_mul_f32 v215, v215, v214
v_cvt_pk_bf16_f32 v179, v213, v215
v_mfma_f32_16x16x32_bf16 v[120:123], v[68:71], a[88:91], v[120:123]
buffer_load_dwordx4 v2, s[8:11], s23 offen offset:3072 lds
buffer_store_dwordx4 v[176:179], v2, s[8:11], s24 offen offset:2048 sc1
v_mfma_f32_16x16x32_bf16 v[124:127], v[64:67], a[76:79], v[124:127]
ds_read_b128 v[60:63], v7 offset:60416
v_mul_f32 v208, v84, v84
v_mfma_f32_16x16x32_bf16 v[124:127], v[68:71], a[92:95], v[124:127]
s_add_u32 m0, s22, 77824
s_waitcnt lgkmcnt(4)
v_mfma_f32_16x16x32_bf16 v[128:131], v[72:75], a[64:67], v[128:131]
v_mul_f32 v210, v85, v85
v_fma_f32 v208, v208, v236, v235
v_mfma_f32_16x16x32_bf16 v[128:131], v[76:79], a[80:83], v[128:131]
s_add_u32 s23, s21, 372736
v_fma_f32 v210, v210, v236, v235
v_mfma_f32_16x16x32_bf16 v[132:135], v[72:75], a[68:71], v[132:135]
ds_read_b128 v[64:67], v7 offset:61440
v_mul_f32 v208, v208, v84
v_mfma_f32_16x16x32_bf16 v[132:135], v[76:79], a[84:87], v[132:135]
buffer_load_dwordx4 v2, s[8:11], s23 offen offset:0 lds
v_mul_f32 v210, v210, v85
v_mfma_f32_16x16x32_bf16 v[136:139], v[72:75], a[72:75], v[136:139]
v_exp_f32 v208, v208
v_mfma_f32_16x16x32_bf16 v[136:139], v[76:79], a[88:91], v[136:139]
buffer_load_dwordx4 v2, s[8:11], s23 offen offset:1024 lds
v_exp_f32 v210, v210
v_mfma_f32_16x16x32_bf16 v[140:143], v[72:75], a[76:79], v[140:143]
ds_read_b128 v[68:71], v7 offset:62464
v_mul_f32 v209, v84, v100
v_mfma_f32_16x16x32_bf16 v[140:143], v[76:79], a[92:95], v[140:143]
v_mul_f32 v211, v85, v101
s_waitcnt lgkmcnt(4)
v_mfma_f32_16x16x32_bf16 v[112:115], v[48:51], a[96:99], v[112:115]
v_fma_f32 v208, v208, v237, v237
v_fma_f32 v210, v210, v237, v237
v_mfma_f32_16x16x32_bf16 v[112:115], v[52:55], a[112:115], v[112:115]
v_rcp_f32 v208, v208
v_mfma_f32_16x16x32_bf16 v[116:119], v[48:51], a[100:103], v[116:119]
ds_read_b128 v[72:75], v7 offset:63488
v_mfma_f32_16x16x32_bf16 v[116:119], v[52:55], a[116:119], v[116:119]
v_rcp_f32 v210, v210
v_mfma_f32_16x16x32_bf16 v[120:123], v[48:51], a[104:107], v[120:123]
v_mul_f32 v209, v209, v208
v_mul_f32 v211, v211, v210
v_mfma_f32_16x16x32_bf16 v[120:123], v[52:55], a[120:123], v[120:123]
v_cvt_pk_bf16_f32 v182, v209, v211
v_mfma_f32_16x16x32_bf16 v[124:127], v[48:51], a[108:111], v[124:127]
ds_read_b128 v[76:79], v7 offset:64512
v_mul_f32 v212, v86, v86
v_mfma_f32_16x16x32_bf16 v[124:127], v[52:55], a[124:127], v[124:127]
v_mul_f32 v214, v87, v87
s_waitcnt lgkmcnt(4)
v_mfma_f32_16x16x32_bf16 v[128:131], v[56:59], a[96:99], v[128:131]
v_fma_f32 v212, v212, v236, v235
v_fma_f32 v214, v214, v236, v235
v_mfma_f32_16x16x32_bf16 v[128:131], v[60:63], a[112:115], v[128:131]
v_mul_f32 v212, v212, v86
v_mul_f32 v214, v214, v87
v_mfma_f32_16x16x32_bf16 v[132:135], v[56:59], a[100:103], v[132:135]
ds_read_b128 v[48:51], v8 offset:0
v_mfma_f32_16x16x32_bf16 v[132:135], v[60:63], a[116:119], v[132:135]
v_exp_f32 v212, v212
v_mfma_f32_16x16x32_bf16 v[136:139], v[56:59], a[104:107], v[136:139]
v_mfma_f32_16x16x32_bf16 v[136:139], v[60:63], a[120:123], v[136:139]
v_exp_f32 v214, v214
v_mfma_f32_16x16x32_bf16 v[140:143], v[56:59], a[108:111], v[140:143]
ds_read_b128 v[52:55], v8 offset:1024
v_mul_f32 v213, v86, v102
v_mfma_f32_16x16x32_bf16 v[140:143], v[60:63], a[124:127], v[140:143]
v_mul_f32 v215, v87, v103
s_waitcnt lgkmcnt(4)
v_mfma_f32_16x16x32_bf16 v[112:115], v[64:67], a[128:131], v[112:115]
v_fma_f32 v212, v212, v237, v237
v_fma_f32 v214, v214, v237, v237
v_mfma_f32_16x16x32_bf16 v[112:115], v[68:71], a[144:147], v[112:115]
v_rcp_f32 v212, v212
v_mfma_f32_16x16x32_bf16 v[116:119], v[64:67], a[132:135], v[116:119]
ds_read_b128 v[56:59], v8 offset:2048
v_mfma_f32_16x16x32_bf16 v[116:119], v[68:71], a[148:151], v[116:119]
v_rcp_f32 v214, v214
v_mfma_f32_16x16x32_bf16 v[120:123], v[64:67], a[136:139], v[120:123]
v_mul_f32 v213, v213, v212
v_mfma_f32_16x16x32_bf16 v[120:123], v[68:71], a[152:155], v[120:123]
v_mul_f32 v215, v215, v214
v_cvt_pk_bf16_f32 v183, v213, v215
v_mfma_f32_16x16x32_bf16 v[124:127], v[64:67], a[140:143], v[124:127]
ds_read_b128 v[60:63], v8 offset:3072
buffer_store_dwordx4 v[180:183], v4, s[8:11], s24 offen offset:2048 sc1
v_mfma_f32_16x16x32_bf16 v[124:127], v[68:71], a[156:159], v[124:127]
v_mul_f32 v208, v88, v88
s_waitcnt lgkmcnt(4)
v_mfma_f32_16x16x32_bf16 v[128:131], v[72:75], a[128:131], v[128:131]
v_mul_f32 v210, v89, v89
v_fma_f32 v208, v208, v239, v238
v_mfma_f32_16x16x32_bf16 v[128:131], v[76:79], a[144:147], v[128:131]
v_fma_f32 v210, v210, v239, v238
v_mfma_f32_16x16x32_bf16 v[132:135], v[72:75], a[132:135], v[132:135]
ds_read_b128 v[64:67], v8 offset:4096
v_mul_f32 v208, v208, v88
v_mfma_f32_16x16x32_bf16 v[132:135], v[76:79], a[148:151], v[132:135]
v_mul_f32 v210, v210, v89
v_mfma_f32_16x16x32_bf16 v[136:139], v[72:75], a[136:139], v[136:139]
v_exp_f32 v208, v208
v_mfma_f32_16x16x32_bf16 v[136:139], v[76:79], a[152:155], v[136:139]
v_mfma_f32_16x16x32_bf16 v[140:143], v[72:75], a[140:143], v[140:143]
ds_read_b128 v[68:71], v8 offset:5120
v_mfma_f32_16x16x32_bf16 v[140:143], v[76:79], a[156:159], v[140:143]
v_exp_f32 v210, v210
s_waitcnt lgkmcnt(4)
v_mfma_f32_16x16x32_bf16 v[112:115], v[48:51], a[160:163], v[112:115]
v_mul_f32 v209, v88, v104
v_mul_f32 v211, v89, v105
v_mfma_f32_16x16x32_bf16 v[112:115], v[52:55], a[176:179], v[112:115]
v_fma_f32 v208, v208, v240, v240
v_fma_f32 v210, v210, v240, v240
v_mfma_f32_16x16x32_bf16 v[116:119], v[48:51], a[164:167], v[116:119]
ds_read_b128 v[72:75], v8 offset:6144
v_mfma_f32_16x16x32_bf16 v[116:119], v[52:55], a[180:183], v[116:119]
v_rcp_f32 v208, v208
v_mfma_f32_16x16x32_bf16 v[120:123], v[48:51], a[168:171], v[120:123]
v_rcp_f32 v210, v210
v_mfma_f32_16x16x32_bf16 v[120:123], v[52:55], a[184:187], v[120:123]
v_mul_f32 v209, v209, v208
v_mfma_f32_16x16x32_bf16 v[124:127], v[48:51], a[172:175], v[124:127]
ds_read_b128 v[76:79], v8 offset:7168
v_mul_f32 v211, v211, v210
v_mfma_f32_16x16x32_bf16 v[124:127], v[52:55], a[188:191], v[124:127]
v_cvt_pk_bf16_f32 v186, v209, v211
s_waitcnt lgkmcnt(4)
v_mfma_f32_16x16x32_bf16 v[128:131], v[56:59], a[160:163], v[128:131]
v_mul_f32 v212, v90, v90
v_mul_f32 v214, v91, v91
v_mfma_f32_16x16x32_bf16 v[128:131], v[60:63], a[176:179], v[128:131]
v_fma_f32 v212, v212, v239, v238
v_mfma_f32_16x16x32_bf16 v[132:135], v[56:59], a[164:167], v[132:135]
ds_read_b128 v[48:51], v8 offset:8192
v_fma_f32 v214, v214, v239, v238
v_mfma_f32_16x16x32_bf16 v[132:135], v[60:63], a[180:183], v[132:135]
v_mul_f32 v212, v212, v90
v_mul_f32 v214, v214, v91
v_mfma_f32_16x16x32_bf16 v[136:139], v[56:59], a[168:171], v[136:139]
v_mfma_f32_16x16x32_bf16 v[136:139], v[60:63], a[184:187], v[136:139]
v_exp_f32 v212, v212
v_mfma_f32_16x16x32_bf16 v[140:143], v[56:59], a[172:175], v[140:143]
ds_read_b128 v[52:55], v8 offset:9216
v_mfma_f32_16x16x32_bf16 v[140:143], v[60:63], a[188:191], v[140:143]
s_waitcnt lgkmcnt(4)
v_mfma_f32_16x16x32_bf16 v[112:115], v[64:67], a[192:195], v[112:115]
v_exp_f32 v214, v214
v_mfma_f32_16x16x32_bf16 v[112:115], v[68:71], a[208:211], v[112:115]
v_mul_f32 v213, v90, v106
v_mul_f32 v215, v91, v107
v_mfma_f32_16x16x32_bf16 v[116:119], v[64:67], a[196:199], v[116:119]
ds_read_b128 v[56:59], v8 offset:10240
v_fma_f32 v212, v212, v240, v240
v_mfma_f32_16x16x32_bf16 v[116:119], v[68:71], a[212:215], v[116:119]
v_fma_f32 v214, v214, v240, v240
v_mfma_f32_16x16x32_bf16 v[120:123], v[64:67], a[200:203], v[120:123]
v_rcp_f32 v212, v212
v_mfma_f32_16x16x32_bf16 v[120:123], v[68:71], a[216:219], v[120:123]
v_rcp_f32 v214, v214
v_mfma_f32_16x16x32_bf16 v[124:127], v[64:67], a[204:207], v[124:127]
ds_read_b128 v[60:63], v8 offset:11264
v_mul_f32 v213, v213, v212
v_mfma_f32_16x16x32_bf16 v[124:127], v[68:71], a[220:223], v[124:127]
v_mul_f32 v215, v215, v214
s_waitcnt lgkmcnt(4)
v_mfma_f32_16x16x32_bf16 v[128:131], v[72:75], a[192:195], v[128:131]
v_cvt_pk_bf16_f32 v187, v213, v215
buffer_store_dwordx4 v[184:187], v5, s[8:11], s24 offen offset:2048 sc1
v_mfma_f32_16x16x32_bf16 v[128:131], v[76:79], a[208:211], v[128:131]
v_mul_f32 v208, v92, v92
v_mfma_f32_16x16x32_bf16 v[132:135], v[72:75], a[196:199], v[132:135]
ds_read_b128 v[64:67], v8 offset:12288
v_mul_f32 v210, v93, v93
v_mfma_f32_16x16x32_bf16 v[132:135], v[76:79], a[212:215], v[132:135]
v_fma_f32 v208, v208, v242, v241
v_fma_f32 v210, v210, v242, v241
v_mfma_f32_16x16x32_bf16 v[136:139], v[72:75], a[200:203], v[136:139]
v_mul_f32 v208, v208, v92
v_mfma_f32_16x16x32_bf16 v[136:139], v[76:79], a[216:219], v[136:139]
v_mul_f32 v210, v210, v93
v_mfma_f32_16x16x32_bf16 v[140:143], v[72:75], a[204:207], v[140:143]
ds_read_b128 v[68:71], v8 offset:13312
v_mfma_f32_16x16x32_bf16 v[140:143], v[76:79], a[220:223], v[140:143]
s_waitcnt lgkmcnt(4)
v_mfma_f32_16x16x32_bf16 v[112:115], v[48:51], a[224:227], v[112:115]
v_exp_f32 v208, v208
v_mfma_f32_16x16x32_bf16 v[112:115], v[52:55], a[240:243], v[112:115]
v_exp_f32 v210, v210
v_mfma_f32_16x16x32_bf16 v[116:119], v[48:51], a[228:231], v[116:119]
ds_read_b128 v[72:75], v8 offset:14336
v_mul_f32 v209, v92, v108
v_mfma_f32_16x16x32_bf16 v[116:119], v[52:55], a[244:247], v[116:119]
v_mul_f32 v211, v93, v109
v_fma_f32 v208, v208, v243, v243
v_mfma_f32_16x16x32_bf16 v[120:123], v[48:51], a[232:235], v[120:123]
v_fma_f32 v210, v210, v243, v243
v_mfma_f32_16x16x32_bf16 v[120:123], v[52:55], a[248:251], v[120:123]
v_rcp_f32 v208, v208
v_mfma_f32_16x16x32_bf16 v[124:127], v[48:51], a[236:239], v[124:127]
ds_read_b128 v[76:79], v8 offset:15360
v_mfma_f32_16x16x32_bf16 v[124:127], v[52:55], a[252:255], v[124:127]
s_waitcnt lgkmcnt(4)
v_mfma_f32_16x16x32_bf16 v[128:131], v[56:59], a[224:227], v[128:131]
v_rcp_f32 v210, v210
v_mfma_f32_16x16x32_bf16 v[128:131], v[60:63], a[240:243], v[128:131]
v_mul_f32 v209, v209, v208
v_mul_f32 v211, v211, v210
v_mfma_f32_16x16x32_bf16 v[132:135], v[56:59], a[228:231], v[132:135]
s_waitcnt vmcnt(26)
s_barrier
ds_read_b128 v[48:51], v2 offset:0
v_mfma_f32_16x16x32_bf16 v[132:135], v[60:63], a[244:247], v[132:135]
s_add_u32 m0, s22, 98304
v_cvt_pk_bf16_f32 v190, v209, v211
v_mul_f32 v212, v94, v94
v_mfma_f32_16x16x32_bf16 v[136:139], v[56:59], a[232:235], v[136:139]
v_mul_f32 v214, v95, v95
v_fma_f32 v212, v212, v242, v241
v_mfma_f32_16x16x32_bf16 v[136:139], v[60:63], a[248:251], v[136:139]
s_add_u32 s23, s21, 393216
v_fma_f32 v214, v214, v242, v241
v_mfma_f32_16x16x32_bf16 v[140:143], v[56:59], a[236:239], v[140:143]
ds_read_b128 v[52:55], v2 offset:1024
v_mul_f32 v212, v212, v94
v_mfma_f32_16x16x32_bf16 v[140:143], v[60:63], a[252:255], v[140:143]
buffer_load_dwordx4 v2, s[8:11], s23 offen offset:0 lds
v_mul_f32 v214, v214, v95
s_waitcnt lgkmcnt(4)
v_mfma_f32_16x16x32_bf16 v[112:115], v[64:67], v[16:19], v[112:115]
v_exp_f32 v212, v212
v_mfma_f32_16x16x32_bf16 v[112:115], v[68:71], v[32:35], v[112:115]
buffer_load_dwordx4 v2, s[8:11], s23 offen offset:1024 lds
v_mfma_f32_16x16x32_bf16 v[116:119], v[64:67], v[20:23], v[116:119]
ds_read_b128 v[56:59], v2 offset:2048
v_exp_f32 v214, v214
v_mfma_f32_16x16x32_bf16 v[116:119], v[68:71], v[36:39], v[116:119]
buffer_load_dwordx4 v2, s[8:11], s23 offen offset:2048 lds
v_mul_f32 v213, v94, v110
v_mfma_f32_16x16x32_bf16 v[120:123], v[64:67], v[24:27], v[120:123]
v_mul_f32 v215, v95, v111
v_fma_f32 v212, v212, v243, v243
v_mfma_f32_16x16x32_bf16 v[120:123], v[68:71], v[40:43], v[120:123]
buffer_load_dwordx4 v2, s[8:11], s23 offen offset:3072 lds
v_fma_f32 v214, v214, v243, v243
v_mfma_f32_16x16x32_bf16 v[124:127], v[64:67], v[28:31], v[124:127]
ds_read_b128 v[60:63], v2 offset:3072
v_mfma_f32_16x16x32_bf16 v[124:127], v[68:71], v[44:47], v[124:127]
s_add_u32 m0, s22, 102400
v_rcp_f32 v212, v212
s_waitcnt lgkmcnt(4)
v_mfma_f32_16x16x32_bf16 v[128:131], v[72:75], v[16:19], v[128:131]
v_rcp_f32 v214, v214
v_mfma_f32_16x16x32_bf16 v[128:131], v[76:79], v[32:35], v[128:131]
s_add_u32 s23, s21, 397312
v_mul_f32 v213, v213, v212
v_mfma_f32_16x16x32_bf16 v[132:135], v[72:75], v[20:23], v[132:135]
ds_read_b128 v[64:67], v2 offset:4096
v_mul_f32 v215, v215, v214
v_mfma_f32_16x16x32_bf16 v[132:135], v[76:79], v[36:39], v[132:135]
buffer_load_dwordx4 v2, s[8:11], s23 offen offset:0 lds
v_cvt_pk_bf16_f32 v191, v213, v215
v_mfma_f32_16x16x32_bf16 v[136:139], v[72:75], v[24:27], v[136:139]
buffer_store_dwordx4 v[188:191], v6, s[8:11], s24 offen offset:2048 sc1
v_mfma_f32_16x16x32_bf16 v[136:139], v[76:79], v[40:43], v[136:139]
buffer_load_dwordx4 v2, s[8:11], s23 offen offset:1024 lds
v_mfma_f32_16x16x32_bf16 v[140:143], v[72:75], v[28:31], v[140:143]
ds_read_b128 v[68:71], v2 offset:5120
v_mfma_f32_16x16x32_bf16 v[140:143], v[76:79], v[44:47], v[140:143]
s_waitcnt vmcnt(16)
v_cmp_le_u32 vcc, 1, v13
s_nop 0
s_cmp_eq_u64 vcc, exec
s_cbranch_scc0 L_f_slow1
L_f_back1:
s_waitcnt lgkmcnt(4)
v_mfma_f32_16x16x32_bf16 v[80:83], v[48:51], a[0:3], 0
v_mfma_f32_16x16x32_bf16 v[80:83], v[52:55], a[16:19], v[80:83]
v_mfma_f32_16x16x32_bf16 v[84:87], v[48:51], a[4:7], 0
ds_read_b128 v[72:75], v2 offset:6144
v_mfma_f32_16x16x32_bf16 v[84:87], v[52:55], a[20:23], v[84:87]
v_mul_f32 v208, v112, v112
v_mfma_f32_16x16x32_bf16 v[88:91], v[48:51], a[8:11], 0
v_mul_f32 v210, v113, v113
v_mfma_f32_16x16x32_bf16 v[88:91], v[52:55], a[24:27], v[88:91]
v_fma_f32 v208, v208, v233, v232
v_fma_f32 v210, v210, v233, v232
v_mfma_f32_16x16x32_bf16 v[92:95], v[48:51], a[12:15], 0
ds_read_b128 v[76:79], v2 offset:7168
v_mul_f32 v208, v208, v112
v_mfma_f32_16x16x32_bf16 v[92:95], v[52:55], a[28:31], v[92:95]
v_mul_f32 v210, v210, v113
s_waitcnt lgkmcnt(4)
v_mfma_f32_16x16x32_bf16 v[96:99], v[56:59], a[0:3], 0
v_mfma_f32_16x16x32_bf16 v[96:99], v[60:63], a[16:19], v[96:99]
v_exp_f32 v208, v208
v_mfma_f32_16x16x32_bf16 v[100:103], v[56:59], a[4:7], 0
ds_read_b128 v[48:51], v2 offset:8192
v_mfma_f32_16x16x32_bf16 v[100:103], v[60:63], a[20:23], v[100:103]
v_exp_f32 v210, v210
v_mfma_f32_16x16x32_bf16 v[104:107], v[56:59], a[8:11], 0
v_mul_f32 v209, v112, v128
v_mul_f32 v211, v113, v129
v_mfma_f32_16x16x32_bf16 v[104:107], v[60:63], a[24:27], v[104:107]
v_fma_f32 v208, v208, v234, v234
v_fma_f32 v210, v210, v234, v234
v_mfma_f32_16x16x32_bf16 v[108:111], v[56:59], a[12:15], 0
ds_read_b128 v[52:55], v2 offset:9216
v_mfma_f32_16x16x32_bf16 v[108:111], v[60:63], a[28:31], v[108:111]
s_waitcnt lgkmcnt(4)
v_mfma_f32_16x16x32_bf16 v[80:83], v[64:67], a[32:35], v[80:83]
v_rcp_f32 v208, v208
v_mfma_f32_16x16x32_bf16 v[80:83], v[68:71], a[48:51], v[80:83]
buffer_load_dwordx4 a[0:3], v2, s[8:11], s25 offen offset:0 sc1
v_mfma_f32_16x16x32_bf16 v[84:87], v[64:67], a[36:39], v[84:87]
ds_read_b128 v[56:59], v2 offset:10240
v_rcp_f32 v210, v210
v_mfma_f32_16x16x32_bf16 v[84:87], v[68:71], a[52:55], v[84:87]
buffer_load_dwordx4 a[4:7], v4, s[8:11], s25 offen offset:0 sc1
v_mul_f32 v209, v209, v208
v_mfma_f32_16x16x32_bf16 v[88:91], v[64:67], a[40:43], v[88:91]
v_mul_f32 v211, v211, v210
v_cvt_pk_bf16_f32 v192, v209, v211
v_mfma_f32_16x16x32_bf16 v[88:91], v[68:71], a[56:59], v[88:91]
buffer_load_dwordx4 a[8:11], v5, s[8:11], s25 offen offset:0 sc1
v_mul_f32 v212, v114, v114
v_mfma_f32_16x16x32_bf16 v[92:95], v[64:67], a[44:47], v[92:95]
ds_read_b128 v[60:63], v2 offset:11264
v_mul_f32 v214, v115, v115
v_mfma_f32_16x16x32_bf16 v[92:95], v[68:71], a[60:63], v[92:95]
buffer_load_dwordx4 a[12:15], v6, s[8:11], s25 offen offset:0 sc1
s_waitcnt lgkmcnt(4)
v_mfma_f32_16x16x32_bf16 v[96:99], v[72:75], a[32:35], v[96:99]
v_fma_f32 v212, v212, v233, v232
v_fma_f32 v214, v214, v233, v232
v_mfma_f32_16x16x32_bf16 v[96:99], v[76:79], a[48:51], v[96:99]
buffer_load_dwordx4 a[16:19], v2, s[8:11], s26 offen offset:0 sc1
v_mul_f32 v212, v212, v114
v_mfma_f32_16x16x32_bf16 v[100:103], v[72:75], a[36:39], v[100:103]
ds_read_b128 v[64:67], v2 offset:12288
v_mul_f32 v214, v214, v115
v_mfma_f32_16x16x32_bf16 v[100:103], v[76:79], a[52:55], v[100:103]
buffer_load_dwordx4 a[20:23], v4, s[8:11], s26 offen offset:0 sc1
v_exp_f32 v212, v212
v_mfma_f32_16x16x32_bf16 v[104:107], v[72:75], a[40:43], v[104:107]
v_exp_f32 v214, v214
v_mfma_f32_16x16x32_bf16 v[104:107], v[76:79], a[56:59], v[104:107]
buffer_load_dwordx4 a[24:27], v5, s[8:11], s26 offen offset:0 sc1
v_mul_f32 v213, v114, v130
v_mfma_f32_16x16x32_bf16 v[108:111], v[72:75], a[44:47], v[108:111]
ds_read_b128 v[68:71], v2 offset:13312
v_mul_f32 v215, v115, v131
v_mfma_f32_16x16x32_bf16 v[108:111], v[76:79], a[60:63], v[108:111]
buffer_load_dwordx4 a[28:31], v6, s[8:11], s26 offen offset:0 sc1
s_waitcnt lgkmcnt(4)
v_mfma_f32_16x16x32_bf16 v[80:83], v[48:51], a[64:67], v[80:83]
v_fma_f32 v212, v212, v234, v234
v_fma_f32 v214, v214, v234, v234
v_mfma_f32_16x16x32_bf16 v[80:83], v[52:55], a[80:83], v[80:83]
buffer_load_dwordx4 a[32:35], v2, s[8:11], s27 offen offset:0 sc1
v_rcp_f32 v212, v212
v_mfma_f32_16x16x32_bf16 v[84:87], v[48:51], a[68:71], v[84:87]
ds_read_b128 v[72:75], v2 offset:14336
v_mfma_f32_16x16x32_bf16 v[84:87], v[52:55], a[84:87], v[84:87]
buffer_load_dwordx4 a[36:39], v4, s[8:11], s27 offen offset:0 sc1
v_rcp_f32 v214, v214
v_mfma_f32_16x16x32_bf16 v[88:91], v[48:51], a[72:75], v[88:91]
v_mul_f32 v213, v213, v212
v_mul_f32 v215, v215, v214
v_mfma_f32_16x16x32_bf16 v[88:91], v[52:55], a[88:91], v[88:91]
buffer_load_dwordx4 a[40:43], v5, s[8:11], s27 offen offset:0 sc1
v_cvt_pk_bf16_f32 v193, v213, v215
v_mfma_f32_16x16x32_bf16 v[92:95], v[48:51], a[76:79], v[92:95]
ds_read_b128 v[76:79], v2 offset:15360
v_mul_f32 v208, v116, v116
v_mfma_f32_16x16x32_bf16 v[92:95], v[52:55], a[92:95], v[92:95]
buffer_load_dwordx4 a[44:47], v6, s[8:11], s27 offen offset:0 sc1
s_waitcnt lgkmcnt(4)
v_mfma_f32_16x16x32_bf16 v[96:99], v[56:59], a[64:67], v[96:99]
v_mul_f32 v210, v117, v117
v_fma_f32 v208, v208, v236, v235
v_mfma_f32_16x16x32_bf16 v[96:99], v[60:63], a[80:83], v[96:99]
buffer_load_dwordx4 a[48:51], v2, s[8:11], s25 offen offset:1024 sc1
v_fma_f32 v210, v210, v236, v235
v_mfma_f32_16x16x32_bf16 v[100:103], v[56:59], a[68:71], v[100:103]
ds_read_b128 v[48:51], v2 offset:16384
v_mul_f32 v208, v208, v116
v_mfma_f32_16x16x32_bf16 v[100:103], v[60:63], a[84:87], v[100:103]
buffer_load_dwordx4 a[52:55], v4, s[8:11], s25 offen offset:1024 sc1
v_mul_f32 v210, v210, v117
v_mfma_f32_16x16x32_bf16 v[104:107], v[56:59], a[72:75], v[104:107]
v_exp_f32 v208, v208
v_mfma_f32_16x16x32_bf16 v[104:107], v[60:63], a[88:91], v[104:107]
buffer_load_dwordx4 a[56:59], v5, s[8:11], s25 offen offset:1024 sc1
v_exp_f32 v210, v210
v_mfma_f32_16x16x32_bf16 v[108:111], v[56:59], a[76:79], v[108:111]
ds_read_b128 v[52:55], v2 offset:17408
v_mul_f32 v209, v116, v132
v_mfma_f32_16x16x32_bf16 v[108:111], v[60:63], a[92:95], v[108:111]
buffer_load_dwordx4 a[60:63], v6, s[8:11], s25 offen offset:1024 sc1
s_waitcnt lgkmcnt(4)
v_mfma_f32_16x16x32_bf16 v[80:83], v[64:67], a[96:99], v[80:83]
v_mul_f32 v211, v117, v133
v_fma_f32 v208, v208, v237, v237
v_mfma_f32_16x16x32_bf16 v[80:83], v[68:71], a[112:115], v[80:83]
buffer_load_dwordx4 a[64:67], v2, s[8:11], s26 offen offset:1024 sc1
v_fma_f32 v210, v210, v237, v237
v_mfma_f32_16x16x32_bf16 v[84:87], v[64:67], a[100:103], v[84:87]
ds_read_b128 v[56:59], v2 offset:18432
v_rcp_f32 v208, v208
v_mfma_f32_16x16x32_bf16 v[84:87], v[68:71], a[116:119], v[84:87]
buffer_load_dwordx4 a[68:71], v4, s[8:11], s26 offen offset:1024 sc1
v_mfma_f32_16x16x32_bf16 v[88:91], v[64:67], a[104:107], v[88:91]
v_rcp_f32 v210, v210
v_mfma_f32_16x16x32_bf16 v[88:91], v[68:71], a[120:123], v[88:91]
buffer_load_dwordx4 a[72:75], v5, s[8:11], s26 offen offset:1024 sc1
v_mul_f32 v209, v209, v208
v_mfma_f32_16x16x32_bf16 v[92:95], v[64:67], a[108:111], v[92:95]
ds_read_b128 v[60:63], v2 offset:19456
v_mul_f32 v211, v211, v210
v_mfma_f32_16x16x32_bf16 v[92:95], v[68:71], a[124:127], v[92:95]
buffer_load_dwordx4 a[76:79], v6, s[8:11], s26 offen offset:1024 sc1
v_cvt_pk_bf16_f32 v196, v209, v211
s_waitcnt lgkmcnt(4)
v_mfma_f32_16x16x32_bf16 v[96:99], v[72:75], a[96:99], v[96:99]
v_mul_f32 v212, v118, v118
v_mul_f32 v214, v119, v119
v_mfma_f32_16x16x32_bf16 v[96:99], v[76:79], a[112:115], v[96:99]
buffer_load_dwordx4 a[80:83], v2, s[8:11], s27 offen offset:1024 sc1
v_fma_f32 v212, v212, v236, v235
v_mfma_f32_16x16x32_bf16 v[100:103], v[72:75], a[100:103], v[100:103]
ds_read_b128 v[64:67], v2 offset:20480
v_fma_f32 v214, v214, v236, v235
v_mfma_f32_16x16x32_bf16 v[100:103], v[76:79], a[116:119], v[100:103]
buffer_load_dwordx4 a[84:87], v4, s[8:11], s27 offen offset:1024 sc1
v_mul_f32 v212, v212, v118
v_mfma_f32_16x16x32_bf16 v[104:107], v[72:75], a[104:107], v[104:107]
v_mul_f32 v214, v214, v119
v_mfma_f32_16x16x32_bf16 v[104:107], v[76:79], a[120:123], v[104:107]
buffer_load_dwordx4 a[88:91], v5, s[8:11], s27 offen offset:1024 sc1
v_exp_f32 v212, v212
v_mfma_f32_16x16x32_bf16 v[108:111], v[72:75], a[108:111], v[108:111]
ds_read_b128 v[68:71], v2 offset:21504
v_exp_f32 v214, v214
v_mfma_f32_16x16x32_bf16 v[108:111], v[76:79], a[124:127], v[108:111]
buffer_load_dwordx4 a[92:95], v6, s[8:11], s27 offen offset:1024 sc1
s_waitcnt lgkmcnt(4)
v_mfma_f32_16x16x32_bf16 v[80:83], v[48:51], a[128:131], v[80:83]
v_mul_f32 v213, v118, v134
v_mul_f32 v215, v119, v135
v_mfma_f32_16x16x32_bf16 v[80:83], v[52:55], a[144:147], v[80:83]
buffer_load_dwordx4 a[96:99], v2, s[8:11], s28 offen offset:0 sc1
v_fma_f32 v212, v212, v237, v237
v_mfma_f32_16x16x32_bf16 v[84:87], v[48:51], a[132:135], v[84:87]
ds_read_b128 v[72:75], v2 offset:22528
v_fma_f32 v214, v214, v237, v237
v_mfma_f32_16x16x32_bf16 v[84:87], v[52:55], a[148:151], v[84:87]
buffer_load_dwordx4 a[100:103], v4, s[8:11], s28 offen offset:0 sc1
v_rcp_f32 v212, v212
v_mfma_f32_16x16x32_bf16 v[88:91], v[48:51], a[136:139], v[88:91]
v_rcp_f32 v214, v214
v_mfma_f32_16x16x32_bf16 v[88:91], v[52:55], a[152:155], v[88:91]
buffer_load_dwordx4 a[104:107], v5, s[8:11], s28 offen offset:0 sc1
v_mul_f32 v213, v213, v212
v_mfma_f32_16x16x32_bf16 v[92:95], v[48:51], a[140:143], v[92:95]
ds_read_b128 v[76:79], v2 offset:23552
v_mul_f32 v215, v215, v214
v_mfma_f32_16x16x32_bf16 v[92:95], v[52:55], a[156:159], v[92:95]
buffer_load_dwordx4 a[108:111], v6, s[8:11], s28 offen offset:0 sc1
s_waitcnt lgkmcnt(4)
v_mfma_f32_16x16x32_bf16 v[96:99], v[56:59], a[128:131], v[96:99]
v_cvt_pk_bf16_f32 v197, v213, v215
v_mul_f32 v208, v120, v120
v_mfma_f32_16x16x32_bf16 v[96:99], v[60:63], a[144:147], v[96:99]
v_mul_f32 v210, v121, v121
v_fma_f32 v208, v208, v239, v238
v_mfma_f32_16x16x32_bf16 v[100:103], v[56:59], a[132:135], v[100:103]
s_waitcnt vmcnt(0)
s_barrier
v_mov_b32 v12, 2
buffer_store_dword v12, v10, s[8:11], s34 offen sc1
ds_read_b128 v[48:51], v2 offset:24576
v_mfma_f32_16x16x32_bf16 v[100:103], v[60:63], a[148:151], v[100:103]
s_add_u32 m0, s22, 122880
v_fma_f32 v210, v210, v239, v238
v_mfma_f32_16x16x32_bf16 v[104:107], v[56:59], a[136:139], v[104:107]
v_mul_f32 v208, v208, v120
v_mul_f32 v210, v210, v121
v_mfma_f32_16x16x32_bf16 v[104:107], v[60:63], a[152:155], v[104:107]
s_add_u32 s23, s21, 417792
v_mfma_f32_16x16x32_bf16 v[108:111], v[56:59], a[140:143], v[108:111]
ds_read_b128 v[52:55], v2 offset:25600
v_exp_f32 v208, v208
v_mfma_f32_16x16x32_bf16 v[108:111], v[60:63], a[156:159], v[108:111]
buffer_load_dwordx4 v2, s[8:11], s23 offen offset:0 lds
v_exp_f32 v210, v210
s_waitcnt lgkmcnt(4)
v_mfma_f32_16x16x32_bf16 v[80:83], v[64:67], a[160:163], v[80:83]
v_mul_f32 v209, v120, v136
v_mul_f32 v211, v121, v137
v_mfma_f32_16x16x32_bf16 v[80:83], v[68:71], a[176:179], v[80:83]
buffer_load_dwordx4 v2, s[8:11], s23 offen offset:1024 lds
v_fma_f32 v208, v208, v240, v240
v_mfma_f32_16x16x32_bf16 v[84:87], v[64:67], a[164:167], v[84:87]
ds_read_b128 v[56:59], v2 offset:26624
v_fma_f32 v210, v210, v240, v240
v_mfma_f32_16x16x32_bf16 v[84:87], v[68:71], a[180:183], v[84:87]
buffer_load_dwordx4 v2, s[8:11], s23 offen offset:2048 lds
v_mfma_f32_16x16x32_bf16 v[88:91], v[64:67], a[168:171], v[88:91]
v_rcp_f32 v208, v208
v_mfma_f32_16x16x32_bf16 v[88:91], v[68:71], a[184:187], v[88:91]
buffer_load_dwordx4 v2, s[8:11], s23 offen offset:3072 lds
v_mfma_f32_16x16x32_bf16 v[92:95], v[64:67], a[172:175], v[92:95]
ds_read_b128 v[60:63], v2 offset:27648
v_rcp_f32 v210, v210
v_mfma_f32_16x16x32_bf16 v[92:95], v[68:71], a[188:191], v[92:95]
s_add_u32 m0, s22, 126976
v_mul_f32 v209, v209, v208
s_waitcnt lgkmcnt(4)
v_mfma_f32_16x16x32_bf16 v[96:99], v[72:75], a[160:163], v[96:99]
v_mul_f32 v211, v211, v210
v_cvt_pk_bf16_f32 v200, v209, v211
v_mfma_f32_16x16x32_bf16 v[96:99], v[76:79], a[176:179], v[96:99]
s_add_u32 s23, s21, 421888
v_mul_f32 v212, v122, v122
v_mfma_f32_16x16x32_bf16 v[100:103], v[72:75], a[164:167], v[100:103]
ds_read_b128 v[64:67], v2 offset:28672
v_mul_f32 v214, v123, v123
v_mfma_f32_16x16x32_bf16 v[100:103], v[76:79], a[180:183], v[100:103]
buffer_load_dwordx4 v2, s[8:11], s23 offen offset:0 lds
v_fma_f32 v212, v212, v239, v238
v_mfma_f32_16x16x32_bf16 v[104:107], v[72:75], a[168:171], v[104:107]
v_fma_f32 v214, v214, v239, v238
v_mul_f32 v212, v212, v122
v_mfma_f32_16x16x32_bf16 v[104:107], v[76:79], a[184:187], v[104:107]
buffer_load_dwordx4 v2, s[8:11], s23 offen offset:1024 lds
v_mul_f32 v214, v214, v123
v_mfma_f32_16x16x32_bf16 v[108:111], v[72:75], a[172:175], v[108:111]
ds_read_b128 v[68:71], v2 offset:29696
v_mfma_f32_16x16x32_bf16 v[108:111], v[76:79], a[188:191], v[108:111]
v_exp_f32 v212, v212
s_waitcnt lgkmcnt(4)
v_mfma_f32_16x16x32_bf16 v[80:83], v[48:51], a[192:195], v[80:83]
v_exp_f32 v214, v214
v_mfma_f32_16x16x32_bf16 v[80:83], v[52:55], a[208:211], v[80:83]
v_mul_f32 v213, v122, v138
v_mul_f32 v215, v123, v139
v_mfma_f32_16x16x32_bf16 v[84:87], v[48:51], a[196:199], v[84:87]
ds_read_b128 v[72:75], v2 offset:30720
v_fma_f32 v212, v212, v240, v240
v_mfma_f32_16x16x32_bf16 v[84:87], v[52:55], a[212:215], v[84:87]
v_fma_f32 v214, v214, v240, v240
v_mfma_f32_16x16x32_bf16 v[88:91], v[48:51], a[200:203], v[88:91]
v_rcp_f32 v212, v212
v_mfma_f32_16x16x32_bf16 v[88:91], v[52:55], a[216:219], v[88:91]
v_mfma_f32_16x16x32_bf16 v[92:95], v[48:51], a[204:207], v[92:95]
ds_read_b128 v[76:79], v2 offset:31744
v_mfma_f32_16x16x32_bf16 v[92:95], v[52:55], a[220:223], v[92:95]
v_rcp_f32 v214, v214
s_waitcnt lgkmcnt(4)
v_mfma_f32_16x16x32_bf16 v[96:99], v[56:59], a[192:195], v[96:99]
v_mul_f32 v213, v213, v212
v_mul_f32 v215, v215, v214
v_mfma_f32_16x16x32_bf16 v[96:99], v[60:63], a[208:211], v[96:99]
v_cvt_pk_bf16_f32 v201, v213, v215
v_mul_f32 v208, v124, v124
v_mfma_f32_16x16x32_bf16 v[100:103], v[56:59], a[196:199], v[100:103]
ds_read_b128 v[48:51], v2 offset:32768
v_mul_f32 v210, v125, v125
v_mfma_f32_16x16x32_bf16 v[100:103], v[60:63], a[212:215], v[100:103]
v_fma_f32 v208, v208, v242, v241
v_fma_f32 v210, v210, v242, v241
v_mfma_f32_16x16x32_bf16 v[104:107], v[56:59], a[200:203], v[104:107]
v_mul_f32 v208, v208, v124
v_mfma_f32_16x16x32_bf16 v[104:107], v[60:63], a[216:219], v[104:107]
v_mul_f32 v210, v210, v125
v_mfma_f32_16x16x32_bf16 v[108:111], v[56:59], a[204:207], v[108:111]
ds_read_b128 v[52:55], v2 offset:33792
v_mfma_f32_16x16x32_bf16 v[108:111], v[60:63], a[220:223], v[108:111]
s_waitcnt lgkmcnt(4)
v_mfma_f32_16x16x32_bf16 v[80:83], v[64:67], a[224:227], v[80:83]
v_exp_f32 v208, v208
v_mfma_f32_16x16x32_bf16 v[80:83], v[68:71], a[240:243], v[80:83]
v_exp_f32 v210, v210
v_mfma_f32_16x16x32_bf16 v[84:87], v[64:67], a[228:231], v[84:87]
ds_read_b128 v[56:59], v2 offset:34816
v_mul_f32 v209, v124, v140
v_mfma_f32_16x16x32_bf16 v[84:87], v[68:71], a[244:247], v[84:87]
v_mul_f32 v211, v125, v141
v_fma_f32 v208, v208, v243, v243
v_mfma_f32_16x16x32_bf16 v[88:91], v[64:67], a[232:235], v[88:91]
v_fma_f32 v210, v210, v243, v243
v_mfma_f32_16x16x32_bf16 v[88:91], v[68:71], a[248:251], v[88:91]
v_rcp_f32 v208, v208
v_mfma_f32_16x16x32_bf16 v[92:95], v[64:67], a[236:239], v[92:95]
ds_read_b128 v[60:63], v2 offset:35840
v_mfma_f32_16x16x32_bf16 v[92:95], v[68:71], a[252:255], v[92:95]
s_waitcnt lgkmcnt(4)
v_mfma_f32_16x16x32_bf16 v[96:99], v[72:75], a[224:227], v[96:99]
v_rcp_f32 v210, v210
v_mfma_f32_16x16x32_bf16 v[96:99], v[76:79], a[240:243], v[96:99]
v_mul_f32 v209, v209, v208
v_mul_f32 v211, v211, v210
v_mfma_f32_16x16x32_bf16 v[100:103], v[72:75], a[228:231], v[100:103]
ds_read_b128 v[64:67], v2 offset:36864
v_cvt_pk_bf16_f32 v204, v209, v211
v_mfma_f32_16x16x32_bf16 v[100:103], v[76:79], a[244:247], v[100:103]
v_mul_f32 v212, v126, v126
v_mul_f32 v214, v127, v127
v_mfma_f32_16x16x32_bf16 v[104:107], v[72:75], a[232:235], v[104:107]
v_fma_f32 v212, v212, v242, v241
v_fma_f32 v214, v214, v242, v241
v_mfma_f32_16x16x32_bf16 v[104:107], v[76:79], a[248:251], v[104:107]
v_mul_f32 v212, v212, v126
v_mfma_f32_16x16x32_bf16 v[108:111], v[72:75], a[236:239], v[108:111]
ds_read_b128 v[68:71], v2 offset:37888
v_mul_f32 v214, v214, v127
v_mfma_f32_16x16x32_bf16 v[108:111], v[76:79], a[252:255], v[108:111]
s_waitcnt lgkmcnt(4)
v_mfma_f32_16x16x32_bf16 v[80:83], v[48:51], v[16:19], v[80:83]
v_exp_f32 v212, v212
v_mfma_f32_16x16x32_bf16 v[80:83], v[52:55], v[32:35], v[80:83]
v_exp_f32 v214, v214
v_mfma_f32_16x16x32_bf16 v[84:87], v[48:51], v[20:23], v[84:87]
ds_read_b128 v[72:75], v2 offset:38912
v_mul_f32 v213, v126, v142
v_mfma_f32_16x16x32_bf16 v[84:87], v[52:55], v[36:39], v[84:87]
v_mul_f32 v215, v127, v143
v_mfma_f32_16x16x32_bf16 v[88:91], v[48:51], v[24:27], v[88:91]
v_fma_f32 v212, v212, v243, v243
v_fma_f32 v214, v214, v243, v243
v_mfma_f32_16x16x32_bf16 v[88:91], v[52:55], v[40:43], v[88:91]
v_mfma_f32_16x16x32_bf16 v[92:95], v[48:51], v[28:31], v[92:95]
ds_read_b128 v[76:79], v2 offset:39936
v_mfma_f32_16x16x32_bf16 v[92:95], v[52:55], v[44:47], v[92:95]
v_rcp_f32 v212, v212
s_waitcnt lgkmcnt(4)
v_mfma_f32_16x16x32_bf16 v[96:99], v[56:59], v[16:19], v[96:99]
v_rcp_f32 v214, v214
v_mfma_f32_16x16x32_bf16 v[96:99], v[60:63], v[32:35], v[96:99]
v_mul_f32 v213, v213, v212
v_mul_f32 v215, v215, v214
v_mfma_f32_16x16x32_bf16 v[100:103], v[56:59], v[20:23], v[100:103]
ds_read_b128 v[48:51], v2 offset:40960
v_cvt_pk_bf16_f32 v205, v213, v215
v_mfma_f32_16x16x32_bf16 v[100:103], v[60:63], v[36:39], v[100:103]
v_mfma_f32_16x16x32_bf16 v[104:107], v[56:59], v[24:27], v[104:107]
v_mfma_f32_16x16x32_bf16 v[104:107], v[60:63], v[40:43], v[104:107]
v_mfma_f32_16x16x32_bf16 v[108:111], v[56:59], v[28:31], v[108:111]
ds_read_b128 v[52:55], v2 offset:41984
v_mfma_f32_16x16x32_bf16 v[108:111], v[60:63], v[44:47], v[108:111]
s_waitcnt lgkmcnt(4)
v_mfma_f32_16x16x32_bf16 a[112:115], v[64:67], v[144:147], 0
v_mfma_f32_16x16x32_bf16 a[112:115], v[68:71], v[160:163], a[112:115]
buffer_load_dwordx4 v[16:19], v2, s[8:11], s29 offen offset:0 sc1
v_mfma_f32_16x16x32_bf16 a[116:119], v[64:67], v[148:151], 0
ds_read_b128 v[56:59], v2 offset:43008
v_mfma_f32_16x16x32_bf16 a[116:119], v[68:71], v[164:167], a[116:119]
buffer_load_dwordx4 v[20:23], v4, s[8:11], s29 offen offset:0 sc1
v_mul_f32 v208, v80, v80
v_mfma_f32_16x16x32_bf16 a[120:123], v[64:67], v[152:155], 0
v_mul_f32 v210, v81, v81
v_fma_f32 v208, v208, v233, v232
v_mfma_f32_16x16x32_bf16 a[120:123], v[68:71], v[168:171], a[120:123]
buffer_load_dwordx4 v[24:27], v5, s[8:11], s29 offen offset:0 sc1
v_fma_f32 v210, v210, v233, v232
v_mfma_f32_16x16x32_bf16 a[124:127], v[64:67], v[156:159], 0
ds_read_b128 v[60:63], v2 offset:44032
v_mul_f32 v208, v208, v80
v_mfma_f32_16x16x32_bf16 a[124:127], v[68:71], v[172:175], a[124:127]
buffer_load_dwordx4 v[28:31], v6, s[8:11], s29 offen offset:0 sc1
v_mul_f32 v210, v210, v81
v_exp_f32 v208, v208
s_waitcnt lgkmcnt(4)
v_mfma_f32_16x16x32_bf16 a[128:131], v[72:75], v[144:147], 0
v_exp_f32 v210, v210
v_mfma_f32_16x16x32_bf16 a[128:131], v[76:79], v[160:163], a[128:131]
v_mul_f32 v209, v80, v96
v_mul_f32 v211, v81, v97
v_mfma_f32_16x16x32_bf16 a[132:135], v[72:75], v[148:151], 0
ds_read_b128 v[64:67], v2 offset:45056
v_fma_f32 v208, v208, v234, v234
v_mfma_f32_16x16x32_bf16 a[132:135], v[76:79], v[164:167], a[132:135]
v_fma_f32 v210, v210, v234, v234
v_rcp_f32 v208, v208
v_mfma_f32_16x16x32_bf16 a[136:139], v[72:75], v[152:155], 0
v_rcp_f32 v210, v210
v_mfma_f32_16x16x32_bf16 a[136:139], v[76:79], v[168:171], a[136:139]
v_mul_f32 v209, v209, v208
v_mul_f32 v211, v211, v210
v_mfma_f32_16x16x32_bf16 a[140:143], v[72:75], v[156:159], 0
ds_read_b128 v[68:71], v2 offset:46080
v_cvt_pk_bf16_f32 v194, v209, v211
v_mfma_f32_16x16x32_bf16 a[140:143], v[76:79], v[172:175], a[140:143]
v_mul_f32 v212, v82, v82
v_mul_f32 v214, v83, v83
s_waitcnt lgkmcnt(4)
v_mfma_f32_16x16x32_bf16 a[144:147], v[48:51], v[144:147], 0
v_fma_f32 v212, v212, v233, v232
v_fma_f32 v214, v214, v233, v232
v_mfma_f32_16x16x32_bf16 a[144:147], v[52:55], v[160:163], a[144:147]
v_mul_f32 v212, v212, v82
v_mul_f32 v214, v214, v83
v_mfma_f32_16x16x32_bf16 a[148:151], v[48:51], v[148:151], 0
ds_read_b128 v[72:75], v2 offset:47104
v_exp_f32 v212, v212
v_mfma_f32_16x16x32_bf16 a[148:151], v[52:55], v[164:167], a[148:151]
v_exp_f32 v214, v214
v_mfma_f32_16x16x32_bf16 a[152:155], v[48:51], v[152:155], 0
v_mul_f32 v213, v82, v98
v_mul_f32 v215, v83, v99
v_mfma_f32_16x16x32_bf16 a[152:155], v[52:55], v[168:171], a[152:155]
v_fma_f32 v212, v212, v234, v234
v_fma_f32 v214, v214, v234, v234
v_mfma_f32_16x16x32_bf16 a[156:159], v[48:51], v[156:159], 0
ds_read_b128 v[76:79], v2 offset:48128
v_rcp_f32 v212, v212
v_mfma_f32_16x16x32_bf16 a[156:159], v[52:55], v[172:175], a[156:159]
v_rcp_f32 v214, v214
s_waitcnt lgkmcnt(4)
v_mfma_f32_16x16x32_bf16 a[160:163], v[56:59], v[144:147], 0
v_mul_f32 v213, v213, v212
v_mul_f32 v215, v215, v214
v_mfma_f32_16x16x32_bf16 a[160:163], v[60:63], v[160:163], a[160:163]
v_cvt_pk_bf16_f32 v195, v213, v215
buffer_store_dwordx4 v[192:195], v2, s[8:11], s24 offen offset:3072 sc1
v_mfma_f32_16x16x32_bf16 a[164:167], v[56:59], v[148:151], 0
s_waitcnt vmcnt(57)
s_barrier
ds_read_b128 v[48:51], v2 offset:49152
v_mul_f32 v208, v84, v84
v_mfma_f32_16x16x32_bf16 a[164:167], v[60:63], v[164:167], a[164:167]
s_add_u32 m0, s22, 0
v_mul_f32 v210, v85, v85
v_fma_f32 v208, v208, v236, v235
v_mfma_f32_16x16x32_bf16 a[168:171], v[56:59], v[152:155], 0
v_fma_f32 v210, v210, v236, v235
v_mul_f32 v208, v208, v84
v_mfma_f32_16x16x32_bf16 a[168:171], v[60:63], v[168:171], a[168:171]
s_add_u32 s23, s21, 442368
v_mul_f32 v210, v210, v85
v_exp_f32 v208, v208
v_mfma_f32_16x16x32_bf16 a[172:175], v[56:59], v[156:159], 0
ds_read_b128 v[52:55], v2 offset:50176
v_exp_f32 v210, v210
v_mfma_f32_16x16x32_bf16 a[172:175], v[60:63], v[172:175], a[172:175]
buffer_load_dwordx4 v2, s[8:11], s23 offen offset:0 lds
v_mul_f32 v209, v84, v100
s_waitcnt lgkmcnt(4)
v_mfma_f32_16x16x32_bf16 a[176:179], v[64:67], v[144:147], 0
v_mul_f32 v211, v85, v101
v_fma_f32 v208, v208, v237, v237
v_mfma_f32_16x16x32_bf16 a[176:179], v[68:71], v[160:163], a[176:179]
buffer_load_dwordx4 v2, s[8:11], s23 offen offset:1024 lds
v_fma_f32 v210, v210, v237, v237
v_rcp_f32 v208, v208
v_mfma_f32_16x16x32_bf16 a[180:183], v[64:67], v[148:151], 0
ds_read_b128 v[56:59], v2 offset:51200
v_rcp_f32 v210, v210
v_mfma_f32_16x16x32_bf16 a[180:183], v[68:71], v[164:167], a[180:183]
buffer_load_dwordx4 v2, s[8:11], s23 offen offset:2048 lds
v_mul_f32 v209, v209, v208
v_mfma_f32_16x16x32_bf16 a[184:187], v[64:67], v[152:155], 0
v_mul_f32 v211, v211, v210
v_cvt_pk_bf16_f32 v198, v209, v211
v_mfma_f32_16x16x32_bf16 a[184:187], v[68:71], v[168:171], a[184:187]
buffer_load_dwordx4 v2, s[8:11], s23 offen offset:3072 lds
v_mul_f32 v212, v86, v86
v_mul_f32 v214, v87, v87
v_mfma_f32_16x16x32_bf16 a[188:191], v[64:67], v[156:159], 0
ds_read_b128 v[60:63], v2 offset:52224
v_fma_f32 v212, v212, v236, v235
v_fma_f32 v214, v214, v236, v235
v_mfma_f32_16x16x32_bf16 a[188:191], v[68:71], v[172:175], a[188:191]
s_add_u32 m0, s22, 4096
v_mul_f32 v212, v212, v86
v_mul_f32 v214, v214, v87
s_waitcnt lgkmcnt(4)
v_mfma_f32_16x16x32_bf16 a[192:195], v[72:75], v[144:147], 0
v_exp_f32 v212, v212
v_mfma_f32_16x16x32_bf16 a[192:195], v[76:79], v[160:163], a[192:195]
s_add_u32 s23, s21, 446464
v_exp_f32 v214, v214
v_mfma_f32_16x16x32_bf16 a[196:199], v[72:75], v[148:151], 0
ds_read_b128 v[64:67], v2 offset:53248
v_mul_f32 v213, v86, v102
v_mul_f32 v215, v87, v103
v_mfma_f32_16x16x32_bf16 a[196:199], v[76:79], v[164:167], a[196:199]
buffer_load_dwordx4 v2, s[8:11], s23 offen offset:0 lds
v_fma_f32 v212, v212, v237, v237
v_fma_f32 v214, v214, v237, v237
v_mfma_f32_16x16x32_bf16 a[200:203], v[72:75], v[152:155], 0
v_rcp_f32 v212, v212
v_mfma_f32_16x16x32_bf16 a[200:203], v[76:79], v[168:171], a[200:203]
buffer_load_dwordx4 v2, s[8:11], s23 offen offset:1024 lds
v_rcp_f32 v214, v214
v_mfma_f32_16x16x32_bf16 a[204:207], v[72:75], v[156:159], 0
ds_read_b128 v[68:71], v2 offset:54272
v_mul_f32 v213, v213, v212
v_mul_f32 v215, v215, v214
v_mfma_f32_16x16x32_bf16 a[204:207], v[76:79], v[172:175], a[204:207]
v_cvt_pk_bf16_f32 v199, v213, v215
s_waitcnt lgkmcnt(4)
v_mfma_f32_16x16x32_bf16 a[208:211], v[48:51], v[144:147], 0
buffer_store_dwordx4 v[196:199], v4, s[8:11], s24 offen offset:3072 sc1
v_mul_f32 v208, v88, v88
v_mfma_f32_16x16x32_bf16 a[208:211], v[52:55], v[160:163], a[208:211]
v_mul_f32 v210, v89, v89
v_fma_f32 v208, v208, v239, v238
v_mfma_f32_16x16x32_bf16 a[212:215], v[48:51], v[148:151], 0
ds_read_b128 v[72:75], v2 offset:55296
v_fma_f32 v210, v210, v239, v238
v_mul_f32 v208, v208, v88
v_mfma_f32_16x16x32_bf16 a[212:215], v[52:55], v[164:167], a[212:215]
v_mul_f32 v210, v210, v89
v_exp_f32 v208, v208
v_mfma_f32_16x16x32_bf16 a[216:219], v[48:51], v[152:155], 0
v_exp_f32 v210, v210
v_mfma_f32_16x16x32_bf16 a[216:219], v[52:55], v[168:171], a[216:219]
v_mul_f32 v209, v88, v104
v_mul_f32 v211, v89, v105
v_mfma_f32_16x16x32_bf16 a[220:223], v[48:51], v[156:159], 0
ds_read_b128 v[76:79], v2 offset:56320
v_fma_f32 v208, v208, v240, v240
v_mfma_f32_16x16x32_bf16 a[220:223], v[52:55], v[172:175], a[220:223]
v_fma_f32 v210, v210, v240, v240
v_rcp_f32 v208, v208
s_waitcnt lgkmcnt(4)
v_mfma_f32_16x16x32_bf16 a[224:227], v[56:59], v[144:147], 0
v_rcp_f32 v210, v210
v_mfma_f32_16x16x32_bf16 a[224:227], v[60:63], v[160:163], a[224:227]
v_mul_f32 v209, v209, v208
v_mul_f32 v211, v211, v210
v_mfma_f32_16x16x32_bf16 a[228:231], v[56:59], v[148:151], 0
ds_read_b128 v[48:51], v2 offset:57344
v_cvt_pk_bf16_f32 v202, v209, v211
v_mfma_f32_16x16x32_bf16 a[228:231], v[60:63], v[164:167], a[228:231]
v_mul_f32 v212, v90, v90
v_mul_f32 v214, v91, v91
v_mfma_f32_16x16x32_bf16 a[232:235], v[56:59], v[152:155], 0
v_fma_f32 v212, v212, v239, v238
v_fma_f32 v214, v214, v239, v238
v_mfma_f32_16x16x32_bf16 a[232:235], v[60:63], v[168:171], a[232:235]
v_mul_f32 v212, v212, v90
v_mul_f32 v214, v214, v91
v_mfma_f32_16x16x32_bf16 a[236:239], v[56:59], v[156:159], 0
ds_read_b128 v[52:55], v2 offset:58368
v_exp_f32 v212, v212
v_mfma_f32_16x16x32_bf16 a[236:239], v[60:63], v[172:175], a[236:239]
v_exp_f32 v214, v214
s_waitcnt lgkmcnt(4)
v_mfma_f32_16x16x32_bf16 a[240:243], v[64:67], v[144:147], 0
v_mul_f32 v213, v90, v106
v_mul_f32 v215, v91, v107
v_mfma_f32_16x16x32_bf16 a[240:243], v[68:71], v[160:163], a[240:243]
v_fma_f32 v212, v212, v240, v240
v_fma_f32 v214, v214, v240, v240
v_mfma_f32_16x16x32_bf16 a[244:247], v[64:67], v[148:151], 0
ds_read_b128 v[56:59], v2 offset:59392
v_rcp_f32 v212, v212
v_mfma_f32_16x16x32_bf16 a[244:247], v[68:71], v[164:167], a[244:247]
v_rcp_f32 v214, v214
v_mfma_f32_16x16x32_bf16 a[248:251], v[64:67], v[152:155], 0
v_mul_f32 v213, v213, v212
v_mul_f32 v215, v215, v214
v_mfma_f32_16x16x32_bf16 a[248:251], v[68:71], v[168:171], a[248:251]
v_cvt_pk_bf16_f32 v203, v213, v215
buffer_store_dwordx4 v[200:203], v5, s[8:11], s24 offen offset:3072 sc1
v_mfma_f32_16x16x32_bf16 a[252:255], v[64:67], v[156:159], 0
ds_read_b128 v[60:63], v2 offset:60416
v_mul_f32 v208, v92, v92
v_mfma_f32_16x16x32_bf16 a[252:255], v[68:71], v[172:175], a[252:255]
v_mul_f32 v210, v93, v93
v_fma_f32 v208, v208, v242, v241
s_waitcnt vmcnt(44)
s_waitcnt lgkmcnt(4)
v_mfma_f32_16x16x32_bf16 a[112:115], v[72:75], v[176:179], a[112:115]
v_fma_f32 v210, v210, v242, v241
v_mul_f32 v208, v208, v92
v_mfma_f32_16x16x32_bf16 a[112:115], v[76:79], a[0:3], a[112:115]
v_mul_f32 v210, v210, v93
v_exp_f32 v208, v208
v_mfma_f32_16x16x32_bf16 a[116:119], v[72:75], v[180:183], a[116:119]
ds_read_b128 v[64:67], v2 offset:61440
v_exp_f32 v210, v210
v_mfma_f32_16x16x32_bf16 a[116:119], v[76:79], a[4:7], a[116:119]
v_mul_f32 v209, v92, v108
v_mul_f32 v211, v93, v109
v_mfma_f32_16x16x32_bf16 a[120:123], v[72:75], v[184:187], a[120:123]
v_fma_f32 v208, v208, v243, v243
v_fma_f32 v210, v210, v243, v243
v_mfma_f32_16x16x32_bf16 a[120:123], v[76:79], a[8:11], a[120:123]
v_rcp_f32 v208, v208
v_mfma_f32_16x16x32_bf16 a[124:127], v[72:75], v[188:191], a[124:127]
ds_read_b128 v[68:71], v2 offset:62464
v_rcp_f32 v210, v210
v_mfma_f32_16x16x32_bf16 a[124:127], v[76:79], a[12:15], a[124:127]
v_mul_f32 v209, v209, v208
s_waitcnt lgkmcnt(4)
v_mfma_f32_16x16x32_bf16 a[128:131], v[48:51], v[176:179], a[128:131]
v_mul_f32 v211, v211, v210
v_cvt_pk_bf16_f32 v206, v209, v211
v_mfma_f32_16x16x32_bf16 a[128:131], v[52:55], a[0:3], a[128:131]
v_mul_f32 v212, v94, v94
v_mul_f32 v214, v95, v95
v_mfma_f32_16x16x32_bf16 a[132:135], v[48:51], v[180:183], a[132:135]
ds_read_b128 v[72:75], v2 offset:63488
v_fma_f32 v212, v212, v242, v241
v_fma_f32 v214, v214, v242, v241
v_mfma_f32_16x16x32_bf16 a[132:135], v[52:55], a[4:7], a[132:135]
v_mul_f32 v212, v212, v94
v_mul_f32 v214, v214, v95
v_mfma_f32_16x16x32_bf16 a[136:139], v[48:51], v[184:187], a[136:139]
v_exp_f32 v212, v212
v_mfma_f32_16x16x32_bf16 a[136:139], v[52:55], a[8:11], a[136:139]
v_exp_f32 v214, v214
v_mfma_f32_16x16x32_bf16 a[140:143], v[48:51], v[188:191], a[140:143]
ds_read_b128 v[76:79], v2 offset:64512
v_mul_f32 v213, v94, v110
v_mul_f32 v215, v95, v111
v_mfma_f32_16x16x32_bf16 a[140:143], v[52:55], a[12:15], a[140:143]
v_fma_f32 v212, v212, v243, v243
v_fma_f32 v214, v214, v243, v243
s_waitcnt lgkmcnt(4)
v_mfma_f32_16x16x32_bf16 a[144:147], v[56:59], v[176:179], a[144:147]
v_rcp_f32 v212, v212
v_mfma_f32_16x16x32_bf16 a[144:147], v[60:63], a[0:3], a[144:147]
v_rcp_f32 v214, v214
v_mfma_f32_16x16x32_bf16 a[148:151], v[56:59], v[180:183], a[148:151]
ds_read_b128 v[48:51], v7 offset:0
v_mul_f32 v213, v213, v212
v_mul_f32 v215, v215, v214
v_mfma_f32_16x16x32_bf16 a[148:151], v[60:63], a[4:7], a[148:151]
v_cvt_pk_bf16_f32 v207, v213, v215
buffer_store_dwordx4 v[204:207], v6, s[8:11], s24 offen offset:3072 sc1
v_mfma_f32_16x16x32_bf16 a[152:155], v[56:59], v[184:187], a[152:155]
v_mfma_f32_16x16x32_bf16 a[152:155], v[60:63], a[8:11], a[152:155]
v_mfma_f32_16x16x32_bf16 a[156:159], v[56:59], v[188:191], a[156:159]
ds_read_b128 v[52:55], v7 offset:1024
v_mfma_f32_16x16x32_bf16 a[156:159], v[60:63], a[12:15], a[156:159]
s_waitcnt lgkmcnt(4)
v_mfma_f32_16x16x32_bf16 a[160:163], v[64:67], v[176:179], a[160:163]
v_mfma_f32_16x16x32_bf16 a[160:163], v[68:71], a[0:3], a[160:163]
v_mfma_f32_16x16x32_bf16 a[164:167], v[64:67], v[180:183], a[164:167]
ds_read_b128 v[56:59], v7 offset:2048
v_mfma_f32_16x16x32_bf16 a[164:167], v[68:71], a[4:7], a[164:167]
v_mfma_f32_16x16x32_bf16 a[168:171], v[64:67], v[184:187], a[168:171]
v_mfma_f32_16x16x32_bf16 a[168:171], v[68:71], a[8:11], a[168:171]
v_mfma_f32_16x16x32_bf16 a[172:175], v[64:67], v[188:191], a[172:175]
ds_read_b128 v[60:63], v7 offset:3072
v_mfma_f32_16x16x32_bf16 a[172:175], v[68:71], a[12:15], a[172:175]
s_waitcnt lgkmcnt(4)
v_mfma_f32_16x16x32_bf16 a[176:179], v[72:75], v[176:179], a[176:179]
v_mfma_f32_16x16x32_bf16 a[176:179], v[76:79], a[0:3], a[176:179]
v_mfma_f32_16x16x32_bf16 a[180:183], v[72:75], v[180:183], a[180:183]
ds_read_b128 v[64:67], v7 offset:4096
v_mfma_f32_16x16x32_bf16 a[180:183], v[76:79], a[4:7], a[180:183]
v_mfma_f32_16x16x32_bf16 a[184:187], v[72:75], v[184:187], a[184:187]
v_mfma_f32_16x16x32_bf16 a[184:187], v[76:79], a[8:11], a[184:187]
v_mfma_f32_16x16x32_bf16 a[188:191], v[72:75], v[188:191], a[188:191]
ds_read_b128 v[68:71], v7 offset:5120
v_mfma_f32_16x16x32_bf16 a[188:191], v[76:79], a[12:15], a[188:191]
s_waitcnt lgkmcnt(4)
v_mfma_f32_16x16x32_bf16 a[192:195], v[48:51], v[176:179], a[192:195]
v_mfma_f32_16x16x32_bf16 a[192:195], v[52:55], a[0:3], a[192:195]
v_mfma_f32_16x16x32_bf16 a[196:199], v[48:51], v[180:183], a[196:199]
ds_read_b128 v[72:75], v7 offset:6144
v_mfma_f32_16x16x32_bf16 a[196:199], v[52:55], a[4:7], a[196:199]
v_mfma_f32_16x16x32_bf16 a[200:203], v[48:51], v[184:187], a[200:203]
v_mfma_f32_16x16x32_bf16 a[200:203], v[52:55], a[8:11], a[200:203]
v_mfma_f32_16x16x32_bf16 a[204:207], v[48:51], v[188:191], a[204:207]
ds_read_b128 v[76:79], v7 offset:7168
v_mfma_f32_16x16x32_bf16 a[204:207], v[52:55], a[12:15], a[204:207]
s_waitcnt lgkmcnt(4)
v_mfma_f32_16x16x32_bf16 a[208:211], v[56:59], v[176:179], a[208:211]
v_mfma_f32_16x16x32_bf16 a[208:211], v[60:63], a[0:3], a[208:211]
v_mfma_f32_16x16x32_bf16 a[212:215], v[56:59], v[180:183], a[212:215]
s_waitcnt vmcnt(58)
s_barrier
buffer_load_dword v13, v11, s[8:11], s34 offen sc1
ds_read_b128 v[48:51], v7 offset:8192
v_mfma_f32_16x16x32_bf16 a[212:215], v[60:63], a[4:7], a[212:215]
s_add_u32 m0, s22, 24576
v_mfma_f32_16x16x32_bf16 a[216:219], v[56:59], v[184:187], a[216:219]
v_mfma_f32_16x16x32_bf16 a[216:219], v[60:63], a[8:11], a[216:219]
s_add_u32 s23, s21, 466944
v_mfma_f32_16x16x32_bf16 a[220:223], v[56:59], v[188:191], a[220:223]
ds_read_b128 v[52:55], v7 offset:9216
v_mfma_f32_16x16x32_bf16 a[220:223], v[60:63], a[12:15], a[220:223]
buffer_load_dwordx4 v2, s[8:11], s23 offen offset:0 lds
s_waitcnt lgkmcnt(4)
v_mfma_f32_16x16x32_bf16 a[224:227], v[64:67], v[176:179], a[224:227]
v_mfma_f32_16x16x32_bf16 a[224:227], v[68:71], a[0:3], a[224:227]
buffer_load_dwordx4 v2, s[8:11], s23 offen offset:1024 lds
v_mfma_f32_16x16x32_bf16 a[228:231], v[64:67], v[180:183], a[228:231]
ds_read_b128 v[56:59], v7 offset:10240
v_mfma_f32_16x16x32_bf16 a[228:231], v[68:71], a[4:7], a[228:231]
buffer_load_dwordx4 v2, s[8:11], s23 offen offset:2048 lds
v_mfma_f32_16x16x32_bf16 a[232:235], v[64:67], v[184:187], a[232:235]
v_mfma_f32_16x16x32_bf16 a[232:235], v[68:71], a[8:11], a[232:235]
buffer_load_dwordx4 v2, s[8:11], s23 offen offset:3072 lds
v_mfma_f32_16x16x32_bf16 a[236:239], v[64:67], v[188:191], a[236:239]
ds_read_b128 v[60:63], v7 offset:11264
v_mfma_f32_16x16x32_bf16 a[236:239], v[68:71], a[12:15], a[236:239]
s_add_u32 m0, s22, 28672
s_waitcnt lgkmcnt(4)
v_mfma_f32_16x16x32_bf16 a[240:243], v[72:75], v[176:179], a[240:243]
v_mfma_f32_16x16x32_bf16 a[240:243], v[76:79], a[0:3], a[240:243]
s_add_u32 s23, s21, 471040
v_mfma_f32_16x16x32_bf16 a[244:247], v[72:75], v[180:183], a[244:247]
ds_read_b128 v[64:67], v7 offset:12288
v_mfma_f32_16x16x32_bf16 a[244:247], v[76:79], a[4:7], a[244:247]
buffer_load_dwordx4 v2, s[8:11], s23 offen offset:0 lds
v_mfma_f32_16x16x32_bf16 a[248:251], v[72:75], v[184:187], a[248:251]
v_mfma_f32_16x16x32_bf16 a[248:251], v[76:79], a[8:11], a[248:251]
buffer_load_dwordx4 v2, s[8:11], s23 offen offset:1024 lds
v_mfma_f32_16x16x32_bf16 a[252:255], v[72:75], v[188:191], a[252:255]
ds_read_b128 v[68:71], v7 offset:13312
v_mfma_f32_16x16x32_bf16 a[252:255], v[76:79], a[12:15], a[252:255]
s_waitcnt vmcnt(44)
s_waitcnt lgkmcnt(4)
v_mfma_f32_16x16x32_bf16 a[112:115], v[48:51], a[16:19], a[112:115]
v_mfma_f32_16x16x32_bf16 a[112:115], v[52:55], a[32:35], a[112:115]
v_mfma_f32_16x16x32_bf16 a[116:119], v[48:51], a[20:23], a[116:119]
ds_read_b128 v[72:75], v7 offset:14336
v_mfma_f32_16x16x32_bf16 a[116:119], v[52:55], a[36:39], a[116:119]
v_mfma_f32_16x16x32_bf16 a[120:123], v[48:51], a[24:27], a[120:123]
v_mfma_f32_16x16x32_bf16 a[120:123], v[52:55], a[40:43], a[120:123]
v_mfma_f32_16x16x32_bf16 a[124:127], v[48:51], a[28:31], a[124:127]
ds_read_b128 v[76:79], v7 offset:15360
v_mfma_f32_16x16x32_bf16 a[124:127], v[52:55], a[44:47], a[124:127]
s_waitcnt lgkmcnt(4)
v_mfma_f32_16x16x32_bf16 a[128:131], v[56:59], a[16:19], a[128:131]
v_mfma_f32_16x16x32_bf16 a[128:131], v[60:63], a[32:35], a[128:131]
v_mfma_f32_16x16x32_bf16 a[132:135], v[56:59], a[20:23], a[132:135]
ds_read_b128 v[48:51], v7 offset:16384
v_mfma_f32_16x16x32_bf16 a[132:135], v[60:63], a[36:39], a[132:135]
v_mfma_f32_16x16x32_bf16 a[136:139], v[56:59], a[24:27], a[136:139]
v_mfma_f32_16x16x32_bf16 a[136:139], v[60:63], a[40:43], a[136:139]
v_mfma_f32_16x16x32_bf16 a[140:143], v[56:59], a[28:31], a[140:143]
ds_read_b128 v[52:55], v7 offset:17408
v_mfma_f32_16x16x32_bf16 a[140:143], v[60:63], a[44:47], a[140:143]
s_waitcnt lgkmcnt(4)
v_mfma_f32_16x16x32_bf16 a[144:147], v[64:67], a[16:19], a[144:147]
v_mfma_f32_16x16x32_bf16 a[144:147], v[68:71], a[32:35], a[144:147]
v_mfma_f32_16x16x32_bf16 a[148:151], v[64:67], a[20:23], a[148:151]
ds_read_b128 v[56:59], v7 offset:18432
v_mfma_f32_16x16x32_bf16 a[148:151], v[68:71], a[36:39], a[148:151]
v_mfma_f32_16x16x32_bf16 a[152:155], v[64:67], a[24:27], a[152:155]
v_mfma_f32_16x16x32_bf16 a[152:155], v[68:71], a[40:43], a[152:155]
v_mfma_f32_16x16x32_bf16 a[156:159], v[64:67], a[28:31], a[156:159]
ds_read_b128 v[60:63], v7 offset:19456
v_mfma_f32_16x16x32_bf16 a[156:159], v[68:71], a[44:47], a[156:159]
s_waitcnt lgkmcnt(4)
v_mfma_f32_16x16x32_bf16 a[160:163], v[72:75], a[16:19], a[160:163]
v_mfma_f32_16x16x32_bf16 a[160:163], v[76:79], a[32:35], a[160:163]
v_mfma_f32_16x16x32_bf16 a[164:167], v[72:75], a[20:23], a[164:167]
ds_read_b128 v[64:67], v7 offset:20480
v_mfma_f32_16x16x32_bf16 a[164:167], v[76:79], a[36:39], a[164:167]
v_mfma_f32_16x16x32_bf16 a[168:171], v[72:75], a[24:27], a[168:171]
v_mfma_f32_16x16x32_bf16 a[168:171], v[76:79], a[40:43], a[168:171]
v_mfma_f32_16x16x32_bf16 a[172:175], v[72:75], a[28:31], a[172:175]
ds_read_b128 v[68:71], v7 offset:21504
v_mfma_f32_16x16x32_bf16 a[172:175], v[76:79], a[44:47], a[172:175]
s_waitcnt lgkmcnt(4)
v_mfma_f32_16x16x32_bf16 a[176:179], v[48:51], a[16:19], a[176:179]
s_waitcnt vmcnt(6)
v_cmp_le_u32 vcc, 2, v13
s_nop 0
s_cmp_eq_u64 vcc, exec
s_cbranch_scc0 L_f_slow2
L_f_back2:
v_mfma_f32_16x16x32_bf16 a[176:179], v[52:55], a[32:35], a[176:179]
buffer_load_dwordx4 v[32:35], v2, s[8:11], s25 offen offset:2048 sc1
v_mfma_f32_16x16x32_bf16 a[180:183], v[48:51], a[20:23], a[180:183]
ds_read_b128 v[72:75], v7 offset:22528
v_mfma_f32_16x16x32_bf16 a[180:183], v[52:55], a[36:39], a[180:183]
buffer_load_dwordx4 v[36:39], v4, s[8:11], s25 offen offset:2048 sc1
v_mfma_f32_16x16x32_bf16 a[184:187], v[48:51], a[24:27], a[184:187]
v_mfma_f32_16x16x32_bf16 a[184:187], v[52:55], a[40:43], a[184:187]
buffer_load_dwordx4 v[40:43], v5, s[8:11], s25 offen offset:2048 sc1
v_mfma_f32_16x16x32_bf16 a[188:191], v[48:51], a[28:31], a[188:191]
ds_read_b128 v[76:79], v7 offset:23552
v_mfma_f32_16x16x32_bf16 a[188:191], v[52:55], a[44:47], a[188:191]
buffer_load_dwordx4 v[44:47], v6, s[8:11], s25 offen offset:2048 sc1
s_waitcnt lgkmcnt(4)
v_mfma_f32_16x16x32_bf16 a[192:195], v[56:59], a[16:19], a[192:195]
v_mfma_f32_16x16x32_bf16 a[192:195], v[60:63], a[32:35], a[192:195]
buffer_load_dwordx4 v[112:115], v2, s[8:11], s26 offen offset:2048 sc1
v_mfma_f32_16x16x32_bf16 a[196:199], v[56:59], a[20:23], a[196:199]
ds_read_b128 v[48:51], v7 offset:24576
v_mfma_f32_16x16x32_bf16 a[196:199], v[60:63], a[36:39], a[196:199]
buffer_load_dwordx4 v[116:119], v4, s[8:11], s26 offen offset:2048 sc1
v_mfma_f32_16x16x32_bf16 a[200:203], v[56:59], a[24:27], a[200:203]
v_mfma_f32_16x16x32_bf16 a[200:203], v[60:63], a[40:43], a[200:203]
buffer_load_dwordx4 v[120:123], v5, s[8:11], s26 offen offset:2048 sc1
v_mfma_f32_16x16x32_bf16 a[204:207], v[56:59], a[28:31], a[204:207]
ds_read_b128 v[52:55], v7 offset:25600
v_mfma_f32_16x16x32_bf16 a[204:207], v[60:63], a[44:47], a[204:207]
buffer_load_dwordx4 v[124:127], v6, s[8:11], s26 offen offset:2048 sc1
s_waitcnt lgkmcnt(4)
v_mfma_f32_16x16x32_bf16 a[208:211], v[64:67], a[16:19], a[208:211]
v_mfma_f32_16x16x32_bf16 a[208:211], v[68:71], a[32:35], a[208:211]
buffer_load_dwordx4 v[128:131], v2, s[8:11], s27 offen offset:2048 sc1
v_mfma_f32_16x16x32_bf16 a[212:215], v[64:67], a[20:23], a[212:215]
ds_read_b128 v[56:59], v7 offset:26624
v_mfma_f32_16x16x32_bf16 a[212:215], v[68:71], a[36:39], a[212:215]
buffer_load_dwordx4 v[132:135], v4, s[8:11], s27 offen offset:2048 sc1
v_mfma_f32_16x16x32_bf16 a[216:219], v[64:67], a[24:27], a[216:219]
v_mfma_f32_16x16x32_bf16 a[216:219], v[68:71], a[40:43], a[216:219]
buffer_load_dwordx4 v[136:139], v5, s[8:11], s27 offen offset:2048 sc1
v_mfma_f32_16x16x32_bf16 a[220:223], v[64:67], a[28:31], a[220:223]
ds_read_b128 v[60:63], v7 offset:27648
v_mfma_f32_16x16x32_bf16 a[220:223], v[68:71], a[44:47], a[220:223]
buffer_load_dwordx4 v[140:143], v6, s[8:11], s27 offen offset:2048 sc1
s_waitcnt lgkmcnt(4)
v_mfma_f32_16x16x32_bf16 a[224:227], v[72:75], a[16:19], a[224:227]
v_mfma_f32_16x16x32_bf16 a[224:227], v[76:79], a[32:35], a[224:227]
v_mfma_f32_16x16x32_bf16 a[228:231], v[72:75], a[20:23], a[228:231]
ds_read_b128 v[64:67], v7 offset:28672
v_mfma_f32_16x16x32_bf16 a[228:231], v[76:79], a[36:39], a[228:231]
v_mfma_f32_16x16x32_bf16 a[232:235], v[72:75], a[24:27], a[232:235]
v_mfma_f32_16x16x32_bf16 a[232:235], v[76:79], a[40:43], a[232:235]
v_mfma_f32_16x16x32_bf16 a[236:239], v[72:75], a[28:31], a[236:239]
ds_read_b128 v[68:71], v7 offset:29696
v_mfma_f32_16x16x32_bf16 a[236:239], v[76:79], a[44:47], a[236:239]
s_waitcnt lgkmcnt(4)
v_mfma_f32_16x16x32_bf16 a[240:243], v[48:51], a[16:19], a[240:243]
v_mfma_f32_16x16x32_bf16 a[240:243], v[52:55], a[32:35], a[240:243]
v_mfma_f32_16x16x32_bf16 a[244:247], v[48:51], a[20:23], a[244:247]
ds_read_b128 v[72:75], v7 offset:30720
v_mfma_f32_16x16x32_bf16 a[244:247], v[52:55], a[36:39], a[244:247]
v_mfma_f32_16x16x32_bf16 a[248:251], v[48:51], a[24:27], a[248:251]
v_mfma_f32_16x16x32_bf16 a[248:251], v[52:55], a[40:43], a[248:251]
v_mfma_f32_16x16x32_bf16 a[252:255], v[48:51], a[28:31], a[252:255]
ds_read_b128 v[76:79], v7 offset:31744
v_mfma_f32_16x16x32_bf16 a[252:255], v[52:55], a[44:47], a[252:255]
s_waitcnt vmcnt(48)
s_waitcnt lgkmcnt(4)
v_mfma_f32_16x16x32_bf16 a[112:115], v[56:59], a[48:51], a[112:115]
v_mfma_f32_16x16x32_bf16 a[112:115], v[60:63], a[64:67], a[112:115]
v_mfma_f32_16x16x32_bf16 a[116:119], v[56:59], a[52:55], a[116:119]
s_waitcnt vmcnt(0)
s_barrier
v_mov_b32 v12, 3
buffer_store_dword v12, v10, s[8:11], s34 offen sc1
ds_read_b128 v[48:51], v7 offset:32768
v_mfma_f32_16x16x32_bf16 a[116:119], v[60:63], a[68:71], a[116:119]
s_add_u32 m0, s22, 49152
v_mfma_f32_16x16x32_bf16 a[120:123], v[56:59], a[56:59], a[120:123]
v_mfma_f32_16x16x32_bf16 a[120:123], v[60:63], a[72:75], a[120:123]
s_add_u32 s23, s21, 491520
v_mfma_f32_16x16x32_bf16 a[124:127], v[56:59], a[60:63], a[124:127]
ds_read_b128 v[52:55], v7 offset:33792
v_mfma_f32_16x16x32_bf16 a[124:127], v[60:63], a[76:79], a[124:127]
buffer_load_dwordx4 v2, s[8:11], s23 offen offset:0 lds
s_waitcnt lgkmcnt(4)
v_mfma_f32_16x16x32_bf16 a[128:131], v[64:67], a[48:51], a[128:131]
v_mfma_f32_16x16x32_bf16 a[128:131], v[68:71], a[64:67], a[128:131]
buffer_load_dwordx4 v2, s[8:11], s23 offen offset:1024 lds
v_mfma_f32_16x16x32_bf16 a[132:135], v[64:67], a[52:55], a[132:135]
ds_read_b128 v[56:59], v7 offset:34816
v_mfma_f32_16x16x32_bf16 a[132:135], v[68:71], a[68:71], a[132:135]
buffer_load_dwordx4 v2, s[8:11], s23 offen offset:2048 lds
v_mfma_f32_16x16x32_bf16 a[136:139], v[64:67], a[56:59], a[136:139]
v_mfma_f32_16x16x32_bf16 a[136:139], v[68:71], a[72:75], a[136:139]
buffer_load_dwordx4 v2, s[8:11], s23 offen offset:3072 lds
v_mfma_f32_16x16x32_bf16 a[140:143], v[64:67], a[60:63], a[140:143]
ds_read_b128 v[60:63], v7 offset:35840
v_mfma_f32_16x16x32_bf16 a[140:143], v[68:71], a[76:79], a[140:143]
s_add_u32 m0, s22, 53248
s_waitcnt lgkmcnt(4)
v_mfma_f32_16x16x32_bf16 a[144:147], v[72:75], a[48:51], a[144:147]
v_mfma_f32_16x16x32_bf16 a[144:147], v[76:79], a[64:67], a[144:147]
s_add_u32 s23, s21, 495616
v_mfma_f32_16x16x32_bf16 a[148:151], v[72:75], a[52:55], a[148:151]
ds_read_b128 v[64:67], v7 offset:36864
v_mfma_f32_16x16x32_bf16 a[148:151], v[76:79], a[68:71], a[148:151]
buffer_load_dwordx4 v2, s[8:11], s23 offen offset:0 lds
v_mfma_f32_16x16x32_bf16 a[152:155], v[72:75], a[56:59], a[152:155]
v_mfma_f32_16x16x32_bf16 a[152:155], v[76:79], a[72:75], a[152:155]
buffer_load_dwordx4 v2, s[8:11], s23 offen offset:1024 lds
v_mfma_f32_16x16x32_bf16 a[156:159], v[72:75], a[60:63], a[156:159]
ds_read_b128 v[68:71], v7 offset:37888
v_mfma_f32_16x16x32_bf16 a[156:159], v[76:79], a[76:79], a[156:159]
s_waitcnt lgkmcnt(4)
v_mfma_f32_16x16x32_bf16 a[160:163], v[48:51], a[48:51], a[160:163]
v_mfma_f32_16x16x32_bf16 a[160:163], v[52:55], a[64:67], a[160:163]
v_mfma_f32_16x16x32_bf16 a[164:167], v[48:51], a[52:55], a[164:167]
ds_read_b128 v[72:75], v7 offset:38912
v_mfma_f32_16x16x32_bf16 a[164:167], v[52:55], a[68:71], a[164:167]
v_mfma_f32_16x16x32_bf16 a[168:171], v[48:51], a[56:59], a[168:171]
v_mfma_f32_16x16x32_bf16 a[168:171], v[52:55], a[72:75], a[168:171]
v_mfma_f32_16x16x32_bf16 a[172:175], v[48:51], a[60:63], a[172:175]
ds_read_b128 v[76:79], v7 offset:39936
v_mfma_f32_16x16x32_bf16 a[172:175], v[52:55], a[76:79], a[172:175]
s_waitcnt lgkmcnt(4)
v_mfma_f32_16x16x32_bf16 a[176:179], v[56:59], a[48:51], a[176:179]
v_mfma_f32_16x16x32_bf16 a[176:179], v[60:63], a[64:67], a[176:179]
v_mfma_f32_16x16x32_bf16 a[180:183], v[56:59], a[52:55], a[180:183]
ds_read_b128 v[48:51], v7 offset:40960
v_mfma_f32_16x16x32_bf16 a[180:183], v[60:63], a[68:71], a[180:183]
v_mfma_f32_16x16x32_bf16 a[184:187], v[56:59], a[56:59], a[184:187]
v_mfma_f32_16x16x32_bf16 a[184:187], v[60:63], a[72:75], a[184:187]
v_mfma_f32_16x16x32_bf16 a[188:191], v[56:59], a[60:63], a[188:191]
ds_read_b128 v[52:55], v7 offset:41984
v_mfma_f32_16x16x32_bf16 a[188:191], v[60:63], a[76:79], a[188:191]
s_waitcnt lgkmcnt(4)
v_mfma_f32_16x16x32_bf16 a[192:195], v[64:67], a[48:51], a[192:195]
v_mfma_f32_16x16x32_bf16 a[192:195], v[68:71], a[64:67], a[192:195]
v_mfma_f32_16x16x32_bf16 a[196:199], v[64:67], a[52:55], a[196:199]
ds_read_b128 v[56:59], v7 offset:43008
v_mfma_f32_16x16x32_bf16 a[196:199], v[68:71], a[68:71], a[196:199]
v_mfma_f32_16x16x32_bf16 a[200:203], v[64:67], a[56:59], a[200:203]
v_mfma_f32_16x16x32_bf16 a[200:203], v[68:71], a[72:75], a[200:203]
v_mfma_f32_16x16x32_bf16 a[204:207], v[64:67], a[60:63], a[204:207]
ds_read_b128 v[60:63], v7 offset:44032
v_mfma_f32_16x16x32_bf16 a[204:207], v[68:71], a[76:79], a[204:207]
s_waitcnt lgkmcnt(4)
v_mfma_f32_16x16x32_bf16 a[208:211], v[72:75], a[48:51], a[208:211]
v_mfma_f32_16x16x32_bf16 a[208:211], v[76:79], a[64:67], a[208:211]
v_mfma_f32_16x16x32_bf16 a[212:215], v[72:75], a[52:55], a[212:215]
ds_read_b128 v[64:67], v7 offset:45056
v_mfma_f32_16x16x32_bf16 a[212:215], v[76:79], a[68:71], a[212:215]
v_mfma_f32_16x16x32_bf16 a[216:219], v[72:75], a[56:59], a[216:219]
v_mfma_f32_16x16x32_bf16 a[216:219], v[76:79], a[72:75], a[216:219]
v_mfma_f32_16x16x32_bf16 a[220:223], v[72:75], a[60:63], a[220:223]
ds_read_b128 v[68:71], v7 offset:46080
v_mfma_f32_16x16x32_bf16 a[220:223], v[76:79], a[76:79], a[220:223]
s_waitcnt lgkmcnt(4)
v_mfma_f32_16x16x32_bf16 a[224:227], v[48:51], a[48:51], a[224:227]
v_mfma_f32_16x16x32_bf16 a[224:227], v[52:55], a[64:67], a[224:227]
v_mfma_f32_16x16x32_bf16 a[228:231], v[48:51], a[52:55], a[228:231]
ds_read_b128 v[72:75], v7 offset:47104
v_mfma_f32_16x16x32_bf16 a[228:231], v[52:55], a[68:71], a[228:231]
v_mfma_f32_16x16x32_bf16 a[232:235], v[48:51], a[56:59], a[232:235]
v_mfma_f32_16x16x32_bf16 a[232:235], v[52:55], a[72:75], a[232:235]
v_mfma_f32_16x16x32_bf16 a[236:239], v[48:51], a[60:63], a[236:239]
ds_read_b128 v[76:79], v7 offset:48128
v_mfma_f32_16x16x32_bf16 a[236:239], v[52:55], a[76:79], a[236:239]
s_waitcnt lgkmcnt(4)
v_mfma_f32_16x16x32_bf16 a[240:243], v[56:59], a[48:51], a[240:243]
v_mfma_f32_16x16x32_bf16 a[240:243], v[60:63], a[64:67], a[240:243]
v_mfma_f32_16x16x32_bf16 a[244:247], v[56:59], a[52:55], a[244:247]
ds_read_b128 v[48:51], v7 offset:49152
v_mfma_f32_16x16x32_bf16 a[244:247], v[60:63], a[68:71], a[244:247]
v_mfma_f32_16x16x32_bf16 a[248:251], v[56:59], a[56:59], a[248:251]
v_mfma_f32_16x16x32_bf16 a[248:251], v[60:63], a[72:75], a[248:251]
v_mfma_f32_16x16x32_bf16 a[252:255], v[56:59], a[60:63], a[252:255]
ds_read_b128 v[52:55], v7 offset:50176
v_mfma_f32_16x16x32_bf16 a[252:255], v[60:63], a[76:79], a[252:255]
s_waitcnt vmcnt(47)
s_waitcnt lgkmcnt(4)
v_mfma_f32_16x16x32_bf16 a[112:115], v[64:67], a[80:83], a[112:115]
v_mfma_f32_16x16x32_bf16 a[112:115], v[68:71], a[96:99], a[112:115]
v_mfma_f32_16x16x32_bf16 a[116:119], v[64:67], a[84:87], a[116:119]
ds_read_b128 v[56:59], v7 offset:51200
v_mfma_f32_16x16x32_bf16 a[116:119], v[68:71], a[100:103], a[116:119]
v_mfma_f32_16x16x32_bf16 a[120:123], v[64:67], a[88:91], a[120:123]
v_mfma_f32_16x16x32_bf16 a[120:123], v[68:71], a[104:107], a[120:123]
v_mfma_f32_16x16x32_bf16 a[124:127], v[64:67], a[92:95], a[124:127]
ds_read_b128 v[60:63], v7 offset:52224
v_mfma_f32_16x16x32_bf16 a[124:127], v[68:71], a[108:111], a[124:127]
s_waitcnt lgkmcnt(4)
v_mfma_f32_16x16x32_bf16 a[128:131], v[72:75], a[80:83], a[128:131]
v_mfma_f32_16x16x32_bf16 a[128:131], v[76:79], a[96:99], a[128:131]
v_mfma_f32_16x16x32_bf16 a[132:135], v[72:75], a[84:87], a[132:135]
ds_read_b128 v[64:67], v7 offset:53248
v_mfma_f32_16x16x32_bf16 a[132:135], v[76:79], a[100:103], a[132:135]
v_mfma_f32_16x16x32_bf16 a[136:139], v[72:75], a[88:91], a[136:139]
v_mfma_f32_16x16x32_bf16 a[136:139], v[76:79], a[104:107], a[136:139]
v_mfma_f32_16x16x32_bf16 a[140:143], v[72:75], a[92:95], a[140:143]
ds_read_b128 v[68:71], v7 offset:54272
v_mfma_f32_16x16x32_bf16 a[140:143], v[76:79], a[108:111], a[140:143]
s_waitcnt lgkmcnt(4)
v_mfma_f32_16x16x32_bf16 a[144:147], v[48:51], a[80:83], a[144:147]
v_mfma_f32_16x16x32_bf16 a[144:147], v[52:55], a[96:99], a[144:147]
v_mfma_f32_16x16x32_bf16 a[148:151], v[48:51], a[84:87], a[148:151]
ds_read_b128 v[72:75], v7 offset:55296
v_mfma_f32_16x16x32_bf16 a[148:151], v[52:55], a[100:103], a[148:151]
v_mfma_f32_16x16x32_bf16 a[152:155], v[48:51], a[88:91], a[152:155]
v_mfma_f32_16x16x32_bf16 a[152:155], v[52:55], a[104:107], a[152:155]
v_mfma_f32_16x16x32_bf16 a[156:159], v[48:51], a[92:95], a[156:159]
ds_read_b128 v[76:79], v7 offset:56320
v_mfma_f32_16x16x32_bf16 a[156:159], v[52:55], a[108:111], a[156:159]
s_waitcnt lgkmcnt(4)
v_mfma_f32_16x16x32_bf16 a[160:163], v[56:59], a[80:83], a[160:163]
v_mfma_f32_16x16x32_bf16 a[160:163], v[60:63], a[96:99], a[160:163]
v_mfma_f32_16x16x32_bf16 a[164:167], v[56:59], a[84:87], a[164:167]
s_waitcnt vmcnt(40)
s_barrier
buffer_load_dword v13, v11, s[8:11], s34 offen sc1
ds_read_b128 v[48:51], v7 offset:57344
v_mfma_f32_16x16x32_bf16 a[164:167], v[60:63], a[100:103], a[164:167]
v_mfma_f32_16x16x32_bf16 a[168:171], v[56:59], a[88:91], a[168:171]
v_mfma_f32_16x16x32_bf16 a[168:171], v[60:63], a[104:107], a[168:171]
v_mfma_f32_16x16x32_bf16 a[172:175], v[56:59], a[92:95], a[172:175]
ds_read_b128 v[52:55], v7 offset:58368
v_mfma_f32_16x16x32_bf16 a[172:175], v[60:63], a[108:111], a[172:175]
s_waitcnt lgkmcnt(4)
v_mfma_f32_16x16x32_bf16 a[176:179], v[64:67], a[80:83], a[176:179]
v_mfma_f32_16x16x32_bf16 a[176:179], v[68:71], a[96:99], a[176:179]
v_mfma_f32_16x16x32_bf16 a[180:183], v[64:67], a[84:87], a[180:183]
ds_read_b128 v[56:59], v7 offset:59392
v_mfma_f32_16x16x32_bf16 a[180:183], v[68:71], a[100:103], a[180:183]
v_mfma_f32_16x16x32_bf16 a[184:187], v[64:67], a[88:91], a[184:187]
v_mfma_f32_16x16x32_bf16 a[184:187], v[68:71], a[104:107], a[184:187]
v_mfma_f32_16x16x32_bf16 a[188:191], v[64:67], a[92:95], a[188:191]
ds_read_b128 v[60:63], v7 offset:60416
v_mfma_f32_16x16x32_bf16 a[188:191], v[68:71], a[108:111], a[188:191]
s_waitcnt lgkmcnt(4)
v_mfma_f32_16x16x32_bf16 a[192:195], v[72:75], a[80:83], a[192:195]
v_mfma_f32_16x16x32_bf16 a[192:195], v[76:79], a[96:99], a[192:195]
v_mfma_f32_16x16x32_bf16 a[196:199], v[72:75], a[84:87], a[196:199]
ds_read_b128 v[64:67], v7 offset:61440
v_mfma_f32_16x16x32_bf16 a[196:199], v[76:79], a[100:103], a[196:199]
v_mfma_f32_16x16x32_bf16 a[200:203], v[72:75], a[88:91], a[200:203]
v_mfma_f32_16x16x32_bf16 a[200:203], v[76:79], a[104:107], a[200:203]
v_mfma_f32_16x16x32_bf16 a[204:207], v[72:75], a[92:95], a[204:207]
ds_read_b128 v[68:71], v7 offset:62464
v_mfma_f32_16x16x32_bf16 a[204:207], v[76:79], a[108:111], a[204:207]
s_waitcnt lgkmcnt(4)
v_mfma_f32_16x16x32_bf16 a[208:211], v[48:51], a[80:83], a[208:211]
v_mfma_f32_16x16x32_bf16 a[208:211], v[52:55], a[96:99], a[208:211]
v_mfma_f32_16x16x32_bf16 a[212:215], v[48:51], a[84:87], a[212:215]
ds_read_b128 v[72:75], v7 offset:63488
v_mfma_f32_16x16x32_bf16 a[212:215], v[52:55], a[100:103], a[212:215]
v_mfma_f32_16x16x32_bf16 a[216:219], v[48:51], a[88:91], a[216:219]
v_mfma_f32_16x16x32_bf16 a[216:219], v[52:55], a[104:107], a[216:219]
v_mfma_f32_16x16x32_bf16 a[220:223], v[48:51], a[92:95], a[220:223]
ds_read_b128 v[76:79], v7 offset:64512
v_mfma_f32_16x16x32_bf16 a[220:223], v[52:55], a[108:111], a[220:223]
s_waitcnt lgkmcnt(4)
v_mfma_f32_16x16x32_bf16 a[224:227], v[56:59], a[80:83], a[224:227]
v_mfma_f32_16x16x32_bf16 a[224:227], v[60:63], a[96:99], a[224:227]
v_mfma_f32_16x16x32_bf16 a[228:231], v[56:59], a[84:87], a[228:231]
ds_read_b128 v[48:51], v8 offset:0
v_mfma_f32_16x16x32_bf16 a[228:231], v[60:63], a[100:103], a[228:231]
v_mfma_f32_16x16x32_bf16 a[232:235], v[56:59], a[88:91], a[232:235]
v_mfma_f32_16x16x32_bf16 a[232:235], v[60:63], a[104:107], a[232:235]
v_mfma_f32_16x16x32_bf16 a[236:239], v[56:59], a[92:95], a[236:239]
ds_read_b128 v[52:55], v8 offset:1024
v_mfma_f32_16x16x32_bf16 a[236:239], v[60:63], a[108:111], a[236:239]
s_waitcnt lgkmcnt(4)
v_mfma_f32_16x16x32_bf16 a[240:243], v[64:67], a[80:83], a[240:243]
v_mfma_f32_16x16x32_bf16 a[240:243], v[68:71], a[96:99], a[240:243]
v_mfma_f32_16x16x32_bf16 a[244:247], v[64:67], a[84:87], a[244:247]
ds_read_b128 v[56:59], v8 offset:2048
v_mfma_f32_16x16x32_bf16 a[244:247], v[68:71], a[100:103], a[244:247]
v_mfma_f32_16x16x32_bf16 a[248:251], v[64:67], a[88:91], a[248:251]
v_mfma_f32_16x16x32_bf16 a[248:251], v[68:71], a[104:107], a[248:251]
v_mfma_f32_16x16x32_bf16 a[252:255], v[64:67], a[92:95], a[252:255]
ds_read_b128 v[60:63], v8 offset:3072
v_mfma_f32_16x16x32_bf16 a[252:255], v[68:71], a[108:111], a[252:255]
s_waitcnt vmcnt(37)
s_waitcnt lgkmcnt(4)
v_mfma_f32_16x16x32_bf16 a[112:115], v[72:75], v[16:19], a[112:115]
v_mfma_f32_16x16x32_bf16 a[112:115], v[76:79], v[192:195], a[112:115]
v_mfma_f32_16x16x32_bf16 a[116:119], v[72:75], v[20:23], a[116:119]
ds_read_b128 v[64:67], v8 offset:4096
v_mfma_f32_16x16x32_bf16 a[116:119], v[76:79], v[196:199], a[116:119]
v_mfma_f32_16x16x32_bf16 a[120:123], v[72:75], v[24:27], a[120:123]
v_mfma_f32_16x16x32_bf16 a[120:123], v[76:79], v[200:203], a[120:123]
v_mfma_f32_16x16x32_bf16 a[124:127], v[72:75], v[28:31], a[124:127]
ds_read_b128 v[68:71], v8 offset:5120
v_mfma_f32_16x16x32_bf16 a[124:127], v[76:79], v[204:207], a[124:127]
s_waitcnt lgkmcnt(4)
v_mfma_f32_16x16x32_bf16 a[128:131], v[48:51], v[16:19], a[128:131]
s_waitcnt vmcnt(0)
v_cmp_le_u32 vcc, 3, v13
s_nop 0
s_cmp_eq_u64 vcc, exec
s_cbranch_scc0 L_f_slow3
L_f_back3:
v_mfma_f32_16x16x32_bf16 a[128:131], v[52:55], v[192:195], a[128:131]
buffer_load_dwordx4 v[80:83], v2, s[8:11], s25 offen offset:3072 sc1
v_mfma_f32_16x16x32_bf16 a[132:135], v[48:51], v[20:23], a[132:135]
ds_read_b128 v[72:75], v8 offset:6144
v_mfma_f32_16x16x32_bf16 a[132:135], v[52:55], v[196:199], a[132:135]
buffer_load_dwordx4 v[84:87], v4, s[8:11], s25 offen offset:3072 sc1
v_mfma_f32_16x16x32_bf16 a[136:139], v[48:51], v[24:27], a[136:139]
v_mfma_f32_16x16x32_bf16 a[136:139], v[52:55], v[200:203], a[136:139]
buffer_load_dwordx4 v[88:91], v5, s[8:11], s25 offen offset:3072 sc1
v_mfma_f32_16x16x32_bf16 a[140:143], v[48:51], v[28:31], a[140:143]
ds_read_b128 v[76:79], v8 offset:7168
v_mfma_f32_16x16x32_bf16 a[140:143], v[52:55], v[204:207], a[140:143]
buffer_load_dwordx4 v[92:95], v6, s[8:11], s25 offen offset:3072 sc1
s_waitcnt lgkmcnt(4)
v_mfma_f32_16x16x32_bf16 a[144:147], v[56:59], v[16:19], a[144:147]
v_mfma_f32_16x16x32_bf16 a[144:147], v[60:63], v[192:195], a[144:147]
buffer_load_dwordx4 v[96:99], v2, s[8:11], s26 offen offset:3072 sc1
v_mfma_f32_16x16x32_bf16 a[148:151], v[56:59], v[20:23], a[148:151]
ds_read_b128 v[48:51], v8 offset:8192
v_mfma_f32_16x16x32_bf16 a[148:151], v[60:63], v[196:199], a[148:151]
buffer_load_dwordx4 v[100:103], v4, s[8:11], s26 offen offset:3072 sc1
v_mfma_f32_16x16x32_bf16 a[152:155], v[56:59], v[24:27], a[152:155]
v_mfma_f32_16x16x32_bf16 a[152:155], v[60:63], v[200:203], a[152:155]
buffer_load_dwordx4 v[104:107], v5, s[8:11], s26 offen offset:3072 sc1
v_mfma_f32_16x16x32_bf16 a[156:159], v[56:59], v[28:31], a[156:159]
ds_read_b128 v[52:55], v8 offset:9216
v_mfma_f32_16x16x32_bf16 a[156:159], v[60:63], v[204:207], a[156:159]
buffer_load_dwordx4 v[108:111], v6, s[8:11], s26 offen offset:3072 sc1
s_waitcnt lgkmcnt(4)
v_mfma_f32_16x16x32_bf16 a[160:163], v[64:67], v[16:19], a[160:163]
v_mfma_f32_16x16x32_bf16 a[160:163], v[68:71], v[192:195], a[160:163]
buffer_load_dwordx4 v[144:147], v2, s[8:11], s27 offen offset:3072 sc1
v_mfma_f32_16x16x32_bf16 a[164:167], v[64:67], v[20:23], a[164:167]
ds_read_b128 v[56:59], v8 offset:10240
v_mfma_f32_16x16x32_bf16 a[164:167], v[68:71], v[196:199], a[164:167]
buffer_load_dwordx4 v[148:151], v4, s[8:11], s27 offen offset:3072 sc1
v_mfma_f32_16x16x32_bf16 a[168:171], v[64:67], v[24:27], a[168:171]
v_mfma_f32_16x16x32_bf16 a[168:171], v[68:71], v[200:203], a[168:171]
buffer_load_dwordx4 v[152:155], v5, s[8:11], s27 offen offset:3072 sc1
v_mfma_f32_16x16x32_bf16 a[172:175], v[64:67], v[28:31], a[172:175]
ds_read_b128 v[60:63], v8 offset:11264
v_mfma_f32_16x16x32_bf16 a[172:175], v[68:71], v[204:207], a[172:175]
buffer_load_dwordx4 v[156:159], v6, s[8:11], s27 offen offset:3072 sc1
s_waitcnt lgkmcnt(4)
v_mfma_f32_16x16x32_bf16 a[176:179], v[72:75], v[16:19], a[176:179]
v_mfma_f32_16x16x32_bf16 a[176:179], v[76:79], v[192:195], a[176:179]
v_mfma_f32_16x16x32_bf16 a[180:183], v[72:75], v[20:23], a[180:183]
ds_read_b128 v[64:67], v8 offset:12288
v_mfma_f32_16x16x32_bf16 a[180:183], v[76:79], v[196:199], a[180:183]
v_mfma_f32_16x16x32_bf16 a[184:187], v[72:75], v[24:27], a[184:187]
v_mfma_f32_16x16x32_bf16 a[184:187], v[76:79], v[200:203], a[184:187]
v_mfma_f32_16x16x32_bf16 a[188:191], v[72:75], v[28:31], a[188:191]
ds_read_b128 v[68:71], v8 offset:13312
v_mfma_f32_16x16x32_bf16 a[188:191], v[76:79], v[204:207], a[188:191]
s_waitcnt lgkmcnt(4)
v_mfma_f32_16x16x32_bf16 a[192:195], v[48:51], v[16:19], a[192:195]
v_mfma_f32_16x16x32_bf16 a[192:195], v[52:55], v[192:195], a[192:195]
v_mfma_f32_16x16x32_bf16 a[196:199], v[48:51], v[20:23], a[196:199]
ds_read_b128 v[72:75], v8 offset:14336
v_mfma_f32_16x16x32_bf16 a[196:199], v[52:55], v[196:199], a[196:199]
v_mfma_f32_16x16x32_bf16 a[200:203], v[48:51], v[24:27], a[200:203]
v_mfma_f32_16x16x32_bf16 a[200:203], v[52:55], v[200:203], a[200:203]
v_mfma_f32_16x16x32_bf16 a[204:207], v[48:51], v[28:31], a[204:207]
ds_read_b128 v[76:79], v8 offset:15360
v_mfma_f32_16x16x32_bf16 a[204:207], v[52:55], v[204:207], a[204:207]
s_waitcnt lgkmcnt(4)
v_mfma_f32_16x16x32_bf16 a[208:211], v[56:59], v[16:19], a[208:211]
v_mfma_f32_16x16x32_bf16 a[208:211], v[60:63], v[192:195], a[208:211]
v_mfma_f32_16x16x32_bf16 a[212:215], v[56:59], v[20:23], a[212:215]
s_waitcnt vmcnt(42)
s_barrier
ds_read_b128 v[48:51], v2 offset:0
v_mfma_f32_16x16x32_bf16 a[212:215], v[60:63], v[196:199], a[212:215]
v_mfma_f32_16x16x32_bf16 a[216:219], v[56:59], v[24:27], a[216:219]
v_mfma_f32_16x16x32_bf16 a[216:219], v[60:63], v[200:203], a[216:219]
v_mfma_f32_16x16x32_bf16 a[220:223], v[56:59], v[28:31], a[220:223]
ds_read_b128 v[52:55], v2 offset:1024
v_mfma_f32_16x16x32_bf16 a[220:223], v[60:63], v[204:207], a[220:223]
s_waitcnt lgkmcnt(4)
v_mfma_f32_16x16x32_bf16 a[224:227], v[64:67], v[16:19], a[224:227]
v_mfma_f32_16x16x32_bf16 a[224:227], v[68:71], v[192:195], a[224:227]
v_mfma_f32_16x16x32_bf16 a[228:231], v[64:67], v[20:23], a[228:231]
ds_read_b128 v[56:59], v2 offset:2048
v_mfma_f32_16x16x32_bf16 a[228:231], v[68:71], v[196:199], a[228:231]
v_mfma_f32_16x16x32_bf16 a[232:235], v[64:67], v[24:27], a[232:235]
v_mfma_f32_16x16x32_bf16 a[232:235], v[68:71], v[200:203], a[232:235]
v_mfma_f32_16x16x32_bf16 a[236:239], v[64:67], v[28:31], a[236:239]
ds_read_b128 v[60:63], v2 offset:3072
v_mfma_f32_16x16x32_bf16 a[236:239], v[68:71], v[204:207], a[236:239]
s_waitcnt lgkmcnt(4)
v_mfma_f32_16x16x32_bf16 a[240:243], v[72:75], v[16:19], a[240:243]
v_mfma_f32_16x16x32_bf16 a[240:243], v[76:79], v[192:195], a[240:243]
v_mfma_f32_16x16x32_bf16 a[244:247], v[72:75], v[20:23], a[244:247]
ds_read_b128 v[64:67], v2 offset:4096
v_mfma_f32_16x16x32_bf16 a[244:247], v[76:79], v[196:199], a[244:247]
v_mfma_f32_16x16x32_bf16 a[248:251], v[72:75], v[24:27], a[248:251]
v_mfma_f32_16x16x32_bf16 a[248:251], v[76:79], v[200:203], a[248:251]
v_mfma_f32_16x16x32_bf16 a[252:255], v[72:75], v[28:31], a[252:255]
ds_read_b128 v[68:71], v2 offset:5120
v_mfma_f32_16x16x32_bf16 a[252:255], v[76:79], v[204:207], a[252:255]
s_waitcnt vmcnt(24)
s_waitcnt lgkmcnt(4)
v_mfma_f32_16x16x32_bf16 a[112:115], v[48:51], v[32:35], a[112:115]
v_mfma_f32_16x16x32_bf16 a[112:115], v[52:55], v[112:115], a[112:115]
v_mfma_f32_16x16x32_bf16 a[116:119], v[48:51], v[36:39], a[116:119]
ds_read_b128 v[72:75], v2 offset:6144
v_mfma_f32_16x16x32_bf16 a[116:119], v[52:55], v[116:119], a[116:119]
v_mfma_f32_16x16x32_bf16 a[120:123], v[48:51], v[40:43], a[120:123]
v_mfma_f32_16x16x32_bf16 a[120:123], v[52:55], v[120:123], a[120:123]
v_mfma_f32_16x16x32_bf16 a[124:127], v[48:51], v[44:47], a[124:127]
ds_read_b128 v[76:79], v2 offset:7168
v_mfma_f32_16x16x32_bf16 a[124:127], v[52:55], v[124:127], a[124:127]
s_waitcnt lgkmcnt(4)
v_mfma_f32_16x16x32_bf16 a[128:131], v[56:59], v[32:35], a[128:131]
v_mfma_f32_16x16x32_bf16 a[128:131], v[60:63], v[112:115], a[128:131]
v_mfma_f32_16x16x32_bf16 a[132:135], v[56:59], v[36:39], a[132:135]
ds_read_b128 v[48:51], v2 offset:8192
v_mfma_f32_16x16x32_bf16 a[132:135], v[60:63], v[116:119], a[132:135]
v_mfma_f32_16x16x32_bf16 a[136:139], v[56:59], v[40:43], a[136:139]
v_mfma_f32_16x16x32_bf16 a[136:139], v[60:63], v[120:123], a[136:139]
v_mfma_f32_16x16x32_bf16 a[140:143], v[56:59], v[44:47], a[140:143]
ds_read_b128 v[52:55], v2 offset:9216
v_mfma_f32_16x16x32_bf16 a[140:143], v[60:63], v[124:127], a[140:143]
s_waitcnt lgkmcnt(4)
v_mfma_f32_16x16x32_bf16 a[144:147], v[64:67], v[32:35], a[144:147]
v_mfma_f32_16x16x32_bf16 a[144:147], v[68:71], v[112:115], a[144:147]
v_mfma_f32_16x16x32_bf16 a[148:151], v[64:67], v[36:39], a[148:151]
ds_read_b128 v[56:59], v2 offset:10240
v_mfma_f32_16x16x32_bf16 a[148:151], v[68:71], v[116:119], a[148:151]
v_mfma_f32_16x16x32_bf16 a[152:155], v[64:67], v[40:43], a[152:155]
v_mfma_f32_16x16x32_bf16 a[152:155], v[68:71], v[120:123], a[152:155]
v_mfma_f32_16x16x32_bf16 a[156:159], v[64:67], v[44:47], a[156:159]
ds_read_b128 v[60:63], v2 offset:11264
v_mfma_f32_16x16x32_bf16 a[156:159], v[68:71], v[124:127], a[156:159]
s_waitcnt lgkmcnt(4)
v_mfma_f32_16x16x32_bf16 a[160:163], v[72:75], v[32:35], a[160:163]
v_mfma_f32_16x16x32_bf16 a[160:163], v[76:79], v[112:115], a[160:163]
v_mfma_f32_16x16x32_bf16 a[164:167], v[72:75], v[36:39], a[164:167]
ds_read_b128 v[64:67], v2 offset:12288
v_mfma_f32_16x16x32_bf16 a[164:167], v[76:79], v[116:119], a[164:167]
v_mfma_f32_16x16x32_bf16 a[168:171], v[72:75], v[40:43], a[168:171]
v_mfma_f32_16x16x32_bf16 a[168:171], v[76:79], v[120:123], a[168:171]
v_mfma_f32_16x16x32_bf16 a[172:175], v[72:75], v[44:47], a[172:175]
ds_read_b128 v[68:71], v2 offset:13312
v_mfma_f32_16x16x32_bf16 a[172:175], v[76:79], v[124:127], a[172:175]
s_waitcnt lgkmcnt(4)
v_mfma_f32_16x16x32_bf16 a[176:179], v[48:51], v[32:35], a[176:179]
v_mfma_f32_16x16x32_bf16 a[176:179], v[52:55], v[112:115], a[176:179]
v_mfma_f32_16x16x32_bf16 a[180:183], v[48:51], v[36:39], a[180:183]
ds_read_b128 v[72:75], v2 offset:14336
v_mfma_f32_16x16x32_bf16 a[180:183], v[52:55], v[116:119], a[180:183]
v_mfma_f32_16x16x32_bf16 a[184:187], v[48:51], v[40:43], a[184:187]
v_mfma_f32_16x16x32_bf16 a[184:187], v[52:55], v[120:123], a[184:187]
v_mfma_f32_16x16x32_bf16 a[188:191], v[48:51], v[44:47], a[188:191]
ds_read_b128 v[76:79], v2 offset:15360
v_mfma_f32_16x16x32_bf16 a[188:191], v[52:55], v[124:127], a[188:191]
s_waitcnt lgkmcnt(4)
v_mfma_f32_16x16x32_bf16 a[192:195], v[56:59], v[32:35], a[192:195]
v_mfma_f32_16x16x32_bf16 a[192:195], v[60:63], v[112:115], a[192:195]
v_mfma_f32_16x16x32_bf16 a[196:199], v[56:59], v[36:39], a[196:199]
ds_read_b128 v[48:51], v2 offset:16384
v_mfma_f32_16x16x32_bf16 a[196:199], v[60:63], v[116:119], a[196:199]
v_mfma_f32_16x16x32_bf16 a[200:203], v[56:59], v[40:43], a[200:203]
v_mfma_f32_16x16x32_bf16 a[200:203], v[60:63], v[120:123], a[200:203]
v_mfma_f32_16x16x32_bf16 a[204:207], v[56:59], v[44:47], a[204:207]
ds_read_b128 v[52:55], v2 offset:17408
v_mfma_f32_16x16x32_bf16 a[204:207], v[60:63], v[124:127], a[204:207]
s_waitcnt lgkmcnt(4)
v_mfma_f32_16x16x32_bf16 a[208:211], v[64:67], v[32:35], a[208:211]
v_mfma_f32_16x16x32_bf16 a[208:211], v[68:71], v[112:115], a[208:211]
v_mfma_f32_16x16x32_bf16 a[212:215], v[64:67], v[36:39], a[212:215]
ds_read_b128 v[56:59], v2 offset:18432
v_mfma_f32_16x16x32_bf16 a[212:215], v[68:71], v[116:119], a[212:215]
v_mfma_f32_16x16x32_bf16 a[216:219], v[64:67], v[40:43], a[216:219]
v_mfma_f32_16x16x32_bf16 a[216:219], v[68:71], v[120:123], a[216:219]
v_mfma_f32_16x16x32_bf16 a[220:223], v[64:67], v[44:47], a[220:223]
ds_read_b128 v[60:63], v2 offset:19456
v_mfma_f32_16x16x32_bf16 a[220:223], v[68:71], v[124:127], a[220:223]
s_waitcnt lgkmcnt(4)
v_mfma_f32_16x16x32_bf16 a[224:227], v[72:75], v[32:35], a[224:227]
v_mfma_f32_16x16x32_bf16 a[224:227], v[76:79], v[112:115], a[224:227]
v_mfma_f32_16x16x32_bf16 a[228:231], v[72:75], v[36:39], a[228:231]
ds_read_b128 v[64:67], v2 offset:20480
v_mfma_f32_16x16x32_bf16 a[228:231], v[76:79], v[116:119], a[228:231]
v_mfma_f32_16x16x32_bf16 a[232:235], v[72:75], v[40:43], a[232:235]
v_mfma_f32_16x16x32_bf16 a[232:235], v[76:79], v[120:123], a[232:235]
v_mfma_f32_16x16x32_bf16 a[236:239], v[72:75], v[44:47], a[236:239]
ds_read_b128 v[68:71], v2 offset:21504
v_mfma_f32_16x16x32_bf16 a[236:239], v[76:79], v[124:127], a[236:239]
s_waitcnt lgkmcnt(4)
v_mfma_f32_16x16x32_bf16 a[240:243], v[48:51], v[32:35], a[240:243]
v_mfma_f32_16x16x32_bf16 a[240:243], v[52:55], v[112:115], a[240:243]
v_mfma_f32_16x16x32_bf16 a[244:247], v[48:51], v[36:39], a[244:247]
ds_read_b128 v[72:75], v2 offset:22528
v_mfma_f32_16x16x32_bf16 a[244:247], v[52:55], v[116:119], a[244:247]
v_mfma_f32_16x16x32_bf16 a[248:251], v[48:51], v[40:43], a[248:251]
v_mfma_f32_16x16x32_bf16 a[248:251], v[52:55], v[120:123], a[248:251]
v_mfma_f32_16x16x32_bf16 a[252:255], v[48:51], v[44:47], a[252:255]
ds_read_b128 v[76:79], v2 offset:23552
v_mfma_f32_16x16x32_bf16 a[252:255], v[52:55], v[124:127], a[252:255]
s_waitcnt vmcnt(8)
s_waitcnt lgkmcnt(4)
v_mfma_f32_16x16x32_bf16 a[112:115], v[56:59], v[128:131], a[112:115]
v_mfma_f32_16x16x32_bf16 a[112:115], v[60:63], v[80:83], a[112:115]
v_mfma_f32_16x16x32_bf16 a[116:119], v[56:59], v[132:135], a[116:119]
s_waitcnt vmcnt(32)
s_barrier
ds_read_b128 v[48:51], v2 offset:24576
v_mfma_f32_16x16x32_bf16 a[116:119], v[60:63], v[84:87], a[116:119]
v_mfma_f32_16x16x32_bf16 a[120:123], v[56:59], v[136:139], a[120:123]
v_mfma_f32_16x16x32_bf16 a[120:123], v[60:63], v[88:91], a[120:123]
v_mfma_f32_16x16x32_bf16 a[124:127], v[56:59], v[140:143], a[124:127]
ds_read_b128 v[52:55], v2 offset:25600
v_mfma_f32_16x16x32_bf16 a[124:127], v[60:63], v[92:95], a[124:127]
s_waitcnt vmcnt(0)
s_waitcnt lgkmcnt(4)
v_mfma_f32_16x16x32_bf16 a[112:115], v[64:67], v[96:99], a[112:115]
v_mfma_f32_16x16x32_bf16 a[112:115], v[68:71], v[144:147], a[112:115]
v_mfma_f32_16x16x32_bf16 a[116:119], v[64:67], v[100:103], a[116:119]
ds_read_b128 v[56:59], v2 offset:26624
v_mfma_f32_16x16x32_bf16 a[116:119], v[68:71], v[148:151], a[116:119]
v_mfma_f32_16x16x32_bf16 a[120:123], v[64:67], v[104:107], a[120:123]
v_mfma_f32_16x16x32_bf16 a[120:123], v[68:71], v[152:155], a[120:123]
v_mfma_f32_16x16x32_bf16 a[124:127], v[64:67], v[108:111], a[124:127]
ds_read_b128 v[60:63], v2 offset:27648
v_mfma_f32_16x16x32_bf16 a[124:127], v[68:71], v[156:159], a[124:127]
s_waitcnt lgkmcnt(4)
v_mfma_f32_16x16x32_bf16 a[128:131], v[72:75], v[128:131], a[128:131]
v_mfma_f32_16x16x32_bf16 a[128:131], v[76:79], v[80:83], a[128:131]
v_mfma_f32_16x16x32_bf16 a[132:135], v[72:75], v[132:135], a[132:135]
ds_read_b128 v[64:67], v2 offset:28672
v_mfma_f32_16x16x32_bf16 a[132:135], v[76:79], v[84:87], a[132:135]
v_mfma_f32_16x16x32_bf16 a[136:139], v[72:75], v[136:139], a[136:139]
v_mfma_f32_16x16x32_bf16 a[136:139], v[76:79], v[88:91], a[136:139]
v_mfma_f32_16x16x32_bf16 a[140:143], v[72:75], v[140:143], a[140:143]
ds_read_b128 v[68:71], v2 offset:29696
v_mfma_f32_16x16x32_bf16 a[140:143], v[76:79], v[92:95], a[140:143]
s_waitcnt lgkmcnt(4)
v_mfma_f32_16x16x32_bf16 a[128:131], v[48:51], v[96:99], a[128:131]
v_mfma_f32_16x16x32_bf16 a[128:131], v[52:55], v[144:147], a[128:131]
v_mfma_f32_16x16x32_bf16 a[132:135], v[48:51], v[100:103], a[132:135]
ds_read_b128 v[72:75], v2 offset:30720
v_mfma_f32_16x16x32_bf16 a[132:135], v[52:55], v[148:151], a[132:135]
v_mfma_f32_16x16x32_bf16 a[136:139], v[48:51], v[104:107], a[136:139]
v_mfma_f32_16x16x32_bf16 a[136:139], v[52:55], v[152:155], a[136:139]
v_mfma_f32_16x16x32_bf16 a[140:143], v[48:51], v[108:111], a[140:143]
ds_read_b128 v[76:79], v2 offset:31744
v_mfma_f32_16x16x32_bf16 a[140:143], v[52:55], v[156:159], a[140:143]
s_waitcnt lgkmcnt(4)
v_mfma_f32_16x16x32_bf16 a[144:147], v[56:59], v[128:131], a[144:147]
v_mfma_f32_16x16x32_bf16 a[144:147], v[60:63], v[80:83], a[144:147]
v_mfma_f32_16x16x32_bf16 a[148:151], v[56:59], v[132:135], a[148:151]
ds_read_b128 v[48:51], v2 offset:32768
v_mfma_f32_16x16x32_bf16 a[148:151], v[60:63], v[84:87], a[148:151]
v_mfma_f32_16x16x32_bf16 a[152:155], v[56:59], v[136:139], a[152:155]
v_accvgpr_read_b32 v208, a112
v_accvgpr_read_b32 v209, a113
v_mfma_f32_16x16x32_bf16 a[152:155], v[60:63], v[88:91], a[152:155]
v_accvgpr_read_b32 v210, a114
v_mfma_f32_16x16x32_bf16 a[156:159], v[56:59], v[140:143], a[156:159]
ds_read_b128 v[52:55], v2 offset:33792
v_accvgpr_read_b32 v211, a115
v_mfma_f32_16x16x32_bf16 a[156:159], v[60:63], v[92:95], a[156:159]
v_accvgpr_read_b32 v212, a128
s_waitcnt lgkmcnt(4)
v_mfma_f32_16x16x32_bf16 a[144:147], v[64:67], v[96:99], a[144:147]
v_accvgpr_read_b32 v213, a129
v_accvgpr_read_b32 v214, a130
v_mfma_f32_16x16x32_bf16 a[144:147], v[68:71], v[144:147], a[144:147]
v_accvgpr_read_b32 v215, a131
v_cvt_pk_bf16_f32 v224, v208, v209
v_mfma_f32_16x16x32_bf16 a[148:151], v[64:67], v[100:103], a[148:151]
ds_read_b128 v[56:59], v2 offset:34816
v_cvt_pk_bf16_f32 v225, v210, v211
v_mfma_f32_16x16x32_bf16 a[148:151], v[68:71], v[148:151], a[148:151]
v_cvt_pk_bf16_f32 v226, v212, v213
v_cvt_pk_bf16_f32 v227, v214, v215
v_mfma_f32_16x16x32_bf16 a[152:155], v[64:67], v[104:107], a[152:155]
buffer_store_dwordx4 v[224:227], v2, s[8:11], s31 offen offset:0
v_accvgpr_read_b32 v216, a116
v_mfma_f32_16x16x32_bf16 a[152:155], v[68:71], v[152:155], a[152:155]
v_accvgpr_read_b32 v217, a117
v_accvgpr_read_b32 v218, a118
v_mfma_f32_16x16x32_bf16 a[156:159], v[64:67], v[108:111], a[156:159]
ds_read_b128 v[60:63], v2 offset:35840
v_accvgpr_read_b32 v219, a119
v_mfma_f32_16x16x32_bf16 a[156:159], v[68:71], v[156:159], a[156:159]
v_accvgpr_read_b32 v220, a132
s_waitcnt lgkmcnt(4)
v_mfma_f32_16x16x32_bf16 a[160:163], v[72:75], v[128:131], a[160:163]
v_accvgpr_read_b32 v221, a133
v_accvgpr_read_b32 v222, a134
v_mfma_f32_16x16x32_bf16 a[160:163], v[76:79], v[80:83], a[160:163]
v_accvgpr_read_b32 v223, a135
v_cvt_pk_bf16_f32 v228, v216, v217
v_mfma_f32_16x16x32_bf16 a[164:167], v[72:75], v[132:135], a[164:167]
ds_read_b128 v[64:67], v2 offset:36864
v_cvt_pk_bf16_f32 v229, v218, v219
v_mfma_f32_16x16x32_bf16 a[164:167], v[76:79], v[84:87], a[164:167]
v_cvt_pk_bf16_f32 v230, v220, v221
v_cvt_pk_bf16_f32 v231, v222, v223
v_mfma_f32_16x16x32_bf16 a[168:171], v[72:75], v[136:139], a[168:171]
buffer_store_dwordx4 v[228:231], v4, s[8:11], s31 offen offset:0
v_accvgpr_read_b32 v208, a120
v_mfma_f32_16x16x32_bf16 a[168:171], v[76:79], v[88:91], a[168:171]
v_accvgpr_read_b32 v209, a121
v_accvgpr_read_b32 v210, a122
v_mfma_f32_16x16x32_bf16 a[172:175], v[72:75], v[140:143], a[172:175]
ds_read_b128 v[68:71], v2 offset:37888
v_accvgpr_read_b32 v211, a123
v_mfma_f32_16x16x32_bf16 a[172:175], v[76:79], v[92:95], a[172:175]
v_accvgpr_read_b32 v212, a136
s_waitcnt lgkmcnt(4)
v_mfma_f32_16x16x32_bf16 a[160:163], v[48:51], v[96:99], a[160:163]
v_accvgpr_read_b32 v213, a137
v_accvgpr_read_b32 v214, a138
v_mfma_f32_16x16x32_bf16 a[160:163], v[52:55], v[144:147], a[160:163]
v_accvgpr_read_b32 v215, a139
v_cvt_pk_bf16_f32 v224, v208, v209
v_mfma_f32_16x16x32_bf16 a[164:167], v[48:51], v[100:103], a[164:167]
ds_read_b128 v[72:75], v2 offset:38912
v_cvt_pk_bf16_f32 v225, v210, v211
v_mfma_f32_16x16x32_bf16 a[164:167], v[52:55], v[148:151], a[164:167]
v_cvt_pk_bf16_f32 v226, v212, v213
v_cvt_pk_bf16_f32 v227, v214, v215
v_mfma_f32_16x16x32_bf16 a[168:171], v[48:51], v[104:107], a[168:171]
buffer_store_dwordx4 v[224:227], v5, s[8:11], s31 offen offset:0
v_accvgpr_read_b32 v216, a124
v_mfma_f32_16x16x32_bf16 a[168:171], v[52:55], v[152:155], a[168:171]
v_accvgpr_read_b32 v217, a125
v_accvgpr_read_b32 v218, a126
v_mfma_f32_16x16x32_bf16 a[172:175], v[48:51], v[108:111], a[172:175]
ds_read_b128 v[76:79], v2 offset:39936
v_accvgpr_read_b32 v219, a127
v_mfma_f32_16x16x32_bf16 a[172:175], v[52:55], v[156:159], a[172:175]
v_accvgpr_read_b32 v220, a140
s_waitcnt lgkmcnt(4)
v_mfma_f32_16x16x32_bf16 a[176:179], v[56:59], v[128:131], a[176:179]
v_mfma_f32_16x16x32_bf16 a[176:179], v[60:63], v[80:83], a[176:179]
v_mfma_f32_16x16x32_bf16 a[180:183], v[56:59], v[132:135], a[180:183]
ds_read_b128 v[48:51], v2 offset:40960
v_mfma_f32_16x16x32_bf16 a[180:183], v[60:63], v[84:87], a[180:183]
v_mfma_f32_16x16x32_bf16 a[184:187], v[56:59], v[136:139], a[184:187]
v_accvgpr_read_b32 v221, a141
v_accvgpr_read_b32 v222, a142
v_mfma_f32_16x16x32_bf16 a[184:187], v[60:63], v[88:91], a[184:187]
v_accvgpr_read_b32 v223, a143
v_cvt_pk_bf16_f32 v228, v216, v217
v_mfma_f32_16x16x32_bf16 a[188:191], v[56:59], v[140:143], a[188:191]
ds_read_b128 v[52:55], v2 offset:41984
v_cvt_pk_bf16_f32 v229, v218, v219
v_mfma_f32_16x16x32_bf16 a[188:191], v[60:63], v[92:95], a[188:191]
v_cvt_pk_bf16_f32 v230, v220, v221
s_waitcnt lgkmcnt(4)
v_mfma_f32_16x16x32_bf16 a[176:179], v[64:67], v[96:99], a[176:179]
v_cvt_pk_bf16_f32 v231, v222, v223
buffer_store_dwordx4 v[228:231], v6, s[8:11], s31 offen offset:0
v_mfma_f32_16x16x32_bf16 a[176:179], v[68:71], v[144:147], a[176:179]
v_accvgpr_read_b32 v208, a144
v_accvgpr_read_b32 v209, a145
v_mfma_f32_16x16x32_bf16 a[180:183], v[64:67], v[100:103], a[180:183]
ds_read_b128 v[56:59], v2 offset:43008
v_accvgpr_read_b32 v210, a146
v_mfma_f32_16x16x32_bf16 a[180:183], v[68:71], v[148:151], a[180:183]
v_accvgpr_read_b32 v211, a147
v_accvgpr_read_b32 v212, a160
v_mfma_f32_16x16x32_bf16 a[184:187], v[64:67], v[104:107], a[184:187]
v_accvgpr_read_b32 v213, a161
v_accvgpr_read_b32 v214, a162
v_mfma_f32_16x16x32_bf16 a[184:187], v[68:71], v[152:155], a[184:187]
v_accvgpr_read_b32 v215, a163
v_cvt_pk_bf16_f32 v224, v208, v209
v_mfma_f32_16x16x32_bf16 a[188:191], v[64:67], v[108:111], a[188:191]
ds_read_b128 v[60:63], v2 offset:44032
v_cvt_pk_bf16_f32 v225, v210, v211
v_mfma_f32_16x16x32_bf16 a[188:191], v[68:71], v[156:159], a[188:191]
v_cvt_pk_bf16_f32 v226, v212, v213
v_cvt_pk_bf16_f32 v227, v214, v215
s_waitcnt lgkmcnt(4)
v_mfma_f32_16x16x32_bf16 a[192:195], v[72:75], v[128:131], a[192:195]
buffer_store_dwordx4 v[224:227], v2, s[8:11], s31 offen offset:1024
v_accvgpr_read_b32 v216, a148
v_mfma_f32_16x16x32_bf16 a[192:195], v[76:79], v[80:83], a[192:195]
v_accvgpr_read_b32 v217, a149
v_accvgpr_read_b32 v218, a150
v_mfma_f32_16x16x32_bf16 a[196:199], v[72:75], v[132:135], a[196:199]
ds_read_b128 v[64:67], v2 offset:45056
v_accvgpr_read_b32 v219, a151
v_accvgpr_read_b32 v220, a164
v_mfma_f32_16x16x32_bf16 a[196:199], v[76:79], v[84:87], a[196:199]
v_accvgpr_read_b32 v221, a165
v_accvgpr_read_b32 v222, a166
v_mfma_f32_16x16x32_bf16 a[200:203], v[72:75], v[136:139], a[200:203]
v_accvgpr_read_b32 v223, a167
v_cvt_pk_bf16_f32 v228, v216, v217
v_mfma_f32_16x16x32_bf16 a[200:203], v[76:79], v[88:91], a[200:203]
v_cvt_pk_bf16_f32 v229, v218, v219
v_cvt_pk_bf16_f32 v230, v220, v221
v_mfma_f32_16x16x32_bf16 a[204:207], v[72:75], v[140:143], a[204:207]
ds_read_b128 v[68:71], v2 offset:46080
v_cvt_pk_bf16_f32 v231, v222, v223
v_mfma_f32_16x16x32_bf16 a[204:207], v[76:79], v[92:95], a[204:207]
buffer_store_dwordx4 v[228:231], v4, s[8:11], s31 offen offset:1024
v_accvgpr_read_b32 v208, a152
s_waitcnt lgkmcnt(4)
v_mfma_f32_16x16x32_bf16 a[192:195], v[48:51], v[96:99], a[192:195]
v_accvgpr_read_b32 v209, a153
v_accvgpr_read_b32 v210, a154
v_mfma_f32_16x16x32_bf16 a[192:195], v[52:55], v[144:147], a[192:195]
v_accvgpr_read_b32 v211, a155
v_accvgpr_read_b32 v212, a168
v_mfma_f32_16x16x32_bf16 a[196:199], v[48:51], v[100:103], a[196:199]
ds_read_b128 v[72:75], v2 offset:47104
v_accvgpr_read_b32 v213, a169
v_accvgpr_read_b32 v214, a170
v_mfma_f32_16x16x32_bf16 a[196:199], v[52:55], v[148:151], a[196:199]
v_accvgpr_read_b32 v215, a171
v_cvt_pk_bf16_f32 v224, v208, v209
v_mfma_f32_16x16x32_bf16 a[200:203], v[48:51], v[104:107], a[200:203]
v_cvt_pk_bf16_f32 v225, v210, v211
v_cvt_pk_bf16_f32 v226, v212, v213
v_mfma_f32_16x16x32_bf16 a[200:203], v[52:55], v[152:155], a[200:203]
v_cvt_pk_bf16_f32 v227, v214, v215
buffer_store_dwordx4 v[224:227], v5, s[8:11], s31 offen offset:1024
v_mfma_f32_16x16x32_bf16 a[204:207], v[48:51], v[108:111], a[204:207]
ds_read_b128 v[76:79], v2 offset:48128
v_accvgpr_read_b32 v216, a156
v_mfma_f32_16x16x32_bf16 a[204:207], v[52:55], v[156:159], a[204:207]
v_accvgpr_read_b32 v217, a157
v_accvgpr_read_b32 v218, a158
s_waitcnt lgkmcnt(4)
v_mfma_f32_16x16x32_bf16 a[208:211], v[56:59], v[128:131], a[208:211]
v_mfma_f32_16x16x32_bf16 a[208:211], v[60:63], v[80:83], a[208:211]
v_mfma_f32_16x16x32_bf16 a[212:215], v[56:59], v[132:135], a[212:215]
s_waitcnt vmcnt(20)
s_barrier
ds_read_b128 v[48:51], v2 offset:49152
v_mfma_f32_16x16x32_bf16 a[212:215], v[60:63], v[84:87], a[212:215]
v_mfma_f32_16x16x32_bf16 a[216:219], v[56:59], v[136:139], a[216:219]
v_accvgpr_read_b32 v219, a159
v_accvgpr_read_b32 v220, a172
v_mfma_f32_16x16x32_bf16 a[216:219], v[60:63], v[88:91], a[216:219]
v_accvgpr_read_b32 v221, a173
v_accvgpr_read_b32 v222, a174
v_mfma_f32_16x16x32_bf16 a[220:223], v[56:59], v[140:143], a[220:223]
ds_read_b128 v[52:55], v2 offset:50176
v_accvgpr_read_b32 v223, a175
v_mfma_f32_16x16x32_bf16 a[220:223], v[60:63], v[92:95], a[220:223]
v_cvt_pk_bf16_f32 v228, v216, v217
s_waitcnt lgkmcnt(4)
v_mfma_f32_16x16x32_bf16 a[208:211], v[64:67], v[96:99], a[208:211]
v_cvt_pk_bf16_f32 v229, v218, v219
v_cvt_pk_bf16_f32 v230, v220, v221
v_mfma_f32_16x16x32_bf16 a[208:211], v[68:71], v[144:147], a[208:211]
v_cvt_pk_bf16_f32 v231, v222, v223
buffer_store_dwordx4 v[228:231], v6, s[8:11], s31 offen offset:1024
v_mfma_f32_16x16x32_bf16 a[212:215], v[64:67], v[100:103], a[212:215]
ds_read_b128 v[56:59], v2 offset:51200
v_accvgpr_read_b32 v208, a176
v_mfma_f32_16x16x32_bf16 a[212:215], v[68:71], v[148:151], a[212:215]
v_accvgpr_read_b32 v209, a177
v_accvgpr_read_b32 v210, a178
v_mfma_f32_16x16x32_bf16 a[216:219], v[64:67], v[104:107], a[216:219]
v_accvgpr_read_b32 v211, a179
v_accvgpr_read_b32 v212, a192
v_mfma_f32_16x16x32_bf16 a[216:219], v[68:71], v[152:155], a[216:219]
v_accvgpr_read_b32 v213, a193
v_accvgpr_read_b32 v214, a194
v_mfma_f32_16x16x32_bf16 a[220:223], v[64:67], v[108:111], a[220:223]
ds_read_b128 v[60:63], v2 offset:52224
v_accvgpr_read_b32 v215, a195
v_cvt_pk_bf16_f32 v224, v208, v209
v_mfma_f32_16x16x32_bf16 a[220:223], v[68:71], v[156:159], a[220:223]
v_cvt_pk_bf16_f32 v225, v210, v211
v_cvt_pk_bf16_f32 v226, v212, v213
s_waitcnt lgkmcnt(4)
v_mfma_f32_16x16x32_bf16 a[224:227], v[72:75], v[128:131], a[224:227]
v_cvt_pk_bf16_f32 v227, v214, v215
buffer_store_dwordx4 v[224:227], v2, s[8:11], s31 offen offset:2048
v_mfma_f32_16x16x32_bf16 a[224:227], v[76:79], v[80:83], a[224:227]
v_accvgpr_read_b32 v216, a180
v_accvgpr_read_b32 v217, a181
v_mfma_f32_16x16x32_bf16 a[228:231], v[72:75], v[132:135], a[228:231]
ds_read_b128 v[64:67], v2 offset:53248
v_accvgpr_read_b32 v218, a182
v_accvgpr_read_b32 v219, a183
v_mfma_f32_16x16x32_bf16 a[228:231], v[76:79], v[84:87], a[228:231]
v_accvgpr_read_b32 v220, a196
v_accvgpr_read_b32 v221, a197
v_mfma_f32_16x16x32_bf16 a[232:235], v[72:75], v[136:139], a[232:235]
v_accvgpr_read_b32 v222, a198
v_accvgpr_read_b32 v223, a199
v_mfma_f32_16x16x32_bf16 a[232:235], v[76:79], v[88:91], a[232:235]
v_cvt_pk_bf16_f32 v228, v216, v217
v_cvt_pk_bf16_f32 v229, v218, v219
v_mfma_f32_16x16x32_bf16 a[236:239], v[72:75], v[140:143], a[236:239]
ds_read_b128 v[68:71], v2 offset:54272
v_cvt_pk_bf16_f32 v230, v220, v221
v_mfma_f32_16x16x32_bf16 a[236:239], v[76:79], v[92:95], a[236:239]
v_cvt_pk_bf16_f32 v231, v222, v223
buffer_store_dwordx4 v[228:231], v4, s[8:11], s31 offen offset:2048
s_waitcnt lgkmcnt(4)
v_mfma_f32_16x16x32_bf16 a[224:227], v[48:51], v[96:99], a[224:227]
v_accvgpr_read_b32 v208, a184
v_accvgpr_read_b32 v209, a185
v_mfma_f32_16x16x32_bf16 a[224:227], v[52:55], v[144:147], a[224:227]
v_accvgpr_read_b32 v210, a186
v_accvgpr_read_b32 v211, a187
v_mfma_f32_16x16x32_bf16 a[228:231], v[48:51], v[100:103], a[228:231]
v_accvgpr_read_b32 v212, a200
v_accvgpr_read_b32 v213, a201
v_mfma_f32_16x16x32_bf16 a[228:231], v[52:55], v[148:151], a[228:231]
v_accvgpr_read_b32 v214, a202
v_accvgpr_read_b32 v215, a203
v_mfma_f32_16x16x32_bf16 a[232:235], v[48:51], v[104:107], a[232:235]
v_cvt_pk_bf16_f32 v224, v208, v209
v_cvt_pk_bf16_f32 v225, v210, v211
v_mfma_f32_16x16x32_bf16 a[232:235], v[52:55], v[152:155], a[232:235]
v_cvt_pk_bf16_f32 v226, v212, v213
v_cvt_pk_bf16_f32 v227, v214, v215
v_mfma_f32_16x16x32_bf16 a[236:239], v[48:51], v[108:111], a[236:239]
buffer_store_dwordx4 v[224:227], v5, s[8:11], s31 offen offset:2048
v_accvgpr_read_b32 v216, a188
v_mfma_f32_16x16x32_bf16 a[236:239], v[52:55], v[156:159], a[236:239]
v_accvgpr_read_b32 v217, a189
v_accvgpr_read_b32 v218, a190
s_waitcnt lgkmcnt(2)
v_mfma_f32_16x16x32_bf16 a[240:243], v[56:59], v[128:131], a[240:243]
v_mfma_f32_16x16x32_bf16 a[240:243], v[60:63], v[80:83], a[240:243]
v_mfma_f32_16x16x32_bf16 a[244:247], v[56:59], v[132:135], a[244:247]
v_mfma_f32_16x16x32_bf16 a[244:247], v[60:63], v[84:87], a[244:247]
v_mfma_f32_16x16x32_bf16 a[248:251], v[56:59], v[136:139], a[248:251]
v_accvgpr_read_b32 v219, a191
v_accvgpr_read_b32 v220, a204
v_mfma_f32_16x16x32_bf16 a[248:251], v[60:63], v[88:91], a[248:251]
v_accvgpr_read_b32 v221, a205
v_accvgpr_read_b32 v222, a206
v_accvgpr_read_b32 v223, a207
v_mfma_f32_16x16x32_bf16 a[252:255], v[56:59], v[140:143], a[252:255]
v_cvt_pk_bf16_f32 v228, v216, v217
v_cvt_pk_bf16_f32 v229, v218, v219
v_cvt_pk_bf16_f32 v230, v220, v221
v_cvt_pk_bf16_f32 v231, v222, v223
v_mfma_f32_16x16x32_bf16 a[252:255], v[60:63], v[92:95], a[252:255]
buffer_store_dwordx4 v[228:231], v6, s[8:11], s31 offen offset:2048
v_accvgpr_read_b32 v208, a208
v_accvgpr_read_b32 v209, a209
v_accvgpr_read_b32 v210, a210
s_waitcnt lgkmcnt(0)
v_mfma_f32_16x16x32_bf16 a[240:243], v[64:67], v[96:99], a[240:243]
v_accvgpr_read_b32 v211, a211
v_accvgpr_read_b32 v212, a224
v_accvgpr_read_b32 v213, a225
v_accvgpr_read_b32 v214, a226
v_mfma_f32_16x16x32_bf16 a[240:243], v[68:71], v[144:147], a[240:243]
v_accvgpr_read_b32 v215, a227
v_cvt_pk_bf16_f32 v224, v208, v209
v_cvt_pk_bf16_f32 v225, v210, v211
v_cvt_pk_bf16_f32 v226, v212, v213
v_mfma_f32_16x16x32_bf16 a[244:247], v[64:67], v[100:103], a[244:247]
v_cvt_pk_bf16_f32 v227, v214, v215
buffer_store_dwordx4 v[224:227], v2, s[8:11], s31 offen offset:3072
v_accvgpr_read_b32 v216, a212
v_accvgpr_read_b32 v217, a213
v_mfma_f32_16x16x32_bf16 a[244:247], v[68:71], v[148:151], a[244:247]
v_accvgpr_read_b32 v218, a214
v_accvgpr_read_b32 v219, a215
v_accvgpr_read_b32 v220, a228
v_mfma_f32_16x16x32_bf16 a[248:251], v[64:67], v[104:107], a[248:251]
v_accvgpr_read_b32 v221, a229
v_accvgpr_read_b32 v222, a230
v_accvgpr_read_b32 v223, a231
v_cvt_pk_bf16_f32 v228, v216, v217
v_mfma_f32_16x16x32_bf16 a[248:251], v[68:71], v[152:155], a[248:251]
v_cvt_pk_bf16_f32 v229, v218, v219
v_cvt_pk_bf16_f32 v230, v220, v221
v_cvt_pk_bf16_f32 v231, v222, v223
buffer_store_dwordx4 v[228:231], v4, s[8:11], s31 offen offset:3072
v_mfma_f32_16x16x32_bf16 a[252:255], v[64:67], v[108:111], a[252:255]
v_accvgpr_read_b32 v208, a216
v_accvgpr_read_b32 v209, a217
v_accvgpr_read_b32 v210, a218
v_accvgpr_read_b32 v211, a219
v_mfma_f32_16x16x32_bf16 a[252:255], v[68:71], v[156:159], a[252:255]
v_accvgpr_read_b32 v212, a232
v_accvgpr_read_b32 v213, a233
v_accvgpr_read_b32 v214, a234
v_accvgpr_read_b32 v215, a235
v_cvt_pk_bf16_f32 v224, v208, v209
v_cvt_pk_bf16_f32 v225, v210, v211
v_cvt_pk_bf16_f32 v226, v212, v213
v_cvt_pk_bf16_f32 v227, v214, v215
buffer_store_dwordx4 v[224:227], v5, s[8:11], s31 offen offset:3072
v_accvgpr_read_b32 v216, a220
v_accvgpr_read_b32 v217, a221
v_accvgpr_read_b32 v218, a222
v_accvgpr_read_b32 v219, a223
v_accvgpr_read_b32 v220, a236
v_accvgpr_read_b32 v221, a237
v_accvgpr_read_b32 v222, a238
v_accvgpr_read_b32 v223, a239
v_cvt_pk_bf16_f32 v228, v216, v217
v_cvt_pk_bf16_f32 v229, v218, v219
v_cvt_pk_bf16_f32 v230, v220, v221
v_cvt_pk_bf16_f32 v231, v222, v223
buffer_store_dwordx4 v[228:231], v6, s[8:11], s31 offen offset:3072
v_accvgpr_read_b32 v208, a240
v_accvgpr_read_b32 v209, a241
v_accvgpr_read_b32 v210, a242
v_accvgpr_read_b32 v211, a243
v_accvgpr_read_b32 v212, a244
v_accvgpr_read_b32 v213, a245
v_accvgpr_read_b32 v214, a246
v_accvgpr_read_b32 v215, a247
v_cvt_pk_bf16_f32 v224, v208, v209
v_cvt_pk_bf16_f32 v225, v210, v211
v_cvt_pk_bf16_f32 v226, v212, v213
v_cvt_pk_bf16_f32 v227, v214, v215
s_nop 0
v_permlane16_swap_b32 v224, v226
v_permlane16_swap_b32 v225, v227
buffer_store_dwordx4 v[224:227], v9, s[8:11], s32 offen
v_accvgpr_read_b32 v216, a248
v_accvgpr_read_b32 v217, a249
v_accvgpr_read_b32 v218, a250
v_accvgpr_read_b32 v219, a251
v_accvgpr_read_b32 v220, a252
v_accvgpr_read_b32 v221, a253
v_accvgpr_read_b32 v222, a254
v_accvgpr_read_b32 v223, a255
v_cvt_pk_bf16_f32 v228, v216, v217
v_cvt_pk_bf16_f32 v229, v218, v219
v_cvt_pk_bf16_f32 v230, v220, v221
v_cvt_pk_bf16_f32 v231, v222, v223
s_nop 0
v_permlane16_swap_b32 v228, v230
v_permlane16_swap_b32 v229, v231
buffer_store_dwordx4 v[228:231], v9, s[8:11], s33 offen
L_fl_end:
s_endpgm
L_f_slow1:
s_mov_b32 s52, 0
L_f_spin1:
s_sleep 1
buffer_load_dword v13, v11, s[8:11], s34 offen sc1
s_add_u32 s52, s52, 1
s_waitcnt vmcnt(0)
v_cmp_le_u32 vcc, 1, v13
s_cmp_gt_u32 s52, 0x40000
s_cbranch_scc1 L_f_back1
s_cmp_eq_u64 vcc, exec
s_cbranch_scc0 L_f_spin1
s_branch L_f_back1
L_f_slow2:
s_mov_b32 s52, 0
L_f_spin2:
s_sleep 1
buffer_load_dword v13, v11, s[8:11], s34 offen sc1
s_add_u32 s52, s52, 1
s_waitcnt vmcnt(0)
v_cmp_le_u32 vcc, 2, v13
s_cmp_gt_u32 s52, 0x40000
s_cbranch_scc1 L_f_back2
s_cmp_eq_u64 vcc, exec
s_cbranch_scc0 L_f_spin2
s_branch L_f_back2
L_f_slow3:
s_mov_b32 s52, 0
L_f_spin3:
s_sleep 1
buffer_load_dword v13, v11, s[8:11], s34 offen sc1
s_add_u32 s52, s52, 1
s_waitcnt vmcnt(0)
v_cmp_le_u32 vcc, 3, v13
s_cmp_gt_u32 s52, 0x40000
s_cbranch_scc1 L_f_back3
s_cmp_eq_u64 vcc, exec
s_cbranch_scc0 L_f_spin3
s_branch L_f_back3
.p2align 8
.globl rl0_kernel
.type rl0_kernel,@function
rl0_kernel:
s_cmp_ge_u32 s2, 256
s_cbranch_scc1 L_r0_end
s_load_dwordx2 s[12:13], s[0:1], 72
v_and_b32 v1, 63, v0
v_lshrrev_b32 v3, 6, v0
v_lshlrev_b32 v2, 4, v1
v_readfirstlane_b32 s4, v3
s_and_b32 s5, s2, 7
s_lshr_b32 s6, s2, 3
s_waitcnt lgkmcnt(0)
s_mov_b32 s8, s12
s_and_b32 s9, s13, 0xffff
s_mov_b32 s10, 268435456
s_mov_b32 s11, 0x20000
v_and_b32 v6, 7, v1
v_lshrrev_b32 v7, 3, v1
s_mul_i32 s22, s4, 24
v_add_u32 v7, s22, v7
s_and_b32 s23, s6, 1
s_lshl_b32 s23, s23, 3
v_add_u32 v8, s23, v6
v_lshlrev_b32 v8, 4, v8
v_lshl_add_u32 v4, v7, 8, v8
s_lshl_b32 s24, s5, 4
s_lshr_b32 s25, s6, 1
s_add_u32 s24, s24, s25
s_mul_i32 s20, s24, 18432
s_add_u32 s24, s20, 33480704
s_add_u32 s25, s24, 4096
buffer_load_dwordx4 v[16:19], v4, s[8:11], s24 offen offset:0
buffer_load_dwordx4 v[20:23], v4, s[8:11], s24 offen offset:2048
buffer_load_dwordx4 v[24:27], v4, s[8:11], s25 offen offset:0
s_add_u32 s24, s20, 76210176
s_add_u32 s25, s24, 4096
buffer_load_dwordx4 v[28:31], v4, s[8:11], s24 offen offset:0
buffer_load_dwordx4 v[32:35], v4, s[8:11], s24 offen offset:2048
buffer_load_dwordx4 v[36:39], v4, s[8:11], s25 offen offset:0
s_add_u32 s24, s20, 78569472
s_add_u32 s25, s24, 4096
buffer_load_dwordx4 v[40:43], v4, s[8:11], s24 offen offset:0
buffer_load_dwordx4 v[44:47], v4, s[8:11], s24 offen offset:2048
buffer_load_dwordx4 v[48:51], v4, s[8:11], s25 offen offset:0
s_add_u32 s24, s20, 80928768
s_add_u32 s25, s24, 4096
buffer_load_dwordx4 v[52:55], v4, s[8:11], s24 offen offset:0
buffer_load_dwordx4 v[56:59], v4, s[8:11], s24 offen offset:2048
buffer_load_dwordx4 v[60:63], v4, s[8:11], s25 offen offset:0
s_add_u32 s24, s20, 83288064
s_add_u32 s25, s24, 4096
buffer_load_dwordx4 v[64:67], v4, s[8:11], s24 offen offset:0
buffer_load_dwordx4 v[68:71], v4, s[8:11], s24 offen offset:2048
buffer_load_dwordx4 v[72:75], v4, s[8:11], s25 offen offset:0
s_add_u32 s24, s20, 85647360
s_add_u32 s25, s24, 4096
buffer_load_dwordx4 v[76:79], v4, s[8:11], s24 offen offset:0
buffer_load_dwordx4 v[80:83], v4, s[8:11], s24 offen offset:2048
buffer_load_dwordx4 v[84:87], v4, s[8:11], s25 offen offset:0
s_add_u32 s24, s20, 88006656
s_add_u32 s25, s24, 4096
buffer_load_dwordx4 v[88:91], v4, s[8:11], s24 offen offset:0
buffer_load_dwordx4 v[92:95], v4, s[8:11], s24 offen offset:2048
buffer_load_dwordx4 v[96:99], v4, s[8:11], s25 offen offset:0
s_add_u32 s24, s20, 90365952
s_add_u32 s25, s24, 4096
buffer_load_dwordx4 v[100:103], v4, s[8:11], s24 offen offset:0
buffer_load_dwordx4 v[104:107], v4, s[8:11], s24 offen offset:2048
buffer_load_dwordx4 v[108:111], v4, s[8:11], s25 offen offset:0
s_add_u32 s24, s20, 92725248
s_add_u32 s25, s24, 4096
buffer_load_dwordx4 v[112:115], v4, s[8:11], s24 offen offset:0
buffer_load_dwordx4 v[116:119], v4, s[8:11], s24 offen offset:2048
buffer_load_dwordx4 v[120:123], v4, s[8:11], s25 offen offset:0
s_waitcnt vmcnt(26)
v_lshlrev_b32 v128, 16, v16
v_and_b32 v129, 0xffff0000, v16
v_lshlrev_b32 v130, 16, v17
v_and_b32 v131, 0xffff0000, v17
v_lshlrev_b32 v132, 16, v18
v_and_b32 v133, 0xffff0000, v18
v_lshlrev_b32 v134, 16, v19
v_and_b32 v135, 0xffff0000, v19
s_waitcnt vmcnt(25)
v_lshlrev_b32 v136, 16, v20
v_and_b32 v137, 0xffff0000, v20
v_lshlrev_b32 v138, 16, v21
v_and_b32 v139, 0xffff0000, v21
v_lshlrev_b32 v140, 16, v22
v_and_b32 v141, 0xffff0000, v22
v_lshlrev_b32 v142, 16, v23
v_and_b32 v143, 0xffff0000, v23
s_waitcnt vmcnt(24)
v_lshlrev_b32 v144, 16, v24
v_and_b32 v145, 0xffff0000, v24
v_lshlrev_b32 v146, 16, v25
v_and_b32 v147, 0xffff0000, v25
v_lshlrev_b32 v148, 16, v26
v_and_b32 v149, 0xffff0000, v26
v_lshlrev_b32 v150, 16, v27
v_and_b32 v151, 0xffff0000, v27
s_waitcnt vmcnt(23)
v_lshlrev_b32 v6, 16, v28
v_and_b32 v7, 0xffff0000, v28
v_add_f32 v128, v128, v6
v_add_f32 v129, v129, v7
v_lshlrev_b32 v8, 16, v29
v_and_b32 v9, 0xffff0000, v29
v_add_f32 v130, v130, v8
v_add_f32 v131, v131, v9
v_lshlrev_b32 v6, 16, v30
v_and_b32 v7, 0xffff0000, v30
v_add_f32 v132, v132, v6
v_add_f32 v133, v133, v7
v_lshlrev_b32 v8, 16, v31
v_and_b32 v9, 0xffff0000, v31
v_add_f32 v134, v134, v8
v_add_f32 v135, v135, v9
s_waitcnt vmcnt(22)
v_lshlrev_b32 v6, 16, v32
v_and_b32 v7, 0xffff0000, v32
v_add_f32 v136, v136, v6
v_add_f32 v137, v137, v7
v_lshlrev_b32 v8, 16, v33
v_and_b32 v9, 0xffff0000, v33
v_add_f32 v138, v138, v8
v_add_f32 v139, v139, v9
v_lshlrev_b32 v6, 16, v34
v_and_b32 v7, 0xffff0000, v34
v_add_f32 v140, v140, v6
v_add_f32 v141, v141, v7
v_lshlrev_b32 v8, 16, v35
v_and_b32 v9, 0xffff0000, v35
v_add_f32 v142, v142, v8
v_add_f32 v143, v143, v9
s_waitcnt vmcnt(21)
v_lshlrev_b32 v6, 16, v36
v_and_b32 v7, 0xffff0000, v36
v_add_f32 v144, v144, v6
v_add_f32 v145, v145, v7
v_lshlrev_b32 v8, 16, v37
v_and_b32 v9, 0xffff0000, v37
v_add_f32 v146, v146, v8
v_add_f32 v147, v147, v9
v_lshlrev_b32 v6, 16, v38
v_and_b32 v7, 0xffff0000, v38
v_add_f32 v148, v148, v6
v_add_f32 v149, v149, v7
v_lshlrev_b32 v8, 16, v39
v_and_b32 v9, 0xffff0000, v39
v_add_f32 v150, v150, v8
v_add_f32 v151, v151, v9
s_waitcnt vmcnt(20)
v_lshlrev_b32 v6, 16, v40
v_and_b32 v7, 0xffff0000, v40
v_add_f32 v128, v128, v6
v_add_f32 v129, v129, v7
v_lshlrev_b32 v8, 16, v41
v_and_b32 v9, 0xffff0000, v41
v_add_f32 v130, v130, v8
v_add_f32 v131, v131, v9
v_lshlrev_b32 v6, 16, v42
v_and_b32 v7, 0xffff0000, v42
v_add_f32 v132, v132, v6
v_add_f32 v133, v133, v7
v_lshlrev_b32 v8, 16, v43
v_and_b32 v9, 0xffff0000, v43
v_add_f32 v134, v134, v8
v_add_f32 v135, v135, v9
s_waitcnt vmcnt(19)
v_lshlrev_b32 v6, 16, v44
v_and_b32 v7, 0xffff0000, v44
v_add_f32 v136, v136, v6
v_add_f32 v137, v137, v7
v_lshlrev_b32 v8, 16, v45
v_and_b32 v9, 0xffff0000, v45
v_add_f32 v138, v138, v8
v_add_f32 v139, v139, v9
v_lshlrev_b32 v6, 16, v46
v_and_b32 v7, 0xffff0000, v46
v_add_f32 v140, v140, v6
v_add_f32 v141, v141, v7
v_lshlrev_b32 v8, 16, v47
v_and_b32 v9, 0xffff0000, v47
v_add_f32 v142, v142, v8
v_add_f32 v143, v143, v9
s_waitcnt vmcnt(18)
v_lshlrev_b32 v6, 16, v48
v_and_b32 v7, 0xffff0000, v48
v_add_f32 v144, v144, v6
v_add_f32 v145, v145, v7
v_lshlrev_b32 v8, 16, v49
v_and_b32 v9, 0xffff0000, v49
v_add_f32 v146, v146, v8
v_add_f32 v147, v147, v9
v_lshlrev_b32 v6, 16, v50
v_and_b32 v7, 0xffff0000, v50
v_add_f32 v148, v148, v6
v_add_f32 v149, v149, v7
v_lshlrev_b32 v8, 16, v51
v_and_b32 v9, 0xffff0000, v51
v_add_f32 v150, v150, v8
v_add_f32 v151, v151, v9
s_waitcnt vmcnt(17)
v_lshlrev_b32 v6, 16, v52
v_and_b32 v7, 0xffff0000, v52
v_add_f32 v128, v128, v6
v_add_f32 v129, v129, v7
v_lshlrev_b32 v8, 16, v53
v_and_b32 v9, 0xffff0000, v53
v_add_f32 v130, v130, v8
v_add_f32 v131, v131, v9
v_lshlrev_b32 v6, 16, v54
v_and_b32 v7, 0xffff0000, v54
v_add_f32 v132, v132, v6
v_add_f32 v133, v133, v7
v_lshlrev_b32 v8, 16, v55
v_and_b32 v9, 0xffff0000, v55
v_add_f32 v134, v134, v8
v_add_f32 v135, v135, v9
s_waitcnt vmcnt(16)
v_lshlrev_b32 v6, 16, v56
v_and_b32 v7, 0xffff0000, v56
v_add_f32 v136, v136, v6
v_add_f32 v137, v137, v7
v_lshlrev_b32 v8, 16, v57
v_and_b32 v9, 0xffff0000, v57
v_add_f32 v138, v138, v8
v_add_f32 v139, v139, v9
v_lshlrev_b32 v6, 16, v58
v_and_b32 v7, 0xffff0000, v58
v_add_f32 v140, v140, v6
v_add_f32 v141, v141, v7
v_lshlrev_b32 v8, 16, v59
v_and_b32 v9, 0xffff0000, v59
v_add_f32 v142, v142, v8
v_add_f32 v143, v143, v9
s_waitcnt vmcnt(15)
v_lshlrev_b32 v6, 16, v60
v_and_b32 v7, 0xffff0000, v60
v_add_f32 v144, v144, v6
v_add_f32 v145, v145, v7
v_lshlrev_b32 v8, 16, v61
v_and_b32 v9, 0xffff0000, v61
v_add_f32 v146, v146, v8
v_add_f32 v147, v147, v9
v_lshlrev_b32 v6, 16, v62
v_and_b32 v7, 0xffff0000, v62
v_add_f32 v148, v148, v6
v_add_f32 v149, v149, v7
v_lshlrev_b32 v8, 16, v63
v_and_b32 v9, 0xffff0000, v63
v_add_f32 v150, v150, v8
v_add_f32 v151, v151, v9
s_waitcnt vmcnt(14)
v_lshlrev_b32 v6, 16, v64
v_and_b32 v7, 0xffff0000, v64
v_add_f32 v128, v128, v6
v_add_f32 v129, v129, v7
v_lshlrev_b32 v8, 16, v65
v_and_b32 v9, 0xffff0000, v65
v_add_f32 v130, v130, v8
v_add_f32 v131, v131, v9
v_lshlrev_b32 v6, 16, v66
v_and_b32 v7, 0xffff0000, v66
v_add_f32 v132, v132, v6
v_add_f32 v133, v133, v7
v_lshlrev_b32 v8, 16, v67
v_and_b32 v9, 0xffff0000, v67
v_add_f32 v134, v134, v8
v_add_f32 v135, v135, v9
s_waitcnt vmcnt(13)
v_lshlrev_b32 v6, 16, v68
v_and_b32 v7, 0xffff0000, v68
v_add_f32 v136, v136, v6
v_add_f32 v137, v137, v7
v_lshlrev_b32 v8, 16, v69
v_and_b32 v9, 0xffff0000, v69
v_add_f32 v138, v138, v8
v_add_f32 v139, v139, v9
v_lshlrev_b32 v6, 16, v70
v_and_b32 v7, 0xffff0000, v70
v_add_f32 v140, v140, v6
v_add_f32 v141, v141, v7
v_lshlrev_b32 v8, 16, v71
v_and_b32 v9, 0xffff0000, v71
v_add_f32 v142, v142, v8
v_add_f32 v143, v143, v9
s_waitcnt vmcnt(12)
v_lshlrev_b32 v6, 16, v72
v_and_b32 v7, 0xffff0000, v72
v_add_f32 v144, v144, v6
v_add_f32 v145, v145, v7
v_lshlrev_b32 v8, 16, v73
v_and_b32 v9, 0xffff0000, v73
v_add_f32 v146, v146, v8
v_add_f32 v147, v147, v9
v_lshlrev_b32 v6, 16, v74
v_and_b32 v7, 0xffff0000, v74
v_add_f32 v148, v148, v6
v_add_f32 v149, v149, v7
v_lshlrev_b32 v8, 16, v75
v_and_b32 v9, 0xffff0000, v75
v_add_f32 v150, v150, v8
v_add_f32 v151, v151, v9
s_waitcnt vmcnt(11)
v_lshlrev_b32 v6, 16, v76
v_and_b32 v7, 0xffff0000, v76
v_add_f32 v128, v128, v6
v_add_f32 v129, v129, v7
v_lshlrev_b32 v8, 16, v77
v_and_b32 v9, 0xffff0000, v77
v_add_f32 v130, v130, v8
v_add_f32 v131, v131, v9
v_lshlrev_b32 v6, 16, v78
v_and_b32 v7, 0xffff0000, v78
v_add_f32 v132, v132, v6
v_add_f32 v133, v133, v7
v_lshlrev_b32 v8, 16, v79
v_and_b32 v9, 0xffff0000, v79
v_add_f32 v134, v134, v8
v_add_f32 v135, v135, v9
s_waitcnt vmcnt(10)
v_lshlrev_b32 v6, 16, v80
v_and_b32 v7, 0xffff0000, v80
v_add_f32 v136, v136, v6
v_add_f32 v137, v137, v7
v_lshlrev_b32 v8, 16, v81
v_and_b32 v9, 0xffff0000, v81
v_add_f32 v138, v138, v8
v_add_f32 v139, v139, v9
v_lshlrev_b32 v6, 16, v82
v_and_b32 v7, 0xffff0000, v82
v_add_f32 v140, v140, v6
v_add_f32 v141, v141, v7
v_lshlrev_b32 v8, 16, v83
v_and_b32 v9, 0xffff0000, v83
v_add_f32 v142, v142, v8
v_add_f32 v143, v143, v9
s_waitcnt vmcnt(9)
v_lshlrev_b32 v6, 16, v84
v_and_b32 v7, 0xffff0000, v84
v_add_f32 v144, v144, v6
v_add_f32 v145, v145, v7
v_lshlrev_b32 v8, 16, v85
v_and_b32 v9, 0xffff0000, v85
v_add_f32 v146, v146, v8
v_add_f32 v147, v147, v9
v_lshlrev_b32 v6, 16, v86
v_and_b32 v7, 0xffff0000, v86
v_add_f32 v148, v148, v6
v_add_f32 v149, v149, v7
v_lshlrev_b32 v8, 16, v87
v_and_b32 v9, 0xffff0000, v87
v_add_f32 v150, v150, v8
v_add_f32 v151, v151, v9
s_waitcnt vmcnt(8)
v_lshlrev_b32 v6, 16, v88
v_and_b32 v7, 0xffff0000, v88
v_add_f32 v128, v128, v6
v_add_f32 v129, v129, v7
v_lshlrev_b32 v8, 16, v89
v_and_b32 v9, 0xffff0000, v89
v_add_f32 v130, v130, v8
v_add_f32 v131, v131, v9
v_lshlrev_b32 v6, 16, v90
v_and_b32 v7, 0xffff0000, v90
v_add_f32 v132, v132, v6
v_add_f32 v133, v133, v7
v_lshlrev_b32 v8, 16, v91
v_and_b32 v9, 0xffff0000, v91
v_add_f32 v134, v134, v8
v_add_f32 v135, v135, v9
s_waitcnt vmcnt(7)
v_lshlrev_b32 v6, 16, v92
v_and_b32 v7, 0xffff0000, v92
v_add_f32 v136, v136, v6
v_add_f32 v137, v137, v7
v_lshlrev_b32 v8, 16, v93
v_and_b32 v9, 0xffff0000, v93
v_add_f32 v138, v138, v8
v_add_f32 v139, v139, v9
v_lshlrev_b32 v6, 16, v94
v_and_b32 v7, 0xffff0000, v94
v_add_f32 v140, v140, v6
v_add_f32 v141, v141, v7
v_lshlrev_b32 v8, 16, v95
v_and_b32 v9, 0xffff0000, v95
v_add_f32 v142, v142, v8
v_add_f32 v143, v143, v9
s_waitcnt vmcnt(6)
v_lshlrev_b32 v6, 16, v96
v_and_b32 v7, 0xffff0000, v96
v_add_f32 v144, v144, v6
v_add_f32 v145, v145, v7
v_lshlrev_b32 v8, 16, v97
v_and_b32 v9, 0xffff0000, v97
v_add_f32 v146, v146, v8
v_add_f32 v147, v147, v9
v_lshlrev_b32 v6, 16, v98
v_and_b32 v7, 0xffff0000, v98
v_add_f32 v148, v148, v6
v_add_f32 v149, v149, v7
v_lshlrev_b32 v8, 16, v99
v_and_b32 v9, 0xffff0000, v99
v_add_f32 v150, v150, v8
v_add_f32 v151, v151, v9
s_waitcnt vmcnt(5)
v_lshlrev_b32 v6, 16, v100
v_and_b32 v7, 0xffff0000, v100
v_add_f32 v128, v128, v6
v_add_f32 v129, v129, v7
v_lshlrev_b32 v8, 16, v101
v_and_b32 v9, 0xffff0000, v101
v_add_f32 v130, v130, v8
v_add_f32 v131, v131, v9
v_lshlrev_b32 v6, 16, v102
v_and_b32 v7, 0xffff0000, v102
v_add_f32 v132, v132, v6
v_add_f32 v133, v133, v7
v_lshlrev_b32 v8, 16, v103
v_and_b32 v9, 0xffff0000, v103
v_add_f32 v134, v134, v8
v_add_f32 v135, v135, v9
s_waitcnt vmcnt(4)
v_lshlrev_b32 v6, 16, v104
v_and_b32 v7, 0xffff0000, v104
v_add_f32 v136, v136, v6
v_add_f32 v137, v137, v7
v_lshlrev_b32 v8, 16, v105
v_and_b32 v9, 0xffff0000, v105
v_add_f32 v138, v138, v8
v_add_f32 v139, v139, v9
v_lshlrev_b32 v6, 16, v106
v_and_b32 v7, 0xffff0000, v106
v_add_f32 v140, v140, v6
v_add_f32 v141, v141, v7
v_lshlrev_b32 v8, 16, v107
v_and_b32 v9, 0xffff0000, v107
v_add_f32 v142, v142, v8
v_add_f32 v143, v143, v9
s_waitcnt vmcnt(3)
v_lshlrev_b32 v6, 16, v108
v_and_b32 v7, 0xffff0000, v108
v_add_f32 v144, v144, v6
v_add_f32 v145, v145, v7
v_lshlrev_b32 v8, 16, v109
v_and_b32 v9, 0xffff0000, v109
v_add_f32 v146, v146, v8
v_add_f32 v147, v147, v9
v_lshlrev_b32 v6, 16, v110
v_and_b32 v7, 0xffff0000, v110
v_add_f32 v148, v148, v6
v_add_f32 v149, v149, v7
v_lshlrev_b32 v8, 16, v111
v_and_b32 v9, 0xffff0000, v111
v_add_f32 v150, v150, v8
v_add_f32 v151, v151, v9
s_waitcnt vmcnt(2)
v_lshlrev_b32 v6, 16, v112
v_and_b32 v7, 0xffff0000, v112
v_add_f32 v128, v128, v6
v_add_f32 v129, v129, v7
v_lshlrev_b32 v8, 16, v113
v_and_b32 v9, 0xffff0000, v113
v_add_f32 v130, v130, v8
v_add_f32 v131, v131, v9
v_lshlrev_b32 v6, 16, v114
v_and_b32 v7, 0xffff0000, v114
v_add_f32 v132, v132, v6
v_add_f32 v133, v133, v7
v_lshlrev_b32 v8, 16, v115
v_and_b32 v9, 0xffff0000, v115
v_add_f32 v134, v134, v8
v_add_f32 v135, v135, v9
s_waitcnt vmcnt(1)
v_lshlrev_b32 v6, 16, v116
v_and_b32 v7, 0xffff0000, v116
v_add_f32 v136, v136, v6
v_add_f32 v137, v137, v7
v_lshlrev_b32 v8, 16, v117
v_and_b32 v9, 0xffff0000, v117
v_add_f32 v138, v138, v8
v_add_f32 v139, v139, v9
v_lshlrev_b32 v6, 16, v118
v_and_b32 v7, 0xffff0000, v118
v_add_f32 v140, v140, v6
v_add_f32 v141, v141, v7
v_lshlrev_b32 v8, 16, v119
v_and_b32 v9, 0xffff0000, v119
v_add_f32 v142, v142, v8
v_add_f32 v143, v143, v9
s_waitcnt vmcnt(0)
v_lshlrev_b32 v6, 16, v120
v_and_b32 v7, 0xffff0000, v120
v_add_f32 v144, v144, v6
v_add_f32 v145, v145, v7
v_lshlrev_b32 v8, 16, v121
v_and_b32 v9, 0xffff0000, v121
v_add_f32 v146, v146, v8
v_add_f32 v147, v147, v9
v_lshlrev_b32 v6, 16, v122
v_and_b32 v7, 0xffff0000, v122
v_add_f32 v148, v148, v6
v_add_f32 v149, v149, v7
v_lshlrev_b32 v8, 16, v123
v_and_b32 v9, 0xffff0000, v123
v_add_f32 v150, v150, v8
v_add_f32 v151, v151, v9
v_cvt_pk_bf16_f32 v152, v128, v129
v_cvt_pk_bf16_f32 v153, v130, v131
v_cvt_pk_bf16_f32 v154, v132, v133
v_cvt_pk_bf16_f32 v155, v134, v135
v_cvt_pk_bf16_f32 v156, v136, v137
v_cvt_pk_bf16_f32 v157, v138, v139
v_cvt_pk_bf16_f32 v158, v140, v141
v_cvt_pk_bf16_f32 v159, v142, v143
v_cvt_pk_bf16_f32 v160, v144, v145
v_cvt_pk_bf16_f32 v161, v146, v147
v_cvt_pk_bf16_f32 v162, v148, v149
v_cvt_pk_bf16_f32 v163, v150, v151
s_add_u32 s24, s20, 26402816
s_add_u32 s25, s24, 4096
buffer_store_dwordx4 v[152:155], v4, s[8:11], s24 offen offset:0
buffer_store_dwordx4 v[156:159], v4, s[8:11], s24 offen offset:2048
buffer_store_dwordx4 v[160:163], v4, s[8:11], s25 offen offset:0
v_add_f32 v6, v128, v129
v_mul_f32 v7, v128, v128
v_mul_f32 v9, v129, v129
v_mov_b32 v8, 0
v_add_f32 v6, v6, v130
v_add_f32 v8, v8, v131
v_fmac_f32 v7, v130, v130
v_fmac_f32 v9, v131, v131
v_add_f32 v6, v6, v132
v_add_f32 v8, v8, v133
v_fmac_f32 v7, v132, v132
v_fmac_f32 v9, v133, v133
v_add_f32 v6, v6, v134
v_add_f32 v8, v8, v135
v_fmac_f32 v7, v134, v134
v_fmac_f32 v9, v135, v135
v_add_f32 v6, v6, v136
v_add_f32 v8, v8, v137
v_fmac_f32 v7, v136, v136
v_fmac_f32 v9, v137, v137
v_add_f32 v6, v6, v138
v_add_f32 v8, v8, v139
v_fmac_f32 v7, v138, v138
v_fmac_f32 v9, v139, v139
v_add_f32 v6, v6, v140
v_add_f32 v8, v8, v141
v_fmac_f32 v7, v140, v140
v_fmac_f32 v9, v141, v141
v_add_f32 v6, v6, v142
v_add_f32 v8, v8, v143
v_fmac_f32 v7, v142, v142
v_fmac_f32 v9, v143, v143
v_add_f32 v6, v6, v144
v_add_f32 v8, v8, v145
v_fmac_f32 v7, v144, v144
v_fmac_f32 v9, v145, v145
v_add_f32 v6, v6, v146
v_add_f32 v8, v8, v147
v_fmac_f32 v7, v146, v146
v_fmac_f32 v9, v147, v147
v_add_f32 v6, v6, v148
v_add_f32 v8, v8, v149
v_fmac_f32 v7, v148, v148
v_fmac_f32 v9, v149, v149
v_add_f32 v6, v6, v150
v_add_f32 v8, v8, v151
v_fmac_f32 v7, v150, v150
v_fmac_f32 v9, v151, v151
v_add_f32 v6, v6, v8
v_add_f32 v7, v7, v9
s_nop 0
v_add_f32_dpp v6, v6, v6 row_ror:8 row_mask:0xf bank_mask:0xf
v_add_f32_dpp v7, v7, v7 row_ror:8 row_mask:0xf bank_mask:0xf
v_mov_b32 v8, v6
v_mov_b32 v9, v7
s_nop 0
v_permlane16_swap_b32 v6, v8
v_permlane16_swap_b32 v7, v9
v_add_f32 v6, v6, v8
v_add_f32 v7, v7, v9
v_mov_b32 v8, v6
v_mov_b32 v9, v7
s_nop 0
v_permlane32_swap_b32 v6, v8
v_permlane32_swap_b32 v7, v9
v_add_f32 v6, v6, v8
v_add_f32 v7, v7, v9
v_and_b32 v10, 7, v1
v_lshlrev_b32 v10, 3, v10
s_lshl_b32 s24, s4, 6
v_add_u32 v11, s24, v10
ds_write_b64 v11, v[6:7]
s_waitcnt lgkmcnt(0)
s_barrier
ds_read_b64 v[6:7], v10
ds_read_b64 v[8:9], v10 offset:64
ds_read_b64 v[12:13], v10 offset:128
s_waitcnt lgkmcnt(0)
v_add_f32 v6, v6, v8
v_add_f32 v7, v7, v9
v_add_f32 v6, v6, v12
v_add_f32 v7, v7, v13
v_mul_f32 v6, 0x3ae38e39, v6
v_mul_f32 v7, 0x3ae38e39, v7
v_fma_f32 v7, -v6, v6, v7
v_max_f32 v7, 0, v7
v_add_f32 v7, 0x3727c5ac, v7
v_rsq_f32 v7, v7
s_nop 0
v_mul_f32 v6, v6, v7
v_fma_f32 v128, v128, v7, -v6
v_fma_f32 v129, v129, v7, -v6
v_fma_f32 v130, v130, v7, -v6
v_fma_f32 v131, v131, v7, -v6
v_fma_f32 v132, v132, v7, -v6
v_fma_f32 v133, v133, v7, -v6
v_fma_f32 v134, v134, v7, -v6
v_fma_f32 v135, v135, v7, -v6
v_fma_f32 v136, v136, v7, -v6
v_fma_f32 v137, v137, v7, -v6
v_fma_f32 v138, v138, v7, -v6
v_fma_f32 v139, v139, v7, -v6
v_fma_f32 v140, v140, v7, -v6
v_fma_f32 v141, v141, v7, -v6
v_fma_f32 v142, v142, v7, -v6
v_fma_f32 v143, v143, v7, -v6
v_fma_f32 v144, v144, v7, -v6
v_fma_f32 v145, v145, v7, -v6
v_fma_f32 v146, v146, v7, -v6
v_fma_f32 v147, v147, v7, -v6
v_fma_f32 v148, v148, v7, -v6
v_fma_f32 v149, v149, v7, -v6
v_fma_f32 v150, v150, v7, -v6
v_fma_f32 v151, v151, v7, -v6
v_cvt_pk_bf16_f32 v168, v128, v129
v_cvt_pk_bf16_f32 v169, v130, v131
v_cvt_pk_bf16_f32 v170, v132, v133
v_cvt_pk_bf16_f32 v171, v134, v135
v_cvt_pk_bf16_f32 v172, v136, v137
v_cvt_pk_bf16_f32 v173, v138, v139
v_cvt_pk_bf16_f32 v174, v140, v141
v_cvt_pk_bf16_f32 v175, v142, v143
v_cvt_pk_bf16_f32 v176, v144, v145
v_cvt_pk_bf16_f32 v177, v146, v147
v_cvt_pk_bf16_f32 v178, v148, v149
v_cvt_pk_bf16_f32 v179, v150, v151
s_add_u32 s24, s20, 21684224
s_add_u32 s25, s24, 4096
buffer_store_dwordx4 v[168:171], v4, s[8:11], s24 offen offset:0
buffer_store_dwordx4 v[172:175], v4, s[8:11], s24 offen offset:2048
buffer_store_dwordx4 v[176:179], v4, s[8:11], s25 offen offset:0
L_r0_end:
s_endpgm
.p2align 8
.globl rl1_kernel
.type rl1_kernel,@function
rl1_kernel:
s_cmp_ge_u32 s2, 256
s_cbranch_scc1 L_r1_end
s_load_dwordx2 s[12:13], s[0:1], 72
v_and_b32 v1, 63, v0
v_lshrrev_b32 v3, 6, v0
v_lshlrev_b32 v2, 4, v1
v_readfirstlane_b32 s4, v3
s_and_b32 s5, s2, 7
s_lshr_b32 s6, s2, 3
s_waitcnt lgkmcnt(0)
s_mov_b32 s8, s12
s_and_b32 s9, s13, 0xffff
s_mov_b32 s10, 268435456
s_mov_b32 s11, 0x20000
v_and_b32 v6, 7, v1
v_lshrrev_b32 v7, 3, v1
s_mul_i32 s22, s4, 24
v_add_u32 v7, s22, v7
s_and_b32 s23, s6, 1
s_lshl_b32 s23, s23, 3
v_add_u32 v8, s23, v6
v_lshlrev_b32 v8, 4, v8
v_lshl_add_u32 v4, v7, 8, v8
s_lshl_b32 s24, s5, 4
s_lshr_b32 s25, s6, 1
s_add_u32 s24, s24, s25
s_mul_i32 s20, s24, 18432
s_lshl_b32 s24, s5, 8
s_lshl_b32 s25, s6, 3
s_add_u32 s24, s24, s25
s_and_b32 s25, s24, 1023
s_lshl_b32 s25, s25, 1
s_lshr_b32 s24, s24, 10
s_add_u32 s24, s24, s25
s_mul_i32 s21, s24, 1152
v_mul_u32_u24 v8, 2304, v6
v_lshl_add_u32 v5, v7, 4, v8
s_load_dwordx2 s[12:13], s[0:1], 56
s_waitcnt lgkmcnt(0)
s_mov_b32 s16, s12
s_and_b32 s17, s13, 0xffff
s_mov_b32 s18, 2359296
s_mov_b32 s19, 0x20000
s_add_u32 s24, s20, 35840000
s_add_u32 s25, s24, 4096
buffer_load_dwordx4 v[16:19], v4, s[8:11], s24 offen offset:0
buffer_load_dwordx4 v[20:23], v4, s[8:11], s24 offen offset:2048
buffer_load_dwordx4 v[24:27], v4, s[8:11], s25 offen offset:0
s_add_u32 s24, s20, 95084544
s_add_u32 s25, s24, 4096
buffer_load_dwordx4 v[28:31], v4, s[8:11], s24 offen offset:0
buffer_load_dwordx4 v[32:35], v4, s[8:11], s24 offen offset:2048
buffer_load_dwordx4 v[36:39], v4, s[8:11], s25 offen offset:0
s_add_u32 s24, s20, 97443840
s_add_u32 s25, s24, 4096
buffer_load_dwordx4 v[40:43], v4, s[8:11], s24 offen offset:0
buffer_load_dwordx4 v[44:47], v4, s[8:11], s24 offen offset:2048
buffer_load_dwordx4 v[48:51], v4, s[8:11], s25 offen offset:0
s_add_u32 s24, s20, 99803136
s_add_u32 s25, s24, 4096
buffer_load_dwordx4 v[52:55], v4, s[8:11], s24 offen offset:0
buffer_load_dwordx4 v[56:59], v4, s[8:11], s24 offen offset:2048
buffer_load_dwordx4 v[60:63], v4, s[8:11], s25 offen offset:0
s_add_u32 s24, s20, 102162432
s_add_u32 s25, s24, 4096
buffer_load_dwordx4 v[64:67], v4, s[8:11], s24 offen offset:0
buffer_load_dwordx4 v[68:71], v4, s[8:11], s24 offen offset:2048
buffer_load_dwordx4 v[72:75], v4, s[8:11], s25 offen offset:0
s_add_u32 s24, s20, 104521728
s_add_u32 s25, s24, 4096
buffer_load_dwordx4 v[76:79], v4, s[8:11], s24 offen offset:0
buffer_load_dwordx4 v[80:83], v4, s[8:11], s24 offen offset:2048
buffer_load_dwordx4 v[84:87], v4, s[8:11], s25 offen offset:0
s_add_u32 s24, s20, 106881024
s_add_u32 s25, s24, 4096
buffer_load_dwordx4 v[88:91], v4, s[8:11], s24 offen offset:0
buffer_load_dwordx4 v[92:95], v4, s[8:11], s24 offen offset:2048
buffer_load_dwordx4 v[96:99], v4, s[8:11], s25 offen offset:0
s_add_u32 s24, s20, 109240320
s_add_u32 s25, s24, 4096
buffer_load_dwordx4 v[100:103], v4, s[8:11], s24 offen offset:0
buffer_load_dwordx4 v[104:107], v4, s[8:11], s24 offen offset:2048
buffer_load_dwordx4 v[108:111], v4, s[8:11], s25 offen offset:0
s_add_u32 s24, s20, 111599616
s_add_u32 s25, s24, 4096
buffer_load_dwordx4 v[112:115], v4, s[8:11], s24 offen offset:0
buffer_load_dwordx4 v[116:119], v4, s[8:11], s24 offen offset:2048
buffer_load_dwordx4 v[120:123], v4, s[8:11], s25 offen offset:0
s_waitcnt vmcnt(26)
v_lshlrev_b32 v128, 16, v16
v_and_b32 v129, 0xffff0000, v16
v_lshlrev_b32 v130, 16, v17
v_and_b32 v131, 0xffff0000, v17
v_lshlrev_b32 v132, 16, v18
v_and_b32 v133, 0xffff0000, v18
v_lshlrev_b32 v134, 16, v19
v_and_b32 v135, 0xffff0000, v19
s_waitcnt vmcnt(25)
v_lshlrev_b32 v136, 16, v20
v_and_b32 v137, 0xffff0000, v20
v_lshlrev_b32 v138, 16, v21
v_and_b32 v139, 0xffff0000, v21
v_lshlrev_b32 v140, 16, v22
v_and_b32 v141, 0xffff0000, v22
v_lshlrev_b32 v142, 16, v23
v_and_b32 v143, 0xffff0000, v23
s_waitcnt vmcnt(24)
v_lshlrev_b32 v144, 16, v24
v_and_b32 v145, 0xffff0000, v24
v_lshlrev_b32 v146, 16, v25
v_and_b32 v147, 0xffff0000, v25
v_lshlrev_b32 v148, 16, v26
v_and_b32 v149, 0xffff0000, v26
v_lshlrev_b32 v150, 16, v27
v_and_b32 v151, 0xffff0000, v27
s_waitcnt vmcnt(23)
v_lshlrev_b32 v6, 16, v28
v_and_b32 v7, 0xffff0000, v28
v_add_f32 v128, v128, v6
v_add_f32 v129, v129, v7
v_lshlrev_b32 v8, 16, v29
v_and_b32 v9, 0xffff0000, v29
v_add_f32 v130, v130, v8
v_add_f32 v131, v131, v9
v_lshlrev_b32 v6, 16, v30
v_and_b32 v7, 0xffff0000, v30
v_add_f32 v132, v132, v6
v_add_f32 v133, v133, v7
v_lshlrev_b32 v8, 16, v31
v_and_b32 v9, 0xffff0000, v31
v_add_f32 v134, v134, v8
v_add_f32 v135, v135, v9
s_waitcnt vmcnt(22)
v_lshlrev_b32 v6, 16, v32
v_and_b32 v7, 0xffff0000, v32
v_add_f32 v136, v136, v6
v_add_f32 v137, v137, v7
v_lshlrev_b32 v8, 16, v33
v_and_b32 v9, 0xffff0000, v33
v_add_f32 v138, v138, v8
v_add_f32 v139, v139, v9
v_lshlrev_b32 v6, 16, v34
v_and_b32 v7, 0xffff0000, v34
v_add_f32 v140, v140, v6
v_add_f32 v141, v141, v7
v_lshlrev_b32 v8, 16, v35
v_and_b32 v9, 0xffff0000, v35
v_add_f32 v142, v142, v8
v_add_f32 v143, v143, v9
s_waitcnt vmcnt(21)
v_lshlrev_b32 v6, 16, v36
v_and_b32 v7, 0xffff0000, v36
v_add_f32 v144, v144, v6
v_add_f32 v145, v145, v7
v_lshlrev_b32 v8, 16, v37
v_and_b32 v9, 0xffff0000, v37
v_add_f32 v146, v146, v8
v_add_f32 v147, v147, v9
v_lshlrev_b32 v6, 16, v38
v_and_b32 v7, 0xffff0000, v38
v_add_f32 v148, v148, v6
v_add_f32 v149, v149, v7
v_lshlrev_b32 v8, 16, v39
v_and_b32 v9, 0xffff0000, v39
v_add_f32 v150, v150, v8
v_add_f32 v151, v151, v9
s_waitcnt vmcnt(20)
v_lshlrev_b32 v6, 16, v40
v_and_b32 v7, 0xffff0000, v40
v_add_f32 v128, v128, v6
v_add_f32 v129, v129, v7
v_lshlrev_b32 v8, 16, v41
v_and_b32 v9, 0xffff0000, v41
v_add_f32 v130, v130, v8
v_add_f32 v131, v131, v9
v_lshlrev_b32 v6, 16, v42
v_and_b32 v7, 0xffff0000, v42
v_add_f32 v132, v132, v6
v_add_f32 v133, v133, v7
v_lshlrev_b32 v8, 16, v43
v_and_b32 v9, 0xffff0000, v43
v_add_f32 v134, v134, v8
v_add_f32 v135, v135, v9
s_waitcnt vmcnt(19)
v_lshlrev_b32 v6, 16, v44
v_and_b32 v7, 0xffff0000, v44
v_add_f32 v136, v136, v6
v_add_f32 v137, v137, v7
v_lshlrev_b32 v8, 16, v45
v_and_b32 v9, 0xffff0000, v45
v_add_f32 v138, v138, v8
v_add_f32 v139, v139, v9
v_lshlrev_b32 v6, 16, v46
v_and_b32 v7, 0xffff0000, v46
v_add_f32 v140, v140, v6
v_add_f32 v141, v141, v7
v_lshlrev_b32 v8, 16, v47
v_and_b32 v9, 0xffff0000, v47
v_add_f32 v142, v142, v8
v_add_f32 v143, v143, v9
s_waitcnt vmcnt(18)
v_lshlrev_b32 v6, 16, v48
v_and_b32 v7, 0xffff0000, v48
v_add_f32 v144, v144, v6
v_add_f32 v145, v145, v7
v_lshlrev_b32 v8, 16, v49
v_and_b32 v9, 0xffff0000, v49
v_add_f32 v146, v146, v8
v_add_f32 v147, v147, v9
v_lshlrev_b32 v6, 16, v50
v_and_b32 v7, 0xffff0000, v50
v_add_f32 v148, v148, v6
v_add_f32 v149, v149, v7
v_lshlrev_b32 v8, 16, v51
v_and_b32 v9, 0xffff0000, v51
v_add_f32 v150, v150, v8
v_add_f32 v151, v151, v9
s_waitcnt vmcnt(17)
v_lshlrev_b32 v6, 16, v52
v_and_b32 v7, 0xffff0000, v52
v_add_f32 v128, v128, v6
v_add_f32 v129, v129, v7
v_lshlrev_b32 v8, 16, v53
v_and_b32 v9, 0xffff0000, v53
v_add_f32 v130, v130, v8
v_add_f32 v131, v131, v9
v_lshlrev_b32 v6, 16, v54
v_and_b32 v7, 0xffff0000, v54
v_add_f32 v132, v132, v6
v_add_f32 v133, v133, v7
v_lshlrev_b32 v8, 16, v55
v_and_b32 v9, 0xffff0000, v55
v_add_f32 v134, v134, v8
v_add_f32 v135, v135, v9
s_waitcnt vmcnt(16)
v_lshlrev_b32 v6, 16, v56
v_and_b32 v7, 0xffff0000, v56
v_add_f32 v136, v136, v6
v_add_f32 v137, v137, v7
v_lshlrev_b32 v8, 16, v57
v_and_b32 v9, 0xffff0000, v57
v_add_f32 v138, v138, v8
v_add_f32 v139, v139, v9
v_lshlrev_b32 v6, 16, v58
v_and_b32 v7, 0xffff0000, v58
v_add_f32 v140, v140, v6
v_add_f32 v141, v141, v7
v_lshlrev_b32 v8, 16, v59
v_and_b32 v9, 0xffff0000, v59
v_add_f32 v142, v142, v8
v_add_f32 v143, v143, v9
s_waitcnt vmcnt(15)
v_lshlrev_b32 v6, 16, v60
v_and_b32 v7, 0xffff0000, v60
v_add_f32 v144, v144, v6
v_add_f32 v145, v145, v7
v_lshlrev_b32 v8, 16, v61
v_and_b32 v9, 0xffff0000, v61
v_add_f32 v146, v146, v8
v_add_f32 v147, v147, v9
v_lshlrev_b32 v6, 16, v62
v_and_b32 v7, 0xffff0000, v62
v_add_f32 v148, v148, v6
v_add_f32 v149, v149, v7
v_lshlrev_b32 v8, 16, v63
v_and_b32 v9, 0xffff0000, v63
v_add_f32 v150, v150, v8
v_add_f32 v151, v151, v9
s_waitcnt vmcnt(14)
v_lshlrev_b32 v6, 16, v64
v_and_b32 v7, 0xffff0000, v64
v_add_f32 v128, v128, v6
v_add_f32 v129, v129, v7
v_lshlrev_b32 v8, 16, v65
v_and_b32 v9, 0xffff0000, v65
v_add_f32 v130, v130, v8
v_add_f32 v131, v131, v9
v_lshlrev_b32 v6, 16, v66
v_and_b32 v7, 0xffff0000, v66
v_add_f32 v132, v132, v6
v_add_f32 v133, v133, v7
v_lshlrev_b32 v8, 16, v67
v_and_b32 v9, 0xffff0000, v67
v_add_f32 v134, v134, v8
v_add_f32 v135, v135, v9
s_waitcnt vmcnt(13)
v_lshlrev_b32 v6, 16, v68
v_and_b32 v7, 0xffff0000, v68
v_add_f32 v136, v136, v6
v_add_f32 v137, v137, v7
v_lshlrev_b32 v8, 16, v69
v_and_b32 v9, 0xffff0000, v69
v_add_f32 v138, v138, v8
v_add_f32 v139, v139, v9
v_lshlrev_b32 v6, 16, v70
v_and_b32 v7, 0xffff0000, v70
v_add_f32 v140, v140, v6
v_add_f32 v141, v141, v7
v_lshlrev_b32 v8, 16, v71
v_and_b32 v9, 0xffff0000, v71
v_add_f32 v142, v142, v8
v_add_f32 v143, v143, v9
s_waitcnt vmcnt(12)
v_lshlrev_b32 v6, 16, v72
v_and_b32 v7, 0xffff0000, v72
v_add_f32 v144, v144, v6
v_add_f32 v145, v145, v7
v_lshlrev_b32 v8, 16, v73
v_and_b32 v9, 0xffff0000, v73
v_add_f32 v146, v146, v8
v_add_f32 v147, v147, v9
v_lshlrev_b32 v6, 16, v74
v_and_b32 v7, 0xffff0000, v74
v_add_f32 v148, v148, v6
v_add_f32 v149, v149, v7
v_lshlrev_b32 v8, 16, v75
v_and_b32 v9, 0xffff0000, v75
v_add_f32 v150, v150, v8
v_add_f32 v151, v151, v9
s_waitcnt vmcnt(11)
v_lshlrev_b32 v6, 16, v76
v_and_b32 v7, 0xffff0000, v76
v_add_f32 v128, v128, v6
v_add_f32 v129, v129, v7
v_lshlrev_b32 v8, 16, v77
v_and_b32 v9, 0xffff0000, v77
v_add_f32 v130, v130, v8
v_add_f32 v131, v131, v9
v_lshlrev_b32 v6, 16, v78
v_and_b32 v7, 0xffff0000, v78
v_add_f32 v132, v132, v6
v_add_f32 v133, v133, v7
v_lshlrev_b32 v8, 16, v79
v_and_b32 v9, 0xffff0000, v79
v_add_f32 v134, v134, v8
v_add_f32 v135, v135, v9
s_waitcnt vmcnt(10)
v_lshlrev_b32 v6, 16, v80
v_and_b32 v7, 0xffff0000, v80
v_add_f32 v136, v136, v6
v_add_f32 v137, v137, v7
v_lshlrev_b32 v8, 16, v81
v_and_b32 v9, 0xffff0000, v81
v_add_f32 v138, v138, v8
v_add_f32 v139, v139, v9
v_lshlrev_b32 v6, 16, v82
v_and_b32 v7, 0xffff0000, v82
v_add_f32 v140, v140, v6
v_add_f32 v141, v141, v7
v_lshlrev_b32 v8, 16, v83
v_and_b32 v9, 0xffff0000, v83
v_add_f32 v142, v142, v8
v_add_f32 v143, v143, v9
s_waitcnt vmcnt(9)
v_lshlrev_b32 v6, 16, v84
v_and_b32 v7, 0xffff0000, v84
v_add_f32 v144, v144, v6
v_add_f32 v145, v145, v7
v_lshlrev_b32 v8, 16, v85
v_and_b32 v9, 0xffff0000, v85
v_add_f32 v146, v146, v8
v_add_f32 v147, v147, v9
v_lshlrev_b32 v6, 16, v86
v_and_b32 v7, 0xffff0000, v86
v_add_f32 v148, v148, v6
v_add_f32 v149, v149, v7
v_lshlrev_b32 v8, 16, v87
v_and_b32 v9, 0xffff0000, v87
v_add_f32 v150, v150, v8
v_add_f32 v151, v151, v9
s_waitcnt vmcnt(8)
v_lshlrev_b32 v6, 16, v88
v_and_b32 v7, 0xffff0000, v88
v_add_f32 v128, v128, v6
v_add_f32 v129, v129, v7
v_lshlrev_b32 v8, 16, v89
v_and_b32 v9, 0xffff0000, v89
v_add_f32 v130, v130, v8
v_add_f32 v131, v131, v9
v_lshlrev_b32 v6, 16, v90
v_and_b32 v7, 0xffff0000, v90
v_add_f32 v132, v132, v6
v_add_f32 v133, v133, v7
v_lshlrev_b32 v8, 16, v91
v_and_b32 v9, 0xffff0000, v91
v_add_f32 v134, v134, v8
v_add_f32 v135, v135, v9
s_waitcnt vmcnt(7)
v_lshlrev_b32 v6, 16, v92
v_and_b32 v7, 0xffff0000, v92
v_add_f32 v136, v136, v6
v_add_f32 v137, v137, v7
v_lshlrev_b32 v8, 16, v93
v_and_b32 v9, 0xffff0000, v93
v_add_f32 v138, v138, v8
v_add_f32 v139, v139, v9
v_lshlrev_b32 v6, 16, v94
v_and_b32 v7, 0xffff0000, v94
v_add_f32 v140, v140, v6
v_add_f32 v141, v141, v7
v_lshlrev_b32 v8, 16, v95
v_and_b32 v9, 0xffff0000, v95
v_add_f32 v142, v142, v8
v_add_f32 v143, v143, v9
s_waitcnt vmcnt(6)
v_lshlrev_b32 v6, 16, v96
v_and_b32 v7, 0xffff0000, v96
v_add_f32 v144, v144, v6
v_add_f32 v145, v145, v7
v_lshlrev_b32 v8, 16, v97
v_and_b32 v9, 0xffff0000, v97
v_add_f32 v146, v146, v8
v_add_f32 v147, v147, v9
v_lshlrev_b32 v6, 16, v98
v_and_b32 v7, 0xffff0000, v98
v_add_f32 v148, v148, v6
v_add_f32 v149, v149, v7
v_lshlrev_b32 v8, 16, v99
v_and_b32 v9, 0xffff0000, v99
v_add_f32 v150, v150, v8
v_add_f32 v151, v151, v9
s_waitcnt vmcnt(5)
v_lshlrev_b32 v6, 16, v100
v_and_b32 v7, 0xffff0000, v100
v_add_f32 v128, v128, v6
v_add_f32 v129, v129, v7
v_lshlrev_b32 v8, 16, v101
v_and_b32 v9, 0xffff0000, v101
v_add_f32 v130, v130, v8
v_add_f32 v131, v131, v9
v_lshlrev_b32 v6, 16, v102
v_and_b32 v7, 0xffff0000, v102
v_add_f32 v132, v132, v6
v_add_f32 v133, v133, v7
v_lshlrev_b32 v8, 16, v103
v_and_b32 v9, 0xffff0000, v103
v_add_f32 v134, v134, v8
v_add_f32 v135, v135, v9
s_waitcnt vmcnt(4)
v_lshlrev_b32 v6, 16, v104
v_and_b32 v7, 0xffff0000, v104
v_add_f32 v136, v136, v6
v_add_f32 v137, v137, v7
v_lshlrev_b32 v8, 16, v105
v_and_b32 v9, 0xffff0000, v105
v_add_f32 v138, v138, v8
v_add_f32 v139, v139, v9
v_lshlrev_b32 v6, 16, v106
v_and_b32 v7, 0xffff0000, v106
v_add_f32 v140, v140, v6
v_add_f32 v141, v141, v7
v_lshlrev_b32 v8, 16, v107
v_and_b32 v9, 0xffff0000, v107
v_add_f32 v142, v142, v8
v_add_f32 v143, v143, v9
s_waitcnt vmcnt(3)
v_lshlrev_b32 v6, 16, v108
v_and_b32 v7, 0xffff0000, v108
v_add_f32 v144, v144, v6
v_add_f32 v145, v145, v7
v_lshlrev_b32 v8, 16, v109
v_and_b32 v9, 0xffff0000, v109
v_add_f32 v146, v146, v8
v_add_f32 v147, v147, v9
v_lshlrev_b32 v6, 16, v110
v_and_b32 v7, 0xffff0000, v110
v_add_f32 v148, v148, v6
v_add_f32 v149, v149, v7
v_lshlrev_b32 v8, 16, v111
v_and_b32 v9, 0xffff0000, v111
v_add_f32 v150, v150, v8
v_add_f32 v151, v151, v9
s_waitcnt vmcnt(2)
v_lshlrev_b32 v6, 16, v112
v_and_b32 v7, 0xffff0000, v112
v_add_f32 v128, v128, v6
v_add_f32 v129, v129, v7
v_lshlrev_b32 v8, 16, v113
v_and_b32 v9, 0xffff0000, v113
v_add_f32 v130, v130, v8
v_add_f32 v131, v131, v9
v_lshlrev_b32 v6, 16, v114
v_and_b32 v7, 0xffff0000, v114
v_add_f32 v132, v132, v6
v_add_f32 v133, v133, v7
v_lshlrev_b32 v8, 16, v115
v_and_b32 v9, 0xffff0000, v115
v_add_f32 v134, v134, v8
v_add_f32 v135, v135, v9
s_waitcnt vmcnt(1)
v_lshlrev_b32 v6, 16, v116
v_and_b32 v7, 0xffff0000, v116
v_add_f32 v136, v136, v6
v_add_f32 v137, v137, v7
v_lshlrev_b32 v8, 16, v117
v_and_b32 v9, 0xffff0000, v117
v_add_f32 v138, v138, v8
v_add_f32 v139, v139, v9
v_lshlrev_b32 v6, 16, v118
v_and_b32 v7, 0xffff0000, v118
v_add_f32 v140, v140, v6
v_add_f32 v141, v141, v7
v_lshlrev_b32 v8, 16, v119
v_and_b32 v9, 0xffff0000, v119
v_add_f32 v142, v142, v8
v_add_f32 v143, v143, v9
s_waitcnt vmcnt(0)
v_lshlrev_b32 v6, 16, v120
v_and_b32 v7, 0xffff0000, v120
v_add_f32 v144, v144, v6
v_add_f32 v145, v145, v7
v_lshlrev_b32 v8, 16, v121
v_and_b32 v9, 0xffff0000, v121
v_add_f32 v146, v146, v8
v_add_f32 v147, v147, v9
v_lshlrev_b32 v6, 16, v122
v_and_b32 v7, 0xffff0000, v122
v_add_f32 v148, v148, v6
v_add_f32 v149, v149, v7
v_lshlrev_b32 v8, 16, v123
v_and_b32 v9, 0xffff0000, v123
v_add_f32 v150, v150, v8
v_add_f32 v151, v151, v9
v_cvt_pk_bf16_f32 v152, v128, v129
v_cvt_pk_bf16_f32 v153, v130, v131
v_cvt_pk_bf16_f32 v154, v132, v133
v_cvt_pk_bf16_f32 v155, v134, v135
v_cvt_pk_bf16_f32 v156, v136, v137
v_cvt_pk_bf16_f32 v157, v138, v139
v_cvt_pk_bf16_f32 v158, v140, v141
v_cvt_pk_bf16_f32 v159, v142, v143
v_cvt_pk_bf16_f32 v160, v144, v145
v_cvt_pk_bf16_f32 v161, v146, v147
v_cvt_pk_bf16_f32 v162, v148, v149
v_cvt_pk_bf16_f32 v163, v150, v151
buffer_store_dwordx4 v[152:155], v5, s[16:19], s21 offen offset:0
buffer_store_dwordx4 v[156:159], v5, s[16:19], s21 offen offset:128
buffer_store_dwordx4 v[160:163], v5, s[16:19], s21 offen offset:256
L_r1_end:
s_endpgm
.section .rodata,"a"
.p2align 6
.amdhsa_kernel prep_kernel
  .amdhsa_next_free_vgpr 184
  .amdhsa_next_free_sgpr 102
  .amdhsa_accum_offset 184
  .amdhsa_group_segment_fixed_size 0
  .amdhsa_kernarg_size 80
  .amdhsa_user_sgpr_count 2
  .amdhsa_user_sgpr_kernarg_segment_ptr 1
  .amdhsa_system_sgpr_workgroup_id_x 1
.end_amdhsa_kernel
.p2align 6
.amdhsa_kernel rl0_kernel
  .amdhsa_next_free_vgpr 184
  .amdhsa_next_free_sgpr 102
  .amdhsa_accum_offset 184
  .amdhsa_group_segment_fixed_size 0
  .amdhsa_kernarg_size 80
  .amdhsa_user_sgpr_count 2
  .amdhsa_user_sgpr_kernarg_segment_ptr 1
  .amdhsa_system_sgpr_workgroup_id_x 1
.end_amdhsa_kernel
.p2align 6
.amdhsa_kernel rl1_kernel
  .amdhsa_next_free_vgpr 184
  .amdhsa_next_free_sgpr 102
  .amdhsa_accum_offset 184
  .amdhsa_group_segment_fixed_size 0
  .amdhsa_kernarg_size 80
  .amdhsa_user_sgpr_count 2
  .amdhsa_user_sgpr_kernarg_segment_ptr 1
  .amdhsa_system_sgpr_workgroup_id_x 1
.end_amdhsa_kernel
.p2align 6
.amdhsa_kernel a1l0_kernel
  .amdhsa_next_free_vgpr 512
  .amdhsa_next_free_sgpr 102
  .amdhsa_accum_offset 256
  .amdhsa_group_segment_fixed_size 0
  .amdhsa_kernarg_size 80
  .amdhsa_user_sgpr_count 2
  .amdhsa_user_sgpr_kernarg_segment_ptr 1
  .amdhsa_system_sgpr_workgroup_id_x 1
.end_amdhsa_kernel
.p2align 6
.amdhsa_kernel a2l0_kernel
  .amdhsa_next_free_vgpr 512
  .amdhsa_next_free_sgpr 102
  .amdhsa_accum_offset 256
  .amdhsa_group_segment_fixed_size 0
  .amdhsa_kernarg_size 80
  .amdhsa_user_sgpr_count 2
  .amdhsa_user_sgpr_kernarg_segment_ptr 1
  .amdhsa_system_sgpr_workgroup_id_x 1
.end_amdhsa_kernel
.p2align 6
.amdhsa_kernel fl0_kernel
  .amdhsa_next_free_vgpr 512
  .amdhsa_next_free_sgpr 102
  .amdhsa_accum_offset 256
  .amdhsa_group_segment_fixed_size 0
  .amdhsa_kernarg_size 80
  .amdhsa_user_sgpr_count 2
  .amdhsa_user_sgpr_kernarg_segment_ptr 1
  .amdhsa_system_sgpr_workgroup_id_x 1
.end_amdhsa_kernel
.p2align 6
.amdhsa_kernel a1l1_kernel
  .amdhsa_next_free_vgpr 512
  .amdhsa_next_free_sgpr 102
  .amdhsa_accum_offset 256
  .amdhsa_group_segment_fixed_size 0
  .amdhsa_kernarg_size 80
  .amdhsa_user_sgpr_count 2
  .amdhsa_user_sgpr_kernarg_segment_ptr 1
  .amdhsa_system_sgpr_workgroup_id_x 1
.end_amdhsa_kernel
.p2align 6
.amdhsa_kernel a2l1_kernel
  .amdhsa_next_free_vgpr 512
  .amdhsa_next_free_sgpr 102
  .amdhsa_accum_offset 256
  .amdhsa_group_segment_fixed_size 0
  .amdhsa_kernarg_size 80
  .amdhsa_user_sgpr_count 2
  .amdhsa_user_sgpr_kernarg_segment_ptr 1
  .amdhsa_system_sgpr_workgroup_id_x 1
.end_amdhsa_kernel
.p2align 6
.amdhsa_kernel fl1_kernel
  .amdhsa_next_free_vgpr 512
  .amdhsa_next_free_sgpr 102
  .amdhsa_accum_offset 256
  .amdhsa_group_segment_fixed_size 0
  .amdhsa_kernarg_size 80
  .amdhsa_user_sgpr_count 2
  .amdhsa_user_sgpr_kernarg_segment_ptr 1
  .amdhsa_system_sgpr_workgroup_id_x 1
.end_amdhsa_kernel
```

```asm
; @launch kernel=prep_kernel grid=(258,1,1) block=(256,1,1) lds=1024
; @launch kernel=main_kernel grid=(256,1,1) block=(256,1,1) lds=159744
.amdgcn_target "amdgcn-amd-amdhsa--gfx950"
.text
.p2align 8
.globl prep_kernel
.type prep_kernel,@function
prep_kernel:
s_cmp_ge_u32 s2, 258
s_cbranch_scc1 L_prep_end
s_load_dwordx2 s[12:13], s[0:1], 72
v_and_b32 v1, 63, v0
v_lshrrev_b32 v3, 6, v0
v_lshlrev_b32 v2, 4, v1
v_readfirstlane_b32 s4, v3
s_and_b32 s5, s2, 7
s_lshr_b32 s6, s2, 3
s_waitcnt lgkmcnt(0)
s_mov_b32 s8, s12
s_and_b32 s9, s13, 0xffff
s_mov_b32 s10, 268435456
s_mov_b32 s11, 0x20000
s_cmp_ge_u32 s2, 256
s_cbranch_scc1 L_prep_pack
s_lshl_b32 s20, s2, 10
s_add_u32 s20, s20, 0
v_lshlrev_b32 v4, 2, v0
v_mov_b32 v5, 0
buffer_store_dword v5, v4, s[8:11], s20 offen
s_cmp_eq_u32 s4, 3
s_cbranch_scc1 L_prep_idle
v_and_b32 v6, 7, v1
v_lshrrev_b32 v7, 3, v1
s_mul_i32 s22, s4, 24
v_add_u32 v7, s22, v7
s_and_b32 s23, s6, 1
s_lshl_b32 s23, s23, 3
v_add_u32 v8, s23, v6
v_lshlrev_b32 v8, 4, v8
v_lshl_add_u32 v4, v7, 8, v8
s_lshl_b32 s24, s5, 4
s_lshr_b32 s25, s6, 1
s_add_u32 s24, s24, s25
s_mul_i32 s20, s24, 18432
s_lshl_b32 s24, s5, 8
s_lshl_b32 s25, s6, 3
s_add_u32 s24, s24, s25
s_and_b32 s25, s24, 1023
s_lshl_b32 s25, s25, 1
s_lshr_b32 s24, s24, 10
s_add_u32 s24, s24, s25
s_mul_i32 s21, s24, 1152
v_mul_u32_u24 v8, 2304, v6
v_lshl_add_u32 v5, v7, 4, v8
s_load_dwordx2 s[12:13], s[0:1], 0
s_waitcnt lgkmcnt(0)
s_mov_b32 s16, s12
s_and_b32 s17, s13, 0xffff
s_mov_b32 s18, 2359296
s_mov_b32 s19, 0x20000
buffer_load_dwordx4 v[16:19], v5, s[16:19], s21 offen offset:0
buffer_load_dwordx4 v[20:23], v5, s[16:19], s21 offen offset:128
buffer_load_dwordx4 v[24:27], v5, s[16:19], s21 offen offset:256
s_waitcnt vmcnt(2)
v_lshlrev_b32 v128, 16, v16
v_and_b32 v129, 0xffff0000, v16
v_lshlrev_b32 v130, 16, v17
v_and_b32 v131, 0xffff0000, v17
v_lshlrev_b32 v132, 16, v18
v_and_b32 v133, 0xffff0000, v18
v_lshlrev_b32 v134, 16, v19
v_and_b32 v135, 0xffff0000, v19
s_waitcnt vmcnt(1)
v_lshlrev_b32 v136, 16, v20
v_and_b32 v137, 0xffff0000, v20
v_lshlrev_b32 v138, 16, v21
v_and_b32 v139, 0xffff0000, v21
v_lshlrev_b32 v140, 16, v22
v_and_b32 v141, 0xffff0000, v22
v_lshlrev_b32 v142, 16, v23
v_and_b32 v143, 0xffff0000, v23
s_waitcnt vmcnt(0)
v_lshlrev_b32 v144, 16, v24
v_and_b32 v145, 0xffff0000, v24
v_lshlrev_b32 v146, 16, v25
v_and_b32 v147, 0xffff0000, v25
v_lshlrev_b32 v148, 16, v26
v_and_b32 v149, 0xffff0000, v26
v_lshlrev_b32 v150, 16, v27
v_and_b32 v151, 0xffff0000, v27
s_add_u32 s24, s20, 24043520
s_add_u32 s25, s24, 4096
buffer_store_dwordx4 v[16:19], v4, s[8:11], s24 offen offset:0
buffer_store_dwordx4 v[20:23], v4, s[8:11], s24 offen offset:2048
buffer_store_dwordx4 v[24:27], v4, s[8:11], s25 offen offset:0
v_add_f32 v6, v128, v129
v_mul_f32 v7, v128, v128
v_mul_f32 v9, v129, v129
v_mov_b32 v8, 0
v_add_f32 v6, v6, v130
v_add_f32 v8, v8, v131
v_fmac_f32 v7, v130, v130
v_fmac_f32 v9, v131, v131
v_add_f32 v6, v6, v132
v_add_f32 v8, v8, v133
v_fmac_f32 v7, v132, v132
v_fmac_f32 v9, v133, v133
v_add_f32 v6, v6, v134
v_add_f32 v8, v8, v135
v_fmac_f32 v7, v134, v134
v_fmac_f32 v9, v135, v135
v_add_f32 v6, v6, v136
v_add_f32 v8, v8, v137
v_fmac_f32 v7, v136, v136
v_fmac_f32 v9, v137, v137
v_add_f32 v6, v6, v138
v_add_f32 v8, v8, v139
v_fmac_f32 v7, v138, v138
v_fmac_f32 v9, v139, v139
v_add_f32 v6, v6, v140
v_add_f32 v8, v8, v141
v_fmac_f32 v7, v140, v140
v_fmac_f32 v9, v141, v141
v_add_f32 v6, v6, v142
v_add_f32 v8, v8, v143
v_fmac_f32 v7, v142, v142
v_fmac_f32 v9, v143, v143
v_add_f32 v6, v6, v144
v_add_f32 v8, v8, v145
v_fmac_f32 v7, v144, v144
v_fmac_f32 v9, v145, v145
v_add_f32 v6, v6, v146
v_add_f32 v8, v8, v147
v_fmac_f32 v7, v146, v146
v_fmac_f32 v9, v147, v147
v_add_f32 v6, v6, v148
v_add_f32 v8, v8, v149
v_fmac_f32 v7, v148, v148
v_fmac_f32 v9, v149, v149
v_add_f32 v6, v6, v150
v_add_f32 v8, v8, v151
v_fmac_f32 v7, v150, v150
v_fmac_f32 v9, v151, v151
v_add_f32 v6, v6, v8
v_add_f32 v7, v7, v9
s_nop 0
v_add_f32_dpp v6, v6, v6 row_ror:8 row_mask:0xf bank_mask:0xf
v_add_f32_dpp v7, v7, v7 row_ror:8 row_mask:0xf bank_mask:0xf
v_mov_b32 v8, v6
v_mov_b32 v9, v7
s_nop 0
v_permlane16_swap_b32 v6, v8
v_permlane16_swap_b32 v7, v9
v_add_f32 v6, v6, v8
v_add_f32 v7, v7, v9
v_mov_b32 v8, v6
v_mov_b32 v9, v7
s_nop 0
v_permlane32_swap_b32 v6, v8
v_permlane32_swap_b32 v7, v9
v_add_f32 v6, v6, v8
v_add_f32 v7, v7, v9
v_and_b32 v10, 7, v1
v_lshlrev_b32 v10, 3, v10
v_add_u32 v10, 0, v10
s_lshl_b32 s24, s4, 6
v_add_u32 v11, s24, v10
ds_write_b64 v11, v[6:7]
s_waitcnt lgkmcnt(0)
s_barrier
ds_read_b64 v[6:7], v10
ds_read_b64 v[8:9], v10 offset:64
ds_read_b64 v[12:13], v10 offset:128
s_waitcnt lgkmcnt(0)
v_add_f32 v6, v6, v8
v_add_f32 v7, v7, v9
v_add_f32 v6, v6, v12
v_add_f32 v7, v7, v13
v_mul_f32 v6, 0x3ae38e39, v6
v_mul_f32 v7, 0x3ae38e39, v7
v_fma_f32 v7, -v6, v6, v7
v_max_f32 v7, 0, v7
v_add_f32 v7, 0x3727c5ac, v7
v_rsq_f32 v7, v7
s_nop 0
v_mul_f32 v6, v6, v7
v_fma_f32 v128, v128, v7, -v6
v_fma_f32 v129, v129, v7, -v6
v_fma_f32 v130, v130, v7, -v6
v_fma_f32 v131, v131, v7, -v6
v_fma_f32 v132, v132, v7, -v6
v_fma_f32 v133, v133, v7, -v6
v_fma_f32 v134, v134, v7, -v6
v_fma_f32 v135, v135, v7, -v6
v_fma_f32 v136, v136, v7, -v6
v_fma_f32 v137, v137, v7, -v6
v_fma_f32 v138, v138, v7, -v6
v_fma_f32 v139, v139, v7, -v6
v_fma_f32 v140, v140, v7, -v6
v_fma_f32 v141, v141, v7, -v6
v_fma_f32 v142, v142, v7, -v6
v_fma_f32 v143, v143, v7, -v6
v_fma_f32 v144, v144, v7, -v6
v_fma_f32 v145, v145, v7, -v6
v_fma_f32 v146, v146, v7, -v6
v_fma_f32 v147, v147, v7, -v6
v_fma_f32 v148, v148, v7, -v6
v_fma_f32 v149, v149, v7, -v6
v_fma_f32 v150, v150, v7, -v6
v_fma_f32 v151, v151, v7, -v6
v_cvt_pk_bf16_f32 v168, v128, v129
v_cvt_pk_bf16_f32 v169, v130, v131
v_cvt_pk_bf16_f32 v170, v132, v133
v_cvt_pk_bf16_f32 v171, v134, v135
v_cvt_pk_bf16_f32 v172, v136, v137
v_cvt_pk_bf16_f32 v173, v138, v139
v_cvt_pk_bf16_f32 v174, v140, v141
v_cvt_pk_bf16_f32 v175, v142, v143
v_cvt_pk_bf16_f32 v176, v144, v145
v_cvt_pk_bf16_f32 v177, v146, v147
v_cvt_pk_bf16_f32 v178, v148, v149
v_cvt_pk_bf16_f32 v179, v150, v151
s_add_u32 s24, s20, 19324928
s_add_u32 s25, s24, 4096
buffer_store_dwordx4 v[168:171], v4, s[8:11], s24 offen offset:0
buffer_store_dwordx4 v[172:175], v4, s[8:11], s24 offen offset:2048
buffer_store_dwordx4 v[176:179], v4, s[8:11], s25 offen offset:0
s_branch L_prep_pack
L_prep_idle:
s_barrier
L_prep_pack:
s_waitcnt vmcnt(0)
s_lshl_b32 s20, s2, 2
s_add_u32 s20, s20, s4
v_and_b32 v6, 15, v1
v_lshrrev_b32 v7, 4, v1
v_lshrrev_b32 v8, 2, v6
v_and_b32 v9, 3, v6
v_lshl_add_u32 v10, v8, 3, v9
s_cmp_ge_u32 s20, 992
s_cbranch_scc1 L_pack_o
s_cmp_ge_u32 s20, 864
s_cbranch_scc1 L_pack_q
s_cmp_ge_u32 s20, 576
s_cbranch_scc1 L_pack_d
s_mul_i32 s21, s2, 911
s_lshr_b32 s21, s21, 16
s_mul_i32 s22, s21, 72
s_sub_u32 s22, s2, s22
s_mul_i32 s23, s22, 7282
s_lshr_b32 s23, s23, 16
s_mul_i32 s24, s23, 9
s_sub_u32 s24, s22, s24
s_lshl_b32 s24, s24, 2
s_add_u32 s24, s24, s4
s_load_dwordx4 s[36:39], s[0:1], 32
s_waitcnt lgkmcnt(0)
s_cmp_eq_u32 s21, 0
s_cselect_b64 s[12:13], s[36:37], s[38:39]
s_mov_b32 s16, s12
s_and_b32 s17, s13, 0xffff
s_mov_b32 s18, 5308416
s_mov_b32 s19, 0x20000
s_lshr_b32 s26, s24, 1
s_lshl_b32 s26, s26, 5
s_and_b32 s27, s24, 1
s_lshl_b32 s27, s27, 2
s_add_u32 s26, s26, s27
s_mul_i32 s27, s23, 576
s_add_u32 s26, s26, s27
v_add_u32 v11, s26, v10
v_lshlrev_b32 v11, 1, v11
v_mul_u32_u24 v12, 73728, v7
v_add_u32 v4, v11, v12
s_mul_i32 s27, s24, 7282
s_lshr_b32 s27, s27, 16
s_mul_i32 s28, s27, 9
s_sub_u32 s28, s24, s28
s_add_u32 s29, s28, 1
s_cmp_eq_u32 s29, 9
s_cselect_b32 s29, 0, s29
s_and_b32 s30, s27, 1
s_cmp_eq_u32 s30, 0
s_cselect_b32 s28, s29, s28
s_lshl_b32 s29, s23, 2
s_add_u32 s29, s29, s27
s_mul_i32 s29, s29, 497664
s_mul_i32 s28, s28, 36864
s_add_u32 s29, s29, s28
s_lshl_b32 s21, s21, 11
s_add_u32 s29, s29, s21
s_add_u32 s29, s29, 3366912
s_mov_b32 s40, 0
buffer_load_ushort v16, v4, s[16:19], s40 offen
s_mov_b32 s40, 9216
buffer_load_ushort v17, v4, s[16:19], s40 offen
s_mov_b32 s40, 18432
buffer_load_ushort v18, v4, s[16:19], s40 offen
s_mov_b32 s40, 27648
buffer_load_ushort v19, v4, s[16:19], s40 offen
s_mov_b32 s40, 36864
buffer_load_ushort v20, v4, s[16:19], s40 offen
s_mov_b32 s40, 46080
buffer_load_ushort v21, v4, s[16:19], s40 offen
s_mov_b32 s40, 55296
buffer_load_ushort v22, v4, s[16:19], s40 offen
s_mov_b32 s40, 64512
buffer_load_ushort v23, v4, s[16:19], s40 offen
s_mov_b32 s40, 294912
buffer_load_ushort v24, v4, s[16:19], s40 offen
s_mov_b32 s40, 304128
buffer_load_ushort v25, v4, s[16:19], s40 offen
s_mov_b32 s40, 313344
buffer_load_ushort v26, v4, s[16:19], s40 offen
s_mov_b32 s40, 322560
buffer_load_ushort v27, v4, s[16:19], s40 offen
s_mov_b32 s40, 331776
buffer_load_ushort v28, v4, s[16:19], s40 offen
s_mov_b32 s40, 340992
buffer_load_ushort v29, v4, s[16:19], s40 offen
s_mov_b32 s40, 350208
buffer_load_ushort v30, v4, s[16:19], s40 offen
s_mov_b32 s40, 359424
buffer_load_ushort v31, v4, s[16:19], s40 offen
s_mov_b32 s40, 589824
buffer_load_ushort v32, v4, s[16:19], s40 offen
s_mov_b32 s40, 599040
buffer_load_ushort v33, v4, s[16:19], s40 offen
s_mov_b32 s40, 608256
buffer_load_ushort v34, v4, s[16:19], s40 offen
s_mov_b32 s40, 617472
buffer_load_ushort v35, v4, s[16:19], s40 offen
s_mov_b32 s40, 626688
buffer_load_ushort v36, v4, s[16:19], s40 offen
s_mov_b32 s40, 635904
buffer_load_ushort v37, v4, s[16:19], s40 offen
s_mov_b32 s40, 645120
buffer_load_ushort v38, v4, s[16:19], s40 offen
s_mov_b32 s40, 654336
buffer_load_ushort v39, v4, s[16:19], s40 offen
s_mov_b32 s40, 884736
buffer_load_ushort v40, v4, s[16:19], s40 offen
s_mov_b32 s40, 893952
buffer_load_ushort v41, v4, s[16:19], s40 offen
s_mov_b32 s40, 903168
buffer_load_ushort v42, v4, s[16:19], s40 offen
s_mov_b32 s40, 912384
buffer_load_ushort v43, v4, s[16:19], s40 offen
s_mov_b32 s40, 921600
buffer_load_ushort v44, v4, s[16:19], s40 offen
s_mov_b32 s40, 930816
buffer_load_ushort v45, v4, s[16:19], s40 offen
s_mov_b32 s40, 940032
buffer_load_ushort v46, v4, s[16:19], s40 offen
s_mov_b32 s40, 949248
buffer_load_ushort v47, v4, s[16:19], s40 offen
s_mov_b32 s40, 1179648
buffer_load_ushort v48, v4, s[16:19], s40 offen
s_mov_b32 s40, 1188864
buffer_load_ushort v49, v4, s[16:19], s40 offen
s_mov_b32 s40, 1198080
buffer_load_ushort v50, v4, s[16:19], s40 offen
s_mov_b32 s40, 1207296
buffer_load_ushort v51, v4, s[16:19], s40 offen
s_mov_b32 s40, 1216512
buffer_load_ushort v52, v4, s[16:19], s40 offen
s_mov_b32 s40, 1225728
buffer_load_ushort v53, v4, s[16:19], s40 offen
s_mov_b32 s40, 1234944
buffer_load_ushort v54, v4, s[16:19], s40 offen
s_mov_b32 s40, 1244160
buffer_load_ushort v55, v4, s[16:19], s40 offen
s_mov_b32 s40, 1474560
buffer_load_ushort v56, v4, s[16:19], s40 offen
s_mov_b32 s40, 1483776
buffer_load_ushort v57, v4, s[16:19], s40 offen
s_mov_b32 s40, 1492992
buffer_load_ushort v58, v4, s[16:19], s40 offen
s_mov_b32 s40, 1502208
buffer_load_ushort v59, v4, s[16:19], s40 offen
s_mov_b32 s40, 1511424
buffer_load_ushort v60, v4, s[16:19], s40 offen
s_mov_b32 s40, 1520640
buffer_load_ushort v61, v4, s[16:19], s40 offen
s_mov_b32 s40, 1529856
buffer_load_ushort v62, v4, s[16:19], s40 offen
s_mov_b32 s40, 1539072
buffer_load_ushort v63, v4, s[16:19], s40 offen
s_waitcnt vmcnt(40)
v_lshl_or_b32 v80, v17, 16, v16
v_lshl_or_b32 v81, v19, 16, v18
v_lshl_or_b32 v82, v21, 16, v20
v_lshl_or_b32 v83, v23, 16, v22
s_waitcnt vmcnt(32)
v_lshl_or_b32 v84, v25, 16, v24
v_lshl_or_b32 v85, v27, 16, v26
v_lshl_or_b32 v86, v29, 16, v28
v_lshl_or_b32 v87, v31, 16, v30
s_waitcnt vmcnt(24)
v_lshl_or_b32 v88, v33, 16, v32
v_lshl_or_b32 v89, v35, 16, v34
v_lshl_or_b32 v90, v37, 16, v36
v_lshl_or_b32 v91, v39, 16, v38
s_waitcnt vmcnt(16)
v_lshl_or_b32 v92, v41, 16, v40
v_lshl_or_b32 v93, v43, 16, v42
v_lshl_or_b32 v94, v45, 16, v44
v_lshl_or_b32 v95, v47, 16, v46
s_waitcnt vmcnt(8)
v_lshl_or_b32 v96, v49, 16, v48
v_lshl_or_b32 v97, v51, 16, v50
v_lshl_or_b32 v98, v53, 16, v52
v_lshl_or_b32 v99, v55, 16, v54
s_waitcnt vmcnt(0)
v_lshl_or_b32 v100, v57, 16, v56
v_lshl_or_b32 v101, v59, 16, v58
v_lshl_or_b32 v102, v61, 16, v60
v_lshl_or_b32 v103, v63, 16, v62
s_mov_b32 s40, 1769472
buffer_load_ushort v16, v4, s[16:19], s40 offen
s_mov_b32 s40, 1778688
buffer_load_ushort v17, v4, s[16:19], s40 offen
s_mov_b32 s40, 1787904
buffer_load_ushort v18, v4, s[16:19], s40 offen
s_mov_b32 s40, 1797120
buffer_load_ushort v19, v4, s[16:19], s40 offen
s_mov_b32 s40, 1806336
buffer_load_ushort v20, v4, s[16:19], s40 offen
s_mov_b32 s40, 1815552
buffer_load_ushort v21, v4, s[16:19], s40 offen
s_mov_b32 s40, 1824768
buffer_load_ushort v22, v4, s[16:19], s40 offen
s_mov_b32 s40, 1833984
buffer_load_ushort v23, v4, s[16:19], s40 offen
s_mov_b32 s40, 2064384
buffer_load_ushort v24, v4, s[16:19], s40 offen
s_mov_b32 s40, 2073600
buffer_load_ushort v25, v4, s[16:19], s40 offen
s_mov_b32 s40, 2082816
buffer_load_ushort v26, v4, s[16:19], s40 offen
s_mov_b32 s40, 2092032
buffer_load_ushort v27, v4, s[16:19], s40 offen
s_mov_b32 s40, 2101248
buffer_load_ushort v28, v4, s[16:19], s40 offen
s_mov_b32 s40, 2110464
buffer_load_ushort v29, v4, s[16:19], s40 offen
s_mov_b32 s40, 2119680
buffer_load_ushort v30, v4, s[16:19], s40 offen
s_mov_b32 s40, 2128896
buffer_load_ushort v31, v4, s[16:19], s40 offen
s_mov_b32 s40, 2359296
buffer_load_ushort v32, v4, s[16:19], s40 offen
s_mov_b32 s40, 2368512
buffer_load_ushort v33, v4, s[16:19], s40 offen
s_mov_b32 s40, 2377728
buffer_load_ushort v34, v4, s[16:19], s40 offen
s_mov_b32 s40, 2386944
buffer_load_ushort v35, v4, s[16:19], s40 offen
s_mov_b32 s40, 2396160
buffer_load_ushort v36, v4, s[16:19], s40 offen
s_mov_b32 s40, 2405376
buffer_load_ushort v37, v4, s[16:19], s40 offen
s_mov_b32 s40, 2414592
buffer_load_ushort v38, v4, s[16:19], s40 offen
s_mov_b32 s40, 2423808
buffer_load_ushort v39, v4, s[16:19], s40 offen
s_mov_b32 s40, 2654208
buffer_load_ushort v40, v4, s[16:19], s40 offen
s_mov_b32 s40, 2663424
buffer_load_ushort v41, v4, s[16:19], s40 offen
s_mov_b32 s40, 2672640
buffer_load_ushort v42, v4, s[16:19], s40 offen
s_mov_b32 s40, 2681856
buffer_load_ushort v43, v4, s[16:19], s40 offen
s_mov_b32 s40, 2691072
buffer_load_ushort v44, v4, s[16:19], s40 offen
s_mov_b32 s40, 2700288
buffer_load_ushort v45, v4, s[16:19], s40 offen
s_mov_b32 s40, 2709504
buffer_load_ushort v46, v4, s[16:19], s40 offen
s_mov_b32 s40, 2718720
buffer_load_ushort v47, v4, s[16:19], s40 offen
s_mov_b32 s40, 2949120
buffer_load_ushort v48, v4, s[16:19], s40 offen
s_mov_b32 s40, 2958336
buffer_load_ushort v49, v4, s[16:19], s40 offen
s_mov_b32 s40, 2967552
buffer_load_ushort v50, v4, s[16:19], s40 offen
s_mov_b32 s40, 2976768
buffer_load_ushort v51, v4, s[16:19], s40 offen
s_mov_b32 s40, 2985984
buffer_load_ushort v52, v4, s[16:19], s40 offen
s_mov_b32 s40, 2995200
buffer_load_ushort v53, v4, s[16:19], s40 offen
s_mov_b32 s40, 3004416
buffer_load_ushort v54, v4, s[16:19], s40 offen
s_mov_b32 s40, 3013632
buffer_load_ushort v55, v4, s[16:19], s40 offen
s_mov_b32 s40, 3244032
buffer_load_ushort v56, v4, s[16:19], s40 offen
s_mov_b32 s40, 3253248
buffer_load_ushort v57, v4, s[16:19], s40 offen
s_mov_b32 s40, 3262464
buffer_load_ushort v58, v4, s[16:19], s40 offen
s_mov_b32 s40, 3271680
buffer_load_ushort v59, v4, s[16:19], s40 offen
s_mov_b32 s40, 3280896
buffer_load_ushort v60, v4, s[16:19], s40 offen
s_mov_b32 s40, 3290112
buffer_load_ushort v61, v4, s[16:19], s40 offen
s_mov_b32 s40, 3299328
buffer_load_ushort v62, v4, s[16:19], s40 offen
s_mov_b32 s40, 3308544
buffer_load_ushort v63, v4, s[16:19], s40 offen
s_waitcnt vmcnt(40)
v_lshl_or_b32 v104, v17, 16, v16
v_lshl_or_b32 v105, v19, 16, v18
v_lshl_or_b32 v106, v21, 16, v20
v_lshl_or_b32 v107, v23, 16, v22
s_waitcnt vmcnt(32)
v_lshl_or_b32 v108, v25, 16, v24
v_lshl_or_b32 v109, v27, 16, v26
v_lshl_or_b32 v110, v29, 16, v28
v_lshl_or_b32 v111, v31, 16, v30
s_waitcnt vmcnt(24)
v_lshl_or_b32 v112, v33, 16, v32
v_lshl_or_b32 v113, v35, 16, v34
v_lshl_or_b32 v114, v37, 16, v36
v_lshl_or_b32 v115, v39, 16, v38
s_waitcnt vmcnt(16)
v_lshl_or_b32 v116, v41, 16, v40
v_lshl_or_b32 v117, v43, 16, v42
v_lshl_or_b32 v118, v45, 16, v44
v_lshl_or_b32 v119, v47, 16, v46
s_waitcnt vmcnt(8)
v_lshl_or_b32 v120, v49, 16, v48
v_lshl_or_b32 v121, v51, 16, v50
v_lshl_or_b32 v122, v53, 16, v52
v_lshl_or_b32 v123, v55, 16, v54
s_waitcnt vmcnt(0)
v_lshl_or_b32 v124, v57, 16, v56
v_lshl_or_b32 v125, v59, 16, v58
v_lshl_or_b32 v126, v61, 16, v60
v_lshl_or_b32 v127, v63, 16, v62
s_mov_b32 s40, 3538944
buffer_load_ushort v16, v4, s[16:19], s40 offen
s_mov_b32 s40, 3548160
buffer_load_ushort v17, v4, s[16:19], s40 offen
s_mov_b32 s40, 3557376
buffer_load_ushort v18, v4, s[16:19], s40 offen
s_mov_b32 s40, 3566592
buffer_load_ushort v19, v4, s[16:19], s40 offen
s_mov_b32 s40, 3575808
buffer_load_ushort v20, v4, s[16:19], s40 offen
s_mov_b32 s40, 3585024
buffer_load_ushort v21, v4, s[16:19], s40 offen
s_mov_b32 s40, 3594240
buffer_load_ushort v22, v4, s[16:19], s40 offen
s_mov_b32 s40, 3603456
buffer_load_ushort v23, v4, s[16:19], s40 offen
s_mov_b32 s40, 3833856
buffer_load_ushort v24, v4, s[16:19], s40 offen
s_mov_b32 s40, 3843072
buffer_load_ushort v25, v4, s[16:19], s40 offen
s_mov_b32 s40, 3852288
buffer_load_ushort v26, v4, s[16:19], s40 offen
s_mov_b32 s40, 3861504
buffer_load_ushort v27, v4, s[16:19], s40 offen
s_mov_b32 s40, 3870720
buffer_load_ushort v28, v4, s[16:19], s40 offen
s_mov_b32 s40, 3879936
buffer_load_ushort v29, v4, s[16:19], s40 offen
s_mov_b32 s40, 3889152
buffer_load_ushort v30, v4, s[16:19], s40 offen
s_mov_b32 s40, 3898368
buffer_load_ushort v31, v4, s[16:19], s40 offen
s_mov_b32 s40, 4128768
buffer_load_ushort v32, v4, s[16:19], s40 offen
s_mov_b32 s40, 4137984
buffer_load_ushort v33, v4, s[16:19], s40 offen
s_mov_b32 s40, 4147200
buffer_load_ushort v34, v4, s[16:19], s40 offen
s_mov_b32 s40, 4156416
buffer_load_ushort v35, v4, s[16:19], s40 offen
s_mov_b32 s40, 4165632
buffer_load_ushort v36, v4, s[16:19], s40 offen
s_mov_b32 s40, 4174848
buffer_load_ushort v37, v4, s[16:19], s40 offen
s_mov_b32 s40, 4184064
buffer_load_ushort v38, v4, s[16:19], s40 offen
s_mov_b32 s40, 4193280
buffer_load_ushort v39, v4, s[16:19], s40 offen
s_mov_b32 s40, 4423680
buffer_load_ushort v40, v4, s[16:19], s40 offen
s_mov_b32 s40, 4432896
buffer_load_ushort v41, v4, s[16:19], s40 offen
s_mov_b32 s40, 4442112
buffer_load_ushort v42, v4, s[16:19], s40 offen
s_mov_b32 s40, 4451328
buffer_load_ushort v43, v4, s[16:19], s40 offen
s_mov_b32 s40, 4460544
buffer_load_ushort v44, v4, s[16:19], s40 offen
s_mov_b32 s40, 4469760
buffer_load_ushort v45, v4, s[16:19], s40 offen
s_mov_b32 s40, 4478976
buffer_load_ushort v46, v4, s[16:19], s40 offen
s_mov_b32 s40, 4488192
buffer_load_ushort v47, v4, s[16:19], s40 offen
s_mov_b32 s40, 4718592
buffer_load_ushort v48, v4, s[16:19], s40 offen
s_mov_b32 s40, 4727808
buffer_load_ushort v49, v4, s[16:19], s40 offen
s_mov_b32 s40, 4737024
buffer_load_ushort v50, v4, s[16:19], s40 offen
s_mov_b32 s40, 4746240
buffer_load_ushort v51, v4, s[16:19], s40 offen
s_mov_b32 s40, 4755456
buffer_load_ushort v52, v4, s[16:19], s40 offen
s_mov_b32 s40, 4764672
buffer_load_ushort v53, v4, s[16:19], s40 offen
s_mov_b32 s40, 4773888
buffer_load_ushort v54, v4, s[16:19], s40 offen
s_mov_b32 s40, 4783104
buffer_load_ushort v55, v4, s[16:19], s40 offen
s_mov_b32 s40, 5013504
buffer_load_ushort v56, v4, s[16:19], s40 offen
s_mov_b32 s40, 5022720
buffer_load_ushort v57, v4, s[16:19], s40 offen
s_mov_b32 s40, 5031936
buffer_load_ushort v58, v4, s[16:19], s40 offen
s_mov_b32 s40, 5041152
buffer_load_ushort v59, v4, s[16:19], s40 offen
s_mov_b32 s40, 5050368
buffer_load_ushort v60, v4, s[16:19], s40 offen
s_mov_b32 s40, 5059584
buffer_load_ushort v61, v4, s[16:19], s40 offen
s_mov_b32 s40, 5068800
buffer_load_ushort v62, v4, s[16:19], s40 offen
s_mov_b32 s40, 5078016
buffer_load_ushort v63, v4, s[16:19], s40 offen
s_waitcnt vmcnt(40)
v_lshl_or_b32 v128, v17, 16, v16
v_lshl_or_b32 v129, v19, 16, v18
v_lshl_or_b32 v130, v21, 16, v20
v_lshl_or_b32 v131, v23, 16, v22
s_waitcnt vmcnt(32)
v_lshl_or_b32 v132, v25, 16, v24
v_lshl_or_b32 v133, v27, 16, v26
v_lshl_or_b32 v134, v29, 16, v28
v_lshl_or_b32 v135, v31, 16, v30
s_waitcnt vmcnt(24)
v_lshl_or_b32 v136, v33, 16, v32
v_lshl_or_b32 v137, v35, 16, v34
v_lshl_or_b32 v138, v37, 16, v36
v_lshl_or_b32 v139, v39, 16, v38
s_waitcnt vmcnt(16)
v_lshl_or_b32 v140, v41, 16, v40
v_lshl_or_b32 v141, v43, 16, v42
v_lshl_or_b32 v142, v45, 16, v44
v_lshl_or_b32 v143, v47, 16, v46
s_waitcnt vmcnt(8)
v_lshl_or_b32 v144, v49, 16, v48
v_lshl_or_b32 v145, v51, 16, v50
v_lshl_or_b32 v146, v53, 16, v52
v_lshl_or_b32 v147, v55, 16, v54
s_waitcnt vmcnt(0)
v_lshl_or_b32 v148, v57, 16, v56
v_lshl_or_b32 v149, v59, 16, v58
v_lshl_or_b32 v150, v61, 16, v60
v_lshl_or_b32 v151, v63, 16, v62
s_mov_b32 s31, 0x3f803f80
v_mov_b32 v12, 0
v_mov_b32 v13, 0
v_dot2_f32_bf16 v12, v80, s31, v12
v_dot2_f32_bf16 v13, v81, s31, v13
v_dot2_f32_bf16 v12, v82, s31, v12
v_dot2_f32_bf16 v13, v83, s31, v13
v_dot2_f32_bf16 v12, v84, s31, v12
v_dot2_f32_bf16 v13, v85, s31, v13
v_dot2_f32_bf16 v12, v86, s31, v12
v_dot2_f32_bf16 v13, v87, s31, v13
v_dot2_f32_bf16 v12, v88, s31, v12
v_dot2_f32_bf16 v13, v89, s31, v13
v_dot2_f32_bf16 v12, v90, s31, v12
v_dot2_f32_bf16 v13, v91, s31, v13
v_dot2_f32_bf16 v12, v92, s31, v12
v_dot2_f32_bf16 v13, v93, s31, v13
v_dot2_f32_bf16 v12, v94, s31, v12
v_dot2_f32_bf16 v13, v95, s31, v13
v_dot2_f32_bf16 v12, v96, s31, v12
v_dot2_f32_bf16 v13, v97, s31, v13
v_dot2_f32_bf16 v12, v98, s31, v12
v_dot2_f32_bf16 v13, v99, s31, v13
v_dot2_f32_bf16 v12, v100, s31, v12
v_dot2_f32_bf16 v13, v101, s31, v13
v_dot2_f32_bf16 v12, v102, s31, v12
v_dot2_f32_bf16 v13, v103, s31, v13
v_dot2_f32_bf16 v12, v104, s31, v12
v_dot2_f32_bf16 v13, v105, s31, v13
v_dot2_f32_bf16 v12, v106, s31, v12
v_dot2_f32_bf16 v13, v107, s31, v13
v_dot2_f32_bf16 v12, v108, s31, v12
v_dot2_f32_bf16 v13, v109, s31, v13
v_dot2_f32_bf16 v12, v110, s31, v12
v_dot2_f32_bf16 v13, v111, s31, v13
v_dot2_f32_bf16 v12, v112, s31, v12
v_dot2_f32_bf16 v13, v113, s31, v13
v_dot2_f32_bf16 v12, v114, s31, v12
v_dot2_f32_bf16 v13, v115, s31, v13
v_dot2_f32_bf16 v12, v116, s31, v12
v_dot2_f32_bf16 v13, v117, s31, v13
v_dot2_f32_bf16 v12, v118, s31, v12
v_dot2_f32_bf16 v13, v119, s31, v13
v_dot2_f32_bf16 v12, v120, s31, v12
v_dot2_f32_bf16 v13, v121, s31, v13
v_dot2_f32_bf16 v12, v122, s31, v12
v_dot2_f32_bf16 v13, v123, s31, v13
v_dot2_f32_bf16 v12, v124, s31, v12
v_dot2_f32_bf16 v13, v125, s31, v13
v_dot2_f32_bf16 v12, v126, s31, v12
v_dot2_f32_bf16 v13, v127, s31, v13
v_dot2_f32_bf16 v12, v128, s31, v12
v_dot2_f32_bf16 v13, v129, s31, v13
v_dot2_f32_bf16 v12, v130, s31, v12
v_dot2_f32_bf16 v13, v131, s31, v13
v_dot2_f32_bf16 v12, v132, s31, v12
v_dot2_f32_bf16 v13, v133, s31, v13
v_dot2_f32_bf16 v12, v134, s31, v12
v_dot2_f32_bf16 v13, v135, s31, v13
v_dot2_f32_bf16 v12, v136, s31, v12
v_dot2_f32_bf16 v13, v137, s31, v13
v_dot2_f32_bf16 v12, v138, s31, v12
v_dot2_f32_bf16 v13, v139, s31, v13
v_dot2_f32_bf16 v12, v140, s31, v12
v_dot2_f32_bf16 v13, v141, s31, v13
v_dot2_f32_bf16 v12, v142, s31, v12
v_dot2_f32_bf16 v13, v143, s31, v13
v_dot2_f32_bf16 v12, v144, s31, v12
v_dot2_f32_bf16 v13, v145, s31, v13
v_dot2_f32_bf16 v12, v146, s31, v12
v_dot2_f32_bf16 v13, v147, s31, v13
v_dot2_f32_bf16 v12, v148, s31, v12
v_dot2_f32_bf16 v13, v149, s31, v13
v_dot2_f32_bf16 v12, v150, s31, v12
v_dot2_f32_bf16 v13, v151, s31, v13
s_nop 2
v_add_f32 v12, v12, v13
v_mov_b32 v13, v12
s_nop 1
v_permlane16_swap_b32 v12, v13
v_add_f32 v12, v12, v13
v_mov_b32 v13, v12
s_nop 1
v_permlane32_swap_b32 v12, v13
v_add_f32 v12, v12, v13
v_mul_f32 v12, 0x3ae38e39, v12
v_lshlrev_b32 v16, 16, v80
v_and_b32 v17, 0xffff0000, v80
v_sub_f32 v16, v16, v12
v_sub_f32 v17, v17, v12
v_cvt_pk_bf16_f32 v80, v16, v17
v_lshlrev_b32 v18, 16, v81
v_and_b32 v19, 0xffff0000, v81
v_sub_f32 v18, v18, v12
v_sub_f32 v19, v19, v12
v_cvt_pk_bf16_f32 v81, v18, v19
v_lshlrev_b32 v20, 16, v82
v_and_b32 v21, 0xffff0000, v82
v_sub_f32 v20, v20, v12
v_sub_f32 v21, v21, v12
v_cvt_pk_bf16_f32 v82, v20, v21
v_lshlrev_b32 v22, 16, v83
v_and_b32 v23, 0xffff0000, v83
v_sub_f32 v22, v22, v12
v_sub_f32 v23, v23, v12
v_cvt_pk_bf16_f32 v83, v22, v23
v_lshlrev_b32 v16, 16, v84
v_and_b32 v17, 0xffff0000, v84
v_sub_f32 v16, v16, v12
v_sub_f32 v17, v17, v12
v_cvt_pk_bf16_f32 v84, v16, v17
v_lshlrev_b32 v18, 16, v85
v_and_b32 v19, 0xffff0000, v85
v_sub_f32 v18, v18, v12
v_sub_f32 v19, v19, v12
v_cvt_pk_bf16_f32 v85, v18, v19
v_lshlrev_b32 v20, 16, v86
v_and_b32 v21, 0xffff0000, v86
v_sub_f32 v20, v20, v12
v_sub_f32 v21, v21, v12
v_cvt_pk_bf16_f32 v86, v20, v21
v_lshlrev_b32 v22, 16, v87
v_and_b32 v23, 0xffff0000, v87
v_sub_f32 v22, v22, v12
v_sub_f32 v23, v23, v12
v_cvt_pk_bf16_f32 v87, v22, v23
v_lshlrev_b32 v16, 16, v88
v_and_b32 v17, 0xffff0000, v88
v_sub_f32 v16, v16, v12
v_sub_f32 v17, v17, v12
v_cvt_pk_bf16_f32 v88, v16, v17
v_lshlrev_b32 v18, 16, v89
v_and_b32 v19, 0xffff0000, v89
v_sub_f32 v18, v18, v12
v_sub_f32 v19, v19, v12
v_cvt_pk_bf16_f32 v89, v18, v19
v_lshlrev_b32 v20, 16, v90
v_and_b32 v21, 0xffff0000, v90
v_sub_f32 v20, v20, v12
v_sub_f32 v21, v21, v12
v_cvt_pk_bf16_f32 v90, v20, v21
v_lshlrev_b32 v22, 16, v91
v_and_b32 v23, 0xffff0000, v91
v_sub_f32 v22, v22, v12
v_sub_f32 v23, v23, v12
v_cvt_pk_bf16_f32 v91, v22, v23
v_lshlrev_b32 v16, 16, v92
v_and_b32 v17, 0xffff0000, v92
v_sub_f32 v16, v16, v12
v_sub_f32 v17, v17, v12
v_cvt_pk_bf16_f32 v92, v16, v17
v_lshlrev_b32 v18, 16, v93
v_and_b32 v19, 0xffff0000, v93
v_sub_f32 v18, v18, v12
v_sub_f32 v19, v19, v12
v_cvt_pk_bf16_f32 v93, v18, v19
v_lshlrev_b32 v20, 16, v94
v_and_b32 v21, 0xffff0000, v94
v_sub_f32 v20, v20, v12
v_sub_f32 v21, v21, v12
v_cvt_pk_bf16_f32 v94, v20, v21
v_lshlrev_b32 v22, 16, v95
v_and_b32 v23, 0xffff0000, v95
v_sub_f32 v22, v22, v12
v_sub_f32 v23, v23, v12
v_cvt_pk_bf16_f32 v95, v22, v23
v_lshlrev_b32 v16, 16, v96
v_and_b32 v17, 0xffff0000, v96
v_sub_f32 v16, v16, v12
v_sub_f32 v17, v17, v12
v_cvt_pk_bf16_f32 v96, v16, v17
v_lshlrev_b32 v18, 16, v97
v_and_b32 v19, 0xffff0000, v97
v_sub_f32 v18, v18, v12
v_sub_f32 v19, v19, v12
v_cvt_pk_bf16_f32 v97, v18, v19
v_lshlrev_b32 v20, 16, v98
v_and_b32 v21, 0xffff0000, v98
v_sub_f32 v20, v20, v12
v_sub_f32 v21, v21, v12
v_cvt_pk_bf16_f32 v98, v20, v21
v_lshlrev_b32 v22, 16, v99
v_and_b32 v23, 0xffff0000, v99
v_sub_f32 v22, v22, v12
v_sub_f32 v23, v23, v12
v_cvt_pk_bf16_f32 v99, v22, v23
v_lshlrev_b32 v16, 16, v100
v_and_b32 v17, 0xffff0000, v100
v_sub_f32 v16, v16, v12
v_sub_f32 v17, v17, v12
v_cvt_pk_bf16_f32 v100, v16, v17
v_lshlrev_b32 v18, 16, v101
v_and_b32 v19, 0xffff0000, v101
v_sub_f32 v18, v18, v12
v_sub_f32 v19, v19, v12
v_cvt_pk_bf16_f32 v101, v18, v19
v_lshlrev_b32 v20, 16, v102
v_and_b32 v21, 0xffff0000, v102
v_sub_f32 v20, v20, v12
v_sub_f32 v21, v21, v12
v_cvt_pk_bf16_f32 v102, v20, v21
v_lshlrev_b32 v22, 16, v103
v_and_b32 v23, 0xffff0000, v103
v_sub_f32 v22, v22, v12
v_sub_f32 v23, v23, v12
v_cvt_pk_bf16_f32 v103, v22, v23
v_lshlrev_b32 v16, 16, v104
v_and_b32 v17, 0xffff0000, v104
v_sub_f32 v16, v16, v12
v_sub_f32 v17, v17, v12
v_cvt_pk_bf16_f32 v104, v16, v17
v_lshlrev_b32 v18, 16, v105
v_and_b32 v19, 0xffff0000, v105
v_sub_f32 v18, v18, v12
v_sub_f32 v19, v19, v12
v_cvt_pk_bf16_f32 v105, v18, v19
v_lshlrev_b32 v20, 16, v106
v_and_b32 v21, 0xffff0000, v106
v_sub_f32 v20, v20, v12
v_sub_f32 v21, v21, v12
v_cvt_pk_bf16_f32 v106, v20, v21
v_lshlrev_b32 v22, 16, v107
v_and_b32 v23, 0xffff0000, v107
v_sub_f32 v22, v22, v12
v_sub_f32 v23, v23, v12
v_cvt_pk_bf16_f32 v107, v22, v23
v_lshlrev_b32 v16, 16, v108
v_and_b32 v17, 0xffff0000, v108
v_sub_f32 v16, v16, v12
v_sub_f32 v17, v17, v12
v_cvt_pk_bf16_f32 v108, v16, v17
v_lshlrev_b32 v18, 16, v109
v_and_b32 v19, 0xffff0000, v109
v_sub_f32 v18, v18, v12
v_sub_f32 v19, v19, v12
v_cvt_pk_bf16_f32 v109, v18, v19
v_lshlrev_b32 v20, 16, v110
v_and_b32 v21, 0xffff0000, v110
v_sub_f32 v20, v20, v12
v_sub_f32 v21, v21, v12
v_cvt_pk_bf16_f32 v110, v20, v21
v_lshlrev_b32 v22, 16, v111
v_and_b32 v23, 0xffff0000, v111
v_sub_f32 v22, v22, v12
v_sub_f32 v23, v23, v12
v_cvt_pk_bf16_f32 v111, v22, v23
v_lshlrev_b32 v16, 16, v112
v_and_b32 v17, 0xffff0000, v112
v_sub_f32 v16, v16, v12
v_sub_f32 v17, v17, v12
v_cvt_pk_bf16_f32 v112, v16, v17
v_lshlrev_b32 v18, 16, v113
v_and_b32 v19, 0xffff0000, v113
v_sub_f32 v18, v18, v12
v_sub_f32 v19, v19, v12
v_cvt_pk_bf16_f32 v113, v18, v19
v_lshlrev_b32 v20, 16, v114
v_and_b32 v21, 0xffff0000, v114
v_sub_f32 v20, v20, v12
v_sub_f32 v21, v21, v12
v_cvt_pk_bf16_f32 v114, v20, v21
v_lshlrev_b32 v22, 16, v115
v_and_b32 v23, 0xffff0000, v115
v_sub_f32 v22, v22, v12
v_sub_f32 v23, v23, v12
v_cvt_pk_bf16_f32 v115, v22, v23
v_lshlrev_b32 v16, 16, v116
v_and_b32 v17, 0xffff0000, v116
v_sub_f32 v16, v16, v12
v_sub_f32 v17, v17, v12
v_cvt_pk_bf16_f32 v116, v16, v17
v_lshlrev_b32 v18, 16, v117
v_and_b32 v19, 0xffff0000, v117
v_sub_f32 v18, v18, v12
v_sub_f32 v19, v19, v12
v_cvt_pk_bf16_f32 v117, v18, v19
v_lshlrev_b32 v20, 16, v118
v_and_b32 v21, 0xffff0000, v118
v_sub_f32 v20, v20, v12
v_sub_f32 v21, v21, v12
v_cvt_pk_bf16_f32 v118, v20, v21
v_lshlrev_b32 v22, 16, v119
v_and_b32 v23, 0xffff0000, v119
v_sub_f32 v22, v22, v12
v_sub_f32 v23, v23, v12
v_cvt_pk_bf16_f32 v119, v22, v23
v_lshlrev_b32 v16, 16, v120
v_and_b32 v17, 0xffff0000, v120
v_sub_f32 v16, v16, v12
v_sub_f32 v17, v17, v12
v_cvt_pk_bf16_f32 v120, v16, v17
v_lshlrev_b32 v18, 16, v121
v_and_b32 v19, 0xffff0000, v121
v_sub_f32 v18, v18, v12
v_sub_f32 v19, v19, v12
v_cvt_pk_bf16_f32 v121, v18, v19
v_lshlrev_b32 v20, 16, v122
v_and_b32 v21, 0xffff0000, v122
v_sub_f32 v20, v20, v12
v_sub_f32 v21, v21, v12
v_cvt_pk_bf16_f32 v122, v20, v21
v_lshlrev_b32 v22, 16, v123
v_and_b32 v23, 0xffff0000, v123
v_sub_f32 v22, v22, v12
v_sub_f32 v23, v23, v12
v_cvt_pk_bf16_f32 v123, v22, v23
v_lshlrev_b32 v16, 16, v124
v_and_b32 v17, 0xffff0000, v124
v_sub_f32 v16, v16, v12
v_sub_f32 v17, v17, v12
v_cvt_pk_bf16_f32 v124, v16, v17
v_lshlrev_b32 v18, 16, v125
v_and_b32 v19, 0xffff0000, v125
v_sub_f32 v18, v18, v12
v_sub_f32 v19, v19, v12
v_cvt_pk_bf16_f32 v125, v18, v19
v_lshlrev_b32 v20, 16, v126
v_and_b32 v21, 0xffff0000, v126
v_sub_f32 v20, v20, v12
v_sub_f32 v21, v21, v12
v_cvt_pk_bf16_f32 v126, v20, v21
v_lshlrev_b32 v22, 16, v127
v_and_b32 v23, 0xffff0000, v127
v_sub_f32 v22, v22, v12
v_sub_f32 v23, v23, v12
v_cvt_pk_bf16_f32 v127, v22, v23
v_lshlrev_b32 v16, 16, v128
v_and_b32 v17, 0xffff0000, v128
v_sub_f32 v16, v16, v12
v_sub_f32 v17, v17, v12
v_cvt_pk_bf16_f32 v128, v16, v17
v_lshlrev_b32 v18, 16, v129
v_and_b32 v19, 0xffff0000, v129
v_sub_f32 v18, v18, v12
v_sub_f32 v19, v19, v12
v_cvt_pk_bf16_f32 v129, v18, v19
v_lshlrev_b32 v20, 16, v130
v_and_b32 v21, 0xffff0000, v130
v_sub_f32 v20, v20, v12
v_sub_f32 v21, v21, v12
v_cvt_pk_bf16_f32 v130, v20, v21
v_lshlrev_b32 v22, 16, v131
v_and_b32 v23, 0xffff0000, v131
v_sub_f32 v22, v22, v12
v_sub_f32 v23, v23, v12
v_cvt_pk_bf16_f32 v131, v22, v23
v_lshlrev_b32 v16, 16, v132
v_and_b32 v17, 0xffff0000, v132
v_sub_f32 v16, v16, v12
v_sub_f32 v17, v17, v12
v_cvt_pk_bf16_f32 v132, v16, v17
v_lshlrev_b32 v18, 16, v133
v_and_b32 v19, 0xffff0000, v133
v_sub_f32 v18, v18, v12
v_sub_f32 v19, v19, v12
v_cvt_pk_bf16_f32 v133, v18, v19
v_lshlrev_b32 v20, 16, v134
v_and_b32 v21, 0xffff0000, v134
v_sub_f32 v20, v20, v12
v_sub_f32 v21, v21, v12
v_cvt_pk_bf16_f32 v134, v20, v21
v_lshlrev_b32 v22, 16, v135
v_and_b32 v23, 0xffff0000, v135
v_sub_f32 v22, v22, v12
v_sub_f32 v23, v23, v12
v_cvt_pk_bf16_f32 v135, v22, v23
v_lshlrev_b32 v16, 16, v136
v_and_b32 v17, 0xffff0000, v136
v_sub_f32 v16, v16, v12
v_sub_f32 v17, v17, v12
v_cvt_pk_bf16_f32 v136, v16, v17
v_lshlrev_b32 v18, 16, v137
v_and_b32 v19, 0xffff0000, v137
v_sub_f32 v18, v18, v12
v_sub_f32 v19, v19, v12
v_cvt_pk_bf16_f32 v137, v18, v19
v_lshlrev_b32 v20, 16, v138
v_and_b32 v21, 0xffff0000, v138
v_sub_f32 v20, v20, v12
v_sub_f32 v21, v21, v12
v_cvt_pk_bf16_f32 v138, v20, v21
v_lshlrev_b32 v22, 16, v139
v_and_b32 v23, 0xffff0000, v139
v_sub_f32 v22, v22, v12
v_sub_f32 v23, v23, v12
v_cvt_pk_bf16_f32 v139, v22, v23
v_lshlrev_b32 v16, 16, v140
v_and_b32 v17, 0xffff0000, v140
v_sub_f32 v16, v16, v12
v_sub_f32 v17, v17, v12
v_cvt_pk_bf16_f32 v140, v16, v17
v_lshlrev_b32 v18, 16, v141
v_and_b32 v19, 0xffff0000, v141
v_sub_f32 v18, v18, v12
v_sub_f32 v19, v19, v12
v_cvt_pk_bf16_f32 v141, v18, v19
v_lshlrev_b32 v20, 16, v142
v_and_b32 v21, 0xffff0000, v142
v_sub_f32 v20, v20, v12
v_sub_f32 v21, v21, v12
v_cvt_pk_bf16_f32 v142, v20, v21
v_lshlrev_b32 v22, 16, v143
v_and_b32 v23, 0xffff0000, v143
v_sub_f32 v22, v22, v12
v_sub_f32 v23, v23, v12
v_cvt_pk_bf16_f32 v143, v22, v23
v_lshlrev_b32 v16, 16, v144
v_and_b32 v17, 0xffff0000, v144
v_sub_f32 v16, v16, v12
v_sub_f32 v17, v17, v12
v_cvt_pk_bf16_f32 v144, v16, v17
v_lshlrev_b32 v18, 16, v145
v_and_b32 v19, 0xffff0000, v145
v_sub_f32 v18, v18, v12
v_sub_f32 v19, v19, v12
v_cvt_pk_bf16_f32 v145, v18, v19
v_lshlrev_b32 v20, 16, v146
v_and_b32 v21, 0xffff0000, v146
v_sub_f32 v20, v20, v12
v_sub_f32 v21, v21, v12
v_cvt_pk_bf16_f32 v146, v20, v21
v_lshlrev_b32 v22, 16, v147
v_and_b32 v23, 0xffff0000, v147
v_sub_f32 v22, v22, v12
v_sub_f32 v23, v23, v12
v_cvt_pk_bf16_f32 v147, v22, v23
v_lshlrev_b32 v16, 16, v148
v_and_b32 v17, 0xffff0000, v148
v_sub_f32 v16, v16, v12
v_sub_f32 v17, v17, v12
v_cvt_pk_bf16_f32 v148, v16, v17
v_lshlrev_b32 v18, 16, v149
v_and_b32 v19, 0xffff0000, v149
v_sub_f32 v18, v18, v12
v_sub_f32 v19, v19, v12
v_cvt_pk_bf16_f32 v149, v18, v19
v_lshlrev_b32 v20, 16, v150
v_and_b32 v21, 0xffff0000, v150
v_sub_f32 v20, v20, v12
v_sub_f32 v21, v21, v12
v_cvt_pk_bf16_f32 v150, v20, v21
v_lshlrev_b32 v22, 16, v151
v_and_b32 v23, 0xffff0000, v151
v_sub_f32 v22, v22, v12
v_sub_f32 v23, v23, v12
v_cvt_pk_bf16_f32 v151, v22, v23
s_add_u32 s40, s29, 0
buffer_store_dwordx4 v[80:83], v2, s[8:11], s40 offen
s_add_u32 s40, s29, 1024
buffer_store_dwordx4 v[84:87], v2, s[8:11], s40 offen
s_add_u32 s40, s29, 4096
buffer_store_dwordx4 v[88:91], v2, s[8:11], s40 offen
s_add_u32 s40, s29, 5120
buffer_store_dwordx4 v[92:95], v2, s[8:11], s40 offen
s_add_u32 s40, s29, 8192
buffer_store_dwordx4 v[96:99], v2, s[8:11], s40 offen
s_add_u32 s40, s29, 9216
buffer_store_dwordx4 v[100:103], v2, s[8:11], s40 offen
s_add_u32 s40, s29, 12288
buffer_store_dwordx4 v[104:107], v2, s[8:11], s40 offen
s_add_u32 s40, s29, 13312
buffer_store_dwordx4 v[108:111], v2, s[8:11], s40 offen
s_add_u32 s40, s29, 16384
buffer_store_dwordx4 v[112:115], v2, s[8:11], s40 offen
s_add_u32 s40, s29, 17408
buffer_store_dwordx4 v[116:119], v2, s[8:11], s40 offen
s_add_u32 s40, s29, 20480
buffer_store_dwordx4 v[120:123], v2, s[8:11], s40 offen
s_add_u32 s40, s29, 21504
buffer_store_dwordx4 v[124:127], v2, s[8:11], s40 offen
s_add_u32 s40, s29, 24576
buffer_store_dwordx4 v[128:131], v2, s[8:11], s40 offen
s_add_u32 s40, s29, 25600
buffer_store_dwordx4 v[132:135], v2, s[8:11], s40 offen
s_add_u32 s40, s29, 28672
buffer_store_dwordx4 v[136:139], v2, s[8:11], s40 offen
s_add_u32 s40, s29, 29696
buffer_store_dwordx4 v[140:143], v2, s[8:11], s40 offen
s_add_u32 s40, s29, 32768
buffer_store_dwordx4 v[144:147], v2, s[8:11], s40 offen
s_add_u32 s40, s29, 33792
buffer_store_dwordx4 v[148:151], v2, s[8:11], s40 offen
s_branch L_prep_end
L_pack_d:
s_sub_u32 s20, s20, 576
s_mul_i32 s21, s20, 7282
s_lshr_b32 s21, s21, 16
s_mul_i32 s22, s21, 9
s_sub_u32 s22, s20, s22
s_lshr_b32 s23, s21, 2
s_and_b32 s24, s21, 3
s_load_dwordx2 s[12:13], s[0:1], 48
s_waitcnt lgkmcnt(0)
s_mov_b32 s16, s12
s_and_b32 s17, s13, 0xffff
s_mov_b32 s18, 5308416
s_mov_b32 s19, 0x20000
s_lshr_b32 s25, s22, 1
s_lshl_b32 s25, s25, 5
s_and_b32 s26, s22, 1
s_lshl_b32 s26, s26, 2
s_add_u32 s25, s25, s26
s_mul_i32 s26, s24, 144
s_add_u32 s25, s25, s26
s_cmp_eq_u32 s22, 8
s_cselect_b64 vcc, -1, 0
v_cndmask_b32 v11, v10, v6, vcc
v_add_u32 v11, s25, v11
v_lshlrev_b32 v11, 1, v11
v_mul_u32_u24 v12, 9216, v7
v_add_u32 v4, v11, v12
s_mul_i32 s26, s23, 663552
s_add_u32 s27, s24, 0
s_and_b32 s27, s27, 3
s_mul_i32 s27, s27, 9
s_add_u32 s27, s27, 1
s_lshr_b32 s27, s27, 1
s_mul_i32 s27, s27, 36864
s_add_u32 s32, s26, s27
s_add_u32 s27, s24, 1
s_and_b32 s27, s27, 3
s_mul_i32 s27, s27, 9
s_add_u32 s27, s27, 1
s_lshr_b32 s27, s27, 1
s_mul_i32 s27, s27, 36864
s_add_u32 s33, s26, s27
s_add_u32 s27, s24, 2
s_and_b32 s27, s27, 3
s_mul_i32 s27, s27, 9
s_add_u32 s27, s27, 1
s_lshr_b32 s27, s27, 1
s_mul_i32 s27, s27, 36864
s_add_u32 s34, s26, s27
s_add_u32 s27, s24, 3
s_and_b32 s27, s27, 3
s_mul_i32 s27, s27, 9
s_add_u32 s27, s27, 1
s_lshr_b32 s27, s27, 1
s_mul_i32 s27, s27, 36864
s_add_u32 s35, s26, s27
s_add_u32 s40, s32, 0
buffer_load_ushort v16, v4, s[16:19], s40 offen
s_add_u32 s40, s32, 1152
buffer_load_ushort v17, v4, s[16:19], s40 offen
s_add_u32 s40, s32, 2304
buffer_load_ushort v18, v4, s[16:19], s40 offen
s_add_u32 s40, s32, 3456
buffer_load_ushort v19, v4, s[16:19], s40 offen
s_add_u32 s40, s32, 4608
buffer_load_ushort v20, v4, s[16:19], s40 offen
s_add_u32 s40, s32, 5760
buffer_load_ushort v21, v4, s[16:19], s40 offen
s_add_u32 s40, s32, 6912
buffer_load_ushort v22, v4, s[16:19], s40 offen
s_add_u32 s40, s32, 8064
buffer_load_ushort v23, v4, s[16:19], s40 offen
s_add_u32 s40, s32, 36864
buffer_load_ushort v24, v4, s[16:19], s40 offen
s_add_u32 s40, s32, 38016
buffer_load_ushort v25, v4, s[16:19], s40 offen
s_add_u32 s40, s32, 39168
buffer_load_ushort v26, v4, s[16:19], s40 offen
s_add_u32 s40, s32, 40320
buffer_load_ushort v27, v4, s[16:19], s40 offen
s_add_u32 s40, s32, 41472
buffer_load_ushort v28, v4, s[16:19], s40 offen
s_add_u32 s40, s32, 42624
buffer_load_ushort v29, v4, s[16:19], s40 offen
s_add_u32 s40, s32, 43776
buffer_load_ushort v30, v4, s[16:19], s40 offen
s_add_u32 s40, s32, 44928
buffer_load_ushort v31, v4, s[16:19], s40 offen
s_add_u32 s40, s32, 73728
buffer_load_ushort v32, v4, s[16:19], s40 offen
s_add_u32 s40, s32, 74880
buffer_load_ushort v33, v4, s[16:19], s40 offen
s_add_u32 s40, s32, 76032
buffer_load_ushort v34, v4, s[16:19], s40 offen
s_add_u32 s40, s32, 77184
buffer_load_ushort v35, v4, s[16:19], s40 offen
s_add_u32 s40, s32, 78336
buffer_load_ushort v36, v4, s[16:19], s40 offen
s_add_u32 s40, s32, 79488
buffer_load_ushort v37, v4, s[16:19], s40 offen
s_add_u32 s40, s32, 80640
buffer_load_ushort v38, v4, s[16:19], s40 offen
s_add_u32 s40, s32, 81792
buffer_load_ushort v39, v4, s[16:19], s40 offen
s_add_u32 s40, s33, 0
buffer_load_ushort v40, v4, s[16:19], s40 offen
s_add_u32 s40, s33, 1152
buffer_load_ushort v41, v4, s[16:19], s40 offen
s_add_u32 s40, s33, 2304
buffer_load_ushort v42, v4, s[16:19], s40 offen
s_add_u32 s40, s33, 3456
buffer_load_ushort v43, v4, s[16:19], s40 offen
s_add_u32 s40, s33, 4608
buffer_load_ushort v44, v4, s[16:19], s40 offen
s_add_u32 s40, s33, 5760
buffer_load_ushort v45, v4, s[16:19], s40 offen
s_add_u32 s40, s33, 6912
buffer_load_ushort v46, v4, s[16:19], s40 offen
s_add_u32 s40, s33, 8064
buffer_load_ushort v47, v4, s[16:19], s40 offen
s_add_u32 s40, s34, 0
buffer_load_ushort v48, v4, s[16:19], s40 offen
s_add_u32 s40, s34, 1152
buffer_load_ushort v49, v4, s[16:19], s40 offen
s_add_u32 s40, s34, 2304
buffer_load_ushort v50, v4, s[16:19], s40 offen
s_add_u32 s40, s34, 3456
buffer_load_ushort v51, v4, s[16:19], s40 offen
s_add_u32 s40, s34, 4608
buffer_load_ushort v52, v4, s[16:19], s40 offen
s_add_u32 s40, s34, 5760
buffer_load_ushort v53, v4, s[16:19], s40 offen
s_add_u32 s40, s34, 6912
buffer_load_ushort v54, v4, s[16:19], s40 offen
s_add_u32 s40, s34, 8064
buffer_load_ushort v55, v4, s[16:19], s40 offen
s_add_u32 s40, s35, 0
buffer_load_ushort v56, v4, s[16:19], s40 offen
s_add_u32 s40, s35, 1152
buffer_load_ushort v57, v4, s[16:19], s40 offen
s_add_u32 s40, s35, 2304
buffer_load_ushort v58, v4, s[16:19], s40 offen
s_add_u32 s40, s35, 3456
buffer_load_ushort v59, v4, s[16:19], s40 offen
s_add_u32 s40, s35, 4608
buffer_load_ushort v60, v4, s[16:19], s40 offen
s_add_u32 s40, s35, 5760
buffer_load_ushort v61, v4, s[16:19], s40 offen
s_add_u32 s40, s35, 6912
buffer_load_ushort v62, v4, s[16:19], s40 offen
s_add_u32 s40, s35, 8064
buffer_load_ushort v63, v4, s[16:19], s40 offen
s_waitcnt vmcnt(40)
v_lshl_or_b32 v80, v17, 16, v16
v_lshl_or_b32 v81, v19, 16, v18
v_lshl_or_b32 v82, v21, 16, v20
v_lshl_or_b32 v83, v23, 16, v22
s_waitcnt vmcnt(32)
v_lshl_or_b32 v84, v25, 16, v24
v_lshl_or_b32 v85, v27, 16, v26
v_lshl_or_b32 v86, v29, 16, v28
v_lshl_or_b32 v87, v31, 16, v30
s_waitcnt vmcnt(24)
v_lshl_or_b32 v88, v33, 16, v32
v_lshl_or_b32 v89, v35, 16, v34
v_lshl_or_b32 v90, v37, 16, v36
v_lshl_or_b32 v91, v39, 16, v38
s_waitcnt vmcnt(16)
v_lshl_or_b32 v92, v41, 16, v40
v_lshl_or_b32 v93, v43, 16, v42
v_lshl_or_b32 v94, v45, 16, v44
v_lshl_or_b32 v95, v47, 16, v46
s_waitcnt vmcnt(8)
v_lshl_or_b32 v96, v49, 16, v48
v_lshl_or_b32 v97, v51, 16, v50
v_lshl_or_b32 v98, v53, 16, v52
v_lshl_or_b32 v99, v55, 16, v54
s_waitcnt vmcnt(0)
v_lshl_or_b32 v100, v57, 16, v56
v_lshl_or_b32 v101, v59, 16, v58
v_lshl_or_b32 v102, v61, 16, v60
v_lshl_or_b32 v103, v63, 16, v62
s_add_u32 s40, s33, 36864
buffer_load_ushort v16, v4, s[16:19], s40 offen
s_add_u32 s40, s33, 38016
buffer_load_ushort v17, v4, s[16:19], s40 offen
s_add_u32 s40, s33, 39168
buffer_load_ushort v18, v4, s[16:19], s40 offen
s_add_u32 s40, s33, 40320
buffer_load_ushort v19, v4, s[16:19], s40 offen
s_add_u32 s40, s33, 41472
buffer_load_ushort v20, v4, s[16:19], s40 offen
s_add_u32 s40, s33, 42624
buffer_load_ushort v21, v4, s[16:19], s40 offen
s_add_u32 s40, s33, 43776
buffer_load_ushort v22, v4, s[16:19], s40 offen
s_add_u32 s40, s33, 44928
buffer_load_ushort v23, v4, s[16:19], s40 offen
s_add_u32 s40, s34, 36864
buffer_load_ushort v24, v4, s[16:19], s40 offen
s_add_u32 s40, s34, 38016
buffer_load_ushort v25, v4, s[16:19], s40 offen
s_add_u32 s40, s34, 39168
buffer_load_ushort v26, v4, s[16:19], s40 offen
s_add_u32 s40, s34, 40320
buffer_load_ushort v27, v4, s[16:19], s40 offen
s_add_u32 s40, s34, 41472
buffer_load_ushort v28, v4, s[16:19], s40 offen
s_add_u32 s40, s34, 42624
buffer_load_ushort v29, v4, s[16:19], s40 offen
s_add_u32 s40, s34, 43776
buffer_load_ushort v30, v4, s[16:19], s40 offen
s_add_u32 s40, s34, 44928
buffer_load_ushort v31, v4, s[16:19], s40 offen
s_add_u32 s40, s35, 36864
buffer_load_ushort v32, v4, s[16:19], s40 offen
s_add_u32 s40, s35, 38016
buffer_load_ushort v33, v4, s[16:19], s40 offen
s_add_u32 s40, s35, 39168
buffer_load_ushort v34, v4, s[16:19], s40 offen
s_add_u32 s40, s35, 40320
buffer_load_ushort v35, v4, s[16:19], s40 offen
s_add_u32 s40, s35, 41472
buffer_load_ushort v36, v4, s[16:19], s40 offen
s_add_u32 s40, s35, 42624
buffer_load_ushort v37, v4, s[16:19], s40 offen
s_add_u32 s40, s35, 43776
buffer_load_ushort v38, v4, s[16:19], s40 offen
s_add_u32 s40, s35, 44928
buffer_load_ushort v39, v4, s[16:19], s40 offen
s_add_u32 s40, s26, 147456
buffer_load_ushort v40, v4, s[16:19], s40 offen
s_add_u32 s40, s26, 148608
buffer_load_ushort v41, v4, s[16:19], s40 offen
s_add_u32 s40, s26, 149760
buffer_load_ushort v42, v4, s[16:19], s40 offen
s_add_u32 s40, s26, 150912
buffer_load_ushort v43, v4, s[16:19], s40 offen
s_add_u32 s40, s26, 152064
buffer_load_ushort v44, v4, s[16:19], s40 offen
s_add_u32 s40, s26, 153216
buffer_load_ushort v45, v4, s[16:19], s40 offen
s_add_u32 s40, s26, 154368
buffer_load_ushort v46, v4, s[16:19], s40 offen
s_add_u32 s40, s26, 155520
buffer_load_ushort v47, v4, s[16:19], s40 offen
s_add_u32 s40, s26, 479232
buffer_load_ushort v48, v4, s[16:19], s40 offen
s_add_u32 s40, s26, 480384
buffer_load_ushort v49, v4, s[16:19], s40 offen
s_add_u32 s40, s26, 481536
buffer_load_ushort v50, v4, s[16:19], s40 offen
s_add_u32 s40, s26, 482688
buffer_load_ushort v51, v4, s[16:19], s40 offen
s_add_u32 s40, s26, 483840
buffer_load_ushort v52, v4, s[16:19], s40 offen
s_add_u32 s40, s26, 484992
buffer_load_ushort v53, v4, s[16:19], s40 offen
s_add_u32 s40, s26, 486144
buffer_load_ushort v54, v4, s[16:19], s40 offen
s_add_u32 s40, s26, 487296
buffer_load_ushort v55, v4, s[16:19], s40 offen
s_add_u32 s40, s32, 110592
buffer_load_ushort v56, v4, s[16:19], s40 offen
s_add_u32 s40, s32, 111744
buffer_load_ushort v57, v4, s[16:19], s40 offen
s_add_u32 s40, s32, 112896
buffer_load_ushort v58, v4, s[16:19], s40 offen
s_add_u32 s40, s32, 114048
buffer_load_ushort v59, v4, s[16:19], s40 offen
s_add_u32 s40, s32, 115200
buffer_load_ushort v60, v4, s[16:19], s40 offen
s_add_u32 s40, s32, 116352
buffer_load_ushort v61, v4, s[16:19], s40 offen
s_add_u32 s40, s32, 117504
buffer_load_ushort v62, v4, s[16:19], s40 offen
s_add_u32 s40, s32, 118656
buffer_load_ushort v63, v4, s[16:19], s40 offen
s_waitcnt vmcnt(40)
v_lshl_or_b32 v104, v17, 16, v16
v_lshl_or_b32 v105, v19, 16, v18
v_lshl_or_b32 v106, v21, 16, v20
v_lshl_or_b32 v107, v23, 16, v22
s_waitcnt vmcnt(32)
v_lshl_or_b32 v108, v25, 16, v24
v_lshl_or_b32 v109, v27, 16, v26
v_lshl_or_b32 v110, v29, 16, v28
v_lshl_or_b32 v111, v31, 16, v30
s_waitcnt vmcnt(24)
v_lshl_or_b32 v112, v33, 16, v32
v_lshl_or_b32 v113, v35, 16, v34
v_lshl_or_b32 v114, v37, 16, v36
v_lshl_or_b32 v115, v39, 16, v38
s_waitcnt vmcnt(16)
v_lshl_or_b32 v116, v41, 16, v40
v_lshl_or_b32 v117, v43, 16, v42
v_lshl_or_b32 v118, v45, 16, v44
v_lshl_or_b32 v119, v47, 16, v46
s_waitcnt vmcnt(8)
v_lshl_or_b32 v120, v49, 16, v48
v_lshl_or_b32 v121, v51, 16, v50
v_lshl_or_b32 v122, v53, 16, v52
v_lshl_or_b32 v123, v55, 16, v54
s_waitcnt vmcnt(0)
v_lshl_or_b32 v124, v57, 16, v56
v_lshl_or_b32 v125, v59, 16, v58
v_lshl_or_b32 v126, v61, 16, v60
v_lshl_or_b32 v127, v63, 16, v62
s_add_u32 s40, s33, 73728
buffer_load_ushort v16, v4, s[16:19], s40 offen
s_add_u32 s40, s33, 74880
buffer_load_ushort v17, v4, s[16:19], s40 offen
s_add_u32 s40, s33, 76032
buffer_load_ushort v18, v4, s[16:19], s40 offen
s_add_u32 s40, s33, 77184
buffer_load_ushort v19, v4, s[16:19], s40 offen
s_add_u32 s40, s33, 78336
buffer_load_ushort v20, v4, s[16:19], s40 offen
s_add_u32 s40, s33, 79488
buffer_load_ushort v21, v4, s[16:19], s40 offen
s_add_u32 s40, s33, 80640
buffer_load_ushort v22, v4, s[16:19], s40 offen
s_add_u32 s40, s33, 81792
buffer_load_ushort v23, v4, s[16:19], s40 offen
s_add_u32 s40, s34, 73728
buffer_load_ushort v24, v4, s[16:19], s40 offen
s_add_u32 s40, s34, 74880
buffer_load_ushort v25, v4, s[16:19], s40 offen
s_add_u32 s40, s34, 76032
buffer_load_ushort v26, v4, s[16:19], s40 offen
s_add_u32 s40, s34, 77184
buffer_load_ushort v27, v4, s[16:19], s40 offen
s_add_u32 s40, s34, 78336
buffer_load_ushort v28, v4, s[16:19], s40 offen
s_add_u32 s40, s34, 79488
buffer_load_ushort v29, v4, s[16:19], s40 offen
s_add_u32 s40, s34, 80640
buffer_load_ushort v30, v4, s[16:19], s40 offen
s_add_u32 s40, s34, 81792
buffer_load_ushort v31, v4, s[16:19], s40 offen
s_add_u32 s40, s35, 73728
buffer_load_ushort v32, v4, s[16:19], s40 offen
s_add_u32 s40, s35, 74880
buffer_load_ushort v33, v4, s[16:19], s40 offen
s_add_u32 s40, s35, 76032
buffer_load_ushort v34, v4, s[16:19], s40 offen
s_add_u32 s40, s35, 77184
buffer_load_ushort v35, v4, s[16:19], s40 offen
s_add_u32 s40, s35, 78336
buffer_load_ushort v36, v4, s[16:19], s40 offen
s_add_u32 s40, s35, 79488
buffer_load_ushort v37, v4, s[16:19], s40 offen
s_add_u32 s40, s35, 80640
buffer_load_ushort v38, v4, s[16:19], s40 offen
s_add_u32 s40, s35, 81792
buffer_load_ushort v39, v4, s[16:19], s40 offen
s_add_u32 s40, s33, 110592
buffer_load_ushort v40, v4, s[16:19], s40 offen
s_add_u32 s40, s33, 111744
buffer_load_ushort v41, v4, s[16:19], s40 offen
s_add_u32 s40, s33, 112896
buffer_load_ushort v42, v4, s[16:19], s40 offen
s_add_u32 s40, s33, 114048
buffer_load_ushort v43, v4, s[16:19], s40 offen
s_add_u32 s40, s33, 115200
buffer_load_ushort v44, v4, s[16:19], s40 offen
s_add_u32 s40, s33, 116352
buffer_load_ushort v45, v4, s[16:19], s40 offen
s_add_u32 s40, s33, 117504
buffer_load_ushort v46, v4, s[16:19], s40 offen
s_add_u32 s40, s33, 118656
buffer_load_ushort v47, v4, s[16:19], s40 offen
s_add_u32 s40, s34, 110592
buffer_load_ushort v48, v4, s[16:19], s40 offen
s_add_u32 s40, s34, 111744
buffer_load_ushort v49, v4, s[16:19], s40 offen
s_add_u32 s40, s34, 112896
buffer_load_ushort v50, v4, s[16:19], s40 offen
s_add_u32 s40, s34, 114048
buffer_load_ushort v51, v4, s[16:19], s40 offen
s_add_u32 s40, s34, 115200
buffer_load_ushort v52, v4, s[16:19], s40 offen
s_add_u32 s40, s34, 116352
buffer_load_ushort v53, v4, s[16:19], s40 offen
s_add_u32 s40, s34, 117504
buffer_load_ushort v54, v4, s[16:19], s40 offen
s_add_u32 s40, s34, 118656
buffer_load_ushort v55, v4, s[16:19], s40 offen
s_add_u32 s40, s35, 110592
buffer_load_ushort v56, v4, s[16:19], s40 offen
s_add_u32 s40, s35, 111744
buffer_load_ushort v57, v4, s[16:19], s40 offen
s_add_u32 s40, s35, 112896
buffer_load_ushort v58, v4, s[16:19], s40 offen
s_add_u32 s40, s35, 114048
buffer_load_ushort v59, v4, s[16:19], s40 offen
s_add_u32 s40, s35, 115200
buffer_load_ushort v60, v4, s[16:19], s40 offen
s_add_u32 s40, s35, 116352
buffer_load_ushort v61, v4, s[16:19], s40 offen
s_add_u32 s40, s35, 117504
buffer_load_ushort v62, v4, s[16:19], s40 offen
s_add_u32 s40, s35, 118656
buffer_load_ushort v63, v4, s[16:19], s40 offen
s_waitcnt vmcnt(40)
v_lshl_or_b32 v128, v17, 16, v16
v_lshl_or_b32 v129, v19, 16, v18
v_lshl_or_b32 v130, v21, 16, v20
v_lshl_or_b32 v131, v23, 16, v22
s_waitcnt vmcnt(32)
v_lshl_or_b32 v132, v25, 16, v24
v_lshl_or_b32 v133, v27, 16, v26
v_lshl_or_b32 v134, v29, 16, v28
v_lshl_or_b32 v135, v31, 16, v30
s_waitcnt vmcnt(24)
v_lshl_or_b32 v136, v33, 16, v32
v_lshl_or_b32 v137, v35, 16, v34
v_lshl_or_b32 v138, v37, 16, v36
v_lshl_or_b32 v139, v39, 16, v38
s_waitcnt vmcnt(16)
v_lshl_or_b32 v140, v41, 16, v40
v_lshl_or_b32 v141, v43, 16, v42
v_lshl_or_b32 v142, v45, 16, v44
v_lshl_or_b32 v143, v47, 16, v46
s_waitcnt vmcnt(8)
v_lshl_or_b32 v144, v49, 16, v48
v_lshl_or_b32 v145, v51, 16, v50
v_lshl_or_b32 v146, v53, 16, v52
v_lshl_or_b32 v147, v55, 16, v54
s_waitcnt vmcnt(0)
v_lshl_or_b32 v148, v57, 16, v56
v_lshl_or_b32 v149, v59, 16, v58
v_lshl_or_b32 v150, v61, 16, v60
v_lshl_or_b32 v151, v63, 16, v62
s_mul_i32 s29, s21, 497664
s_add_u32 s29, s29, 3698688
s_lshl_b32 s30, s22, 11
s_add_u32 s30, s30, s29
s_lshl_b32 s31, s22, 12
s_add_u32 s31, s31, s29
s_add_u32 s40, s30, 0
buffer_store_dwordx4 v[80:83], v2, s[8:11], s40 offen
s_add_u32 s40, s30, 1024
buffer_store_dwordx4 v[84:87], v2, s[8:11], s40 offen
s_add_u32 s40, s30, 18432
buffer_store_dwordx4 v[88:91], v2, s[8:11], s40 offen
s_add_u32 s40, s30, 19456
buffer_store_dwordx4 v[92:95], v2, s[8:11], s40 offen
s_add_u32 s40, s30, 36864
buffer_store_dwordx4 v[96:99], v2, s[8:11], s40 offen
s_add_u32 s40, s30, 37888
buffer_store_dwordx4 v[100:103], v2, s[8:11], s40 offen
s_add_u32 s40, s30, 55296
buffer_store_dwordx4 v[104:107], v2, s[8:11], s40 offen
s_add_u32 s40, s30, 56320
buffer_store_dwordx4 v[108:111], v2, s[8:11], s40 offen
s_add_u32 s40, s30, 73728
buffer_store_dwordx4 v[112:115], v2, s[8:11], s40 offen
s_add_u32 s40, s30, 74752
buffer_store_dwordx4 v[116:119], v2, s[8:11], s40 offen
s_add_u32 s40, s30, 92160
buffer_store_dwordx4 v[120:123], v2, s[8:11], s40 offen
s_add_u32 s40, s30, 93184
buffer_store_dwordx4 v[124:127], v2, s[8:11], s40 offen
s_add_u32 s40, s30, 110592
buffer_store_dwordx4 v[128:131], v2, s[8:11], s40 offen
s_add_u32 s40, s30, 111616
buffer_store_dwordx4 v[132:135], v2, s[8:11], s40 offen
s_add_u32 s40, s31, 129024
buffer_store_dwordx4 v[136:139], v2, s[8:11], s40 offen
s_add_u32 s40, s31, 130048
buffer_store_dwordx4 v[140:143], v2, s[8:11], s40 offen
s_add_u32 s40, s31, 131072
buffer_store_dwordx4 v[144:147], v2, s[8:11], s40 offen
s_add_u32 s40, s31, 132096
buffer_store_dwordx4 v[148:151], v2, s[8:11], s40 offen
s_branch L_prep_end
L_pack_q:
s_sub_u32 s20, s20, 864
s_lshr_b32 s21, s20, 3
s_and_b32 s22, s20, 7
s_load_dwordx2 s[12:13], s[0:1], 8
s_waitcnt lgkmcnt(0)
s_mov_b32 s16, s12
s_and_b32 s17, s13, 0xffff
s_mov_b32 s18, 1990656
s_mov_b32 s19, 0x20000
s_mov_b32 s23, 0
s_cmp_eq_u32 s22, 0
s_cselect_b32 s23, 0, s23
s_cmp_eq_u32 s22, 1
s_cselect_b32 s23, 18, s23
s_cmp_eq_u32 s22, 2
s_cselect_b32 s23, 576, s23
s_cmp_eq_u32 s22, 3
s_cselect_b32 s23, 594, s23
s_cmp_eq_u32 s22, 4
s_cselect_b32 s23, 16, s23
s_cmp_eq_u32 s22, 5
s_cselect_b32 s23, 1152, s23
s_cmp_eq_u32 s22, 6
s_cselect_b32 s23, 1170, s23
s_cmp_eq_u32 s22, 7
s_cselect_b32 s23, 1168, s23
s_mul_i32 s24, s21, 36
s_add_u32 s23, s23, s24
v_and_b32 v11, 1, v6
v_bfe_u32 v12, v6, 1, 1
v_mul_u32_u24 v12, 18, v12
v_add_u32 v11, v11, v12
v_mul_u32_u24 v12, 576, v8
v_add_u32 v11, v11, v12
s_mov_b32 s24, 16
s_cmp_eq_u32 s22, 4
s_cselect_b32 s24, 8, s24
s_cmp_eq_u32 s22, 7
s_cselect_b32 s24, 4, s24
s_cmp_lg_u32 s24, 16
s_cselect_b64 vcc, -1, 0
v_cndmask_b32 v11, v6, v11, vcc
v_add_u32 v11, s23, v11
v_lshlrev_b32 v11, 1, v11
v_mul_u32_u24 v12, 27648, v7
v_add_u32 v11, v11, v12
v_mov_b32 v12, 2146435072
v_cmp_gt_u32 vcc, s24, v6
s_nop 1
v_cndmask_b32 v4, v12, v11, vcc
s_mov_b32 s40, 0
buffer_load_ushort v16, v4, s[16:19], s40 offen
s_mov_b32 s40, 3456
buffer_load_ushort v17, v4, s[16:19], s40 offen
s_mov_b32 s40, 6912
buffer_load_ushort v18, v4, s[16:19], s40 offen
s_mov_b32 s40, 10368
buffer_load_ushort v19, v4, s[16:19], s40 offen
s_mov_b32 s40, 13824
buffer_load_ushort v20, v4, s[16:19], s40 offen
s_mov_b32 s40, 17280
buffer_load_ushort v21, v4, s[16:19], s40 offen
s_mov_b32 s40, 20736
buffer_load_ushort v22, v4, s[16:19], s40 offen
s_mov_b32 s40, 24192
buffer_load_ushort v23, v4, s[16:19], s40 offen
s_mov_b32 s40, 110592
buffer_load_ushort v24, v4, s[16:19], s40 offen
s_mov_b32 s40, 114048
buffer_load_ushort v25, v4, s[16:19], s40 offen
s_mov_b32 s40, 117504
buffer_load_ushort v26, v4, s[16:19], s40 offen
s_mov_b32 s40, 120960
buffer_load_ushort v27, v4, s[16:19], s40 offen
s_mov_b32 s40, 124416
buffer_load_ushort v28, v4, s[16:19], s40 offen
s_mov_b32 s40, 127872
buffer_load_ushort v29, v4, s[16:19], s40 offen
s_mov_b32 s40, 131328
buffer_load_ushort v30, v4, s[16:19], s40 offen
s_mov_b32 s40, 134784
buffer_load_ushort v31, v4, s[16:19], s40 offen
s_mov_b32 s40, 221184
buffer_load_ushort v32, v4, s[16:19], s40 offen
s_mov_b32 s40, 224640
buffer_load_ushort v33, v4, s[16:19], s40 offen
s_mov_b32 s40, 228096
buffer_load_ushort v34, v4, s[16:19], s40 offen
s_mov_b32 s40, 231552
buffer_load_ushort v35, v4, s[16:19], s40 offen
s_mov_b32 s40, 235008
buffer_load_ushort v36, v4, s[16:19], s40 offen
s_mov_b32 s40, 238464
buffer_load_ushort v37, v4, s[16:19], s40 offen
s_mov_b32 s40, 241920
buffer_load_ushort v38, v4, s[16:19], s40 offen
s_mov_b32 s40, 245376
buffer_load_ushort v39, v4, s[16:19], s40 offen
s_mov_b32 s40, 331776
buffer_load_ushort v40, v4, s[16:19], s40 offen
s_mov_b32 s40, 335232
buffer_load_ushort v41, v4, s[16:19], s40 offen
s_mov_b32 s40, 338688
buffer_load_ushort v42, v4, s[16:19], s40 offen
s_mov_b32 s40, 342144
buffer_load_ushort v43, v4, s[16:19], s40 offen
s_mov_b32 s40, 345600
buffer_load_ushort v44, v4, s[16:19], s40 offen
s_mov_b32 s40, 349056
buffer_load_ushort v45, v4, s[16:19], s40 offen
s_mov_b32 s40, 352512
buffer_load_ushort v46, v4, s[16:19], s40 offen
s_mov_b32 s40, 355968
buffer_load_ushort v47, v4, s[16:19], s40 offen
s_mov_b32 s40, 442368
buffer_load_ushort v48, v4, s[16:19], s40 offen
s_mov_b32 s40, 445824
buffer_load_ushort v49, v4, s[16:19], s40 offen
s_mov_b32 s40, 449280
buffer_load_ushort v50, v4, s[16:19], s40 offen
s_mov_b32 s40, 452736
buffer_load_ushort v51, v4, s[16:19], s40 offen
s_mov_b32 s40, 456192
buffer_load_ushort v52, v4, s[16:19], s40 offen
s_mov_b32 s40, 459648
buffer_load_ushort v53, v4, s[16:19], s40 offen
s_mov_b32 s40, 463104
buffer_load_ushort v54, v4, s[16:19], s40 offen
s_mov_b32 s40, 466560
buffer_load_ushort v55, v4, s[16:19], s40 offen
s_mov_b32 s40, 552960
buffer_load_ushort v56, v4, s[16:19], s40 offen
s_mov_b32 s40, 556416
buffer_load_ushort v57, v4, s[16:19], s40 offen
s_mov_b32 s40, 559872
buffer_load_ushort v58, v4, s[16:19], s40 offen
s_mov_b32 s40, 563328
buffer_load_ushort v59, v4, s[16:19], s40 offen
s_mov_b32 s40, 566784
buffer_load_ushort v60, v4, s[16:19], s40 offen
s_mov_b32 s40, 570240
buffer_load_ushort v61, v4, s[16:19], s40 offen
s_mov_b32 s40, 573696
buffer_load_ushort v62, v4, s[16:19], s40 offen
s_mov_b32 s40, 577152
buffer_load_ushort v63, v4, s[16:19], s40 offen
s_waitcnt vmcnt(40)
v_lshl_or_b32 v80, v17, 16, v16
v_lshl_or_b32 v81, v19, 16, v18
v_lshl_or_b32 v82, v21, 16, v20
v_lshl_or_b32 v83, v23, 16, v22
s_waitcnt vmcnt(32)
v_lshl_or_b32 v84, v25, 16, v24
v_lshl_or_b32 v85, v27, 16, v26
v_lshl_or_b32 v86, v29, 16, v28
v_lshl_or_b32 v87, v31, 16, v30
s_waitcnt vmcnt(24)
v_lshl_or_b32 v88, v33, 16, v32
v_lshl_or_b32 v89, v35, 16, v34
v_lshl_or_b32 v90, v37, 16, v36
v_lshl_or_b32 v91, v39, 16, v38
s_waitcnt vmcnt(16)
v_lshl_or_b32 v92, v41, 16, v40
v_lshl_or_b32 v93, v43, 16, v42
v_lshl_or_b32 v94, v45, 16, v44
v_lshl_or_b32 v95, v47, 16, v46
s_waitcnt vmcnt(8)
v_lshl_or_b32 v96, v49, 16, v48
v_lshl_or_b32 v97, v51, 16, v50
v_lshl_or_b32 v98, v53, 16, v52
v_lshl_or_b32 v99, v55, 16, v54
s_waitcnt vmcnt(0)
v_lshl_or_b32 v100, v57, 16, v56
v_lshl_or_b32 v101, v59, 16, v58
v_lshl_or_b32 v102, v61, 16, v60
v_lshl_or_b32 v103, v63, 16, v62
s_mov_b32 s40, 663552
buffer_load_ushort v16, v4, s[16:19], s40 offen
s_mov_b32 s40, 667008
buffer_load_ushort v17, v4, s[16:19], s40 offen
s_mov_b32 s40, 670464
buffer_load_ushort v18, v4, s[16:19], s40 offen
s_mov_b32 s40, 673920
buffer_load_ushort v19, v4, s[16:19], s40 offen
s_mov_b32 s40, 677376
buffer_load_ushort v20, v4, s[16:19], s40 offen
s_mov_b32 s40, 680832
buffer_load_ushort v21, v4, s[16:19], s40 offen
s_mov_b32 s40, 684288
buffer_load_ushort v22, v4, s[16:19], s40 offen
s_mov_b32 s40, 687744
buffer_load_ushort v23, v4, s[16:19], s40 offen
s_mov_b32 s40, 774144
buffer_load_ushort v24, v4, s[16:19], s40 offen
s_mov_b32 s40, 777600
buffer_load_ushort v25, v4, s[16:19], s40 offen
s_mov_b32 s40, 781056
buffer_load_ushort v26, v4, s[16:19], s40 offen
s_mov_b32 s40, 784512
buffer_load_ushort v27, v4, s[16:19], s40 offen
s_mov_b32 s40, 787968
buffer_load_ushort v28, v4, s[16:19], s40 offen
s_mov_b32 s40, 791424
buffer_load_ushort v29, v4, s[16:19], s40 offen
s_mov_b32 s40, 794880
buffer_load_ushort v30, v4, s[16:19], s40 offen
s_mov_b32 s40, 798336
buffer_load_ushort v31, v4, s[16:19], s40 offen
s_mov_b32 s40, 884736
buffer_load_ushort v32, v4, s[16:19], s40 offen
s_mov_b32 s40, 888192
buffer_load_ushort v33, v4, s[16:19], s40 offen
s_mov_b32 s40, 891648
buffer_load_ushort v34, v4, s[16:19], s40 offen
s_mov_b32 s40, 895104
buffer_load_ushort v35, v4, s[16:19], s40 offen
s_mov_b32 s40, 898560
buffer_load_ushort v36, v4, s[16:19], s40 offen
s_mov_b32 s40, 902016
buffer_load_ushort v37, v4, s[16:19], s40 offen
s_mov_b32 s40, 905472
buffer_load_ushort v38, v4, s[16:19], s40 offen
s_mov_b32 s40, 908928
buffer_load_ushort v39, v4, s[16:19], s40 offen
s_mov_b32 s40, 995328
buffer_load_ushort v40, v4, s[16:19], s40 offen
s_mov_b32 s40, 998784
buffer_load_ushort v41, v4, s[16:19], s40 offen
s_mov_b32 s40, 1002240
buffer_load_ushort v42, v4, s[16:19], s40 offen
s_mov_b32 s40, 1005696
buffer_load_ushort v43, v4, s[16:19], s40 offen
s_mov_b32 s40, 1009152
buffer_load_ushort v44, v4, s[16:19], s40 offen
s_mov_b32 s40, 1012608
buffer_load_ushort v45, v4, s[16:19], s40 offen
s_mov_b32 s40, 1016064
buffer_load_ushort v46, v4, s[16:19], s40 offen
s_mov_b32 s40, 1019520
buffer_load_ushort v47, v4, s[16:19], s40 offen
s_mov_b32 s40, 1105920
buffer_load_ushort v48, v4, s[16:19], s40 offen
s_mov_b32 s40, 1109376
buffer_load_ushort v49, v4, s[16:19], s40 offen
s_mov_b32 s40, 1112832
buffer_load_ushort v50, v4, s[16:19], s40 offen
s_mov_b32 s40, 1116288
buffer_load_ushort v51, v4, s[16:19], s40 offen
s_mov_b32 s40, 1119744
buffer_load_ushort v52, v4, s[16:19], s40 offen
s_mov_b32 s40, 1123200
buffer_load_ushort v53, v4, s[16:19], s40 offen
s_mov_b32 s40, 1126656
buffer_load_ushort v54, v4, s[16:19], s40 offen
s_mov_b32 s40, 1130112
buffer_load_ushort v55, v4, s[16:19], s40 offen
s_mov_b32 s40, 1216512
buffer_load_ushort v56, v4, s[16:19], s40 offen
s_mov_b32 s40, 1219968
buffer_load_ushort v57, v4, s[16:19], s40 offen
s_mov_b32 s40, 1223424
buffer_load_ushort v58, v4, s[16:19], s40 offen
s_mov_b32 s40, 1226880
buffer_load_ushort v59, v4, s[16:19], s40 offen
s_mov_b32 s40, 1230336
buffer_load_ushort v60, v4, s[16:19], s40 offen
s_mov_b32 s40, 1233792
buffer_load_ushort v61, v4, s[16:19], s40 offen
s_mov_b32 s40, 1237248
buffer_load_ushort v62, v4, s[16:19], s40 offen
s_mov_b32 s40, 1240704
buffer_load_ushort v63, v4, s[16:19], s40 offen
s_waitcnt vmcnt(40)
v_lshl_or_b32 v104, v17, 16, v16
v_lshl_or_b32 v105, v19, 16, v18
v_lshl_or_b32 v106, v21, 16, v20
v_lshl_or_b32 v107, v23, 16, v22
s_waitcnt vmcnt(32)
v_lshl_or_b32 v108, v25, 16, v24
v_lshl_or_b32 v109, v27, 16, v26
v_lshl_or_b32 v110, v29, 16, v28
v_lshl_or_b32 v111, v31, 16, v30
s_waitcnt vmcnt(24)
v_lshl_or_b32 v112, v33, 16, v32
v_lshl_or_b32 v113, v35, 16, v34
v_lshl_or_b32 v114, v37, 16, v36
v_lshl_or_b32 v115, v39, 16, v38
s_waitcnt vmcnt(16)
v_lshl_or_b32 v116, v41, 16, v40
v_lshl_or_b32 v117, v43, 16, v42
v_lshl_or_b32 v118, v45, 16, v44
v_lshl_or_b32 v119, v47, 16, v46
s_waitcnt vmcnt(8)
v_lshl_or_b32 v120, v49, 16, v48
v_lshl_or_b32 v121, v51, 16, v50
v_lshl_or_b32 v122, v53, 16, v52
v_lshl_or_b32 v123, v55, 16, v54
s_waitcnt vmcnt(0)
v_lshl_or_b32 v124, v57, 16, v56
v_lshl_or_b32 v125, v59, 16, v58
v_lshl_or_b32 v126, v61, 16, v60
v_lshl_or_b32 v127, v63, 16, v62
s_mov_b32 s40, 1327104
buffer_load_ushort v16, v4, s[16:19], s40 offen
s_mov_b32 s40, 1330560
buffer_load_ushort v17, v4, s[16:19], s40 offen
s_mov_b32 s40, 1334016
buffer_load_ushort v18, v4, s[16:19], s40 offen
s_mov_b32 s40, 1337472
buffer_load_ushort v19, v4, s[16:19], s40 offen
s_mov_b32 s40, 1340928
buffer_load_ushort v20, v4, s[16:19], s40 offen
s_mov_b32 s40, 1344384
buffer_load_ushort v21, v4, s[16:19], s40 offen
s_mov_b32 s40, 1347840
buffer_load_ushort v22, v4, s[16:19], s40 offen
s_mov_b32 s40, 1351296
buffer_load_ushort v23, v4, s[16:19], s40 offen
s_mov_b32 s40, 1437696
buffer_load_ushort v24, v4, s[16:19], s40 offen
s_mov_b32 s40, 1441152
buffer_load_ushort v25, v4, s[16:19], s40 offen
s_mov_b32 s40, 1444608
buffer_load_ushort v26, v4, s[16:19], s40 offen
s_mov_b32 s40, 1448064
buffer_load_ushort v27, v4, s[16:19], s40 offen
s_mov_b32 s40, 1451520
buffer_load_ushort v28, v4, s[16:19], s40 offen
s_mov_b32 s40, 1454976
buffer_load_ushort v29, v4, s[16:19], s40 offen
s_mov_b32 s40, 1458432
buffer_load_ushort v30, v4, s[16:19], s40 offen
s_mov_b32 s40, 1461888
buffer_load_ushort v31, v4, s[16:19], s40 offen
s_mov_b32 s40, 1548288
buffer_load_ushort v32, v4, s[16:19], s40 offen
s_mov_b32 s40, 1551744
buffer_load_ushort v33, v4, s[16:19], s40 offen
s_mov_b32 s40, 1555200
buffer_load_ushort v34, v4, s[16:19], s40 offen
s_mov_b32 s40, 1558656
buffer_load_ushort v35, v4, s[16:19], s40 offen
s_mov_b32 s40, 1562112
buffer_load_ushort v36, v4, s[16:19], s40 offen
s_mov_b32 s40, 1565568
buffer_load_ushort v37, v4, s[16:19], s40 offen
s_mov_b32 s40, 1569024
buffer_load_ushort v38, v4, s[16:19], s40 offen
s_mov_b32 s40, 1572480
buffer_load_ushort v39, v4, s[16:19], s40 offen
s_mov_b32 s40, 1658880
buffer_load_ushort v40, v4, s[16:19], s40 offen
s_mov_b32 s40, 1662336
buffer_load_ushort v41, v4, s[16:19], s40 offen
s_mov_b32 s40, 1665792
buffer_load_ushort v42, v4, s[16:19], s40 offen
s_mov_b32 s40, 1669248
buffer_load_ushort v43, v4, s[16:19], s40 offen
s_mov_b32 s40, 1672704
buffer_load_ushort v44, v4, s[16:19], s40 offen
s_mov_b32 s40, 1676160
buffer_load_ushort v45, v4, s[16:19], s40 offen
s_mov_b32 s40, 1679616
buffer_load_ushort v46, v4, s[16:19], s40 offen
s_mov_b32 s40, 1683072
buffer_load_ushort v47, v4, s[16:19], s40 offen
s_mov_b32 s40, 1769472
buffer_load_ushort v48, v4, s[16:19], s40 offen
s_mov_b32 s40, 1772928
buffer_load_ushort v49, v4, s[16:19], s40 offen
s_mov_b32 s40, 1776384
buffer_load_ushort v50, v4, s[16:19], s40 offen
s_mov_b32 s40, 1779840
buffer_load_ushort v51, v4, s[16:19], s40 offen
s_mov_b32 s40, 1783296
buffer_load_ushort v52, v4, s[16:19], s40 offen
s_mov_b32 s40, 1786752
buffer_load_ushort v53, v4, s[16:19], s40 offen
s_mov_b32 s40, 1790208
buffer_load_ushort v54, v4, s[16:19], s40 offen
s_mov_b32 s40, 1793664
buffer_load_ushort v55, v4, s[16:19], s40 offen
s_mov_b32 s40, 1880064
buffer_load_ushort v56, v4, s[16:19], s40 offen
s_mov_b32 s40, 1883520
buffer_load_ushort v57, v4, s[16:19], s40 offen
s_mov_b32 s40, 1886976
buffer_load_ushort v58, v4, s[16:19], s40 offen
s_mov_b32 s40, 1890432
buffer_load_ushort v59, v4, s[16:19], s40 offen
s_mov_b32 s40, 1893888
buffer_load_ushort v60, v4, s[16:19], s40 offen
s_mov_b32 s40, 1897344
buffer_load_ushort v61, v4, s[16:19], s40 offen
s_mov_b32 s40, 1900800
buffer_load_ushort v62, v4, s[16:19], s40 offen
s_mov_b32 s40, 1904256
buffer_load_ushort v63, v4, s[16:19], s40 offen
s_waitcnt vmcnt(40)
v_lshl_or_b32 v128, v17, 16, v16
v_lshl_or_b32 v129, v19, 16, v18
v_lshl_or_b32 v130, v21, 16, v20
v_lshl_or_b32 v131, v23, 16, v22
s_waitcnt vmcnt(32)
v_lshl_or_b32 v132, v25, 16, v24
v_lshl_or_b32 v133, v27, 16, v26
v_lshl_or_b32 v134, v29, 16, v28
v_lshl_or_b32 v135, v31, 16, v30
s_waitcnt vmcnt(24)
v_lshl_or_b32 v136, v33, 16, v32
v_lshl_or_b32 v137, v35, 16, v34
v_lshl_or_b32 v138, v37, 16, v36
v_lshl_or_b32 v139, v39, 16, v38
s_waitcnt vmcnt(16)
v_lshl_or_b32 v140, v41, 16, v40
v_lshl_or_b32 v141, v43, 16, v42
v_lshl_or_b32 v142, v45, 16, v44
v_lshl_or_b32 v143, v47, 16, v46
s_waitcnt vmcnt(8)
v_lshl_or_b32 v144, v49, 16, v48
v_lshl_or_b32 v145, v51, 16, v50
v_lshl_or_b32 v146, v53, 16, v52
v_lshl_or_b32 v147, v55, 16, v54
s_waitcnt vmcnt(0)
v_lshl_or_b32 v148, v57, 16, v56
v_lshl_or_b32 v149, v59, 16, v58
v_lshl_or_b32 v150, v61, 16, v60
v_lshl_or_b32 v151, v63, 16, v62
s_mul_i32 s29, s21, 147456
s_lshl_b32 s30, s22, 10
s_add_u32 s29, s29, s30
s_add_u32 s29, s29, 262144
s_add_u32 s40, s29, 0
buffer_store_dwordx4 v[80:83], v2, s[8:11], s40 offen
s_add_u32 s40, s29, 8192
buffer_store_dwordx4 v[84:87], v2, s[8:11], s40 offen
s_add_u32 s40, s29, 16384
buffer_store_dwordx4 v[88:91], v2, s[8:11], s40 offen
s_add_u32 s40, s29, 24576
buffer_store_dwordx4 v[92:95], v2, s[8:11], s40 offen
s_add_u32 s40, s29, 32768
buffer_store_dwordx4 v[96:99], v2, s[8:11], s40 offen
s_add_u32 s40, s29, 40960
buffer_store_dwordx4 v[100:103], v2, s[8:11], s40 offen
s_add_u32 s40, s29, 49152
buffer_store_dwordx4 v[104:107], v2, s[8:11], s40 offen
s_add_u32 s40, s29, 57344
buffer_store_dwordx4 v[108:111], v2, s[8:11], s40 offen
s_add_u32 s40, s29, 65536
buffer_store_dwordx4 v[112:115], v2, s[8:11], s40 offen
s_add_u32 s40, s29, 73728
buffer_store_dwordx4 v[116:119], v2, s[8:11], s40 offen
s_add_u32 s40, s29, 81920
buffer_store_dwordx4 v[120:123], v2, s[8:11], s40 offen
s_add_u32 s40, s29, 90112
buffer_store_dwordx4 v[124:127], v2, s[8:11], s40 offen
s_add_u32 s40, s29, 98304
buffer_store_dwordx4 v[128:131], v2, s[8:11], s40 offen
s_add_u32 s40, s29, 106496
buffer_store_dwordx4 v[132:135], v2, s[8:11], s40 offen
s_add_u32 s40, s29, 114688
buffer_store_dwordx4 v[136:139], v2, s[8:11], s40 offen
s_add_u32 s40, s29, 122880
buffer_store_dwordx4 v[140:143], v2, s[8:11], s40 offen
s_add_u32 s40, s29, 131072
buffer_store_dwordx4 v[144:147], v2, s[8:11], s40 offen
s_add_u32 s40, s29, 139264
buffer_store_dwordx4 v[148:151], v2, s[8:11], s40 offen
s_branch L_prep_end
L_pack_o:
s_sub_u32 s20, s20, 992
s_mul_i32 s21, s20, 13108
s_lshr_b32 s21, s21, 16
s_mul_i32 s22, s21, 5
s_sub_u32 s22, s20, s22
s_load_dwordx2 s[12:13], s[0:1], 16
s_waitcnt lgkmcnt(0)
s_mov_b32 s16, s12
s_and_b32 s17, s13, 0xffff
s_mov_b32 s18, 663552
s_mov_b32 s19, 0x20000
s_lshr_b32 s25, s22, 1
s_lshl_b32 s25, s25, 5
s_and_b32 s26, s22, 1
s_lshl_b32 s26, s26, 2
s_add_u32 s25, s25, s26
s_mul_i32 s26, s21, 72
s_add_u32 s25, s25, s26
s_cmp_eq_u32 s22, 4
s_cselect_b64 vcc, -1, 0
s_cselect_b32 s24, 8, 16
v_cndmask_b32 v11, v10, v6, vcc
v_add_u32 v11, s25, v11
v_lshlrev_b32 v11, 1, v11
v_mov_b32 v12, 2146435072
v_cmp_gt_u32 vcc, s24, v6
s_nop 1
v_cndmask_b32 v11, v12, v11, vcc
v_mul_u32_u24 v12, 4608, v7
v_add_u32 v4, v11, v12
v_mul_u32_u24 v12, 82944, v7
v_add_u32 v5, v11, v12
s_mov_b32 s40, 0
buffer_load_ushort v16, v4, s[16:19], s40 offen
s_mov_b32 s40, 1152
buffer_load_ushort v17, v4, s[16:19], s40 offen
s_mov_b32 s40, 2304
buffer_load_ushort v18, v4, s[16:19], s40 offen
s_mov_b32 s40, 3456
buffer_load_ushort v19, v4, s[16:19], s40 offen
s_mov_b32 s40, 20736
buffer_load_ushort v20, v4, s[16:19], s40 offen
s_mov_b32 s40, 21888
buffer_load_ushort v21, v4, s[16:19], s40 offen
s_mov_b32 s40, 23040
buffer_load_ushort v22, v4, s[16:19], s40 offen
s_mov_b32 s40, 24192
buffer_load_ushort v23, v4, s[16:19], s40 offen
s_mov_b32 s40, 41472
buffer_load_ushort v24, v4, s[16:19], s40 offen
s_mov_b32 s40, 42624
buffer_load_ushort v25, v4, s[16:19], s40 offen
s_mov_b32 s40, 43776
buffer_load_ushort v26, v4, s[16:19], s40 offen
s_mov_b32 s40, 44928
buffer_load_ushort v27, v4, s[16:19], s40 offen
s_mov_b32 s40, 62208
buffer_load_ushort v28, v4, s[16:19], s40 offen
s_mov_b32 s40, 63360
buffer_load_ushort v29, v4, s[16:19], s40 offen
s_mov_b32 s40, 64512
buffer_load_ushort v30, v4, s[16:19], s40 offen
s_mov_b32 s40, 65664
buffer_load_ushort v31, v4, s[16:19], s40 offen
s_mov_b32 s40, 82944
buffer_load_ushort v32, v4, s[16:19], s40 offen
s_mov_b32 s40, 84096
buffer_load_ushort v33, v4, s[16:19], s40 offen
s_mov_b32 s40, 85248
buffer_load_ushort v34, v4, s[16:19], s40 offen
s_mov_b32 s40, 86400
buffer_load_ushort v35, v4, s[16:19], s40 offen
s_mov_b32 s40, 103680
buffer_load_ushort v36, v4, s[16:19], s40 offen
s_mov_b32 s40, 104832
buffer_load_ushort v37, v4, s[16:19], s40 offen
s_mov_b32 s40, 105984
buffer_load_ushort v38, v4, s[16:19], s40 offen
s_mov_b32 s40, 107136
buffer_load_ushort v39, v4, s[16:19], s40 offen
s_mov_b32 s40, 124416
buffer_load_ushort v40, v4, s[16:19], s40 offen
s_mov_b32 s40, 125568
buffer_load_ushort v41, v4, s[16:19], s40 offen
s_mov_b32 s40, 126720
buffer_load_ushort v42, v4, s[16:19], s40 offen
s_mov_b32 s40, 127872
buffer_load_ushort v43, v4, s[16:19], s40 offen
s_mov_b32 s40, 145152
buffer_load_ushort v44, v4, s[16:19], s40 offen
s_mov_b32 s40, 146304
buffer_load_ushort v45, v4, s[16:19], s40 offen
s_mov_b32 s40, 147456
buffer_load_ushort v46, v4, s[16:19], s40 offen
s_mov_b32 s40, 148608
buffer_load_ushort v47, v4, s[16:19], s40 offen
s_mov_b32 s40, 165888
buffer_load_ushort v48, v4, s[16:19], s40 offen
s_mov_b32 s40, 167040
buffer_load_ushort v49, v4, s[16:19], s40 offen
s_mov_b32 s40, 168192
buffer_load_ushort v50, v4, s[16:19], s40 offen
s_mov_b32 s40, 169344
buffer_load_ushort v51, v4, s[16:19], s40 offen
s_mov_b32 s40, 186624
buffer_load_ushort v52, v4, s[16:19], s40 offen
s_mov_b32 s40, 187776
buffer_load_ushort v53, v4, s[16:19], s40 offen
s_mov_b32 s40, 188928
buffer_load_ushort v54, v4, s[16:19], s40 offen
s_mov_b32 s40, 190080
buffer_load_ushort v55, v4, s[16:19], s40 offen
s_mov_b32 s40, 207360
buffer_load_ushort v56, v4, s[16:19], s40 offen
s_mov_b32 s40, 208512
buffer_load_ushort v57, v4, s[16:19], s40 offen
s_mov_b32 s40, 209664
buffer_load_ushort v58, v4, s[16:19], s40 offen
s_mov_b32 s40, 210816
buffer_load_ushort v59, v4, s[16:19], s40 offen
s_mov_b32 s40, 228096
buffer_load_ushort v60, v4, s[16:19], s40 offen
s_mov_b32 s40, 229248
buffer_load_ushort v61, v4, s[16:19], s40 offen
s_mov_b32 s40, 230400
buffer_load_ushort v62, v4, s[16:19], s40 offen
s_mov_b32 s40, 231552
buffer_load_ushort v63, v4, s[16:19], s40 offen
s_waitcnt vmcnt(40)
v_lshl_or_b32 v80, v17, 16, v16
v_lshl_or_b32 v81, v19, 16, v18
v_lshl_or_b32 v82, v21, 16, v20
v_lshl_or_b32 v83, v23, 16, v22
s_waitcnt vmcnt(32)
v_lshl_or_b32 v84, v25, 16, v24
v_lshl_or_b32 v85, v27, 16, v26
v_lshl_or_b32 v86, v29, 16, v28
v_lshl_or_b32 v87, v31, 16, v30
s_waitcnt vmcnt(24)
v_lshl_or_b32 v88, v33, 16, v32
v_lshl_or_b32 v89, v35, 16, v34
v_lshl_or_b32 v90, v37, 16, v36
v_lshl_or_b32 v91, v39, 16, v38
s_waitcnt vmcnt(16)
v_lshl_or_b32 v92, v41, 16, v40
v_lshl_or_b32 v93, v43, 16, v42
v_lshl_or_b32 v94, v45, 16, v44
v_lshl_or_b32 v95, v47, 16, v46
s_waitcnt vmcnt(8)
v_lshl_or_b32 v96, v49, 16, v48
v_lshl_or_b32 v97, v51, 16, v50
v_lshl_or_b32 v98, v53, 16, v52
v_lshl_or_b32 v99, v55, 16, v54
s_waitcnt vmcnt(0)
v_lshl_or_b32 v100, v57, 16, v56
v_lshl_or_b32 v101, v59, 16, v58
v_lshl_or_b32 v102, v61, 16, v60
v_lshl_or_b32 v103, v63, 16, v62
s_mov_b32 s40, 248832
buffer_load_ushort v16, v4, s[16:19], s40 offen
s_mov_b32 s40, 249984
buffer_load_ushort v17, v4, s[16:19], s40 offen
s_mov_b32 s40, 251136
buffer_load_ushort v18, v4, s[16:19], s40 offen
s_mov_b32 s40, 252288
buffer_load_ushort v19, v4, s[16:19], s40 offen
s_mov_b32 s40, 269568
buffer_load_ushort v20, v4, s[16:19], s40 offen
s_mov_b32 s40, 270720
buffer_load_ushort v21, v4, s[16:19], s40 offen
s_mov_b32 s40, 271872
buffer_load_ushort v22, v4, s[16:19], s40 offen
s_mov_b32 s40, 273024
buffer_load_ushort v23, v4, s[16:19], s40 offen
s_mov_b32 s40, 290304
buffer_load_ushort v24, v4, s[16:19], s40 offen
s_mov_b32 s40, 291456
buffer_load_ushort v25, v4, s[16:19], s40 offen
s_mov_b32 s40, 292608
buffer_load_ushort v26, v4, s[16:19], s40 offen
s_mov_b32 s40, 293760
buffer_load_ushort v27, v4, s[16:19], s40 offen
s_mov_b32 s40, 311040
buffer_load_ushort v28, v4, s[16:19], s40 offen
s_mov_b32 s40, 312192
buffer_load_ushort v29, v4, s[16:19], s40 offen
s_mov_b32 s40, 313344
buffer_load_ushort v30, v4, s[16:19], s40 offen
s_mov_b32 s40, 314496
buffer_load_ushort v31, v4, s[16:19], s40 offen
s_mov_b32 s40, 331776
buffer_load_ushort v32, v4, s[16:19], s40 offen
s_mov_b32 s40, 332928
buffer_load_ushort v33, v4, s[16:19], s40 offen
s_mov_b32 s40, 334080
buffer_load_ushort v34, v4, s[16:19], s40 offen
s_mov_b32 s40, 335232
buffer_load_ushort v35, v4, s[16:19], s40 offen
s_mov_b32 s40, 352512
buffer_load_ushort v36, v4, s[16:19], s40 offen
s_mov_b32 s40, 353664
buffer_load_ushort v37, v4, s[16:19], s40 offen
s_mov_b32 s40, 354816
buffer_load_ushort v38, v4, s[16:19], s40 offen
s_mov_b32 s40, 355968
buffer_load_ushort v39, v4, s[16:19], s40 offen
s_mov_b32 s40, 373248
buffer_load_ushort v40, v4, s[16:19], s40 offen
s_mov_b32 s40, 374400
buffer_load_ushort v41, v4, s[16:19], s40 offen
s_mov_b32 s40, 375552
buffer_load_ushort v42, v4, s[16:19], s40 offen
s_mov_b32 s40, 376704
buffer_load_ushort v43, v4, s[16:19], s40 offen
s_mov_b32 s40, 393984
buffer_load_ushort v44, v4, s[16:19], s40 offen
s_mov_b32 s40, 395136
buffer_load_ushort v45, v4, s[16:19], s40 offen
s_mov_b32 s40, 396288
buffer_load_ushort v46, v4, s[16:19], s40 offen
s_mov_b32 s40, 397440
buffer_load_ushort v47, v4, s[16:19], s40 offen
s_mov_b32 s40, 414720
buffer_load_ushort v48, v4, s[16:19], s40 offen
s_mov_b32 s40, 415872
buffer_load_ushort v49, v4, s[16:19], s40 offen
s_mov_b32 s40, 417024
buffer_load_ushort v50, v4, s[16:19], s40 offen
s_mov_b32 s40, 418176
buffer_load_ushort v51, v4, s[16:19], s40 offen
s_mov_b32 s40, 435456
buffer_load_ushort v52, v4, s[16:19], s40 offen
s_mov_b32 s40, 436608
buffer_load_ushort v53, v4, s[16:19], s40 offen
s_mov_b32 s40, 437760
buffer_load_ushort v54, v4, s[16:19], s40 offen
s_mov_b32 s40, 438912
buffer_load_ushort v55, v4, s[16:19], s40 offen
s_mov_b32 s40, 456192
buffer_load_ushort v56, v4, s[16:19], s40 offen
s_mov_b32 s40, 457344
buffer_load_ushort v57, v4, s[16:19], s40 offen
s_mov_b32 s40, 458496
buffer_load_ushort v58, v4, s[16:19], s40 offen
s_mov_b32 s40, 459648
buffer_load_ushort v59, v4, s[16:19], s40 offen
s_mov_b32 s40, 476928
buffer_load_ushort v60, v4, s[16:19], s40 offen
s_mov_b32 s40, 478080
buffer_load_ushort v61, v4, s[16:19], s40 offen
s_mov_b32 s40, 479232
buffer_load_ushort v62, v4, s[16:19], s40 offen
s_mov_b32 s40, 480384
buffer_load_ushort v63, v4, s[16:19], s40 offen
s_waitcnt vmcnt(40)
v_lshl_or_b32 v104, v17, 16, v16
v_lshl_or_b32 v105, v19, 16, v18
v_lshl_or_b32 v106, v21, 16, v20
v_lshl_or_b32 v107, v23, 16, v22
s_waitcnt vmcnt(32)
v_lshl_or_b32 v108, v25, 16, v24
v_lshl_or_b32 v109, v27, 16, v26
v_lshl_or_b32 v110, v29, 16, v28
v_lshl_or_b32 v111, v31, 16, v30
s_waitcnt vmcnt(24)
v_lshl_or_b32 v112, v33, 16, v32
v_lshl_or_b32 v113, v35, 16, v34
v_lshl_or_b32 v114, v37, 16, v36
v_lshl_or_b32 v115, v39, 16, v38
s_waitcnt vmcnt(16)
v_lshl_or_b32 v116, v41, 16, v40
v_lshl_or_b32 v117, v43, 16, v42
v_lshl_or_b32 v118, v45, 16, v44
v_lshl_or_b32 v119, v47, 16, v46
s_waitcnt vmcnt(8)
v_lshl_or_b32 v120, v49, 16, v48
v_lshl_or_b32 v121, v51, 16, v50
v_lshl_or_b32 v122, v53, 16, v52
v_lshl_or_b32 v123, v55, 16, v54
s_waitcnt vmcnt(0)
v_lshl_or_b32 v124, v57, 16, v56
v_lshl_or_b32 v125, v59, 16, v58
v_lshl_or_b32 v126, v61, 16, v60
v_lshl_or_b32 v127, v63, 16, v62
s_mov_b32 s40, 497664
buffer_load_ushort v16, v4, s[16:19], s40 offen
s_mov_b32 s40, 498816
buffer_load_ushort v17, v4, s[16:19], s40 offen
s_mov_b32 s40, 499968
buffer_load_ushort v18, v4, s[16:19], s40 offen
s_mov_b32 s40, 501120
buffer_load_ushort v19, v4, s[16:19], s40 offen
s_mov_b32 s40, 518400
buffer_load_ushort v20, v4, s[16:19], s40 offen
s_mov_b32 s40, 519552
buffer_load_ushort v21, v4, s[16:19], s40 offen
s_mov_b32 s40, 520704
buffer_load_ushort v22, v4, s[16:19], s40 offen
s_mov_b32 s40, 521856
buffer_load_ushort v23, v4, s[16:19], s40 offen
s_mov_b32 s40, 539136
buffer_load_ushort v24, v4, s[16:19], s40 offen
s_mov_b32 s40, 540288
buffer_load_ushort v25, v4, s[16:19], s40 offen
s_mov_b32 s40, 541440
buffer_load_ushort v26, v4, s[16:19], s40 offen
s_mov_b32 s40, 542592
buffer_load_ushort v27, v4, s[16:19], s40 offen
s_mov_b32 s40, 559872
buffer_load_ushort v28, v4, s[16:19], s40 offen
s_mov_b32 s40, 561024
buffer_load_ushort v29, v4, s[16:19], s40 offen
s_mov_b32 s40, 562176
buffer_load_ushort v30, v4, s[16:19], s40 offen
s_mov_b32 s40, 563328
buffer_load_ushort v31, v4, s[16:19], s40 offen
s_mov_b32 s40, 580608
buffer_load_ushort v32, v4, s[16:19], s40 offen
s_mov_b32 s40, 581760
buffer_load_ushort v33, v4, s[16:19], s40 offen
s_mov_b32 s40, 582912
buffer_load_ushort v34, v4, s[16:19], s40 offen
s_mov_b32 s40, 584064
buffer_load_ushort v35, v4, s[16:19], s40 offen
s_mov_b32 s40, 601344
buffer_load_ushort v36, v4, s[16:19], s40 offen
s_mov_b32 s40, 602496
buffer_load_ushort v37, v4, s[16:19], s40 offen
s_mov_b32 s40, 603648
buffer_load_ushort v38, v4, s[16:19], s40 offen
s_mov_b32 s40, 604800
buffer_load_ushort v39, v4, s[16:19], s40 offen
s_mov_b32 s40, 622080
buffer_load_ushort v40, v4, s[16:19], s40 offen
s_mov_b32 s40, 623232
buffer_load_ushort v41, v4, s[16:19], s40 offen
s_mov_b32 s40, 624384
buffer_load_ushort v42, v4, s[16:19], s40 offen
s_mov_b32 s40, 625536
buffer_load_ushort v43, v4, s[16:19], s40 offen
s_mov_b32 s40, 642816
buffer_load_ushort v44, v4, s[16:19], s40 offen
s_mov_b32 s40, 643968
buffer_load_ushort v45, v4, s[16:19], s40 offen
s_mov_b32 s40, 645120
buffer_load_ushort v46, v4, s[16:19], s40 offen
s_mov_b32 s40, 646272
buffer_load_ushort v47, v4, s[16:19], s40 offen
s_mov_b32 s40, 18432
buffer_load_ushort v48, v5, s[16:19], s40 offen
s_mov_b32 s40, 19584
buffer_load_ushort v49, v5, s[16:19], s40 offen
s_mov_b32 s40, 39168
buffer_load_ushort v50, v5, s[16:19], s40 offen
s_mov_b32 s40, 40320
buffer_load_ushort v51, v5, s[16:19], s40 offen
s_mov_b32 s40, 59904
buffer_load_ushort v52, v5, s[16:19], s40 offen
s_mov_b32 s40, 61056
buffer_load_ushort v53, v5, s[16:19], s40 offen
s_mov_b32 s40, 80640
buffer_load_ushort v54, v5, s[16:19], s40 offen
s_mov_b32 s40, 81792
buffer_load_ushort v55, v5, s[16:19], s40 offen
s_mov_b32 s40, 350208
buffer_load_ushort v56, v5, s[16:19], s40 offen
s_mov_b32 s40, 351360
buffer_load_ushort v57, v5, s[16:19], s40 offen
s_mov_b32 s40, 370944
buffer_load_ushort v58, v5, s[16:19], s40 offen
s_mov_b32 s40, 372096
buffer_load_ushort v59, v5, s[16:19], s40 offen
s_mov_b32 s40, 391680
buffer_load_ushort v60, v5, s[16:19], s40 offen
s_mov_b32 s40, 392832
buffer_load_ushort v61, v5, s[16:19], s40 offen
s_mov_b32 s40, 412416
buffer_load_ushort v62, v5, s[16:19], s40 offen
s_mov_b32 s40, 413568
buffer_load_ushort v63, v5, s[16:19], s40 offen
s_waitcnt vmcnt(40)
v_lshl_or_b32 v128, v17, 16, v16
v_lshl_or_b32 v129, v19, 16, v18
v_lshl_or_b32 v130, v21, 16, v20
v_lshl_or_b32 v131, v23, 16, v22
s_waitcnt vmcnt(32)
v_lshl_or_b32 v132, v25, 16, v24
v_lshl_or_b32 v133, v27, 16, v26
v_lshl_or_b32 v134, v29, 16, v28
v_lshl_or_b32 v135, v31, 16, v30
s_waitcnt vmcnt(24)
v_lshl_or_b32 v136, v33, 16, v32
v_lshl_or_b32 v137, v35, 16, v34
v_lshl_or_b32 v138, v37, 16, v36
v_lshl_or_b32 v139, v39, 16, v38
s_waitcnt vmcnt(16)
v_lshl_or_b32 v140, v41, 16, v40
v_lshl_or_b32 v141, v43, 16, v42
v_lshl_or_b32 v142, v45, 16, v44
v_lshl_or_b32 v143, v47, 16, v46
s_waitcnt vmcnt(8)
v_lshl_or_b32 v144, v49, 16, v48
v_lshl_or_b32 v145, v51, 16, v50
v_lshl_or_b32 v146, v53, 16, v52
v_lshl_or_b32 v147, v55, 16, v54
s_waitcnt vmcnt(0)
v_lshl_or_b32 v148, v57, 16, v56
v_lshl_or_b32 v149, v59, 16, v58
v_lshl_or_b32 v150, v61, 16, v60
v_lshl_or_b32 v151, v63, 16, v62
s_mul_i32 s29, s21, 92160
s_lshl_b32 s30, s22, 10
s_add_u32 s29, s29, s30
s_add_u32 s29, s29, 2621440
s_add_u32 s40, s29, 0
buffer_store_dwordx4 v[80:83], v2, s[8:11], s40 offen
s_add_u32 s40, s29, 5120
buffer_store_dwordx4 v[84:87], v2, s[8:11], s40 offen
s_add_u32 s40, s29, 10240
buffer_store_dwordx4 v[88:91], v2, s[8:11], s40 offen
s_add_u32 s40, s29, 15360
buffer_store_dwordx4 v[92:95], v2, s[8:11], s40 offen
s_add_u32 s40, s29, 20480
buffer_store_dwordx4 v[96:99], v2, s[8:11], s40 offen
s_add_u32 s40, s29, 25600
buffer_store_dwordx4 v[100:103], v2, s[8:11], s40 offen
s_add_u32 s40, s29, 30720
buffer_store_dwordx4 v[104:107], v2, s[8:11], s40 offen
s_add_u32 s40, s29, 35840
buffer_store_dwordx4 v[108:111], v2, s[8:11], s40 offen
s_add_u32 s40, s29, 40960
buffer_store_dwordx4 v[112:115], v2, s[8:11], s40 offen
s_add_u32 s40, s29, 46080
buffer_store_dwordx4 v[116:119], v2, s[8:11], s40 offen
s_add_u32 s40, s29, 51200
buffer_store_dwordx4 v[120:123], v2, s[8:11], s40 offen
s_add_u32 s40, s29, 56320
buffer_store_dwordx4 v[124:127], v2, s[8:11], s40 offen
s_add_u32 s40, s29, 61440
buffer_store_dwordx4 v[128:131], v2, s[8:11], s40 offen
s_add_u32 s40, s29, 66560
buffer_store_dwordx4 v[132:135], v2, s[8:11], s40 offen
s_add_u32 s40, s29, 71680
buffer_store_dwordx4 v[136:139], v2, s[8:11], s40 offen
s_add_u32 s40, s29, 76800
buffer_store_dwordx4 v[140:143], v2, s[8:11], s40 offen
s_add_u32 s40, s29, 81920
buffer_store_dwordx4 v[144:147], v2, s[8:11], s40 offen
s_add_u32 s40, s29, 87040
buffer_store_dwordx4 v[148:151], v2, s[8:11], s40 offen
L_prep_end:
s_endpgm
.p2align 8
.globl main_kernel
.type main_kernel,@function
main_kernel:
s_cmp_ge_u32 s2, 256
s_cbranch_scc1 L_end
s_load_dwordx2 s[12:13], s[0:1], 72
v_and_b32 v1, 63, v0
v_lshrrev_b32 v3, 6, v0
v_lshlrev_b32 v2, 4, v1
v_readfirstlane_b32 s4, v3
s_and_b32 s5, s2, 7
s_lshr_b32 s6, s2, 3
s_waitcnt lgkmcnt(0)
s_mov_b32 s8, s12
s_and_b32 s9, s13, 0xffff
s_mov_b32 s10, 268435456
s_mov_b32 s11, 0x20000
s_mov_b32 s70, 19324928
s_mov_b32 s71, 24043520
s_mov_b32 s72, 28762112
s_mov_b32 s73, 33480704
s_mov_b32 s74, 38199296
s_mov_b32 s75, 38461440
s_mov_b32 s76, 76210176
s_mov_b32 s77, 0
s_mov_b32 s7, 0
s_lshr_b32 s20, s6, 4
s_lshl_b32 s21, s5, 1
s_add_u32 s20, s20, s21
s_and_b32 s21, s6, 15
s_mul_i32 s22, s21, 147456
s_add_u32 s22, s22, 262144
s_mul_i32 s23, s4, 36864
s_add_u32 s22, s22, s23
s_add_u32 m0, s23, 0
s_add_u32 s40, s22, 0
buffer_load_dwordx4 v2, s[8:11], s40 offen offset:0 lds
buffer_load_dwordx4 v2, s[8:11], s40 offen offset:1024 lds
buffer_load_dwordx4 v2, s[8:11], s40 offen offset:2048 lds
buffer_load_dwordx4 v2, s[8:11], s40 offen offset:3072 lds
s_add_u32 m0, s23, 4096
s_add_u32 s40, s22, 4096
buffer_load_dwordx4 v2, s[8:11], s40 offen offset:0 lds
buffer_load_dwordx4 v2, s[8:11], s40 offen offset:1024 lds
buffer_load_dwordx4 v2, s[8:11], s40 offen offset:2048 lds
buffer_load_dwordx4 v2, s[8:11], s40 offen offset:3072 lds
s_add_u32 m0, s23, 8192
s_add_u32 s40, s22, 8192
buffer_load_dwordx4 v2, s[8:11], s40 offen offset:0 lds
buffer_load_dwordx4 v2, s[8:11], s40 offen offset:1024 lds
buffer_load_dwordx4 v2, s[8:11], s40 offen offset:2048 lds
buffer_load_dwordx4 v2, s[8:11], s40 offen offset:3072 lds
s_add_u32 m0, s23, 12288
s_add_u32 s40, s22, 12288
buffer_load_dwordx4 v2, s[8:11], s40 offen offset:0 lds
buffer_load_dwordx4 v2, s[8:11], s40 offen offset:1024 lds
buffer_load_dwordx4 v2, s[8:11], s40 offen offset:2048 lds
buffer_load_dwordx4 v2, s[8:11], s40 offen offset:3072 lds
s_add_u32 m0, s23, 16384
s_add_u32 s40, s22, 16384
buffer_load_dwordx4 v2, s[8:11], s40 offen offset:0 lds
buffer_load_dwordx4 v2, s[8:11], s40 offen offset:1024 lds
buffer_load_dwordx4 v2, s[8:11], s40 offen offset:2048 lds
buffer_load_dwordx4 v2, s[8:11], s40 offen offset:3072 lds
s_add_u32 m0, s23, 20480
s_add_u32 s40, s22, 20480
buffer_load_dwordx4 v2, s[8:11], s40 offen offset:0 lds
buffer_load_dwordx4 v2, s[8:11], s40 offen offset:1024 lds
buffer_load_dwordx4 v2, s[8:11], s40 offen offset:2048 lds
buffer_load_dwordx4 v2, s[8:11], s40 offen offset:3072 lds
s_add_u32 m0, s23, 24576
s_add_u32 s40, s22, 24576
buffer_load_dwordx4 v2, s[8:11], s40 offen offset:0 lds
buffer_load_dwordx4 v2, s[8:11], s40 offen offset:1024 lds
buffer_load_dwordx4 v2, s[8:11], s40 offen offset:2048 lds
buffer_load_dwordx4 v2, s[8:11], s40 offen offset:3072 lds
s_add_u32 m0, s23, 28672
s_add_u32 s40, s22, 28672
buffer_load_dwordx4 v2, s[8:11], s40 offen offset:0 lds
buffer_load_dwordx4 v2, s[8:11], s40 offen offset:1024 lds
buffer_load_dwordx4 v2, s[8:11], s40 offen offset:2048 lds
buffer_load_dwordx4 v2, s[8:11], s40 offen offset:3072 lds
s_add_u32 m0, s23, 32768
s_add_u32 s40, s22, 32768
buffer_load_dwordx4 v2, s[8:11], s40 offen offset:0 lds
buffer_load_dwordx4 v2, s[8:11], s40 offen offset:1024 lds
buffer_load_dwordx4 v2, s[8:11], s40 offen offset:2048 lds
buffer_load_dwordx4 v2, s[8:11], s40 offen offset:3072 lds
L_layer:
s_lshl_b32 s24, s20, 3
s_sub_u32 s25, s24, 1
s_max_i32 s25, s25, 0
s_mul_i32 s25, s25, 18432
s_lshl_b32 s26, s4, 1
s_add_u32 s24, s24, s26
s_mul_i32 s24, s24, 18432
s_add_u32 s26, s24, s70
s_add_u32 s27, s26, 18432
s_add_u32 s28, s25, s70
buffer_load_dwordx4 a[0:3], v2, s[8:11], s26 offen offset:0 sc1
buffer_load_dwordx4 a[72:75], v2, s[8:11], s27 offen offset:0 sc1
buffer_load_dwordx4 a[144:147], v2, s[8:11], s28 offen offset:0 sc1
buffer_load_dwordx4 a[4:7], v2, s[8:11], s26 offen offset:1024 sc1
buffer_load_dwordx4 a[76:79], v2, s[8:11], s27 offen offset:1024 sc1
buffer_load_dwordx4 a[148:151], v2, s[8:11], s28 offen offset:1024 sc1
buffer_load_dwordx4 a[8:11], v2, s[8:11], s26 offen offset:2048 sc1
buffer_load_dwordx4 a[80:83], v2, s[8:11], s27 offen offset:2048 sc1
buffer_load_dwordx4 a[152:155], v2, s[8:11], s28 offen offset:2048 sc1
buffer_load_dwordx4 a[12:15], v2, s[8:11], s26 offen offset:3072 sc1
buffer_load_dwordx4 a[84:87], v2, s[8:11], s27 offen offset:3072 sc1
buffer_load_dwordx4 a[156:159], v2, s[8:11], s28 offen offset:3072 sc1
s_add_u32 s26, s26, 4096
s_add_u32 s27, s27, 4096
s_add_u32 s28, s28, 4096
buffer_load_dwordx4 a[16:19], v2, s[8:11], s26 offen offset:0 sc1
buffer_load_dwordx4 a[88:91], v2, s[8:11], s27 offen offset:0 sc1
buffer_load_dwordx4 a[160:163], v2, s[8:11], s28 offen offset:0 sc1
buffer_load_dwordx4 a[20:23], v2, s[8:11], s26 offen offset:1024 sc1
buffer_load_dwordx4 a[92:95], v2, s[8:11], s27 offen offset:1024 sc1
buffer_load_dwordx4 a[164:167], v2, s[8:11], s28 offen offset:1024 sc1
buffer_load_dwordx4 a[24:27], v2, s[8:11], s26 offen offset:2048 sc1
buffer_load_dwordx4 a[96:99], v2, s[8:11], s27 offen offset:2048 sc1
buffer_load_dwordx4 a[168:171], v2, s[8:11], s28 offen offset:2048 sc1
buffer_load_dwordx4 a[28:31], v2, s[8:11], s26 offen offset:3072 sc1
buffer_load_dwordx4 a[100:103], v2, s[8:11], s27 offen offset:3072 sc1
buffer_load_dwordx4 a[172:175], v2, s[8:11], s28 offen offset:3072 sc1
s_add_u32 s26, s26, 4096
s_add_u32 s27, s27, 4096
s_add_u32 s28, s28, 4096
buffer_load_dwordx4 a[32:35], v2, s[8:11], s26 offen offset:0 sc1
buffer_load_dwordx4 a[104:107], v2, s[8:11], s27 offen offset:0 sc1
buffer_load_dwordx4 a[176:179], v2, s[8:11], s28 offen offset:0 sc1
buffer_load_dwordx4 a[36:39], v2, s[8:11], s26 offen offset:1024 sc1
buffer_load_dwordx4 a[108:111], v2, s[8:11], s27 offen offset:1024 sc1
buffer_load_dwordx4 a[180:183], v2, s[8:11], s28 offen offset:1024 sc1
buffer_load_dwordx4 a[40:43], v2, s[8:11], s26 offen offset:2048 sc1
buffer_load_dwordx4 a[112:115], v2, s[8:11], s27 offen offset:2048 sc1
buffer_load_dwordx4 a[184:187], v2, s[8:11], s28 offen offset:2048 sc1
buffer_load_dwordx4 a[44:47], v2, s[8:11], s26 offen offset:3072 sc1
buffer_load_dwordx4 a[116:119], v2, s[8:11], s27 offen offset:3072 sc1
buffer_load_dwordx4 a[188:191], v2, s[8:11], s28 offen offset:3072 sc1
s_add_u32 s26, s26, 4096
s_add_u32 s27, s27, 4096
s_add_u32 s28, s28, 4096
buffer_load_dwordx4 a[48:51], v2, s[8:11], s26 offen offset:0 sc1
buffer_load_dwordx4 a[120:123], v2, s[8:11], s27 offen offset:0 sc1
buffer_load_dwordx4 a[192:195], v2, s[8:11], s28 offen offset:0 sc1
buffer_load_dwordx4 a[52:55], v2, s[8:11], s26 offen offset:1024 sc1
buffer_load_dwordx4 a[124:127], v2, s[8:11], s27 offen offset:1024 sc1
buffer_load_dwordx4 a[196:199], v2, s[8:11], s28 offen offset:1024 sc1
buffer_load_dwordx4 a[56:59], v2, s[8:11], s26 offen offset:2048 sc1
buffer_load_dwordx4 a[128:131], v2, s[8:11], s27 offen offset:2048 sc1
buffer_load_dwordx4 a[200:203], v2, s[8:11], s28 offen offset:2048 sc1
buffer_load_dwordx4 a[60:63], v2, s[8:11], s26 offen offset:3072 sc1
buffer_load_dwordx4 a[132:135], v2, s[8:11], s27 offen offset:3072 sc1
buffer_load_dwordx4 a[204:207], v2, s[8:11], s28 offen offset:3072 sc1
s_add_u32 s26, s26, 4096
s_add_u32 s27, s27, 4096
s_add_u32 s28, s28, 4096
buffer_load_dwordx4 a[64:67], v2, s[8:11], s26 offen offset:0 sc1
buffer_load_dwordx4 a[136:139], v2, s[8:11], s27 offen offset:0 sc1
buffer_load_dwordx4 a[208:211], v2, s[8:11], s28 offen offset:0 sc1
buffer_load_dwordx4 a[68:71], v2, s[8:11], s26 offen offset:1024 sc1
buffer_load_dwordx4 a[140:143], v2, s[8:11], s27 offen offset:1024 sc1
buffer_load_dwordx4 a[212:215], v2, s[8:11], s28 offen offset:1024 sc1
v_add_u32 v4, 0x10000, v2
v_add_u32 v5, 0x20000, v2
s_cmp_eq_u32 s4, 3
s_cselect_b32 s29, 0, s4
s_lshl_b32 s30, s29, 10
s_add_u32 s31, s30, 2048
v_add_u32 v6, s31, v2
v_add_u32 v7, s31, v4
v_add_u32 v8, s31, v5
s_add_u32 s31, s30, 5120
v_add_u32 v9, s31, v2
v_add_u32 v10, s31, v4
v_add_u32 v11, s31, v5
v_and_b32 v12, 15, v1
v_lshrrev_b32 v13, 4, v1
v_lshlrev_b32 v14, 2, v13
v_sub_u32 v14, v12, v14
v_subrev_u32 v15, 0, v14
v_cmp_gt_u32 s[52:53], 8, v15
v_cmp_gt_i32 s[44:45], -8, v15
v_subrev_u32 v15, 1, v14
v_cmp_gt_u32 s[54:55], 8, v15
v_cmp_gt_i32 s[46:47], -8, v15
v_subrev_u32 v15, 2, v14
v_cmp_gt_u32 s[56:57], 8, v15
v_cmp_gt_i32 s[48:49], -8, v15
v_subrev_u32 v15, 3, v14
v_cmp_gt_u32 s[58:59], 8, v15
v_cmp_gt_i32 s[50:51], -8, v15
s_and_b32 s31, s20, 7
s_or_b32 s31, s31, s4
s_cmp_eq_u32 s31, 0
s_cselect_b64 s[60:61], 0, s[44:45]
s_cselect_b64 s[62:63], 0, s[46:47]
s_cselect_b64 s[64:65], 0, s[48:49]
s_cselect_b64 s[66:67], 0, s[50:51]
s_waitcnt vmcnt(54)
s_barrier
ds_read_b128 a[216:219], v2 offset:0
ds_read_b128 a[220:223], v2 offset:8192
ds_read_b128 a[224:227], v2 offset:1024
ds_read_b128 a[228:231], v2 offset:9216
ds_read_b128 a[232:235], v2 offset:2048
ds_read_b128 a[236:239], v2 offset:10240
s_waitcnt vmcnt(48)
s_waitcnt lgkmcnt(4)
v_mfma_f32_16x16x32_bf16 v[32:35], a[216:219], a[0:3], 0
v_mfma_f32_16x16x32_bf16 v[32:35], a[220:223], a[4:7], v[32:35]
ds_read_b128 a[240:243], v2 offset:3072
v_mfma_f32_16x16x32_bf16 v[36:39], a[216:219], a[72:75], 0
v_mfma_f32_16x16x32_bf16 v[36:39], a[220:223], a[76:79], v[36:39]
ds_read_b128 a[244:247], v2 offset:11264
s_waitcnt lgkmcnt(4)
v_mfma_f32_16x16x32_bf16 v[40:43], a[224:227], a[0:3], 0
v_mfma_f32_16x16x32_bf16 v[40:43], a[228:231], a[4:7], v[40:43]
ds_read_b128 a[216:219], v2 offset:4096
v_mfma_f32_16x16x32_bf16 v[44:47], a[224:227], a[72:75], 0
v_mfma_f32_16x16x32_bf16 v[44:47], a[228:231], a[76:79], v[44:47]
ds_read_b128 a[220:223], v2 offset:12288
s_waitcnt lgkmcnt(4)
v_mfma_f32_16x16x32_bf16 v[48:51], a[232:235], a[0:3], 0
v_mfma_f32_16x16x32_bf16 v[48:51], a[236:239], a[4:7], v[48:51]
ds_read_b128 a[224:227], v2 offset:5120
v_mfma_f32_16x16x32_bf16 v[52:55], a[232:235], a[72:75], 0
v_mfma_f32_16x16x32_bf16 v[52:55], a[236:239], a[76:79], v[52:55]
ds_read_b128 a[228:231], v2 offset:13312
s_waitcnt lgkmcnt(4)
v_mfma_f32_16x16x32_bf16 v[56:59], a[240:243], a[0:3], 0
v_mfma_f32_16x16x32_bf16 v[56:59], a[244:247], a[4:7], v[56:59]
ds_read_b128 a[232:235], v2 offset:6144
v_mfma_f32_16x16x32_bf16 v[60:63], a[240:243], a[72:75], 0
v_mfma_f32_16x16x32_bf16 v[60:63], a[244:247], a[76:79], v[60:63]
ds_read_b128 a[236:239], v2 offset:14336
s_waitcnt lgkmcnt(4)
v_mfma_f32_16x16x32_bf16 v[64:67], a[216:219], a[0:3], 0
v_mfma_f32_16x16x32_bf16 v[64:67], a[220:223], a[4:7], v[64:67]
ds_read_b128 a[240:243], v2 offset:7168
v_mfma_f32_16x16x32_bf16 v[68:71], a[216:219], a[72:75], 0
v_mfma_f32_16x16x32_bf16 v[68:71], a[220:223], a[76:79], v[68:71]
ds_read_b128 a[244:247], v2 offset:15360
s_waitcnt lgkmcnt(4)
v_mfma_f32_16x16x32_bf16 v[72:75], a[0:3], a[224:227], 0
v_mfma_f32_16x16x32_bf16 v[72:75], a[4:7], a[228:231], v[72:75]
ds_read_b128 a[216:219], v6 offset:0
v_mfma_f32_16x16x32_bf16 v[76:79], a[72:75], a[224:227], 0
v_mfma_f32_16x16x32_bf16 v[76:79], a[76:79], a[228:231], v[76:79]
ds_read_b128 a[220:223], v6 offset:8192
s_waitcnt lgkmcnt(4)
v_mfma_f32_16x16x32_bf16 v[80:83], a[0:3], a[232:235], 0
v_mfma_f32_16x16x32_bf16 v[80:83], a[4:7], a[236:239], v[80:83]
ds_read_b128 a[224:227], v9 offset:0
v_mfma_f32_16x16x32_bf16 v[84:87], a[72:75], a[232:235], 0
v_mfma_f32_16x16x32_bf16 v[84:87], a[76:79], a[236:239], v[84:87]
ds_read_b128 a[228:231], v9 offset:8192
s_waitcnt lgkmcnt(4)
v_mfma_f32_16x16x32_bf16 v[88:91], a[0:3], a[240:243], 0
v_mfma_f32_16x16x32_bf16 v[88:91], a[4:7], a[244:247], v[88:91]
ds_read_b128 a[232:235], v2 offset:16384
v_mfma_f32_16x16x32_bf16 v[92:95], a[72:75], a[240:243], 0
v_mfma_f32_16x16x32_bf16 v[92:95], a[76:79], a[244:247], v[92:95]
ds_read_b128 a[236:239], v2 offset:24576
s_waitcnt lgkmcnt(4)
v_mfma_f32_16x16x32_bf16 v[96:99], a[216:219], a[144:147], 0
ds_read_b128 a[240:243], v2 offset:17408
v_mfma_f32_16x16x32_bf16 v[96:99], a[220:223], a[148:151], v[96:99]
ds_read_b128 a[244:247], v2 offset:25600
s_waitcnt lgkmcnt(4)
v_mfma_f32_16x16x32_bf16 v[100:103], a[144:147], a[224:227], 0
ds_read_b128 a[216:219], v2 offset:18432
v_mfma_f32_16x16x32_bf16 v[100:103], a[148:151], a[228:231], v[100:103]
ds_read_b128 a[220:223], v2 offset:26624
s_waitcnt vmcnt(42)
s_waitcnt lgkmcnt(4)
v_mfma_f32_16x16x32_bf16 v[32:35], a[232:235], a[8:11], v[32:35]
v_mfma_f32_16x16x32_bf16 v[32:35], a[236:239], a[12:15], v[32:35]
ds_read_b128 a[224:227], v2 offset:19456
v_mfma_f32_16x16x32_bf16 v[36:39], a[232:235], a[80:83], v[36:39]
v_mfma_f32_16x16x32_bf16 v[36:39], a[236:239], a[84:87], v[36:39]
ds_read_b128 a[228:231], v2 offset:27648
s_waitcnt lgkmcnt(4)
v_mfma_f32_16x16x32_bf16 v[40:43], a[240:243], a[8:11], v[40:43]
v_mfma_f32_16x16x32_bf16 v[40:43], a[244:247], a[12:15], v[40:43]
ds_read_b128 a[232:235], v2 offset:20480
v_mfma_f32_16x16x32_bf16 v[44:47], a[240:243], a[80:83], v[44:47]
v_mfma_f32_16x16x32_bf16 v[44:47], a[244:247], a[84:87], v[44:47]
ds_read_b128 a[236:239], v2 offset:28672
s_waitcnt lgkmcnt(4)
v_mfma_f32_16x16x32_bf16 v[48:51], a[216:219], a[8:11], v[48:51]
v_mfma_f32_16x16x32_bf16 v[48:51], a[220:223], a[12:15], v[48:51]
ds_read_b128 a[240:243], v2 offset:21504
v_mfma_f32_16x16x32_bf16 v[52:55], a[216:219], a[80:83], v[52:55]
v_mfma_f32_16x16x32_bf16 v[52:55], a[220:223], a[84:87], v[52:55]
ds_read_b128 a[244:247], v2 offset:29696
s_waitcnt lgkmcnt(4)
v_mfma_f32_16x16x32_bf16 v[56:59], a[224:227], a[8:11], v[56:59]
v_mfma_f32_16x16x32_bf16 v[56:59], a[228:231], a[12:15], v[56:59]
ds_read_b128 a[216:219], v2 offset:22528
v_mfma_f32_16x16x32_bf16 v[60:63], a[224:227], a[80:83], v[60:63]
v_mfma_f32_16x16x32_bf16 v[60:63], a[228:231], a[84:87], v[60:63]
ds_read_b128 a[220:223], v2 offset:30720
s_waitcnt lgkmcnt(4)
v_mfma_f32_16x16x32_bf16 v[64:67], a[232:235], a[8:11], v[64:67]
v_mfma_f32_16x16x32_bf16 v[64:67], a[236:239], a[12:15], v[64:67]
ds_read_b128 a[224:227], v2 offset:23552
v_mfma_f32_16x16x32_bf16 v[68:71], a[232:235], a[80:83], v[68:71]
v_mfma_f32_16x16x32_bf16 v[68:71], a[236:239], a[84:87], v[68:71]
ds_read_b128 a[228:231], v2 offset:31744
s_waitcnt lgkmcnt(4)
v_mfma_f32_16x16x32_bf16 v[72:75], a[8:11], a[240:243], v[72:75]
v_mfma_f32_16x16x32_bf16 v[72:75], a[12:15], a[244:247], v[72:75]
ds_read_b128 a[232:235], v6 offset:16384
v_mfma_f32_16x16x32_bf16 v[76:79], a[80:83], a[240:243], v[76:79]
v_mfma_f32_16x16x32_bf16 v[76:79], a[84:87], a[244:247], v[76:79]
ds_read_b128 a[236:239], v6 offset:24576
s_waitcnt lgkmcnt(4)
v_mfma_f32_16x16x32_bf16 v[80:83], a[8:11], a[216:219], v[80:83]
v_mfma_f32_16x16x32_bf16 v[80:83], a[12:15], a[220:223], v[80:83]
ds_read_b128 a[240:243], v9 offset:16384
v_mfma_f32_16x16x32_bf16 v[84:87], a[80:83], a[216:219], v[84:87]
v_mfma_f32_16x16x32_bf16 v[84:87], a[84:87], a[220:223], v[84:87]
ds_read_b128 a[244:247], v9 offset:24576
s_waitcnt lgkmcnt(4)
v_mfma_f32_16x16x32_bf16 v[88:91], a[8:11], a[224:227], v[88:91]
v_mfma_f32_16x16x32_bf16 v[88:91], a[12:15], a[228:231], v[88:91]
ds_read_b128 a[216:219], v2 offset:32768
v_mfma_f32_16x16x32_bf16 v[92:95], a[80:83], a[224:227], v[92:95]
v_mfma_f32_16x16x32_bf16 v[92:95], a[84:87], a[228:231], v[92:95]
ds_read_b128 a[220:223], v2 offset:40960
s_waitcnt lgkmcnt(4)
v_mfma_f32_16x16x32_bf16 v[96:99], a[232:235], a[152:155], v[96:99]
ds_read_b128 a[224:227], v2 offset:33792
v_mfma_f32_16x16x32_bf16 v[96:99], a[236:239], a[156:159], v[96:99]
ds_read_b128 a[228:231], v2 offset:41984
s_waitcnt lgkmcnt(4)
v_mfma_f32_16x16x32_bf16 v[100:103], a[152:155], a[240:243], v[100:103]
ds_read_b128 a[232:235], v2 offset:34816
v_mfma_f32_16x16x32_bf16 v[100:103], a[156:159], a[244:247], v[100:103]
ds_read_b128 a[236:239], v2 offset:43008
s_waitcnt vmcnt(36)
s_waitcnt lgkmcnt(4)
v_mfma_f32_16x16x32_bf16 v[32:35], a[216:219], a[16:19], v[32:35]
v_mfma_f32_16x16x32_bf16 v[32:35], a[220:223], a[20:23], v[32:35]
ds_read_b128 a[240:243], v2 offset:35840
v_mfma_f32_16x16x32_bf16 v[36:39], a[216:219], a[88:91], v[36:39]
v_mfma_f32_16x16x32_bf16 v[36:39], a[220:223], a[92:95], v[36:39]
ds_read_b128 a[244:247], v2 offset:44032
s_waitcnt lgkmcnt(4)
v_mfma_f32_16x16x32_bf16 v[40:43], a[224:227], a[16:19], v[40:43]
v_mfma_f32_16x16x32_bf16 v[40:43], a[228:231], a[20:23], v[40:43]
ds_read_b128 a[216:219], v2 offset:36864
v_mfma_f32_16x16x32_bf16 v[44:47], a[224:227], a[88:91], v[44:47]
v_mfma_f32_16x16x32_bf16 v[44:47], a[228:231], a[92:95], v[44:47]
ds_read_b128 a[220:223], v2 offset:45056
s_waitcnt lgkmcnt(4)
v_mfma_f32_16x16x32_bf16 v[48:51], a[232:235], a[16:19], v[48:51]
v_mfma_f32_16x16x32_bf16 v[48:51], a[236:239], a[20:23], v[48:51]
ds_read_b128 a[224:227], v2 offset:37888
v_mfma_f32_16x16x32_bf16 v[52:55], a[232:235], a[88:91], v[52:55]
v_mfma_f32_16x16x32_bf16 v[52:55], a[236:239], a[92:95], v[52:55]
ds_read_b128 a[228:231], v2 offset:46080
s_waitcnt lgkmcnt(4)
v_mfma_f32_16x16x32_bf16 v[56:59], a[240:243], a[16:19], v[56:59]
v_mfma_f32_16x16x32_bf16 v[56:59], a[244:247], a[20:23], v[56:59]
ds_read_b128 a[232:235], v2 offset:38912
v_mfma_f32_16x16x32_bf16 v[60:63], a[240:243], a[88:91], v[60:63]
v_mfma_f32_16x16x32_bf16 v[60:63], a[244:247], a[92:95], v[60:63]
ds_read_b128 a[236:239], v2 offset:47104
s_waitcnt lgkmcnt(4)
v_mfma_f32_16x16x32_bf16 v[64:67], a[216:219], a[16:19], v[64:67]
v_mfma_f32_16x16x32_bf16 v[64:67], a[220:223], a[20:23], v[64:67]
ds_read_b128 a[240:243], v2 offset:39936
v_mfma_f32_16x16x32_bf16 v[68:71], a[216:219], a[88:91], v[68:71]
v_mfma_f32_16x16x32_bf16 v[68:71], a[220:223], a[92:95], v[68:71]
ds_read_b128 a[244:247], v2 offset:48128
s_waitcnt lgkmcnt(4)
v_mfma_f32_16x16x32_bf16 v[72:75], a[16:19], a[224:227], v[72:75]
v_mfma_f32_16x16x32_bf16 v[72:75], a[20:23], a[228:231], v[72:75]
ds_read_b128 a[216:219], v6 offset:32768
v_mfma_f32_16x16x32_bf16 v[76:79], a[88:91], a[224:227], v[76:79]
v_mfma_f32_16x16x32_bf16 v[76:79], a[92:95], a[228:231], v[76:79]
ds_read_b128 a[220:223], v6 offset:40960
s_waitcnt lgkmcnt(4)
v_mfma_f32_16x16x32_bf16 v[80:83], a[16:19], a[232:235], v[80:83]
v_mfma_f32_16x16x32_bf16 v[80:83], a[20:23], a[236:239], v[80:83]
ds_read_b128 a[224:227], v9 offset:32768
v_mfma_f32_16x16x32_bf16 v[84:87], a[88:91], a[232:235], v[84:87]
v_mfma_f32_16x16x32_bf16 v[84:87], a[92:95], a[236:239], v[84:87]
ds_read_b128 a[228:231], v9 offset:40960
s_waitcnt lgkmcnt(4)
v_mfma_f32_16x16x32_bf16 v[88:91], a[16:19], a[240:243], v[88:91]
v_mfma_f32_16x16x32_bf16 v[88:91], a[20:23], a[244:247], v[88:91]
ds_read_b128 a[232:235], v2 offset:49152
v_mfma_f32_16x16x32_bf16 v[92:95], a[88:91], a[240:243], v[92:95]
v_mfma_f32_16x16x32_bf16 v[92:95], a[92:95], a[244:247], v[92:95]
ds_read_b128 a[236:239], v2 offset:57344
s_waitcnt lgkmcnt(4)
v_mfma_f32_16x16x32_bf16 v[96:99], a[216:219], a[160:163], v[96:99]
ds_read_b128 a[240:243], v2 offset:50176
v_mfma_f32_16x16x32_bf16 v[96:99], a[220:223], a[164:167], v[96:99]
ds_read_b128 a[244:247], v2 offset:58368
s_waitcnt lgkmcnt(4)
v_mfma_f32_16x16x32_bf16 v[100:103], a[160:163], a[224:227], v[100:103]
ds_read_b128 a[216:219], v2 offset:51200
v_mfma_f32_16x16x32_bf16 v[100:103], a[164:167], a[228:231], v[100:103]
ds_read_b128 a[220:223], v2 offset:59392
s_waitcnt vmcnt(30)
s_waitcnt lgkmcnt(4)
v_mfma_f32_16x16x32_bf16 v[32:35], a[232:235], a[24:27], v[32:35]
v_mfma_f32_16x16x32_bf16 v[32:35], a[236:239], a[28:31], v[32:35]
ds_read_b128 a[224:227], v2 offset:52224
v_mfma_f32_16x16x32_bf16 v[36:39], a[232:235], a[96:99], v[36:39]
v_mfma_f32_16x16x32_bf16 v[36:39], a[236:239], a[100:103], v[36:39]
ds_read_b128 a[228:231], v2 offset:60416
s_waitcnt lgkmcnt(4)
v_mfma_f32_16x16x32_bf16 v[40:43], a[240:243], a[24:27], v[40:43]
v_mfma_f32_16x16x32_bf16 v[40:43], a[244:247], a[28:31], v[40:43]
ds_read_b128 a[232:235], v2 offset:53248
v_mfma_f32_16x16x32_bf16 v[44:47], a[240:243], a[96:99], v[44:47]
v_mfma_f32_16x16x32_bf16 v[44:47], a[244:247], a[100:103], v[44:47]
ds_read_b128 a[236:239], v2 offset:61440
s_waitcnt lgkmcnt(4)
v_mfma_f32_16x16x32_bf16 v[48:51], a[216:219], a[24:27], v[48:51]
v_mfma_f32_16x16x32_bf16 v[48:51], a[220:223], a[28:31], v[48:51]
ds_read_b128 a[240:243], v2 offset:54272
v_mfma_f32_16x16x32_bf16 v[52:55], a[216:219], a[96:99], v[52:55]
v_mfma_f32_16x16x32_bf16 v[52:55], a[220:223], a[100:103], v[52:55]
ds_read_b128 a[244:247], v2 offset:62464
s_waitcnt lgkmcnt(4)
v_mfma_f32_16x16x32_bf16 v[56:59], a[224:227], a[24:27], v[56:59]
v_mfma_f32_16x16x32_bf16 v[56:59], a[228:231], a[28:31], v[56:59]
ds_read_b128 a[216:219], v2 offset:55296
v_mfma_f32_16x16x32_bf16 v[60:63], a[224:227], a[96:99], v[60:63]
v_mfma_f32_16x16x32_bf16 v[60:63], a[228:231], a[100:103], v[60:63]
ds_read_b128 a[220:223], v2 offset:63488
s_waitcnt lgkmcnt(4)
v_mfma_f32_16x16x32_bf16 v[64:67], a[232:235], a[24:27], v[64:67]
v_mfma_f32_16x16x32_bf16 v[64:67], a[236:239], a[28:31], v[64:67]
ds_read_b128 a[224:227], v2 offset:56320
v_mfma_f32_16x16x32_bf16 v[68:71], a[232:235], a[96:99], v[68:71]
v_mfma_f32_16x16x32_bf16 v[68:71], a[236:239], a[100:103], v[68:71]
ds_read_b128 a[228:231], v2 offset:64512
s_waitcnt lgkmcnt(4)
v_mfma_f32_16x16x32_bf16 v[72:75], a[24:27], a[240:243], v[72:75]
v_mfma_f32_16x16x32_bf16 v[72:75], a[28:31], a[244:247], v[72:75]
ds_read_b128 a[232:235], v6 offset:49152
v_mfma_f32_16x16x32_bf16 v[76:79], a[96:99], a[240:243], v[76:79]
v_mfma_f32_16x16x32_bf16 v[76:79], a[100:103], a[244:247], v[76:79]
ds_read_b128 a[236:239], v6 offset:57344
s_waitcnt lgkmcnt(4)
v_mfma_f32_16x16x32_bf16 v[80:83], a[24:27], a[216:219], v[80:83]
v_mfma_f32_16x16x32_bf16 v[80:83], a[28:31], a[220:223], v[80:83]
ds_read_b128 a[240:243], v9 offset:49152
v_mfma_f32_16x16x32_bf16 v[84:87], a[96:99], a[216:219], v[84:87]
v_mfma_f32_16x16x32_bf16 v[84:87], a[100:103], a[220:223], v[84:87]
ds_read_b128 a[244:247], v9 offset:57344
s_waitcnt lgkmcnt(4)
v_mfma_f32_16x16x32_bf16 v[88:91], a[24:27], a[224:227], v[88:91]
v_mfma_f32_16x16x32_bf16 v[88:91], a[28:31], a[228:231], v[88:91]
ds_read_b128 a[216:219], v4 offset:0
v_mfma_f32_16x16x32_bf16 v[92:95], a[96:99], a[224:227], v[92:95]
v_mfma_f32_16x16x32_bf16 v[92:95], a[100:103], a[228:231], v[92:95]
ds_read_b128 a[220:223], v4 offset:8192
s_waitcnt lgkmcnt(4)
v_mfma_f32_16x16x32_bf16 v[96:99], a[232:235], a[168:171], v[96:99]
ds_read_b128 a[224:227], v4 offset:1024
v_mfma_f32_16x16x32_bf16 v[96:99], a[236:239], a[172:175], v[96:99]
ds_read_b128 a[228:231], v4 offset:9216
s_waitcnt lgkmcnt(4)
v_mfma_f32_16x16x32_bf16 v[100:103], a[168:171], a[240:243], v[100:103]
ds_read_b128 a[232:235], v4 offset:2048
v_mfma_f32_16x16x32_bf16 v[100:103], a[172:175], a[244:247], v[100:103]
ds_read_b128 a[236:239], v4 offset:10240
s_waitcnt vmcnt(24)
s_waitcnt lgkmcnt(4)
v_mfma_f32_16x16x32_bf16 v[32:35], a[216:219], a[32:35], v[32:35]
v_mfma_f32_16x16x32_bf16 v[32:35], a[220:223], a[36:39], v[32:35]
ds_read_b128 a[240:243], v4 offset:3072
v_mfma_f32_16x16x32_bf16 v[36:39], a[216:219], a[104:107], v[36:39]
v_mfma_f32_16x16x32_bf16 v[36:39], a[220:223], a[108:111], v[36:39]
ds_read_b128 a[244:247], v4 offset:11264
s_waitcnt lgkmcnt(4)
v_mfma_f32_16x16x32_bf16 v[40:43], a[224:227], a[32:35], v[40:43]
v_mfma_f32_16x16x32_bf16 v[40:43], a[228:231], a[36:39], v[40:43]
ds_read_b128 a[216:219], v4 offset:4096
v_mfma_f32_16x16x32_bf16 v[44:47], a[224:227], a[104:107], v[44:47]
v_mfma_f32_16x16x32_bf16 v[44:47], a[228:231], a[108:111], v[44:47]
ds_read_b128 a[220:223], v4 offset:12288
s_waitcnt lgkmcnt(4)
v_mfma_f32_16x16x32_bf16 v[48:51], a[232:235], a[32:35], v[48:51]
v_mfma_f32_16x16x32_bf16 v[48:51], a[236:239], a[36:39], v[48:51]
ds_read_b128 a[224:227], v4 offset:5120
v_mfma_f32_16x16x32_bf16 v[52:55], a[232:235], a[104:107], v[52:55]
v_mfma_f32_16x16x32_bf16 v[52:55], a[236:239], a[108:111], v[52:55]
ds_read_b128 a[228:231], v4 offset:13312
s_waitcnt lgkmcnt(4)
v_mfma_f32_16x16x32_bf16 v[56:59], a[240:243], a[32:35], v[56:59]
v_mfma_f32_16x16x32_bf16 v[56:59], a[244:247], a[36:39], v[56:59]
ds_read_b128 a[232:235], v4 offset:6144
v_mfma_f32_16x16x32_bf16 v[60:63], a[240:243], a[104:107], v[60:63]
v_mfma_f32_16x16x32_bf16 v[60:63], a[244:247], a[108:111], v[60:63]
ds_read_b128 a[236:239], v4 offset:14336
s_waitcnt lgkmcnt(4)
v_mfma_f32_16x16x32_bf16 v[64:67], a[216:219], a[32:35], v[64:67]
v_mfma_f32_16x16x32_bf16 v[64:67], a[220:223], a[36:39], v[64:67]
ds_read_b128 a[240:243], v4 offset:7168
v_mfma_f32_16x16x32_bf16 v[68:71], a[216:219], a[104:107], v[68:71]
v_mfma_f32_16x16x32_bf16 v[68:71], a[220:223], a[108:111], v[68:71]
ds_read_b128 a[244:247], v4 offset:15360
s_waitcnt lgkmcnt(4)
v_mfma_f32_16x16x32_bf16 v[72:75], a[32:35], a[224:227], v[72:75]
v_mfma_f32_16x16x32_bf16 v[72:75], a[36:39], a[228:231], v[72:75]
ds_read_b128 a[216:219], v7 offset:0
v_mfma_f32_16x16x32_bf16 v[76:79], a[104:107], a[224:227], v[76:79]
v_mfma_f32_16x16x32_bf16 v[76:79], a[108:111], a[228:231], v[76:79]
ds_read_b128 a[220:223], v7 offset:8192
s_waitcnt lgkmcnt(4)
v_mfma_f32_16x16x32_bf16 v[80:83], a[32:35], a[232:235], v[80:83]
v_mfma_f32_16x16x32_bf16 v[80:83], a[36:39], a[236:239], v[80:83]
ds_read_b128 a[224:227], v10 offset:0
v_mfma_f32_16x16x32_bf16 v[84:87], a[104:107], a[232:235], v[84:87]
v_mfma_f32_16x16x32_bf16 v[84:87], a[108:111], a[236:239], v[84:87]
ds_read_b128 a[228:231], v10 offset:8192
s_waitcnt lgkmcnt(4)
v_mfma_f32_16x16x32_bf16 v[88:91], a[32:35], a[240:243], v[88:91]
v_mfma_f32_16x16x32_bf16 v[88:91], a[36:39], a[244:247], v[88:91]
ds_read_b128 a[232:235], v4 offset:16384
v_mfma_f32_16x16x32_bf16 v[92:95], a[104:107], a[240:243], v[92:95]
v_mfma_f32_16x16x32_bf16 v[92:95], a[108:111], a[244:247], v[92:95]
ds_read_b128 a[236:239], v4 offset:24576
s_waitcnt lgkmcnt(4)
v_mfma_f32_16x16x32_bf16 v[96:99], a[216:219], a[176:179], v[96:99]
ds_read_b128 a[240:243], v4 offset:17408
v_mfma_f32_16x16x32_bf16 v[96:99], a[220:223], a[180:183], v[96:99]
ds_read_b128 a[244:247], v4 offset:25600
s_waitcnt lgkmcnt(4)
v_mfma_f32_16x16x32_bf16 v[100:103], a[176:179], a[224:227], v[100:103]
ds_read_b128 a[216:219], v4 offset:18432
v_mfma_f32_16x16x32_bf16 v[100:103], a[180:183], a[228:231], v[100:103]
ds_read_b128 a[220:223], v4 offset:26624
s_waitcnt vmcnt(18)
s_waitcnt lgkmcnt(4)
v_mfma_f32_16x16x32_bf16 v[32:35], a[232:235], a[40:43], v[32:35]
v_mfma_f32_16x16x32_bf16 v[32:35], a[236:239], a[44:47], v[32:35]
ds_read_b128 a[224:227], v4 offset:19456
v_mfma_f32_16x16x32_bf16 v[36:39], a[232:235], a[112:115], v[36:39]
v_mfma_f32_16x16x32_bf16 v[36:39], a[236:239], a[116:119], v[36:39]
ds_read_b128 a[228:231], v4 offset:27648
s_waitcnt lgkmcnt(4)
v_mfma_f32_16x16x32_bf16 v[40:43], a[240:243], a[40:43], v[40:43]
v_mfma_f32_16x16x32_bf16 v[40:43], a[244:247], a[44:47], v[40:43]
ds_read_b128 a[232:235], v4 offset:20480
v_mfma_f32_16x16x32_bf16 v[44:47], a[240:243], a[112:115], v[44:47]
v_mfma_f32_16x16x32_bf16 v[44:47], a[244:247], a[116:119], v[44:47]
ds_read_b128 a[236:239], v4 offset:28672
s_waitcnt lgkmcnt(4)
v_mfma_f32_16x16x32_bf16 v[48:51], a[216:219], a[40:43], v[48:51]
v_mfma_f32_16x16x32_bf16 v[48:51], a[220:223], a[44:47], v[48:51]
ds_read_b128 a[240:243], v4 offset:21504
v_mfma_f32_16x16x32_bf16 v[52:55], a[216:219], a[112:115], v[52:55]
v_mfma_f32_16x16x32_bf16 v[52:55], a[220:223], a[116:119], v[52:55]
ds_read_b128 a[244:247], v4 offset:29696
s_waitcnt lgkmcnt(4)
v_mfma_f32_16x16x32_bf16 v[56:59], a[224:227], a[40:43], v[56:59]
v_mfma_f32_16x16x32_bf16 v[56:59], a[228:231], a[44:47], v[56:59]
ds_read_b128 a[216:219], v4 offset:22528
v_mfma_f32_16x16x32_bf16 v[60:63], a[224:227], a[112:115], v[60:63]
v_mfma_f32_16x16x32_bf16 v[60:63], a[228:231], a[116:119], v[60:63]
ds_read_b128 a[220:223], v4 offset:30720
s_waitcnt lgkmcnt(4)
v_mfma_f32_16x16x32_bf16 v[64:67], a[232:235], a[40:43], v[64:67]
v_mfma_f32_16x16x32_bf16 v[64:67], a[236:239], a[44:47], v[64:67]
ds_read_b128 a[224:227], v4 offset:23552
v_mfma_f32_16x16x32_bf16 v[68:71], a[232:235], a[112:115], v[68:71]
v_mfma_f32_16x16x32_bf16 v[68:71], a[236:239], a[116:119], v[68:71]
ds_read_b128 a[228:231], v4 offset:31744
s_waitcnt lgkmcnt(4)
v_mfma_f32_16x16x32_bf16 v[72:75], a[40:43], a[240:243], v[72:75]
v_mfma_f32_16x16x32_bf16 v[72:75], a[44:47], a[244:247], v[72:75]
ds_read_b128 a[232:235], v7 offset:16384
v_mfma_f32_16x16x32_bf16 v[76:79], a[112:115], a[240:243], v[76:79]
v_mfma_f32_16x16x32_bf16 v[76:79], a[116:119], a[244:247], v[76:79]
ds_read_b128 a[236:239], v7 offset:24576
s_waitcnt lgkmcnt(4)
v_mfma_f32_16x16x32_bf16 v[80:83], a[40:43], a[216:219], v[80:83]
v_mfma_f32_16x16x32_bf16 v[80:83], a[44:47], a[220:223], v[80:83]
ds_read_b128 a[240:243], v10 offset:16384
v_mfma_f32_16x16x32_bf16 v[84:87], a[112:115], a[216:219], v[84:87]
v_mfma_f32_16x16x32_bf16 v[84:87], a[116:119], a[220:223], v[84:87]
ds_read_b128 a[244:247], v10 offset:24576
s_waitcnt lgkmcnt(4)
v_mfma_f32_16x16x32_bf16 v[88:91], a[40:43], a[224:227], v[88:91]
v_mfma_f32_16x16x32_bf16 v[88:91], a[44:47], a[228:231], v[88:91]
ds_read_b128 a[216:219], v4 offset:32768
v_mfma_f32_16x16x32_bf16 v[92:95], a[112:115], a[224:227], v[92:95]
v_mfma_f32_16x16x32_bf16 v[92:95], a[116:119], a[228:231], v[92:95]
ds_read_b128 a[220:223], v4 offset:40960
s_waitcnt lgkmcnt(4)
v_mfma_f32_16x16x32_bf16 v[96:99], a[232:235], a[184:187], v[96:99]
ds_read_b128 a[224:227], v4 offset:33792
v_mfma_f32_16x16x32_bf16 v[96:99], a[236:239], a[188:191], v[96:99]
ds_read_b128 a[228:231], v4 offset:41984
s_waitcnt lgkmcnt(4)
v_mfma_f32_16x16x32_bf16 v[100:103], a[184:187], a[240:243], v[100:103]
ds_read_b128 a[232:235], v4 offset:34816
v_mfma_f32_16x16x32_bf16 v[100:103], a[188:191], a[244:247], v[100:103]
ds_read_b128 a[236:239], v4 offset:43008
s_waitcnt vmcnt(12)
s_waitcnt lgkmcnt(4)
v_mfma_f32_16x16x32_bf16 v[32:35], a[216:219], a[48:51], v[32:35]
v_mfma_f32_16x16x32_bf16 v[32:35], a[220:223], a[52:55], v[32:35]
ds_read_b128 a[240:243], v4 offset:35840
v_mfma_f32_16x16x32_bf16 v[36:39], a[216:219], a[120:123], v[36:39]
v_mfma_f32_16x16x32_bf16 v[36:39], a[220:223], a[124:127], v[36:39]
ds_read_b128 a[244:247], v4 offset:44032
s_waitcnt lgkmcnt(4)
v_mfma_f32_16x16x32_bf16 v[40:43], a[224:227], a[48:51], v[40:43]
v_mfma_f32_16x16x32_bf16 v[40:43], a[228:231], a[52:55], v[40:43]
ds_read_b128 a[216:219], v4 offset:36864
v_mfma_f32_16x16x32_bf16 v[44:47], a[224:227], a[120:123], v[44:47]
v_mfma_f32_16x16x32_bf16 v[44:47], a[228:231], a[124:127], v[44:47]
ds_read_b128 a[220:223], v4 offset:45056
s_waitcnt lgkmcnt(4)
v_mfma_f32_16x16x32_bf16 v[48:51], a[232:235], a[48:51], v[48:51]
v_mfma_f32_16x16x32_bf16 v[48:51], a[236:239], a[52:55], v[48:51]
ds_read_b128 a[224:227], v4 offset:37888
v_mfma_f32_16x16x32_bf16 v[52:55], a[232:235], a[120:123], v[52:55]
v_mfma_f32_16x16x32_bf16 v[52:55], a[236:239], a[124:127], v[52:55]
ds_read_b128 a[228:231], v4 offset:46080
s_waitcnt lgkmcnt(4)
v_mfma_f32_16x16x32_bf16 v[56:59], a[240:243], a[48:51], v[56:59]
v_mfma_f32_16x16x32_bf16 v[56:59], a[244:247], a[52:55], v[56:59]
ds_read_b128 a[232:235], v4 offset:38912
v_mfma_f32_16x16x32_bf16 v[60:63], a[240:243], a[120:123], v[60:63]
v_mfma_f32_16x16x32_bf16 v[60:63], a[244:247], a[124:127], v[60:63]
ds_read_b128 a[236:239], v4 offset:47104
s_waitcnt lgkmcnt(4)
v_mfma_f32_16x16x32_bf16 v[64:67], a[216:219], a[48:51], v[64:67]
v_mfma_f32_16x16x32_bf16 v[64:67], a[220:223], a[52:55], v[64:67]
ds_read_b128 a[240:243], v4 offset:39936
v_mfma_f32_16x16x32_bf16 v[68:71], a[216:219], a[120:123], v[68:71]
v_mfma_f32_16x16x32_bf16 v[68:71], a[220:223], a[124:127], v[68:71]
ds_read_b128 a[244:247], v4 offset:48128
s_waitcnt lgkmcnt(4)
v_mfma_f32_16x16x32_bf16 v[72:75], a[48:51], a[224:227], v[72:75]
v_mfma_f32_16x16x32_bf16 v[72:75], a[52:55], a[228:231], v[72:75]
ds_read_b128 a[216:219], v7 offset:32768
v_mfma_f32_16x16x32_bf16 v[76:79], a[120:123], a[224:227], v[76:79]
v_mfma_f32_16x16x32_bf16 v[76:79], a[124:127], a[228:231], v[76:79]
ds_read_b128 a[220:223], v7 offset:40960
s_waitcnt lgkmcnt(4)
v_mfma_f32_16x16x32_bf16 v[80:83], a[48:51], a[232:235], v[80:83]
v_mfma_f32_16x16x32_bf16 v[80:83], a[52:55], a[236:239], v[80:83]
ds_read_b128 a[224:227], v10 offset:32768
v_mfma_f32_16x16x32_bf16 v[84:87], a[120:123], a[232:235], v[84:87]
v_mfma_f32_16x16x32_bf16 v[84:87], a[124:127], a[236:239], v[84:87]
ds_read_b128 a[228:231], v10 offset:40960
s_waitcnt lgkmcnt(4)
v_mfma_f32_16x16x32_bf16 v[88:91], a[48:51], a[240:243], v[88:91]
v_mfma_f32_16x16x32_bf16 v[88:91], a[52:55], a[244:247], v[88:91]
ds_read_b128 a[232:235], v4 offset:49152
v_mfma_f32_16x16x32_bf16 v[92:95], a[120:123], a[240:243], v[92:95]
v_mfma_f32_16x16x32_bf16 v[92:95], a[124:127], a[244:247], v[92:95]
ds_read_b128 a[236:239], v4 offset:57344
s_waitcnt lgkmcnt(4)
v_mfma_f32_16x16x32_bf16 v[96:99], a[216:219], a[192:195], v[96:99]
ds_read_b128 a[240:243], v4 offset:50176
v_mfma_f32_16x16x32_bf16 v[96:99], a[220:223], a[196:199], v[96:99]
ds_read_b128 a[244:247], v4 offset:58368
s_waitcnt lgkmcnt(4)
v_mfma_f32_16x16x32_bf16 v[100:103], a[192:195], a[224:227], v[100:103]
ds_read_b128 a[216:219], v4 offset:51200
v_mfma_f32_16x16x32_bf16 v[100:103], a[196:199], a[228:231], v[100:103]
ds_read_b128 a[220:223], v4 offset:59392
s_waitcnt vmcnt(6)
s_waitcnt lgkmcnt(4)
v_mfma_f32_16x16x32_bf16 v[32:35], a[232:235], a[56:59], v[32:35]
v_mfma_f32_16x16x32_bf16 v[32:35], a[236:239], a[60:63], v[32:35]
ds_read_b128 a[224:227], v4 offset:52224
v_mfma_f32_16x16x32_bf16 v[36:39], a[232:235], a[128:131], v[36:39]
v_mfma_f32_16x16x32_bf16 v[36:39], a[236:239], a[132:135], v[36:39]
ds_read_b128 a[228:231], v4 offset:60416
s_waitcnt lgkmcnt(4)
v_mfma_f32_16x16x32_bf16 v[40:43], a[240:243], a[56:59], v[40:43]
v_mfma_f32_16x16x32_bf16 v[40:43], a[244:247], a[60:63], v[40:43]
ds_read_b128 a[232:235], v4 offset:53248
v_mfma_f32_16x16x32_bf16 v[44:47], a[240:243], a[128:131], v[44:47]
v_mfma_f32_16x16x32_bf16 v[44:47], a[244:247], a[132:135], v[44:47]
ds_read_b128 a[236:239], v4 offset:61440
s_waitcnt lgkmcnt(4)
v_mfma_f32_16x16x32_bf16 v[48:51], a[216:219], a[56:59], v[48:51]
v_mfma_f32_16x16x32_bf16 v[48:51], a[220:223], a[60:63], v[48:51]
ds_read_b128 a[240:243], v4 offset:54272
v_mfma_f32_16x16x32_bf16 v[52:55], a[216:219], a[128:131], v[52:55]
v_mfma_f32_16x16x32_bf16 v[52:55], a[220:223], a[132:135], v[52:55]
ds_read_b128 a[244:247], v4 offset:62464
s_waitcnt lgkmcnt(4)
v_mfma_f32_16x16x32_bf16 v[56:59], a[224:227], a[56:59], v[56:59]
v_mfma_f32_16x16x32_bf16 v[56:59], a[228:231], a[60:63], v[56:59]
ds_read_b128 a[216:219], v4 offset:55296
v_mfma_f32_16x16x32_bf16 v[60:63], a[224:227], a[128:131], v[60:63]
v_mfma_f32_16x16x32_bf16 v[60:63], a[228:231], a[132:135], v[60:63]
ds_read_b128 a[220:223], v4 offset:63488
s_waitcnt lgkmcnt(4)
v_mfma_f32_16x16x32_bf16 v[64:67], a[232:235], a[56:59], v[64:67]
v_mfma_f32_16x16x32_bf16 v[64:67], a[236:239], a[60:63], v[64:67]
ds_read_b128 a[224:227], v4 offset:56320
v_mfma_f32_16x16x32_bf16 v[68:71], a[232:235], a[128:131], v[68:71]
v_mfma_f32_16x16x32_bf16 v[68:71], a[236:239], a[132:135], v[68:71]
ds_read_b128 a[228:231], v4 offset:64512
s_waitcnt lgkmcnt(4)
v_mfma_f32_16x16x32_bf16 v[72:75], a[56:59], a[240:243], v[72:75]
v_mfma_f32_16x16x32_bf16 v[72:75], a[60:63], a[244:247], v[72:75]
ds_read_b128 a[232:235], v7 offset:49152
v_mfma_f32_16x16x32_bf16 v[76:79], a[128:131], a[240:243], v[76:79]
v_mfma_f32_16x16x32_bf16 v[76:79], a[132:135], a[244:247], v[76:79]
ds_read_b128 a[236:239], v7 offset:57344
s_waitcnt lgkmcnt(4)
v_mfma_f32_16x16x32_bf16 v[80:83], a[56:59], a[216:219], v[80:83]
v_mfma_f32_16x16x32_bf16 v[80:83], a[60:63], a[220:223], v[80:83]
ds_read_b128 a[240:243], v10 offset:49152
v_mfma_f32_16x16x32_bf16 v[84:87], a[128:131], a[216:219], v[84:87]
v_mfma_f32_16x16x32_bf16 v[84:87], a[132:135], a[220:223], v[84:87]
ds_read_b128 a[244:247], v10 offset:57344
s_waitcnt lgkmcnt(4)
v_mfma_f32_16x16x32_bf16 v[88:91], a[56:59], a[224:227], v[88:91]
v_mfma_f32_16x16x32_bf16 v[88:91], a[60:63], a[228:231], v[88:91]
ds_read_b128 a[216:219], v5 offset:0
v_mfma_f32_16x16x32_bf16 v[92:95], a[128:131], a[224:227], v[92:95]
v_mfma_f32_16x16x32_bf16 v[92:95], a[132:135], a[228:231], v[92:95]
ds_read_b128 a[220:223], v5 offset:8192
s_waitcnt lgkmcnt(4)
v_mfma_f32_16x16x32_bf16 v[96:99], a[232:235], a[200:203], v[96:99]
ds_read_b128 a[224:227], v5 offset:1024
v_mfma_f32_16x16x32_bf16 v[96:99], a[236:239], a[204:207], v[96:99]
ds_read_b128 a[228:231], v5 offset:9216
s_waitcnt lgkmcnt(4)
v_mfma_f32_16x16x32_bf16 v[100:103], a[200:203], a[240:243], v[100:103]
ds_read_b128 a[232:235], v5 offset:2048
v_mfma_f32_16x16x32_bf16 v[100:103], a[204:207], a[244:247], v[100:103]
ds_read_b128 a[236:239], v5 offset:10240
s_waitcnt vmcnt(0)
s_waitcnt lgkmcnt(4)
v_mfma_f32_16x16x32_bf16 v[32:35], a[216:219], a[64:67], v[32:35]
v_mfma_f32_16x16x32_bf16 v[32:35], a[220:223], a[68:71], v[32:35]
ds_read_b128 a[240:243], v5 offset:3072
v_mfma_f32_16x16x32_bf16 v[36:39], a[216:219], a[136:139], v[36:39]
v_mfma_f32_16x16x32_bf16 v[36:39], a[220:223], a[140:143], v[36:39]
ds_read_b128 a[244:247], v5 offset:11264
s_waitcnt lgkmcnt(4)
v_mfma_f32_16x16x32_bf16 v[40:43], a[224:227], a[64:67], v[40:43]
v_mfma_f32_16x16x32_bf16 v[40:43], a[228:231], a[68:71], v[40:43]
ds_read_b128 a[216:219], v5 offset:4096
v_mfma_f32_16x16x32_bf16 v[44:47], a[224:227], a[136:139], v[44:47]
v_mfma_f32_16x16x32_bf16 v[44:47], a[228:231], a[140:143], v[44:47]
ds_read_b128 a[220:223], v5 offset:12288
s_waitcnt lgkmcnt(4)
v_mfma_f32_16x16x32_bf16 v[48:51], a[232:235], a[64:67], v[48:51]
v_mfma_f32_16x16x32_bf16 v[48:51], a[236:239], a[68:71], v[48:51]
ds_read_b128 a[224:227], v5 offset:5120
v_mfma_f32_16x16x32_bf16 v[52:55], a[232:235], a[136:139], v[52:55]
v_mfma_f32_16x16x32_bf16 v[52:55], a[236:239], a[140:143], v[52:55]
ds_read_b128 a[228:231], v5 offset:13312
s_waitcnt lgkmcnt(4)
v_mfma_f32_16x16x32_bf16 v[56:59], a[240:243], a[64:67], v[56:59]
v_mfma_f32_16x16x32_bf16 v[56:59], a[244:247], a[68:71], v[56:59]
ds_read_b128 a[232:235], v5 offset:6144
v_mfma_f32_16x16x32_bf16 v[60:63], a[240:243], a[136:139], v[60:63]
v_mfma_f32_16x16x32_bf16 v[60:63], a[244:247], a[140:143], v[60:63]
ds_read_b128 a[236:239], v5 offset:14336
s_waitcnt lgkmcnt(4)
v_mfma_f32_16x16x32_bf16 v[64:67], a[216:219], a[64:67], v[64:67]
v_mfma_f32_16x16x32_bf16 v[64:67], a[220:223], a[68:71], v[64:67]
ds_read_b128 a[240:243], v5 offset:7168
v_mfma_f32_16x16x32_bf16 v[68:71], a[216:219], a[136:139], v[68:71]
v_mfma_f32_16x16x32_bf16 v[68:71], a[220:223], a[140:143], v[68:71]
ds_read_b128 a[244:247], v5 offset:15360
s_waitcnt lgkmcnt(4)
v_mfma_f32_16x16x32_bf16 v[72:75], a[64:67], a[224:227], v[72:75]
v_mfma_f32_16x16x32_bf16 v[72:75], a[68:71], a[228:231], v[72:75]
ds_read_b128 a[216:219], v8 offset:0
v_mfma_f32_16x16x32_bf16 v[76:79], a[136:139], a[224:227], v[76:79]
v_mfma_f32_16x16x32_bf16 v[76:79], a[140:143], a[228:231], v[76:79]
ds_read_b128 a[220:223], v8 offset:8192
s_waitcnt lgkmcnt(4)
v_mfma_f32_16x16x32_bf16 v[80:83], a[64:67], a[232:235], v[80:83]
v_mfma_f32_16x16x32_bf16 v[80:83], a[68:71], a[236:239], v[80:83]
ds_read_b128 a[224:227], v11 offset:0
v_mfma_f32_16x16x32_bf16 v[84:87], a[136:139], a[232:235], v[84:87]
v_mfma_f32_16x16x32_bf16 v[84:87], a[140:143], a[236:239], v[84:87]
ds_read_b128 a[228:231], v11 offset:8192
s_waitcnt lgkmcnt(4)
v_mfma_f32_16x16x32_bf16 v[88:91], a[64:67], a[240:243], v[88:91]
v_mfma_f32_16x16x32_bf16 v[88:91], a[68:71], a[244:247], v[88:91]
v_mfma_f32_16x16x32_bf16 v[92:95], a[136:139], a[240:243], v[92:95]
v_mfma_f32_16x16x32_bf16 v[92:95], a[140:143], a[244:247], v[92:95]
s_waitcnt lgkmcnt(2)
v_mfma_f32_16x16x32_bf16 v[96:99], a[216:219], a[208:211], v[96:99]
v_mfma_f32_16x16x32_bf16 v[96:99], a[220:223], a[212:215], v[96:99]
s_waitcnt lgkmcnt(0)
v_mfma_f32_16x16x32_bf16 v[100:103], a[208:211], a[224:227], v[100:103]
v_mfma_f32_16x16x32_bf16 v[100:103], a[212:215], a[228:231], v[100:103]
v_cvt_pk_bf16_f32 v116, v52, v53
v_cvt_pk_bf16_f32 v117, v54, v55
v_cvt_pk_bf16_f32 v120, v60, v61
v_cvt_pk_bf16_f32 v121, v62, v63
v_cvt_pk_bf16_f32 v160, v68, v69
v_cvt_pk_bf16_f32 v161, v70, v71
v_cvt_pk_bf16_f32 v126, v76, v77
v_cvt_pk_bf16_f32 v127, v78, v79
v_cvt_pk_bf16_f32 v132, v84, v85
v_cvt_pk_bf16_f32 v133, v86, v87
v_cvt_pk_bf16_f32 v138, v92, v93
v_cvt_pk_bf16_f32 v139, v94, v95
v_cvt_pk_bf16_f32 v156, v96, v97
v_cvt_pk_bf16_f32 v157, v98, v99
v_cvt_pk_bf16_f32 v158, v100, v101
v_cvt_pk_bf16_f32 v159, v102, v103
v_lshlrev_b32 v14, 3, v1
s_mul_i32 s31, s4, 3072
s_add_u32 s32, s31, 147456
v_add_u32 v15, s32, v14
s_lshl_b32 s33, s29, 9
s_add_u32 s33, s33, 147456
v_add_u32 v16, s33, v14
ds_write_b64 v16, v[156:157]
ds_write_b64 v16, v[158:159] offset:1536
s_cmp_eq_u32 s4, 3
s_cbranch_scc1 L_a1_noxch
ds_write_b64 v15, v[116:117] offset:3072
ds_write_b64 v15, v[120:121] offset:3584
ds_write_b64 v15, v[160:161] offset:4096
ds_write_b64 v15, v[126:127] offset:4608
ds_write_b64 v15, v[132:133] offset:5120
ds_write_b64 v15, v[138:139] offset:5632
L_a1_noxch:
v_cvt_pk_bf16_f32 v110, v48, v49
v_cvt_pk_bf16_f32 v111, v50, v51
v_cvt_pk_bf16_f32 v114, v56, v57
v_cvt_pk_bf16_f32 v115, v58, v59
v_cvt_pk_bf16_f32 v124, v72, v73
v_cvt_pk_bf16_f32 v125, v74, v75
v_cvt_pk_bf16_f32 v130, v80, v81
v_cvt_pk_bf16_f32 v131, v82, v83
v_cvt_pk_bf16_f32 v136, v88, v89
v_cvt_pk_bf16_f32 v137, v90, v91
v_cvt_pk_bf16_f32 v140, v32, v33
v_cvt_pk_bf16_f32 v141, v34, v35
v_cvt_pk_bf16_f32 v146, v40, v41
v_cvt_pk_bf16_f32 v147, v42, v43
v_cvt_pk_bf16_f32 v142, v64, v65
v_cvt_pk_bf16_f32 v145, v66, v67
v_mov_b32 v143, 0
v_mov_b32 v144, 0
v_mov_b32 v112, 0
v_mov_b32 v113, 0
s_nop 0
v_permlane16_swap_b32 v142, v112
v_permlane16_swap_b32 v145, v113
v_cvt_pk_bf16_f32 v148, v36, v37
v_cvt_pk_bf16_f32 v149, v38, v39
v_cvt_pk_bf16_f32 v154, v44, v45
v_cvt_pk_bf16_f32 v155, v46, v47
v_cvt_pk_bf16_f32 v150, v68, v69
v_cvt_pk_bf16_f32 v153, v70, v71
v_mov_b32 v151, 0
v_mov_b32 v152, 0
v_mov_b32 v118, 0
v_mov_b32 v119, 0
s_nop 0
v_permlane16_swap_b32 v150, v118
v_permlane16_swap_b32 v153, v119
v_add_u32 v17, 16, v12
v_add_u32 v18, 32, v12
v_cmp_gt_u32 vcc, 16, v1
s_nop 1
v_cndmask_b32 v17, v18, v17, vcc
v_lshlrev_b32 v17, 3, v17
v_add_u32 v17, s32, v17
s_waitcnt lgkmcnt(0)
s_barrier
ds_read_b64 v[104:105], v15
ds_read_b64 v[108:109], v15 offset:512
ds_read_b64 v[106:107], v17 offset:1024
ds_read_b64 v[122:123], v15 offset:1536
ds_read_b64 v[128:129], v15 offset:2048
ds_read_b64 v[134:135], v15 offset:2560
v_mfma_f32_16x16x32_bf16 v[32:35], v[110:113], v[148:151], 0
v_mfma_f32_16x16x32_bf16 v[36:39], v[116:119], v[148:151], 0
v_mfma_f32_16x16x32_bf16 v[40:43], v[112:115], v[152:155], 0
v_mfma_f32_16x16x32_bf16 v[44:47], v[118:121], v[152:155], 0
s_waitcnt lgkmcnt(0)
v_mfma_f32_16x16x32_bf16 v[48:51], v[104:107], v[140:143], 0
v_mfma_f32_16x16x32_bf16 v[52:55], v[110:113], v[140:143], 0
v_mfma_f32_16x16x32_bf16 v[56:59], v[106:109], v[144:147], 0
v_mfma_f32_16x16x32_bf16 v[60:63], v[112:115], v[144:147], 0
v_mov_b32 v18, 0xff61b1e6
s_mov_b32 s34, 0x3eae1a93
v_cndmask_b32 v32, v18, v32, s[44:45]
v_cndmask_b32 v40, v18, v40, s[44:45]
s_nop 0
v_cndmask_b32 v48, v18, v48, s[60:61]
s_nop 0
v_cndmask_b32 v56, v18, v56, s[60:61]
v_cndmask_b32 v33, v18, v33, s[46:47]
v_cndmask_b32 v41, v18, v41, s[46:47]
v_cndmask_b32 v49, v18, v49, s[62:63]
v_cndmask_b32 v57, v18, v57, s[62:63]
v_cndmask_b32 v34, v18, v34, s[48:49]
v_cndmask_b32 v42, v18, v42, s[48:49]
v_cndmask_b32 v50, v18, v50, s[64:65]
v_cndmask_b32 v58, v18, v58, s[64:65]
v_cndmask_b32 v35, v18, v35, s[50:51]
v_cndmask_b32 v43, v18, v43, s[50:51]
v_cndmask_b32 v51, v18, v51, s[66:67]
v_cndmask_b32 v59, v18, v59, s[66:67]
v_cndmask_b32 v36, v18, v36, s[52:53]
v_cndmask_b32 v44, v18, v44, s[52:53]
v_cndmask_b32 v52, v18, v52, s[52:53]
v_cndmask_b32 v60, v18, v60, s[52:53]
v_cndmask_b32 v37, v18, v37, s[54:55]
v_cndmask_b32 v45, v18, v45, s[54:55]
v_cndmask_b32 v53, v18, v53, s[54:55]
v_cndmask_b32 v61, v18, v61, s[54:55]
v_cndmask_b32 v38, v18, v38, s[56:57]
v_cndmask_b32 v46, v18, v46, s[56:57]
v_cndmask_b32 v54, v18, v54, s[56:57]
v_cndmask_b32 v62, v18, v62, s[56:57]
v_cndmask_b32 v39, v18, v39, s[58:59]
v_cndmask_b32 v47, v18, v47, s[58:59]
v_cndmask_b32 v55, v18, v55, s[58:59]
v_cndmask_b32 v63, v18, v63, s[58:59]
v_max3_f32 v20, v32, v33, v34
v_max3_f32 v21, v40, v41, v42
v_max3_f32 v22, v48, v49, v50
v_max3_f32 v23, v56, v57, v58
v_max3_f32 v20, v20, v35, v36
v_max3_f32 v21, v21, v43, v44
v_max3_f32 v22, v22, v51, v52
v_max3_f32 v23, v23, v59, v60
v_max3_f32 v20, v20, v37, v38
v_max3_f32 v21, v21, v45, v46
v_max3_f32 v22, v22, v53, v54
v_max3_f32 v23, v23, v61, v62
v_max_f32 v20, v20, v39
v_max_f32 v21, v21, v47
v_max_f32 v22, v22, v55
v_max_f32 v23, v23, v63
v_mov_b32 v24, v20
v_mov_b32 v25, v21
v_mov_b32 v26, v22
v_mov_b32 v27, v23
v_permlane16_swap_b32 v20, v24
v_permlane16_swap_b32 v21, v25
v_permlane16_swap_b32 v22, v26
v_permlane16_swap_b32 v23, v27
v_max_f32 v20, v20, v24
v_max_f32 v21, v21, v25
v_max_f32 v22, v22, v26
v_max_f32 v23, v23, v27
v_mov_b32 v24, v20
v_mov_b32 v25, v21
v_mov_b32 v26, v22
v_mov_b32 v27, v23
v_permlane32_swap_b32 v20, v24
v_permlane32_swap_b32 v21, v25
v_permlane32_swap_b32 v22, v26
v_permlane32_swap_b32 v23, v27
v_max_f32 v20, v20, v24
v_max_f32 v21, v21, v25
v_max_f32 v22, v22, v26
v_max_f32 v23, v23, v27
v_mul_f32 v20, s34, v20
v_mul_f32 v21, s34, v21
v_mul_f32 v22, s34, v22
v_mul_f32 v23, s34, v23
v_fma_f32 v32, v32, s34, -v20
v_fma_f32 v40, v40, s34, -v21
v_fma_f32 v48, v48, s34, -v22
v_fma_f32 v56, v56, s34, -v23
v_exp_f32 v32, v32
v_exp_f32 v40, v40
v_exp_f32 v48, v48
v_exp_f32 v56, v56
v_fma_f32 v33, v33, s34, -v20
v_fma_f32 v41, v41, s34, -v21
v_fma_f32 v49, v49, s34, -v22
v_fma_f32 v57, v57, s34, -v23
v_exp_f32 v33, v33
v_exp_f32 v41, v41
v_exp_f32 v49, v49
v_exp_f32 v57, v57
v_fma_f32 v34, v34, s34, -v20
v_fma_f32 v42, v42, s34, -v21
v_fma_f32 v50, v50, s34, -v22
v_fma_f32 v58, v58, s34, -v23
v_exp_f32 v34, v34
v_exp_f32 v42, v42
v_exp_f32 v50, v50
v_exp_f32 v58, v58
v_fma_f32 v35, v35, s34, -v20
v_fma_f32 v43, v43, s34, -v21
v_fma_f32 v51, v51, s34, -v22
v_fma_f32 v59, v59, s34, -v23
v_exp_f32 v35, v35
v_exp_f32 v43, v43
v_exp_f32 v51, v51
v_exp_f32 v59, v59
v_fma_f32 v36, v36, s34, -v20
v_fma_f32 v44, v44, s34, -v21
v_fma_f32 v52, v52, s34, -v22
v_fma_f32 v60, v60, s34, -v23
v_exp_f32 v36, v36
v_exp_f32 v44, v44
v_exp_f32 v52, v52
v_exp_f32 v60, v60
v_fma_f32 v37, v37, s34, -v20
v_fma_f32 v45, v45, s34, -v21
v_fma_f32 v53, v53, s34, -v22
v_fma_f32 v61, v61, s34, -v23
v_exp_f32 v37, v37
v_exp_f32 v45, v45
v_exp_f32 v53, v53
v_exp_f32 v61, v61
v_fma_f32 v38, v38, s34, -v20
v_fma_f32 v46, v46, s34, -v21
v_fma_f32 v54, v54, s34, -v22
v_fma_f32 v62, v62, s34, -v23
v_exp_f32 v38, v38
v_exp_f32 v46, v46
v_exp_f32 v54, v54
v_exp_f32 v62, v62
v_fma_f32 v39, v39, s34, -v20
v_fma_f32 v47, v47, s34, -v21
v_fma_f32 v55, v55, s34, -v22
v_fma_f32 v63, v63, s34, -v23
v_exp_f32 v39, v39
v_exp_f32 v47, v47
v_exp_f32 v55, v55
v_exp_f32 v63, v63
v_add_f32 v28, v32, v33
v_add_f32 v29, v40, v41
v_add_f32 v30, v48, v49
v_add_f32 v31, v56, v57
v_add_f32 v28, v28, v34
v_add_f32 v29, v29, v42
v_add_f32 v30, v30, v50
v_add_f32 v31, v31, v58
v_add_f32 v28, v28, v35
v_add_f32 v29, v29, v43
v_add_f32 v30, v30, v51
v_add_f32 v31, v31, v59
v_add_f32 v28, v28, v36
v_add_f32 v29, v29, v44
v_add_f32 v30, v30, v52
v_add_f32 v31, v31, v60
v_add_f32 v28, v28, v37
v_add_f32 v29, v29, v45
v_add_f32 v30, v30, v53
v_add_f32 v31, v31, v61
v_add_f32 v28, v28, v38
v_add_f32 v29, v29, v46
v_add_f32 v30, v30, v54
v_add_f32 v31, v31, v62
v_add_f32 v28, v28, v39
v_add_f32 v29, v29, v47
v_add_f32 v30, v30, v55
v_add_f32 v31, v31, v63
v_mov_b32 v24, v28
v_mov_b32 v25, v29
v_mov_b32 v26, v30
v_mov_b32 v27, v31
v_permlane16_swap_b32 v28, v24
v_permlane16_swap_b32 v29, v25
v_permlane16_swap_b32 v30, v26
v_permlane16_swap_b32 v31, v27
v_add_f32 v28, v28, v24
v_add_f32 v29, v29, v25
v_add_f32 v30, v30, v26
v_add_f32 v31, v31, v27
v_mov_b32 v24, v28
v_mov_b32 v25, v29
v_mov_b32 v26, v30
v_mov_b32 v27, v31
v_permlane32_swap_b32 v28, v24
v_permlane32_swap_b32 v29, v25
v_permlane32_swap_b32 v30, v26
v_permlane32_swap_b32 v31, v27
v_add_f32 v28, v28, v24
v_add_f32 v29, v29, v25
v_add_f32 v30, v30, v26
v_add_f32 v31, v31, v27
v_rcp_f32 v28, v28
v_rcp_f32 v29, v29
v_rcp_f32 v30, v30
v_rcp_f32 v31, v31
v_mul_f32 v32, v32, v28
v_mul_f32 v40, v40, v29
v_mul_f32 v48, v48, v30
v_mul_f32 v56, v56, v31
v_mul_f32 v33, v33, v28
v_mul_f32 v41, v41, v29
v_mul_f32 v49, v49, v30
v_mul_f32 v57, v57, v31
v_mul_f32 v34, v34, v28
v_mul_f32 v42, v42, v29
v_mul_f32 v50, v50, v30
v_mul_f32 v58, v58, v31
v_mul_f32 v35, v35, v28
v_mul_f32 v43, v43, v29
v_mul_f32 v51, v51, v30
v_mul_f32 v59, v59, v31
v_mul_f32 v36, v36, v28
v_mul_f32 v44, v44, v29
v_mul_f32 v52, v52, v30
v_mul_f32 v60, v60, v31
v_mul_f32 v37, v37, v28
v_mul_f32 v45, v45, v29
v_mul_f32 v53, v53, v30
v_mul_f32 v61, v61, v31
v_mul_f32 v38, v38, v28
v_mul_f32 v46, v46, v29
v_mul_f32 v54, v54, v30
v_mul_f32 v62, v62, v31
v_mul_f32 v39, v39, v28
v_mul_f32 v47, v47, v29
v_mul_f32 v55, v55, v30
v_mul_f32 v63, v63, v31
v_cvt_pk_bf16_f32 v64, v32, v33
v_cvt_pk_bf16_f32 v65, v34, v35
v_cvt_pk_bf16_f32 v66, v36, v37
v_cvt_pk_bf16_f32 v67, v38, v39
v_cvt_pk_bf16_f32 v68, v40, v41
v_cvt_pk_bf16_f32 v69, v42, v43
v_cvt_pk_bf16_f32 v70, v44, v45
v_cvt_pk_bf16_f32 v71, v46, v47
v_cvt_pk_bf16_f32 v72, v48, v49
v_cvt_pk_bf16_f32 v73, v50, v51
v_cvt_pk_bf16_f32 v74, v52, v53
v_cvt_pk_bf16_f32 v75, v54, v55
v_cvt_pk_bf16_f32 v76, v56, v57
v_cvt_pk_bf16_f32 v77, v58, v59
v_cvt_pk_bf16_f32 v78, v60, v61
v_cvt_pk_bf16_f32 v79, v62, v63
v_mfma_f32_16x16x32_bf16 v[80:83], v[124:127], v[64:67], 0
v_mfma_f32_16x16x32_bf16 v[84:87], v[136:139], v[64:67], 0
v_mfma_f32_16x16x32_bf16 v[88:91], v[130:133], v[68:71], 0
v_mfma_f32_16x16x32_bf16 v[92:95], v[136:139], v[68:71], 0
v_mfma_f32_16x16x32_bf16 v[96:99], v[122:125], v[72:75], 0
v_mfma_f32_16x16x32_bf16 v[100:103], v[134:137], v[72:75], 0
v_mfma_f32_16x16x32_bf16 v[164:167], v[128:131], v[76:79], 0
v_mfma_f32_16x16x32_bf16 v[168:171], v[134:137], v[76:79], 0
v_lshlrev_b32 v14, 4, v12
v_mov_b32 v15, 2146435072
v_cmp_gt_u32 vcc, 16, v1
s_nop 1
v_cndmask_b32 v14, v15, v14, vcc
s_add_u32 s26, s24, s72
s_lshl_b32 s27, s21, 10
s_add_u32 s27, s27, s26
s_lshr_b32 s28, s21, 1
s_lshl_b32 s28, s28, 8
s_and_b32 s30, s21, 1
s_lshl_b32 s30, s30, 3
s_add_u32 s28, s28, s30
s_add_u32 s28, s28, 16384
s_add_u32 s28, s28, s26
s_add_u32 s30, s27, 18432
s_add_u32 s31, s28, 18432
v_cvt_pk_bf16_f32 v180, v80, v81
v_cvt_pk_bf16_f32 v181, v82, v83
v_cvt_pk_bf16_f32 v182, v88, v89
v_cvt_pk_bf16_f32 v183, v90, v91
v_cvt_pk_bf16_f32 v184, v84, v85
v_cvt_pk_bf16_f32 v185, v94, v95
buffer_store_dwordx4 v[180:183], v2, s[8:11], s30 offen sc1
buffer_store_dwordx2 v[184:185], v14, s[8:11], s31 offen sc1
v_cvt_pk_bf16_f32 v172, v96, v97
v_cvt_pk_bf16_f32 v173, v98, v99
v_cvt_pk_bf16_f32 v174, v164, v165
v_cvt_pk_bf16_f32 v175, v166, v167
v_cvt_pk_bf16_f32 v176, v100, v101
v_cvt_pk_bf16_f32 v177, v170, v171
buffer_store_dwordx4 v[172:175], v2, s[8:11], s27 offen sc1
buffer_store_dwordx2 v[176:177], v14, s[8:11], s28 offen sc1
s_lshl_b32 s26, s20, 2
s_add_u32 s26, s26, s4
s_lshl_b32 s26, s26, 4
s_add_u32 s26, s26, s21
s_lshl_b32 s26, s26, 2
s_add_u32 s26, s26, s77
s_add_u32 s26, s26, 16384
v_mov_b32 v14, 2146435072
v_cmp_eq_u32 vcc, 0, v1
s_nop 1
v_cndmask_b32 v14, v14, 0, vcc
v_mov_b32 v15, 1
s_waitcnt vmcnt(0)
buffer_store_dword v15, v14, s[8:11], s26 offen sc1
s_lshr_b32 s20, s6, 3
s_lshl_b32 s21, s5, 2
s_add_u32 s20, s20, s21
s_lshl_b32 s20, s20, 2
s_add_u32 s20, s20, s4
s_and_b32 s21, s6, 7
s_cmp_eq_u32 s4, 0
s_cbranch_scc0 L_a2_pre
s_lshr_b32 s22, s20, 2
s_lshl_b32 s22, s22, 7
s_add_u32 s22, s22, s77
s_add_u32 s22, s22, 16384
v_and_b32 v6, 31, v1
v_lshlrev_b32 v6, 2, v6
s_mov_b32 s52, 0
L_poll1:
buffer_load_dword v14, v6, s[8:11], s22 offen sc1
s_add_u32 s52, s52, 1
s_waitcnt vmcnt(0)
v_cmp_ne_u32 vcc, 0, v14
s_cmp_gt_u32 s52, 0x80000
s_cbranch_scc1 L_got1
s_cmp_eq_u64 vcc, exec
s_cbranch_scc0 L_poll1
L_got1:
s_branch L_a2_go
L_a2_pre:
s_mul_i32 s22, s21, 92160
s_sub_u32 s23, s4, 1
s_mul_i32 s23, s23, 30720
s_add_u32 s22, s22, s23
s_add_u32 s22, s22, 2621440
s_add_u32 m0, s23, 0
s_add_u32 s40, s22, 0
buffer_load_dwordx4 v2, s[8:11], s40 offen offset:0 lds
buffer_load_dwordx4 v2, s[8:11], s40 offen offset:1024 lds
buffer_load_dwordx4 v2, s[8:11], s40 offen offset:2048 lds
buffer_load_dwordx4 v2, s[8:11], s40 offen offset:3072 lds
s_add_u32 m0, s23, 4096
s_add_u32 s40, s22, 4096
buffer_load_dwordx4 v2, s[8:11], s40 offen offset:0 lds
buffer_load_dwordx4 v2, s[8:11], s40 offen offset:1024 lds
buffer_load_dwordx4 v2, s[8:11], s40 offen offset:2048 lds
buffer_load_dwordx4 v2, s[8:11], s40 offen offset:3072 lds
s_add_u32 m0, s23, 8192
s_add_u32 s40, s22, 8192
buffer_load_dwordx4 v2, s[8:11], s40 offen offset:0 lds
buffer_load_dwordx4 v2, s[8:11], s40 offen offset:1024 lds
buffer_load_dwordx4 v2, s[8:11], s40 offen offset:2048 lds
buffer_load_dwordx4 v2, s[8:11], s40 offen offset:3072 lds
s_add_u32 m0, s23, 12288
s_add_u32 s40, s22, 12288
buffer_load_dwordx4 v2, s[8:11], s40 offen offset:0 lds
buffer_load_dwordx4 v2, s[8:11], s40 offen offset:1024 lds
buffer_load_dwordx4 v2, s[8:11], s40 offen offset:2048 lds
buffer_load_dwordx4 v2, s[8:11], s40 offen offset:3072 lds
s_add_u32 m0, s23, 16384
s_add_u32 s40, s22, 16384
buffer_load_dwordx4 v2, s[8:11], s40 offen offset:0 lds
buffer_load_dwordx4 v2, s[8:11], s40 offen offset:1024 lds
buffer_load_dwordx4 v2, s[8:11], s40 offen offset:2048 lds
buffer_load_dwordx4 v2, s[8:11], s40 offen offset:3072 lds
s_add_u32 m0, s23, 20480
s_add_u32 s40, s22, 20480
buffer_load_dwordx4 v2, s[8:11], s40 offen offset:0 lds
buffer_load_dwordx4 v2, s[8:11], s40 offen offset:1024 lds
buffer_load_dwordx4 v2, s[8:11], s40 offen offset:2048 lds
buffer_load_dwordx4 v2, s[8:11], s40 offen offset:3072 lds
s_add_u32 m0, s23, 24576
s_add_u32 s40, s22, 24576
buffer_load_dwordx4 v2, s[8:11], s40 offen offset:0 lds
buffer_load_dwordx4 v2, s[8:11], s40 offen offset:1024 lds
buffer_load_dwordx4 v2, s[8:11], s40 offen offset:2048 lds
buffer_load_dwordx4 v2, s[8:11], s40 offen offset:3072 lds
s_add_u32 m0, s23, 28672
s_add_u32 s40, s22, 28672
buffer_load_dwordx4 v2, s[8:11], s40 offen offset:0 lds
buffer_load_dwordx4 v2, s[8:11], s40 offen offset:1024 lds
L_a2_go:
s_barrier
s_mul_i32 s24, s20, 18432
s_add_u32 s25, s24, s72
buffer_load_dwordx4 a[0:3], v2, s[8:11], s25 offen offset:0 sc1
buffer_load_dwordx4 a[4:7], v2, s[8:11], s25 offen offset:1024 sc1
buffer_load_dwordx4 a[8:11], v2, s[8:11], s25 offen offset:2048 sc1
buffer_load_dwordx4 a[12:15], v2, s[8:11], s25 offen offset:3072 sc1
s_add_u32 s25, s25, 4096
buffer_load_dwordx4 a[16:19], v2, s[8:11], s25 offen offset:0 sc1
buffer_load_dwordx4 a[20:23], v2, s[8:11], s25 offen offset:1024 sc1
buffer_load_dwordx4 a[24:27], v2, s[8:11], s25 offen offset:2048 sc1
buffer_load_dwordx4 a[28:31], v2, s[8:11], s25 offen offset:3072 sc1
s_add_u32 s25, s25, 4096
buffer_load_dwordx4 a[32:35], v2, s[8:11], s25 offen offset:0 sc1
buffer_load_dwordx4 a[36:39], v2, s[8:11], s25 offen offset:1024 sc1
buffer_load_dwordx4 a[40:43], v2, s[8:11], s25 offen offset:2048 sc1
buffer_load_dwordx4 a[44:47], v2, s[8:11], s25 offen offset:3072 sc1
s_add_u32 s25, s25, 4096
buffer_load_dwordx4 a[48:51], v2, s[8:11], s25 offen offset:0 sc1
buffer_load_dwordx4 a[52:55], v2, s[8:11], s25 offen offset:1024 sc1
buffer_load_dwordx4 a[56:59], v2, s[8:11], s25 offen offset:2048 sc1
buffer_load_dwordx4 a[60:63], v2, s[8:11], s25 offen offset:3072 sc1
s_add_u32 s25, s25, 4096
buffer_load_dwordx4 a[64:67], v2, s[8:11], s25 offen offset:0 sc1
buffer_load_dwordx4 a[68:71], v2, s[8:11], s25 offen offset:1024 sc1
s_mul_i32 s26, s21, 2304
s_add_u32 s26, s26, s24
s_add_u32 s27, s26, s71
v_and_b32 v6, 15, v1
v_lshrrev_b32 v7, 4, v1
v_lshlrev_b32 v8, 4, v6
v_lshl_add_u32 v8, v7, 3, v8
v_add_u32 v8, 2048, v8
v_mov_b32 v9, 2146435072
v_cmp_gt_u32 vcc, 32, v1
s_nop 1
v_cndmask_b32 v4, v9, v8, vcc
buffer_load_dwordx4 v[56:59], v2, s[8:11], s27 offen sc1
buffer_load_dwordx4 v[60:63], v2, s[8:11], s27 offen offset:1024 sc1
buffer_load_dwordx2 v[64:65], v4, s[8:11], s27 offen sc1
v_add_u32 v5, 0x10000, v2
s_waitcnt vmcnt(21)
s_barrier
ds_read_b128 a[216:219], v2 offset:0
ds_read_b128 a[220:223], v2 offset:5120
ds_read_b128 a[224:227], v2 offset:1024
ds_read_b128 a[228:231], v2 offset:6144
ds_read_b128 a[232:235], v2 offset:2048
ds_read_b128 a[236:239], v2 offset:7168
s_waitcnt vmcnt(19)
s_waitcnt lgkmcnt(4)
v_mfma_f32_16x16x32_bf16 v[32:35], a[216:219], a[0:3], 0
ds_read_b128 a[240:243], v2 offset:3072
v_mfma_f32_16x16x32_bf16 v[32:35], a[220:223], a[4:7], v[32:35]
ds_read_b128 a[244:247], v2 offset:8192
s_waitcnt lgkmcnt(4)
v_mfma_f32_16x16x32_bf16 v[36:39], a[224:227], a[0:3], 0
ds_read_b128 a[216:219], v2 offset:4096
v_mfma_f32_16x16x32_bf16 v[36:39], a[228:231], a[4:7], v[36:39]
ds_read_b128 a[220:223], v2 offset:9216
s_waitcnt lgkmcnt(4)
v_mfma_f32_16x16x32_bf16 v[40:43], a[232:235], a[0:3], 0
ds_read_b128 a[224:227], v2 offset:10240
v_mfma_f32_16x16x32_bf16 v[40:43], a[236:239], a[4:7], v[40:43]
ds_read_b128 a[228:231], v2 offset:15360
s_waitcnt lgkmcnt(4)
v_mfma_f32_16x16x32_bf16 v[44:47], a[240:243], a[0:3], 0
ds_read_b128 a[232:235], v2 offset:11264
v_mfma_f32_16x16x32_bf16 v[44:47], a[244:247], a[4:7], v[44:47]
ds_read_b128 a[236:239], v2 offset:16384
s_waitcnt lgkmcnt(4)
v_mfma_f32_16x16x32_bf16 v[48:51], a[216:219], a[0:3], 0
ds_read_b128 a[240:243], v2 offset:12288
v_mfma_f32_16x16x32_bf16 v[48:51], a[220:223], a[4:7], v[48:51]
ds_read_b128 a[244:247], v2 offset:17408
s_waitcnt vmcnt(17)
s_waitcnt lgkmcnt(4)
v_mfma_f32_16x16x32_bf16 v[32:35], a[224:227], a[8:11], v[32:35]
ds_read_b128 a[216:219], v2 offset:13312
v_mfma_f32_16x16x32_bf16 v[32:35], a[228:231], a[12:15], v[32:35]
ds_read_b128 a[220:223], v2 offset:18432
s_waitcnt lgkmcnt(4)
v_mfma_f32_16x16x32_bf16 v[36:39], a[232:235], a[8:11], v[36:39]
ds_read_b128 a[224:227], v2 offset:14336
v_mfma_f32_16x16x32_bf16 v[36:39], a[236:239], a[12:15], v[36:39]
ds_read_b128 a[228:231], v2 offset:19456
s_waitcnt lgkmcnt(4)
v_mfma_f32_16x16x32_bf16 v[40:43], a[240:243], a[8:11], v[40:43]
ds_read_b128 a[232:235], v2 offset:20480
v_mfma_f32_16x16x32_bf16 v[40:43], a[244:247], a[12:15], v[40:43]
ds_read_b128 a[236:239], v2 offset:25600
s_waitcnt lgkmcnt(4)
v_mfma_f32_16x16x32_bf16 v[44:47], a[216:219], a[8:11], v[44:47]
ds_read_b128 a[240:243], v2 offset:21504
v_mfma_f32_16x16x32_bf16 v[44:47], a[220:223], a[12:15], v[44:47]
ds_read_b128 a[244:247], v2 offset:26624
s_waitcnt lgkmcnt(4)
v_mfma_f32_16x16x32_bf16 v[48:51], a[224:227], a[8:11], v[48:51]
ds_read_b128 a[216:219], v2 offset:22528
v_mfma_f32_16x16x32_bf16 v[48:51], a[228:231], a[12:15], v[48:51]
ds_read_b128 a[220:223], v2 offset:27648
s_waitcnt vmcnt(15)
s_waitcnt lgkmcnt(4)
v_mfma_f32_16x16x32_bf16 v[32:35], a[232:235], a[16:19], v[32:35]
ds_read_b128 a[224:227], v2 offset:23552
v_mfma_f32_16x16x32_bf16 v[32:35], a[236:239], a[20:23], v[32:35]
ds_read_b128 a[228:231], v2 offset:28672
s_waitcnt lgkmcnt(4)
v_mfma_f32_16x16x32_bf16 v[36:39], a[240:243], a[16:19], v[36:39]
ds_read_b128 a[232:235], v2 offset:24576
v_mfma_f32_16x16x32_bf16 v[36:39], a[244:247], a[20:23], v[36:39]
ds_read_b128 a[236:239], v2 offset:29696
s_waitcnt lgkmcnt(4)
v_mfma_f32_16x16x32_bf16 v[40:43], a[216:219], a[16:19], v[40:43]
ds_read_b128 a[240:243], v2 offset:30720
v_mfma_f32_16x16x32_bf16 v[40:43], a[220:223], a[20:23], v[40:43]
ds_read_b128 a[244:247], v2 offset:35840
s_waitcnt lgkmcnt(4)
v_mfma_f32_16x16x32_bf16 v[44:47], a[224:227], a[16:19], v[44:47]
ds_read_b128 a[216:219], v2 offset:31744
v_mfma_f32_16x16x32_bf16 v[44:47], a[228:231], a[20:23], v[44:47]
ds_read_b128 a[220:223], v2 offset:36864
s_waitcnt lgkmcnt(4)
v_mfma_f32_16x16x32_bf16 v[48:51], a[232:235], a[16:19], v[48:51]
ds_read_b128 a[224:227], v2 offset:32768
v_mfma_f32_16x16x32_bf16 v[48:51], a[236:239], a[20:23], v[48:51]
ds_read_b128 a[228:231], v2 offset:37888
s_waitcnt vmcnt(13)
s_waitcnt lgkmcnt(4)
v_mfma_f32_16x16x32_bf16 v[32:35], a[240:243], a[24:27], v[32:35]
ds_read_b128 a[232:235], v2 offset:33792
v_mfma_f32_16x16x32_bf16 v[32:35], a[244:247], a[28:31], v[32:35]
ds_read_b128 a[236:239], v2 offset:38912
s_waitcnt lgkmcnt(4)
v_mfma_f32_16x16x32_bf16 v[36:39], a[216:219], a[24:27], v[36:39]
ds_read_b128 a[240:243], v2 offset:34816
v_mfma_f32_16x16x32_bf16 v[36:39], a[220:223], a[28:31], v[36:39]
ds_read_b128 a[244:247], v2 offset:39936
s_waitcnt lgkmcnt(4)
v_mfma_f32_16x16x32_bf16 v[40:43], a[224:227], a[24:27], v[40:43]
ds_read_b128 a[216:219], v2 offset:40960
v_mfma_f32_16x16x32_bf16 v[40:43], a[228:231], a[28:31], v[40:43]
ds_read_b128 a[220:223], v2 offset:46080
s_waitcnt lgkmcnt(4)
v_mfma_f32_16x16x32_bf16 v[44:47], a[232:235], a[24:27], v[44:47]
ds_read_b128 a[224:227], v2 offset:41984
v_mfma_f32_16x16x32_bf16 v[44:47], a[236:239], a[28:31], v[44:47]
ds_read_b128 a[228:231], v2 offset:47104
s_waitcnt lgkmcnt(4)
v_mfma_f32_16x16x32_bf16 v[48:51], a[240:243], a[24:27], v[48:51]
ds_read_b128 a[232:235], v2 offset:43008
v_mfma_f32_16x16x32_bf16 v[48:51], a[244:247], a[28:31], v[48:51]
ds_read_b128 a[236:239], v2 offset:48128
s_waitcnt vmcnt(11)
s_waitcnt lgkmcnt(4)
v_mfma_f32_16x16x32_bf16 v[32:35], a[216:219], a[32:35], v[32:35]
ds_read_b128 a[240:243], v2 offset:44032
v_mfma_f32_16x16x32_bf16 v[32:35], a[220:223], a[36:39], v[32:35]
ds_read_b128 a[244:247], v2 offset:49152
s_waitcnt lgkmcnt(4)
v_mfma_f32_16x16x32_bf16 v[36:39], a[224:227], a[32:35], v[36:39]
ds_read_b128 a[216:219], v2 offset:45056
v_mfma_f32_16x16x32_bf16 v[36:39], a[228:231], a[36:39], v[36:39]
ds_read_b128 a[220:223], v2 offset:50176
s_waitcnt lgkmcnt(4)
v_mfma_f32_16x16x32_bf16 v[40:43], a[232:235], a[32:35], v[40:43]
ds_read_b128 a[224:227], v2 offset:51200
v_mfma_f32_16x16x32_bf16 v[40:43], a[236:239], a[36:39], v[40:43]
ds_read_b128 a[228:231], v2 offset:56320
s_waitcnt lgkmcnt(4)
v_mfma_f32_16x16x32_bf16 v[44:47], a[240:243], a[32:35], v[44:47]
ds_read_b128 a[232:235], v2 offset:52224
v_mfma_f32_16x16x32_bf16 v[44:47], a[244:247], a[36:39], v[44:47]
ds_read_b128 a[236:239], v2 offset:57344
s_waitcnt lgkmcnt(4)
v_mfma_f32_16x16x32_bf16 v[48:51], a[216:219], a[32:35], v[48:51]
ds_read_b128 a[240:243], v2 offset:53248
v_mfma_f32_16x16x32_bf16 v[48:51], a[220:223], a[36:39], v[48:51]
ds_read_b128 a[244:247], v2 offset:58368
s_waitcnt vmcnt(9)
s_waitcnt lgkmcnt(4)
v_mfma_f32_16x16x32_bf16 v[32:35], a[224:227], a[40:43], v[32:35]
ds_read_b128 a[216:219], v2 offset:54272
v_mfma_f32_16x16x32_bf16 v[32:35], a[228:231], a[44:47], v[32:35]
ds_read_b128 a[220:223], v2 offset:59392
s_waitcnt lgkmcnt(4)
v_mfma_f32_16x16x32_bf16 v[36:39], a[232:235], a[40:43], v[36:39]
ds_read_b128 a[224:227], v2 offset:55296
v_mfma_f32_16x16x32_bf16 v[36:39], a[236:239], a[44:47], v[36:39]
ds_read_b128 a[228:231], v2 offset:60416
s_waitcnt lgkmcnt(4)
v_mfma_f32_16x16x32_bf16 v[40:43], a[240:243], a[40:43], v[40:43]
ds_read_b128 a[232:235], v2 offset:61440
v_mfma_f32_16x16x32_bf16 v[40:43], a[244:247], a[44:47], v[40:43]
ds_read_b128 a[236:239], v5 offset:1024
s_waitcnt lgkmcnt(4)
v_mfma_f32_16x16x32_bf16 v[44:47], a[216:219], a[40:43], v[44:47]
ds_read_b128 a[240:243], v2 offset:62464
v_mfma_f32_16x16x32_bf16 v[44:47], a[220:223], a[44:47], v[44:47]
ds_read_b128 a[244:247], v5 offset:2048
s_waitcnt lgkmcnt(4)
v_mfma_f32_16x16x32_bf16 v[48:51], a[224:227], a[40:43], v[48:51]
ds_read_b128 a[216:219], v2 offset:63488
v_mfma_f32_16x16x32_bf16 v[48:51], a[228:231], a[44:47], v[48:51]
ds_read_b128 a[220:223], v5 offset:3072
s_waitcnt vmcnt(7)
s_waitcnt lgkmcnt(4)
v_mfma_f32_16x16x32_bf16 v[32:35], a[232:235], a[48:51], v[32:35]
ds_read_b128 a[224:227], v2 offset:64512
v_mfma_f32_16x16x32_bf16 v[32:35], a[236:239], a[52:55], v[32:35]
ds_read_b128 a[228:231], v5 offset:4096
s_waitcnt lgkmcnt(4)
v_mfma_f32_16x16x32_bf16 v[36:39], a[240:243], a[48:51], v[36:39]
ds_read_b128 a[232:235], v5 offset:0
v_mfma_f32_16x16x32_bf16 v[36:39], a[244:247], a[52:55], v[36:39]
ds_read_b128 a[236:239], v5 offset:5120
s_waitcnt lgkmcnt(4)
v_mfma_f32_16x16x32_bf16 v[40:43], a[216:219], a[48:51], v[40:43]
ds_read_b128 a[240:243], v5 offset:6144
v_mfma_f32_16x16x32_bf16 v[40:43], a[220:223], a[52:55], v[40:43]
ds_read_b128 a[244:247], v5 offset:11264
s_waitcnt lgkmcnt(4)
v_mfma_f32_16x16x32_bf16 v[44:47], a[224:227], a[48:51], v[44:47]
ds_read_b128 a[216:219], v5 offset:7168
v_mfma_f32_16x16x32_bf16 v[44:47], a[228:231], a[52:55], v[44:47]
ds_read_b128 a[220:223], v5 offset:12288
s_waitcnt lgkmcnt(4)
v_mfma_f32_16x16x32_bf16 v[48:51], a[232:235], a[48:51], v[48:51]
ds_read_b128 a[224:227], v5 offset:8192
v_mfma_f32_16x16x32_bf16 v[48:51], a[236:239], a[52:55], v[48:51]
ds_read_b128 a[228:231], v5 offset:13312
s_waitcnt vmcnt(5)
s_waitcnt lgkmcnt(4)
v_mfma_f32_16x16x32_bf16 v[32:35], a[240:243], a[56:59], v[32:35]
ds_read_b128 a[232:235], v5 offset:9216
v_mfma_f32_16x16x32_bf16 v[32:35], a[244:247], a[60:63], v[32:35]
ds_read_b128 a[236:239], v5 offset:14336
s_waitcnt lgkmcnt(4)
v_mfma_f32_16x16x32_bf16 v[36:39], a[216:219], a[56:59], v[36:39]
ds_read_b128 a[240:243], v5 offset:10240
v_mfma_f32_16x16x32_bf16 v[36:39], a[220:223], a[60:63], v[36:39]
ds_read_b128 a[244:247], v5 offset:15360
s_waitcnt lgkmcnt(4)
v_mfma_f32_16x16x32_bf16 v[40:43], a[224:227], a[56:59], v[40:43]
ds_read_b128 a[216:219], v5 offset:16384
v_mfma_f32_16x16x32_bf16 v[40:43], a[228:231], a[60:63], v[40:43]
ds_read_b128 a[220:223], v5 offset:21504
s_waitcnt lgkmcnt(4)
v_mfma_f32_16x16x32_bf16 v[44:47], a[232:235], a[56:59], v[44:47]
ds_read_b128 a[224:227], v5 offset:17408
v_mfma_f32_16x16x32_bf16 v[44:47], a[236:239], a[60:63], v[44:47]
ds_read_b128 a[228:231], v5 offset:22528
s_waitcnt lgkmcnt(4)
v_mfma_f32_16x16x32_bf16 v[48:51], a[240:243], a[56:59], v[48:51]
ds_read_b128 a[232:235], v5 offset:18432
v_mfma_f32_16x16x32_bf16 v[48:51], a[244:247], a[60:63], v[48:51]
ds_read_b128 a[236:239], v5 offset:23552
s_waitcnt vmcnt(3)
s_waitcnt lgkmcnt(4)
v_mfma_f32_16x16x32_bf16 v[32:35], a[216:219], a[64:67], v[32:35]
ds_read_b128 a[240:243], v5 offset:19456
v_mfma_f32_16x16x32_bf16 v[32:35], a[220:223], a[68:71], v[32:35]
ds_read_b128 a[244:247], v5 offset:24576
s_waitcnt lgkmcnt(4)
v_mfma_f32_16x16x32_bf16 v[36:39], a[224:227], a[64:67], v[36:39]
ds_read_b128 a[216:219], v5 offset:20480
v_mfma_f32_16x16x32_bf16 v[36:39], a[228:231], a[68:71], v[36:39]
ds_read_b128 a[220:223], v5 offset:25600
s_waitcnt lgkmcnt(4)
v_mfma_f32_16x16x32_bf16 v[40:43], a[232:235], a[64:67], v[40:43]
v_mfma_f32_16x16x32_bf16 v[40:43], a[236:239], a[68:71], v[40:43]
s_waitcnt lgkmcnt(2)
v_mfma_f32_16x16x32_bf16 v[44:47], a[240:243], a[64:67], v[44:47]
v_mfma_f32_16x16x32_bf16 v[44:47], a[244:247], a[68:71], v[44:47]
s_waitcnt lgkmcnt(0)
v_mfma_f32_16x16x32_bf16 v[48:51], a[216:219], a[64:67], v[48:51]
v_mfma_f32_16x16x32_bf16 v[48:51], a[220:223], a[68:71], v[48:51]
s_waitcnt vmcnt(0)
v_lshlrev_b32 v68, 16, v56
v_and_b32 v69, 0xffff0000, v56
v_add_f32 v32, v32, v68
v_add_f32 v33, v33, v69
v_lshlrev_b32 v70, 16, v57
v_and_b32 v71, 0xffff0000, v57
v_add_f32 v34, v34, v70
v_add_f32 v35, v35, v71
v_lshlrev_b32 v72, 16, v58
v_and_b32 v73, 0xffff0000, v58
v_add_f32 v36, v36, v72
v_add_f32 v37, v37, v73
v_lshlrev_b32 v74, 16, v59
v_and_b32 v75, 0xffff0000, v59
v_add_f32 v38, v38, v74
v_add_f32 v39, v39, v75
v_lshlrev_b32 v68, 16, v60
v_and_b32 v69, 0xffff0000, v60
v_add_f32 v40, v40, v68
v_add_f32 v41, v41, v69
v_lshlrev_b32 v70, 16, v61
v_and_b32 v71, 0xffff0000, v61
v_add_f32 v42, v42, v70
v_add_f32 v43, v43, v71
v_lshlrev_b32 v72, 16, v62
v_and_b32 v73, 0xffff0000, v62
v_add_f32 v44, v44, v72
v_add_f32 v45, v45, v73
v_lshlrev_b32 v74, 16, v63
v_and_b32 v75, 0xffff0000, v63
v_add_f32 v46, v46, v74
v_add_f32 v47, v47, v75
v_lshlrev_b32 v68, 16, v64
v_and_b32 v69, 0xffff0000, v64
v_add_f32 v48, v48, v68
v_add_f32 v49, v49, v69
v_lshlrev_b32 v70, 16, v65
v_and_b32 v71, 0xffff0000, v65
v_add_f32 v50, v50, v70
v_add_f32 v51, v51, v71
v_cvt_pk_bf16_f32 v80, v32, v33
v_cvt_pk_bf16_f32 v81, v34, v35
v_cvt_pk_bf16_f32 v82, v36, v37
v_cvt_pk_bf16_f32 v83, v38, v39
v_cvt_pk_bf16_f32 v84, v40, v41
v_cvt_pk_bf16_f32 v85, v42, v43
v_cvt_pk_bf16_f32 v86, v44, v45
v_cvt_pk_bf16_f32 v87, v46, v47
v_cvt_pk_bf16_f32 v88, v48, v49
v_cvt_pk_bf16_f32 v89, v50, v51
s_add_u32 s27, s26, s73
buffer_store_dwordx4 v[80:83], v2, s[8:11], s27 offen sc1
buffer_store_dwordx4 v[84:87], v2, s[8:11], s27 offen offset:1024 sc1
buffer_store_dwordx2 v[88:89], v4, s[8:11], s27 offen sc1
v_add_f32 v10, v32, v33
v_mul_f32 v11, v32, v32
v_mul_f32 v13, v33, v33
v_mov_b32 v12, 0
v_add_f32 v10, v10, v34
v_add_f32 v12, v12, v35
v_fmac_f32 v11, v34, v34
v_fmac_f32 v13, v35, v35
v_add_f32 v10, v10, v36
v_add_f32 v12, v12, v37
v_fmac_f32 v11, v36, v36
v_fmac_f32 v13, v37, v37
v_add_f32 v10, v10, v38
v_add_f32 v12, v12, v39
v_fmac_f32 v11, v38, v38
v_fmac_f32 v13, v39, v39
v_add_f32 v10, v10, v40
v_add_f32 v12, v12, v41
v_fmac_f32 v11, v40, v40
v_fmac_f32 v13, v41, v41
v_add_f32 v10, v10, v42
v_add_f32 v12, v12, v43
v_fmac_f32 v11, v42, v42
v_fmac_f32 v13, v43, v43
v_add_f32 v10, v10, v44
v_add_f32 v12, v12, v45
v_fmac_f32 v11, v44, v44
v_fmac_f32 v13, v45, v45
v_add_f32 v10, v10, v46
v_add_f32 v12, v12, v47
v_fmac_f32 v11, v46, v46
v_fmac_f32 v13, v47, v47
v_add_f32 v10, v10, v48
v_add_f32 v12, v12, v49
v_fmac_f32 v11, v48, v48
v_fmac_f32 v13, v49, v49
v_add_f32 v10, v10, v50
v_add_f32 v12, v12, v51
v_fmac_f32 v11, v50, v50
v_fmac_f32 v13, v51, v51
v_add_f32 v10, v10, v12
v_add_f32 v11, v11, v13
v_mov_b32 v12, v10
v_mov_b32 v13, v11
s_nop 0
v_permlane16_swap_b32 v10, v12
v_permlane16_swap_b32 v11, v13
v_add_f32 v10, v10, v12
v_add_f32 v11, v11, v13
v_mov_b32 v12, v10
v_mov_b32 v13, v11
s_nop 0
v_permlane32_swap_b32 v10, v12
v_permlane32_swap_b32 v11, v13
v_add_f32 v10, v10, v12
v_add_f32 v11, v11, v13
v_lshlrev_b32 v8, 3, v6
v_cmp_gt_u32 vcc, 16, v1
s_nop 1
v_cndmask_b32 v8, v9, v8, vcc
s_lshl_b32 s27, s20, 10
s_lshl_b32 s28, s21, 7
s_add_u32 s27, s27, s28
s_add_u32 s27, s27, s74
buffer_store_dwordx2 v[10:11], v8, s[8:11], s27 offen sc1
s_lshr_b32 s27, s20, 2
s_lshl_b32 s27, s27, 3
s_add_u32 s27, s27, s21
s_lshl_b32 s27, s27, 2
s_add_u32 s27, s27, s4
s_lshl_b32 s27, s27, 2
s_add_u32 s27, s27, s77
s_add_u32 s27, s27, 24576
v_mov_b32 v14, 2146435072
v_cmp_eq_u32 vcc, 0, v1
s_nop 1
v_cndmask_b32 v14, v14, 0, vcc
v_mov_b32 v15, 1
s_waitcnt vmcnt(0)
buffer_store_dword v15, v14, s[8:11], s27 offen sc1
s_and_b32 s40, s5, 1
s_lshl_b32 s40, s40, 2
s_lshr_b32 s41, s6, 3
s_add_u32 s40, s40, s41
s_lshr_b32 s41, s5, 1
s_lshl_b32 s41, s41, 3
s_and_b32 s42, s6, 7
s_add_u32 s41, s41, s42
s_lshr_b32 s42, s41, 2
s_and_b32 s43, s41, 3
s_lshl_b32 s44, s40, 4
s_lshl_b32 s45, s4, 2
s_add_u32 s44, s44, s45
s_mul_i32 s46, s44, 18432
s_add_u32 s20, s46, s73
s_mul_i32 s22, s4, 6144
s_mul_i32 s21, s41, 497664
s_add_u32 s21, s21, s22
s_add_u32 s21, s21, 3366912
s_cmp_eq_u32 s4, 0
s_cbranch_scc0 L_f_pre
s_lshl_b32 s47, s40, 9
s_add_u32 s47, s47, s77
s_add_u32 s47, s47, 24576
v_lshlrev_b32 v13, 3, v1
s_mov_b32 s52, 0
L_poll2:
buffer_load_dwordx2 v[14:15], v13, s[8:11], s47 offen sc1
s_add_u32 s52, s52, 1
s_waitcnt vmcnt(0)
v_min_u32 v14, v14, v15
v_cmp_ne_u32 vcc, 0, v14
s_cmp_gt_u32 s52, 0x80000
s_cbranch_scc1 L_got2
s_cmp_eq_u64 vcc, exec
s_cbranch_scc0 L_poll2
L_got2:
s_branch L_f_go
L_f_pre:
s_sub_u32 s47, s4, 1
s_lshl_b32 s47, s47, 14
s_sub_u32 s48, s21, s22
s_add_u32 s48, s48, s47
s_add_u32 s47, s47, 98304
s_add_u32 m0, s47, 0
s_add_u32 s23, s48, 0
buffer_load_dwordx4 v2, s[8:11], s23 offen offset:0 lds
buffer_load_dwordx4 v2, s[8:11], s23 offen offset:1024 lds
buffer_load_dwordx4 v2, s[8:11], s23 offen offset:2048 lds
buffer_load_dwordx4 v2, s[8:11], s23 offen offset:3072 lds
s_add_u32 m0, s47, 4096
s_add_u32 s23, s48, 4096
buffer_load_dwordx4 v2, s[8:11], s23 offen offset:0 lds
buffer_load_dwordx4 v2, s[8:11], s23 offen offset:1024 lds
buffer_load_dwordx4 v2, s[8:11], s23 offen offset:2048 lds
buffer_load_dwordx4 v2, s[8:11], s23 offen offset:3072 lds
s_add_u32 m0, s47, 8192
s_add_u32 s23, s48, 8192
buffer_load_dwordx4 v2, s[8:11], s23 offen offset:0 lds
buffer_load_dwordx4 v2, s[8:11], s23 offen offset:1024 lds
buffer_load_dwordx4 v2, s[8:11], s23 offen offset:2048 lds
buffer_load_dwordx4 v2, s[8:11], s23 offen offset:3072 lds
s_add_u32 m0, s47, 12288
s_add_u32 s23, s48, 12288
buffer_load_dwordx4 v2, s[8:11], s23 offen offset:0 lds
buffer_load_dwordx4 v2, s[8:11], s23 offen offset:1024 lds
buffer_load_dwordx4 v2, s[8:11], s23 offen offset:2048 lds
buffer_load_dwordx4 v2, s[8:11], s23 offen offset:3072 lds
L_f_go:
s_barrier
v_add_u32 v4, 18432, v2
v_add_u32 v5, 36864, v2
v_add_u32 v6, 55296, v2
v_and_b32 v13, 15, v1
v_lshrrev_b32 v14, 4, v1
v_lshlrev_b32 v15, 3, v13
v_lshl_add_u32 v15, v14, 8, v15
s_lshl_b32 s47, s44, 10
s_add_u32 s47, s47, s74
buffer_load_dwordx2 v[144:145], v15, s[8:11], s47 offen offset:0 sc1
buffer_load_dwordx2 v[146:147], v15, s[8:11], s47 offen offset:128 sc1
buffer_load_dwordx2 v[148:149], v15, s[8:11], s47 offen offset:1024 sc1
buffer_load_dwordx2 v[150:151], v15, s[8:11], s47 offen offset:1152 sc1
buffer_load_dwordx2 v[152:153], v15, s[8:11], s47 offen offset:2048 sc1
buffer_load_dwordx2 v[154:155], v15, s[8:11], s47 offen offset:2176 sc1
buffer_load_dwordx2 v[156:157], v15, s[8:11], s47 offen offset:3072 sc1
buffer_load_dwordx2 v[158:159], v15, s[8:11], s47 offen offset:3200 sc1
s_add_u32 s48, s20, 0
buffer_load_dwordx4 a[0:3], v2, s[8:11], s48 offen offset:0 sc1
buffer_load_dwordx4 a[4:7], v4, s[8:11], s48 offen offset:0 sc1
buffer_load_dwordx4 a[8:11], v5, s[8:11], s48 offen offset:0 sc1
buffer_load_dwordx4 a[12:15], v6, s[8:11], s48 offen offset:0 sc1
buffer_load_dwordx4 a[16:19], v2, s[8:11], s48 offen offset:1024 sc1
buffer_load_dwordx4 a[20:23], v4, s[8:11], s48 offen offset:1024 sc1
buffer_load_dwordx4 a[24:27], v5, s[8:11], s48 offen offset:1024 sc1
buffer_load_dwordx4 a[28:31], v6, s[8:11], s48 offen offset:1024 sc1
buffer_load_dwordx4 a[32:35], v2, s[8:11], s48 offen offset:2048 sc1
buffer_load_dwordx4 a[36:39], v4, s[8:11], s48 offen offset:2048 sc1
buffer_load_dwordx4 a[40:43], v5, s[8:11], s48 offen offset:2048 sc1
buffer_load_dwordx4 a[44:47], v6, s[8:11], s48 offen offset:2048 sc1
buffer_load_dwordx4 a[48:51], v2, s[8:11], s48 offen offset:3072 sc1
buffer_load_dwordx4 a[52:55], v4, s[8:11], s48 offen offset:3072 sc1
buffer_load_dwordx4 a[56:59], v5, s[8:11], s48 offen offset:3072 sc1
buffer_load_dwordx4 a[60:63], v6, s[8:11], s48 offen offset:3072 sc1
s_add_u32 s48, s20, 4096
buffer_load_dwordx4 a[64:67], v2, s[8:11], s48 offen offset:0 sc1
buffer_load_dwordx4 a[68:71], v4, s[8:11], s48 offen offset:0 sc1
buffer_load_dwordx4 a[72:75], v5, s[8:11], s48 offen offset:0 sc1
buffer_load_dwordx4 a[76:79], v6, s[8:11], s48 offen offset:0 sc1
buffer_load_dwordx4 a[80:83], v2, s[8:11], s48 offen offset:1024 sc1
buffer_load_dwordx4 a[84:87], v4, s[8:11], s48 offen offset:1024 sc1
buffer_load_dwordx4 a[88:91], v5, s[8:11], s48 offen offset:1024 sc1
buffer_load_dwordx4 a[92:95], v6, s[8:11], s48 offen offset:1024 sc1
buffer_load_dwordx4 a[96:99], v2, s[8:11], s48 offen offset:2048 sc1
buffer_load_dwordx4 a[100:103], v4, s[8:11], s48 offen offset:2048 sc1
buffer_load_dwordx4 a[104:107], v5, s[8:11], s48 offen offset:2048 sc1
buffer_load_dwordx4 a[108:111], v6, s[8:11], s48 offen offset:2048 sc1
buffer_load_dwordx4 a[112:115], v2, s[8:11], s48 offen offset:3072 sc1
buffer_load_dwordx4 a[116:119], v4, s[8:11], s48 offen offset:3072 sc1
buffer_load_dwordx4 a[120:123], v5, s[8:11], s48 offen offset:3072 sc1
buffer_load_dwordx4 a[124:127], v6, s[8:11], s48 offen offset:3072 sc1
s_add_u32 s48, s20, 8192
buffer_load_dwordx4 a[128:131], v2, s[8:11], s48 offen offset:0 sc1
buffer_load_dwordx4 a[132:135], v4, s[8:11], s48 offen offset:0 sc1
buffer_load_dwordx4 a[136:139], v5, s[8:11], s48 offen offset:0 sc1
buffer_load_dwordx4 a[140:143], v6, s[8:11], s48 offen offset:0 sc1
buffer_load_dwordx4 a[144:147], v2, s[8:11], s48 offen offset:1024 sc1
buffer_load_dwordx4 a[148:151], v4, s[8:11], s48 offen offset:1024 sc1
buffer_load_dwordx4 a[152:155], v5, s[8:11], s48 offen offset:1024 sc1
buffer_load_dwordx4 a[156:159], v6, s[8:11], s48 offen offset:1024 sc1
buffer_load_dwordx4 a[160:163], v2, s[8:11], s48 offen offset:2048 sc1
buffer_load_dwordx4 a[164:167], v4, s[8:11], s48 offen offset:2048 sc1
buffer_load_dwordx4 a[168:171], v5, s[8:11], s48 offen offset:2048 sc1
buffer_load_dwordx4 a[172:175], v6, s[8:11], s48 offen offset:2048 sc1
buffer_load_dwordx4 a[176:179], v2, s[8:11], s48 offen offset:3072 sc1
buffer_load_dwordx4 a[180:183], v4, s[8:11], s48 offen offset:3072 sc1
buffer_load_dwordx4 a[184:187], v5, s[8:11], s48 offen offset:3072 sc1
buffer_load_dwordx4 a[188:191], v6, s[8:11], s48 offen offset:3072 sc1
v_add_u32 v7, 0x10000, v2
v_add_u32 v8, 0x20000, v2
v_and_b32 v9, 1, v14
v_mul_u32_u24 v9, 18432, v9
v_lshrrev_b32 v15, 1, v14
v_lshlrev_b32 v15, 8, v15
v_lshl_add_u32 v15, v13, 4, v15
v_add_u32 v9, v9, v15
v_and_b32 v11, 3, v1
v_lshlrev_b32 v11, 2, v11
s_lshl_b32 s49, s43, 2
v_mov_b32 v10, 2146435072
v_mov_b32 v15, s49
v_cmp_eq_u32 vcc, 0, v1
s_nop 1
v_cndmask_b32 v10, v10, v15, vcc
s_lshl_b32 s49, s40, 3
s_add_u32 s49, s49, s42
s_lshl_b32 s50, s49, 2
s_add_u32 s50, s50, s4
s_lshl_b32 s50, s50, 6
s_add_u32 s34, s50, s77
s_add_u32 s34, s34, 0
s_lshl_b32 s49, s49, 4
s_add_u32 s49, s49, s45
s_mul_i32 s49, s49, 18432
s_add_u32 s49, s49, s75
s_add_u32 s50, s43, 0
s_and_b32 s50, s50, 3
s_mul_i32 s50, s50, 9
s_add_u32 s50, s50, 1
s_lshr_b32 s50, s50, 1
s_lshl_b32 s50, s50, 10
s_add_u32 s24, s49, s50
s_add_u32 s50, s43, 1
s_and_b32 s50, s50, 3
s_mul_i32 s50, s50, 9
s_add_u32 s50, s50, 1
s_lshr_b32 s50, s50, 1
s_lshl_b32 s50, s50, 10
s_add_u32 s25, s49, s50
s_add_u32 s50, s43, 2
s_and_b32 s50, s50, 3
s_mul_i32 s50, s50, 9
s_add_u32 s50, s50, 1
s_lshr_b32 s50, s50, 1
s_lshl_b32 s50, s50, 10
s_add_u32 s26, s49, s50
s_add_u32 s50, s43, 3
s_and_b32 s50, s50, 3
s_mul_i32 s50, s50, 9
s_add_u32 s50, s50, 1
s_lshr_b32 s50, s50, 1
s_lshl_b32 s50, s50, 10
s_add_u32 s27, s49, s50
s_add_u32 s28, s49, 4096
s_add_u32 s29, s49, 13312
s_cmp_ge_u32 s43, 2
s_cselect_b32 s50, s29, s28
s_and_b32 s51, s43, 1
s_lshl_b32 s51, s51, 3
s_add_u32 s30, s50, s51
s_mul_i32 s50, s42, 2359296
s_add_u32 s50, s50, s46
s_mul_i32 s51, s43, 4608
s_add_u32 s50, s50, s51
s_add_u32 s31, s50, s76
s_add_u32 s32, s31, 4096
s_add_u32 s33, s32, 36864
s_waitcnt vmcnt(48)
v_add_f32 v144, v144, v146
v_add_f32 v145, v145, v147
v_add_f32 v148, v148, v150
v_add_f32 v149, v149, v151
v_add_f32 v152, v152, v154
v_add_f32 v153, v153, v155
v_add_f32 v156, v156, v158
v_add_f32 v157, v157, v159
v_mov_b32 v160, v144
v_mov_b32 v161, v145
v_mov_b32 v162, v148
v_mov_b32 v163, v149
v_mov_b32 v164, v152
v_mov_b32 v165, v153
v_mov_b32 v166, v156
v_mov_b32 v167, v157
v_permlane16_swap_b32 v144, v160
v_permlane16_swap_b32 v145, v161
v_permlane16_swap_b32 v148, v162
v_permlane16_swap_b32 v149, v163
v_permlane16_swap_b32 v152, v164
v_permlane16_swap_b32 v153, v165
v_permlane16_swap_b32 v156, v166
v_permlane16_swap_b32 v157, v167
v_add_f32 v144, v144, v160
v_add_f32 v145, v145, v161
v_add_f32 v148, v148, v162
v_add_f32 v149, v149, v163
v_add_f32 v152, v152, v164
v_add_f32 v153, v153, v165
v_add_f32 v156, v156, v166
v_add_f32 v157, v157, v167
v_mov_b32 v160, v144
v_mov_b32 v161, v145
v_mov_b32 v162, v148
v_mov_b32 v163, v149
v_mov_b32 v164, v152
v_mov_b32 v165, v153
v_mov_b32 v166, v156
v_mov_b32 v167, v157
v_permlane32_swap_b32 v144, v160
v_permlane32_swap_b32 v145, v161
v_permlane32_swap_b32 v148, v162
v_permlane32_swap_b32 v149, v163
v_permlane32_swap_b32 v152, v164
v_permlane32_swap_b32 v153, v165
v_permlane32_swap_b32 v156, v166
v_permlane32_swap_b32 v157, v167
v_add_f32 v144, v144, v160
v_add_f32 v145, v145, v161
v_add_f32 v148, v148, v162
v_add_f32 v149, v149, v163
v_add_f32 v152, v152, v164
v_add_f32 v153, v153, v165
v_add_f32 v156, v156, v166
v_add_f32 v157, v157, v167
v_mul_f32 v144, 0x3ae38e39, v144
v_mul_f32 v145, 0x3ae38e39, v145
v_fma_f32 v145, -v144, v144, v145
v_max_f32 v145, 0, v145
v_add_f32 v234, 0x3727c5ac, v145
v_rsq_f32 v144, v234
v_mul_f32 v148, 0x3ae38e39, v148
v_mul_f32 v149, 0x3ae38e39, v149
v_fma_f32 v149, -v148, v148, v149
v_max_f32 v149, 0, v149
v_add_f32 v237, 0x3727c5ac, v149
v_rsq_f32 v148, v237
v_mul_f32 v152, 0x3ae38e39, v152
v_mul_f32 v153, 0x3ae38e39, v153
v_fma_f32 v153, -v152, v152, v153
v_max_f32 v153, 0, v153
v_add_f32 v240, 0x3727c5ac, v153
v_rsq_f32 v152, v240
v_mul_f32 v156, 0x3ae38e39, v156
v_mul_f32 v157, 0x3ae38e39, v157
v_fma_f32 v157, -v156, v156, v157
v_max_f32 v157, 0, v157
v_add_f32 v243, 0x3727c5ac, v157
v_rsq_f32 v156, v243
v_mul_f32 v232, 0xc0135761, v144
v_mul_f32 v145, v144, v144
v_mul_f32 v145, v145, v144
v_mul_f32 v233, 0xbdd2d3e8, v145
v_mul_f32 v235, 0xc0135761, v148
v_mul_f32 v149, v148, v148
v_mul_f32 v149, v149, v148
v_mul_f32 v236, 0xbdd2d3e8, v149
v_mul_f32 v238, 0xc0135761, v152
v_mul_f32 v153, v152, v152
v_mul_f32 v153, v153, v152
v_mul_f32 v239, 0xbdd2d3e8, v153
v_mul_f32 v241, 0xc0135761, v156
v_mul_f32 v157, v156, v156
v_mul_f32 v157, v157, v156
v_mul_f32 v242, 0xbdd2d3e8, v157
s_barrier
ds_read_b128 v[48:51], v7 offset:32768
ds_read_b128 v[52:55], v7 offset:33792
ds_read_b128 v[56:59], v7 offset:34816
ds_read_b128 v[60:63], v7 offset:35840
ds_read_b128 v[64:67], v7 offset:36864
ds_read_b128 v[68:71], v7 offset:37888
s_waitcnt vmcnt(40)
s_waitcnt lgkmcnt(4)
v_mfma_f32_16x16x32_bf16 v[80:83], v[48:51], a[0:3], 0
s_add_u32 s48, s20, 12288
buffer_load_dwordx4 a[192:195], v2, s[8:11], s48 offen offset:0 sc1
v_mfma_f32_16x16x32_bf16 v[80:83], v[52:55], a[16:19], v[80:83]
buffer_load_dwordx4 a[196:199], v4, s[8:11], s48 offen offset:0 sc1
buffer_load_dwordx4 a[200:203], v5, s[8:11], s48 offen offset:0 sc1
v_mfma_f32_16x16x32_bf16 v[84:87], v[48:51], a[4:7], 0
ds_read_b128 v[72:75], v7 offset:38912
buffer_load_dwordx4 a[204:207], v6, s[8:11], s48 offen offset:0 sc1
buffer_load_dwordx4 a[208:211], v2, s[8:11], s48 offen offset:1024 sc1
v_mfma_f32_16x16x32_bf16 v[84:87], v[52:55], a[20:23], v[84:87]
buffer_load_dwordx4 a[212:215], v4, s[8:11], s48 offen offset:1024 sc1
buffer_load_dwordx4 a[216:219], v5, s[8:11], s48 offen offset:1024 sc1
v_mfma_f32_16x16x32_bf16 v[88:91], v[48:51], a[8:11], 0
buffer_load_dwordx4 a[220:223], v6, s[8:11], s48 offen offset:1024 sc1
buffer_load_dwordx4 a[224:227], v2, s[8:11], s48 offen offset:2048 sc1
v_mfma_f32_16x16x32_bf16 v[88:91], v[52:55], a[24:27], v[88:91]
buffer_load_dwordx4 a[228:231], v4, s[8:11], s48 offen offset:2048 sc1
buffer_load_dwordx4 a[232:235], v5, s[8:11], s48 offen offset:2048 sc1
v_mfma_f32_16x16x32_bf16 v[92:95], v[48:51], a[12:15], 0
ds_read_b128 v[76:79], v7 offset:39936
buffer_load_dwordx4 a[236:239], v6, s[8:11], s48 offen offset:2048 sc1
buffer_load_dwordx4 a[240:243], v2, s[8:11], s48 offen offset:3072 sc1
v_mfma_f32_16x16x32_bf16 v[92:95], v[52:55], a[28:31], v[92:95]
buffer_load_dwordx4 a[244:247], v4, s[8:11], s48 offen offset:3072 sc1
buffer_load_dwordx4 a[248:251], v5, s[8:11], s48 offen offset:3072 sc1
s_waitcnt lgkmcnt(4)
v_mfma_f32_16x16x32_bf16 v[96:99], v[56:59], a[0:3], 0
buffer_load_dwordx4 a[252:255], v6, s[8:11], s48 offen offset:3072 sc1
s_add_u32 s48, s20, 16384
v_mfma_f32_16x16x32_bf16 v[96:99], v[60:63], a[16:19], v[96:99]
buffer_load_dwordx4 v[16:19], v2, s[8:11], s48 offen offset:0 sc1
buffer_load_dwordx4 v[20:23], v4, s[8:11], s48 offen offset:0 sc1
v_mfma_f32_16x16x32_bf16 v[100:103], v[56:59], a[4:7], 0
ds_read_b128 v[48:51], v7 offset:40960
buffer_load_dwordx4 v[24:27], v5, s[8:11], s48 offen offset:0 sc1
buffer_load_dwordx4 v[28:31], v6, s[8:11], s48 offen offset:0 sc1
v_mfma_f32_16x16x32_bf16 v[100:103], v[60:63], a[20:23], v[100:103]
buffer_load_dwordx4 v[32:35], v2, s[8:11], s48 offen offset:1024 sc1
buffer_load_dwordx4 v[36:39], v4, s[8:11], s48 offen offset:1024 sc1
v_mfma_f32_16x16x32_bf16 v[104:107], v[56:59], a[8:11], 0
buffer_load_dwordx4 v[40:43], v5, s[8:11], s48 offen offset:1024 sc1
buffer_load_dwordx4 v[44:47], v6, s[8:11], s48 offen offset:1024 sc1
v_mfma_f32_16x16x32_bf16 v[104:107], v[60:63], a[24:27], v[104:107]
s_add_u32 m0, s22, 0
s_add_u32 s23, s21, 49152
v_mfma_f32_16x16x32_bf16 v[108:111], v[56:59], a[12:15], 0
ds_read_b128 v[52:55], v7 offset:41984
buffer_load_dwordx4 v2, s[8:11], s23 offen offset:0 lds
buffer_load_dwordx4 v2, s[8:11], s23 offen offset:1024 lds
v_mfma_f32_16x16x32_bf16 v[108:111], v[60:63], a[28:31], v[108:111]
buffer_load_dwordx4 v2, s[8:11], s23 offen offset:2048 lds
buffer_load_dwordx4 v2, s[8:11], s23 offen offset:3072 lds
s_waitcnt vmcnt(60)
s_waitcnt lgkmcnt(4)
v_mfma_f32_16x16x32_bf16 v[80:83], v[64:67], a[32:35], v[80:83]
s_add_u32 m0, s22, 4096
s_add_u32 s23, s21, 53248
v_mfma_f32_16x16x32_bf16 v[80:83], v[68:71], a[48:51], v[80:83]
buffer_load_dwordx4 v2, s[8:11], s23 offen offset:0 lds
buffer_load_dwordx4 v2, s[8:11], s23 offen offset:1024 lds
v_mfma_f32_16x16x32_bf16 v[84:87], v[64:67], a[36:39], v[84:87]
ds_read_b128 v[56:59], v7 offset:43008
s_add_u32 m0, s22, 24576
s_add_u32 s23, s21, 73728
v_mfma_f32_16x16x32_bf16 v[84:87], v[68:71], a[52:55], v[84:87]
buffer_load_dwordx4 v2, s[8:11], s23 offen offset:0 lds
buffer_load_dwordx4 v2, s[8:11], s23 offen offset:1024 lds
v_mfma_f32_16x16x32_bf16 v[88:91], v[64:67], a[40:43], v[88:91]
buffer_load_dwordx4 v2, s[8:11], s23 offen offset:2048 lds
buffer_load_dwordx4 v2, s[8:11], s23 offen offset:3072 lds
v_mfma_f32_16x16x32_bf16 v[88:91], v[68:71], a[56:59], v[88:91]
s_add_u32 m0, s22, 28672
s_add_u32 s23, s21, 77824
v_mfma_f32_16x16x32_bf16 v[92:95], v[64:67], a[44:47], v[92:95]
ds_read_b128 v[60:63], v7 offset:44032
buffer_load_dwordx4 v2, s[8:11], s23 offen offset:0 lds
buffer_load_dwordx4 v2, s[8:11], s23 offen offset:1024 lds
v_mfma_f32_16x16x32_bf16 v[92:95], v[68:71], a[60:63], v[92:95]
s_add_u32 m0, s22, 49152
s_add_u32 s23, s21, 98304
s_waitcnt lgkmcnt(4)
v_mfma_f32_16x16x32_bf16 v[96:99], v[72:75], a[32:35], v[96:99]
buffer_load_dwordx4 v2, s[8:11], s23 offen offset:0 lds
buffer_load_dwordx4 v2, s[8:11], s23 offen offset:1024 lds
v_mfma_f32_16x16x32_bf16 v[96:99], v[76:79], a[48:51], v[96:99]
buffer_load_dwordx4 v2, s[8:11], s23 offen offset:2048 lds
buffer_load_dwordx4 v2, s[8:11], s23 offen offset:3072 lds
v_mfma_f32_16x16x32_bf16 v[100:103], v[72:75], a[36:39], v[100:103]
ds_read_b128 v[64:67], v7 offset:45056
s_add_u32 m0, s22, 53248
s_add_u32 s23, s21, 102400
v_mfma_f32_16x16x32_bf16 v[100:103], v[76:79], a[52:55], v[100:103]
buffer_load_dwordx4 v2, s[8:11], s23 offen offset:0 lds
buffer_load_dwordx4 v2, s[8:11], s23 offen offset:1024 lds
v_mfma_f32_16x16x32_bf16 v[104:107], v[72:75], a[40:43], v[104:107]
v_mfma_f32_16x16x32_bf16 v[104:107], v[76:79], a[56:59], v[104:107]
v_mfma_f32_16x16x32_bf16 v[108:111], v[72:75], a[44:47], v[108:111]
ds_read_b128 v[68:71], v7 offset:46080
v_mfma_f32_16x16x32_bf16 v[108:111], v[76:79], a[60:63], v[108:111]
s_waitcnt vmcnt(63)
s_waitcnt lgkmcnt(4)
v_mfma_f32_16x16x32_bf16 v[80:83], v[48:51], a[64:67], v[80:83]
v_mfma_f32_16x16x32_bf16 v[80:83], v[52:55], a[80:83], v[80:83]
v_mfma_f32_16x16x32_bf16 v[84:87], v[48:51], a[68:71], v[84:87]
ds_read_b128 v[72:75], v7 offset:47104
v_mfma_f32_16x16x32_bf16 v[84:87], v[52:55], a[84:87], v[84:87]
v_mfma_f32_16x16x32_bf16 v[88:91], v[48:51], a[72:75], v[88:91]
v_mfma_f32_16x16x32_bf16 v[88:91], v[52:55], a[88:91], v[88:91]
v_mfma_f32_16x16x32_bf16 v[92:95], v[48:51], a[76:79], v[92:95]
ds_read_b128 v[76:79], v7 offset:48128
v_mfma_f32_16x16x32_bf16 v[92:95], v[52:55], a[92:95], v[92:95]
s_waitcnt lgkmcnt(4)
v_mfma_f32_16x16x32_bf16 v[96:99], v[56:59], a[64:67], v[96:99]
v_mfma_f32_16x16x32_bf16 v[96:99], v[60:63], a[80:83], v[96:99]
v_mfma_f32_16x16x32_bf16 v[100:103], v[56:59], a[68:71], v[100:103]
ds_read_b128 v[48:51], v7 offset:49152
v_mfma_f32_16x16x32_bf16 v[100:103], v[60:63], a[84:87], v[100:103]
v_mfma_f32_16x16x32_bf16 v[104:107], v[56:59], a[72:75], v[104:107]
v_mfma_f32_16x16x32_bf16 v[104:107], v[60:63], a[88:91], v[104:107]
v_mfma_f32_16x16x32_bf16 v[108:111], v[56:59], a[76:79], v[108:111]
ds_read_b128 v[52:55], v7 offset:50176
v_mfma_f32_16x16x32_bf16 v[108:111], v[60:63], a[92:95], v[108:111]
s_waitcnt vmcnt(58)
s_waitcnt lgkmcnt(4)
v_mfma_f32_16x16x32_bf16 v[80:83], v[64:67], a[96:99], v[80:83]
v_mfma_f32_16x16x32_bf16 v[80:83], v[68:71], a[112:115], v[80:83]
v_mfma_f32_16x16x32_bf16 v[84:87], v[64:67], a[100:103], v[84:87]
ds_read_b128 v[56:59], v7 offset:51200
v_mfma_f32_16x16x32_bf16 v[84:87], v[68:71], a[116:119], v[84:87]
v_mfma_f32_16x16x32_bf16 v[88:91], v[64:67], a[104:107], v[88:91]
v_mfma_f32_16x16x32_bf16 v[88:91], v[68:71], a[120:123], v[88:91]
v_mfma_f32_16x16x32_bf16 v[92:95], v[64:67], a[108:111], v[92:95]
ds_read_b128 v[60:63], v7 offset:52224
v_mfma_f32_16x16x32_bf16 v[92:95], v[68:71], a[124:127], v[92:95]
s_waitcnt lgkmcnt(4)
v_mfma_f32_16x16x32_bf16 v[96:99], v[72:75], a[96:99], v[96:99]
v_mfma_f32_16x16x32_bf16 v[96:99], v[76:79], a[112:115], v[96:99]
v_mfma_f32_16x16x32_bf16 v[100:103], v[72:75], a[100:103], v[100:103]
ds_read_b128 v[64:67], v7 offset:53248
v_mfma_f32_16x16x32_bf16 v[100:103], v[76:79], a[116:119], v[100:103]
v_mfma_f32_16x16x32_bf16 v[104:107], v[72:75], a[104:107], v[104:107]
v_mfma_f32_16x16x32_bf16 v[104:107], v[76:79], a[120:123], v[104:107]
v_mfma_f32_16x16x32_bf16 v[108:111], v[72:75], a[108:111], v[108:111]
ds_read_b128 v[68:71], v7 offset:54272
v_mfma_f32_16x16x32_bf16 v[108:111], v[76:79], a[124:127], v[108:111]
s_waitcnt vmcnt(50)
s_waitcnt lgkmcnt(4)
v_mfma_f32_16x16x32_bf16 v[80:83], v[48:51], a[128:131], v[80:83]
v_mfma_f32_16x16x32_bf16 v[80:83], v[52:55], a[144:147], v[80:83]
v_mfma_f32_16x16x32_bf16 v[84:87], v[48:51], a[132:135], v[84:87]
ds_read_b128 v[72:75], v7 offset:55296
v_mfma_f32_16x16x32_bf16 v[84:87], v[52:55], a[148:151], v[84:87]
v_mfma_f32_16x16x32_bf16 v[88:91], v[48:51], a[136:139], v[88:91]
v_mfma_f32_16x16x32_bf16 v[88:91], v[52:55], a[152:155], v[88:91]
v_mfma_f32_16x16x32_bf16 v[92:95], v[48:51], a[140:143], v[92:95]
ds_read_b128 v[76:79], v7 offset:56320
v_mfma_f32_16x16x32_bf16 v[92:95], v[52:55], a[156:159], v[92:95]
s_waitcnt lgkmcnt(4)
v_mfma_f32_16x16x32_bf16 v[96:99], v[56:59], a[128:131], v[96:99]
v_mfma_f32_16x16x32_bf16 v[96:99], v[60:63], a[144:147], v[96:99]
v_mfma_f32_16x16x32_bf16 v[100:103], v[56:59], a[132:135], v[100:103]
s_waitcnt vmcnt(63)
s_barrier
ds_read_b128 v[48:51], v7 offset:57344
v_mfma_f32_16x16x32_bf16 v[100:103], v[60:63], a[148:151], v[100:103]
s_add_u32 m0, s22, 73728
v_mfma_f32_16x16x32_bf16 v[104:107], v[56:59], a[136:139], v[104:107]
v_mfma_f32_16x16x32_bf16 v[104:107], v[60:63], a[152:155], v[104:107]
s_add_u32 s23, s21, 122880
v_mfma_f32_16x16x32_bf16 v[108:111], v[56:59], a[140:143], v[108:111]
ds_read_b128 v[52:55], v7 offset:58368
v_mfma_f32_16x16x32_bf16 v[108:111], v[60:63], a[156:159], v[108:111]
buffer_load_dwordx4 v2, s[8:11], s23 offen offset:0 lds
s_waitcnt vmcnt(43)
s_waitcnt lgkmcnt(4)
v_mfma_f32_16x16x32_bf16 v[80:83], v[64:67], a[160:163], v[80:83]
v_mfma_f32_16x16x32_bf16 v[80:83], v[68:71], a[176:179], v[80:83]
buffer_load_dwordx4 v2, s[8:11], s23 offen offset:1024 lds
v_mfma_f32_16x16x32_bf16 v[84:87], v[64:67], a[164:167], v[84:87]
ds_read_b128 v[56:59], v7 offset:59392
v_mfma_f32_16x16x32_bf16 v[84:87], v[68:71], a[180:183], v[84:87]
buffer_load_dwordx4 v2, s[8:11], s23 offen offset:2048 lds
v_mfma_f32_16x16x32_bf16 v[88:91], v[64:67], a[168:171], v[88:91]
v_mfma_f32_16x16x32_bf16 v[88:91], v[68:71], a[184:187], v[88:91]
buffer_load_dwordx4 v2, s[8:11], s23 offen offset:3072 lds
v_mfma_f32_16x16x32_bf16 v[92:95], v[64:67], a[172:175], v[92:95]
ds_read_b128 v[60:63], v7 offset:60416
v_mfma_f32_16x16x32_bf16 v[92:95], v[68:71], a[188:191], v[92:95]
s_add_u32 m0, s22, 77824
s_waitcnt lgkmcnt(4)
v_mfma_f32_16x16x32_bf16 v[96:99], v[72:75], a[160:163], v[96:99]
v_mfma_f32_16x16x32_bf16 v[96:99], v[76:79], a[176:179], v[96:99]
s_add_u32 s23, s21, 126976
v_mfma_f32_16x16x32_bf16 v[100:103], v[72:75], a[164:167], v[100:103]
ds_read_b128 v[64:67], v7 offset:61440
v_mfma_f32_16x16x32_bf16 v[100:103], v[76:79], a[180:183], v[100:103]
buffer_load_dwordx4 v2, s[8:11], s23 offen offset:0 lds
v_mfma_f32_16x16x32_bf16 v[104:107], v[72:75], a[168:171], v[104:107]
v_mfma_f32_16x16x32_bf16 v[104:107], v[76:79], a[184:187], v[104:107]
buffer_load_dwordx4 v2, s[8:11], s23 offen offset:1024 lds
v_mfma_f32_16x16x32_bf16 v[108:111], v[72:75], a[172:175], v[108:111]
ds_read_b128 v[68:71], v7 offset:62464
v_mfma_f32_16x16x32_bf16 v[108:111], v[76:79], a[188:191], v[108:111]
s_waitcnt vmcnt(40)
s_waitcnt lgkmcnt(4)
v_mfma_f32_16x16x32_bf16 v[80:83], v[48:51], a[192:195], v[80:83]
v_mfma_f32_16x16x32_bf16 v[80:83], v[52:55], a[208:211], v[80:83]
v_mfma_f32_16x16x32_bf16 v[84:87], v[48:51], a[196:199], v[84:87]
ds_read_b128 v[72:75], v7 offset:63488
v_mfma_f32_16x16x32_bf16 v[84:87], v[52:55], a[212:215], v[84:87]
v_mfma_f32_16x16x32_bf16 v[88:91], v[48:51], a[200:203], v[88:91]
v_mfma_f32_16x16x32_bf16 v[88:91], v[52:55], a[216:219], v[88:91]
v_mfma_f32_16x16x32_bf16 v[92:95], v[48:51], a[204:207], v[92:95]
ds_read_b128 v[76:79], v7 offset:64512
v_mfma_f32_16x16x32_bf16 v[92:95], v[52:55], a[220:223], v[92:95]
s_waitcnt lgkmcnt(4)
v_mfma_f32_16x16x32_bf16 v[96:99], v[56:59], a[192:195], v[96:99]
v_mfma_f32_16x16x32_bf16 v[96:99], v[60:63], a[208:211], v[96:99]
v_mfma_f32_16x16x32_bf16 v[100:103], v[56:59], a[196:199], v[100:103]
ds_read_b128 v[48:51], v8 offset:0
v_mfma_f32_16x16x32_bf16 v[100:103], v[60:63], a[212:215], v[100:103]
v_mfma_f32_16x16x32_bf16 v[104:107], v[56:59], a[200:203], v[104:107]
v_mfma_f32_16x16x32_bf16 v[104:107], v[60:63], a[216:219], v[104:107]
v_mfma_f32_16x16x32_bf16 v[108:111], v[56:59], a[204:207], v[108:111]
ds_read_b128 v[52:55], v8 offset:1024
v_mfma_f32_16x16x32_bf16 v[108:111], v[60:63], a[220:223], v[108:111]
s_waitcnt vmcnt(32)
s_waitcnt lgkmcnt(4)
v_mfma_f32_16x16x32_bf16 v[80:83], v[64:67], a[224:227], v[80:83]
v_mfma_f32_16x16x32_bf16 v[80:83], v[68:71], a[240:243], v[80:83]
v_mfma_f32_16x16x32_bf16 v[84:87], v[64:67], a[228:231], v[84:87]
ds_read_b128 v[56:59], v8 offset:2048
v_mfma_f32_16x16x32_bf16 v[84:87], v[68:71], a[244:247], v[84:87]
v_mfma_f32_16x16x32_bf16 v[88:91], v[64:67], a[232:235], v[88:91]
v_mfma_f32_16x16x32_bf16 v[88:91], v[68:71], a[248:251], v[88:91]
v_mfma_f32_16x16x32_bf16 v[92:95], v[64:67], a[236:239], v[92:95]
ds_read_b128 v[60:63], v8 offset:3072
v_mfma_f32_16x16x32_bf16 v[92:95], v[68:71], a[252:255], v[92:95]
s_waitcnt lgkmcnt(4)
v_mfma_f32_16x16x32_bf16 v[96:99], v[72:75], a[224:227], v[96:99]
v_mfma_f32_16x16x32_bf16 v[96:99], v[76:79], a[240:243], v[96:99]
v_mfma_f32_16x16x32_bf16 v[100:103], v[72:75], a[228:231], v[100:103]
ds_read_b128 v[64:67], v8 offset:4096
v_mfma_f32_16x16x32_bf16 v[100:103], v[76:79], a[244:247], v[100:103]
v_mfma_f32_16x16x32_bf16 v[104:107], v[72:75], a[232:235], v[104:107]
v_mfma_f32_16x16x32_bf16 v[104:107], v[76:79], a[248:251], v[104:107]
v_mfma_f32_16x16x32_bf16 v[108:111], v[72:75], a[236:239], v[108:111]
ds_read_b128 v[68:71], v8 offset:5120
v_mfma_f32_16x16x32_bf16 v[108:111], v[76:79], a[252:255], v[108:111]
s_waitcnt vmcnt(24)
s_waitcnt lgkmcnt(4)
v_mfma_f32_16x16x32_bf16 v[80:83], v[48:51], v[16:19], v[80:83]
v_mfma_f32_16x16x32_bf16 v[80:83], v[52:55], v[32:35], v[80:83]
v_mfma_f32_16x16x32_bf16 v[84:87], v[48:51], v[20:23], v[84:87]
ds_read_b128 v[72:75], v8 offset:6144
v_mfma_f32_16x16x32_bf16 v[84:87], v[52:55], v[36:39], v[84:87]
v_mfma_f32_16x16x32_bf16 v[88:91], v[48:51], v[24:27], v[88:91]
v_mfma_f32_16x16x32_bf16 v[88:91], v[52:55], v[40:43], v[88:91]
v_mfma_f32_16x16x32_bf16 v[92:95], v[48:51], v[28:31], v[92:95]
ds_read_b128 v[76:79], v8 offset:7168
v_mfma_f32_16x16x32_bf16 v[92:95], v[52:55], v[44:47], v[92:95]
s_waitcnt lgkmcnt(4)
v_mfma_f32_16x16x32_bf16 v[96:99], v[56:59], v[16:19], v[96:99]
v_mfma_f32_16x16x32_bf16 v[96:99], v[60:63], v[32:35], v[96:99]
v_mfma_f32_16x16x32_bf16 v[100:103], v[56:59], v[20:23], v[100:103]
ds_read_b128 v[48:51], v8 offset:8192
v_mfma_f32_16x16x32_bf16 v[100:103], v[60:63], v[36:39], v[100:103]
v_mfma_f32_16x16x32_bf16 v[104:107], v[56:59], v[24:27], v[104:107]
v_mfma_f32_16x16x32_bf16 v[104:107], v[60:63], v[40:43], v[104:107]
v_mfma_f32_16x16x32_bf16 v[108:111], v[56:59], v[28:31], v[108:111]
ds_read_b128 v[52:55], v8 offset:9216
v_mfma_f32_16x16x32_bf16 v[108:111], v[60:63], v[44:47], v[108:111]
s_waitcnt lgkmcnt(4)
v_mfma_f32_16x16x32_bf16 v[112:115], v[64:67], a[0:3], 0
v_mfma_f32_16x16x32_bf16 v[112:115], v[68:71], a[16:19], v[112:115]
v_mfma_f32_16x16x32_bf16 v[116:119], v[64:67], a[4:7], 0
ds_read_b128 v[56:59], v8 offset:10240
v_mfma_f32_16x16x32_bf16 v[116:119], v[68:71], a[20:23], v[116:119]
v_mul_f32 v208, v80, v80
v_mfma_f32_16x16x32_bf16 v[120:123], v[64:67], a[8:11], 0
v_mul_f32 v210, v81, v81
v_fma_f32 v208, v208, v233, v232
v_mfma_f32_16x16x32_bf16 v[120:123], v[68:71], a[24:27], v[120:123]
v_fma_f32 v210, v210, v233, v232
v_mfma_f32_16x16x32_bf16 v[124:127], v[64:67], a[12:15], 0
ds_read_b128 v[60:63], v8 offset:11264
v_mul_f32 v208, v208, v80
v_mfma_f32_16x16x32_bf16 v[124:127], v[68:71], a[28:31], v[124:127]
v_mul_f32 v210, v210, v81
s_waitcnt lgkmcnt(4)
v_mfma_f32_16x16x32_bf16 v[128:131], v[72:75], a[0:3], 0
v_exp_f32 v208, v208
v_mfma_f32_16x16x32_bf16 v[128:131], v[76:79], a[16:19], v[128:131]
v_mfma_f32_16x16x32_bf16 v[132:135], v[72:75], a[4:7], 0
ds_read_b128 v[64:67], v8 offset:12288
v_mfma_f32_16x16x32_bf16 v[132:135], v[76:79], a[20:23], v[132:135]
v_exp_f32 v210, v210
v_mfma_f32_16x16x32_bf16 v[136:139], v[72:75], a[8:11], 0
v_mul_f32 v209, v80, v96
v_mul_f32 v211, v81, v97
v_mfma_f32_16x16x32_bf16 v[136:139], v[76:79], a[24:27], v[136:139]
v_fma_f32 v208, v208, v234, v234
v_fma_f32 v210, v210, v234, v234
v_mfma_f32_16x16x32_bf16 v[140:143], v[72:75], a[12:15], 0
ds_read_b128 v[68:71], v8 offset:13312
v_mfma_f32_16x16x32_bf16 v[140:143], v[76:79], a[28:31], v[140:143]
s_waitcnt lgkmcnt(4)
v_mfma_f32_16x16x32_bf16 v[112:115], v[48:51], a[32:35], v[112:115]
v_rcp_f32 v208, v208
v_mfma_f32_16x16x32_bf16 v[112:115], v[52:55], a[48:51], v[112:115]
v_rcp_f32 v210, v210
v_mfma_f32_16x16x32_bf16 v[116:119], v[48:51], a[36:39], v[116:119]
ds_read_b128 v[72:75], v8 offset:14336
v_mul_f32 v209, v209, v208
v_mfma_f32_16x16x32_bf16 v[116:119], v[52:55], a[52:55], v[116:119]
v_mul_f32 v211, v211, v210
v_cvt_pk_bf16_f32 v224, v209, v211
v_mfma_f32_16x16x32_bf16 v[120:123], v[48:51], a[40:43], v[120:123]
v_mul_f32 v212, v82, v82
v_mul_f32 v214, v83, v83
v_mfma_f32_16x16x32_bf16 v[120:123], v[52:55], a[56:59], v[120:123]
v_fma_f32 v212, v212, v233, v232
v_mfma_f32_16x16x32_bf16 v[124:127], v[48:51], a[44:47], v[124:127]
ds_read_b128 v[76:79], v8 offset:15360
v_fma_f32 v214, v214, v233, v232
v_mfma_f32_16x16x32_bf16 v[124:127], v[52:55], a[60:63], v[124:127]
v_mul_f32 v212, v212, v82
s_waitcnt lgkmcnt(4)
v_mfma_f32_16x16x32_bf16 v[128:131], v[56:59], a[32:35], v[128:131]
v_mul_f32 v214, v214, v83
v_mfma_f32_16x16x32_bf16 v[128:131], v[60:63], a[48:51], v[128:131]
v_exp_f32 v212, v212
v_mfma_f32_16x16x32_bf16 v[132:135], v[56:59], a[36:39], v[132:135]
s_waitcnt vmcnt(18)
s_barrier
ds_read_b128 v[48:51], v2 offset:0
v_mfma_f32_16x16x32_bf16 v[132:135], v[60:63], a[52:55], v[132:135]
s_add_u32 m0, s22, 98304
v_mfma_f32_16x16x32_bf16 v[136:139], v[56:59], a[40:43], v[136:139]
v_exp_f32 v214, v214
v_mfma_f32_16x16x32_bf16 v[136:139], v[60:63], a[56:59], v[136:139]
s_add_u32 s23, s21, 147456
v_mul_f32 v213, v82, v98
v_mfma_f32_16x16x32_bf16 v[140:143], v[56:59], a[44:47], v[140:143]
ds_read_b128 v[52:55], v2 offset:1024
v_mul_f32 v215, v83, v99
v_mfma_f32_16x16x32_bf16 v[140:143], v[60:63], a[60:63], v[140:143]
buffer_load_dwordx4 v2, s[8:11], s23 offen offset:0 lds
v_fma_f32 v212, v212, v234, v234
s_waitcnt lgkmcnt(4)
v_mfma_f32_16x16x32_bf16 v[112:115], v[64:67], a[64:67], v[112:115]
v_fma_f32 v214, v214, v234, v234
v_mfma_f32_16x16x32_bf16 v[112:115], v[68:71], a[80:83], v[112:115]
buffer_load_dwordx4 v2, s[8:11], s23 offen offset:1024 lds
v_rcp_f32 v212, v212
v_mfma_f32_16x16x32_bf16 v[116:119], v[64:67], a[68:71], v[116:119]
ds_read_b128 v[56:59], v2 offset:2048
v_rcp_f32 v214, v214
v_mfma_f32_16x16x32_bf16 v[116:119], v[68:71], a[84:87], v[116:119]
buffer_load_dwordx4 v2, s[8:11], s23 offen offset:2048 lds
v_mul_f32 v213, v213, v212
v_mfma_f32_16x16x32_bf16 v[120:123], v[64:67], a[72:75], v[120:123]
v_mul_f32 v215, v215, v214
v_cvt_pk_bf16_f32 v225, v213, v215
v_mfma_f32_16x16x32_bf16 v[120:123], v[68:71], a[88:91], v[120:123]
buffer_load_dwordx4 v2, s[8:11], s23 offen offset:3072 lds
buffer_store_dwordx2 v[224:225], v2, s[8:11], s30 offen sc1
v_mfma_f32_16x16x32_bf16 v[124:127], v[64:67], a[76:79], v[124:127]
ds_read_b128 v[60:63], v2 offset:3072
v_mul_f32 v208, v84, v84
v_mfma_f32_16x16x32_bf16 v[124:127], v[68:71], a[92:95], v[124:127]
s_add_u32 m0, s22, 102400
s_waitcnt lgkmcnt(4)
v_mfma_f32_16x16x32_bf16 v[128:131], v[72:75], a[64:67], v[128:131]
v_mul_f32 v210, v85, v85
v_fma_f32 v208, v208, v236, v235
v_mfma_f32_16x16x32_bf16 v[128:131], v[76:79], a[80:83], v[128:131]
s_add_u32 s23, s21, 151552
v_fma_f32 v210, v210, v236, v235
v_mfma_f32_16x16x32_bf16 v[132:135], v[72:75], a[68:71], v[132:135]
ds_read_b128 v[64:67], v2 offset:4096
v_mul_f32 v208, v208, v84
v_mfma_f32_16x16x32_bf16 v[132:135], v[76:79], a[84:87], v[132:135]
buffer_load_dwordx4 v2, s[8:11], s23 offen offset:0 lds
v_mul_f32 v210, v210, v85
v_mfma_f32_16x16x32_bf16 v[136:139], v[72:75], a[72:75], v[136:139]
v_exp_f32 v208, v208
v_mfma_f32_16x16x32_bf16 v[136:139], v[76:79], a[88:91], v[136:139]
buffer_load_dwordx4 v2, s[8:11], s23 offen offset:1024 lds
v_exp_f32 v210, v210
v_mfma_f32_16x16x32_bf16 v[140:143], v[72:75], a[76:79], v[140:143]
ds_read_b128 v[68:71], v2 offset:5120
v_mul_f32 v209, v84, v100
v_mfma_f32_16x16x32_bf16 v[140:143], v[76:79], a[92:95], v[140:143]
v_mul_f32 v211, v85, v101
s_waitcnt lgkmcnt(4)
v_mfma_f32_16x16x32_bf16 v[112:115], v[48:51], a[96:99], v[112:115]
v_fma_f32 v208, v208, v237, v237
v_fma_f32 v210, v210, v237, v237
v_mfma_f32_16x16x32_bf16 v[112:115], v[52:55], a[112:115], v[112:115]
v_rcp_f32 v208, v208
v_mfma_f32_16x16x32_bf16 v[116:119], v[48:51], a[100:103], v[116:119]
ds_read_b128 v[72:75], v2 offset:6144
v_mfma_f32_16x16x32_bf16 v[116:119], v[52:55], a[116:119], v[116:119]
v_rcp_f32 v210, v210
v_mfma_f32_16x16x32_bf16 v[120:123], v[48:51], a[104:107], v[120:123]
v_mul_f32 v209, v209, v208
v_mul_f32 v211, v211, v210
v_mfma_f32_16x16x32_bf16 v[120:123], v[52:55], a[120:123], v[120:123]
v_cvt_pk_bf16_f32 v226, v209, v211
v_mfma_f32_16x16x32_bf16 v[124:127], v[48:51], a[108:111], v[124:127]
ds_read_b128 v[76:79], v2 offset:7168
v_mul_f32 v212, v86, v86
v_mfma_f32_16x16x32_bf16 v[124:127], v[52:55], a[124:127], v[124:127]
v_mul_f32 v214, v87, v87
s_waitcnt lgkmcnt(4)
v_mfma_f32_16x16x32_bf16 v[128:131], v[56:59], a[96:99], v[128:131]
v_fma_f32 v212, v212, v236, v235
v_fma_f32 v214, v214, v236, v235
v_mfma_f32_16x16x32_bf16 v[128:131], v[60:63], a[112:115], v[128:131]
v_mul_f32 v212, v212, v86
v_mul_f32 v214, v214, v87
v_mfma_f32_16x16x32_bf16 v[132:135], v[56:59], a[100:103], v[132:135]
ds_read_b128 v[48:51], v2 offset:8192
v_mfma_f32_16x16x32_bf16 v[132:135], v[60:63], a[116:119], v[132:135]
v_exp_f32 v212, v212
v_mfma_f32_16x16x32_bf16 v[136:139], v[56:59], a[104:107], v[136:139]
v_mfma_f32_16x16x32_bf16 v[136:139], v[60:63], a[120:123], v[136:139]
v_exp_f32 v214, v214
v_mfma_f32_16x16x32_bf16 v[140:143], v[56:59], a[108:111], v[140:143]
ds_read_b128 v[52:55], v2 offset:9216
v_mul_f32 v213, v86, v102
v_mfma_f32_16x16x32_bf16 v[140:143], v[60:63], a[124:127], v[140:143]
v_mul_f32 v215, v87, v103
s_waitcnt lgkmcnt(4)
v_mfma_f32_16x16x32_bf16 v[112:115], v[64:67], a[128:131], v[112:115]
v_fma_f32 v212, v212, v237, v237
v_fma_f32 v214, v214, v237, v237
v_mfma_f32_16x16x32_bf16 v[112:115], v[68:71], a[144:147], v[112:115]
v_rcp_f32 v212, v212
v_mfma_f32_16x16x32_bf16 v[116:119], v[64:67], a[132:135], v[116:119]
ds_read_b128 v[56:59], v2 offset:10240
v_mfma_f32_16x16x32_bf16 v[116:119], v[68:71], a[148:151], v[116:119]
v_rcp_f32 v214, v214
v_mfma_f32_16x16x32_bf16 v[120:123], v[64:67], a[136:139], v[120:123]
v_mul_f32 v213, v213, v212
v_mfma_f32_16x16x32_bf16 v[120:123], v[68:71], a[152:155], v[120:123]
v_mul_f32 v215, v215, v214
v_cvt_pk_bf16_f32 v227, v213, v215
v_mfma_f32_16x16x32_bf16 v[124:127], v[64:67], a[140:143], v[124:127]
ds_read_b128 v[60:63], v2 offset:11264
buffer_store_dwordx2 v[226:227], v4, s[8:11], s30 offen sc1
v_mfma_f32_16x16x32_bf16 v[124:127], v[68:71], a[156:159], v[124:127]
v_mul_f32 v208, v88, v88
s_waitcnt lgkmcnt(4)
v_mfma_f32_16x16x32_bf16 v[128:131], v[72:75], a[128:131], v[128:131]
v_mul_f32 v210, v89, v89
v_fma_f32 v208, v208, v239, v238
v_mfma_f32_16x16x32_bf16 v[128:131], v[76:79], a[144:147], v[128:131]
v_fma_f32 v210, v210, v239, v238
v_mfma_f32_16x16x32_bf16 v[132:135], v[72:75], a[132:135], v[132:135]
ds_read_b128 v[64:67], v2 offset:12288
v_mul_f32 v208, v208, v88
v_mfma_f32_16x16x32_bf16 v[132:135], v[76:79], a[148:151], v[132:135]
v_mul_f32 v210, v210, v89
v_mfma_f32_16x16x32_bf16 v[136:139], v[72:75], a[136:139], v[136:139]
v_exp_f32 v208, v208
v_mfma_f32_16x16x32_bf16 v[136:139], v[76:79], a[152:155], v[136:139]
v_mfma_f32_16x16x32_bf16 v[140:143], v[72:75], a[140:143], v[140:143]
ds_read_b128 v[68:71], v2 offset:13312
v_mfma_f32_16x16x32_bf16 v[140:143], v[76:79], a[156:159], v[140:143]
v_exp_f32 v210, v210
s_waitcnt lgkmcnt(4)
v_mfma_f32_16x16x32_bf16 v[112:115], v[48:51], a[160:163], v[112:115]
v_mul_f32 v209, v88, v104
v_mul_f32 v211, v89, v105
v_mfma_f32_16x16x32_bf16 v[112:115], v[52:55], a[176:179], v[112:115]
v_fma_f32 v208, v208, v240, v240
v_fma_f32 v210, v210, v240, v240
v_mfma_f32_16x16x32_bf16 v[116:119], v[48:51], a[164:167], v[116:119]
ds_read_b128 v[72:75], v2 offset:14336
v_mfma_f32_16x16x32_bf16 v[116:119], v[52:55], a[180:183], v[116:119]
v_rcp_f32 v208, v208
v_mfma_f32_16x16x32_bf16 v[120:123], v[48:51], a[168:171], v[120:123]
v_rcp_f32 v210, v210
v_mfma_f32_16x16x32_bf16 v[120:123], v[52:55], a[184:187], v[120:123]
v_mul_f32 v209, v209, v208
v_mfma_f32_16x16x32_bf16 v[124:127], v[48:51], a[172:175], v[124:127]
ds_read_b128 v[76:79], v2 offset:15360
v_mul_f32 v211, v211, v210
v_mfma_f32_16x16x32_bf16 v[124:127], v[52:55], a[188:191], v[124:127]
v_cvt_pk_bf16_f32 v228, v209, v211
s_waitcnt lgkmcnt(4)
v_mfma_f32_16x16x32_bf16 v[128:131], v[56:59], a[160:163], v[128:131]
v_mul_f32 v212, v90, v90
v_mul_f32 v214, v91, v91
v_mfma_f32_16x16x32_bf16 v[128:131], v[60:63], a[176:179], v[128:131]
v_fma_f32 v212, v212, v239, v238
v_mfma_f32_16x16x32_bf16 v[132:135], v[56:59], a[164:167], v[132:135]
ds_read_b128 v[48:51], v2 offset:16384
v_fma_f32 v214, v214, v239, v238
v_mfma_f32_16x16x32_bf16 v[132:135], v[60:63], a[180:183], v[132:135]
v_mul_f32 v212, v212, v90
v_mul_f32 v214, v214, v91
v_mfma_f32_16x16x32_bf16 v[136:139], v[56:59], a[168:171], v[136:139]
v_mfma_f32_16x16x32_bf16 v[136:139], v[60:63], a[184:187], v[136:139]
v_exp_f32 v212, v212
v_mfma_f32_16x16x32_bf16 v[140:143], v[56:59], a[172:175], v[140:143]
ds_read_b128 v[52:55], v2 offset:17408
v_mfma_f32_16x16x32_bf16 v[140:143], v[60:63], a[188:191], v[140:143]
s_waitcnt lgkmcnt(4)
v_mfma_f32_16x16x32_bf16 v[112:115], v[64:67], a[192:195], v[112:115]
v_exp_f32 v214, v214
v_mfma_f32_16x16x32_bf16 v[112:115], v[68:71], a[208:211], v[112:115]
v_mul_f32 v213, v90, v106
v_mul_f32 v215, v91, v107
v_mfma_f32_16x16x32_bf16 v[116:119], v[64:67], a[196:199], v[116:119]
ds_read_b128 v[56:59], v2 offset:18432
v_fma_f32 v212, v212, v240, v240
v_mfma_f32_16x16x32_bf16 v[116:119], v[68:71], a[212:215], v[116:119]
v_fma_f32 v214, v214, v240, v240
v_mfma_f32_16x16x32_bf16 v[120:123], v[64:67], a[200:203], v[120:123]
v_rcp_f32 v212, v212
v_mfma_f32_16x16x32_bf16 v[120:123], v[68:71], a[216:219], v[120:123]
v_rcp_f32 v214, v214
v_mfma_f32_16x16x32_bf16 v[124:127], v[64:67], a[204:207], v[124:127]
ds_read_b128 v[60:63], v2 offset:19456
v_mul_f32 v213, v213, v212
v_mfma_f32_16x16x32_bf16 v[124:127], v[68:71], a[220:223], v[124:127]
v_mul_f32 v215, v215, v214
s_waitcnt lgkmcnt(4)
v_mfma_f32_16x16x32_bf16 v[128:131], v[72:75], a[192:195], v[128:131]
v_cvt_pk_bf16_f32 v229, v213, v215
buffer_store_dwordx2 v[228:229], v5, s[8:11], s30 offen sc1
v_mfma_f32_16x16x32_bf16 v[128:131], v[76:79], a[208:211], v[128:131]
v_mul_f32 v208, v92, v92
v_mfma_f32_16x16x32_bf16 v[132:135], v[72:75], a[196:199], v[132:135]
ds_read_b128 v[64:67], v2 offset:20480
v_mul_f32 v210, v93, v93
v_mfma_f32_16x16x32_bf16 v[132:135], v[76:79], a[212:215], v[132:135]
v_fma_f32 v208, v208, v242, v241
v_fma_f32 v210, v210, v242, v241
v_mfma_f32_16x16x32_bf16 v[136:139], v[72:75], a[200:203], v[136:139]
v_mul_f32 v208, v208, v92
v_mfma_f32_16x16x32_bf16 v[136:139], v[76:79], a[216:219], v[136:139]
v_mul_f32 v210, v210, v93
v_mfma_f32_16x16x32_bf16 v[140:143], v[72:75], a[204:207], v[140:143]
ds_read_b128 v[68:71], v2 offset:21504
v_mfma_f32_16x16x32_bf16 v[140:143], v[76:79], a[220:223], v[140:143]
s_waitcnt lgkmcnt(4)
v_mfma_f32_16x16x32_bf16 v[112:115], v[48:51], a[224:227], v[112:115]
v_exp_f32 v208, v208
v_mfma_f32_16x16x32_bf16 v[112:115], v[52:55], a[240:243], v[112:115]
v_exp_f32 v210, v210
v_mfma_f32_16x16x32_bf16 v[116:119], v[48:51], a[228:231], v[116:119]
ds_read_b128 v[72:75], v2 offset:22528
v_mul_f32 v209, v92, v108
v_mfma_f32_16x16x32_bf16 v[116:119], v[52:55], a[244:247], v[116:119]
v_mul_f32 v211, v93, v109
v_fma_f32 v208, v208, v243, v243
v_mfma_f32_16x16x32_bf16 v[120:123], v[48:51], a[232:235], v[120:123]
v_fma_f32 v210, v210, v243, v243
v_mfma_f32_16x16x32_bf16 v[120:123], v[52:55], a[248:251], v[120:123]
v_rcp_f32 v208, v208
v_mfma_f32_16x16x32_bf16 v[124:127], v[48:51], a[236:239], v[124:127]
ds_read_b128 v[76:79], v2 offset:23552
v_mfma_f32_16x16x32_bf16 v[124:127], v[52:55], a[252:255], v[124:127]
s_waitcnt lgkmcnt(4)
v_mfma_f32_16x16x32_bf16 v[128:131], v[56:59], a[224:227], v[128:131]
v_rcp_f32 v210, v210
v_mfma_f32_16x16x32_bf16 v[128:131], v[60:63], a[240:243], v[128:131]
v_mul_f32 v209, v209, v208
v_mul_f32 v211, v211, v210
v_mfma_f32_16x16x32_bf16 v[132:135], v[56:59], a[228:231], v[132:135]
s_waitcnt vmcnt(21)
s_barrier
ds_read_b128 v[48:51], v2 offset:24576
v_mfma_f32_16x16x32_bf16 v[132:135], v[60:63], a[244:247], v[132:135]
s_add_u32 m0, s22, 122880
v_cvt_pk_bf16_f32 v230, v209, v211
v_mul_f32 v212, v94, v94
v_mfma_f32_16x16x32_bf16 v[136:139], v[56:59], a[232:235], v[136:139]
v_mul_f32 v214, v95, v95
v_fma_f32 v212, v212, v242, v241
v_mfma_f32_16x16x32_bf16 v[136:139], v[60:63], a[248:251], v[136:139]
s_add_u32 s23, s21, 172032
v_fma_f32 v214, v214, v242, v241
v_mfma_f32_16x16x32_bf16 v[140:143], v[56:59], a[236:239], v[140:143]
ds_read_b128 v[52:55], v2 offset:25600
v_mul_f32 v212, v212, v94
v_mfma_f32_16x16x32_bf16 v[140:143], v[60:63], a[252:255], v[140:143]
buffer_load_dwordx4 v2, s[8:11], s23 offen offset:0 lds
v_mul_f32 v214, v214, v95
s_waitcnt lgkmcnt(4)
v_mfma_f32_16x16x32_bf16 v[112:115], v[64:67], v[16:19], v[112:115]
v_exp_f32 v212, v212
v_mfma_f32_16x16x32_bf16 v[112:115], v[68:71], v[32:35], v[112:115]
buffer_load_dwordx4 v2, s[8:11], s23 offen offset:1024 lds
v_mfma_f32_16x16x32_bf16 v[116:119], v[64:67], v[20:23], v[116:119]
ds_read_b128 v[56:59], v2 offset:26624
v_exp_f32 v214, v214
v_mfma_f32_16x16x32_bf16 v[116:119], v[68:71], v[36:39], v[116:119]
buffer_load_dwordx4 v2, s[8:11], s23 offen offset:2048 lds
v_mul_f32 v213, v94, v110
v_mfma_f32_16x16x32_bf16 v[120:123], v[64:67], v[24:27], v[120:123]
v_mul_f32 v215, v95, v111
v_fma_f32 v212, v212, v243, v243
v_mfma_f32_16x16x32_bf16 v[120:123], v[68:71], v[40:43], v[120:123]
buffer_load_dwordx4 v2, s[8:11], s23 offen offset:3072 lds
v_fma_f32 v214, v214, v243, v243
v_mfma_f32_16x16x32_bf16 v[124:127], v[64:67], v[28:31], v[124:127]
ds_read_b128 v[60:63], v2 offset:27648
v_mfma_f32_16x16x32_bf16 v[124:127], v[68:71], v[44:47], v[124:127]
s_add_u32 m0, s22, 126976
v_rcp_f32 v212, v212
s_waitcnt lgkmcnt(4)
v_mfma_f32_16x16x32_bf16 v[128:131], v[72:75], v[16:19], v[128:131]
v_rcp_f32 v214, v214
v_mfma_f32_16x16x32_bf16 v[128:131], v[76:79], v[32:35], v[128:131]
s_add_u32 s23, s21, 176128
v_mul_f32 v213, v213, v212
v_mfma_f32_16x16x32_bf16 v[132:135], v[72:75], v[20:23], v[132:135]
ds_read_b128 v[64:67], v2 offset:28672
v_mul_f32 v215, v215, v214
v_mfma_f32_16x16x32_bf16 v[132:135], v[76:79], v[36:39], v[132:135]
buffer_load_dwordx4 v2, s[8:11], s23 offen offset:0 lds
v_cvt_pk_bf16_f32 v231, v213, v215
v_mfma_f32_16x16x32_bf16 v[136:139], v[72:75], v[24:27], v[136:139]
buffer_store_dwordx2 v[230:231], v6, s[8:11], s30 offen sc1
v_mfma_f32_16x16x32_bf16 v[136:139], v[76:79], v[40:43], v[136:139]
buffer_load_dwordx4 v2, s[8:11], s23 offen offset:1024 lds
v_mfma_f32_16x16x32_bf16 v[140:143], v[72:75], v[28:31], v[140:143]
ds_read_b128 v[68:71], v2 offset:29696
v_mfma_f32_16x16x32_bf16 v[140:143], v[76:79], v[44:47], v[140:143]
s_waitcnt lgkmcnt(4)
v_mfma_f32_16x16x32_bf16 v[80:83], v[48:51], a[0:3], 0
v_mfma_f32_16x16x32_bf16 v[80:83], v[52:55], a[16:19], v[80:83]
v_mfma_f32_16x16x32_bf16 v[84:87], v[48:51], a[4:7], 0
ds_read_b128 v[72:75], v2 offset:30720
v_mfma_f32_16x16x32_bf16 v[84:87], v[52:55], a[20:23], v[84:87]
v_mul_f32 v208, v112, v112
v_mfma_f32_16x16x32_bf16 v[88:91], v[48:51], a[8:11], 0
v_mul_f32 v210, v113, v113
v_mfma_f32_16x16x32_bf16 v[88:91], v[52:55], a[24:27], v[88:91]
v_fma_f32 v208, v208, v233, v232
v_fma_f32 v210, v210, v233, v232
v_mfma_f32_16x16x32_bf16 v[92:95], v[48:51], a[12:15], 0
ds_read_b128 v[76:79], v2 offset:31744
v_mul_f32 v208, v208, v112
v_mfma_f32_16x16x32_bf16 v[92:95], v[52:55], a[28:31], v[92:95]
v_mul_f32 v210, v210, v113
s_waitcnt lgkmcnt(4)
v_mfma_f32_16x16x32_bf16 v[96:99], v[56:59], a[0:3], 0
v_mfma_f32_16x16x32_bf16 v[96:99], v[60:63], a[16:19], v[96:99]
v_exp_f32 v208, v208
v_mfma_f32_16x16x32_bf16 v[100:103], v[56:59], a[4:7], 0
ds_read_b128 v[48:51], v2 offset:32768
v_mfma_f32_16x16x32_bf16 v[100:103], v[60:63], a[20:23], v[100:103]
v_exp_f32 v210, v210
v_mfma_f32_16x16x32_bf16 v[104:107], v[56:59], a[8:11], 0
v_mul_f32 v209, v112, v128
v_mul_f32 v211, v113, v129
v_mfma_f32_16x16x32_bf16 v[104:107], v[60:63], a[24:27], v[104:107]
v_fma_f32 v208, v208, v234, v234
v_fma_f32 v210, v210, v234, v234
v_mfma_f32_16x16x32_bf16 v[108:111], v[56:59], a[12:15], 0
ds_read_b128 v[52:55], v2 offset:33792
v_mfma_f32_16x16x32_bf16 v[108:111], v[60:63], a[28:31], v[108:111]
s_waitcnt lgkmcnt(4)
v_mfma_f32_16x16x32_bf16 v[80:83], v[64:67], a[32:35], v[80:83]
v_rcp_f32 v208, v208
v_mfma_f32_16x16x32_bf16 v[80:83], v[68:71], a[48:51], v[80:83]
v_rcp_f32 v210, v210
v_mfma_f32_16x16x32_bf16 v[84:87], v[64:67], a[36:39], v[84:87]
ds_read_b128 v[56:59], v2 offset:34816
v_mul_f32 v209, v209, v208
v_mfma_f32_16x16x32_bf16 v[84:87], v[68:71], a[52:55], v[84:87]
v_mul_f32 v211, v211, v210
v_cvt_pk_bf16_f32 v144, v209, v211
v_mfma_f32_16x16x32_bf16 v[88:91], v[64:67], a[40:43], v[88:91]
v_mul_f32 v212, v114, v114
v_mfma_f32_16x16x32_bf16 v[88:91], v[68:71], a[56:59], v[88:91]
v_mul_f32 v214, v115, v115
v_mfma_f32_16x16x32_bf16 v[92:95], v[64:67], a[44:47], v[92:95]
ds_read_b128 v[60:63], v2 offset:35840
v_fma_f32 v212, v212, v233, v232
v_mfma_f32_16x16x32_bf16 v[92:95], v[68:71], a[60:63], v[92:95]
v_fma_f32 v214, v214, v233, v232
s_waitcnt lgkmcnt(4)
v_mfma_f32_16x16x32_bf16 v[96:99], v[72:75], a[32:35], v[96:99]
v_mul_f32 v212, v212, v114
v_mul_f32 v214, v214, v115
v_mfma_f32_16x16x32_bf16 v[96:99], v[76:79], a[48:51], v[96:99]
v_mfma_f32_16x16x32_bf16 v[100:103], v[72:75], a[36:39], v[100:103]
ds_read_b128 v[64:67], v2 offset:36864
v_mfma_f32_16x16x32_bf16 v[100:103], v[76:79], a[52:55], v[100:103]
v_exp_f32 v212, v212
v_mfma_f32_16x16x32_bf16 v[104:107], v[72:75], a[40:43], v[104:107]
v_exp_f32 v214, v214
v_mfma_f32_16x16x32_bf16 v[104:107], v[76:79], a[56:59], v[104:107]
v_mul_f32 v213, v114, v130
v_mul_f32 v215, v115, v131
v_mfma_f32_16x16x32_bf16 v[108:111], v[72:75], a[44:47], v[108:111]
ds_read_b128 v[68:71], v2 offset:37888
v_fma_f32 v212, v212, v234, v234
v_mfma_f32_16x16x32_bf16 v[108:111], v[76:79], a[60:63], v[108:111]
v_fma_f32 v214, v214, v234, v234
s_waitcnt lgkmcnt(4)
v_mfma_f32_16x16x32_bf16 v[80:83], v[48:51], a[64:67], v[80:83]
v_rcp_f32 v212, v212
v_mfma_f32_16x16x32_bf16 v[80:83], v[52:55], a[80:83], v[80:83]
v_mfma_f32_16x16x32_bf16 v[84:87], v[48:51], a[68:71], v[84:87]
ds_read_b128 v[72:75], v2 offset:38912
v_mfma_f32_16x16x32_bf16 v[84:87], v[52:55], a[84:87], v[84:87]
v_rcp_f32 v214, v214
v_mfma_f32_16x16x32_bf16 v[88:91], v[48:51], a[72:75], v[88:91]
v_mul_f32 v213, v213, v212
v_mul_f32 v215, v215, v214
v_mfma_f32_16x16x32_bf16 v[88:91], v[52:55], a[88:91], v[88:91]
v_cvt_pk_bf16_f32 v145, v213, v215
v_mul_f32 v208, v116, v116
v_mfma_f32_16x16x32_bf16 v[92:95], v[48:51], a[76:79], v[92:95]
ds_read_b128 v[76:79], v2 offset:39936
v_mul_f32 v210, v117, v117
v_mfma_f32_16x16x32_bf16 v[92:95], v[52:55], a[92:95], v[92:95]
v_fma_f32 v208, v208, v236, v235
s_waitcnt lgkmcnt(4)
v_mfma_f32_16x16x32_bf16 v[96:99], v[56:59], a[64:67], v[96:99]
v_fma_f32 v210, v210, v236, v235
v_mul_f32 v208, v208, v116
v_mfma_f32_16x16x32_bf16 v[96:99], v[60:63], a[80:83], v[96:99]
v_mul_f32 v210, v210, v117
v_mfma_f32_16x16x32_bf16 v[100:103], v[56:59], a[68:71], v[100:103]
ds_read_b128 v[48:51], v2 offset:40960
v_mfma_f32_16x16x32_bf16 v[100:103], v[60:63], a[84:87], v[100:103]
v_exp_f32 v208, v208
v_mfma_f32_16x16x32_bf16 v[104:107], v[56:59], a[72:75], v[104:107]
v_exp_f32 v210, v210
v_mfma_f32_16x16x32_bf16 v[104:107], v[60:63], a[88:91], v[104:107]
v_mul_f32 v209, v116, v132
v_mfma_f32_16x16x32_bf16 v[108:111], v[56:59], a[76:79], v[108:111]
ds_read_b128 v[52:55], v2 offset:41984
v_mul_f32 v211, v117, v133
v_mfma_f32_16x16x32_bf16 v[108:111], v[60:63], a[92:95], v[108:111]
v_fma_f32 v208, v208, v237, v237
s_waitcnt lgkmcnt(4)
v_mfma_f32_16x16x32_bf16 v[80:83], v[64:67], a[96:99], v[80:83]
v_fma_f32 v210, v210, v237, v237
v_mfma_f32_16x16x32_bf16 v[80:83], v[68:71], a[112:115], v[80:83]
v_rcp_f32 v208, v208
v_mfma_f32_16x16x32_bf16 v[84:87], v[64:67], a[100:103], v[84:87]
ds_read_b128 v[56:59], v2 offset:43008
v_mfma_f32_16x16x32_bf16 v[84:87], v[68:71], a[116:119], v[84:87]
v_rcp_f32 v210, v210
v_mfma_f32_16x16x32_bf16 v[88:91], v[64:67], a[104:107], v[88:91]
v_mul_f32 v209, v209, v208
v_mul_f32 v211, v211, v210
v_mfma_f32_16x16x32_bf16 v[88:91], v[68:71], a[120:123], v[88:91]
v_cvt_pk_bf16_f32 v148, v209, v211
v_mfma_f32_16x16x32_bf16 v[92:95], v[64:67], a[108:111], v[92:95]
ds_read_b128 v[60:63], v2 offset:44032
v_mul_f32 v212, v118, v118
v_mfma_f32_16x16x32_bf16 v[92:95], v[68:71], a[124:127], v[92:95]
v_mul_f32 v214, v119, v119
s_waitcnt lgkmcnt(4)
v_mfma_f32_16x16x32_bf16 v[96:99], v[72:75], a[96:99], v[96:99]
v_fma_f32 v212, v212, v236, v235
v_fma_f32 v214, v214, v236, v235
v_mfma_f32_16x16x32_bf16 v[96:99], v[76:79], a[112:115], v[96:99]
v_mul_f32 v212, v212, v118
v_mfma_f32_16x16x32_bf16 v[100:103], v[72:75], a[100:103], v[100:103]
ds_read_b128 v[64:67], v2 offset:45056
v_mul_f32 v214, v214, v119
v_mfma_f32_16x16x32_bf16 v[100:103], v[76:79], a[116:119], v[100:103]
v_mfma_f32_16x16x32_bf16 v[104:107], v[72:75], a[104:107], v[104:107]
v_exp_f32 v212, v212
v_mfma_f32_16x16x32_bf16 v[104:107], v[76:79], a[120:123], v[104:107]
v_exp_f32 v214, v214
v_mfma_f32_16x16x32_bf16 v[108:111], v[72:75], a[108:111], v[108:111]
ds_read_b128 v[68:71], v2 offset:46080
v_mul_f32 v213, v118, v134
v_mfma_f32_16x16x32_bf16 v[108:111], v[76:79], a[124:127], v[108:111]
v_mul_f32 v215, v119, v135
s_waitcnt lgkmcnt(4)
v_mfma_f32_16x16x32_bf16 v[80:83], v[48:51], a[128:131], v[80:83]
v_fma_f32 v212, v212, v237, v237
v_fma_f32 v214, v214, v237, v237
v_mfma_f32_16x16x32_bf16 v[80:83], v[52:55], a[144:147], v[80:83]
v_mfma_f32_16x16x32_bf16 v[84:87], v[48:51], a[132:135], v[84:87]
ds_read_b128 v[72:75], v2 offset:47104
v_mfma_f32_16x16x32_bf16 v[84:87], v[52:55], a[148:151], v[84:87]
v_rcp_f32 v212, v212
v_mfma_f32_16x16x32_bf16 v[88:91], v[48:51], a[136:139], v[88:91]
v_rcp_f32 v214, v214
v_mfma_f32_16x16x32_bf16 v[88:91], v[52:55], a[152:155], v[88:91]
v_mul_f32 v213, v213, v212
v_mul_f32 v215, v215, v214
v_mfma_f32_16x16x32_bf16 v[92:95], v[48:51], a[140:143], v[92:95]
ds_read_b128 v[76:79], v2 offset:48128
v_cvt_pk_bf16_f32 v149, v213, v215
v_mfma_f32_16x16x32_bf16 v[92:95], v[52:55], a[156:159], v[92:95]
v_mul_f32 v208, v120, v120
s_waitcnt lgkmcnt(4)
v_mfma_f32_16x16x32_bf16 v[96:99], v[56:59], a[128:131], v[96:99]
v_mul_f32 v210, v121, v121
v_mfma_f32_16x16x32_bf16 v[96:99], v[60:63], a[144:147], v[96:99]
v_fma_f32 v208, v208, v239, v238
v_fma_f32 v210, v210, v239, v238
v_mfma_f32_16x16x32_bf16 v[100:103], v[56:59], a[132:135], v[100:103]
s_waitcnt vmcnt(22)
s_barrier
ds_read_b128 v[48:51], v2 offset:49152
v_mfma_f32_16x16x32_bf16 v[100:103], v[60:63], a[148:151], v[100:103]
s_add_u32 m0, s22, 0
v_mul_f32 v208, v208, v120
v_mfma_f32_16x16x32_bf16 v[104:107], v[56:59], a[136:139], v[104:107]
v_mul_f32 v210, v210, v121
v_mfma_f32_16x16x32_bf16 v[104:107], v[60:63], a[152:155], v[104:107]
s_add_u32 s23, s21, 196608
v_mfma_f32_16x16x32_bf16 v[108:111], v[56:59], a[140:143], v[108:111]
ds_read_b128 v[52:55], v2 offset:50176
v_exp_f32 v208, v208
v_mfma_f32_16x16x32_bf16 v[108:111], v[60:63], a[156:159], v[108:111]
buffer_load_dwordx4 v2, s[8:11], s23 offen offset:0 lds
v_exp_f32 v210, v210
s_waitcnt lgkmcnt(4)
v_mfma_f32_16x16x32_bf16 v[80:83], v[64:67], a[160:163], v[80:83]
v_mul_f32 v209, v120, v136
v_mul_f32 v211, v121, v137
v_mfma_f32_16x16x32_bf16 v[80:83], v[68:71], a[176:179], v[80:83]
buffer_load_dwordx4 v2, s[8:11], s23 offen offset:1024 lds
v_fma_f32 v208, v208, v240, v240
v_mfma_f32_16x16x32_bf16 v[84:87], v[64:67], a[164:167], v[84:87]
ds_read_b128 v[56:59], v2 offset:51200
v_fma_f32 v210, v210, v240, v240
v_mfma_f32_16x16x32_bf16 v[84:87], v[68:71], a[180:183], v[84:87]
buffer_load_dwordx4 v2, s[8:11], s23 offen offset:2048 lds
v_mfma_f32_16x16x32_bf16 v[88:91], v[64:67], a[168:171], v[88:91]
v_rcp_f32 v208, v208
v_mfma_f32_16x16x32_bf16 v[88:91], v[68:71], a[184:187], v[88:91]
buffer_load_dwordx4 v2, s[8:11], s23 offen offset:3072 lds
v_mfma_f32_16x16x32_bf16 v[92:95], v[64:67], a[172:175], v[92:95]
ds_read_b128 v[60:63], v2 offset:52224
v_rcp_f32 v210, v210
v_mfma_f32_16x16x32_bf16 v[92:95], v[68:71], a[188:191], v[92:95]
s_add_u32 m0, s22, 4096
v_mul_f32 v209, v209, v208
s_waitcnt lgkmcnt(4)
v_mfma_f32_16x16x32_bf16 v[96:99], v[72:75], a[160:163], v[96:99]
v_mul_f32 v211, v211, v210
v_cvt_pk_bf16_f32 v152, v209, v211
v_mfma_f32_16x16x32_bf16 v[96:99], v[76:79], a[176:179], v[96:99]
s_add_u32 s23, s21, 200704
v_mul_f32 v212, v122, v122
v_mfma_f32_16x16x32_bf16 v[100:103], v[72:75], a[164:167], v[100:103]
ds_read_b128 v[64:67], v2 offset:53248
v_mul_f32 v214, v123, v123
v_mfma_f32_16x16x32_bf16 v[100:103], v[76:79], a[180:183], v[100:103]
buffer_load_dwordx4 v2, s[8:11], s23 offen offset:0 lds
v_fma_f32 v212, v212, v239, v238
v_mfma_f32_16x16x32_bf16 v[104:107], v[72:75], a[168:171], v[104:107]
v_fma_f32 v214, v214, v239, v238
v_mul_f32 v212, v212, v122
v_mfma_f32_16x16x32_bf16 v[104:107], v[76:79], a[184:187], v[104:107]
buffer_load_dwordx4 v2, s[8:11], s23 offen offset:1024 lds
v_mul_f32 v214, v214, v123
v_mfma_f32_16x16x32_bf16 v[108:111], v[72:75], a[172:175], v[108:111]
ds_read_b128 v[68:71], v2 offset:54272
v_mfma_f32_16x16x32_bf16 v[108:111], v[76:79], a[188:191], v[108:111]
v_exp_f32 v212, v212
s_waitcnt lgkmcnt(4)
v_mfma_f32_16x16x32_bf16 v[80:83], v[48:51], a[192:195], v[80:83]
v_exp_f32 v214, v214
v_mfma_f32_16x16x32_bf16 v[80:83], v[52:55], a[208:211], v[80:83]
v_mul_f32 v213, v122, v138
v_mul_f32 v215, v123, v139
v_mfma_f32_16x16x32_bf16 v[84:87], v[48:51], a[196:199], v[84:87]
ds_read_b128 v[72:75], v2 offset:55296
v_fma_f32 v212, v212, v240, v240
v_mfma_f32_16x16x32_bf16 v[84:87], v[52:55], a[212:215], v[84:87]
v_fma_f32 v214, v214, v240, v240
v_mfma_f32_16x16x32_bf16 v[88:91], v[48:51], a[200:203], v[88:91]
v_rcp_f32 v212, v212
v_mfma_f32_16x16x32_bf16 v[88:91], v[52:55], a[216:219], v[88:91]
v_mfma_f32_16x16x32_bf16 v[92:95], v[48:51], a[204:207], v[92:95]
ds_read_b128 v[76:79], v2 offset:56320
v_mfma_f32_16x16x32_bf16 v[92:95], v[52:55], a[220:223], v[92:95]
v_rcp_f32 v214, v214
s_waitcnt lgkmcnt(4)
v_mfma_f32_16x16x32_bf16 v[96:99], v[56:59], a[192:195], v[96:99]
v_mul_f32 v213, v213, v212
v_mul_f32 v215, v215, v214
v_mfma_f32_16x16x32_bf16 v[96:99], v[60:63], a[208:211], v[96:99]
v_cvt_pk_bf16_f32 v153, v213, v215
v_mul_f32 v208, v124, v124
v_mfma_f32_16x16x32_bf16 v[100:103], v[56:59], a[196:199], v[100:103]
ds_read_b128 v[48:51], v2 offset:57344
v_mul_f32 v210, v125, v125
v_mfma_f32_16x16x32_bf16 v[100:103], v[60:63], a[212:215], v[100:103]
v_fma_f32 v208, v208, v242, v241
v_fma_f32 v210, v210, v242, v241
v_mfma_f32_16x16x32_bf16 v[104:107], v[56:59], a[200:203], v[104:107]
v_mul_f32 v208, v208, v124
v_mfma_f32_16x16x32_bf16 v[104:107], v[60:63], a[216:219], v[104:107]
v_mul_f32 v210, v210, v125
v_mfma_f32_16x16x32_bf16 v[108:111], v[56:59], a[204:207], v[108:111]
ds_read_b128 v[52:55], v2 offset:58368
v_mfma_f32_16x16x32_bf16 v[108:111], v[60:63], a[220:223], v[108:111]
s_waitcnt lgkmcnt(4)
v_mfma_f32_16x16x32_bf16 v[80:83], v[64:67], a[224:227], v[80:83]
v_exp_f32 v208, v208
v_mfma_f32_16x16x32_bf16 v[80:83], v[68:71], a[240:243], v[80:83]
v_exp_f32 v210, v210
v_mfma_f32_16x16x32_bf16 v[84:87], v[64:67], a[228:231], v[84:87]
ds_read_b128 v[56:59], v2 offset:59392
v_mul_f32 v209, v124, v140
v_mfma_f32_16x16x32_bf16 v[84:87], v[68:71], a[244:247], v[84:87]
v_mul_f32 v211, v125, v141
v_fma_f32 v208, v208, v243, v243
v_mfma_f32_16x16x32_bf16 v[88:91], v[64:67], a[232:235], v[88:91]
v_fma_f32 v210, v210, v243, v243
v_mfma_f32_16x16x32_bf16 v[88:91], v[68:71], a[248:251], v[88:91]
v_rcp_f32 v208, v208
v_mfma_f32_16x16x32_bf16 v[92:95], v[64:67], a[236:239], v[92:95]
ds_read_b128 v[60:63], v2 offset:60416
v_mfma_f32_16x16x32_bf16 v[92:95], v[68:71], a[252:255], v[92:95]
s_waitcnt lgkmcnt(4)
v_mfma_f32_16x16x32_bf16 v[96:99], v[72:75], a[224:227], v[96:99]
v_rcp_f32 v210, v210
v_mfma_f32_16x16x32_bf16 v[96:99], v[76:79], a[240:243], v[96:99]
v_mul_f32 v209, v209, v208
v_mul_f32 v211, v211, v210
v_mfma_f32_16x16x32_bf16 v[100:103], v[72:75], a[228:231], v[100:103]
ds_read_b128 v[64:67], v2 offset:61440
v_cvt_pk_bf16_f32 v156, v209, v211
v_mfma_f32_16x16x32_bf16 v[100:103], v[76:79], a[244:247], v[100:103]
v_mul_f32 v212, v126, v126
v_mul_f32 v214, v127, v127
v_mfma_f32_16x16x32_bf16 v[104:107], v[72:75], a[232:235], v[104:107]
v_fma_f32 v212, v212, v242, v241
v_fma_f32 v214, v214, v242, v241
v_mfma_f32_16x16x32_bf16 v[104:107], v[76:79], a[248:251], v[104:107]
v_mul_f32 v212, v212, v126
v_mfma_f32_16x16x32_bf16 v[108:111], v[72:75], a[236:239], v[108:111]
ds_read_b128 v[68:71], v2 offset:62464
v_mul_f32 v214, v214, v127
v_mfma_f32_16x16x32_bf16 v[108:111], v[76:79], a[252:255], v[108:111]
s_waitcnt lgkmcnt(4)
v_mfma_f32_16x16x32_bf16 v[80:83], v[48:51], v[16:19], v[80:83]
v_exp_f32 v212, v212
v_mfma_f32_16x16x32_bf16 v[80:83], v[52:55], v[32:35], v[80:83]
v_exp_f32 v214, v214
v_mfma_f32_16x16x32_bf16 v[84:87], v[48:51], v[20:23], v[84:87]
ds_read_b128 v[72:75], v2 offset:63488
v_mul_f32 v213, v126, v142
v_mfma_f32_16x16x32_bf16 v[84:87], v[52:55], v[36:39], v[84:87]
v_mul_f32 v215, v127, v143
v_mfma_f32_16x16x32_bf16 v[88:91], v[48:51], v[24:27], v[88:91]
v_fma_f32 v212, v212, v243, v243
v_fma_f32 v214, v214, v243, v243
v_mfma_f32_16x16x32_bf16 v[88:91], v[52:55], v[40:43], v[88:91]
v_mfma_f32_16x16x32_bf16 v[92:95], v[48:51], v[28:31], v[92:95]
ds_read_b128 v[76:79], v2 offset:64512
v_mfma_f32_16x16x32_bf16 v[92:95], v[52:55], v[44:47], v[92:95]
v_rcp_f32 v212, v212
s_waitcnt lgkmcnt(4)
v_mfma_f32_16x16x32_bf16 v[96:99], v[56:59], v[16:19], v[96:99]
v_rcp_f32 v214, v214
v_mfma_f32_16x16x32_bf16 v[96:99], v[60:63], v[32:35], v[96:99]
v_mul_f32 v213, v213, v212
v_mul_f32 v215, v215, v214
v_mfma_f32_16x16x32_bf16 v[100:103], v[56:59], v[20:23], v[100:103]
ds_read_b128 v[48:51], v7 offset:0
v_cvt_pk_bf16_f32 v157, v213, v215
v_mfma_f32_16x16x32_bf16 v[100:103], v[60:63], v[36:39], v[100:103]
v_mfma_f32_16x16x32_bf16 v[104:107], v[56:59], v[24:27], v[104:107]
v_mfma_f32_16x16x32_bf16 v[104:107], v[60:63], v[40:43], v[104:107]
v_mfma_f32_16x16x32_bf16 v[108:111], v[56:59], v[28:31], v[108:111]
ds_read_b128 v[52:55], v7 offset:1024
v_mfma_f32_16x16x32_bf16 v[108:111], v[60:63], v[44:47], v[108:111]
s_waitcnt lgkmcnt(4)
v_mfma_f32_16x16x32_bf16 v[112:115], v[64:67], a[0:3], 0
v_mfma_f32_16x16x32_bf16 v[112:115], v[68:71], a[16:19], v[112:115]
v_mfma_f32_16x16x32_bf16 v[116:119], v[64:67], a[4:7], 0
ds_read_b128 v[56:59], v7 offset:2048
v_mfma_f32_16x16x32_bf16 v[116:119], v[68:71], a[20:23], v[116:119]
v_mul_f32 v208, v80, v80
v_mfma_f32_16x16x32_bf16 v[120:123], v[64:67], a[8:11], 0
v_mul_f32 v210, v81, v81
v_fma_f32 v208, v208, v233, v232
v_mfma_f32_16x16x32_bf16 v[120:123], v[68:71], a[24:27], v[120:123]
v_fma_f32 v210, v210, v233, v232
v_mfma_f32_16x16x32_bf16 v[124:127], v[64:67], a[12:15], 0
ds_read_b128 v[60:63], v7 offset:3072
v_mul_f32 v208, v208, v80
v_mfma_f32_16x16x32_bf16 v[124:127], v[68:71], a[28:31], v[124:127]
v_mul_f32 v210, v210, v81
s_waitcnt lgkmcnt(4)
v_mfma_f32_16x16x32_bf16 v[128:131], v[72:75], a[0:3], 0
v_exp_f32 v208, v208
v_mfma_f32_16x16x32_bf16 v[128:131], v[76:79], a[16:19], v[128:131]
v_mfma_f32_16x16x32_bf16 v[132:135], v[72:75], a[4:7], 0
ds_read_b128 v[64:67], v7 offset:4096
v_mfma_f32_16x16x32_bf16 v[132:135], v[76:79], a[20:23], v[132:135]
v_exp_f32 v210, v210
v_mfma_f32_16x16x32_bf16 v[136:139], v[72:75], a[8:11], 0
v_mul_f32 v209, v80, v96
v_mul_f32 v211, v81, v97
v_mfma_f32_16x16x32_bf16 v[136:139], v[76:79], a[24:27], v[136:139]
v_fma_f32 v208, v208, v234, v234
v_fma_f32 v210, v210, v234, v234
v_mfma_f32_16x16x32_bf16 v[140:143], v[72:75], a[12:15], 0
ds_read_b128 v[68:71], v7 offset:5120
v_mfma_f32_16x16x32_bf16 v[140:143], v[76:79], a[28:31], v[140:143]
s_waitcnt lgkmcnt(4)
v_mfma_f32_16x16x32_bf16 v[112:115], v[48:51], a[32:35], v[112:115]
v_rcp_f32 v208, v208
v_mfma_f32_16x16x32_bf16 v[112:115], v[52:55], a[48:51], v[112:115]
v_rcp_f32 v210, v210
v_mfma_f32_16x16x32_bf16 v[116:119], v[48:51], a[36:39], v[116:119]
ds_read_b128 v[72:75], v7 offset:6144
v_mul_f32 v209, v209, v208
v_mfma_f32_16x16x32_bf16 v[116:119], v[52:55], a[52:55], v[116:119]
v_mul_f32 v211, v211, v210
v_cvt_pk_bf16_f32 v146, v209, v211
v_mfma_f32_16x16x32_bf16 v[120:123], v[48:51], a[40:43], v[120:123]
v_mul_f32 v212, v82, v82
v_mul_f32 v214, v83, v83
v_mfma_f32_16x16x32_bf16 v[120:123], v[52:55], a[56:59], v[120:123]
v_fma_f32 v212, v212, v233, v232
v_mfma_f32_16x16x32_bf16 v[124:127], v[48:51], a[44:47], v[124:127]
ds_read_b128 v[76:79], v7 offset:7168
v_fma_f32 v214, v214, v233, v232
v_mfma_f32_16x16x32_bf16 v[124:127], v[52:55], a[60:63], v[124:127]
v_mul_f32 v212, v212, v82
s_waitcnt lgkmcnt(4)
v_mfma_f32_16x16x32_bf16 v[128:131], v[56:59], a[32:35], v[128:131]
v_mul_f32 v214, v214, v83
v_mfma_f32_16x16x32_bf16 v[128:131], v[60:63], a[48:51], v[128:131]
v_exp_f32 v212, v212
v_mfma_f32_16x16x32_bf16 v[132:135], v[56:59], a[36:39], v[132:135]
s_waitcnt vmcnt(22)
s_barrier
ds_read_b128 v[48:51], v7 offset:8192
v_mfma_f32_16x16x32_bf16 v[132:135], v[60:63], a[52:55], v[132:135]
s_add_u32 m0, s22, 24576
v_mfma_f32_16x16x32_bf16 v[136:139], v[56:59], a[40:43], v[136:139]
v_exp_f32 v214, v214
v_mfma_f32_16x16x32_bf16 v[136:139], v[60:63], a[56:59], v[136:139]
s_add_u32 s23, s21, 221184
v_mul_f32 v213, v82, v98
v_mfma_f32_16x16x32_bf16 v[140:143], v[56:59], a[44:47], v[140:143]
ds_read_b128 v[52:55], v7 offset:9216
v_mul_f32 v215, v83, v99
v_mfma_f32_16x16x32_bf16 v[140:143], v[60:63], a[60:63], v[140:143]
buffer_load_dwordx4 v2, s[8:11], s23 offen offset:0 lds
v_fma_f32 v212, v212, v234, v234
s_waitcnt lgkmcnt(4)
v_mfma_f32_16x16x32_bf16 v[112:115], v[64:67], a[64:67], v[112:115]
v_fma_f32 v214, v214, v234, v234
v_mfma_f32_16x16x32_bf16 v[112:115], v[68:71], a[80:83], v[112:115]
buffer_load_dwordx4 v2, s[8:11], s23 offen offset:1024 lds
v_rcp_f32 v212, v212
v_mfma_f32_16x16x32_bf16 v[116:119], v[64:67], a[68:71], v[116:119]
ds_read_b128 v[56:59], v7 offset:10240
v_rcp_f32 v214, v214
v_mfma_f32_16x16x32_bf16 v[116:119], v[68:71], a[84:87], v[116:119]
buffer_load_dwordx4 v2, s[8:11], s23 offen offset:2048 lds
v_mul_f32 v213, v213, v212
v_mfma_f32_16x16x32_bf16 v[120:123], v[64:67], a[72:75], v[120:123]
v_mul_f32 v215, v215, v214
v_cvt_pk_bf16_f32 v147, v213, v215
v_mfma_f32_16x16x32_bf16 v[120:123], v[68:71], a[88:91], v[120:123]
buffer_load_dwordx4 v2, s[8:11], s23 offen offset:3072 lds
buffer_store_dwordx4 v[144:147], v2, s[8:11], s24 offen offset:0 sc1
v_mfma_f32_16x16x32_bf16 v[124:127], v[64:67], a[76:79], v[124:127]
ds_read_b128 v[60:63], v7 offset:11264
v_mul_f32 v208, v84, v84
v_mfma_f32_16x16x32_bf16 v[124:127], v[68:71], a[92:95], v[124:127]
s_add_u32 m0, s22, 28672
s_waitcnt lgkmcnt(4)
v_mfma_f32_16x16x32_bf16 v[128:131], v[72:75], a[64:67], v[128:131]
v_mul_f32 v210, v85, v85
v_fma_f32 v208, v208, v236, v235
v_mfma_f32_16x16x32_bf16 v[128:131], v[76:79], a[80:83], v[128:131]
s_add_u32 s23, s21, 225280
v_fma_f32 v210, v210, v236, v235
v_mfma_f32_16x16x32_bf16 v[132:135], v[72:75], a[68:71], v[132:135]
ds_read_b128 v[64:67], v7 offset:12288
v_mul_f32 v208, v208, v84
v_mfma_f32_16x16x32_bf16 v[132:135], v[76:79], a[84:87], v[132:135]
buffer_load_dwordx4 v2, s[8:11], s23 offen offset:0 lds
v_mul_f32 v210, v210, v85
v_mfma_f32_16x16x32_bf16 v[136:139], v[72:75], a[72:75], v[136:139]
v_exp_f32 v208, v208
v_mfma_f32_16x16x32_bf16 v[136:139], v[76:79], a[88:91], v[136:139]
buffer_load_dwordx4 v2, s[8:11], s23 offen offset:1024 lds
v_exp_f32 v210, v210
v_mfma_f32_16x16x32_bf16 v[140:143], v[72:75], a[76:79], v[140:143]
ds_read_b128 v[68:71], v7 offset:13312
v_mul_f32 v209, v84, v100
v_mfma_f32_16x16x32_bf16 v[140:143], v[76:79], a[92:95], v[140:143]
v_mul_f32 v211, v85, v101
s_waitcnt lgkmcnt(4)
v_mfma_f32_16x16x32_bf16 v[112:115], v[48:51], a[96:99], v[112:115]
v_fma_f32 v208, v208, v237, v237
v_fma_f32 v210, v210, v237, v237
v_mfma_f32_16x16x32_bf16 v[112:115], v[52:55], a[112:115], v[112:115]
v_rcp_f32 v208, v208
v_mfma_f32_16x16x32_bf16 v[116:119], v[48:51], a[100:103], v[116:119]
ds_read_b128 v[72:75], v7 offset:14336
v_mfma_f32_16x16x32_bf16 v[116:119], v[52:55], a[116:119], v[116:119]
v_rcp_f32 v210, v210
v_mfma_f32_16x16x32_bf16 v[120:123], v[48:51], a[104:107], v[120:123]
v_mul_f32 v209, v209, v208
v_mul_f32 v211, v211, v210
v_mfma_f32_16x16x32_bf16 v[120:123], v[52:55], a[120:123], v[120:123]
v_cvt_pk_bf16_f32 v150, v209, v211
v_mfma_f32_16x16x32_bf16 v[124:127], v[48:51], a[108:111], v[124:127]
ds_read_b128 v[76:79], v7 offset:15360
v_mul_f32 v212, v86, v86
v_mfma_f32_16x16x32_bf16 v[124:127], v[52:55], a[124:127], v[124:127]
v_mul_f32 v214, v87, v87
s_waitcnt lgkmcnt(4)
v_mfma_f32_16x16x32_bf16 v[128:131], v[56:59], a[96:99], v[128:131]
v_fma_f32 v212, v212, v236, v235
v_fma_f32 v214, v214, v236, v235
v_mfma_f32_16x16x32_bf16 v[128:131], v[60:63], a[112:115], v[128:131]
v_mul_f32 v212, v212, v86
v_mul_f32 v214, v214, v87
v_mfma_f32_16x16x32_bf16 v[132:135], v[56:59], a[100:103], v[132:135]
ds_read_b128 v[48:51], v7 offset:16384
v_mfma_f32_16x16x32_bf16 v[132:135], v[60:63], a[116:119], v[132:135]
v_exp_f32 v212, v212
v_mfma_f32_16x16x32_bf16 v[136:139], v[56:59], a[104:107], v[136:139]
v_mfma_f32_16x16x32_bf16 v[136:139], v[60:63], a[120:123], v[136:139]
v_exp_f32 v214, v214
v_mfma_f32_16x16x32_bf16 v[140:143], v[56:59], a[108:111], v[140:143]
ds_read_b128 v[52:55], v7 offset:17408
v_mul_f32 v213, v86, v102
v_mfma_f32_16x16x32_bf16 v[140:143], v[60:63], a[124:127], v[140:143]
v_mul_f32 v215, v87, v103
s_waitcnt lgkmcnt(4)
v_mfma_f32_16x16x32_bf16 v[112:115], v[64:67], a[128:131], v[112:115]
v_fma_f32 v212, v212, v237, v237
v_fma_f32 v214, v214, v237, v237
v_mfma_f32_16x16x32_bf16 v[112:115], v[68:71], a[144:147], v[112:115]
v_rcp_f32 v212, v212
v_mfma_f32_16x16x32_bf16 v[116:119], v[64:67], a[132:135], v[116:119]
ds_read_b128 v[56:59], v7 offset:18432
v_mfma_f32_16x16x32_bf16 v[116:119], v[68:71], a[148:151], v[116:119]
v_rcp_f32 v214, v214
v_mfma_f32_16x16x32_bf16 v[120:123], v[64:67], a[136:139], v[120:123]
v_mul_f32 v213, v213, v212
v_mfma_f32_16x16x32_bf16 v[120:123], v[68:71], a[152:155], v[120:123]
v_mul_f32 v215, v215, v214
v_cvt_pk_bf16_f32 v151, v213, v215
v_mfma_f32_16x16x32_bf16 v[124:127], v[64:67], a[140:143], v[124:127]
ds_read_b128 v[60:63], v7 offset:19456
buffer_store_dwordx4 v[148:151], v4, s[8:11], s24 offen offset:0 sc1
v_mfma_f32_16x16x32_bf16 v[124:127], v[68:71], a[156:159], v[124:127]
v_mul_f32 v208, v88, v88
s_waitcnt lgkmcnt(4)
v_mfma_f32_16x16x32_bf16 v[128:131], v[72:75], a[128:131], v[128:131]
v_mul_f32 v210, v89, v89
v_fma_f32 v208, v208, v239, v238
v_mfma_f32_16x16x32_bf16 v[128:131], v[76:79], a[144:147], v[128:131]
v_fma_f32 v210, v210, v239, v238
v_mfma_f32_16x16x32_bf16 v[132:135], v[72:75], a[132:135], v[132:135]
ds_read_b128 v[64:67], v7 offset:20480
v_mul_f32 v208, v208, v88
v_mfma_f32_16x16x32_bf16 v[132:135], v[76:79], a[148:151], v[132:135]
v_mul_f32 v210, v210, v89
v_mfma_f32_16x16x32_bf16 v[136:139], v[72:75], a[136:139], v[136:139]
v_exp_f32 v208, v208
v_mfma_f32_16x16x32_bf16 v[136:139], v[76:79], a[152:155], v[136:139]
v_mfma_f32_16x16x32_bf16 v[140:143], v[72:75], a[140:143], v[140:143]
ds_read_b128 v[68:71], v7 offset:21504
v_mfma_f32_16x16x32_bf16 v[140:143], v[76:79], a[156:159], v[140:143]
v_exp_f32 v210, v210
s_waitcnt lgkmcnt(4)
v_mfma_f32_16x16x32_bf16 v[112:115], v[48:51], a[160:163], v[112:115]
v_mul_f32 v209, v88, v104
v_mul_f32 v211, v89, v105
v_mfma_f32_16x16x32_bf16 v[112:115], v[52:55], a[176:179], v[112:115]
v_fma_f32 v208, v208, v240, v240
v_fma_f32 v210, v210, v240, v240
v_mfma_f32_16x16x32_bf16 v[116:119], v[48:51], a[164:167], v[116:119]
ds_read_b128 v[72:75], v7 offset:22528
v_mfma_f32_16x16x32_bf16 v[116:119], v[52:55], a[180:183], v[116:119]
v_rcp_f32 v208, v208
v_mfma_f32_16x16x32_bf16 v[120:123], v[48:51], a[168:171], v[120:123]
v_rcp_f32 v210, v210
v_mfma_f32_16x16x32_bf16 v[120:123], v[52:55], a[184:187], v[120:123]
v_mul_f32 v209, v209, v208
v_mfma_f32_16x16x32_bf16 v[124:127], v[48:51], a[172:175], v[124:127]
ds_read_b128 v[76:79], v7 offset:23552
v_mul_f32 v211, v211, v210
v_mfma_f32_16x16x32_bf16 v[124:127], v[52:55], a[188:191], v[124:127]
v_cvt_pk_bf16_f32 v154, v209, v211
s_waitcnt lgkmcnt(4)
v_mfma_f32_16x16x32_bf16 v[128:131], v[56:59], a[160:163], v[128:131]
v_mul_f32 v212, v90, v90
v_mul_f32 v214, v91, v91
v_mfma_f32_16x16x32_bf16 v[128:131], v[60:63], a[176:179], v[128:131]
v_fma_f32 v212, v212, v239, v238
v_mfma_f32_16x16x32_bf16 v[132:135], v[56:59], a[164:167], v[132:135]
ds_read_b128 v[48:51], v7 offset:24576
v_fma_f32 v214, v214, v239, v238
v_mfma_f32_16x16x32_bf16 v[132:135], v[60:63], a[180:183], v[132:135]
v_mul_f32 v212, v212, v90
v_mul_f32 v214, v214, v91
v_mfma_f32_16x16x32_bf16 v[136:139], v[56:59], a[168:171], v[136:139]
v_mfma_f32_16x16x32_bf16 v[136:139], v[60:63], a[184:187], v[136:139]
v_exp_f32 v212, v212
v_mfma_f32_16x16x32_bf16 v[140:143], v[56:59], a[172:175], v[140:143]
ds_read_b128 v[52:55], v7 offset:25600
v_mfma_f32_16x16x32_bf16 v[140:143], v[60:63], a[188:191], v[140:143]
s_waitcnt lgkmcnt(4)
v_mfma_f32_16x16x32_bf16 v[112:115], v[64:67], a[192:195], v[112:115]
v_exp_f32 v214, v214
v_mfma_f32_16x16x32_bf16 v[112:115], v[68:71], a[208:211], v[112:115]
v_mul_f32 v213, v90, v106
v_mul_f32 v215, v91, v107
v_mfma_f32_16x16x32_bf16 v[116:119], v[64:67], a[196:199], v[116:119]
ds_read_b128 v[56:59], v7 offset:26624
v_fma_f32 v212, v212, v240, v240
v_mfma_f32_16x16x32_bf16 v[116:119], v[68:71], a[212:215], v[116:119]
v_fma_f32 v214, v214, v240, v240
v_mfma_f32_16x16x32_bf16 v[120:123], v[64:67], a[200:203], v[120:123]
v_rcp_f32 v212, v212
v_mfma_f32_16x16x32_bf16 v[120:123], v[68:71], a[216:219], v[120:123]
v_rcp_f32 v214, v214
v_mfma_f32_16x16x32_bf16 v[124:127], v[64:67], a[204:207], v[124:127]
ds_read_b128 v[60:63], v7 offset:27648
v_mul_f32 v213, v213, v212
v_mfma_f32_16x16x32_bf16 v[124:127], v[68:71], a[220:223], v[124:127]
v_mul_f32 v215, v215, v214
s_waitcnt lgkmcnt(4)
v_mfma_f32_16x16x32_bf16 v[128:131], v[72:75], a[192:195], v[128:131]
v_cvt_pk_bf16_f32 v155, v213, v215
buffer_store_dwordx4 v[152:155], v5, s[8:11], s24 offen offset:0 sc1
v_mfma_f32_16x16x32_bf16 v[128:131], v[76:79], a[208:211], v[128:131]
v_mul_f32 v208, v92, v92
v_mfma_f32_16x16x32_bf16 v[132:135], v[72:75], a[196:199], v[132:135]
ds_read_b128 v[64:67], v7 offset:28672
v_mul_f32 v210, v93, v93
v_mfma_f32_16x16x32_bf16 v[132:135], v[76:79], a[212:215], v[132:135]
v_fma_f32 v208, v208, v242, v241
v_fma_f32 v210, v210, v242, v241
v_mfma_f32_16x16x32_bf16 v[136:139], v[72:75], a[200:203], v[136:139]
v_mul_f32 v208, v208, v92
v_mfma_f32_16x16x32_bf16 v[136:139], v[76:79], a[216:219], v[136:139]
v_mul_f32 v210, v210, v93
v_mfma_f32_16x16x32_bf16 v[140:143], v[72:75], a[204:207], v[140:143]
ds_read_b128 v[68:71], v7 offset:29696
v_mfma_f32_16x16x32_bf16 v[140:143], v[76:79], a[220:223], v[140:143]
s_waitcnt lgkmcnt(4)
v_mfma_f32_16x16x32_bf16 v[112:115], v[48:51], a[224:227], v[112:115]
v_exp_f32 v208, v208
v_mfma_f32_16x16x32_bf16 v[112:115], v[52:55], a[240:243], v[112:115]
v_exp_f32 v210, v210
v_mfma_f32_16x16x32_bf16 v[116:119], v[48:51], a[228:231], v[116:119]
ds_read_b128 v[72:75], v7 offset:30720
v_mul_f32 v209, v92, v108
v_mfma_f32_16x16x32_bf16 v[116:119], v[52:55], a[244:247], v[116:119]
v_mul_f32 v211, v93, v109
v_fma_f32 v208, v208, v243, v243
v_mfma_f32_16x16x32_bf16 v[120:123], v[48:51], a[232:235], v[120:123]
v_fma_f32 v210, v210, v243, v243
v_mfma_f32_16x16x32_bf16 v[120:123], v[52:55], a[248:251], v[120:123]
v_rcp_f32 v208, v208
v_mfma_f32_16x16x32_bf16 v[124:127], v[48:51], a[236:239], v[124:127]
ds_read_b128 v[76:79], v7 offset:31744
v_mfma_f32_16x16x32_bf16 v[124:127], v[52:55], a[252:255], v[124:127]
s_waitcnt lgkmcnt(4)
v_mfma_f32_16x16x32_bf16 v[128:131], v[56:59], a[224:227], v[128:131]
v_rcp_f32 v210, v210
v_mfma_f32_16x16x32_bf16 v[128:131], v[60:63], a[240:243], v[128:131]
v_mul_f32 v209, v209, v208
v_mul_f32 v211, v211, v210
v_mfma_f32_16x16x32_bf16 v[132:135], v[56:59], a[228:231], v[132:135]
s_waitcnt vmcnt(24)
s_barrier
ds_read_b128 v[48:51], v7 offset:32768
v_mfma_f32_16x16x32_bf16 v[132:135], v[60:63], a[244:247], v[132:135]
s_add_u32 m0, s22, 49152
v_cvt_pk_bf16_f32 v158, v209, v211
v_mul_f32 v212, v94, v94
v_mfma_f32_16x16x32_bf16 v[136:139], v[56:59], a[232:235], v[136:139]
v_mul_f32 v214, v95, v95
v_fma_f32 v212, v212, v242, v241
v_mfma_f32_16x16x32_bf16 v[136:139], v[60:63], a[248:251], v[136:139]
s_add_u32 s23, s21, 245760
v_fma_f32 v214, v214, v242, v241
v_mfma_f32_16x16x32_bf16 v[140:143], v[56:59], a[236:239], v[140:143]
ds_read_b128 v[52:55], v7 offset:33792
v_mul_f32 v212, v212, v94
v_mfma_f32_16x16x32_bf16 v[140:143], v[60:63], a[252:255], v[140:143]
buffer_load_dwordx4 v2, s[8:11], s23 offen offset:0 lds
v_mul_f32 v214, v214, v95
s_waitcnt lgkmcnt(4)
v_mfma_f32_16x16x32_bf16 v[112:115], v[64:67], v[16:19], v[112:115]
v_exp_f32 v212, v212
v_mfma_f32_16x16x32_bf16 v[112:115], v[68:71], v[32:35], v[112:115]
buffer_load_dwordx4 v2, s[8:11], s23 offen offset:1024 lds
v_mfma_f32_16x16x32_bf16 v[116:119], v[64:67], v[20:23], v[116:119]
ds_read_b128 v[56:59], v7 offset:34816
v_exp_f32 v214, v214
v_mfma_f32_16x16x32_bf16 v[116:119], v[68:71], v[36:39], v[116:119]
buffer_load_dwordx4 v2, s[8:11], s23 offen offset:2048 lds
v_mul_f32 v213, v94, v110
v_mfma_f32_16x16x32_bf16 v[120:123], v[64:67], v[24:27], v[120:123]
v_mul_f32 v215, v95, v111
v_fma_f32 v212, v212, v243, v243
v_mfma_f32_16x16x32_bf16 v[120:123], v[68:71], v[40:43], v[120:123]
buffer_load_dwordx4 v2, s[8:11], s23 offen offset:3072 lds
v_fma_f32 v214, v214, v243, v243
v_mfma_f32_16x16x32_bf16 v[124:127], v[64:67], v[28:31], v[124:127]
ds_read_b128 v[60:63], v7 offset:35840
v_mfma_f32_16x16x32_bf16 v[124:127], v[68:71], v[44:47], v[124:127]
s_add_u32 m0, s22, 53248
v_rcp_f32 v212, v212
s_waitcnt lgkmcnt(4)
v_mfma_f32_16x16x32_bf16 v[128:131], v[72:75], v[16:19], v[128:131]
v_rcp_f32 v214, v214
v_mfma_f32_16x16x32_bf16 v[128:131], v[76:79], v[32:35], v[128:131]
s_add_u32 s23, s21, 249856
v_mul_f32 v213, v213, v212
v_mfma_f32_16x16x32_bf16 v[132:135], v[72:75], v[20:23], v[132:135]
ds_read_b128 v[64:67], v7 offset:36864
v_mul_f32 v215, v215, v214
v_mfma_f32_16x16x32_bf16 v[132:135], v[76:79], v[36:39], v[132:135]
buffer_load_dwordx4 v2, s[8:11], s23 offen offset:0 lds
v_cvt_pk_bf16_f32 v159, v213, v215
v_mfma_f32_16x16x32_bf16 v[136:139], v[72:75], v[24:27], v[136:139]
buffer_store_dwordx4 v[156:159], v6, s[8:11], s24 offen offset:0 sc1
v_mfma_f32_16x16x32_bf16 v[136:139], v[76:79], v[40:43], v[136:139]
buffer_load_dwordx4 v2, s[8:11], s23 offen offset:1024 lds
v_mfma_f32_16x16x32_bf16 v[140:143], v[72:75], v[28:31], v[140:143]
ds_read_b128 v[68:71], v7 offset:37888
v_mfma_f32_16x16x32_bf16 v[140:143], v[76:79], v[44:47], v[140:143]
s_waitcnt lgkmcnt(4)
v_mfma_f32_16x16x32_bf16 v[80:83], v[48:51], a[0:3], 0
v_mfma_f32_16x16x32_bf16 v[80:83], v[52:55], a[16:19], v[80:83]
v_mfma_f32_16x16x32_bf16 v[84:87], v[48:51], a[4:7], 0
ds_read_b128 v[72:75], v7 offset:38912
v_mfma_f32_16x16x32_bf16 v[84:87], v[52:55], a[20:23], v[84:87]
v_mul_f32 v208, v112, v112
v_mfma_f32_16x16x32_bf16 v[88:91], v[48:51], a[8:11], 0
v_mul_f32 v210, v113, v113
v_mfma_f32_16x16x32_bf16 v[88:91], v[52:55], a[24:27], v[88:91]
v_fma_f32 v208, v208, v233, v232
v_fma_f32 v210, v210, v233, v232
v_mfma_f32_16x16x32_bf16 v[92:95], v[48:51], a[12:15], 0
ds_read_b128 v[76:79], v7 offset:39936
v_mul_f32 v208, v208, v112
v_mfma_f32_16x16x32_bf16 v[92:95], v[52:55], a[28:31], v[92:95]
v_mul_f32 v210, v210, v113
s_waitcnt lgkmcnt(4)
v_mfma_f32_16x16x32_bf16 v[96:99], v[56:59], a[0:3], 0
v_mfma_f32_16x16x32_bf16 v[96:99], v[60:63], a[16:19], v[96:99]
v_exp_f32 v208, v208
v_mfma_f32_16x16x32_bf16 v[100:103], v[56:59], a[4:7], 0
ds_read_b128 v[48:51], v7 offset:40960
v_mfma_f32_16x16x32_bf16 v[100:103], v[60:63], a[20:23], v[100:103]
v_exp_f32 v210, v210
v_mfma_f32_16x16x32_bf16 v[104:107], v[56:59], a[8:11], 0
v_mul_f32 v209, v112, v128
v_mul_f32 v211, v113, v129
v_mfma_f32_16x16x32_bf16 v[104:107], v[60:63], a[24:27], v[104:107]
v_fma_f32 v208, v208, v234, v234
v_fma_f32 v210, v210, v234, v234
v_mfma_f32_16x16x32_bf16 v[108:111], v[56:59], a[12:15], 0
ds_read_b128 v[52:55], v7 offset:41984
v_mfma_f32_16x16x32_bf16 v[108:111], v[60:63], a[28:31], v[108:111]
s_waitcnt lgkmcnt(4)
v_mfma_f32_16x16x32_bf16 v[80:83], v[64:67], a[32:35], v[80:83]
v_rcp_f32 v208, v208
v_mfma_f32_16x16x32_bf16 v[80:83], v[68:71], a[48:51], v[80:83]
v_rcp_f32 v210, v210
v_mfma_f32_16x16x32_bf16 v[84:87], v[64:67], a[36:39], v[84:87]
ds_read_b128 v[56:59], v7 offset:43008
v_mul_f32 v209, v209, v208
v_mfma_f32_16x16x32_bf16 v[84:87], v[68:71], a[52:55], v[84:87]
v_mul_f32 v211, v211, v210
v_cvt_pk_bf16_f32 v160, v209, v211
v_mfma_f32_16x16x32_bf16 v[88:91], v[64:67], a[40:43], v[88:91]
v_mul_f32 v212, v114, v114
v_mfma_f32_16x16x32_bf16 v[88:91], v[68:71], a[56:59], v[88:91]
v_mul_f32 v214, v115, v115
v_mfma_f32_16x16x32_bf16 v[92:95], v[64:67], a[44:47], v[92:95]
ds_read_b128 v[60:63], v7 offset:44032
v_fma_f32 v212, v212, v233, v232
v_mfma_f32_16x16x32_bf16 v[92:95], v[68:71], a[60:63], v[92:95]
v_fma_f32 v214, v214, v233, v232
s_waitcnt lgkmcnt(4)
v_mfma_f32_16x16x32_bf16 v[96:99], v[72:75], a[32:35], v[96:99]
v_mul_f32 v212, v212, v114
v_mul_f32 v214, v214, v115
v_mfma_f32_16x16x32_bf16 v[96:99], v[76:79], a[48:51], v[96:99]
v_mfma_f32_16x16x32_bf16 v[100:103], v[72:75], a[36:39], v[100:103]
ds_read_b128 v[64:67], v7 offset:45056
v_mfma_f32_16x16x32_bf16 v[100:103], v[76:79], a[52:55], v[100:103]
v_exp_f32 v212, v212
v_mfma_f32_16x16x32_bf16 v[104:107], v[72:75], a[40:43], v[104:107]
v_exp_f32 v214, v214
v_mfma_f32_16x16x32_bf16 v[104:107], v[76:79], a[56:59], v[104:107]
v_mul_f32 v213, v114, v130
v_mul_f32 v215, v115, v131
v_mfma_f32_16x16x32_bf16 v[108:111], v[72:75], a[44:47], v[108:111]
ds_read_b128 v[68:71], v7 offset:46080
v_fma_f32 v212, v212, v234, v234
v_mfma_f32_16x16x32_bf16 v[108:111], v[76:79], a[60:63], v[108:111]
v_fma_f32 v214, v214, v234, v234
s_waitcnt lgkmcnt(4)
v_mfma_f32_16x16x32_bf16 v[80:83], v[48:51], a[64:67], v[80:83]
v_rcp_f32 v212, v212
v_mfma_f32_16x16x32_bf16 v[80:83], v[52:55], a[80:83], v[80:83]
v_mfma_f32_16x16x32_bf16 v[84:87], v[48:51], a[68:71], v[84:87]
ds_read_b128 v[72:75], v7 offset:47104
v_mfma_f32_16x16x32_bf16 v[84:87], v[52:55], a[84:87], v[84:87]
v_rcp_f32 v214, v214
v_mfma_f32_16x16x32_bf16 v[88:91], v[48:51], a[72:75], v[88:91]
v_mul_f32 v213, v213, v212
v_mul_f32 v215, v215, v214
v_mfma_f32_16x16x32_bf16 v[88:91], v[52:55], a[88:91], v[88:91]
v_cvt_pk_bf16_f32 v161, v213, v215
v_mul_f32 v208, v116, v116
v_mfma_f32_16x16x32_bf16 v[92:95], v[48:51], a[76:79], v[92:95]
ds_read_b128 v[76:79], v7 offset:48128
v_mul_f32 v210, v117, v117
v_mfma_f32_16x16x32_bf16 v[92:95], v[52:55], a[92:95], v[92:95]
v_fma_f32 v208, v208, v236, v235
s_waitcnt lgkmcnt(4)
v_mfma_f32_16x16x32_bf16 v[96:99], v[56:59], a[64:67], v[96:99]
v_fma_f32 v210, v210, v236, v235
v_mul_f32 v208, v208, v116
v_mfma_f32_16x16x32_bf16 v[96:99], v[60:63], a[80:83], v[96:99]
v_mul_f32 v210, v210, v117
v_mfma_f32_16x16x32_bf16 v[100:103], v[56:59], a[68:71], v[100:103]
ds_read_b128 v[48:51], v7 offset:49152
v_mfma_f32_16x16x32_bf16 v[100:103], v[60:63], a[84:87], v[100:103]
v_exp_f32 v208, v208
v_mfma_f32_16x16x32_bf16 v[104:107], v[56:59], a[72:75], v[104:107]
v_exp_f32 v210, v210
v_mfma_f32_16x16x32_bf16 v[104:107], v[60:63], a[88:91], v[104:107]
v_mul_f32 v209, v116, v132
v_mfma_f32_16x16x32_bf16 v[108:111], v[56:59], a[76:79], v[108:111]
ds_read_b128 v[52:55], v7 offset:50176
v_mul_f32 v211, v117, v133
v_mfma_f32_16x16x32_bf16 v[108:111], v[60:63], a[92:95], v[108:111]
v_fma_f32 v208, v208, v237, v237
s_waitcnt lgkmcnt(4)
v_mfma_f32_16x16x32_bf16 v[80:83], v[64:67], a[96:99], v[80:83]
v_fma_f32 v210, v210, v237, v237
v_mfma_f32_16x16x32_bf16 v[80:83], v[68:71], a[112:115], v[80:83]
v_rcp_f32 v208, v208
v_mfma_f32_16x16x32_bf16 v[84:87], v[64:67], a[100:103], v[84:87]
ds_read_b128 v[56:59], v7 offset:51200
v_mfma_f32_16x16x32_bf16 v[84:87], v[68:71], a[116:119], v[84:87]
v_rcp_f32 v210, v210
v_mfma_f32_16x16x32_bf16 v[88:91], v[64:67], a[104:107], v[88:91]
v_mul_f32 v209, v209, v208
v_mul_f32 v211, v211, v210
v_mfma_f32_16x16x32_bf16 v[88:91], v[68:71], a[120:123], v[88:91]
v_cvt_pk_bf16_f32 v164, v209, v211
v_mfma_f32_16x16x32_bf16 v[92:95], v[64:67], a[108:111], v[92:95]
ds_read_b128 v[60:63], v7 offset:52224
v_mul_f32 v212, v118, v118
v_mfma_f32_16x16x32_bf16 v[92:95], v[68:71], a[124:127], v[92:95]
v_mul_f32 v214, v119, v119
s_waitcnt lgkmcnt(4)
v_mfma_f32_16x16x32_bf16 v[96:99], v[72:75], a[96:99], v[96:99]
v_fma_f32 v212, v212, v236, v235
v_fma_f32 v214, v214, v236, v235
v_mfma_f32_16x16x32_bf16 v[96:99], v[76:79], a[112:115], v[96:99]
v_mul_f32 v212, v212, v118
v_mfma_f32_16x16x32_bf16 v[100:103], v[72:75], a[100:103], v[100:103]
ds_read_b128 v[64:67], v7 offset:53248
v_mul_f32 v214, v214, v119
v_mfma_f32_16x16x32_bf16 v[100:103], v[76:79], a[116:119], v[100:103]
v_mfma_f32_16x16x32_bf16 v[104:107], v[72:75], a[104:107], v[104:107]
v_exp_f32 v212, v212
v_mfma_f32_16x16x32_bf16 v[104:107], v[76:79], a[120:123], v[104:107]
v_exp_f32 v214, v214
v_mfma_f32_16x16x32_bf16 v[108:111], v[72:75], a[108:111], v[108:111]
ds_read_b128 v[68:71], v7 offset:54272
v_mul_f32 v213, v118, v134
v_mfma_f32_16x16x32_bf16 v[108:111], v[76:79], a[124:127], v[108:111]
v_mul_f32 v215, v119, v135
s_waitcnt lgkmcnt(4)
v_mfma_f32_16x16x32_bf16 v[80:83], v[48:51], a[128:131], v[80:83]
v_fma_f32 v212, v212, v237, v237
v_fma_f32 v214, v214, v237, v237
v_mfma_f32_16x16x32_bf16 v[80:83], v[52:55], a[144:147], v[80:83]
v_mfma_f32_16x16x32_bf16 v[84:87], v[48:51], a[132:135], v[84:87]
ds_read_b128 v[72:75], v7 offset:55296
v_mfma_f32_16x16x32_bf16 v[84:87], v[52:55], a[148:151], v[84:87]
v_rcp_f32 v212, v212
v_mfma_f32_16x16x32_bf16 v[88:91], v[48:51], a[136:139], v[88:91]
v_rcp_f32 v214, v214
v_mfma_f32_16x16x32_bf16 v[88:91], v[52:55], a[152:155], v[88:91]
v_mul_f32 v213, v213, v212
v_mul_f32 v215, v215, v214
v_mfma_f32_16x16x32_bf16 v[92:95], v[48:51], a[140:143], v[92:95]
ds_read_b128 v[76:79], v7 offset:56320
v_cvt_pk_bf16_f32 v165, v213, v215
v_mfma_f32_16x16x32_bf16 v[92:95], v[52:55], a[156:159], v[92:95]
v_mul_f32 v208, v120, v120
s_waitcnt lgkmcnt(4)
v_mfma_f32_16x16x32_bf16 v[96:99], v[56:59], a[128:131], v[96:99]
v_mul_f32 v210, v121, v121
v_mfma_f32_16x16x32_bf16 v[96:99], v[60:63], a[144:147], v[96:99]
v_fma_f32 v208, v208, v239, v238
v_fma_f32 v210, v210, v239, v238
v_mfma_f32_16x16x32_bf16 v[100:103], v[56:59], a[132:135], v[100:103]
s_waitcnt vmcnt(22)
s_barrier
ds_read_b128 v[48:51], v7 offset:57344
v_mfma_f32_16x16x32_bf16 v[100:103], v[60:63], a[148:151], v[100:103]
s_add_u32 m0, s22, 73728
v_mul_f32 v208, v208, v120
v_mfma_f32_16x16x32_bf16 v[104:107], v[56:59], a[136:139], v[104:107]
v_mul_f32 v210, v210, v121
v_mfma_f32_16x16x32_bf16 v[104:107], v[60:63], a[152:155], v[104:107]
s_add_u32 s23, s21, 270336
v_mfma_f32_16x16x32_bf16 v[108:111], v[56:59], a[140:143], v[108:111]
ds_read_b128 v[52:55], v7 offset:58368
v_exp_f32 v208, v208
v_mfma_f32_16x16x32_bf16 v[108:111], v[60:63], a[156:159], v[108:111]
buffer_load_dwordx4 v2, s[8:11], s23 offen offset:0 lds
v_exp_f32 v210, v210
s_waitcnt lgkmcnt(4)
v_mfma_f32_16x16x32_bf16 v[80:83], v[64:67], a[160:163], v[80:83]
v_mul_f32 v209, v120, v136
v_mul_f32 v211, v121, v137
v_mfma_f32_16x16x32_bf16 v[80:83], v[68:71], a[176:179], v[80:83]
buffer_load_dwordx4 v2, s[8:11], s23 offen offset:1024 lds
v_fma_f32 v208, v208, v240, v240
v_mfma_f32_16x16x32_bf16 v[84:87], v[64:67], a[164:167], v[84:87]
ds_read_b128 v[56:59], v7 offset:59392
v_fma_f32 v210, v210, v240, v240
v_mfma_f32_16x16x32_bf16 v[84:87], v[68:71], a[180:183], v[84:87]
buffer_load_dwordx4 v2, s[8:11], s23 offen offset:2048 lds
v_mfma_f32_16x16x32_bf16 v[88:91], v[64:67], a[168:171], v[88:91]
v_rcp_f32 v208, v208
v_mfma_f32_16x16x32_bf16 v[88:91], v[68:71], a[184:187], v[88:91]
buffer_load_dwordx4 v2, s[8:11], s23 offen offset:3072 lds
v_mfma_f32_16x16x32_bf16 v[92:95], v[64:67], a[172:175], v[92:95]
ds_read_b128 v[60:63], v7 offset:60416
v_rcp_f32 v210, v210
v_mfma_f32_16x16x32_bf16 v[92:95], v[68:71], a[188:191], v[92:95]
s_add_u32 m0, s22, 77824
v_mul_f32 v209, v209, v208
s_waitcnt lgkmcnt(4)
v_mfma_f32_16x16x32_bf16 v[96:99], v[72:75], a[160:163], v[96:99]
v_mul_f32 v211, v211, v210
v_cvt_pk_bf16_f32 v168, v209, v211
v_mfma_f32_16x16x32_bf16 v[96:99], v[76:79], a[176:179], v[96:99]
s_add_u32 s23, s21, 274432
v_mul_f32 v212, v122, v122
v_mfma_f32_16x16x32_bf16 v[100:103], v[72:75], a[164:167], v[100:103]
ds_read_b128 v[64:67], v7 offset:61440
v_mul_f32 v214, v123, v123
v_mfma_f32_16x16x32_bf16 v[100:103], v[76:79], a[180:183], v[100:103]
buffer_load_dwordx4 v2, s[8:11], s23 offen offset:0 lds
v_fma_f32 v212, v212, v239, v238
v_mfma_f32_16x16x32_bf16 v[104:107], v[72:75], a[168:171], v[104:107]
v_fma_f32 v214, v214, v239, v238
v_mul_f32 v212, v212, v122
v_mfma_f32_16x16x32_bf16 v[104:107], v[76:79], a[184:187], v[104:107]
buffer_load_dwordx4 v2, s[8:11], s23 offen offset:1024 lds
v_mul_f32 v214, v214, v123
v_mfma_f32_16x16x32_bf16 v[108:111], v[72:75], a[172:175], v[108:111]
ds_read_b128 v[68:71], v7 offset:62464
v_mfma_f32_16x16x32_bf16 v[108:111], v[76:79], a[188:191], v[108:111]
v_exp_f32 v212, v212
s_waitcnt lgkmcnt(4)
v_mfma_f32_16x16x32_bf16 v[80:83], v[48:51], a[192:195], v[80:83]
v_exp_f32 v214, v214
v_mfma_f32_16x16x32_bf16 v[80:83], v[52:55], a[208:211], v[80:83]
v_mul_f32 v213, v122, v138
v_mul_f32 v215, v123, v139
v_mfma_f32_16x16x32_bf16 v[84:87], v[48:51], a[196:199], v[84:87]
ds_read_b128 v[72:75], v7 offset:63488
v_fma_f32 v212, v212, v240, v240
v_mfma_f32_16x16x32_bf16 v[84:87], v[52:55], a[212:215], v[84:87]
v_fma_f32 v214, v214, v240, v240
v_mfma_f32_16x16x32_bf16 v[88:91], v[48:51], a[200:203], v[88:91]
v_rcp_f32 v212, v212
v_mfma_f32_16x16x32_bf16 v[88:91], v[52:55], a[216:219], v[88:91]
v_mfma_f32_16x16x32_bf16 v[92:95], v[48:51], a[204:207], v[92:95]
ds_read_b128 v[76:79], v7 offset:64512
v_mfma_f32_16x16x32_bf16 v[92:95], v[52:55], a[220:223], v[92:95]
v_rcp_f32 v214, v214
s_waitcnt lgkmcnt(4)
v_mfma_f32_16x16x32_bf16 v[96:99], v[56:59], a[192:195], v[96:99]
v_mul_f32 v213, v213, v212
v_mul_f32 v215, v215, v214
v_mfma_f32_16x16x32_bf16 v[96:99], v[60:63], a[208:211], v[96:99]
v_cvt_pk_bf16_f32 v169, v213, v215
v_mul_f32 v208, v124, v124
v_mfma_f32_16x16x32_bf16 v[100:103], v[56:59], a[196:199], v[100:103]
ds_read_b128 v[48:51], v8 offset:0
v_mul_f32 v210, v125, v125
v_mfma_f32_16x16x32_bf16 v[100:103], v[60:63], a[212:215], v[100:103]
v_fma_f32 v208, v208, v242, v241
v_fma_f32 v210, v210, v242, v241
v_mfma_f32_16x16x32_bf16 v[104:107], v[56:59], a[200:203], v[104:107]
v_mul_f32 v208, v208, v124
v_mfma_f32_16x16x32_bf16 v[104:107], v[60:63], a[216:219], v[104:107]
v_mul_f32 v210, v210, v125
v_mfma_f32_16x16x32_bf16 v[108:111], v[56:59], a[204:207], v[108:111]
ds_read_b128 v[52:55], v8 offset:1024
v_mfma_f32_16x16x32_bf16 v[108:111], v[60:63], a[220:223], v[108:111]
s_waitcnt lgkmcnt(4)
v_mfma_f32_16x16x32_bf16 v[80:83], v[64:67], a[224:227], v[80:83]
v_exp_f32 v208, v208
v_mfma_f32_16x16x32_bf16 v[80:83], v[68:71], a[240:243], v[80:83]
v_exp_f32 v210, v210
v_mfma_f32_16x16x32_bf16 v[84:87], v[64:67], a[228:231], v[84:87]
ds_read_b128 v[56:59], v8 offset:2048
v_mul_f32 v209, v124, v140
v_mfma_f32_16x16x32_bf16 v[84:87], v[68:71], a[244:247], v[84:87]
v_mul_f32 v211, v125, v141
v_fma_f32 v208, v208, v243, v243
v_mfma_f32_16x16x32_bf16 v[88:91], v[64:67], a[232:235], v[88:91]
v_fma_f32 v210, v210, v243, v243
v_mfma_f32_16x16x32_bf16 v[88:91], v[68:71], a[248:251], v[88:91]
v_rcp_f32 v208, v208
v_mfma_f32_16x16x32_bf16 v[92:95], v[64:67], a[236:239], v[92:95]
ds_read_b128 v[60:63], v8 offset:3072
v_mfma_f32_16x16x32_bf16 v[92:95], v[68:71], a[252:255], v[92:95]
s_waitcnt lgkmcnt(4)
v_mfma_f32_16x16x32_bf16 v[96:99], v[72:75], a[224:227], v[96:99]
v_rcp_f32 v210, v210
v_mfma_f32_16x16x32_bf16 v[96:99], v[76:79], a[240:243], v[96:99]
v_mul_f32 v209, v209, v208
v_mul_f32 v211, v211, v210
v_mfma_f32_16x16x32_bf16 v[100:103], v[72:75], a[228:231], v[100:103]
ds_read_b128 v[64:67], v8 offset:4096
v_cvt_pk_bf16_f32 v172, v209, v211
v_mfma_f32_16x16x32_bf16 v[100:103], v[76:79], a[244:247], v[100:103]
v_mul_f32 v212, v126, v126
v_mul_f32 v214, v127, v127
v_mfma_f32_16x16x32_bf16 v[104:107], v[72:75], a[232:235], v[104:107]
v_fma_f32 v212, v212, v242, v241
v_fma_f32 v214, v214, v242, v241
v_mfma_f32_16x16x32_bf16 v[104:107], v[76:79], a[248:251], v[104:107]
v_mul_f32 v212, v212, v126
v_mfma_f32_16x16x32_bf16 v[108:111], v[72:75], a[236:239], v[108:111]
ds_read_b128 v[68:71], v8 offset:5120
v_mul_f32 v214, v214, v127
v_mfma_f32_16x16x32_bf16 v[108:111], v[76:79], a[252:255], v[108:111]
s_waitcnt lgkmcnt(4)
v_mfma_f32_16x16x32_bf16 v[80:83], v[48:51], v[16:19], v[80:83]
v_exp_f32 v212, v212
v_mfma_f32_16x16x32_bf16 v[80:83], v[52:55], v[32:35], v[80:83]
v_exp_f32 v214, v214
v_mfma_f32_16x16x32_bf16 v[84:87], v[48:51], v[20:23], v[84:87]
ds_read_b128 v[72:75], v8 offset:6144
v_mul_f32 v213, v126, v142
v_mfma_f32_16x16x32_bf16 v[84:87], v[52:55], v[36:39], v[84:87]
v_mul_f32 v215, v127, v143
v_mfma_f32_16x16x32_bf16 v[88:91], v[48:51], v[24:27], v[88:91]
v_fma_f32 v212, v212, v243, v243
v_fma_f32 v214, v214, v243, v243
v_mfma_f32_16x16x32_bf16 v[88:91], v[52:55], v[40:43], v[88:91]
v_mfma_f32_16x16x32_bf16 v[92:95], v[48:51], v[28:31], v[92:95]
ds_read_b128 v[76:79], v8 offset:7168
v_mfma_f32_16x16x32_bf16 v[92:95], v[52:55], v[44:47], v[92:95]
v_rcp_f32 v212, v212
s_waitcnt lgkmcnt(4)
v_mfma_f32_16x16x32_bf16 v[96:99], v[56:59], v[16:19], v[96:99]
v_rcp_f32 v214, v214
v_mfma_f32_16x16x32_bf16 v[96:99], v[60:63], v[32:35], v[96:99]
v_mul_f32 v213, v213, v212
v_mul_f32 v215, v215, v214
v_mfma_f32_16x16x32_bf16 v[100:103], v[56:59], v[20:23], v[100:103]
ds_read_b128 v[48:51], v8 offset:8192
v_cvt_pk_bf16_f32 v173, v213, v215
v_mfma_f32_16x16x32_bf16 v[100:103], v[60:63], v[36:39], v[100:103]
v_mfma_f32_16x16x32_bf16 v[104:107], v[56:59], v[24:27], v[104:107]
v_mfma_f32_16x16x32_bf16 v[104:107], v[60:63], v[40:43], v[104:107]
v_mfma_f32_16x16x32_bf16 v[108:111], v[56:59], v[28:31], v[108:111]
ds_read_b128 v[52:55], v8 offset:9216
v_mfma_f32_16x16x32_bf16 v[108:111], v[60:63], v[44:47], v[108:111]
s_waitcnt lgkmcnt(4)
v_mfma_f32_16x16x32_bf16 v[112:115], v[64:67], a[0:3], 0
v_mfma_f32_16x16x32_bf16 v[112:115], v[68:71], a[16:19], v[112:115]
v_mfma_f32_16x16x32_bf16 v[116:119], v[64:67], a[4:7], 0
ds_read_b128 v[56:59], v8 offset:10240
v_mfma_f32_16x16x32_bf16 v[116:119], v[68:71], a[20:23], v[116:119]
v_mul_f32 v208, v80, v80
v_mfma_f32_16x16x32_bf16 v[120:123], v[64:67], a[8:11], 0
v_mul_f32 v210, v81, v81
v_fma_f32 v208, v208, v233, v232
v_mfma_f32_16x16x32_bf16 v[120:123], v[68:71], a[24:27], v[120:123]
v_fma_f32 v210, v210, v233, v232
v_mfma_f32_16x16x32_bf16 v[124:127], v[64:67], a[12:15], 0
ds_read_b128 v[60:63], v8 offset:11264
v_mul_f32 v208, v208, v80
v_mfma_f32_16x16x32_bf16 v[124:127], v[68:71], a[28:31], v[124:127]
v_mul_f32 v210, v210, v81
s_waitcnt lgkmcnt(4)
v_mfma_f32_16x16x32_bf16 v[128:131], v[72:75], a[0:3], 0
v_exp_f32 v208, v208
v_mfma_f32_16x16x32_bf16 v[128:131], v[76:79], a[16:19], v[128:131]
v_mfma_f32_16x16x32_bf16 v[132:135], v[72:75], a[4:7], 0
ds_read_b128 v[64:67], v8 offset:12288
v_mfma_f32_16x16x32_bf16 v[132:135], v[76:79], a[20:23], v[132:135]
v_exp_f32 v210, v210
v_mfma_f32_16x16x32_bf16 v[136:139], v[72:75], a[8:11], 0
v_mul_f32 v209, v80, v96
v_mul_f32 v211, v81, v97
v_mfma_f32_16x16x32_bf16 v[136:139], v[76:79], a[24:27], v[136:139]
v_fma_f32 v208, v208, v234, v234
v_fma_f32 v210, v210, v234, v234
v_mfma_f32_16x16x32_bf16 v[140:143], v[72:75], a[12:15], 0
ds_read_b128 v[68:71], v8 offset:13312
v_mfma_f32_16x16x32_bf16 v[140:143], v[76:79], a[28:31], v[140:143]
s_waitcnt lgkmcnt(4)
v_mfma_f32_16x16x32_bf16 v[112:115], v[48:51], a[32:35], v[112:115]
v_rcp_f32 v208, v208
v_mfma_f32_16x16x32_bf16 v[112:115], v[52:55], a[48:51], v[112:115]
v_rcp_f32 v210, v210
v_mfma_f32_16x16x32_bf16 v[116:119], v[48:51], a[36:39], v[116:119]
ds_read_b128 v[72:75], v8 offset:14336
v_mul_f32 v209, v209, v208
v_mfma_f32_16x16x32_bf16 v[116:119], v[52:55], a[52:55], v[116:119]
v_mul_f32 v211, v211, v210
v_cvt_pk_bf16_f32 v162, v209, v211
v_mfma_f32_16x16x32_bf16 v[120:123], v[48:51], a[40:43], v[120:123]
v_mul_f32 v212, v82, v82
v_mul_f32 v214, v83, v83
v_mfma_f32_16x16x32_bf16 v[120:123], v[52:55], a[56:59], v[120:123]
v_fma_f32 v212, v212, v233, v232
v_mfma_f32_16x16x32_bf16 v[124:127], v[48:51], a[44:47], v[124:127]
ds_read_b128 v[76:79], v8 offset:15360
v_fma_f32 v214, v214, v233, v232
v_mfma_f32_16x16x32_bf16 v[124:127], v[52:55], a[60:63], v[124:127]
v_mul_f32 v212, v212, v82
s_waitcnt lgkmcnt(4)
v_mfma_f32_16x16x32_bf16 v[128:131], v[56:59], a[32:35], v[128:131]
v_mul_f32 v214, v214, v83
v_mfma_f32_16x16x32_bf16 v[128:131], v[60:63], a[48:51], v[128:131]
v_exp_f32 v212, v212
v_mfma_f32_16x16x32_bf16 v[132:135], v[56:59], a[36:39], v[132:135]
s_waitcnt vmcnt(22)
s_barrier
ds_read_b128 v[48:51], v2 offset:0
v_mfma_f32_16x16x32_bf16 v[132:135], v[60:63], a[52:55], v[132:135]
s_add_u32 m0, s22, 98304
v_mfma_f32_16x16x32_bf16 v[136:139], v[56:59], a[40:43], v[136:139]
v_exp_f32 v214, v214
v_mfma_f32_16x16x32_bf16 v[136:139], v[60:63], a[56:59], v[136:139]
s_add_u32 s23, s21, 294912
v_mul_f32 v213, v82, v98
v_mfma_f32_16x16x32_bf16 v[140:143], v[56:59], a[44:47], v[140:143]
ds_read_b128 v[52:55], v2 offset:1024
v_mul_f32 v215, v83, v99
v_mfma_f32_16x16x32_bf16 v[140:143], v[60:63], a[60:63], v[140:143]
buffer_load_dwordx4 v2, s[8:11], s23 offen offset:0 lds
v_fma_f32 v212, v212, v234, v234
s_waitcnt lgkmcnt(4)
v_mfma_f32_16x16x32_bf16 v[112:115], v[64:67], a[64:67], v[112:115]
v_fma_f32 v214, v214, v234, v234
v_mfma_f32_16x16x32_bf16 v[112:115], v[68:71], a[80:83], v[112:115]
buffer_load_dwordx4 v2, s[8:11], s23 offen offset:1024 lds
v_rcp_f32 v212, v212
v_mfma_f32_16x16x32_bf16 v[116:119], v[64:67], a[68:71], v[116:119]
ds_read_b128 v[56:59], v2 offset:2048
v_rcp_f32 v214, v214
v_mfma_f32_16x16x32_bf16 v[116:119], v[68:71], a[84:87], v[116:119]
buffer_load_dwordx4 v2, s[8:11], s23 offen offset:2048 lds
v_mul_f32 v213, v213, v212
v_mfma_f32_16x16x32_bf16 v[120:123], v[64:67], a[72:75], v[120:123]
v_mul_f32 v215, v215, v214
v_cvt_pk_bf16_f32 v163, v213, v215
v_mfma_f32_16x16x32_bf16 v[120:123], v[68:71], a[88:91], v[120:123]
buffer_load_dwordx4 v2, s[8:11], s23 offen offset:3072 lds
buffer_store_dwordx4 v[160:163], v2, s[8:11], s24 offen offset:1024 sc1
v_mfma_f32_16x16x32_bf16 v[124:127], v[64:67], a[76:79], v[124:127]
ds_read_b128 v[60:63], v2 offset:3072
v_mul_f32 v208, v84, v84
v_mfma_f32_16x16x32_bf16 v[124:127], v[68:71], a[92:95], v[124:127]
s_add_u32 m0, s22, 102400
s_waitcnt lgkmcnt(4)
v_mfma_f32_16x16x32_bf16 v[128:131], v[72:75], a[64:67], v[128:131]
v_mul_f32 v210, v85, v85
v_fma_f32 v208, v208, v236, v235
v_mfma_f32_16x16x32_bf16 v[128:131], v[76:79], a[80:83], v[128:131]
s_add_u32 s23, s21, 299008
v_fma_f32 v210, v210, v236, v235
v_mfma_f32_16x16x32_bf16 v[132:135], v[72:75], a[68:71], v[132:135]
ds_read_b128 v[64:67], v2 offset:4096
v_mul_f32 v208, v208, v84
v_mfma_f32_16x16x32_bf16 v[132:135], v[76:79], a[84:87], v[132:135]
buffer_load_dwordx4 v2, s[8:11], s23 offen offset:0 lds
v_mul_f32 v210, v210, v85
v_mfma_f32_16x16x32_bf16 v[136:139], v[72:75], a[72:75], v[136:139]
v_exp_f32 v208, v208
v_mfma_f32_16x16x32_bf16 v[136:139], v[76:79], a[88:91], v[136:139]
buffer_load_dwordx4 v2, s[8:11], s23 offen offset:1024 lds
v_exp_f32 v210, v210
v_mfma_f32_16x16x32_bf16 v[140:143], v[72:75], a[76:79], v[140:143]
ds_read_b128 v[68:71], v2 offset:5120
v_mul_f32 v209, v84, v100
v_mfma_f32_16x16x32_bf16 v[140:143], v[76:79], a[92:95], v[140:143]
v_mul_f32 v211, v85, v101
s_waitcnt lgkmcnt(4)
v_mfma_f32_16x16x32_bf16 v[112:115], v[48:51], a[96:99], v[112:115]
v_fma_f32 v208, v208, v237, v237
v_fma_f32 v210, v210, v237, v237
v_mfma_f32_16x16x32_bf16 v[112:115], v[52:55], a[112:115], v[112:115]
v_rcp_f32 v208, v208
v_mfma_f32_16x16x32_bf16 v[116:119], v[48:51], a[100:103], v[116:119]
ds_read_b128 v[72:75], v2 offset:6144
v_mfma_f32_16x16x32_bf16 v[116:119], v[52:55], a[116:119], v[116:119]
v_rcp_f32 v210, v210
v_mfma_f32_16x16x32_bf16 v[120:123], v[48:51], a[104:107], v[120:123]
v_mul_f32 v209, v209, v208
v_mul_f32 v211, v211, v210
v_mfma_f32_16x16x32_bf16 v[120:123], v[52:55], a[120:123], v[120:123]
v_cvt_pk_bf16_f32 v166, v209, v211
v_mfma_f32_16x16x32_bf16 v[124:127], v[48:51], a[108:111], v[124:127]
ds_read_b128 v[76:79], v2 offset:7168
v_mul_f32 v212, v86, v86
v_mfma_f32_16x16x32_bf16 v[124:127], v[52:55], a[124:127], v[124:127]
v_mul_f32 v214, v87, v87
s_waitcnt lgkmcnt(4)
v_mfma_f32_16x16x32_bf16 v[128:131], v[56:59], a[96:99], v[128:131]
v_fma_f32 v212, v212, v236, v235
v_fma_f32 v214, v214, v236, v235
v_mfma_f32_16x16x32_bf16 v[128:131], v[60:63], a[112:115], v[128:131]
v_mul_f32 v212, v212, v86
v_mul_f32 v214, v214, v87
v_mfma_f32_16x16x32_bf16 v[132:135], v[56:59], a[100:103], v[132:135]
ds_read_b128 v[48:51], v2 offset:8192
v_mfma_f32_16x16x32_bf16 v[132:135], v[60:63], a[116:119], v[132:135]
v_exp_f32 v212, v212
v_mfma_f32_16x16x32_bf16 v[136:139], v[56:59], a[104:107], v[136:139]
v_mfma_f32_16x16x32_bf16 v[136:139], v[60:63], a[120:123], v[136:139]
v_exp_f32 v214, v214
v_mfma_f32_16x16x32_bf16 v[140:143], v[56:59], a[108:111], v[140:143]
ds_read_b128 v[52:55], v2 offset:9216
v_mul_f32 v213, v86, v102
v_mfma_f32_16x16x32_bf16 v[140:143], v[60:63], a[124:127], v[140:143]
v_mul_f32 v215, v87, v103
s_waitcnt lgkmcnt(4)
v_mfma_f32_16x16x32_bf16 v[112:115], v[64:67], a[128:131], v[112:115]
v_fma_f32 v212, v212, v237, v237
v_fma_f32 v214, v214, v237, v237
v_mfma_f32_16x16x32_bf16 v[112:115], v[68:71], a[144:147], v[112:115]
v_rcp_f32 v212, v212
v_mfma_f32_16x16x32_bf16 v[116:119], v[64:67], a[132:135], v[116:119]
ds_read_b128 v[56:59], v2 offset:10240
v_mfma_f32_16x16x32_bf16 v[116:119], v[68:71], a[148:151], v[116:119]
v_rcp_f32 v214, v214
v_mfma_f32_16x16x32_bf16 v[120:123], v[64:67], a[136:139], v[120:123]
v_mul_f32 v213, v213, v212
v_mfma_f32_16x16x32_bf16 v[120:123], v[68:71], a[152:155], v[120:123]
v_mul_f32 v215, v215, v214
v_cvt_pk_bf16_f32 v167, v213, v215
v_mfma_f32_16x16x32_bf16 v[124:127], v[64:67], a[140:143], v[124:127]
ds_read_b128 v[60:63], v2 offset:11264
buffer_store_dwordx4 v[164:167], v4, s[8:11], s24 offen offset:1024 sc1
v_mfma_f32_16x16x32_bf16 v[124:127], v[68:71], a[156:159], v[124:127]
v_mul_f32 v208, v88, v88
s_waitcnt lgkmcnt(4)
v_mfma_f32_16x16x32_bf16 v[128:131], v[72:75], a[128:131], v[128:131]
v_mul_f32 v210, v89, v89
v_fma_f32 v208, v208, v239, v238
v_mfma_f32_16x16x32_bf16 v[128:131], v[76:79], a[144:147], v[128:131]
v_fma_f32 v210, v210, v239, v238
v_mfma_f32_16x16x32_bf16 v[132:135], v[72:75], a[132:135], v[132:135]
ds_read_b128 v[64:67], v2 offset:12288
v_mul_f32 v208, v208, v88
v_mfma_f32_16x16x32_bf16 v[132:135], v[76:79], a[148:151], v[132:135]
v_mul_f32 v210, v210, v89
v_mfma_f32_16x16x32_bf16 v[136:139], v[72:75], a[136:139], v[136:139]
v_exp_f32 v208, v208
v_mfma_f32_16x16x32_bf16 v[136:139], v[76:79], a[152:155], v[136:139]
v_mfma_f32_16x16x32_bf16 v[140:143], v[72:75], a[140:143], v[140:143]
ds_read_b128 v[68:71], v2 offset:13312
v_mfma_f32_16x16x32_bf16 v[140:143], v[76:79], a[156:159], v[140:143]
v_exp_f32 v210, v210
s_waitcnt lgkmcnt(4)
v_mfma_f32_16x16x32_bf16 v[112:115], v[48:51], a[160:163], v[112:115]
v_mul_f32 v209, v88, v104
v_mul_f32 v211, v89, v105
v_mfma_f32_16x16x32_bf16 v[112:115], v[52:55], a[176:179], v[112:115]
v_fma_f32 v208, v208, v240, v240
v_fma_f32 v210, v210, v240, v240
v_mfma_f32_16x16x32_bf16 v[116:119], v[48:51], a[164:167], v[116:119]
ds_read_b128 v[72:75], v2 offset:14336
v_mfma_f32_16x16x32_bf16 v[116:119], v[52:55], a[180:183], v[116:119]
v_rcp_f32 v208, v208
v_mfma_f32_16x16x32_bf16 v[120:123], v[48:51], a[168:171], v[120:123]
v_rcp_f32 v210, v210
v_mfma_f32_16x16x32_bf16 v[120:123], v[52:55], a[184:187], v[120:123]
v_mul_f32 v209, v209, v208
v_mfma_f32_16x16x32_bf16 v[124:127], v[48:51], a[172:175], v[124:127]
ds_read_b128 v[76:79], v2 offset:15360
v_mul_f32 v211, v211, v210
v_mfma_f32_16x16x32_bf16 v[124:127], v[52:55], a[188:191], v[124:127]
v_cvt_pk_bf16_f32 v170, v209, v211
s_waitcnt lgkmcnt(4)
v_mfma_f32_16x16x32_bf16 v[128:131], v[56:59], a[160:163], v[128:131]
v_mul_f32 v212, v90, v90
v_mul_f32 v214, v91, v91
v_mfma_f32_16x16x32_bf16 v[128:131], v[60:63], a[176:179], v[128:131]
v_fma_f32 v212, v212, v239, v238
v_mfma_f32_16x16x32_bf16 v[132:135], v[56:59], a[164:167], v[132:135]
ds_read_b128 v[48:51], v2 offset:16384
v_fma_f32 v214, v214, v239, v238
v_mfma_f32_16x16x32_bf16 v[132:135], v[60:63], a[180:183], v[132:135]
v_mul_f32 v212, v212, v90
v_mul_f32 v214, v214, v91
v_mfma_f32_16x16x32_bf16 v[136:139], v[56:59], a[168:171], v[136:139]
v_mfma_f32_16x16x32_bf16 v[136:139], v[60:63], a[184:187], v[136:139]
v_exp_f32 v212, v212
v_mfma_f32_16x16x32_bf16 v[140:143], v[56:59], a[172:175], v[140:143]
ds_read_b128 v[52:55], v2 offset:17408
v_mfma_f32_16x16x32_bf16 v[140:143], v[60:63], a[188:191], v[140:143]
s_waitcnt lgkmcnt(4)
v_mfma_f32_16x16x32_bf16 v[112:115], v[64:67], a[192:195], v[112:115]
v_exp_f32 v214, v214
v_mfma_f32_16x16x32_bf16 v[112:115], v[68:71], a[208:211], v[112:115]
v_mul_f32 v213, v90, v106
v_mul_f32 v215, v91, v107
v_mfma_f32_16x16x32_bf16 v[116:119], v[64:67], a[196:199], v[116:119]
ds_read_b128 v[56:59], v2 offset:18432
v_fma_f32 v212, v212, v240, v240
v_mfma_f32_16x16x32_bf16 v[116:119], v[68:71], a[212:215], v[116:119]
v_fma_f32 v214, v214, v240, v240
v_mfma_f32_16x16x32_bf16 v[120:123], v[64:67], a[200:203], v[120:123]
v_rcp_f32 v212, v212
v_mfma_f32_16x16x32_bf16 v[120:123], v[68:71], a[216:219], v[120:123]
v_rcp_f32 v214, v214
v_mfma_f32_16x16x32_bf16 v[124:127], v[64:67], a[204:207], v[124:127]
ds_read_b128 v[60:63], v2 offset:19456
v_mul_f32 v213, v213, v212
v_mfma_f32_16x16x32_bf16 v[124:127], v[68:71], a[220:223], v[124:127]
v_mul_f32 v215, v215, v214
s_waitcnt lgkmcnt(4)
v_mfma_f32_16x16x32_bf16 v[128:131], v[72:75], a[192:195], v[128:131]
v_cvt_pk_bf16_f32 v171, v213, v215
buffer_store_dwordx4 v[168:171], v5, s[8:11], s24 offen offset:1024 sc1
v_mfma_f32_16x16x32_bf16 v[128:131], v[76:79], a[208:211], v[128:131]
v_mul_f32 v208, v92, v92
v_mfma_f32_16x16x32_bf16 v[132:135], v[72:75], a[196:199], v[132:135]
ds_read_b128 v[64:67], v2 offset:20480
v_mul_f32 v210, v93, v93
v_mfma_f32_16x16x32_bf16 v[132:135], v[76:79], a[212:215], v[132:135]
v_fma_f32 v208, v208, v242, v241
v_fma_f32 v210, v210, v242, v241
v_mfma_f32_16x16x32_bf16 v[136:139], v[72:75], a[200:203], v[136:139]
v_mul_f32 v208, v208, v92
v_mfma_f32_16x16x32_bf16 v[136:139], v[76:79], a[216:219], v[136:139]
v_mul_f32 v210, v210, v93
v_mfma_f32_16x16x32_bf16 v[140:143], v[72:75], a[204:207], v[140:143]
ds_read_b128 v[68:71], v2 offset:21504
v_mfma_f32_16x16x32_bf16 v[140:143], v[76:79], a[220:223], v[140:143]
s_waitcnt lgkmcnt(4)
v_mfma_f32_16x16x32_bf16 v[112:115], v[48:51], a[224:227], v[112:115]
v_exp_f32 v208, v208
v_mfma_f32_16x16x32_bf16 v[112:115], v[52:55], a[240:243], v[112:115]
v_exp_f32 v210, v210
v_mfma_f32_16x16x32_bf16 v[116:119], v[48:51], a[228:231], v[116:119]
ds_read_b128 v[72:75], v2 offset:22528
v_mul_f32 v209, v92, v108
v_mfma_f32_16x16x32_bf16 v[116:119], v[52:55], a[244:247], v[116:119]
v_mul_f32 v211, v93, v109
v_fma_f32 v208, v208, v243, v243
v_mfma_f32_16x16x32_bf16 v[120:123], v[48:51], a[232:235], v[120:123]
v_fma_f32 v210, v210, v243, v243
v_mfma_f32_16x16x32_bf16 v[120:123], v[52:55], a[248:251], v[120:123]
v_rcp_f32 v208, v208
v_mfma_f32_16x16x32_bf16 v[124:127], v[48:51], a[236:239], v[124:127]
ds_read_b128 v[76:79], v2 offset:23552
v_mfma_f32_16x16x32_bf16 v[124:127], v[52:55], a[252:255], v[124:127]
s_waitcnt lgkmcnt(4)
v_mfma_f32_16x16x32_bf16 v[128:131], v[56:59], a[224:227], v[128:131]
v_rcp_f32 v210, v210
v_mfma_f32_16x16x32_bf16 v[128:131], v[60:63], a[240:243], v[128:131]
v_mul_f32 v209, v209, v208
v_mul_f32 v211, v211, v210
v_mfma_f32_16x16x32_bf16 v[132:135], v[56:59], a[228:231], v[132:135]
s_waitcnt vmcnt(24)
s_barrier
ds_read_b128 v[48:51], v2 offset:24576
v_mfma_f32_16x16x32_bf16 v[132:135], v[60:63], a[244:247], v[132:135]
s_add_u32 m0, s22, 122880
v_cvt_pk_bf16_f32 v174, v209, v211
v_mul_f32 v212, v94, v94
v_mfma_f32_16x16x32_bf16 v[136:139], v[56:59], a[232:235], v[136:139]
v_mul_f32 v214, v95, v95
v_fma_f32 v212, v212, v242, v241
v_mfma_f32_16x16x32_bf16 v[136:139], v[60:63], a[248:251], v[136:139]
s_add_u32 s23, s21, 319488
v_fma_f32 v214, v214, v242, v241
v_mfma_f32_16x16x32_bf16 v[140:143], v[56:59], a[236:239], v[140:143]
ds_read_b128 v[52:55], v2 offset:25600
v_mul_f32 v212, v212, v94
v_mfma_f32_16x16x32_bf16 v[140:143], v[60:63], a[252:255], v[140:143]
buffer_load_dwordx4 v2, s[8:11], s23 offen offset:0 lds
v_mul_f32 v214, v214, v95
s_waitcnt lgkmcnt(4)
v_mfma_f32_16x16x32_bf16 v[112:115], v[64:67], v[16:19], v[112:115]
v_exp_f32 v212, v212
v_mfma_f32_16x16x32_bf16 v[112:115], v[68:71], v[32:35], v[112:115]
buffer_load_dwordx4 v2, s[8:11], s23 offen offset:1024 lds
v_mfma_f32_16x16x32_bf16 v[116:119], v[64:67], v[20:23], v[116:119]
ds_read_b128 v[56:59], v2 offset:26624
v_exp_f32 v214, v214
v_mfma_f32_16x16x32_bf16 v[116:119], v[68:71], v[36:39], v[116:119]
buffer_load_dwordx4 v2, s[8:11], s23 offen offset:2048 lds
v_mul_f32 v213, v94, v110
v_mfma_f32_16x16x32_bf16 v[120:123], v[64:67], v[24:27], v[120:123]
v_mul_f32 v215, v95, v111
v_fma_f32 v212, v212, v243, v243
v_mfma_f32_16x16x32_bf16 v[120:123], v[68:71], v[40:43], v[120:123]
buffer_load_dwordx4 v2, s[8:11], s23 offen offset:3072 lds
v_fma_f32 v214, v214, v243, v243
v_mfma_f32_16x16x32_bf16 v[124:127], v[64:67], v[28:31], v[124:127]
ds_read_b128 v[60:63], v2 offset:27648
v_mfma_f32_16x16x32_bf16 v[124:127], v[68:71], v[44:47], v[124:127]
s_add_u32 m0, s22, 126976
v_rcp_f32 v212, v212
s_waitcnt lgkmcnt(4)
v_mfma_f32_16x16x32_bf16 v[128:131], v[72:75], v[16:19], v[128:131]
v_rcp_f32 v214, v214
v_mfma_f32_16x16x32_bf16 v[128:131], v[76:79], v[32:35], v[128:131]
s_add_u32 s23, s21, 323584
v_mul_f32 v213, v213, v212
v_mfma_f32_16x16x32_bf16 v[132:135], v[72:75], v[20:23], v[132:135]
ds_read_b128 v[64:67], v2 offset:28672
v_mul_f32 v215, v215, v214
v_mfma_f32_16x16x32_bf16 v[132:135], v[76:79], v[36:39], v[132:135]
buffer_load_dwordx4 v2, s[8:11], s23 offen offset:0 lds
v_cvt_pk_bf16_f32 v175, v213, v215
v_mfma_f32_16x16x32_bf16 v[136:139], v[72:75], v[24:27], v[136:139]
buffer_store_dwordx4 v[172:175], v6, s[8:11], s24 offen offset:1024 sc1
v_mfma_f32_16x16x32_bf16 v[136:139], v[76:79], v[40:43], v[136:139]
buffer_load_dwordx4 v2, s[8:11], s23 offen offset:1024 lds
v_mfma_f32_16x16x32_bf16 v[140:143], v[72:75], v[28:31], v[140:143]
ds_read_b128 v[68:71], v2 offset:29696
v_mfma_f32_16x16x32_bf16 v[140:143], v[76:79], v[44:47], v[140:143]
s_waitcnt lgkmcnt(4)
v_mfma_f32_16x16x32_bf16 v[80:83], v[48:51], a[0:3], 0
v_mfma_f32_16x16x32_bf16 v[80:83], v[52:55], a[16:19], v[80:83]
v_mfma_f32_16x16x32_bf16 v[84:87], v[48:51], a[4:7], 0
ds_read_b128 v[72:75], v2 offset:30720
v_mfma_f32_16x16x32_bf16 v[84:87], v[52:55], a[20:23], v[84:87]
v_mul_f32 v208, v112, v112
v_mfma_f32_16x16x32_bf16 v[88:91], v[48:51], a[8:11], 0
v_mul_f32 v210, v113, v113
v_mfma_f32_16x16x32_bf16 v[88:91], v[52:55], a[24:27], v[88:91]
v_fma_f32 v208, v208, v233, v232
v_fma_f32 v210, v210, v233, v232
v_mfma_f32_16x16x32_bf16 v[92:95], v[48:51], a[12:15], 0
ds_read_b128 v[76:79], v2 offset:31744
v_mul_f32 v208, v208, v112
v_mfma_f32_16x16x32_bf16 v[92:95], v[52:55], a[28:31], v[92:95]
v_mul_f32 v210, v210, v113
s_waitcnt lgkmcnt(4)
v_mfma_f32_16x16x32_bf16 v[96:99], v[56:59], a[0:3], 0
v_mfma_f32_16x16x32_bf16 v[96:99], v[60:63], a[16:19], v[96:99]
v_exp_f32 v208, v208
v_mfma_f32_16x16x32_bf16 v[100:103], v[56:59], a[4:7], 0
ds_read_b128 v[48:51], v2 offset:32768
v_mfma_f32_16x16x32_bf16 v[100:103], v[60:63], a[20:23], v[100:103]
v_exp_f32 v210, v210
v_mfma_f32_16x16x32_bf16 v[104:107], v[56:59], a[8:11], 0
v_mul_f32 v209, v112, v128
v_mul_f32 v211, v113, v129
v_mfma_f32_16x16x32_bf16 v[104:107], v[60:63], a[24:27], v[104:107]
v_fma_f32 v208, v208, v234, v234
v_fma_f32 v210, v210, v234, v234
v_mfma_f32_16x16x32_bf16 v[108:111], v[56:59], a[12:15], 0
ds_read_b128 v[52:55], v2 offset:33792
v_mfma_f32_16x16x32_bf16 v[108:111], v[60:63], a[28:31], v[108:111]
s_waitcnt lgkmcnt(4)
v_mfma_f32_16x16x32_bf16 v[80:83], v[64:67], a[32:35], v[80:83]
v_rcp_f32 v208, v208
v_mfma_f32_16x16x32_bf16 v[80:83], v[68:71], a[48:51], v[80:83]
v_rcp_f32 v210, v210
v_mfma_f32_16x16x32_bf16 v[84:87], v[64:67], a[36:39], v[84:87]
ds_read_b128 v[56:59], v2 offset:34816
v_mul_f32 v209, v209, v208
v_mfma_f32_16x16x32_bf16 v[84:87], v[68:71], a[52:55], v[84:87]
v_mul_f32 v211, v211, v210
v_cvt_pk_bf16_f32 v176, v209, v211
v_mfma_f32_16x16x32_bf16 v[88:91], v[64:67], a[40:43], v[88:91]
v_mul_f32 v212, v114, v114
v_mfma_f32_16x16x32_bf16 v[88:91], v[68:71], a[56:59], v[88:91]
v_mul_f32 v214, v115, v115
v_mfma_f32_16x16x32_bf16 v[92:95], v[64:67], a[44:47], v[92:95]
ds_read_b128 v[60:63], v2 offset:35840
v_fma_f32 v212, v212, v233, v232
v_mfma_f32_16x16x32_bf16 v[92:95], v[68:71], a[60:63], v[92:95]
v_fma_f32 v214, v214, v233, v232
s_waitcnt lgkmcnt(4)
v_mfma_f32_16x16x32_bf16 v[96:99], v[72:75], a[32:35], v[96:99]
v_mul_f32 v212, v212, v114
v_mul_f32 v214, v214, v115
v_mfma_f32_16x16x32_bf16 v[96:99], v[76:79], a[48:51], v[96:99]
v_mfma_f32_16x16x32_bf16 v[100:103], v[72:75], a[36:39], v[100:103]
ds_read_b128 v[64:67], v2 offset:36864
v_mfma_f32_16x16x32_bf16 v[100:103], v[76:79], a[52:55], v[100:103]
v_exp_f32 v212, v212
v_mfma_f32_16x16x32_bf16 v[104:107], v[72:75], a[40:43], v[104:107]
v_exp_f32 v214, v214
v_mfma_f32_16x16x32_bf16 v[104:107], v[76:79], a[56:59], v[104:107]
v_mul_f32 v213, v114, v130
v_mul_f32 v215, v115, v131
v_mfma_f32_16x16x32_bf16 v[108:111], v[72:75], a[44:47], v[108:111]
ds_read_b128 v[68:71], v2 offset:37888
v_fma_f32 v212, v212, v234, v234
v_mfma_f32_16x16x32_bf16 v[108:111], v[76:79], a[60:63], v[108:111]
v_fma_f32 v214, v214, v234, v234
s_waitcnt lgkmcnt(4)
v_mfma_f32_16x16x32_bf16 v[80:83], v[48:51], a[64:67], v[80:83]
v_rcp_f32 v212, v212
v_mfma_f32_16x16x32_bf16 v[80:83], v[52:55], a[80:83], v[80:83]
v_mfma_f32_16x16x32_bf16 v[84:87], v[48:51], a[68:71], v[84:87]
ds_read_b128 v[72:75], v2 offset:38912
v_mfma_f32_16x16x32_bf16 v[84:87], v[52:55], a[84:87], v[84:87]
v_rcp_f32 v214, v214
v_mfma_f32_16x16x32_bf16 v[88:91], v[48:51], a[72:75], v[88:91]
v_mul_f32 v213, v213, v212
v_mul_f32 v215, v215, v214
v_mfma_f32_16x16x32_bf16 v[88:91], v[52:55], a[88:91], v[88:91]
v_cvt_pk_bf16_f32 v177, v213, v215
v_mul_f32 v208, v116, v116
v_mfma_f32_16x16x32_bf16 v[92:95], v[48:51], a[76:79], v[92:95]
ds_read_b128 v[76:79], v2 offset:39936
v_mul_f32 v210, v117, v117
v_mfma_f32_16x16x32_bf16 v[92:95], v[52:55], a[92:95], v[92:95]
v_fma_f32 v208, v208, v236, v235
s_waitcnt lgkmcnt(4)
v_mfma_f32_16x16x32_bf16 v[96:99], v[56:59], a[64:67], v[96:99]
v_fma_f32 v210, v210, v236, v235
v_mul_f32 v208, v208, v116
v_mfma_f32_16x16x32_bf16 v[96:99], v[60:63], a[80:83], v[96:99]
v_mul_f32 v210, v210, v117
v_mfma_f32_16x16x32_bf16 v[100:103], v[56:59], a[68:71], v[100:103]
ds_read_b128 v[48:51], v2 offset:40960
v_mfma_f32_16x16x32_bf16 v[100:103], v[60:63], a[84:87], v[100:103]
v_exp_f32 v208, v208
v_mfma_f32_16x16x32_bf16 v[104:107], v[56:59], a[72:75], v[104:107]
v_exp_f32 v210, v210
v_mfma_f32_16x16x32_bf16 v[104:107], v[60:63], a[88:91], v[104:107]
v_mul_f32 v209, v116, v132
v_mfma_f32_16x16x32_bf16 v[108:111], v[56:59], a[76:79], v[108:111]
ds_read_b128 v[52:55], v2 offset:41984
v_mul_f32 v211, v117, v133
v_mfma_f32_16x16x32_bf16 v[108:111], v[60:63], a[92:95], v[108:111]
v_fma_f32 v208, v208, v237, v237
s_waitcnt lgkmcnt(4)
v_mfma_f32_16x16x32_bf16 v[80:83], v[64:67], a[96:99], v[80:83]
v_fma_f32 v210, v210, v237, v237
v_mfma_f32_16x16x32_bf16 v[80:83], v[68:71], a[112:115], v[80:83]
v_rcp_f32 v208, v208
v_mfma_f32_16x16x32_bf16 v[84:87], v[64:67], a[100:103], v[84:87]
ds_read_b128 v[56:59], v2 offset:43008
v_mfma_f32_16x16x32_bf16 v[84:87], v[68:71], a[116:119], v[84:87]
v_rcp_f32 v210, v210
v_mfma_f32_16x16x32_bf16 v[88:91], v[64:67], a[104:107], v[88:91]
v_mul_f32 v209, v209, v208
v_mul_f32 v211, v211, v210
v_mfma_f32_16x16x32_bf16 v[88:91], v[68:71], a[120:123], v[88:91]
v_cvt_pk_bf16_f32 v180, v209, v211
v_mfma_f32_16x16x32_bf16 v[92:95], v[64:67], a[108:111], v[92:95]
ds_read_b128 v[60:63], v2 offset:44032
v_mul_f32 v212, v118, v118
v_mfma_f32_16x16x32_bf16 v[92:95], v[68:71], a[124:127], v[92:95]
v_mul_f32 v214, v119, v119
s_waitcnt lgkmcnt(4)
v_mfma_f32_16x16x32_bf16 v[96:99], v[72:75], a[96:99], v[96:99]
v_fma_f32 v212, v212, v236, v235
v_fma_f32 v214, v214, v236, v235
v_mfma_f32_16x16x32_bf16 v[96:99], v[76:79], a[112:115], v[96:99]
v_mul_f32 v212, v212, v118
v_mfma_f32_16x16x32_bf16 v[100:103], v[72:75], a[100:103], v[100:103]
ds_read_b128 v[64:67], v2 offset:45056
v_mul_f32 v214, v214, v119
v_mfma_f32_16x16x32_bf16 v[100:103], v[76:79], a[116:119], v[100:103]
v_mfma_f32_16x16x32_bf16 v[104:107], v[72:75], a[104:107], v[104:107]
v_exp_f32 v212, v212
v_mfma_f32_16x16x32_bf16 v[104:107], v[76:79], a[120:123], v[104:107]
v_exp_f32 v214, v214
v_mfma_f32_16x16x32_bf16 v[108:111], v[72:75], a[108:111], v[108:111]
ds_read_b128 v[68:71], v2 offset:46080
v_mul_f32 v213, v118, v134
v_mfma_f32_16x16x32_bf16 v[108:111], v[76:79], a[124:127], v[108:111]
v_mul_f32 v215, v119, v135
s_waitcnt lgkmcnt(4)
v_mfma_f32_16x16x32_bf16 v[80:83], v[48:51], a[128:131], v[80:83]
v_fma_f32 v212, v212, v237, v237
v_fma_f32 v214, v214, v237, v237
v_mfma_f32_16x16x32_bf16 v[80:83], v[52:55], a[144:147], v[80:83]
v_mfma_f32_16x16x32_bf16 v[84:87], v[48:51], a[132:135], v[84:87]
ds_read_b128 v[72:75], v2 offset:47104
v_mfma_f32_16x16x32_bf16 v[84:87], v[52:55], a[148:151], v[84:87]
v_rcp_f32 v212, v212
v_mfma_f32_16x16x32_bf16 v[88:91], v[48:51], a[136:139], v[88:91]
v_rcp_f32 v214, v214
v_mfma_f32_16x16x32_bf16 v[88:91], v[52:55], a[152:155], v[88:91]
v_mul_f32 v213, v213, v212
v_mul_f32 v215, v215, v214
v_mfma_f32_16x16x32_bf16 v[92:95], v[48:51], a[140:143], v[92:95]
ds_read_b128 v[76:79], v2 offset:48128
v_cvt_pk_bf16_f32 v181, v213, v215
v_mfma_f32_16x16x32_bf16 v[92:95], v[52:55], a[156:159], v[92:95]
v_mul_f32 v208, v120, v120
s_waitcnt lgkmcnt(4)
v_mfma_f32_16x16x32_bf16 v[96:99], v[56:59], a[128:131], v[96:99]
v_mul_f32 v210, v121, v121
v_mfma_f32_16x16x32_bf16 v[96:99], v[60:63], a[144:147], v[96:99]
v_fma_f32 v208, v208, v239, v238
v_fma_f32 v210, v210, v239, v238
v_mfma_f32_16x16x32_bf16 v[100:103], v[56:59], a[132:135], v[100:103]
s_waitcnt vmcnt(0)
s_barrier
v_mov_b32 v12, 1
buffer_store_dword v12, v10, s[8:11], s34 offen sc1
ds_read_b128 v[48:51], v2 offset:49152
v_mfma_f32_16x16x32_bf16 v[100:103], v[60:63], a[148:151], v[100:103]
s_add_u32 m0, s22, 0
v_mul_f32 v208, v208, v120
v_mfma_f32_16x16x32_bf16 v[104:107], v[56:59], a[136:139], v[104:107]
v_mul_f32 v210, v210, v121
v_mfma_f32_16x16x32_bf16 v[104:107], v[60:63], a[152:155], v[104:107]
s_add_u32 s23, s21, 344064
v_mfma_f32_16x16x32_bf16 v[108:111], v[56:59], a[140:143], v[108:111]
ds_read_b128 v[52:55], v2 offset:50176
v_exp_f32 v208, v208
v_mfma_f32_16x16x32_bf16 v[108:111], v[60:63], a[156:159], v[108:111]
buffer_load_dwordx4 v2, s[8:11], s23 offen offset:0 lds
v_exp_f32 v210, v210
s_waitcnt lgkmcnt(4)
v_mfma_f32_16x16x32_bf16 v[80:83], v[64:67], a[160:163], v[80:83]
v_mul_f32 v209, v120, v136
v_mul_f32 v211, v121, v137
v_mfma_f32_16x16x32_bf16 v[80:83], v[68:71], a[176:179], v[80:83]
buffer_load_dwordx4 v2, s[8:11], s23 offen offset:1024 lds
v_fma_f32 v208, v208, v240, v240
v_mfma_f32_16x16x32_bf16 v[84:87], v[64:67], a[164:167], v[84:87]
ds_read_b128 v[56:59], v2 offset:51200
v_fma_f32 v210, v210, v240, v240
v_mfma_f32_16x16x32_bf16 v[84:87], v[68:71], a[180:183], v[84:87]
buffer_load_dwordx4 v2, s[8:11], s23 offen offset:2048 lds
v_mfma_f32_16x16x32_bf16 v[88:91], v[64:67], a[168:171], v[88:91]
v_rcp_f32 v208, v208
v_mfma_f32_16x16x32_bf16 v[88:91], v[68:71], a[184:187], v[88:91]
buffer_load_dwordx4 v2, s[8:11], s23 offen offset:3072 lds
v_mfma_f32_16x16x32_bf16 v[92:95], v[64:67], a[172:175], v[92:95]
ds_read_b128 v[60:63], v2 offset:52224
v_rcp_f32 v210, v210
v_mfma_f32_16x16x32_bf16 v[92:95], v[68:71], a[188:191], v[92:95]
s_add_u32 m0, s22, 4096
v_mul_f32 v209, v209, v208
s_waitcnt lgkmcnt(4)
v_mfma_f32_16x16x32_bf16 v[96:99], v[72:75], a[160:163], v[96:99]
v_mul_f32 v211, v211, v210
v_cvt_pk_bf16_f32 v184, v209, v211
v_mfma_f32_16x16x32_bf16 v[96:99], v[76:79], a[176:179], v[96:99]
s_add_u32 s23, s21, 348160
v_mul_f32 v212, v122, v122
v_mfma_f32_16x16x32_bf16 v[100:103], v[72:75], a[164:167], v[100:103]
ds_read_b128 v[64:67], v2 offset:53248
v_mul_f32 v214, v123, v123
v_mfma_f32_16x16x32_bf16 v[100:103], v[76:79], a[180:183], v[100:103]
buffer_load_dwordx4 v2, s[8:11], s23 offen offset:0 lds
v_fma_f32 v212, v212, v239, v238
v_mfma_f32_16x16x32_bf16 v[104:107], v[72:75], a[168:171], v[104:107]
v_fma_f32 v214, v214, v239, v238
v_mul_f32 v212, v212, v122
v_mfma_f32_16x16x32_bf16 v[104:107], v[76:79], a[184:187], v[104:107]
buffer_load_dwordx4 v2, s[8:11], s23 offen offset:1024 lds
v_mul_f32 v214, v214, v123
v_mfma_f32_16x16x32_bf16 v[108:111], v[72:75], a[172:175], v[108:111]
ds_read_b128 v[68:71], v2 offset:54272
v_mfma_f32_16x16x32_bf16 v[108:111], v[76:79], a[188:191], v[108:111]
v_exp_f32 v212, v212
s_waitcnt lgkmcnt(4)
v_mfma_f32_16x16x32_bf16 v[80:83], v[48:51], a[192:195], v[80:83]
v_exp_f32 v214, v214
v_mfma_f32_16x16x32_bf16 v[80:83], v[52:55], a[208:211], v[80:83]
v_mul_f32 v213, v122, v138
v_mul_f32 v215, v123, v139
v_mfma_f32_16x16x32_bf16 v[84:87], v[48:51], a[196:199], v[84:87]
ds_read_b128 v[72:75], v2 offset:55296
v_fma_f32 v212, v212, v240, v240
v_mfma_f32_16x16x32_bf16 v[84:87], v[52:55], a[212:215], v[84:87]
v_fma_f32 v214, v214, v240, v240
v_mfma_f32_16x16x32_bf16 v[88:91], v[48:51], a[200:203], v[88:91]
v_rcp_f32 v212, v212
v_mfma_f32_16x16x32_bf16 v[88:91], v[52:55], a[216:219], v[88:91]
v_mfma_f32_16x16x32_bf16 v[92:95], v[48:51], a[204:207], v[92:95]
ds_read_b128 v[76:79], v2 offset:56320
v_mfma_f32_16x16x32_bf16 v[92:95], v[52:55], a[220:223], v[92:95]
v_rcp_f32 v214, v214
s_waitcnt lgkmcnt(4)
v_mfma_f32_16x16x32_bf16 v[96:99], v[56:59], a[192:195], v[96:99]
v_mul_f32 v213, v213, v212
v_mul_f32 v215, v215, v214
v_mfma_f32_16x16x32_bf16 v[96:99], v[60:63], a[208:211], v[96:99]
v_cvt_pk_bf16_f32 v185, v213, v215
v_mul_f32 v208, v124, v124
v_mfma_f32_16x16x32_bf16 v[100:103], v[56:59], a[196:199], v[100:103]
ds_read_b128 v[48:51], v2 offset:57344
v_mul_f32 v210, v125, v125
v_mfma_f32_16x16x32_bf16 v[100:103], v[60:63], a[212:215], v[100:103]
v_fma_f32 v208, v208, v242, v241
v_fma_f32 v210, v210, v242, v241
v_mfma_f32_16x16x32_bf16 v[104:107], v[56:59], a[200:203], v[104:107]
v_mul_f32 v208, v208, v124
v_mfma_f32_16x16x32_bf16 v[104:107], v[60:63], a[216:219], v[104:107]
v_mul_f32 v210, v210, v125
v_mfma_f32_16x16x32_bf16 v[108:111], v[56:59], a[204:207], v[108:111]
ds_read_b128 v[52:55], v2 offset:58368
v_mfma_f32_16x16x32_bf16 v[108:111], v[60:63], a[220:223], v[108:111]
s_waitcnt lgkmcnt(4)
v_mfma_f32_16x16x32_bf16 v[80:83], v[64:67], a[224:227], v[80:83]
v_exp_f32 v208, v208
v_mfma_f32_16x16x32_bf16 v[80:83], v[68:71], a[240:243], v[80:83]
v_exp_f32 v210, v210
v_mfma_f32_16x16x32_bf16 v[84:87], v[64:67], a[228:231], v[84:87]
ds_read_b128 v[56:59], v2 offset:59392
v_mul_f32 v209, v124, v140
v_mfma_f32_16x16x32_bf16 v[84:87], v[68:71], a[244:247], v[84:87]
v_mul_f32 v211, v125, v141
v_fma_f32 v208, v208, v243, v243
v_mfma_f32_16x16x32_bf16 v[88:91], v[64:67], a[232:235], v[88:91]
v_fma_f32 v210, v210, v243, v243
v_mfma_f32_16x16x32_bf16 v[88:91], v[68:71], a[248:251], v[88:91]
v_rcp_f32 v208, v208
v_mfma_f32_16x16x32_bf16 v[92:95], v[64:67], a[236:239], v[92:95]
ds_read_b128 v[60:63], v2 offset:60416
v_mfma_f32_16x16x32_bf16 v[92:95], v[68:71], a[252:255], v[92:95]
s_waitcnt lgkmcnt(4)
v_mfma_f32_16x16x32_bf16 v[96:99], v[72:75], a[224:227], v[96:99]
v_rcp_f32 v210, v210
v_mfma_f32_16x16x32_bf16 v[96:99], v[76:79], a[240:243], v[96:99]
v_mul_f32 v209, v209, v208
v_mul_f32 v211, v211, v210
v_mfma_f32_16x16x32_bf16 v[100:103], v[72:75], a[228:231], v[100:103]
ds_read_b128 v[64:67], v2 offset:61440
v_cvt_pk_bf16_f32 v188, v209, v211
v_mfma_f32_16x16x32_bf16 v[100:103], v[76:79], a[244:247], v[100:103]
v_mul_f32 v212, v126, v126
v_mul_f32 v214, v127, v127
v_mfma_f32_16x16x32_bf16 v[104:107], v[72:75], a[232:235], v[104:107]
v_fma_f32 v212, v212, v242, v241
v_fma_f32 v214, v214, v242, v241
v_mfma_f32_16x16x32_bf16 v[104:107], v[76:79], a[248:251], v[104:107]
v_mul_f32 v212, v212, v126
v_mfma_f32_16x16x32_bf16 v[108:111], v[72:75], a[236:239], v[108:111]
ds_read_b128 v[68:71], v2 offset:62464
v_mul_f32 v214, v214, v127
v_mfma_f32_16x16x32_bf16 v[108:111], v[76:79], a[252:255], v[108:111]
s_waitcnt lgkmcnt(4)
v_mfma_f32_16x16x32_bf16 v[80:83], v[48:51], v[16:19], v[80:83]
v_exp_f32 v212, v212
v_mfma_f32_16x16x32_bf16 v[80:83], v[52:55], v[32:35], v[80:83]
v_exp_f32 v214, v214
v_mfma_f32_16x16x32_bf16 v[84:87], v[48:51], v[20:23], v[84:87]
ds_read_b128 v[72:75], v2 offset:63488
v_mul_f32 v213, v126, v142
v_mfma_f32_16x16x32_bf16 v[84:87], v[52:55], v[36:39], v[84:87]
v_mul_f32 v215, v127, v143
v_mfma_f32_16x16x32_bf16 v[88:91], v[48:51], v[24:27], v[88:91]
v_fma_f32 v212, v212, v243, v243
v_fma_f32 v214, v214, v243, v243
v_mfma_f32_16x16x32_bf16 v[88:91], v[52:55], v[40:43], v[88:91]
v_mfma_f32_16x16x32_bf16 v[92:95], v[48:51], v[28:31], v[92:95]
ds_read_b128 v[76:79], v2 offset:64512
v_mfma_f32_16x16x32_bf16 v[92:95], v[52:55], v[44:47], v[92:95]
v_rcp_f32 v212, v212
s_waitcnt lgkmcnt(4)
v_mfma_f32_16x16x32_bf16 v[96:99], v[56:59], v[16:19], v[96:99]
v_rcp_f32 v214, v214
v_mfma_f32_16x16x32_bf16 v[96:99], v[60:63], v[32:35], v[96:99]
v_mul_f32 v213, v213, v212
v_mul_f32 v215, v215, v214
v_mfma_f32_16x16x32_bf16 v[100:103], v[56:59], v[20:23], v[100:103]
ds_read_b128 v[48:51], v7 offset:0
v_cvt_pk_bf16_f32 v189, v213, v215
v_mfma_f32_16x16x32_bf16 v[100:103], v[60:63], v[36:39], v[100:103]
v_mfma_f32_16x16x32_bf16 v[104:107], v[56:59], v[24:27], v[104:107]
v_mfma_f32_16x16x32_bf16 v[104:107], v[60:63], v[40:43], v[104:107]
v_mfma_f32_16x16x32_bf16 v[108:111], v[56:59], v[28:31], v[108:111]
ds_read_b128 v[52:55], v7 offset:1024
v_mfma_f32_16x16x32_bf16 v[108:111], v[60:63], v[44:47], v[108:111]
s_waitcnt lgkmcnt(4)
v_mfma_f32_16x16x32_bf16 v[112:115], v[64:67], a[0:3], 0
v_mfma_f32_16x16x32_bf16 v[112:115], v[68:71], a[16:19], v[112:115]
v_mfma_f32_16x16x32_bf16 v[116:119], v[64:67], a[4:7], 0
ds_read_b128 v[56:59], v7 offset:2048
v_mfma_f32_16x16x32_bf16 v[116:119], v[68:71], a[20:23], v[116:119]
v_mul_f32 v208, v80, v80
v_mfma_f32_16x16x32_bf16 v[120:123], v[64:67], a[8:11], 0
v_mul_f32 v210, v81, v81
v_fma_f32 v208, v208, v233, v232
v_mfma_f32_16x16x32_bf16 v[120:123], v[68:71], a[24:27], v[120:123]
v_fma_f32 v210, v210, v233, v232
v_mfma_f32_16x16x32_bf16 v[124:127], v[64:67], a[12:15], 0
ds_read_b128 v[60:63], v7 offset:3072
v_mul_f32 v208, v208, v80
v_mfma_f32_16x16x32_bf16 v[124:127], v[68:71], a[28:31], v[124:127]
v_mul_f32 v210, v210, v81
s_waitcnt lgkmcnt(4)
v_mfma_f32_16x16x32_bf16 v[128:131], v[72:75], a[0:3], 0
v_exp_f32 v208, v208
v_mfma_f32_16x16x32_bf16 v[128:131], v[76:79], a[16:19], v[128:131]
v_mfma_f32_16x16x32_bf16 v[132:135], v[72:75], a[4:7], 0
ds_read_b128 v[64:67], v7 offset:4096
v_mfma_f32_16x16x32_bf16 v[132:135], v[76:79], a[20:23], v[132:135]
v_exp_f32 v210, v210
v_mfma_f32_16x16x32_bf16 v[136:139], v[72:75], a[8:11], 0
v_mul_f32 v209, v80, v96
v_mul_f32 v211, v81, v97
v_mfma_f32_16x16x32_bf16 v[136:139], v[76:79], a[24:27], v[136:139]
v_fma_f32 v208, v208, v234, v234
v_fma_f32 v210, v210, v234, v234
v_mfma_f32_16x16x32_bf16 v[140:143], v[72:75], a[12:15], 0
ds_read_b128 v[68:71], v7 offset:5120
v_mfma_f32_16x16x32_bf16 v[140:143], v[76:79], a[28:31], v[140:143]
s_waitcnt lgkmcnt(4)
v_mfma_f32_16x16x32_bf16 v[112:115], v[48:51], a[32:35], v[112:115]
v_rcp_f32 v208, v208
v_mfma_f32_16x16x32_bf16 v[112:115], v[52:55], a[48:51], v[112:115]
v_rcp_f32 v210, v210
v_mfma_f32_16x16x32_bf16 v[116:119], v[48:51], a[36:39], v[116:119]
ds_read_b128 v[72:75], v7 offset:6144
v_mul_f32 v209, v209, v208
v_mfma_f32_16x16x32_bf16 v[116:119], v[52:55], a[52:55], v[116:119]
v_mul_f32 v211, v211, v210
v_cvt_pk_bf16_f32 v178, v209, v211
v_mfma_f32_16x16x32_bf16 v[120:123], v[48:51], a[40:43], v[120:123]
v_mul_f32 v212, v82, v82
v_mul_f32 v214, v83, v83
v_mfma_f32_16x16x32_bf16 v[120:123], v[52:55], a[56:59], v[120:123]
v_fma_f32 v212, v212, v233, v232
v_mfma_f32_16x16x32_bf16 v[124:127], v[48:51], a[44:47], v[124:127]
ds_read_b128 v[76:79], v7 offset:7168
v_fma_f32 v214, v214, v233, v232
v_mfma_f32_16x16x32_bf16 v[124:127], v[52:55], a[60:63], v[124:127]
v_mul_f32 v212, v212, v82
s_waitcnt lgkmcnt(4)
v_mfma_f32_16x16x32_bf16 v[128:131], v[56:59], a[32:35], v[128:131]
v_mul_f32 v214, v214, v83
v_mfma_f32_16x16x32_bf16 v[128:131], v[60:63], a[48:51], v[128:131]
v_exp_f32 v212, v212
v_mfma_f32_16x16x32_bf16 v[132:135], v[56:59], a[36:39], v[132:135]
s_waitcnt vmcnt(23)
s_barrier
buffer_load_dword v13, v11, s[8:11], s34 offen sc1
ds_read_b128 v[48:51], v7 offset:8192
v_mfma_f32_16x16x32_bf16 v[132:135], v[60:63], a[52:55], v[132:135]
s_add_u32 m0, s22, 24576
v_mfma_f32_16x16x32_bf16 v[136:139], v[56:59], a[40:43], v[136:139]
v_exp_f32 v214, v214
v_mfma_f32_16x16x32_bf16 v[136:139], v[60:63], a[56:59], v[136:139]
s_add_u32 s23, s21, 368640
v_mul_f32 v213, v82, v98
v_mfma_f32_16x16x32_bf16 v[140:143], v[56:59], a[44:47], v[140:143]
ds_read_b128 v[52:55], v7 offset:9216
v_mul_f32 v215, v83, v99
v_mfma_f32_16x16x32_bf16 v[140:143], v[60:63], a[60:63], v[140:143]
buffer_load_dwordx4 v2, s[8:11], s23 offen offset:0 lds
v_fma_f32 v212, v212, v234, v234
s_waitcnt lgkmcnt(4)
v_mfma_f32_16x16x32_bf16 v[112:115], v[64:67], a[64:67], v[112:115]
v_fma_f32 v214, v214, v234, v234
v_mfma_f32_16x16x32_bf16 v[112:115], v[68:71], a[80:83], v[112:115]
buffer_load_dwordx4 v2, s[8:11], s23 offen offset:1024 lds
v_rcp_f32 v212, v212
v_mfma_f32_16x16x32_bf16 v[116:119], v[64:67], a[68:71], v[116:119]
ds_read_b128 v[56:59], v7 offset:10240
v_rcp_f32 v214, v214
v_mfma_f32_16x16x32_bf16 v[116:119], v[68:71], a[84:87], v[116:119]
buffer_load_dwordx4 v2, s[8:11], s23 offen offset:2048 lds
v_mul_f32 v213, v213, v212
v_mfma_f32_16x16x32_bf16 v[120:123], v[64:67], a[72:75], v[120:123]
v_mul_f32 v215, v215, v214
v_cvt_pk_bf16_f32 v179, v213, v215
v_mfma_f32_16x16x32_bf16 v[120:123], v[68:71], a[88:91], v[120:123]
buffer_load_dwordx4 v2, s[8:11], s23 offen offset:3072 lds
buffer_store_dwordx4 v[176:179], v2, s[8:11], s24 offen offset:2048 sc1
v_mfma_f32_16x16x32_bf16 v[124:127], v[64:67], a[76:79], v[124:127]
ds_read_b128 v[60:63], v7 offset:11264
v_mul_f32 v208, v84, v84
v_mfma_f32_16x16x32_bf16 v[124:127], v[68:71], a[92:95], v[124:127]
s_add_u32 m0, s22, 28672
s_waitcnt lgkmcnt(4)
v_mfma_f32_16x16x32_bf16 v[128:131], v[72:75], a[64:67], v[128:131]
v_mul_f32 v210, v85, v85
v_fma_f32 v208, v208, v236, v235
v_mfma_f32_16x16x32_bf16 v[128:131], v[76:79], a[80:83], v[128:131]
s_add_u32 s23, s21, 372736
v_fma_f32 v210, v210, v236, v235
v_mfma_f32_16x16x32_bf16 v[132:135], v[72:75], a[68:71], v[132:135]
ds_read_b128 v[64:67], v7 offset:12288
v_mul_f32 v208, v208, v84
v_mfma_f32_16x16x32_bf16 v[132:135], v[76:79], a[84:87], v[132:135]
buffer_load_dwordx4 v2, s[8:11], s23 offen offset:0 lds
v_mul_f32 v210, v210, v85
v_mfma_f32_16x16x32_bf16 v[136:139], v[72:75], a[72:75], v[136:139]
v_exp_f32 v208, v208
v_mfma_f32_16x16x32_bf16 v[136:139], v[76:79], a[88:91], v[136:139]
buffer_load_dwordx4 v2, s[8:11], s23 offen offset:1024 lds
v_exp_f32 v210, v210
v_mfma_f32_16x16x32_bf16 v[140:143], v[72:75], a[76:79], v[140:143]
ds_read_b128 v[68:71], v7 offset:13312
v_mul_f32 v209, v84, v100
v_mfma_f32_16x16x32_bf16 v[140:143], v[76:79], a[92:95], v[140:143]
v_mul_f32 v211, v85, v101
s_waitcnt lgkmcnt(4)
v_mfma_f32_16x16x32_bf16 v[112:115], v[48:51], a[96:99], v[112:115]
v_fma_f32 v208, v208, v237, v237
v_fma_f32 v210, v210, v237, v237
v_mfma_f32_16x16x32_bf16 v[112:115], v[52:55], a[112:115], v[112:115]
v_rcp_f32 v208, v208
v_mfma_f32_16x16x32_bf16 v[116:119], v[48:51], a[100:103], v[116:119]
ds_read_b128 v[72:75], v7 offset:14336
v_mfma_f32_16x16x32_bf16 v[116:119], v[52:55], a[116:119], v[116:119]
v_rcp_f32 v210, v210
v_mfma_f32_16x16x32_bf16 v[120:123], v[48:51], a[104:107], v[120:123]
v_mul_f32 v209, v209, v208
v_mul_f32 v211, v211, v210
v_mfma_f32_16x16x32_bf16 v[120:123], v[52:55], a[120:123], v[120:123]
v_cvt_pk_bf16_f32 v182, v209, v211
v_mfma_f32_16x16x32_bf16 v[124:127], v[48:51], a[108:111], v[124:127]
ds_read_b128 v[76:79], v7 offset:15360
v_mul_f32 v212, v86, v86
v_mfma_f32_16x16x32_bf16 v[124:127], v[52:55], a[124:127], v[124:127]
v_mul_f32 v214, v87, v87
s_waitcnt lgkmcnt(4)
v_mfma_f32_16x16x32_bf16 v[128:131], v[56:59], a[96:99], v[128:131]
v_fma_f32 v212, v212, v236, v235
v_fma_f32 v214, v214, v236, v235
v_mfma_f32_16x16x32_bf16 v[128:131], v[60:63], a[112:115], v[128:131]
v_mul_f32 v212, v212, v86
v_mul_f32 v214, v214, v87
v_mfma_f32_16x16x32_bf16 v[132:135], v[56:59], a[100:103], v[132:135]
ds_read_b128 v[48:51], v7 offset:16384
v_mfma_f32_16x16x32_bf16 v[132:135], v[60:63], a[116:119], v[132:135]
v_exp_f32 v212, v212
v_mfma_f32_16x16x32_bf16 v[136:139], v[56:59], a[104:107], v[136:139]
v_mfma_f32_16x16x32_bf16 v[136:139], v[60:63], a[120:123], v[136:139]
v_exp_f32 v214, v214
v_mfma_f32_16x16x32_bf16 v[140:143], v[56:59], a[108:111], v[140:143]
ds_read_b128 v[52:55], v7 offset:17408
v_mul_f32 v213, v86, v102
v_mfma_f32_16x16x32_bf16 v[140:143], v[60:63], a[124:127], v[140:143]
v_mul_f32 v215, v87, v103
s_waitcnt lgkmcnt(4)
v_mfma_f32_16x16x32_bf16 v[112:115], v[64:67], a[128:131], v[112:115]
v_fma_f32 v212, v212, v237, v237
v_fma_f32 v214, v214, v237, v237
v_mfma_f32_16x16x32_bf16 v[112:115], v[68:71], a[144:147], v[112:115]
v_rcp_f32 v212, v212
v_mfma_f32_16x16x32_bf16 v[116:119], v[64:67], a[132:135], v[116:119]
ds_read_b128 v[56:59], v7 offset:18432
v_mfma_f32_16x16x32_bf16 v[116:119], v[68:71], a[148:151], v[116:119]
v_rcp_f32 v214, v214
v_mfma_f32_16x16x32_bf16 v[120:123], v[64:67], a[136:139], v[120:123]
v_mul_f32 v213, v213, v212
v_mfma_f32_16x16x32_bf16 v[120:123], v[68:71], a[152:155], v[120:123]
v_mul_f32 v215, v215, v214
v_cvt_pk_bf16_f32 v183, v213, v215
v_mfma_f32_16x16x32_bf16 v[124:127], v[64:67], a[140:143], v[124:127]
ds_read_b128 v[60:63], v7 offset:19456
buffer_store_dwordx4 v[180:183], v4, s[8:11], s24 offen offset:2048 sc1
v_mfma_f32_16x16x32_bf16 v[124:127], v[68:71], a[156:159], v[124:127]
v_mul_f32 v208, v88, v88
s_waitcnt lgkmcnt(4)
v_mfma_f32_16x16x32_bf16 v[128:131], v[72:75], a[128:131], v[128:131]
v_mul_f32 v210, v89, v89
v_fma_f32 v208, v208, v239, v238
v_mfma_f32_16x16x32_bf16 v[128:131], v[76:79], a[144:147], v[128:131]
v_fma_f32 v210, v210, v239, v238
v_mfma_f32_16x16x32_bf16 v[132:135], v[72:75], a[132:135], v[132:135]
ds_read_b128 v[64:67], v7 offset:20480
v_mul_f32 v208, v208, v88
v_mfma_f32_16x16x32_bf16 v[132:135], v[76:79], a[148:151], v[132:135]
v_mul_f32 v210, v210, v89
v_mfma_f32_16x16x32_bf16 v[136:139], v[72:75], a[136:139], v[136:139]
v_exp_f32 v208, v208
v_mfma_f32_16x16x32_bf16 v[136:139], v[76:79], a[152:155], v[136:139]
v_mfma_f32_16x16x32_bf16 v[140:143], v[72:75], a[140:143], v[140:143]
ds_read_b128 v[68:71], v7 offset:21504
v_mfma_f32_16x16x32_bf16 v[140:143], v[76:79], a[156:159], v[140:143]
v_exp_f32 v210, v210
s_waitcnt lgkmcnt(4)
v_mfma_f32_16x16x32_bf16 v[112:115], v[48:51], a[160:163], v[112:115]
v_mul_f32 v209, v88, v104
v_mul_f32 v211, v89, v105
v_mfma_f32_16x16x32_bf16 v[112:115], v[52:55], a[176:179], v[112:115]
v_fma_f32 v208, v208, v240, v240
v_fma_f32 v210, v210, v240, v240
v_mfma_f32_16x16x32_bf16 v[116:119], v[48:51], a[164:167], v[116:119]
ds_read_b128 v[72:75], v7 offset:22528
v_mfma_f32_16x16x32_bf16 v[116:119], v[52:55], a[180:183], v[116:119]
v_rcp_f32 v208, v208
v_mfma_f32_16x16x32_bf16 v[120:123], v[48:51], a[168:171], v[120:123]
v_rcp_f32 v210, v210
v_mfma_f32_16x16x32_bf16 v[120:123], v[52:55], a[184:187], v[120:123]
v_mul_f32 v209, v209, v208
v_mfma_f32_16x16x32_bf16 v[124:127], v[48:51], a[172:175], v[124:127]
ds_read_b128 v[76:79], v7 offset:23552
v_mul_f32 v211, v211, v210
v_mfma_f32_16x16x32_bf16 v[124:127], v[52:55], a[188:191], v[124:127]
v_cvt_pk_bf16_f32 v186, v209, v211
s_waitcnt lgkmcnt(4)
v_mfma_f32_16x16x32_bf16 v[128:131], v[56:59], a[160:163], v[128:131]
v_mul_f32 v212, v90, v90
v_mul_f32 v214, v91, v91
v_mfma_f32_16x16x32_bf16 v[128:131], v[60:63], a[176:179], v[128:131]
v_fma_f32 v212, v212, v239, v238
v_mfma_f32_16x16x32_bf16 v[132:135], v[56:59], a[164:167], v[132:135]
ds_read_b128 v[48:51], v7 offset:24576
v_fma_f32 v214, v214, v239, v238
v_mfma_f32_16x16x32_bf16 v[132:135], v[60:63], a[180:183], v[132:135]
v_mul_f32 v212, v212, v90
v_mul_f32 v214, v214, v91
v_mfma_f32_16x16x32_bf16 v[136:139], v[56:59], a[168:171], v[136:139]
v_mfma_f32_16x16x32_bf16 v[136:139], v[60:63], a[184:187], v[136:139]
v_exp_f32 v212, v212
v_mfma_f32_16x16x32_bf16 v[140:143], v[56:59], a[172:175], v[140:143]
ds_read_b128 v[52:55], v7 offset:25600
v_mfma_f32_16x16x32_bf16 v[140:143], v[60:63], a[188:191], v[140:143]
s_waitcnt lgkmcnt(4)
v_mfma_f32_16x16x32_bf16 v[112:115], v[64:67], a[192:195], v[112:115]
v_exp_f32 v214, v214
v_mfma_f32_16x16x32_bf16 v[112:115], v[68:71], a[208:211], v[112:115]
v_mul_f32 v213, v90, v106
v_mul_f32 v215, v91, v107
v_mfma_f32_16x16x32_bf16 v[116:119], v[64:67], a[196:199], v[116:119]
ds_read_b128 v[56:59], v7 offset:26624
v_fma_f32 v212, v212, v240, v240
v_mfma_f32_16x16x32_bf16 v[116:119], v[68:71], a[212:215], v[116:119]
v_fma_f32 v214, v214, v240, v240
v_mfma_f32_16x16x32_bf16 v[120:123], v[64:67], a[200:203], v[120:123]
v_rcp_f32 v212, v212
v_mfma_f32_16x16x32_bf16 v[120:123], v[68:71], a[216:219], v[120:123]
v_rcp_f32 v214, v214
v_mfma_f32_16x16x32_bf16 v[124:127], v[64:67], a[204:207], v[124:127]
ds_read_b128 v[60:63], v7 offset:27648
v_mul_f32 v213, v213, v212
v_mfma_f32_16x16x32_bf16 v[124:127], v[68:71], a[220:223], v[124:127]
v_mul_f32 v215, v215, v214
s_waitcnt lgkmcnt(4)
v_mfma_f32_16x16x32_bf16 v[128:131], v[72:75], a[192:195], v[128:131]
v_cvt_pk_bf16_f32 v187, v213, v215
buffer_store_dwordx4 v[184:187], v5, s[8:11], s24 offen offset:2048 sc1
v_mfma_f32_16x16x32_bf16 v[128:131], v[76:79], a[208:211], v[128:131]
v_mul_f32 v208, v92, v92
v_mfma_f32_16x16x32_bf16 v[132:135], v[72:75], a[196:199], v[132:135]
ds_read_b128 v[64:67], v7 offset:28672
v_mul_f32 v210, v93, v93
v_mfma_f32_16x16x32_bf16 v[132:135], v[76:79], a[212:215], v[132:135]
v_fma_f32 v208, v208, v242, v241
v_fma_f32 v210, v210, v242, v241
v_mfma_f32_16x16x32_bf16 v[136:139], v[72:75], a[200:203], v[136:139]
v_mul_f32 v208, v208, v92
v_mfma_f32_16x16x32_bf16 v[136:139], v[76:79], a[216:219], v[136:139]
v_mul_f32 v210, v210, v93
v_mfma_f32_16x16x32_bf16 v[140:143], v[72:75], a[204:207], v[140:143]
ds_read_b128 v[68:71], v7 offset:29696
v_mfma_f32_16x16x32_bf16 v[140:143], v[76:79], a[220:223], v[140:143]
s_waitcnt lgkmcnt(4)
v_mfma_f32_16x16x32_bf16 v[112:115], v[48:51], a[224:227], v[112:115]
v_exp_f32 v208, v208
v_mfma_f32_16x16x32_bf16 v[112:115], v[52:55], a[240:243], v[112:115]
v_exp_f32 v210, v210
v_mfma_f32_16x16x32_bf16 v[116:119], v[48:51], a[228:231], v[116:119]
ds_read_b128 v[72:75], v7 offset:30720
v_mul_f32 v209, v92, v108
v_mfma_f32_16x16x32_bf16 v[116:119], v[52:55], a[244:247], v[116:119]
v_mul_f32 v211, v93, v109
v_fma_f32 v208, v208, v243, v243
v_mfma_f32_16x16x32_bf16 v[120:123], v[48:51], a[232:235], v[120:123]
v_fma_f32 v210, v210, v243, v243
v_mfma_f32_16x16x32_bf16 v[120:123], v[52:55], a[248:251], v[120:123]
v_rcp_f32 v208, v208
v_mfma_f32_16x16x32_bf16 v[124:127], v[48:51], a[236:239], v[124:127]
ds_read_b128 v[76:79], v7 offset:31744
v_mfma_f32_16x16x32_bf16 v[124:127], v[52:55], a[252:255], v[124:127]
s_waitcnt lgkmcnt(4)
v_mfma_f32_16x16x32_bf16 v[128:131], v[56:59], a[224:227], v[128:131]
v_rcp_f32 v210, v210
v_mfma_f32_16x16x32_bf16 v[128:131], v[60:63], a[240:243], v[128:131]
v_mul_f32 v209, v209, v208
v_mul_f32 v211, v211, v210
v_mfma_f32_16x16x32_bf16 v[132:135], v[56:59], a[228:231], v[132:135]
s_waitcnt vmcnt(26)
s_barrier
ds_read_b128 v[48:51], v7 offset:32768
v_mfma_f32_16x16x32_bf16 v[132:135], v[60:63], a[244:247], v[132:135]
s_add_u32 m0, s22, 49152
v_cvt_pk_bf16_f32 v190, v209, v211
v_mul_f32 v212, v94, v94
v_mfma_f32_16x16x32_bf16 v[136:139], v[56:59], a[232:235], v[136:139]
v_mul_f32 v214, v95, v95
v_fma_f32 v212, v212, v242, v241
v_mfma_f32_16x16x32_bf16 v[136:139], v[60:63], a[248:251], v[136:139]
s_add_u32 s23, s21, 393216
v_fma_f32 v214, v214, v242, v241
v_mfma_f32_16x16x32_bf16 v[140:143], v[56:59], a[236:239], v[140:143]
ds_read_b128 v[52:55], v7 offset:33792
v_mul_f32 v212, v212, v94
v_mfma_f32_16x16x32_bf16 v[140:143], v[60:63], a[252:255], v[140:143]
buffer_load_dwordx4 v2, s[8:11], s23 offen offset:0 lds
v_mul_f32 v214, v214, v95
s_waitcnt lgkmcnt(4)
v_mfma_f32_16x16x32_bf16 v[112:115], v[64:67], v[16:19], v[112:115]
v_exp_f32 v212, v212
v_mfma_f32_16x16x32_bf16 v[112:115], v[68:71], v[32:35], v[112:115]
buffer_load_dwordx4 v2, s[8:11], s23 offen offset:1024 lds
v_mfma_f32_16x16x32_bf16 v[116:119], v[64:67], v[20:23], v[116:119]
ds_read_b128 v[56:59], v7 offset:34816
v_exp_f32 v214, v214
v_mfma_f32_16x16x32_bf16 v[116:119], v[68:71], v[36:39], v[116:119]
buffer_load_dwordx4 v2, s[8:11], s23 offen offset:2048 lds
v_mul_f32 v213, v94, v110
v_mfma_f32_16x16x32_bf16 v[120:123], v[64:67], v[24:27], v[120:123]
v_mul_f32 v215, v95, v111
v_fma_f32 v212, v212, v243, v243
v_mfma_f32_16x16x32_bf16 v[120:123], v[68:71], v[40:43], v[120:123]
buffer_load_dwordx4 v2, s[8:11], s23 offen offset:3072 lds
v_fma_f32 v214, v214, v243, v243
v_mfma_f32_16x16x32_bf16 v[124:127], v[64:67], v[28:31], v[124:127]
ds_read_b128 v[60:63], v7 offset:35840
v_mfma_f32_16x16x32_bf16 v[124:127], v[68:71], v[44:47], v[124:127]
s_add_u32 m0, s22, 53248
v_rcp_f32 v212, v212
s_waitcnt lgkmcnt(4)
v_mfma_f32_16x16x32_bf16 v[128:131], v[72:75], v[16:19], v[128:131]
v_rcp_f32 v214, v214
v_mfma_f32_16x16x32_bf16 v[128:131], v[76:79], v[32:35], v[128:131]
s_add_u32 s23, s21, 397312
v_mul_f32 v213, v213, v212
v_mfma_f32_16x16x32_bf16 v[132:135], v[72:75], v[20:23], v[132:135]
ds_read_b128 v[64:67], v7 offset:36864
v_mul_f32 v215, v215, v214
v_mfma_f32_16x16x32_bf16 v[132:135], v[76:79], v[36:39], v[132:135]
buffer_load_dwordx4 v2, s[8:11], s23 offen offset:0 lds
v_cvt_pk_bf16_f32 v191, v213, v215
v_mfma_f32_16x16x32_bf16 v[136:139], v[72:75], v[24:27], v[136:139]
buffer_store_dwordx4 v[188:191], v6, s[8:11], s24 offen offset:2048 sc1
v_mfma_f32_16x16x32_bf16 v[136:139], v[76:79], v[40:43], v[136:139]
buffer_load_dwordx4 v2, s[8:11], s23 offen offset:1024 lds
v_mfma_f32_16x16x32_bf16 v[140:143], v[72:75], v[28:31], v[140:143]
ds_read_b128 v[68:71], v7 offset:37888
v_mfma_f32_16x16x32_bf16 v[140:143], v[76:79], v[44:47], v[140:143]
s_waitcnt vmcnt(16)
v_cmp_le_u32 vcc, 1, v13
s_nop 0
s_cmp_eq_u64 vcc, exec
s_cbranch_scc0 L_f_slow1
L_f_back1:
s_waitcnt lgkmcnt(4)
v_mfma_f32_16x16x32_bf16 v[80:83], v[48:51], a[0:3], 0
v_mfma_f32_16x16x32_bf16 v[80:83], v[52:55], a[16:19], v[80:83]
v_mfma_f32_16x16x32_bf16 v[84:87], v[48:51], a[4:7], 0
ds_read_b128 v[72:75], v7 offset:38912
v_mfma_f32_16x16x32_bf16 v[84:87], v[52:55], a[20:23], v[84:87]
v_mul_f32 v208, v112, v112
v_mfma_f32_16x16x32_bf16 v[88:91], v[48:51], a[8:11], 0
v_mul_f32 v210, v113, v113
v_mfma_f32_16x16x32_bf16 v[88:91], v[52:55], a[24:27], v[88:91]
v_fma_f32 v208, v208, v233, v232
v_fma_f32 v210, v210, v233, v232
v_mfma_f32_16x16x32_bf16 v[92:95], v[48:51], a[12:15], 0
ds_read_b128 v[76:79], v7 offset:39936
v_mul_f32 v208, v208, v112
v_mfma_f32_16x16x32_bf16 v[92:95], v[52:55], a[28:31], v[92:95]
v_mul_f32 v210, v210, v113
s_waitcnt lgkmcnt(4)
v_mfma_f32_16x16x32_bf16 v[96:99], v[56:59], a[0:3], 0
v_mfma_f32_16x16x32_bf16 v[96:99], v[60:63], a[16:19], v[96:99]
v_exp_f32 v208, v208
v_mfma_f32_16x16x32_bf16 v[100:103], v[56:59], a[4:7], 0
ds_read_b128 v[48:51], v7 offset:40960
v_mfma_f32_16x16x32_bf16 v[100:103], v[60:63], a[20:23], v[100:103]
v_exp_f32 v210, v210
v_mfma_f32_16x16x32_bf16 v[104:107], v[56:59], a[8:11], 0
v_mul_f32 v209, v112, v128
v_mul_f32 v211, v113, v129
v_mfma_f32_16x16x32_bf16 v[104:107], v[60:63], a[24:27], v[104:107]
v_fma_f32 v208, v208, v234, v234
v_fma_f32 v210, v210, v234, v234
v_mfma_f32_16x16x32_bf16 v[108:111], v[56:59], a[12:15], 0
ds_read_b128 v[52:55], v7 offset:41984
v_mfma_f32_16x16x32_bf16 v[108:111], v[60:63], a[28:31], v[108:111]
s_waitcnt lgkmcnt(4)
v_mfma_f32_16x16x32_bf16 v[80:83], v[64:67], a[32:35], v[80:83]
v_rcp_f32 v208, v208
v_mfma_f32_16x16x32_bf16 v[80:83], v[68:71], a[48:51], v[80:83]
buffer_load_dwordx4 a[0:3], v2, s[8:11], s25 offen offset:0 sc1
v_mfma_f32_16x16x32_bf16 v[84:87], v[64:67], a[36:39], v[84:87]
ds_read_b128 v[56:59], v7 offset:43008
v_rcp_f32 v210, v210
v_mfma_f32_16x16x32_bf16 v[84:87], v[68:71], a[52:55], v[84:87]
buffer_load_dwordx4 a[4:7], v4, s[8:11], s25 offen offset:0 sc1
v_mul_f32 v209, v209, v208
v_mfma_f32_16x16x32_bf16 v[88:91], v[64:67], a[40:43], v[88:91]
v_mul_f32 v211, v211, v210
v_cvt_pk_bf16_f32 v192, v209, v211
v_mfma_f32_16x16x32_bf16 v[88:91], v[68:71], a[56:59], v[88:91]
buffer_load_dwordx4 a[8:11], v5, s[8:11], s25 offen offset:0 sc1
v_mul_f32 v212, v114, v114
v_mfma_f32_16x16x32_bf16 v[92:95], v[64:67], a[44:47], v[92:95]
ds_read_b128 v[60:63], v7 offset:44032
v_mul_f32 v214, v115, v115
v_mfma_f32_16x16x32_bf16 v[92:95], v[68:71], a[60:63], v[92:95]
buffer_load_dwordx4 a[12:15], v6, s[8:11], s25 offen offset:0 sc1
s_waitcnt lgkmcnt(4)
v_mfma_f32_16x16x32_bf16 v[96:99], v[72:75], a[32:35], v[96:99]
v_fma_f32 v212, v212, v233, v232
v_fma_f32 v214, v214, v233, v232
v_mfma_f32_16x16x32_bf16 v[96:99], v[76:79], a[48:51], v[96:99]
buffer_load_dwordx4 a[16:19], v2, s[8:11], s26 offen offset:0 sc1
v_mul_f32 v212, v212, v114
v_mfma_f32_16x16x32_bf16 v[100:103], v[72:75], a[36:39], v[100:103]
ds_read_b128 v[64:67], v7 offset:45056
v_mul_f32 v214, v214, v115
v_mfma_f32_16x16x32_bf16 v[100:103], v[76:79], a[52:55], v[100:103]
buffer_load_dwordx4 a[20:23], v4, s[8:11], s26 offen offset:0 sc1
v_exp_f32 v212, v212
v_mfma_f32_16x16x32_bf16 v[104:107], v[72:75], a[40:43], v[104:107]
v_exp_f32 v214, v214
v_mfma_f32_16x16x32_bf16 v[104:107], v[76:79], a[56:59], v[104:107]
buffer_load_dwordx4 a[24:27], v5, s[8:11], s26 offen offset:0 sc1
v_mul_f32 v213, v114, v130
v_mfma_f32_16x16x32_bf16 v[108:111], v[72:75], a[44:47], v[108:111]
ds_read_b128 v[68:71], v7 offset:46080
v_mul_f32 v215, v115, v131
v_mfma_f32_16x16x32_bf16 v[108:111], v[76:79], a[60:63], v[108:111]
buffer_load_dwordx4 a[28:31], v6, s[8:11], s26 offen offset:0 sc1
s_waitcnt lgkmcnt(4)
v_mfma_f32_16x16x32_bf16 v[80:83], v[48:51], a[64:67], v[80:83]
v_fma_f32 v212, v212, v234, v234
v_fma_f32 v214, v214, v234, v234
v_mfma_f32_16x16x32_bf16 v[80:83], v[52:55], a[80:83], v[80:83]
buffer_load_dwordx4 a[32:35], v2, s[8:11], s27 offen offset:0 sc1
v_rcp_f32 v212, v212
v_mfma_f32_16x16x32_bf16 v[84:87], v[48:51], a[68:71], v[84:87]
ds_read_b128 v[72:75], v7 offset:47104
v_mfma_f32_16x16x32_bf16 v[84:87], v[52:55], a[84:87], v[84:87]
buffer_load_dwordx4 a[36:39], v4, s[8:11], s27 offen offset:0 sc1
v_rcp_f32 v214, v214
v_mfma_f32_16x16x32_bf16 v[88:91], v[48:51], a[72:75], v[88:91]
v_mul_f32 v213, v213, v212
v_mul_f32 v215, v215, v214
v_mfma_f32_16x16x32_bf16 v[88:91], v[52:55], a[88:91], v[88:91]
buffer_load_dwordx4 a[40:43], v5, s[8:11], s27 offen offset:0 sc1
v_cvt_pk_bf16_f32 v193, v213, v215
v_mfma_f32_16x16x32_bf16 v[92:95], v[48:51], a[76:79], v[92:95]
ds_read_b128 v[76:79], v7 offset:48128
v_mul_f32 v208, v116, v116
v_mfma_f32_16x16x32_bf16 v[92:95], v[52:55], a[92:95], v[92:95]
buffer_load_dwordx4 a[44:47], v6, s[8:11], s27 offen offset:0 sc1
s_waitcnt lgkmcnt(4)
v_mfma_f32_16x16x32_bf16 v[96:99], v[56:59], a[64:67], v[96:99]
v_mul_f32 v210, v117, v117
v_fma_f32 v208, v208, v236, v235
v_mfma_f32_16x16x32_bf16 v[96:99], v[60:63], a[80:83], v[96:99]
buffer_load_dwordx4 a[48:51], v2, s[8:11], s25 offen offset:1024 sc1
v_fma_f32 v210, v210, v236, v235
v_mfma_f32_16x16x32_bf16 v[100:103], v[56:59], a[68:71], v[100:103]
ds_read_b128 v[48:51], v7 offset:49152
v_mul_f32 v208, v208, v116
v_mfma_f32_16x16x32_bf16 v[100:103], v[60:63], a[84:87], v[100:103]
buffer_load_dwordx4 a[52:55], v4, s[8:11], s25 offen offset:1024 sc1
v_mul_f32 v210, v210, v117
v_mfma_f32_16x16x32_bf16 v[104:107], v[56:59], a[72:75], v[104:107]
v_exp_f32 v208, v208
v_mfma_f32_16x16x32_bf16 v[104:107], v[60:63], a[88:91], v[104:107]
buffer_load_dwordx4 a[56:59], v5, s[8:11], s25 offen offset:1024 sc1
v_exp_f32 v210, v210
v_mfma_f32_16x16x32_bf16 v[108:111], v[56:59], a[76:79], v[108:111]
ds_read_b128 v[52:55], v7 offset:50176
v_mul_f32 v209, v116, v132
v_mfma_f32_16x16x32_bf16 v[108:111], v[60:63], a[92:95], v[108:111]
buffer_load_dwordx4 a[60:63], v6, s[8:11], s25 offen offset:1024 sc1
s_waitcnt lgkmcnt(4)
v_mfma_f32_16x16x32_bf16 v[80:83], v[64:67], a[96:99], v[80:83]
v_mul_f32 v211, v117, v133
v_fma_f32 v208, v208, v237, v237
v_mfma_f32_16x16x32_bf16 v[80:83], v[68:71], a[112:115], v[80:83]
buffer_load_dwordx4 a[64:67], v2, s[8:11], s26 offen offset:1024 sc1
v_fma_f32 v210, v210, v237, v237
v_mfma_f32_16x16x32_bf16 v[84:87], v[64:67], a[100:103], v[84:87]
ds_read_b128 v[56:59], v7 offset:51200
v_rcp_f32 v208, v208
v_mfma_f32_16x16x32_bf16 v[84:87], v[68:71], a[116:119], v[84:87]
buffer_load_dwordx4 a[68:71], v4, s[8:11], s26 offen offset:1024 sc1
v_mfma_f32_16x16x32_bf16 v[88:91], v[64:67], a[104:107], v[88:91]
v_rcp_f32 v210, v210
v_mfma_f32_16x16x32_bf16 v[88:91], v[68:71], a[120:123], v[88:91]
buffer_load_dwordx4 a[72:75], v5, s[8:11], s26 offen offset:1024 sc1
v_mul_f32 v209, v209, v208
v_mfma_f32_16x16x32_bf16 v[92:95], v[64:67], a[108:111], v[92:95]
ds_read_b128 v[60:63], v7 offset:52224
v_mul_f32 v211, v211, v210
v_mfma_f32_16x16x32_bf16 v[92:95], v[68:71], a[124:127], v[92:95]
buffer_load_dwordx4 a[76:79], v6, s[8:11], s26 offen offset:1024 sc1
v_cvt_pk_bf16_f32 v196, v209, v211
s_waitcnt lgkmcnt(4)
v_mfma_f32_16x16x32_bf16 v[96:99], v[72:75], a[96:99], v[96:99]
v_mul_f32 v212, v118, v118
v_mul_f32 v214, v119, v119
v_mfma_f32_16x16x32_bf16 v[96:99], v[76:79], a[112:115], v[96:99]
buffer_load_dwordx4 a[80:83], v2, s[8:11], s27 offen offset:1024 sc1
v_fma_f32 v212, v212, v236, v235
v_mfma_f32_16x16x32_bf16 v[100:103], v[72:75], a[100:103], v[100:103]
ds_read_b128 v[64:67], v7 offset:53248
v_fma_f32 v214, v214, v236, v235
v_mfma_f32_16x16x32_bf16 v[100:103], v[76:79], a[116:119], v[100:103]
buffer_load_dwordx4 a[84:87], v4, s[8:11], s27 offen offset:1024 sc1
v_mul_f32 v212, v212, v118
v_mfma_f32_16x16x32_bf16 v[104:107], v[72:75], a[104:107], v[104:107]
v_mul_f32 v214, v214, v119
v_mfma_f32_16x16x32_bf16 v[104:107], v[76:79], a[120:123], v[104:107]
buffer_load_dwordx4 a[88:91], v5, s[8:11], s27 offen offset:1024 sc1
v_exp_f32 v212, v212
v_mfma_f32_16x16x32_bf16 v[108:111], v[72:75], a[108:111], v[108:111]
ds_read_b128 v[68:71], v7 offset:54272
v_exp_f32 v214, v214
v_mfma_f32_16x16x32_bf16 v[108:111], v[76:79], a[124:127], v[108:111]
buffer_load_dwordx4 a[92:95], v6, s[8:11], s27 offen offset:1024 sc1
s_waitcnt lgkmcnt(4)
v_mfma_f32_16x16x32_bf16 v[80:83], v[48:51], a[128:131], v[80:83]
v_mul_f32 v213, v118, v134
v_mul_f32 v215, v119, v135
v_mfma_f32_16x16x32_bf16 v[80:83], v[52:55], a[144:147], v[80:83]
buffer_load_dwordx4 a[96:99], v2, s[8:11], s28 offen offset:0 sc1
v_fma_f32 v212, v212, v237, v237
v_mfma_f32_16x16x32_bf16 v[84:87], v[48:51], a[132:135], v[84:87]
ds_read_b128 v[72:75], v7 offset:55296
v_fma_f32 v214, v214, v237, v237
v_mfma_f32_16x16x32_bf16 v[84:87], v[52:55], a[148:151], v[84:87]
buffer_load_dwordx4 a[100:103], v4, s[8:11], s28 offen offset:0 sc1
v_rcp_f32 v212, v212
v_mfma_f32_16x16x32_bf16 v[88:91], v[48:51], a[136:139], v[88:91]
v_rcp_f32 v214, v214
v_mfma_f32_16x16x32_bf16 v[88:91], v[52:55], a[152:155], v[88:91]
buffer_load_dwordx4 a[104:107], v5, s[8:11], s28 offen offset:0 sc1
v_mul_f32 v213, v213, v212
v_mfma_f32_16x16x32_bf16 v[92:95], v[48:51], a[140:143], v[92:95]
ds_read_b128 v[76:79], v7 offset:56320
v_mul_f32 v215, v215, v214
v_mfma_f32_16x16x32_bf16 v[92:95], v[52:55], a[156:159], v[92:95]
buffer_load_dwordx4 a[108:111], v6, s[8:11], s28 offen offset:0 sc1
s_waitcnt lgkmcnt(4)
v_mfma_f32_16x16x32_bf16 v[96:99], v[56:59], a[128:131], v[96:99]
v_cvt_pk_bf16_f32 v197, v213, v215
v_mul_f32 v208, v120, v120
v_mfma_f32_16x16x32_bf16 v[96:99], v[60:63], a[144:147], v[96:99]
v_mul_f32 v210, v121, v121
v_fma_f32 v208, v208, v239, v238
v_mfma_f32_16x16x32_bf16 v[100:103], v[56:59], a[132:135], v[100:103]
s_waitcnt vmcnt(0)
s_barrier
v_mov_b32 v12, 2
buffer_store_dword v12, v10, s[8:11], s34 offen sc1
ds_read_b128 v[48:51], v7 offset:57344
v_mfma_f32_16x16x32_bf16 v[100:103], v[60:63], a[148:151], v[100:103]
s_add_u32 m0, s22, 73728
v_fma_f32 v210, v210, v239, v238
v_mfma_f32_16x16x32_bf16 v[104:107], v[56:59], a[136:139], v[104:107]
v_mul_f32 v208, v208, v120
v_mul_f32 v210, v210, v121
v_mfma_f32_16x16x32_bf16 v[104:107], v[60:63], a[152:155], v[104:107]
s_add_u32 s23, s21, 417792
v_mfma_f32_16x16x32_bf16 v[108:111], v[56:59], a[140:143], v[108:111]
ds_read_b128 v[52:55], v7 offset:58368
v_exp_f32 v208, v208
v_mfma_f32_16x16x32_bf16 v[108:111], v[60:63], a[156:159], v[108:111]
buffer_load_dwordx4 v2, s[8:11], s23 offen offset:0 lds
v_exp_f32 v210, v210
s_waitcnt lgkmcnt(4)
v_mfma_f32_16x16x32_bf16 v[80:83], v[64:67], a[160:163], v[80:83]
v_mul_f32 v209, v120, v136
v_mul_f32 v211, v121, v137
v_mfma_f32_16x16x32_bf16 v[80:83], v[68:71], a[176:179], v[80:83]
buffer_load_dwordx4 v2, s[8:11], s23 offen offset:1024 lds
v_fma_f32 v208, v208, v240, v240
v_mfma_f32_16x16x32_bf16 v[84:87], v[64:67], a[164:167], v[84:87]
ds_read_b128 v[56:59], v7 offset:59392
v_fma_f32 v210, v210, v240, v240
v_mfma_f32_16x16x32_bf16 v[84:87], v[68:71], a[180:183], v[84:87]
buffer_load_dwordx4 v2, s[8:11], s23 offen offset:2048 lds
v_mfma_f32_16x16x32_bf16 v[88:91], v[64:67], a[168:171], v[88:91]
v_rcp_f32 v208, v208
v_mfma_f32_16x16x32_bf16 v[88:91], v[68:71], a[184:187], v[88:91]
buffer_load_dwordx4 v2, s[8:11], s23 offen offset:3072 lds
v_mfma_f32_16x16x32_bf16 v[92:95], v[64:67], a[172:175], v[92:95]
ds_read_b128 v[60:63], v7 offset:60416
v_rcp_f32 v210, v210
v_mfma_f32_16x16x32_bf16 v[92:95], v[68:71], a[188:191], v[92:95]
s_add_u32 m0, s22, 77824
v_mul_f32 v209, v209, v208
s_waitcnt lgkmcnt(4)
v_mfma_f32_16x16x32_bf16 v[96:99], v[72:75], a[160:163], v[96:99]
v_mul_f32 v211, v211, v210
v_cvt_pk_bf16_f32 v200, v209, v211
v_mfma_f32_16x16x32_bf16 v[96:99], v[76:79], a[176:179], v[96:99]
s_add_u32 s23, s21, 421888
v_mul_f32 v212, v122, v122
v_mfma_f32_16x16x32_bf16 v[100:103], v[72:75], a[164:167], v[100:103]
ds_read_b128 v[64:67], v7 offset:61440
v_mul_f32 v214, v123, v123
v_mfma_f32_16x16x32_bf16 v[100:103], v[76:79], a[180:183], v[100:103]
buffer_load_dwordx4 v2, s[8:11], s23 offen offset:0 lds
v_fma_f32 v212, v212, v239, v238
v_mfma_f32_16x16x32_bf16 v[104:107], v[72:75], a[168:171], v[104:107]
v_fma_f32 v214, v214, v239, v238
v_mul_f32 v212, v212, v122
v_mfma_f32_16x16x32_bf16 v[104:107], v[76:79], a[184:187], v[104:107]
buffer_load_dwordx4 v2, s[8:11], s23 offen offset:1024 lds
v_mul_f32 v214, v214, v123
v_mfma_f32_16x16x32_bf16 v[108:111], v[72:75], a[172:175], v[108:111]
ds_read_b128 v[68:71], v7 offset:62464
v_mfma_f32_16x16x32_bf16 v[108:111], v[76:79], a[188:191], v[108:111]
v_exp_f32 v212, v212
s_waitcnt lgkmcnt(4)
v_mfma_f32_16x16x32_bf16 v[80:83], v[48:51], a[192:195], v[80:83]
v_exp_f32 v214, v214
v_mfma_f32_16x16x32_bf16 v[80:83], v[52:55], a[208:211], v[80:83]
v_mul_f32 v213, v122, v138
v_mul_f32 v215, v123, v139
v_mfma_f32_16x16x32_bf16 v[84:87], v[48:51], a[196:199], v[84:87]
ds_read_b128 v[72:75], v7 offset:63488
v_fma_f32 v212, v212, v240, v240
v_mfma_f32_16x16x32_bf16 v[84:87], v[52:55], a[212:215], v[84:87]
v_fma_f32 v214, v214, v240, v240
v_mfma_f32_16x16x32_bf16 v[88:91], v[48:51], a[200:203], v[88:91]
v_rcp_f32 v212, v212
v_mfma_f32_16x16x32_bf16 v[88:91], v[52:55], a[216:219], v[88:91]
v_mfma_f32_16x16x32_bf16 v[92:95], v[48:51], a[204:207], v[92:95]
ds_read_b128 v[76:79], v7 offset:64512
v_mfma_f32_16x16x32_bf16 v[92:95], v[52:55], a[220:223], v[92:95]
v_rcp_f32 v214, v214
s_waitcnt lgkmcnt(4)
v_mfma_f32_16x16x32_bf16 v[96:99], v[56:59], a[192:195], v[96:99]
v_mul_f32 v213, v213, v212
v_mul_f32 v215, v215, v214
v_mfma_f32_16x16x32_bf16 v[96:99], v[60:63], a[208:211], v[96:99]
v_cvt_pk_bf16_f32 v201, v213, v215
v_mul_f32 v208, v124, v124
v_mfma_f32_16x16x32_bf16 v[100:103], v[56:59], a[196:199], v[100:103]
ds_read_b128 v[48:51], v8 offset:0
v_mul_f32 v210, v125, v125
v_mfma_f32_16x16x32_bf16 v[100:103], v[60:63], a[212:215], v[100:103]
v_fma_f32 v208, v208, v242, v241
v_fma_f32 v210, v210, v242, v241
v_mfma_f32_16x16x32_bf16 v[104:107], v[56:59], a[200:203], v[104:107]
v_mul_f32 v208, v208, v124
v_mfma_f32_16x16x32_bf16 v[104:107], v[60:63], a[216:219], v[104:107]
v_mul_f32 v210, v210, v125
v_mfma_f32_16x16x32_bf16 v[108:111], v[56:59], a[204:207], v[108:111]
ds_read_b128 v[52:55], v8 offset:1024
v_mfma_f32_16x16x32_bf16 v[108:111], v[60:63], a[220:223], v[108:111]
s_waitcnt lgkmcnt(4)
v_mfma_f32_16x16x32_bf16 v[80:83], v[64:67], a[224:227], v[80:83]
v_exp_f32 v208, v208
v_mfma_f32_16x16x32_bf16 v[80:83], v[68:71], a[240:243], v[80:83]
v_exp_f32 v210, v210
v_mfma_f32_16x16x32_bf16 v[84:87], v[64:67], a[228:231], v[84:87]
ds_read_b128 v[56:59], v8 offset:2048
v_mul_f32 v209, v124, v140
v_mfma_f32_16x16x32_bf16 v[84:87], v[68:71], a[244:247], v[84:87]
v_mul_f32 v211, v125, v141
v_fma_f32 v208, v208, v243, v243
v_mfma_f32_16x16x32_bf16 v[88:91], v[64:67], a[232:235], v[88:91]
v_fma_f32 v210, v210, v243, v243
v_mfma_f32_16x16x32_bf16 v[88:91], v[68:71], a[248:251], v[88:91]
v_rcp_f32 v208, v208
v_mfma_f32_16x16x32_bf16 v[92:95], v[64:67], a[236:239], v[92:95]
ds_read_b128 v[60:63], v8 offset:3072
v_mfma_f32_16x16x32_bf16 v[92:95], v[68:71], a[252:255], v[92:95]
s_waitcnt lgkmcnt(4)
v_mfma_f32_16x16x32_bf16 v[96:99], v[72:75], a[224:227], v[96:99]
v_rcp_f32 v210, v210
v_mfma_f32_16x16x32_bf16 v[96:99], v[76:79], a[240:243], v[96:99]
v_mul_f32 v209, v209, v208
v_mul_f32 v211, v211, v210
v_mfma_f32_16x16x32_bf16 v[100:103], v[72:75], a[228:231], v[100:103]
ds_read_b128 v[64:67], v8 offset:4096
v_cvt_pk_bf16_f32 v204, v209, v211
v_mfma_f32_16x16x32_bf16 v[100:103], v[76:79], a[244:247], v[100:103]
v_mul_f32 v212, v126, v126
v_mul_f32 v214, v127, v127
v_mfma_f32_16x16x32_bf16 v[104:107], v[72:75], a[232:235], v[104:107]
v_fma_f32 v212, v212, v242, v241
v_fma_f32 v214, v214, v242, v241
v_mfma_f32_16x16x32_bf16 v[104:107], v[76:79], a[248:251], v[104:107]
v_mul_f32 v212, v212, v126
v_mfma_f32_16x16x32_bf16 v[108:111], v[72:75], a[236:239], v[108:111]
ds_read_b128 v[68:71], v8 offset:5120
v_mul_f32 v214, v214, v127
v_mfma_f32_16x16x32_bf16 v[108:111], v[76:79], a[252:255], v[108:111]
s_waitcnt lgkmcnt(4)
v_mfma_f32_16x16x32_bf16 v[80:83], v[48:51], v[16:19], v[80:83]
v_exp_f32 v212, v212
v_mfma_f32_16x16x32_bf16 v[80:83], v[52:55], v[32:35], v[80:83]
v_exp_f32 v214, v214
v_mfma_f32_16x16x32_bf16 v[84:87], v[48:51], v[20:23], v[84:87]
ds_read_b128 v[72:75], v8 offset:6144
v_mul_f32 v213, v126, v142
v_mfma_f32_16x16x32_bf16 v[84:87], v[52:55], v[36:39], v[84:87]
v_mul_f32 v215, v127, v143
v_mfma_f32_16x16x32_bf16 v[88:91], v[48:51], v[24:27], v[88:91]
v_fma_f32 v212, v212, v243, v243
v_fma_f32 v214, v214, v243, v243
v_mfma_f32_16x16x32_bf16 v[88:91], v[52:55], v[40:43], v[88:91]
v_mfma_f32_16x16x32_bf16 v[92:95], v[48:51], v[28:31], v[92:95]
ds_read_b128 v[76:79], v8 offset:7168
v_mfma_f32_16x16x32_bf16 v[92:95], v[52:55], v[44:47], v[92:95]
v_rcp_f32 v212, v212
s_waitcnt lgkmcnt(4)
v_mfma_f32_16x16x32_bf16 v[96:99], v[56:59], v[16:19], v[96:99]
v_rcp_f32 v214, v214
v_mfma_f32_16x16x32_bf16 v[96:99], v[60:63], v[32:35], v[96:99]
v_mul_f32 v213, v213, v212
v_mul_f32 v215, v215, v214
v_mfma_f32_16x16x32_bf16 v[100:103], v[56:59], v[20:23], v[100:103]
ds_read_b128 v[48:51], v8 offset:8192
v_cvt_pk_bf16_f32 v205, v213, v215
v_mfma_f32_16x16x32_bf16 v[100:103], v[60:63], v[36:39], v[100:103]
v_mfma_f32_16x16x32_bf16 v[104:107], v[56:59], v[24:27], v[104:107]
v_mfma_f32_16x16x32_bf16 v[104:107], v[60:63], v[40:43], v[104:107]
v_mfma_f32_16x16x32_bf16 v[108:111], v[56:59], v[28:31], v[108:111]
ds_read_b128 v[52:55], v8 offset:9216
v_mfma_f32_16x16x32_bf16 v[108:111], v[60:63], v[44:47], v[108:111]
s_waitcnt lgkmcnt(4)
v_mfma_f32_16x16x32_bf16 a[112:115], v[64:67], v[144:147], 0
v_mfma_f32_16x16x32_bf16 a[112:115], v[68:71], v[160:163], a[112:115]
buffer_load_dwordx4 v[16:19], v2, s[8:11], s29 offen offset:0 sc1
v_mfma_f32_16x16x32_bf16 a[116:119], v[64:67], v[148:151], 0
ds_read_b128 v[56:59], v8 offset:10240
v_mfma_f32_16x16x32_bf16 a[116:119], v[68:71], v[164:167], a[116:119]
buffer_load_dwordx4 v[20:23], v4, s[8:11], s29 offen offset:0 sc1
v_mul_f32 v208, v80, v80
v_mfma_f32_16x16x32_bf16 a[120:123], v[64:67], v[152:155], 0
v_mul_f32 v210, v81, v81
v_fma_f32 v208, v208, v233, v232
v_mfma_f32_16x16x32_bf16 a[120:123], v[68:71], v[168:171], a[120:123]
buffer_load_dwordx4 v[24:27], v5, s[8:11], s29 offen offset:0 sc1
v_fma_f32 v210, v210, v233, v232
v_mfma_f32_16x16x32_bf16 a[124:127], v[64:67], v[156:159], 0
ds_read_b128 v[60:63], v8 offset:11264
v_mul_f32 v208, v208, v80
v_mfma_f32_16x16x32_bf16 a[124:127], v[68:71], v[172:175], a[124:127]
buffer_load_dwordx4 v[28:31], v6, s[8:11], s29 offen offset:0 sc1
v_mul_f32 v210, v210, v81
v_exp_f32 v208, v208
s_waitcnt lgkmcnt(4)
v_mfma_f32_16x16x32_bf16 a[128:131], v[72:75], v[144:147], 0
v_exp_f32 v210, v210
v_mfma_f32_16x16x32_bf16 a[128:131], v[76:79], v[160:163], a[128:131]
v_mul_f32 v209, v80, v96
v_mul_f32 v211, v81, v97
v_mfma_f32_16x16x32_bf16 a[132:135], v[72:75], v[148:151], 0
ds_read_b128 v[64:67], v8 offset:12288
v_fma_f32 v208, v208, v234, v234
v_mfma_f32_16x16x32_bf16 a[132:135], v[76:79], v[164:167], a[132:135]
v_fma_f32 v210, v210, v234, v234
v_rcp_f32 v208, v208
v_mfma_f32_16x16x32_bf16 a[136:139], v[72:75], v[152:155], 0
v_rcp_f32 v210, v210
v_mfma_f32_16x16x32_bf16 a[136:139], v[76:79], v[168:171], a[136:139]
v_mul_f32 v209, v209, v208
v_mul_f32 v211, v211, v210
v_mfma_f32_16x16x32_bf16 a[140:143], v[72:75], v[156:159], 0
ds_read_b128 v[68:71], v8 offset:13312
v_cvt_pk_bf16_f32 v194, v209, v211
v_mfma_f32_16x16x32_bf16 a[140:143], v[76:79], v[172:175], a[140:143]
v_mul_f32 v212, v82, v82
v_mul_f32 v214, v83, v83
s_waitcnt lgkmcnt(4)
v_mfma_f32_16x16x32_bf16 a[144:147], v[48:51], v[144:147], 0
v_fma_f32 v212, v212, v233, v232
v_fma_f32 v214, v214, v233, v232
v_mfma_f32_16x16x32_bf16 a[144:147], v[52:55], v[160:163], a[144:147]
v_mul_f32 v212, v212, v82
v_mul_f32 v214, v214, v83
v_mfma_f32_16x16x32_bf16 a[148:151], v[48:51], v[148:151], 0
ds_read_b128 v[72:75], v8 offset:14336
v_exp_f32 v212, v212
v_mfma_f32_16x16x32_bf16 a[148:151], v[52:55], v[164:167], a[148:151]
v_exp_f32 v214, v214
v_mfma_f32_16x16x32_bf16 a[152:155], v[48:51], v[152:155], 0
v_mul_f32 v213, v82, v98
v_mul_f32 v215, v83, v99
v_mfma_f32_16x16x32_bf16 a[152:155], v[52:55], v[168:171], a[152:155]
v_fma_f32 v212, v212, v234, v234
v_fma_f32 v214, v214, v234, v234
v_mfma_f32_16x16x32_bf16 a[156:159], v[48:51], v[156:159], 0
ds_read_b128 v[76:79], v8 offset:15360
v_rcp_f32 v212, v212
v_mfma_f32_16x16x32_bf16 a[156:159], v[52:55], v[172:175], a[156:159]
v_rcp_f32 v214, v214
s_waitcnt lgkmcnt(4)
v_mfma_f32_16x16x32_bf16 a[160:163], v[56:59], v[144:147], 0
v_mul_f32 v213, v213, v212
v_mul_f32 v215, v215, v214
v_mfma_f32_16x16x32_bf16 a[160:163], v[60:63], v[160:163], a[160:163]
v_cvt_pk_bf16_f32 v195, v213, v215
buffer_store_dwordx4 v[192:195], v2, s[8:11], s24 offen offset:3072 sc1
v_mfma_f32_16x16x32_bf16 a[164:167], v[56:59], v[148:151], 0
s_waitcnt vmcnt(57)
s_barrier
ds_read_b128 v[48:51], v2 offset:0
v_mul_f32 v208, v84, v84
v_mfma_f32_16x16x32_bf16 a[164:167], v[60:63], v[164:167], a[164:167]
s_add_u32 m0, s22, 98304
v_mul_f32 v210, v85, v85
v_fma_f32 v208, v208, v236, v235
v_mfma_f32_16x16x32_bf16 a[168:171], v[56:59], v[152:155], 0
v_fma_f32 v210, v210, v236, v235
v_mul_f32 v208, v208, v84
v_mfma_f32_16x16x32_bf16 a[168:171], v[60:63], v[168:171], a[168:171]
s_add_u32 s23, s21, 442368
v_mul_f32 v210, v210, v85
v_exp_f32 v208, v208
v_mfma_f32_16x16x32_bf16 a[172:175], v[56:59], v[156:159], 0
ds_read_b128 v[52:55], v2 offset:1024
v_exp_f32 v210, v210
v_mfma_f32_16x16x32_bf16 a[172:175], v[60:63], v[172:175], a[172:175]
buffer_load_dwordx4 v2, s[8:11], s23 offen offset:0 lds
v_mul_f32 v209, v84, v100
s_waitcnt lgkmcnt(4)
v_mfma_f32_16x16x32_bf16 a[176:179], v[64:67], v[144:147], 0
v_mul_f32 v211, v85, v101
v_fma_f32 v208, v208, v237, v237
v_mfma_f32_16x16x32_bf16 a[176:179], v[68:71], v[160:163], a[176:179]
buffer_load_dwordx4 v2, s[8:11], s23 offen offset:1024 lds
v_fma_f32 v210, v210, v237, v237
v_rcp_f32 v208, v208
v_mfma_f32_16x16x32_bf16 a[180:183], v[64:67], v[148:151], 0
ds_read_b128 v[56:59], v2 offset:2048
v_rcp_f32 v210, v210
v_mfma_f32_16x16x32_bf16 a[180:183], v[68:71], v[164:167], a[180:183]
buffer_load_dwordx4 v2, s[8:11], s23 offen offset:2048 lds
v_mul_f32 v209, v209, v208
v_mfma_f32_16x16x32_bf16 a[184:187], v[64:67], v[152:155], 0
v_mul_f32 v211, v211, v210
v_cvt_pk_bf16_f32 v198, v209, v211
v_mfma_f32_16x16x32_bf16 a[184:187], v[68:71], v[168:171], a[184:187]
buffer_load_dwordx4 v2, s[8:11], s23 offen offset:3072 lds
v_mul_f32 v212, v86, v86
v_mul_f32 v214, v87, v87
v_mfma_f32_16x16x32_bf16 a[188:191], v[64:67], v[156:159], 0
ds_read_b128 v[60:63], v2 offset:3072
v_fma_f32 v212, v212, v236, v235
v_fma_f32 v214, v214, v236, v235
v_mfma_f32_16x16x32_bf16 a[188:191], v[68:71], v[172:175], a[188:191]
s_add_u32 m0, s22, 102400
v_mul_f32 v212, v212, v86
v_mul_f32 v214, v214, v87
s_waitcnt lgkmcnt(4)
v_mfma_f32_16x16x32_bf16 a[192:195], v[72:75], v[144:147], 0
v_exp_f32 v212, v212
v_mfma_f32_16x16x32_bf16 a[192:195], v[76:79], v[160:163], a[192:195]
s_add_u32 s23, s21, 446464
v_exp_f32 v214, v214
v_mfma_f32_16x16x32_bf16 a[196:199], v[72:75], v[148:151], 0
ds_read_b128 v[64:67], v2 offset:4096
v_mul_f32 v213, v86, v102
v_mul_f32 v215, v87, v103
v_mfma_f32_16x16x32_bf16 a[196:199], v[76:79], v[164:167], a[196:199]
buffer_load_dwordx4 v2, s[8:11], s23 offen offset:0 lds
v_fma_f32 v212, v212, v237, v237
v_fma_f32 v214, v214, v237, v237
v_mfma_f32_16x16x32_bf16 a[200:203], v[72:75], v[152:155], 0
v_rcp_f32 v212, v212
v_mfma_f32_16x16x32_bf16 a[200:203], v[76:79], v[168:171], a[200:203]
buffer_load_dwordx4 v2, s[8:11], s23 offen offset:1024 lds
v_rcp_f32 v214, v214
v_mfma_f32_16x16x32_bf16 a[204:207], v[72:75], v[156:159], 0
ds_read_b128 v[68:71], v2 offset:5120
v_mul_f32 v213, v213, v212
v_mul_f32 v215, v215, v214
v_mfma_f32_16x16x32_bf16 a[204:207], v[76:79], v[172:175], a[204:207]
v_cvt_pk_bf16_f32 v199, v213, v215
s_waitcnt lgkmcnt(4)
v_mfma_f32_16x16x32_bf16 a[208:211], v[48:51], v[144:147], 0
buffer_store_dwordx4 v[196:199], v4, s[8:11], s24 offen offset:3072 sc1
v_mul_f32 v208, v88, v88
v_mfma_f32_16x16x32_bf16 a[208:211], v[52:55], v[160:163], a[208:211]
v_mul_f32 v210, v89, v89
v_fma_f32 v208, v208, v239, v238
v_mfma_f32_16x16x32_bf16 a[212:215], v[48:51], v[148:151], 0
ds_read_b128 v[72:75], v2 offset:6144
v_fma_f32 v210, v210, v239, v238
v_mul_f32 v208, v208, v88
v_mfma_f32_16x16x32_bf16 a[212:215], v[52:55], v[164:167], a[212:215]
v_mul_f32 v210, v210, v89
v_exp_f32 v208, v208
v_mfma_f32_16x16x32_bf16 a[216:219], v[48:51], v[152:155], 0
v_exp_f32 v210, v210
v_mfma_f32_16x16x32_bf16 a[216:219], v[52:55], v[168:171], a[216:219]
v_mul_f32 v209, v88, v104
v_mul_f32 v211, v89, v105
v_mfma_f32_16x16x32_bf16 a[220:223], v[48:51], v[156:159], 0
ds_read_b128 v[76:79], v2 offset:7168
v_fma_f32 v208, v208, v240, v240
v_mfma_f32_16x16x32_bf16 a[220:223], v[52:55], v[172:175], a[220:223]
v_fma_f32 v210, v210, v240, v240
v_rcp_f32 v208, v208
s_waitcnt lgkmcnt(4)
v_mfma_f32_16x16x32_bf16 a[224:227], v[56:59], v[144:147], 0
v_rcp_f32 v210, v210
v_mfma_f32_16x16x32_bf16 a[224:227], v[60:63], v[160:163], a[224:227]
v_mul_f32 v209, v209, v208
v_mul_f32 v211, v211, v210
v_mfma_f32_16x16x32_bf16 a[228:231], v[56:59], v[148:151], 0
ds_read_b128 v[48:51], v2 offset:8192
v_cvt_pk_bf16_f32 v202, v209, v211
v_mfma_f32_16x16x32_bf16 a[228:231], v[60:63], v[164:167], a[228:231]
v_mul_f32 v212, v90, v90
v_mul_f32 v214, v91, v91
v_mfma_f32_16x16x32_bf16 a[232:235], v[56:59], v[152:155], 0
v_fma_f32 v212, v212, v239, v238
v_fma_f32 v214, v214, v239, v238
v_mfma_f32_16x16x32_bf16 a[232:235], v[60:63], v[168:171], a[232:235]
v_mul_f32 v212, v212, v90
v_mul_f32 v214, v214, v91
v_mfma_f32_16x16x32_bf16 a[236:239], v[56:59], v[156:159], 0
ds_read_b128 v[52:55], v2 offset:9216
v_exp_f32 v212, v212
v_mfma_f32_16x16x32_bf16 a[236:239], v[60:63], v[172:175], a[236:239]
v_exp_f32 v214, v214
s_waitcnt lgkmcnt(4)
v_mfma_f32_16x16x32_bf16 a[240:243], v[64:67], v[144:147], 0
v_mul_f32 v213, v90, v106
v_mul_f32 v215, v91, v107
v_mfma_f32_16x16x32_bf16 a[240:243], v[68:71], v[160:163], a[240:243]
v_fma_f32 v212, v212, v240, v240
v_fma_f32 v214, v214, v240, v240
v_mfma_f32_16x16x32_bf16 a[244:247], v[64:67], v[148:151], 0
ds_read_b128 v[56:59], v2 offset:10240
v_rcp_f32 v212, v212
v_mfma_f32_16x16x32_bf16 a[244:247], v[68:71], v[164:167], a[244:247]
v_rcp_f32 v214, v214
v_mfma_f32_16x16x32_bf16 a[248:251], v[64:67], v[152:155], 0
v_mul_f32 v213, v213, v212
v_mul_f32 v215, v215, v214
v_mfma_f32_16x16x32_bf16 a[248:251], v[68:71], v[168:171], a[248:251]
v_cvt_pk_bf16_f32 v203, v213, v215
buffer_store_dwordx4 v[200:203], v5, s[8:11], s24 offen offset:3072 sc1
v_mfma_f32_16x16x32_bf16 a[252:255], v[64:67], v[156:159], 0
ds_read_b128 v[60:63], v2 offset:11264
v_mul_f32 v208, v92, v92
v_mfma_f32_16x16x32_bf16 a[252:255], v[68:71], v[172:175], a[252:255]
v_mul_f32 v210, v93, v93
v_fma_f32 v208, v208, v242, v241
s_waitcnt vmcnt(44)
s_waitcnt lgkmcnt(4)
v_mfma_f32_16x16x32_bf16 a[112:115], v[72:75], v[176:179], a[112:115]
v_fma_f32 v210, v210, v242, v241
v_mul_f32 v208, v208, v92
v_mfma_f32_16x16x32_bf16 a[112:115], v[76:79], a[0:3], a[112:115]
v_mul_f32 v210, v210, v93
v_exp_f32 v208, v208
v_mfma_f32_16x16x32_bf16 a[116:119], v[72:75], v[180:183], a[116:119]
ds_read_b128 v[64:67], v2 offset:12288
v_exp_f32 v210, v210
v_mfma_f32_16x16x32_bf16 a[116:119], v[76:79], a[4:7], a[116:119]
v_mul_f32 v209, v92, v108
v_mul_f32 v211, v93, v109
v_mfma_f32_16x16x32_bf16 a[120:123], v[72:75], v[184:187], a[120:123]
v_fma_f32 v208, v208, v243, v243
v_fma_f32 v210, v210, v243, v243
v_mfma_f32_16x16x32_bf16 a[120:123], v[76:79], a[8:11], a[120:123]
v_rcp_f32 v208, v208
v_mfma_f32_16x16x32_bf16 a[124:127], v[72:75], v[188:191], a[124:127]
ds_read_b128 v[68:71], v2 offset:13312
v_rcp_f32 v210, v210
v_mfma_f32_16x16x32_bf16 a[124:127], v[76:79], a[12:15], a[124:127]
v_mul_f32 v209, v209, v208
s_waitcnt lgkmcnt(4)
v_mfma_f32_16x16x32_bf16 a[128:131], v[48:51], v[176:179], a[128:131]
v_mul_f32 v211, v211, v210
v_cvt_pk_bf16_f32 v206, v209, v211
v_mfma_f32_16x16x32_bf16 a[128:131], v[52:55], a[0:3], a[128:131]
v_mul_f32 v212, v94, v94
v_mul_f32 v214, v95, v95
v_mfma_f32_16x16x32_bf16 a[132:135], v[48:51], v[180:183], a[132:135]
ds_read_b128 v[72:75], v2 offset:14336
v_fma_f32 v212, v212, v242, v241
v_fma_f32 v214, v214, v242, v241
v_mfma_f32_16x16x32_bf16 a[132:135], v[52:55], a[4:7], a[132:135]
v_mul_f32 v212, v212, v94
v_mul_f32 v214, v214, v95
v_mfma_f32_16x16x32_bf16 a[136:139], v[48:51], v[184:187], a[136:139]
v_exp_f32 v212, v212
v_mfma_f32_16x16x32_bf16 a[136:139], v[52:55], a[8:11], a[136:139]
v_exp_f32 v214, v214
v_mfma_f32_16x16x32_bf16 a[140:143], v[48:51], v[188:191], a[140:143]
ds_read_b128 v[76:79], v2 offset:15360
v_mul_f32 v213, v94, v110
v_mul_f32 v215, v95, v111
v_mfma_f32_16x16x32_bf16 a[140:143], v[52:55], a[12:15], a[140:143]
v_fma_f32 v212, v212, v243, v243
v_fma_f32 v214, v214, v243, v243
s_waitcnt lgkmcnt(4)
v_mfma_f32_16x16x32_bf16 a[144:147], v[56:59], v[176:179], a[144:147]
v_rcp_f32 v212, v212
v_mfma_f32_16x16x32_bf16 a[144:147], v[60:63], a[0:3], a[144:147]
v_rcp_f32 v214, v214
v_mfma_f32_16x16x32_bf16 a[148:151], v[56:59], v[180:183], a[148:151]
ds_read_b128 v[48:51], v2 offset:16384
v_mul_f32 v213, v213, v212
v_mul_f32 v215, v215, v214
v_mfma_f32_16x16x32_bf16 a[148:151], v[60:63], a[4:7], a[148:151]
v_cvt_pk_bf16_f32 v207, v213, v215
buffer_store_dwordx4 v[204:207], v6, s[8:11], s24 offen offset:3072 sc1
v_mfma_f32_16x16x32_bf16 a[152:155], v[56:59], v[184:187], a[152:155]
v_mfma_f32_16x16x32_bf16 a[152:155], v[60:63], a[8:11], a[152:155]
v_mfma_f32_16x16x32_bf16 a[156:159], v[56:59], v[188:191], a[156:159]
ds_read_b128 v[52:55], v2 offset:17408
v_mfma_f32_16x16x32_bf16 a[156:159], v[60:63], a[12:15], a[156:159]
s_waitcnt lgkmcnt(4)
v_mfma_f32_16x16x32_bf16 a[160:163], v[64:67], v[176:179], a[160:163]
v_mfma_f32_16x16x32_bf16 a[160:163], v[68:71], a[0:3], a[160:163]
v_mfma_f32_16x16x32_bf16 a[164:167], v[64:67], v[180:183], a[164:167]
ds_read_b128 v[56:59], v2 offset:18432
v_mfma_f32_16x16x32_bf16 a[164:167], v[68:71], a[4:7], a[164:167]
v_mfma_f32_16x16x32_bf16 a[168:171], v[64:67], v[184:187], a[168:171]
v_mfma_f32_16x16x32_bf16 a[168:171], v[68:71], a[8:11], a[168:171]
v_mfma_f32_16x16x32_bf16 a[172:175], v[64:67], v[188:191], a[172:175]
ds_read_b128 v[60:63], v2 offset:19456
v_mfma_f32_16x16x32_bf16 a[172:175], v[68:71], a[12:15], a[172:175]
s_waitcnt lgkmcnt(4)
v_mfma_f32_16x16x32_bf16 a[176:179], v[72:75], v[176:179], a[176:179]
v_mfma_f32_16x16x32_bf16 a[176:179], v[76:79], a[0:3], a[176:179]
v_mfma_f32_16x16x32_bf16 a[180:183], v[72:75], v[180:183], a[180:183]
ds_read_b128 v[64:67], v2 offset:20480
v_mfma_f32_16x16x32_bf16 a[180:183], v[76:79], a[4:7], a[180:183]
v_mfma_f32_16x16x32_bf16 a[184:187], v[72:75], v[184:187], a[184:187]
v_mfma_f32_16x16x32_bf16 a[184:187], v[76:79], a[8:11], a[184:187]
v_mfma_f32_16x16x32_bf16 a[188:191], v[72:75], v[188:191], a[188:191]
ds_read_b128 v[68:71], v2 offset:21504
v_mfma_f32_16x16x32_bf16 a[188:191], v[76:79], a[12:15], a[188:191]
s_waitcnt lgkmcnt(4)
v_mfma_f32_16x16x32_bf16 a[192:195], v[48:51], v[176:179], a[192:195]
v_mfma_f32_16x16x32_bf16 a[192:195], v[52:55], a[0:3], a[192:195]
v_mfma_f32_16x16x32_bf16 a[196:199], v[48:51], v[180:183], a[196:199]
ds_read_b128 v[72:75], v2 offset:22528
v_mfma_f32_16x16x32_bf16 a[196:199], v[52:55], a[4:7], a[196:199]
v_mfma_f32_16x16x32_bf16 a[200:203], v[48:51], v[184:187], a[200:203]
v_mfma_f32_16x16x32_bf16 a[200:203], v[52:55], a[8:11], a[200:203]
v_mfma_f32_16x16x32_bf16 a[204:207], v[48:51], v[188:191], a[204:207]
ds_read_b128 v[76:79], v2 offset:23552
v_mfma_f32_16x16x32_bf16 a[204:207], v[52:55], a[12:15], a[204:207]
s_waitcnt lgkmcnt(4)
v_mfma_f32_16x16x32_bf16 a[208:211], v[56:59], v[176:179], a[208:211]
v_mfma_f32_16x16x32_bf16 a[208:211], v[60:63], a[0:3], a[208:211]
v_mfma_f32_16x16x32_bf16 a[212:215], v[56:59], v[180:183], a[212:215]
s_waitcnt vmcnt(58)
s_barrier
buffer_load_dword v13, v11, s[8:11], s34 offen sc1
ds_read_b128 v[48:51], v2 offset:24576
v_mfma_f32_16x16x32_bf16 a[212:215], v[60:63], a[4:7], a[212:215]
s_add_u32 m0, s22, 122880
v_mfma_f32_16x16x32_bf16 a[216:219], v[56:59], v[184:187], a[216:219]
v_mfma_f32_16x16x32_bf16 a[216:219], v[60:63], a[8:11], a[216:219]
s_add_u32 s23, s21, 466944
v_mfma_f32_16x16x32_bf16 a[220:223], v[56:59], v[188:191], a[220:223]
ds_read_b128 v[52:55], v2 offset:25600
v_mfma_f32_16x16x32_bf16 a[220:223], v[60:63], a[12:15], a[220:223]
buffer_load_dwordx4 v2, s[8:11], s23 offen offset:0 lds
s_waitcnt lgkmcnt(4)
v_mfma_f32_16x16x32_bf16 a[224:227], v[64:67], v[176:179], a[224:227]
v_mfma_f32_16x16x32_bf16 a[224:227], v[68:71], a[0:3], a[224:227]
buffer_load_dwordx4 v2, s[8:11], s23 offen offset:1024 lds
v_mfma_f32_16x16x32_bf16 a[228:231], v[64:67], v[180:183], a[228:231]
ds_read_b128 v[56:59], v2 offset:26624
v_mfma_f32_16x16x32_bf16 a[228:231], v[68:71], a[4:7], a[228:231]
buffer_load_dwordx4 v2, s[8:11], s23 offen offset:2048 lds
v_mfma_f32_16x16x32_bf16 a[232:235], v[64:67], v[184:187], a[232:235]
v_mfma_f32_16x16x32_bf16 a[232:235], v[68:71], a[8:11], a[232:235]
buffer_load_dwordx4 v2, s[8:11], s23 offen offset:3072 lds
v_mfma_f32_16x16x32_bf16 a[236:239], v[64:67], v[188:191], a[236:239]
ds_read_b128 v[60:63], v2 offset:27648
v_mfma_f32_16x16x32_bf16 a[236:239], v[68:71], a[12:15], a[236:239]
s_add_u32 m0, s22, 126976
s_waitcnt lgkmcnt(4)
v_mfma_f32_16x16x32_bf16 a[240:243], v[72:75], v[176:179], a[240:243]
v_mfma_f32_16x16x32_bf16 a[240:243], v[76:79], a[0:3], a[240:243]
s_add_u32 s23, s21, 471040
v_mfma_f32_16x16x32_bf16 a[244:247], v[72:75], v[180:183], a[244:247]
ds_read_b128 v[64:67], v2 offset:28672
v_mfma_f32_16x16x32_bf16 a[244:247], v[76:79], a[4:7], a[244:247]
buffer_load_dwordx4 v2, s[8:11], s23 offen offset:0 lds
v_mfma_f32_16x16x32_bf16 a[248:251], v[72:75], v[184:187], a[248:251]
v_mfma_f32_16x16x32_bf16 a[248:251], v[76:79], a[8:11], a[248:251]
buffer_load_dwordx4 v2, s[8:11], s23 offen offset:1024 lds
v_mfma_f32_16x16x32_bf16 a[252:255], v[72:75], v[188:191], a[252:255]
ds_read_b128 v[68:71], v2 offset:29696
v_mfma_f32_16x16x32_bf16 a[252:255], v[76:79], a[12:15], a[252:255]
s_waitcnt vmcnt(44)
s_waitcnt lgkmcnt(4)
v_mfma_f32_16x16x32_bf16 a[112:115], v[48:51], a[16:19], a[112:115]
v_mfma_f32_16x16x32_bf16 a[112:115], v[52:55], a[32:35], a[112:115]
v_mfma_f32_16x16x32_bf16 a[116:119], v[48:51], a[20:23], a[116:119]
ds_read_b128 v[72:75], v2 offset:30720
v_mfma_f32_16x16x32_bf16 a[116:119], v[52:55], a[36:39], a[116:119]
v_mfma_f32_16x16x32_bf16 a[120:123], v[48:51], a[24:27], a[120:123]
v_mfma_f32_16x16x32_bf16 a[120:123], v[52:55], a[40:43], a[120:123]
v_mfma_f32_16x16x32_bf16 a[124:127], v[48:51], a[28:31], a[124:127]
ds_read_b128 v[76:79], v2 offset:31744
v_mfma_f32_16x16x32_bf16 a[124:127], v[52:55], a[44:47], a[124:127]
s_waitcnt lgkmcnt(4)
v_mfma_f32_16x16x32_bf16 a[128:131], v[56:59], a[16:19], a[128:131]
v_mfma_f32_16x16x32_bf16 a[128:131], v[60:63], a[32:35], a[128:131]
v_mfma_f32_16x16x32_bf16 a[132:135], v[56:59], a[20:23], a[132:135]
ds_read_b128 v[48:51], v2 offset:32768
v_mfma_f32_16x16x32_bf16 a[132:135], v[60:63], a[36:39], a[132:135]
v_mfma_f32_16x16x32_bf16 a[136:139], v[56:59], a[24:27], a[136:139]
v_mfma_f32_16x16x32_bf16 a[136:139], v[60:63], a[40:43], a[136:139]
v_mfma_f32_16x16x32_bf16 a[140:143], v[56:59], a[28:31], a[140:143]
ds_read_b128 v[52:55], v2 offset:33792
v_mfma_f32_16x16x32_bf16 a[140:143], v[60:63], a[44:47], a[140:143]
s_waitcnt lgkmcnt(4)
v_mfma_f32_16x16x32_bf16 a[144:147], v[64:67], a[16:19], a[144:147]
v_mfma_f32_16x16x32_bf16 a[144:147], v[68:71], a[32:35], a[144:147]
v_mfma_f32_16x16x32_bf16 a[148:151], v[64:67], a[20:23], a[148:151]
ds_read_b128 v[56:59], v2 offset:34816
v_mfma_f32_16x16x32_bf16 a[148:151], v[68:71], a[36:39], a[148:151]
v_mfma_f32_16x16x32_bf16 a[152:155], v[64:67], a[24:27], a[152:155]
v_mfma_f32_16x16x32_bf16 a[152:155], v[68:71], a[40:43], a[152:155]
v_mfma_f32_16x16x32_bf16 a[156:159], v[64:67], a[28:31], a[156:159]
ds_read_b128 v[60:63], v2 offset:35840
v_mfma_f32_16x16x32_bf16 a[156:159], v[68:71], a[44:47], a[156:159]
s_waitcnt lgkmcnt(4)
v_mfma_f32_16x16x32_bf16 a[160:163], v[72:75], a[16:19], a[160:163]
v_mfma_f32_16x16x32_bf16 a[160:163], v[76:79], a[32:35], a[160:163]
v_mfma_f32_16x16x32_bf16 a[164:167], v[72:75], a[20:23], a[164:167]
ds_read_b128 v[64:67], v2 offset:36864
v_mfma_f32_16x16x32_bf16 a[164:167], v[76:79], a[36:39], a[164:167]
v_mfma_f32_16x16x32_bf16 a[168:171], v[72:75], a[24:27], a[168:171]
v_mfma_f32_16x16x32_bf16 a[168:171], v[76:79], a[40:43], a[168:171]
v_mfma_f32_16x16x32_bf16 a[172:175], v[72:75], a[28:31], a[172:175]
ds_read_b128 v[68:71], v2 offset:37888
v_mfma_f32_16x16x32_bf16 a[172:175], v[76:79], a[44:47], a[172:175]
s_waitcnt lgkmcnt(4)
v_mfma_f32_16x16x32_bf16 a[176:179], v[48:51], a[16:19], a[176:179]
s_waitcnt vmcnt(6)
v_cmp_le_u32 vcc, 2, v13
s_nop 0
s_cmp_eq_u64 vcc, exec
s_cbranch_scc0 L_f_slow2
L_f_back2:
v_mfma_f32_16x16x32_bf16 a[176:179], v[52:55], a[32:35], a[176:179]
buffer_load_dwordx4 v[32:35], v2, s[8:11], s25 offen offset:2048 sc1
v_mfma_f32_16x16x32_bf16 a[180:183], v[48:51], a[20:23], a[180:183]
ds_read_b128 v[72:75], v2 offset:38912
v_mfma_f32_16x16x32_bf16 a[180:183], v[52:55], a[36:39], a[180:183]
buffer_load_dwordx4 v[36:39], v4, s[8:11], s25 offen offset:2048 sc1
v_mfma_f32_16x16x32_bf16 a[184:187], v[48:51], a[24:27], a[184:187]
v_mfma_f32_16x16x32_bf16 a[184:187], v[52:55], a[40:43], a[184:187]
buffer_load_dwordx4 v[40:43], v5, s[8:11], s25 offen offset:2048 sc1
v_mfma_f32_16x16x32_bf16 a[188:191], v[48:51], a[28:31], a[188:191]
ds_read_b128 v[76:79], v2 offset:39936
v_mfma_f32_16x16x32_bf16 a[188:191], v[52:55], a[44:47], a[188:191]
buffer_load_dwordx4 v[44:47], v6, s[8:11], s25 offen offset:2048 sc1
s_waitcnt lgkmcnt(4)
v_mfma_f32_16x16x32_bf16 a[192:195], v[56:59], a[16:19], a[192:195]
v_mfma_f32_16x16x32_bf16 a[192:195], v[60:63], a[32:35], a[192:195]
buffer_load_dwordx4 v[112:115], v2, s[8:11], s26 offen offset:2048 sc1
v_mfma_f32_16x16x32_bf16 a[196:199], v[56:59], a[20:23], a[196:199]
ds_read_b128 v[48:51], v2 offset:40960
v_mfma_f32_16x16x32_bf16 a[196:199], v[60:63], a[36:39], a[196:199]
buffer_load_dwordx4 v[116:119], v4, s[8:11], s26 offen offset:2048 sc1
v_mfma_f32_16x16x32_bf16 a[200:203], v[56:59], a[24:27], a[200:203]
v_mfma_f32_16x16x32_bf16 a[200:203], v[60:63], a[40:43], a[200:203]
buffer_load_dwordx4 v[120:123], v5, s[8:11], s26 offen offset:2048 sc1
v_mfma_f32_16x16x32_bf16 a[204:207], v[56:59], a[28:31], a[204:207]
ds_read_b128 v[52:55], v2 offset:41984
v_mfma_f32_16x16x32_bf16 a[204:207], v[60:63], a[44:47], a[204:207]
buffer_load_dwordx4 v[124:127], v6, s[8:11], s26 offen offset:2048 sc1
s_waitcnt lgkmcnt(4)
v_mfma_f32_16x16x32_bf16 a[208:211], v[64:67], a[16:19], a[208:211]
v_mfma_f32_16x16x32_bf16 a[208:211], v[68:71], a[32:35], a[208:211]
buffer_load_dwordx4 v[128:131], v2, s[8:11], s27 offen offset:2048 sc1
v_mfma_f32_16x16x32_bf16 a[212:215], v[64:67], a[20:23], a[212:215]
ds_read_b128 v[56:59], v2 offset:43008
v_mfma_f32_16x16x32_bf16 a[212:215], v[68:71], a[36:39], a[212:215]
buffer_load_dwordx4 v[132:135], v4, s[8:11], s27 offen offset:2048 sc1
v_mfma_f32_16x16x32_bf16 a[216:219], v[64:67], a[24:27], a[216:219]
v_mfma_f32_16x16x32_bf16 a[216:219], v[68:71], a[40:43], a[216:219]
buffer_load_dwordx4 v[136:139], v5, s[8:11], s27 offen offset:2048 sc1
v_mfma_f32_16x16x32_bf16 a[220:223], v[64:67], a[28:31], a[220:223]
ds_read_b128 v[60:63], v2 offset:44032
v_mfma_f32_16x16x32_bf16 a[220:223], v[68:71], a[44:47], a[220:223]
buffer_load_dwordx4 v[140:143], v6, s[8:11], s27 offen offset:2048 sc1
s_waitcnt lgkmcnt(4)
v_mfma_f32_16x16x32_bf16 a[224:227], v[72:75], a[16:19], a[224:227]
v_mfma_f32_16x16x32_bf16 a[224:227], v[76:79], a[32:35], a[224:227]
v_mfma_f32_16x16x32_bf16 a[228:231], v[72:75], a[20:23], a[228:231]
ds_read_b128 v[64:67], v2 offset:45056
v_mfma_f32_16x16x32_bf16 a[228:231], v[76:79], a[36:39], a[228:231]
v_mfma_f32_16x16x32_bf16 a[232:235], v[72:75], a[24:27], a[232:235]
v_mfma_f32_16x16x32_bf16 a[232:235], v[76:79], a[40:43], a[232:235]
v_mfma_f32_16x16x32_bf16 a[236:239], v[72:75], a[28:31], a[236:239]
ds_read_b128 v[68:71], v2 offset:46080
v_mfma_f32_16x16x32_bf16 a[236:239], v[76:79], a[44:47], a[236:239]
s_waitcnt lgkmcnt(4)
v_mfma_f32_16x16x32_bf16 a[240:243], v[48:51], a[16:19], a[240:243]
v_mfma_f32_16x16x32_bf16 a[240:243], v[52:55], a[32:35], a[240:243]
v_mfma_f32_16x16x32_bf16 a[244:247], v[48:51], a[20:23], a[244:247]
ds_read_b128 v[72:75], v2 offset:47104
v_mfma_f32_16x16x32_bf16 a[244:247], v[52:55], a[36:39], a[244:247]
v_mfma_f32_16x16x32_bf16 a[248:251], v[48:51], a[24:27], a[248:251]
v_mfma_f32_16x16x32_bf16 a[248:251], v[52:55], a[40:43], a[248:251]
v_mfma_f32_16x16x32_bf16 a[252:255], v[48:51], a[28:31], a[252:255]
ds_read_b128 v[76:79], v2 offset:48128
v_mfma_f32_16x16x32_bf16 a[252:255], v[52:55], a[44:47], a[252:255]
s_waitcnt vmcnt(48)
s_waitcnt lgkmcnt(4)
v_mfma_f32_16x16x32_bf16 a[112:115], v[56:59], a[48:51], a[112:115]
v_mfma_f32_16x16x32_bf16 a[112:115], v[60:63], a[64:67], a[112:115]
v_mfma_f32_16x16x32_bf16 a[116:119], v[56:59], a[52:55], a[116:119]
s_waitcnt vmcnt(0)
s_barrier
v_mov_b32 v12, 3
buffer_store_dword v12, v10, s[8:11], s34 offen sc1
ds_read_b128 v[48:51], v2 offset:49152
v_mfma_f32_16x16x32_bf16 a[116:119], v[60:63], a[68:71], a[116:119]
s_add_u32 m0, s22, 0
v_mfma_f32_16x16x32_bf16 a[120:123], v[56:59], a[56:59], a[120:123]
v_mfma_f32_16x16x32_bf16 a[120:123], v[60:63], a[72:75], a[120:123]
s_add_u32 s23, s21, 491520
v_mfma_f32_16x16x32_bf16 a[124:127], v[56:59], a[60:63], a[124:127]
ds_read_b128 v[52:55], v2 offset:50176
v_mfma_f32_16x16x32_bf16 a[124:127], v[60:63], a[76:79], a[124:127]
buffer_load_dwordx4 v2, s[8:11], s23 offen offset:0 lds
s_waitcnt lgkmcnt(4)
v_mfma_f32_16x16x32_bf16 a[128:131], v[64:67], a[48:51], a[128:131]
v_mfma_f32_16x16x32_bf16 a[128:131], v[68:71], a[64:67], a[128:131]
buffer_load_dwordx4 v2, s[8:11], s23 offen offset:1024 lds
v_mfma_f32_16x16x32_bf16 a[132:135], v[64:67], a[52:55], a[132:135]
ds_read_b128 v[56:59], v2 offset:51200
v_mfma_f32_16x16x32_bf16 a[132:135], v[68:71], a[68:71], a[132:135]
buffer_load_dwordx4 v2, s[8:11], s23 offen offset:2048 lds
v_mfma_f32_16x16x32_bf16 a[136:139], v[64:67], a[56:59], a[136:139]
v_mfma_f32_16x16x32_bf16 a[136:139], v[68:71], a[72:75], a[136:139]
buffer_load_dwordx4 v2, s[8:11], s23 offen offset:3072 lds
v_mfma_f32_16x16x32_bf16 a[140:143], v[64:67], a[60:63], a[140:143]
ds_read_b128 v[60:63], v2 offset:52224
v_mfma_f32_16x16x32_bf16 a[140:143], v[68:71], a[76:79], a[140:143]
s_add_u32 m0, s22, 4096
s_waitcnt lgkmcnt(4)
v_mfma_f32_16x16x32_bf16 a[144:147], v[72:75], a[48:51], a[144:147]
v_mfma_f32_16x16x32_bf16 a[144:147], v[76:79], a[64:67], a[144:147]
s_add_u32 s23, s21, 495616
v_mfma_f32_16x16x32_bf16 a[148:151], v[72:75], a[52:55], a[148:151]
ds_read_b128 v[64:67], v2 offset:53248
v_mfma_f32_16x16x32_bf16 a[148:151], v[76:79], a[68:71], a[148:151]
buffer_load_dwordx4 v2, s[8:11], s23 offen offset:0 lds
v_mfma_f32_16x16x32_bf16 a[152:155], v[72:75], a[56:59], a[152:155]
v_mfma_f32_16x16x32_bf16 a[152:155], v[76:79], a[72:75], a[152:155]
buffer_load_dwordx4 v2, s[8:11], s23 offen offset:1024 lds
v_mfma_f32_16x16x32_bf16 a[156:159], v[72:75], a[60:63], a[156:159]
ds_read_b128 v[68:71], v2 offset:54272
v_mfma_f32_16x16x32_bf16 a[156:159], v[76:79], a[76:79], a[156:159]
s_waitcnt lgkmcnt(4)
v_mfma_f32_16x16x32_bf16 a[160:163], v[48:51], a[48:51], a[160:163]
v_mfma_f32_16x16x32_bf16 a[160:163], v[52:55], a[64:67], a[160:163]
v_mfma_f32_16x16x32_bf16 a[164:167], v[48:51], a[52:55], a[164:167]
ds_read_b128 v[72:75], v2 offset:55296
v_mfma_f32_16x16x32_bf16 a[164:167], v[52:55], a[68:71], a[164:167]
v_mfma_f32_16x16x32_bf16 a[168:171], v[48:51], a[56:59], a[168:171]
v_mfma_f32_16x16x32_bf16 a[168:171], v[52:55], a[72:75], a[168:171]
v_mfma_f32_16x16x32_bf16 a[172:175], v[48:51], a[60:63], a[172:175]
ds_read_b128 v[76:79], v2 offset:56320
v_mfma_f32_16x16x32_bf16 a[172:175], v[52:55], a[76:79], a[172:175]
s_waitcnt lgkmcnt(4)
v_mfma_f32_16x16x32_bf16 a[176:179], v[56:59], a[48:51], a[176:179]
v_mfma_f32_16x16x32_bf16 a[176:179], v[60:63], a[64:67], a[176:179]
v_mfma_f32_16x16x32_bf16 a[180:183], v[56:59], a[52:55], a[180:183]
ds_read_b128 v[48:51], v2 offset:57344
v_mfma_f32_16x16x32_bf16 a[180:183], v[60:63], a[68:71], a[180:183]
v_mfma_f32_16x16x32_bf16 a[184:187], v[56:59], a[56:59], a[184:187]
v_mfma_f32_16x16x32_bf16 a[184:187], v[60:63], a[72:75], a[184:187]
v_mfma_f32_16x16x32_bf16 a[188:191], v[56:59], a[60:63], a[188:191]
ds_read_b128 v[52:55], v2 offset:58368
v_mfma_f32_16x16x32_bf16 a[188:191], v[60:63], a[76:79], a[188:191]
s_waitcnt lgkmcnt(4)
v_mfma_f32_16x16x32_bf16 a[192:195], v[64:67], a[48:51], a[192:195]
v_mfma_f32_16x16x32_bf16 a[192:195], v[68:71], a[64:67], a[192:195]
v_mfma_f32_16x16x32_bf16 a[196:199], v[64:67], a[52:55], a[196:199]
ds_read_b128 v[56:59], v2 offset:59392
v_mfma_f32_16x16x32_bf16 a[196:199], v[68:71], a[68:71], a[196:199]
v_mfma_f32_16x16x32_bf16 a[200:203], v[64:67], a[56:59], a[200:203]
v_mfma_f32_16x16x32_bf16 a[200:203], v[68:71], a[72:75], a[200:203]
v_mfma_f32_16x16x32_bf16 a[204:207], v[64:67], a[60:63], a[204:207]
ds_read_b128 v[60:63], v2 offset:60416
v_mfma_f32_16x16x32_bf16 a[204:207], v[68:71], a[76:79], a[204:207]
s_waitcnt lgkmcnt(4)
v_mfma_f32_16x16x32_bf16 a[208:211], v[72:75], a[48:51], a[208:211]
v_mfma_f32_16x16x32_bf16 a[208:211], v[76:79], a[64:67], a[208:211]
v_mfma_f32_16x16x32_bf16 a[212:215], v[72:75], a[52:55], a[212:215]
ds_read_b128 v[64:67], v2 offset:61440
v_mfma_f32_16x16x32_bf16 a[212:215], v[76:79], a[68:71], a[212:215]
v_mfma_f32_16x16x32_bf16 a[216:219], v[72:75], a[56:59], a[216:219]
v_mfma_f32_16x16x32_bf16 a[216:219], v[76:79], a[72:75], a[216:219]
v_mfma_f32_16x16x32_bf16 a[220:223], v[72:75], a[60:63], a[220:223]
ds_read_b128 v[68:71], v2 offset:62464
v_mfma_f32_16x16x32_bf16 a[220:223], v[76:79], a[76:79], a[220:223]
s_waitcnt lgkmcnt(4)
v_mfma_f32_16x16x32_bf16 a[224:227], v[48:51], a[48:51], a[224:227]
v_mfma_f32_16x16x32_bf16 a[224:227], v[52:55], a[64:67], a[224:227]
v_mfma_f32_16x16x32_bf16 a[228:231], v[48:51], a[52:55], a[228:231]
ds_read_b128 v[72:75], v2 offset:63488
v_mfma_f32_16x16x32_bf16 a[228:231], v[52:55], a[68:71], a[228:231]
v_mfma_f32_16x16x32_bf16 a[232:235], v[48:51], a[56:59], a[232:235]
v_mfma_f32_16x16x32_bf16 a[232:235], v[52:55], a[72:75], a[232:235]
v_mfma_f32_16x16x32_bf16 a[236:239], v[48:51], a[60:63], a[236:239]
ds_read_b128 v[76:79], v2 offset:64512
v_mfma_f32_16x16x32_bf16 a[236:239], v[52:55], a[76:79], a[236:239]
s_waitcnt lgkmcnt(4)
v_mfma_f32_16x16x32_bf16 a[240:243], v[56:59], a[48:51], a[240:243]
v_mfma_f32_16x16x32_bf16 a[240:243], v[60:63], a[64:67], a[240:243]
v_mfma_f32_16x16x32_bf16 a[244:247], v[56:59], a[52:55], a[244:247]
ds_read_b128 v[48:51], v7 offset:0
v_mfma_f32_16x16x32_bf16 a[244:247], v[60:63], a[68:71], a[244:247]
v_mfma_f32_16x16x32_bf16 a[248:251], v[56:59], a[56:59], a[248:251]
v_mfma_f32_16x16x32_bf16 a[248:251], v[60:63], a[72:75], a[248:251]
v_mfma_f32_16x16x32_bf16 a[252:255], v[56:59], a[60:63], a[252:255]
ds_read_b128 v[52:55], v7 offset:1024
v_mfma_f32_16x16x32_bf16 a[252:255], v[60:63], a[76:79], a[252:255]
s_waitcnt vmcnt(47)
s_waitcnt lgkmcnt(4)
v_mfma_f32_16x16x32_bf16 a[112:115], v[64:67], a[80:83], a[112:115]
v_mfma_f32_16x16x32_bf16 a[112:115], v[68:71], a[96:99], a[112:115]
v_mfma_f32_16x16x32_bf16 a[116:119], v[64:67], a[84:87], a[116:119]
ds_read_b128 v[56:59], v7 offset:2048
v_mfma_f32_16x16x32_bf16 a[116:119], v[68:71], a[100:103], a[116:119]
v_mfma_f32_16x16x32_bf16 a[120:123], v[64:67], a[88:91], a[120:123]
v_mfma_f32_16x16x32_bf16 a[120:123], v[68:71], a[104:107], a[120:123]
v_mfma_f32_16x16x32_bf16 a[124:127], v[64:67], a[92:95], a[124:127]
ds_read_b128 v[60:63], v7 offset:3072
v_mfma_f32_16x16x32_bf16 a[124:127], v[68:71], a[108:111], a[124:127]
s_waitcnt lgkmcnt(4)
v_mfma_f32_16x16x32_bf16 a[128:131], v[72:75], a[80:83], a[128:131]
v_mfma_f32_16x16x32_bf16 a[128:131], v[76:79], a[96:99], a[128:131]
v_mfma_f32_16x16x32_bf16 a[132:135], v[72:75], a[84:87], a[132:135]
ds_read_b128 v[64:67], v7 offset:4096
v_mfma_f32_16x16x32_bf16 a[132:135], v[76:79], a[100:103], a[132:135]
v_mfma_f32_16x16x32_bf16 a[136:139], v[72:75], a[88:91], a[136:139]
v_mfma_f32_16x16x32_bf16 a[136:139], v[76:79], a[104:107], a[136:139]
v_mfma_f32_16x16x32_bf16 a[140:143], v[72:75], a[92:95], a[140:143]
ds_read_b128 v[68:71], v7 offset:5120
v_mfma_f32_16x16x32_bf16 a[140:143], v[76:79], a[108:111], a[140:143]
s_waitcnt lgkmcnt(4)
v_mfma_f32_16x16x32_bf16 a[144:147], v[48:51], a[80:83], a[144:147]
v_mfma_f32_16x16x32_bf16 a[144:147], v[52:55], a[96:99], a[144:147]
v_mfma_f32_16x16x32_bf16 a[148:151], v[48:51], a[84:87], a[148:151]
ds_read_b128 v[72:75], v7 offset:6144
v_mfma_f32_16x16x32_bf16 a[148:151], v[52:55], a[100:103], a[148:151]
v_mfma_f32_16x16x32_bf16 a[152:155], v[48:51], a[88:91], a[152:155]
v_mfma_f32_16x16x32_bf16 a[152:155], v[52:55], a[104:107], a[152:155]
v_mfma_f32_16x16x32_bf16 a[156:159], v[48:51], a[92:95], a[156:159]
ds_read_b128 v[76:79], v7 offset:7168
v_mfma_f32_16x16x32_bf16 a[156:159], v[52:55], a[108:111], a[156:159]
s_waitcnt lgkmcnt(4)
v_mfma_f32_16x16x32_bf16 a[160:163], v[56:59], a[80:83], a[160:163]
v_mfma_f32_16x16x32_bf16 a[160:163], v[60:63], a[96:99], a[160:163]
v_mfma_f32_16x16x32_bf16 a[164:167], v[56:59], a[84:87], a[164:167]
s_waitcnt vmcnt(40)
s_barrier
buffer_load_dword v13, v11, s[8:11], s34 offen sc1
ds_read_b128 v[48:51], v7 offset:8192
v_mfma_f32_16x16x32_bf16 a[164:167], v[60:63], a[100:103], a[164:167]
v_mfma_f32_16x16x32_bf16 a[168:171], v[56:59], a[88:91], a[168:171]
v_mfma_f32_16x16x32_bf16 a[168:171], v[60:63], a[104:107], a[168:171]
v_mfma_f32_16x16x32_bf16 a[172:175], v[56:59], a[92:95], a[172:175]
ds_read_b128 v[52:55], v7 offset:9216
v_mfma_f32_16x16x32_bf16 a[172:175], v[60:63], a[108:111], a[172:175]
s_waitcnt lgkmcnt(4)
v_mfma_f32_16x16x32_bf16 a[176:179], v[64:67], a[80:83], a[176:179]
v_mfma_f32_16x16x32_bf16 a[176:179], v[68:71], a[96:99], a[176:179]
v_mfma_f32_16x16x32_bf16 a[180:183], v[64:67], a[84:87], a[180:183]
ds_read_b128 v[56:59], v7 offset:10240
v_mfma_f32_16x16x32_bf16 a[180:183], v[68:71], a[100:103], a[180:183]
v_mfma_f32_16x16x32_bf16 a[184:187], v[64:67], a[88:91], a[184:187]
v_mfma_f32_16x16x32_bf16 a[184:187], v[68:71], a[104:107], a[184:187]
v_mfma_f32_16x16x32_bf16 a[188:191], v[64:67], a[92:95], a[188:191]
ds_read_b128 v[60:63], v7 offset:11264
v_mfma_f32_16x16x32_bf16 a[188:191], v[68:71], a[108:111], a[188:191]
s_waitcnt lgkmcnt(4)
v_mfma_f32_16x16x32_bf16 a[192:195], v[72:75], a[80:83], a[192:195]
v_mfma_f32_16x16x32_bf16 a[192:195], v[76:79], a[96:99], a[192:195]
v_mfma_f32_16x16x32_bf16 a[196:199], v[72:75], a[84:87], a[196:199]
ds_read_b128 v[64:67], v7 offset:12288
v_mfma_f32_16x16x32_bf16 a[196:199], v[76:79], a[100:103], a[196:199]
v_mfma_f32_16x16x32_bf16 a[200:203], v[72:75], a[88:91], a[200:203]
v_mfma_f32_16x16x32_bf16 a[200:203], v[76:79], a[104:107], a[200:203]
v_mfma_f32_16x16x32_bf16 a[204:207], v[72:75], a[92:95], a[204:207]
ds_read_b128 v[68:71], v7 offset:13312
v_mfma_f32_16x16x32_bf16 a[204:207], v[76:79], a[108:111], a[204:207]
s_waitcnt lgkmcnt(4)
v_mfma_f32_16x16x32_bf16 a[208:211], v[48:51], a[80:83], a[208:211]
v_mfma_f32_16x16x32_bf16 a[208:211], v[52:55], a[96:99], a[208:211]
v_mfma_f32_16x16x32_bf16 a[212:215], v[48:51], a[84:87], a[212:215]
ds_read_b128 v[72:75], v7 offset:14336
v_mfma_f32_16x16x32_bf16 a[212:215], v[52:55], a[100:103], a[212:215]
v_mfma_f32_16x16x32_bf16 a[216:219], v[48:51], a[88:91], a[216:219]
v_mfma_f32_16x16x32_bf16 a[216:219], v[52:55], a[104:107], a[216:219]
v_mfma_f32_16x16x32_bf16 a[220:223], v[48:51], a[92:95], a[220:223]
ds_read_b128 v[76:79], v7 offset:15360
v_mfma_f32_16x16x32_bf16 a[220:223], v[52:55], a[108:111], a[220:223]
s_waitcnt lgkmcnt(4)
v_mfma_f32_16x16x32_bf16 a[224:227], v[56:59], a[80:83], a[224:227]
v_mfma_f32_16x16x32_bf16 a[224:227], v[60:63], a[96:99], a[224:227]
v_mfma_f32_16x16x32_bf16 a[228:231], v[56:59], a[84:87], a[228:231]
ds_read_b128 v[48:51], v7 offset:16384
v_mfma_f32_16x16x32_bf16 a[228:231], v[60:63], a[100:103], a[228:231]
v_mfma_f32_16x16x32_bf16 a[232:235], v[56:59], a[88:91], a[232:235]
v_mfma_f32_16x16x32_bf16 a[232:235], v[60:63], a[104:107], a[232:235]
v_mfma_f32_16x16x32_bf16 a[236:239], v[56:59], a[92:95], a[236:239]
ds_read_b128 v[52:55], v7 offset:17408
v_mfma_f32_16x16x32_bf16 a[236:239], v[60:63], a[108:111], a[236:239]
s_waitcnt lgkmcnt(4)
v_mfma_f32_16x16x32_bf16 a[240:243], v[64:67], a[80:83], a[240:243]
v_mfma_f32_16x16x32_bf16 a[240:243], v[68:71], a[96:99], a[240:243]
v_mfma_f32_16x16x32_bf16 a[244:247], v[64:67], a[84:87], a[244:247]
ds_read_b128 v[56:59], v7 offset:18432
v_mfma_f32_16x16x32_bf16 a[244:247], v[68:71], a[100:103], a[244:247]
v_mfma_f32_16x16x32_bf16 a[248:251], v[64:67], a[88:91], a[248:251]
v_mfma_f32_16x16x32_bf16 a[248:251], v[68:71], a[104:107], a[248:251]
v_mfma_f32_16x16x32_bf16 a[252:255], v[64:67], a[92:95], a[252:255]
ds_read_b128 v[60:63], v7 offset:19456
v_mfma_f32_16x16x32_bf16 a[252:255], v[68:71], a[108:111], a[252:255]
s_waitcnt vmcnt(37)
s_waitcnt lgkmcnt(4)
v_mfma_f32_16x16x32_bf16 a[112:115], v[72:75], v[16:19], a[112:115]
v_mfma_f32_16x16x32_bf16 a[112:115], v[76:79], v[192:195], a[112:115]
v_mfma_f32_16x16x32_bf16 a[116:119], v[72:75], v[20:23], a[116:119]
ds_read_b128 v[64:67], v7 offset:20480
v_mfma_f32_16x16x32_bf16 a[116:119], v[76:79], v[196:199], a[116:119]
v_mfma_f32_16x16x32_bf16 a[120:123], v[72:75], v[24:27], a[120:123]
v_mfma_f32_16x16x32_bf16 a[120:123], v[76:79], v[200:203], a[120:123]
v_mfma_f32_16x16x32_bf16 a[124:127], v[72:75], v[28:31], a[124:127]
ds_read_b128 v[68:71], v7 offset:21504
v_mfma_f32_16x16x32_bf16 a[124:127], v[76:79], v[204:207], a[124:127]
s_waitcnt lgkmcnt(4)
v_mfma_f32_16x16x32_bf16 a[128:131], v[48:51], v[16:19], a[128:131]
s_waitcnt vmcnt(0)
v_cmp_le_u32 vcc, 3, v13
s_nop 0
s_cmp_eq_u64 vcc, exec
s_cbranch_scc0 L_f_slow3
L_f_back3:
v_mfma_f32_16x16x32_bf16 a[128:131], v[52:55], v[192:195], a[128:131]
buffer_load_dwordx4 v[80:83], v2, s[8:11], s25 offen offset:3072 sc1
v_mfma_f32_16x16x32_bf16 a[132:135], v[48:51], v[20:23], a[132:135]
ds_read_b128 v[72:75], v7 offset:22528
v_mfma_f32_16x16x32_bf16 a[132:135], v[52:55], v[196:199], a[132:135]
buffer_load_dwordx4 v[84:87], v4, s[8:11], s25 offen offset:3072 sc1
v_mfma_f32_16x16x32_bf16 a[136:139], v[48:51], v[24:27], a[136:139]
v_mfma_f32_16x16x32_bf16 a[136:139], v[52:55], v[200:203], a[136:139]
buffer_load_dwordx4 v[88:91], v5, s[8:11], s25 offen offset:3072 sc1
v_mfma_f32_16x16x32_bf16 a[140:143], v[48:51], v[28:31], a[140:143]
ds_read_b128 v[76:79], v7 offset:23552
v_mfma_f32_16x16x32_bf16 a[140:143], v[52:55], v[204:207], a[140:143]
buffer_load_dwordx4 v[92:95], v6, s[8:11], s25 offen offset:3072 sc1
s_waitcnt lgkmcnt(4)
v_mfma_f32_16x16x32_bf16 a[144:147], v[56:59], v[16:19], a[144:147]
v_mfma_f32_16x16x32_bf16 a[144:147], v[60:63], v[192:195], a[144:147]
buffer_load_dwordx4 v[96:99], v2, s[8:11], s26 offen offset:3072 sc1
v_mfma_f32_16x16x32_bf16 a[148:151], v[56:59], v[20:23], a[148:151]
ds_read_b128 v[48:51], v7 offset:24576
v_mfma_f32_16x16x32_bf16 a[148:151], v[60:63], v[196:199], a[148:151]
buffer_load_dwordx4 v[100:103], v4, s[8:11], s26 offen offset:3072 sc1
v_mfma_f32_16x16x32_bf16 a[152:155], v[56:59], v[24:27], a[152:155]
v_mfma_f32_16x16x32_bf16 a[152:155], v[60:63], v[200:203], a[152:155]
buffer_load_dwordx4 v[104:107], v5, s[8:11], s26 offen offset:3072 sc1
v_mfma_f32_16x16x32_bf16 a[156:159], v[56:59], v[28:31], a[156:159]
ds_read_b128 v[52:55], v7 offset:25600
v_mfma_f32_16x16x32_bf16 a[156:159], v[60:63], v[204:207], a[156:159]
buffer_load_dwordx4 v[108:111], v6, s[8:11], s26 offen offset:3072 sc1
s_waitcnt lgkmcnt(4)
v_mfma_f32_16x16x32_bf16 a[160:163], v[64:67], v[16:19], a[160:163]
v_mfma_f32_16x16x32_bf16 a[160:163], v[68:71], v[192:195], a[160:163]
buffer_load_dwordx4 v[144:147], v2, s[8:11], s27 offen offset:3072 sc1
v_mfma_f32_16x16x32_bf16 a[164:167], v[64:67], v[20:23], a[164:167]
ds_read_b128 v[56:59], v7 offset:26624
v_mfma_f32_16x16x32_bf16 a[164:167], v[68:71], v[196:199], a[164:167]
buffer_load_dwordx4 v[148:151], v4, s[8:11], s27 offen offset:3072 sc1
v_mfma_f32_16x16x32_bf16 a[168:171], v[64:67], v[24:27], a[168:171]
v_mfma_f32_16x16x32_bf16 a[168:171], v[68:71], v[200:203], a[168:171]
buffer_load_dwordx4 v[152:155], v5, s[8:11], s27 offen offset:3072 sc1
v_mfma_f32_16x16x32_bf16 a[172:175], v[64:67], v[28:31], a[172:175]
ds_read_b128 v[60:63], v7 offset:27648
v_mfma_f32_16x16x32_bf16 a[172:175], v[68:71], v[204:207], a[172:175]
buffer_load_dwordx4 v[156:159], v6, s[8:11], s27 offen offset:3072 sc1
s_waitcnt lgkmcnt(4)
v_mfma_f32_16x16x32_bf16 a[176:179], v[72:75], v[16:19], a[176:179]
v_mfma_f32_16x16x32_bf16 a[176:179], v[76:79], v[192:195], a[176:179]
v_mfma_f32_16x16x32_bf16 a[180:183], v[72:75], v[20:23], a[180:183]
ds_read_b128 v[64:67], v7 offset:28672
v_mfma_f32_16x16x32_bf16 a[180:183], v[76:79], v[196:199], a[180:183]
v_mfma_f32_16x16x32_bf16 a[184:187], v[72:75], v[24:27], a[184:187]
v_mfma_f32_16x16x32_bf16 a[184:187], v[76:79], v[200:203], a[184:187]
v_mfma_f32_16x16x32_bf16 a[188:191], v[72:75], v[28:31], a[188:191]
ds_read_b128 v[68:71], v7 offset:29696
v_mfma_f32_16x16x32_bf16 a[188:191], v[76:79], v[204:207], a[188:191]
s_waitcnt lgkmcnt(4)
v_mfma_f32_16x16x32_bf16 a[192:195], v[48:51], v[16:19], a[192:195]
v_mfma_f32_16x16x32_bf16 a[192:195], v[52:55], v[192:195], a[192:195]
v_mfma_f32_16x16x32_bf16 a[196:199], v[48:51], v[20:23], a[196:199]
ds_read_b128 v[72:75], v7 offset:30720
v_mfma_f32_16x16x32_bf16 a[196:199], v[52:55], v[196:199], a[196:199]
v_mfma_f32_16x16x32_bf16 a[200:203], v[48:51], v[24:27], a[200:203]
v_mfma_f32_16x16x32_bf16 a[200:203], v[52:55], v[200:203], a[200:203]
v_mfma_f32_16x16x32_bf16 a[204:207], v[48:51], v[28:31], a[204:207]
ds_read_b128 v[76:79], v7 offset:31744
v_mfma_f32_16x16x32_bf16 a[204:207], v[52:55], v[204:207], a[204:207]
s_waitcnt lgkmcnt(4)
v_mfma_f32_16x16x32_bf16 a[208:211], v[56:59], v[16:19], a[208:211]
v_mfma_f32_16x16x32_bf16 a[208:211], v[60:63], v[192:195], a[208:211]
v_mfma_f32_16x16x32_bf16 a[212:215], v[56:59], v[20:23], a[212:215]
s_waitcnt vmcnt(42)
s_barrier
ds_read_b128 v[48:51], v7 offset:32768
v_mfma_f32_16x16x32_bf16 a[212:215], v[60:63], v[196:199], a[212:215]
v_mfma_f32_16x16x32_bf16 a[216:219], v[56:59], v[24:27], a[216:219]
v_mfma_f32_16x16x32_bf16 a[216:219], v[60:63], v[200:203], a[216:219]
v_mfma_f32_16x16x32_bf16 a[220:223], v[56:59], v[28:31], a[220:223]
ds_read_b128 v[52:55], v7 offset:33792
v_mfma_f32_16x16x32_bf16 a[220:223], v[60:63], v[204:207], a[220:223]
s_waitcnt lgkmcnt(4)
v_mfma_f32_16x16x32_bf16 a[224:227], v[64:67], v[16:19], a[224:227]
v_mfma_f32_16x16x32_bf16 a[224:227], v[68:71], v[192:195], a[224:227]
v_mfma_f32_16x16x32_bf16 a[228:231], v[64:67], v[20:23], a[228:231]
ds_read_b128 v[56:59], v7 offset:34816
v_mfma_f32_16x16x32_bf16 a[228:231], v[68:71], v[196:199], a[228:231]
v_mfma_f32_16x16x32_bf16 a[232:235], v[64:67], v[24:27], a[232:235]
v_mfma_f32_16x16x32_bf16 a[232:235], v[68:71], v[200:203], a[232:235]
v_mfma_f32_16x16x32_bf16 a[236:239], v[64:67], v[28:31], a[236:239]
ds_read_b128 v[60:63], v7 offset:35840
v_mfma_f32_16x16x32_bf16 a[236:239], v[68:71], v[204:207], a[236:239]
s_waitcnt lgkmcnt(4)
v_mfma_f32_16x16x32_bf16 a[240:243], v[72:75], v[16:19], a[240:243]
v_mfma_f32_16x16x32_bf16 a[240:243], v[76:79], v[192:195], a[240:243]
v_mfma_f32_16x16x32_bf16 a[244:247], v[72:75], v[20:23], a[244:247]
ds_read_b128 v[64:67], v7 offset:36864
v_mfma_f32_16x16x32_bf16 a[244:247], v[76:79], v[196:199], a[244:247]
v_mfma_f32_16x16x32_bf16 a[248:251], v[72:75], v[24:27], a[248:251]
v_mfma_f32_16x16x32_bf16 a[248:251], v[76:79], v[200:203], a[248:251]
v_mfma_f32_16x16x32_bf16 a[252:255], v[72:75], v[28:31], a[252:255]
ds_read_b128 v[68:71], v7 offset:37888
v_mfma_f32_16x16x32_bf16 a[252:255], v[76:79], v[204:207], a[252:255]
s_waitcnt vmcnt(24)
s_waitcnt lgkmcnt(4)
v_mfma_f32_16x16x32_bf16 a[112:115], v[48:51], v[32:35], a[112:115]
v_mfma_f32_16x16x32_bf16 a[112:115], v[52:55], v[112:115], a[112:115]
v_mfma_f32_16x16x32_bf16 a[116:119], v[48:51], v[36:39], a[116:119]
ds_read_b128 v[72:75], v7 offset:38912
v_mfma_f32_16x16x32_bf16 a[116:119], v[52:55], v[116:119], a[116:119]
v_mfma_f32_16x16x32_bf16 a[120:123], v[48:51], v[40:43], a[120:123]
v_mfma_f32_16x16x32_bf16 a[120:123], v[52:55], v[120:123], a[120:123]
v_mfma_f32_16x16x32_bf16 a[124:127], v[48:51], v[44:47], a[124:127]
ds_read_b128 v[76:79], v7 offset:39936
v_mfma_f32_16x16x32_bf16 a[124:127], v[52:55], v[124:127], a[124:127]
s_waitcnt lgkmcnt(4)
v_mfma_f32_16x16x32_bf16 a[128:131], v[56:59], v[32:35], a[128:131]
v_mfma_f32_16x16x32_bf16 a[128:131], v[60:63], v[112:115], a[128:131]
v_mfma_f32_16x16x32_bf16 a[132:135], v[56:59], v[36:39], a[132:135]
ds_read_b128 v[48:51], v7 offset:40960
v_mfma_f32_16x16x32_bf16 a[132:135], v[60:63], v[116:119], a[132:135]
v_mfma_f32_16x16x32_bf16 a[136:139], v[56:59], v[40:43], a[136:139]
v_mfma_f32_16x16x32_bf16 a[136:139], v[60:63], v[120:123], a[136:139]
v_mfma_f32_16x16x32_bf16 a[140:143], v[56:59], v[44:47], a[140:143]
ds_read_b128 v[52:55], v7 offset:41984
v_mfma_f32_16x16x32_bf16 a[140:143], v[60:63], v[124:127], a[140:143]
s_waitcnt lgkmcnt(4)
v_mfma_f32_16x16x32_bf16 a[144:147], v[64:67], v[32:35], a[144:147]
v_mfma_f32_16x16x32_bf16 a[144:147], v[68:71], v[112:115], a[144:147]
v_mfma_f32_16x16x32_bf16 a[148:151], v[64:67], v[36:39], a[148:151]
ds_read_b128 v[56:59], v7 offset:43008
v_mfma_f32_16x16x32_bf16 a[148:151], v[68:71], v[116:119], a[148:151]
v_mfma_f32_16x16x32_bf16 a[152:155], v[64:67], v[40:43], a[152:155]
v_mfma_f32_16x16x32_bf16 a[152:155], v[68:71], v[120:123], a[152:155]
v_mfma_f32_16x16x32_bf16 a[156:159], v[64:67], v[44:47], a[156:159]
ds_read_b128 v[60:63], v7 offset:44032
v_mfma_f32_16x16x32_bf16 a[156:159], v[68:71], v[124:127], a[156:159]
s_waitcnt lgkmcnt(4)
v_mfma_f32_16x16x32_bf16 a[160:163], v[72:75], v[32:35], a[160:163]
v_mfma_f32_16x16x32_bf16 a[160:163], v[76:79], v[112:115], a[160:163]
v_mfma_f32_16x16x32_bf16 a[164:167], v[72:75], v[36:39], a[164:167]
ds_read_b128 v[64:67], v7 offset:45056
v_mfma_f32_16x16x32_bf16 a[164:167], v[76:79], v[116:119], a[164:167]
v_mfma_f32_16x16x32_bf16 a[168:171], v[72:75], v[40:43], a[168:171]
v_mfma_f32_16x16x32_bf16 a[168:171], v[76:79], v[120:123], a[168:171]
v_mfma_f32_16x16x32_bf16 a[172:175], v[72:75], v[44:47], a[172:175]
ds_read_b128 v[68:71], v7 offset:46080
v_mfma_f32_16x16x32_bf16 a[172:175], v[76:79], v[124:127], a[172:175]
s_waitcnt lgkmcnt(4)
v_mfma_f32_16x16x32_bf16 a[176:179], v[48:51], v[32:35], a[176:179]
v_mfma_f32_16x16x32_bf16 a[176:179], v[52:55], v[112:115], a[176:179]
v_mfma_f32_16x16x32_bf16 a[180:183], v[48:51], v[36:39], a[180:183]
ds_read_b128 v[72:75], v7 offset:47104
v_mfma_f32_16x16x32_bf16 a[180:183], v[52:55], v[116:119], a[180:183]
v_mfma_f32_16x16x32_bf16 a[184:187], v[48:51], v[40:43], a[184:187]
v_mfma_f32_16x16x32_bf16 a[184:187], v[52:55], v[120:123], a[184:187]
v_mfma_f32_16x16x32_bf16 a[188:191], v[48:51], v[44:47], a[188:191]
ds_read_b128 v[76:79], v7 offset:48128
v_mfma_f32_16x16x32_bf16 a[188:191], v[52:55], v[124:127], a[188:191]
s_waitcnt lgkmcnt(4)
v_mfma_f32_16x16x32_bf16 a[192:195], v[56:59], v[32:35], a[192:195]
v_mfma_f32_16x16x32_bf16 a[192:195], v[60:63], v[112:115], a[192:195]
v_mfma_f32_16x16x32_bf16 a[196:199], v[56:59], v[36:39], a[196:199]
ds_read_b128 v[48:51], v7 offset:49152
v_mfma_f32_16x16x32_bf16 a[196:199], v[60:63], v[116:119], a[196:199]
v_mfma_f32_16x16x32_bf16 a[200:203], v[56:59], v[40:43], a[200:203]
v_mfma_f32_16x16x32_bf16 a[200:203], v[60:63], v[120:123], a[200:203]
v_mfma_f32_16x16x32_bf16 a[204:207], v[56:59], v[44:47], a[204:207]
ds_read_b128 v[52:55], v7 offset:50176
v_mfma_f32_16x16x32_bf16 a[204:207], v[60:63], v[124:127], a[204:207]
s_waitcnt lgkmcnt(4)
v_mfma_f32_16x16x32_bf16 a[208:211], v[64:67], v[32:35], a[208:211]
v_mfma_f32_16x16x32_bf16 a[208:211], v[68:71], v[112:115], a[208:211]
v_mfma_f32_16x16x32_bf16 a[212:215], v[64:67], v[36:39], a[212:215]
ds_read_b128 v[56:59], v7 offset:51200
v_mfma_f32_16x16x32_bf16 a[212:215], v[68:71], v[116:119], a[212:215]
v_mfma_f32_16x16x32_bf16 a[216:219], v[64:67], v[40:43], a[216:219]
v_mfma_f32_16x16x32_bf16 a[216:219], v[68:71], v[120:123], a[216:219]
v_mfma_f32_16x16x32_bf16 a[220:223], v[64:67], v[44:47], a[220:223]
ds_read_b128 v[60:63], v7 offset:52224
v_mfma_f32_16x16x32_bf16 a[220:223], v[68:71], v[124:127], a[220:223]
s_waitcnt lgkmcnt(4)
v_mfma_f32_16x16x32_bf16 a[224:227], v[72:75], v[32:35], a[224:227]
v_mfma_f32_16x16x32_bf16 a[224:227], v[76:79], v[112:115], a[224:227]
v_mfma_f32_16x16x32_bf16 a[228:231], v[72:75], v[36:39], a[228:231]
ds_read_b128 v[64:67], v7 offset:53248
v_mfma_f32_16x16x32_bf16 a[228:231], v[76:79], v[116:119], a[228:231]
v_mfma_f32_16x16x32_bf16 a[232:235], v[72:75], v[40:43], a[232:235]
v_mfma_f32_16x16x32_bf16 a[232:235], v[76:79], v[120:123], a[232:235]
v_mfma_f32_16x16x32_bf16 a[236:239], v[72:75], v[44:47], a[236:239]
ds_read_b128 v[68:71], v7 offset:54272
v_mfma_f32_16x16x32_bf16 a[236:239], v[76:79], v[124:127], a[236:239]
s_waitcnt lgkmcnt(4)
v_mfma_f32_16x16x32_bf16 a[240:243], v[48:51], v[32:35], a[240:243]
v_mfma_f32_16x16x32_bf16 a[240:243], v[52:55], v[112:115], a[240:243]
v_mfma_f32_16x16x32_bf16 a[244:247], v[48:51], v[36:39], a[244:247]
ds_read_b128 v[72:75], v7 offset:55296
v_mfma_f32_16x16x32_bf16 a[244:247], v[52:55], v[116:119], a[244:247]
v_mfma_f32_16x16x32_bf16 a[248:251], v[48:51], v[40:43], a[248:251]
v_mfma_f32_16x16x32_bf16 a[248:251], v[52:55], v[120:123], a[248:251]
v_mfma_f32_16x16x32_bf16 a[252:255], v[48:51], v[44:47], a[252:255]
ds_read_b128 v[76:79], v7 offset:56320
v_mfma_f32_16x16x32_bf16 a[252:255], v[52:55], v[124:127], a[252:255]
s_waitcnt vmcnt(8)
s_waitcnt lgkmcnt(4)
v_mfma_f32_16x16x32_bf16 a[112:115], v[56:59], v[128:131], a[112:115]
v_mfma_f32_16x16x32_bf16 a[112:115], v[60:63], v[80:83], a[112:115]
v_mfma_f32_16x16x32_bf16 a[116:119], v[56:59], v[132:135], a[116:119]
s_waitcnt vmcnt(32)
s_barrier
ds_read_b128 v[48:51], v7 offset:57344
v_mfma_f32_16x16x32_bf16 a[116:119], v[60:63], v[84:87], a[116:119]
v_mfma_f32_16x16x32_bf16 a[120:123], v[56:59], v[136:139], a[120:123]
v_mfma_f32_16x16x32_bf16 a[120:123], v[60:63], v[88:91], a[120:123]
v_mfma_f32_16x16x32_bf16 a[124:127], v[56:59], v[140:143], a[124:127]
ds_read_b128 v[52:55], v7 offset:58368
v_mfma_f32_16x16x32_bf16 a[124:127], v[60:63], v[92:95], a[124:127]
s_waitcnt vmcnt(0)
s_waitcnt lgkmcnt(4)
v_mfma_f32_16x16x32_bf16 a[112:115], v[64:67], v[96:99], a[112:115]
v_mfma_f32_16x16x32_bf16 a[112:115], v[68:71], v[144:147], a[112:115]
v_mfma_f32_16x16x32_bf16 a[116:119], v[64:67], v[100:103], a[116:119]
ds_read_b128 v[56:59], v7 offset:59392
v_mfma_f32_16x16x32_bf16 a[116:119], v[68:71], v[148:151], a[116:119]
v_mfma_f32_16x16x32_bf16 a[120:123], v[64:67], v[104:107], a[120:123]
v_mfma_f32_16x16x32_bf16 a[120:123], v[68:71], v[152:155], a[120:123]
v_mfma_f32_16x16x32_bf16 a[124:127], v[64:67], v[108:111], a[124:127]
ds_read_b128 v[60:63], v7 offset:60416
v_mfma_f32_16x16x32_bf16 a[124:127], v[68:71], v[156:159], a[124:127]
s_waitcnt lgkmcnt(4)
v_mfma_f32_16x16x32_bf16 a[128:131], v[72:75], v[128:131], a[128:131]
v_mfma_f32_16x16x32_bf16 a[128:131], v[76:79], v[80:83], a[128:131]
v_mfma_f32_16x16x32_bf16 a[132:135], v[72:75], v[132:135], a[132:135]
ds_read_b128 v[64:67], v7 offset:61440
v_mfma_f32_16x16x32_bf16 a[132:135], v[76:79], v[84:87], a[132:135]
v_mfma_f32_16x16x32_bf16 a[136:139], v[72:75], v[136:139], a[136:139]
v_mfma_f32_16x16x32_bf16 a[136:139], v[76:79], v[88:91], a[136:139]
v_mfma_f32_16x16x32_bf16 a[140:143], v[72:75], v[140:143], a[140:143]
ds_read_b128 v[68:71], v7 offset:62464
v_mfma_f32_16x16x32_bf16 a[140:143], v[76:79], v[92:95], a[140:143]
s_waitcnt lgkmcnt(4)
v_mfma_f32_16x16x32_bf16 a[128:131], v[48:51], v[96:99], a[128:131]
v_mfma_f32_16x16x32_bf16 a[128:131], v[52:55], v[144:147], a[128:131]
v_mfma_f32_16x16x32_bf16 a[132:135], v[48:51], v[100:103], a[132:135]
ds_read_b128 v[72:75], v7 offset:63488
v_mfma_f32_16x16x32_bf16 a[132:135], v[52:55], v[148:151], a[132:135]
v_mfma_f32_16x16x32_bf16 a[136:139], v[48:51], v[104:107], a[136:139]
v_mfma_f32_16x16x32_bf16 a[136:139], v[52:55], v[152:155], a[136:139]
v_mfma_f32_16x16x32_bf16 a[140:143], v[48:51], v[108:111], a[140:143]
ds_read_b128 v[76:79], v7 offset:64512
v_mfma_f32_16x16x32_bf16 a[140:143], v[52:55], v[156:159], a[140:143]
s_waitcnt lgkmcnt(4)
v_mfma_f32_16x16x32_bf16 a[144:147], v[56:59], v[128:131], a[144:147]
v_mfma_f32_16x16x32_bf16 a[144:147], v[60:63], v[80:83], a[144:147]
v_mfma_f32_16x16x32_bf16 a[148:151], v[56:59], v[132:135], a[148:151]
ds_read_b128 v[48:51], v8 offset:0
v_mfma_f32_16x16x32_bf16 a[148:151], v[60:63], v[84:87], a[148:151]
v_mfma_f32_16x16x32_bf16 a[152:155], v[56:59], v[136:139], a[152:155]
v_accvgpr_read_b32 v208, a112
v_accvgpr_read_b32 v209, a113
v_mfma_f32_16x16x32_bf16 a[152:155], v[60:63], v[88:91], a[152:155]
v_accvgpr_read_b32 v210, a114
v_mfma_f32_16x16x32_bf16 a[156:159], v[56:59], v[140:143], a[156:159]
ds_read_b128 v[52:55], v8 offset:1024
v_accvgpr_read_b32 v211, a115
v_mfma_f32_16x16x32_bf16 a[156:159], v[60:63], v[92:95], a[156:159]
v_accvgpr_read_b32 v212, a128
s_waitcnt lgkmcnt(4)
v_mfma_f32_16x16x32_bf16 a[144:147], v[64:67], v[96:99], a[144:147]
v_accvgpr_read_b32 v213, a129
v_accvgpr_read_b32 v214, a130
v_mfma_f32_16x16x32_bf16 a[144:147], v[68:71], v[144:147], a[144:147]
v_accvgpr_read_b32 v215, a131
v_cvt_pk_bf16_f32 v224, v208, v209
v_mfma_f32_16x16x32_bf16 a[148:151], v[64:67], v[100:103], a[148:151]
ds_read_b128 v[56:59], v8 offset:2048
v_cvt_pk_bf16_f32 v225, v210, v211
v_mfma_f32_16x16x32_bf16 a[148:151], v[68:71], v[148:151], a[148:151]
v_cvt_pk_bf16_f32 v226, v212, v213
v_cvt_pk_bf16_f32 v227, v214, v215
v_mfma_f32_16x16x32_bf16 a[152:155], v[64:67], v[104:107], a[152:155]
buffer_store_dwordx4 v[224:227], v2, s[8:11], s31 offen offset:0 sc1
v_accvgpr_read_b32 v216, a116
v_mfma_f32_16x16x32_bf16 a[152:155], v[68:71], v[152:155], a[152:155]
v_accvgpr_read_b32 v217, a117
v_accvgpr_read_b32 v218, a118
v_mfma_f32_16x16x32_bf16 a[156:159], v[64:67], v[108:111], a[156:159]
ds_read_b128 v[60:63], v8 offset:3072
v_accvgpr_read_b32 v219, a119
v_mfma_f32_16x16x32_bf16 a[156:159], v[68:71], v[156:159], a[156:159]
v_accvgpr_read_b32 v220, a132
s_waitcnt lgkmcnt(4)
v_mfma_f32_16x16x32_bf16 a[160:163], v[72:75], v[128:131], a[160:163]
v_accvgpr_read_b32 v221, a133
v_accvgpr_read_b32 v222, a134
v_mfma_f32_16x16x32_bf16 a[160:163], v[76:79], v[80:83], a[160:163]
v_accvgpr_read_b32 v223, a135
v_cvt_pk_bf16_f32 v228, v216, v217
v_mfma_f32_16x16x32_bf16 a[164:167], v[72:75], v[132:135], a[164:167]
ds_read_b128 v[64:67], v8 offset:4096
v_cvt_pk_bf16_f32 v229, v218, v219
v_mfma_f32_16x16x32_bf16 a[164:167], v[76:79], v[84:87], a[164:167]
v_cvt_pk_bf16_f32 v230, v220, v221
v_cvt_pk_bf16_f32 v231, v222, v223
v_mfma_f32_16x16x32_bf16 a[168:171], v[72:75], v[136:139], a[168:171]
buffer_store_dwordx4 v[228:231], v4, s[8:11], s31 offen offset:0 sc1
v_accvgpr_read_b32 v208, a120
v_mfma_f32_16x16x32_bf16 a[168:171], v[76:79], v[88:91], a[168:171]
v_accvgpr_read_b32 v209, a121
v_accvgpr_read_b32 v210, a122
v_mfma_f32_16x16x32_bf16 a[172:175], v[72:75], v[140:143], a[172:175]
ds_read_b128 v[68:71], v8 offset:5120
v_accvgpr_read_b32 v211, a123
v_mfma_f32_16x16x32_bf16 a[172:175], v[76:79], v[92:95], a[172:175]
v_accvgpr_read_b32 v212, a136
s_waitcnt lgkmcnt(4)
v_mfma_f32_16x16x32_bf16 a[160:163], v[48:51], v[96:99], a[160:163]
v_accvgpr_read_b32 v213, a137
v_accvgpr_read_b32 v214, a138
v_mfma_f32_16x16x32_bf16 a[160:163], v[52:55], v[144:147], a[160:163]
v_accvgpr_read_b32 v215, a139
v_cvt_pk_bf16_f32 v224, v208, v209
v_mfma_f32_16x16x32_bf16 a[164:167], v[48:51], v[100:103], a[164:167]
ds_read_b128 v[72:75], v8 offset:6144
v_cvt_pk_bf16_f32 v225, v210, v211
v_mfma_f32_16x16x32_bf16 a[164:167], v[52:55], v[148:151], a[164:167]
v_cvt_pk_bf16_f32 v226, v212, v213
v_cvt_pk_bf16_f32 v227, v214, v215
v_mfma_f32_16x16x32_bf16 a[168:171], v[48:51], v[104:107], a[168:171]
buffer_store_dwordx4 v[224:227], v5, s[8:11], s31 offen offset:0 sc1
v_accvgpr_read_b32 v216, a124
v_mfma_f32_16x16x32_bf16 a[168:171], v[52:55], v[152:155], a[168:171]
v_accvgpr_read_b32 v217, a125
v_accvgpr_read_b32 v218, a126
v_mfma_f32_16x16x32_bf16 a[172:175], v[48:51], v[108:111], a[172:175]
ds_read_b128 v[76:79], v8 offset:7168
v_accvgpr_read_b32 v219, a127
v_mfma_f32_16x16x32_bf16 a[172:175], v[52:55], v[156:159], a[172:175]
v_accvgpr_read_b32 v220, a140
s_waitcnt lgkmcnt(4)
v_mfma_f32_16x16x32_bf16 a[176:179], v[56:59], v[128:131], a[176:179]
v_mfma_f32_16x16x32_bf16 a[176:179], v[60:63], v[80:83], a[176:179]
v_mfma_f32_16x16x32_bf16 a[180:183], v[56:59], v[132:135], a[180:183]
ds_read_b128 v[48:51], v8 offset:8192
v_mfma_f32_16x16x32_bf16 a[180:183], v[60:63], v[84:87], a[180:183]
v_mfma_f32_16x16x32_bf16 a[184:187], v[56:59], v[136:139], a[184:187]
v_accvgpr_read_b32 v221, a141
v_accvgpr_read_b32 v222, a142
v_mfma_f32_16x16x32_bf16 a[184:187], v[60:63], v[88:91], a[184:187]
v_accvgpr_read_b32 v223, a143
v_cvt_pk_bf16_f32 v228, v216, v217
v_mfma_f32_16x16x32_bf16 a[188:191], v[56:59], v[140:143], a[188:191]
ds_read_b128 v[52:55], v8 offset:9216
v_cvt_pk_bf16_f32 v229, v218, v219
v_mfma_f32_16x16x32_bf16 a[188:191], v[60:63], v[92:95], a[188:191]
v_cvt_pk_bf16_f32 v230, v220, v221
s_waitcnt lgkmcnt(4)
v_mfma_f32_16x16x32_bf16 a[176:179], v[64:67], v[96:99], a[176:179]
v_cvt_pk_bf16_f32 v231, v222, v223
buffer_store_dwordx4 v[228:231], v6, s[8:11], s31 offen offset:0 sc1
v_mfma_f32_16x16x32_bf16 a[176:179], v[68:71], v[144:147], a[176:179]
v_accvgpr_read_b32 v208, a144
v_accvgpr_read_b32 v209, a145
v_mfma_f32_16x16x32_bf16 a[180:183], v[64:67], v[100:103], a[180:183]
ds_read_b128 v[56:59], v8 offset:10240
v_accvgpr_read_b32 v210, a146
v_mfma_f32_16x16x32_bf16 a[180:183], v[68:71], v[148:151], a[180:183]
v_accvgpr_read_b32 v211, a147
v_accvgpr_read_b32 v212, a160
v_mfma_f32_16x16x32_bf16 a[184:187], v[64:67], v[104:107], a[184:187]
v_accvgpr_read_b32 v213, a161
v_accvgpr_read_b32 v214, a162
v_mfma_f32_16x16x32_bf16 a[184:187], v[68:71], v[152:155], a[184:187]
v_accvgpr_read_b32 v215, a163
v_cvt_pk_bf16_f32 v224, v208, v209
v_mfma_f32_16x16x32_bf16 a[188:191], v[64:67], v[108:111], a[188:191]
ds_read_b128 v[60:63], v8 offset:11264
v_cvt_pk_bf16_f32 v225, v210, v211
v_mfma_f32_16x16x32_bf16 a[188:191], v[68:71], v[156:159], a[188:191]
v_cvt_pk_bf16_f32 v226, v212, v213
v_cvt_pk_bf16_f32 v227, v214, v215
s_waitcnt lgkmcnt(4)
v_mfma_f32_16x16x32_bf16 a[192:195], v[72:75], v[128:131], a[192:195]
buffer_store_dwordx4 v[224:227], v2, s[8:11], s31 offen offset:1024 sc1
v_accvgpr_read_b32 v216, a148
v_mfma_f32_16x16x32_bf16 a[192:195], v[76:79], v[80:83], a[192:195]
v_accvgpr_read_b32 v217, a149
v_accvgpr_read_b32 v218, a150
v_mfma_f32_16x16x32_bf16 a[196:199], v[72:75], v[132:135], a[196:199]
ds_read_b128 v[64:67], v8 offset:12288
v_accvgpr_read_b32 v219, a151
v_accvgpr_read_b32 v220, a164
v_mfma_f32_16x16x32_bf16 a[196:199], v[76:79], v[84:87], a[196:199]
v_accvgpr_read_b32 v221, a165
v_accvgpr_read_b32 v222, a166
v_mfma_f32_16x16x32_bf16 a[200:203], v[72:75], v[136:139], a[200:203]
v_accvgpr_read_b32 v223, a167
v_cvt_pk_bf16_f32 v228, v216, v217
v_mfma_f32_16x16x32_bf16 a[200:203], v[76:79], v[88:91], a[200:203]
v_cvt_pk_bf16_f32 v229, v218, v219
v_cvt_pk_bf16_f32 v230, v220, v221
v_mfma_f32_16x16x32_bf16 a[204:207], v[72:75], v[140:143], a[204:207]
ds_read_b128 v[68:71], v8 offset:13312
v_cvt_pk_bf16_f32 v231, v222, v223
v_mfma_f32_16x16x32_bf16 a[204:207], v[76:79], v[92:95], a[204:207]
buffer_store_dwordx4 v[228:231], v4, s[8:11], s31 offen offset:1024 sc1
v_accvgpr_read_b32 v208, a152
s_waitcnt lgkmcnt(4)
v_mfma_f32_16x16x32_bf16 a[192:195], v[48:51], v[96:99], a[192:195]
v_accvgpr_read_b32 v209, a153
v_accvgpr_read_b32 v210, a154
v_mfma_f32_16x16x32_bf16 a[192:195], v[52:55], v[144:147], a[192:195]
v_accvgpr_read_b32 v211, a155
v_accvgpr_read_b32 v212, a168
v_mfma_f32_16x16x32_bf16 a[196:199], v[48:51], v[100:103], a[196:199]
ds_read_b128 v[72:75], v8 offset:14336
v_accvgpr_read_b32 v213, a169
v_accvgpr_read_b32 v214, a170
v_mfma_f32_16x16x32_bf16 a[196:199], v[52:55], v[148:151], a[196:199]
v_accvgpr_read_b32 v215, a171
v_cvt_pk_bf16_f32 v224, v208, v209
v_mfma_f32_16x16x32_bf16 a[200:203], v[48:51], v[104:107], a[200:203]
v_cvt_pk_bf16_f32 v225, v210, v211
v_cvt_pk_bf16_f32 v226, v212, v213
v_mfma_f32_16x16x32_bf16 a[200:203], v[52:55], v[152:155], a[200:203]
v_cvt_pk_bf16_f32 v227, v214, v215
buffer_store_dwordx4 v[224:227], v5, s[8:11], s31 offen offset:1024 sc1
v_mfma_f32_16x16x32_bf16 a[204:207], v[48:51], v[108:111], a[204:207]
ds_read_b128 v[76:79], v8 offset:15360
v_accvgpr_read_b32 v216, a156
v_mfma_f32_16x16x32_bf16 a[204:207], v[52:55], v[156:159], a[204:207]
v_accvgpr_read_b32 v217, a157
v_accvgpr_read_b32 v218, a158
s_waitcnt lgkmcnt(4)
v_mfma_f32_16x16x32_bf16 a[208:211], v[56:59], v[128:131], a[208:211]
v_mfma_f32_16x16x32_bf16 a[208:211], v[60:63], v[80:83], a[208:211]
v_mfma_f32_16x16x32_bf16 a[212:215], v[56:59], v[132:135], a[212:215]
s_waitcnt vmcnt(20)
s_barrier
ds_read_b128 v[48:51], v2 offset:0
v_mfma_f32_16x16x32_bf16 a[212:215], v[60:63], v[84:87], a[212:215]
v_mfma_f32_16x16x32_bf16 a[216:219], v[56:59], v[136:139], a[216:219]
v_accvgpr_read_b32 v219, a159
v_accvgpr_read_b32 v220, a172
v_mfma_f32_16x16x32_bf16 a[216:219], v[60:63], v[88:91], a[216:219]
v_accvgpr_read_b32 v221, a173
v_accvgpr_read_b32 v222, a174
v_mfma_f32_16x16x32_bf16 a[220:223], v[56:59], v[140:143], a[220:223]
ds_read_b128 v[52:55], v2 offset:1024
v_accvgpr_read_b32 v223, a175
v_mfma_f32_16x16x32_bf16 a[220:223], v[60:63], v[92:95], a[220:223]
v_cvt_pk_bf16_f32 v228, v216, v217
s_waitcnt lgkmcnt(4)
v_mfma_f32_16x16x32_bf16 a[208:211], v[64:67], v[96:99], a[208:211]
v_cvt_pk_bf16_f32 v229, v218, v219
v_cvt_pk_bf16_f32 v230, v220, v221
v_mfma_f32_16x16x32_bf16 a[208:211], v[68:71], v[144:147], a[208:211]
v_cvt_pk_bf16_f32 v231, v222, v223
buffer_store_dwordx4 v[228:231], v6, s[8:11], s31 offen offset:1024 sc1
v_mfma_f32_16x16x32_bf16 a[212:215], v[64:67], v[100:103], a[212:215]
ds_read_b128 v[56:59], v2 offset:2048
v_accvgpr_read_b32 v208, a176
v_mfma_f32_16x16x32_bf16 a[212:215], v[68:71], v[148:151], a[212:215]
v_accvgpr_read_b32 v209, a177
v_accvgpr_read_b32 v210, a178
v_mfma_f32_16x16x32_bf16 a[216:219], v[64:67], v[104:107], a[216:219]
v_accvgpr_read_b32 v211, a179
v_accvgpr_read_b32 v212, a192
v_mfma_f32_16x16x32_bf16 a[216:219], v[68:71], v[152:155], a[216:219]
v_accvgpr_read_b32 v213, a193
v_accvgpr_read_b32 v214, a194
v_mfma_f32_16x16x32_bf16 a[220:223], v[64:67], v[108:111], a[220:223]
ds_read_b128 v[60:63], v2 offset:3072
v_accvgpr_read_b32 v215, a195
v_cvt_pk_bf16_f32 v224, v208, v209
v_mfma_f32_16x16x32_bf16 a[220:223], v[68:71], v[156:159], a[220:223]
v_cvt_pk_bf16_f32 v225, v210, v211
v_cvt_pk_bf16_f32 v226, v212, v213
s_waitcnt lgkmcnt(4)
v_mfma_f32_16x16x32_bf16 a[224:227], v[72:75], v[128:131], a[224:227]
v_cvt_pk_bf16_f32 v227, v214, v215
buffer_store_dwordx4 v[224:227], v2, s[8:11], s31 offen offset:2048 sc1
v_mfma_f32_16x16x32_bf16 a[224:227], v[76:79], v[80:83], a[224:227]
v_accvgpr_read_b32 v216, a180
v_accvgpr_read_b32 v217, a181
v_mfma_f32_16x16x32_bf16 a[228:231], v[72:75], v[132:135], a[228:231]
ds_read_b128 v[64:67], v2 offset:4096
v_accvgpr_read_b32 v218, a182
v_accvgpr_read_b32 v219, a183
v_mfma_f32_16x16x32_bf16 a[228:231], v[76:79], v[84:87], a[228:231]
v_accvgpr_read_b32 v220, a196
v_accvgpr_read_b32 v221, a197
v_mfma_f32_16x16x32_bf16 a[232:235], v[72:75], v[136:139], a[232:235]
v_accvgpr_read_b32 v222, a198
v_accvgpr_read_b32 v223, a199
v_mfma_f32_16x16x32_bf16 a[232:235], v[76:79], v[88:91], a[232:235]
v_cvt_pk_bf16_f32 v228, v216, v217
v_cvt_pk_bf16_f32 v229, v218, v219
v_mfma_f32_16x16x32_bf16 a[236:239], v[72:75], v[140:143], a[236:239]
ds_read_b128 v[68:71], v2 offset:5120
v_cvt_pk_bf16_f32 v230, v220, v221
v_mfma_f32_16x16x32_bf16 a[236:239], v[76:79], v[92:95], a[236:239]
v_cvt_pk_bf16_f32 v231, v222, v223
buffer_store_dwordx4 v[228:231], v4, s[8:11], s31 offen offset:2048 sc1
s_waitcnt lgkmcnt(4)
v_mfma_f32_16x16x32_bf16 a[224:227], v[48:51], v[96:99], a[224:227]
v_accvgpr_read_b32 v208, a184
v_accvgpr_read_b32 v209, a185
v_mfma_f32_16x16x32_bf16 a[224:227], v[52:55], v[144:147], a[224:227]
v_accvgpr_read_b32 v210, a186
v_accvgpr_read_b32 v211, a187
v_mfma_f32_16x16x32_bf16 a[228:231], v[48:51], v[100:103], a[228:231]
v_accvgpr_read_b32 v212, a200
v_accvgpr_read_b32 v213, a201
v_mfma_f32_16x16x32_bf16 a[228:231], v[52:55], v[148:151], a[228:231]
v_accvgpr_read_b32 v214, a202
v_accvgpr_read_b32 v215, a203
v_mfma_f32_16x16x32_bf16 a[232:235], v[48:51], v[104:107], a[232:235]
v_cvt_pk_bf16_f32 v224, v208, v209
v_cvt_pk_bf16_f32 v225, v210, v211
v_mfma_f32_16x16x32_bf16 a[232:235], v[52:55], v[152:155], a[232:235]
v_cvt_pk_bf16_f32 v226, v212, v213
v_cvt_pk_bf16_f32 v227, v214, v215
v_mfma_f32_16x16x32_bf16 a[236:239], v[48:51], v[108:111], a[236:239]
buffer_store_dwordx4 v[224:227], v5, s[8:11], s31 offen offset:2048 sc1
v_accvgpr_read_b32 v216, a188
v_mfma_f32_16x16x32_bf16 a[236:239], v[52:55], v[156:159], a[236:239]
v_accvgpr_read_b32 v217, a189
v_accvgpr_read_b32 v218, a190
s_waitcnt lgkmcnt(2)
v_mfma_f32_16x16x32_bf16 a[240:243], v[56:59], v[128:131], a[240:243]
v_mfma_f32_16x16x32_bf16 a[240:243], v[60:63], v[80:83], a[240:243]
v_mfma_f32_16x16x32_bf16 a[244:247], v[56:59], v[132:135], a[244:247]
v_mfma_f32_16x16x32_bf16 a[244:247], v[60:63], v[84:87], a[244:247]
v_mfma_f32_16x16x32_bf16 a[248:251], v[56:59], v[136:139], a[248:251]
v_accvgpr_read_b32 v219, a191
v_accvgpr_read_b32 v220, a204
v_mfma_f32_16x16x32_bf16 a[248:251], v[60:63], v[88:91], a[248:251]
v_accvgpr_read_b32 v221, a205
v_accvgpr_read_b32 v222, a206
v_accvgpr_read_b32 v223, a207
v_mfma_f32_16x16x32_bf16 a[252:255], v[56:59], v[140:143], a[252:255]
v_cvt_pk_bf16_f32 v228, v216, v217
v_cvt_pk_bf16_f32 v229, v218, v219
v_cvt_pk_bf16_f32 v230, v220, v221
v_cvt_pk_bf16_f32 v231, v222, v223
v_mfma_f32_16x16x32_bf16 a[252:255], v[60:63], v[92:95], a[252:255]
buffer_store_dwordx4 v[228:231], v6, s[8:11], s31 offen offset:2048 sc1
v_accvgpr_read_b32 v208, a208
v_accvgpr_read_b32 v209, a209
v_accvgpr_read_b32 v210, a210
s_waitcnt lgkmcnt(0)
v_mfma_f32_16x16x32_bf16 a[240:243], v[64:67], v[96:99], a[240:243]
v_accvgpr_read_b32 v211, a211
v_accvgpr_read_b32 v212, a224
v_accvgpr_read_b32 v213, a225
v_accvgpr_read_b32 v214, a226
v_mfma_f32_16x16x32_bf16 a[240:243], v[68:71], v[144:147], a[240:243]
v_accvgpr_read_b32 v215, a227
v_cvt_pk_bf16_f32 v224, v208, v209
v_cvt_pk_bf16_f32 v225, v210, v211
v_cvt_pk_bf16_f32 v226, v212, v213
v_mfma_f32_16x16x32_bf16 a[244:247], v[64:67], v[100:103], a[244:247]
v_cvt_pk_bf16_f32 v227, v214, v215
buffer_store_dwordx4 v[224:227], v2, s[8:11], s31 offen offset:3072 sc1
v_accvgpr_read_b32 v216, a212
v_accvgpr_read_b32 v217, a213
v_mfma_f32_16x16x32_bf16 a[244:247], v[68:71], v[148:151], a[244:247]
v_accvgpr_read_b32 v218, a214
v_accvgpr_read_b32 v219, a215
v_accvgpr_read_b32 v220, a228
v_mfma_f32_16x16x32_bf16 a[248:251], v[64:67], v[104:107], a[248:251]
v_accvgpr_read_b32 v221, a229
v_accvgpr_read_b32 v222, a230
v_accvgpr_read_b32 v223, a231
v_cvt_pk_bf16_f32 v228, v216, v217
v_mfma_f32_16x16x32_bf16 a[248:251], v[68:71], v[152:155], a[248:251]
v_cvt_pk_bf16_f32 v229, v218, v219
v_cvt_pk_bf16_f32 v230, v220, v221
v_cvt_pk_bf16_f32 v231, v222, v223
buffer_store_dwordx4 v[228:231], v4, s[8:11], s31 offen offset:3072 sc1
v_mfma_f32_16x16x32_bf16 a[252:255], v[64:67], v[108:111], a[252:255]
v_accvgpr_read_b32 v208, a216
v_accvgpr_read_b32 v209, a217
v_accvgpr_read_b32 v210, a218
v_accvgpr_read_b32 v211, a219
v_mfma_f32_16x16x32_bf16 a[252:255], v[68:71], v[156:159], a[252:255]
v_accvgpr_read_b32 v212, a232
v_accvgpr_read_b32 v213, a233
v_accvgpr_read_b32 v214, a234
v_accvgpr_read_b32 v215, a235
s_barrier
v_cvt_pk_bf16_f32 v224, v208, v209
v_cvt_pk_bf16_f32 v225, v210, v211
v_cvt_pk_bf16_f32 v226, v212, v213
v_cvt_pk_bf16_f32 v227, v214, v215
buffer_store_dwordx4 v[224:227], v5, s[8:11], s31 offen offset:3072 sc1
v_accvgpr_read_b32 v216, a220
v_accvgpr_read_b32 v217, a221
v_accvgpr_read_b32 v218, a222
v_accvgpr_read_b32 v219, a223
v_accvgpr_read_b32 v220, a236
v_accvgpr_read_b32 v221, a237
v_accvgpr_read_b32 v222, a238
v_accvgpr_read_b32 v223, a239
v_cvt_pk_bf16_f32 v228, v216, v217
v_cvt_pk_bf16_f32 v229, v218, v219
v_cvt_pk_bf16_f32 v230, v220, v221
v_cvt_pk_bf16_f32 v231, v222, v223
buffer_store_dwordx4 v[228:231], v6, s[8:11], s31 offen offset:3072 sc1
v_accvgpr_read_b32 v208, a240
v_accvgpr_read_b32 v209, a241
v_accvgpr_read_b32 v210, a242
v_accvgpr_read_b32 v211, a243
v_accvgpr_read_b32 v212, a244
v_accvgpr_read_b32 v213, a245
v_accvgpr_read_b32 v214, a246
v_accvgpr_read_b32 v215, a247
v_cvt_pk_bf16_f32 v224, v208, v209
v_cvt_pk_bf16_f32 v225, v210, v211
v_cvt_pk_bf16_f32 v226, v212, v213
v_cvt_pk_bf16_f32 v227, v214, v215
s_nop 0
v_permlane16_swap_b32 v224, v226
v_permlane16_swap_b32 v225, v227
buffer_store_dwordx4 v[224:227], v9, s[8:11], s32 offen sc1
v_accvgpr_read_b32 v216, a248
v_accvgpr_read_b32 v217, a249
v_accvgpr_read_b32 v218, a250
v_accvgpr_read_b32 v219, a251
v_accvgpr_read_b32 v220, a252
v_accvgpr_read_b32 v221, a253
v_accvgpr_read_b32 v222, a254
v_accvgpr_read_b32 v223, a255
v_cvt_pk_bf16_f32 v228, v216, v217
v_cvt_pk_bf16_f32 v229, v218, v219
v_cvt_pk_bf16_f32 v230, v220, v221
v_cvt_pk_bf16_f32 v231, v222, v223
s_nop 0
v_permlane16_swap_b32 v228, v230
v_permlane16_swap_b32 v229, v231
buffer_store_dwordx4 v[228:231], v9, s[8:11], s33 offen sc1
s_lshl_b32 s47, s40, 2
s_add_u32 s47, s47, s4
s_lshl_b32 s47, s47, 5
s_add_u32 s47, s47, s41
s_lshl_b32 s47, s47, 2
s_add_u32 s47, s47, s77
s_add_u32 s47, s47, 32768
v_mov_b32 v14, 2146435072
v_cmp_eq_u32 vcc, 0, v1
s_nop 1
v_cndmask_b32 v14, v14, 0, vcc
v_mov_b32 v15, 1
s_waitcnt vmcnt(0)
buffer_store_dword v15, v14, s[8:11], s47 offen sc1
s_cmp_eq_u32 s7, 1
s_cbranch_scc1 L_last
s_cmp_eq_u32 s4, 3
s_cbranch_scc1 L_r_side
v_and_b32 v6, 7, v1
v_lshrrev_b32 v7, 3, v1
s_mul_i32 s22, s4, 24
v_add_u32 v7, s22, v7
s_and_b32 s23, s6, 1
s_lshl_b32 s23, s23, 3
v_add_u32 v8, s23, v6
v_lshlrev_b32 v8, 4, v8
v_lshl_add_u32 v4, v7, 8, v8
s_lshl_b32 s24, s5, 4
s_lshr_b32 s25, s6, 1
s_add_u32 s24, s24, s25
s_mul_i32 s20, s24, 18432
s_add_u32 s24, s20, 33480704
s_add_u32 s25, s24, 4096
buffer_load_dwordx4 v[16:19], v4, s[8:11], s24 offen offset:0 sc1
buffer_load_dwordx4 v[20:23], v4, s[8:11], s24 offen offset:2048 sc1
buffer_load_dwordx4 v[24:27], v4, s[8:11], s25 offen offset:0 sc1
s_lshl_b32 s24, s5, 2
s_lshr_b32 s25, s6, 3
s_add_u32 s24, s24, s25
s_lshl_b32 s24, s24, 7
s_add_u32 s24, s24, 32768
v_and_b32 v6, 31, v1
v_lshlrev_b32 v6, 2, v6
s_mov_b32 s52, 0
L_poll3:
buffer_load_dword v14, v6, s[8:11], s24 offen sc1
s_add_u32 s52, s52, 1
s_waitcnt vmcnt(0)
v_cmp_ne_u32 vcc, 0, v14
s_cmp_gt_u32 s52, 0x80000
s_cbranch_scc1 L_got3
s_cmp_eq_u64 vcc, exec
s_cbranch_scc0 L_poll3
L_got3:
s_add_u32 s24, s20, 76210176
s_add_u32 s25, s24, 4096
buffer_load_dwordx4 v[28:31], v4, s[8:11], s24 offen offset:0 sc1
buffer_load_dwordx4 v[32:35], v4, s[8:11], s24 offen offset:2048 sc1
buffer_load_dwordx4 v[36:39], v4, s[8:11], s25 offen offset:0 sc1
s_add_u32 s24, s20, 78569472
s_add_u32 s25, s24, 4096
buffer_load_dwordx4 v[40:43], v4, s[8:11], s24 offen offset:0 sc1
buffer_load_dwordx4 v[44:47], v4, s[8:11], s24 offen offset:2048 sc1
buffer_load_dwordx4 v[48:51], v4, s[8:11], s25 offen offset:0 sc1
s_add_u32 s24, s20, 80928768
s_add_u32 s25, s24, 4096
buffer_load_dwordx4 v[52:55], v4, s[8:11], s24 offen offset:0 sc1
buffer_load_dwordx4 v[56:59], v4, s[8:11], s24 offen offset:2048 sc1
buffer_load_dwordx4 v[60:63], v4, s[8:11], s25 offen offset:0 sc1
s_add_u32 s24, s20, 83288064
s_add_u32 s25, s24, 4096
buffer_load_dwordx4 v[64:67], v4, s[8:11], s24 offen offset:0 sc1
buffer_load_dwordx4 v[68:71], v4, s[8:11], s24 offen offset:2048 sc1
buffer_load_dwordx4 v[72:75], v4, s[8:11], s25 offen offset:0 sc1
s_add_u32 s24, s20, 85647360
s_add_u32 s25, s24, 4096
buffer_load_dwordx4 v[76:79], v4, s[8:11], s24 offen offset:0 sc1
buffer_load_dwordx4 v[80:83], v4, s[8:11], s24 offen offset:2048 sc1
buffer_load_dwordx4 v[84:87], v4, s[8:11], s25 offen offset:0 sc1
s_add_u32 s24, s20, 88006656
s_add_u32 s25, s24, 4096
buffer_load_dwordx4 v[88:91], v4, s[8:11], s24 offen offset:0 sc1
buffer_load_dwordx4 v[92:95], v4, s[8:11], s24 offen offset:2048 sc1
buffer_load_dwordx4 v[96:99], v4, s[8:11], s25 offen offset:0 sc1
s_add_u32 s24, s20, 90365952
s_add_u32 s25, s24, 4096
buffer_load_dwordx4 v[100:103], v4, s[8:11], s24 offen offset:0 sc1
buffer_load_dwordx4 v[104:107], v4, s[8:11], s24 offen offset:2048 sc1
buffer_load_dwordx4 v[108:111], v4, s[8:11], s25 offen offset:0 sc1
s_add_u32 s24, s20, 92725248
s_add_u32 s25, s24, 4096
buffer_load_dwordx4 v[112:115], v4, s[8:11], s24 offen offset:0 sc1
buffer_load_dwordx4 v[116:119], v4, s[8:11], s24 offen offset:2048 sc1
buffer_load_dwordx4 v[120:123], v4, s[8:11], s25 offen offset:0 sc1
s_waitcnt vmcnt(26)
v_lshlrev_b32 v128, 16, v16
v_and_b32 v129, 0xffff0000, v16
v_lshlrev_b32 v130, 16, v17
v_and_b32 v131, 0xffff0000, v17
v_lshlrev_b32 v132, 16, v18
v_and_b32 v133, 0xffff0000, v18
v_lshlrev_b32 v134, 16, v19
v_and_b32 v135, 0xffff0000, v19
s_waitcnt vmcnt(25)
v_lshlrev_b32 v136, 16, v20
v_and_b32 v137, 0xffff0000, v20
v_lshlrev_b32 v138, 16, v21
v_and_b32 v139, 0xffff0000, v21
v_lshlrev_b32 v140, 16, v22
v_and_b32 v141, 0xffff0000, v22
v_lshlrev_b32 v142, 16, v23
v_and_b32 v143, 0xffff0000, v23
s_waitcnt vmcnt(24)
v_lshlrev_b32 v144, 16, v24
v_and_b32 v145, 0xffff0000, v24
v_lshlrev_b32 v146, 16, v25
v_and_b32 v147, 0xffff0000, v25
v_lshlrev_b32 v148, 16, v26
v_and_b32 v149, 0xffff0000, v26
v_lshlrev_b32 v150, 16, v27
v_and_b32 v151, 0xffff0000, v27
s_waitcnt vmcnt(23)
v_lshlrev_b32 v6, 16, v28
v_and_b32 v7, 0xffff0000, v28
v_add_f32 v128, v128, v6
v_add_f32 v129, v129, v7
v_lshlrev_b32 v8, 16, v29
v_and_b32 v9, 0xffff0000, v29
v_add_f32 v130, v130, v8
v_add_f32 v131, v131, v9
v_lshlrev_b32 v6, 16, v30
v_and_b32 v7, 0xffff0000, v30
v_add_f32 v132, v132, v6
v_add_f32 v133, v133, v7
v_lshlrev_b32 v8, 16, v31
v_and_b32 v9, 0xffff0000, v31
v_add_f32 v134, v134, v8
v_add_f32 v135, v135, v9
s_waitcnt vmcnt(22)
v_lshlrev_b32 v6, 16, v32
v_and_b32 v7, 0xffff0000, v32
v_add_f32 v136, v136, v6
v_add_f32 v137, v137, v7
v_lshlrev_b32 v8, 16, v33
v_and_b32 v9, 0xffff0000, v33
v_add_f32 v138, v138, v8
v_add_f32 v139, v139, v9
v_lshlrev_b32 v6, 16, v34
v_and_b32 v7, 0xffff0000, v34
v_add_f32 v140, v140, v6
v_add_f32 v141, v141, v7
v_lshlrev_b32 v8, 16, v35
v_and_b32 v9, 0xffff0000, v35
v_add_f32 v142, v142, v8
v_add_f32 v143, v143, v9
s_waitcnt vmcnt(21)
v_lshlrev_b32 v6, 16, v36
v_and_b32 v7, 0xffff0000, v36
v_add_f32 v144, v144, v6
v_add_f32 v145, v145, v7
v_lshlrev_b32 v8, 16, v37
v_and_b32 v9, 0xffff0000, v37
v_add_f32 v146, v146, v8
v_add_f32 v147, v147, v9
v_lshlrev_b32 v6, 16, v38
v_and_b32 v7, 0xffff0000, v38
v_add_f32 v148, v148, v6
v_add_f32 v149, v149, v7
v_lshlrev_b32 v8, 16, v39
v_and_b32 v9, 0xffff0000, v39
v_add_f32 v150, v150, v8
v_add_f32 v151, v151, v9
s_waitcnt vmcnt(20)
v_lshlrev_b32 v6, 16, v40
v_and_b32 v7, 0xffff0000, v40
v_add_f32 v128, v128, v6
v_add_f32 v129, v129, v7
v_lshlrev_b32 v8, 16, v41
v_and_b32 v9, 0xffff0000, v41
v_add_f32 v130, v130, v8
v_add_f32 v131, v131, v9
v_lshlrev_b32 v6, 16, v42
v_and_b32 v7, 0xffff0000, v42
v_add_f32 v132, v132, v6
v_add_f32 v133, v133, v7
v_lshlrev_b32 v8, 16, v43
v_and_b32 v9, 0xffff0000, v43
v_add_f32 v134, v134, v8
v_add_f32 v135, v135, v9
s_waitcnt vmcnt(19)
v_lshlrev_b32 v6, 16, v44
v_and_b32 v7, 0xffff0000, v44
v_add_f32 v136, v136, v6
v_add_f32 v137, v137, v7
v_lshlrev_b32 v8, 16, v45
v_and_b32 v9, 0xffff0000, v45
v_add_f32 v138, v138, v8
v_add_f32 v139, v139, v9
v_lshlrev_b32 v6, 16, v46
v_and_b32 v7, 0xffff0000, v46
v_add_f32 v140, v140, v6
v_add_f32 v141, v141, v7
v_lshlrev_b32 v8, 16, v47
v_and_b32 v9, 0xffff0000, v47
v_add_f32 v142, v142, v8
v_add_f32 v143, v143, v9
s_waitcnt vmcnt(18)
v_lshlrev_b32 v6, 16, v48
v_and_b32 v7, 0xffff0000, v48
v_add_f32 v144, v144, v6
v_add_f32 v145, v145, v7
v_lshlrev_b32 v8, 16, v49
v_and_b32 v9, 0xffff0000, v49
v_add_f32 v146, v146, v8
v_add_f32 v147, v147, v9
v_lshlrev_b32 v6, 16, v50
v_and_b32 v7, 0xffff0000, v50
v_add_f32 v148, v148, v6
v_add_f32 v149, v149, v7
v_lshlrev_b32 v8, 16, v51
v_and_b32 v9, 0xffff0000, v51
v_add_f32 v150, v150, v8
v_add_f32 v151, v151, v9
s_waitcnt vmcnt(17)
v_lshlrev_b32 v6, 16, v52
v_and_b32 v7, 0xffff0000, v52
v_add_f32 v128, v128, v6
v_add_f32 v129, v129, v7
v_lshlrev_b32 v8, 16, v53
v_and_b32 v9, 0xffff0000, v53
v_add_f32 v130, v130, v8
v_add_f32 v131, v131, v9
v_lshlrev_b32 v6, 16, v54
v_and_b32 v7, 0xffff0000, v54
v_add_f32 v132, v132, v6
v_add_f32 v133, v133, v7
v_lshlrev_b32 v8, 16, v55
v_and_b32 v9, 0xffff0000, v55
v_add_f32 v134, v134, v8
v_add_f32 v135, v135, v9
s_waitcnt vmcnt(16)
v_lshlrev_b32 v6, 16, v56
v_and_b32 v7, 0xffff0000, v56
v_add_f32 v136, v136, v6
v_add_f32 v137, v137, v7
v_lshlrev_b32 v8, 16, v57
v_and_b32 v9, 0xffff0000, v57
v_add_f32 v138, v138, v8
v_add_f32 v139, v139, v9
v_lshlrev_b32 v6, 16, v58
v_and_b32 v7, 0xffff0000, v58
v_add_f32 v140, v140, v6
v_add_f32 v141, v141, v7
v_lshlrev_b32 v8, 16, v59
v_and_b32 v9, 0xffff0000, v59
v_add_f32 v142, v142, v8
v_add_f32 v143, v143, v9
s_waitcnt vmcnt(15)
v_lshlrev_b32 v6, 16, v60
v_and_b32 v7, 0xffff0000, v60
v_add_f32 v144, v144, v6
v_add_f32 v145, v145, v7
v_lshlrev_b32 v8, 16, v61
v_and_b32 v9, 0xffff0000, v61
v_add_f32 v146, v146, v8
v_add_f32 v147, v147, v9
v_lshlrev_b32 v6, 16, v62
v_and_b32 v7, 0xffff0000, v62
v_add_f32 v148, v148, v6
v_add_f32 v149, v149, v7
v_lshlrev_b32 v8, 16, v63
v_and_b32 v9, 0xffff0000, v63
v_add_f32 v150, v150, v8
v_add_f32 v151, v151, v9
s_waitcnt vmcnt(14)
v_lshlrev_b32 v6, 16, v64
v_and_b32 v7, 0xffff0000, v64
v_add_f32 v128, v128, v6
v_add_f32 v129, v129, v7
v_lshlrev_b32 v8, 16, v65
v_and_b32 v9, 0xffff0000, v65
v_add_f32 v130, v130, v8
v_add_f32 v131, v131, v9
v_lshlrev_b32 v6, 16, v66
v_and_b32 v7, 0xffff0000, v66
v_add_f32 v132, v132, v6
v_add_f32 v133, v133, v7
v_lshlrev_b32 v8, 16, v67
v_and_b32 v9, 0xffff0000, v67
v_add_f32 v134, v134, v8
v_add_f32 v135, v135, v9
s_waitcnt vmcnt(13)
v_lshlrev_b32 v6, 16, v68
v_and_b32 v7, 0xffff0000, v68
v_add_f32 v136, v136, v6
v_add_f32 v137, v137, v7
v_lshlrev_b32 v8, 16, v69
v_and_b32 v9, 0xffff0000, v69
v_add_f32 v138, v138, v8
v_add_f32 v139, v139, v9
v_lshlrev_b32 v6, 16, v70
v_and_b32 v7, 0xffff0000, v70
v_add_f32 v140, v140, v6
v_add_f32 v141, v141, v7
v_lshlrev_b32 v8, 16, v71
v_and_b32 v9, 0xffff0000, v71
v_add_f32 v142, v142, v8
v_add_f32 v143, v143, v9
s_waitcnt vmcnt(12)
v_lshlrev_b32 v6, 16, v72
v_and_b32 v7, 0xffff0000, v72
v_add_f32 v144, v144, v6
v_add_f32 v145, v145, v7
v_lshlrev_b32 v8, 16, v73
v_and_b32 v9, 0xffff0000, v73
v_add_f32 v146, v146, v8
v_add_f32 v147, v147, v9
v_lshlrev_b32 v6, 16, v74
v_and_b32 v7, 0xffff0000, v74
v_add_f32 v148, v148, v6
v_add_f32 v149, v149, v7
v_lshlrev_b32 v8, 16, v75
v_and_b32 v9, 0xffff0000, v75
v_add_f32 v150, v150, v8
v_add_f32 v151, v151, v9
s_waitcnt vmcnt(11)
v_lshlrev_b32 v6, 16, v76
v_and_b32 v7, 0xffff0000, v76
v_add_f32 v128, v128, v6
v_add_f32 v129, v129, v7
v_lshlrev_b32 v8, 16, v77
v_and_b32 v9, 0xffff0000, v77
v_add_f32 v130, v130, v8
v_add_f32 v131, v131, v9
v_lshlrev_b32 v6, 16, v78
v_and_b32 v7, 0xffff0000, v78
v_add_f32 v132, v132, v6
v_add_f32 v133, v133, v7
v_lshlrev_b32 v8, 16, v79
v_and_b32 v9, 0xffff0000, v79
v_add_f32 v134, v134, v8
v_add_f32 v135, v135, v9
s_waitcnt vmcnt(10)
v_lshlrev_b32 v6, 16, v80
v_and_b32 v7, 0xffff0000, v80
v_add_f32 v136, v136, v6
v_add_f32 v137, v137, v7
v_lshlrev_b32 v8, 16, v81
v_and_b32 v9, 0xffff0000, v81
v_add_f32 v138, v138, v8
v_add_f32 v139, v139, v9
v_lshlrev_b32 v6, 16, v82
v_and_b32 v7, 0xffff0000, v82
v_add_f32 v140, v140, v6
v_add_f32 v141, v141, v7
v_lshlrev_b32 v8, 16, v83
v_and_b32 v9, 0xffff0000, v83
v_add_f32 v142, v142, v8
v_add_f32 v143, v143, v9
s_waitcnt vmcnt(9)
v_lshlrev_b32 v6, 16, v84
v_and_b32 v7, 0xffff0000, v84
v_add_f32 v144, v144, v6
v_add_f32 v145, v145, v7
v_lshlrev_b32 v8, 16, v85
v_and_b32 v9, 0xffff0000, v85
v_add_f32 v146, v146, v8
v_add_f32 v147, v147, v9
v_lshlrev_b32 v6, 16, v86
v_and_b32 v7, 0xffff0000, v86
v_add_f32 v148, v148, v6
v_add_f32 v149, v149, v7
v_lshlrev_b32 v8, 16, v87
v_and_b32 v9, 0xffff0000, v87
v_add_f32 v150, v150, v8
v_add_f32 v151, v151, v9
s_waitcnt vmcnt(8)
v_lshlrev_b32 v6, 16, v88
v_and_b32 v7, 0xffff0000, v88
v_add_f32 v128, v128, v6
v_add_f32 v129, v129, v7
v_lshlrev_b32 v8, 16, v89
v_and_b32 v9, 0xffff0000, v89
v_add_f32 v130, v130, v8
v_add_f32 v131, v131, v9
v_lshlrev_b32 v6, 16, v90
v_and_b32 v7, 0xffff0000, v90
v_add_f32 v132, v132, v6
v_add_f32 v133, v133, v7
v_lshlrev_b32 v8, 16, v91
v_and_b32 v9, 0xffff0000, v91
v_add_f32 v134, v134, v8
v_add_f32 v135, v135, v9
s_waitcnt vmcnt(7)
v_lshlrev_b32 v6, 16, v92
v_and_b32 v7, 0xffff0000, v92
v_add_f32 v136, v136, v6
v_add_f32 v137, v137, v7
v_lshlrev_b32 v8, 16, v93
v_and_b32 v9, 0xffff0000, v93
v_add_f32 v138, v138, v8
v_add_f32 v139, v139, v9
v_lshlrev_b32 v6, 16, v94
v_and_b32 v7, 0xffff0000, v94
v_add_f32 v140, v140, v6
v_add_f32 v141, v141, v7
v_lshlrev_b32 v8, 16, v95
v_and_b32 v9, 0xffff0000, v95
v_add_f32 v142, v142, v8
v_add_f32 v143, v143, v9
s_waitcnt vmcnt(6)
v_lshlrev_b32 v6, 16, v96
v_and_b32 v7, 0xffff0000, v96
v_add_f32 v144, v144, v6
v_add_f32 v145, v145, v7
v_lshlrev_b32 v8, 16, v97
v_and_b32 v9, 0xffff0000, v97
v_add_f32 v146, v146, v8
v_add_f32 v147, v147, v9
v_lshlrev_b32 v6, 16, v98
v_and_b32 v7, 0xffff0000, v98
v_add_f32 v148, v148, v6
v_add_f32 v149, v149, v7
v_lshlrev_b32 v8, 16, v99
v_and_b32 v9, 0xffff0000, v99
v_add_f32 v150, v150, v8
v_add_f32 v151, v151, v9
s_waitcnt vmcnt(5)
v_lshlrev_b32 v6, 16, v100
v_and_b32 v7, 0xffff0000, v100
v_add_f32 v128, v128, v6
v_add_f32 v129, v129, v7
v_lshlrev_b32 v8, 16, v101
v_and_b32 v9, 0xffff0000, v101
v_add_f32 v130, v130, v8
v_add_f32 v131, v131, v9
v_lshlrev_b32 v6, 16, v102
v_and_b32 v7, 0xffff0000, v102
v_add_f32 v132, v132, v6
v_add_f32 v133, v133, v7
v_lshlrev_b32 v8, 16, v103
v_and_b32 v9, 0xffff0000, v103
v_add_f32 v134, v134, v8
v_add_f32 v135, v135, v9
s_waitcnt vmcnt(4)
v_lshlrev_b32 v6, 16, v104
v_and_b32 v7, 0xffff0000, v104
v_add_f32 v136, v136, v6
v_add_f32 v137, v137, v7
v_lshlrev_b32 v8, 16, v105
v_and_b32 v9, 0xffff0000, v105
v_add_f32 v138, v138, v8
v_add_f32 v139, v139, v9
v_lshlrev_b32 v6, 16, v106
v_and_b32 v7, 0xffff0000, v106
v_add_f32 v140, v140, v6
v_add_f32 v141, v141, v7
v_lshlrev_b32 v8, 16, v107
v_and_b32 v9, 0xffff0000, v107
v_add_f32 v142, v142, v8
v_add_f32 v143, v143, v9
s_waitcnt vmcnt(3)
v_lshlrev_b32 v6, 16, v108
v_and_b32 v7, 0xffff0000, v108
v_add_f32 v144, v144, v6
v_add_f32 v145, v145, v7
v_lshlrev_b32 v8, 16, v109
v_and_b32 v9, 0xffff0000, v109
v_add_f32 v146, v146, v8
v_add_f32 v147, v147, v9
v_lshlrev_b32 v6, 16, v110
v_and_b32 v7, 0xffff0000, v110
v_add_f32 v148, v148, v6
v_add_f32 v149, v149, v7
v_lshlrev_b32 v8, 16, v111
v_and_b32 v9, 0xffff0000, v111
v_add_f32 v150, v150, v8
v_add_f32 v151, v151, v9
s_waitcnt vmcnt(2)
v_lshlrev_b32 v6, 16, v112
v_and_b32 v7, 0xffff0000, v112
v_add_f32 v128, v128, v6
v_add_f32 v129, v129, v7
v_lshlrev_b32 v8, 16, v113
v_and_b32 v9, 0xffff0000, v113
v_add_f32 v130, v130, v8
v_add_f32 v131, v131, v9
v_lshlrev_b32 v6, 16, v114
v_and_b32 v7, 0xffff0000, v114
v_add_f32 v132, v132, v6
v_add_f32 v133, v133, v7
v_lshlrev_b32 v8, 16, v115
v_and_b32 v9, 0xffff0000, v115
v_add_f32 v134, v134, v8
v_add_f32 v135, v135, v9
s_waitcnt vmcnt(1)
v_lshlrev_b32 v6, 16, v116
v_and_b32 v7, 0xffff0000, v116
v_add_f32 v136, v136, v6
v_add_f32 v137, v137, v7
v_lshlrev_b32 v8, 16, v117
v_and_b32 v9, 0xffff0000, v117
v_add_f32 v138, v138, v8
v_add_f32 v139, v139, v9
v_lshlrev_b32 v6, 16, v118
v_and_b32 v7, 0xffff0000, v118
v_add_f32 v140, v140, v6
v_add_f32 v141, v141, v7
v_lshlrev_b32 v8, 16, v119
v_and_b32 v9, 0xffff0000, v119
v_add_f32 v142, v142, v8
v_add_f32 v143, v143, v9
s_waitcnt vmcnt(0)
v_lshlrev_b32 v6, 16, v120
v_and_b32 v7, 0xffff0000, v120
v_add_f32 v144, v144, v6
v_add_f32 v145, v145, v7
v_lshlrev_b32 v8, 16, v121
v_and_b32 v9, 0xffff0000, v121
v_add_f32 v146, v146, v8
v_add_f32 v147, v147, v9
v_lshlrev_b32 v6, 16, v122
v_and_b32 v7, 0xffff0000, v122
v_add_f32 v148, v148, v6
v_add_f32 v149, v149, v7
v_lshlrev_b32 v8, 16, v123
v_and_b32 v9, 0xffff0000, v123
v_add_f32 v150, v150, v8
v_add_f32 v151, v151, v9
v_cvt_pk_bf16_f32 v152, v128, v129
v_cvt_pk_bf16_f32 v153, v130, v131
v_cvt_pk_bf16_f32 v154, v132, v133
v_cvt_pk_bf16_f32 v155, v134, v135
v_cvt_pk_bf16_f32 v156, v136, v137
v_cvt_pk_bf16_f32 v157, v138, v139
v_cvt_pk_bf16_f32 v158, v140, v141
v_cvt_pk_bf16_f32 v159, v142, v143
v_cvt_pk_bf16_f32 v160, v144, v145
v_cvt_pk_bf16_f32 v161, v146, v147
v_cvt_pk_bf16_f32 v162, v148, v149
v_cvt_pk_bf16_f32 v163, v150, v151
s_add_u32 s24, s20, 26402816
s_add_u32 s25, s24, 4096
buffer_store_dwordx4 v[152:155], v4, s[8:11], s24 offen offset:0 sc1
buffer_store_dwordx4 v[156:159], v4, s[8:11], s24 offen offset:2048 sc1
buffer_store_dwordx4 v[160:163], v4, s[8:11], s25 offen offset:0 sc1
v_add_f32 v6, v128, v129
v_mul_f32 v7, v128, v128
v_mul_f32 v9, v129, v129
v_mov_b32 v8, 0
v_add_f32 v6, v6, v130
v_add_f32 v8, v8, v131
v_fmac_f32 v7, v130, v130
v_fmac_f32 v9, v131, v131
v_add_f32 v6, v6, v132
v_add_f32 v8, v8, v133
v_fmac_f32 v7, v132, v132
v_fmac_f32 v9, v133, v133
v_add_f32 v6, v6, v134
v_add_f32 v8, v8, v135
v_fmac_f32 v7, v134, v134
v_fmac_f32 v9, v135, v135
v_add_f32 v6, v6, v136
v_add_f32 v8, v8, v137
v_fmac_f32 v7, v136, v136
v_fmac_f32 v9, v137, v137
v_add_f32 v6, v6, v138
v_add_f32 v8, v8, v139
v_fmac_f32 v7, v138, v138
v_fmac_f32 v9, v139, v139
v_add_f32 v6, v6, v140
v_add_f32 v8, v8, v141
v_fmac_f32 v7, v140, v140
v_fmac_f32 v9, v141, v141
v_add_f32 v6, v6, v142
v_add_f32 v8, v8, v143
v_fmac_f32 v7, v142, v142
v_fmac_f32 v9, v143, v143
v_add_f32 v6, v6, v144
v_add_f32 v8, v8, v145
v_fmac_f32 v7, v144, v144
v_fmac_f32 v9, v145, v145
v_add_f32 v6, v6, v146
v_add_f32 v8, v8, v147
v_fmac_f32 v7, v146, v146
v_fmac_f32 v9, v147, v147
v_add_f32 v6, v6, v148
v_add_f32 v8, v8, v149
v_fmac_f32 v7, v148, v148
v_fmac_f32 v9, v149, v149
v_add_f32 v6, v6, v150
v_add_f32 v8, v8, v151
v_fmac_f32 v7, v150, v150
v_fmac_f32 v9, v151, v151
v_add_f32 v6, v6, v8
v_add_f32 v7, v7, v9
s_nop 0
v_add_f32_dpp v6, v6, v6 row_ror:8 row_mask:0xf bank_mask:0xf
v_add_f32_dpp v7, v7, v7 row_ror:8 row_mask:0xf bank_mask:0xf
v_mov_b32 v8, v6
v_mov_b32 v9, v7
s_nop 0
v_permlane16_swap_b32 v6, v8
v_permlane16_swap_b32 v7, v9
v_add_f32 v6, v6, v8
v_add_f32 v7, v7, v9
v_mov_b32 v8, v6
v_mov_b32 v9, v7
s_nop 0
v_permlane32_swap_b32 v6, v8
v_permlane32_swap_b32 v7, v9
v_add_f32 v6, v6, v8
v_add_f32 v7, v7, v9
v_and_b32 v10, 7, v1
v_lshlrev_b32 v10, 3, v10
v_add_u32 v10, 147456, v10
s_lshl_b32 s24, s4, 6
v_add_u32 v11, s24, v10
ds_write_b64 v11, v[6:7]
s_waitcnt lgkmcnt(0)
s_barrier
ds_read_b64 v[6:7], v10
ds_read_b64 v[8:9], v10 offset:64
ds_read_b64 v[12:13], v10 offset:128
s_waitcnt lgkmcnt(0)
v_add_f32 v6, v6, v8
v_add_f32 v7, v7, v9
v_add_f32 v6, v6, v12
v_add_f32 v7, v7, v13
v_mul_f32 v6, 0x3ae38e39, v6
v_mul_f32 v7, 0x3ae38e39, v7
v_fma_f32 v7, -v6, v6, v7
v_max_f32 v7, 0, v7
v_add_f32 v7, 0x3727c5ac, v7
v_rsq_f32 v7, v7
s_nop 0
v_mul_f32 v6, v6, v7
v_fma_f32 v128, v128, v7, -v6
v_fma_f32 v129, v129, v7, -v6
v_fma_f32 v130, v130, v7, -v6
v_fma_f32 v131, v131, v7, -v6
v_fma_f32 v132, v132, v7, -v6
v_fma_f32 v133, v133, v7, -v6
v_fma_f32 v134, v134, v7, -v6
v_fma_f32 v135, v135, v7, -v6
v_fma_f32 v136, v136, v7, -v6
v_fma_f32 v137, v137, v7, -v6
v_fma_f32 v138, v138, v7, -v6
v_fma_f32 v139, v139, v7, -v6
v_fma_f32 v140, v140, v7, -v6
v_fma_f32 v141, v141, v7, -v6
v_fma_f32 v142, v142, v7, -v6
v_fma_f32 v143, v143, v7, -v6
v_fma_f32 v144, v144, v7, -v6
v_fma_f32 v145, v145, v7, -v6
v_fma_f32 v146, v146, v7, -v6
v_fma_f32 v147, v147, v7, -v6
v_fma_f32 v148, v148, v7, -v6
v_fma_f32 v149, v149, v7, -v6
v_fma_f32 v150, v150, v7, -v6
v_fma_f32 v151, v151, v7, -v6
v_cvt_pk_bf16_f32 v168, v128, v129
v_cvt_pk_bf16_f32 v169, v130, v131
v_cvt_pk_bf16_f32 v170, v132, v133
v_cvt_pk_bf16_f32 v171, v134, v135
v_cvt_pk_bf16_f32 v172, v136, v137
v_cvt_pk_bf16_f32 v173, v138, v139
v_cvt_pk_bf16_f32 v174, v140, v141
v_cvt_pk_bf16_f32 v175, v142, v143
v_cvt_pk_bf16_f32 v176, v144, v145
v_cvt_pk_bf16_f32 v177, v146, v147
v_cvt_pk_bf16_f32 v178, v148, v149
v_cvt_pk_bf16_f32 v179, v150, v151
s_add_u32 s24, s20, 21684224
s_add_u32 s25, s24, 4096
buffer_store_dwordx4 v[168:171], v4, s[8:11], s24 offen offset:0 sc1
buffer_store_dwordx4 v[172:175], v4, s[8:11], s24 offen offset:2048 sc1
buffer_store_dwordx4 v[176:179], v4, s[8:11], s25 offen offset:0 sc1
s_lshl_b32 s24, s5, 4
s_lshr_b32 s25, s6, 1
s_add_u32 s24, s24, s25
s_lshl_b32 s24, s24, 3
s_and_b32 s25, s6, 1
s_mul_i32 s25, s25, 3
s_add_u32 s24, s24, s25
s_add_u32 s24, s24, s4
s_lshl_b32 s24, s24, 2
s_add_u32 s24, s24, 106496
v_mov_b32 v14, 2146435072
v_cmp_eq_u32 vcc, 0, v1
s_nop 1
v_cndmask_b32 v14, v14, 0, vcc
v_mov_b32 v15, 1
s_waitcnt vmcnt(0)
buffer_store_dword v15, v14, s[8:11], s24 offen sc1
s_branch L_r_done
L_r_side:
s_lshr_b32 s20, s6, 4
s_lshl_b32 s21, s5, 1
s_add_u32 s20, s20, s21
s_and_b32 s21, s6, 15
s_mul_i32 s22, s21, 147456
s_add_u32 s22, s22, 262144
s_mov_b32 s23, 0
s_add_u32 m0, s23, 0
s_add_u32 s40, s22, 0
buffer_load_dwordx4 v2, s[8:11], s40 offen offset:0 lds
buffer_load_dwordx4 v2, s[8:11], s40 offen offset:1024 lds
buffer_load_dwordx4 v2, s[8:11], s40 offen offset:2048 lds
buffer_load_dwordx4 v2, s[8:11], s40 offen offset:3072 lds
s_add_u32 m0, s23, 4096
s_add_u32 s40, s22, 4096
buffer_load_dwordx4 v2, s[8:11], s40 offen offset:0 lds
buffer_load_dwordx4 v2, s[8:11], s40 offen offset:1024 lds
buffer_load_dwordx4 v2, s[8:11], s40 offen offset:2048 lds
buffer_load_dwordx4 v2, s[8:11], s40 offen offset:3072 lds
s_add_u32 m0, s23, 8192
s_add_u32 s40, s22, 8192
buffer_load_dwordx4 v2, s[8:11], s40 offen offset:0 lds
buffer_load_dwordx4 v2, s[8:11], s40 offen offset:1024 lds
buffer_load_dwordx4 v2, s[8:11], s40 offen offset:2048 lds
buffer_load_dwordx4 v2, s[8:11], s40 offen offset:3072 lds
s_add_u32 m0, s23, 12288
s_add_u32 s40, s22, 12288
buffer_load_dwordx4 v2, s[8:11], s40 offen offset:0 lds
buffer_load_dwordx4 v2, s[8:11], s40 offen offset:1024 lds
buffer_load_dwordx4 v2, s[8:11], s40 offen offset:2048 lds
buffer_load_dwordx4 v2, s[8:11], s40 offen offset:3072 lds
s_add_u32 m0, s23, 16384
s_add_u32 s40, s22, 16384
buffer_load_dwordx4 v2, s[8:11], s40 offen offset:0 lds
buffer_load_dwordx4 v2, s[8:11], s40 offen offset:1024 lds
buffer_load_dwordx4 v2, s[8:11], s40 offen offset:2048 lds
buffer_load_dwordx4 v2, s[8:11], s40 offen offset:3072 lds
s_add_u32 m0, s23, 20480
s_add_u32 s40, s22, 20480
buffer_load_dwordx4 v2, s[8:11], s40 offen offset:0 lds
buffer_load_dwordx4 v2, s[8:11], s40 offen offset:1024 lds
buffer_load_dwordx4 v2, s[8:11], s40 offen offset:2048 lds
buffer_load_dwordx4 v2, s[8:11], s40 offen offset:3072 lds
s_add_u32 m0, s23, 24576
s_add_u32 s40, s22, 24576
buffer_load_dwordx4 v2, s[8:11], s40 offen offset:0 lds
buffer_load_dwordx4 v2, s[8:11], s40 offen offset:1024 lds
buffer_load_dwordx4 v2, s[8:11], s40 offen offset:2048 lds
buffer_load_dwordx4 v2, s[8:11], s40 offen offset:3072 lds
s_add_u32 m0, s23, 28672
s_add_u32 s40, s22, 28672
buffer_load_dwordx4 v2, s[8:11], s40 offen offset:0 lds
buffer_load_dwordx4 v2, s[8:11], s40 offen offset:1024 lds
buffer_load_dwordx4 v2, s[8:11], s40 offen offset:2048 lds
buffer_load_dwordx4 v2, s[8:11], s40 offen offset:3072 lds
s_add_u32 m0, s23, 32768
s_add_u32 s40, s22, 32768
buffer_load_dwordx4 v2, s[8:11], s40 offen offset:0 lds
buffer_load_dwordx4 v2, s[8:11], s40 offen offset:1024 lds
buffer_load_dwordx4 v2, s[8:11], s40 offen offset:2048 lds
buffer_load_dwordx4 v2, s[8:11], s40 offen offset:3072 lds
s_add_u32 m0, s23, 36864
s_add_u32 s40, s22, 36864
buffer_load_dwordx4 v2, s[8:11], s40 offen offset:0 lds
buffer_load_dwordx4 v2, s[8:11], s40 offen offset:1024 lds
buffer_load_dwordx4 v2, s[8:11], s40 offen offset:2048 lds
buffer_load_dwordx4 v2, s[8:11], s40 offen offset:3072 lds
s_add_u32 m0, s23, 40960
s_add_u32 s40, s22, 40960
buffer_load_dwordx4 v2, s[8:11], s40 offen offset:0 lds
buffer_load_dwordx4 v2, s[8:11], s40 offen offset:1024 lds
buffer_load_dwordx4 v2, s[8:11], s40 offen offset:2048 lds
buffer_load_dwordx4 v2, s[8:11], s40 offen offset:3072 lds
s_add_u32 m0, s23, 45056
s_add_u32 s40, s22, 45056
buffer_load_dwordx4 v2, s[8:11], s40 offen offset:0 lds
buffer_load_dwordx4 v2, s[8:11], s40 offen offset:1024 lds
buffer_load_dwordx4 v2, s[8:11], s40 offen offset:2048 lds
buffer_load_dwordx4 v2, s[8:11], s40 offen offset:3072 lds
s_add_u32 m0, s23, 49152
s_add_u32 s40, s22, 49152
buffer_load_dwordx4 v2, s[8:11], s40 offen offset:0 lds
buffer_load_dwordx4 v2, s[8:11], s40 offen offset:1024 lds
buffer_load_dwordx4 v2, s[8:11], s40 offen offset:2048 lds
buffer_load_dwordx4 v2, s[8:11], s40 offen offset:3072 lds
s_add_u32 m0, s23, 53248
s_add_u32 s40, s22, 53248
buffer_load_dwordx4 v2, s[8:11], s40 offen offset:0 lds
buffer_load_dwordx4 v2, s[8:11], s40 offen offset:1024 lds
buffer_load_dwordx4 v2, s[8:11], s40 offen offset:2048 lds
buffer_load_dwordx4 v2, s[8:11], s40 offen offset:3072 lds
s_add_u32 m0, s23, 57344
s_add_u32 s40, s22, 57344
buffer_load_dwordx4 v2, s[8:11], s40 offen offset:0 lds
buffer_load_dwordx4 v2, s[8:11], s40 offen offset:1024 lds
buffer_load_dwordx4 v2, s[8:11], s40 offen offset:2048 lds
buffer_load_dwordx4 v2, s[8:11], s40 offen offset:3072 lds
s_add_u32 m0, s23, 61440
s_add_u32 s40, s22, 61440
buffer_load_dwordx4 v2, s[8:11], s40 offen offset:0 lds
buffer_load_dwordx4 v2, s[8:11], s40 offen offset:1024 lds
buffer_load_dwordx4 v2, s[8:11], s40 offen offset:2048 lds
buffer_load_dwordx4 v2, s[8:11], s40 offen offset:3072 lds
s_add_u32 m0, s23, 65536
s_add_u32 s40, s22, 65536
buffer_load_dwordx4 v2, s[8:11], s40 offen offset:0 lds
buffer_load_dwordx4 v2, s[8:11], s40 offen offset:1024 lds
buffer_load_dwordx4 v2, s[8:11], s40 offen offset:2048 lds
buffer_load_dwordx4 v2, s[8:11], s40 offen offset:3072 lds
s_add_u32 m0, s23, 69632
s_add_u32 s40, s22, 69632
buffer_load_dwordx4 v2, s[8:11], s40 offen offset:0 lds
buffer_load_dwordx4 v2, s[8:11], s40 offen offset:1024 lds
buffer_load_dwordx4 v2, s[8:11], s40 offen offset:2048 lds
buffer_load_dwordx4 v2, s[8:11], s40 offen offset:3072 lds
s_add_u32 m0, s23, 73728
s_add_u32 s40, s22, 73728
buffer_load_dwordx4 v2, s[8:11], s40 offen offset:0 lds
buffer_load_dwordx4 v2, s[8:11], s40 offen offset:1024 lds
buffer_load_dwordx4 v2, s[8:11], s40 offen offset:2048 lds
buffer_load_dwordx4 v2, s[8:11], s40 offen offset:3072 lds
s_add_u32 m0, s23, 77824
s_add_u32 s40, s22, 77824
buffer_load_dwordx4 v2, s[8:11], s40 offen offset:0 lds
buffer_load_dwordx4 v2, s[8:11], s40 offen offset:1024 lds
buffer_load_dwordx4 v2, s[8:11], s40 offen offset:2048 lds
buffer_load_dwordx4 v2, s[8:11], s40 offen offset:3072 lds
s_add_u32 m0, s23, 81920
s_add_u32 s40, s22, 81920
buffer_load_dwordx4 v2, s[8:11], s40 offen offset:0 lds
buffer_load_dwordx4 v2, s[8:11], s40 offen offset:1024 lds
buffer_load_dwordx4 v2, s[8:11], s40 offen offset:2048 lds
buffer_load_dwordx4 v2, s[8:11], s40 offen offset:3072 lds
s_add_u32 m0, s23, 86016
s_add_u32 s40, s22, 86016
buffer_load_dwordx4 v2, s[8:11], s40 offen offset:0 lds
buffer_load_dwordx4 v2, s[8:11], s40 offen offset:1024 lds
buffer_load_dwordx4 v2, s[8:11], s40 offen offset:2048 lds
buffer_load_dwordx4 v2, s[8:11], s40 offen offset:3072 lds
s_add_u32 m0, s23, 90112
s_add_u32 s40, s22, 90112
buffer_load_dwordx4 v2, s[8:11], s40 offen offset:0 lds
buffer_load_dwordx4 v2, s[8:11], s40 offen offset:1024 lds
buffer_load_dwordx4 v2, s[8:11], s40 offen offset:2048 lds
buffer_load_dwordx4 v2, s[8:11], s40 offen offset:3072 lds
s_add_u32 m0, s23, 94208
s_add_u32 s40, s22, 94208
buffer_load_dwordx4 v2, s[8:11], s40 offen offset:0 lds
buffer_load_dwordx4 v2, s[8:11], s40 offen offset:1024 lds
buffer_load_dwordx4 v2, s[8:11], s40 offen offset:2048 lds
buffer_load_dwordx4 v2, s[8:11], s40 offen offset:3072 lds
s_add_u32 m0, s23, 98304
s_add_u32 s40, s22, 98304
buffer_load_dwordx4 v2, s[8:11], s40 offen offset:0 lds
buffer_load_dwordx4 v2, s[8:11], s40 offen offset:1024 lds
buffer_load_dwordx4 v2, s[8:11], s40 offen offset:2048 lds
buffer_load_dwordx4 v2, s[8:11], s40 offen offset:3072 lds
s_add_u32 m0, s23, 102400
s_add_u32 s40, s22, 102400
buffer_load_dwordx4 v2, s[8:11], s40 offen offset:0 lds
buffer_load_dwordx4 v2, s[8:11], s40 offen offset:1024 lds
buffer_load_dwordx4 v2, s[8:11], s40 offen offset:2048 lds
buffer_load_dwordx4 v2, s[8:11], s40 offen offset:3072 lds
s_add_u32 m0, s23, 106496
s_add_u32 s40, s22, 106496
buffer_load_dwordx4 v2, s[8:11], s40 offen offset:0 lds
buffer_load_dwordx4 v2, s[8:11], s40 offen offset:1024 lds
buffer_load_dwordx4 v2, s[8:11], s40 offen offset:2048 lds
buffer_load_dwordx4 v2, s[8:11], s40 offen offset:3072 lds
s_add_u32 m0, s23, 110592
s_add_u32 s40, s22, 110592
buffer_load_dwordx4 v2, s[8:11], s40 offen offset:0 lds
buffer_load_dwordx4 v2, s[8:11], s40 offen offset:1024 lds
buffer_load_dwordx4 v2, s[8:11], s40 offen offset:2048 lds
buffer_load_dwordx4 v2, s[8:11], s40 offen offset:3072 lds
s_add_u32 m0, s23, 114688
s_add_u32 s40, s22, 114688
buffer_load_dwordx4 v2, s[8:11], s40 offen offset:0 lds
buffer_load_dwordx4 v2, s[8:11], s40 offen offset:1024 lds
buffer_load_dwordx4 v2, s[8:11], s40 offen offset:2048 lds
buffer_load_dwordx4 v2, s[8:11], s40 offen offset:3072 lds
s_add_u32 m0, s23, 118784
s_add_u32 s40, s22, 118784
buffer_load_dwordx4 v2, s[8:11], s40 offen offset:0 lds
buffer_load_dwordx4 v2, s[8:11], s40 offen offset:1024 lds
buffer_load_dwordx4 v2, s[8:11], s40 offen offset:2048 lds
buffer_load_dwordx4 v2, s[8:11], s40 offen offset:3072 lds
s_add_u32 m0, s23, 122880
s_add_u32 s40, s22, 122880
buffer_load_dwordx4 v2, s[8:11], s40 offen offset:0 lds
buffer_load_dwordx4 v2, s[8:11], s40 offen offset:1024 lds
buffer_load_dwordx4 v2, s[8:11], s40 offen offset:2048 lds
buffer_load_dwordx4 v2, s[8:11], s40 offen offset:3072 lds
s_add_u32 m0, s23, 126976
s_add_u32 s40, s22, 126976
buffer_load_dwordx4 v2, s[8:11], s40 offen offset:0 lds
buffer_load_dwordx4 v2, s[8:11], s40 offen offset:1024 lds
buffer_load_dwordx4 v2, s[8:11], s40 offen offset:2048 lds
buffer_load_dwordx4 v2, s[8:11], s40 offen offset:3072 lds
s_add_u32 m0, s23, 131072
s_add_u32 s40, s22, 131072
buffer_load_dwordx4 v2, s[8:11], s40 offen offset:0 lds
buffer_load_dwordx4 v2, s[8:11], s40 offen offset:1024 lds
buffer_load_dwordx4 v2, s[8:11], s40 offen offset:2048 lds
buffer_load_dwordx4 v2, s[8:11], s40 offen offset:3072 lds
s_add_u32 m0, s23, 135168
s_add_u32 s40, s22, 135168
buffer_load_dwordx4 v2, s[8:11], s40 offen offset:0 lds
buffer_load_dwordx4 v2, s[8:11], s40 offen offset:1024 lds
buffer_load_dwordx4 v2, s[8:11], s40 offen offset:2048 lds
buffer_load_dwordx4 v2, s[8:11], s40 offen offset:3072 lds
s_add_u32 m0, s23, 139264
s_add_u32 s40, s22, 139264
buffer_load_dwordx4 v2, s[8:11], s40 offen offset:0 lds
buffer_load_dwordx4 v2, s[8:11], s40 offen offset:1024 lds
buffer_load_dwordx4 v2, s[8:11], s40 offen offset:2048 lds
buffer_load_dwordx4 v2, s[8:11], s40 offen offset:3072 lds
s_add_u32 m0, s23, 143360
s_add_u32 s40, s22, 143360
buffer_load_dwordx4 v2, s[8:11], s40 offen offset:0 lds
buffer_load_dwordx4 v2, s[8:11], s40 offen offset:1024 lds
buffer_load_dwordx4 v2, s[8:11], s40 offen offset:2048 lds
buffer_load_dwordx4 v2, s[8:11], s40 offen offset:3072 lds
s_barrier
L_r_done:
s_mov_b32 s70, 21684224
s_mov_b32 s71, 26402816
s_mov_b32 s72, 31121408
s_mov_b32 s73, 35840000
s_mov_b32 s74, 38330368
s_mov_b32 s75, 57335808
s_mov_b32 s76, 95084544
s_mov_b32 s77, 65536
s_mov_b32 s7, 1
s_lshr_b32 s20, s6, 4
s_lshl_b32 s21, s5, 1
s_add_u32 s20, s20, s21
s_and_b32 s21, s6, 15
s_cmp_eq_u32 s4, 0
s_cbranch_scc0 L_a1_go
v_mul_u32_u24 v6, 43, v1
v_lshrrev_b32 v6, 8, v6
v_mul_u32_u24 v7, 6, v6
v_sub_u32 v7, v1, v7
v_min_u32 v6, 8, v6
s_lshl_b32 s22, s20, 3
s_sub_u32 s22, s22, 1
v_add_u32 v6, s22, v6
v_max_i32 v6, 0, v6
v_lshlrev_b32 v6, 3, v6
v_add_lshl_u32 v6, v6, v7, 2
s_add_u32 s22, s77, 40960
s_mov_b32 s52, 0
L_poll4:
buffer_load_dword v14, v6, s[8:11], s22 offen sc1
s_add_u32 s52, s52, 1
s_waitcnt vmcnt(0)
v_cmp_ne_u32 vcc, 0, v14
s_cmp_gt_u32 s52, 0x80000
s_cbranch_scc1 L_got4
s_cmp_eq_u64 vcc, exec
s_cbranch_scc0 L_poll4
L_got4:
L_a1_go:
s_barrier
s_branch L_layer
L_last:
s_cmp_eq_u32 s4, 3
s_cbranch_scc1 L_end
v_and_b32 v6, 7, v1
v_lshrrev_b32 v7, 3, v1
s_mul_i32 s22, s4, 24
v_add_u32 v7, s22, v7
s_and_b32 s23, s6, 1
s_lshl_b32 s23, s23, 3
v_add_u32 v8, s23, v6
v_lshlrev_b32 v8, 4, v8
v_lshl_add_u32 v4, v7, 8, v8
s_lshl_b32 s24, s5, 4
s_lshr_b32 s25, s6, 1
s_add_u32 s24, s24, s25
s_mul_i32 s20, s24, 18432
s_lshl_b32 s24, s5, 8
s_lshl_b32 s25, s6, 3
s_add_u32 s24, s24, s25
s_and_b32 s25, s24, 1023
s_lshl_b32 s25, s25, 1
s_lshr_b32 s24, s24, 10
s_add_u32 s24, s24, s25
s_mul_i32 s21, s24, 1152
v_mul_u32_u24 v8, 2304, v6
v_lshl_add_u32 v5, v7, 4, v8
s_load_dwordx2 s[12:13], s[0:1], 56
s_waitcnt lgkmcnt(0)
s_mov_b32 s16, s12
s_and_b32 s17, s13, 0xffff
s_mov_b32 s18, 2359296
s_mov_b32 s19, 0x20000
s_add_u32 s24, s20, 35840000
s_add_u32 s25, s24, 4096
buffer_load_dwordx4 v[16:19], v4, s[8:11], s24 offen offset:0 sc1
buffer_load_dwordx4 v[20:23], v4, s[8:11], s24 offen offset:2048 sc1
buffer_load_dwordx4 v[24:27], v4, s[8:11], s25 offen offset:0 sc1
s_lshl_b32 s24, s5, 2
s_lshr_b32 s25, s6, 3
s_add_u32 s24, s24, s25
s_lshl_b32 s24, s24, 7
s_add_u32 s24, s24, 98304
v_and_b32 v6, 31, v1
v_lshlrev_b32 v6, 2, v6
s_mov_b32 s52, 0
L_poll5:
buffer_load_dword v14, v6, s[8:11], s24 offen sc1
s_add_u32 s52, s52, 1
s_waitcnt vmcnt(0)
v_cmp_ne_u32 vcc, 0, v14
s_cmp_gt_u32 s52, 0x80000
s_cbranch_scc1 L_got5
s_cmp_eq_u64 vcc, exec
s_cbranch_scc0 L_poll5
L_got5:
s_add_u32 s24, s20, 95084544
s_add_u32 s25, s24, 4096
buffer_load_dwordx4 v[28:31], v4, s[8:11], s24 offen offset:0 sc1
buffer_load_dwordx4 v[32:35], v4, s[8:11], s24 offen offset:2048 sc1
buffer_load_dwordx4 v[36:39], v4, s[8:11], s25 offen offset:0 sc1
s_add_u32 s24, s20, 97443840
s_add_u32 s25, s24, 4096
buffer_load_dwordx4 v[40:43], v4, s[8:11], s24 offen offset:0 sc1
buffer_load_dwordx4 v[44:47], v4, s[8:11], s24 offen offset:2048 sc1
buffer_load_dwordx4 v[48:51], v4, s[8:11], s25 offen offset:0 sc1
s_add_u32 s24, s20, 99803136
s_add_u32 s25, s24, 4096
buffer_load_dwordx4 v[52:55], v4, s[8:11], s24 offen offset:0 sc1
buffer_load_dwordx4 v[56:59], v4, s[8:11], s24 offen offset:2048 sc1
buffer_load_dwordx4 v[60:63], v4, s[8:11], s25 offen offset:0 sc1
s_add_u32 s24, s20, 102162432
s_add_u32 s25, s24, 4096
buffer_load_dwordx4 v[64:67], v4, s[8:11], s24 offen offset:0 sc1
buffer_load_dwordx4 v[68:71], v4, s[8:11], s24 offen offset:2048 sc1
buffer_load_dwordx4 v[72:75], v4, s[8:11], s25 offen offset:0 sc1
s_add_u32 s24, s20, 104521728
s_add_u32 s25, s24, 4096
buffer_load_dwordx4 v[76:79], v4, s[8:11], s24 offen offset:0 sc1
buffer_load_dwordx4 v[80:83], v4, s[8:11], s24 offen offset:2048 sc1
buffer_load_dwordx4 v[84:87], v4, s[8:11], s25 offen offset:0 sc1
s_add_u32 s24, s20, 106881024
s_add_u32 s25, s24, 4096
buffer_load_dwordx4 v[88:91], v4, s[8:11], s24 offen offset:0 sc1
buffer_load_dwordx4 v[92:95], v4, s[8:11], s24 offen offset:2048 sc1
buffer_load_dwordx4 v[96:99], v4, s[8:11], s25 offen offset:0 sc1
s_add_u32 s24, s20, 109240320
s_add_u32 s25, s24, 4096
buffer_load_dwordx4 v[100:103], v4, s[8:11], s24 offen offset:0 sc1
buffer_load_dwordx4 v[104:107], v4, s[8:11], s24 offen offset:2048 sc1
buffer_load_dwordx4 v[108:111], v4, s[8:11], s25 offen offset:0 sc1
s_add_u32 s24, s20, 111599616
s_add_u32 s25, s24, 4096
buffer_load_dwordx4 v[112:115], v4, s[8:11], s24 offen offset:0 sc1
buffer_load_dwordx4 v[116:119], v4, s[8:11], s24 offen offset:2048 sc1
buffer_load_dwordx4 v[120:123], v4, s[8:11], s25 offen offset:0 sc1
s_waitcnt vmcnt(26)
v_lshlrev_b32 v128, 16, v16
v_and_b32 v129, 0xffff0000, v16
v_lshlrev_b32 v130, 16, v17
v_and_b32 v131, 0xffff0000, v17
v_lshlrev_b32 v132, 16, v18
v_and_b32 v133, 0xffff0000, v18
v_lshlrev_b32 v134, 16, v19
v_and_b32 v135, 0xffff0000, v19
s_waitcnt vmcnt(25)
v_lshlrev_b32 v136, 16, v20
v_and_b32 v137, 0xffff0000, v20
v_lshlrev_b32 v138, 16, v21
v_and_b32 v139, 0xffff0000, v21
v_lshlrev_b32 v140, 16, v22
v_and_b32 v141, 0xffff0000, v22
v_lshlrev_b32 v142, 16, v23
v_and_b32 v143, 0xffff0000, v23
s_waitcnt vmcnt(24)
v_lshlrev_b32 v144, 16, v24
v_and_b32 v145, 0xffff0000, v24
v_lshlrev_b32 v146, 16, v25
v_and_b32 v147, 0xffff0000, v25
v_lshlrev_b32 v148, 16, v26
v_and_b32 v149, 0xffff0000, v26
v_lshlrev_b32 v150, 16, v27
v_and_b32 v151, 0xffff0000, v27
s_waitcnt vmcnt(23)
v_lshlrev_b32 v6, 16, v28
v_and_b32 v7, 0xffff0000, v28
v_add_f32 v128, v128, v6
v_add_f32 v129, v129, v7
v_lshlrev_b32 v8, 16, v29
v_and_b32 v9, 0xffff0000, v29
v_add_f32 v130, v130, v8
v_add_f32 v131, v131, v9
v_lshlrev_b32 v6, 16, v30
v_and_b32 v7, 0xffff0000, v30
v_add_f32 v132, v132, v6
v_add_f32 v133, v133, v7
v_lshlrev_b32 v8, 16, v31
v_and_b32 v9, 0xffff0000, v31
v_add_f32 v134, v134, v8
v_add_f32 v135, v135, v9
s_waitcnt vmcnt(22)
v_lshlrev_b32 v6, 16, v32
v_and_b32 v7, 0xffff0000, v32
v_add_f32 v136, v136, v6
v_add_f32 v137, v137, v7
v_lshlrev_b32 v8, 16, v33
v_and_b32 v9, 0xffff0000, v33
v_add_f32 v138, v138, v8
v_add_f32 v139, v139, v9
v_lshlrev_b32 v6, 16, v34
v_and_b32 v7, 0xffff0000, v34
v_add_f32 v140, v140, v6
v_add_f32 v141, v141, v7
v_lshlrev_b32 v8, 16, v35
v_and_b32 v9, 0xffff0000, v35
v_add_f32 v142, v142, v8
v_add_f32 v143, v143, v9
s_waitcnt vmcnt(21)
v_lshlrev_b32 v6, 16, v36
v_and_b32 v7, 0xffff0000, v36
v_add_f32 v144, v144, v6
v_add_f32 v145, v145, v7
v_lshlrev_b32 v8, 16, v37
v_and_b32 v9, 0xffff0000, v37
v_add_f32 v146, v146, v8
v_add_f32 v147, v147, v9
v_lshlrev_b32 v6, 16, v38
v_and_b32 v7, 0xffff0000, v38
v_add_f32 v148, v148, v6
v_add_f32 v149, v149, v7
v_lshlrev_b32 v8, 16, v39
v_and_b32 v9, 0xffff0000, v39
v_add_f32 v150, v150, v8
v_add_f32 v151, v151, v9
s_waitcnt vmcnt(20)
v_lshlrev_b32 v6, 16, v40
v_and_b32 v7, 0xffff0000, v40
v_add_f32 v128, v128, v6
v_add_f32 v129, v129, v7
v_lshlrev_b32 v8, 16, v41
v_and_b32 v9, 0xffff0000, v41
v_add_f32 v130, v130, v8
v_add_f32 v131, v131, v9
v_lshlrev_b32 v6, 16, v42
v_and_b32 v7, 0xffff0000, v42
v_add_f32 v132, v132, v6
v_add_f32 v133, v133, v7
v_lshlrev_b32 v8, 16, v43
v_and_b32 v9, 0xffff0000, v43
v_add_f32 v134, v134, v8
v_add_f32 v135, v135, v9
s_waitcnt vmcnt(19)
v_lshlrev_b32 v6, 16, v44
v_and_b32 v7, 0xffff0000, v44
v_add_f32 v136, v136, v6
v_add_f32 v137, v137, v7
v_lshlrev_b32 v8, 16, v45
v_and_b32 v9, 0xffff0000, v45
v_add_f32 v138, v138, v8
v_add_f32 v139, v139, v9
v_lshlrev_b32 v6, 16, v46
v_and_b32 v7, 0xffff0000, v46
v_add_f32 v140, v140, v6
v_add_f32 v141, v141, v7
v_lshlrev_b32 v8, 16, v47
v_and_b32 v9, 0xffff0000, v47
v_add_f32 v142, v142, v8
v_add_f32 v143, v143, v9
s_waitcnt vmcnt(18)
v_lshlrev_b32 v6, 16, v48
v_and_b32 v7, 0xffff0000, v48
v_add_f32 v144, v144, v6
v_add_f32 v145, v145, v7
v_lshlrev_b32 v8, 16, v49
v_and_b32 v9, 0xffff0000, v49
v_add_f32 v146, v146, v8
v_add_f32 v147, v147, v9
v_lshlrev_b32 v6, 16, v50
v_and_b32 v7, 0xffff0000, v50
v_add_f32 v148, v148, v6
v_add_f32 v149, v149, v7
v_lshlrev_b32 v8, 16, v51
v_and_b32 v9, 0xffff0000, v51
v_add_f32 v150, v150, v8
v_add_f32 v151, v151, v9
s_waitcnt vmcnt(17)
v_lshlrev_b32 v6, 16, v52
v_and_b32 v7, 0xffff0000, v52
v_add_f32 v128, v128, v6
v_add_f32 v129, v129, v7
v_lshlrev_b32 v8, 16, v53
v_and_b32 v9, 0xffff0000, v53
v_add_f32 v130, v130, v8
v_add_f32 v131, v131, v9
v_lshlrev_b32 v6, 16, v54
v_and_b32 v7, 0xffff0000, v54
v_add_f32 v132, v132, v6
v_add_f32 v133, v133, v7
v_lshlrev_b32 v8, 16, v55
v_and_b32 v9, 0xffff0000, v55
v_add_f32 v134, v134, v8
v_add_f32 v135, v135, v9
s_waitcnt vmcnt(16)
v_lshlrev_b32 v6, 16, v56
v_and_b32 v7, 0xffff0000, v56
v_add_f32 v136, v136, v6
v_add_f32 v137, v137, v7
v_lshlrev_b32 v8, 16, v57
v_and_b32 v9, 0xffff0000, v57
v_add_f32 v138, v138, v8
v_add_f32 v139, v139, v9
v_lshlrev_b32 v6, 16, v58
v_and_b32 v7, 0xffff0000, v58
v_add_f32 v140, v140, v6
v_add_f32 v141, v141, v7
v_lshlrev_b32 v8, 16, v59
v_and_b32 v9, 0xffff0000, v59
v_add_f32 v142, v142, v8
v_add_f32 v143, v143, v9
s_waitcnt vmcnt(15)
v_lshlrev_b32 v6, 16, v60
v_and_b32 v7, 0xffff0000, v60
v_add_f32 v144, v144, v6
v_add_f32 v145, v145, v7
v_lshlrev_b32 v8, 16, v61
v_and_b32 v9, 0xffff0000, v61
v_add_f32 v146, v146, v8
v_add_f32 v147, v147, v9
v_lshlrev_b32 v6, 16, v62
v_and_b32 v7, 0xffff0000, v62
v_add_f32 v148, v148, v6
v_add_f32 v149, v149, v7
v_lshlrev_b32 v8, 16, v63
v_and_b32 v9, 0xffff0000, v63
v_add_f32 v150, v150, v8
v_add_f32 v151, v151, v9
s_waitcnt vmcnt(14)
v_lshlrev_b32 v6, 16, v64
v_and_b32 v7, 0xffff0000, v64
v_add_f32 v128, v128, v6
v_add_f32 v129, v129, v7
v_lshlrev_b32 v8, 16, v65
v_and_b32 v9, 0xffff0000, v65
v_add_f32 v130, v130, v8
v_add_f32 v131, v131, v9
v_lshlrev_b32 v6, 16, v66
v_and_b32 v7, 0xffff0000, v66
v_add_f32 v132, v132, v6
v_add_f32 v133, v133, v7
v_lshlrev_b32 v8, 16, v67
v_and_b32 v9, 0xffff0000, v67
v_add_f32 v134, v134, v8
v_add_f32 v135, v135, v9
s_waitcnt vmcnt(13)
v_lshlrev_b32 v6, 16, v68
v_and_b32 v7, 0xffff0000, v68
v_add_f32 v136, v136, v6
v_add_f32 v137, v137, v7
v_lshlrev_b32 v8, 16, v69
v_and_b32 v9, 0xffff0000, v69
v_add_f32 v138, v138, v8
v_add_f32 v139, v139, v9
v_lshlrev_b32 v6, 16, v70
v_and_b32 v7, 0xffff0000, v70
v_add_f32 v140, v140, v6
v_add_f32 v141, v141, v7
v_lshlrev_b32 v8, 16, v71
v_and_b32 v9, 0xffff0000, v71
v_add_f32 v142, v142, v8
v_add_f32 v143, v143, v9
s_waitcnt vmcnt(12)
v_lshlrev_b32 v6, 16, v72
v_and_b32 v7, 0xffff0000, v72
v_add_f32 v144, v144, v6
v_add_f32 v145, v145, v7
v_lshlrev_b32 v8, 16, v73
v_and_b32 v9, 0xffff0000, v73
v_add_f32 v146, v146, v8
v_add_f32 v147, v147, v9
v_lshlrev_b32 v6, 16, v74
v_and_b32 v7, 0xffff0000, v74
v_add_f32 v148, v148, v6
v_add_f32 v149, v149, v7
v_lshlrev_b32 v8, 16, v75
v_and_b32 v9, 0xffff0000, v75
v_add_f32 v150, v150, v8
v_add_f32 v151, v151, v9
s_waitcnt vmcnt(11)
v_lshlrev_b32 v6, 16, v76
v_and_b32 v7, 0xffff0000, v76
v_add_f32 v128, v128, v6
v_add_f32 v129, v129, v7
v_lshlrev_b32 v8, 16, v77
v_and_b32 v9, 0xffff0000, v77
v_add_f32 v130, v130, v8
v_add_f32 v131, v131, v9
v_lshlrev_b32 v6, 16, v78
v_and_b32 v7, 0xffff0000, v78
v_add_f32 v132, v132, v6
v_add_f32 v133, v133, v7
v_lshlrev_b32 v8, 16, v79
v_and_b32 v9, 0xffff0000, v79
v_add_f32 v134, v134, v8
v_add_f32 v135, v135, v9
s_waitcnt vmcnt(10)
v_lshlrev_b32 v6, 16, v80
v_and_b32 v7, 0xffff0000, v80
v_add_f32 v136, v136, v6
v_add_f32 v137, v137, v7
v_lshlrev_b32 v8, 16, v81
v_and_b32 v9, 0xffff0000, v81
v_add_f32 v138, v138, v8
v_add_f32 v139, v139, v9
v_lshlrev_b32 v6, 16, v82
v_and_b32 v7, 0xffff0000, v82
v_add_f32 v140, v140, v6
v_add_f32 v141, v141, v7
v_lshlrev_b32 v8, 16, v83
v_and_b32 v9, 0xffff0000, v83
v_add_f32 v142, v142, v8
v_add_f32 v143, v143, v9
s_waitcnt vmcnt(9)
v_lshlrev_b32 v6, 16, v84
v_and_b32 v7, 0xffff0000, v84
v_add_f32 v144, v144, v6
v_add_f32 v145, v145, v7
v_lshlrev_b32 v8, 16, v85
v_and_b32 v9, 0xffff0000, v85
v_add_f32 v146, v146, v8
v_add_f32 v147, v147, v9
v_lshlrev_b32 v6, 16, v86
v_and_b32 v7, 0xffff0000, v86
v_add_f32 v148, v148, v6
v_add_f32 v149, v149, v7
v_lshlrev_b32 v8, 16, v87
v_and_b32 v9, 0xffff0000, v87
v_add_f32 v150, v150, v8
v_add_f32 v151, v151, v9
s_waitcnt vmcnt(8)
v_lshlrev_b32 v6, 16, v88
v_and_b32 v7, 0xffff0000, v88
v_add_f32 v128, v128, v6
v_add_f32 v129, v129, v7
v_lshlrev_b32 v8, 16, v89
v_and_b32 v9, 0xffff0000, v89
v_add_f32 v130, v130, v8
v_add_f32 v131, v131, v9
v_lshlrev_b32 v6, 16, v90
v_and_b32 v7, 0xffff0000, v90
v_add_f32 v132, v132, v6
v_add_f32 v133, v133, v7
v_lshlrev_b32 v8, 16, v91
v_and_b32 v9, 0xffff0000, v91
v_add_f32 v134, v134, v8
v_add_f32 v135, v135, v9
s_waitcnt vmcnt(7)
v_lshlrev_b32 v6, 16, v92
v_and_b32 v7, 0xffff0000, v92
v_add_f32 v136, v136, v6
v_add_f32 v137, v137, v7
v_lshlrev_b32 v8, 16, v93
v_and_b32 v9, 0xffff0000, v93
v_add_f32 v138, v138, v8
v_add_f32 v139, v139, v9
v_lshlrev_b32 v6, 16, v94
v_and_b32 v7, 0xffff0000, v94
v_add_f32 v140, v140, v6
v_add_f32 v141, v141, v7
v_lshlrev_b32 v8, 16, v95
v_and_b32 v9, 0xffff0000, v95
v_add_f32 v142, v142, v8
v_add_f32 v143, v143, v9
s_waitcnt vmcnt(6)
v_lshlrev_b32 v6, 16, v96
v_and_b32 v7, 0xffff0000, v96
v_add_f32 v144, v144, v6
v_add_f32 v145, v145, v7
v_lshlrev_b32 v8, 16, v97
v_and_b32 v9, 0xffff0000, v97
v_add_f32 v146, v146, v8
v_add_f32 v147, v147, v9
v_lshlrev_b32 v6, 16, v98
v_and_b32 v7, 0xffff0000, v98
v_add_f32 v148, v148, v6
v_add_f32 v149, v149, v7
v_lshlrev_b32 v8, 16, v99
v_and_b32 v9, 0xffff0000, v99
v_add_f32 v150, v150, v8
v_add_f32 v151, v151, v9
s_waitcnt vmcnt(5)
v_lshlrev_b32 v6, 16, v100
v_and_b32 v7, 0xffff0000, v100
v_add_f32 v128, v128, v6
v_add_f32 v129, v129, v7
v_lshlrev_b32 v8, 16, v101
v_and_b32 v9, 0xffff0000, v101
v_add_f32 v130, v130, v8
v_add_f32 v131, v131, v9
v_lshlrev_b32 v6, 16, v102
v_and_b32 v7, 0xffff0000, v102
v_add_f32 v132, v132, v6
v_add_f32 v133, v133, v7
v_lshlrev_b32 v8, 16, v103
v_and_b32 v9, 0xffff0000, v103
v_add_f32 v134, v134, v8
v_add_f32 v135, v135, v9
s_waitcnt vmcnt(4)
v_lshlrev_b32 v6, 16, v104
v_and_b32 v7, 0xffff0000, v104
v_add_f32 v136, v136, v6
v_add_f32 v137, v137, v7
v_lshlrev_b32 v8, 16, v105
v_and_b32 v9, 0xffff0000, v105
v_add_f32 v138, v138, v8
v_add_f32 v139, v139, v9
v_lshlrev_b32 v6, 16, v106
v_and_b32 v7, 0xffff0000, v106
v_add_f32 v140, v140, v6
v_add_f32 v141, v141, v7
v_lshlrev_b32 v8, 16, v107
v_and_b32 v9, 0xffff0000, v107
v_add_f32 v142, v142, v8
v_add_f32 v143, v143, v9
s_waitcnt vmcnt(3)
v_lshlrev_b32 v6, 16, v108
v_and_b32 v7, 0xffff0000, v108
v_add_f32 v144, v144, v6
v_add_f32 v145, v145, v7
v_lshlrev_b32 v8, 16, v109
v_and_b32 v9, 0xffff0000, v109
v_add_f32 v146, v146, v8
v_add_f32 v147, v147, v9
v_lshlrev_b32 v6, 16, v110
v_and_b32 v7, 0xffff0000, v110
v_add_f32 v148, v148, v6
v_add_f32 v149, v149, v7
v_lshlrev_b32 v8, 16, v111
v_and_b32 v9, 0xffff0000, v111
v_add_f32 v150, v150, v8
v_add_f32 v151, v151, v9
s_waitcnt vmcnt(2)
v_lshlrev_b32 v6, 16, v112
v_and_b32 v7, 0xffff0000, v112
v_add_f32 v128, v128, v6
v_add_f32 v129, v129, v7
v_lshlrev_b32 v8, 16, v113
v_and_b32 v9, 0xffff0000, v113
v_add_f32 v130, v130, v8
v_add_f32 v131, v131, v9
v_lshlrev_b32 v6, 16, v114
v_and_b32 v7, 0xffff0000, v114
v_add_f32 v132, v132, v6
v_add_f32 v133, v133, v7
v_lshlrev_b32 v8, 16, v115
v_and_b32 v9, 0xffff0000, v115
v_add_f32 v134, v134, v8
v_add_f32 v135, v135, v9
s_waitcnt vmcnt(1)
v_lshlrev_b32 v6, 16, v116
v_and_b32 v7, 0xffff0000, v116
v_add_f32 v136, v136, v6
v_add_f32 v137, v137, v7
v_lshlrev_b32 v8, 16, v117
v_and_b32 v9, 0xffff0000, v117
v_add_f32 v138, v138, v8
v_add_f32 v139, v139, v9
v_lshlrev_b32 v6, 16, v118
v_and_b32 v7, 0xffff0000, v118
v_add_f32 v140, v140, v6
v_add_f32 v141, v141, v7
v_lshlrev_b32 v8, 16, v119
v_and_b32 v9, 0xffff0000, v119
v_add_f32 v142, v142, v8
v_add_f32 v143, v143, v9
s_waitcnt vmcnt(0)
v_lshlrev_b32 v6, 16, v120
v_and_b32 v7, 0xffff0000, v120
v_add_f32 v144, v144, v6
v_add_f32 v145, v145, v7
v_lshlrev_b32 v8, 16, v121
v_and_b32 v9, 0xffff0000, v121
v_add_f32 v146, v146, v8
v_add_f32 v147, v147, v9
v_lshlrev_b32 v6, 16, v122
v_and_b32 v7, 0xffff0000, v122
v_add_f32 v148, v148, v6
v_add_f32 v149, v149, v7
v_lshlrev_b32 v8, 16, v123
v_and_b32 v9, 0xffff0000, v123
v_add_f32 v150, v150, v8
v_add_f32 v151, v151, v9
v_cvt_pk_bf16_f32 v152, v128, v129
v_cvt_pk_bf16_f32 v153, v130, v131
v_cvt_pk_bf16_f32 v154, v132, v133
v_cvt_pk_bf16_f32 v155, v134, v135
v_cvt_pk_bf16_f32 v156, v136, v137
v_cvt_pk_bf16_f32 v157, v138, v139
v_cvt_pk_bf16_f32 v158, v140, v141
v_cvt_pk_bf16_f32 v159, v142, v143
v_cvt_pk_bf16_f32 v160, v144, v145
v_cvt_pk_bf16_f32 v161, v146, v147
v_cvt_pk_bf16_f32 v162, v148, v149
v_cvt_pk_bf16_f32 v163, v150, v151
buffer_store_dwordx4 v[152:155], v5, s[16:19], s21 offen offset:0
buffer_store_dwordx4 v[156:159], v5, s[16:19], s21 offen offset:128
buffer_store_dwordx4 v[160:163], v5, s[16:19], s21 offen offset:256
L_end:
s_endpgm
L_f_slow1:
s_mov_b32 s52, 0
L_f_spin1:
s_sleep 1
buffer_load_dword v13, v11, s[8:11], s34 offen sc1
s_add_u32 s52, s52, 1
s_waitcnt vmcnt(0)
v_cmp_le_u32 vcc, 1, v13
s_cmp_gt_u32 s52, 0x40000
s_cbranch_scc1 L_f_back1
s_cmp_eq_u64 vcc, exec
s_cbranch_scc0 L_f_spin1
s_branch L_f_back1
L_f_slow2:
s_mov_b32 s52, 0
L_f_spin2:
s_sleep 1
buffer_load_dword v13, v11, s[8:11], s34 offen sc1
s_add_u32 s52, s52, 1
s_waitcnt vmcnt(0)
v_cmp_le_u32 vcc, 2, v13
s_cmp_gt_u32 s52, 0x40000
s_cbranch_scc1 L_f_back2
s_cmp_eq_u64 vcc, exec
s_cbranch_scc0 L_f_spin2
s_branch L_f_back2
L_f_slow3:
s_mov_b32 s52, 0
L_f_spin3:
s_sleep 1
buffer_load_dword v13, v11, s[8:11], s34 offen sc1
s_add_u32 s52, s52, 1
s_waitcnt vmcnt(0)
v_cmp_le_u32 vcc, 3, v13
s_cmp_gt_u32 s52, 0x40000
s_cbranch_scc1 L_f_back3
s_cmp_eq_u64 vcc, exec
s_cbranch_scc0 L_f_spin3
s_branch L_f_back3
.section .rodata,"a"
.p2align 6
.amdhsa_kernel prep_kernel
  .amdhsa_next_free_vgpr 184
  .amdhsa_next_free_sgpr 102
  .amdhsa_accum_offset 184
  .amdhsa_group_segment_fixed_size 0
  .amdhsa_kernarg_size 80
  .amdhsa_user_sgpr_count 2
  .amdhsa_user_sgpr_kernarg_segment_ptr 1
  .amdhsa_system_sgpr_workgroup_id_x 1
.end_amdhsa_kernel
.p2align 6
.amdhsa_kernel main_kernel
  .amdhsa_next_free_vgpr 512
  .amdhsa_next_free_sgpr 102
  .amdhsa_accum_offset 256
  .amdhsa_group_segment_fixed_size 0
  .amdhsa_kernarg_size 80
  .amdhsa_user_sgpr_count 2
  .amdhsa_user_sgpr_kernarg_segment_ptr 1
  .amdhsa_system_sgpr_workgroup_id_x 1
.end_amdhsa_kernel
```

```asm
; @launch kernel=prep_kernel grid=(258,1,1) block=(256,1,1) lds=1024
; @launch kernel=main_kernel grid=(256,1,1) block=(256,1,1) lds=159744
.amdgcn_target "amdgcn-amd-amdhsa--gfx950"
.text
.p2align 8
.globl prep_kernel
.type prep_kernel,@function
prep_kernel:
s_cmp_ge_u32 s2, 258
s_cbranch_scc1 L_prep_end
s_load_dwordx2 s[12:13], s[0:1], 72
v_and_b32 v1, 63, v0
v_lshrrev_b32 v3, 6, v0
v_lshlrev_b32 v2, 4, v1
v_readfirstlane_b32 s4, v3
s_and_b32 s5, s2, 7
s_lshr_b32 s6, s2, 3
s_waitcnt lgkmcnt(0)
s_mov_b32 s8, s12
s_and_b32 s9, s13, 0xffff
s_mov_b32 s10, 268435456
s_mov_b32 s11, 0x20000
s_cmp_ge_u32 s2, 256
s_cbranch_scc1 L_prep_pack
s_lshl_b32 s20, s2, 10
s_add_u32 s20, s20, 0
v_lshlrev_b32 v4, 2, v0
v_mov_b32 v5, 0
buffer_store_dword v5, v4, s[8:11], s20 offen
s_cmp_eq_u32 s4, 3
s_cbranch_scc1 L_prep_idle
v_and_b32 v6, 7, v1
v_lshrrev_b32 v7, 3, v1
s_mul_i32 s22, s4, 24
v_add_u32 v7, s22, v7
s_and_b32 s23, s6, 1
s_lshl_b32 s23, s23, 3
v_add_u32 v8, s23, v6
v_lshlrev_b32 v8, 4, v8
v_lshl_add_u32 v4, v7, 8, v8
s_lshl_b32 s24, s5, 4
s_lshr_b32 s25, s6, 1
s_add_u32 s24, s24, s25
s_mul_i32 s20, s24, 18432
s_lshl_b32 s24, s5, 8
s_lshl_b32 s25, s6, 3
s_add_u32 s24, s24, s25
s_and_b32 s25, s24, 1023
s_lshl_b32 s25, s25, 1
s_lshr_b32 s24, s24, 10
s_add_u32 s24, s24, s25
s_mul_i32 s21, s24, 1152
v_mul_u32_u24 v8, 2304, v6
v_lshl_add_u32 v5, v7, 4, v8
s_load_dwordx2 s[12:13], s[0:1], 0
s_waitcnt lgkmcnt(0)
s_mov_b32 s16, s12
s_and_b32 s17, s13, 0xffff
s_mov_b32 s18, 2359296
s_mov_b32 s19, 0x20000
buffer_load_dwordx4 v[16:19], v5, s[16:19], s21 offen offset:0
buffer_load_dwordx4 v[20:23], v5, s[16:19], s21 offen offset:128
buffer_load_dwordx4 v[24:27], v5, s[16:19], s21 offen offset:256
s_waitcnt vmcnt(2)
v_lshlrev_b32 v128, 16, v16
v_and_b32 v129, 0xffff0000, v16
v_lshlrev_b32 v130, 16, v17
v_and_b32 v131, 0xffff0000, v17
v_lshlrev_b32 v132, 16, v18
v_and_b32 v133, 0xffff0000, v18
v_lshlrev_b32 v134, 16, v19
v_and_b32 v135, 0xffff0000, v19
s_waitcnt vmcnt(1)
v_lshlrev_b32 v136, 16, v20
v_and_b32 v137, 0xffff0000, v20
v_lshlrev_b32 v138, 16, v21
v_and_b32 v139, 0xffff0000, v21
v_lshlrev_b32 v140, 16, v22
v_and_b32 v141, 0xffff0000, v22
v_lshlrev_b32 v142, 16, v23
v_and_b32 v143, 0xffff0000, v23
s_waitcnt vmcnt(0)
v_lshlrev_b32 v144, 16, v24
v_and_b32 v145, 0xffff0000, v24
v_lshlrev_b32 v146, 16, v25
v_and_b32 v147, 0xffff0000, v25
v_lshlrev_b32 v148, 16, v26
v_and_b32 v149, 0xffff0000, v26
v_lshlrev_b32 v150, 16, v27
v_and_b32 v151, 0xffff0000, v27
s_add_u32 s24, s20, 24043520
s_add_u32 s25, s24, 4096
buffer_store_dwordx4 v[16:19], v4, s[8:11], s24 offen offset:0
buffer_store_dwordx4 v[20:23], v4, s[8:11], s24 offen offset:2048
buffer_store_dwordx4 v[24:27], v4, s[8:11], s25 offen offset:0
v_add_f32 v6, v128, v129
v_mul_f32 v7, v128, v128
v_mul_f32 v9, v129, v129
v_mov_b32 v8, 0
v_add_f32 v6, v6, v130
v_add_f32 v8, v8, v131
v_fmac_f32 v7, v130, v130
v_fmac_f32 v9, v131, v131
v_add_f32 v6, v6, v132
v_add_f32 v8, v8, v133
v_fmac_f32 v7, v132, v132
v_fmac_f32 v9, v133, v133
v_add_f32 v6, v6, v134
v_add_f32 v8, v8, v135
v_fmac_f32 v7, v134, v134
v_fmac_f32 v9, v135, v135
v_add_f32 v6, v6, v136
v_add_f32 v8, v8, v137
v_fmac_f32 v7, v136, v136
v_fmac_f32 v9, v137, v137
v_add_f32 v6, v6, v138
v_add_f32 v8, v8, v139
v_fmac_f32 v7, v138, v138
v_fmac_f32 v9, v139, v139
v_add_f32 v6, v6, v140
v_add_f32 v8, v8, v141
v_fmac_f32 v7, v140, v140
v_fmac_f32 v9, v141, v141
v_add_f32 v6, v6, v142
v_add_f32 v8, v8, v143
v_fmac_f32 v7, v142, v142
v_fmac_f32 v9, v143, v143
v_add_f32 v6, v6, v144
v_add_f32 v8, v8, v145
v_fmac_f32 v7, v144, v144
v_fmac_f32 v9, v145, v145
v_add_f32 v6, v6, v146
v_add_f32 v8, v8, v147
v_fmac_f32 v7, v146, v146
v_fmac_f32 v9, v147, v147
v_add_f32 v6, v6, v148
v_add_f32 v8, v8, v149
v_fmac_f32 v7, v148, v148
v_fmac_f32 v9, v149, v149
v_add_f32 v6, v6, v150
v_add_f32 v8, v8, v151
v_fmac_f32 v7, v150, v150
v_fmac_f32 v9, v151, v151
v_add_f32 v6, v6, v8
v_add_f32 v7, v7, v9
s_nop 0
v_add_f32_dpp v6, v6, v6 row_ror:8 row_mask:0xf bank_mask:0xf
v_add_f32_dpp v7, v7, v7 row_ror:8 row_mask:0xf bank_mask:0xf
v_mov_b32 v8, v6
v_mov_b32 v9, v7
s_nop 0
v_permlane16_swap_b32 v6, v8
v_permlane16_swap_b32 v7, v9
v_add_f32 v6, v6, v8
v_add_f32 v7, v7, v9
v_mov_b32 v8, v6
v_mov_b32 v9, v7
s_nop 0
v_permlane32_swap_b32 v6, v8
v_permlane32_swap_b32 v7, v9
v_add_f32 v6, v6, v8
v_add_f32 v7, v7, v9
v_and_b32 v10, 7, v1
v_lshlrev_b32 v10, 3, v10
v_add_u32 v10, 0, v10
s_lshl_b32 s24, s4, 6
v_add_u32 v11, s24, v10
ds_write_b64 v11, v[6:7]
s_waitcnt lgkmcnt(0)
s_barrier
ds_read_b64 v[6:7], v10
ds_read_b64 v[8:9], v10 offset:64
ds_read_b64 v[12:13], v10 offset:128
s_waitcnt lgkmcnt(0)
v_add_f32 v6, v6, v8
v_add_f32 v7, v7, v9
v_add_f32 v6, v6, v12
v_add_f32 v7, v7, v13
v_mul_f32 v6, 0x3ae38e39, v6
v_mul_f32 v7, 0x3ae38e39, v7
v_fma_f32 v7, -v6, v6, v7
v_max_f32 v7, 0, v7
v_add_f32 v7, 0x3727c5ac, v7
v_rsq_f32 v7, v7
s_nop 0
v_mul_f32 v6, v6, v7
v_fma_f32 v128, v128, v7, -v6
v_fma_f32 v129, v129, v7, -v6
v_fma_f32 v130, v130, v7, -v6
v_fma_f32 v131, v131, v7, -v6
v_fma_f32 v132, v132, v7, -v6
v_fma_f32 v133, v133, v7, -v6
v_fma_f32 v134, v134, v7, -v6
v_fma_f32 v135, v135, v7, -v6
v_fma_f32 v136, v136, v7, -v6
v_fma_f32 v137, v137, v7, -v6
v_fma_f32 v138, v138, v7, -v6
v_fma_f32 v139, v139, v7, -v6
v_fma_f32 v140, v140, v7, -v6
v_fma_f32 v141, v141, v7, -v6
v_fma_f32 v142, v142, v7, -v6
v_fma_f32 v143, v143, v7, -v6
v_fma_f32 v144, v144, v7, -v6
v_fma_f32 v145, v145, v7, -v6
v_fma_f32 v146, v146, v7, -v6
v_fma_f32 v147, v147, v7, -v6
v_fma_f32 v148, v148, v7, -v6
v_fma_f32 v149, v149, v7, -v6
v_fma_f32 v150, v150, v7, -v6
v_fma_f32 v151, v151, v7, -v6
v_cvt_pk_bf16_f32 v168, v128, v129
v_cvt_pk_bf16_f32 v169, v130, v131
v_cvt_pk_bf16_f32 v170, v132, v133
v_cvt_pk_bf16_f32 v171, v134, v135
v_cvt_pk_bf16_f32 v172, v136, v137
v_cvt_pk_bf16_f32 v173, v138, v139
v_cvt_pk_bf16_f32 v174, v140, v141
v_cvt_pk_bf16_f32 v175, v142, v143
v_cvt_pk_bf16_f32 v176, v144, v145
v_cvt_pk_bf16_f32 v177, v146, v147
v_cvt_pk_bf16_f32 v178, v148, v149
v_cvt_pk_bf16_f32 v179, v150, v151
s_add_u32 s24, s20, 19324928
s_add_u32 s25, s24, 4096
buffer_store_dwordx4 v[168:171], v4, s[8:11], s24 offen offset:0
buffer_store_dwordx4 v[172:175], v4, s[8:11], s24 offen offset:2048
buffer_store_dwordx4 v[176:179], v4, s[8:11], s25 offen offset:0
s_branch L_prep_pack
L_prep_idle:
s_barrier
L_prep_pack:
s_waitcnt vmcnt(0)
s_lshl_b32 s20, s2, 2
s_add_u32 s20, s20, s4
v_and_b32 v6, 15, v1
v_lshrrev_b32 v7, 4, v1
v_lshrrev_b32 v8, 2, v6
v_and_b32 v9, 3, v6
v_lshl_add_u32 v10, v8, 3, v9
s_cmp_ge_u32 s20, 992
s_cbranch_scc1 L_pack_o
s_cmp_ge_u32 s20, 864
s_cbranch_scc1 L_pack_q
s_cmp_ge_u32 s20, 576
s_cbranch_scc1 L_pack_d
s_mul_i32 s21, s2, 911
s_lshr_b32 s21, s21, 16
s_mul_i32 s22, s21, 72
s_sub_u32 s22, s2, s22
s_mul_i32 s23, s22, 7282
s_lshr_b32 s23, s23, 16
s_mul_i32 s24, s23, 9
s_sub_u32 s24, s22, s24
s_lshl_b32 s24, s24, 2
s_add_u32 s24, s24, s4
s_load_dwordx4 s[36:39], s[0:1], 32
s_waitcnt lgkmcnt(0)
s_cmp_eq_u32 s21, 0
s_cselect_b64 s[12:13], s[36:37], s[38:39]
s_mov_b32 s16, s12
s_and_b32 s17, s13, 0xffff
s_mov_b32 s18, 5308416
s_mov_b32 s19, 0x20000
s_lshr_b32 s26, s24, 1
s_lshl_b32 s26, s26, 5
s_and_b32 s27, s24, 1
s_lshl_b32 s27, s27, 2
s_add_u32 s26, s26, s27
s_mul_i32 s27, s23, 576
s_add_u32 s26, s26, s27
v_add_u32 v11, s26, v10
v_lshlrev_b32 v11, 1, v11
v_mul_u32_u24 v12, 73728, v7
v_add_u32 v4, v11, v12
s_mul_i32 s27, s24, 7282
s_lshr_b32 s27, s27, 16
s_mul_i32 s28, s27, 9
s_sub_u32 s28, s24, s28
s_add_u32 s29, s28, 1
s_cmp_eq_u32 s29, 9
s_cselect_b32 s29, 0, s29
s_and_b32 s30, s27, 1
s_cmp_eq_u32 s30, 0
s_cselect_b32 s28, s29, s28
s_lshl_b32 s29, s23, 2
s_add_u32 s29, s29, s27
s_mul_i32 s29, s29, 497664
s_mul_i32 s30, s28, 36864
s_lshl_b32 s33, s28, 12
s_cmp_lt_u32 s28, 2
s_cselect_b32 s30, s33, s30
s_cselect_b32 s32, 2, 1
s_lshl_b32 s32, s32, 12
s_add_u32 s29, s29, s30
s_lshl_b32 s21, s21, 11
s_add_u32 s29, s29, s21
s_add_u32 s29, s29, 3366912
s_mov_b32 s40, 0
buffer_load_ushort v16, v4, s[16:19], s40 offen
s_mov_b32 s40, 9216
buffer_load_ushort v17, v4, s[16:19], s40 offen
s_mov_b32 s40, 18432
buffer_load_ushort v18, v4, s[16:19], s40 offen
s_mov_b32 s40, 27648
buffer_load_ushort v19, v4, s[16:19], s40 offen
s_mov_b32 s40, 36864
buffer_load_ushort v20, v4, s[16:19], s40 offen
s_mov_b32 s40, 46080
buffer_load_ushort v21, v4, s[16:19], s40 offen
s_mov_b32 s40, 55296
buffer_load_ushort v22, v4, s[16:19], s40 offen
s_mov_b32 s40, 64512
buffer_load_ushort v23, v4, s[16:19], s40 offen
s_mov_b32 s40, 294912
buffer_load_ushort v24, v4, s[16:19], s40 offen
s_mov_b32 s40, 304128
buffer_load_ushort v25, v4, s[16:19], s40 offen
s_mov_b32 s40, 313344
buffer_load_ushort v26, v4, s[16:19], s40 offen
s_mov_b32 s40, 322560
buffer_load_ushort v27, v4, s[16:19], s40 offen
s_mov_b32 s40, 331776
buffer_load_ushort v28, v4, s[16:19], s40 offen
s_mov_b32 s40, 340992
buffer_load_ushort v29, v4, s[16:19], s40 offen
s_mov_b32 s40, 350208
buffer_load_ushort v30, v4, s[16:19], s40 offen
s_mov_b32 s40, 359424
buffer_load_ushort v31, v4, s[16:19], s40 offen
s_mov_b32 s40, 589824
buffer_load_ushort v32, v4, s[16:19], s40 offen
s_mov_b32 s40, 599040
buffer_load_ushort v33, v4, s[16:19], s40 offen
s_mov_b32 s40, 608256
buffer_load_ushort v34, v4, s[16:19], s40 offen
s_mov_b32 s40, 617472
buffer_load_ushort v35, v4, s[16:19], s40 offen
s_mov_b32 s40, 626688
buffer_load_ushort v36, v4, s[16:19], s40 offen
s_mov_b32 s40, 635904
buffer_load_ushort v37, v4, s[16:19], s40 offen
s_mov_b32 s40, 645120
buffer_load_ushort v38, v4, s[16:19], s40 offen
s_mov_b32 s40, 654336
buffer_load_ushort v39, v4, s[16:19], s40 offen
s_mov_b32 s40, 884736
buffer_load_ushort v40, v4, s[16:19], s40 offen
s_mov_b32 s40, 893952
buffer_load_ushort v41, v4, s[16:19], s40 offen
s_mov_b32 s40, 903168
buffer_load_ushort v42, v4, s[16:19], s40 offen
s_mov_b32 s40, 912384
buffer_load_ushort v43, v4, s[16:19], s40 offen
s_mov_b32 s40, 921600
buffer_load_ushort v44, v4, s[16:19], s40 offen
s_mov_b32 s40, 930816
buffer_load_ushort v45, v4, s[16:19], s40 offen
s_mov_b32 s40, 940032
buffer_load_ushort v46, v4, s[16:19], s40 offen
s_mov_b32 s40, 949248
buffer_load_ushort v47, v4, s[16:19], s40 offen
s_mov_b32 s40, 1179648
buffer_load_ushort v48, v4, s[16:19], s40 offen
s_mov_b32 s40, 1188864
buffer_load_ushort v49, v4, s[16:19], s40 offen
s_mov_b32 s40, 1198080
buffer_load_ushort v50, v4, s[16:19], s40 offen
s_mov_b32 s40, 1207296
buffer_load_ushort v51, v4, s[16:19], s40 offen
s_mov_b32 s40, 1216512
buffer_load_ushort v52, v4, s[16:19], s40 offen
s_mov_b32 s40, 1225728
buffer_load_ushort v53, v4, s[16:19], s40 offen
s_mov_b32 s40, 1234944
buffer_load_ushort v54, v4, s[16:19], s40 offen
s_mov_b32 s40, 1244160
buffer_load_ushort v55, v4, s[16:19], s40 offen
s_mov_b32 s40, 1474560
buffer_load_ushort v56, v4, s[16:19], s40 offen
s_mov_b32 s40, 1483776
buffer_load_ushort v57, v4, s[16:19], s40 offen
s_mov_b32 s40, 1492992
buffer_load_ushort v58, v4, s[16:19], s40 offen
s_mov_b32 s40, 1502208
buffer_load_ushort v59, v4, s[16:19], s40 offen
s_mov_b32 s40, 1511424
buffer_load_ushort v60, v4, s[16:19], s40 offen
s_mov_b32 s40, 1520640
buffer_load_ushort v61, v4, s[16:19], s40 offen
s_mov_b32 s40, 1529856
buffer_load_ushort v62, v4, s[16:19], s40 offen
s_mov_b32 s40, 1539072
buffer_load_ushort v63, v4, s[16:19], s40 offen
s_waitcnt vmcnt(40)
v_lshl_or_b32 v80, v17, 16, v16
v_lshl_or_b32 v81, v19, 16, v18
v_lshl_or_b32 v82, v21, 16, v20
v_lshl_or_b32 v83, v23, 16, v22
s_waitcnt vmcnt(32)
v_lshl_or_b32 v84, v25, 16, v24
v_lshl_or_b32 v85, v27, 16, v26
v_lshl_or_b32 v86, v29, 16, v28
v_lshl_or_b32 v87, v31, 16, v30
s_waitcnt vmcnt(24)
v_lshl_or_b32 v88, v33, 16, v32
v_lshl_or_b32 v89, v35, 16, v34
v_lshl_or_b32 v90, v37, 16, v36
v_lshl_or_b32 v91, v39, 16, v38
s_waitcnt vmcnt(16)
v_lshl_or_b32 v92, v41, 16, v40
v_lshl_or_b32 v93, v43, 16, v42
v_lshl_or_b32 v94, v45, 16, v44
v_lshl_or_b32 v95, v47, 16, v46
s_waitcnt vmcnt(8)
v_lshl_or_b32 v96, v49, 16, v48
v_lshl_or_b32 v97, v51, 16, v50
v_lshl_or_b32 v98, v53, 16, v52
v_lshl_or_b32 v99, v55, 16, v54
s_waitcnt vmcnt(0)
v_lshl_or_b32 v100, v57, 16, v56
v_lshl_or_b32 v101, v59, 16, v58
v_lshl_or_b32 v102, v61, 16, v60
v_lshl_or_b32 v103, v63, 16, v62
s_mov_b32 s40, 1769472
buffer_load_ushort v16, v4, s[16:19], s40 offen
s_mov_b32 s40, 1778688
buffer_load_ushort v17, v4, s[16:19], s40 offen
s_mov_b32 s40, 1787904
buffer_load_ushort v18, v4, s[16:19], s40 offen
s_mov_b32 s40, 1797120
buffer_load_ushort v19, v4, s[16:19], s40 offen
s_mov_b32 s40, 1806336
buffer_load_ushort v20, v4, s[16:19], s40 offen
s_mov_b32 s40, 1815552
buffer_load_ushort v21, v4, s[16:19], s40 offen
s_mov_b32 s40, 1824768
buffer_load_ushort v22, v4, s[16:19], s40 offen
s_mov_b32 s40, 1833984
buffer_load_ushort v23, v4, s[16:19], s40 offen
s_mov_b32 s40, 2064384
buffer_load_ushort v24, v4, s[16:19], s40 offen
s_mov_b32 s40, 2073600
buffer_load_ushort v25, v4, s[16:19], s40 offen
s_mov_b32 s40, 2082816
buffer_load_ushort v26, v4, s[16:19], s40 offen
s_mov_b32 s40, 2092032
buffer_load_ushort v27, v4, s[16:19], s40 offen
s_mov_b32 s40, 2101248
buffer_load_ushort v28, v4, s[16:19], s40 offen
s_mov_b32 s40, 2110464
buffer_load_ushort v29, v4, s[16:19], s40 offen
s_mov_b32 s40, 2119680
buffer_load_ushort v30, v4, s[16:19], s40 offen
s_mov_b32 s40, 2128896
buffer_load_ushort v31, v4, s[16:19], s40 offen
s_mov_b32 s40, 2359296
buffer_load_ushort v32, v4, s[16:19], s40 offen
s_mov_b32 s40, 2368512
buffer_load_ushort v33, v4, s[16:19], s40 offen
s_mov_b32 s40, 2377728
buffer_load_ushort v34, v4, s[16:19], s40 offen
s_mov_b32 s40, 2386944
buffer_load_ushort v35, v4, s[16:19], s40 offen
s_mov_b32 s40, 2396160
buffer_load_ushort v36, v4, s[16:19], s40 offen
s_mov_b32 s40, 2405376
buffer_load_ushort v37, v4, s[16:19], s40 offen
s_mov_b32 s40, 2414592
buffer_load_ushort v38, v4, s[16:19], s40 offen
s_mov_b32 s40, 2423808
buffer_load_ushort v39, v4, s[16:19], s40 offen
s_mov_b32 s40, 2654208
buffer_load_ushort v40, v4, s[16:19], s40 offen
s_mov_b32 s40, 2663424
buffer_load_ushort v41, v4, s[16:19], s40 offen
s_mov_b32 s40, 2672640
buffer_load_ushort v42, v4, s[16:19], s40 offen
s_mov_b32 s40, 2681856
buffer_load_ushort v43, v4, s[16:19], s40 offen
s_mov_b32 s40, 2691072
buffer_load_ushort v44, v4, s[16:19], s40 offen
s_mov_b32 s40, 2700288
buffer_load_ushort v45, v4, s[16:19], s40 offen
s_mov_b32 s40, 2709504
buffer_load_ushort v46, v4, s[16:19], s40 offen
s_mov_b32 s40, 2718720
buffer_load_ushort v47, v4, s[16:19], s40 offen
s_mov_b32 s40, 2949120
buffer_load_ushort v48, v4, s[16:19], s40 offen
s_mov_b32 s40, 2958336
buffer_load_ushort v49, v4, s[16:19], s40 offen
s_mov_b32 s40, 2967552
buffer_load_ushort v50, v4, s[16:19], s40 offen
s_mov_b32 s40, 2976768
buffer_load_ushort v51, v4, s[16:19], s40 offen
s_mov_b32 s40, 2985984
buffer_load_ushort v52, v4, s[16:19], s40 offen
s_mov_b32 s40, 2995200
buffer_load_ushort v53, v4, s[16:19], s40 offen
s_mov_b32 s40, 3004416
buffer_load_ushort v54, v4, s[16:19], s40 offen
s_mov_b32 s40, 3013632
buffer_load_ushort v55, v4, s[16:19], s40 offen
s_mov_b32 s40, 3244032
buffer_load_ushort v56, v4, s[16:19], s40 offen
s_mov_b32 s40, 3253248
buffer_load_ushort v57, v4, s[16:19], s40 offen
s_mov_b32 s40, 3262464
buffer_load_ushort v58, v4, s[16:19], s40 offen
s_mov_b32 s40, 3271680
buffer_load_ushort v59, v4, s[16:19], s40 offen
s_mov_b32 s40, 3280896
buffer_load_ushort v60, v4, s[16:19], s40 offen
s_mov_b32 s40, 3290112
buffer_load_ushort v61, v4, s[16:19], s40 offen
s_mov_b32 s40, 3299328
buffer_load_ushort v62, v4, s[16:19], s40 offen
s_mov_b32 s40, 3308544
buffer_load_ushort v63, v4, s[16:19], s40 offen
s_waitcnt vmcnt(40)
v_lshl_or_b32 v104, v17, 16, v16
v_lshl_or_b32 v105, v19, 16, v18
v_lshl_or_b32 v106, v21, 16, v20
v_lshl_or_b32 v107, v23, 16, v22
s_waitcnt vmcnt(32)
v_lshl_or_b32 v108, v25, 16, v24
v_lshl_or_b32 v109, v27, 16, v26
v_lshl_or_b32 v110, v29, 16, v28
v_lshl_or_b32 v111, v31, 16, v30
s_waitcnt vmcnt(24)
v_lshl_or_b32 v112, v33, 16, v32
v_lshl_or_b32 v113, v35, 16, v34
v_lshl_or_b32 v114, v37, 16, v36
v_lshl_or_b32 v115, v39, 16, v38
s_waitcnt vmcnt(16)
v_lshl_or_b32 v116, v41, 16, v40
v_lshl_or_b32 v117, v43, 16, v42
v_lshl_or_b32 v118, v45, 16, v44
v_lshl_or_b32 v119, v47, 16, v46
s_waitcnt vmcnt(8)
v_lshl_or_b32 v120, v49, 16, v48
v_lshl_or_b32 v121, v51, 16, v50
v_lshl_or_b32 v122, v53, 16, v52
v_lshl_or_b32 v123, v55, 16, v54
s_waitcnt vmcnt(0)
v_lshl_or_b32 v124, v57, 16, v56
v_lshl_or_b32 v125, v59, 16, v58
v_lshl_or_b32 v126, v61, 16, v60
v_lshl_or_b32 v127, v63, 16, v62
s_mov_b32 s40, 3538944
buffer_load_ushort v16, v4, s[16:19], s40 offen
s_mov_b32 s40, 3548160
buffer_load_ushort v17, v4, s[16:19], s40 offen
s_mov_b32 s40, 3557376
buffer_load_ushort v18, v4, s[16:19], s40 offen
s_mov_b32 s40, 3566592
buffer_load_ushort v19, v4, s[16:19], s40 offen
s_mov_b32 s40, 3575808
buffer_load_ushort v20, v4, s[16:19], s40 offen
s_mov_b32 s40, 3585024
buffer_load_ushort v21, v4, s[16:19], s40 offen
s_mov_b32 s40, 3594240
buffer_load_ushort v22, v4, s[16:19], s40 offen
s_mov_b32 s40, 3603456
buffer_load_ushort v23, v4, s[16:19], s40 offen
s_mov_b32 s40, 3833856
buffer_load_ushort v24, v4, s[16:19], s40 offen
s_mov_b32 s40, 3843072
buffer_load_ushort v25, v4, s[16:19], s40 offen
s_mov_b32 s40, 3852288
buffer_load_ushort v26, v4, s[16:19], s40 offen
s_mov_b32 s40, 3861504
buffer_load_ushort v27, v4, s[16:19], s40 offen
s_mov_b32 s40, 3870720
buffer_load_ushort v28, v4, s[16:19], s40 offen
s_mov_b32 s40, 3879936
buffer_load_ushort v29, v4, s[16:19], s40 offen
s_mov_b32 s40, 3889152
buffer_load_ushort v30, v4, s[16:19], s40 offen
s_mov_b32 s40, 3898368
buffer_load_ushort v31, v4, s[16:19], s40 offen
s_mov_b32 s40, 4128768
buffer_load_ushort v32, v4, s[16:19], s40 offen
s_mov_b32 s40, 4137984
buffer_load_ushort v33, v4, s[16:19], s40 offen
s_mov_b32 s40, 4147200
buffer_load_ushort v34, v4, s[16:19], s40 offen
s_mov_b32 s40, 4156416
buffer_load_ushort v35, v4, s[16:19], s40 offen
s_mov_b32 s40, 4165632
buffer_load_ushort v36, v4, s[16:19], s40 offen
s_mov_b32 s40, 4174848
buffer_load_ushort v37, v4, s[16:19], s40 offen
s_mov_b32 s40, 4184064
buffer_load_ushort v38, v4, s[16:19], s40 offen
s_mov_b32 s40, 4193280
buffer_load_ushort v39, v4, s[16:19], s40 offen
s_mov_b32 s40, 4423680
buffer_load_ushort v40, v4, s[16:19], s40 offen
s_mov_b32 s40, 4432896
buffer_load_ushort v41, v4, s[16:19], s40 offen
s_mov_b32 s40, 4442112
buffer_load_ushort v42, v4, s[16:19], s40 offen
s_mov_b32 s40, 4451328
buffer_load_ushort v43, v4, s[16:19], s40 offen
s_mov_b32 s40, 4460544
buffer_load_ushort v44, v4, s[16:19], s40 offen
s_mov_b32 s40, 4469760
buffer_load_ushort v45, v4, s[16:19], s40 offen
s_mov_b32 s40, 4478976
buffer_load_ushort v46, v4, s[16:19], s40 offen
s_mov_b32 s40, 4488192
buffer_load_ushort v47, v4, s[16:19], s40 offen
s_mov_b32 s40, 4718592
buffer_load_ushort v48, v4, s[16:19], s40 offen
s_mov_b32 s40, 4727808
buffer_load_ushort v49, v4, s[16:19], s40 offen
s_mov_b32 s40, 4737024
buffer_load_ushort v50, v4, s[16:19], s40 offen
s_mov_b32 s40, 4746240
buffer_load_ushort v51, v4, s[16:19], s40 offen
s_mov_b32 s40, 4755456
buffer_load_ushort v52, v4, s[16:19], s40 offen
s_mov_b32 s40, 4764672
buffer_load_ushort v53, v4, s[16:19], s40 offen
s_mov_b32 s40, 4773888
buffer_load_ushort v54, v4, s[16:19], s40 offen
s_mov_b32 s40, 4783104
buffer_load_ushort v55, v4, s[16:19], s40 offen
s_mov_b32 s40, 5013504
buffer_load_ushort v56, v4, s[16:19], s40 offen
s_mov_b32 s40, 5022720
buffer_load_ushort v57, v4, s[16:19], s40 offen
s_mov_b32 s40, 5031936
buffer_load_ushort v58, v4, s[16:19], s40 offen
s_mov_b32 s40, 5041152
buffer_load_ushort v59, v4, s[16:19], s40 offen
s_mov_b32 s40, 5050368
buffer_load_ushort v60, v4, s[16:19], s40 offen
s_mov_b32 s40, 5059584
buffer_load_ushort v61, v4, s[16:19], s40 offen
s_mov_b32 s40, 5068800
buffer_load_ushort v62, v4, s[16:19], s40 offen
s_mov_b32 s40, 5078016
buffer_load_ushort v63, v4, s[16:19], s40 offen
s_waitcnt vmcnt(40)
v_lshl_or_b32 v128, v17, 16, v16
v_lshl_or_b32 v129, v19, 16, v18
v_lshl_or_b32 v130, v21, 16, v20
v_lshl_or_b32 v131, v23, 16, v22
s_waitcnt vmcnt(32)
v_lshl_or_b32 v132, v25, 16, v24
v_lshl_or_b32 v133, v27, 16, v26
v_lshl_or_b32 v134, v29, 16, v28
v_lshl_or_b32 v135, v31, 16, v30
s_waitcnt vmcnt(24)
v_lshl_or_b32 v136, v33, 16, v32
v_lshl_or_b32 v137, v35, 16, v34
v_lshl_or_b32 v138, v37, 16, v36
v_lshl_or_b32 v139, v39, 16, v38
s_waitcnt vmcnt(16)
v_lshl_or_b32 v140, v41, 16, v40
v_lshl_or_b32 v141, v43, 16, v42
v_lshl_or_b32 v142, v45, 16, v44
v_lshl_or_b32 v143, v47, 16, v46
s_waitcnt vmcnt(8)
v_lshl_or_b32 v144, v49, 16, v48
v_lshl_or_b32 v145, v51, 16, v50
v_lshl_or_b32 v146, v53, 16, v52
v_lshl_or_b32 v147, v55, 16, v54
s_waitcnt vmcnt(0)
v_lshl_or_b32 v148, v57, 16, v56
v_lshl_or_b32 v149, v59, 16, v58
v_lshl_or_b32 v150, v61, 16, v60
v_lshl_or_b32 v151, v63, 16, v62
s_mov_b32 s31, 0x3f803f80
v_mov_b32 v12, 0
v_mov_b32 v13, 0
v_dot2_f32_bf16 v12, v80, s31, v12
v_dot2_f32_bf16 v13, v81, s31, v13
v_dot2_f32_bf16 v12, v82, s31, v12
v_dot2_f32_bf16 v13, v83, s31, v13
v_dot2_f32_bf16 v12, v84, s31, v12
v_dot2_f32_bf16 v13, v85, s31, v13
v_dot2_f32_bf16 v12, v86, s31, v12
v_dot2_f32_bf16 v13, v87, s31, v13
v_dot2_f32_bf16 v12, v88, s31, v12
v_dot2_f32_bf16 v13, v89, s31, v13
v_dot2_f32_bf16 v12, v90, s31, v12
v_dot2_f32_bf16 v13, v91, s31, v13
v_dot2_f32_bf16 v12, v92, s31, v12
v_dot2_f32_bf16 v13, v93, s31, v13
v_dot2_f32_bf16 v12, v94, s31, v12
v_dot2_f32_bf16 v13, v95, s31, v13
v_dot2_f32_bf16 v12, v96, s31, v12
v_dot2_f32_bf16 v13, v97, s31, v13
v_dot2_f32_bf16 v12, v98, s31, v12
v_dot2_f32_bf16 v13, v99, s31, v13
v_dot2_f32_bf16 v12, v100, s31, v12
v_dot2_f32_bf16 v13, v101, s31, v13
v_dot2_f32_bf16 v12, v102, s31, v12
v_dot2_f32_bf16 v13, v103, s31, v13
v_dot2_f32_bf16 v12, v104, s31, v12
v_dot2_f32_bf16 v13, v105, s31, v13
v_dot2_f32_bf16 v12, v106, s31, v12
v_dot2_f32_bf16 v13, v107, s31, v13
v_dot2_f32_bf16 v12, v108, s31, v12
v_dot2_f32_bf16 v13, v109, s31, v13
v_dot2_f32_bf16 v12, v110, s31, v12
v_dot2_f32_bf16 v13, v111, s31, v13
v_dot2_f32_bf16 v12, v112, s31, v12
v_dot2_f32_bf16 v13, v113, s31, v13
v_dot2_f32_bf16 v12, v114, s31, v12
v_dot2_f32_bf16 v13, v115, s31, v13
v_dot2_f32_bf16 v12, v116, s31, v12
v_dot2_f32_bf16 v13, v117, s31, v13
v_dot2_f32_bf16 v12, v118, s31, v12
v_dot2_f32_bf16 v13, v119, s31, v13
v_dot2_f32_bf16 v12, v120, s31, v12
v_dot2_f32_bf16 v13, v121, s31, v13
v_dot2_f32_bf16 v12, v122, s31, v12
v_dot2_f32_bf16 v13, v123, s31, v13
v_dot2_f32_bf16 v12, v124, s31, v12
v_dot2_f32_bf16 v13, v125, s31, v13
v_dot2_f32_bf16 v12, v126, s31, v12
v_dot2_f32_bf16 v13, v127, s31, v13
v_dot2_f32_bf16 v12, v128, s31, v12
v_dot2_f32_bf16 v13, v129, s31, v13
v_dot2_f32_bf16 v12, v130, s31, v12
v_dot2_f32_bf16 v13, v131, s31, v13
v_dot2_f32_bf16 v12, v132, s31, v12
v_dot2_f32_bf16 v13, v133, s31, v13
v_dot2_f32_bf16 v12, v134, s31, v12
v_dot2_f32_bf16 v13, v135, s31, v13
v_dot2_f32_bf16 v12, v136, s31, v12
v_dot2_f32_bf16 v13, v137, s31, v13
v_dot2_f32_bf16 v12, v138, s31, v12
v_dot2_f32_bf16 v13, v139, s31, v13
v_dot2_f32_bf16 v12, v140, s31, v12
v_dot2_f32_bf16 v13, v141, s31, v13
v_dot2_f32_bf16 v12, v142, s31, v12
v_dot2_f32_bf16 v13, v143, s31, v13
v_dot2_f32_bf16 v12, v144, s31, v12
v_dot2_f32_bf16 v13, v145, s31, v13
v_dot2_f32_bf16 v12, v146, s31, v12
v_dot2_f32_bf16 v13, v147, s31, v13
v_dot2_f32_bf16 v12, v148, s31, v12
v_dot2_f32_bf16 v13, v149, s31, v13
v_dot2_f32_bf16 v12, v150, s31, v12
v_dot2_f32_bf16 v13, v151, s31, v13
s_nop 2
v_add_f32 v12, v12, v13
v_mov_b32 v13, v12
s_nop 1
v_permlane16_swap_b32 v12, v13
v_add_f32 v12, v12, v13
v_mov_b32 v13, v12
s_nop 1
v_permlane32_swap_b32 v12, v13
v_add_f32 v12, v12, v13
v_mul_f32 v12, 0x3ae38e39, v12
v_lshlrev_b32 v16, 16, v80
v_and_b32 v17, 0xffff0000, v80
v_sub_f32 v16, v16, v12
v_sub_f32 v17, v17, v12
v_cvt_pk_bf16_f32 v80, v16, v17
v_lshlrev_b32 v18, 16, v81
v_and_b32 v19, 0xffff0000, v81
v_sub_f32 v18, v18, v12
v_sub_f32 v19, v19, v12
v_cvt_pk_bf16_f32 v81, v18, v19
v_lshlrev_b32 v20, 16, v82
v_and_b32 v21, 0xffff0000, v82
v_sub_f32 v20, v20, v12
v_sub_f32 v21, v21, v12
v_cvt_pk_bf16_f32 v82, v20, v21
v_lshlrev_b32 v22, 16, v83
v_and_b32 v23, 0xffff0000, v83
v_sub_f32 v22, v22, v12
v_sub_f32 v23, v23, v12
v_cvt_pk_bf16_f32 v83, v22, v23
v_lshlrev_b32 v16, 16, v84
v_and_b32 v17, 0xffff0000, v84
v_sub_f32 v16, v16, v12
v_sub_f32 v17, v17, v12
v_cvt_pk_bf16_f32 v84, v16, v17
v_lshlrev_b32 v18, 16, v85
v_and_b32 v19, 0xffff0000, v85
v_sub_f32 v18, v18, v12
v_sub_f32 v19, v19, v12
v_cvt_pk_bf16_f32 v85, v18, v19
v_lshlrev_b32 v20, 16, v86
v_and_b32 v21, 0xffff0000, v86
v_sub_f32 v20, v20, v12
v_sub_f32 v21, v21, v12
v_cvt_pk_bf16_f32 v86, v20, v21
v_lshlrev_b32 v22, 16, v87
v_and_b32 v23, 0xffff0000, v87
v_sub_f32 v22, v22, v12
v_sub_f32 v23, v23, v12
v_cvt_pk_bf16_f32 v87, v22, v23
v_lshlrev_b32 v16, 16, v88
v_and_b32 v17, 0xffff0000, v88
v_sub_f32 v16, v16, v12
v_sub_f32 v17, v17, v12
v_cvt_pk_bf16_f32 v88, v16, v17
v_lshlrev_b32 v18, 16, v89
v_and_b32 v19, 0xffff0000, v89
v_sub_f32 v18, v18, v12
v_sub_f32 v19, v19, v12
v_cvt_pk_bf16_f32 v89, v18, v19
v_lshlrev_b32 v20, 16, v90
v_and_b32 v21, 0xffff0000, v90
v_sub_f32 v20, v20, v12
v_sub_f32 v21, v21, v12
v_cvt_pk_bf16_f32 v90, v20, v21
v_lshlrev_b32 v22, 16, v91
v_and_b32 v23, 0xffff0000, v91
v_sub_f32 v22, v22, v12
v_sub_f32 v23, v23, v12
v_cvt_pk_bf16_f32 v91, v22, v23
v_lshlrev_b32 v16, 16, v92
v_and_b32 v17, 0xffff0000, v92
v_sub_f32 v16, v16, v12
v_sub_f32 v17, v17, v12
v_cvt_pk_bf16_f32 v92, v16, v17
v_lshlrev_b32 v18, 16, v93
v_and_b32 v19, 0xffff0000, v93
v_sub_f32 v18, v18, v12
v_sub_f32 v19, v19, v12
v_cvt_pk_bf16_f32 v93, v18, v19
v_lshlrev_b32 v20, 16, v94
v_and_b32 v21, 0xffff0000, v94
v_sub_f32 v20, v20, v12
v_sub_f32 v21, v21, v12
v_cvt_pk_bf16_f32 v94, v20, v21
v_lshlrev_b32 v22, 16, v95
v_and_b32 v23, 0xffff0000, v95
v_sub_f32 v22, v22, v12
v_sub_f32 v23, v23, v12
v_cvt_pk_bf16_f32 v95, v22, v23
v_lshlrev_b32 v16, 16, v96
v_and_b32 v17, 0xffff0000, v96
v_sub_f32 v16, v16, v12
v_sub_f32 v17, v17, v12
v_cvt_pk_bf16_f32 v96, v16, v17
v_lshlrev_b32 v18, 16, v97
v_and_b32 v19, 0xffff0000, v97
v_sub_f32 v18, v18, v12
v_sub_f32 v19, v19, v12
v_cvt_pk_bf16_f32 v97, v18, v19
v_lshlrev_b32 v20, 16, v98
v_and_b32 v21, 0xffff0000, v98
v_sub_f32 v20, v20, v12
v_sub_f32 v21, v21, v12
v_cvt_pk_bf16_f32 v98, v20, v21
v_lshlrev_b32 v22, 16, v99
v_and_b32 v23, 0xffff0000, v99
v_sub_f32 v22, v22, v12
v_sub_f32 v23, v23, v12
v_cvt_pk_bf16_f32 v99, v22, v23
v_lshlrev_b32 v16, 16, v100
v_and_b32 v17, 0xffff0000, v100
v_sub_f32 v16, v16, v12
v_sub_f32 v17, v17, v12
v_cvt_pk_bf16_f32 v100, v16, v17
v_lshlrev_b32 v18, 16, v101
v_and_b32 v19, 0xffff0000, v101
v_sub_f32 v18, v18, v12
v_sub_f32 v19, v19, v12
v_cvt_pk_bf16_f32 v101, v18, v19
v_lshlrev_b32 v20, 16, v102
v_and_b32 v21, 0xffff0000, v102
v_sub_f32 v20, v20, v12
v_sub_f32 v21, v21, v12
v_cvt_pk_bf16_f32 v102, v20, v21
v_lshlrev_b32 v22, 16, v103
v_and_b32 v23, 0xffff0000, v103
v_sub_f32 v22, v22, v12
v_sub_f32 v23, v23, v12
v_cvt_pk_bf16_f32 v103, v22, v23
v_lshlrev_b32 v16, 16, v104
v_and_b32 v17, 0xffff0000, v104
v_sub_f32 v16, v16, v12
v_sub_f32 v17, v17, v12
v_cvt_pk_bf16_f32 v104, v16, v17
v_lshlrev_b32 v18, 16, v105
v_and_b32 v19, 0xffff0000, v105
v_sub_f32 v18, v18, v12
v_sub_f32 v19, v19, v12
v_cvt_pk_bf16_f32 v105, v18, v19
v_lshlrev_b32 v20, 16, v106
v_and_b32 v21, 0xffff0000, v106
v_sub_f32 v20, v20, v12
v_sub_f32 v21, v21, v12
v_cvt_pk_bf16_f32 v106, v20, v21
v_lshlrev_b32 v22, 16, v107
v_and_b32 v23, 0xffff0000, v107
v_sub_f32 v22, v22, v12
v_sub_f32 v23, v23, v12
v_cvt_pk_bf16_f32 v107, v22, v23
v_lshlrev_b32 v16, 16, v108
v_and_b32 v17, 0xffff0000, v108
v_sub_f32 v16, v16, v12
v_sub_f32 v17, v17, v12
v_cvt_pk_bf16_f32 v108, v16, v17
v_lshlrev_b32 v18, 16, v109
v_and_b32 v19, 0xffff0000, v109
v_sub_f32 v18, v18, v12
v_sub_f32 v19, v19, v12
v_cvt_pk_bf16_f32 v109, v18, v19
v_lshlrev_b32 v20, 16, v110
v_and_b32 v21, 0xffff0000, v110
v_sub_f32 v20, v20, v12
v_sub_f32 v21, v21, v12
v_cvt_pk_bf16_f32 v110, v20, v21
v_lshlrev_b32 v22, 16, v111
v_and_b32 v23, 0xffff0000, v111
v_sub_f32 v22, v22, v12
v_sub_f32 v23, v23, v12
v_cvt_pk_bf16_f32 v111, v22, v23
v_lshlrev_b32 v16, 16, v112
v_and_b32 v17, 0xffff0000, v112
v_sub_f32 v16, v16, v12
v_sub_f32 v17, v17, v12
v_cvt_pk_bf16_f32 v112, v16, v17
v_lshlrev_b32 v18, 16, v113
v_and_b32 v19, 0xffff0000, v113
v_sub_f32 v18, v18, v12
v_sub_f32 v19, v19, v12
v_cvt_pk_bf16_f32 v113, v18, v19
v_lshlrev_b32 v20, 16, v114
v_and_b32 v21, 0xffff0000, v114
v_sub_f32 v20, v20, v12
v_sub_f32 v21, v21, v12
v_cvt_pk_bf16_f32 v114, v20, v21
v_lshlrev_b32 v22, 16, v115
v_and_b32 v23, 0xffff0000, v115
v_sub_f32 v22, v22, v12
v_sub_f32 v23, v23, v12
v_cvt_pk_bf16_f32 v115, v22, v23
v_lshlrev_b32 v16, 16, v116
v_and_b32 v17, 0xffff0000, v116
v_sub_f32 v16, v16, v12
v_sub_f32 v17, v17, v12
v_cvt_pk_bf16_f32 v116, v16, v17
v_lshlrev_b32 v18, 16, v117
v_and_b32 v19, 0xffff0000, v117
v_sub_f32 v18, v18, v12
v_sub_f32 v19, v19, v12
v_cvt_pk_bf16_f32 v117, v18, v19
v_lshlrev_b32 v20, 16, v118
v_and_b32 v21, 0xffff0000, v118
v_sub_f32 v20, v20, v12
v_sub_f32 v21, v21, v12
v_cvt_pk_bf16_f32 v118, v20, v21
v_lshlrev_b32 v22, 16, v119
v_and_b32 v23, 0xffff0000, v119
v_sub_f32 v22, v22, v12
v_sub_f32 v23, v23, v12
v_cvt_pk_bf16_f32 v119, v22, v23
v_lshlrev_b32 v16, 16, v120
v_and_b32 v17, 0xffff0000, v120
v_sub_f32 v16, v16, v12
v_sub_f32 v17, v17, v12
v_cvt_pk_bf16_f32 v120, v16, v17
v_lshlrev_b32 v18, 16, v121
v_and_b32 v19, 0xffff0000, v121
v_sub_f32 v18, v18, v12
v_sub_f32 v19, v19, v12
v_cvt_pk_bf16_f32 v121, v18, v19
v_lshlrev_b32 v20, 16, v122
v_and_b32 v21, 0xffff0000, v122
v_sub_f32 v20, v20, v12
v_sub_f32 v21, v21, v12
v_cvt_pk_bf16_f32 v122, v20, v21
v_lshlrev_b32 v22, 16, v123
v_and_b32 v23, 0xffff0000, v123
v_sub_f32 v22, v22, v12
v_sub_f32 v23, v23, v12
v_cvt_pk_bf16_f32 v123, v22, v23
v_lshlrev_b32 v16, 16, v124
v_and_b32 v17, 0xffff0000, v124
v_sub_f32 v16, v16, v12
v_sub_f32 v17, v17, v12
v_cvt_pk_bf16_f32 v124, v16, v17
v_lshlrev_b32 v18, 16, v125
v_and_b32 v19, 0xffff0000, v125
v_sub_f32 v18, v18, v12
v_sub_f32 v19, v19, v12
v_cvt_pk_bf16_f32 v125, v18, v19
v_lshlrev_b32 v20, 16, v126
v_and_b32 v21, 0xffff0000, v126
v_sub_f32 v20, v20, v12
v_sub_f32 v21, v21, v12
v_cvt_pk_bf16_f32 v126, v20, v21
v_lshlrev_b32 v22, 16, v127
v_and_b32 v23, 0xffff0000, v127
v_sub_f32 v22, v22, v12
v_sub_f32 v23, v23, v12
v_cvt_pk_bf16_f32 v127, v22, v23
v_lshlrev_b32 v16, 16, v128
v_and_b32 v17, 0xffff0000, v128
v_sub_f32 v16, v16, v12
v_sub_f32 v17, v17, v12
v_cvt_pk_bf16_f32 v128, v16, v17
v_lshlrev_b32 v18, 16, v129
v_and_b32 v19, 0xffff0000, v129
v_sub_f32 v18, v18, v12
v_sub_f32 v19, v19, v12
v_cvt_pk_bf16_f32 v129, v18, v19
v_lshlrev_b32 v20, 16, v130
v_and_b32 v21, 0xffff0000, v130
v_sub_f32 v20, v20, v12
v_sub_f32 v21, v21, v12
v_cvt_pk_bf16_f32 v130, v20, v21
v_lshlrev_b32 v22, 16, v131
v_and_b32 v23, 0xffff0000, v131
v_sub_f32 v22, v22, v12
v_sub_f32 v23, v23, v12
v_cvt_pk_bf16_f32 v131, v22, v23
v_lshlrev_b32 v16, 16, v132
v_and_b32 v17, 0xffff0000, v132
v_sub_f32 v16, v16, v12
v_sub_f32 v17, v17, v12
v_cvt_pk_bf16_f32 v132, v16, v17
v_lshlrev_b32 v18, 16, v133
v_and_b32 v19, 0xffff0000, v133
v_sub_f32 v18, v18, v12
v_sub_f32 v19, v19, v12
v_cvt_pk_bf16_f32 v133, v18, v19
v_lshlrev_b32 v20, 16, v134
v_and_b32 v21, 0xffff0000, v134
v_sub_f32 v20, v20, v12
v_sub_f32 v21, v21, v12
v_cvt_pk_bf16_f32 v134, v20, v21
v_lshlrev_b32 v22, 16, v135
v_and_b32 v23, 0xffff0000, v135
v_sub_f32 v22, v22, v12
v_sub_f32 v23, v23, v12
v_cvt_pk_bf16_f32 v135, v22, v23
v_lshlrev_b32 v16, 16, v136
v_and_b32 v17, 0xffff0000, v136
v_sub_f32 v16, v16, v12
v_sub_f32 v17, v17, v12
v_cvt_pk_bf16_f32 v136, v16, v17
v_lshlrev_b32 v18, 16, v137
v_and_b32 v19, 0xffff0000, v137
v_sub_f32 v18, v18, v12
v_sub_f32 v19, v19, v12
v_cvt_pk_bf16_f32 v137, v18, v19
v_lshlrev_b32 v20, 16, v138
v_and_b32 v21, 0xffff0000, v138
v_sub_f32 v20, v20, v12
v_sub_f32 v21, v21, v12
v_cvt_pk_bf16_f32 v138, v20, v21
v_lshlrev_b32 v22, 16, v139
v_and_b32 v23, 0xffff0000, v139
v_sub_f32 v22, v22, v12
v_sub_f32 v23, v23, v12
v_cvt_pk_bf16_f32 v139, v22, v23
v_lshlrev_b32 v16, 16, v140
v_and_b32 v17, 0xffff0000, v140
v_sub_f32 v16, v16, v12
v_sub_f32 v17, v17, v12
v_cvt_pk_bf16_f32 v140, v16, v17
v_lshlrev_b32 v18, 16, v141
v_and_b32 v19, 0xffff0000, v141
v_sub_f32 v18, v18, v12
v_sub_f32 v19, v19, v12
v_cvt_pk_bf16_f32 v141, v18, v19
v_lshlrev_b32 v20, 16, v142
v_and_b32 v21, 0xffff0000, v142
v_sub_f32 v20, v20, v12
v_sub_f32 v21, v21, v12
v_cvt_pk_bf16_f32 v142, v20, v21
v_lshlrev_b32 v22, 16, v143
v_and_b32 v23, 0xffff0000, v143
v_sub_f32 v22, v22, v12
v_sub_f32 v23, v23, v12
v_cvt_pk_bf16_f32 v143, v22, v23
v_lshlrev_b32 v16, 16, v144
v_and_b32 v17, 0xffff0000, v144
v_sub_f32 v16, v16, v12
v_sub_f32 v17, v17, v12
v_cvt_pk_bf16_f32 v144, v16, v17
v_lshlrev_b32 v18, 16, v145
v_and_b32 v19, 0xffff0000, v145
v_sub_f32 v18, v18, v12
v_sub_f32 v19, v19, v12
v_cvt_pk_bf16_f32 v145, v18, v19
v_lshlrev_b32 v20, 16, v146
v_and_b32 v21, 0xffff0000, v146
v_sub_f32 v20, v20, v12
v_sub_f32 v21, v21, v12
v_cvt_pk_bf16_f32 v146, v20, v21
v_lshlrev_b32 v22, 16, v147
v_and_b32 v23, 0xffff0000, v147
v_sub_f32 v22, v22, v12
v_sub_f32 v23, v23, v12
v_cvt_pk_bf16_f32 v147, v22, v23
v_lshlrev_b32 v16, 16, v148
v_and_b32 v17, 0xffff0000, v148
v_sub_f32 v16, v16, v12
v_sub_f32 v17, v17, v12
v_cvt_pk_bf16_f32 v148, v16, v17
v_lshlrev_b32 v18, 16, v149
v_and_b32 v19, 0xffff0000, v149
v_sub_f32 v18, v18, v12
v_sub_f32 v19, v19, v12
v_cvt_pk_bf16_f32 v149, v18, v19
v_lshlrev_b32 v20, 16, v150
v_and_b32 v21, 0xffff0000, v150
v_sub_f32 v20, v20, v12
v_sub_f32 v21, v21, v12
v_cvt_pk_bf16_f32 v150, v20, v21
v_lshlrev_b32 v22, 16, v151
v_and_b32 v23, 0xffff0000, v151
v_sub_f32 v22, v22, v12
v_sub_f32 v23, v23, v12
v_cvt_pk_bf16_f32 v151, v22, v23
s_add_u32 s40, s29, 0
buffer_store_dwordx4 v[80:83], v2, s[8:11], s40 offen
s_add_u32 s40, s29, 1024
buffer_store_dwordx4 v[84:87], v2, s[8:11], s40 offen
s_add_u32 s29, s29, s32
s_add_u32 s40, s29, 0
buffer_store_dwordx4 v[88:91], v2, s[8:11], s40 offen
s_add_u32 s40, s29, 1024
buffer_store_dwordx4 v[92:95], v2, s[8:11], s40 offen
s_add_u32 s29, s29, s32
s_add_u32 s40, s29, 0
buffer_store_dwordx4 v[96:99], v2, s[8:11], s40 offen
s_add_u32 s40, s29, 1024
buffer_store_dwordx4 v[100:103], v2, s[8:11], s40 offen
s_add_u32 s29, s29, s32
s_add_u32 s40, s29, 0
buffer_store_dwordx4 v[104:107], v2, s[8:11], s40 offen
s_add_u32 s40, s29, 1024
buffer_store_dwordx4 v[108:111], v2, s[8:11], s40 offen
s_add_u32 s29, s29, s32
s_add_u32 s40, s29, 0
buffer_store_dwordx4 v[112:115], v2, s[8:11], s40 offen
s_add_u32 s40, s29, 1024
buffer_store_dwordx4 v[116:119], v2, s[8:11], s40 offen
s_add_u32 s29, s29, s32
s_add_u32 s40, s29, 0
buffer_store_dwordx4 v[120:123], v2, s[8:11], s40 offen
s_add_u32 s40, s29, 1024
buffer_store_dwordx4 v[124:127], v2, s[8:11], s40 offen
s_add_u32 s29, s29, s32
s_add_u32 s40, s29, 0
buffer_store_dwordx4 v[128:131], v2, s[8:11], s40 offen
s_add_u32 s40, s29, 1024
buffer_store_dwordx4 v[132:135], v2, s[8:11], s40 offen
s_add_u32 s29, s29, s32
s_add_u32 s40, s29, 0
buffer_store_dwordx4 v[136:139], v2, s[8:11], s40 offen
s_add_u32 s40, s29, 1024
buffer_store_dwordx4 v[140:143], v2, s[8:11], s40 offen
s_add_u32 s29, s29, s32
s_add_u32 s40, s29, 0
buffer_store_dwordx4 v[144:147], v2, s[8:11], s40 offen
s_add_u32 s40, s29, 1024
buffer_store_dwordx4 v[148:151], v2, s[8:11], s40 offen
s_branch L_prep_end
L_pack_d:
s_sub_u32 s20, s20, 576
s_mul_i32 s21, s20, 7282
s_lshr_b32 s21, s21, 16
s_mul_i32 s22, s21, 9
s_sub_u32 s22, s20, s22
s_lshr_b32 s23, s21, 2
s_and_b32 s24, s21, 3
s_load_dwordx2 s[12:13], s[0:1], 48
s_waitcnt lgkmcnt(0)
s_mov_b32 s16, s12
s_and_b32 s17, s13, 0xffff
s_mov_b32 s18, 5308416
s_mov_b32 s19, 0x20000
s_lshr_b32 s25, s22, 1
s_lshl_b32 s25, s25, 5
s_and_b32 s26, s22, 1
s_lshl_b32 s26, s26, 2
s_add_u32 s25, s25, s26
s_mul_i32 s26, s24, 144
s_add_u32 s25, s25, s26
s_cmp_eq_u32 s22, 8
s_cselect_b64 vcc, -1, 0
v_cndmask_b32 v11, v10, v6, vcc
v_add_u32 v11, s25, v11
v_lshlrev_b32 v11, 1, v11
v_mul_u32_u24 v12, 9216, v7
v_add_u32 v4, v11, v12
s_mul_i32 s26, s23, 663552
s_add_u32 s27, s24, 0
s_and_b32 s27, s27, 3
s_mul_i32 s27, s27, 9
s_add_u32 s27, s27, 1
s_lshr_b32 s27, s27, 1
s_mul_i32 s27, s27, 36864
s_add_u32 s32, s26, s27
s_add_u32 s27, s24, 1
s_and_b32 s27, s27, 3
s_mul_i32 s27, s27, 9
s_add_u32 s27, s27, 1
s_lshr_b32 s27, s27, 1
s_mul_i32 s27, s27, 36864
s_add_u32 s33, s26, s27
s_add_u32 s27, s24, 2
s_and_b32 s27, s27, 3
s_mul_i32 s27, s27, 9
s_add_u32 s27, s27, 1
s_lshr_b32 s27, s27, 1
s_mul_i32 s27, s27, 36864
s_add_u32 s34, s26, s27
s_add_u32 s27, s24, 3
s_and_b32 s27, s27, 3
s_mul_i32 s27, s27, 9
s_add_u32 s27, s27, 1
s_lshr_b32 s27, s27, 1
s_mul_i32 s27, s27, 36864
s_add_u32 s35, s26, s27
s_add_u32 s40, s32, 0
buffer_load_ushort v16, v4, s[16:19], s40 offen
s_add_u32 s40, s32, 1152
buffer_load_ushort v17, v4, s[16:19], s40 offen
s_add_u32 s40, s32, 2304
buffer_load_ushort v18, v4, s[16:19], s40 offen
s_add_u32 s40, s32, 3456
buffer_load_ushort v19, v4, s[16:19], s40 offen
s_add_u32 s40, s32, 4608
buffer_load_ushort v20, v4, s[16:19], s40 offen
s_add_u32 s40, s32, 5760
buffer_load_ushort v21, v4, s[16:19], s40 offen
s_add_u32 s40, s32, 6912
buffer_load_ushort v22, v4, s[16:19], s40 offen
s_add_u32 s40, s32, 8064
buffer_load_ushort v23, v4, s[16:19], s40 offen
s_add_u32 s40, s32, 36864
buffer_load_ushort v24, v4, s[16:19], s40 offen
s_add_u32 s40, s32, 38016
buffer_load_ushort v25, v4, s[16:19], s40 offen
s_add_u32 s40, s32, 39168
buffer_load_ushort v26, v4, s[16:19], s40 offen
s_add_u32 s40, s32, 40320
buffer_load_ushort v27, v4, s[16:19], s40 offen
s_add_u32 s40, s32, 41472
buffer_load_ushort v28, v4, s[16:19], s40 offen
s_add_u32 s40, s32, 42624
buffer_load_ushort v29, v4, s[16:19], s40 offen
s_add_u32 s40, s32, 43776
buffer_load_ushort v30, v4, s[16:19], s40 offen
s_add_u32 s40, s32, 44928
buffer_load_ushort v31, v4, s[16:19], s40 offen
s_add_u32 s40, s32, 73728
buffer_load_ushort v32, v4, s[16:19], s40 offen
s_add_u32 s40, s32, 74880
buffer_load_ushort v33, v4, s[16:19], s40 offen
s_add_u32 s40, s32, 76032
buffer_load_ushort v34, v4, s[16:19], s40 offen
s_add_u32 s40, s32, 77184
buffer_load_ushort v35, v4, s[16:19], s40 offen
s_add_u32 s40, s32, 78336
buffer_load_ushort v36, v4, s[16:19], s40 offen
s_add_u32 s40, s32, 79488
buffer_load_ushort v37, v4, s[16:19], s40 offen
s_add_u32 s40, s32, 80640
buffer_load_ushort v38, v4, s[16:19], s40 offen
s_add_u32 s40, s32, 81792
buffer_load_ushort v39, v4, s[16:19], s40 offen
s_add_u32 s40, s33, 0
buffer_load_ushort v40, v4, s[16:19], s40 offen
s_add_u32 s40, s33, 1152
buffer_load_ushort v41, v4, s[16:19], s40 offen
s_add_u32 s40, s33, 2304
buffer_load_ushort v42, v4, s[16:19], s40 offen
s_add_u32 s40, s33, 3456
buffer_load_ushort v43, v4, s[16:19], s40 offen
s_add_u32 s40, s33, 4608
buffer_load_ushort v44, v4, s[16:19], s40 offen
s_add_u32 s40, s33, 5760
buffer_load_ushort v45, v4, s[16:19], s40 offen
s_add_u32 s40, s33, 6912
buffer_load_ushort v46, v4, s[16:19], s40 offen
s_add_u32 s40, s33, 8064
buffer_load_ushort v47, v4, s[16:19], s40 offen
s_add_u32 s40, s34, 0
buffer_load_ushort v48, v4, s[16:19], s40 offen
s_add_u32 s40, s34, 1152
buffer_load_ushort v49, v4, s[16:19], s40 offen
s_add_u32 s40, s34, 2304
buffer_load_ushort v50, v4, s[16:19], s40 offen
s_add_u32 s40, s34, 3456
buffer_load_ushort v51, v4, s[16:19], s40 offen
s_add_u32 s40, s34, 4608
buffer_load_ushort v52, v4, s[16:19], s40 offen
s_add_u32 s40, s34, 5760
buffer_load_ushort v53, v4, s[16:19], s40 offen
s_add_u32 s40, s34, 6912
buffer_load_ushort v54, v4, s[16:19], s40 offen
s_add_u32 s40, s34, 8064
buffer_load_ushort v55, v4, s[16:19], s40 offen
s_add_u32 s40, s35, 0
buffer_load_ushort v56, v4, s[16:19], s40 offen
s_add_u32 s40, s35, 1152
buffer_load_ushort v57, v4, s[16:19], s40 offen
s_add_u32 s40, s35, 2304
buffer_load_ushort v58, v4, s[16:19], s40 offen
s_add_u32 s40, s35, 3456
buffer_load_ushort v59, v4, s[16:19], s40 offen
s_add_u32 s40, s35, 4608
buffer_load_ushort v60, v4, s[16:19], s40 offen
s_add_u32 s40, s35, 5760
buffer_load_ushort v61, v4, s[16:19], s40 offen
s_add_u32 s40, s35, 6912
buffer_load_ushort v62, v4, s[16:19], s40 offen
s_add_u32 s40, s35, 8064
buffer_load_ushort v63, v4, s[16:19], s40 offen
s_waitcnt vmcnt(40)
v_lshl_or_b32 v80, v17, 16, v16
v_lshl_or_b32 v81, v19, 16, v18
v_lshl_or_b32 v82, v21, 16, v20
v_lshl_or_b32 v83, v23, 16, v22
s_waitcnt vmcnt(32)
v_lshl_or_b32 v84, v25, 16, v24
v_lshl_or_b32 v85, v27, 16, v26
v_lshl_or_b32 v86, v29, 16, v28
v_lshl_or_b32 v87, v31, 16, v30
s_waitcnt vmcnt(24)
v_lshl_or_b32 v88, v33, 16, v32
v_lshl_or_b32 v89, v35, 16, v34
v_lshl_or_b32 v90, v37, 16, v36
v_lshl_or_b32 v91, v39, 16, v38
s_waitcnt vmcnt(16)
v_lshl_or_b32 v92, v41, 16, v40
v_lshl_or_b32 v93, v43, 16, v42
v_lshl_or_b32 v94, v45, 16, v44
v_lshl_or_b32 v95, v47, 16, v46
s_waitcnt vmcnt(8)
v_lshl_or_b32 v96, v49, 16, v48
v_lshl_or_b32 v97, v51, 16, v50
v_lshl_or_b32 v98, v53, 16, v52
v_lshl_or_b32 v99, v55, 16, v54
s_waitcnt vmcnt(0)
v_lshl_or_b32 v100, v57, 16, v56
v_lshl_or_b32 v101, v59, 16, v58
v_lshl_or_b32 v102, v61, 16, v60
v_lshl_or_b32 v103, v63, 16, v62
s_add_u32 s40, s33, 36864
buffer_load_ushort v16, v4, s[16:19], s40 offen
s_add_u32 s40, s33, 38016
buffer_load_ushort v17, v4, s[16:19], s40 offen
s_add_u32 s40, s33, 39168
buffer_load_ushort v18, v4, s[16:19], s40 offen
s_add_u32 s40, s33, 40320
buffer_load_ushort v19, v4, s[16:19], s40 offen
s_add_u32 s40, s33, 41472
buffer_load_ushort v20, v4, s[16:19], s40 offen
s_add_u32 s40, s33, 42624
buffer_load_ushort v21, v4, s[16:19], s40 offen
s_add_u32 s40, s33, 43776
buffer_load_ushort v22, v4, s[16:19], s40 offen
s_add_u32 s40, s33, 44928
buffer_load_ushort v23, v4, s[16:19], s40 offen
s_add_u32 s40, s34, 36864
buffer_load_ushort v24, v4, s[16:19], s40 offen
s_add_u32 s40, s34, 38016
buffer_load_ushort v25, v4, s[16:19], s40 offen
s_add_u32 s40, s34, 39168
buffer_load_ushort v26, v4, s[16:19], s40 offen
s_add_u32 s40, s34, 40320
buffer_load_ushort v27, v4, s[16:19], s40 offen
s_add_u32 s40, s34, 41472
buffer_load_ushort v28, v4, s[16:19], s40 offen
s_add_u32 s40, s34, 42624
buffer_load_ushort v29, v4, s[16:19], s40 offen
s_add_u32 s40, s34, 43776
buffer_load_ushort v30, v4, s[16:19], s40 offen
s_add_u32 s40, s34, 44928
buffer_load_ushort v31, v4, s[16:19], s40 offen
s_add_u32 s40, s35, 36864
buffer_load_ushort v32, v4, s[16:19], s40 offen
s_add_u32 s40, s35, 38016
buffer_load_ushort v33, v4, s[16:19], s40 offen
s_add_u32 s40, s35, 39168
buffer_load_ushort v34, v4, s[16:19], s40 offen
s_add_u32 s40, s35, 40320
buffer_load_ushort v35, v4, s[16:19], s40 offen
s_add_u32 s40, s35, 41472
buffer_load_ushort v36, v4, s[16:19], s40 offen
s_add_u32 s40, s35, 42624
buffer_load_ushort v37, v4, s[16:19], s40 offen
s_add_u32 s40, s35, 43776
buffer_load_ushort v38, v4, s[16:19], s40 offen
s_add_u32 s40, s35, 44928
buffer_load_ushort v39, v4, s[16:19], s40 offen
s_add_u32 s40, s26, 147456
buffer_load_ushort v40, v4, s[16:19], s40 offen
s_add_u32 s40, s26, 148608
buffer_load_ushort v41, v4, s[16:19], s40 offen
s_add_u32 s40, s26, 149760
buffer_load_ushort v42, v4, s[16:19], s40 offen
s_add_u32 s40, s26, 150912
buffer_load_ushort v43, v4, s[16:19], s40 offen
s_add_u32 s40, s26, 152064
buffer_load_ushort v44, v4, s[16:19], s40 offen
s_add_u32 s40, s26, 153216
buffer_load_ushort v45, v4, s[16:19], s40 offen
s_add_u32 s40, s26, 154368
buffer_load_ushort v46, v4, s[16:19], s40 offen
s_add_u32 s40, s26, 155520
buffer_load_ushort v47, v4, s[16:19], s40 offen
s_add_u32 s40, s26, 479232
buffer_load_ushort v48, v4, s[16:19], s40 offen
s_add_u32 s40, s26, 480384
buffer_load_ushort v49, v4, s[16:19], s40 offen
s_add_u32 s40, s26, 481536
buffer_load_ushort v50, v4, s[16:19], s40 offen
s_add_u32 s40, s26, 482688
buffer_load_ushort v51, v4, s[16:19], s40 offen
s_add_u32 s40, s26, 483840
buffer_load_ushort v52, v4, s[16:19], s40 offen
s_add_u32 s40, s26, 484992
buffer_load_ushort v53, v4, s[16:19], s40 offen
s_add_u32 s40, s26, 486144
buffer_load_ushort v54, v4, s[16:19], s40 offen
s_add_u32 s40, s26, 487296
buffer_load_ushort v55, v4, s[16:19], s40 offen
s_add_u32 s40, s32, 110592
buffer_load_ushort v56, v4, s[16:19], s40 offen
s_add_u32 s40, s32, 111744
buffer_load_ushort v57, v4, s[16:19], s40 offen
s_add_u32 s40, s32, 112896
buffer_load_ushort v58, v4, s[16:19], s40 offen
s_add_u32 s40, s32, 114048
buffer_load_ushort v59, v4, s[16:19], s40 offen
s_add_u32 s40, s32, 115200
buffer_load_ushort v60, v4, s[16:19], s40 offen
s_add_u32 s40, s32, 116352
buffer_load_ushort v61, v4, s[16:19], s40 offen
s_add_u32 s40, s32, 117504
buffer_load_ushort v62, v4, s[16:19], s40 offen
s_add_u32 s40, s32, 118656
buffer_load_ushort v63, v4, s[16:19], s40 offen
s_waitcnt vmcnt(40)
v_lshl_or_b32 v104, v17, 16, v16
v_lshl_or_b32 v105, v19, 16, v18
v_lshl_or_b32 v106, v21, 16, v20
v_lshl_or_b32 v107, v23, 16, v22
s_waitcnt vmcnt(32)
v_lshl_or_b32 v108, v25, 16, v24
v_lshl_or_b32 v109, v27, 16, v26
v_lshl_or_b32 v110, v29, 16, v28
v_lshl_or_b32 v111, v31, 16, v30
s_waitcnt vmcnt(24)
v_lshl_or_b32 v112, v33, 16, v32
v_lshl_or_b32 v113, v35, 16, v34
v_lshl_or_b32 v114, v37, 16, v36
v_lshl_or_b32 v115, v39, 16, v38
s_waitcnt vmcnt(16)
v_lshl_or_b32 v116, v41, 16, v40
v_lshl_or_b32 v117, v43, 16, v42
v_lshl_or_b32 v118, v45, 16, v44
v_lshl_or_b32 v119, v47, 16, v46
s_waitcnt vmcnt(8)
v_lshl_or_b32 v120, v49, 16, v48
v_lshl_or_b32 v121, v51, 16, v50
v_lshl_or_b32 v122, v53, 16, v52
v_lshl_or_b32 v123, v55, 16, v54
s_waitcnt vmcnt(0)
v_lshl_or_b32 v124, v57, 16, v56
v_lshl_or_b32 v125, v59, 16, v58
v_lshl_or_b32 v126, v61, 16, v60
v_lshl_or_b32 v127, v63, 16, v62
s_add_u32 s40, s33, 73728
buffer_load_ushort v16, v4, s[16:19], s40 offen
s_add_u32 s40, s33, 74880
buffer_load_ushort v17, v4, s[16:19], s40 offen
s_add_u32 s40, s33, 76032
buffer_load_ushort v18, v4, s[16:19], s40 offen
s_add_u32 s40, s33, 77184
buffer_load_ushort v19, v4, s[16:19], s40 offen
s_add_u32 s40, s33, 78336
buffer_load_ushort v20, v4, s[16:19], s40 offen
s_add_u32 s40, s33, 79488
buffer_load_ushort v21, v4, s[16:19], s40 offen
s_add_u32 s40, s33, 80640
buffer_load_ushort v22, v4, s[16:19], s40 offen
s_add_u32 s40, s33, 81792
buffer_load_ushort v23, v4, s[16:19], s40 offen
s_add_u32 s40, s34, 73728
buffer_load_ushort v24, v4, s[16:19], s40 offen
s_add_u32 s40, s34, 74880
buffer_load_ushort v25, v4, s[16:19], s40 offen
s_add_u32 s40, s34, 76032
buffer_load_ushort v26, v4, s[16:19], s40 offen
s_add_u32 s40, s34, 77184
buffer_load_ushort v27, v4, s[16:19], s40 offen
s_add_u32 s40, s34, 78336
buffer_load_ushort v28, v4, s[16:19], s40 offen
s_add_u32 s40, s34, 79488
buffer_load_ushort v29, v4, s[16:19], s40 offen
s_add_u32 s40, s34, 80640
buffer_load_ushort v30, v4, s[16:19], s40 offen
s_add_u32 s40, s34, 81792
buffer_load_ushort v31, v4, s[16:19], s40 offen
s_add_u32 s40, s35, 73728
buffer_load_ushort v32, v4, s[16:19], s40 offen
s_add_u32 s40, s35, 74880
buffer_load_ushort v33, v4, s[16:19], s40 offen
s_add_u32 s40, s35, 76032
buffer_load_ushort v34, v4, s[16:19], s40 offen
s_add_u32 s40, s35, 77184
buffer_load_ushort v35, v4, s[16:19], s40 offen
s_add_u32 s40, s35, 78336
buffer_load_ushort v36, v4, s[16:19], s40 offen
s_add_u32 s40, s35, 79488
buffer_load_ushort v37, v4, s[16:19], s40 offen
s_add_u32 s40, s35, 80640
buffer_load_ushort v38, v4, s[16:19], s40 offen
s_add_u32 s40, s35, 81792
buffer_load_ushort v39, v4, s[16:19], s40 offen
s_add_u32 s40, s33, 110592
buffer_load_ushort v40, v4, s[16:19], s40 offen
s_add_u32 s40, s33, 111744
buffer_load_ushort v41, v4, s[16:19], s40 offen
s_add_u32 s40, s33, 112896
buffer_load_ushort v42, v4, s[16:19], s40 offen
s_add_u32 s40, s33, 114048
buffer_load_ushort v43, v4, s[16:19], s40 offen
s_add_u32 s40, s33, 115200
buffer_load_ushort v44, v4, s[16:19], s40 offen
s_add_u32 s40, s33, 116352
buffer_load_ushort v45, v4, s[16:19], s40 offen
s_add_u32 s40, s33, 117504
buffer_load_ushort v46, v4, s[16:19], s40 offen
s_add_u32 s40, s33, 118656
buffer_load_ushort v47, v4, s[16:19], s40 offen
s_add_u32 s40, s34, 110592
buffer_load_ushort v48, v4, s[16:19], s40 offen
s_add_u32 s40, s34, 111744
buffer_load_ushort v49, v4, s[16:19], s40 offen
s_add_u32 s40, s34, 112896
buffer_load_ushort v50, v4, s[16:19], s40 offen
s_add_u32 s40, s34, 114048
buffer_load_ushort v51, v4, s[16:19], s40 offen
s_add_u32 s40, s34, 115200
buffer_load_ushort v52, v4, s[16:19], s40 offen
s_add_u32 s40, s34, 116352
buffer_load_ushort v53, v4, s[16:19], s40 offen
s_add_u32 s40, s34, 117504
buffer_load_ushort v54, v4, s[16:19], s40 offen
s_add_u32 s40, s34, 118656
buffer_load_ushort v55, v4, s[16:19], s40 offen
s_add_u32 s40, s35, 110592
buffer_load_ushort v56, v4, s[16:19], s40 offen
s_add_u32 s40, s35, 111744
buffer_load_ushort v57, v4, s[16:19], s40 offen
s_add_u32 s40, s35, 112896
buffer_load_ushort v58, v4, s[16:19], s40 offen
s_add_u32 s40, s35, 114048
buffer_load_ushort v59, v4, s[16:19], s40 offen
s_add_u32 s40, s35, 115200
buffer_load_ushort v60, v4, s[16:19], s40 offen
s_add_u32 s40, s35, 116352
buffer_load_ushort v61, v4, s[16:19], s40 offen
s_add_u32 s40, s35, 117504
buffer_load_ushort v62, v4, s[16:19], s40 offen
s_add_u32 s40, s35, 118656
buffer_load_ushort v63, v4, s[16:19], s40 offen
s_waitcnt vmcnt(40)
v_lshl_or_b32 v128, v17, 16, v16
v_lshl_or_b32 v129, v19, 16, v18
v_lshl_or_b32 v130, v21, 16, v20
v_lshl_or_b32 v131, v23, 16, v22
s_waitcnt vmcnt(32)
v_lshl_or_b32 v132, v25, 16, v24
v_lshl_or_b32 v133, v27, 16, v26
v_lshl_or_b32 v134, v29, 16, v28
v_lshl_or_b32 v135, v31, 16, v30
s_waitcnt vmcnt(24)
v_lshl_or_b32 v136, v33, 16, v32
v_lshl_or_b32 v137, v35, 16, v34
v_lshl_or_b32 v138, v37, 16, v36
v_lshl_or_b32 v139, v39, 16, v38
s_waitcnt vmcnt(16)
v_lshl_or_b32 v140, v41, 16, v40
v_lshl_or_b32 v141, v43, 16, v42
v_lshl_or_b32 v142, v45, 16, v44
v_lshl_or_b32 v143, v47, 16, v46
s_waitcnt vmcnt(8)
v_lshl_or_b32 v144, v49, 16, v48
v_lshl_or_b32 v145, v51, 16, v50
v_lshl_or_b32 v146, v53, 16, v52
v_lshl_or_b32 v147, v55, 16, v54
s_waitcnt vmcnt(0)
v_lshl_or_b32 v148, v57, 16, v56
v_lshl_or_b32 v149, v59, 16, v58
v_lshl_or_b32 v150, v61, 16, v60
v_lshl_or_b32 v151, v63, 16, v62
s_mul_i32 s29, s21, 497664
s_add_u32 s29, s29, 3698688
s_lshl_b32 s30, s22, 11
s_add_u32 s30, s30, s29
s_lshl_b32 s31, s22, 12
s_add_u32 s31, s31, s29
s_add_u32 s40, s30, 0
buffer_store_dwordx4 v[80:83], v2, s[8:11], s40 offen
s_add_u32 s40, s30, 1024
buffer_store_dwordx4 v[84:87], v2, s[8:11], s40 offen
s_add_u32 s40, s30, 18432
buffer_store_dwordx4 v[88:91], v2, s[8:11], s40 offen
s_add_u32 s40, s30, 19456
buffer_store_dwordx4 v[92:95], v2, s[8:11], s40 offen
s_add_u32 s40, s30, 36864
buffer_store_dwordx4 v[96:99], v2, s[8:11], s40 offen
s_add_u32 s40, s30, 37888
buffer_store_dwordx4 v[100:103], v2, s[8:11], s40 offen
s_add_u32 s40, s30, 55296
buffer_store_dwordx4 v[104:107], v2, s[8:11], s40 offen
s_add_u32 s40, s30, 56320
buffer_store_dwordx4 v[108:111], v2, s[8:11], s40 offen
s_add_u32 s40, s30, 73728
buffer_store_dwordx4 v[112:115], v2, s[8:11], s40 offen
s_add_u32 s40, s30, 74752
buffer_store_dwordx4 v[116:119], v2, s[8:11], s40 offen
s_add_u32 s40, s30, 92160
buffer_store_dwordx4 v[120:123], v2, s[8:11], s40 offen
s_add_u32 s40, s30, 93184
buffer_store_dwordx4 v[124:127], v2, s[8:11], s40 offen
s_add_u32 s40, s30, 110592
buffer_store_dwordx4 v[128:131], v2, s[8:11], s40 offen
s_add_u32 s40, s30, 111616
buffer_store_dwordx4 v[132:135], v2, s[8:11], s40 offen
s_add_u32 s40, s31, 129024
buffer_store_dwordx4 v[136:139], v2, s[8:11], s40 offen
s_add_u32 s40, s31, 130048
buffer_store_dwordx4 v[140:143], v2, s[8:11], s40 offen
s_add_u32 s40, s31, 131072
buffer_store_dwordx4 v[144:147], v2, s[8:11], s40 offen
s_add_u32 s40, s31, 132096
buffer_store_dwordx4 v[148:151], v2, s[8:11], s40 offen
s_branch L_prep_end
L_pack_q:
s_sub_u32 s20, s20, 864
s_lshr_b32 s21, s20, 3
s_and_b32 s22, s20, 7
s_load_dwordx2 s[12:13], s[0:1], 8
s_waitcnt lgkmcnt(0)
s_mov_b32 s16, s12
s_and_b32 s17, s13, 0xffff
s_mov_b32 s18, 1990656
s_mov_b32 s19, 0x20000
s_mov_b32 s23, 0
s_cmp_eq_u32 s22, 0
s_cselect_b32 s23, 0, s23
s_cmp_eq_u32 s22, 1
s_cselect_b32 s23, 18, s23
s_cmp_eq_u32 s22, 2
s_cselect_b32 s23, 576, s23
s_cmp_eq_u32 s22, 3
s_cselect_b32 s23, 594, s23
s_cmp_eq_u32 s22, 4
s_cselect_b32 s23, 16, s23
s_cmp_eq_u32 s22, 5
s_cselect_b32 s23, 1152, s23
s_cmp_eq_u32 s22, 6
s_cselect_b32 s23, 1170, s23
s_cmp_eq_u32 s22, 7
s_cselect_b32 s23, 1168, s23
s_mul_i32 s24, s21, 36
s_add_u32 s23, s23, s24
v_and_b32 v11, 1, v6
v_bfe_u32 v12, v6, 1, 1
v_mul_u32_u24 v12, 18, v12
v_add_u32 v11, v11, v12
v_mul_u32_u24 v12, 576, v8
v_add_u32 v11, v11, v12
s_mov_b32 s24, 16
s_cmp_eq_u32 s22, 4
s_cselect_b32 s24, 8, s24
s_cmp_eq_u32 s22, 7
s_cselect_b32 s24, 4, s24
s_cmp_lg_u32 s24, 16
s_cselect_b64 vcc, -1, 0
v_cndmask_b32 v11, v6, v11, vcc
v_add_u32 v11, s23, v11
v_lshlrev_b32 v11, 1, v11
v_mul_u32_u24 v12, 27648, v7
v_add_u32 v11, v11, v12
v_mov_b32 v12, 2146435072
v_cmp_gt_u32 vcc, s24, v6
s_nop 1
v_cndmask_b32 v4, v12, v11, vcc
s_mov_b32 s40, 0
buffer_load_ushort v16, v4, s[16:19], s40 offen
s_mov_b32 s40, 3456
buffer_load_ushort v17, v4, s[16:19], s40 offen
s_mov_b32 s40, 6912
buffer_load_ushort v18, v4, s[16:19], s40 offen
s_mov_b32 s40, 10368
buffer_load_ushort v19, v4, s[16:19], s40 offen
s_mov_b32 s40, 13824
buffer_load_ushort v20, v4, s[16:19], s40 offen
s_mov_b32 s40, 17280
buffer_load_ushort v21, v4, s[16:19], s40 offen
s_mov_b32 s40, 20736
buffer_load_ushort v22, v4, s[16:19], s40 offen
s_mov_b32 s40, 24192
buffer_load_ushort v23, v4, s[16:19], s40 offen
s_mov_b32 s40, 110592
buffer_load_ushort v24, v4, s[16:19], s40 offen
s_mov_b32 s40, 114048
buffer_load_ushort v25, v4, s[16:19], s40 offen
s_mov_b32 s40, 117504
buffer_load_ushort v26, v4, s[16:19], s40 offen
s_mov_b32 s40, 120960
buffer_load_ushort v27, v4, s[16:19], s40 offen
s_mov_b32 s40, 124416
buffer_load_ushort v28, v4, s[16:19], s40 offen
s_mov_b32 s40, 127872
buffer_load_ushort v29, v4, s[16:19], s40 offen
s_mov_b32 s40, 131328
buffer_load_ushort v30, v4, s[16:19], s40 offen
s_mov_b32 s40, 134784
buffer_load_ushort v31, v4, s[16:19], s40 offen
s_mov_b32 s40, 221184
buffer_load_ushort v32, v4, s[16:19], s40 offen
s_mov_b32 s40, 224640
buffer_load_ushort v33, v4, s[16:19], s40 offen
s_mov_b32 s40, 228096
buffer_load_ushort v34, v4, s[16:19], s40 offen
s_mov_b32 s40, 231552
buffer_load_ushort v35, v4, s[16:19], s40 offen
s_mov_b32 s40, 235008
buffer_load_ushort v36, v4, s[16:19], s40 offen
s_mov_b32 s40, 238464
buffer_load_ushort v37, v4, s[16:19], s40 offen
s_mov_b32 s40, 241920
buffer_load_ushort v38, v4, s[16:19], s40 offen
s_mov_b32 s40, 245376
buffer_load_ushort v39, v4, s[16:19], s40 offen
s_mov_b32 s40, 331776
buffer_load_ushort v40, v4, s[16:19], s40 offen
s_mov_b32 s40, 335232
buffer_load_ushort v41, v4, s[16:19], s40 offen
s_mov_b32 s40, 338688
buffer_load_ushort v42, v4, s[16:19], s40 offen
s_mov_b32 s40, 342144
buffer_load_ushort v43, v4, s[16:19], s40 offen
s_mov_b32 s40, 345600
buffer_load_ushort v44, v4, s[16:19], s40 offen
s_mov_b32 s40, 349056
buffer_load_ushort v45, v4, s[16:19], s40 offen
s_mov_b32 s40, 352512
buffer_load_ushort v46, v4, s[16:19], s40 offen
s_mov_b32 s40, 355968
buffer_load_ushort v47, v4, s[16:19], s40 offen
s_mov_b32 s40, 442368
buffer_load_ushort v48, v4, s[16:19], s40 offen
s_mov_b32 s40, 445824
buffer_load_ushort v49, v4, s[16:19], s40 offen
s_mov_b32 s40, 449280
buffer_load_ushort v50, v4, s[16:19], s40 offen
s_mov_b32 s40, 452736
buffer_load_ushort v51, v4, s[16:19], s40 offen
s_mov_b32 s40, 456192
buffer_load_ushort v52, v4, s[16:19], s40 offen
s_mov_b32 s40, 459648
buffer_load_ushort v53, v4, s[16:19], s40 offen
s_mov_b32 s40, 463104
buffer_load_ushort v54, v4, s[16:19], s40 offen
s_mov_b32 s40, 466560
buffer_load_ushort v55, v4, s[16:19], s40 offen
s_mov_b32 s40, 552960
buffer_load_ushort v56, v4, s[16:19], s40 offen
s_mov_b32 s40, 556416
buffer_load_ushort v57, v4, s[16:19], s40 offen
s_mov_b32 s40, 559872
buffer_load_ushort v58, v4, s[16:19], s40 offen
s_mov_b32 s40, 563328
buffer_load_ushort v59, v4, s[16:19], s40 offen
s_mov_b32 s40, 566784
buffer_load_ushort v60, v4, s[16:19], s40 offen
s_mov_b32 s40, 570240
buffer_load_ushort v61, v4, s[16:19], s40 offen
s_mov_b32 s40, 573696
buffer_load_ushort v62, v4, s[16:19], s40 offen
s_mov_b32 s40, 577152
buffer_load_ushort v63, v4, s[16:19], s40 offen
s_waitcnt vmcnt(40)
v_lshl_or_b32 v80, v17, 16, v16
v_lshl_or_b32 v81, v19, 16, v18
v_lshl_or_b32 v82, v21, 16, v20
v_lshl_or_b32 v83, v23, 16, v22
s_waitcnt vmcnt(32)
v_lshl_or_b32 v84, v25, 16, v24
v_lshl_or_b32 v85, v27, 16, v26
v_lshl_or_b32 v86, v29, 16, v28
v_lshl_or_b32 v87, v31, 16, v30
s_waitcnt vmcnt(24)
v_lshl_or_b32 v88, v33, 16, v32
v_lshl_or_b32 v89, v35, 16, v34
v_lshl_or_b32 v90, v37, 16, v36
v_lshl_or_b32 v91, v39, 16, v38
s_waitcnt vmcnt(16)
v_lshl_or_b32 v92, v41, 16, v40
v_lshl_or_b32 v93, v43, 16, v42
v_lshl_or_b32 v94, v45, 16, v44
v_lshl_or_b32 v95, v47, 16, v46
s_waitcnt vmcnt(8)
v_lshl_or_b32 v96, v49, 16, v48
v_lshl_or_b32 v97, v51, 16, v50
v_lshl_or_b32 v98, v53, 16, v52
v_lshl_or_b32 v99, v55, 16, v54
s_waitcnt vmcnt(0)
v_lshl_or_b32 v100, v57, 16, v56
v_lshl_or_b32 v101, v59, 16, v58
v_lshl_or_b32 v102, v61, 16, v60
v_lshl_or_b32 v103, v63, 16, v62
s_mov_b32 s40, 663552
buffer_load_ushort v16, v4, s[16:19], s40 offen
s_mov_b32 s40, 667008
buffer_load_ushort v17, v4, s[16:19], s40 offen
s_mov_b32 s40, 670464
buffer_load_ushort v18, v4, s[16:19], s40 offen
s_mov_b32 s40, 673920
buffer_load_ushort v19, v4, s[16:19], s40 offen
s_mov_b32 s40, 677376
buffer_load_ushort v20, v4, s[16:19], s40 offen
s_mov_b32 s40, 680832
buffer_load_ushort v21, v4, s[16:19], s40 offen
s_mov_b32 s40, 684288
buffer_load_ushort v22, v4, s[16:19], s40 offen
s_mov_b32 s40, 687744
buffer_load_ushort v23, v4, s[16:19], s40 offen
s_mov_b32 s40, 774144
buffer_load_ushort v24, v4, s[16:19], s40 offen
s_mov_b32 s40, 777600
buffer_load_ushort v25, v4, s[16:19], s40 offen
s_mov_b32 s40, 781056
buffer_load_ushort v26, v4, s[16:19], s40 offen
s_mov_b32 s40, 784512
buffer_load_ushort v27, v4, s[16:19], s40 offen
s_mov_b32 s40, 787968
buffer_load_ushort v28, v4, s[16:19], s40 offen
s_mov_b32 s40, 791424
buffer_load_ushort v29, v4, s[16:19], s40 offen
s_mov_b32 s40, 794880
buffer_load_ushort v30, v4, s[16:19], s40 offen
s_mov_b32 s40, 798336
buffer_load_ushort v31, v4, s[16:19], s40 offen
s_mov_b32 s40, 884736
buffer_load_ushort v32, v4, s[16:19], s40 offen
s_mov_b32 s40, 888192
buffer_load_ushort v33, v4, s[16:19], s40 offen
s_mov_b32 s40, 891648
buffer_load_ushort v34, v4, s[16:19], s40 offen
s_mov_b32 s40, 895104
buffer_load_ushort v35, v4, s[16:19], s40 offen
s_mov_b32 s40, 898560
buffer_load_ushort v36, v4, s[16:19], s40 offen
s_mov_b32 s40, 902016
buffer_load_ushort v37, v4, s[16:19], s40 offen
s_mov_b32 s40, 905472
buffer_load_ushort v38, v4, s[16:19], s40 offen
s_mov_b32 s40, 908928
buffer_load_ushort v39, v4, s[16:19], s40 offen
s_mov_b32 s40, 995328
buffer_load_ushort v40, v4, s[16:19], s40 offen
s_mov_b32 s40, 998784
buffer_load_ushort v41, v4, s[16:19], s40 offen
s_mov_b32 s40, 1002240
buffer_load_ushort v42, v4, s[16:19], s40 offen
s_mov_b32 s40, 1005696
buffer_load_ushort v43, v4, s[16:19], s40 offen
s_mov_b32 s40, 1009152
buffer_load_ushort v44, v4, s[16:19], s40 offen
s_mov_b32 s40, 1012608
buffer_load_ushort v45, v4, s[16:19], s40 offen
s_mov_b32 s40, 1016064
buffer_load_ushort v46, v4, s[16:19], s40 offen
s_mov_b32 s40, 1019520
buffer_load_ushort v47, v4, s[16:19], s40 offen
s_mov_b32 s40, 1105920
buffer_load_ushort v48, v4, s[16:19], s40 offen
s_mov_b32 s40, 1109376
buffer_load_ushort v49, v4, s[16:19], s40 offen
s_mov_b32 s40, 1112832
buffer_load_ushort v50, v4, s[16:19], s40 offen
s_mov_b32 s40, 1116288
buffer_load_ushort v51, v4, s[16:19], s40 offen
s_mov_b32 s40, 1119744
buffer_load_ushort v52, v4, s[16:19], s40 offen
s_mov_b32 s40, 1123200
buffer_load_ushort v53, v4, s[16:19], s40 offen
s_mov_b32 s40, 1126656
buffer_load_ushort v54, v4, s[16:19], s40 offen
s_mov_b32 s40, 1130112
buffer_load_ushort v55, v4, s[16:19], s40 offen
s_mov_b32 s40, 1216512
buffer_load_ushort v56, v4, s[16:19], s40 offen
s_mov_b32 s40, 1219968
buffer_load_ushort v57, v4, s[16:19], s40 offen
s_mov_b32 s40, 1223424
buffer_load_ushort v58, v4, s[16:19], s40 offen
s_mov_b32 s40, 1226880
buffer_load_ushort v59, v4, s[16:19], s40 offen
s_mov_b32 s40, 1230336
buffer_load_ushort v60, v4, s[16:19], s40 offen
s_mov_b32 s40, 1233792
buffer_load_ushort v61, v4, s[16:19], s40 offen
s_mov_b32 s40, 1237248
buffer_load_ushort v62, v4, s[16:19], s40 offen
s_mov_b32 s40, 1240704
buffer_load_ushort v63, v4, s[16:19], s40 offen
s_waitcnt vmcnt(40)
v_lshl_or_b32 v104, v17, 16, v16
v_lshl_or_b32 v105, v19, 16, v18
v_lshl_or_b32 v106, v21, 16, v20
v_lshl_or_b32 v107, v23, 16, v22
s_waitcnt vmcnt(32)
v_lshl_or_b32 v108, v25, 16, v24
v_lshl_or_b32 v109, v27, 16, v26
v_lshl_or_b32 v110, v29, 16, v28
v_lshl_or_b32 v111, v31, 16, v30
s_waitcnt vmcnt(24)
v_lshl_or_b32 v112, v33, 16, v32
v_lshl_or_b32 v113, v35, 16, v34
v_lshl_or_b32 v114, v37, 16, v36
v_lshl_or_b32 v115, v39, 16, v38
s_waitcnt vmcnt(16)
v_lshl_or_b32 v116, v41, 16, v40
v_lshl_or_b32 v117, v43, 16, v42
v_lshl_or_b32 v118, v45, 16, v44
v_lshl_or_b32 v119, v47, 16, v46
s_waitcnt vmcnt(8)
v_lshl_or_b32 v120, v49, 16, v48
v_lshl_or_b32 v121, v51, 16, v50
v_lshl_or_b32 v122, v53, 16, v52
v_lshl_or_b32 v123, v55, 16, v54
s_waitcnt vmcnt(0)
v_lshl_or_b32 v124, v57, 16, v56
v_lshl_or_b32 v125, v59, 16, v58
v_lshl_or_b32 v126, v61, 16, v60
v_lshl_or_b32 v127, v63, 16, v62
s_mov_b32 s40, 1327104
buffer_load_ushort v16, v4, s[16:19], s40 offen
s_mov_b32 s40, 1330560
buffer_load_ushort v17, v4, s[16:19], s40 offen
s_mov_b32 s40, 1334016
buffer_load_ushort v18, v4, s[16:19], s40 offen
s_mov_b32 s40, 1337472
buffer_load_ushort v19, v4, s[16:19], s40 offen
s_mov_b32 s40, 1340928
buffer_load_ushort v20, v4, s[16:19], s40 offen
s_mov_b32 s40, 1344384
buffer_load_ushort v21, v4, s[16:19], s40 offen
s_mov_b32 s40, 1347840
buffer_load_ushort v22, v4, s[16:19], s40 offen
s_mov_b32 s40, 1351296
buffer_load_ushort v23, v4, s[16:19], s40 offen
s_mov_b32 s40, 1437696
buffer_load_ushort v24, v4, s[16:19], s40 offen
s_mov_b32 s40, 1441152
buffer_load_ushort v25, v4, s[16:19], s40 offen
s_mov_b32 s40, 1444608
buffer_load_ushort v26, v4, s[16:19], s40 offen
s_mov_b32 s40, 1448064
buffer_load_ushort v27, v4, s[16:19], s40 offen
s_mov_b32 s40, 1451520
buffer_load_ushort v28, v4, s[16:19], s40 offen
s_mov_b32 s40, 1454976
buffer_load_ushort v29, v4, s[16:19], s40 offen
s_mov_b32 s40, 1458432
buffer_load_ushort v30, v4, s[16:19], s40 offen
s_mov_b32 s40, 1461888
buffer_load_ushort v31, v4, s[16:19], s40 offen
s_mov_b32 s40, 1548288
buffer_load_ushort v32, v4, s[16:19], s40 offen
s_mov_b32 s40, 1551744
buffer_load_ushort v33, v4, s[16:19], s40 offen
s_mov_b32 s40, 1555200
buffer_load_ushort v34, v4, s[16:19], s40 offen
s_mov_b32 s40, 1558656
buffer_load_ushort v35, v4, s[16:19], s40 offen
s_mov_b32 s40, 1562112
buffer_load_ushort v36, v4, s[16:19], s40 offen
s_mov_b32 s40, 1565568
buffer_load_ushort v37, v4, s[16:19], s40 offen
s_mov_b32 s40, 1569024
buffer_load_ushort v38, v4, s[16:19], s40 offen
s_mov_b32 s40, 1572480
buffer_load_ushort v39, v4, s[16:19], s40 offen
s_mov_b32 s40, 1658880
buffer_load_ushort v40, v4, s[16:19], s40 offen
s_mov_b32 s40, 1662336
buffer_load_ushort v41, v4, s[16:19], s40 offen
s_mov_b32 s40, 1665792
buffer_load_ushort v42, v4, s[16:19], s40 offen
s_mov_b32 s40, 1669248
buffer_load_ushort v43, v4, s[16:19], s40 offen
s_mov_b32 s40, 1672704
buffer_load_ushort v44, v4, s[16:19], s40 offen
s_mov_b32 s40, 1676160
buffer_load_ushort v45, v4, s[16:19], s40 offen
s_mov_b32 s40, 1679616
buffer_load_ushort v46, v4, s[16:19], s40 offen
s_mov_b32 s40, 1683072
buffer_load_ushort v47, v4, s[16:19], s40 offen
s_mov_b32 s40, 1769472
buffer_load_ushort v48, v4, s[16:19], s40 offen
s_mov_b32 s40, 1772928
buffer_load_ushort v49, v4, s[16:19], s40 offen
s_mov_b32 s40, 1776384
buffer_load_ushort v50, v4, s[16:19], s40 offen
s_mov_b32 s40, 1779840
buffer_load_ushort v51, v4, s[16:19], s40 offen
s_mov_b32 s40, 1783296
buffer_load_ushort v52, v4, s[16:19], s40 offen
s_mov_b32 s40, 1786752
buffer_load_ushort v53, v4, s[16:19], s40 offen
s_mov_b32 s40, 1790208
buffer_load_ushort v54, v4, s[16:19], s40 offen
s_mov_b32 s40, 1793664
buffer_load_ushort v55, v4, s[16:19], s40 offen
s_mov_b32 s40, 1880064
buffer_load_ushort v56, v4, s[16:19], s40 offen
s_mov_b32 s40, 1883520
buffer_load_ushort v57, v4, s[16:19], s40 offen
s_mov_b32 s40, 1886976
buffer_load_ushort v58, v4, s[16:19], s40 offen
s_mov_b32 s40, 1890432
buffer_load_ushort v59, v4, s[16:19], s40 offen
s_mov_b32 s40, 1893888
buffer_load_ushort v60, v4, s[16:19], s40 offen
s_mov_b32 s40, 1897344
buffer_load_ushort v61, v4, s[16:19], s40 offen
s_mov_b32 s40, 1900800
buffer_load_ushort v62, v4, s[16:19], s40 offen
s_mov_b32 s40, 1904256
buffer_load_ushort v63, v4, s[16:19], s40 offen
s_waitcnt vmcnt(40)
v_lshl_or_b32 v128, v17, 16, v16
v_lshl_or_b32 v129, v19, 16, v18
v_lshl_or_b32 v130, v21, 16, v20
v_lshl_or_b32 v131, v23, 16, v22
s_waitcnt vmcnt(32)
v_lshl_or_b32 v132, v25, 16, v24
v_lshl_or_b32 v133, v27, 16, v26
v_lshl_or_b32 v134, v29, 16, v28
v_lshl_or_b32 v135, v31, 16, v30
s_waitcnt vmcnt(24)
v_lshl_or_b32 v136, v33, 16, v32
v_lshl_or_b32 v137, v35, 16, v34
v_lshl_or_b32 v138, v37, 16, v36
v_lshl_or_b32 v139, v39, 16, v38
s_waitcnt vmcnt(16)
v_lshl_or_b32 v140, v41, 16, v40
v_lshl_or_b32 v141, v43, 16, v42
v_lshl_or_b32 v142, v45, 16, v44
v_lshl_or_b32 v143, v47, 16, v46
s_waitcnt vmcnt(8)
v_lshl_or_b32 v144, v49, 16, v48
v_lshl_or_b32 v145, v51, 16, v50
v_lshl_or_b32 v146, v53, 16, v52
v_lshl_or_b32 v147, v55, 16, v54
s_waitcnt vmcnt(0)
v_lshl_or_b32 v148, v57, 16, v56
v_lshl_or_b32 v149, v59, 16, v58
v_lshl_or_b32 v150, v61, 16, v60
v_lshl_or_b32 v151, v63, 16, v62
s_mul_i32 s29, s21, 147456
s_lshl_b32 s30, s22, 10
s_add_u32 s29, s29, s30
s_add_u32 s29, s29, 262144
s_add_u32 s40, s29, 0
buffer_store_dwordx4 v[80:83], v2, s[8:11], s40 offen
s_add_u32 s40, s29, 8192
buffer_store_dwordx4 v[84:87], v2, s[8:11], s40 offen
s_add_u32 s40, s29, 16384
buffer_store_dwordx4 v[88:91], v2, s[8:11], s40 offen
s_add_u32 s40, s29, 24576
buffer_store_dwordx4 v[92:95], v2, s[8:11], s40 offen
s_add_u32 s40, s29, 32768
buffer_store_dwordx4 v[96:99], v2, s[8:11], s40 offen
s_add_u32 s40, s29, 40960
buffer_store_dwordx4 v[100:103], v2, s[8:11], s40 offen
s_add_u32 s40, s29, 49152
buffer_store_dwordx4 v[104:107], v2, s[8:11], s40 offen
s_add_u32 s40, s29, 57344
buffer_store_dwordx4 v[108:111], v2, s[8:11], s40 offen
s_add_u32 s40, s29, 65536
buffer_store_dwordx4 v[112:115], v2, s[8:11], s40 offen
s_add_u32 s40, s29, 73728
buffer_store_dwordx4 v[116:119], v2, s[8:11], s40 offen
s_add_u32 s40, s29, 81920
buffer_store_dwordx4 v[120:123], v2, s[8:11], s40 offen
s_add_u32 s40, s29, 90112
buffer_store_dwordx4 v[124:127], v2, s[8:11], s40 offen
s_add_u32 s40, s29, 98304
buffer_store_dwordx4 v[128:131], v2, s[8:11], s40 offen
s_add_u32 s40, s29, 106496
buffer_store_dwordx4 v[132:135], v2, s[8:11], s40 offen
s_add_u32 s40, s29, 114688
buffer_store_dwordx4 v[136:139], v2, s[8:11], s40 offen
s_add_u32 s40, s29, 122880
buffer_store_dwordx4 v[140:143], v2, s[8:11], s40 offen
s_add_u32 s40, s29, 131072
buffer_store_dwordx4 v[144:147], v2, s[8:11], s40 offen
s_add_u32 s40, s29, 139264
buffer_store_dwordx4 v[148:151], v2, s[8:11], s40 offen
s_branch L_prep_end
L_pack_o:
s_sub_u32 s20, s20, 992
s_mul_i32 s21, s20, 13108
s_lshr_b32 s21, s21, 16
s_mul_i32 s22, s21, 5
s_sub_u32 s22, s20, s22
s_load_dwordx2 s[12:13], s[0:1], 16
s_waitcnt lgkmcnt(0)
s_mov_b32 s16, s12
s_and_b32 s17, s13, 0xffff
s_mov_b32 s18, 663552
s_mov_b32 s19, 0x20000
s_lshr_b32 s25, s22, 1
s_lshl_b32 s25, s25, 5
s_and_b32 s26, s22, 1
s_lshl_b32 s26, s26, 2
s_add_u32 s25, s25, s26
s_mul_i32 s26, s21, 72
s_add_u32 s25, s25, s26
s_cmp_eq_u32 s22, 4
s_cselect_b64 vcc, -1, 0
s_cselect_b32 s24, 8, 16
v_cndmask_b32 v11, v10, v6, vcc
v_add_u32 v11, s25, v11
v_lshlrev_b32 v11, 1, v11
v_mov_b32 v12, 2146435072
v_cmp_gt_u32 vcc, s24, v6
s_nop 1
v_cndmask_b32 v11, v12, v11, vcc
v_mul_u32_u24 v12, 4608, v7
v_add_u32 v4, v11, v12
v_mul_u32_u24 v12, 82944, v7
v_add_u32 v5, v11, v12
s_mov_b32 s40, 0
buffer_load_ushort v16, v4, s[16:19], s40 offen
s_mov_b32 s40, 1152
buffer_load_ushort v17, v4, s[16:19], s40 offen
s_mov_b32 s40, 2304
buffer_load_ushort v18, v4, s[16:19], s40 offen
s_mov_b32 s40, 3456
buffer_load_ushort v19, v4, s[16:19], s40 offen
s_mov_b32 s40, 20736
buffer_load_ushort v20, v4, s[16:19], s40 offen
s_mov_b32 s40, 21888
buffer_load_ushort v21, v4, s[16:19], s40 offen
s_mov_b32 s40, 23040
buffer_load_ushort v22, v4, s[16:19], s40 offen
s_mov_b32 s40, 24192
buffer_load_ushort v23, v4, s[16:19], s40 offen
s_mov_b32 s40, 41472
buffer_load_ushort v24, v4, s[16:19], s40 offen
s_mov_b32 s40, 42624
buffer_load_ushort v25, v4, s[16:19], s40 offen
s_mov_b32 s40, 43776
buffer_load_ushort v26, v4, s[16:19], s40 offen
s_mov_b32 s40, 44928
buffer_load_ushort v27, v4, s[16:19], s40 offen
s_mov_b32 s40, 62208
buffer_load_ushort v28, v4, s[16:19], s40 offen
s_mov_b32 s40, 63360
buffer_load_ushort v29, v4, s[16:19], s40 offen
s_mov_b32 s40, 64512
buffer_load_ushort v30, v4, s[16:19], s40 offen
s_mov_b32 s40, 65664
buffer_load_ushort v31, v4, s[16:19], s40 offen
s_mov_b32 s40, 82944
buffer_load_ushort v32, v4, s[16:19], s40 offen
s_mov_b32 s40, 84096
buffer_load_ushort v33, v4, s[16:19], s40 offen
s_mov_b32 s40, 85248
buffer_load_ushort v34, v4, s[16:19], s40 offen
s_mov_b32 s40, 86400
buffer_load_ushort v35, v4, s[16:19], s40 offen
s_mov_b32 s40, 103680
buffer_load_ushort v36, v4, s[16:19], s40 offen
s_mov_b32 s40, 104832
buffer_load_ushort v37, v4, s[16:19], s40 offen
s_mov_b32 s40, 105984
buffer_load_ushort v38, v4, s[16:19], s40 offen
s_mov_b32 s40, 107136
buffer_load_ushort v39, v4, s[16:19], s40 offen
s_mov_b32 s40, 124416
buffer_load_ushort v40, v4, s[16:19], s40 offen
s_mov_b32 s40, 125568
buffer_load_ushort v41, v4, s[16:19], s40 offen
s_mov_b32 s40, 126720
buffer_load_ushort v42, v4, s[16:19], s40 offen
s_mov_b32 s40, 127872
buffer_load_ushort v43, v4, s[16:19], s40 offen
s_mov_b32 s40, 145152
buffer_load_ushort v44, v4, s[16:19], s40 offen
s_mov_b32 s40, 146304
buffer_load_ushort v45, v4, s[16:19], s40 offen
s_mov_b32 s40, 147456
buffer_load_ushort v46, v4, s[16:19], s40 offen
s_mov_b32 s40, 148608
buffer_load_ushort v47, v4, s[16:19], s40 offen
s_mov_b32 s40, 165888
buffer_load_ushort v48, v4, s[16:19], s40 offen
s_mov_b32 s40, 167040
buffer_load_ushort v49, v4, s[16:19], s40 offen
s_mov_b32 s40, 168192
buffer_load_ushort v50, v4, s[16:19], s40 offen
s_mov_b32 s40, 169344
buffer_load_ushort v51, v4, s[16:19], s40 offen
s_mov_b32 s40, 186624
buffer_load_ushort v52, v4, s[16:19], s40 offen
s_mov_b32 s40, 187776
buffer_load_ushort v53, v4, s[16:19], s40 offen
s_mov_b32 s40, 188928
buffer_load_ushort v54, v4, s[16:19], s40 offen
s_mov_b32 s40, 190080
buffer_load_ushort v55, v4, s[16:19], s40 offen
s_mov_b32 s40, 207360
buffer_load_ushort v56, v4, s[16:19], s40 offen
s_mov_b32 s40, 208512
buffer_load_ushort v57, v4, s[16:19], s40 offen
s_mov_b32 s40, 209664
buffer_load_ushort v58, v4, s[16:19], s40 offen
s_mov_b32 s40, 210816
buffer_load_ushort v59, v4, s[16:19], s40 offen
s_mov_b32 s40, 228096
buffer_load_ushort v60, v4, s[16:19], s40 offen
s_mov_b32 s40, 229248
buffer_load_ushort v61, v4, s[16:19], s40 offen
s_mov_b32 s40, 230400
buffer_load_ushort v62, v4, s[16:19], s40 offen
s_mov_b32 s40, 231552
buffer_load_ushort v63, v4, s[16:19], s40 offen
s_waitcnt vmcnt(40)
v_lshl_or_b32 v80, v17, 16, v16
v_lshl_or_b32 v81, v19, 16, v18
v_lshl_or_b32 v82, v21, 16, v20
v_lshl_or_b32 v83, v23, 16, v22
s_waitcnt vmcnt(32)
v_lshl_or_b32 v84, v25, 16, v24
v_lshl_or_b32 v85, v27, 16, v26
v_lshl_or_b32 v86, v29, 16, v28
v_lshl_or_b32 v87, v31, 16, v30
s_waitcnt vmcnt(24)
v_lshl_or_b32 v88, v33, 16, v32
v_lshl_or_b32 v89, v35, 16, v34
v_lshl_or_b32 v90, v37, 16, v36
v_lshl_or_b32 v91, v39, 16, v38
s_waitcnt vmcnt(16)
v_lshl_or_b32 v92, v41, 16, v40
v_lshl_or_b32 v93, v43, 16, v42
v_lshl_or_b32 v94, v45, 16, v44
v_lshl_or_b32 v95, v47, 16, v46
s_waitcnt vmcnt(8)
v_lshl_or_b32 v96, v49, 16, v48
v_lshl_or_b32 v97, v51, 16, v50
v_lshl_or_b32 v98, v53, 16, v52
v_lshl_or_b32 v99, v55, 16, v54
s_waitcnt vmcnt(0)
v_lshl_or_b32 v100, v57, 16, v56
v_lshl_or_b32 v101, v59, 16, v58
v_lshl_or_b32 v102, v61, 16, v60
v_lshl_or_b32 v103, v63, 16, v62
s_mov_b32 s40, 248832
buffer_load_ushort v16, v4, s[16:19], s40 offen
s_mov_b32 s40, 249984
buffer_load_ushort v17, v4, s[16:19], s40 offen
s_mov_b32 s40, 251136
buffer_load_ushort v18, v4, s[16:19], s40 offen
s_mov_b32 s40, 252288
buffer_load_ushort v19, v4, s[16:19], s40 offen
s_mov_b32 s40, 269568
buffer_load_ushort v20, v4, s[16:19], s40 offen
s_mov_b32 s40, 270720
buffer_load_ushort v21, v4, s[16:19], s40 offen
s_mov_b32 s40, 271872
buffer_load_ushort v22, v4, s[16:19], s40 offen
s_mov_b32 s40, 273024
buffer_load_ushort v23, v4, s[16:19], s40 offen
s_mov_b32 s40, 290304
buffer_load_ushort v24, v4, s[16:19], s40 offen
s_mov_b32 s40, 291456
buffer_load_ushort v25, v4, s[16:19], s40 offen
s_mov_b32 s40, 292608
buffer_load_ushort v26, v4, s[16:19], s40 offen
s_mov_b32 s40, 293760
buffer_load_ushort v27, v4, s[16:19], s40 offen
s_mov_b32 s40, 311040
buffer_load_ushort v28, v4, s[16:19], s40 offen
s_mov_b32 s40, 312192
buffer_load_ushort v29, v4, s[16:19], s40 offen
s_mov_b32 s40, 313344
buffer_load_ushort v30, v4, s[16:19], s40 offen
s_mov_b32 s40, 314496
buffer_load_ushort v31, v4, s[16:19], s40 offen
s_mov_b32 s40, 331776
buffer_load_ushort v32, v4, s[16:19], s40 offen
s_mov_b32 s40, 332928
buffer_load_ushort v33, v4, s[16:19], s40 offen
s_mov_b32 s40, 334080
buffer_load_ushort v34, v4, s[16:19], s40 offen
s_mov_b32 s40, 335232
buffer_load_ushort v35, v4, s[16:19], s40 offen
s_mov_b32 s40, 352512
buffer_load_ushort v36, v4, s[16:19], s40 offen
s_mov_b32 s40, 353664
buffer_load_ushort v37, v4, s[16:19], s40 offen
s_mov_b32 s40, 354816
buffer_load_ushort v38, v4, s[16:19], s40 offen
s_mov_b32 s40, 355968
buffer_load_ushort v39, v4, s[16:19], s40 offen
s_mov_b32 s40, 373248
buffer_load_ushort v40, v4, s[16:19], s40 offen
s_mov_b32 s40, 374400
buffer_load_ushort v41, v4, s[16:19], s40 offen
s_mov_b32 s40, 375552
buffer_load_ushort v42, v4, s[16:19], s40 offen
s_mov_b32 s40, 376704
buffer_load_ushort v43, v4, s[16:19], s40 offen
s_mov_b32 s40, 393984
buffer_load_ushort v44, v4, s[16:19], s40 offen
s_mov_b32 s40, 395136
buffer_load_ushort v45, v4, s[16:19], s40 offen
s_mov_b32 s40, 396288
buffer_load_ushort v46, v4, s[16:19], s40 offen
s_mov_b32 s40, 397440
buffer_load_ushort v47, v4, s[16:19], s40 offen
s_mov_b32 s40, 414720
buffer_load_ushort v48, v4, s[16:19], s40 offen
s_mov_b32 s40, 415872
buffer_load_ushort v49, v4, s[16:19], s40 offen
s_mov_b32 s40, 417024
buffer_load_ushort v50, v4, s[16:19], s40 offen
s_mov_b32 s40, 418176
buffer_load_ushort v51, v4, s[16:19], s40 offen
s_mov_b32 s40, 435456
buffer_load_ushort v52, v4, s[16:19], s40 offen
s_mov_b32 s40, 436608
buffer_load_ushort v53, v4, s[16:19], s40 offen
s_mov_b32 s40, 437760
buffer_load_ushort v54, v4, s[16:19], s40 offen
s_mov_b32 s40, 438912
buffer_load_ushort v55, v4, s[16:19], s40 offen
s_mov_b32 s40, 456192
buffer_load_ushort v56, v4, s[16:19], s40 offen
s_mov_b32 s40, 457344
buffer_load_ushort v57, v4, s[16:19], s40 offen
s_mov_b32 s40, 458496
buffer_load_ushort v58, v4, s[16:19], s40 offen
s_mov_b32 s40, 459648
buffer_load_ushort v59, v4, s[16:19], s40 offen
s_mov_b32 s40, 476928
buffer_load_ushort v60, v4, s[16:19], s40 offen
s_mov_b32 s40, 478080
buffer_load_ushort v61, v4, s[16:19], s40 offen
s_mov_b32 s40, 479232
buffer_load_ushort v62, v4, s[16:19], s40 offen
s_mov_b32 s40, 480384
buffer_load_ushort v63, v4, s[16:19], s40 offen
s_waitcnt vmcnt(40)
v_lshl_or_b32 v104, v17, 16, v16
v_lshl_or_b32 v105, v19, 16, v18
v_lshl_or_b32 v106, v21, 16, v20
v_lshl_or_b32 v107, v23, 16, v22
s_waitcnt vmcnt(32)
v_lshl_or_b32 v108, v25, 16, v24
v_lshl_or_b32 v109, v27, 16, v26
v_lshl_or_b32 v110, v29, 16, v28
v_lshl_or_b32 v111, v31, 16, v30
s_waitcnt vmcnt(24)
v_lshl_or_b32 v112, v33, 16, v32
v_lshl_or_b32 v113, v35, 16, v34
v_lshl_or_b32 v114, v37, 16, v36
v_lshl_or_b32 v115, v39, 16, v38
s_waitcnt vmcnt(16)
v_lshl_or_b32 v116, v41, 16, v40
v_lshl_or_b32 v117, v43, 16, v42
v_lshl_or_b32 v118, v45, 16, v44
v_lshl_or_b32 v119, v47, 16, v46
s_waitcnt vmcnt(8)
v_lshl_or_b32 v120, v49, 16, v48
v_lshl_or_b32 v121, v51, 16, v50
v_lshl_or_b32 v122, v53, 16, v52
v_lshl_or_b32 v123, v55, 16, v54
s_waitcnt vmcnt(0)
v_lshl_or_b32 v124, v57, 16, v56
v_lshl_or_b32 v125, v59, 16, v58
v_lshl_or_b32 v126, v61, 16, v60
v_lshl_or_b32 v127, v63, 16, v62
s_mov_b32 s40, 497664
buffer_load_ushort v16, v4, s[16:19], s40 offen
s_mov_b32 s40, 498816
buffer_load_ushort v17, v4, s[16:19], s40 offen
s_mov_b32 s40, 499968
buffer_load_ushort v18, v4, s[16:19], s40 offen
s_mov_b32 s40, 501120
buffer_load_ushort v19, v4, s[16:19], s40 offen
s_mov_b32 s40, 518400
buffer_load_ushort v20, v4, s[16:19], s40 offen
s_mov_b32 s40, 519552
buffer_load_ushort v21, v4, s[16:19], s40 offen
s_mov_b32 s40, 520704
buffer_load_ushort v22, v4, s[16:19], s40 offen
s_mov_b32 s40, 521856
buffer_load_ushort v23, v4, s[16:19], s40 offen
s_mov_b32 s40, 539136
buffer_load_ushort v24, v4, s[16:19], s40 offen
s_mov_b32 s40, 540288
buffer_load_ushort v25, v4, s[16:19], s40 offen
s_mov_b32 s40, 541440
buffer_load_ushort v26, v4, s[16:19], s40 offen
s_mov_b32 s40, 542592
buffer_load_ushort v27, v4, s[16:19], s40 offen
s_mov_b32 s40, 559872
buffer_load_ushort v28, v4, s[16:19], s40 offen
s_mov_b32 s40, 561024
buffer_load_ushort v29, v4, s[16:19], s40 offen
s_mov_b32 s40, 562176
buffer_load_ushort v30, v4, s[16:19], s40 offen
s_mov_b32 s40, 563328
buffer_load_ushort v31, v4, s[16:19], s40 offen
s_mov_b32 s40, 580608
buffer_load_ushort v32, v4, s[16:19], s40 offen
s_mov_b32 s40, 581760
buffer_load_ushort v33, v4, s[16:19], s40 offen
s_mov_b32 s40, 582912
buffer_load_ushort v34, v4, s[16:19], s40 offen
s_mov_b32 s40, 584064
buffer_load_ushort v35, v4, s[16:19], s40 offen
s_mov_b32 s40, 601344
buffer_load_ushort v36, v4, s[16:19], s40 offen
s_mov_b32 s40, 602496
buffer_load_ushort v37, v4, s[16:19], s40 offen
s_mov_b32 s40, 603648
buffer_load_ushort v38, v4, s[16:19], s40 offen
s_mov_b32 s40, 604800
buffer_load_ushort v39, v4, s[16:19], s40 offen
s_mov_b32 s40, 622080
buffer_load_ushort v40, v4, s[16:19], s40 offen
s_mov_b32 s40, 623232
buffer_load_ushort v41, v4, s[16:19], s40 offen
s_mov_b32 s40, 624384
buffer_load_ushort v42, v4, s[16:19], s40 offen
s_mov_b32 s40, 625536
buffer_load_ushort v43, v4, s[16:19], s40 offen
s_mov_b32 s40, 642816
buffer_load_ushort v44, v4, s[16:19], s40 offen
s_mov_b32 s40, 643968
buffer_load_ushort v45, v4, s[16:19], s40 offen
s_mov_b32 s40, 645120
buffer_load_ushort v46, v4, s[16:19], s40 offen
s_mov_b32 s40, 646272
buffer_load_ushort v47, v4, s[16:19], s40 offen
s_mov_b32 s40, 18432
buffer_load_ushort v48, v5, s[16:19], s40 offen
s_mov_b32 s40, 19584
buffer_load_ushort v49, v5, s[16:19], s40 offen
s_mov_b32 s40, 39168
buffer_load_ushort v50, v5, s[16:19], s40 offen
s_mov_b32 s40, 40320
buffer_load_ushort v51, v5, s[16:19], s40 offen
s_mov_b32 s40, 59904
buffer_load_ushort v52, v5, s[16:19], s40 offen
s_mov_b32 s40, 61056
buffer_load_ushort v53, v5, s[16:19], s40 offen
s_mov_b32 s40, 80640
buffer_load_ushort v54, v5, s[16:19], s40 offen
s_mov_b32 s40, 81792
buffer_load_ushort v55, v5, s[16:19], s40 offen
s_mov_b32 s40, 350208
buffer_load_ushort v56, v5, s[16:19], s40 offen
s_mov_b32 s40, 351360
buffer_load_ushort v57, v5, s[16:19], s40 offen
s_mov_b32 s40, 370944
buffer_load_ushort v58, v5, s[16:19], s40 offen
s_mov_b32 s40, 372096
buffer_load_ushort v59, v5, s[16:19], s40 offen
s_mov_b32 s40, 391680
buffer_load_ushort v60, v5, s[16:19], s40 offen
s_mov_b32 s40, 392832
buffer_load_ushort v61, v5, s[16:19], s40 offen
s_mov_b32 s40, 412416
buffer_load_ushort v62, v5, s[16:19], s40 offen
s_mov_b32 s40, 413568
buffer_load_ushort v63, v5, s[16:19], s40 offen
s_waitcnt vmcnt(40)
v_lshl_or_b32 v128, v17, 16, v16
v_lshl_or_b32 v129, v19, 16, v18
v_lshl_or_b32 v130, v21, 16, v20
v_lshl_or_b32 v131, v23, 16, v22
s_waitcnt vmcnt(32)
v_lshl_or_b32 v132, v25, 16, v24
v_lshl_or_b32 v133, v27, 16, v26
v_lshl_or_b32 v134, v29, 16, v28
v_lshl_or_b32 v135, v31, 16, v30
s_waitcnt vmcnt(24)
v_lshl_or_b32 v136, v33, 16, v32
v_lshl_or_b32 v137, v35, 16, v34
v_lshl_or_b32 v138, v37, 16, v36
v_lshl_or_b32 v139, v39, 16, v38
s_waitcnt vmcnt(16)
v_lshl_or_b32 v140, v41, 16, v40
v_lshl_or_b32 v141, v43, 16, v42
v_lshl_or_b32 v142, v45, 16, v44
v_lshl_or_b32 v143, v47, 16, v46
s_waitcnt vmcnt(8)
v_lshl_or_b32 v144, v49, 16, v48
v_lshl_or_b32 v145, v51, 16, v50
v_lshl_or_b32 v146, v53, 16, v52
v_lshl_or_b32 v147, v55, 16, v54
s_waitcnt vmcnt(0)
v_lshl_or_b32 v148, v57, 16, v56
v_lshl_or_b32 v149, v59, 16, v58
v_lshl_or_b32 v150, v61, 16, v60
v_lshl_or_b32 v151, v63, 16, v62
s_mul_i32 s29, s21, 92160
s_lshl_b32 s30, s22, 10
s_add_u32 s29, s29, s30
s_add_u32 s29, s29, 2621440
s_add_u32 s40, s29, 0
buffer_store_dwordx4 v[80:83], v2, s[8:11], s40 offen
s_add_u32 s40, s29, 5120
buffer_store_dwordx4 v[84:87], v2, s[8:11], s40 offen
s_add_u32 s40, s29, 10240
buffer_store_dwordx4 v[88:91], v2, s[8:11], s40 offen
s_add_u32 s40, s29, 15360
buffer_store_dwordx4 v[92:95], v2, s[8:11], s40 offen
s_add_u32 s40, s29, 20480
buffer_store_dwordx4 v[96:99], v2, s[8:11], s40 offen
s_add_u32 s40, s29, 25600
buffer_store_dwordx4 v[100:103], v2, s[8:11], s40 offen
s_add_u32 s40, s29, 30720
buffer_store_dwordx4 v[104:107], v2, s[8:11], s40 offen
s_add_u32 s40, s29, 35840
buffer_store_dwordx4 v[108:111], v2, s[8:11], s40 offen
s_add_u32 s40, s29, 40960
buffer_store_dwordx4 v[112:115], v2, s[8:11], s40 offen
s_add_u32 s40, s29, 46080
buffer_store_dwordx4 v[116:119], v2, s[8:11], s40 offen
s_add_u32 s40, s29, 51200
buffer_store_dwordx4 v[120:123], v2, s[8:11], s40 offen
s_add_u32 s40, s29, 56320
buffer_store_dwordx4 v[124:127], v2, s[8:11], s40 offen
s_add_u32 s40, s29, 61440
buffer_store_dwordx4 v[128:131], v2, s[8:11], s40 offen
s_add_u32 s40, s29, 66560
buffer_store_dwordx4 v[132:135], v2, s[8:11], s40 offen
s_add_u32 s40, s29, 71680
buffer_store_dwordx4 v[136:139], v2, s[8:11], s40 offen
s_add_u32 s40, s29, 76800
buffer_store_dwordx4 v[140:143], v2, s[8:11], s40 offen
s_add_u32 s40, s29, 81920
buffer_store_dwordx4 v[144:147], v2, s[8:11], s40 offen
s_add_u32 s40, s29, 87040
buffer_store_dwordx4 v[148:151], v2, s[8:11], s40 offen
L_prep_end:
s_endpgm
.p2align 8
.globl main_kernel
.type main_kernel,@function
main_kernel:
s_cmp_ge_u32 s2, 256
s_cbranch_scc1 L_end
s_load_dwordx2 s[12:13], s[0:1], 72
v_and_b32 v1, 63, v0
v_lshrrev_b32 v3, 6, v0
v_lshlrev_b32 v2, 4, v1
v_readfirstlane_b32 s4, v3
s_and_b32 s5, s2, 7
s_lshr_b32 s6, s2, 3
s_waitcnt lgkmcnt(0)
s_mov_b32 s8, s12
s_and_b32 s9, s13, 0xffff
s_mov_b32 s10, 268435456
s_mov_b32 s11, 0x20000
s_mov_b32 s70, 19324928
s_mov_b32 s71, 24043520
s_mov_b32 s72, 28762112
s_mov_b32 s73, 33480704
s_mov_b32 s74, 38199296
s_mov_b32 s75, 38461440
s_mov_b32 s76, 76210176
s_mov_b32 s77, 0
s_mov_b32 s7, 0
s_lshr_b32 s20, s6, 4
s_lshl_b32 s21, s5, 1
s_add_u32 s20, s20, s21
s_and_b32 s21, s6, 15
s_mul_i32 s22, s21, 147456
s_add_u32 s22, s22, 262144
s_mul_i32 s23, s4, 36864
s_add_u32 s22, s22, s23
s_add_u32 m0, s23, 0
s_add_u32 s40, s22, 0
buffer_load_dwordx4 v2, s[8:11], s40 offen offset:0 lds
buffer_load_dwordx4 v2, s[8:11], s40 offen offset:1024 lds
buffer_load_dwordx4 v2, s[8:11], s40 offen offset:2048 lds
buffer_load_dwordx4 v2, s[8:11], s40 offen offset:3072 lds
s_add_u32 m0, s23, 4096
s_add_u32 s40, s22, 4096
buffer_load_dwordx4 v2, s[8:11], s40 offen offset:0 lds
buffer_load_dwordx4 v2, s[8:11], s40 offen offset:1024 lds
buffer_load_dwordx4 v2, s[8:11], s40 offen offset:2048 lds
buffer_load_dwordx4 v2, s[8:11], s40 offen offset:3072 lds
s_add_u32 m0, s23, 8192
s_add_u32 s40, s22, 8192
buffer_load_dwordx4 v2, s[8:11], s40 offen offset:0 lds
buffer_load_dwordx4 v2, s[8:11], s40 offen offset:1024 lds
buffer_load_dwordx4 v2, s[8:11], s40 offen offset:2048 lds
buffer_load_dwordx4 v2, s[8:11], s40 offen offset:3072 lds
s_add_u32 m0, s23, 12288
s_add_u32 s40, s22, 12288
buffer_load_dwordx4 v2, s[8:11], s40 offen offset:0 lds
buffer_load_dwordx4 v2, s[8:11], s40 offen offset:1024 lds
buffer_load_dwordx4 v2, s[8:11], s40 offen offset:2048 lds
buffer_load_dwordx4 v2, s[8:11], s40 offen offset:3072 lds
s_add_u32 m0, s23, 16384
s_add_u32 s40, s22, 16384
buffer_load_dwordx4 v2, s[8:11], s40 offen offset:0 lds
buffer_load_dwordx4 v2, s[8:11], s40 offen offset:1024 lds
buffer_load_dwordx4 v2, s[8:11], s40 offen offset:2048 lds
buffer_load_dwordx4 v2, s[8:11], s40 offen offset:3072 lds
s_add_u32 m0, s23, 20480
s_add_u32 s40, s22, 20480
buffer_load_dwordx4 v2, s[8:11], s40 offen offset:0 lds
buffer_load_dwordx4 v2, s[8:11], s40 offen offset:1024 lds
buffer_load_dwordx4 v2, s[8:11], s40 offen offset:2048 lds
buffer_load_dwordx4 v2, s[8:11], s40 offen offset:3072 lds
s_add_u32 m0, s23, 24576
s_add_u32 s40, s22, 24576
buffer_load_dwordx4 v2, s[8:11], s40 offen offset:0 lds
buffer_load_dwordx4 v2, s[8:11], s40 offen offset:1024 lds
buffer_load_dwordx4 v2, s[8:11], s40 offen offset:2048 lds
buffer_load_dwordx4 v2, s[8:11], s40 offen offset:3072 lds
s_add_u32 m0, s23, 28672
s_add_u32 s40, s22, 28672
buffer_load_dwordx4 v2, s[8:11], s40 offen offset:0 lds
buffer_load_dwordx4 v2, s[8:11], s40 offen offset:1024 lds
buffer_load_dwordx4 v2, s[8:11], s40 offen offset:2048 lds
buffer_load_dwordx4 v2, s[8:11], s40 offen offset:3072 lds
s_add_u32 m0, s23, 32768
s_add_u32 s40, s22, 32768
buffer_load_dwordx4 v2, s[8:11], s40 offen offset:0 lds
buffer_load_dwordx4 v2, s[8:11], s40 offen offset:1024 lds
buffer_load_dwordx4 v2, s[8:11], s40 offen offset:2048 lds
buffer_load_dwordx4 v2, s[8:11], s40 offen offset:3072 lds
L_layer:
s_lshr_b32 s20, s6, 4
s_lshl_b32 s21, s5, 1
s_add_u32 s20, s20, s21
s_and_b32 s21, s6, 15
s_lshl_b32 s24, s20, 3
s_sub_u32 s25, s24, 1
s_max_i32 s35, s25, 0
s_mul_i32 s25, s35, 18432
s_lshl_b32 s26, s4, 1
s_add_u32 s36, s24, s26
s_mul_i32 s24, s36, 18432
s_add_u32 s26, s24, s70
s_add_u32 s27, s26, 18432
s_add_u32 s28, s25, s70
v_add_u32 v4, 0x10000, v2
v_add_u32 v5, 0x20000, v2
s_cmp_eq_u32 s4, 3
s_cselect_b32 s29, 0, s4
s_cselect_b32 s31, 16, 9
s_lshl_b32 s30, s29, 10
v_and_b32 v12, 15, v1
v_mov_b32 v13, 2146435072
v_cmp_le_u32 vcc, s31, v12
s_nop 1
v_cndmask_b32 v19, v13, v2, vcc
s_add_u32 s31, s30, 2048
v_add_u32 v6, s31, v2
v_add_u32 v7, s31, v4
v_add_u32 v8, s31, v5
s_add_u32 s31, s30, 5120
v_add_u32 v9, s31, v2
v_add_u32 v10, s31, v4
v_add_u32 v11, s31, v5
s_cmp_eq_u32 s7, 0
s_cbranch_scc1 L_a1go1
v_mul_u32_u24 v14, 43, v1
v_lshrrev_b32 v14, 8, v14
v_mul_u32_u24 v15, 6, v14
v_sub_u32 v15, v1, v15
v_cmp_eq_u32 vcc, 1, v14
v_mov_b32 v16, s36
s_nop 0
v_addc_co_u32 v16, vcc, 0, v16, vcc
v_cmp_eq_u32 vcc, 2, v14
v_mov_b32 v17, s35
s_nop 0
v_cndmask_b32 v16, v16, v17, vcc
v_lshlrev_b32 v16, 3, v16
v_add_lshl_u32 v16, v16, v15, 2
s_add_u32 s22, s77, 40960
s_mov_b32 s52, 0
buffer_load_dword v253, v16, s[8:11], s22 offen sc1
s_sleep 2
buffer_load_dword v254, v16, s[8:11], s22 offen sc1
s_sleep 2
L_poll2:
buffer_load_dword v255, v16, s[8:11], s22 offen sc1
s_waitcnt vmcnt(2)
v_cmp_ne_u32 vcc, 0, v253
s_add_u32 s52, s52, 1
s_cmp_eq_u64 vcc, exec
s_cbranch_scc1 L_got2
buffer_load_dword v253, v16, s[8:11], s22 offen sc1
s_waitcnt vmcnt(2)
v_cmp_ne_u32 vcc, 0, v254
s_add_u32 s52, s52, 1
s_cmp_eq_u64 vcc, exec
s_cbranch_scc1 L_got2
buffer_load_dword v254, v16, s[8:11], s22 offen sc1
s_waitcnt vmcnt(2)
v_cmp_ne_u32 vcc, 0, v255
s_add_u32 s52, s52, 1
s_cmp_eq_u64 vcc, exec
s_cbranch_scc1 L_got2
s_cmp_lt_u32 s52, 0x200000
s_cbranch_scc1 L_poll2
L_got2:
L_a1go1:
buffer_load_dwordx4 a[0:3], v2, s[8:11], s26 offen offset:0 sc1
buffer_load_dwordx4 a[72:75], v2, s[8:11], s27 offen offset:0 sc1
buffer_load_dwordx4 a[144:147], v19, s[8:11], s28 offen offset:0 sc1
buffer_load_dwordx4 a[4:7], v2, s[8:11], s26 offen offset:1024 sc1
buffer_load_dwordx4 a[76:79], v2, s[8:11], s27 offen offset:1024 sc1
buffer_load_dwordx4 a[148:151], v19, s[8:11], s28 offen offset:1024 sc1
buffer_load_dwordx4 a[8:11], v2, s[8:11], s26 offen offset:2048 sc1
buffer_load_dwordx4 a[80:83], v2, s[8:11], s27 offen offset:2048 sc1
buffer_load_dwordx4 a[152:155], v19, s[8:11], s28 offen offset:2048 sc1
buffer_load_dwordx4 a[12:15], v2, s[8:11], s26 offen offset:3072 sc1
buffer_load_dwordx4 a[84:87], v2, s[8:11], s27 offen offset:3072 sc1
buffer_load_dwordx4 a[156:159], v19, s[8:11], s28 offen offset:3072 sc1
s_add_u32 s26, s26, 4096
s_add_u32 s27, s27, 4096
s_add_u32 s28, s28, 4096
buffer_load_dwordx4 a[16:19], v2, s[8:11], s26 offen offset:0 sc1
buffer_load_dwordx4 a[88:91], v2, s[8:11], s27 offen offset:0 sc1
buffer_load_dwordx4 a[160:163], v19, s[8:11], s28 offen offset:0 sc1
buffer_load_dwordx4 a[20:23], v2, s[8:11], s26 offen offset:1024 sc1
buffer_load_dwordx4 a[92:95], v2, s[8:11], s27 offen offset:1024 sc1
buffer_load_dwordx4 a[164:167], v19, s[8:11], s28 offen offset:1024 sc1
buffer_load_dwordx4 a[24:27], v2, s[8:11], s26 offen offset:2048 sc1
buffer_load_dwordx4 a[96:99], v2, s[8:11], s27 offen offset:2048 sc1
buffer_load_dwordx4 a[168:171], v19, s[8:11], s28 offen offset:2048 sc1
buffer_load_dwordx4 a[28:31], v2, s[8:11], s26 offen offset:3072 sc1
buffer_load_dwordx4 a[100:103], v2, s[8:11], s27 offen offset:3072 sc1
buffer_load_dwordx4 a[172:175], v19, s[8:11], s28 offen offset:3072 sc1
v_lshrrev_b32 v13, 4, v1
v_lshlrev_b32 v14, 2, v13
v_sub_u32 v14, v12, v14
v_subrev_u32 v15, 0, v14
v_cmp_gt_u32 s[52:53], 8, v15
v_cmp_gt_i32 s[44:45], -8, v15
v_subrev_u32 v15, 1, v14
v_cmp_gt_u32 s[54:55], 8, v15
v_cmp_gt_i32 s[46:47], -8, v15
v_subrev_u32 v15, 2, v14
v_cmp_gt_u32 s[56:57], 8, v15
v_cmp_gt_i32 s[48:49], -8, v15
v_subrev_u32 v15, 3, v14
v_cmp_gt_u32 s[58:59], 8, v15
v_cmp_gt_i32 s[50:51], -8, v15
s_and_b32 s31, s20, 7
s_or_b32 s31, s31, s4
s_cmp_eq_u32 s31, 0
s_cselect_b64 s[60:61], 0, s[44:45]
s_cselect_b64 s[62:63], 0, s[46:47]
s_cselect_b64 s[64:65], 0, s[48:49]
s_cselect_b64 s[66:67], 0, s[50:51]
s_cmp_eq_u32 s7, 0
s_cbranch_scc0 L_a1w1
s_waitcnt vmcnt(24)
s_barrier
L_a1w1:
ds_read_b128 a[216:219], v2 offset:0
ds_read_b128 a[220:223], v2 offset:8192
ds_read_b128 a[224:227], v2 offset:1024
ds_read_b128 a[228:231], v2 offset:9216
ds_read_b128 a[232:235], v2 offset:2048
ds_read_b128 a[236:239], v2 offset:10240
s_waitcnt vmcnt(18)
s_waitcnt lgkmcnt(4)
v_mfma_f32_16x16x32_bf16 v[32:35], a[216:219], a[0:3], 0
s_add_u32 s26, s26, 4096
s_add_u32 s27, s27, 4096
s_add_u32 s28, s28, 4096
buffer_load_dwordx4 a[32:35], v2, s[8:11], s26 offen offset:0 sc1
v_mfma_f32_16x16x32_bf16 v[32:35], a[220:223], a[4:7], v[32:35]
ds_read_b128 a[240:243], v2 offset:3072
v_mfma_f32_16x16x32_bf16 v[36:39], a[216:219], a[72:75], 0
v_mfma_f32_16x16x32_bf16 v[36:39], a[220:223], a[76:79], v[36:39]
ds_read_b128 a[244:247], v2 offset:11264
s_waitcnt lgkmcnt(4)
v_mfma_f32_16x16x32_bf16 v[40:43], a[224:227], a[0:3], 0
buffer_load_dwordx4 a[104:107], v2, s[8:11], s27 offen offset:0 sc1
v_mfma_f32_16x16x32_bf16 v[40:43], a[228:231], a[4:7], v[40:43]
ds_read_b128 a[216:219], v2 offset:4096
v_mfma_f32_16x16x32_bf16 v[44:47], a[224:227], a[72:75], 0
v_mfma_f32_16x16x32_bf16 v[44:47], a[228:231], a[76:79], v[44:47]
ds_read_b128 a[220:223], v2 offset:12288
s_waitcnt lgkmcnt(4)
v_mfma_f32_16x16x32_bf16 v[48:51], a[232:235], a[0:3], 0
buffer_load_dwordx4 a[176:179], v19, s[8:11], s28 offen offset:0 sc1
v_mfma_f32_16x16x32_bf16 v[48:51], a[236:239], a[4:7], v[48:51]
ds_read_b128 a[224:227], v2 offset:5120
v_mfma_f32_16x16x32_bf16 v[52:55], a[232:235], a[72:75], 0
v_mfma_f32_16x16x32_bf16 v[52:55], a[236:239], a[76:79], v[52:55]
ds_read_b128 a[228:231], v2 offset:13312
s_waitcnt lgkmcnt(4)
v_mfma_f32_16x16x32_bf16 v[56:59], a[240:243], a[0:3], 0
buffer_load_dwordx4 a[36:39], v2, s[8:11], s26 offen offset:1024 sc1
v_mfma_f32_16x16x32_bf16 v[56:59], a[244:247], a[4:7], v[56:59]
ds_read_b128 a[232:235], v2 offset:6144
v_mfma_f32_16x16x32_bf16 v[60:63], a[240:243], a[72:75], 0
v_mfma_f32_16x16x32_bf16 v[60:63], a[244:247], a[76:79], v[60:63]
ds_read_b128 a[236:239], v2 offset:14336
s_waitcnt lgkmcnt(4)
v_mfma_f32_16x16x32_bf16 v[64:67], a[216:219], a[0:3], 0
buffer_load_dwordx4 a[108:111], v2, s[8:11], s27 offen offset:1024 sc1
v_mfma_f32_16x16x32_bf16 v[64:67], a[220:223], a[4:7], v[64:67]
ds_read_b128 a[240:243], v2 offset:7168
v_mfma_f32_16x16x32_bf16 v[68:71], a[216:219], a[72:75], 0
v_mfma_f32_16x16x32_bf16 v[68:71], a[220:223], a[76:79], v[68:71]
ds_read_b128 a[244:247], v2 offset:15360
s_waitcnt lgkmcnt(4)
v_mfma_f32_16x16x32_bf16 v[72:75], a[0:3], a[224:227], 0
buffer_load_dwordx4 a[180:183], v19, s[8:11], s28 offen offset:1024 sc1
v_mfma_f32_16x16x32_bf16 v[72:75], a[4:7], a[228:231], v[72:75]
ds_read_b128 a[216:219], v6 offset:0
v_mfma_f32_16x16x32_bf16 v[76:79], a[72:75], a[224:227], 0
v_mfma_f32_16x16x32_bf16 v[76:79], a[76:79], a[228:231], v[76:79]
ds_read_b128 a[220:223], v6 offset:8192
s_waitcnt lgkmcnt(4)
v_mfma_f32_16x16x32_bf16 v[80:83], a[0:3], a[232:235], 0
buffer_load_dwordx4 a[40:43], v2, s[8:11], s26 offen offset:2048 sc1
v_mfma_f32_16x16x32_bf16 v[80:83], a[4:7], a[236:239], v[80:83]
ds_read_b128 a[224:227], v9 offset:0
v_mfma_f32_16x16x32_bf16 v[84:87], a[72:75], a[232:235], 0
v_mfma_f32_16x16x32_bf16 v[84:87], a[76:79], a[236:239], v[84:87]
ds_read_b128 a[228:231], v9 offset:8192
s_waitcnt lgkmcnt(4)
v_mfma_f32_16x16x32_bf16 v[88:91], a[0:3], a[240:243], 0
buffer_load_dwordx4 a[112:115], v2, s[8:11], s27 offen offset:2048 sc1
v_mfma_f32_16x16x32_bf16 v[88:91], a[4:7], a[244:247], v[88:91]
ds_read_b128 a[232:235], v2 offset:16384
v_mfma_f32_16x16x32_bf16 v[92:95], a[72:75], a[240:243], 0
v_mfma_f32_16x16x32_bf16 v[92:95], a[76:79], a[244:247], v[92:95]
ds_read_b128 a[236:239], v2 offset:24576
s_waitcnt lgkmcnt(4)
v_mfma_f32_16x16x32_bf16 v[96:99], a[216:219], a[144:147], 0
ds_read_b128 a[240:243], v2 offset:17408
buffer_load_dwordx4 a[184:187], v19, s[8:11], s28 offen offset:2048 sc1
v_mfma_f32_16x16x32_bf16 v[96:99], a[220:223], a[148:151], v[96:99]
ds_read_b128 a[244:247], v2 offset:25600
s_waitcnt lgkmcnt(4)
v_mfma_f32_16x16x32_bf16 v[100:103], a[144:147], a[224:227], 0
ds_read_b128 a[216:219], v2 offset:18432
v_mfma_f32_16x16x32_bf16 v[100:103], a[148:151], a[228:231], v[100:103]
ds_read_b128 a[220:223], v2 offset:26624
s_waitcnt vmcnt(21)
s_waitcnt lgkmcnt(4)
v_mfma_f32_16x16x32_bf16 v[32:35], a[232:235], a[8:11], v[32:35]
buffer_load_dwordx4 a[44:47], v2, s[8:11], s26 offen offset:3072 sc1
v_mfma_f32_16x16x32_bf16 v[32:35], a[236:239], a[12:15], v[32:35]
ds_read_b128 a[224:227], v2 offset:19456
v_mfma_f32_16x16x32_bf16 v[36:39], a[232:235], a[80:83], v[36:39]
v_mfma_f32_16x16x32_bf16 v[36:39], a[236:239], a[84:87], v[36:39]
ds_read_b128 a[228:231], v2 offset:27648
s_waitcnt lgkmcnt(4)
v_mfma_f32_16x16x32_bf16 v[40:43], a[240:243], a[8:11], v[40:43]
buffer_load_dwordx4 a[116:119], v2, s[8:11], s27 offen offset:3072 sc1
v_mfma_f32_16x16x32_bf16 v[40:43], a[244:247], a[12:15], v[40:43]
ds_read_b128 a[232:235], v2 offset:20480
v_mfma_f32_16x16x32_bf16 v[44:47], a[240:243], a[80:83], v[44:47]
v_mfma_f32_16x16x32_bf16 v[44:47], a[244:247], a[84:87], v[44:47]
ds_read_b128 a[236:239], v2 offset:28672
s_waitcnt lgkmcnt(4)
v_mfma_f32_16x16x32_bf16 v[48:51], a[216:219], a[8:11], v[48:51]
buffer_load_dwordx4 a[188:191], v19, s[8:11], s28 offen offset:3072 sc1
v_mfma_f32_16x16x32_bf16 v[48:51], a[220:223], a[12:15], v[48:51]
ds_read_b128 a[240:243], v2 offset:21504
v_mfma_f32_16x16x32_bf16 v[52:55], a[216:219], a[80:83], v[52:55]
v_mfma_f32_16x16x32_bf16 v[52:55], a[220:223], a[84:87], v[52:55]
ds_read_b128 a[244:247], v2 offset:29696
s_waitcnt lgkmcnt(4)
v_mfma_f32_16x16x32_bf16 v[56:59], a[224:227], a[8:11], v[56:59]
s_add_u32 s26, s26, 4096
s_add_u32 s27, s27, 4096
s_add_u32 s28, s28, 4096
buffer_load_dwordx4 a[48:51], v2, s[8:11], s26 offen offset:0 sc1
v_mfma_f32_16x16x32_bf16 v[56:59], a[228:231], a[12:15], v[56:59]
ds_read_b128 a[216:219], v2 offset:22528
v_mfma_f32_16x16x32_bf16 v[60:63], a[224:227], a[80:83], v[60:63]
v_mfma_f32_16x16x32_bf16 v[60:63], a[228:231], a[84:87], v[60:63]
ds_read_b128 a[220:223], v2 offset:30720
s_waitcnt lgkmcnt(4)
v_mfma_f32_16x16x32_bf16 v[64:67], a[232:235], a[8:11], v[64:67]
buffer_load_dwordx4 a[120:123], v2, s[8:11], s27 offen offset:0 sc1
v_mfma_f32_16x16x32_bf16 v[64:67], a[236:239], a[12:15], v[64:67]
ds_read_b128 a[224:227], v2 offset:23552
v_mfma_f32_16x16x32_bf16 v[68:71], a[232:235], a[80:83], v[68:71]
v_mfma_f32_16x16x32_bf16 v[68:71], a[236:239], a[84:87], v[68:71]
ds_read_b128 a[228:231], v2 offset:31744
s_waitcnt lgkmcnt(4)
v_mfma_f32_16x16x32_bf16 v[72:75], a[8:11], a[240:243], v[72:75]
buffer_load_dwordx4 a[192:195], v19, s[8:11], s28 offen offset:0 sc1
v_mfma_f32_16x16x32_bf16 v[72:75], a[12:15], a[244:247], v[72:75]
ds_read_b128 a[232:235], v6 offset:16384
v_mfma_f32_16x16x32_bf16 v[76:79], a[80:83], a[240:243], v[76:79]
v_mfma_f32_16x16x32_bf16 v[76:79], a[84:87], a[244:247], v[76:79]
ds_read_b128 a[236:239], v6 offset:24576
s_waitcnt lgkmcnt(4)
v_mfma_f32_16x16x32_bf16 v[80:83], a[8:11], a[216:219], v[80:83]
buffer_load_dwordx4 a[52:55], v2, s[8:11], s26 offen offset:1024 sc1
v_mfma_f32_16x16x32_bf16 v[80:83], a[12:15], a[220:223], v[80:83]
ds_read_b128 a[240:243], v9 offset:16384
v_mfma_f32_16x16x32_bf16 v[84:87], a[80:83], a[216:219], v[84:87]
v_mfma_f32_16x16x32_bf16 v[84:87], a[84:87], a[220:223], v[84:87]
ds_read_b128 a[244:247], v9 offset:24576
s_waitcnt lgkmcnt(4)
v_mfma_f32_16x16x32_bf16 v[88:91], a[8:11], a[224:227], v[88:91]
buffer_load_dwordx4 a[124:127], v2, s[8:11], s27 offen offset:1024 sc1
v_mfma_f32_16x16x32_bf16 v[88:91], a[12:15], a[228:231], v[88:91]
ds_read_b128 a[216:219], v2 offset:32768
v_mfma_f32_16x16x32_bf16 v[92:95], a[80:83], a[224:227], v[92:95]
v_mfma_f32_16x16x32_bf16 v[92:95], a[84:87], a[228:231], v[92:95]
ds_read_b128 a[220:223], v2 offset:40960
s_waitcnt lgkmcnt(4)
v_mfma_f32_16x16x32_bf16 v[96:99], a[232:235], a[152:155], v[96:99]
ds_read_b128 a[224:227], v2 offset:33792
buffer_load_dwordx4 a[196:199], v19, s[8:11], s28 offen offset:1024 sc1
v_mfma_f32_16x16x32_bf16 v[96:99], a[236:239], a[156:159], v[96:99]
ds_read_b128 a[228:231], v2 offset:41984
s_waitcnt lgkmcnt(4)
v_mfma_f32_16x16x32_bf16 v[100:103], a[152:155], a[240:243], v[100:103]
ds_read_b128 a[232:235], v2 offset:34816
v_mfma_f32_16x16x32_bf16 v[100:103], a[156:159], a[244:247], v[100:103]
ds_read_b128 a[236:239], v2 offset:43008
s_waitcnt vmcnt(24)
s_waitcnt lgkmcnt(4)
v_mfma_f32_16x16x32_bf16 v[32:35], a[216:219], a[16:19], v[32:35]
buffer_load_dwordx4 a[56:59], v2, s[8:11], s26 offen offset:2048 sc1
v_mfma_f32_16x16x32_bf16 v[32:35], a[220:223], a[20:23], v[32:35]
ds_read_b128 a[240:243], v2 offset:35840
v_mfma_f32_16x16x32_bf16 v[36:39], a[216:219], a[88:91], v[36:39]
v_mfma_f32_16x16x32_bf16 v[36:39], a[220:223], a[92:95], v[36:39]
ds_read_b128 a[244:247], v2 offset:44032
s_waitcnt lgkmcnt(4)
v_mfma_f32_16x16x32_bf16 v[40:43], a[224:227], a[16:19], v[40:43]
buffer_load_dwordx4 a[128:131], v2, s[8:11], s27 offen offset:2048 sc1
v_mfma_f32_16x16x32_bf16 v[40:43], a[228:231], a[20:23], v[40:43]
ds_read_b128 a[216:219], v2 offset:36864
v_mfma_f32_16x16x32_bf16 v[44:47], a[224:227], a[88:91], v[44:47]
v_mfma_f32_16x16x32_bf16 v[44:47], a[228:231], a[92:95], v[44:47]
ds_read_b128 a[220:223], v2 offset:45056
s_waitcnt lgkmcnt(4)
v_mfma_f32_16x16x32_bf16 v[48:51], a[232:235], a[16:19], v[48:51]
buffer_load_dwordx4 a[200:203], v19, s[8:11], s28 offen offset:2048 sc1
v_mfma_f32_16x16x32_bf16 v[48:51], a[236:239], a[20:23], v[48:51]
ds_read_b128 a[224:227], v2 offset:37888
v_mfma_f32_16x16x32_bf16 v[52:55], a[232:235], a[88:91], v[52:55]
v_mfma_f32_16x16x32_bf16 v[52:55], a[236:239], a[92:95], v[52:55]
ds_read_b128 a[228:231], v2 offset:46080
s_waitcnt lgkmcnt(4)
v_mfma_f32_16x16x32_bf16 v[56:59], a[240:243], a[16:19], v[56:59]
buffer_load_dwordx4 a[60:63], v2, s[8:11], s26 offen offset:3072 sc1
v_mfma_f32_16x16x32_bf16 v[56:59], a[244:247], a[20:23], v[56:59]
ds_read_b128 a[232:235], v2 offset:38912
v_mfma_f32_16x16x32_bf16 v[60:63], a[240:243], a[88:91], v[60:63]
v_mfma_f32_16x16x32_bf16 v[60:63], a[244:247], a[92:95], v[60:63]
ds_read_b128 a[236:239], v2 offset:47104
s_waitcnt lgkmcnt(4)
v_mfma_f32_16x16x32_bf16 v[64:67], a[216:219], a[16:19], v[64:67]
buffer_load_dwordx4 a[132:135], v2, s[8:11], s27 offen offset:3072 sc1
v_mfma_f32_16x16x32_bf16 v[64:67], a[220:223], a[20:23], v[64:67]
ds_read_b128 a[240:243], v2 offset:39936
v_mfma_f32_16x16x32_bf16 v[68:71], a[216:219], a[88:91], v[68:71]
v_mfma_f32_16x16x32_bf16 v[68:71], a[220:223], a[92:95], v[68:71]
ds_read_b128 a[244:247], v2 offset:48128
s_waitcnt lgkmcnt(4)
v_mfma_f32_16x16x32_bf16 v[72:75], a[16:19], a[224:227], v[72:75]
buffer_load_dwordx4 a[204:207], v19, s[8:11], s28 offen offset:3072 sc1
v_mfma_f32_16x16x32_bf16 v[72:75], a[20:23], a[228:231], v[72:75]
ds_read_b128 a[216:219], v6 offset:32768
v_mfma_f32_16x16x32_bf16 v[76:79], a[88:91], a[224:227], v[76:79]
v_mfma_f32_16x16x32_bf16 v[76:79], a[92:95], a[228:231], v[76:79]
ds_read_b128 a[220:223], v6 offset:40960
s_waitcnt lgkmcnt(4)
v_mfma_f32_16x16x32_bf16 v[80:83], a[16:19], a[232:235], v[80:83]
s_add_u32 s26, s26, 4096
s_add_u32 s27, s27, 4096
s_add_u32 s28, s28, 4096
buffer_load_dwordx4 a[64:67], v2, s[8:11], s26 offen offset:0 sc1
v_mfma_f32_16x16x32_bf16 v[80:83], a[20:23], a[236:239], v[80:83]
ds_read_b128 a[224:227], v9 offset:32768
v_mfma_f32_16x16x32_bf16 v[84:87], a[88:91], a[232:235], v[84:87]
v_mfma_f32_16x16x32_bf16 v[84:87], a[92:95], a[236:239], v[84:87]
ds_read_b128 a[228:231], v9 offset:40960
s_waitcnt lgkmcnt(4)
v_mfma_f32_16x16x32_bf16 v[88:91], a[16:19], a[240:243], v[88:91]
buffer_load_dwordx4 a[136:139], v2, s[8:11], s27 offen offset:0 sc1
v_mfma_f32_16x16x32_bf16 v[88:91], a[20:23], a[244:247], v[88:91]
ds_read_b128 a[232:235], v2 offset:49152
v_mfma_f32_16x16x32_bf16 v[92:95], a[88:91], a[240:243], v[92:95]
v_mfma_f32_16x16x32_bf16 v[92:95], a[92:95], a[244:247], v[92:95]
ds_read_b128 a[236:239], v2 offset:57344
s_waitcnt lgkmcnt(4)
v_mfma_f32_16x16x32_bf16 v[96:99], a[216:219], a[160:163], v[96:99]
ds_read_b128 a[240:243], v2 offset:50176
buffer_load_dwordx4 a[208:211], v19, s[8:11], s28 offen offset:0 sc1
v_mfma_f32_16x16x32_bf16 v[96:99], a[220:223], a[164:167], v[96:99]
ds_read_b128 a[244:247], v2 offset:58368
s_waitcnt lgkmcnt(4)
v_mfma_f32_16x16x32_bf16 v[100:103], a[160:163], a[224:227], v[100:103]
ds_read_b128 a[216:219], v2 offset:51200
v_mfma_f32_16x16x32_bf16 v[100:103], a[164:167], a[228:231], v[100:103]
ds_read_b128 a[220:223], v2 offset:59392
s_waitcnt vmcnt(27)
s_waitcnt lgkmcnt(4)
v_mfma_f32_16x16x32_bf16 v[32:35], a[232:235], a[24:27], v[32:35]
buffer_load_dwordx4 a[68:71], v2, s[8:11], s26 offen offset:1024 sc1
v_mfma_f32_16x16x32_bf16 v[32:35], a[236:239], a[28:31], v[32:35]
ds_read_b128 a[224:227], v2 offset:52224
v_mfma_f32_16x16x32_bf16 v[36:39], a[232:235], a[96:99], v[36:39]
v_mfma_f32_16x16x32_bf16 v[36:39], a[236:239], a[100:103], v[36:39]
ds_read_b128 a[228:231], v2 offset:60416
s_waitcnt lgkmcnt(4)
v_mfma_f32_16x16x32_bf16 v[40:43], a[240:243], a[24:27], v[40:43]
buffer_load_dwordx4 a[140:143], v2, s[8:11], s27 offen offset:1024 sc1
v_mfma_f32_16x16x32_bf16 v[40:43], a[244:247], a[28:31], v[40:43]
ds_read_b128 a[232:235], v2 offset:53248
v_mfma_f32_16x16x32_bf16 v[44:47], a[240:243], a[96:99], v[44:47]
v_mfma_f32_16x16x32_bf16 v[44:47], a[244:247], a[100:103], v[44:47]
ds_read_b128 a[236:239], v2 offset:61440
s_waitcnt lgkmcnt(4)
v_mfma_f32_16x16x32_bf16 v[48:51], a[216:219], a[24:27], v[48:51]
buffer_load_dwordx4 a[212:215], v19, s[8:11], s28 offen offset:1024 sc1
v_mfma_f32_16x16x32_bf16 v[48:51], a[220:223], a[28:31], v[48:51]
ds_read_b128 a[240:243], v2 offset:54272
v_mfma_f32_16x16x32_bf16 v[52:55], a[216:219], a[96:99], v[52:55]
v_mfma_f32_16x16x32_bf16 v[52:55], a[220:223], a[100:103], v[52:55]
ds_read_b128 a[244:247], v2 offset:62464
s_waitcnt lgkmcnt(4)
v_mfma_f32_16x16x32_bf16 v[56:59], a[224:227], a[24:27], v[56:59]
v_mfma_f32_16x16x32_bf16 v[56:59], a[228:231], a[28:31], v[56:59]
ds_read_b128 a[216:219], v2 offset:55296
v_mfma_f32_16x16x32_bf16 v[60:63], a[224:227], a[96:99], v[60:63]
v_mfma_f32_16x16x32_bf16 v[60:63], a[228:231], a[100:103], v[60:63]
ds_read_b128 a[220:223], v2 offset:63488
s_waitcnt lgkmcnt(4)
v_mfma_f32_16x16x32_bf16 v[64:67], a[232:235], a[24:27], v[64:67]
v_mfma_f32_16x16x32_bf16 v[64:67], a[236:239], a[28:31], v[64:67]
ds_read_b128 a[224:227], v2 offset:56320
v_mfma_f32_16x16x32_bf16 v[68:71], a[232:235], a[96:99], v[68:71]
v_mfma_f32_16x16x32_bf16 v[68:71], a[236:239], a[100:103], v[68:71]
ds_read_b128 a[228:231], v2 offset:64512
s_waitcnt lgkmcnt(4)
v_mfma_f32_16x16x32_bf16 v[72:75], a[24:27], a[240:243], v[72:75]
v_mfma_f32_16x16x32_bf16 v[72:75], a[28:31], a[244:247], v[72:75]
ds_read_b128 a[232:235], v6 offset:49152
v_mfma_f32_16x16x32_bf16 v[76:79], a[96:99], a[240:243], v[76:79]
v_mfma_f32_16x16x32_bf16 v[76:79], a[100:103], a[244:247], v[76:79]
ds_read_b128 a[236:239], v6 offset:57344
s_waitcnt lgkmcnt(4)
v_mfma_f32_16x16x32_bf16 v[80:83], a[24:27], a[216:219], v[80:83]
v_mfma_f32_16x16x32_bf16 v[80:83], a[28:31], a[220:223], v[80:83]
ds_read_b128 a[240:243], v9 offset:49152
v_mfma_f32_16x16x32_bf16 v[84:87], a[96:99], a[216:219], v[84:87]
v_mfma_f32_16x16x32_bf16 v[84:87], a[100:103], a[220:223], v[84:87]
ds_read_b128 a[244:247], v9 offset:57344
s_waitcnt lgkmcnt(4)
v_mfma_f32_16x16x32_bf16 v[88:91], a[24:27], a[224:227], v[88:91]
v_mfma_f32_16x16x32_bf16 v[88:91], a[28:31], a[228:231], v[88:91]
ds_read_b128 a[216:219], v4 offset:0
v_mfma_f32_16x16x32_bf16 v[92:95], a[96:99], a[224:227], v[92:95]
v_mfma_f32_16x16x32_bf16 v[92:95], a[100:103], a[228:231], v[92:95]
ds_read_b128 a[220:223], v4 offset:8192
s_waitcnt lgkmcnt(4)
v_mfma_f32_16x16x32_bf16 v[96:99], a[232:235], a[168:171], v[96:99]
ds_read_b128 a[224:227], v4 offset:1024
v_mfma_f32_16x16x32_bf16 v[96:99], a[236:239], a[172:175], v[96:99]
ds_read_b128 a[228:231], v4 offset:9216
s_waitcnt lgkmcnt(4)
v_mfma_f32_16x16x32_bf16 v[100:103], a[168:171], a[240:243], v[100:103]
ds_read_b128 a[232:235], v4 offset:2048
v_mfma_f32_16x16x32_bf16 v[100:103], a[172:175], a[244:247], v[100:103]
ds_read_b128 a[236:239], v4 offset:10240
s_waitcnt vmcnt(24)
s_waitcnt lgkmcnt(4)
v_mfma_f32_16x16x32_bf16 v[32:35], a[216:219], a[32:35], v[32:35]
v_mfma_f32_16x16x32_bf16 v[32:35], a[220:223], a[36:39], v[32:35]
ds_read_b128 a[240:243], v4 offset:3072
v_mfma_f32_16x16x32_bf16 v[36:39], a[216:219], a[104:107], v[36:39]
v_mfma_f32_16x16x32_bf16 v[36:39], a[220:223], a[108:111], v[36:39]
ds_read_b128 a[244:247], v4 offset:11264
s_waitcnt lgkmcnt(4)
v_mfma_f32_16x16x32_bf16 v[40:43], a[224:227], a[32:35], v[40:43]
v_mfma_f32_16x16x32_bf16 v[40:43], a[228:231], a[36:39], v[40:43]
ds_read_b128 a[216:219], v4 offset:4096
v_mfma_f32_16x16x32_bf16 v[44:47], a[224:227], a[104:107], v[44:47]
v_mfma_f32_16x16x32_bf16 v[44:47], a[228:231], a[108:111], v[44:47]
ds_read_b128 a[220:223], v4 offset:12288
s_waitcnt lgkmcnt(4)
v_mfma_f32_16x16x32_bf16 v[48:51], a[232:235], a[32:35], v[48:51]
v_mfma_f32_16x16x32_bf16 v[48:51], a[236:239], a[36:39], v[48:51]
ds_read_b128 a[224:227], v4 offset:5120
v_mfma_f32_16x16x32_bf16 v[52:55], a[232:235], a[104:107], v[52:55]
v_mfma_f32_16x16x32_bf16 v[52:55], a[236:239], a[108:111], v[52:55]
ds_read_b128 a[228:231], v4 offset:13312
s_waitcnt lgkmcnt(4)
v_mfma_f32_16x16x32_bf16 v[56:59], a[240:243], a[32:35], v[56:59]
v_mfma_f32_16x16x32_bf16 v[56:59], a[244:247], a[36:39], v[56:59]
ds_read_b128 a[232:235], v4 offset:6144
v_mfma_f32_16x16x32_bf16 v[60:63], a[240:243], a[104:107], v[60:63]
v_mfma_f32_16x16x32_bf16 v[60:63], a[244:247], a[108:111], v[60:63]
ds_read_b128 a[236:239], v4 offset:14336
s_waitcnt lgkmcnt(4)
v_mfma_f32_16x16x32_bf16 v[64:67], a[216:219], a[32:35], v[64:67]
v_mfma_f32_16x16x32_bf16 v[64:67], a[220:223], a[36:39], v[64:67]
ds_read_b128 a[240:243], v4 offset:7168
v_mfma_f32_16x16x32_bf16 v[68:71], a[216:219], a[104:107], v[68:71]
v_mfma_f32_16x16x32_bf16 v[68:71], a[220:223], a[108:111], v[68:71]
ds_read_b128 a[244:247], v4 offset:15360
s_waitcnt lgkmcnt(4)
v_mfma_f32_16x16x32_bf16 v[72:75], a[32:35], a[224:227], v[72:75]
v_mfma_f32_16x16x32_bf16 v[72:75], a[36:39], a[228:231], v[72:75]
ds_read_b128 a[216:219], v7 offset:0
v_mfma_f32_16x16x32_bf16 v[76:79], a[104:107], a[224:227], v[76:79]
v_mfma_f32_16x16x32_bf16 v[76:79], a[108:111], a[228:231], v[76:79]
ds_read_b128 a[220:223], v7 offset:8192
s_waitcnt lgkmcnt(4)
v_mfma_f32_16x16x32_bf16 v[80:83], a[32:35], a[232:235], v[80:83]
v_mfma_f32_16x16x32_bf16 v[80:83], a[36:39], a[236:239], v[80:83]
ds_read_b128 a[224:227], v10 offset:0
v_mfma_f32_16x16x32_bf16 v[84:87], a[104:107], a[232:235], v[84:87]
v_mfma_f32_16x16x32_bf16 v[84:87], a[108:111], a[236:239], v[84:87]
ds_read_b128 a[228:231], v10 offset:8192
s_waitcnt lgkmcnt(4)
v_mfma_f32_16x16x32_bf16 v[88:91], a[32:35], a[240:243], v[88:91]
v_mfma_f32_16x16x32_bf16 v[88:91], a[36:39], a[244:247], v[88:91]
ds_read_b128 a[232:235], v4 offset:16384
v_mfma_f32_16x16x32_bf16 v[92:95], a[104:107], a[240:243], v[92:95]
v_mfma_f32_16x16x32_bf16 v[92:95], a[108:111], a[244:247], v[92:95]
ds_read_b128 a[236:239], v4 offset:24576
s_waitcnt lgkmcnt(4)
v_mfma_f32_16x16x32_bf16 v[96:99], a[216:219], a[176:179], v[96:99]
ds_read_b128 a[240:243], v4 offset:17408
v_mfma_f32_16x16x32_bf16 v[96:99], a[220:223], a[180:183], v[96:99]
ds_read_b128 a[244:247], v4 offset:25600
s_waitcnt lgkmcnt(4)
v_mfma_f32_16x16x32_bf16 v[100:103], a[176:179], a[224:227], v[100:103]
ds_read_b128 a[216:219], v4 offset:18432
v_mfma_f32_16x16x32_bf16 v[100:103], a[180:183], a[228:231], v[100:103]
ds_read_b128 a[220:223], v4 offset:26624
s_waitcnt vmcnt(18)
s_waitcnt lgkmcnt(4)
v_mfma_f32_16x16x32_bf16 v[32:35], a[232:235], a[40:43], v[32:35]
v_mfma_f32_16x16x32_bf16 v[32:35], a[236:239], a[44:47], v[32:35]
ds_read_b128 a[224:227], v4 offset:19456
v_mfma_f32_16x16x32_bf16 v[36:39], a[232:235], a[112:115], v[36:39]
v_mfma_f32_16x16x32_bf16 v[36:39], a[236:239], a[116:119], v[36:39]
ds_read_b128 a[228:231], v4 offset:27648
s_waitcnt lgkmcnt(4)
v_mfma_f32_16x16x32_bf16 v[40:43], a[240:243], a[40:43], v[40:43]
v_mfma_f32_16x16x32_bf16 v[40:43], a[244:247], a[44:47], v[40:43]
ds_read_b128 a[232:235], v4 offset:20480
v_mfma_f32_16x16x32_bf16 v[44:47], a[240:243], a[112:115], v[44:47]
v_mfma_f32_16x16x32_bf16 v[44:47], a[244:247], a[116:119], v[44:47]
ds_read_b128 a[236:239], v4 offset:28672
s_waitcnt lgkmcnt(4)
v_mfma_f32_16x16x32_bf16 v[48:51], a[216:219], a[40:43], v[48:51]
v_mfma_f32_16x16x32_bf16 v[48:51], a[220:223], a[44:47], v[48:51]
ds_read_b128 a[240:243], v4 offset:21504
v_mfma_f32_16x16x32_bf16 v[52:55], a[216:219], a[112:115], v[52:55]
v_mfma_f32_16x16x32_bf16 v[52:55], a[220:223], a[116:119], v[52:55]
ds_read_b128 a[244:247], v4 offset:29696
s_waitcnt lgkmcnt(4)
v_mfma_f32_16x16x32_bf16 v[56:59], a[224:227], a[40:43], v[56:59]
v_mfma_f32_16x16x32_bf16 v[56:59], a[228:231], a[44:47], v[56:59]
ds_read_b128 a[216:219], v4 offset:22528
v_mfma_f32_16x16x32_bf16 v[60:63], a[224:227], a[112:115], v[60:63]
v_mfma_f32_16x16x32_bf16 v[60:63], a[228:231], a[116:119], v[60:63]
ds_read_b128 a[220:223], v4 offset:30720
s_waitcnt lgkmcnt(4)
v_mfma_f32_16x16x32_bf16 v[64:67], a[232:235], a[40:43], v[64:67]
v_mfma_f32_16x16x32_bf16 v[64:67], a[236:239], a[44:47], v[64:67]
ds_read_b128 a[224:227], v4 offset:23552
v_mfma_f32_16x16x32_bf16 v[68:71], a[232:235], a[112:115], v[68:71]
v_mfma_f32_16x16x32_bf16 v[68:71], a[236:239], a[116:119], v[68:71]
ds_read_b128 a[228:231], v4 offset:31744
s_waitcnt lgkmcnt(4)
v_mfma_f32_16x16x32_bf16 v[72:75], a[40:43], a[240:243], v[72:75]
v_mfma_f32_16x16x32_bf16 v[72:75], a[44:47], a[244:247], v[72:75]
ds_read_b128 a[232:235], v7 offset:16384
v_mfma_f32_16x16x32_bf16 v[76:79], a[112:115], a[240:243], v[76:79]
v_mfma_f32_16x16x32_bf16 v[76:79], a[116:119], a[244:247], v[76:79]
ds_read_b128 a[236:239], v7 offset:24576
s_waitcnt lgkmcnt(4)
v_mfma_f32_16x16x32_bf16 v[80:83], a[40:43], a[216:219], v[80:83]
v_mfma_f32_16x16x32_bf16 v[80:83], a[44:47], a[220:223], v[80:83]
ds_read_b128 a[240:243], v10 offset:16384
v_mfma_f32_16x16x32_bf16 v[84:87], a[112:115], a[216:219], v[84:87]
v_mfma_f32_16x16x32_bf16 v[84:87], a[116:119], a[220:223], v[84:87]
ds_read_b128 a[244:247], v10 offset:24576
s_waitcnt lgkmcnt(4)
v_mfma_f32_16x16x32_bf16 v[88:91], a[40:43], a[224:227], v[88:91]
v_mfma_f32_16x16x32_bf16 v[88:91], a[44:47], a[228:231], v[88:91]
ds_read_b128 a[216:219], v4 offset:32768
v_mfma_f32_16x16x32_bf16 v[92:95], a[112:115], a[224:227], v[92:95]
v_mfma_f32_16x16x32_bf16 v[92:95], a[116:119], a[228:231], v[92:95]
ds_read_b128 a[220:223], v4 offset:40960
s_waitcnt lgkmcnt(4)
v_mfma_f32_16x16x32_bf16 v[96:99], a[232:235], a[184:187], v[96:99]
ds_read_b128 a[224:227], v4 offset:33792
v_mfma_f32_16x16x32_bf16 v[96:99], a[236:239], a[188:191], v[96:99]
ds_read_b128 a[228:231], v4 offset:41984
s_waitcnt lgkmcnt(4)
v_mfma_f32_16x16x32_bf16 v[100:103], a[184:187], a[240:243], v[100:103]
ds_read_b128 a[232:235], v4 offset:34816
v_mfma_f32_16x16x32_bf16 v[100:103], a[188:191], a[244:247], v[100:103]
ds_read_b128 a[236:239], v4 offset:43008
s_waitcnt vmcnt(12)
s_waitcnt lgkmcnt(4)
v_mfma_f32_16x16x32_bf16 v[32:35], a[216:219], a[48:51], v[32:35]
v_mfma_f32_16x16x32_bf16 v[32:35], a[220:223], a[52:55], v[32:35]
ds_read_b128 a[240:243], v4 offset:35840
v_mfma_f32_16x16x32_bf16 v[36:39], a[216:219], a[120:123], v[36:39]
v_mfma_f32_16x16x32_bf16 v[36:39], a[220:223], a[124:127], v[36:39]
ds_read_b128 a[244:247], v4 offset:44032
s_waitcnt lgkmcnt(4)
v_mfma_f32_16x16x32_bf16 v[40:43], a[224:227], a[48:51], v[40:43]
v_mfma_f32_16x16x32_bf16 v[40:43], a[228:231], a[52:55], v[40:43]
ds_read_b128 a[216:219], v4 offset:36864
v_mfma_f32_16x16x32_bf16 v[44:47], a[224:227], a[120:123], v[44:47]
v_mfma_f32_16x16x32_bf16 v[44:47], a[228:231], a[124:127], v[44:47]
ds_read_b128 a[220:223], v4 offset:45056
s_waitcnt lgkmcnt(4)
v_mfma_f32_16x16x32_bf16 v[48:51], a[232:235], a[48:51], v[48:51]
v_mfma_f32_16x16x32_bf16 v[48:51], a[236:239], a[52:55], v[48:51]
ds_read_b128 a[224:227], v4 offset:37888
v_mfma_f32_16x16x32_bf16 v[52:55], a[232:235], a[120:123], v[52:55]
v_mfma_f32_16x16x32_bf16 v[52:55], a[236:239], a[124:127], v[52:55]
ds_read_b128 a[228:231], v4 offset:46080
s_waitcnt lgkmcnt(4)
v_mfma_f32_16x16x32_bf16 v[56:59], a[240:243], a[48:51], v[56:59]
v_mfma_f32_16x16x32_bf16 v[56:59], a[244:247], a[52:55], v[56:59]
ds_read_b128 a[232:235], v4 offset:38912
v_mfma_f32_16x16x32_bf16 v[60:63], a[240:243], a[120:123], v[60:63]
v_mfma_f32_16x16x32_bf16 v[60:63], a[244:247], a[124:127], v[60:63]
ds_read_b128 a[236:239], v4 offset:47104
s_waitcnt lgkmcnt(4)
v_mfma_f32_16x16x32_bf16 v[64:67], a[216:219], a[48:51], v[64:67]
v_mfma_f32_16x16x32_bf16 v[64:67], a[220:223], a[52:55], v[64:67]
ds_read_b128 a[240:243], v4 offset:39936
v_mfma_f32_16x16x32_bf16 v[68:71], a[216:219], a[120:123], v[68:71]
v_mfma_f32_16x16x32_bf16 v[68:71], a[220:223], a[124:127], v[68:71]
ds_read_b128 a[244:247], v4 offset:48128
s_waitcnt lgkmcnt(4)
v_mfma_f32_16x16x32_bf16 v[72:75], a[48:51], a[224:227], v[72:75]
v_mfma_f32_16x16x32_bf16 v[72:75], a[52:55], a[228:231], v[72:75]
ds_read_b128 a[216:219], v7 offset:32768
v_mfma_f32_16x16x32_bf16 v[76:79], a[120:123], a[224:227], v[76:79]
v_mfma_f32_16x16x32_bf16 v[76:79], a[124:127], a[228:231], v[76:79]
ds_read_b128 a[220:223], v7 offset:40960
s_waitcnt lgkmcnt(4)
v_mfma_f32_16x16x32_bf16 v[80:83], a[48:51], a[232:235], v[80:83]
v_mfma_f32_16x16x32_bf16 v[80:83], a[52:55], a[236:239], v[80:83]
ds_read_b128 a[224:227], v10 offset:32768
v_mfma_f32_16x16x32_bf16 v[84:87], a[120:123], a[232:235], v[84:87]
v_mfma_f32_16x16x32_bf16 v[84:87], a[124:127], a[236:239], v[84:87]
ds_read_b128 a[228:231], v10 offset:40960
s_waitcnt lgkmcnt(4)
v_mfma_f32_16x16x32_bf16 v[88:91], a[48:51], a[240:243], v[88:91]
v_mfma_f32_16x16x32_bf16 v[88:91], a[52:55], a[244:247], v[88:91]
ds_read_b128 a[232:235], v4 offset:49152
v_mfma_f32_16x16x32_bf16 v[92:95], a[120:123], a[240:243], v[92:95]
v_mfma_f32_16x16x32_bf16 v[92:95], a[124:127], a[244:247], v[92:95]
ds_read_b128 a[236:239], v4 offset:57344
s_waitcnt lgkmcnt(4)
v_mfma_f32_16x16x32_bf16 v[96:99], a[216:219], a[192:195], v[96:99]
ds_read_b128 a[240:243], v4 offset:50176
v_mfma_f32_16x16x32_bf16 v[96:99], a[220:223], a[196:199], v[96:99]
ds_read_b128 a[244:247], v4 offset:58368
s_waitcnt lgkmcnt(4)
v_mfma_f32_16x16x32_bf16 v[100:103], a[192:195], a[224:227], v[100:103]
ds_read_b128 a[216:219], v4 offset:51200
v_mfma_f32_16x16x32_bf16 v[100:103], a[196:199], a[228:231], v[100:103]
ds_read_b128 a[220:223], v4 offset:59392
s_waitcnt vmcnt(6)
s_waitcnt lgkmcnt(4)
v_mfma_f32_16x16x32_bf16 v[32:35], a[232:235], a[56:59], v[32:35]
v_mfma_f32_16x16x32_bf16 v[32:35], a[236:239], a[60:63], v[32:35]
ds_read_b128 a[224:227], v4 offset:52224
v_mfma_f32_16x16x32_bf16 v[36:39], a[232:235], a[128:131], v[36:39]
v_mfma_f32_16x16x32_bf16 v[36:39], a[236:239], a[132:135], v[36:39]
ds_read_b128 a[228:231], v4 offset:60416
s_waitcnt lgkmcnt(4)
v_mfma_f32_16x16x32_bf16 v[40:43], a[240:243], a[56:59], v[40:43]
v_mfma_f32_16x16x32_bf16 v[40:43], a[244:247], a[60:63], v[40:43]
ds_read_b128 a[232:235], v4 offset:53248
v_mfma_f32_16x16x32_bf16 v[44:47], a[240:243], a[128:131], v[44:47]
v_mfma_f32_16x16x32_bf16 v[44:47], a[244:247], a[132:135], v[44:47]
ds_read_b128 a[236:239], v4 offset:61440
s_waitcnt lgkmcnt(4)
v_mfma_f32_16x16x32_bf16 v[48:51], a[216:219], a[56:59], v[48:51]
v_mfma_f32_16x16x32_bf16 v[48:51], a[220:223], a[60:63], v[48:51]
ds_read_b128 a[240:243], v4 offset:54272
v_mfma_f32_16x16x32_bf16 v[52:55], a[216:219], a[128:131], v[52:55]
v_mfma_f32_16x16x32_bf16 v[52:55], a[220:223], a[132:135], v[52:55]
ds_read_b128 a[244:247], v4 offset:62464
s_waitcnt lgkmcnt(4)
v_mfma_f32_16x16x32_bf16 v[56:59], a[224:227], a[56:59], v[56:59]
v_mfma_f32_16x16x32_bf16 v[56:59], a[228:231], a[60:63], v[56:59]
ds_read_b128 a[216:219], v4 offset:55296
v_mfma_f32_16x16x32_bf16 v[60:63], a[224:227], a[128:131], v[60:63]
v_mfma_f32_16x16x32_bf16 v[60:63], a[228:231], a[132:135], v[60:63]
ds_read_b128 a[220:223], v4 offset:63488
s_waitcnt lgkmcnt(4)
v_mfma_f32_16x16x32_bf16 v[64:67], a[232:235], a[56:59], v[64:67]
v_mfma_f32_16x16x32_bf16 v[64:67], a[236:239], a[60:63], v[64:67]
ds_read_b128 a[224:227], v4 offset:56320
v_mfma_f32_16x16x32_bf16 v[68:71], a[232:235], a[128:131], v[68:71]
v_mfma_f32_16x16x32_bf16 v[68:71], a[236:239], a[132:135], v[68:71]
ds_read_b128 a[228:231], v4 offset:64512
s_waitcnt lgkmcnt(4)
v_mfma_f32_16x16x32_bf16 v[72:75], a[56:59], a[240:243], v[72:75]
v_mfma_f32_16x16x32_bf16 v[72:75], a[60:63], a[244:247], v[72:75]
ds_read_b128 a[232:235], v7 offset:49152
v_mfma_f32_16x16x32_bf16 v[76:79], a[128:131], a[240:243], v[76:79]
v_mfma_f32_16x16x32_bf16 v[76:79], a[132:135], a[244:247], v[76:79]
ds_read_b128 a[236:239], v7 offset:57344
s_waitcnt lgkmcnt(4)
v_mfma_f32_16x16x32_bf16 v[80:83], a[56:59], a[216:219], v[80:83]
v_mfma_f32_16x16x32_bf16 v[80:83], a[60:63], a[220:223], v[80:83]
ds_read_b128 a[240:243], v10 offset:49152
v_mfma_f32_16x16x32_bf16 v[84:87], a[128:131], a[216:219], v[84:87]
v_mfma_f32_16x16x32_bf16 v[84:87], a[132:135], a[220:223], v[84:87]
ds_read_b128 a[244:247], v10 offset:57344
s_waitcnt lgkmcnt(4)
v_mfma_f32_16x16x32_bf16 v[88:91], a[56:59], a[224:227], v[88:91]
v_mfma_f32_16x16x32_bf16 v[88:91], a[60:63], a[228:231], v[88:91]
ds_read_b128 a[216:219], v5 offset:0
v_mfma_f32_16x16x32_bf16 v[92:95], a[128:131], a[224:227], v[92:95]
v_mfma_f32_16x16x32_bf16 v[92:95], a[132:135], a[228:231], v[92:95]
ds_read_b128 a[220:223], v5 offset:8192
s_waitcnt lgkmcnt(4)
v_mfma_f32_16x16x32_bf16 v[96:99], a[232:235], a[200:203], v[96:99]
ds_read_b128 a[224:227], v5 offset:1024
v_mfma_f32_16x16x32_bf16 v[96:99], a[236:239], a[204:207], v[96:99]
ds_read_b128 a[228:231], v5 offset:9216
s_waitcnt lgkmcnt(4)
v_mfma_f32_16x16x32_bf16 v[100:103], a[200:203], a[240:243], v[100:103]
ds_read_b128 a[232:235], v5 offset:2048
v_mfma_f32_16x16x32_bf16 v[100:103], a[204:207], a[244:247], v[100:103]
ds_read_b128 a[236:239], v5 offset:10240
s_waitcnt vmcnt(0)
s_waitcnt lgkmcnt(4)
v_mfma_f32_16x16x32_bf16 v[32:35], a[216:219], a[64:67], v[32:35]
v_mfma_f32_16x16x32_bf16 v[32:35], a[220:223], a[68:71], v[32:35]
ds_read_b128 a[240:243], v5 offset:3072
v_mfma_f32_16x16x32_bf16 v[36:39], a[216:219], a[136:139], v[36:39]
v_mfma_f32_16x16x32_bf16 v[36:39], a[220:223], a[140:143], v[36:39]
ds_read_b128 a[244:247], v5 offset:11264
s_waitcnt lgkmcnt(4)
v_mfma_f32_16x16x32_bf16 v[40:43], a[224:227], a[64:67], v[40:43]
v_mfma_f32_16x16x32_bf16 v[40:43], a[228:231], a[68:71], v[40:43]
ds_read_b128 a[216:219], v5 offset:4096
v_mfma_f32_16x16x32_bf16 v[44:47], a[224:227], a[136:139], v[44:47]
v_mfma_f32_16x16x32_bf16 v[44:47], a[228:231], a[140:143], v[44:47]
ds_read_b128 a[220:223], v5 offset:12288
s_waitcnt lgkmcnt(4)
v_mfma_f32_16x16x32_bf16 v[48:51], a[232:235], a[64:67], v[48:51]
v_mfma_f32_16x16x32_bf16 v[48:51], a[236:239], a[68:71], v[48:51]
ds_read_b128 a[224:227], v5 offset:5120
v_mfma_f32_16x16x32_bf16 v[52:55], a[232:235], a[136:139], v[52:55]
v_mfma_f32_16x16x32_bf16 v[52:55], a[236:239], a[140:143], v[52:55]
ds_read_b128 a[228:231], v5 offset:13312
s_waitcnt lgkmcnt(4)
v_mfma_f32_16x16x32_bf16 v[56:59], a[240:243], a[64:67], v[56:59]
v_mfma_f32_16x16x32_bf16 v[56:59], a[244:247], a[68:71], v[56:59]
ds_read_b128 a[232:235], v5 offset:6144
v_mfma_f32_16x16x32_bf16 v[60:63], a[240:243], a[136:139], v[60:63]
v_mfma_f32_16x16x32_bf16 v[60:63], a[244:247], a[140:143], v[60:63]
ds_read_b128 a[236:239], v5 offset:14336
s_waitcnt lgkmcnt(4)
v_mfma_f32_16x16x32_bf16 v[64:67], a[216:219], a[64:67], v[64:67]
v_mfma_f32_16x16x32_bf16 v[64:67], a[220:223], a[68:71], v[64:67]
ds_read_b128 a[240:243], v5 offset:7168
v_mfma_f32_16x16x32_bf16 v[68:71], a[216:219], a[136:139], v[68:71]
v_mfma_f32_16x16x32_bf16 v[68:71], a[220:223], a[140:143], v[68:71]
ds_read_b128 a[244:247], v5 offset:15360
s_waitcnt lgkmcnt(4)
v_mfma_f32_16x16x32_bf16 v[72:75], a[64:67], a[224:227], v[72:75]
v_mfma_f32_16x16x32_bf16 v[72:75], a[68:71], a[228:231], v[72:75]
ds_read_b128 a[216:219], v8 offset:0
v_mfma_f32_16x16x32_bf16 v[76:79], a[136:139], a[224:227], v[76:79]
v_mfma_f32_16x16x32_bf16 v[76:79], a[140:143], a[228:231], v[76:79]
ds_read_b128 a[220:223], v8 offset:8192
s_waitcnt lgkmcnt(4)
v_mfma_f32_16x16x32_bf16 v[80:83], a[64:67], a[232:235], v[80:83]
v_mfma_f32_16x16x32_bf16 v[80:83], a[68:71], a[236:239], v[80:83]
ds_read_b128 a[224:227], v11 offset:0
v_mfma_f32_16x16x32_bf16 v[84:87], a[136:139], a[232:235], v[84:87]
v_mfma_f32_16x16x32_bf16 v[84:87], a[140:143], a[236:239], v[84:87]
ds_read_b128 a[228:231], v11 offset:8192
s_waitcnt lgkmcnt(4)
v_mfma_f32_16x16x32_bf16 v[88:91], a[64:67], a[240:243], v[88:91]
v_mfma_f32_16x16x32_bf16 v[88:91], a[68:71], a[244:247], v[88:91]
v_mfma_f32_16x16x32_bf16 v[92:95], a[136:139], a[240:243], v[92:95]
v_mfma_f32_16x16x32_bf16 v[92:95], a[140:143], a[244:247], v[92:95]
s_waitcnt lgkmcnt(2)
v_mfma_f32_16x16x32_bf16 v[96:99], a[216:219], a[208:211], v[96:99]
v_mfma_f32_16x16x32_bf16 v[96:99], a[220:223], a[212:215], v[96:99]
s_waitcnt lgkmcnt(0)
v_mfma_f32_16x16x32_bf16 v[100:103], a[208:211], a[224:227], v[100:103]
v_mfma_f32_16x16x32_bf16 v[100:103], a[212:215], a[228:231], v[100:103]
v_cvt_pk_bf16_f32 v116, v52, v53
v_cvt_pk_bf16_f32 v117, v54, v55
v_cvt_pk_bf16_f32 v120, v60, v61
v_cvt_pk_bf16_f32 v121, v62, v63
v_cvt_pk_bf16_f32 v160, v68, v69
v_cvt_pk_bf16_f32 v161, v70, v71
v_cvt_pk_bf16_f32 v126, v76, v77
v_cvt_pk_bf16_f32 v127, v78, v79
v_cvt_pk_bf16_f32 v132, v84, v85
v_cvt_pk_bf16_f32 v133, v86, v87
v_cvt_pk_bf16_f32 v138, v92, v93
v_cvt_pk_bf16_f32 v139, v94, v95
v_cvt_pk_bf16_f32 v156, v96, v97
v_cvt_pk_bf16_f32 v157, v98, v99
v_cvt_pk_bf16_f32 v158, v100, v101
v_cvt_pk_bf16_f32 v159, v102, v103
v_lshlrev_b32 v14, 3, v1
s_mul_i32 s31, s4, 3072
s_add_u32 s32, s31, 147456
v_add_u32 v15, s32, v14
s_lshl_b32 s33, s29, 9
s_add_u32 s33, s33, 147456
v_add_u32 v16, s33, v14
s_cmp_eq_u32 s4, 3
s_cbranch_scc1 L_a1_noxch
ds_write_b64 v16, v[156:157]
ds_write_b64 v16, v[158:159] offset:1536
ds_write_b64 v15, v[116:117] offset:3072
ds_write_b64 v15, v[120:121] offset:3584
ds_write_b64 v15, v[160:161] offset:4096
ds_write_b64 v15, v[126:127] offset:4608
ds_write_b64 v15, v[132:133] offset:5120
ds_write_b64 v15, v[138:139] offset:5632
L_a1_noxch:
v_cvt_pk_bf16_f32 v110, v48, v49
v_cvt_pk_bf16_f32 v111, v50, v51
v_cvt_pk_bf16_f32 v114, v56, v57
v_cvt_pk_bf16_f32 v115, v58, v59
v_cvt_pk_bf16_f32 v124, v72, v73
v_cvt_pk_bf16_f32 v125, v74, v75
v_cvt_pk_bf16_f32 v130, v80, v81
v_cvt_pk_bf16_f32 v131, v82, v83
v_cvt_pk_bf16_f32 v136, v88, v89
v_cvt_pk_bf16_f32 v137, v90, v91
v_cvt_pk_bf16_f32 v140, v32, v33
v_cvt_pk_bf16_f32 v141, v34, v35
v_cvt_pk_bf16_f32 v146, v40, v41
v_cvt_pk_bf16_f32 v147, v42, v43
v_cvt_pk_bf16_f32 v142, v64, v65
v_cvt_pk_bf16_f32 v145, v66, v67
v_mov_b32 v143, 0
v_mov_b32 v144, 0
v_mov_b32 v112, 0
v_mov_b32 v113, 0
s_nop 0
v_permlane16_swap_b32 v142, v112
v_permlane16_swap_b32 v145, v113
v_cvt_pk_bf16_f32 v148, v36, v37
v_cvt_pk_bf16_f32 v149, v38, v39
v_cvt_pk_bf16_f32 v154, v44, v45
v_cvt_pk_bf16_f32 v155, v46, v47
v_cvt_pk_bf16_f32 v150, v68, v69
v_cvt_pk_bf16_f32 v153, v70, v71
v_mov_b32 v151, 0
v_mov_b32 v152, 0
v_mov_b32 v118, 0
v_mov_b32 v119, 0
s_nop 0
v_permlane16_swap_b32 v150, v118
v_permlane16_swap_b32 v153, v119
v_add_u32 v17, 16, v12
v_add_u32 v18, 32, v12
v_cmp_gt_u32 vcc, 16, v1
s_nop 1
v_cndmask_b32 v17, v18, v17, vcc
v_lshlrev_b32 v17, 3, v17
v_add_u32 v17, s32, v17
s_waitcnt lgkmcnt(0)
s_barrier
s_and_b32 s37, s6, 7
s_mul_i32 s37, s37, 92160
s_mul_i32 s38, s4, 23552
s_add_u32 s37, s37, s38
s_add_u32 s37, s37, 2621440
ds_read_b64 v[104:105], v15
ds_read_b64 v[108:109], v15 offset:512
ds_read_b64 v[106:107], v17 offset:1024
ds_read_b64 v[122:123], v15 offset:1536
s_add_u32 m0, s38, 0
s_add_u32 s40, s37, 0
buffer_load_dwordx4 v2, s[8:11], s40 offen offset:0 lds
ds_read_b64 v[128:129], v15 offset:2048
ds_read_b64 v[134:135], v15 offset:2560
v_mfma_f32_16x16x32_bf16 v[32:35], v[110:113], v[148:151], 0
v_mfma_f32_16x16x32_bf16 v[36:39], v[116:119], v[148:151], 0
v_mfma_f32_16x16x32_bf16 v[40:43], v[112:115], v[152:155], 0
v_mfma_f32_16x16x32_bf16 v[44:47], v[118:121], v[152:155], 0
s_waitcnt lgkmcnt(0)
v_mfma_f32_16x16x32_bf16 v[48:51], v[104:107], v[140:143], 0
v_mfma_f32_16x16x32_bf16 v[52:55], v[110:113], v[140:143], 0
v_mfma_f32_16x16x32_bf16 v[56:59], v[106:109], v[144:147], 0
v_mfma_f32_16x16x32_bf16 v[60:63], v[112:115], v[144:147], 0
v_mov_b32 v18, 0xff61b1e6
buffer_load_dwordx4 v2, s[8:11], s40 offen offset:1024 lds
s_mov_b32 s34, 0x3eae1a93
v_cndmask_b32 v32, v18, v32, s[44:45]
v_cndmask_b32 v40, v18, v40, s[44:45]
v_cndmask_b32 v48, v18, v48, s[60:61]
s_nop 0
v_cndmask_b32 v56, v18, v56, s[60:61]
v_cndmask_b32 v33, v18, v33, s[46:47]
v_cndmask_b32 v41, v18, v41, s[46:47]
v_cndmask_b32 v49, v18, v49, s[62:63]
v_cndmask_b32 v57, v18, v57, s[62:63]
v_cndmask_b32 v34, v18, v34, s[48:49]
v_cndmask_b32 v42, v18, v42, s[48:49]
v_cndmask_b32 v50, v18, v50, s[64:65]
buffer_load_dwordx4 v2, s[8:11], s40 offen offset:2048 lds
v_cndmask_b32 v58, v18, v58, s[64:65]
v_cndmask_b32 v35, v18, v35, s[50:51]
v_cndmask_b32 v43, v18, v43, s[50:51]
v_cndmask_b32 v51, v18, v51, s[66:67]
v_cndmask_b32 v59, v18, v59, s[66:67]
v_cndmask_b32 v36, v18, v36, s[52:53]
v_cndmask_b32 v44, v18, v44, s[52:53]
v_cndmask_b32 v52, v18, v52, s[52:53]
v_cndmask_b32 v60, v18, v60, s[52:53]
v_cndmask_b32 v37, v18, v37, s[54:55]
v_cndmask_b32 v45, v18, v45, s[54:55]
v_cndmask_b32 v53, v18, v53, s[54:55]
buffer_load_dwordx4 v2, s[8:11], s40 offen offset:3072 lds
v_cndmask_b32 v61, v18, v61, s[54:55]
v_cndmask_b32 v38, v18, v38, s[56:57]
v_cndmask_b32 v46, v18, v46, s[56:57]
v_cndmask_b32 v54, v18, v54, s[56:57]
v_cndmask_b32 v62, v18, v62, s[56:57]
v_cndmask_b32 v39, v18, v39, s[58:59]
v_cndmask_b32 v47, v18, v47, s[58:59]
v_cndmask_b32 v55, v18, v55, s[58:59]
v_cndmask_b32 v63, v18, v63, s[58:59]
v_max3_f32 v20, v32, v33, v34
v_max3_f32 v21, v40, v41, v42
v_max3_f32 v22, v48, v49, v50
s_add_u32 m0, s38, 4096
s_add_u32 s40, s37, 4096
buffer_load_dwordx4 v2, s[8:11], s40 offen offset:0 lds
v_max3_f32 v23, v56, v57, v58
v_max3_f32 v20, v20, v35, v36
v_max3_f32 v21, v21, v43, v44
v_max3_f32 v22, v22, v51, v52
v_max3_f32 v23, v23, v59, v60
v_max3_f32 v20, v20, v37, v38
v_max3_f32 v21, v21, v45, v46
v_max3_f32 v22, v22, v53, v54
v_max3_f32 v23, v23, v61, v62
v_max_f32 v20, v20, v39
v_max_f32 v21, v21, v47
v_max_f32 v22, v22, v55
buffer_load_dwordx4 v2, s[8:11], s40 offen offset:1024 lds
v_max_f32 v23, v23, v63
v_mov_b32 v24, v20
v_mov_b32 v25, v21
v_mov_b32 v26, v22
v_mov_b32 v27, v23
v_permlane16_swap_b32 v20, v24
v_permlane16_swap_b32 v21, v25
v_permlane16_swap_b32 v22, v26
v_permlane16_swap_b32 v23, v27
v_max_f32 v20, v20, v24
v_max_f32 v21, v21, v25
v_max_f32 v22, v22, v26
buffer_load_dwordx4 v2, s[8:11], s40 offen offset:2048 lds
v_max_f32 v23, v23, v27
v_mov_b32 v24, v20
v_mov_b32 v25, v21
v_mov_b32 v26, v22
v_mov_b32 v27, v23
v_permlane32_swap_b32 v20, v24
v_permlane32_swap_b32 v21, v25
v_permlane32_swap_b32 v22, v26
v_permlane32_swap_b32 v23, v27
v_max_f32 v20, v20, v24
v_max_f32 v21, v21, v25
v_max_f32 v22, v22, v26
buffer_load_dwordx4 v2, s[8:11], s40 offen offset:3072 lds
v_max_f32 v23, v23, v27
v_mul_f32 v20, s34, v20
v_mul_f32 v21, s34, v21
v_mul_f32 v22, s34, v22
v_mul_f32 v23, s34, v23
v_fma_f32 v32, v32, s34, -v20
v_fma_f32 v40, v40, s34, -v21
v_fma_f32 v48, v48, s34, -v22
v_fma_f32 v56, v56, s34, -v23
v_exp_f32 v32, v32
v_exp_f32 v40, v40
v_exp_f32 v48, v48
s_add_u32 m0, s38, 8192
s_add_u32 s40, s37, 8192
buffer_load_dwordx4 v2, s[8:11], s40 offen offset:0 lds
v_exp_f32 v56, v56
v_fma_f32 v33, v33, s34, -v20
v_fma_f32 v41, v41, s34, -v21
v_fma_f32 v49, v49, s34, -v22
v_fma_f32 v57, v57, s34, -v23
v_exp_f32 v33, v33
v_exp_f32 v41, v41
v_exp_f32 v49, v49
v_exp_f32 v57, v57
v_fma_f32 v34, v34, s34, -v20
v_fma_f32 v42, v42, s34, -v21
v_fma_f32 v50, v50, s34, -v22
buffer_load_dwordx4 v2, s[8:11], s40 offen offset:1024 lds
v_fma_f32 v58, v58, s34, -v23
v_exp_f32 v34, v34
v_exp_f32 v42, v42
v_exp_f32 v50, v50
v_exp_f32 v58, v58
v_fma_f32 v35, v35, s34, -v20
v_fma_f32 v43, v43, s34, -v21
v_fma_f32 v51, v51, s34, -v22
v_fma_f32 v59, v59, s34, -v23
v_exp_f32 v35, v35
v_exp_f32 v43, v43
v_exp_f32 v51, v51
buffer_load_dwordx4 v2, s[8:11], s40 offen offset:2048 lds
v_exp_f32 v59, v59
v_fma_f32 v36, v36, s34, -v20
v_fma_f32 v44, v44, s34, -v21
v_fma_f32 v52, v52, s34, -v22
v_fma_f32 v60, v60, s34, -v23
v_exp_f32 v36, v36
v_exp_f32 v44, v44
v_exp_f32 v52, v52
v_exp_f32 v60, v60
v_fma_f32 v37, v37, s34, -v20
v_fma_f32 v45, v45, s34, -v21
v_fma_f32 v53, v53, s34, -v22
buffer_load_dwordx4 v2, s[8:11], s40 offen offset:3072 lds
v_fma_f32 v61, v61, s34, -v23
v_exp_f32 v37, v37
v_exp_f32 v45, v45
v_exp_f32 v53, v53
v_exp_f32 v61, v61
v_fma_f32 v38, v38, s34, -v20
v_fma_f32 v46, v46, s34, -v21
v_fma_f32 v54, v54, s34, -v22
v_fma_f32 v62, v62, s34, -v23
v_exp_f32 v38, v38
v_exp_f32 v46, v46
v_exp_f32 v54, v54
s_add_u32 m0, s38, 12288
s_add_u32 s40, s37, 12288
buffer_load_dwordx4 v2, s[8:11], s40 offen offset:0 lds
v_exp_f32 v62, v62
v_fma_f32 v39, v39, s34, -v20
v_fma_f32 v47, v47, s34, -v21
v_fma_f32 v55, v55, s34, -v22
v_fma_f32 v63, v63, s34, -v23
v_exp_f32 v39, v39
v_exp_f32 v47, v47
v_exp_f32 v55, v55
v_exp_f32 v63, v63
v_add_f32 v28, v32, v33
v_add_f32 v29, v40, v41
v_add_f32 v30, v48, v49
buffer_load_dwordx4 v2, s[8:11], s40 offen offset:1024 lds
v_add_f32 v31, v56, v57
v_add_f32 v28, v28, v34
v_add_f32 v29, v29, v42
v_add_f32 v30, v30, v50
v_add_f32 v31, v31, v58
v_add_f32 v28, v28, v35
v_add_f32 v29, v29, v43
v_add_f32 v30, v30, v51
v_add_f32 v31, v31, v59
v_add_f32 v28, v28, v36
v_add_f32 v29, v29, v44
v_add_f32 v30, v30, v52
buffer_load_dwordx4 v2, s[8:11], s40 offen offset:2048 lds
v_add_f32 v31, v31, v60
v_add_f32 v28, v28, v37
v_add_f32 v29, v29, v45
v_add_f32 v30, v30, v53
v_add_f32 v31, v31, v61
v_add_f32 v28, v28, v38
v_add_f32 v29, v29, v46
v_add_f32 v30, v30, v54
v_add_f32 v31, v31, v62
v_add_f32 v28, v28, v39
v_add_f32 v29, v29, v47
v_add_f32 v30, v30, v55
buffer_load_dwordx4 v2, s[8:11], s40 offen offset:3072 lds
v_add_f32 v31, v31, v63
v_mov_b32 v24, v28
v_mov_b32 v25, v29
v_mov_b32 v26, v30
v_mov_b32 v27, v31
v_permlane16_swap_b32 v28, v24
v_permlane16_swap_b32 v29, v25
v_permlane16_swap_b32 v30, v26
v_permlane16_swap_b32 v31, v27
v_add_f32 v28, v28, v24
v_add_f32 v29, v29, v25
v_add_f32 v30, v30, v26
s_add_u32 m0, s38, 16384
s_add_u32 s40, s37, 16384
buffer_load_dwordx4 v2, s[8:11], s40 offen offset:0 lds
v_add_f32 v31, v31, v27
v_mov_b32 v24, v28
v_mov_b32 v25, v29
v_mov_b32 v26, v30
v_mov_b32 v27, v31
v_permlane32_swap_b32 v28, v24
v_permlane32_swap_b32 v29, v25
v_permlane32_swap_b32 v30, v26
v_permlane32_swap_b32 v31, v27
v_add_f32 v28, v28, v24
v_add_f32 v29, v29, v25
v_add_f32 v30, v30, v26
buffer_load_dwordx4 v2, s[8:11], s40 offen offset:1024 lds
v_add_f32 v31, v31, v27
v_rcp_f32 v28, v28
v_rcp_f32 v29, v29
v_rcp_f32 v30, v30
v_rcp_f32 v31, v31
v_mul_f32 v32, v32, v28
v_mul_f32 v40, v40, v29
v_mul_f32 v48, v48, v30
v_mul_f32 v56, v56, v31
v_mul_f32 v33, v33, v28
v_mul_f32 v41, v41, v29
v_mul_f32 v49, v49, v30
buffer_load_dwordx4 v2, s[8:11], s40 offen offset:2048 lds
v_mul_f32 v57, v57, v31
v_mul_f32 v34, v34, v28
v_mul_f32 v42, v42, v29
v_mul_f32 v50, v50, v30
v_mul_f32 v58, v58, v31
v_mul_f32 v35, v35, v28
v_mul_f32 v43, v43, v29
v_mul_f32 v51, v51, v30
v_mul_f32 v59, v59, v31
v_mul_f32 v36, v36, v28
v_mul_f32 v44, v44, v29
v_mul_f32 v52, v52, v30
buffer_load_dwordx4 v2, s[8:11], s40 offen offset:3072 lds
v_mul_f32 v60, v60, v31
v_mul_f32 v37, v37, v28
v_mul_f32 v45, v45, v29
v_mul_f32 v53, v53, v30
v_mul_f32 v61, v61, v31
v_mul_f32 v38, v38, v28
v_mul_f32 v46, v46, v29
v_mul_f32 v54, v54, v30
v_mul_f32 v62, v62, v31
v_mul_f32 v39, v39, v28
v_mul_f32 v47, v47, v29
v_mul_f32 v55, v55, v30
s_add_u32 m0, s38, 20480
s_add_u32 s40, s37, 20480
buffer_load_dwordx4 v2, s[8:11], s40 offen offset:0 lds
v_mul_f32 v63, v63, v31
v_cvt_pk_bf16_f32 v64, v32, v33
v_cvt_pk_bf16_f32 v65, v34, v35
v_cvt_pk_bf16_f32 v66, v36, v37
v_cvt_pk_bf16_f32 v67, v38, v39
v_cvt_pk_bf16_f32 v68, v40, v41
v_cvt_pk_bf16_f32 v69, v42, v43
v_cvt_pk_bf16_f32 v70, v44, v45
v_cvt_pk_bf16_f32 v71, v46, v47
v_cvt_pk_bf16_f32 v72, v48, v49
v_cvt_pk_bf16_f32 v73, v50, v51
v_cvt_pk_bf16_f32 v74, v52, v53
buffer_load_dwordx4 v2, s[8:11], s40 offen offset:1024 lds
v_cvt_pk_bf16_f32 v75, v54, v55
v_cvt_pk_bf16_f32 v76, v56, v57
v_cvt_pk_bf16_f32 v77, v58, v59
v_cvt_pk_bf16_f32 v78, v60, v61
v_cvt_pk_bf16_f32 v79, v62, v63
v_mfma_f32_16x16x32_bf16 v[80:83], v[124:127], v[64:67], 0
v_mfma_f32_16x16x32_bf16 v[84:87], v[136:139], v[64:67], 0
v_mfma_f32_16x16x32_bf16 v[88:91], v[130:133], v[68:71], 0
v_mfma_f32_16x16x32_bf16 v[92:95], v[136:139], v[68:71], 0
v_mfma_f32_16x16x32_bf16 v[96:99], v[122:125], v[72:75], 0
v_mfma_f32_16x16x32_bf16 v[100:103], v[134:137], v[72:75], 0
v_mfma_f32_16x16x32_bf16 v[164:167], v[128:131], v[76:79], 0
buffer_load_dwordx4 v2, s[8:11], s40 offen offset:2048 lds
v_mfma_f32_16x16x32_bf16 v[168:171], v[134:137], v[76:79], 0
v_lshlrev_b32 v14, 4, v12
v_mov_b32 v15, 2146435072
v_cmp_gt_u32 vcc, 16, v1
s_nop 1
v_cndmask_b32 v14, v15, v14, vcc
s_add_u32 s26, s24, s72
s_lshl_b32 s27, s21, 10
s_add_u32 s27, s27, s26
s_lshr_b32 s28, s21, 1
s_lshl_b32 s28, s28, 8
s_and_b32 s30, s21, 1
s_lshl_b32 s30, s30, 3
s_add_u32 s28, s28, s30
s_add_u32 s28, s28, 16384
s_add_u32 s28, s28, s26
s_add_u32 s30, s27, 18432
s_add_u32 s31, s28, 18432
v_cvt_pk_bf16_f32 v180, v80, v81
v_cvt_pk_bf16_f32 v181, v82, v83
v_cvt_pk_bf16_f32 v182, v88, v89
v_cvt_pk_bf16_f32 v183, v90, v91
v_cvt_pk_bf16_f32 v184, v84, v85
v_cvt_pk_bf16_f32 v185, v94, v95
buffer_store_dwordx4 v[180:183], v2, s[8:11], s30 offen sc1
buffer_store_dwordx2 v[184:185], v14, s[8:11], s31 offen sc1
v_cvt_pk_bf16_f32 v172, v96, v97
v_cvt_pk_bf16_f32 v173, v98, v99
v_cvt_pk_bf16_f32 v174, v164, v165
v_cvt_pk_bf16_f32 v175, v166, v167
v_cvt_pk_bf16_f32 v176, v100, v101
v_cvt_pk_bf16_f32 v177, v170, v171
buffer_store_dwordx4 v[172:175], v2, s[8:11], s27 offen sc1
buffer_store_dwordx2 v[176:177], v14, s[8:11], s28 offen sc1
s_lshl_b32 s26, s20, 2
s_add_u32 s26, s26, s4
s_lshl_b32 s26, s26, 4
s_add_u32 s26, s26, s21
s_lshl_b32 s26, s26, 2
s_add_u32 s26, s26, s77
s_add_u32 s26, s26, 16384
v_mov_b32 v14, 2146435072
v_cmp_eq_u32 vcc, 0, v1
s_nop 1
v_cndmask_b32 v14, v14, 0, vcc
v_mov_b32 v15, 1
s_waitcnt vmcnt(0)
buffer_store_dword v15, v14, s[8:11], s26 offen sc1
s_barrier
s_lshr_b32 s20, s6, 3
s_lshl_b32 s21, s5, 2
s_add_u32 s20, s20, s21
s_lshl_b32 s20, s20, 2
s_add_u32 s20, s20, s4
s_and_b32 s21, s6, 7
s_mul_i32 s24, s20, 18432
s_add_u32 s25, s24, s72
s_mul_i32 s26, s21, 2304
s_add_u32 s26, s26, s24
s_add_u32 s27, s26, s71
v_and_b32 v6, 15, v1
v_lshrrev_b32 v7, 4, v1
v_lshlrev_b32 v8, 4, v6
v_lshl_add_u32 v8, v7, 3, v8
v_add_u32 v8, 2048, v8
v_mov_b32 v9, 2146435072
v_cmp_gt_u32 vcc, 32, v1
s_nop 1
v_cndmask_b32 v4, v9, v8, vcc
v_add_u32 v5, 0x10000, v2
buffer_load_dwordx4 v[56:59], v2, s[8:11], s27 offen sc1
buffer_load_dwordx4 v[60:63], v2, s[8:11], s27 offen offset:1024 sc1
buffer_load_dwordx2 v[64:65], v4, s[8:11], s27 offen sc1
s_lshr_b32 s22, s20, 1
s_lshl_b32 s22, s22, 6
s_add_u32 s22, s22, s77
s_add_u32 s22, s22, 16384
v_lshlrev_b32 v10, 2, v6
ds_read_b128 a[216:219], v2 offset:0
ds_read_b128 a[220:223], v2 offset:5120
ds_read_b128 a[224:227], v2 offset:1024
ds_read_b128 a[228:231], v2 offset:6144
ds_read_b128 a[232:235], v2 offset:2048
ds_read_b128 a[236:239], v2 offset:7168
s_mov_b32 s52, 0
buffer_load_dword v253, v10, s[8:11], s22 offen sc1
s_sleep 2
buffer_load_dword v254, v10, s[8:11], s22 offen sc1
s_sleep 2
L_poll3:
buffer_load_dword v255, v10, s[8:11], s22 offen sc1
s_waitcnt vmcnt(2)
v_cmp_ne_u32 vcc, 0, v253
s_add_u32 s52, s52, 1
s_cmp_eq_u64 vcc, exec
s_cbranch_scc1 L_got3
buffer_load_dword v253, v10, s[8:11], s22 offen sc1
s_waitcnt vmcnt(2)
v_cmp_ne_u32 vcc, 0, v254
s_add_u32 s52, s52, 1
s_cmp_eq_u64 vcc, exec
s_cbranch_scc1 L_got3
buffer_load_dword v254, v10, s[8:11], s22 offen sc1
s_waitcnt vmcnt(2)
v_cmp_ne_u32 vcc, 0, v255
s_add_u32 s52, s52, 1
s_cmp_eq_u64 vcc, exec
s_cbranch_scc1 L_got3
s_cmp_lt_u32 s52, 0x200000
s_cbranch_scc1 L_poll3
L_got3:
buffer_load_dwordx4 a[0:3], v2, s[8:11], s25 offen offset:0 sc1
buffer_load_dwordx4 a[4:7], v2, s[8:11], s25 offen offset:1024 sc1
buffer_load_dwordx4 a[8:11], v2, s[8:11], s25 offen offset:2048 sc1
buffer_load_dwordx4 a[12:15], v2, s[8:11], s25 offen offset:3072 sc1
s_add_u32 s25, s25, 4096
buffer_load_dwordx4 a[16:19], v2, s[8:11], s25 offen offset:0 sc1
buffer_load_dwordx4 a[20:23], v2, s[8:11], s25 offen offset:1024 sc1
buffer_load_dwordx4 a[24:27], v2, s[8:11], s25 offen offset:2048 sc1
buffer_load_dwordx4 a[28:31], v2, s[8:11], s25 offen offset:3072 sc1
s_add_u32 s25, s25, 4096
buffer_load_dwordx4 a[32:35], v2, s[8:11], s25 offen offset:0 sc1
buffer_load_dwordx4 a[36:39], v2, s[8:11], s25 offen offset:1024 sc1
buffer_load_dwordx4 a[40:43], v2, s[8:11], s25 offen offset:2048 sc1
buffer_load_dwordx4 a[44:47], v2, s[8:11], s25 offen offset:3072 sc1
s_waitcnt vmcnt(10)
s_waitcnt lgkmcnt(4)
v_mfma_f32_16x16x32_bf16 v[32:35], a[216:219], a[0:3], 0
ds_read_b128 a[240:243], v2 offset:3072
v_mfma_f32_16x16x32_bf16 v[32:35], a[220:223], a[4:7], v[32:35]
ds_read_b128 a[244:247], v2 offset:8192
s_add_u32 s25, s25, 4096
buffer_load_dwordx4 a[48:51], v2, s[8:11], s25 offen offset:0 sc1
s_waitcnt lgkmcnt(4)
v_mfma_f32_16x16x32_bf16 v[36:39], a[224:227], a[0:3], 0
ds_read_b128 a[216:219], v2 offset:4096
v_mfma_f32_16x16x32_bf16 v[36:39], a[228:231], a[4:7], v[36:39]
ds_read_b128 a[220:223], v2 offset:9216
s_waitcnt lgkmcnt(4)
v_mfma_f32_16x16x32_bf16 v[40:43], a[232:235], a[0:3], 0
ds_read_b128 a[224:227], v2 offset:10240
v_mfma_f32_16x16x32_bf16 v[40:43], a[236:239], a[4:7], v[40:43]
ds_read_b128 a[228:231], v2 offset:15360
buffer_load_dwordx4 a[52:55], v2, s[8:11], s25 offen offset:1024 sc1
s_waitcnt lgkmcnt(4)
v_mfma_f32_16x16x32_bf16 v[44:47], a[240:243], a[0:3], 0
ds_read_b128 a[232:235], v2 offset:11264
v_mfma_f32_16x16x32_bf16 v[44:47], a[244:247], a[4:7], v[44:47]
ds_read_b128 a[236:239], v2 offset:16384
s_waitcnt lgkmcnt(4)
v_mfma_f32_16x16x32_bf16 v[48:51], a[216:219], a[0:3], 0
ds_read_b128 a[240:243], v2 offset:12288
v_mfma_f32_16x16x32_bf16 v[48:51], a[220:223], a[4:7], v[48:51]
ds_read_b128 a[244:247], v2 offset:17408
buffer_load_dwordx4 a[56:59], v2, s[8:11], s25 offen offset:2048 sc1
s_waitcnt vmcnt(11)
s_waitcnt lgkmcnt(4)
v_mfma_f32_16x16x32_bf16 v[32:35], a[224:227], a[8:11], v[32:35]
ds_read_b128 a[216:219], v2 offset:13312
v_mfma_f32_16x16x32_bf16 v[32:35], a[228:231], a[12:15], v[32:35]
ds_read_b128 a[220:223], v2 offset:18432
s_waitcnt lgkmcnt(4)
v_mfma_f32_16x16x32_bf16 v[36:39], a[232:235], a[8:11], v[36:39]
ds_read_b128 a[224:227], v2 offset:14336
v_mfma_f32_16x16x32_bf16 v[36:39], a[236:239], a[12:15], v[36:39]
ds_read_b128 a[228:231], v2 offset:19456
buffer_load_dwordx4 a[60:63], v2, s[8:11], s25 offen offset:3072 sc1
s_waitcnt lgkmcnt(4)
v_mfma_f32_16x16x32_bf16 v[40:43], a[240:243], a[8:11], v[40:43]
ds_read_b128 a[232:235], v2 offset:20480
v_mfma_f32_16x16x32_bf16 v[40:43], a[244:247], a[12:15], v[40:43]
ds_read_b128 a[236:239], v2 offset:25600
s_waitcnt lgkmcnt(4)
v_mfma_f32_16x16x32_bf16 v[44:47], a[216:219], a[8:11], v[44:47]
ds_read_b128 a[240:243], v2 offset:21504
v_mfma_f32_16x16x32_bf16 v[44:47], a[220:223], a[12:15], v[44:47]
ds_read_b128 a[244:247], v2 offset:26624
s_add_u32 s25, s25, 4096
buffer_load_dwordx4 a[64:67], v2, s[8:11], s25 offen offset:0 sc1
s_waitcnt lgkmcnt(4)
v_mfma_f32_16x16x32_bf16 v[48:51], a[224:227], a[8:11], v[48:51]
ds_read_b128 a[216:219], v2 offset:22528
v_mfma_f32_16x16x32_bf16 v[48:51], a[228:231], a[12:15], v[48:51]
ds_read_b128 a[220:223], v2 offset:27648
s_waitcnt vmcnt(11)
s_waitcnt lgkmcnt(4)
v_mfma_f32_16x16x32_bf16 v[32:35], a[232:235], a[16:19], v[32:35]
ds_read_b128 a[224:227], v2 offset:23552
v_mfma_f32_16x16x32_bf16 v[32:35], a[236:239], a[20:23], v[32:35]
ds_read_b128 a[228:231], v2 offset:28672
buffer_load_dwordx4 a[68:71], v2, s[8:11], s25 offen offset:1024 sc1
s_waitcnt lgkmcnt(4)
v_mfma_f32_16x16x32_bf16 v[36:39], a[240:243], a[16:19], v[36:39]
ds_read_b128 a[232:235], v2 offset:24576
v_mfma_f32_16x16x32_bf16 v[36:39], a[244:247], a[20:23], v[36:39]
ds_read_b128 a[236:239], v2 offset:29696
s_waitcnt lgkmcnt(4)
v_mfma_f32_16x16x32_bf16 v[40:43], a[216:219], a[16:19], v[40:43]
ds_read_b128 a[240:243], v2 offset:30720
v_mfma_f32_16x16x32_bf16 v[40:43], a[220:223], a[20:23], v[40:43]
ds_read_b128 a[244:247], v2 offset:35840
s_waitcnt lgkmcnt(4)
v_mfma_f32_16x16x32_bf16 v[44:47], a[224:227], a[16:19], v[44:47]
ds_read_b128 a[216:219], v2 offset:31744
v_mfma_f32_16x16x32_bf16 v[44:47], a[228:231], a[20:23], v[44:47]
ds_read_b128 a[220:223], v2 offset:36864
s_waitcnt lgkmcnt(4)
v_mfma_f32_16x16x32_bf16 v[48:51], a[232:235], a[16:19], v[48:51]
ds_read_b128 a[224:227], v2 offset:32768
v_mfma_f32_16x16x32_bf16 v[48:51], a[236:239], a[20:23], v[48:51]
ds_read_b128 a[228:231], v2 offset:37888
s_waitcnt vmcnt(10)
s_waitcnt lgkmcnt(4)
v_mfma_f32_16x16x32_bf16 v[32:35], a[240:243], a[24:27], v[32:35]
ds_read_b128 a[232:235], v2 offset:33792
v_mfma_f32_16x16x32_bf16 v[32:35], a[244:247], a[28:31], v[32:35]
ds_read_b128 a[236:239], v2 offset:38912
s_waitcnt lgkmcnt(4)
v_mfma_f32_16x16x32_bf16 v[36:39], a[216:219], a[24:27], v[36:39]
ds_read_b128 a[240:243], v2 offset:34816
v_mfma_f32_16x16x32_bf16 v[36:39], a[220:223], a[28:31], v[36:39]
ds_read_b128 a[244:247], v2 offset:39936
s_waitcnt lgkmcnt(4)
v_mfma_f32_16x16x32_bf16 v[40:43], a[224:227], a[24:27], v[40:43]
ds_read_b128 a[216:219], v2 offset:40960
v_mfma_f32_16x16x32_bf16 v[40:43], a[228:231], a[28:31], v[40:43]
ds_read_b128 a[220:223], v2 offset:46080
s_waitcnt lgkmcnt(4)
v_mfma_f32_16x16x32_bf16 v[44:47], a[232:235], a[24:27], v[44:47]
ds_read_b128 a[224:227], v2 offset:41984
v_mfma_f32_16x16x32_bf16 v[44:47], a[236:239], a[28:31], v[44:47]
ds_read_b128 a[228:231], v2 offset:47104
s_waitcnt lgkmcnt(4)
v_mfma_f32_16x16x32_bf16 v[48:51], a[240:243], a[24:27], v[48:51]
ds_read_b128 a[232:235], v2 offset:43008
v_mfma_f32_16x16x32_bf16 v[48:51], a[244:247], a[28:31], v[48:51]
ds_read_b128 a[236:239], v2 offset:48128
s_waitcnt vmcnt(8)
s_waitcnt lgkmcnt(4)
v_mfma_f32_16x16x32_bf16 v[32:35], a[216:219], a[32:35], v[32:35]
ds_read_b128 a[240:243], v2 offset:44032
v_mfma_f32_16x16x32_bf16 v[32:35], a[220:223], a[36:39], v[32:35]
ds_read_b128 a[244:247], v2 offset:49152
s_waitcnt lgkmcnt(4)
v_mfma_f32_16x16x32_bf16 v[36:39], a[224:227], a[32:35], v[36:39]
ds_read_b128 a[216:219], v2 offset:45056
v_mfma_f32_16x16x32_bf16 v[36:39], a[228:231], a[36:39], v[36:39]
ds_read_b128 a[220:223], v2 offset:50176
s_waitcnt lgkmcnt(4)
v_mfma_f32_16x16x32_bf16 v[40:43], a[232:235], a[32:35], v[40:43]
ds_read_b128 a[224:227], v2 offset:51200
v_mfma_f32_16x16x32_bf16 v[40:43], a[236:239], a[36:39], v[40:43]
ds_read_b128 a[228:231], v2 offset:56320
s_waitcnt lgkmcnt(4)
v_mfma_f32_16x16x32_bf16 v[44:47], a[240:243], a[32:35], v[44:47]
ds_read_b128 a[232:235], v2 offset:52224
v_mfma_f32_16x16x32_bf16 v[44:47], a[244:247], a[36:39], v[44:47]
ds_read_b128 a[236:239], v2 offset:57344
s_waitcnt lgkmcnt(4)
v_mfma_f32_16x16x32_bf16 v[48:51], a[216:219], a[32:35], v[48:51]
ds_read_b128 a[240:243], v2 offset:53248
v_mfma_f32_16x16x32_bf16 v[48:51], a[220:223], a[36:39], v[48:51]
ds_read_b128 a[244:247], v2 offset:58368
s_waitcnt vmcnt(6)
s_waitcnt lgkmcnt(4)
v_mfma_f32_16x16x32_bf16 v[32:35], a[224:227], a[40:43], v[32:35]
ds_read_b128 a[216:219], v2 offset:54272
v_mfma_f32_16x16x32_bf16 v[32:35], a[228:231], a[44:47], v[32:35]
ds_read_b128 a[220:223], v2 offset:59392
s_waitcnt lgkmcnt(4)
v_mfma_f32_16x16x32_bf16 v[36:39], a[232:235], a[40:43], v[36:39]
ds_read_b128 a[224:227], v2 offset:55296
v_mfma_f32_16x16x32_bf16 v[36:39], a[236:239], a[44:47], v[36:39]
ds_read_b128 a[228:231], v2 offset:60416
s_waitcnt lgkmcnt(4)
v_mfma_f32_16x16x32_bf16 v[40:43], a[240:243], a[40:43], v[40:43]
ds_read_b128 a[232:235], v2 offset:61440
v_mfma_f32_16x16x32_bf16 v[40:43], a[244:247], a[44:47], v[40:43]
ds_read_b128 a[236:239], v5 offset:1024
s_waitcnt lgkmcnt(4)
v_mfma_f32_16x16x32_bf16 v[44:47], a[216:219], a[40:43], v[44:47]
ds_read_b128 a[240:243], v2 offset:62464
v_mfma_f32_16x16x32_bf16 v[44:47], a[220:223], a[44:47], v[44:47]
ds_read_b128 a[244:247], v5 offset:2048
s_waitcnt lgkmcnt(4)
v_mfma_f32_16x16x32_bf16 v[48:51], a[224:227], a[40:43], v[48:51]
ds_read_b128 a[216:219], v2 offset:63488
v_mfma_f32_16x16x32_bf16 v[48:51], a[228:231], a[44:47], v[48:51]
ds_read_b128 a[220:223], v5 offset:3072
s_waitcnt vmcnt(4)
s_waitcnt lgkmcnt(4)
v_mfma_f32_16x16x32_bf16 v[32:35], a[232:235], a[48:51], v[32:35]
ds_read_b128 a[224:227], v2 offset:64512
v_mfma_f32_16x16x32_bf16 v[32:35], a[236:239], a[52:55], v[32:35]
ds_read_b128 a[228:231], v5 offset:4096
s_waitcnt lgkmcnt(4)
v_mfma_f32_16x16x32_bf16 v[36:39], a[240:243], a[48:51], v[36:39]
ds_read_b128 a[232:235], v5 offset:0
v_mfma_f32_16x16x32_bf16 v[36:39], a[244:247], a[52:55], v[36:39]
ds_read_b128 a[236:239], v5 offset:5120
s_waitcnt lgkmcnt(4)
v_mfma_f32_16x16x32_bf16 v[40:43], a[216:219], a[48:51], v[40:43]
ds_read_b128 a[240:243], v5 offset:6144
v_mfma_f32_16x16x32_bf16 v[40:43], a[220:223], a[52:55], v[40:43]
ds_read_b128 a[244:247], v5 offset:11264
s_waitcnt lgkmcnt(4)
v_mfma_f32_16x16x32_bf16 v[44:47], a[224:227], a[48:51], v[44:47]
ds_read_b128 a[216:219], v5 offset:7168
v_mfma_f32_16x16x32_bf16 v[44:47], a[228:231], a[52:55], v[44:47]
ds_read_b128 a[220:223], v5 offset:12288
s_waitcnt lgkmcnt(4)
v_mfma_f32_16x16x32_bf16 v[48:51], a[232:235], a[48:51], v[48:51]
ds_read_b128 a[224:227], v5 offset:8192
v_mfma_f32_16x16x32_bf16 v[48:51], a[236:239], a[52:55], v[48:51]
ds_read_b128 a[228:231], v5 offset:13312
s_waitcnt vmcnt(2)
s_waitcnt lgkmcnt(4)
v_mfma_f32_16x16x32_bf16 v[32:35], a[240:243], a[56:59], v[32:35]
ds_read_b128 a[232:235], v5 offset:9216
v_mfma_f32_16x16x32_bf16 v[32:35], a[244:247], a[60:63], v[32:35]
ds_read_b128 a[236:239], v5 offset:14336
s_waitcnt lgkmcnt(4)
v_mfma_f32_16x16x32_bf16 v[36:39], a[216:219], a[56:59], v[36:39]
ds_read_b128 a[240:243], v5 offset:10240
v_mfma_f32_16x16x32_bf16 v[36:39], a[220:223], a[60:63], v[36:39]
ds_read_b128 a[244:247], v5 offset:15360
s_waitcnt lgkmcnt(4)
v_mfma_f32_16x16x32_bf16 v[40:43], a[224:227], a[56:59], v[40:43]
ds_read_b128 a[216:219], v5 offset:16384
v_mfma_f32_16x16x32_bf16 v[40:43], a[228:231], a[60:63], v[40:43]
ds_read_b128 a[220:223], v5 offset:21504
s_waitcnt lgkmcnt(4)
v_mfma_f32_16x16x32_bf16 v[44:47], a[232:235], a[56:59], v[44:47]
ds_read_b128 a[224:227], v5 offset:17408
v_mfma_f32_16x16x32_bf16 v[44:47], a[236:239], a[60:63], v[44:47]
ds_read_b128 a[228:231], v5 offset:22528
s_waitcnt lgkmcnt(4)
v_mfma_f32_16x16x32_bf16 v[48:51], a[240:243], a[56:59], v[48:51]
ds_read_b128 a[232:235], v5 offset:18432
v_mfma_f32_16x16x32_bf16 v[48:51], a[244:247], a[60:63], v[48:51]
ds_read_b128 a[236:239], v5 offset:23552
s_waitcnt vmcnt(0)
s_waitcnt lgkmcnt(4)
v_mfma_f32_16x16x32_bf16 v[32:35], a[216:219], a[64:67], v[32:35]
ds_read_b128 a[240:243], v5 offset:19456
v_mfma_f32_16x16x32_bf16 v[32:35], a[220:223], a[68:71], v[32:35]
ds_read_b128 a[244:247], v5 offset:24576
s_waitcnt lgkmcnt(4)
v_mfma_f32_16x16x32_bf16 v[36:39], a[224:227], a[64:67], v[36:39]
ds_read_b128 a[216:219], v5 offset:20480
v_mfma_f32_16x16x32_bf16 v[36:39], a[228:231], a[68:71], v[36:39]
ds_read_b128 a[220:223], v5 offset:25600
s_waitcnt lgkmcnt(4)
v_mfma_f32_16x16x32_bf16 v[40:43], a[232:235], a[64:67], v[40:43]
v_mfma_f32_16x16x32_bf16 v[40:43], a[236:239], a[68:71], v[40:43]
s_waitcnt lgkmcnt(2)
v_mfma_f32_16x16x32_bf16 v[44:47], a[240:243], a[64:67], v[44:47]
v_mfma_f32_16x16x32_bf16 v[44:47], a[244:247], a[68:71], v[44:47]
s_waitcnt lgkmcnt(0)
v_mfma_f32_16x16x32_bf16 v[48:51], a[216:219], a[64:67], v[48:51]
v_mfma_f32_16x16x32_bf16 v[48:51], a[220:223], a[68:71], v[48:51]
s_waitcnt vmcnt(18)
v_lshlrev_b32 v68, 16, v56
v_and_b32 v69, 0xffff0000, v56
v_add_f32 v32, v32, v68
v_add_f32 v33, v33, v69
v_lshlrev_b32 v70, 16, v57
v_and_b32 v71, 0xffff0000, v57
v_add_f32 v34, v34, v70
v_add_f32 v35, v35, v71
v_lshlrev_b32 v72, 16, v58
v_and_b32 v73, 0xffff0000, v58
v_add_f32 v36, v36, v72
v_add_f32 v37, v37, v73
v_lshlrev_b32 v74, 16, v59
v_and_b32 v75, 0xffff0000, v59
v_add_f32 v38, v38, v74
v_add_f32 v39, v39, v75
v_lshlrev_b32 v68, 16, v60
v_and_b32 v69, 0xffff0000, v60
v_add_f32 v40, v40, v68
v_add_f32 v41, v41, v69
v_lshlrev_b32 v70, 16, v61
v_and_b32 v71, 0xffff0000, v61
v_add_f32 v42, v42, v70
v_add_f32 v43, v43, v71
v_lshlrev_b32 v72, 16, v62
v_and_b32 v73, 0xffff0000, v62
v_add_f32 v44, v44, v72
v_add_f32 v45, v45, v73
v_lshlrev_b32 v74, 16, v63
v_and_b32 v75, 0xffff0000, v63
v_add_f32 v46, v46, v74
v_add_f32 v47, v47, v75
v_lshlrev_b32 v68, 16, v64
v_and_b32 v69, 0xffff0000, v64
v_add_f32 v48, v48, v68
v_add_f32 v49, v49, v69
v_lshlrev_b32 v70, 16, v65
v_and_b32 v71, 0xffff0000, v65
v_add_f32 v50, v50, v70
v_add_f32 v51, v51, v71
v_cvt_pk_bf16_f32 v80, v32, v33
v_cvt_pk_bf16_f32 v81, v34, v35
v_cvt_pk_bf16_f32 v82, v36, v37
v_cvt_pk_bf16_f32 v83, v38, v39
v_cvt_pk_bf16_f32 v84, v40, v41
v_cvt_pk_bf16_f32 v85, v42, v43
v_cvt_pk_bf16_f32 v86, v44, v45
v_cvt_pk_bf16_f32 v87, v46, v47
v_cvt_pk_bf16_f32 v88, v48, v49
v_cvt_pk_bf16_f32 v89, v50, v51
s_add_u32 s27, s26, s73
buffer_store_dwordx4 v[80:83], v2, s[8:11], s27 offen sc1
buffer_store_dwordx4 v[84:87], v2, s[8:11], s27 offen offset:1024 sc1
buffer_store_dwordx2 v[88:89], v4, s[8:11], s27 offen sc1
v_add_f32 v10, v32, v33
v_mul_f32 v11, v32, v32
v_mul_f32 v13, v33, v33
v_mov_b32 v12, 0
v_add_f32 v10, v10, v34
v_add_f32 v12, v12, v35
v_fmac_f32 v11, v34, v34
v_fmac_f32 v13, v35, v35
v_add_f32 v10, v10, v36
v_add_f32 v12, v12, v37
v_fmac_f32 v11, v36, v36
v_fmac_f32 v13, v37, v37
v_add_f32 v10, v10, v38
v_add_f32 v12, v12, v39
v_fmac_f32 v11, v38, v38
v_fmac_f32 v13, v39, v39
v_add_f32 v10, v10, v40
v_add_f32 v12, v12, v41
v_fmac_f32 v11, v40, v40
v_fmac_f32 v13, v41, v41
v_add_f32 v10, v10, v42
v_add_f32 v12, v12, v43
v_fmac_f32 v11, v42, v42
v_fmac_f32 v13, v43, v43
v_add_f32 v10, v10, v44
v_add_f32 v12, v12, v45
v_fmac_f32 v11, v44, v44
v_fmac_f32 v13, v45, v45
v_add_f32 v10, v10, v46
v_add_f32 v12, v12, v47
v_fmac_f32 v11, v46, v46
v_fmac_f32 v13, v47, v47
v_add_f32 v10, v10, v48
v_add_f32 v12, v12, v49
v_fmac_f32 v11, v48, v48
v_fmac_f32 v13, v49, v49
v_add_f32 v10, v10, v50
v_add_f32 v12, v12, v51
v_fmac_f32 v11, v50, v50
v_fmac_f32 v13, v51, v51
v_add_f32 v10, v10, v12
v_add_f32 v11, v11, v13
v_mov_b32 v12, v10
v_mov_b32 v13, v11
s_nop 0
v_permlane16_swap_b32 v10, v12
v_permlane16_swap_b32 v11, v13
v_add_f32 v10, v10, v12
v_add_f32 v11, v11, v13
v_mov_b32 v12, v10
v_mov_b32 v13, v11
s_nop 0
v_permlane32_swap_b32 v10, v12
v_permlane32_swap_b32 v11, v13
v_add_f32 v10, v10, v12
v_add_f32 v11, v11, v13
v_lshlrev_b32 v8, 3, v6
v_cmp_gt_u32 vcc, 16, v1
s_nop 1
v_cndmask_b32 v8, v9, v8, vcc
s_lshl_b32 s27, s20, 10
s_lshl_b32 s28, s21, 7
s_add_u32 s27, s27, s28
s_add_u32 s27, s27, s74
buffer_store_dwordx2 v[10:11], v8, s[8:11], s27 offen sc1
s_lshr_b32 s27, s20, 2
s_lshl_b32 s27, s27, 3
s_add_u32 s27, s27, s21
s_lshl_b32 s27, s27, 2
s_add_u32 s27, s27, s4
s_lshl_b32 s27, s27, 2
s_add_u32 s27, s27, s77
s_add_u32 s27, s27, 24576
v_mov_b32 v14, 2146435072
v_cmp_eq_u32 vcc, 0, v1
s_nop 1
v_cndmask_b32 v14, v14, 0, vcc
v_mov_b32 v15, 1
s_waitcnt vmcnt(0)
buffer_store_dword v15, v14, s[8:11], s27 offen sc1
s_barrier
s_lshr_b32 s40, s6, 2
s_lshl_b32 s41, s5, 2
s_and_b32 s42, s6, 3
s_add_u32 s41, s41, s42
s_lshr_b32 s42, s41, 2
s_and_b32 s43, s41, 3
s_mul_i32 s22, s4, 6144
s_mul_i32 s21, s41, 497664
s_add_u32 s21, s21, s22
s_add_u32 s21, s21, 3366912
v_add_u32 v3, s21, v2
s_add_u32 m0, s22, 0
s_nop 0
buffer_load_dwordx4 v3, s[8:11], 0 offen offset:0 lds
buffer_load_dwordx4 v3, s[8:11], 0 offen offset:1024 lds
buffer_load_dwordx4 v3, s[8:11], 0 offen offset:2048 lds
buffer_load_dwordx4 v3, s[8:11], 0 offen offset:3072 lds
s_add_u32 m0, s22, 4096
v_add_u32 v3, 4096, v3
buffer_load_dwordx4 v3, s[8:11], 0 offen offset:0 lds
buffer_load_dwordx4 v3, s[8:11], 0 offen offset:1024 lds
s_add_u32 m0, s22, 24576
v_add_u32 v3, 20480, v3
buffer_load_dwordx4 v3, s[8:11], 0 offen offset:0 lds
buffer_load_dwordx4 v3, s[8:11], 0 offen offset:1024 lds
buffer_load_dwordx4 v3, s[8:11], 0 offen offset:2048 lds
buffer_load_dwordx4 v3, s[8:11], 0 offen offset:3072 lds
s_add_u32 m0, s22, 28672
v_add_u32 v3, 4096, v3
buffer_load_dwordx4 v3, s[8:11], 0 offen offset:0 lds
buffer_load_dwordx4 v3, s[8:11], 0 offen offset:1024 lds
s_add_u32 m0, s22, 49152
v_add_u32 v3, 20480, v3
buffer_load_dwordx4 v3, s[8:11], 0 offen offset:0 lds
buffer_load_dwordx4 v3, s[8:11], 0 offen offset:1024 lds
buffer_load_dwordx4 v3, s[8:11], 0 offen offset:2048 lds
buffer_load_dwordx4 v3, s[8:11], 0 offen offset:3072 lds
s_add_u32 m0, s22, 53248
v_add_u32 v3, 4096, v3
buffer_load_dwordx4 v3, s[8:11], 0 offen offset:0 lds
buffer_load_dwordx4 v3, s[8:11], 0 offen offset:1024 lds
s_add_u32 m0, s22, 73728
v_add_u32 v3, 20480, v3
buffer_load_dwordx4 v3, s[8:11], 0 offen offset:0 lds
buffer_load_dwordx4 v3, s[8:11], 0 offen offset:1024 lds
buffer_load_dwordx4 v3, s[8:11], 0 offen offset:2048 lds
buffer_load_dwordx4 v3, s[8:11], 0 offen offset:3072 lds
s_add_u32 m0, s22, 77824
v_add_u32 v3, 4096, v3
buffer_load_dwordx4 v3, s[8:11], 0 offen offset:0 lds
buffer_load_dwordx4 v3, s[8:11], 0 offen offset:1024 lds
s_lshl_b32 s44, s40, 4
s_lshl_b32 s45, s4, 2
s_add_u32 s44, s44, s45
s_mul_i32 s46, s44, 18432
s_add_u32 s20, s46, s73
v_add_u32 v4, 18432, v2
v_add_u32 v5, 36864, v2
v_add_u32 v6, 55296, v2
v_lshlrev_b32 v244, 3, v1
v_add_u32 v245, 18432, v244
v_add_u32 v246, 36864, v244
v_add_u32 v247, 55296, v244
v_and_b32 v13, 15, v1
v_lshrrev_b32 v14, 4, v1
v_add_u32 v7, 0x10000, v2
v_add_u32 v8, 0x20000, v2
v_and_b32 v9, 1, v14
v_mul_u32_u24 v9, 18432, v9
v_lshrrev_b32 v15, 1, v14
v_lshlrev_b32 v15, 8, v15
v_lshl_add_u32 v15, v13, 4, v15
v_add_u32 v9, v9, v15
v_and_b32 v11, 3, v1
v_lshlrev_b32 v11, 2, v11
s_lshl_b32 s49, s43, 2
v_mov_b32 v10, 2146435072
v_mov_b32 v15, s49
v_cmp_eq_u32 vcc, 0, v1
s_nop 1
v_cndmask_b32 v10, v10, v15, vcc
s_lshl_b32 s49, s40, 3
s_add_u32 s49, s49, s42
s_lshl_b32 s50, s49, 2
s_add_u32 s50, s50, s4
s_lshl_b32 s50, s50, 6
s_add_u32 s34, s50, s77
s_add_u32 s34, s34, 0
s_lshl_b32 s49, s49, 4
s_add_u32 s49, s49, s45
s_mul_i32 s49, s49, 18432
s_add_u32 s49, s49, s75
s_add_u32 s50, s43, 0
s_and_b32 s50, s50, 3
s_mul_i32 s50, s50, 9
s_add_u32 s50, s50, 1
s_lshr_b32 s50, s50, 1
s_lshl_b32 s50, s50, 10
s_add_u32 s24, s49, s50
s_add_u32 s50, s43, 1
s_and_b32 s50, s50, 3
s_mul_i32 s50, s50, 9
s_add_u32 s50, s50, 1
s_lshr_b32 s50, s50, 1
s_lshl_b32 s50, s50, 10
s_add_u32 s25, s49, s50
s_add_u32 s50, s43, 2
s_and_b32 s50, s50, 3
s_mul_i32 s50, s50, 9
s_add_u32 s50, s50, 1
s_lshr_b32 s50, s50, 1
s_lshl_b32 s50, s50, 10
s_add_u32 s26, s49, s50
s_add_u32 s50, s43, 3
s_and_b32 s50, s50, 3
s_mul_i32 s50, s50, 9
s_add_u32 s50, s50, 1
s_lshr_b32 s50, s50, 1
s_lshl_b32 s50, s50, 10
s_add_u32 s27, s49, s50
s_add_u32 s28, s49, 4096
s_add_u32 s29, s49, 13312
s_cmp_ge_u32 s43, 2
s_cselect_b32 s50, s29, s28
s_and_b32 s51, s43, 1
s_lshl_b32 s51, s51, 9
s_add_u32 s30, s50, s51
s_mul_i32 s50, s42, 2359296
s_add_u32 s50, s50, s46
s_mul_i32 s51, s43, 4608
s_add_u32 s50, s50, s51
s_add_u32 s31, s50, s76
s_add_u32 s32, s31, 4096
s_add_u32 s33, s32, 36864
s_lshl_b32 s35, s40, 2
s_add_u32 s35, s35, s4
s_lshl_b32 s35, s35, 5
s_add_u32 s35, s35, s41
s_lshl_b32 s35, s35, 2
s_add_u32 s35, s35, s77
s_add_u32 s35, s35, 32768
v_lshlrev_b32 v15, 3, v13
v_lshl_add_u32 v15, v14, 8, v15
s_lshl_b32 s47, s44, 10
s_add_u32 s47, s47, s74
s_lshl_b32 s49, s44, 5
s_add_u32 s49, s49, s77
s_add_u32 s49, s49, 24576
v_and_b32 v16, 31, v1
v_lshlrev_b32 v16, 2, v16
s_mov_b32 s52, 0
buffer_load_dword v253, v16, s[8:11], s49 offen sc1
s_sleep 2
buffer_load_dword v254, v16, s[8:11], s49 offen sc1
s_sleep 2
L_poll4:
buffer_load_dword v255, v16, s[8:11], s49 offen sc1
s_waitcnt vmcnt(2)
v_cmp_ne_u32 vcc, 0, v253
s_add_u32 s52, s52, 1
s_cmp_eq_u64 vcc, exec
s_cbranch_scc1 L_got4
buffer_load_dword v253, v16, s[8:11], s49 offen sc1
s_waitcnt vmcnt(2)
v_cmp_ne_u32 vcc, 0, v254
s_add_u32 s52, s52, 1
s_cmp_eq_u64 vcc, exec
s_cbranch_scc1 L_got4
buffer_load_dword v254, v16, s[8:11], s49 offen sc1
s_waitcnt vmcnt(2)
v_cmp_ne_u32 vcc, 0, v255
s_add_u32 s52, s52, 1
s_cmp_eq_u64 vcc, exec
s_cbranch_scc1 L_got4
s_cmp_lt_u32 s52, 0x200000
s_cbranch_scc1 L_poll4
L_got4:
s_add_u32 s48, s20, 0
buffer_load_dwordx4 a[0:3], v2, s[8:11], s48 offen offset:0 sc1
buffer_load_dwordx4 a[4:7], v4, s[8:11], s48 offen offset:0 sc1
buffer_load_dwordx4 a[8:11], v5, s[8:11], s48 offen offset:0 sc1
buffer_load_dwordx4 a[12:15], v6, s[8:11], s48 offen offset:0 sc1
buffer_load_dwordx4 a[16:19], v2, s[8:11], s48 offen offset:1024 sc1
buffer_load_dwordx4 a[20:23], v4, s[8:11], s48 offen offset:1024 sc1
buffer_load_dwordx4 a[24:27], v5, s[8:11], s48 offen offset:1024 sc1
buffer_load_dwordx4 a[28:31], v6, s[8:11], s48 offen offset:1024 sc1
buffer_load_dwordx2 v[144:145], v15, s[8:11], s47 offen offset:0 sc1
buffer_load_dwordx2 v[146:147], v15, s[8:11], s47 offen offset:128 sc1
buffer_load_dwordx2 v[148:149], v15, s[8:11], s47 offen offset:1024 sc1
buffer_load_dwordx2 v[150:151], v15, s[8:11], s47 offen offset:1152 sc1
buffer_load_dwordx2 v[152:153], v15, s[8:11], s47 offen offset:2048 sc1
buffer_load_dwordx2 v[154:155], v15, s[8:11], s47 offen offset:2176 sc1
buffer_load_dwordx2 v[156:157], v15, s[8:11], s47 offen offset:3072 sc1
buffer_load_dwordx2 v[158:159], v15, s[8:11], s47 offen offset:3200 sc1
buffer_load_dwordx4 a[32:35], v2, s[8:11], s48 offen offset:2048 sc1
buffer_load_dwordx4 a[36:39], v4, s[8:11], s48 offen offset:2048 sc1
buffer_load_dwordx4 a[40:43], v5, s[8:11], s48 offen offset:2048 sc1
buffer_load_dwordx4 a[44:47], v6, s[8:11], s48 offen offset:2048 sc1
buffer_load_dwordx4 a[48:51], v2, s[8:11], s48 offen offset:3072 sc1
buffer_load_dwordx4 a[52:55], v4, s[8:11], s48 offen offset:3072 sc1
buffer_load_dwordx4 a[56:59], v5, s[8:11], s48 offen offset:3072 sc1
buffer_load_dwordx4 a[60:63], v6, s[8:11], s48 offen offset:3072 sc1
s_add_u32 s48, s20, 4096
buffer_load_dwordx4 a[64:67], v2, s[8:11], s48 offen offset:0 sc1
buffer_load_dwordx4 a[68:71], v4, s[8:11], s48 offen offset:0 sc1
buffer_load_dwordx4 a[72:75], v5, s[8:11], s48 offen offset:0 sc1
buffer_load_dwordx4 a[76:79], v6, s[8:11], s48 offen offset:0 sc1
s_barrier
ds_read_b128 v[48:51], v2 offset:0
ds_read_b128 v[52:55], v2 offset:1024
ds_read_b128 v[56:59], v2 offset:2048
ds_read_b128 v[60:63], v2 offset:3072
ds_read_b128 v[64:67], v2 offset:4096
ds_read_b128 v[68:71], v2 offset:5120
s_waitcnt vmcnt(20)
s_waitcnt lgkmcnt(4)
v_mfma_f32_16x16x32_bf16 v[80:83], v[48:51], a[0:3], 0
buffer_load_dwordx4 a[80:83], v2, s[8:11], s48 offen offset:1024 sc1
v_mfma_f32_16x16x32_bf16 v[80:83], v[52:55], a[16:19], v[80:83]
v_mfma_f32_16x16x32_bf16 v[84:87], v[48:51], a[4:7], 0
ds_read_b128 v[72:75], v2 offset:6144
v_mfma_f32_16x16x32_bf16 v[84:87], v[52:55], a[20:23], v[84:87]
v_mfma_f32_16x16x32_bf16 v[88:91], v[48:51], a[8:11], 0
buffer_load_dwordx4 a[84:87], v4, s[8:11], s48 offen offset:1024 sc1
v_mfma_f32_16x16x32_bf16 v[88:91], v[52:55], a[24:27], v[88:91]
ds_read_b128 v[76:79], v2 offset:7168
v_mfma_f32_16x16x32_bf16 v[92:95], v[48:51], a[12:15], 0
v_mfma_f32_16x16x32_bf16 v[92:95], v[52:55], a[28:31], v[92:95]
s_waitcnt lgkmcnt(4)
v_mfma_f32_16x16x32_bf16 v[96:99], v[56:59], a[0:3], 0
buffer_load_dwordx4 a[88:91], v5, s[8:11], s48 offen offset:1024 sc1
v_mfma_f32_16x16x32_bf16 v[96:99], v[60:63], a[16:19], v[96:99]
v_mfma_f32_16x16x32_bf16 v[100:103], v[56:59], a[4:7], 0
ds_read_b128 v[48:51], v2 offset:8192
v_mfma_f32_16x16x32_bf16 v[100:103], v[60:63], a[20:23], v[100:103]
v_mfma_f32_16x16x32_bf16 v[104:107], v[56:59], a[8:11], 0
buffer_load_dwordx4 a[92:95], v6, s[8:11], s48 offen offset:1024 sc1
v_mfma_f32_16x16x32_bf16 v[104:107], v[60:63], a[24:27], v[104:107]
ds_read_b128 v[52:55], v2 offset:9216
v_mfma_f32_16x16x32_bf16 v[108:111], v[56:59], a[12:15], 0
v_mfma_f32_16x16x32_bf16 v[108:111], v[60:63], a[28:31], v[108:111]
s_waitcnt lgkmcnt(4)
v_mfma_f32_16x16x32_bf16 v[112:115], v[64:67], a[0:3], 0
buffer_load_dwordx4 a[96:99], v2, s[8:11], s48 offen offset:2048 sc1
v_mfma_f32_16x16x32_bf16 v[112:115], v[68:71], a[16:19], v[112:115]
v_mfma_f32_16x16x32_bf16 v[116:119], v[64:67], a[4:7], 0
ds_read_b128 v[56:59], v2 offset:10240
v_mfma_f32_16x16x32_bf16 v[116:119], v[68:71], a[20:23], v[116:119]
v_mfma_f32_16x16x32_bf16 v[120:123], v[64:67], a[8:11], 0
buffer_load_dwordx4 a[100:103], v4, s[8:11], s48 offen offset:2048 sc1
v_mfma_f32_16x16x32_bf16 v[120:123], v[68:71], a[24:27], v[120:123]
ds_read_b128 v[60:63], v2 offset:11264
v_mfma_f32_16x16x32_bf16 v[124:127], v[64:67], a[12:15], 0
v_mfma_f32_16x16x32_bf16 v[124:127], v[68:71], a[28:31], v[124:127]
s_waitcnt lgkmcnt(4)
v_mfma_f32_16x16x32_bf16 v[128:131], v[72:75], a[0:3], 0
buffer_load_dwordx4 a[104:107], v5, s[8:11], s48 offen offset:2048 sc1
v_mfma_f32_16x16x32_bf16 v[128:131], v[76:79], a[16:19], v[128:131]
v_mfma_f32_16x16x32_bf16 v[132:135], v[72:75], a[4:7], 0
ds_read_b128 v[64:67], v2 offset:12288
v_mfma_f32_16x16x32_bf16 v[132:135], v[76:79], a[20:23], v[132:135]
v_mfma_f32_16x16x32_bf16 v[136:139], v[72:75], a[8:11], 0
buffer_load_dwordx4 a[108:111], v6, s[8:11], s48 offen offset:2048 sc1
v_mfma_f32_16x16x32_bf16 v[136:139], v[76:79], a[24:27], v[136:139]
ds_read_b128 v[68:71], v2 offset:13312
v_mfma_f32_16x16x32_bf16 v[140:143], v[72:75], a[12:15], 0
v_mfma_f32_16x16x32_bf16 v[140:143], v[76:79], a[28:31], v[140:143]
s_waitcnt vmcnt(12)
s_waitcnt lgkmcnt(4)
v_mfma_f32_16x16x32_bf16 v[80:83], v[48:51], a[32:35], v[80:83]
buffer_load_dwordx4 a[112:115], v2, s[8:11], s48 offen offset:3072 sc1
v_mfma_f32_16x16x32_bf16 v[80:83], v[52:55], a[48:51], v[80:83]
v_mfma_f32_16x16x32_bf16 v[84:87], v[48:51], a[36:39], v[84:87]
ds_read_b128 v[72:75], v2 offset:14336
v_mfma_f32_16x16x32_bf16 v[84:87], v[52:55], a[52:55], v[84:87]
v_mfma_f32_16x16x32_bf16 v[88:91], v[48:51], a[40:43], v[88:91]
buffer_load_dwordx4 a[116:119], v4, s[8:11], s48 offen offset:3072 sc1
v_mfma_f32_16x16x32_bf16 v[88:91], v[52:55], a[56:59], v[88:91]
ds_read_b128 v[76:79], v2 offset:15360
v_mfma_f32_16x16x32_bf16 v[92:95], v[48:51], a[44:47], v[92:95]
v_mfma_f32_16x16x32_bf16 v[92:95], v[52:55], a[60:63], v[92:95]
s_waitcnt lgkmcnt(4)
v_mfma_f32_16x16x32_bf16 v[96:99], v[56:59], a[32:35], v[96:99]
buffer_load_dwordx4 a[120:123], v5, s[8:11], s48 offen offset:3072 sc1
v_mfma_f32_16x16x32_bf16 v[96:99], v[60:63], a[48:51], v[96:99]
v_mfma_f32_16x16x32_bf16 v[100:103], v[56:59], a[36:39], v[100:103]
ds_read_b128 v[48:51], v2 offset:16384
v_mfma_f32_16x16x32_bf16 v[100:103], v[60:63], a[52:55], v[100:103]
v_mfma_f32_16x16x32_bf16 v[104:107], v[56:59], a[40:43], v[104:107]
buffer_load_dwordx4 a[124:127], v6, s[8:11], s48 offen offset:3072 sc1
v_mfma_f32_16x16x32_bf16 v[104:107], v[60:63], a[56:59], v[104:107]
ds_read_b128 v[52:55], v2 offset:17408
s_add_u32 s48, s20, 8192
v_mfma_f32_16x16x32_bf16 v[108:111], v[56:59], a[44:47], v[108:111]
v_mfma_f32_16x16x32_bf16 v[108:111], v[60:63], a[60:63], v[108:111]
s_waitcnt lgkmcnt(4)
v_mfma_f32_16x16x32_bf16 v[112:115], v[64:67], a[32:35], v[112:115]
buffer_load_dwordx4 a[128:131], v2, s[8:11], s48 offen offset:0 sc1
v_mfma_f32_16x16x32_bf16 v[112:115], v[68:71], a[48:51], v[112:115]
v_mfma_f32_16x16x32_bf16 v[116:119], v[64:67], a[36:39], v[116:119]
ds_read_b128 v[56:59], v2 offset:18432
v_mfma_f32_16x16x32_bf16 v[116:119], v[68:71], a[52:55], v[116:119]
v_mfma_f32_16x16x32_bf16 v[120:123], v[64:67], a[40:43], v[120:123]
buffer_load_dwordx4 a[132:135], v4, s[8:11], s48 offen offset:0 sc1
v_mfma_f32_16x16x32_bf16 v[120:123], v[68:71], a[56:59], v[120:123]
ds_read_b128 v[60:63], v2 offset:19456
v_mfma_f32_16x16x32_bf16 v[124:127], v[64:67], a[44:47], v[124:127]
v_mfma_f32_16x16x32_bf16 v[124:127], v[68:71], a[60:63], v[124:127]
s_waitcnt lgkmcnt(4)
v_mfma_f32_16x16x32_bf16 v[128:131], v[72:75], a[32:35], v[128:131]
buffer_load_dwordx4 a[136:139], v5, s[8:11], s48 offen offset:0 sc1
v_mfma_f32_16x16x32_bf16 v[128:131], v[76:79], a[48:51], v[128:131]
v_mfma_f32_16x16x32_bf16 v[132:135], v[72:75], a[36:39], v[132:135]
ds_read_b128 v[64:67], v2 offset:20480
v_mfma_f32_16x16x32_bf16 v[132:135], v[76:79], a[52:55], v[132:135]
v_mfma_f32_16x16x32_bf16 v[136:139], v[72:75], a[40:43], v[136:139]
buffer_load_dwordx4 a[140:143], v6, s[8:11], s48 offen offset:0 sc1
v_mfma_f32_16x16x32_bf16 v[136:139], v[76:79], a[56:59], v[136:139]
ds_read_b128 v[68:71], v2 offset:21504
v_mfma_f32_16x16x32_bf16 v[140:143], v[72:75], a[44:47], v[140:143]
v_mfma_f32_16x16x32_bf16 v[140:143], v[76:79], a[60:63], v[140:143]
s_waitcnt vmcnt(12)
s_waitcnt lgkmcnt(4)
v_mfma_f32_16x16x32_bf16 v[80:83], v[48:51], a[64:67], v[80:83]
buffer_load_dwordx4 a[144:147], v2, s[8:11], s48 offen offset:1024 sc1
v_mfma_f32_16x16x32_bf16 v[80:83], v[52:55], a[80:83], v[80:83]
v_mfma_f32_16x16x32_bf16 v[84:87], v[48:51], a[68:71], v[84:87]
ds_read_b128 v[72:75], v2 offset:22528
v_mfma_f32_16x16x32_bf16 v[84:87], v[52:55], a[84:87], v[84:87]
v_add_f32 v144, v144, v146
v_add_f32 v145, v145, v147
v_mfma_f32_16x16x32_bf16 v[88:91], v[48:51], a[72:75], v[88:91]
buffer_load_dwordx4 a[148:151], v4, s[8:11], s48 offen offset:1024 sc1
v_mfma_f32_16x16x32_bf16 v[88:91], v[52:55], a[88:91], v[88:91]
ds_read_b128 v[76:79], v2 offset:23552
v_add_f32 v148, v148, v150
v_mfma_f32_16x16x32_bf16 v[92:95], v[48:51], a[76:79], v[92:95]
v_add_f32 v149, v149, v151
v_add_f32 v152, v152, v154
v_mfma_f32_16x16x32_bf16 v[92:95], v[52:55], a[92:95], v[92:95]
v_add_f32 v153, v153, v155
s_waitcnt lgkmcnt(4)
v_mfma_f32_16x16x32_bf16 v[96:99], v[56:59], a[64:67], v[96:99]
buffer_load_dwordx4 a[152:155], v5, s[8:11], s48 offen offset:1024 sc1
v_mfma_f32_16x16x32_bf16 v[96:99], v[60:63], a[80:83], v[96:99]
s_barrier
v_mfma_f32_16x16x32_bf16 v[100:103], v[56:59], a[68:71], v[100:103]
ds_read_b128 v[48:51], v2 offset:24576
v_add_f32 v156, v156, v158
v_mfma_f32_16x16x32_bf16 v[100:103], v[60:63], a[84:87], v[100:103]
v_add_f32 v157, v157, v159
v_mov_b32 v160, v144
v_mfma_f32_16x16x32_bf16 v[104:107], v[56:59], a[72:75], v[104:107]
buffer_load_dwordx4 a[156:159], v6, s[8:11], s48 offen offset:1024 sc1
v_mfma_f32_16x16x32_bf16 v[104:107], v[60:63], a[88:91], v[104:107]
ds_read_b128 v[52:55], v2 offset:25600
v_mov_b32 v161, v145
v_mfma_f32_16x16x32_bf16 v[108:111], v[56:59], a[76:79], v[108:111]
v_mov_b32 v162, v148
v_mov_b32 v163, v149
v_mfma_f32_16x16x32_bf16 v[108:111], v[60:63], a[92:95], v[108:111]
v_mov_b32 v164, v152
s_waitcnt lgkmcnt(4)
v_mfma_f32_16x16x32_bf16 v[112:115], v[64:67], a[64:67], v[112:115]
buffer_load_dwordx4 a[160:163], v2, s[8:11], s48 offen offset:2048 sc1
v_mfma_f32_16x16x32_bf16 v[112:115], v[68:71], a[80:83], v[112:115]
v_mov_b32 v165, v153
v_mov_b32 v166, v156
v_mfma_f32_16x16x32_bf16 v[116:119], v[64:67], a[68:71], v[116:119]
ds_read_b128 v[56:59], v2 offset:26624
v_mov_b32 v167, v157
v_mfma_f32_16x16x32_bf16 v[116:119], v[68:71], a[84:87], v[116:119]
v_permlane16_swap_b32 v144, v160
v_permlane16_swap_b32 v145, v161
v_mfma_f32_16x16x32_bf16 v[120:123], v[64:67], a[72:75], v[120:123]
buffer_load_dwordx4 a[164:167], v4, s[8:11], s48 offen offset:2048 sc1
v_mfma_f32_16x16x32_bf16 v[120:123], v[68:71], a[88:91], v[120:123]
ds_read_b128 v[60:63], v2 offset:27648
v_permlane16_swap_b32 v148, v162
v_mfma_f32_16x16x32_bf16 v[124:127], v[64:67], a[76:79], v[124:127]
v_permlane16_swap_b32 v149, v163
v_permlane16_swap_b32 v152, v164
v_mfma_f32_16x16x32_bf16 v[124:127], v[68:71], a[92:95], v[124:127]
v_permlane16_swap_b32 v153, v165
s_waitcnt lgkmcnt(4)
v_mfma_f32_16x16x32_bf16 v[128:131], v[72:75], a[64:67], v[128:131]
buffer_load_dwordx4 a[168:171], v5, s[8:11], s48 offen offset:2048 sc1
v_mfma_f32_16x16x32_bf16 v[128:131], v[76:79], a[80:83], v[128:131]
v_permlane16_swap_b32 v156, v166
v_permlane16_swap_b32 v157, v167
v_mfma_f32_16x16x32_bf16 v[132:135], v[72:75], a[68:71], v[132:135]
ds_read_b128 v[64:67], v2 offset:28672
v_add_f32 v144, v144, v160
v_mfma_f32_16x16x32_bf16 v[132:135], v[76:79], a[84:87], v[132:135]
v_add_f32 v145, v145, v161
v_add_f32 v148, v148, v162
v_mfma_f32_16x16x32_bf16 v[136:139], v[72:75], a[72:75], v[136:139]
buffer_load_dwordx4 a[172:175], v6, s[8:11], s48 offen offset:2048 sc1
v_mfma_f32_16x16x32_bf16 v[136:139], v[76:79], a[88:91], v[136:139]
ds_read_b128 v[68:71], v2 offset:29696
v_add_f32 v149, v149, v163
v_mfma_f32_16x16x32_bf16 v[140:143], v[72:75], a[76:79], v[140:143]
v_add_f32 v152, v152, v164
v_add_f32 v153, v153, v165
v_mfma_f32_16x16x32_bf16 v[140:143], v[76:79], a[92:95], v[140:143]
v_add_f32 v156, v156, v166
s_waitcnt vmcnt(12)
s_waitcnt lgkmcnt(4)
v_mfma_f32_16x16x32_bf16 v[80:83], v[48:51], a[96:99], v[80:83]
buffer_load_dwordx4 a[176:179], v2, s[8:11], s48 offen offset:3072 sc1
v_mfma_f32_16x16x32_bf16 v[80:83], v[52:55], a[112:115], v[80:83]
v_add_f32 v157, v157, v167
v_mov_b32 v160, v144
v_mfma_f32_16x16x32_bf16 v[84:87], v[48:51], a[100:103], v[84:87]
ds_read_b128 v[72:75], v2 offset:30720
v_mov_b32 v161, v145
v_mfma_f32_16x16x32_bf16 v[84:87], v[52:55], a[116:119], v[84:87]
v_mov_b32 v162, v148
v_mov_b32 v163, v149
v_mfma_f32_16x16x32_bf16 v[88:91], v[48:51], a[104:107], v[88:91]
buffer_load_dwordx4 a[180:183], v4, s[8:11], s48 offen offset:3072 sc1
v_mfma_f32_16x16x32_bf16 v[88:91], v[52:55], a[120:123], v[88:91]
ds_read_b128 v[76:79], v2 offset:31744
v_mov_b32 v164, v152
v_mfma_f32_16x16x32_bf16 v[92:95], v[48:51], a[108:111], v[92:95]
v_mov_b32 v165, v153
v_mov_b32 v166, v156
v_mfma_f32_16x16x32_bf16 v[92:95], v[52:55], a[124:127], v[92:95]
v_mov_b32 v167, v157
s_waitcnt lgkmcnt(4)
v_mfma_f32_16x16x32_bf16 v[96:99], v[56:59], a[96:99], v[96:99]
buffer_load_dwordx4 a[184:187], v5, s[8:11], s48 offen offset:3072 sc1
v_mfma_f32_16x16x32_bf16 v[96:99], v[60:63], a[112:115], v[96:99]
v_permlane32_swap_b32 v144, v160
v_permlane32_swap_b32 v145, v161
v_mfma_f32_16x16x32_bf16 v[100:103], v[56:59], a[100:103], v[100:103]
ds_read_b128 v[48:51], v2 offset:32768
v_permlane32_swap_b32 v148, v162
v_mfma_f32_16x16x32_bf16 v[100:103], v[60:63], a[116:119], v[100:103]
v_permlane32_swap_b32 v149, v163
v_permlane32_swap_b32 v152, v164
v_mfma_f32_16x16x32_bf16 v[104:107], v[56:59], a[104:107], v[104:107]
buffer_load_dwordx4 a[188:191], v6, s[8:11], s48 offen offset:3072 sc1
v_mfma_f32_16x16x32_bf16 v[104:107], v[60:63], a[120:123], v[104:107]
ds_read_b128 v[52:55], v2 offset:33792
s_add_u32 s48, s20, 12288
v_mfma_f32_16x16x32_bf16 v[108:111], v[56:59], a[108:111], v[108:111]
v_permlane32_swap_b32 v153, v165
v_permlane32_swap_b32 v156, v166
v_mfma_f32_16x16x32_bf16 v[108:111], v[60:63], a[124:127], v[108:111]
v_permlane32_swap_b32 v157, v167
s_waitcnt lgkmcnt(4)
v_mfma_f32_16x16x32_bf16 v[112:115], v[64:67], a[96:99], v[112:115]
buffer_load_dwordx4 a[192:195], v2, s[8:11], s48 offen offset:0 sc1
v_mfma_f32_16x16x32_bf16 v[112:115], v[68:71], a[112:115], v[112:115]
v_add_f32 v144, v144, v160
v_add_f32 v145, v145, v161
v_mfma_f32_16x16x32_bf16 v[116:119], v[64:67], a[100:103], v[116:119]
ds_read_b128 v[56:59], v2 offset:34816
v_add_f32 v148, v148, v162
v_mfma_f32_16x16x32_bf16 v[116:119], v[68:71], a[116:119], v[116:119]
v_add_f32 v149, v149, v163
v_add_f32 v152, v152, v164
v_mfma_f32_16x16x32_bf16 v[120:123], v[64:67], a[104:107], v[120:123]
buffer_load_dwordx4 a[196:199], v4, s[8:11], s48 offen offset:0 sc1
v_mfma_f32_16x16x32_bf16 v[120:123], v[68:71], a[120:123], v[120:123]
ds_read_b128 v[60:63], v2 offset:35840
v_add_f32 v153, v153, v165
v_mfma_f32_16x16x32_bf16 v[124:127], v[64:67], a[108:111], v[124:127]
v_add_f32 v156, v156, v166
v_add_f32 v157, v157, v167
v_mfma_f32_16x16x32_bf16 v[124:127], v[68:71], a[124:127], v[124:127]
v_mul_f32 v144, 0x3ae38e39, v144
s_waitcnt lgkmcnt(4)
v_mfma_f32_16x16x32_bf16 v[128:131], v[72:75], a[96:99], v[128:131]
buffer_load_dwordx4 a[200:203], v5, s[8:11], s48 offen offset:0 sc1
v_mfma_f32_16x16x32_bf16 v[128:131], v[76:79], a[112:115], v[128:131]
v_mul_f32 v148, 0x3ae38e39, v148
v_mul_f32 v152, 0x3ae38e39, v152
v_mfma_f32_16x16x32_bf16 v[132:135], v[72:75], a[100:103], v[132:135]
ds_read_b128 v[64:67], v2 offset:36864
v_mul_f32 v156, 0x3ae38e39, v156
v_mfma_f32_16x16x32_bf16 v[132:135], v[76:79], a[116:119], v[132:135]
v_mul_f32 v145, 0x3ae38e39, v145
v_mul_f32 v149, 0x3ae38e39, v149
v_mfma_f32_16x16x32_bf16 v[136:139], v[72:75], a[104:107], v[136:139]
buffer_load_dwordx4 a[204:207], v6, s[8:11], s48 offen offset:0 sc1
v_mfma_f32_16x16x32_bf16 v[136:139], v[76:79], a[120:123], v[136:139]
ds_read_b128 v[68:71], v2 offset:37888
v_mul_f32 v153, 0x3ae38e39, v153
v_mfma_f32_16x16x32_bf16 v[140:143], v[72:75], a[108:111], v[140:143]
v_mul_f32 v157, 0x3ae38e39, v157
v_fma_f32 v145, -v144, v144, v145
v_mfma_f32_16x16x32_bf16 v[140:143], v[76:79], a[124:127], v[140:143]
v_fma_f32 v149, -v148, v148, v149
s_waitcnt vmcnt(12)
s_waitcnt lgkmcnt(4)
v_mfma_f32_16x16x32_bf16 v[80:83], v[48:51], a[128:131], v[80:83]
buffer_load_dwordx4 a[208:211], v2, s[8:11], s48 offen offset:1024 sc1
v_mfma_f32_16x16x32_bf16 v[80:83], v[52:55], a[144:147], v[80:83]
v_fma_f32 v153, -v152, v152, v153
v_fma_f32 v157, -v156, v156, v157
v_mfma_f32_16x16x32_bf16 v[84:87], v[48:51], a[132:135], v[84:87]
ds_read_b128 v[72:75], v2 offset:38912
v_max_f32 v145, 0, v145
v_mfma_f32_16x16x32_bf16 v[84:87], v[52:55], a[148:151], v[84:87]
v_max_f32 v149, 0, v149
v_max_f32 v153, 0, v153
v_mfma_f32_16x16x32_bf16 v[88:91], v[48:51], a[136:139], v[88:91]
buffer_load_dwordx4 a[212:215], v4, s[8:11], s48 offen offset:1024 sc1
v_mfma_f32_16x16x32_bf16 v[88:91], v[52:55], a[152:155], v[88:91]
ds_read_b128 v[76:79], v2 offset:39936
v_max_f32 v157, 0, v157
v_mfma_f32_16x16x32_bf16 v[92:95], v[48:51], a[140:143], v[92:95]
v_add_f32 v234, 0x3727c5ac, v145
v_add_f32 v237, 0x3727c5ac, v149
v_mfma_f32_16x16x32_bf16 v[92:95], v[52:55], a[156:159], v[92:95]
v_add_f32 v240, 0x3727c5ac, v153
s_waitcnt lgkmcnt(4)
v_mfma_f32_16x16x32_bf16 v[96:99], v[56:59], a[128:131], v[96:99]
buffer_load_dwordx4 a[216:219], v5, s[8:11], s48 offen offset:1024 sc1
v_mfma_f32_16x16x32_bf16 v[96:99], v[60:63], a[144:147], v[96:99]
v_add_f32 v243, 0x3727c5ac, v157
v_mfma_f32_16x16x32_bf16 v[100:103], v[56:59], a[132:135], v[100:103]
ds_read_b128 v[48:51], v2 offset:40960
v_mfma_f32_16x16x32_bf16 v[100:103], v[60:63], a[148:151], v[100:103]
v_rsq_f32 v144, v234
v_mfma_f32_16x16x32_bf16 v[104:107], v[56:59], a[136:139], v[104:107]
buffer_load_dwordx4 a[220:223], v6, s[8:11], s48 offen offset:1024 sc1
v_mfma_f32_16x16x32_bf16 v[104:107], v[60:63], a[152:155], v[104:107]
ds_read_b128 v[52:55], v2 offset:41984
v_mul_f32 v232, 0xc0135761, v144
v_mfma_f32_16x16x32_bf16 v[108:111], v[56:59], a[140:143], v[108:111]
v_rsq_f32 v148, v237
v_mfma_f32_16x16x32_bf16 v[108:111], v[60:63], a[156:159], v[108:111]
v_mul_f32 v235, 0xc0135761, v148
s_waitcnt lgkmcnt(4)
v_mfma_f32_16x16x32_bf16 v[112:115], v[64:67], a[128:131], v[112:115]
buffer_load_dwordx4 a[224:227], v2, s[8:11], s48 offen offset:2048 sc1
v_mfma_f32_16x16x32_bf16 v[112:115], v[68:71], a[144:147], v[112:115]
v_rsq_f32 v152, v240
v_mfma_f32_16x16x32_bf16 v[116:119], v[64:67], a[132:135], v[116:119]
ds_read_b128 v[56:59], v2 offset:43008
v_mul_f32 v238, 0xc0135761, v152
v_mfma_f32_16x16x32_bf16 v[116:119], v[68:71], a[148:151], v[116:119]
v_rsq_f32 v156, v243
v_mfma_f32_16x16x32_bf16 v[120:123], v[64:67], a[136:139], v[120:123]
buffer_load_dwordx4 a[228:231], v4, s[8:11], s48 offen offset:2048 sc1
v_mfma_f32_16x16x32_bf16 v[120:123], v[68:71], a[152:155], v[120:123]
ds_read_b128 v[60:63], v2 offset:44032
v_mul_f32 v241, 0xc0135761, v156
v_mfma_f32_16x16x32_bf16 v[124:127], v[64:67], a[140:143], v[124:127]
v_mul_f32 v145, v144, v144
v_mul_f32 v149, v148, v148
v_mfma_f32_16x16x32_bf16 v[124:127], v[68:71], a[156:159], v[124:127]
v_mul_f32 v153, v152, v152
s_waitcnt lgkmcnt(4)
v_mfma_f32_16x16x32_bf16 v[128:131], v[72:75], a[128:131], v[128:131]
buffer_load_dwordx4 a[232:235], v5, s[8:11], s48 offen offset:2048 sc1
v_mfma_f32_16x16x32_bf16 v[128:131], v[76:79], a[144:147], v[128:131]
v_mul_f32 v157, v156, v156
v_mul_f32 v145, v145, v144
v_mfma_f32_16x16x32_bf16 v[132:135], v[72:75], a[132:135], v[132:135]
ds_read_b128 v[64:67], v2 offset:45056
v_mul_f32 v149, v149, v148
v_mfma_f32_16x16x32_bf16 v[132:135], v[76:79], a[148:151], v[132:135]
v_mul_f32 v153, v153, v152
v_mul_f32 v157, v157, v156
v_mfma_f32_16x16x32_bf16 v[136:139], v[72:75], a[136:139], v[136:139]
buffer_load_dwordx4 a[236:239], v6, s[8:11], s48 offen offset:2048 sc1
v_mfma_f32_16x16x32_bf16 v[136:139], v[76:79], a[152:155], v[136:139]
ds_read_b128 v[68:71], v2 offset:46080
v_mul_f32 v233, 0xbdd2d3e8, v145
v_mfma_f32_16x16x32_bf16 v[140:143], v[72:75], a[140:143], v[140:143]
v_mul_f32 v236, 0xbdd2d3e8, v149
v_mul_f32 v239, 0xbdd2d3e8, v153
v_mfma_f32_16x16x32_bf16 v[140:143], v[76:79], a[156:159], v[140:143]
v_mul_f32 v242, 0xbdd2d3e8, v157
s_waitcnt vmcnt(12)
s_waitcnt lgkmcnt(4)
v_mfma_f32_16x16x32_bf16 v[80:83], v[48:51], a[160:163], v[80:83]
buffer_load_dwordx4 a[240:243], v2, s[8:11], s48 offen offset:3072 sc1
v_mfma_f32_16x16x32_bf16 v[80:83], v[52:55], a[176:179], v[80:83]
v_mfma_f32_16x16x32_bf16 v[84:87], v[48:51], a[164:167], v[84:87]
ds_read_b128 v[72:75], v2 offset:47104
v_mfma_f32_16x16x32_bf16 v[84:87], v[52:55], a[180:183], v[84:87]
v_mfma_f32_16x16x32_bf16 v[88:91], v[48:51], a[168:171], v[88:91]
buffer_load_dwordx4 a[244:247], v4, s[8:11], s48 offen offset:3072 sc1
v_mfma_f32_16x16x32_bf16 v[88:91], v[52:55], a[184:187], v[88:91]
ds_read_b128 v[76:79], v2 offset:48128
v_mfma_f32_16x16x32_bf16 v[92:95], v[48:51], a[172:175], v[92:95]
v_mfma_f32_16x16x32_bf16 v[92:95], v[52:55], a[188:191], v[92:95]
s_waitcnt lgkmcnt(4)
v_mfma_f32_16x16x32_bf16 v[96:99], v[56:59], a[160:163], v[96:99]
buffer_load_dwordx4 a[248:251], v5, s[8:11], s48 offen offset:3072 sc1
v_mfma_f32_16x16x32_bf16 v[96:99], v[60:63], a[176:179], v[96:99]
s_barrier
v_mfma_f32_16x16x32_bf16 v[100:103], v[56:59], a[164:167], v[100:103]
ds_read_b128 v[48:51], v2 offset:49152
v_mfma_f32_16x16x32_bf16 v[100:103], v[60:63], a[180:183], v[100:103]
v_mfma_f32_16x16x32_bf16 v[104:107], v[56:59], a[168:171], v[104:107]
buffer_load_dwordx4 a[252:255], v6, s[8:11], s48 offen offset:3072 sc1
v_mfma_f32_16x16x32_bf16 v[104:107], v[60:63], a[184:187], v[104:107]
ds_read_b128 v[52:55], v2 offset:50176
s_add_u32 s48, s20, 16384
v_mfma_f32_16x16x32_bf16 v[108:111], v[56:59], a[172:175], v[108:111]
v_mfma_f32_16x16x32_bf16 v[108:111], v[60:63], a[188:191], v[108:111]
s_waitcnt lgkmcnt(4)
v_mfma_f32_16x16x32_bf16 v[112:115], v[64:67], a[160:163], v[112:115]
buffer_load_dwordx4 v[16:19], v2, s[8:11], s48 offen offset:0 sc1
v_mfma_f32_16x16x32_bf16 v[112:115], v[68:71], a[176:179], v[112:115]
v_mfma_f32_16x16x32_bf16 v[116:119], v[64:67], a[164:167], v[116:119]
ds_read_b128 v[56:59], v2 offset:51200
v_mfma_f32_16x16x32_bf16 v[116:119], v[68:71], a[180:183], v[116:119]
v_mfma_f32_16x16x32_bf16 v[120:123], v[64:67], a[168:171], v[120:123]
buffer_load_dwordx4 v[20:23], v4, s[8:11], s48 offen offset:0 sc1
v_mfma_f32_16x16x32_bf16 v[120:123], v[68:71], a[184:187], v[120:123]
ds_read_b128 v[60:63], v2 offset:52224
v_mfma_f32_16x16x32_bf16 v[124:127], v[64:67], a[172:175], v[124:127]
v_mfma_f32_16x16x32_bf16 v[124:127], v[68:71], a[188:191], v[124:127]
s_waitcnt lgkmcnt(4)
v_mfma_f32_16x16x32_bf16 v[128:131], v[72:75], a[160:163], v[128:131]
buffer_load_dwordx4 v[24:27], v5, s[8:11], s48 offen offset:0 sc1
v_mfma_f32_16x16x32_bf16 v[128:131], v[76:79], a[176:179], v[128:131]
v_mfma_f32_16x16x32_bf16 v[132:135], v[72:75], a[164:167], v[132:135]
ds_read_b128 v[64:67], v2 offset:53248
v_mfma_f32_16x16x32_bf16 v[132:135], v[76:79], a[180:183], v[132:135]
v_mfma_f32_16x16x32_bf16 v[136:139], v[72:75], a[168:171], v[136:139]
buffer_load_dwordx4 v[28:31], v6, s[8:11], s48 offen offset:0 sc1
v_mfma_f32_16x16x32_bf16 v[136:139], v[76:79], a[184:187], v[136:139]
ds_read_b128 v[68:71], v2 offset:54272
v_mfma_f32_16x16x32_bf16 v[140:143], v[72:75], a[172:175], v[140:143]
v_mfma_f32_16x16x32_bf16 v[140:143], v[76:79], a[188:191], v[140:143]
s_waitcnt vmcnt(12)
s_waitcnt lgkmcnt(4)
v_mfma_f32_16x16x32_bf16 v[80:83], v[48:51], a[192:195], v[80:83]
buffer_load_dwordx4 v[32:35], v2, s[8:11], s48 offen offset:1024 sc1
v_mfma_f32_16x16x32_bf16 v[80:83], v[52:55], a[208:211], v[80:83]
v_mfma_f32_16x16x32_bf16 v[84:87], v[48:51], a[196:199], v[84:87]
ds_read_b128 v[72:75], v2 offset:55296
v_mfma_f32_16x16x32_bf16 v[84:87], v[52:55], a[212:215], v[84:87]
v_mfma_f32_16x16x32_bf16 v[88:91], v[48:51], a[200:203], v[88:91]
buffer_load_dwordx4 v[36:39], v4, s[8:11], s48 offen offset:1024 sc1
v_mfma_f32_16x16x32_bf16 v[88:91], v[52:55], a[216:219], v[88:91]
ds_read_b128 v[76:79], v2 offset:56320
v_mfma_f32_16x16x32_bf16 v[92:95], v[48:51], a[204:207], v[92:95]
v_mfma_f32_16x16x32_bf16 v[92:95], v[52:55], a[220:223], v[92:95]
s_waitcnt lgkmcnt(4)
v_mfma_f32_16x16x32_bf16 v[96:99], v[56:59], a[192:195], v[96:99]
buffer_load_dwordx4 v[40:43], v5, s[8:11], s48 offen offset:1024 sc1
v_mfma_f32_16x16x32_bf16 v[96:99], v[60:63], a[208:211], v[96:99]
v_mfma_f32_16x16x32_bf16 v[100:103], v[56:59], a[196:199], v[100:103]
ds_read_b128 v[48:51], v2 offset:57344
v_mfma_f32_16x16x32_bf16 v[100:103], v[60:63], a[212:215], v[100:103]
v_mfma_f32_16x16x32_bf16 v[104:107], v[56:59], a[200:203], v[104:107]
buffer_load_dwordx4 v[44:47], v6, s[8:11], s48 offen offset:1024 sc1
v_mfma_f32_16x16x32_bf16 v[104:107], v[60:63], a[216:219], v[104:107]
ds_read_b128 v[52:55], v2 offset:58368
s_add_u32 m0, s22, 98304
v_mfma_f32_16x16x32_bf16 v[108:111], v[56:59], a[204:207], v[108:111]
v_add_u32 v3, 20480, v3
v_mfma_f32_16x16x32_bf16 v[108:111], v[60:63], a[220:223], v[108:111]
s_waitcnt lgkmcnt(4)
v_mfma_f32_16x16x32_bf16 v[112:115], v[64:67], a[192:195], v[112:115]
buffer_load_dwordx4 v3, s[8:11], 0 offen offset:0 lds
v_mfma_f32_16x16x32_bf16 v[112:115], v[68:71], a[208:211], v[112:115]
v_mfma_f32_16x16x32_bf16 v[116:119], v[64:67], a[196:199], v[116:119]
ds_read_b128 v[56:59], v2 offset:59392
v_mfma_f32_16x16x32_bf16 v[116:119], v[68:71], a[212:215], v[116:119]
v_mfma_f32_16x16x32_bf16 v[120:123], v[64:67], a[200:203], v[120:123]
buffer_load_dwordx4 v3, s[8:11], 0 offen offset:1024 lds
v_mfma_f32_16x16x32_bf16 v[120:123], v[68:71], a[216:219], v[120:123]
ds_read_b128 v[60:63], v2 offset:60416
v_mfma_f32_16x16x32_bf16 v[124:127], v[64:67], a[204:207], v[124:127]
v_mfma_f32_16x16x32_bf16 v[124:127], v[68:71], a[220:223], v[124:127]
s_waitcnt lgkmcnt(4)
v_mfma_f32_16x16x32_bf16 v[128:131], v[72:75], a[192:195], v[128:131]
buffer_load_dwordx4 v3, s[8:11], 0 offen offset:2048 lds
v_mfma_f32_16x16x32_bf16 v[128:131], v[76:79], a[208:211], v[128:131]
v_mfma_f32_16x16x32_bf16 v[132:135], v[72:75], a[196:199], v[132:135]
ds_read_b128 v[64:67], v2 offset:61440
v_mfma_f32_16x16x32_bf16 v[132:135], v[76:79], a[212:215], v[132:135]
v_mfma_f32_16x16x32_bf16 v[136:139], v[72:75], a[200:203], v[136:139]
buffer_load_dwordx4 v3, s[8:11], 0 offen offset:3072 lds
v_mfma_f32_16x16x32_bf16 v[136:139], v[76:79], a[216:219], v[136:139]
ds_read_b128 v[68:71], v2 offset:62464
s_add_u32 m0, s22, 102400
v_mfma_f32_16x16x32_bf16 v[140:143], v[72:75], a[204:207], v[140:143]
v_add_u32 v3, 4096, v3
v_mfma_f32_16x16x32_bf16 v[140:143], v[76:79], a[220:223], v[140:143]
s_waitcnt vmcnt(12)
s_waitcnt lgkmcnt(4)
v_mfma_f32_16x16x32_bf16 v[80:83], v[48:51], a[224:227], v[80:83]
buffer_load_dwordx4 v3, s[8:11], 0 offen offset:0 lds
v_mfma_f32_16x16x32_bf16 v[80:83], v[52:55], a[240:243], v[80:83]
v_mfma_f32_16x16x32_bf16 v[84:87], v[48:51], a[228:231], v[84:87]
ds_read_b128 v[72:75], v2 offset:63488
v_mfma_f32_16x16x32_bf16 v[84:87], v[52:55], a[244:247], v[84:87]
v_mfma_f32_16x16x32_bf16 v[88:91], v[48:51], a[232:235], v[88:91]
buffer_load_dwordx4 v3, s[8:11], 0 offen offset:1024 lds
v_mfma_f32_16x16x32_bf16 v[88:91], v[52:55], a[248:251], v[88:91]
ds_read_b128 v[76:79], v2 offset:64512
s_add_u32 m0, s22, 122880
v_mfma_f32_16x16x32_bf16 v[92:95], v[48:51], a[236:239], v[92:95]
v_add_u32 v3, 20480, v3
v_mfma_f32_16x16x32_bf16 v[92:95], v[52:55], a[252:255], v[92:95]
s_waitcnt lgkmcnt(4)
v_mfma_f32_16x16x32_bf16 v[96:99], v[56:59], a[224:227], v[96:99]
buffer_load_dwordx4 v3, s[8:11], 0 offen offset:0 lds
v_mfma_f32_16x16x32_bf16 v[96:99], v[60:63], a[240:243], v[96:99]
v_mfma_f32_16x16x32_bf16 v[100:103], v[56:59], a[228:231], v[100:103]
ds_read_b128 v[48:51], v7 offset:0
v_mfma_f32_16x16x32_bf16 v[100:103], v[60:63], a[244:247], v[100:103]
v_mfma_f32_16x16x32_bf16 v[104:107], v[56:59], a[232:235], v[104:107]
buffer_load_dwordx4 v3, s[8:11], 0 offen offset:1024 lds
v_mfma_f32_16x16x32_bf16 v[104:107], v[60:63], a[248:251], v[104:107]
ds_read_b128 v[52:55], v7 offset:1024
v_mfma_f32_16x16x32_bf16 v[108:111], v[56:59], a[236:239], v[108:111]
v_mfma_f32_16x16x32_bf16 v[108:111], v[60:63], a[252:255], v[108:111]
s_waitcnt lgkmcnt(4)
v_mfma_f32_16x16x32_bf16 v[112:115], v[64:67], a[224:227], v[112:115]
buffer_load_dwordx4 v3, s[8:11], 0 offen offset:2048 lds
v_mfma_f32_16x16x32_bf16 v[112:115], v[68:71], a[240:243], v[112:115]
v_mfma_f32_16x16x32_bf16 v[116:119], v[64:67], a[228:231], v[116:119]
ds_read_b128 v[56:59], v7 offset:2048
v_mfma_f32_16x16x32_bf16 v[116:119], v[68:71], a[244:247], v[116:119]
v_mfma_f32_16x16x32_bf16 v[120:123], v[64:67], a[232:235], v[120:123]
buffer_load_dwordx4 v3, s[8:11], 0 offen offset:3072 lds
v_mfma_f32_16x16x32_bf16 v[120:123], v[68:71], a[248:251], v[120:123]
ds_read_b128 v[60:63], v7 offset:3072
s_add_u32 m0, s22, 126976
v_mfma_f32_16x16x32_bf16 v[124:127], v[64:67], a[236:239], v[124:127]
v_add_u32 v3, 4096, v3
v_mfma_f32_16x16x32_bf16 v[124:127], v[68:71], a[252:255], v[124:127]
s_waitcnt lgkmcnt(4)
v_mfma_f32_16x16x32_bf16 v[128:131], v[72:75], a[224:227], v[128:131]
buffer_load_dwordx4 v3, s[8:11], 0 offen offset:0 lds
v_mfma_f32_16x16x32_bf16 v[128:131], v[76:79], a[240:243], v[128:131]
v_mfma_f32_16x16x32_bf16 v[132:135], v[72:75], a[228:231], v[132:135]
ds_read_b128 v[64:67], v7 offset:4096
v_mfma_f32_16x16x32_bf16 v[132:135], v[76:79], a[244:247], v[132:135]
v_mfma_f32_16x16x32_bf16 v[136:139], v[72:75], a[232:235], v[136:139]
buffer_load_dwordx4 v3, s[8:11], 0 offen offset:1024 lds
v_mfma_f32_16x16x32_bf16 v[136:139], v[76:79], a[248:251], v[136:139]
ds_read_b128 v[68:71], v7 offset:5120
s_add_u32 m0, s22, 0
v_mfma_f32_16x16x32_bf16 v[140:143], v[72:75], a[236:239], v[140:143]
v_add_u32 v3, 20480, v3
v_mfma_f32_16x16x32_bf16 v[140:143], v[76:79], a[252:255], v[140:143]
s_waitcnt vmcnt(12)
s_waitcnt lgkmcnt(4)
v_mfma_f32_16x16x32_bf16 v[80:83], v[48:51], v[16:19], v[80:83]
buffer_load_dwordx4 v3, s[8:11], 0 offen offset:0 lds
v_mfma_f32_16x16x32_bf16 v[80:83], v[52:55], v[32:35], v[80:83]
v_mfma_f32_16x16x32_bf16 v[84:87], v[48:51], v[20:23], v[84:87]
ds_read_b128 v[72:75], v7 offset:6144
v_mfma_f32_16x16x32_bf16 v[84:87], v[52:55], v[36:39], v[84:87]
v_mfma_f32_16x16x32_bf16 v[88:91], v[48:51], v[24:27], v[88:91]
buffer_load_dwordx4 v3, s[8:11], 0 offen offset:1024 lds
v_mfma_f32_16x16x32_bf16 v[88:91], v[52:55], v[40:43], v[88:91]
ds_read_b128 v[76:79], v7 offset:7168
v_mfma_f32_16x16x32_bf16 v[92:95], v[48:51], v[28:31], v[92:95]
v_mfma_f32_16x16x32_bf16 v[92:95], v[52:55], v[44:47], v[92:95]
s_waitcnt lgkmcnt(4)
v_mfma_f32_16x16x32_bf16 v[96:99], v[56:59], v[16:19], v[96:99]
buffer_load_dwordx4 v3, s[8:11], 0 offen offset:2048 lds
v_mfma_f32_16x16x32_bf16 v[96:99], v[60:63], v[32:35], v[96:99]
s_barrier
v_mfma_f32_16x16x32_bf16 v[100:103], v[56:59], v[20:23], v[100:103]
ds_read_b128 v[48:51], v7 offset:8192
v_mfma_f32_16x16x32_bf16 v[100:103], v[60:63], v[36:39], v[100:103]
v_mfma_f32_16x16x32_bf16 v[104:107], v[56:59], v[24:27], v[104:107]
buffer_load_dwordx4 v3, s[8:11], 0 offen offset:3072 lds
v_mfma_f32_16x16x32_bf16 v[104:107], v[60:63], v[40:43], v[104:107]
ds_read_b128 v[52:55], v7 offset:9216
s_add_u32 m0, s22, 4096
v_mfma_f32_16x16x32_bf16 v[108:111], v[56:59], v[28:31], v[108:111]
v_add_u32 v3, 4096, v3
v_mfma_f32_16x16x32_bf16 v[108:111], v[60:63], v[44:47], v[108:111]
s_waitcnt lgkmcnt(4)
v_mfma_f32_16x16x32_bf16 v[112:115], v[64:67], v[16:19], v[112:115]
buffer_load_dwordx4 v3, s[8:11], 0 offen offset:0 lds
v_mfma_f32_16x16x32_bf16 v[112:115], v[68:71], v[32:35], v[112:115]
v_mfma_f32_16x16x32_bf16 v[116:119], v[64:67], v[20:23], v[116:119]
ds_read_b128 v[56:59], v7 offset:10240
v_mfma_f32_16x16x32_bf16 v[116:119], v[68:71], v[36:39], v[116:119]
v_mfma_f32_16x16x32_bf16 v[120:123], v[64:67], v[24:27], v[120:123]
buffer_load_dwordx4 v3, s[8:11], 0 offen offset:1024 lds
v_mfma_f32_16x16x32_bf16 v[120:123], v[68:71], v[40:43], v[120:123]
ds_read_b128 v[60:63], v7 offset:11264
s_add_u32 m0, s22, 24576
v_mfma_f32_16x16x32_bf16 v[124:127], v[64:67], v[28:31], v[124:127]
v_add_u32 v3, 20480, v3
v_mfma_f32_16x16x32_bf16 v[124:127], v[68:71], v[44:47], v[124:127]
s_waitcnt lgkmcnt(4)
v_mfma_f32_16x16x32_bf16 v[128:131], v[72:75], v[16:19], v[128:131]
buffer_load_dwordx4 v3, s[8:11], 0 offen offset:0 lds
v_mfma_f32_16x16x32_bf16 v[128:131], v[76:79], v[32:35], v[128:131]
v_mfma_f32_16x16x32_bf16 v[132:135], v[72:75], v[20:23], v[132:135]
ds_read_b128 v[64:67], v7 offset:12288
v_mfma_f32_16x16x32_bf16 v[132:135], v[76:79], v[36:39], v[132:135]
v_mfma_f32_16x16x32_bf16 v[136:139], v[72:75], v[24:27], v[136:139]
buffer_load_dwordx4 v3, s[8:11], 0 offen offset:1024 lds
v_mfma_f32_16x16x32_bf16 v[136:139], v[76:79], v[40:43], v[136:139]
ds_read_b128 v[68:71], v7 offset:13312
v_mfma_f32_16x16x32_bf16 v[140:143], v[72:75], v[28:31], v[140:143]
v_mfma_f32_16x16x32_bf16 v[140:143], v[76:79], v[44:47], v[140:143]
s_waitcnt lgkmcnt(4)
v_mfma_f32_16x16x32_bf16 v[176:179], v[48:51], a[0:3], 0
buffer_load_dwordx4 v3, s[8:11], 0 offen offset:2048 lds
v_mfma_f32_16x16x32_bf16 v[176:179], v[52:55], a[16:19], v[176:179]
v_mfma_f32_16x16x32_bf16 v[180:183], v[48:51], a[4:7], 0
ds_read_b128 v[72:75], v7 offset:14336
v_mfma_f32_16x16x32_bf16 v[180:183], v[52:55], a[20:23], v[180:183]
v_mul_f32 v208, v80, v80
v_mul_f32 v210, v81, v81
v_mfma_f32_16x16x32_bf16 v[184:187], v[48:51], a[8:11], 0
buffer_load_dwordx4 v3, s[8:11], 0 offen offset:3072 lds
v_mfma_f32_16x16x32_bf16 v[184:187], v[52:55], a[24:27], v[184:187]
ds_read_b128 v[76:79], v7 offset:15360
s_add_u32 m0, s22, 28672
v_mfma_f32_16x16x32_bf16 v[188:191], v[48:51], a[12:15], 0
v_add_u32 v3, 4096, v3
v_fma_f32 v208, v208, v233, v232
v_mfma_f32_16x16x32_bf16 v[188:191], v[52:55], a[28:31], v[188:191]
v_fma_f32 v210, v210, v233, v232
s_waitcnt lgkmcnt(4)
v_mfma_f32_16x16x32_bf16 v[192:195], v[56:59], a[0:3], 0
buffer_load_dwordx4 v3, s[8:11], 0 offen offset:0 lds
v_mfma_f32_16x16x32_bf16 v[192:195], v[60:63], a[16:19], v[192:195]
v_mul_f32 v208, v208, v80
v_mul_f32 v210, v210, v81
v_mfma_f32_16x16x32_bf16 v[196:199], v[56:59], a[4:7], 0
ds_read_b128 v[48:51], v7 offset:16384
v_mul_f32 v209, v80, v96
v_mfma_f32_16x16x32_bf16 v[196:199], v[60:63], a[20:23], v[196:199]
v_exp_f32 v208, v208
v_mfma_f32_16x16x32_bf16 v[200:203], v[56:59], a[8:11], 0
buffer_load_dwordx4 v3, s[8:11], 0 offen offset:1024 lds
v_mfma_f32_16x16x32_bf16 v[200:203], v[60:63], a[24:27], v[200:203]
ds_read_b128 v[52:55], v7 offset:17408
v_mul_f32 v211, v81, v97
v_mfma_f32_16x16x32_bf16 v[204:207], v[56:59], a[12:15], 0
v_exp_f32 v210, v210
v_mfma_f32_16x16x32_bf16 v[204:207], v[60:63], a[28:31], v[204:207]
v_fma_f32 v208, v208, v234, v234
s_waitcnt lgkmcnt(4)
v_mfma_f32_16x16x32_bf16 v[176:179], v[64:67], a[32:35], v[176:179]
v_fma_f32 v210, v210, v234, v234
v_mul_f32 v212, v82, v82
v_mfma_f32_16x16x32_bf16 v[176:179], v[68:71], a[48:51], v[176:179]
v_rcp_f32 v208, v208
v_mfma_f32_16x16x32_bf16 v[180:183], v[64:67], a[36:39], v[180:183]
ds_read_b128 v[56:59], v7 offset:18432
v_mul_f32 v209, v209, v208
v_mfma_f32_16x16x32_bf16 v[180:183], v[68:71], a[52:55], v[180:183]
v_rcp_f32 v210, v210
v_mfma_f32_16x16x32_bf16 v[184:187], v[64:67], a[40:43], v[184:187]
v_mul_f32 v211, v211, v210
v_cvt_pk_bf16_f32 v224, v209, v211
v_mfma_f32_16x16x32_bf16 v[184:187], v[68:71], a[56:59], v[184:187]
ds_read_b128 v[60:63], v7 offset:19456
v_mul_f32 v214, v83, v83
v_mfma_f32_16x16x32_bf16 v[188:191], v[64:67], a[44:47], v[188:191]
v_fma_f32 v212, v212, v233, v232
v_fma_f32 v214, v214, v233, v232
v_mfma_f32_16x16x32_bf16 v[188:191], v[68:71], a[60:63], v[188:191]
v_mul_f32 v212, v212, v82
s_waitcnt lgkmcnt(4)
v_mfma_f32_16x16x32_bf16 v[192:195], v[72:75], a[32:35], v[192:195]
v_mul_f32 v214, v214, v83
v_mul_f32 v213, v82, v98
v_mfma_f32_16x16x32_bf16 v[192:195], v[76:79], a[48:51], v[192:195]
v_exp_f32 v212, v212
v_mfma_f32_16x16x32_bf16 v[196:199], v[72:75], a[36:39], v[196:199]
ds_read_b128 v[64:67], v7 offset:20480
v_mul_f32 v215, v83, v99
v_mfma_f32_16x16x32_bf16 v[196:199], v[76:79], a[52:55], v[196:199]
v_exp_f32 v214, v214
v_mfma_f32_16x16x32_bf16 v[200:203], v[72:75], a[40:43], v[200:203]
v_fma_f32 v212, v212, v234, v234
v_fma_f32 v214, v214, v234, v234
v_mfma_f32_16x16x32_bf16 v[200:203], v[76:79], a[56:59], v[200:203]
ds_read_b128 v[68:71], v7 offset:21504
v_mul_f32 v208, v84, v84
v_mfma_f32_16x16x32_bf16 v[204:207], v[72:75], a[44:47], v[204:207]
v_rcp_f32 v212, v212
v_mfma_f32_16x16x32_bf16 v[204:207], v[76:79], a[60:63], v[204:207]
v_mul_f32 v213, v213, v212
s_waitcnt lgkmcnt(4)
v_mfma_f32_16x16x32_bf16 v[176:179], v[48:51], a[64:67], v[176:179]
v_rcp_f32 v214, v214
v_mfma_f32_16x16x32_bf16 v[176:179], v[52:55], a[80:83], v[176:179]
v_mul_f32 v215, v215, v214
v_cvt_pk_bf16_f32 v225, v213, v215
v_mfma_f32_16x16x32_bf16 v[180:183], v[48:51], a[68:71], v[180:183]
ds_read_b128 v[72:75], v7 offset:22528
v_mul_f32 v210, v85, v85
v_mfma_f32_16x16x32_bf16 v[180:183], v[52:55], a[84:87], v[180:183]
buffer_store_dwordx2 v[224:225], v244, s[8:11], s30 offen sc1
v_mfma_f32_16x16x32_bf16 v[184:187], v[48:51], a[72:75], v[184:187]
v_fma_f32 v208, v208, v236, v235
v_fma_f32 v210, v210, v236, v235
v_mfma_f32_16x16x32_bf16 v[184:187], v[52:55], a[88:91], v[184:187]
ds_read_b128 v[76:79], v7 offset:23552
v_mul_f32 v208, v208, v84
v_mfma_f32_16x16x32_bf16 v[188:191], v[48:51], a[76:79], v[188:191]
v_mul_f32 v210, v210, v85
v_mul_f32 v209, v84, v100
v_mfma_f32_16x16x32_bf16 v[188:191], v[52:55], a[92:95], v[188:191]
v_mul_f32 v211, v85, v101
s_waitcnt lgkmcnt(4)
v_mfma_f32_16x16x32_bf16 v[192:195], v[56:59], a[64:67], v[192:195]
v_exp_f32 v208, v208
v_mfma_f32_16x16x32_bf16 v[192:195], v[60:63], a[80:83], v[192:195]
v_exp_f32 v210, v210
v_mfma_f32_16x16x32_bf16 v[196:199], v[56:59], a[68:71], v[196:199]
ds_read_b128 v[48:51], v7 offset:24576
v_fma_f32 v208, v208, v237, v237
v_mfma_f32_16x16x32_bf16 v[196:199], v[60:63], a[84:87], v[196:199]
v_fma_f32 v210, v210, v237, v237
v_mul_f32 v212, v86, v86
v_mfma_f32_16x16x32_bf16 v[200:203], v[56:59], a[72:75], v[200:203]
v_rcp_f32 v208, v208
v_mfma_f32_16x16x32_bf16 v[200:203], v[60:63], a[88:91], v[200:203]
ds_read_b128 v[52:55], v7 offset:25600
v_mul_f32 v209, v209, v208
v_mfma_f32_16x16x32_bf16 v[204:207], v[56:59], a[76:79], v[204:207]
v_rcp_f32 v210, v210
v_mfma_f32_16x16x32_bf16 v[204:207], v[60:63], a[92:95], v[204:207]
v_mul_f32 v211, v211, v210
s_waitcnt lgkmcnt(4)
v_mfma_f32_16x16x32_bf16 v[176:179], v[64:67], a[96:99], v[176:179]
v_cvt_pk_bf16_f32 v226, v209, v211
v_mul_f32 v214, v87, v87
v_mfma_f32_16x16x32_bf16 v[176:179], v[68:71], a[112:115], v[176:179]
v_fma_f32 v212, v212, v236, v235
v_fma_f32 v214, v214, v236, v235
v_mfma_f32_16x16x32_bf16 v[180:183], v[64:67], a[100:103], v[180:183]
ds_read_b128 v[56:59], v7 offset:26624
v_mul_f32 v212, v212, v86
v_mfma_f32_16x16x32_bf16 v[180:183], v[68:71], a[116:119], v[180:183]
v_mul_f32 v214, v214, v87
v_mul_f32 v213, v86, v102
v_mfma_f32_16x16x32_bf16 v[184:187], v[64:67], a[104:107], v[184:187]
v_exp_f32 v212, v212
v_mfma_f32_16x16x32_bf16 v[184:187], v[68:71], a[120:123], v[184:187]
ds_read_b128 v[60:63], v7 offset:27648
v_mul_f32 v215, v87, v103
v_mfma_f32_16x16x32_bf16 v[188:191], v[64:67], a[108:111], v[188:191]
v_exp_f32 v214, v214
v_mfma_f32_16x16x32_bf16 v[188:191], v[68:71], a[124:127], v[188:191]
v_fma_f32 v212, v212, v237, v237
s_waitcnt lgkmcnt(4)
v_mfma_f32_16x16x32_bf16 v[192:195], v[72:75], a[96:99], v[192:195]
v_fma_f32 v214, v214, v237, v237
v_mul_f32 v208, v88, v88
v_mfma_f32_16x16x32_bf16 v[192:195], v[76:79], a[112:115], v[192:195]
v_rcp_f32 v212, v212
v_mfma_f32_16x16x32_bf16 v[196:199], v[72:75], a[100:103], v[196:199]
ds_read_b128 v[64:67], v7 offset:28672
v_mul_f32 v213, v213, v212
v_mfma_f32_16x16x32_bf16 v[196:199], v[76:79], a[116:119], v[196:199]
v_rcp_f32 v214, v214
v_mfma_f32_16x16x32_bf16 v[200:203], v[72:75], a[104:107], v[200:203]
v_mul_f32 v215, v215, v214
v_cvt_pk_bf16_f32 v227, v213, v215
v_mfma_f32_16x16x32_bf16 v[200:203], v[76:79], a[120:123], v[200:203]
ds_read_b128 v[68:71], v7 offset:29696
v_mul_f32 v210, v89, v89
v_mfma_f32_16x16x32_bf16 v[204:207], v[72:75], a[108:111], v[204:207]
buffer_store_dwordx2 v[226:227], v245, s[8:11], s30 offen sc1
v_mfma_f32_16x16x32_bf16 v[204:207], v[76:79], a[124:127], v[204:207]
v_fma_f32 v208, v208, v239, v238
s_waitcnt lgkmcnt(4)
v_mfma_f32_16x16x32_bf16 v[176:179], v[48:51], a[128:131], v[176:179]
v_fma_f32 v210, v210, v239, v238
v_mul_f32 v208, v208, v88
v_mfma_f32_16x16x32_bf16 v[176:179], v[52:55], a[144:147], v[176:179]
v_mul_f32 v210, v210, v89
v_mul_f32 v209, v88, v104
v_mfma_f32_16x16x32_bf16 v[180:183], v[48:51], a[132:135], v[180:183]
ds_read_b128 v[72:75], v7 offset:30720
v_mul_f32 v211, v89, v105
v_mfma_f32_16x16x32_bf16 v[180:183], v[52:55], a[148:151], v[180:183]
v_exp_f32 v208, v208
v_mfma_f32_16x16x32_bf16 v[184:187], v[48:51], a[136:139], v[184:187]
v_exp_f32 v210, v210
v_mfma_f32_16x16x32_bf16 v[184:187], v[52:55], a[152:155], v[184:187]
ds_read_b128 v[76:79], v7 offset:31744
v_fma_f32 v208, v208, v240, v240
v_mfma_f32_16x16x32_bf16 v[188:191], v[48:51], a[140:143], v[188:191]
v_fma_f32 v210, v210, v240, v240
v_mul_f32 v212, v90, v90
v_mfma_f32_16x16x32_bf16 v[188:191], v[52:55], a[156:159], v[188:191]
v_mul_f32 v214, v91, v91
s_waitcnt lgkmcnt(4)
v_mfma_f32_16x16x32_bf16 v[192:195], v[56:59], a[128:131], v[192:195]
s_waitcnt vmcnt(20)
v_fma_f32 v212, v212, v239, v238
v_mfma_f32_16x16x32_bf16 v[192:195], v[60:63], a[144:147], v[192:195]
s_barrier
v_mfma_f32_16x16x32_bf16 v[196:199], v[56:59], a[132:135], v[196:199]
ds_read_b128 v[48:51], v7 offset:32768
s_add_u32 m0, s22, 49152
v_mfma_f32_16x16x32_bf16 v[196:199], v[60:63], a[148:151], v[196:199]
v_add_u32 v3, 20480, v3
buffer_load_dwordx4 v3, s[8:11], 0 offen offset:0 lds
v_mfma_f32_16x16x32_bf16 v[200:203], v[56:59], a[136:139], v[200:203]
v_rcp_f32 v208, v208
v_mfma_f32_16x16x32_bf16 v[200:203], v[60:63], a[152:155], v[200:203]
ds_read_b128 v[52:55], v7 offset:33792
v_mul_f32 v209, v209, v208
v_mfma_f32_16x16x32_bf16 v[204:207], v[56:59], a[140:143], v[204:207]
v_rcp_f32 v210, v210
v_mfma_f32_16x16x32_bf16 v[204:207], v[60:63], a[156:159], v[204:207]
v_mul_f32 v211, v211, v210
s_waitcnt lgkmcnt(4)
v_mfma_f32_16x16x32_bf16 v[176:179], v[64:67], a[160:163], v[176:179]
buffer_load_dwordx4 v3, s[8:11], 0 offen offset:1024 lds
v_mfma_f32_16x16x32_bf16 v[176:179], v[68:71], a[176:179], v[176:179]
v_cvt_pk_bf16_f32 v228, v209, v211
v_fma_f32 v214, v214, v239, v238
v_mfma_f32_16x16x32_bf16 v[180:183], v[64:67], a[164:167], v[180:183]
ds_read_b128 v[56:59], v7 offset:34816
v_mul_f32 v212, v212, v90
v_mfma_f32_16x16x32_bf16 v[180:183], v[68:71], a[180:183], v[180:183]
v_mul_f32 v214, v214, v91
v_mul_f32 v213, v90, v106
v_mfma_f32_16x16x32_bf16 v[184:187], v[64:67], a[168:171], v[184:187]
buffer_load_dwordx4 v3, s[8:11], 0 offen offset:2048 lds
v_mfma_f32_16x16x32_bf16 v[184:187], v[68:71], a[184:187], v[184:187]
ds_read_b128 v[60:63], v7 offset:35840
v_mul_f32 v215, v91, v107
v_mfma_f32_16x16x32_bf16 v[188:191], v[64:67], a[172:175], v[188:191]
v_exp_f32 v212, v212
v_mfma_f32_16x16x32_bf16 v[188:191], v[68:71], a[188:191], v[188:191]
v_fma_f32 v212, v212, v240, v240
s_waitcnt lgkmcnt(4)
v_mfma_f32_16x16x32_bf16 v[192:195], v[72:75], a[160:163], v[192:195]
buffer_load_dwordx4 v3, s[8:11], 0 offen offset:3072 lds
v_mfma_f32_16x16x32_bf16 v[192:195], v[76:79], a[176:179], v[192:195]
s_add_u32 m0, s22, 53248
v_add_u32 v3, 4096, v3
v_mfma_f32_16x16x32_bf16 v[196:199], v[72:75], a[164:167], v[196:199]
ds_read_b128 v[64:67], v7 offset:36864
v_mul_f32 v208, v92, v92
v_mfma_f32_16x16x32_bf16 v[196:199], v[76:79], a[180:183], v[196:199]
v_exp_f32 v214, v214
v_mfma_f32_16x16x32_bf16 v[200:203], v[72:75], a[168:171], v[200:203]
buffer_load_dwordx4 v3, s[8:11], 0 offen offset:0 lds
v_mfma_f32_16x16x32_bf16 v[200:203], v[76:79], a[184:187], v[200:203]
ds_read_b128 v[68:71], v7 offset:37888
v_fma_f32 v214, v214, v240, v240
v_mfma_f32_16x16x32_bf16 v[204:207], v[72:75], a[172:175], v[204:207]
v_rcp_f32 v212, v212
v_mfma_f32_16x16x32_bf16 v[204:207], v[76:79], a[188:191], v[204:207]
v_mul_f32 v213, v213, v212
s_waitcnt lgkmcnt(4)
v_mfma_f32_16x16x32_bf16 v[176:179], v[48:51], a[192:195], v[176:179]
buffer_load_dwordx4 v3, s[8:11], 0 offen offset:1024 lds
v_mfma_f32_16x16x32_bf16 v[176:179], v[52:55], a[208:211], v[176:179]
v_rcp_f32 v214, v214
v_mfma_f32_16x16x32_bf16 v[180:183], v[48:51], a[196:199], v[180:183]
ds_read_b128 v[72:75], v7 offset:38912
v_mul_f32 v215, v215, v214
v_mfma_f32_16x16x32_bf16 v[180:183], v[52:55], a[212:215], v[180:183]
v_cvt_pk_bf16_f32 v229, v213, v215
v_mul_f32 v210, v93, v93
v_mfma_f32_16x16x32_bf16 v[184:187], v[48:51], a[200:203], v[184:187]
buffer_store_dwordx2 v[228:229], v246, s[8:11], s30 offen sc1
v_mfma_f32_16x16x32_bf16 v[184:187], v[52:55], a[216:219], v[184:187]
ds_read_b128 v[76:79], v7 offset:39936
v_fma_f32 v208, v208, v242, v241
v_mfma_f32_16x16x32_bf16 v[188:191], v[48:51], a[204:207], v[188:191]
v_fma_f32 v210, v210, v242, v241
v_mul_f32 v208, v208, v92
v_mfma_f32_16x16x32_bf16 v[188:191], v[52:55], a[220:223], v[188:191]
v_mul_f32 v210, v210, v93
s_waitcnt lgkmcnt(4)
v_mfma_f32_16x16x32_bf16 v[192:195], v[56:59], a[192:195], v[192:195]
v_exp_f32 v208, v208
v_mfma_f32_16x16x32_bf16 v[192:195], v[60:63], a[208:211], v[192:195]
v_exp_f32 v210, v210
v_mfma_f32_16x16x32_bf16 v[196:199], v[56:59], a[196:199], v[196:199]
ds_read_b128 v[48:51], v7 offset:40960
v_mul_f32 v209, v92, v108
v_mfma_f32_16x16x32_bf16 v[196:199], v[60:63], a[212:215], v[196:199]
v_mul_f32 v211, v93, v109
v_fma_f32 v208, v208, v243, v243
v_mfma_f32_16x16x32_bf16 v[200:203], v[56:59], a[200:203], v[200:203]
v_fma_f32 v210, v210, v243, v243
v_mul_f32 v212, v94, v94
v_mfma_f32_16x16x32_bf16 v[200:203], v[60:63], a[216:219], v[200:203]
ds_read_b128 v[52:55], v7 offset:41984
v_mul_f32 v214, v95, v95
v_mfma_f32_16x16x32_bf16 v[204:207], v[56:59], a[204:207], v[204:207]
v_rcp_f32 v208, v208
v_mfma_f32_16x16x32_bf16 v[204:207], v[60:63], a[220:223], v[204:207]
v_mul_f32 v209, v209, v208
s_waitcnt lgkmcnt(4)
v_mfma_f32_16x16x32_bf16 v[176:179], v[64:67], a[224:227], v[176:179]
v_rcp_f32 v210, v210
v_mfma_f32_16x16x32_bf16 v[176:179], v[68:71], a[240:243], v[176:179]
v_mul_f32 v211, v211, v210
v_cvt_pk_bf16_f32 v230, v209, v211
v_mfma_f32_16x16x32_bf16 v[180:183], v[64:67], a[228:231], v[180:183]
ds_read_b128 v[56:59], v7 offset:43008
v_fma_f32 v212, v212, v242, v241
v_mfma_f32_16x16x32_bf16 v[180:183], v[68:71], a[244:247], v[180:183]
v_fma_f32 v214, v214, v242, v241
v_mul_f32 v212, v212, v94
v_mfma_f32_16x16x32_bf16 v[184:187], v[64:67], a[232:235], v[184:187]
v_mul_f32 v214, v214, v95
v_mul_f32 v213, v94, v110
v_mfma_f32_16x16x32_bf16 v[184:187], v[68:71], a[248:251], v[184:187]
ds_read_b128 v[60:63], v7 offset:44032
v_mul_f32 v215, v95, v111
v_mfma_f32_16x16x32_bf16 v[188:191], v[64:67], a[236:239], v[188:191]
v_exp_f32 v212, v212
v_mfma_f32_16x16x32_bf16 v[188:191], v[68:71], a[252:255], v[188:191]
v_fma_f32 v212, v212, v243, v243
s_waitcnt lgkmcnt(4)
v_mfma_f32_16x16x32_bf16 v[192:195], v[72:75], a[224:227], v[192:195]
v_exp_f32 v214, v214
v_mfma_f32_16x16x32_bf16 v[192:195], v[76:79], a[240:243], v[192:195]
v_fma_f32 v214, v214, v243, v243
v_mul_f32 v208, v112, v112
v_mfma_f32_16x16x32_bf16 v[196:199], v[72:75], a[228:231], v[196:199]
ds_read_b128 v[64:67], v7 offset:45056
v_mul_f32 v210, v113, v113
v_mfma_f32_16x16x32_bf16 v[196:199], v[76:79], a[244:247], v[196:199]
v_rcp_f32 v212, v212
v_mfma_f32_16x16x32_bf16 v[200:203], v[72:75], a[232:235], v[200:203]
v_rcp_f32 v214, v214
v_mfma_f32_16x16x32_bf16 v[200:203], v[76:79], a[248:251], v[200:203]
ds_read_b128 v[68:71], v7 offset:46080
v_mul_f32 v213, v213, v212
v_mfma_f32_16x16x32_bf16 v[204:207], v[72:75], a[236:239], v[204:207]
v_mul_f32 v215, v215, v214
v_cvt_pk_bf16_f32 v231, v213, v215
v_mfma_f32_16x16x32_bf16 v[204:207], v[76:79], a[252:255], v[204:207]
v_fma_f32 v208, v208, v233, v232
s_waitcnt lgkmcnt(4)
v_mfma_f32_16x16x32_bf16 v[176:179], v[48:51], v[16:19], v[176:179]
buffer_store_dwordx2 v[230:231], v247, s[8:11], s30 offen sc1
v_mfma_f32_16x16x32_bf16 v[176:179], v[52:55], v[32:35], v[176:179]
v_fma_f32 v210, v210, v233, v232
v_mul_f32 v208, v208, v112
v_mfma_f32_16x16x32_bf16 v[180:183], v[48:51], v[20:23], v[180:183]
ds_read_b128 v[72:75], v7 offset:47104
v_mul_f32 v210, v210, v113
v_mfma_f32_16x16x32_bf16 v[180:183], v[52:55], v[36:39], v[180:183]
v_exp_f32 v208, v208
v_mfma_f32_16x16x32_bf16 v[184:187], v[48:51], v[24:27], v[184:187]
v_exp_f32 v210, v210
v_mfma_f32_16x16x32_bf16 v[184:187], v[52:55], v[40:43], v[184:187]
ds_read_b128 v[76:79], v7 offset:48128
v_mul_f32 v209, v112, v128
v_mfma_f32_16x16x32_bf16 v[188:191], v[48:51], v[28:31], v[188:191]
v_mul_f32 v211, v113, v129
v_fma_f32 v208, v208, v234, v234
v_mfma_f32_16x16x32_bf16 v[188:191], v[52:55], v[44:47], v[188:191]
v_fma_f32 v210, v210, v234, v234
s_waitcnt lgkmcnt(4)
v_mfma_f32_16x16x32_bf16 v[192:195], v[56:59], v[16:19], v[192:195]
v_rcp_f32 v208, v208
v_mfma_f32_16x16x32_bf16 v[192:195], v[60:63], v[32:35], v[192:195]
v_rcp_f32 v210, v210
v_mfma_f32_16x16x32_bf16 v[196:199], v[56:59], v[20:23], v[196:199]
ds_read_b128 v[48:51], v7 offset:49152
v_mul_f32 v209, v209, v208
v_mfma_f32_16x16x32_bf16 v[196:199], v[60:63], v[36:39], v[196:199]
v_mul_f32 v211, v211, v210
v_cvt_pk_bf16_f32 v144, v209, v211
v_mfma_f32_16x16x32_bf16 v[200:203], v[56:59], v[24:27], v[200:203]
v_mul_f32 v212, v114, v114
v_mul_f32 v214, v115, v115
v_mfma_f32_16x16x32_bf16 v[200:203], v[60:63], v[40:43], v[200:203]
ds_read_b128 v[52:55], v7 offset:50176
v_fma_f32 v212, v212, v233, v232
v_mfma_f32_16x16x32_bf16 v[204:207], v[56:59], v[28:31], v[204:207]
v_fma_f32 v214, v214, v233, v232
v_mul_f32 v212, v212, v114
v_mfma_f32_16x16x32_bf16 v[204:207], v[60:63], v[44:47], v[204:207]
v_mul_f32 v214, v214, v115
s_waitcnt lgkmcnt(4)
v_mfma_f32_16x16x32_bf16 v[80:83], v[64:67], a[0:3], 0
v_exp_f32 v212, v212
v_mfma_f32_16x16x32_bf16 v[80:83], v[68:71], a[16:19], v[80:83]
v_exp_f32 v214, v214
v_mfma_f32_16x16x32_bf16 v[84:87], v[64:67], a[4:7], 0
ds_read_b128 v[56:59], v7 offset:51200
v_mul_f32 v213, v114, v130
v_mfma_f32_16x16x32_bf16 v[84:87], v[68:71], a[20:23], v[84:87]
v_mul_f32 v215, v115, v131
v_fma_f32 v212, v212, v234, v234
v_mfma_f32_16x16x32_bf16 v[88:91], v[64:67], a[8:11], 0
v_fma_f32 v214, v214, v234, v234
v_mul_f32 v208, v116, v116
v_mfma_f32_16x16x32_bf16 v[88:91], v[68:71], a[24:27], v[88:91]
ds_read_b128 v[60:63], v7 offset:52224
v_mul_f32 v210, v117, v117
v_mfma_f32_16x16x32_bf16 v[92:95], v[64:67], a[12:15], 0
v_rcp_f32 v212, v212
v_mfma_f32_16x16x32_bf16 v[92:95], v[68:71], a[28:31], v[92:95]
v_mul_f32 v213, v213, v212
s_waitcnt lgkmcnt(4)
v_mfma_f32_16x16x32_bf16 v[96:99], v[72:75], a[0:3], 0
v_rcp_f32 v214, v214
v_mfma_f32_16x16x32_bf16 v[96:99], v[76:79], a[16:19], v[96:99]
v_mul_f32 v215, v215, v214
v_cvt_pk_bf16_f32 v145, v213, v215
v_mfma_f32_16x16x32_bf16 v[100:103], v[72:75], a[4:7], 0
ds_read_b128 v[64:67], v7 offset:53248
v_fma_f32 v208, v208, v236, v235
v_mfma_f32_16x16x32_bf16 v[100:103], v[76:79], a[20:23], v[100:103]
v_fma_f32 v210, v210, v236, v235
v_mul_f32 v208, v208, v116
v_mfma_f32_16x16x32_bf16 v[104:107], v[72:75], a[8:11], 0
v_mul_f32 v210, v210, v117
v_mul_f32 v209, v116, v132
v_mfma_f32_16x16x32_bf16 v[104:107], v[76:79], a[24:27], v[104:107]
ds_read_b128 v[68:71], v7 offset:54272
v_mul_f32 v211, v117, v133
v_mfma_f32_16x16x32_bf16 v[108:111], v[72:75], a[12:15], 0
v_exp_f32 v208, v208
v_mfma_f32_16x16x32_bf16 v[108:111], v[76:79], a[28:31], v[108:111]
v_fma_f32 v208, v208, v237, v237
s_waitcnt lgkmcnt(4)
v_mfma_f32_16x16x32_bf16 v[80:83], v[48:51], a[32:35], v[80:83]
v_exp_f32 v210, v210
v_mfma_f32_16x16x32_bf16 v[80:83], v[52:55], a[48:51], v[80:83]
v_fma_f32 v210, v210, v237, v237
v_mul_f32 v212, v118, v118
v_mfma_f32_16x16x32_bf16 v[84:87], v[48:51], a[36:39], v[84:87]
ds_read_b128 v[72:75], v7 offset:55296
v_mul_f32 v214, v119, v119
v_mfma_f32_16x16x32_bf16 v[84:87], v[52:55], a[52:55], v[84:87]
v_rcp_f32 v208, v208
v_mfma_f32_16x16x32_bf16 v[88:91], v[48:51], a[40:43], v[88:91]
v_rcp_f32 v210, v210
v_mfma_f32_16x16x32_bf16 v[88:91], v[52:55], a[56:59], v[88:91]
ds_read_b128 v[76:79], v7 offset:56320
v_mul_f32 v209, v209, v208
v_mfma_f32_16x16x32_bf16 v[92:95], v[48:51], a[44:47], v[92:95]
v_mul_f32 v211, v211, v210
v_cvt_pk_bf16_f32 v148, v209, v211
v_mfma_f32_16x16x32_bf16 v[92:95], v[52:55], a[60:63], v[92:95]
v_fma_f32 v212, v212, v236, v235
s_waitcnt lgkmcnt(4)
v_mfma_f32_16x16x32_bf16 v[96:99], v[56:59], a[32:35], v[96:99]
s_waitcnt vmcnt(22)
v_fma_f32 v214, v214, v236, v235
v_mfma_f32_16x16x32_bf16 v[96:99], v[60:63], a[48:51], v[96:99]
s_barrier
v_mfma_f32_16x16x32_bf16 v[100:103], v[56:59], a[36:39], v[100:103]
ds_read_b128 v[48:51], v7 offset:57344
s_add_u32 m0, s22, 73728
v_mfma_f32_16x16x32_bf16 v[100:103], v[60:63], a[52:55], v[100:103]
v_add_u32 v3, 20480, v3
buffer_load_dwordx4 v3, s[8:11], 0 offen offset:0 lds
v_mfma_f32_16x16x32_bf16 v[104:107], v[56:59], a[40:43], v[104:107]
v_mul_f32 v212, v212, v118
v_mul_f32 v214, v214, v119
v_mfma_f32_16x16x32_bf16 v[104:107], v[60:63], a[56:59], v[104:107]
ds_read_b128 v[52:55], v7 offset:58368
v_mul_f32 v213, v118, v134
v_mfma_f32_16x16x32_bf16 v[108:111], v[56:59], a[44:47], v[108:111]
v_exp_f32 v212, v212
v_mfma_f32_16x16x32_bf16 v[108:111], v[60:63], a[60:63], v[108:111]
v_mul_f32 v215, v119, v135
s_waitcnt lgkmcnt(4)
v_mfma_f32_16x16x32_bf16 v[80:83], v[64:67], a[64:67], v[80:83]
buffer_load_dwordx4 v3, s[8:11], 0 offen offset:1024 lds
v_mfma_f32_16x16x32_bf16 v[80:83], v[68:71], a[80:83], v[80:83]
v_exp_f32 v214, v214
v_mfma_f32_16x16x32_bf16 v[84:87], v[64:67], a[68:71], v[84:87]
ds_read_b128 v[56:59], v7 offset:59392
v_fma_f32 v212, v212, v237, v237
v_mfma_f32_16x16x32_bf16 v[84:87], v[68:71], a[84:87], v[84:87]
v_fma_f32 v214, v214, v237, v237
v_mul_f32 v208, v120, v120
v_mfma_f32_16x16x32_bf16 v[88:91], v[64:67], a[72:75], v[88:91]
buffer_load_dwordx4 v3, s[8:11], 0 offen offset:2048 lds
v_mfma_f32_16x16x32_bf16 v[88:91], v[68:71], a[88:91], v[88:91]
ds_read_b128 v[60:63], v7 offset:60416
v_mul_f32 v210, v121, v121
v_mfma_f32_16x16x32_bf16 v[92:95], v[64:67], a[76:79], v[92:95]
v_rcp_f32 v212, v212
v_mfma_f32_16x16x32_bf16 v[92:95], v[68:71], a[92:95], v[92:95]
v_mul_f32 v213, v213, v212
s_waitcnt lgkmcnt(4)
v_mfma_f32_16x16x32_bf16 v[96:99], v[72:75], a[64:67], v[96:99]
buffer_load_dwordx4 v3, s[8:11], 0 offen offset:3072 lds
v_mfma_f32_16x16x32_bf16 v[96:99], v[76:79], a[80:83], v[96:99]
s_add_u32 m0, s22, 77824
v_add_u32 v3, 4096, v3
v_mfma_f32_16x16x32_bf16 v[100:103], v[72:75], a[68:71], v[100:103]
ds_read_b128 v[64:67], v7 offset:61440
v_fma_f32 v208, v208, v239, v238
v_mfma_f32_16x16x32_bf16 v[100:103], v[76:79], a[84:87], v[100:103]
v_rcp_f32 v214, v214
v_mfma_f32_16x16x32_bf16 v[104:107], v[72:75], a[72:75], v[104:107]
buffer_load_dwordx4 v3, s[8:11], 0 offen offset:0 lds
v_mfma_f32_16x16x32_bf16 v[104:107], v[76:79], a[88:91], v[104:107]
ds_read_b128 v[68:71], v7 offset:62464
v_mul_f32 v215, v215, v214
v_mfma_f32_16x16x32_bf16 v[108:111], v[72:75], a[76:79], v[108:111]
v_cvt_pk_bf16_f32 v149, v213, v215
v_fma_f32 v210, v210, v239, v238
v_mfma_f32_16x16x32_bf16 v[108:111], v[76:79], a[92:95], v[108:111]
v_mul_f32 v208, v208, v120
s_waitcnt lgkmcnt(4)
v_mfma_f32_16x16x32_bf16 v[80:83], v[48:51], a[96:99], v[80:83]
buffer_load_dwordx4 v3, s[8:11], 0 offen offset:1024 lds
v_mfma_f32_16x16x32_bf16 v[80:83], v[52:55], a[112:115], v[80:83]
v_mul_f32 v210, v210, v121
v_mul_f32 v209, v120, v136
v_mfma_f32_16x16x32_bf16 v[84:87], v[48:51], a[100:103], v[84:87]
ds_read_b128 v[72:75], v7 offset:63488
v_mul_f32 v211, v121, v137
v_mfma_f32_16x16x32_bf16 v[84:87], v[52:55], a[116:119], v[84:87]
v_exp_f32 v208, v208
v_mfma_f32_16x16x32_bf16 v[88:91], v[48:51], a[104:107], v[88:91]
v_exp_f32 v210, v210
v_mfma_f32_16x16x32_bf16 v[88:91], v[52:55], a[120:123], v[88:91]
ds_read_b128 v[76:79], v7 offset:64512
v_fma_f32 v208, v208, v240, v240
v_mfma_f32_16x16x32_bf16 v[92:95], v[48:51], a[108:111], v[92:95]
v_fma_f32 v210, v210, v240, v240
v_mul_f32 v212, v122, v122
v_mfma_f32_16x16x32_bf16 v[92:95], v[52:55], a[124:127], v[92:95]
v_mul_f32 v214, v123, v123
s_waitcnt lgkmcnt(4)
v_mfma_f32_16x16x32_bf16 v[96:99], v[56:59], a[96:99], v[96:99]
v_rcp_f32 v208, v208
v_mfma_f32_16x16x32_bf16 v[96:99], v[60:63], a[112:115], v[96:99]
v_rcp_f32 v210, v210
v_mfma_f32_16x16x32_bf16 v[100:103], v[56:59], a[100:103], v[100:103]
ds_read_b128 v[48:51], v8 offset:0
v_mul_f32 v209, v209, v208
v_mfma_f32_16x16x32_bf16 v[100:103], v[60:63], a[116:119], v[100:103]
v_mul_f32 v211, v211, v210
v_cvt_pk_bf16_f32 v152, v209, v211
v_mfma_f32_16x16x32_bf16 v[104:107], v[56:59], a[104:107], v[104:107]
v_fma_f32 v212, v212, v239, v238
v_fma_f32 v214, v214, v239, v238
v_mfma_f32_16x16x32_bf16 v[104:107], v[60:63], a[120:123], v[104:107]
ds_read_b128 v[52:55], v8 offset:1024
v_mul_f32 v212, v212, v122
v_mfma_f32_16x16x32_bf16 v[108:111], v[56:59], a[108:111], v[108:111]
v_mul_f32 v214, v214, v123
v_mul_f32 v213, v122, v138
v_mfma_f32_16x16x32_bf16 v[108:111], v[60:63], a[124:127], v[108:111]
v_mul_f32 v215, v123, v139
s_waitcnt lgkmcnt(4)
v_mfma_f32_16x16x32_bf16 v[80:83], v[64:67], a[128:131], v[80:83]
v_exp_f32 v212, v212
v_mfma_f32_16x16x32_bf16 v[80:83], v[68:71], a[144:147], v[80:83]
v_exp_f32 v214, v214
v_mfma_f32_16x16x32_bf16 v[84:87], v[64:67], a[132:135], v[84:87]
ds_read_b128 v[56:59], v8 offset:2048
v_fma_f32 v212, v212, v240, v240
v_mfma_f32_16x16x32_bf16 v[84:87], v[68:71], a[148:151], v[84:87]
v_fma_f32 v214, v214, v240, v240
v_mul_f32 v208, v124, v124
v_mfma_f32_16x16x32_bf16 v[88:91], v[64:67], a[136:139], v[88:91]
v_rcp_f32 v212, v212
v_mfma_f32_16x16x32_bf16 v[88:91], v[68:71], a[152:155], v[88:91]
ds_read_b128 v[60:63], v8 offset:3072
v_mul_f32 v213, v213, v212
v_mfma_f32_16x16x32_bf16 v[92:95], v[64:67], a[140:143], v[92:95]
v_rcp_f32 v214, v214
v_mfma_f32_16x16x32_bf16 v[92:95], v[68:71], a[156:159], v[92:95]
v_mul_f32 v215, v215, v214
s_waitcnt lgkmcnt(4)
v_mfma_f32_16x16x32_bf16 v[96:99], v[72:75], a[128:131], v[96:99]
v_cvt_pk_bf16_f32 v153, v213, v215
v_mul_f32 v210, v125, v125
v_mfma_f32_16x16x32_bf16 v[96:99], v[76:79], a[144:147], v[96:99]
v_fma_f32 v208, v208, v242, v241
v_fma_f32 v210, v210, v242, v241
v_mfma_f32_16x16x32_bf16 v[100:103], v[72:75], a[132:135], v[100:103]
ds_read_b128 v[64:67], v8 offset:4096
v_mul_f32 v208, v208, v124
v_mfma_f32_16x16x32_bf16 v[100:103], v[76:79], a[148:151], v[100:103]
v_mul_f32 v210, v210, v125
v_mul_f32 v209, v124, v140
v_mfma_f32_16x16x32_bf16 v[104:107], v[72:75], a[136:139], v[104:107]
v_exp_f32 v208, v208
v_mfma_f32_16x16x32_bf16 v[104:107], v[76:79], a[152:155], v[104:107]
ds_read_b128 v[68:71], v8 offset:5120
v_mul_f32 v211, v125, v141
v_mfma_f32_16x16x32_bf16 v[108:111], v[72:75], a[140:143], v[108:111]
v_exp_f32 v210, v210
v_mfma_f32_16x16x32_bf16 v[108:111], v[76:79], a[156:159], v[108:111]
v_fma_f32 v208, v208, v243, v243
s_waitcnt lgkmcnt(4)
v_mfma_f32_16x16x32_bf16 v[80:83], v[48:51], a[160:163], v[80:83]
v_fma_f32 v210, v210, v243, v243
v_mul_f32 v212, v126, v126
v_mfma_f32_16x16x32_bf16 v[80:83], v[52:55], a[176:179], v[80:83]
v_rcp_f32 v208, v208
v_mfma_f32_16x16x32_bf16 v[84:87], v[48:51], a[164:167], v[84:87]
ds_read_b128 v[72:75], v8 offset:6144
v_mul_f32 v209, v209, v208
v_mfma_f32_16x16x32_bf16 v[84:87], v[52:55], a[180:183], v[84:87]
v_rcp_f32 v210, v210
v_mfma_f32_16x16x32_bf16 v[88:91], v[48:51], a[168:171], v[88:91]
v_mul_f32 v211, v211, v210
v_cvt_pk_bf16_f32 v156, v209, v211
v_mfma_f32_16x16x32_bf16 v[88:91], v[52:55], a[184:187], v[88:91]
ds_read_b128 v[76:79], v8 offset:7168
v_mul_f32 v214, v127, v127
v_mfma_f32_16x16x32_bf16 v[92:95], v[48:51], a[172:175], v[92:95]
v_fma_f32 v212, v212, v242, v241
v_fma_f32 v214, v214, v242, v241
v_mfma_f32_16x16x32_bf16 v[92:95], v[52:55], a[188:191], v[92:95]
v_mul_f32 v212, v212, v126
s_waitcnt lgkmcnt(4)
v_mfma_f32_16x16x32_bf16 v[96:99], v[56:59], a[160:163], v[96:99]
v_mul_f32 v214, v214, v127
v_mul_f32 v213, v126, v142
v_mfma_f32_16x16x32_bf16 v[96:99], v[60:63], a[176:179], v[96:99]
v_exp_f32 v212, v212
v_mfma_f32_16x16x32_bf16 v[100:103], v[56:59], a[164:167], v[100:103]
ds_read_b128 v[48:51], v8 offset:8192
v_mul_f32 v215, v127, v143
v_mfma_f32_16x16x32_bf16 v[100:103], v[60:63], a[180:183], v[100:103]
v_exp_f32 v214, v214
v_mfma_f32_16x16x32_bf16 v[104:107], v[56:59], a[168:171], v[104:107]
v_fma_f32 v212, v212, v243, v243
v_fma_f32 v214, v214, v243, v243
v_mfma_f32_16x16x32_bf16 v[104:107], v[60:63], a[184:187], v[104:107]
ds_read_b128 v[52:55], v8 offset:9216
v_mul_f32 v216, v176, v176
v_mfma_f32_16x16x32_bf16 v[108:111], v[56:59], a[172:175], v[108:111]
v_rcp_f32 v212, v212
v_mfma_f32_16x16x32_bf16 v[108:111], v[60:63], a[188:191], v[108:111]
v_mul_f32 v213, v213, v212
s_waitcnt lgkmcnt(4)
v_mfma_f32_16x16x32_bf16 v[80:83], v[64:67], a[192:195], v[80:83]
v_rcp_f32 v214, v214
v_mfma_f32_16x16x32_bf16 v[80:83], v[68:71], a[208:211], v[80:83]
v_mul_f32 v215, v215, v214
v_cvt_pk_bf16_f32 v157, v213, v215
v_mfma_f32_16x16x32_bf16 v[84:87], v[64:67], a[196:199], v[84:87]
ds_read_b128 v[56:59], v8 offset:10240
v_mul_f32 v218, v177, v177
v_mfma_f32_16x16x32_bf16 v[84:87], v[68:71], a[212:215], v[84:87]
v_fma_f32 v216, v216, v233, v232
v_fma_f32 v218, v218, v233, v232
v_mfma_f32_16x16x32_bf16 v[88:91], v[64:67], a[200:203], v[88:91]
v_mul_f32 v216, v216, v176
v_mul_f32 v218, v218, v177
v_mfma_f32_16x16x32_bf16 v[88:91], v[68:71], a[216:219], v[88:91]
ds_read_b128 v[60:63], v8 offset:11264
v_mul_f32 v217, v176, v192
v_mfma_f32_16x16x32_bf16 v[92:95], v[64:67], a[204:207], v[92:95]
v_exp_f32 v216, v216
v_mfma_f32_16x16x32_bf16 v[92:95], v[68:71], a[220:223], v[92:95]
v_mul_f32 v219, v177, v193
s_waitcnt lgkmcnt(4)
v_mfma_f32_16x16x32_bf16 v[96:99], v[72:75], a[192:195], v[96:99]
v_exp_f32 v218, v218
v_mfma_f32_16x16x32_bf16 v[96:99], v[76:79], a[208:211], v[96:99]
v_fma_f32 v216, v216, v234, v234
v_fma_f32 v218, v218, v234, v234
v_mfma_f32_16x16x32_bf16 v[100:103], v[72:75], a[196:199], v[100:103]
ds_read_b128 v[64:67], v8 offset:12288
v_mul_f32 v220, v178, v178
v_mfma_f32_16x16x32_bf16 v[100:103], v[76:79], a[212:215], v[100:103]
v_rcp_f32 v216, v216
v_mfma_f32_16x16x32_bf16 v[104:107], v[72:75], a[200:203], v[104:107]
v_rcp_f32 v218, v218
v_mfma_f32_16x16x32_bf16 v[104:107], v[76:79], a[216:219], v[104:107]
ds_read_b128 v[68:71], v8 offset:13312
v_mul_f32 v217, v217, v216
v_mfma_f32_16x16x32_bf16 v[108:111], v[72:75], a[204:207], v[108:111]
v_mul_f32 v219, v219, v218
v_cvt_pk_bf16_f32 v146, v217, v219
v_mfma_f32_16x16x32_bf16 v[108:111], v[76:79], a[220:223], v[108:111]
v_mul_f32 v222, v179, v179
s_waitcnt lgkmcnt(4)
v_mfma_f32_16x16x32_bf16 v[80:83], v[48:51], a[224:227], v[80:83]
v_fma_f32 v220, v220, v233, v232
v_fma_f32 v222, v222, v233, v232
v_mfma_f32_16x16x32_bf16 v[80:83], v[52:55], a[240:243], v[80:83]
v_mul_f32 v220, v220, v178
v_mul_f32 v222, v222, v179
v_mfma_f32_16x16x32_bf16 v[84:87], v[48:51], a[228:231], v[84:87]
ds_read_b128 v[72:75], v8 offset:14336
v_mul_f32 v221, v178, v194
v_mfma_f32_16x16x32_bf16 v[84:87], v[52:55], a[244:247], v[84:87]
v_exp_f32 v220, v220
v_mfma_f32_16x16x32_bf16 v[88:91], v[48:51], a[232:235], v[88:91]
v_exp_f32 v222, v222
v_mfma_f32_16x16x32_bf16 v[88:91], v[52:55], a[248:251], v[88:91]
ds_read_b128 v[76:79], v8 offset:15360
v_mul_f32 v223, v179, v195
v_mfma_f32_16x16x32_bf16 v[92:95], v[48:51], a[236:239], v[92:95]
v_fma_f32 v220, v220, v234, v234
v_fma_f32 v222, v222, v234, v234
v_mfma_f32_16x16x32_bf16 v[92:95], v[52:55], a[252:255], v[92:95]
v_mul_f32 v216, v180, v180
s_waitcnt lgkmcnt(4)
v_mfma_f32_16x16x32_bf16 v[96:99], v[56:59], a[224:227], v[96:99]
s_waitcnt vmcnt(22)
v_mul_f32 v218, v181, v181
v_mfma_f32_16x16x32_bf16 v[96:99], v[60:63], a[240:243], v[96:99]
s_barrier
v_mfma_f32_16x16x32_bf16 v[100:103], v[56:59], a[228:231], v[100:103]
ds_read_b128 v[48:51], v2 offset:0
s_add_u32 m0, s22, 98304
v_mfma_f32_16x16x32_bf16 v[100:103], v[60:63], a[244:247], v[100:103]
v_add_u32 v3, 20480, v3
buffer_load_dwordx4 v3, s[8:11], 0 offen offset:0 lds
v_mfma_f32_16x16x32_bf16 v[104:107], v[56:59], a[232:235], v[104:107]
v_rcp_f32 v220, v220
v_mfma_f32_16x16x32_bf16 v[104:107], v[60:63], a[248:251], v[104:107]
ds_read_b128 v[52:55], v2 offset:1024
v_mul_f32 v221, v221, v220
v_mfma_f32_16x16x32_bf16 v[108:111], v[56:59], a[236:239], v[108:111]
v_rcp_f32 v222, v222
v_mfma_f32_16x16x32_bf16 v[108:111], v[60:63], a[252:255], v[108:111]
v_mul_f32 v223, v223, v222
s_waitcnt lgkmcnt(4)
v_mfma_f32_16x16x32_bf16 v[80:83], v[64:67], v[16:19], v[80:83]
buffer_load_dwordx4 v3, s[8:11], 0 offen offset:1024 lds
v_mfma_f32_16x16x32_bf16 v[80:83], v[68:71], v[32:35], v[80:83]
v_cvt_pk_bf16_f32 v147, v221, v223
v_fma_f32 v216, v216, v236, v235
v_mfma_f32_16x16x32_bf16 v[84:87], v[64:67], v[20:23], v[84:87]
ds_read_b128 v[56:59], v2 offset:2048
v_fma_f32 v218, v218, v236, v235
v_mfma_f32_16x16x32_bf16 v[84:87], v[68:71], v[36:39], v[84:87]
buffer_store_dwordx4 v[144:147], v2, s[8:11], s24 offen offset:0 sc1
v_mfma_f32_16x16x32_bf16 v[88:91], v[64:67], v[24:27], v[88:91]
v_mul_f32 v216, v216, v180
v_mul_f32 v218, v218, v181
v_mfma_f32_16x16x32_bf16 v[88:91], v[68:71], v[40:43], v[88:91]
ds_read_b128 v[60:63], v2 offset:3072
v_mul_f32 v217, v180, v196
v_mfma_f32_16x16x32_bf16 v[92:95], v[64:67], v[28:31], v[92:95]
v_exp_f32 v216, v216
v_mfma_f32_16x16x32_bf16 v[92:95], v[68:71], v[44:47], v[92:95]
v_mul_f32 v219, v181, v197
s_waitcnt lgkmcnt(4)
v_mfma_f32_16x16x32_bf16 v[96:99], v[72:75], v[16:19], v[96:99]
buffer_load_dwordx4 v3, s[8:11], 0 offen offset:2048 lds
v_mfma_f32_16x16x32_bf16 v[96:99], v[76:79], v[32:35], v[96:99]
v_exp_f32 v218, v218
v_mfma_f32_16x16x32_bf16 v[100:103], v[72:75], v[20:23], v[100:103]
ds_read_b128 v[64:67], v2 offset:4096
v_fma_f32 v216, v216, v237, v237
v_mfma_f32_16x16x32_bf16 v[100:103], v[76:79], v[36:39], v[100:103]
v_fma_f32 v218, v218, v237, v237
v_mul_f32 v220, v182, v182
v_mfma_f32_16x16x32_bf16 v[104:107], v[72:75], v[24:27], v[104:107]
buffer_load_dwordx4 v3, s[8:11], 0 offen offset:3072 lds
v_mfma_f32_16x16x32_bf16 v[104:107], v[76:79], v[40:43], v[104:107]
ds_read_b128 v[68:71], v2 offset:5120
s_add_u32 m0, s22, 102400
v_mfma_f32_16x16x32_bf16 v[108:111], v[72:75], v[28:31], v[108:111]
v_add_u32 v3, 4096, v3
v_mul_f32 v222, v183, v183
v_mfma_f32_16x16x32_bf16 v[108:111], v[76:79], v[44:47], v[108:111]
v_fma_f32 v220, v220, v236, v235
s_waitcnt lgkmcnt(4)
v_mfma_f32_16x16x32_bf16 v[112:115], v[48:51], a[0:3], 0
buffer_load_dwordx4 v3, s[8:11], 0 offen offset:0 lds
v_mfma_f32_16x16x32_bf16 v[112:115], v[52:55], a[16:19], v[112:115]
v_rcp_f32 v216, v216
v_mfma_f32_16x16x32_bf16 v[116:119], v[48:51], a[4:7], 0
ds_read_b128 v[72:75], v2 offset:6144
v_mul_f32 v217, v217, v216
v_mfma_f32_16x16x32_bf16 v[116:119], v[52:55], a[20:23], v[116:119]
v_mul_f32 v208, v80, v80
v_mul_f32 v210, v81, v81
v_mfma_f32_16x16x32_bf16 v[120:123], v[48:51], a[8:11], 0
buffer_load_dwordx4 v3, s[8:11], 0 offen offset:1024 lds
v_mfma_f32_16x16x32_bf16 v[120:123], v[52:55], a[24:27], v[120:123]
ds_read_b128 v[76:79], v2 offset:7168
v_fma_f32 v208, v208, v233, v232
v_mfma_f32_16x16x32_bf16 v[124:127], v[48:51], a[12:15], 0
v_fma_f32 v210, v210, v233, v232
v_mul_f32 v208, v208, v80
v_mfma_f32_16x16x32_bf16 v[124:127], v[52:55], a[28:31], v[124:127]
v_mul_f32 v210, v210, v81
s_waitcnt lgkmcnt(4)
v_mfma_f32_16x16x32_bf16 v[128:131], v[56:59], a[0:3], 0
v_exp_f32 v208, v208
v_mfma_f32_16x16x32_bf16 v[128:131], v[60:63], a[16:19], v[128:131]
v_exp_f32 v210, v210
v_mfma_f32_16x16x32_bf16 v[132:135], v[56:59], a[4:7], 0
ds_read_b128 v[48:51], v2 offset:8192
v_mul_f32 v209, v80, v96
v_mfma_f32_16x16x32_bf16 v[132:135], v[60:63], a[20:23], v[132:135]
v_mul_f32 v211, v81, v97
v_fma_f32 v208, v208, v234, v234
v_mfma_f32_16x16x32_bf16 v[136:139], v[56:59], a[8:11], 0
v_fma_f32 v210, v210, v234, v234
v_mul_f32 v212, v82, v82
v_mfma_f32_16x16x32_bf16 v[136:139], v[60:63], a[24:27], v[136:139]
ds_read_b128 v[52:55], v2 offset:9216
v_mul_f32 v214, v83, v83
v_mfma_f32_16x16x32_bf16 v[140:143], v[56:59], a[12:15], 0
v_rcp_f32 v208, v208
v_mfma_f32_16x16x32_bf16 v[140:143], v[60:63], a[28:31], v[140:143]
v_mul_f32 v209, v209, v208
s_waitcnt lgkmcnt(4)
v_mfma_f32_16x16x32_bf16 v[112:115], v[64:67], a[32:35], v[112:115]
v_rcp_f32 v210, v210
v_mfma_f32_16x16x32_bf16 v[112:115], v[68:71], a[48:51], v[112:115]
v_mul_f32 v211, v211, v210
v_cvt_pk_bf16_f32 v160, v209, v211
v_mfma_f32_16x16x32_bf16 v[116:119], v[64:67], a[36:39], v[116:119]
ds_read_b128 v[56:59], v2 offset:10240
v_fma_f32 v212, v212, v233, v232
v_mfma_f32_16x16x32_bf16 v[116:119], v[68:71], a[52:55], v[116:119]
v_fma_f32 v214, v214, v233, v232
v_mul_f32 v212, v212, v82
v_mfma_f32_16x16x32_bf16 v[120:123], v[64:67], a[40:43], v[120:123]
v_mul_f32 v214, v214, v83
v_mul_f32 v213, v82, v98
v_mfma_f32_16x16x32_bf16 v[120:123], v[68:71], a[56:59], v[120:123]
ds_read_b128 v[60:63], v2 offset:11264
v_mul_f32 v215, v83, v99
v_mfma_f32_16x16x32_bf16 v[124:127], v[64:67], a[44:47], v[124:127]
v_exp_f32 v212, v212
v_mfma_f32_16x16x32_bf16 v[124:127], v[68:71], a[60:63], v[124:127]
v_fma_f32 v212, v212, v234, v234
s_waitcnt lgkmcnt(4)
v_mfma_f32_16x16x32_bf16 v[128:131], v[72:75], a[32:35], v[128:131]
v_exp_f32 v214, v214
v_mfma_f32_16x16x32_bf16 v[128:131], v[76:79], a[48:51], v[128:131]
v_fma_f32 v214, v214, v234, v234
v_mul_f32 v208, v84, v84
v_mfma_f32_16x16x32_bf16 v[132:135], v[72:75], a[36:39], v[132:135]
ds_read_b128 v[64:67], v2 offset:12288
v_mul_f32 v210, v85, v85
v_mfma_f32_16x16x32_bf16 v[132:135], v[76:79], a[52:55], v[132:135]
v_rcp_f32 v212, v212
v_mfma_f32_16x16x32_bf16 v[136:139], v[72:75], a[40:43], v[136:139]
v_rcp_f32 v214, v214
v_mfma_f32_16x16x32_bf16 v[136:139], v[76:79], a[56:59], v[136:139]
ds_read_b128 v[68:71], v2 offset:13312
v_mul_f32 v213, v213, v212
v_mfma_f32_16x16x32_bf16 v[140:143], v[72:75], a[44:47], v[140:143]
v_mul_f32 v215, v215, v214
v_cvt_pk_bf16_f32 v161, v213, v215
v_mfma_f32_16x16x32_bf16 v[140:143], v[76:79], a[60:63], v[140:143]
v_fma_f32 v208, v208, v236, v235
s_waitcnt lgkmcnt(4)
v_mfma_f32_16x16x32_bf16 v[112:115], v[48:51], a[64:67], v[112:115]
v_fma_f32 v210, v210, v236, v235
v_mul_f32 v208, v208, v84
v_mfma_f32_16x16x32_bf16 v[112:115], v[52:55], a[80:83], v[112:115]
v_mul_f32 v210, v210, v85
v_mul_f32 v209, v84, v100
v_mfma_f32_16x16x32_bf16 v[116:119], v[48:51], a[68:71], v[116:119]
ds_read_b128 v[72:75], v2 offset:14336
v_mul_f32 v211, v85, v101
v_mfma_f32_16x16x32_bf16 v[116:119], v[52:55], a[84:87], v[116:119]
v_exp_f32 v208, v208
v_mfma_f32_16x16x32_bf16 v[120:123], v[48:51], a[72:75], v[120:123]
v_exp_f32 v210, v210
v_mfma_f32_16x16x32_bf16 v[120:123], v[52:55], a[88:91], v[120:123]
ds_read_b128 v[76:79], v2 offset:15360
v_fma_f32 v208, v208, v237, v237
v_mfma_f32_16x16x32_bf16 v[124:127], v[48:51], a[76:79], v[124:127]
v_fma_f32 v210, v210, v237, v237
v_mul_f32 v212, v86, v86
v_mfma_f32_16x16x32_bf16 v[124:127], v[52:55], a[92:95], v[124:127]
v_mul_f32 v214, v87, v87
s_waitcnt lgkmcnt(4)
v_mfma_f32_16x16x32_bf16 v[128:131], v[56:59], a[64:67], v[128:131]
v_rcp_f32 v208, v208
v_mfma_f32_16x16x32_bf16 v[128:131], v[60:63], a[80:83], v[128:131]
v_rcp_f32 v210, v210
v_mfma_f32_16x16x32_bf16 v[132:135], v[56:59], a[68:71], v[132:135]
ds_read_b128 v[48:51], v2 offset:16384
v_mul_f32 v209, v209, v208
v_mfma_f32_16x16x32_bf16 v[132:135], v[60:63], a[84:87], v[132:135]
v_mul_f32 v211, v211, v210
v_cvt_pk_bf16_f32 v164, v209, v211
v_mfma_f32_16x16x32_bf16 v[136:139], v[56:59], a[72:75], v[136:139]
v_fma_f32 v212, v212, v236, v235
v_fma_f32 v214, v214, v236, v235
v_mfma_f32_16x16x32_bf16 v[136:139], v[60:63], a[88:91], v[136:139]
ds_read_b128 v[52:55], v2 offset:17408
v_mul_f32 v212, v212, v86
v_mfma_f32_16x16x32_bf16 v[140:143], v[56:59], a[76:79], v[140:143]
v_mul_f32 v214, v214, v87
v_mul_f32 v213, v86, v102
v_mfma_f32_16x16x32_bf16 v[140:143], v[60:63], a[92:95], v[140:143]
v_mul_f32 v215, v87, v103
s_waitcnt lgkmcnt(4)
v_mfma_f32_16x16x32_bf16 v[112:115], v[64:67], a[96:99], v[112:115]
v_exp_f32 v212, v212
v_mfma_f32_16x16x32_bf16 v[112:115], v[68:71], a[112:115], v[112:115]
v_exp_f32 v214, v214
v_mfma_f32_16x16x32_bf16 v[116:119], v[64:67], a[100:103], v[116:119]
ds_read_b128 v[56:59], v2 offset:18432
v_fma_f32 v212, v212, v237, v237
v_mfma_f32_16x16x32_bf16 v[116:119], v[68:71], a[116:119], v[116:119]
v_fma_f32 v214, v214, v237, v237
v_mul_f32 v208, v88, v88
v_mfma_f32_16x16x32_bf16 v[120:123], v[64:67], a[104:107], v[120:123]
v_rcp_f32 v212, v212
v_mfma_f32_16x16x32_bf16 v[120:123], v[68:71], a[120:123], v[120:123]
ds_read_b128 v[60:63], v2 offset:19456
v_mul_f32 v213, v213, v212
v_mfma_f32_16x16x32_bf16 v[124:127], v[64:67], a[108:111], v[124:127]
v_rcp_f32 v214, v214
v_mfma_f32_16x16x32_bf16 v[124:127], v[68:71], a[124:127], v[124:127]
v_mul_f32 v215, v215, v214
s_waitcnt lgkmcnt(4)
v_mfma_f32_16x16x32_bf16 v[128:131], v[72:75], a[96:99], v[128:131]
v_cvt_pk_bf16_f32 v165, v213, v215
v_mul_f32 v210, v89, v89
v_mfma_f32_16x16x32_bf16 v[128:131], v[76:79], a[112:115], v[128:131]
v_fma_f32 v208, v208, v239, v238
v_fma_f32 v210, v210, v239, v238
v_mfma_f32_16x16x32_bf16 v[132:135], v[72:75], a[100:103], v[132:135]
ds_read_b128 v[64:67], v2 offset:20480
v_mul_f32 v208, v208, v88
v_mfma_f32_16x16x32_bf16 v[132:135], v[76:79], a[116:119], v[132:135]
v_mul_f32 v210, v210, v89
v_mul_f32 v209, v88, v104
v_mfma_f32_16x16x32_bf16 v[136:139], v[72:75], a[104:107], v[136:139]
v_exp_f32 v208, v208
v_mfma_f32_16x16x32_bf16 v[136:139], v[76:79], a[120:123], v[136:139]
ds_read_b128 v[68:71], v2 offset:21504
v_mul_f32 v211, v89, v105
v_mfma_f32_16x16x32_bf16 v[140:143], v[72:75], a[108:111], v[140:143]
v_exp_f32 v210, v210
v_mfma_f32_16x16x32_bf16 v[140:143], v[76:79], a[124:127], v[140:143]
v_fma_f32 v208, v208, v240, v240
s_waitcnt lgkmcnt(4)
v_mfma_f32_16x16x32_bf16 v[112:115], v[48:51], a[128:131], v[112:115]
v_fma_f32 v210, v210, v240, v240
v_mul_f32 v212, v90, v90
v_mfma_f32_16x16x32_bf16 v[112:115], v[52:55], a[144:147], v[112:115]
v_rcp_f32 v208, v208
v_mfma_f32_16x16x32_bf16 v[116:119], v[48:51], a[132:135], v[116:119]
ds_read_b128 v[72:75], v2 offset:22528
v_mul_f32 v209, v209, v208
v_mfma_f32_16x16x32_bf16 v[116:119], v[52:55], a[148:151], v[116:119]
v_rcp_f32 v210, v210
v_mfma_f32_16x16x32_bf16 v[120:123], v[48:51], a[136:139], v[120:123]
v_mul_f32 v211, v211, v210
v_cvt_pk_bf16_f32 v168, v209, v211
v_mfma_f32_16x16x32_bf16 v[120:123], v[52:55], a[152:155], v[120:123]
ds_read_b128 v[76:79], v2 offset:23552
v_mul_f32 v214, v91, v91
v_mfma_f32_16x16x32_bf16 v[124:127], v[48:51], a[140:143], v[124:127]
v_fma_f32 v212, v212, v239, v238
v_fma_f32 v214, v214, v239, v238
v_mfma_f32_16x16x32_bf16 v[124:127], v[52:55], a[156:159], v[124:127]
v_mul_f32 v212, v212, v90
s_waitcnt lgkmcnt(4)
v_mfma_f32_16x16x32_bf16 v[128:131], v[56:59], a[128:131], v[128:131]
s_waitcnt vmcnt(23)
v_mul_f32 v214, v214, v91
v_mfma_f32_16x16x32_bf16 v[128:131], v[60:63], a[144:147], v[128:131]
s_barrier
v_mfma_f32_16x16x32_bf16 v[132:135], v[56:59], a[132:135], v[132:135]
ds_read_b128 v[48:51], v2 offset:24576
s_add_u32 m0, s22, 122880
v_mfma_f32_16x16x32_bf16 v[132:135], v[60:63], a[148:151], v[132:135]
v_add_u32 v3, 20480, v3
buffer_load_dwordx4 v3, s[8:11], 0 offen offset:0 lds
v_mfma_f32_16x16x32_bf16 v[136:139], v[56:59], a[136:139], v[136:139]
v_exp_f32 v212, v212
v_mfma_f32_16x16x32_bf16 v[136:139], v[60:63], a[152:155], v[136:139]
ds_read_b128 v[52:55], v2 offset:25600
v_mul_f32 v213, v90, v106
v_mfma_f32_16x16x32_bf16 v[140:143], v[56:59], a[140:143], v[140:143]
v_exp_f32 v214, v214
v_mfma_f32_16x16x32_bf16 v[140:143], v[60:63], a[156:159], v[140:143]
v_mul_f32 v215, v91, v107
s_waitcnt lgkmcnt(4)
v_mfma_f32_16x16x32_bf16 v[112:115], v[64:67], a[160:163], v[112:115]
buffer_load_dwordx4 v3, s[8:11], 0 offen offset:1024 lds
v_mfma_f32_16x16x32_bf16 v[112:115], v[68:71], a[176:179], v[112:115]
v_fma_f32 v212, v212, v240, v240
v_fma_f32 v214, v214, v240, v240
v_mfma_f32_16x16x32_bf16 v[116:119], v[64:67], a[164:167], v[116:119]
ds_read_b128 v[56:59], v2 offset:26624
v_mul_f32 v208, v92, v92
v_mfma_f32_16x16x32_bf16 v[116:119], v[68:71], a[180:183], v[116:119]
v_rcp_f32 v212, v212
v_mfma_f32_16x16x32_bf16 v[120:123], v[64:67], a[168:171], v[120:123]
buffer_load_dwordx4 v3, s[8:11], 0 offen offset:2048 lds
v_mfma_f32_16x16x32_bf16 v[120:123], v[68:71], a[184:187], v[120:123]
ds_read_b128 v[60:63], v2 offset:27648
v_mul_f32 v213, v213, v212
v_mfma_f32_16x16x32_bf16 v[124:127], v[64:67], a[172:175], v[124:127]
v_rcp_f32 v214, v214
v_mfma_f32_16x16x32_bf16 v[124:127], v[68:71], a[188:191], v[124:127]
v_mul_f32 v215, v215, v214
s_waitcnt lgkmcnt(4)
v_mfma_f32_16x16x32_bf16 v[128:131], v[72:75], a[160:163], v[128:131]
buffer_load_dwordx4 v3, s[8:11], 0 offen offset:3072 lds
v_mfma_f32_16x16x32_bf16 v[128:131], v[76:79], a[176:179], v[128:131]
s_add_u32 m0, s22, 126976
v_add_u32 v3, 4096, v3
v_mfma_f32_16x16x32_bf16 v[132:135], v[72:75], a[164:167], v[132:135]
ds_read_b128 v[64:67], v2 offset:28672
v_cvt_pk_bf16_f32 v169, v213, v215
v_mfma_f32_16x16x32_bf16 v[132:135], v[76:79], a[180:183], v[132:135]
v_mul_f32 v210, v93, v93
v_fma_f32 v208, v208, v242, v241
v_mfma_f32_16x16x32_bf16 v[136:139], v[72:75], a[168:171], v[136:139]
buffer_load_dwordx4 v3, s[8:11], 0 offen offset:0 lds
v_mfma_f32_16x16x32_bf16 v[136:139], v[76:79], a[184:187], v[136:139]
ds_read_b128 v[68:71], v2 offset:29696
v_fma_f32 v210, v210, v242, v241
v_mfma_f32_16x16x32_bf16 v[140:143], v[72:75], a[172:175], v[140:143]
v_mul_f32 v208, v208, v92
v_mul_f32 v210, v210, v93
v_mfma_f32_16x16x32_bf16 v[140:143], v[76:79], a[188:191], v[140:143]
v_mul_f32 v209, v92, v108
s_waitcnt lgkmcnt(4)
v_mfma_f32_16x16x32_bf16 v[112:115], v[48:51], a[192:195], v[112:115]
buffer_load_dwordx4 v3, s[8:11], 0 offen offset:1024 lds
v_mfma_f32_16x16x32_bf16 v[112:115], v[52:55], a[208:211], v[112:115]
v_exp_f32 v208, v208
v_mfma_f32_16x16x32_bf16 v[116:119], v[48:51], a[196:199], v[116:119]
ds_read_b128 v[72:75], v2 offset:30720
v_mul_f32 v211, v93, v109
v_mfma_f32_16x16x32_bf16 v[116:119], v[52:55], a[212:215], v[116:119]
v_exp_f32 v210, v210
v_mfma_f32_16x16x32_bf16 v[120:123], v[48:51], a[200:203], v[120:123]
v_fma_f32 v208, v208, v243, v243
v_fma_f32 v210, v210, v243, v243
v_mfma_f32_16x16x32_bf16 v[120:123], v[52:55], a[216:219], v[120:123]
ds_read_b128 v[76:79], v2 offset:31744
v_mul_f32 v212, v94, v94
v_mfma_f32_16x16x32_bf16 v[124:127], v[48:51], a[204:207], v[124:127]
v_rcp_f32 v208, v208
v_mfma_f32_16x16x32_bf16 v[124:127], v[52:55], a[220:223], v[124:127]
v_mul_f32 v209, v209, v208
s_waitcnt lgkmcnt(4)
v_mfma_f32_16x16x32_bf16 v[128:131], v[56:59], a[192:195], v[128:131]
v_rcp_f32 v210, v210
v_mfma_f32_16x16x32_bf16 v[128:131], v[60:63], a[208:211], v[128:131]
v_mul_f32 v211, v211, v210
v_cvt_pk_bf16_f32 v172, v209, v211
v_mfma_f32_16x16x32_bf16 v[132:135], v[56:59], a[196:199], v[132:135]
ds_read_b128 v[48:51], v2 offset:32768
v_mul_f32 v214, v95, v95
v_mfma_f32_16x16x32_bf16 v[132:135], v[60:63], a[212:215], v[132:135]
v_fma_f32 v212, v212, v242, v241
v_fma_f32 v214, v214, v242, v241
v_mfma_f32_16x16x32_bf16 v[136:139], v[56:59], a[200:203], v[136:139]
v_mul_f32 v212, v212, v94
v_mul_f32 v214, v214, v95
v_mfma_f32_16x16x32_bf16 v[136:139], v[60:63], a[216:219], v[136:139]
ds_read_b128 v[52:55], v2 offset:33792
v_mul_f32 v213, v94, v110
v_mfma_f32_16x16x32_bf16 v[140:143], v[56:59], a[204:207], v[140:143]
v_exp_f32 v212, v212
v_mfma_f32_16x16x32_bf16 v[140:143], v[60:63], a[220:223], v[140:143]
v_mul_f32 v215, v95, v111
s_waitcnt lgkmcnt(4)
v_mfma_f32_16x16x32_bf16 v[112:115], v[64:67], a[224:227], v[112:115]
v_exp_f32 v214, v214
v_mfma_f32_16x16x32_bf16 v[112:115], v[68:71], a[240:243], v[112:115]
v_fma_f32 v212, v212, v243, v243
v_fma_f32 v214, v214, v243, v243
v_mfma_f32_16x16x32_bf16 v[116:119], v[64:67], a[228:231], v[116:119]
ds_read_b128 v[56:59], v2 offset:34816
v_fma_f32 v222, v222, v236, v235
v_mfma_f32_16x16x32_bf16 v[116:119], v[68:71], a[244:247], v[116:119]
v_rcp_f32 v212, v212
v_mfma_f32_16x16x32_bf16 v[120:123], v[64:67], a[232:235], v[120:123]
v_rcp_f32 v214, v214
v_mfma_f32_16x16x32_bf16 v[120:123], v[68:71], a[248:251], v[120:123]
ds_read_b128 v[60:63], v2 offset:35840
v_mul_f32 v213, v213, v212
v_mfma_f32_16x16x32_bf16 v[124:127], v[64:67], a[236:239], v[124:127]
v_mul_f32 v215, v215, v214
v_cvt_pk_bf16_f32 v173, v213, v215
v_mfma_f32_16x16x32_bf16 v[124:127], v[68:71], a[252:255], v[124:127]
v_mul_f32 v220, v220, v182
s_waitcnt lgkmcnt(4)
v_mfma_f32_16x16x32_bf16 v[128:131], v[72:75], a[224:227], v[128:131]
v_rcp_f32 v218, v218
v_mfma_f32_16x16x32_bf16 v[128:131], v[76:79], a[240:243], v[128:131]
v_mul_f32 v219, v219, v218
v_cvt_pk_bf16_f32 v150, v217, v219
v_mfma_f32_16x16x32_bf16 v[132:135], v[72:75], a[228:231], v[132:135]
ds_read_b128 v[64:67], v2 offset:36864
v_mul_f32 v222, v222, v183
v_mfma_f32_16x16x32_bf16 v[132:135], v[76:79], a[244:247], v[132:135]
v_exp_f32 v220, v220
v_mfma_f32_16x16x32_bf16 v[136:139], v[72:75], a[232:235], v[136:139]
v_exp_f32 v222, v222
v_mfma_f32_16x16x32_bf16 v[136:139], v[76:79], a[248:251], v[136:139]
ds_read_b128 v[68:71], v2 offset:37888
v_mul_f32 v221, v182, v198
v_mfma_f32_16x16x32_bf16 v[140:143], v[72:75], a[236:239], v[140:143]
v_mul_f32 v223, v183, v199
v_fma_f32 v220, v220, v237, v237
v_mfma_f32_16x16x32_bf16 v[140:143], v[76:79], a[252:255], v[140:143]
v_fma_f32 v222, v222, v237, v237
s_waitcnt lgkmcnt(4)
v_mfma_f32_16x16x32_bf16 v[112:115], v[48:51], v[16:19], v[112:115]
v_rcp_f32 v220, v220
v_mfma_f32_16x16x32_bf16 v[112:115], v[52:55], v[32:35], v[112:115]
v_rcp_f32 v222, v222
v_mfma_f32_16x16x32_bf16 v[116:119], v[48:51], v[20:23], v[116:119]
ds_read_b128 v[72:75], v2 offset:38912
v_mul_f32 v221, v221, v220
v_mfma_f32_16x16x32_bf16 v[116:119], v[52:55], v[36:39], v[116:119]
v_mul_f32 v223, v223, v222
v_cvt_pk_bf16_f32 v151, v221, v223
v_mfma_f32_16x16x32_bf16 v[120:123], v[48:51], v[24:27], v[120:123]
buffer_store_dwordx4 v[148:151], v4, s[8:11], s24 offen offset:0 sc1
v_mfma_f32_16x16x32_bf16 v[120:123], v[52:55], v[40:43], v[120:123]
ds_read_b128 v[76:79], v2 offset:39936
v_mul_f32 v216, v184, v184
v_mfma_f32_16x16x32_bf16 v[124:127], v[48:51], v[28:31], v[124:127]
v_mul_f32 v218, v185, v185
v_fma_f32 v216, v216, v239, v238
v_mfma_f32_16x16x32_bf16 v[124:127], v[52:55], v[44:47], v[124:127]
v_fma_f32 v218, v218, v239, v238
s_waitcnt lgkmcnt(4)
v_mfma_f32_16x16x32_bf16 v[128:131], v[56:59], v[16:19], v[128:131]
v_mul_f32 v216, v216, v184
v_mul_f32 v218, v218, v185
v_mfma_f32_16x16x32_bf16 v[128:131], v[60:63], v[32:35], v[128:131]
v_exp_f32 v216, v216
v_mfma_f32_16x16x32_bf16 v[132:135], v[56:59], v[20:23], v[132:135]
ds_read_b128 v[48:51], v2 offset:40960
v_mul_f32 v217, v184, v200
v_mfma_f32_16x16x32_bf16 v[132:135], v[60:63], v[36:39], v[132:135]
v_exp_f32 v218, v218
v_mfma_f32_16x16x32_bf16 v[136:139], v[56:59], v[24:27], v[136:139]
v_mul_f32 v219, v185, v201
v_fma_f32 v216, v216, v240, v240
v_mfma_f32_16x16x32_bf16 v[136:139], v[60:63], v[40:43], v[136:139]
ds_read_b128 v[52:55], v2 offset:41984
v_fma_f32 v218, v218, v240, v240
v_mfma_f32_16x16x32_bf16 v[140:143], v[56:59], v[28:31], v[140:143]
v_rcp_f32 v216, v216
v_mfma_f32_16x16x32_bf16 v[140:143], v[60:63], v[44:47], v[140:143]
v_mul_f32 v217, v217, v216
s_waitcnt lgkmcnt(4)
v_mfma_f32_16x16x32_bf16 v[80:83], v[64:67], a[0:3], 0
v_rcp_f32 v218, v218
v_mfma_f32_16x16x32_bf16 v[80:83], v[68:71], a[16:19], v[80:83]
v_mul_f32 v219, v219, v218
v_cvt_pk_bf16_f32 v154, v217, v219
v_mfma_f32_16x16x32_bf16 v[84:87], v[64:67], a[4:7], 0
ds_read_b128 v[56:59], v2 offset:43008
v_mul_f32 v220, v186, v186
v_mfma_f32_16x16x32_bf16 v[84:87], v[68:71], a[20:23], v[84:87]
v_mul_f32 v208, v112, v112
v_mul_f32 v210, v113, v113
v_mfma_f32_16x16x32_bf16 v[88:91], v[64:67], a[8:11], 0
v_fma_f32 v208, v208, v233, v232
v_fma_f32 v210, v210, v233, v232
v_mfma_f32_16x16x32_bf16 v[88:91], v[68:71], a[24:27], v[88:91]
ds_read_b128 v[60:63], v2 offset:44032
v_mul_f32 v208, v208, v112
v_mfma_f32_16x16x32_bf16 v[92:95], v[64:67], a[12:15], 0
v_mul_f32 v210, v210, v113
v_mul_f32 v209, v112, v128
v_mfma_f32_16x16x32_bf16 v[92:95], v[68:71], a[28:31], v[92:95]
v_mul_f32 v211, v113, v129
s_waitcnt lgkmcnt(4)
v_mfma_f32_16x16x32_bf16 v[96:99], v[72:75], a[0:3], 0
v_exp_f32 v208, v208
v_mfma_f32_16x16x32_bf16 v[96:99], v[76:79], a[16:19], v[96:99]
v_exp_f32 v210, v210
v_mfma_f32_16x16x32_bf16 v[100:103], v[72:75], a[4:7], 0
ds_read_b128 v[64:67], v2 offset:45056
v_fma_f32 v208, v208, v234, v234
v_mfma_f32_16x16x32_bf16 v[100:103], v[76:79], a[20:23], v[100:103]
v_fma_f32 v210, v210, v234, v234
v_mul_f32 v212, v114, v114
v_mfma_f32_16x16x32_bf16 v[104:107], v[72:75], a[8:11], 0
v_rcp_f32 v208, v208
v_mfma_f32_16x16x32_bf16 v[104:107], v[76:79], a[24:27], v[104:107]
ds_read_b128 v[68:71], v2 offset:46080
v_mul_f32 v209, v209, v208
v_mfma_f32_16x16x32_bf16 v[108:111], v[72:75], a[12:15], 0
v_rcp_f32 v210, v210
v_mfma_f32_16x16x32_bf16 v[108:111], v[76:79], a[28:31], v[108:111]
v_mul_f32 v211, v211, v210
s_waitcnt lgkmcnt(4)
v_mfma_f32_16x16x32_bf16 v[80:83], v[48:51], a[32:35], v[80:83]
v_cvt_pk_bf16_f32 v162, v209, v211
v_mul_f32 v214, v115, v115
v_mfma_f32_16x16x32_bf16 v[80:83], v[52:55], a[48:51], v[80:83]
v_fma_f32 v212, v212, v233, v232
v_fma_f32 v214, v214, v233, v232
v_mfma_f32_16x16x32_bf16 v[84:87], v[48:51], a[36:39], v[84:87]
ds_read_b128 v[72:75], v2 offset:47104
v_mul_f32 v212, v212, v114
v_mfma_f32_16x16x32_bf16 v[84:87], v[52:55], a[52:55], v[84:87]
v_mul_f32 v214, v214, v115
v_mul_f32 v213, v114, v130
v_mfma_f32_16x16x32_bf16 v[88:91], v[48:51], a[40:43], v[88:91]
v_exp_f32 v212, v212
v_mfma_f32_16x16x32_bf16 v[88:91], v[52:55], a[56:59], v[88:91]
ds_read_b128 v[76:79], v2 offset:48128
v_mul_f32 v215, v115, v131
v_mfma_f32_16x16x32_bf16 v[92:95], v[48:51], a[44:47], v[92:95]
v_exp_f32 v214, v214
v_mfma_f32_16x16x32_bf16 v[92:95], v[52:55], a[60:63], v[92:95]
v_fma_f32 v212, v212, v234, v234
s_waitcnt lgkmcnt(4)
v_mfma_f32_16x16x32_bf16 v[96:99], v[56:59], a[32:35], v[96:99]
s_waitcnt vmcnt(22)
v_fma_f32 v214, v214, v234, v234
v_mfma_f32_16x16x32_bf16 v[96:99], v[60:63], a[48:51], v[96:99]
s_barrier
v_mfma_f32_16x16x32_bf16 v[100:103], v[56:59], a[36:39], v[100:103]
ds_read_b128 v[48:51], v2 offset:49152
s_add_u32 m0, s22, 0
v_mfma_f32_16x16x32_bf16 v[100:103], v[60:63], a[52:55], v[100:103]
v_add_u32 v3, 20480, v3
buffer_load_dwordx4 v3, s[8:11], 0 offen offset:0 lds
v_mfma_f32_16x16x32_bf16 v[104:107], v[56:59], a[40:43], v[104:107]
v_rcp_f32 v212, v212
v_mfma_f32_16x16x32_bf16 v[104:107], v[60:63], a[56:59], v[104:107]
ds_read_b128 v[52:55], v2 offset:50176
v_mul_f32 v213, v213, v212
v_mfma_f32_16x16x32_bf16 v[108:111], v[56:59], a[44:47], v[108:111]
v_rcp_f32 v214, v214
v_mfma_f32_16x16x32_bf16 v[108:111], v[60:63], a[60:63], v[108:111]
v_mul_f32 v215, v215, v214
s_waitcnt lgkmcnt(4)
v_mfma_f32_16x16x32_bf16 v[80:83], v[64:67], a[64:67], v[80:83]
buffer_load_dwordx4 v3, s[8:11], 0 offen offset:1024 lds
v_mfma_f32_16x16x32_bf16 v[80:83], v[68:71], a[80:83], v[80:83]
v_cvt_pk_bf16_f32 v163, v213, v215
v_mul_f32 v208, v116, v116
v_mfma_f32_16x16x32_bf16 v[84:87], v[64:67], a[68:71], v[84:87]
ds_read_b128 v[56:59], v2 offset:51200
v_mul_f32 v210, v117, v117
v_mfma_f32_16x16x32_bf16 v[84:87], v[68:71], a[84:87], v[84:87]
buffer_store_dwordx4 v[160:163], v2, s[8:11], s24 offen offset:1024 sc1
v_mfma_f32_16x16x32_bf16 v[88:91], v[64:67], a[72:75], v[88:91]
v_fma_f32 v208, v208, v236, v235
v_fma_f32 v210, v210, v236, v235
v_mfma_f32_16x16x32_bf16 v[88:91], v[68:71], a[88:91], v[88:91]
ds_read_b128 v[60:63], v2 offset:52224
v_mul_f32 v208, v208, v116
v_mfma_f32_16x16x32_bf16 v[92:95], v[64:67], a[76:79], v[92:95]
v_mul_f32 v210, v210, v117
v_mul_f32 v209, v116, v132
v_mfma_f32_16x16x32_bf16 v[92:95], v[68:71], a[92:95], v[92:95]
v_mul_f32 v211, v117, v133
s_waitcnt lgkmcnt(4)
v_mfma_f32_16x16x32_bf16 v[96:99], v[72:75], a[64:67], v[96:99]
buffer_load_dwordx4 v3, s[8:11], 0 offen offset:2048 lds
v_mfma_f32_16x16x32_bf16 v[96:99], v[76:79], a[80:83], v[96:99]
v_exp_f32 v208, v208
v_mfma_f32_16x16x32_bf16 v[100:103], v[72:75], a[68:71], v[100:103]
ds_read_b128 v[64:67], v2 offset:53248
v_fma_f32 v208, v208, v237, v237
v_mfma_f32_16x16x32_bf16 v[100:103], v[76:79], a[84:87], v[100:103]
v_exp_f32 v210, v210
v_mfma_f32_16x16x32_bf16 v[104:107], v[72:75], a[72:75], v[104:107]
buffer_load_dwordx4 v3, s[8:11], 0 offen offset:3072 lds
v_mfma_f32_16x16x32_bf16 v[104:107], v[76:79], a[88:91], v[104:107]
ds_read_b128 v[68:71], v2 offset:54272
s_add_u32 m0, s22, 4096
v_mfma_f32_16x16x32_bf16 v[108:111], v[72:75], a[76:79], v[108:111]
v_add_u32 v3, 4096, v3
v_fma_f32 v210, v210, v237, v237
v_mfma_f32_16x16x32_bf16 v[108:111], v[76:79], a[92:95], v[108:111]
v_mul_f32 v212, v118, v118
s_waitcnt lgkmcnt(4)
v_mfma_f32_16x16x32_bf16 v[80:83], v[48:51], a[96:99], v[80:83]
buffer_load_dwordx4 v3, s[8:11], 0 offen offset:0 lds
v_mfma_f32_16x16x32_bf16 v[80:83], v[52:55], a[112:115], v[80:83]
v_rcp_f32 v208, v208
v_mfma_f32_16x16x32_bf16 v[84:87], v[48:51], a[100:103], v[84:87]
ds_read_b128 v[72:75], v2 offset:55296
v_mul_f32 v209, v209, v208
v_mfma_f32_16x16x32_bf16 v[84:87], v[52:55], a[116:119], v[84:87]
v_rcp_f32 v210, v210
v_mfma_f32_16x16x32_bf16 v[88:91], v[48:51], a[104:107], v[88:91]
buffer_load_dwordx4 v3, s[8:11], 0 offen offset:1024 lds
v_mfma_f32_16x16x32_bf16 v[88:91], v[52:55], a[120:123], v[88:91]
ds_read_b128 v[76:79], v2 offset:56320
v_mul_f32 v211, v211, v210
v_mfma_f32_16x16x32_bf16 v[92:95], v[48:51], a[108:111], v[92:95]
v_cvt_pk_bf16_f32 v166, v209, v211
v_mul_f32 v214, v119, v119
v_mfma_f32_16x16x32_bf16 v[92:95], v[52:55], a[124:127], v[92:95]
v_fma_f32 v212, v212, v236, v235
s_waitcnt lgkmcnt(4)
v_mfma_f32_16x16x32_bf16 v[96:99], v[56:59], a[96:99], v[96:99]
v_fma_f32 v214, v214, v236, v235
v_mul_f32 v212, v212, v118
v_mfma_f32_16x16x32_bf16 v[96:99], v[60:63], a[112:115], v[96:99]
v_mul_f32 v214, v214, v119
v_mul_f32 v213, v118, v134
v_mfma_f32_16x16x32_bf16 v[100:103], v[56:59], a[100:103], v[100:103]
ds_read_b128 v[48:51], v2 offset:57344
v_mul_f32 v215, v119, v135
v_mfma_f32_16x16x32_bf16 v[100:103], v[60:63], a[116:119], v[100:103]
v_exp_f32 v212, v212
v_mfma_f32_16x16x32_bf16 v[104:107], v[56:59], a[104:107], v[104:107]
v_exp_f32 v214, v214
v_mfma_f32_16x16x32_bf16 v[104:107], v[60:63], a[120:123], v[104:107]
ds_read_b128 v[52:55], v2 offset:58368
v_fma_f32 v212, v212, v237, v237
v_mfma_f32_16x16x32_bf16 v[108:111], v[56:59], a[108:111], v[108:111]
v_fma_f32 v214, v214, v237, v237
v_mul_f32 v208, v120, v120
v_mfma_f32_16x16x32_bf16 v[108:111], v[60:63], a[124:127], v[108:111]
v_mul_f32 v210, v121, v121
s_waitcnt lgkmcnt(4)
v_mfma_f32_16x16x32_bf16 v[80:83], v[64:67], a[128:131], v[80:83]
v_rcp_f32 v212, v212
v_mfma_f32_16x16x32_bf16 v[80:83], v[68:71], a[144:147], v[80:83]
v_rcp_f32 v214, v214
v_mfma_f32_16x16x32_bf16 v[84:87], v[64:67], a[132:135], v[84:87]
ds_read_b128 v[56:59], v2 offset:59392
v_mul_f32 v213, v213, v212
v_mfma_f32_16x16x32_bf16 v[84:87], v[68:71], a[148:151], v[84:87]
v_mul_f32 v215, v215, v214
v_cvt_pk_bf16_f32 v167, v213, v215
v_mfma_f32_16x16x32_bf16 v[88:91], v[64:67], a[136:139], v[88:91]
buffer_store_dwordx4 v[164:167], v4, s[8:11], s24 offen offset:1024 sc1
v_mfma_f32_16x16x32_bf16 v[88:91], v[68:71], a[152:155], v[88:91]
ds_read_b128 v[60:63], v2 offset:60416
v_fma_f32 v208, v208, v239, v238
v_mfma_f32_16x16x32_bf16 v[92:95], v[64:67], a[140:143], v[92:95]
v_fma_f32 v210, v210, v239, v238
v_mul_f32 v208, v208, v120
v_mfma_f32_16x16x32_bf16 v[92:95], v[68:71], a[156:159], v[92:95]
v_mul_f32 v210, v210, v121
s_waitcnt lgkmcnt(4)
v_mfma_f32_16x16x32_bf16 v[96:99], v[72:75], a[128:131], v[96:99]
v_exp_f32 v208, v208
v_mfma_f32_16x16x32_bf16 v[96:99], v[76:79], a[144:147], v[96:99]
v_exp_f32 v210, v210
v_mfma_f32_16x16x32_bf16 v[100:103], v[72:75], a[132:135], v[100:103]
ds_read_b128 v[64:67], v2 offset:61440
v_mul_f32 v209, v120, v136
v_mfma_f32_16x16x32_bf16 v[100:103], v[76:79], a[148:151], v[100:103]
v_mul_f32 v211, v121, v137
v_fma_f32 v208, v208, v240, v240
v_mfma_f32_16x16x32_bf16 v[104:107], v[72:75], a[136:139], v[104:107]
v_fma_f32 v210, v210, v240, v240
v_mul_f32 v212, v122, v122
v_mfma_f32_16x16x32_bf16 v[104:107], v[76:79], a[152:155], v[104:107]
ds_read_b128 v[68:71], v2 offset:62464
v_mul_f32 v214, v123, v123
v_mfma_f32_16x16x32_bf16 v[108:111], v[72:75], a[140:143], v[108:111]
v_rcp_f32 v208, v208
v_mfma_f32_16x16x32_bf16 v[108:111], v[76:79], a[156:159], v[108:111]
v_mul_f32 v209, v209, v208
s_waitcnt lgkmcnt(4)
v_mfma_f32_16x16x32_bf16 v[80:83], v[48:51], a[160:163], v[80:83]
v_rcp_f32 v210, v210
v_mfma_f32_16x16x32_bf16 v[80:83], v[52:55], a[176:179], v[80:83]
v_mul_f32 v211, v211, v210
v_cvt_pk_bf16_f32 v170, v209, v211
v_mfma_f32_16x16x32_bf16 v[84:87], v[48:51], a[164:167], v[84:87]
ds_read_b128 v[72:75], v2 offset:63488
v_fma_f32 v212, v212, v239, v238
v_mfma_f32_16x16x32_bf16 v[84:87], v[52:55], a[180:183], v[84:87]
v_fma_f32 v214, v214, v239, v238
v_mul_f32 v212, v212, v122
v_mfma_f32_16x16x32_bf16 v[88:91], v[48:51], a[168:171], v[88:91]
v_mul_f32 v214, v214, v123
v_mul_f32 v213, v122, v138
v_mfma_f32_16x16x32_bf16 v[88:91], v[52:55], a[184:187], v[88:91]
ds_read_b128 v[76:79], v2 offset:64512
v_mul_f32 v215, v123, v139
v_mfma_f32_16x16x32_bf16 v[92:95], v[48:51], a[172:175], v[92:95]
v_exp_f32 v212, v212
v_mfma_f32_16x16x32_bf16 v[92:95], v[52:55], a[188:191], v[92:95]
v_fma_f32 v212, v212, v240, v240
s_waitcnt lgkmcnt(4)
v_mfma_f32_16x16x32_bf16 v[96:99], v[56:59], a[160:163], v[96:99]
v_exp_f32 v214, v214
v_mfma_f32_16x16x32_bf16 v[96:99], v[60:63], a[176:179], v[96:99]
v_fma_f32 v214, v214, v240, v240
v_mul_f32 v208, v124, v124
v_mfma_f32_16x16x32_bf16 v[100:103], v[56:59], a[164:167], v[100:103]
ds_read_b128 v[48:51], v7 offset:0
v_mul_f32 v210, v125, v125
v_mfma_f32_16x16x32_bf16 v[100:103], v[60:63], a[180:183], v[100:103]
v_rcp_f32 v212, v212
v_mfma_f32_16x16x32_bf16 v[104:107], v[56:59], a[168:171], v[104:107]
v_rcp_f32 v214, v214
v_mfma_f32_16x16x32_bf16 v[104:107], v[60:63], a[184:187], v[104:107]
ds_read_b128 v[52:55], v7 offset:1024
v_mul_f32 v213, v213, v212
v_mfma_f32_16x16x32_bf16 v[108:111], v[56:59], a[172:175], v[108:111]
v_mul_f32 v215, v215, v214
v_cvt_pk_bf16_f32 v171, v213, v215
v_mfma_f32_16x16x32_bf16 v[108:111], v[60:63], a[188:191], v[108:111]
v_fma_f32 v208, v208, v242, v241
s_waitcnt lgkmcnt(4)
v_mfma_f32_16x16x32_bf16 v[80:83], v[64:67], a[192:195], v[80:83]
buffer_store_dwordx4 v[168:171], v5, s[8:11], s24 offen offset:1024 sc1
v_mfma_f32_16x16x32_bf16 v[80:83], v[68:71], a[208:211], v[80:83]
v_fma_f32 v210, v210, v242, v241
v_mul_f32 v208, v208, v124
v_mfma_f32_16x16x32_bf16 v[84:87], v[64:67], a[196:199], v[84:87]
ds_read_b128 v[56:59], v7 offset:2048
v_mul_f32 v210, v210, v125
v_mfma_f32_16x16x32_bf16 v[84:87], v[68:71], a[212:215], v[84:87]
v_exp_f32 v208, v208
v_mfma_f32_16x16x32_bf16 v[88:91], v[64:67], a[200:203], v[88:91]
v_exp_f32 v210, v210
v_mfma_f32_16x16x32_bf16 v[88:91], v[68:71], a[216:219], v[88:91]
ds_read_b128 v[60:63], v7 offset:3072
v_mul_f32 v209, v124, v140
v_mfma_f32_16x16x32_bf16 v[92:95], v[64:67], a[204:207], v[92:95]
v_mul_f32 v211, v125, v141
v_fma_f32 v208, v208, v243, v243
v_mfma_f32_16x16x32_bf16 v[92:95], v[68:71], a[220:223], v[92:95]
v_fma_f32 v210, v210, v243, v243
s_waitcnt lgkmcnt(4)
v_mfma_f32_16x16x32_bf16 v[96:99], v[72:75], a[192:195], v[96:99]
v_rcp_f32 v208, v208
v_mfma_f32_16x16x32_bf16 v[96:99], v[76:79], a[208:211], v[96:99]
v_rcp_f32 v210, v210
v_mfma_f32_16x16x32_bf16 v[100:103], v[72:75], a[196:199], v[100:103]
ds_read_b128 v[64:67], v7 offset:4096
v_mul_f32 v209, v209, v208
v_mfma_f32_16x16x32_bf16 v[100:103], v[76:79], a[212:215], v[100:103]
v_mul_f32 v211, v211, v210
v_cvt_pk_bf16_f32 v174, v209, v211
v_mfma_f32_16x16x32_bf16 v[104:107], v[72:75], a[200:203], v[104:107]
v_mul_f32 v212, v126, v126
v_mul_f32 v214, v127, v127
v_mfma_f32_16x16x32_bf16 v[104:107], v[76:79], a[216:219], v[104:107]
ds_read_b128 v[68:71], v7 offset:5120
v_fma_f32 v212, v212, v242, v241
v_mfma_f32_16x16x32_bf16 v[108:111], v[72:75], a[204:207], v[108:111]
v_fma_f32 v214, v214, v242, v241
v_mul_f32 v212, v212, v126
v_mfma_f32_16x16x32_bf16 v[108:111], v[76:79], a[220:223], v[108:111]
v_mul_f32 v214, v214, v127
s_waitcnt lgkmcnt(4)
v_mfma_f32_16x16x32_bf16 v[80:83], v[48:51], a[224:227], v[80:83]
v_exp_f32 v212, v212
v_mfma_f32_16x16x32_bf16 v[80:83], v[52:55], a[240:243], v[80:83]
v_exp_f32 v214, v214
v_mfma_f32_16x16x32_bf16 v[84:87], v[48:51], a[228:231], v[84:87]
ds_read_b128 v[72:75], v7 offset:6144
v_mul_f32 v213, v126, v142
v_mfma_f32_16x16x32_bf16 v[84:87], v[52:55], a[244:247], v[84:87]
v_mul_f32 v215, v127, v143
v_fma_f32 v212, v212, v243, v243
v_mfma_f32_16x16x32_bf16 v[88:91], v[48:51], a[232:235], v[88:91]
v_fma_f32 v214, v214, v243, v243
v_mul_f32 v222, v187, v187
v_mfma_f32_16x16x32_bf16 v[88:91], v[52:55], a[248:251], v[88:91]
ds_read_b128 v[76:79], v7 offset:7168
v_fma_f32 v220, v220, v239, v238
v_mfma_f32_16x16x32_bf16 v[92:95], v[48:51], a[236:239], v[92:95]
v_rcp_f32 v212, v212
v_mfma_f32_16x16x32_bf16 v[92:95], v[52:55], a[252:255], v[92:95]
v_mul_f32 v213, v213, v212
s_waitcnt lgkmcnt(4)
v_mfma_f32_16x16x32_bf16 v[96:99], v[56:59], a[224:227], v[96:99]
s_waitcnt vmcnt(23)
v_fma_f32 v222, v222, v239, v238
v_mfma_f32_16x16x32_bf16 v[96:99], v[60:63], a[240:243], v[96:99]
s_barrier
v_mfma_f32_16x16x32_bf16 v[100:103], v[56:59], a[228:231], v[100:103]
ds_read_b128 v[48:51], v7 offset:8192
s_add_u32 m0, s22, 24576
v_mfma_f32_16x16x32_bf16 v[100:103], v[60:63], a[244:247], v[100:103]
v_add_u32 v3, 20480, v3
buffer_load_dwordx4 v3, s[8:11], 0 offen offset:0 lds
v_mfma_f32_16x16x32_bf16 v[104:107], v[56:59], a[232:235], v[104:107]
v_rcp_f32 v214, v214
v_mfma_f32_16x16x32_bf16 v[104:107], v[60:63], a[248:251], v[104:107]
ds_read_b128 v[52:55], v7 offset:9216
v_mul_f32 v215, v215, v214
v_mfma_f32_16x16x32_bf16 v[108:111], v[56:59], a[236:239], v[108:111]
v_cvt_pk_bf16_f32 v175, v213, v215
v_mul_f32 v220, v220, v186
v_mfma_f32_16x16x32_bf16 v[108:111], v[60:63], a[252:255], v[108:111]
v_mul_f32 v222, v222, v187
s_waitcnt lgkmcnt(4)
v_mfma_f32_16x16x32_bf16 v[80:83], v[64:67], v[16:19], v[80:83]
buffer_load_dwordx4 v3, s[8:11], 0 offen offset:1024 lds
v_mfma_f32_16x16x32_bf16 v[80:83], v[68:71], v[32:35], v[80:83]
v_exp_f32 v220, v220
v_mfma_f32_16x16x32_bf16 v[84:87], v[64:67], v[20:23], v[84:87]
ds_read_b128 v[56:59], v7 offset:10240
v_mul_f32 v221, v186, v202
v_mfma_f32_16x16x32_bf16 v[84:87], v[68:71], v[36:39], v[84:87]
buffer_store_dwordx4 v[172:175], v6, s[8:11], s24 offen offset:1024 sc1
v_mfma_f32_16x16x32_bf16 v[88:91], v[64:67], v[24:27], v[88:91]
v_exp_f32 v222, v222
v_mfma_f32_16x16x32_bf16 v[88:91], v[68:71], v[40:43], v[88:91]
ds_read_b128 v[60:63], v7 offset:11264
v_mul_f32 v223, v187, v203
v_mfma_f32_16x16x32_bf16 v[92:95], v[64:67], v[28:31], v[92:95]
v_fma_f32 v220, v220, v240, v240
v_fma_f32 v222, v222, v240, v240
v_mfma_f32_16x16x32_bf16 v[92:95], v[68:71], v[44:47], v[92:95]
v_mul_f32 v216, v188, v188
s_waitcnt lgkmcnt(4)
v_mfma_f32_16x16x32_bf16 v[96:99], v[72:75], v[16:19], v[96:99]
buffer_load_dwordx4 v3, s[8:11], 0 offen offset:2048 lds
v_mfma_f32_16x16x32_bf16 v[96:99], v[76:79], v[32:35], v[96:99]
v_rcp_f32 v220, v220
v_mfma_f32_16x16x32_bf16 v[100:103], v[72:75], v[20:23], v[100:103]
ds_read_b128 v[64:67], v7 offset:12288
v_mul_f32 v221, v221, v220
v_mfma_f32_16x16x32_bf16 v[100:103], v[76:79], v[36:39], v[100:103]
v_rcp_f32 v222, v222
v_mfma_f32_16x16x32_bf16 v[104:107], v[72:75], v[24:27], v[104:107]
buffer_load_dwordx4 v3, s[8:11], 0 offen offset:3072 lds
v_mfma_f32_16x16x32_bf16 v[104:107], v[76:79], v[40:43], v[104:107]
ds_read_b128 v[68:71], v7 offset:13312
s_add_u32 m0, s22, 28672
v_mfma_f32_16x16x32_bf16 v[108:111], v[72:75], v[28:31], v[108:111]
v_add_u32 v3, 4096, v3
v_mul_f32 v223, v223, v222
v_mfma_f32_16x16x32_bf16 v[108:111], v[76:79], v[44:47], v[108:111]
v_cvt_pk_bf16_f32 v155, v221, v223
s_waitcnt lgkmcnt(4)
v_mfma_f32_16x16x32_bf16 v[112:115], v[48:51], a[0:3], 0
buffer_load_dwordx4 v3, s[8:11], 0 offen offset:0 lds
v_mfma_f32_16x16x32_bf16 v[112:115], v[52:55], a[16:19], v[112:115]
v_mul_f32 v218, v189, v189
v_fma_f32 v216, v216, v242, v241
v_mfma_f32_16x16x32_bf16 v[116:119], v[48:51], a[4:7], 0
ds_read_b128 v[72:75], v7 offset:14336
v_fma_f32 v218, v218, v242, v241
v_mfma_f32_16x16x32_bf16 v[116:119], v[52:55], a[20:23], v[116:119]
buffer_store_dwordx4 v[152:155], v5, s[8:11], s24 offen offset:0 sc1
v_mfma_f32_16x16x32_bf16 v[120:123], v[48:51], a[8:11], 0
v_mul_f32 v216, v216, v188
v_mul_f32 v218, v218, v189
v_mfma_f32_16x16x32_bf16 v[120:123], v[52:55], a[24:27], v[120:123]
ds_read_b128 v[76:79], v7 offset:15360
v_mul_f32 v217, v188, v204
v_mfma_f32_16x16x32_bf16 v[124:127], v[48:51], a[12:15], 0
v_exp_f32 v216, v216
v_mfma_f32_16x16x32_bf16 v[124:127], v[52:55], a[28:31], v[124:127]
v_mul_f32 v219, v189, v205
s_waitcnt lgkmcnt(4)
v_mfma_f32_16x16x32_bf16 v[128:131], v[56:59], a[0:3], 0
buffer_load_dwordx4 v3, s[8:11], 0 offen offset:1024 lds
v_mfma_f32_16x16x32_bf16 v[128:131], v[60:63], a[16:19], v[128:131]
v_exp_f32 v218, v218
v_mfma_f32_16x16x32_bf16 v[132:135], v[56:59], a[4:7], 0
ds_read_b128 v[48:51], v7 offset:16384
v_fma_f32 v216, v216, v243, v243
v_mfma_f32_16x16x32_bf16 v[132:135], v[60:63], a[20:23], v[132:135]
v_fma_f32 v218, v218, v243, v243
v_mul_f32 v220, v190, v190
v_mfma_f32_16x16x32_bf16 v[136:139], v[56:59], a[8:11], 0
v_rcp_f32 v216, v216
v_mfma_f32_16x16x32_bf16 v[136:139], v[60:63], a[24:27], v[136:139]
ds_read_b128 v[52:55], v7 offset:17408
v_mul_f32 v217, v217, v216
v_mfma_f32_16x16x32_bf16 v[140:143], v[56:59], a[12:15], 0
v_rcp_f32 v218, v218
v_mfma_f32_16x16x32_bf16 v[140:143], v[60:63], a[28:31], v[140:143]
v_mul_f32 v219, v219, v218
s_waitcnt lgkmcnt(4)
v_mfma_f32_16x16x32_bf16 v[112:115], v[64:67], a[32:35], v[112:115]
v_cvt_pk_bf16_f32 v158, v217, v219
v_mul_f32 v222, v191, v191
v_mfma_f32_16x16x32_bf16 v[112:115], v[68:71], a[48:51], v[112:115]
v_fma_f32 v220, v220, v242, v241
v_fma_f32 v222, v222, v242, v241
v_mfma_f32_16x16x32_bf16 v[116:119], v[64:67], a[36:39], v[116:119]
ds_read_b128 v[56:59], v7 offset:18432
v_mul_f32 v220, v220, v190
v_mfma_f32_16x16x32_bf16 v[116:119], v[68:71], a[52:55], v[116:119]
v_mul_f32 v222, v222, v191
v_mul_f32 v221, v190, v206
v_mfma_f32_16x16x32_bf16 v[120:123], v[64:67], a[40:43], v[120:123]
v_exp_f32 v220, v220
v_mfma_f32_16x16x32_bf16 v[120:123], v[68:71], a[56:59], v[120:123]
ds_read_b128 v[60:63], v7 offset:19456
v_mul_f32 v223, v191, v207
v_mfma_f32_16x16x32_bf16 v[124:127], v[64:67], a[44:47], v[124:127]
v_exp_f32 v222, v222
v_mfma_f32_16x16x32_bf16 v[124:127], v[68:71], a[60:63], v[124:127]
v_fma_f32 v220, v220, v243, v243
s_waitcnt lgkmcnt(4)
v_mfma_f32_16x16x32_bf16 v[128:131], v[72:75], a[32:35], v[128:131]
v_fma_f32 v222, v222, v243, v243
v_mfma_f32_16x16x32_bf16 v[128:131], v[76:79], a[48:51], v[128:131]
v_rcp_f32 v220, v220
v_mfma_f32_16x16x32_bf16 v[132:135], v[72:75], a[36:39], v[132:135]
ds_read_b128 v[64:67], v7 offset:20480
v_mul_f32 v221, v221, v220
v_mfma_f32_16x16x32_bf16 v[132:135], v[76:79], a[52:55], v[132:135]
v_rcp_f32 v222, v222
v_mfma_f32_16x16x32_bf16 v[136:139], v[72:75], a[40:43], v[136:139]
v_mul_f32 v223, v223, v222
v_cvt_pk_bf16_f32 v159, v221, v223
v_mfma_f32_16x16x32_bf16 v[136:139], v[76:79], a[56:59], v[136:139]
ds_read_b128 v[68:71], v7 offset:21504
v_mfma_f32_16x16x32_bf16 v[140:143], v[72:75], a[44:47], v[140:143]
buffer_store_dwordx4 v[156:159], v6, s[8:11], s24 offen offset:0 sc1
v_mfma_f32_16x16x32_bf16 v[140:143], v[76:79], a[60:63], v[140:143]
v_mul_f32 v208, v80, v80
s_waitcnt lgkmcnt(4)
v_mfma_f32_16x16x32_bf16 v[112:115], v[48:51], a[64:67], v[112:115]
v_mul_f32 v210, v81, v81
v_fma_f32 v208, v208, v233, v232
v_mfma_f32_16x16x32_bf16 v[112:115], v[52:55], a[80:83], v[112:115]
v_fma_f32 v210, v210, v233, v232
v_mul_f32 v208, v208, v80
v_mfma_f32_16x16x32_bf16 v[116:119], v[48:51], a[68:71], v[116:119]
ds_read_b128 v[72:75], v7 offset:22528
v_mul_f32 v210, v210, v81
v_mfma_f32_16x16x32_bf16 v[116:119], v[52:55], a[84:87], v[116:119]
v_exp_f32 v208, v208
v_mfma_f32_16x16x32_bf16 v[120:123], v[48:51], a[72:75], v[120:123]
v_exp_f32 v210, v210
v_mfma_f32_16x16x32_bf16 v[120:123], v[52:55], a[88:91], v[120:123]
ds_read_b128 v[76:79], v7 offset:23552
v_mul_f32 v209, v80, v96
v_mfma_f32_16x16x32_bf16 v[124:127], v[48:51], a[76:79], v[124:127]
v_mul_f32 v211, v81, v97
v_fma_f32 v208, v208, v234, v234
v_mfma_f32_16x16x32_bf16 v[124:127], v[52:55], a[92:95], v[124:127]
v_fma_f32 v210, v210, v234, v234
s_waitcnt lgkmcnt(4)
v_mfma_f32_16x16x32_bf16 v[128:131], v[56:59], a[64:67], v[128:131]
v_rcp_f32 v208, v208
v_mfma_f32_16x16x32_bf16 v[128:131], v[60:63], a[80:83], v[128:131]
v_rcp_f32 v210, v210
v_mfma_f32_16x16x32_bf16 v[132:135], v[56:59], a[68:71], v[132:135]
ds_read_b128 v[48:51], v7 offset:24576
v_mul_f32 v209, v209, v208
v_mfma_f32_16x16x32_bf16 v[132:135], v[60:63], a[84:87], v[132:135]
v_mul_f32 v211, v211, v210
v_cvt_pk_bf16_f32 v176, v209, v211
v_mfma_f32_16x16x32_bf16 v[136:139], v[56:59], a[72:75], v[136:139]
v_mul_f32 v212, v82, v82
v_mul_f32 v214, v83, v83
v_mfma_f32_16x16x32_bf16 v[136:139], v[60:63], a[88:91], v[136:139]
ds_read_b128 v[52:55], v7 offset:25600
v_fma_f32 v212, v212, v233, v232
v_mfma_f32_16x16x32_bf16 v[140:143], v[56:59], a[76:79], v[140:143]
v_fma_f32 v214, v214, v233, v232
v_mul_f32 v212, v212, v82
v_mfma_f32_16x16x32_bf16 v[140:143], v[60:63], a[92:95], v[140:143]
v_mul_f32 v214, v214, v83
s_waitcnt lgkmcnt(4)
v_mfma_f32_16x16x32_bf16 v[112:115], v[64:67], a[96:99], v[112:115]
v_exp_f32 v212, v212
v_mfma_f32_16x16x32_bf16 v[112:115], v[68:71], a[112:115], v[112:115]
v_exp_f32 v214, v214
v_mfma_f32_16x16x32_bf16 v[116:119], v[64:67], a[100:103], v[116:119]
ds_read_b128 v[56:59], v7 offset:26624
v_mul_f32 v213, v82, v98
v_mfma_f32_16x16x32_bf16 v[116:119], v[68:71], a[116:119], v[116:119]
v_mul_f32 v215, v83, v99
v_fma_f32 v212, v212, v234, v234
v_mfma_f32_16x16x32_bf16 v[120:123], v[64:67], a[104:107], v[120:123]
v_fma_f32 v214, v214, v234, v234
v_mul_f32 v208, v84, v84
v_mfma_f32_16x16x32_bf16 v[120:123], v[68:71], a[120:123], v[120:123]
ds_read_b128 v[60:63], v7 offset:27648
v_mul_f32 v210, v85, v85
v_mfma_f32_16x16x32_bf16 v[124:127], v[64:67], a[108:111], v[124:127]
v_rcp_f32 v212, v212
v_mfma_f32_16x16x32_bf16 v[124:127], v[68:71], a[124:127], v[124:127]
v_mul_f32 v213, v213, v212
s_waitcnt lgkmcnt(4)
v_mfma_f32_16x16x32_bf16 v[128:131], v[72:75], a[96:99], v[128:131]
v_rcp_f32 v214, v214
v_mfma_f32_16x16x32_bf16 v[128:131], v[76:79], a[112:115], v[128:131]
v_mul_f32 v215, v215, v214
v_cvt_pk_bf16_f32 v177, v213, v215
v_mfma_f32_16x16x32_bf16 v[132:135], v[72:75], a[100:103], v[132:135]
ds_read_b128 v[64:67], v7 offset:28672
v_fma_f32 v208, v208, v236, v235
v_mfma_f32_16x16x32_bf16 v[132:135], v[76:79], a[116:119], v[132:135]
v_fma_f32 v210, v210, v236, v235
v_mul_f32 v208, v208, v84
v_mfma_f32_16x16x32_bf16 v[136:139], v[72:75], a[104:107], v[136:139]
v_mul_f32 v210, v210, v85
v_mul_f32 v209, v84, v100
v_mfma_f32_16x16x32_bf16 v[136:139], v[76:79], a[120:123], v[136:139]
ds_read_b128 v[68:71], v7 offset:29696
v_mul_f32 v211, v85, v101
v_mfma_f32_16x16x32_bf16 v[140:143], v[72:75], a[108:111], v[140:143]
v_exp_f32 v208, v208
v_mfma_f32_16x16x32_bf16 v[140:143], v[76:79], a[124:127], v[140:143]
v_fma_f32 v208, v208, v237, v237
s_waitcnt lgkmcnt(4)
v_mfma_f32_16x16x32_bf16 v[112:115], v[48:51], a[128:131], v[112:115]
v_exp_f32 v210, v210
v_mfma_f32_16x16x32_bf16 v[112:115], v[52:55], a[144:147], v[112:115]
v_fma_f32 v210, v210, v237, v237
v_mul_f32 v212, v86, v86
v_mfma_f32_16x16x32_bf16 v[116:119], v[48:51], a[132:135], v[116:119]
ds_read_b128 v[72:75], v7 offset:30720
v_mul_f32 v214, v87, v87
v_mfma_f32_16x16x32_bf16 v[116:119], v[52:55], a[148:151], v[116:119]
v_rcp_f32 v208, v208
v_mfma_f32_16x16x32_bf16 v[120:123], v[48:51], a[136:139], v[120:123]
v_rcp_f32 v210, v210
v_mfma_f32_16x16x32_bf16 v[120:123], v[52:55], a[152:155], v[120:123]
ds_read_b128 v[76:79], v7 offset:31744
v_mul_f32 v209, v209, v208
v_mfma_f32_16x16x32_bf16 v[124:127], v[48:51], a[140:143], v[124:127]
v_mul_f32 v211, v211, v210
v_cvt_pk_bf16_f32 v180, v209, v211
v_mfma_f32_16x16x32_bf16 v[124:127], v[52:55], a[156:159], v[124:127]
v_fma_f32 v212, v212, v236, v235
s_waitcnt lgkmcnt(4)
v_mfma_f32_16x16x32_bf16 v[128:131], v[56:59], a[128:131], v[128:131]
s_waitcnt vmcnt(25)
v_fma_f32 v214, v214, v236, v235
v_mfma_f32_16x16x32_bf16 v[128:131], v[60:63], a[144:147], v[128:131]
s_barrier
v_mfma_f32_16x16x32_bf16 v[132:135], v[56:59], a[132:135], v[132:135]
ds_read_b128 v[48:51], v7 offset:32768
s_add_u32 m0, s22, 49152
v_mfma_f32_16x16x32_bf16 v[132:135], v[60:63], a[148:151], v[132:135]
v_add_u32 v3, 20480, v3
buffer_load_dwordx4 v3, s[8:11], 0 offen offset:0 lds
v_mfma_f32_16x16x32_bf16 v[136:139], v[56:59], a[136:139], v[136:139]
v_mul_f32 v212, v212, v86
v_mul_f32 v214, v214, v87
v_mfma_f32_16x16x32_bf16 v[136:139], v[60:63], a[152:155], v[136:139]
ds_read_b128 v[52:55], v7 offset:33792
v_mul_f32 v213, v86, v102
v_mfma_f32_16x16x32_bf16 v[140:143], v[56:59], a[140:143], v[140:143]
v_exp_f32 v212, v212
v_mfma_f32_16x16x32_bf16 v[140:143], v[60:63], a[156:159], v[140:143]
v_mul_f32 v215, v87, v103
s_waitcnt lgkmcnt(4)
v_mfma_f32_16x16x32_bf16 v[112:115], v[64:67], a[160:163], v[112:115]
buffer_load_dwordx4 v3, s[8:11], 0 offen offset:1024 lds
v_mfma_f32_16x16x32_bf16 v[112:115], v[68:71], a[176:179], v[112:115]
v_exp_f32 v214, v214
v_mfma_f32_16x16x32_bf16 v[116:119], v[64:67], a[164:167], v[116:119]
ds_read_b128 v[56:59], v7 offset:34816
v_fma_f32 v212, v212, v237, v237
v_mfma_f32_16x16x32_bf16 v[116:119], v[68:71], a[180:183], v[116:119]
v_fma_f32 v214, v214, v237, v237
v_mul_f32 v208, v88, v88
v_mfma_f32_16x16x32_bf16 v[120:123], v[64:67], a[168:171], v[120:123]
buffer_load_dwordx4 v3, s[8:11], 0 offen offset:2048 lds
v_mfma_f32_16x16x32_bf16 v[120:123], v[68:71], a[184:187], v[120:123]
ds_read_b128 v[60:63], v7 offset:35840
v_mul_f32 v210, v89, v89
v_mfma_f32_16x16x32_bf16 v[124:127], v[64:67], a[172:175], v[124:127]
v_rcp_f32 v212, v212
v_mfma_f32_16x16x32_bf16 v[124:127], v[68:71], a[188:191], v[124:127]
v_mul_f32 v213, v213, v212
s_waitcnt lgkmcnt(4)
v_mfma_f32_16x16x32_bf16 v[128:131], v[72:75], a[160:163], v[128:131]
buffer_load_dwordx4 v3, s[8:11], 0 offen offset:3072 lds
v_mfma_f32_16x16x32_bf16 v[128:131], v[76:79], a[176:179], v[128:131]
s_add_u32 m0, s22, 53248
v_add_u32 v3, 4096, v3
v_mfma_f32_16x16x32_bf16 v[132:135], v[72:75], a[164:167], v[132:135]
ds_read_b128 v[64:67], v7 offset:36864
v_fma_f32 v208, v208, v239, v238
v_mfma_f32_16x16x32_bf16 v[132:135], v[76:79], a[180:183], v[132:135]
v_rcp_f32 v214, v214
v_mfma_f32_16x16x32_bf16 v[136:139], v[72:75], a[168:171], v[136:139]
buffer_load_dwordx4 v3, s[8:11], 0 offen offset:0 lds
v_mfma_f32_16x16x32_bf16 v[136:139], v[76:79], a[184:187], v[136:139]
ds_read_b128 v[68:71], v7 offset:37888
v_mul_f32 v215, v215, v214
v_mfma_f32_16x16x32_bf16 v[140:143], v[72:75], a[172:175], v[140:143]
v_cvt_pk_bf16_f32 v181, v213, v215
v_fma_f32 v210, v210, v239, v238
v_mfma_f32_16x16x32_bf16 v[140:143], v[76:79], a[188:191], v[140:143]
v_mul_f32 v208, v208, v88
s_waitcnt lgkmcnt(4)
v_mfma_f32_16x16x32_bf16 v[112:115], v[48:51], a[192:195], v[112:115]
buffer_load_dwordx4 v3, s[8:11], 0 offen offset:1024 lds
v_mfma_f32_16x16x32_bf16 v[112:115], v[52:55], a[208:211], v[112:115]
v_mul_f32 v210, v210, v89
v_mul_f32 v209, v88, v104
v_mfma_f32_16x16x32_bf16 v[116:119], v[48:51], a[196:199], v[116:119]
ds_read_b128 v[72:75], v7 offset:38912
v_mul_f32 v211, v89, v105
v_mfma_f32_16x16x32_bf16 v[116:119], v[52:55], a[212:215], v[116:119]
v_exp_f32 v208, v208
v_mfma_f32_16x16x32_bf16 v[120:123], v[48:51], a[200:203], v[120:123]
v_exp_f32 v210, v210
v_mfma_f32_16x16x32_bf16 v[120:123], v[52:55], a[216:219], v[120:123]
ds_read_b128 v[76:79], v7 offset:39936
v_fma_f32 v208, v208, v240, v240
v_mfma_f32_16x16x32_bf16 v[124:127], v[48:51], a[204:207], v[124:127]
v_fma_f32 v210, v210, v240, v240
v_mul_f32 v212, v90, v90
v_mfma_f32_16x16x32_bf16 v[124:127], v[52:55], a[220:223], v[124:127]
v_mul_f32 v214, v91, v91
s_waitcnt lgkmcnt(4)
v_mfma_f32_16x16x32_bf16 v[128:131], v[56:59], a[192:195], v[128:131]
v_mov_b32 v12, 1
s_waitcnt vmcnt(6)
buffer_store_dword v12, v10, s[8:11], s34 offen sc1
v_mfma_f32_16x16x32_bf16 v[128:131], v[60:63], a[208:211], v[128:131]
v_rcp_f32 v208, v208
v_mfma_f32_16x16x32_bf16 v[132:135], v[56:59], a[196:199], v[132:135]
ds_read_b128 v[48:51], v7 offset:40960
v_mul_f32 v209, v209, v208
v_mfma_f32_16x16x32_bf16 v[132:135], v[60:63], a[212:215], v[132:135]
v_rcp_f32 v210, v210
v_mfma_f32_16x16x32_bf16 v[136:139], v[56:59], a[200:203], v[136:139]
v_mul_f32 v211, v211, v210
v_cvt_pk_bf16_f32 v184, v209, v211
v_mfma_f32_16x16x32_bf16 v[136:139], v[60:63], a[216:219], v[136:139]
ds_read_b128 v[52:55], v7 offset:41984
v_fma_f32 v212, v212, v239, v238
v_mfma_f32_16x16x32_bf16 v[140:143], v[56:59], a[204:207], v[140:143]
v_fma_f32 v214, v214, v239, v238
v_mul_f32 v212, v212, v90
v_mfma_f32_16x16x32_bf16 v[140:143], v[60:63], a[220:223], v[140:143]
v_mul_f32 v214, v214, v91
s_waitcnt lgkmcnt(4)
v_mfma_f32_16x16x32_bf16 v[112:115], v[64:67], a[224:227], v[112:115]
v_exp_f32 v212, v212
v_mfma_f32_16x16x32_bf16 v[112:115], v[68:71], a[240:243], v[112:115]
v_exp_f32 v214, v214
v_mfma_f32_16x16x32_bf16 v[116:119], v[64:67], a[228:231], v[116:119]
ds_read_b128 v[56:59], v7 offset:43008
v_mul_f32 v213, v90, v106
v_mfma_f32_16x16x32_bf16 v[116:119], v[68:71], a[244:247], v[116:119]
v_mul_f32 v215, v91, v107
v_fma_f32 v212, v212, v240, v240
v_mfma_f32_16x16x32_bf16 v[120:123], v[64:67], a[232:235], v[120:123]
v_fma_f32 v214, v214, v240, v240
v_mul_f32 v208, v92, v92
v_mfma_f32_16x16x32_bf16 v[120:123], v[68:71], a[248:251], v[120:123]
ds_read_b128 v[60:63], v7 offset:44032
v_rcp_f32 v212, v212
v_mfma_f32_16x16x32_bf16 v[124:127], v[64:67], a[236:239], v[124:127]
v_rcp_f32 v214, v214
v_mfma_f32_16x16x32_bf16 v[124:127], v[68:71], a[252:255], v[124:127]
v_mul_f32 v213, v213, v212
s_waitcnt lgkmcnt(4)
v_mfma_f32_16x16x32_bf16 v[128:131], v[72:75], a[224:227], v[128:131]
v_mul_f32 v215, v215, v214
v_cvt_pk_bf16_f32 v185, v213, v215
v_mfma_f32_16x16x32_bf16 v[128:131], v[76:79], a[240:243], v[128:131]
v_mul_f32 v210, v93, v93
v_fma_f32 v208, v208, v242, v241
v_mfma_f32_16x16x32_bf16 v[132:135], v[72:75], a[228:231], v[132:135]
ds_read_b128 v[64:67], v7 offset:45056
v_fma_f32 v210, v210, v242, v241
v_mfma_f32_16x16x32_bf16 v[132:135], v[76:79], a[244:247], v[132:135]
v_mul_f32 v208, v208, v92
v_mul_f32 v210, v210, v93
v_mfma_f32_16x16x32_bf16 v[136:139], v[72:75], a[232:235], v[136:139]
v_exp_f32 v208, v208
v_mfma_f32_16x16x32_bf16 v[136:139], v[76:79], a[248:251], v[136:139]
ds_read_b128 v[68:71], v7 offset:46080
v_exp_f32 v210, v210
v_mfma_f32_16x16x32_bf16 v[140:143], v[72:75], a[236:239], v[140:143]
v_mul_f32 v209, v92, v108
v_mul_f32 v211, v93, v109
v_mfma_f32_16x16x32_bf16 v[140:143], v[76:79], a[252:255], v[140:143]
v_fma_f32 v208, v208, v243, v243
s_waitcnt lgkmcnt(4)
v_mfma_f32_16x16x32_bf16 v[112:115], v[48:51], v[16:19], v[112:115]
v_fma_f32 v210, v210, v243, v243
v_rcp_f32 v208, v208
v_mfma_f32_16x16x32_bf16 v[112:115], v[52:55], v[32:35], v[112:115]
v_rcp_f32 v210, v210
v_mfma_f32_16x16x32_bf16 v[116:119], v[48:51], v[20:23], v[116:119]
ds_read_b128 v[72:75], v7 offset:47104
v_mul_f32 v209, v209, v208
v_mfma_f32_16x16x32_bf16 v[116:119], v[52:55], v[36:39], v[116:119]
v_mul_f32 v211, v211, v210
v_cvt_pk_bf16_f32 v188, v209, v211
v_mfma_f32_16x16x32_bf16 v[120:123], v[48:51], v[24:27], v[120:123]
v_mul_f32 v212, v94, v94
v_mul_f32 v214, v95, v95
v_mfma_f32_16x16x32_bf16 v[120:123], v[52:55], v[40:43], v[120:123]
ds_read_b128 v[76:79], v7 offset:48128
v_fma_f32 v212, v212, v242, v241
v_mfma_f32_16x16x32_bf16 v[124:127], v[48:51], v[28:31], v[124:127]
v_fma_f32 v214, v214, v242, v241
v_mul_f32 v212, v212, v94
v_mfma_f32_16x16x32_bf16 v[124:127], v[52:55], v[44:47], v[124:127]
v_mul_f32 v214, v214, v95
s_waitcnt lgkmcnt(4)
v_mfma_f32_16x16x32_bf16 v[128:131], v[56:59], v[16:19], v[128:131]
v_exp_f32 v212, v212
v_mfma_f32_16x16x32_bf16 v[128:131], v[60:63], v[32:35], v[128:131]
v_exp_f32 v214, v214
v_mfma_f32_16x16x32_bf16 v[132:135], v[56:59], v[20:23], v[132:135]
ds_read_b128 v[48:51], v7 offset:49152
v_mul_f32 v213, v94, v110
v_mfma_f32_16x16x32_bf16 v[132:135], v[60:63], v[36:39], v[132:135]
v_mul_f32 v215, v95, v111
v_fma_f32 v212, v212, v243, v243
v_mfma_f32_16x16x32_bf16 v[136:139], v[56:59], v[24:27], v[136:139]
v_fma_f32 v214, v214, v243, v243
v_rcp_f32 v212, v212
v_mfma_f32_16x16x32_bf16 v[136:139], v[60:63], v[40:43], v[136:139]
ds_read_b128 v[52:55], v7 offset:50176
v_rcp_f32 v214, v214
v_mfma_f32_16x16x32_bf16 v[140:143], v[56:59], v[28:31], v[140:143]
v_mul_f32 v213, v213, v212
v_mul_f32 v215, v215, v214
v_mfma_f32_16x16x32_bf16 v[140:143], v[60:63], v[44:47], v[140:143]
v_cvt_pk_bf16_f32 v189, v213, v215
s_waitcnt lgkmcnt(4)
v_mfma_f32_16x16x32_bf16 v[80:83], v[64:67], a[0:3], 0
v_mfma_f32_16x16x32_bf16 v[80:83], v[68:71], a[16:19], v[80:83]
v_mfma_f32_16x16x32_bf16 v[84:87], v[64:67], a[4:7], 0
ds_read_b128 v[56:59], v7 offset:51200
v_mfma_f32_16x16x32_bf16 v[84:87], v[68:71], a[20:23], v[84:87]
v_mul_f32 v208, v112, v112
v_mul_f32 v210, v113, v113
v_mfma_f32_16x16x32_bf16 v[88:91], v[64:67], a[8:11], 0
v_fma_f32 v208, v208, v233, v232
v_fma_f32 v210, v210, v233, v232
v_mfma_f32_16x16x32_bf16 v[88:91], v[68:71], a[24:27], v[88:91]
ds_read_b128 v[60:63], v7 offset:52224
v_mul_f32 v208, v208, v112
v_mfma_f32_16x16x32_bf16 v[92:95], v[64:67], a[12:15], 0
v_mul_f32 v210, v210, v113
v_mul_f32 v209, v112, v128
v_mfma_f32_16x16x32_bf16 v[92:95], v[68:71], a[28:31], v[92:95]
v_mul_f32 v211, v113, v129
s_waitcnt lgkmcnt(4)
v_mfma_f32_16x16x32_bf16 v[96:99], v[72:75], a[0:3], 0
v_exp_f32 v208, v208
v_mfma_f32_16x16x32_bf16 v[96:99], v[76:79], a[16:19], v[96:99]
v_exp_f32 v210, v210
v_mfma_f32_16x16x32_bf16 v[100:103], v[72:75], a[4:7], 0
ds_read_b128 v[64:67], v7 offset:53248
v_fma_f32 v208, v208, v234, v234
v_mfma_f32_16x16x32_bf16 v[100:103], v[76:79], a[20:23], v[100:103]
v_fma_f32 v210, v210, v234, v234
v_mul_f32 v212, v114, v114
v_mfma_f32_16x16x32_bf16 v[104:107], v[72:75], a[8:11], 0
v_rcp_f32 v208, v208
v_mfma_f32_16x16x32_bf16 v[104:107], v[76:79], a[24:27], v[104:107]
ds_read_b128 v[68:71], v7 offset:54272
v_mul_f32 v209, v209, v208
v_mfma_f32_16x16x32_bf16 v[108:111], v[72:75], a[12:15], 0
v_rcp_f32 v210, v210
v_mfma_f32_16x16x32_bf16 v[108:111], v[76:79], a[28:31], v[108:111]
v_mul_f32 v211, v211, v210
s_waitcnt lgkmcnt(4)
v_mfma_f32_16x16x32_bf16 v[80:83], v[48:51], a[32:35], v[80:83]
v_cvt_pk_bf16_f32 v178, v209, v211
v_mul_f32 v214, v115, v115
v_mfma_f32_16x16x32_bf16 v[80:83], v[52:55], a[48:51], v[80:83]
v_fma_f32 v212, v212, v233, v232
v_fma_f32 v214, v214, v233, v232
v_mfma_f32_16x16x32_bf16 v[84:87], v[48:51], a[36:39], v[84:87]
ds_read_b128 v[72:75], v7 offset:55296
v_mul_f32 v212, v212, v114
v_mfma_f32_16x16x32_bf16 v[84:87], v[52:55], a[52:55], v[84:87]
v_mul_f32 v214, v214, v115
v_mul_f32 v213, v114, v130
v_mfma_f32_16x16x32_bf16 v[88:91], v[48:51], a[40:43], v[88:91]
v_exp_f32 v212, v212
v_mfma_f32_16x16x32_bf16 v[88:91], v[52:55], a[56:59], v[88:91]
ds_read_b128 v[76:79], v7 offset:56320
v_mul_f32 v215, v115, v131
v_mfma_f32_16x16x32_bf16 v[92:95], v[48:51], a[44:47], v[92:95]
v_exp_f32 v214, v214
v_mfma_f32_16x16x32_bf16 v[92:95], v[52:55], a[60:63], v[92:95]
v_fma_f32 v212, v212, v234, v234
s_waitcnt lgkmcnt(4)
v_mfma_f32_16x16x32_bf16 v[96:99], v[56:59], a[32:35], v[96:99]
s_waitcnt vmcnt(26)
v_fma_f32 v214, v214, v234, v234
v_mfma_f32_16x16x32_bf16 v[96:99], v[60:63], a[48:51], v[96:99]
s_barrier
v_mfma_f32_16x16x32_bf16 v[100:103], v[56:59], a[36:39], v[100:103]
ds_read_b128 v[48:51], v7 offset:57344
s_add_u32 m0, s22, 73728
v_mfma_f32_16x16x32_bf16 v[100:103], v[60:63], a[52:55], v[100:103]
v_add_u32 v3, 20480, v3
buffer_load_dwordx4 v3, s[8:11], 0 offen offset:0 lds
v_mfma_f32_16x16x32_bf16 v[104:107], v[56:59], a[40:43], v[104:107]
v_rcp_f32 v212, v212
v_mfma_f32_16x16x32_bf16 v[104:107], v[60:63], a[56:59], v[104:107]
ds_read_b128 v[52:55], v7 offset:58368
v_mul_f32 v213, v213, v212
v_mfma_f32_16x16x32_bf16 v[108:111], v[56:59], a[44:47], v[108:111]
v_rcp_f32 v214, v214
v_mfma_f32_16x16x32_bf16 v[108:111], v[60:63], a[60:63], v[108:111]
v_mul_f32 v215, v215, v214
s_waitcnt lgkmcnt(4)
v_mfma_f32_16x16x32_bf16 v[80:83], v[64:67], a[64:67], v[80:83]
buffer_load_dwordx4 v3, s[8:11], 0 offen offset:1024 lds
v_mfma_f32_16x16x32_bf16 v[80:83], v[68:71], a[80:83], v[80:83]
v_cvt_pk_bf16_f32 v179, v213, v215
v_mul_f32 v208, v116, v116
v_mfma_f32_16x16x32_bf16 v[84:87], v[64:67], a[68:71], v[84:87]
ds_read_b128 v[56:59], v7 offset:59392
v_mul_f32 v210, v117, v117
v_mfma_f32_16x16x32_bf16 v[84:87], v[68:71], a[84:87], v[84:87]
buffer_store_dwordx4 v[176:179], v2, s[8:11], s24 offen offset:2048 sc1
v_mfma_f32_16x16x32_bf16 v[88:91], v[64:67], a[72:75], v[88:91]
v_fma_f32 v208, v208, v236, v235
v_fma_f32 v210, v210, v236, v235
v_mfma_f32_16x16x32_bf16 v[88:91], v[68:71], a[88:91], v[88:91]
ds_read_b128 v[60:63], v7 offset:60416
v_mul_f32 v208, v208, v116
v_mfma_f32_16x16x32_bf16 v[92:95], v[64:67], a[76:79], v[92:95]
v_mul_f32 v210, v210, v117
v_mul_f32 v209, v116, v132
v_mfma_f32_16x16x32_bf16 v[92:95], v[68:71], a[92:95], v[92:95]
v_mul_f32 v211, v117, v133
s_waitcnt lgkmcnt(4)
v_mfma_f32_16x16x32_bf16 v[96:99], v[72:75], a[64:67], v[96:99]
buffer_load_dwordx4 v3, s[8:11], 0 offen offset:2048 lds
v_mfma_f32_16x16x32_bf16 v[96:99], v[76:79], a[80:83], v[96:99]
v_exp_f32 v208, v208
v_mfma_f32_16x16x32_bf16 v[100:103], v[72:75], a[68:71], v[100:103]
ds_read_b128 v[64:67], v7 offset:61440
v_fma_f32 v208, v208, v237, v237
v_mfma_f32_16x16x32_bf16 v[100:103], v[76:79], a[84:87], v[100:103]
v_exp_f32 v210, v210
v_mfma_f32_16x16x32_bf16 v[104:107], v[72:75], a[72:75], v[104:107]
buffer_load_dwordx4 v3, s[8:11], 0 offen offset:3072 lds
v_mfma_f32_16x16x32_bf16 v[104:107], v[76:79], a[88:91], v[104:107]
ds_read_b128 v[68:71], v7 offset:62464
s_add_u32 m0, s22, 77824
v_mfma_f32_16x16x32_bf16 v[108:111], v[72:75], a[76:79], v[108:111]
v_add_u32 v3, 4096, v3
v_fma_f32 v210, v210, v237, v237
v_mfma_f32_16x16x32_bf16 v[108:111], v[76:79], a[92:95], v[108:111]
v_mul_f32 v212, v118, v118
s_waitcnt lgkmcnt(4)
v_mfma_f32_16x16x32_bf16 v[80:83], v[48:51], a[96:99], v[80:83]
buffer_load_dwordx4 v3, s[8:11], 0 offen offset:0 lds
v_mfma_f32_16x16x32_bf16 v[80:83], v[52:55], a[112:115], v[80:83]
v_rcp_f32 v208, v208
v_mfma_f32_16x16x32_bf16 v[84:87], v[48:51], a[100:103], v[84:87]
ds_read_b128 v[72:75], v7 offset:63488
v_mul_f32 v209, v209, v208
v_mfma_f32_16x16x32_bf16 v[84:87], v[52:55], a[116:119], v[84:87]
v_rcp_f32 v210, v210
v_mfma_f32_16x16x32_bf16 v[88:91], v[48:51], a[104:107], v[88:91]
buffer_load_dwordx4 v3, s[8:11], 0 offen offset:1024 lds
v_mfma_f32_16x16x32_bf16 v[88:91], v[52:55], a[120:123], v[88:91]
ds_read_b128 v[76:79], v7 offset:64512
v_mul_f32 v211, v211, v210
v_mfma_f32_16x16x32_bf16 v[92:95], v[48:51], a[108:111], v[92:95]
v_cvt_pk_bf16_f32 v182, v209, v211
v_mul_f32 v214, v119, v119
v_mfma_f32_16x16x32_bf16 v[92:95], v[52:55], a[124:127], v[92:95]
v_fma_f32 v212, v212, v236, v235
s_waitcnt lgkmcnt(4)
v_mfma_f32_16x16x32_bf16 v[96:99], v[56:59], a[96:99], v[96:99]
buffer_load_dword v13, v11, s[8:11], s34 offen sc1
v_mfma_f32_16x16x32_bf16 v[96:99], v[60:63], a[112:115], v[96:99]
v_fma_f32 v214, v214, v236, v235
v_mul_f32 v212, v212, v118
v_mfma_f32_16x16x32_bf16 v[100:103], v[56:59], a[100:103], v[100:103]
ds_read_b128 v[48:51], v8 offset:0
v_mul_f32 v214, v214, v119
v_mfma_f32_16x16x32_bf16 v[100:103], v[60:63], a[116:119], v[100:103]
v_exp_f32 v212, v212
v_mfma_f32_16x16x32_bf16 v[104:107], v[56:59], a[104:107], v[104:107]
v_exp_f32 v214, v214
v_mfma_f32_16x16x32_bf16 v[104:107], v[60:63], a[120:123], v[104:107]
ds_read_b128 v[52:55], v8 offset:1024
v_mul_f32 v213, v118, v134
v_mfma_f32_16x16x32_bf16 v[108:111], v[56:59], a[108:111], v[108:111]
v_mul_f32 v215, v119, v135
v_fma_f32 v212, v212, v237, v237
v_mfma_f32_16x16x32_bf16 v[108:111], v[60:63], a[124:127], v[108:111]
v_fma_f32 v214, v214, v237, v237
s_waitcnt lgkmcnt(4)
v_mfma_f32_16x16x32_bf16 v[80:83], v[64:67], a[128:131], v[80:83]
v_rcp_f32 v212, v212
v_mfma_f32_16x16x32_bf16 v[80:83], v[68:71], a[144:147], v[80:83]
v_rcp_f32 v214, v214
v_mfma_f32_16x16x32_bf16 v[84:87], v[64:67], a[132:135], v[84:87]
ds_read_b128 v[56:59], v8 offset:2048
v_mul_f32 v213, v213, v212
v_mfma_f32_16x16x32_bf16 v[84:87], v[68:71], a[148:151], v[84:87]
v_mul_f32 v215, v215, v214
v_cvt_pk_bf16_f32 v183, v213, v215
v_mfma_f32_16x16x32_bf16 v[88:91], v[64:67], a[136:139], v[88:91]
buffer_store_dwordx4 v[180:183], v4, s[8:11], s24 offen offset:2048 sc1
v_mfma_f32_16x16x32_bf16 v[88:91], v[68:71], a[152:155], v[88:91]
ds_read_b128 v[60:63], v8 offset:3072
v_mul_f32 v208, v120, v120
v_mfma_f32_16x16x32_bf16 v[92:95], v[64:67], a[140:143], v[92:95]
v_mul_f32 v210, v121, v121
v_fma_f32 v208, v208, v239, v238
v_mfma_f32_16x16x32_bf16 v[92:95], v[68:71], a[156:159], v[92:95]
v_fma_f32 v210, v210, v239, v238
s_waitcnt lgkmcnt(4)
v_mfma_f32_16x16x32_bf16 v[96:99], v[72:75], a[128:131], v[96:99]
v_mul_f32 v208, v208, v120
v_mul_f32 v210, v210, v121
v_mfma_f32_16x16x32_bf16 v[96:99], v[76:79], a[144:147], v[96:99]
v_exp_f32 v208, v208
v_mfma_f32_16x16x32_bf16 v[100:103], v[72:75], a[132:135], v[100:103]
ds_read_b128 v[64:67], v8 offset:4096
v_mul_f32 v209, v120, v136
v_mfma_f32_16x16x32_bf16 v[100:103], v[76:79], a[148:151], v[100:103]
v_exp_f32 v210, v210
v_mfma_f32_16x16x32_bf16 v[104:107], v[72:75], a[136:139], v[104:107]
v_mul_f32 v211, v121, v137
v_fma_f32 v208, v208, v240, v240
v_mfma_f32_16x16x32_bf16 v[104:107], v[76:79], a[152:155], v[104:107]
ds_read_b128 v[68:71], v8 offset:5120
v_fma_f32 v210, v210, v240, v240
v_mfma_f32_16x16x32_bf16 v[108:111], v[72:75], a[140:143], v[108:111]
v_rcp_f32 v208, v208
v_mfma_f32_16x16x32_bf16 v[108:111], v[76:79], a[156:159], v[108:111]
v_mul_f32 v209, v209, v208
s_waitcnt lgkmcnt(4)
v_mfma_f32_16x16x32_bf16 v[80:83], v[48:51], a[160:163], v[80:83]
v_rcp_f32 v210, v210
v_mfma_f32_16x16x32_bf16 v[80:83], v[52:55], a[176:179], v[80:83]
v_mul_f32 v211, v211, v210
v_cvt_pk_bf16_f32 v186, v209, v211
v_mfma_f32_16x16x32_bf16 v[84:87], v[48:51], a[164:167], v[84:87]
ds_read_b128 v[72:75], v8 offset:6144
v_mul_f32 v212, v122, v122
v_mfma_f32_16x16x32_bf16 v[84:87], v[52:55], a[180:183], v[84:87]
v_mul_f32 v214, v123, v123
v_fma_f32 v212, v212, v239, v238
v_mfma_f32_16x16x32_bf16 v[88:91], v[48:51], a[168:171], v[88:91]
v_fma_f32 v214, v214, v239, v238
v_mul_f32 v212, v212, v122
v_mfma_f32_16x16x32_bf16 v[88:91], v[52:55], a[184:187], v[88:91]
ds_read_b128 v[76:79], v8 offset:7168
v_mul_f32 v214, v214, v123
v_mfma_f32_16x16x32_bf16 v[92:95], v[48:51], a[172:175], v[92:95]
v_exp_f32 v212, v212
v_mfma_f32_16x16x32_bf16 v[92:95], v[52:55], a[188:191], v[92:95]
v_mul_f32 v213, v122, v138
s_waitcnt lgkmcnt(4)
v_mfma_f32_16x16x32_bf16 v[96:99], v[56:59], a[160:163], v[96:99]
v_exp_f32 v214, v214
v_mfma_f32_16x16x32_bf16 v[96:99], v[60:63], a[176:179], v[96:99]
v_mul_f32 v215, v123, v139
v_fma_f32 v212, v212, v240, v240
v_mfma_f32_16x16x32_bf16 v[100:103], v[56:59], a[164:167], v[100:103]
ds_read_b128 v[48:51], v8 offset:8192
v_fma_f32 v214, v214, v240, v240
v_mfma_f32_16x16x32_bf16 v[100:103], v[60:63], a[180:183], v[100:103]
v_rcp_f32 v212, v212
v_mfma_f32_16x16x32_bf16 v[104:107], v[56:59], a[168:171], v[104:107]
v_mfma_f32_16x16x32_bf16 v[104:107], v[60:63], a[184:187], v[104:107]
ds_read_b128 v[52:55], v8 offset:9216
v_mul_f32 v213, v213, v212
v_mfma_f32_16x16x32_bf16 v[108:111], v[56:59], a[172:175], v[108:111]
v_rcp_f32 v214, v214
v_mfma_f32_16x16x32_bf16 v[108:111], v[60:63], a[188:191], v[108:111]
s_waitcnt lgkmcnt(4)
v_mfma_f32_16x16x32_bf16 v[80:83], v[64:67], a[192:195], v[80:83]
v_mul_f32 v215, v215, v214
v_cvt_pk_bf16_f32 v187, v213, v215
v_mfma_f32_16x16x32_bf16 v[80:83], v[68:71], a[208:211], v[80:83]
buffer_store_dwordx4 v[184:187], v5, s[8:11], s24 offen offset:2048 sc1
v_mfma_f32_16x16x32_bf16 v[84:87], v[64:67], a[196:199], v[84:87]
ds_read_b128 v[56:59], v8 offset:10240
v_mfma_f32_16x16x32_bf16 v[84:87], v[68:71], a[212:215], v[84:87]
v_mul_f32 v208, v124, v124
v_mul_f32 v210, v125, v125
v_mfma_f32_16x16x32_bf16 v[88:91], v[64:67], a[200:203], v[88:91]
v_mfma_f32_16x16x32_bf16 v[88:91], v[68:71], a[216:219], v[88:91]
ds_read_b128 v[60:63], v8 offset:11264
v_fma_f32 v208, v208, v242, v241
v_mfma_f32_16x16x32_bf16 v[92:95], v[64:67], a[204:207], v[92:95]
v_fma_f32 v210, v210, v242, v241
v_mul_f32 v208, v208, v124
v_mfma_f32_16x16x32_bf16 v[92:95], v[68:71], a[220:223], v[92:95]
v_mul_f32 v210, v210, v125
s_waitcnt lgkmcnt(4)
v_mfma_f32_16x16x32_bf16 v[96:99], v[72:75], a[192:195], v[96:99]
v_exp_f32 v208, v208
v_mfma_f32_16x16x32_bf16 v[96:99], v[76:79], a[208:211], v[96:99]
v_mfma_f32_16x16x32_bf16 v[100:103], v[72:75], a[196:199], v[100:103]
ds_read_b128 v[64:67], v8 offset:12288
v_mul_f32 v209, v124, v140
v_mfma_f32_16x16x32_bf16 v[100:103], v[76:79], a[212:215], v[100:103]
v_exp_f32 v210, v210
v_mfma_f32_16x16x32_bf16 v[104:107], v[72:75], a[200:203], v[104:107]
v_mfma_f32_16x16x32_bf16 v[104:107], v[76:79], a[216:219], v[104:107]
ds_read_b128 v[68:71], v8 offset:13312
v_mul_f32 v211, v125, v141
v_mfma_f32_16x16x32_bf16 v[108:111], v[72:75], a[204:207], v[108:111]
v_fma_f32 v208, v208, v243, v243
v_fma_f32 v210, v210, v243, v243
v_mfma_f32_16x16x32_bf16 v[108:111], v[76:79], a[220:223], v[108:111]
v_mul_f32 v212, v126, v126
s_waitcnt lgkmcnt(4)
v_mfma_f32_16x16x32_bf16 v[80:83], v[48:51], a[224:227], v[80:83]
v_rcp_f32 v208, v208
v_mfma_f32_16x16x32_bf16 v[80:83], v[52:55], a[240:243], v[80:83]
v_mfma_f32_16x16x32_bf16 v[84:87], v[48:51], a[228:231], v[84:87]
ds_read_b128 v[72:75], v8 offset:14336
v_mul_f32 v209, v209, v208
v_mfma_f32_16x16x32_bf16 v[84:87], v[52:55], a[244:247], v[84:87]
v_rcp_f32 v210, v210
v_mfma_f32_16x16x32_bf16 v[88:91], v[48:51], a[232:235], v[88:91]
v_mul_f32 v211, v211, v210
v_cvt_pk_bf16_f32 v190, v209, v211
v_mfma_f32_16x16x32_bf16 v[88:91], v[52:55], a[248:251], v[88:91]
ds_read_b128 v[76:79], v8 offset:15360
v_mfma_f32_16x16x32_bf16 v[92:95], v[48:51], a[236:239], v[92:95]
v_mul_f32 v214, v127, v127
v_fma_f32 v212, v212, v242, v241
v_mfma_f32_16x16x32_bf16 v[92:95], v[52:55], a[252:255], v[92:95]
s_waitcnt lgkmcnt(4)
v_mfma_f32_16x16x32_bf16 v[96:99], v[56:59], a[224:227], v[96:99]
s_waitcnt vmcnt(28)
v_fma_f32 v214, v214, v242, v241
v_mfma_f32_16x16x32_bf16 v[96:99], v[60:63], a[240:243], v[96:99]
s_barrier
v_mfma_f32_16x16x32_bf16 v[100:103], v[56:59], a[228:231], v[100:103]
ds_read_b128 v[48:51], v2 offset:0
s_add_u32 m0, s22, 98304
v_mfma_f32_16x16x32_bf16 v[100:103], v[60:63], a[244:247], v[100:103]
v_add_u32 v3, 20480, v3
buffer_load_dwordx4 v3, s[8:11], 0 offen offset:0 lds
v_mfma_f32_16x16x32_bf16 v[104:107], v[56:59], a[232:235], v[104:107]
v_mul_f32 v212, v212, v126
v_mul_f32 v214, v214, v127
v_mfma_f32_16x16x32_bf16 v[104:107], v[60:63], a[248:251], v[104:107]
ds_read_b128 v[52:55], v2 offset:1024
v_mul_f32 v213, v126, v142
v_mfma_f32_16x16x32_bf16 v[108:111], v[56:59], a[236:239], v[108:111]
v_exp_f32 v212, v212
v_mfma_f32_16x16x32_bf16 v[108:111], v[60:63], a[252:255], v[108:111]
v_mul_f32 v215, v127, v143
s_waitcnt lgkmcnt(4)
v_mfma_f32_16x16x32_bf16 v[80:83], v[64:67], v[16:19], v[80:83]
buffer_load_dwordx4 v3, s[8:11], 0 offen offset:1024 lds
v_mfma_f32_16x16x32_bf16 v[80:83], v[68:71], v[32:35], v[80:83]
v_exp_f32 v214, v214
v_mfma_f32_16x16x32_bf16 v[84:87], v[64:67], v[20:23], v[84:87]
ds_read_b128 v[56:59], v2 offset:2048
v_fma_f32 v212, v212, v243, v243
v_mfma_f32_16x16x32_bf16 v[84:87], v[68:71], v[36:39], v[84:87]
v_fma_f32 v214, v214, v243, v243
v_mfma_f32_16x16x32_bf16 v[88:91], v[64:67], v[24:27], v[88:91]
buffer_load_dwordx4 v3, s[8:11], 0 offen offset:2048 lds
v_mfma_f32_16x16x32_bf16 v[88:91], v[68:71], v[40:43], v[88:91]
ds_read_b128 v[60:63], v2 offset:3072
v_mfma_f32_16x16x32_bf16 v[92:95], v[64:67], v[28:31], v[92:95]
v_rcp_f32 v212, v212
v_mfma_f32_16x16x32_bf16 v[92:95], v[68:71], v[44:47], v[92:95]
v_mul_f32 v213, v213, v212
s_waitcnt lgkmcnt(4)
v_mfma_f32_16x16x32_bf16 v[96:99], v[72:75], v[16:19], v[96:99]
buffer_load_dwordx4 v3, s[8:11], 0 offen offset:3072 lds
v_mfma_f32_16x16x32_bf16 v[96:99], v[76:79], v[32:35], v[96:99]
s_add_u32 m0, s22, 102400
v_add_u32 v3, 4096, v3
v_mfma_f32_16x16x32_bf16 v[100:103], v[72:75], v[20:23], v[100:103]
ds_read_b128 v[64:67], v2 offset:4096
v_mfma_f32_16x16x32_bf16 v[100:103], v[76:79], v[36:39], v[100:103]
v_rcp_f32 v214, v214
v_mfma_f32_16x16x32_bf16 v[104:107], v[72:75], v[24:27], v[104:107]
buffer_load_dwordx4 v3, s[8:11], 0 offen offset:0 lds
v_mul_f32 v215, v215, v214
v_mfma_f32_16x16x32_bf16 v[104:107], v[76:79], v[40:43], v[104:107]
ds_read_b128 v[68:71], v2 offset:5120
v_cvt_pk_bf16_f32 v191, v213, v215
v_mfma_f32_16x16x32_bf16 v[108:111], v[72:75], v[28:31], v[108:111]
buffer_store_dwordx4 v[188:191], v6, s[8:11], s24 offen offset:2048 sc1
v_mfma_f32_16x16x32_bf16 v[108:111], v[76:79], v[44:47], v[108:111]
s_waitcnt lgkmcnt(4)
v_mfma_f32_16x16x32_bf16 v[112:115], v[48:51], a[0:3], 0
v_mfma_f32_16x16x32_bf16 v[112:115], v[52:55], a[16:19], v[112:115]
v_mfma_f32_16x16x32_bf16 v[116:119], v[48:51], a[4:7], 0
ds_read_b128 v[72:75], v2 offset:6144
v_mfma_f32_16x16x32_bf16 v[116:119], v[52:55], a[20:23], v[116:119]
buffer_load_dwordx4 v3, s[8:11], 0 offen offset:1024 lds
v_mfma_f32_16x16x32_bf16 v[120:123], v[48:51], a[8:11], 0
s_waitcnt vmcnt(9)
v_cmp_le_u32 vcc, 1, v13
s_nop 0
s_cmp_eq_u64 vcc, exec
s_cbranch_scc0 L_f_slow1
L_f_back1:
v_mul_f32 v208, v80, v80
v_mfma_f32_16x16x32_bf16 v[120:123], v[52:55], a[24:27], v[120:123]
ds_read_b128 v[76:79], v2 offset:7168
v_mul_f32 v210, v81, v81
v_mfma_f32_16x16x32_bf16 v[124:127], v[48:51], a[12:15], 0
v_fma_f32 v208, v208, v233, v232
v_fma_f32 v210, v210, v233, v232
v_mfma_f32_16x16x32_bf16 v[124:127], v[52:55], a[28:31], v[124:127]
v_mul_f32 v208, v208, v80
s_waitcnt lgkmcnt(4)
v_mfma_f32_16x16x32_bf16 v[128:131], v[56:59], a[0:3], 0
v_mul_f32 v210, v210, v81
v_mul_f32 v209, v80, v96
v_mfma_f32_16x16x32_bf16 v[128:131], v[60:63], a[16:19], v[128:131]
v_exp_f32 v208, v208
v_mfma_f32_16x16x32_bf16 v[132:135], v[56:59], a[4:7], 0
ds_read_b128 v[48:51], v2 offset:8192
v_mul_f32 v211, v81, v97
v_mfma_f32_16x16x32_bf16 v[132:135], v[60:63], a[20:23], v[132:135]
v_exp_f32 v210, v210
v_mfma_f32_16x16x32_bf16 v[136:139], v[56:59], a[8:11], 0
v_fma_f32 v208, v208, v234, v234
v_fma_f32 v210, v210, v234, v234
v_mfma_f32_16x16x32_bf16 v[136:139], v[60:63], a[24:27], v[136:139]
ds_read_b128 v[52:55], v2 offset:9216
v_mul_f32 v212, v82, v82
v_mfma_f32_16x16x32_bf16 v[140:143], v[56:59], a[12:15], 0
v_rcp_f32 v208, v208
v_mfma_f32_16x16x32_bf16 v[140:143], v[60:63], a[28:31], v[140:143]
v_mul_f32 v209, v209, v208
s_waitcnt lgkmcnt(4)
v_mfma_f32_16x16x32_bf16 v[112:115], v[64:67], a[32:35], v[112:115]
v_rcp_f32 v210, v210
v_mfma_f32_16x16x32_bf16 v[112:115], v[68:71], a[48:51], v[112:115]
v_mul_f32 v211, v211, v210
v_cvt_pk_bf16_f32 v192, v209, v211
v_mfma_f32_16x16x32_bf16 v[116:119], v[64:67], a[36:39], v[116:119]
ds_read_b128 v[56:59], v2 offset:10240
v_mul_f32 v214, v83, v83
v_mfma_f32_16x16x32_bf16 v[116:119], v[68:71], a[52:55], v[116:119]
v_fma_f32 v212, v212, v233, v232
v_fma_f32 v214, v214, v233, v232
v_mfma_f32_16x16x32_bf16 v[120:123], v[64:67], a[40:43], v[120:123]
v_mul_f32 v212, v212, v82
v_mul_f32 v214, v214, v83
v_mfma_f32_16x16x32_bf16 v[120:123], v[68:71], a[56:59], v[120:123]
ds_read_b128 v[60:63], v2 offset:11264
v_mul_f32 v213, v82, v98
v_mfma_f32_16x16x32_bf16 v[124:127], v[64:67], a[44:47], v[124:127]
v_exp_f32 v212, v212
v_mfma_f32_16x16x32_bf16 v[124:127], v[68:71], a[60:63], v[124:127]
v_mul_f32 v215, v83, v99
s_waitcnt lgkmcnt(4)
v_mfma_f32_16x16x32_bf16 v[128:131], v[72:75], a[32:35], v[128:131]
buffer_load_dwordx4 a[0:3], v2, s[8:11], s25 offen offset:0 sc1
v_mfma_f32_16x16x32_bf16 v[128:131], v[76:79], a[48:51], v[128:131]
v_exp_f32 v214, v214
v_mfma_f32_16x16x32_bf16 v[132:135], v[72:75], a[36:39], v[132:135]
ds_read_b128 v[64:67], v2 offset:12288
v_fma_f32 v212, v212, v234, v234
v_mfma_f32_16x16x32_bf16 v[132:135], v[76:79], a[52:55], v[132:135]
v_fma_f32 v214, v214, v234, v234
v_mul_f32 v208, v84, v84
v_mfma_f32_16x16x32_bf16 v[136:139], v[72:75], a[40:43], v[136:139]
buffer_load_dwordx4 a[4:7], v4, s[8:11], s25 offen offset:0 sc1
v_mfma_f32_16x16x32_bf16 v[136:139], v[76:79], a[56:59], v[136:139]
ds_read_b128 v[68:71], v2 offset:13312
v_mul_f32 v210, v85, v85
v_mfma_f32_16x16x32_bf16 v[140:143], v[72:75], a[44:47], v[140:143]
v_rcp_f32 v212, v212
v_mfma_f32_16x16x32_bf16 v[140:143], v[76:79], a[60:63], v[140:143]
v_mul_f32 v213, v213, v212
s_waitcnt lgkmcnt(4)
v_mfma_f32_16x16x32_bf16 v[112:115], v[48:51], a[64:67], v[112:115]
buffer_load_dwordx4 a[8:11], v5, s[8:11], s25 offen offset:0 sc1
v_mfma_f32_16x16x32_bf16 v[112:115], v[52:55], a[80:83], v[112:115]
v_rcp_f32 v214, v214
v_mfma_f32_16x16x32_bf16 v[116:119], v[48:51], a[68:71], v[116:119]
ds_read_b128 v[72:75], v2 offset:14336
v_mul_f32 v215, v215, v214
v_mfma_f32_16x16x32_bf16 v[116:119], v[52:55], a[84:87], v[116:119]
v_cvt_pk_bf16_f32 v193, v213, v215
v_fma_f32 v208, v208, v236, v235
v_mfma_f32_16x16x32_bf16 v[120:123], v[48:51], a[72:75], v[120:123]
buffer_load_dwordx4 a[12:15], v6, s[8:11], s25 offen offset:0 sc1
v_mfma_f32_16x16x32_bf16 v[120:123], v[52:55], a[88:91], v[120:123]
ds_read_b128 v[76:79], v2 offset:15360
v_fma_f32 v210, v210, v236, v235
v_mfma_f32_16x16x32_bf16 v[124:127], v[48:51], a[76:79], v[124:127]
v_mul_f32 v208, v208, v84
v_mul_f32 v210, v210, v85
v_mfma_f32_16x16x32_bf16 v[124:127], v[52:55], a[92:95], v[124:127]
v_mul_f32 v209, v84, v100
s_waitcnt lgkmcnt(4)
v_mfma_f32_16x16x32_bf16 v[128:131], v[56:59], a[64:67], v[128:131]
v_exp_f32 v208, v208
v_mfma_f32_16x16x32_bf16 v[128:131], v[60:63], a[80:83], v[128:131]
v_exp_f32 v210, v210
v_mfma_f32_16x16x32_bf16 v[132:135], v[56:59], a[68:71], v[132:135]
ds_read_b128 v[48:51], v2 offset:16384
v_mul_f32 v211, v85, v101
v_mfma_f32_16x16x32_bf16 v[132:135], v[60:63], a[84:87], v[132:135]
v_fma_f32 v208, v208, v237, v237
v_fma_f32 v210, v210, v237, v237
v_mfma_f32_16x16x32_bf16 v[136:139], v[56:59], a[72:75], v[136:139]
v_rcp_f32 v208, v208
v_mfma_f32_16x16x32_bf16 v[136:139], v[60:63], a[88:91], v[136:139]
ds_read_b128 v[52:55], v2 offset:17408
v_mul_f32 v209, v209, v208
v_mfma_f32_16x16x32_bf16 v[140:143], v[56:59], a[76:79], v[140:143]
v_rcp_f32 v210, v210
v_mfma_f32_16x16x32_bf16 v[140:143], v[60:63], a[92:95], v[140:143]
v_mul_f32 v211, v211, v210
s_waitcnt lgkmcnt(4)
v_mfma_f32_16x16x32_bf16 v[112:115], v[64:67], a[96:99], v[112:115]
v_mov_b32 v12, 2
s_waitcnt vmcnt(5)
buffer_store_dword v12, v10, s[8:11], s34 offen sc1
v_mfma_f32_16x16x32_bf16 v[112:115], v[68:71], a[112:115], v[112:115]
v_cvt_pk_bf16_f32 v196, v209, v211
v_mul_f32 v212, v86, v86
v_mfma_f32_16x16x32_bf16 v[116:119], v[64:67], a[100:103], v[116:119]
ds_read_b128 v[56:59], v2 offset:18432
v_mul_f32 v214, v87, v87
v_mfma_f32_16x16x32_bf16 v[116:119], v[68:71], a[116:119], v[116:119]
v_fma_f32 v212, v212, v236, v235
v_fma_f32 v214, v214, v236, v235
v_mfma_f32_16x16x32_bf16 v[120:123], v[64:67], a[104:107], v[120:123]
buffer_load_dwordx4 a[16:19], v2, s[8:11], s26 offen offset:0 sc1
v_mfma_f32_16x16x32_bf16 v[120:123], v[68:71], a[120:123], v[120:123]
ds_read_b128 v[60:63], v2 offset:19456
v_mul_f32 v212, v212, v86
v_mfma_f32_16x16x32_bf16 v[124:127], v[64:67], a[108:111], v[124:127]
v_mul_f32 v214, v214, v87
v_mul_f32 v213, v86, v102
v_mfma_f32_16x16x32_bf16 v[124:127], v[68:71], a[124:127], v[124:127]
v_mul_f32 v215, v87, v103
s_waitcnt lgkmcnt(4)
v_mfma_f32_16x16x32_bf16 v[128:131], v[72:75], a[96:99], v[128:131]
buffer_load_dwordx4 a[20:23], v4, s[8:11], s26 offen offset:0 sc1
v_mfma_f32_16x16x32_bf16 v[128:131], v[76:79], a[112:115], v[128:131]
v_exp_f32 v212, v212
v_mfma_f32_16x16x32_bf16 v[132:135], v[72:75], a[100:103], v[132:135]
ds_read_b128 v[64:67], v2 offset:20480
v_fma_f32 v212, v212, v237, v237
v_mfma_f32_16x16x32_bf16 v[132:135], v[76:79], a[116:119], v[132:135]
v_exp_f32 v214, v214
v_mfma_f32_16x16x32_bf16 v[136:139], v[72:75], a[104:107], v[136:139]
buffer_load_dwordx4 a[24:27], v5, s[8:11], s26 offen offset:0 sc1
v_mfma_f32_16x16x32_bf16 v[136:139], v[76:79], a[120:123], v[136:139]
ds_read_b128 v[68:71], v2 offset:21504
v_fma_f32 v214, v214, v237, v237
v_mfma_f32_16x16x32_bf16 v[140:143], v[72:75], a[108:111], v[140:143]
v_rcp_f32 v212, v212
v_mfma_f32_16x16x32_bf16 v[140:143], v[76:79], a[124:127], v[140:143]
v_mul_f32 v213, v213, v212
s_waitcnt lgkmcnt(4)
v_mfma_f32_16x16x32_bf16 v[112:115], v[48:51], a[128:131], v[112:115]
buffer_load_dwordx4 a[28:31], v6, s[8:11], s26 offen offset:0 sc1
v_mfma_f32_16x16x32_bf16 v[112:115], v[52:55], a[144:147], v[112:115]
v_rcp_f32 v214, v214
v_mfma_f32_16x16x32_bf16 v[116:119], v[48:51], a[132:135], v[116:119]
ds_read_b128 v[72:75], v2 offset:22528
v_mul_f32 v215, v215, v214
v_mfma_f32_16x16x32_bf16 v[116:119], v[52:55], a[148:151], v[116:119]
v_cvt_pk_bf16_f32 v197, v213, v215
v_mul_f32 v208, v88, v88
v_mfma_f32_16x16x32_bf16 v[120:123], v[48:51], a[136:139], v[120:123]
v_mul_f32 v210, v89, v89
v_fma_f32 v208, v208, v239, v238
v_mfma_f32_16x16x32_bf16 v[120:123], v[52:55], a[152:155], v[120:123]
ds_read_b128 v[76:79], v2 offset:23552
v_fma_f32 v210, v210, v239, v238
v_mfma_f32_16x16x32_bf16 v[124:127], v[48:51], a[140:143], v[124:127]
v_mul_f32 v208, v208, v88
v_mul_f32 v210, v210, v89
v_mfma_f32_16x16x32_bf16 v[124:127], v[52:55], a[156:159], v[124:127]
v_mul_f32 v209, v88, v104
s_waitcnt lgkmcnt(4)
v_mfma_f32_16x16x32_bf16 v[128:131], v[56:59], a[128:131], v[128:131]
s_waitcnt vmcnt(34)
buffer_load_dwordx4 a[32:35], v2, s[8:11], s27 offen offset:0 sc1
v_mfma_f32_16x16x32_bf16 v[128:131], v[60:63], a[144:147], v[128:131]
s_barrier
v_mfma_f32_16x16x32_bf16 v[132:135], v[56:59], a[132:135], v[132:135]
ds_read_b128 v[48:51], v2 offset:24576
v_mul_f32 v211, v89, v105
v_mfma_f32_16x16x32_bf16 v[132:135], v[60:63], a[148:151], v[132:135]
v_exp_f32 v208, v208
v_mfma_f32_16x16x32_bf16 v[136:139], v[56:59], a[136:139], v[136:139]
buffer_load_dwordx4 a[36:39], v4, s[8:11], s27 offen offset:0 sc1
v_mfma_f32_16x16x32_bf16 v[136:139], v[60:63], a[152:155], v[136:139]
ds_read_b128 v[52:55], v2 offset:25600
v_fma_f32 v208, v208, v240, v240
v_mfma_f32_16x16x32_bf16 v[140:143], v[56:59], a[140:143], v[140:143]
v_exp_f32 v210, v210
v_mfma_f32_16x16x32_bf16 v[140:143], v[60:63], a[156:159], v[140:143]
v_fma_f32 v210, v210, v240, v240
s_waitcnt lgkmcnt(4)
v_mfma_f32_16x16x32_bf16 v[112:115], v[64:67], a[160:163], v[112:115]
buffer_load_dwordx4 a[40:43], v5, s[8:11], s27 offen offset:0 sc1
v_mfma_f32_16x16x32_bf16 v[112:115], v[68:71], a[176:179], v[112:115]
v_rcp_f32 v208, v208
v_mfma_f32_16x16x32_bf16 v[116:119], v[64:67], a[164:167], v[116:119]
ds_read_b128 v[56:59], v2 offset:26624
v_mul_f32 v209, v209, v208
v_mfma_f32_16x16x32_bf16 v[116:119], v[68:71], a[180:183], v[116:119]
v_rcp_f32 v210, v210
v_mfma_f32_16x16x32_bf16 v[120:123], v[64:67], a[168:171], v[120:123]
buffer_load_dwordx4 a[44:47], v6, s[8:11], s27 offen offset:0 sc1
v_mfma_f32_16x16x32_bf16 v[120:123], v[68:71], a[184:187], v[120:123]
ds_read_b128 v[60:63], v2 offset:27648
s_add_u32 m0, s22, 122880
v_mfma_f32_16x16x32_bf16 v[124:127], v[64:67], a[172:175], v[124:127]
v_add_u32 v3, 20480, v3
v_mul_f32 v211, v211, v210
v_mfma_f32_16x16x32_bf16 v[124:127], v[68:71], a[188:191], v[124:127]
v_cvt_pk_bf16_f32 v200, v209, v211
s_waitcnt lgkmcnt(4)
v_mfma_f32_16x16x32_bf16 v[128:131], v[72:75], a[160:163], v[128:131]
buffer_load_dwordx4 v3, s[8:11], 0 offen offset:0 lds
v_mfma_f32_16x16x32_bf16 v[128:131], v[76:79], a[176:179], v[128:131]
v_mul_f32 v212, v90, v90
v_mul_f32 v214, v91, v91
v_mfma_f32_16x16x32_bf16 v[132:135], v[72:75], a[164:167], v[132:135]
ds_read_b128 v[64:67], v2 offset:28672
v_fma_f32 v212, v212, v239, v238
v_mfma_f32_16x16x32_bf16 v[132:135], v[76:79], a[180:183], v[132:135]
v_fma_f32 v214, v214, v239, v238
v_mul_f32 v212, v212, v90
v_mfma_f32_16x16x32_bf16 v[136:139], v[72:75], a[168:171], v[136:139]
buffer_load_dwordx4 v3, s[8:11], 0 offen offset:1024 lds
v_mfma_f32_16x16x32_bf16 v[136:139], v[76:79], a[184:187], v[136:139]
ds_read_b128 v[68:71], v2 offset:29696
v_mul_f32 v214, v214, v91
v_mfma_f32_16x16x32_bf16 v[140:143], v[72:75], a[172:175], v[140:143]
v_exp_f32 v212, v212
v_mfma_f32_16x16x32_bf16 v[140:143], v[76:79], a[188:191], v[140:143]
v_mul_f32 v213, v90, v106
s_waitcnt lgkmcnt(4)
v_mfma_f32_16x16x32_bf16 v[112:115], v[48:51], a[192:195], v[112:115]
buffer_load_dwordx4 v3, s[8:11], 0 offen offset:2048 lds
v_mfma_f32_16x16x32_bf16 v[112:115], v[52:55], a[208:211], v[112:115]
v_exp_f32 v214, v214
v_mfma_f32_16x16x32_bf16 v[116:119], v[48:51], a[196:199], v[116:119]
ds_read_b128 v[72:75], v2 offset:30720
v_mul_f32 v215, v91, v107
v_mfma_f32_16x16x32_bf16 v[116:119], v[52:55], a[212:215], v[116:119]
v_fma_f32 v212, v212, v240, v240
v_fma_f32 v214, v214, v240, v240
v_mfma_f32_16x16x32_bf16 v[120:123], v[48:51], a[200:203], v[120:123]
buffer_load_dwordx4 v3, s[8:11], 0 offen offset:3072 lds
v_mfma_f32_16x16x32_bf16 v[120:123], v[52:55], a[216:219], v[120:123]
ds_read_b128 v[76:79], v2 offset:31744
s_add_u32 m0, s22, 126976
v_mfma_f32_16x16x32_bf16 v[124:127], v[48:51], a[204:207], v[124:127]
v_add_u32 v3, 4096, v3
v_mul_f32 v208, v92, v92
v_mfma_f32_16x16x32_bf16 v[124:127], v[52:55], a[220:223], v[124:127]
v_mul_f32 v210, v93, v93
s_waitcnt lgkmcnt(4)
v_mfma_f32_16x16x32_bf16 v[128:131], v[56:59], a[192:195], v[128:131]
buffer_load_dwordx4 v3, s[8:11], 0 offen offset:0 lds
v_mfma_f32_16x16x32_bf16 v[128:131], v[60:63], a[208:211], v[128:131]
v_rcp_f32 v212, v212
v_mfma_f32_16x16x32_bf16 v[132:135], v[56:59], a[196:199], v[132:135]
ds_read_b128 v[48:51], v2 offset:32768
v_mul_f32 v213, v213, v212
v_mfma_f32_16x16x32_bf16 v[132:135], v[60:63], a[212:215], v[132:135]
v_rcp_f32 v214, v214
v_mfma_f32_16x16x32_bf16 v[136:139], v[56:59], a[200:203], v[136:139]
buffer_load_dwordx4 v3, s[8:11], 0 offen offset:1024 lds
v_mfma_f32_16x16x32_bf16 v[136:139], v[60:63], a[216:219], v[136:139]
ds_read_b128 v[52:55], v2 offset:33792
v_mul_f32 v215, v215, v214
v_mfma_f32_16x16x32_bf16 v[140:143], v[56:59], a[204:207], v[140:143]
v_cvt_pk_bf16_f32 v201, v213, v215
v_fma_f32 v208, v208, v242, v241
v_mfma_f32_16x16x32_bf16 v[140:143], v[60:63], a[220:223], v[140:143]
v_fma_f32 v210, v210, v242, v241
s_waitcnt lgkmcnt(4)
v_mfma_f32_16x16x32_bf16 v[112:115], v[64:67], a[224:227], v[112:115]
buffer_load_dwordx4 a[48:51], v2, s[8:11], s25 offen offset:1024 sc1
v_mfma_f32_16x16x32_bf16 v[112:115], v[68:71], a[240:243], v[112:115]
v_mul_f32 v208, v208, v92
v_mul_f32 v210, v210, v93
v_mfma_f32_16x16x32_bf16 v[116:119], v[64:67], a[228:231], v[116:119]
ds_read_b128 v[56:59], v2 offset:34816
v_mul_f32 v209, v92, v108
v_mfma_f32_16x16x32_bf16 v[116:119], v[68:71], a[244:247], v[116:119]
v_exp_f32 v208, v208
v_mfma_f32_16x16x32_bf16 v[120:123], v[64:67], a[232:235], v[120:123]
buffer_load_dwordx4 a[52:55], v4, s[8:11], s25 offen offset:1024 sc1
v_mfma_f32_16x16x32_bf16 v[120:123], v[68:71], a[248:251], v[120:123]
ds_read_b128 v[60:63], v2 offset:35840
v_mul_f32 v211, v93, v109
v_mfma_f32_16x16x32_bf16 v[124:127], v[64:67], a[236:239], v[124:127]
v_exp_f32 v210, v210
v_mfma_f32_16x16x32_bf16 v[124:127], v[68:71], a[252:255], v[124:127]
v_fma_f32 v208, v208, v243, v243
s_waitcnt lgkmcnt(4)
v_mfma_f32_16x16x32_bf16 v[128:131], v[72:75], a[224:227], v[128:131]
buffer_load_dwordx4 a[56:59], v5, s[8:11], s25 offen offset:1024 sc1
v_mfma_f32_16x16x32_bf16 v[128:131], v[76:79], a[240:243], v[128:131]
v_fma_f32 v210, v210, v243, v243
v_mul_f32 v212, v94, v94
v_mfma_f32_16x16x32_bf16 v[132:135], v[72:75], a[228:231], v[132:135]
ds_read_b128 v[64:67], v2 offset:36864
v_mul_f32 v214, v95, v95
v_mfma_f32_16x16x32_bf16 v[132:135], v[76:79], a[244:247], v[132:135]
v_rcp_f32 v208, v208
v_mfma_f32_16x16x32_bf16 v[136:139], v[72:75], a[232:235], v[136:139]
buffer_load_dwordx4 a[60:63], v6, s[8:11], s25 offen offset:1024 sc1
v_mfma_f32_16x16x32_bf16 v[136:139], v[76:79], a[248:251], v[136:139]
ds_read_b128 v[68:71], v2 offset:37888
v_mul_f32 v209, v209, v208
v_mfma_f32_16x16x32_bf16 v[140:143], v[72:75], a[236:239], v[140:143]
v_rcp_f32 v210, v210
v_mfma_f32_16x16x32_bf16 v[140:143], v[76:79], a[252:255], v[140:143]
v_mul_f32 v211, v211, v210
s_waitcnt lgkmcnt(4)
v_mfma_f32_16x16x32_bf16 v[112:115], v[48:51], v[16:19], v[112:115]
buffer_load_dwordx4 a[64:67], v2, s[8:11], s26 offen offset:1024 sc1
v_mfma_f32_16x16x32_bf16 v[112:115], v[52:55], v[32:35], v[112:115]
v_cvt_pk_bf16_f32 v204, v209, v211
v_fma_f32 v212, v212, v242, v241
v_mfma_f32_16x16x32_bf16 v[116:119], v[48:51], v[20:23], v[116:119]
ds_read_b128 v[72:75], v2 offset:38912
v_fma_f32 v214, v214, v242, v241
v_mfma_f32_16x16x32_bf16 v[116:119], v[52:55], v[36:39], v[116:119]
v_mul_f32 v212, v212, v94
v_mul_f32 v214, v214, v95
v_mfma_f32_16x16x32_bf16 v[120:123], v[48:51], v[24:27], v[120:123]
buffer_load_dwordx4 a[68:71], v4, s[8:11], s26 offen offset:1024 sc1
v_mfma_f32_16x16x32_bf16 v[120:123], v[52:55], v[40:43], v[120:123]
ds_read_b128 v[76:79], v2 offset:39936
v_mul_f32 v213, v94, v110
v_mfma_f32_16x16x32_bf16 v[124:127], v[48:51], v[28:31], v[124:127]
v_exp_f32 v212, v212
v_mfma_f32_16x16x32_bf16 v[124:127], v[52:55], v[44:47], v[124:127]
v_mul_f32 v215, v95, v111
s_waitcnt lgkmcnt(4)
v_mfma_f32_16x16x32_bf16 v[128:131], v[56:59], v[16:19], v[128:131]
buffer_load_dwordx4 a[72:75], v5, s[8:11], s26 offen offset:1024 sc1
v_mfma_f32_16x16x32_bf16 v[128:131], v[60:63], v[32:35], v[128:131]
v_exp_f32 v214, v214
v_mfma_f32_16x16x32_bf16 v[132:135], v[56:59], v[20:23], v[132:135]
ds_read_b128 v[48:51], v2 offset:40960
v_fma_f32 v212, v212, v243, v243
v_mfma_f32_16x16x32_bf16 v[132:135], v[60:63], v[36:39], v[132:135]
v_fma_f32 v214, v214, v243, v243
v_mfma_f32_16x16x32_bf16 v[136:139], v[56:59], v[24:27], v[136:139]
buffer_load_dwordx4 a[76:79], v6, s[8:11], s26 offen offset:1024 sc1
v_mfma_f32_16x16x32_bf16 v[136:139], v[60:63], v[40:43], v[136:139]
ds_read_b128 v[52:55], v2 offset:41984
v_mfma_f32_16x16x32_bf16 v[140:143], v[56:59], v[28:31], v[140:143]
v_rcp_f32 v212, v212
v_mfma_f32_16x16x32_bf16 v[140:143], v[60:63], v[44:47], v[140:143]
v_mul_f32 v213, v213, v212
s_waitcnt lgkmcnt(4)
v_mfma_f32_16x16x32_bf16 a[112:115], v[64:67], v[144:147], 0
buffer_load_dwordx4 a[80:83], v2, s[8:11], s27 offen offset:1024 sc1
v_mfma_f32_16x16x32_bf16 a[112:115], v[68:71], v[160:163], a[112:115]
v_rcp_f32 v214, v214
v_mfma_f32_16x16x32_bf16 a[116:119], v[64:67], v[148:151], 0
ds_read_b128 v[56:59], v2 offset:43008
v_mul_f32 v215, v215, v214
v_mfma_f32_16x16x32_bf16 a[116:119], v[68:71], v[164:167], a[116:119]
v_cvt_pk_bf16_f32 v205, v213, v215
v_mfma_f32_16x16x32_bf16 a[120:123], v[64:67], v[152:155], 0
buffer_load_dwordx4 a[84:87], v4, s[8:11], s27 offen offset:1024 sc1
v_mfma_f32_16x16x32_bf16 a[120:123], v[68:71], v[168:171], a[120:123]
ds_read_b128 v[60:63], v2 offset:44032
v_mul_f32 v208, v112, v112
v_mfma_f32_16x16x32_bf16 a[124:127], v[64:67], v[156:159], 0
v_mul_f32 v210, v113, v113
v_fma_f32 v208, v208, v233, v232
v_mfma_f32_16x16x32_bf16 a[124:127], v[68:71], v[172:175], a[124:127]
v_fma_f32 v210, v210, v233, v232
s_waitcnt lgkmcnt(4)
v_mfma_f32_16x16x32_bf16 a[128:131], v[72:75], v[144:147], 0
buffer_load_dwordx4 a[88:91], v5, s[8:11], s27 offen offset:1024 sc1
v_mfma_f32_16x16x32_bf16 a[128:131], v[76:79], v[160:163], a[128:131]
v_mul_f32 v208, v208, v112
v_mul_f32 v210, v210, v113
v_mfma_f32_16x16x32_bf16 a[132:135], v[72:75], v[148:151], 0
ds_read_b128 v[64:67], v2 offset:45056
v_mul_f32 v209, v112, v128
v_mfma_f32_16x16x32_bf16 a[132:135], v[76:79], v[164:167], a[132:135]
v_exp_f32 v208, v208
v_mfma_f32_16x16x32_bf16 a[136:139], v[72:75], v[152:155], 0
buffer_load_dwordx4 a[92:95], v6, s[8:11], s27 offen offset:1024 sc1
v_mfma_f32_16x16x32_bf16 a[136:139], v[76:79], v[168:171], a[136:139]
ds_read_b128 v[68:71], v2 offset:46080
v_mul_f32 v211, v113, v129
v_mfma_f32_16x16x32_bf16 a[140:143], v[72:75], v[156:159], 0
v_exp_f32 v210, v210
v_mfma_f32_16x16x32_bf16 a[140:143], v[76:79], v[172:175], a[140:143]
v_fma_f32 v208, v208, v234, v234
s_waitcnt lgkmcnt(4)
v_mfma_f32_16x16x32_bf16 a[144:147], v[48:51], v[144:147], 0
v_fma_f32 v210, v210, v234, v234
v_mul_f32 v212, v114, v114
v_mfma_f32_16x16x32_bf16 a[144:147], v[52:55], v[160:163], a[144:147]
v_rcp_f32 v208, v208
v_mfma_f32_16x16x32_bf16 a[148:151], v[48:51], v[148:151], 0
ds_read_b128 v[72:75], v2 offset:47104
v_mul_f32 v209, v209, v208
v_mfma_f32_16x16x32_bf16 a[148:151], v[52:55], v[164:167], a[148:151]
v_rcp_f32 v210, v210
v_mfma_f32_16x16x32_bf16 a[152:155], v[48:51], v[152:155], 0
v_mul_f32 v211, v211, v210
v_cvt_pk_bf16_f32 v194, v209, v211
v_mfma_f32_16x16x32_bf16 a[152:155], v[52:55], v[168:171], a[152:155]
ds_read_b128 v[76:79], v2 offset:48128
v_mul_f32 v214, v115, v115
v_mfma_f32_16x16x32_bf16 a[156:159], v[48:51], v[156:159], 0
v_fma_f32 v212, v212, v233, v232
v_fma_f32 v214, v214, v233, v232
v_mfma_f32_16x16x32_bf16 a[156:159], v[52:55], v[172:175], a[156:159]
v_mul_f32 v212, v212, v114
s_waitcnt lgkmcnt(4)
v_mfma_f32_16x16x32_bf16 a[160:163], v[56:59], v[144:147], 0
s_waitcnt vmcnt(49)
buffer_load_dwordx2 a[96:97], v244, s[8:11], s28 offen offset:0 sc1
v_mfma_f32_16x16x32_bf16 a[160:163], v[60:63], v[160:163], a[160:163]
s_barrier
v_mfma_f32_16x16x32_bf16 a[164:167], v[56:59], v[148:151], 0
ds_read_b128 v[48:51], v2 offset:49152
v_mul_f32 v214, v214, v115
v_mfma_f32_16x16x32_bf16 a[164:167], v[60:63], v[164:167], a[164:167]
v_exp_f32 v212, v212
v_mfma_f32_16x16x32_bf16 a[168:171], v[56:59], v[152:155], 0
buffer_load_dwordx2 a[98:99], v244, s[8:11], s28 offen offset:512 sc1
v_mfma_f32_16x16x32_bf16 a[168:171], v[60:63], v[168:171], a[168:171]
ds_read_b128 v[52:55], v2 offset:50176
v_mul_f32 v213, v114, v130
v_mfma_f32_16x16x32_bf16 a[172:175], v[56:59], v[156:159], 0
v_exp_f32 v214, v214
v_mfma_f32_16x16x32_bf16 a[172:175], v[60:63], v[172:175], a[172:175]
v_mul_f32 v215, v115, v131
s_waitcnt lgkmcnt(4)
v_mfma_f32_16x16x32_bf16 a[176:179], v[64:67], v[144:147], 0
buffer_load_dwordx2 a[100:101], v245, s[8:11], s28 offen offset:0 sc1
v_mfma_f32_16x16x32_bf16 a[176:179], v[68:71], v[160:163], a[176:179]
v_fma_f32 v212, v212, v234, v234
v_fma_f32 v214, v214, v234, v234
v_mfma_f32_16x16x32_bf16 a[180:183], v[64:67], v[148:151], 0
ds_read_b128 v[56:59], v2 offset:51200
v_mul_f32 v208, v116, v116
v_mfma_f32_16x16x32_bf16 a[180:183], v[68:71], v[164:167], a[180:183]
v_rcp_f32 v212, v212
v_mfma_f32_16x16x32_bf16 a[184:187], v[64:67], v[152:155], 0
buffer_load_dwordx2 a[102:103], v245, s[8:11], s28 offen offset:512 sc1
v_mfma_f32_16x16x32_bf16 a[184:187], v[68:71], v[168:171], a[184:187]
ds_read_b128 v[60:63], v2 offset:52224
v_mul_f32 v213, v213, v212
v_mfma_f32_16x16x32_bf16 a[188:191], v[64:67], v[156:159], 0
v_rcp_f32 v214, v214
v_mfma_f32_16x16x32_bf16 a[188:191], v[68:71], v[172:175], a[188:191]
v_mul_f32 v215, v215, v214
s_waitcnt lgkmcnt(4)
v_mfma_f32_16x16x32_bf16 a[192:195], v[72:75], v[144:147], 0
buffer_load_dwordx2 a[104:105], v246, s[8:11], s28 offen offset:0 sc1
v_mfma_f32_16x16x32_bf16 a[192:195], v[76:79], v[160:163], a[192:195]
v_cvt_pk_bf16_f32 v195, v213, v215
v_mul_f32 v210, v117, v117
v_mfma_f32_16x16x32_bf16 a[196:199], v[72:75], v[148:151], 0
ds_read_b128 v[64:67], v2 offset:53248
v_fma_f32 v208, v208, v236, v235
v_mfma_f32_16x16x32_bf16 a[196:199], v[76:79], v[164:167], a[196:199]
buffer_store_dwordx4 v[192:195], v2, s[8:11], s24 offen offset:3072 sc1
v_mfma_f32_16x16x32_bf16 a[200:203], v[72:75], v[152:155], 0
v_fma_f32 v210, v210, v236, v235
v_mul_f32 v208, v208, v116
v_mfma_f32_16x16x32_bf16 a[200:203], v[76:79], v[168:171], a[200:203]
ds_read_b128 v[68:71], v2 offset:54272
v_mul_f32 v210, v210, v117
v_mfma_f32_16x16x32_bf16 a[204:207], v[72:75], v[156:159], 0
v_exp_f32 v208, v208
v_mfma_f32_16x16x32_bf16 a[204:207], v[76:79], v[172:175], a[204:207]
v_mul_f32 v209, v116, v132
s_waitcnt lgkmcnt(4)
v_mfma_f32_16x16x32_bf16 a[208:211], v[48:51], v[144:147], 0
buffer_load_dwordx2 a[106:107], v246, s[8:11], s28 offen offset:512 sc1
v_mfma_f32_16x16x32_bf16 a[208:211], v[52:55], v[160:163], a[208:211]
v_exp_f32 v210, v210
v_mfma_f32_16x16x32_bf16 a[212:215], v[48:51], v[148:151], 0
ds_read_b128 v[72:75], v2 offset:55296
v_mul_f32 v211, v117, v133
v_mfma_f32_16x16x32_bf16 a[212:215], v[52:55], v[164:167], a[212:215]
v_fma_f32 v208, v208, v237, v237
v_fma_f32 v210, v210, v237, v237
v_mfma_f32_16x16x32_bf16 a[216:219], v[48:51], v[152:155], 0
buffer_load_dwordx2 a[108:109], v247, s[8:11], s28 offen offset:0 sc1
v_mfma_f32_16x16x32_bf16 a[216:219], v[52:55], v[168:171], a[216:219]
ds_read_b128 v[76:79], v2 offset:56320
v_mul_f32 v212, v118, v118
v_mfma_f32_16x16x32_bf16 a[220:223], v[48:51], v[156:159], 0
v_rcp_f32 v208, v208
v_mfma_f32_16x16x32_bf16 a[220:223], v[52:55], v[172:175], a[220:223]
v_mul_f32 v209, v209, v208
s_waitcnt lgkmcnt(4)
v_mfma_f32_16x16x32_bf16 a[224:227], v[56:59], v[144:147], 0
buffer_load_dwordx2 a[110:111], v247, s[8:11], s28 offen offset:512 sc1
v_mfma_f32_16x16x32_bf16 a[224:227], v[60:63], v[160:163], a[224:227]
s_add_u32 m0, s22, 0
v_add_u32 v3, 20480, v3
v_mfma_f32_16x16x32_bf16 a[228:231], v[56:59], v[148:151], 0
ds_read_b128 v[48:51], v2 offset:57344
v_mul_f32 v214, v119, v119
v_mfma_f32_16x16x32_bf16 a[228:231], v[60:63], v[164:167], a[228:231]
v_rcp_f32 v210, v210
v_mfma_f32_16x16x32_bf16 a[232:235], v[56:59], v[152:155], 0
buffer_load_dwordx4 v3, s[8:11], 0 offen offset:0 lds
v_mfma_f32_16x16x32_bf16 a[232:235], v[60:63], v[168:171], a[232:235]
ds_read_b128 v[52:55], v2 offset:58368
v_mul_f32 v211, v211, v210
v_mfma_f32_16x16x32_bf16 a[236:239], v[56:59], v[156:159], 0
v_cvt_pk_bf16_f32 v198, v209, v211
v_fma_f32 v212, v212, v236, v235
v_mfma_f32_16x16x32_bf16 a[236:239], v[60:63], v[172:175], a[236:239]
v_fma_f32 v214, v214, v236, v235
s_waitcnt lgkmcnt(4)
v_mfma_f32_16x16x32_bf16 a[240:243], v[64:67], v[144:147], 0
buffer_load_dwordx4 v3, s[8:11], 0 offen offset:1024 lds
v_mfma_f32_16x16x32_bf16 a[240:243], v[68:71], v[160:163], a[240:243]
v_mul_f32 v212, v212, v118
v_mul_f32 v214, v214, v119
v_mfma_f32_16x16x32_bf16 a[244:247], v[64:67], v[148:151], 0
ds_read_b128 v[56:59], v2 offset:59392
v_mul_f32 v213, v118, v134
v_mfma_f32_16x16x32_bf16 a[244:247], v[68:71], v[164:167], a[244:247]
v_exp_f32 v212, v212
v_mfma_f32_16x16x32_bf16 a[248:251], v[64:67], v[152:155], 0
buffer_load_dwordx4 v3, s[8:11], 0 offen offset:2048 lds
v_mfma_f32_16x16x32_bf16 a[248:251], v[68:71], v[168:171], a[248:251]
ds_read_b128 v[60:63], v2 offset:60416
v_mul_f32 v215, v119, v135
v_mfma_f32_16x16x32_bf16 a[252:255], v[64:67], v[156:159], 0
v_exp_f32 v214, v214
v_mfma_f32_16x16x32_bf16 a[252:255], v[68:71], v[172:175], a[252:255]
v_fma_f32 v212, v212, v237, v237
s_waitcnt vmcnt(39)
s_waitcnt lgkmcnt(4)
v_mfma_f32_16x16x32_bf16 a[112:115], v[72:75], v[176:179], a[112:115]
buffer_load_dwordx4 v3, s[8:11], 0 offen offset:3072 lds
v_mfma_f32_16x16x32_bf16 a[112:115], v[76:79], a[0:3], a[112:115]
s_add_u32 m0, s22, 4096
v_add_u32 v3, 4096, v3
v_mfma_f32_16x16x32_bf16 a[116:119], v[72:75], v[180:183], a[116:119]
ds_read_b128 v[64:67], v2 offset:61440
v_fma_f32 v214, v214, v237, v237
v_mfma_f32_16x16x32_bf16 a[116:119], v[76:79], a[4:7], a[116:119]
v_rcp_f32 v212, v212
v_mfma_f32_16x16x32_bf16 a[120:123], v[72:75], v[184:187], a[120:123]
buffer_load_dwordx4 v3, s[8:11], 0 offen offset:0 lds
v_mfma_f32_16x16x32_bf16 a[120:123], v[76:79], a[8:11], a[120:123]
ds_read_b128 v[68:71], v2 offset:62464
v_mul_f32 v213, v213, v212
v_mfma_f32_16x16x32_bf16 a[124:127], v[72:75], v[188:191], a[124:127]
v_rcp_f32 v214, v214
v_mfma_f32_16x16x32_bf16 a[124:127], v[76:79], a[12:15], a[124:127]
v_mul_f32 v215, v215, v214
s_waitcnt lgkmcnt(4)
v_mfma_f32_16x16x32_bf16 a[128:131], v[48:51], v[176:179], a[128:131]
buffer_load_dwordx4 v3, s[8:11], 0 offen offset:1024 lds
v_mfma_f32_16x16x32_bf16 a[128:131], v[52:55], a[0:3], a[128:131]
v_cvt_pk_bf16_f32 v199, v213, v215
v_mul_f32 v208, v120, v120
v_mfma_f32_16x16x32_bf16 a[132:135], v[48:51], v[180:183], a[132:135]
ds_read_b128 v[72:75], v2 offset:63488
v_mul_f32 v210, v121, v121
v_mfma_f32_16x16x32_bf16 a[132:135], v[52:55], a[4:7], a[132:135]
buffer_store_dwordx4 v[196:199], v4, s[8:11], s24 offen offset:3072 sc1
v_mfma_f32_16x16x32_bf16 a[136:139], v[48:51], v[184:187], a[136:139]
v_fma_f32 v208, v208, v239, v238
v_fma_f32 v210, v210, v239, v238
v_mfma_f32_16x16x32_bf16 a[136:139], v[52:55], a[8:11], a[136:139]
ds_read_b128 v[76:79], v2 offset:64512
v_mul_f32 v208, v208, v120
v_mfma_f32_16x16x32_bf16 a[140:143], v[48:51], v[188:191], a[140:143]
v_mul_f32 v210, v210, v121
v_mul_f32 v209, v120, v136
v_mfma_f32_16x16x32_bf16 a[140:143], v[52:55], a[12:15], a[140:143]
v_mul_f32 v211, v121, v137
s_waitcnt lgkmcnt(4)
v_mfma_f32_16x16x32_bf16 a[144:147], v[56:59], v[176:179], a[144:147]
buffer_load_dword v13, v11, s[8:11], s34 offen sc1
v_mfma_f32_16x16x32_bf16 a[144:147], v[60:63], a[0:3], a[144:147]
v_exp_f32 v208, v208
v_mfma_f32_16x16x32_bf16 a[148:151], v[56:59], v[180:183], a[148:151]
ds_read_b128 v[48:51], v7 offset:0
v_fma_f32 v208, v208, v240, v240
v_mfma_f32_16x16x32_bf16 a[148:151], v[60:63], a[4:7], a[148:151]
v_exp_f32 v210, v210
v_mfma_f32_16x16x32_bf16 a[152:155], v[56:59], v[184:187], a[152:155]
buffer_load_dwordx2 v[16:17], v244, s[8:11], s29 offen offset:0 sc1
v_mfma_f32_16x16x32_bf16 a[152:155], v[60:63], a[8:11], a[152:155]
ds_read_b128 v[52:55], v7 offset:1024
v_fma_f32 v210, v210, v240, v240
v_mfma_f32_16x16x32_bf16 a[156:159], v[56:59], v[188:191], a[156:159]
v_rcp_f32 v208, v208
v_mfma_f32_16x16x32_bf16 a[156:159], v[60:63], a[12:15], a[156:159]
v_mul_f32 v209, v209, v208
s_waitcnt lgkmcnt(4)
v_mfma_f32_16x16x32_bf16 a[160:163], v[64:67], v[176:179], a[160:163]
buffer_load_dwordx2 v[18:19], v244, s[8:11], s29 offen offset:512 sc1
v_mfma_f32_16x16x32_bf16 a[160:163], v[68:71], a[0:3], a[160:163]
v_rcp_f32 v210, v210
v_mfma_f32_16x16x32_bf16 a[164:167], v[64:67], v[180:183], a[164:167]
ds_read_b128 v[56:59], v7 offset:2048
v_mul_f32 v211, v211, v210
v_mfma_f32_16x16x32_bf16 a[164:167], v[68:71], a[4:7], a[164:167]
v_cvt_pk_bf16_f32 v202, v209, v211
v_mul_f32 v212, v122, v122
v_mfma_f32_16x16x32_bf16 a[168:171], v[64:67], v[184:187], a[168:171]
buffer_load_dwordx2 v[20:21], v245, s[8:11], s29 offen offset:0 sc1
v_mfma_f32_16x16x32_bf16 a[168:171], v[68:71], a[8:11], a[168:171]
ds_read_b128 v[60:63], v7 offset:3072
v_mul_f32 v214, v123, v123
v_mfma_f32_16x16x32_bf16 a[172:175], v[64:67], v[188:191], a[172:175]
v_fma_f32 v212, v212, v239, v238
v_fma_f32 v214, v214, v239, v238
v_mfma_f32_16x16x32_bf16 a[172:175], v[68:71], a[12:15], a[172:175]
v_mul_f32 v212, v212, v122
s_waitcnt lgkmcnt(4)
v_mfma_f32_16x16x32_bf16 a[176:179], v[72:75], v[176:179], a[176:179]
buffer_load_dwordx2 v[22:23], v245, s[8:11], s29 offen offset:512 sc1
v_mfma_f32_16x16x32_bf16 a[176:179], v[76:79], a[0:3], a[176:179]
v_mul_f32 v214, v214, v123
v_mul_f32 v213, v122, v138
v_mfma_f32_16x16x32_bf16 a[180:183], v[72:75], v[180:183], a[180:183]
ds_read_b128 v[64:67], v7 offset:4096
v_mul_f32 v215, v123, v139
v_mfma_f32_16x16x32_bf16 a[180:183], v[76:79], a[4:7], a[180:183]
v_exp_f32 v212, v212
v_mfma_f32_16x16x32_bf16 a[184:187], v[72:75], v[184:187], a[184:187]
buffer_load_dwordx2 v[24:25], v246, s[8:11], s29 offen offset:0 sc1
v_mfma_f32_16x16x32_bf16 a[184:187], v[76:79], a[8:11], a[184:187]
ds_read_b128 v[68:71], v7 offset:5120
v_fma_f32 v212, v212, v240, v240
v_mfma_f32_16x16x32_bf16 a[188:191], v[72:75], v[188:191], a[188:191]
v_exp_f32 v214, v214
v_mfma_f32_16x16x32_bf16 a[188:191], v[76:79], a[12:15], a[188:191]
v_fma_f32 v214, v214, v240, v240
s_waitcnt lgkmcnt(4)
v_mfma_f32_16x16x32_bf16 a[192:195], v[48:51], v[176:179], a[192:195]
buffer_load_dwordx2 v[26:27], v246, s[8:11], s29 offen offset:512 sc1
v_mfma_f32_16x16x32_bf16 a[192:195], v[52:55], a[0:3], a[192:195]
v_rcp_f32 v212, v212
v_mfma_f32_16x16x32_bf16 a[196:199], v[48:51], v[180:183], a[196:199]
ds_read_b128 v[72:75], v7 offset:6144
v_mul_f32 v213, v213, v212
v_mfma_f32_16x16x32_bf16 a[196:199], v[52:55], a[4:7], a[196:199]
v_rcp_f32 v214, v214
v_mfma_f32_16x16x32_bf16 a[200:203], v[48:51], v[184:187], a[200:203]
buffer_load_dwordx2 v[28:29], v247, s[8:11], s29 offen offset:0 sc1
v_mfma_f32_16x16x32_bf16 a[200:203], v[52:55], a[8:11], a[200:203]
ds_read_b128 v[76:79], v7 offset:7168
v_mul_f32 v215, v215, v214
v_mfma_f32_16x16x32_bf16 a[204:207], v[48:51], v[188:191], a[204:207]
v_cvt_pk_bf16_f32 v203, v213, v215
v_mul_f32 v208, v124, v124
v_mfma_f32_16x16x32_bf16 a[204:207], v[52:55], a[12:15], a[204:207]
v_mul_f32 v210, v125, v125
s_waitcnt lgkmcnt(4)
v_mfma_f32_16x16x32_bf16 a[208:211], v[56:59], v[176:179], a[208:211]
s_waitcnt vmcnt(63)
v_fma_f32 v208, v208, v242, v241
v_mfma_f32_16x16x32_bf16 a[208:211], v[60:63], a[0:3], a[208:211]
s_barrier
v_mfma_f32_16x16x32_bf16 a[212:215], v[56:59], v[180:183], a[212:215]
ds_read_b128 v[48:51], v7 offset:8192
v_fma_f32 v210, v210, v242, v241
v_mfma_f32_16x16x32_bf16 a[212:215], v[60:63], a[4:7], a[212:215]
buffer_load_dwordx2 v[30:31], v247, s[8:11], s29 offen offset:512 sc1
v_mfma_f32_16x16x32_bf16 a[216:219], v[56:59], v[184:187], a[216:219]
s_add_u32 m0, s22, 24576
v_add_u32 v3, 20480, v3
v_mfma_f32_16x16x32_bf16 a[216:219], v[60:63], a[8:11], a[216:219]
ds_read_b128 v[52:55], v7 offset:9216
v_mul_f32 v208, v208, v124
v_mfma_f32_16x16x32_bf16 a[220:223], v[56:59], v[188:191], a[220:223]
buffer_store_dwordx4 v[200:203], v5, s[8:11], s24 offen offset:3072 sc1
v_mfma_f32_16x16x32_bf16 a[220:223], v[60:63], a[12:15], a[220:223]
v_mul_f32 v210, v210, v125
s_waitcnt lgkmcnt(4)
v_mfma_f32_16x16x32_bf16 a[224:227], v[64:67], v[176:179], a[224:227]
v_exp_f32 v208, v208
v_mfma_f32_16x16x32_bf16 a[224:227], v[68:71], a[0:3], a[224:227]
v_exp_f32 v210, v210
v_mfma_f32_16x16x32_bf16 a[228:231], v[64:67], v[180:183], a[228:231]
ds_read_b128 v[56:59], v7 offset:10240
v_mul_f32 v209, v124, v140
v_mfma_f32_16x16x32_bf16 a[228:231], v[68:71], a[4:7], a[228:231]
buffer_load_dwordx4 v3, s[8:11], 0 offen offset:0 lds
v_mfma_f32_16x16x32_bf16 a[232:235], v[64:67], v[184:187], a[232:235]
v_mul_f32 v211, v125, v141
v_fma_f32 v208, v208, v243, v243
v_mfma_f32_16x16x32_bf16 a[232:235], v[68:71], a[8:11], a[232:235]
ds_read_b128 v[60:63], v7 offset:11264
v_fma_f32 v210, v210, v243, v243
v_mfma_f32_16x16x32_bf16 a[236:239], v[64:67], v[188:191], a[236:239]
v_rcp_f32 v208, v208
v_mfma_f32_16x16x32_bf16 a[236:239], v[68:71], a[12:15], a[236:239]
v_mul_f32 v209, v209, v208
s_waitcnt lgkmcnt(4)
v_mfma_f32_16x16x32_bf16 a[240:243], v[72:75], v[176:179], a[240:243]
buffer_load_dwordx4 v3, s[8:11], 0 offen offset:1024 lds
v_rcp_f32 v210, v210
v_mfma_f32_16x16x32_bf16 a[240:243], v[76:79], a[0:3], a[240:243]
v_mul_f32 v211, v211, v210
v_cvt_pk_bf16_f32 v206, v209, v211
v_mfma_f32_16x16x32_bf16 a[244:247], v[72:75], v[180:183], a[244:247]
ds_read_b128 v[64:67], v7 offset:12288
v_mul_f32 v212, v126, v126
v_mfma_f32_16x16x32_bf16 a[244:247], v[76:79], a[4:7], a[244:247]
v_mul_f32 v214, v127, v127
v_fma_f32 v212, v212, v242, v241
v_mfma_f32_16x16x32_bf16 a[248:251], v[72:75], v[184:187], a[248:251]
buffer_load_dwordx4 v3, s[8:11], 0 offen offset:2048 lds
v_fma_f32 v214, v214, v242, v241
v_mfma_f32_16x16x32_bf16 a[248:251], v[76:79], a[8:11], a[248:251]
ds_read_b128 v[68:71], v7 offset:13312
v_mul_f32 v212, v212, v126
v_mfma_f32_16x16x32_bf16 a[252:255], v[72:75], v[188:191], a[252:255]
v_mul_f32 v214, v214, v127
v_exp_f32 v212, v212
v_mfma_f32_16x16x32_bf16 a[252:255], v[76:79], a[12:15], a[252:255]
v_exp_f32 v214, v214
s_waitcnt vmcnt(47)
s_waitcnt lgkmcnt(4)
v_mfma_f32_16x16x32_bf16 a[112:115], v[48:51], a[16:19], a[112:115]
buffer_load_dwordx4 v3, s[8:11], 0 offen offset:3072 lds
v_mul_f32 v213, v126, v142
v_mfma_f32_16x16x32_bf16 a[112:115], v[52:55], a[32:35], a[112:115]
s_add_u32 m0, s22, 28672
v_add_u32 v3, 4096, v3
v_mul_f32 v215, v127, v143
v_mfma_f32_16x16x32_bf16 a[116:119], v[48:51], a[20:23], a[116:119]
ds_read_b128 v[72:75], v7 offset:14336
v_fma_f32 v212, v212, v243, v243
v_mfma_f32_16x16x32_bf16 a[116:119], v[52:55], a[36:39], a[116:119]
v_fma_f32 v214, v214, v243, v243
v_rcp_f32 v212, v212
v_mfma_f32_16x16x32_bf16 a[120:123], v[48:51], a[24:27], a[120:123]
buffer_load_dwordx4 v3, s[8:11], 0 offen offset:0 lds
v_rcp_f32 v214, v214
v_mfma_f32_16x16x32_bf16 a[120:123], v[52:55], a[40:43], a[120:123]
ds_read_b128 v[76:79], v7 offset:15360
v_mul_f32 v213, v213, v212
v_mfma_f32_16x16x32_bf16 a[124:127], v[48:51], a[28:31], a[124:127]
v_mul_f32 v215, v215, v214
v_cvt_pk_bf16_f32 v207, v213, v215
v_mfma_f32_16x16x32_bf16 a[124:127], v[52:55], a[44:47], a[124:127]
buffer_store_dwordx4 v[204:207], v6, s[8:11], s24 offen offset:3072 sc1
s_waitcnt lgkmcnt(4)
v_mfma_f32_16x16x32_bf16 a[128:131], v[56:59], a[16:19], a[128:131]
v_mfma_f32_16x16x32_bf16 a[128:131], v[60:63], a[32:35], a[128:131]
v_mfma_f32_16x16x32_bf16 a[132:135], v[56:59], a[20:23], a[132:135]
ds_read_b128 v[48:51], v7 offset:16384
v_mfma_f32_16x16x32_bf16 a[132:135], v[60:63], a[36:39], a[132:135]
buffer_load_dwordx4 v3, s[8:11], 0 offen offset:1024 lds
v_mfma_f32_16x16x32_bf16 a[136:139], v[56:59], a[24:27], a[136:139]
s_waitcnt vmcnt(16)
v_cmp_le_u32 vcc, 2, v13
s_nop 0
s_cmp_eq_u64 vcc, exec
s_cbranch_scc0 L_f_slow2
L_f_back2:
v_mfma_f32_16x16x32_bf16 a[136:139], v[60:63], a[40:43], a[136:139]
ds_read_b128 v[52:55], v7 offset:17408
v_mfma_f32_16x16x32_bf16 a[140:143], v[56:59], a[28:31], a[140:143]
v_mfma_f32_16x16x32_bf16 a[140:143], v[60:63], a[44:47], a[140:143]
s_waitcnt lgkmcnt(4)
v_mfma_f32_16x16x32_bf16 a[144:147], v[64:67], a[16:19], a[144:147]
buffer_load_dwordx4 v[32:35], v2, s[8:11], s25 offen offset:2048 sc1
v_mfma_f32_16x16x32_bf16 a[144:147], v[68:71], a[32:35], a[144:147]
v_mfma_f32_16x16x32_bf16 a[148:151], v[64:67], a[20:23], a[148:151]
ds_read_b128 v[56:59], v7 offset:18432
v_mfma_f32_16x16x32_bf16 a[148:151], v[68:71], a[36:39], a[148:151]
v_mfma_f32_16x16x32_bf16 a[152:155], v[64:67], a[24:27], a[152:155]
buffer_load_dwordx4 v[36:39], v4, s[8:11], s25 offen offset:2048 sc1
v_mfma_f32_16x16x32_bf16 a[152:155], v[68:71], a[40:43], a[152:155]
ds_read_b128 v[60:63], v7 offset:19456
v_mfma_f32_16x16x32_bf16 a[156:159], v[64:67], a[28:31], a[156:159]
v_mfma_f32_16x16x32_bf16 a[156:159], v[68:71], a[44:47], a[156:159]
s_waitcnt lgkmcnt(4)
v_mfma_f32_16x16x32_bf16 a[160:163], v[72:75], a[16:19], a[160:163]
buffer_load_dwordx4 v[40:43], v5, s[8:11], s25 offen offset:2048 sc1
v_mfma_f32_16x16x32_bf16 a[160:163], v[76:79], a[32:35], a[160:163]
v_mfma_f32_16x16x32_bf16 a[164:167], v[72:75], a[20:23], a[164:167]
ds_read_b128 v[64:67], v7 offset:20480
v_mfma_f32_16x16x32_bf16 a[164:167], v[76:79], a[36:39], a[164:167]
v_mfma_f32_16x16x32_bf16 a[168:171], v[72:75], a[24:27], a[168:171]
buffer_load_dwordx4 v[44:47], v6, s[8:11], s25 offen offset:2048 sc1
v_mfma_f32_16x16x32_bf16 a[168:171], v[76:79], a[40:43], a[168:171]
ds_read_b128 v[68:71], v7 offset:21504
v_mfma_f32_16x16x32_bf16 a[172:175], v[72:75], a[28:31], a[172:175]
v_mfma_f32_16x16x32_bf16 a[172:175], v[76:79], a[44:47], a[172:175]
s_waitcnt lgkmcnt(4)
v_mfma_f32_16x16x32_bf16 a[176:179], v[48:51], a[16:19], a[176:179]
buffer_load_dwordx4 v[80:83], v2, s[8:11], s26 offen offset:2048 sc1
v_mfma_f32_16x16x32_bf16 a[176:179], v[52:55], a[32:35], a[176:179]
v_mfma_f32_16x16x32_bf16 a[180:183], v[48:51], a[20:23], a[180:183]
ds_read_b128 v[72:75], v7 offset:22528
v_mfma_f32_16x16x32_bf16 a[180:183], v[52:55], a[36:39], a[180:183]
v_mfma_f32_16x16x32_bf16 a[184:187], v[48:51], a[24:27], a[184:187]
buffer_load_dwordx4 v[84:87], v4, s[8:11], s26 offen offset:2048 sc1
v_mfma_f32_16x16x32_bf16 a[184:187], v[52:55], a[40:43], a[184:187]
ds_read_b128 v[76:79], v7 offset:23552
v_mfma_f32_16x16x32_bf16 a[188:191], v[48:51], a[28:31], a[188:191]
v_mfma_f32_16x16x32_bf16 a[188:191], v[52:55], a[44:47], a[188:191]
s_waitcnt lgkmcnt(4)
v_mfma_f32_16x16x32_bf16 a[192:195], v[56:59], a[16:19], a[192:195]
buffer_load_dwordx4 v[88:91], v5, s[8:11], s26 offen offset:2048 sc1
v_mfma_f32_16x16x32_bf16 a[192:195], v[60:63], a[32:35], a[192:195]
v_mfma_f32_16x16x32_bf16 a[196:199], v[56:59], a[20:23], a[196:199]
ds_read_b128 v[48:51], v7 offset:24576
v_mfma_f32_16x16x32_bf16 a[196:199], v[60:63], a[36:39], a[196:199]
v_mfma_f32_16x16x32_bf16 a[200:203], v[56:59], a[24:27], a[200:203]
buffer_load_dwordx4 v[92:95], v6, s[8:11], s26 offen offset:2048 sc1
v_mfma_f32_16x16x32_bf16 a[200:203], v[60:63], a[40:43], a[200:203]
ds_read_b128 v[52:55], v7 offset:25600
v_mfma_f32_16x16x32_bf16 a[204:207], v[56:59], a[28:31], a[204:207]
v_mfma_f32_16x16x32_bf16 a[204:207], v[60:63], a[44:47], a[204:207]
s_waitcnt lgkmcnt(4)
v_mfma_f32_16x16x32_bf16 a[208:211], v[64:67], a[16:19], a[208:211]
buffer_load_dwordx4 v[96:99], v2, s[8:11], s27 offen offset:2048 sc1
v_mfma_f32_16x16x32_bf16 a[208:211], v[68:71], a[32:35], a[208:211]
v_mfma_f32_16x16x32_bf16 a[212:215], v[64:67], a[20:23], a[212:215]
ds_read_b128 v[56:59], v7 offset:26624
v_mfma_f32_16x16x32_bf16 a[212:215], v[68:71], a[36:39], a[212:215]
v_mfma_f32_16x16x32_bf16 a[216:219], v[64:67], a[24:27], a[216:219]
buffer_load_dwordx4 v[100:103], v4, s[8:11], s27 offen offset:2048 sc1
v_mfma_f32_16x16x32_bf16 a[216:219], v[68:71], a[40:43], a[216:219]
ds_read_b128 v[60:63], v7 offset:27648
v_mfma_f32_16x16x32_bf16 a[220:223], v[64:67], a[28:31], a[220:223]
v_mfma_f32_16x16x32_bf16 a[220:223], v[68:71], a[44:47], a[220:223]
s_waitcnt lgkmcnt(4)
v_mfma_f32_16x16x32_bf16 a[224:227], v[72:75], a[16:19], a[224:227]
buffer_load_dwordx4 v[104:107], v5, s[8:11], s27 offen offset:2048 sc1
v_mfma_f32_16x16x32_bf16 a[224:227], v[76:79], a[32:35], a[224:227]
v_mfma_f32_16x16x32_bf16 a[228:231], v[72:75], a[20:23], a[228:231]
ds_read_b128 v[64:67], v7 offset:28672
v_mfma_f32_16x16x32_bf16 a[228:231], v[76:79], a[36:39], a[228:231]
v_mfma_f32_16x16x32_bf16 a[232:235], v[72:75], a[24:27], a[232:235]
buffer_load_dwordx4 v[108:111], v6, s[8:11], s27 offen offset:2048 sc1
v_mfma_f32_16x16x32_bf16 a[232:235], v[76:79], a[40:43], a[232:235]
ds_read_b128 v[68:71], v7 offset:29696
v_mov_b32 v12, 3
v_mfma_f32_16x16x32_bf16 a[236:239], v[72:75], a[28:31], a[236:239]
s_waitcnt vmcnt(13)
v_mfma_f32_16x16x32_bf16 a[236:239], v[76:79], a[44:47], a[236:239]
s_waitcnt lgkmcnt(4)
v_mfma_f32_16x16x32_bf16 a[240:243], v[48:51], a[16:19], a[240:243]
buffer_store_dword v12, v10, s[8:11], s34 offen sc1
v_mfma_f32_16x16x32_bf16 a[240:243], v[52:55], a[32:35], a[240:243]
v_mfma_f32_16x16x32_bf16 a[244:247], v[48:51], a[20:23], a[244:247]
ds_read_b128 v[72:75], v7 offset:30720
v_mfma_f32_16x16x32_bf16 a[244:247], v[52:55], a[36:39], a[244:247]
v_mfma_f32_16x16x32_bf16 a[248:251], v[48:51], a[24:27], a[248:251]
v_mfma_f32_16x16x32_bf16 a[248:251], v[52:55], a[40:43], a[248:251]
ds_read_b128 v[76:79], v7 offset:31744
v_mfma_f32_16x16x32_bf16 a[252:255], v[48:51], a[28:31], a[252:255]
v_mfma_f32_16x16x32_bf16 a[252:255], v[52:55], a[44:47], a[252:255]
s_waitcnt vmcnt(50)
s_waitcnt lgkmcnt(4)
v_mfma_f32_16x16x32_bf16 a[112:115], v[56:59], a[48:51], a[112:115]
s_waitcnt vmcnt(63)
v_mfma_f32_16x16x32_bf16 a[112:115], v[60:63], a[64:67], a[112:115]
s_barrier
v_mfma_f32_16x16x32_bf16 a[116:119], v[56:59], a[52:55], a[116:119]
ds_read_b128 v[48:51], v7 offset:32768
s_add_u32 m0, s22, 49152
v_mfma_f32_16x16x32_bf16 a[116:119], v[60:63], a[68:71], a[116:119]
v_add_u32 v3, 20480, v3
buffer_load_dwordx4 v3, s[8:11], 0 offen offset:0 lds
v_mfma_f32_16x16x32_bf16 a[120:123], v[56:59], a[56:59], a[120:123]
v_mfma_f32_16x16x32_bf16 a[120:123], v[60:63], a[72:75], a[120:123]
ds_read_b128 v[52:55], v7 offset:33792
v_mfma_f32_16x16x32_bf16 a[124:127], v[56:59], a[60:63], a[124:127]
v_mfma_f32_16x16x32_bf16 a[124:127], v[60:63], a[76:79], a[124:127]
s_waitcnt lgkmcnt(4)
v_mfma_f32_16x16x32_bf16 a[128:131], v[64:67], a[48:51], a[128:131]
buffer_load_dwordx4 v3, s[8:11], 0 offen offset:1024 lds
v_mfma_f32_16x16x32_bf16 a[128:131], v[68:71], a[64:67], a[128:131]
v_mfma_f32_16x16x32_bf16 a[132:135], v[64:67], a[52:55], a[132:135]
ds_read_b128 v[56:59], v7 offset:34816
v_mfma_f32_16x16x32_bf16 a[132:135], v[68:71], a[68:71], a[132:135]
v_mfma_f32_16x16x32_bf16 a[136:139], v[64:67], a[56:59], a[136:139]
buffer_load_dwordx4 v3, s[8:11], 0 offen offset:2048 lds
v_mfma_f32_16x16x32_bf16 a[136:139], v[68:71], a[72:75], a[136:139]
ds_read_b128 v[60:63], v7 offset:35840
v_mfma_f32_16x16x32_bf16 a[140:143], v[64:67], a[60:63], a[140:143]
v_mfma_f32_16x16x32_bf16 a[140:143], v[68:71], a[76:79], a[140:143]
s_waitcnt lgkmcnt(4)
v_mfma_f32_16x16x32_bf16 a[144:147], v[72:75], a[48:51], a[144:147]
buffer_load_dwordx4 v3, s[8:11], 0 offen offset:3072 lds
v_mfma_f32_16x16x32_bf16 a[144:147], v[76:79], a[64:67], a[144:147]
s_add_u32 m0, s22, 53248
v_add_u32 v3, 4096, v3
v_mfma_f32_16x16x32_bf16 a[148:151], v[72:75], a[52:55], a[148:151]
ds_read_b128 v[64:67], v7 offset:36864
v_mfma_f32_16x16x32_bf16 a[148:151], v[76:79], a[68:71], a[148:151]
v_mfma_f32_16x16x32_bf16 a[152:155], v[72:75], a[56:59], a[152:155]
buffer_load_dwordx4 v3, s[8:11], 0 offen offset:0 lds
v_mfma_f32_16x16x32_bf16 a[152:155], v[76:79], a[72:75], a[152:155]
ds_read_b128 v[68:71], v7 offset:37888
v_mfma_f32_16x16x32_bf16 a[156:159], v[72:75], a[60:63], a[156:159]
v_mfma_f32_16x16x32_bf16 a[156:159], v[76:79], a[76:79], a[156:159]
s_waitcnt lgkmcnt(4)
v_mfma_f32_16x16x32_bf16 a[160:163], v[48:51], a[48:51], a[160:163]
buffer_load_dwordx4 v3, s[8:11], 0 offen offset:1024 lds
v_mfma_f32_16x16x32_bf16 a[160:163], v[52:55], a[64:67], a[160:163]
v_mfma_f32_16x16x32_bf16 a[164:167], v[48:51], a[52:55], a[164:167]
ds_read_b128 v[72:75], v7 offset:38912
v_mfma_f32_16x16x32_bf16 a[164:167], v[52:55], a[68:71], a[164:167]
v_mfma_f32_16x16x32_bf16 a[168:171], v[48:51], a[56:59], a[168:171]
v_mfma_f32_16x16x32_bf16 a[168:171], v[52:55], a[72:75], a[168:171]
ds_read_b128 v[76:79], v7 offset:39936
v_mfma_f32_16x16x32_bf16 a[172:175], v[48:51], a[60:63], a[172:175]
v_mfma_f32_16x16x32_bf16 a[172:175], v[52:55], a[76:79], a[172:175]
s_waitcnt lgkmcnt(4)
v_mfma_f32_16x16x32_bf16 a[176:179], v[56:59], a[48:51], a[176:179]
v_mfma_f32_16x16x32_bf16 a[176:179], v[60:63], a[64:67], a[176:179]
v_mfma_f32_16x16x32_bf16 a[180:183], v[56:59], a[52:55], a[180:183]
ds_read_b128 v[48:51], v7 offset:40960
v_mfma_f32_16x16x32_bf16 a[180:183], v[60:63], a[68:71], a[180:183]
v_mfma_f32_16x16x32_bf16 a[184:187], v[56:59], a[56:59], a[184:187]
v_mfma_f32_16x16x32_bf16 a[184:187], v[60:63], a[72:75], a[184:187]
ds_read_b128 v[52:55], v7 offset:41984
v_mfma_f32_16x16x32_bf16 a[188:191], v[56:59], a[60:63], a[188:191]
v_mfma_f32_16x16x32_bf16 a[188:191], v[60:63], a[76:79], a[188:191]
s_waitcnt lgkmcnt(4)
v_mfma_f32_16x16x32_bf16 a[192:195], v[64:67], a[48:51], a[192:195]
v_mfma_f32_16x16x32_bf16 a[192:195], v[68:71], a[64:67], a[192:195]
v_mfma_f32_16x16x32_bf16 a[196:199], v[64:67], a[52:55], a[196:199]
ds_read_b128 v[56:59], v7 offset:43008
v_mfma_f32_16x16x32_bf16 a[196:199], v[68:71], a[68:71], a[196:199]
v_mfma_f32_16x16x32_bf16 a[200:203], v[64:67], a[56:59], a[200:203]
v_mfma_f32_16x16x32_bf16 a[200:203], v[68:71], a[72:75], a[200:203]
ds_read_b128 v[60:63], v7 offset:44032
v_mfma_f32_16x16x32_bf16 a[204:207], v[64:67], a[60:63], a[204:207]
v_mfma_f32_16x16x32_bf16 a[204:207], v[68:71], a[76:79], a[204:207]
s_waitcnt lgkmcnt(4)
v_mfma_f32_16x16x32_bf16 a[208:211], v[72:75], a[48:51], a[208:211]
v_mfma_f32_16x16x32_bf16 a[208:211], v[76:79], a[64:67], a[208:211]
v_mfma_f32_16x16x32_bf16 a[212:215], v[72:75], a[52:55], a[212:215]
ds_read_b128 v[64:67], v7 offset:45056
v_mfma_f32_16x16x32_bf16 a[212:215], v[76:79], a[68:71], a[212:215]
v_mfma_f32_16x16x32_bf16 a[216:219], v[72:75], a[56:59], a[216:219]
v_mfma_f32_16x16x32_bf16 a[216:219], v[76:79], a[72:75], a[216:219]
ds_read_b128 v[68:71], v7 offset:46080
v_mfma_f32_16x16x32_bf16 a[220:223], v[72:75], a[60:63], a[220:223]
v_mfma_f32_16x16x32_bf16 a[220:223], v[76:79], a[76:79], a[220:223]
s_waitcnt lgkmcnt(4)
v_mfma_f32_16x16x32_bf16 a[224:227], v[48:51], a[48:51], a[224:227]
v_mfma_f32_16x16x32_bf16 a[224:227], v[52:55], a[64:67], a[224:227]
v_mfma_f32_16x16x32_bf16 a[228:231], v[48:51], a[52:55], a[228:231]
ds_read_b128 v[72:75], v7 offset:47104
v_mfma_f32_16x16x32_bf16 a[228:231], v[52:55], a[68:71], a[228:231]
v_mfma_f32_16x16x32_bf16 a[232:235], v[48:51], a[56:59], a[232:235]
v_mfma_f32_16x16x32_bf16 a[232:235], v[52:55], a[72:75], a[232:235]
ds_read_b128 v[76:79], v7 offset:48128
v_mfma_f32_16x16x32_bf16 a[236:239], v[48:51], a[60:63], a[236:239]
v_mfma_f32_16x16x32_bf16 a[236:239], v[52:55], a[76:79], a[236:239]
s_waitcnt lgkmcnt(4)
v_mfma_f32_16x16x32_bf16 a[240:243], v[56:59], a[48:51], a[240:243]
v_mfma_f32_16x16x32_bf16 a[240:243], v[60:63], a[64:67], a[240:243]
v_mfma_f32_16x16x32_bf16 a[244:247], v[56:59], a[52:55], a[244:247]
ds_read_b128 v[48:51], v7 offset:49152
v_mfma_f32_16x16x32_bf16 a[244:247], v[60:63], a[68:71], a[244:247]
v_mfma_f32_16x16x32_bf16 a[248:251], v[56:59], a[56:59], a[248:251]
v_mfma_f32_16x16x32_bf16 a[248:251], v[60:63], a[72:75], a[248:251]
ds_read_b128 v[52:55], v7 offset:50176
v_mfma_f32_16x16x32_bf16 a[252:255], v[56:59], a[60:63], a[252:255]
v_mfma_f32_16x16x32_bf16 a[252:255], v[60:63], a[76:79], a[252:255]
s_waitcnt vmcnt(43)
s_waitcnt lgkmcnt(4)
v_mfma_f32_16x16x32_bf16 a[112:115], v[64:67], a[80:83], a[112:115]
buffer_load_dword v13, v11, s[8:11], s34 offen sc1
v_mfma_f32_16x16x32_bf16 a[112:115], v[68:71], a[96:99], a[112:115]
v_mfma_f32_16x16x32_bf16 a[116:119], v[64:67], a[84:87], a[116:119]
ds_read_b128 v[56:59], v7 offset:51200
v_mfma_f32_16x16x32_bf16 a[116:119], v[68:71], a[100:103], a[116:119]
v_mfma_f32_16x16x32_bf16 a[120:123], v[64:67], a[88:91], a[120:123]
v_mfma_f32_16x16x32_bf16 a[120:123], v[68:71], a[104:107], a[120:123]
ds_read_b128 v[60:63], v7 offset:52224
v_mfma_f32_16x16x32_bf16 a[124:127], v[64:67], a[92:95], a[124:127]
v_mfma_f32_16x16x32_bf16 a[124:127], v[68:71], a[108:111], a[124:127]
s_waitcnt lgkmcnt(4)
v_mfma_f32_16x16x32_bf16 a[128:131], v[72:75], a[80:83], a[128:131]
v_mfma_f32_16x16x32_bf16 a[128:131], v[76:79], a[96:99], a[128:131]
v_mfma_f32_16x16x32_bf16 a[132:135], v[72:75], a[84:87], a[132:135]
ds_read_b128 v[64:67], v7 offset:53248
v_mfma_f32_16x16x32_bf16 a[132:135], v[76:79], a[100:103], a[132:135]
v_mfma_f32_16x16x32_bf16 a[136:139], v[72:75], a[88:91], a[136:139]
v_mfma_f32_16x16x32_bf16 a[136:139], v[76:79], a[104:107], a[136:139]
ds_read_b128 v[68:71], v7 offset:54272
v_mfma_f32_16x16x32_bf16 a[140:143], v[72:75], a[92:95], a[140:143]
v_mfma_f32_16x16x32_bf16 a[140:143], v[76:79], a[108:111], a[140:143]
s_waitcnt lgkmcnt(4)
v_mfma_f32_16x16x32_bf16 a[144:147], v[48:51], a[80:83], a[144:147]
v_mfma_f32_16x16x32_bf16 a[144:147], v[52:55], a[96:99], a[144:147]
v_mfma_f32_16x16x32_bf16 a[148:151], v[48:51], a[84:87], a[148:151]
ds_read_b128 v[72:75], v7 offset:55296
v_mfma_f32_16x16x32_bf16 a[148:151], v[52:55], a[100:103], a[148:151]
v_mfma_f32_16x16x32_bf16 a[152:155], v[48:51], a[88:91], a[152:155]
v_mfma_f32_16x16x32_bf16 a[152:155], v[52:55], a[104:107], a[152:155]
ds_read_b128 v[76:79], v7 offset:56320
v_mfma_f32_16x16x32_bf16 a[156:159], v[48:51], a[92:95], a[156:159]
v_mfma_f32_16x16x32_bf16 a[156:159], v[52:55], a[108:111], a[156:159]
s_waitcnt lgkmcnt(4)
v_mfma_f32_16x16x32_bf16 a[160:163], v[56:59], a[80:83], a[160:163]
s_waitcnt vmcnt(63)
v_mfma_f32_16x16x32_bf16 a[160:163], v[60:63], a[96:99], a[160:163]
s_barrier
v_mfma_f32_16x16x32_bf16 a[164:167], v[56:59], a[84:87], a[164:167]
ds_read_b128 v[48:51], v7 offset:57344
v_mfma_f32_16x16x32_bf16 a[164:167], v[60:63], a[100:103], a[164:167]
v_mfma_f32_16x16x32_bf16 a[168:171], v[56:59], a[88:91], a[168:171]
v_mfma_f32_16x16x32_bf16 a[168:171], v[60:63], a[104:107], a[168:171]
ds_read_b128 v[52:55], v7 offset:58368
v_mfma_f32_16x16x32_bf16 a[172:175], v[56:59], a[92:95], a[172:175]
v_mfma_f32_16x16x32_bf16 a[172:175], v[60:63], a[108:111], a[172:175]
s_waitcnt lgkmcnt(4)
v_mfma_f32_16x16x32_bf16 a[176:179], v[64:67], a[80:83], a[176:179]
v_mfma_f32_16x16x32_bf16 a[176:179], v[68:71], a[96:99], a[176:179]
v_mfma_f32_16x16x32_bf16 a[180:183], v[64:67], a[84:87], a[180:183]
ds_read_b128 v[56:59], v7 offset:59392
v_mfma_f32_16x16x32_bf16 a[180:183], v[68:71], a[100:103], a[180:183]
v_mfma_f32_16x16x32_bf16 a[184:187], v[64:67], a[88:91], a[184:187]
v_mfma_f32_16x16x32_bf16 a[184:187], v[68:71], a[104:107], a[184:187]
ds_read_b128 v[60:63], v7 offset:60416
v_mfma_f32_16x16x32_bf16 a[188:191], v[64:67], a[92:95], a[188:191]
v_mfma_f32_16x16x32_bf16 a[188:191], v[68:71], a[108:111], a[188:191]
s_waitcnt lgkmcnt(4)
v_mfma_f32_16x16x32_bf16 a[192:195], v[72:75], a[80:83], a[192:195]
v_mfma_f32_16x16x32_bf16 a[192:195], v[76:79], a[96:99], a[192:195]
v_mfma_f32_16x16x32_bf16 a[196:199], v[72:75], a[84:87], a[196:199]
ds_read_b128 v[64:67], v7 offset:61440
v_mfma_f32_16x16x32_bf16 a[196:199], v[76:79], a[100:103], a[196:199]
v_mfma_f32_16x16x32_bf16 a[200:203], v[72:75], a[88:91], a[200:203]
v_mfma_f32_16x16x32_bf16 a[200:203], v[76:79], a[104:107], a[200:203]
ds_read_b128 v[68:71], v7 offset:62464
v_mfma_f32_16x16x32_bf16 a[204:207], v[72:75], a[92:95], a[204:207]
v_mfma_f32_16x16x32_bf16 a[204:207], v[76:79], a[108:111], a[204:207]
s_waitcnt lgkmcnt(4)
v_mfma_f32_16x16x32_bf16 a[208:211], v[48:51], a[80:83], a[208:211]
v_mfma_f32_16x16x32_bf16 a[208:211], v[52:55], a[96:99], a[208:211]
v_mfma_f32_16x16x32_bf16 a[212:215], v[48:51], a[84:87], a[212:215]
ds_read_b128 v[72:75], v7 offset:63488
v_mfma_f32_16x16x32_bf16 a[212:215], v[52:55], a[100:103], a[212:215]
v_mfma_f32_16x16x32_bf16 a[216:219], v[48:51], a[88:91], a[216:219]
v_mfma_f32_16x16x32_bf16 a[216:219], v[52:55], a[104:107], a[216:219]
ds_read_b128 v[76:79], v7 offset:64512
v_mfma_f32_16x16x32_bf16 a[220:223], v[48:51], a[92:95], a[220:223]
v_mfma_f32_16x16x32_bf16 a[220:223], v[52:55], a[108:111], a[220:223]
s_waitcnt lgkmcnt(4)
v_mfma_f32_16x16x32_bf16 a[224:227], v[56:59], a[80:83], a[224:227]
v_mfma_f32_16x16x32_bf16 a[224:227], v[60:63], a[96:99], a[224:227]
v_mfma_f32_16x16x32_bf16 a[228:231], v[56:59], a[84:87], a[228:231]
ds_read_b128 v[48:51], v8 offset:0
v_mfma_f32_16x16x32_bf16 a[228:231], v[60:63], a[100:103], a[228:231]
v_mfma_f32_16x16x32_bf16 a[232:235], v[56:59], a[88:91], a[232:235]
v_mfma_f32_16x16x32_bf16 a[232:235], v[60:63], a[104:107], a[232:235]
ds_read_b128 v[52:55], v8 offset:1024
v_mfma_f32_16x16x32_bf16 a[236:239], v[56:59], a[92:95], a[236:239]
v_mfma_f32_16x16x32_bf16 a[236:239], v[60:63], a[108:111], a[236:239]
s_waitcnt lgkmcnt(4)
v_mfma_f32_16x16x32_bf16 a[240:243], v[64:67], a[80:83], a[240:243]
v_mfma_f32_16x16x32_bf16 a[240:243], v[68:71], a[96:99], a[240:243]
v_mfma_f32_16x16x32_bf16 a[244:247], v[64:67], a[84:87], a[244:247]
ds_read_b128 v[56:59], v8 offset:2048
v_mfma_f32_16x16x32_bf16 a[244:247], v[68:71], a[100:103], a[244:247]
v_mfma_f32_16x16x32_bf16 a[248:251], v[64:67], a[88:91], a[248:251]
v_mfma_f32_16x16x32_bf16 a[248:251], v[68:71], a[104:107], a[248:251]
ds_read_b128 v[60:63], v8 offset:3072
v_mfma_f32_16x16x32_bf16 a[252:255], v[64:67], a[92:95], a[252:255]
v_mfma_f32_16x16x32_bf16 a[252:255], v[68:71], a[108:111], a[252:255]
s_waitcnt vmcnt(28)
s_waitcnt lgkmcnt(4)
v_mfma_f32_16x16x32_bf16 a[112:115], v[72:75], v[16:19], a[112:115]
v_mfma_f32_16x16x32_bf16 a[112:115], v[76:79], v[192:195], a[112:115]
v_mfma_f32_16x16x32_bf16 a[116:119], v[72:75], v[20:23], a[116:119]
ds_read_b128 v[64:67], v8 offset:4096
v_mfma_f32_16x16x32_bf16 a[116:119], v[76:79], v[196:199], a[116:119]
v_mfma_f32_16x16x32_bf16 a[120:123], v[72:75], v[24:27], a[120:123]
v_mfma_f32_16x16x32_bf16 a[120:123], v[76:79], v[200:203], a[120:123]
ds_read_b128 v[68:71], v8 offset:5120
v_mfma_f32_16x16x32_bf16 a[124:127], v[72:75], v[28:31], a[124:127]
v_mfma_f32_16x16x32_bf16 a[124:127], v[76:79], v[204:207], a[124:127]
s_waitcnt lgkmcnt(4)
v_mfma_f32_16x16x32_bf16 a[128:131], v[48:51], v[16:19], a[128:131]
s_waitcnt vmcnt(0)
v_cmp_le_u32 vcc, 3, v13
s_nop 0
s_cmp_eq_u64 vcc, exec
s_cbranch_scc0 L_f_slow3
L_f_back3:
buffer_load_dwordx4 v[112:115], v2, s[8:11], s25 offen offset:3072 sc1
v_mfma_f32_16x16x32_bf16 a[128:131], v[52:55], v[192:195], a[128:131]
v_mfma_f32_16x16x32_bf16 a[132:135], v[48:51], v[20:23], a[132:135]
ds_read_b128 v[72:75], v8 offset:6144
v_mfma_f32_16x16x32_bf16 a[132:135], v[52:55], v[196:199], a[132:135]
v_mfma_f32_16x16x32_bf16 a[136:139], v[48:51], v[24:27], a[136:139]
buffer_load_dwordx4 v[116:119], v4, s[8:11], s25 offen offset:3072 sc1
v_mfma_f32_16x16x32_bf16 a[136:139], v[52:55], v[200:203], a[136:139]
ds_read_b128 v[76:79], v8 offset:7168
v_mfma_f32_16x16x32_bf16 a[140:143], v[48:51], v[28:31], a[140:143]
v_mfma_f32_16x16x32_bf16 a[140:143], v[52:55], v[204:207], a[140:143]
s_waitcnt lgkmcnt(4)
v_mfma_f32_16x16x32_bf16 a[144:147], v[56:59], v[16:19], a[144:147]
buffer_load_dwordx4 v[120:123], v5, s[8:11], s25 offen offset:3072 sc1
v_mfma_f32_16x16x32_bf16 a[144:147], v[60:63], v[192:195], a[144:147]
v_mfma_f32_16x16x32_bf16 a[148:151], v[56:59], v[20:23], a[148:151]
ds_read_b128 v[48:51], v8 offset:8192
v_mfma_f32_16x16x32_bf16 a[148:151], v[60:63], v[196:199], a[148:151]
v_mfma_f32_16x16x32_bf16 a[152:155], v[56:59], v[24:27], a[152:155]
buffer_load_dwordx4 v[124:127], v6, s[8:11], s25 offen offset:3072 sc1
v_mfma_f32_16x16x32_bf16 a[152:155], v[60:63], v[200:203], a[152:155]
ds_read_b128 v[52:55], v8 offset:9216
v_mfma_f32_16x16x32_bf16 a[156:159], v[56:59], v[28:31], a[156:159]
v_mfma_f32_16x16x32_bf16 a[156:159], v[60:63], v[204:207], a[156:159]
s_waitcnt lgkmcnt(4)
v_mfma_f32_16x16x32_bf16 a[160:163], v[64:67], v[16:19], a[160:163]
buffer_load_dwordx4 v[128:131], v2, s[8:11], s26 offen offset:3072 sc1
v_mfma_f32_16x16x32_bf16 a[160:163], v[68:71], v[192:195], a[160:163]
v_mfma_f32_16x16x32_bf16 a[164:167], v[64:67], v[20:23], a[164:167]
ds_read_b128 v[56:59], v8 offset:10240
v_mfma_f32_16x16x32_bf16 a[164:167], v[68:71], v[196:199], a[164:167]
v_mfma_f32_16x16x32_bf16 a[168:171], v[64:67], v[24:27], a[168:171]
buffer_load_dwordx4 v[132:135], v4, s[8:11], s26 offen offset:3072 sc1
v_mfma_f32_16x16x32_bf16 a[168:171], v[68:71], v[200:203], a[168:171]
ds_read_b128 v[60:63], v8 offset:11264
v_mfma_f32_16x16x32_bf16 a[172:175], v[64:67], v[28:31], a[172:175]
v_mfma_f32_16x16x32_bf16 a[172:175], v[68:71], v[204:207], a[172:175]
s_waitcnt lgkmcnt(4)
v_mfma_f32_16x16x32_bf16 a[176:179], v[72:75], v[16:19], a[176:179]
buffer_load_dwordx4 v[136:139], v5, s[8:11], s26 offen offset:3072 sc1
v_mfma_f32_16x16x32_bf16 a[176:179], v[76:79], v[192:195], a[176:179]
v_mfma_f32_16x16x32_bf16 a[180:183], v[72:75], v[20:23], a[180:183]
ds_read_b128 v[64:67], v8 offset:12288
v_mfma_f32_16x16x32_bf16 a[180:183], v[76:79], v[196:199], a[180:183]
v_mfma_f32_16x16x32_bf16 a[184:187], v[72:75], v[24:27], a[184:187]
buffer_load_dwordx4 v[140:143], v6, s[8:11], s26 offen offset:3072 sc1
v_mfma_f32_16x16x32_bf16 a[184:187], v[76:79], v[200:203], a[184:187]
ds_read_b128 v[68:71], v8 offset:13312
v_mfma_f32_16x16x32_bf16 a[188:191], v[72:75], v[28:31], a[188:191]
v_mfma_f32_16x16x32_bf16 a[188:191], v[76:79], v[204:207], a[188:191]
s_waitcnt lgkmcnt(4)
v_mfma_f32_16x16x32_bf16 a[192:195], v[48:51], v[16:19], a[192:195]
buffer_load_dwordx4 v[144:147], v2, s[8:11], s27 offen offset:3072 sc1
v_mfma_f32_16x16x32_bf16 a[192:195], v[52:55], v[192:195], a[192:195]
v_mfma_f32_16x16x32_bf16 a[196:199], v[48:51], v[20:23], a[196:199]
ds_read_b128 v[72:75], v8 offset:14336
v_mfma_f32_16x16x32_bf16 a[196:199], v[52:55], v[196:199], a[196:199]
v_mfma_f32_16x16x32_bf16 a[200:203], v[48:51], v[24:27], a[200:203]
buffer_load_dwordx4 v[148:151], v4, s[8:11], s27 offen offset:3072 sc1
v_mfma_f32_16x16x32_bf16 a[200:203], v[52:55], v[200:203], a[200:203]
ds_read_b128 v[76:79], v8 offset:15360
v_mfma_f32_16x16x32_bf16 a[204:207], v[48:51], v[28:31], a[204:207]
v_mfma_f32_16x16x32_bf16 a[204:207], v[52:55], v[204:207], a[204:207]
s_waitcnt lgkmcnt(4)
v_mfma_f32_16x16x32_bf16 a[208:211], v[56:59], v[16:19], a[208:211]
s_waitcnt vmcnt(48)
v_mfma_f32_16x16x32_bf16 a[208:211], v[60:63], v[192:195], a[208:211]
s_barrier
v_mfma_f32_16x16x32_bf16 a[212:215], v[56:59], v[20:23], a[212:215]
ds_read_b128 v[48:51], v2 offset:0
v_mfma_f32_16x16x32_bf16 a[212:215], v[60:63], v[196:199], a[212:215]
buffer_load_dwordx4 v[152:155], v5, s[8:11], s27 offen offset:3072 sc1
v_mfma_f32_16x16x32_bf16 a[216:219], v[56:59], v[24:27], a[216:219]
v_mfma_f32_16x16x32_bf16 a[216:219], v[60:63], v[200:203], a[216:219]
ds_read_b128 v[52:55], v2 offset:1024
v_mfma_f32_16x16x32_bf16 a[220:223], v[56:59], v[28:31], a[220:223]
v_mfma_f32_16x16x32_bf16 a[220:223], v[60:63], v[204:207], a[220:223]
s_waitcnt lgkmcnt(4)
v_mfma_f32_16x16x32_bf16 a[224:227], v[64:67], v[16:19], a[224:227]
buffer_load_dwordx4 v[156:159], v6, s[8:11], s27 offen offset:3072 sc1
v_mfma_f32_16x16x32_bf16 a[224:227], v[68:71], v[192:195], a[224:227]
v_mfma_f32_16x16x32_bf16 a[228:231], v[64:67], v[20:23], a[228:231]
ds_read_b128 v[56:59], v2 offset:2048
v_mfma_f32_16x16x32_bf16 a[228:231], v[68:71], v[196:199], a[228:231]
v_mfma_f32_16x16x32_bf16 a[232:235], v[64:67], v[24:27], a[232:235]
v_mfma_f32_16x16x32_bf16 a[232:235], v[68:71], v[200:203], a[232:235]
ds_read_b128 v[60:63], v2 offset:3072
v_mfma_f32_16x16x32_bf16 a[236:239], v[64:67], v[28:31], a[236:239]
v_mfma_f32_16x16x32_bf16 a[236:239], v[68:71], v[204:207], a[236:239]
s_waitcnt lgkmcnt(4)
v_mfma_f32_16x16x32_bf16 a[240:243], v[72:75], v[16:19], a[240:243]
v_mfma_f32_16x16x32_bf16 a[240:243], v[76:79], v[192:195], a[240:243]
v_mfma_f32_16x16x32_bf16 a[244:247], v[72:75], v[20:23], a[244:247]
ds_read_b128 v[64:67], v2 offset:4096
v_mfma_f32_16x16x32_bf16 a[244:247], v[76:79], v[196:199], a[244:247]
v_mfma_f32_16x16x32_bf16 a[248:251], v[72:75], v[24:27], a[248:251]
v_mfma_f32_16x16x32_bf16 a[248:251], v[76:79], v[200:203], a[248:251]
ds_read_b128 v[68:71], v2 offset:5120
v_mfma_f32_16x16x32_bf16 a[252:255], v[72:75], v[28:31], a[252:255]
v_mfma_f32_16x16x32_bf16 a[252:255], v[76:79], v[204:207], a[252:255]
s_waitcnt vmcnt(24)
s_waitcnt lgkmcnt(4)
v_mfma_f32_16x16x32_bf16 a[112:115], v[48:51], v[32:35], a[112:115]
v_mfma_f32_16x16x32_bf16 a[112:115], v[52:55], v[80:83], a[112:115]
v_mfma_f32_16x16x32_bf16 a[116:119], v[48:51], v[36:39], a[116:119]
ds_read_b128 v[72:75], v2 offset:6144
v_mfma_f32_16x16x32_bf16 a[116:119], v[52:55], v[84:87], a[116:119]
v_mfma_f32_16x16x32_bf16 a[120:123], v[48:51], v[40:43], a[120:123]
v_mfma_f32_16x16x32_bf16 a[120:123], v[52:55], v[88:91], a[120:123]
ds_read_b128 v[76:79], v2 offset:7168
v_mfma_f32_16x16x32_bf16 a[124:127], v[48:51], v[44:47], a[124:127]
v_mfma_f32_16x16x32_bf16 a[124:127], v[52:55], v[92:95], a[124:127]
s_waitcnt lgkmcnt(4)
v_mfma_f32_16x16x32_bf16 a[128:131], v[56:59], v[32:35], a[128:131]
v_mfma_f32_16x16x32_bf16 a[128:131], v[60:63], v[80:83], a[128:131]
v_mfma_f32_16x16x32_bf16 a[132:135], v[56:59], v[36:39], a[132:135]
ds_read_b128 v[48:51], v2 offset:8192
v_mfma_f32_16x16x32_bf16 a[132:135], v[60:63], v[84:87], a[132:135]
v_mfma_f32_16x16x32_bf16 a[136:139], v[56:59], v[40:43], a[136:139]
v_mfma_f32_16x16x32_bf16 a[136:139], v[60:63], v[88:91], a[136:139]
ds_read_b128 v[52:55], v2 offset:9216
v_mfma_f32_16x16x32_bf16 a[140:143], v[56:59], v[44:47], a[140:143]
v_mfma_f32_16x16x32_bf16 a[140:143], v[60:63], v[92:95], a[140:143]
s_waitcnt lgkmcnt(4)
v_mfma_f32_16x16x32_bf16 a[144:147], v[64:67], v[32:35], a[144:147]
v_mfma_f32_16x16x32_bf16 a[144:147], v[68:71], v[80:83], a[144:147]
v_mfma_f32_16x16x32_bf16 a[148:151], v[64:67], v[36:39], a[148:151]
ds_read_b128 v[56:59], v2 offset:10240
v_mfma_f32_16x16x32_bf16 a[148:151], v[68:71], v[84:87], a[148:151]
v_mfma_f32_16x16x32_bf16 a[152:155], v[64:67], v[40:43], a[152:155]
v_mfma_f32_16x16x32_bf16 a[152:155], v[68:71], v[88:91], a[152:155]
ds_read_b128 v[60:63], v2 offset:11264
v_mfma_f32_16x16x32_bf16 a[156:159], v[64:67], v[44:47], a[156:159]
v_mfma_f32_16x16x32_bf16 a[156:159], v[68:71], v[92:95], a[156:159]
s_waitcnt lgkmcnt(4)
v_mfma_f32_16x16x32_bf16 a[160:163], v[72:75], v[32:35], a[160:163]
v_mfma_f32_16x16x32_bf16 a[160:163], v[76:79], v[80:83], a[160:163]
v_mfma_f32_16x16x32_bf16 a[164:167], v[72:75], v[36:39], a[164:167]
ds_read_b128 v[64:67], v2 offset:12288
v_mfma_f32_16x16x32_bf16 a[164:167], v[76:79], v[84:87], a[164:167]
v_mfma_f32_16x16x32_bf16 a[168:171], v[72:75], v[40:43], a[168:171]
v_mfma_f32_16x16x32_bf16 a[168:171], v[76:79], v[88:91], a[168:171]
ds_read_b128 v[68:71], v2 offset:13312
v_mfma_f32_16x16x32_bf16 a[172:175], v[72:75], v[44:47], a[172:175]
v_mfma_f32_16x16x32_bf16 a[172:175], v[76:79], v[92:95], a[172:175]
s_waitcnt lgkmcnt(4)
v_mfma_f32_16x16x32_bf16 a[176:179], v[48:51], v[32:35], a[176:179]
v_mfma_f32_16x16x32_bf16 a[176:179], v[52:55], v[80:83], a[176:179]
v_mfma_f32_16x16x32_bf16 a[180:183], v[48:51], v[36:39], a[180:183]
ds_read_b128 v[72:75], v2 offset:14336
v_mfma_f32_16x16x32_bf16 a[180:183], v[52:55], v[84:87], a[180:183]
v_mfma_f32_16x16x32_bf16 a[184:187], v[48:51], v[40:43], a[184:187]
v_mfma_f32_16x16x32_bf16 a[184:187], v[52:55], v[88:91], a[184:187]
ds_read_b128 v[76:79], v2 offset:15360
v_mfma_f32_16x16x32_bf16 a[188:191], v[48:51], v[44:47], a[188:191]
v_mfma_f32_16x16x32_bf16 a[188:191], v[52:55], v[92:95], a[188:191]
s_waitcnt lgkmcnt(4)
v_mfma_f32_16x16x32_bf16 a[192:195], v[56:59], v[32:35], a[192:195]
v_mfma_f32_16x16x32_bf16 a[192:195], v[60:63], v[80:83], a[192:195]
v_mfma_f32_16x16x32_bf16 a[196:199], v[56:59], v[36:39], a[196:199]
ds_read_b128 v[48:51], v2 offset:16384
v_mfma_f32_16x16x32_bf16 a[196:199], v[60:63], v[84:87], a[196:199]
v_mfma_f32_16x16x32_bf16 a[200:203], v[56:59], v[40:43], a[200:203]
v_mfma_f32_16x16x32_bf16 a[200:203], v[60:63], v[88:91], a[200:203]
ds_read_b128 v[52:55], v2 offset:17408
v_mfma_f32_16x16x32_bf16 a[204:207], v[56:59], v[44:47], a[204:207]
v_mfma_f32_16x16x32_bf16 a[204:207], v[60:63], v[92:95], a[204:207]
s_waitcnt lgkmcnt(4)
v_mfma_f32_16x16x32_bf16 a[208:211], v[64:67], v[32:35], a[208:211]
v_mfma_f32_16x16x32_bf16 a[208:211], v[68:71], v[80:83], a[208:211]
v_mfma_f32_16x16x32_bf16 a[212:215], v[64:67], v[36:39], a[212:215]
ds_read_b128 v[56:59], v2 offset:18432
v_mfma_f32_16x16x32_bf16 a[212:215], v[68:71], v[84:87], a[212:215]
v_mfma_f32_16x16x32_bf16 a[216:219], v[64:67], v[40:43], a[216:219]
v_mfma_f32_16x16x32_bf16 a[216:219], v[68:71], v[88:91], a[216:219]
ds_read_b128 v[60:63], v2 offset:19456
v_mfma_f32_16x16x32_bf16 a[220:223], v[64:67], v[44:47], a[220:223]
v_mfma_f32_16x16x32_bf16 a[220:223], v[68:71], v[92:95], a[220:223]
s_waitcnt lgkmcnt(4)
v_mfma_f32_16x16x32_bf16 a[224:227], v[72:75], v[32:35], a[224:227]
v_mfma_f32_16x16x32_bf16 a[224:227], v[76:79], v[80:83], a[224:227]
v_mfma_f32_16x16x32_bf16 a[228:231], v[72:75], v[36:39], a[228:231]
ds_read_b128 v[64:67], v2 offset:20480
v_mfma_f32_16x16x32_bf16 a[228:231], v[76:79], v[84:87], a[228:231]
v_mfma_f32_16x16x32_bf16 a[232:235], v[72:75], v[40:43], a[232:235]
v_mfma_f32_16x16x32_bf16 a[232:235], v[76:79], v[88:91], a[232:235]
ds_read_b128 v[68:71], v2 offset:21504
v_mfma_f32_16x16x32_bf16 a[236:239], v[72:75], v[44:47], a[236:239]
v_mfma_f32_16x16x32_bf16 a[236:239], v[76:79], v[92:95], a[236:239]
s_waitcnt lgkmcnt(4)
v_mfma_f32_16x16x32_bf16 a[240:243], v[48:51], v[32:35], a[240:243]
v_mfma_f32_16x16x32_bf16 a[240:243], v[52:55], v[80:83], a[240:243]
v_mfma_f32_16x16x32_bf16 a[244:247], v[48:51], v[36:39], a[244:247]
ds_read_b128 v[72:75], v2 offset:22528
v_mfma_f32_16x16x32_bf16 a[244:247], v[52:55], v[84:87], a[244:247]
v_mfma_f32_16x16x32_bf16 a[248:251], v[48:51], v[40:43], a[248:251]
v_mfma_f32_16x16x32_bf16 a[248:251], v[52:55], v[88:91], a[248:251]
ds_read_b128 v[76:79], v2 offset:23552
v_mfma_f32_16x16x32_bf16 a[252:255], v[48:51], v[44:47], a[252:255]
v_mfma_f32_16x16x32_bf16 a[252:255], v[52:55], v[92:95], a[252:255]
s_waitcnt vmcnt(8)
s_waitcnt lgkmcnt(4)
v_mfma_f32_16x16x32_bf16 a[112:115], v[56:59], v[96:99], a[112:115]
s_waitcnt vmcnt(32)
v_mfma_f32_16x16x32_bf16 a[112:115], v[60:63], v[112:115], a[112:115]
s_barrier
v_mfma_f32_16x16x32_bf16 a[116:119], v[56:59], v[100:103], a[116:119]
ds_read_b128 v[48:51], v2 offset:24576
v_mfma_f32_16x16x32_bf16 a[116:119], v[60:63], v[116:119], a[116:119]
v_mfma_f32_16x16x32_bf16 a[120:123], v[56:59], v[104:107], a[120:123]
v_mfma_f32_16x16x32_bf16 a[120:123], v[60:63], v[120:123], a[120:123]
ds_read_b128 v[52:55], v2 offset:25600
v_mfma_f32_16x16x32_bf16 a[124:127], v[56:59], v[108:111], a[124:127]
v_mfma_f32_16x16x32_bf16 a[124:127], v[60:63], v[124:127], a[124:127]
s_waitcnt vmcnt(0)
s_waitcnt lgkmcnt(4)
v_mfma_f32_16x16x32_bf16 a[112:115], v[64:67], v[128:131], a[112:115]
v_mfma_f32_16x16x32_bf16 a[112:115], v[68:71], v[144:147], a[112:115]
v_mfma_f32_16x16x32_bf16 a[116:119], v[64:67], v[132:135], a[116:119]
ds_read_b128 v[56:59], v2 offset:26624
v_mfma_f32_16x16x32_bf16 a[116:119], v[68:71], v[148:151], a[116:119]
v_mfma_f32_16x16x32_bf16 a[120:123], v[64:67], v[136:139], a[120:123]
v_mfma_f32_16x16x32_bf16 a[120:123], v[68:71], v[152:155], a[120:123]
ds_read_b128 v[60:63], v2 offset:27648
v_mfma_f32_16x16x32_bf16 a[124:127], v[64:67], v[140:143], a[124:127]
v_mfma_f32_16x16x32_bf16 a[124:127], v[68:71], v[156:159], a[124:127]
s_waitcnt lgkmcnt(4)
v_mfma_f32_16x16x32_bf16 a[128:131], v[72:75], v[96:99], a[128:131]
s_mul_i32 s48, s7, 2146435072
s_add_u32 s48, s48, 262144
v_mfma_f32_16x16x32_bf16 a[128:131], v[76:79], v[112:115], a[128:131]
s_lshl_b32 s49, s6, 2
s_add_u32 s49, s49, s4
v_mfma_f32_16x16x32_bf16 a[132:135], v[72:75], v[100:103], a[132:135]
ds_read_b128 v[64:67], v2 offset:28672
s_mul_i32 s49, s49, 24576
v_mfma_f32_16x16x32_bf16 a[132:135], v[76:79], v[116:119], a[132:135]
s_add_u32 s48, s48, s49
v_lshlrev_b32 v14, 7, v1
buffer_load_dword v248, v14, s[8:11], s48 offen
v_mfma_f32_16x16x32_bf16 a[136:139], v[72:75], v[104:107], a[136:139]
s_add_u32 s48, s48, 8192
v_mfma_f32_16x16x32_bf16 a[136:139], v[76:79], v[120:123], a[136:139]
ds_read_b128 v[68:71], v2 offset:29696
v_mfma_f32_16x16x32_bf16 a[140:143], v[72:75], v[108:111], a[140:143]
v_mfma_f32_16x16x32_bf16 a[140:143], v[76:79], v[124:127], a[140:143]
s_waitcnt lgkmcnt(4)
v_mfma_f32_16x16x32_bf16 a[128:131], v[48:51], v[128:131], a[128:131]
buffer_load_dword v249, v14, s[8:11], s48 offen
v_mfma_f32_16x16x32_bf16 a[128:131], v[52:55], v[144:147], a[128:131]
s_add_u32 s48, s48, 8192
v_mfma_f32_16x16x32_bf16 a[132:135], v[48:51], v[132:135], a[132:135]
ds_read_b128 v[72:75], v2 offset:30720
v_mfma_f32_16x16x32_bf16 a[132:135], v[52:55], v[148:151], a[132:135]
v_mfma_f32_16x16x32_bf16 a[136:139], v[48:51], v[136:139], a[136:139]
buffer_load_dword v250, v14, s[8:11], s48 offen
v_mfma_f32_16x16x32_bf16 a[136:139], v[52:55], v[152:155], a[136:139]
ds_read_b128 v[76:79], v2 offset:31744
v_mfma_f32_16x16x32_bf16 a[140:143], v[48:51], v[140:143], a[140:143]
v_mfma_f32_16x16x32_bf16 a[140:143], v[52:55], v[156:159], a[140:143]
s_waitcnt lgkmcnt(4)
v_mfma_f32_16x16x32_bf16 a[144:147], v[56:59], v[96:99], a[144:147]
v_mfma_f32_16x16x32_bf16 a[144:147], v[60:63], v[112:115], a[144:147]
v_mfma_f32_16x16x32_bf16 a[148:151], v[56:59], v[100:103], a[148:151]
ds_read_b128 v[48:51], v2 offset:32768
v_mfma_f32_16x16x32_bf16 a[148:151], v[60:63], v[116:119], a[148:151]
v_accvgpr_read_b32 v208, a112
v_accvgpr_read_b32 v209, a113
v_mfma_f32_16x16x32_bf16 a[152:155], v[56:59], v[104:107], a[152:155]
v_accvgpr_read_b32 v210, a114
v_accvgpr_read_b32 v211, a115
v_mfma_f32_16x16x32_bf16 a[152:155], v[60:63], v[120:123], a[152:155]
ds_read_b128 v[52:55], v2 offset:33792
v_accvgpr_read_b32 v212, a128
v_mfma_f32_16x16x32_bf16 a[156:159], v[56:59], v[108:111], a[156:159]
v_accvgpr_read_b32 v213, a129
v_accvgpr_read_b32 v214, a130
v_mfma_f32_16x16x32_bf16 a[156:159], v[60:63], v[124:127], a[156:159]
v_accvgpr_read_b32 v215, a131
s_waitcnt lgkmcnt(4)
v_mfma_f32_16x16x32_bf16 a[144:147], v[64:67], v[128:131], a[144:147]
v_cvt_pk_bf16_f32 v224, v208, v209
v_cvt_pk_bf16_f32 v225, v210, v211
v_mfma_f32_16x16x32_bf16 a[144:147], v[68:71], v[144:147], a[144:147]
v_cvt_pk_bf16_f32 v226, v212, v213
v_cvt_pk_bf16_f32 v227, v214, v215
v_mfma_f32_16x16x32_bf16 a[148:151], v[64:67], v[132:135], a[148:151]
ds_read_b128 v[56:59], v2 offset:34816
buffer_store_dwordx4 v[224:227], v2, s[8:11], s31 offen offset:0 sc1
v_mfma_f32_16x16x32_bf16 a[148:151], v[68:71], v[148:151], a[148:151]
v_accvgpr_read_b32 v216, a116
v_accvgpr_read_b32 v217, a117
v_mfma_f32_16x16x32_bf16 a[152:155], v[64:67], v[136:139], a[152:155]
v_accvgpr_read_b32 v218, a118
v_accvgpr_read_b32 v219, a119
v_mfma_f32_16x16x32_bf16 a[152:155], v[68:71], v[152:155], a[152:155]
ds_read_b128 v[60:63], v2 offset:35840
v_accvgpr_read_b32 v220, a132
v_mfma_f32_16x16x32_bf16 a[156:159], v[64:67], v[140:143], a[156:159]
v_accvgpr_read_b32 v221, a133
v_accvgpr_read_b32 v222, a134
v_mfma_f32_16x16x32_bf16 a[156:159], v[68:71], v[156:159], a[156:159]
v_accvgpr_read_b32 v223, a135
s_waitcnt lgkmcnt(4)
v_mfma_f32_16x16x32_bf16 a[160:163], v[72:75], v[96:99], a[160:163]
v_cvt_pk_bf16_f32 v228, v216, v217
v_cvt_pk_bf16_f32 v229, v218, v219
v_mfma_f32_16x16x32_bf16 a[160:163], v[76:79], v[112:115], a[160:163]
v_cvt_pk_bf16_f32 v230, v220, v221
v_cvt_pk_bf16_f32 v231, v222, v223
v_mfma_f32_16x16x32_bf16 a[164:167], v[72:75], v[100:103], a[164:167]
ds_read_b128 v[64:67], v2 offset:36864
buffer_store_dwordx4 v[228:231], v4, s[8:11], s31 offen offset:0 sc1
v_mfma_f32_16x16x32_bf16 a[164:167], v[76:79], v[116:119], a[164:167]
v_accvgpr_read_b32 v208, a120
v_accvgpr_read_b32 v209, a121
v_mfma_f32_16x16x32_bf16 a[168:171], v[72:75], v[104:107], a[168:171]
v_accvgpr_read_b32 v210, a122
v_accvgpr_read_b32 v211, a123
v_mfma_f32_16x16x32_bf16 a[168:171], v[76:79], v[120:123], a[168:171]
ds_read_b128 v[68:71], v2 offset:37888
v_accvgpr_read_b32 v212, a136
v_mfma_f32_16x16x32_bf16 a[172:175], v[72:75], v[108:111], a[172:175]
v_accvgpr_read_b32 v213, a137
v_accvgpr_read_b32 v214, a138
v_mfma_f32_16x16x32_bf16 a[172:175], v[76:79], v[124:127], a[172:175]
v_accvgpr_read_b32 v215, a139
s_waitcnt lgkmcnt(4)
v_mfma_f32_16x16x32_bf16 a[160:163], v[48:51], v[128:131], a[160:163]
v_cvt_pk_bf16_f32 v224, v208, v209
v_cvt_pk_bf16_f32 v225, v210, v211
v_mfma_f32_16x16x32_bf16 a[160:163], v[52:55], v[144:147], a[160:163]
v_cvt_pk_bf16_f32 v226, v212, v213
v_cvt_pk_bf16_f32 v227, v214, v215
v_mfma_f32_16x16x32_bf16 a[164:167], v[48:51], v[132:135], a[164:167]
ds_read_b128 v[72:75], v2 offset:38912
buffer_store_dwordx4 v[224:227], v5, s[8:11], s31 offen offset:0 sc1
v_mfma_f32_16x16x32_bf16 a[164:167], v[52:55], v[148:151], a[164:167]
v_accvgpr_read_b32 v216, a124
v_accvgpr_read_b32 v217, a125
v_mfma_f32_16x16x32_bf16 a[168:171], v[48:51], v[136:139], a[168:171]
v_accvgpr_read_b32 v218, a126
v_accvgpr_read_b32 v219, a127
v_mfma_f32_16x16x32_bf16 a[168:171], v[52:55], v[152:155], a[168:171]
ds_read_b128 v[76:79], v2 offset:39936
v_accvgpr_read_b32 v220, a140
v_mfma_f32_16x16x32_bf16 a[172:175], v[48:51], v[140:143], a[172:175]
v_accvgpr_read_b32 v221, a141
v_accvgpr_read_b32 v222, a142
v_mfma_f32_16x16x32_bf16 a[172:175], v[52:55], v[156:159], a[172:175]
v_accvgpr_read_b32 v223, a143
v_cvt_pk_bf16_f32 v228, v216, v217
v_cvt_pk_bf16_f32 v229, v218, v219
v_cvt_pk_bf16_f32 v230, v220, v221
v_cvt_pk_bf16_f32 v231, v222, v223
buffer_store_dwordx4 v[228:231], v6, s[8:11], s31 offen offset:0 sc1
s_waitcnt lgkmcnt(4)
v_mfma_f32_16x16x32_bf16 a[176:179], v[56:59], v[96:99], a[176:179]
v_mfma_f32_16x16x32_bf16 a[176:179], v[60:63], v[112:115], a[176:179]
v_mfma_f32_16x16x32_bf16 a[180:183], v[56:59], v[100:103], a[180:183]
ds_read_b128 v[48:51], v2 offset:40960
v_mfma_f32_16x16x32_bf16 a[180:183], v[60:63], v[116:119], a[180:183]
v_accvgpr_read_b32 v208, a144
v_accvgpr_read_b32 v209, a145
v_mfma_f32_16x16x32_bf16 a[184:187], v[56:59], v[104:107], a[184:187]
v_accvgpr_read_b32 v210, a146
v_accvgpr_read_b32 v211, a147
v_mfma_f32_16x16x32_bf16 a[184:187], v[60:63], v[120:123], a[184:187]
ds_read_b128 v[52:55], v2 offset:41984
v_accvgpr_read_b32 v212, a160
v_mfma_f32_16x16x32_bf16 a[188:191], v[56:59], v[108:111], a[188:191]
v_accvgpr_read_b32 v213, a161
v_accvgpr_read_b32 v214, a162
v_mfma_f32_16x16x32_bf16 a[188:191], v[60:63], v[124:127], a[188:191]
v_accvgpr_read_b32 v215, a163
s_waitcnt lgkmcnt(4)
v_mfma_f32_16x16x32_bf16 a[176:179], v[64:67], v[128:131], a[176:179]
v_cvt_pk_bf16_f32 v224, v208, v209
v_cvt_pk_bf16_f32 v225, v210, v211
v_mfma_f32_16x16x32_bf16 a[176:179], v[68:71], v[144:147], a[176:179]
v_cvt_pk_bf16_f32 v226, v212, v213
v_cvt_pk_bf16_f32 v227, v214, v215
v_mfma_f32_16x16x32_bf16 a[180:183], v[64:67], v[132:135], a[180:183]
ds_read_b128 v[56:59], v2 offset:43008
buffer_store_dwordx4 v[224:227], v2, s[8:11], s31 offen offset:1024 sc1
v_mfma_f32_16x16x32_bf16 a[180:183], v[68:71], v[148:151], a[180:183]
v_accvgpr_read_b32 v216, a148
v_accvgpr_read_b32 v217, a149
v_mfma_f32_16x16x32_bf16 a[184:187], v[64:67], v[136:139], a[184:187]
v_accvgpr_read_b32 v218, a150
v_accvgpr_read_b32 v219, a151
v_mfma_f32_16x16x32_bf16 a[184:187], v[68:71], v[152:155], a[184:187]
ds_read_b128 v[60:63], v2 offset:44032
v_accvgpr_read_b32 v220, a164
v_mfma_f32_16x16x32_bf16 a[188:191], v[64:67], v[140:143], a[188:191]
v_accvgpr_read_b32 v221, a165
v_accvgpr_read_b32 v222, a166
v_mfma_f32_16x16x32_bf16 a[188:191], v[68:71], v[156:159], a[188:191]
v_accvgpr_read_b32 v223, a167
s_waitcnt lgkmcnt(4)
v_mfma_f32_16x16x32_bf16 a[192:195], v[72:75], v[96:99], a[192:195]
v_cvt_pk_bf16_f32 v228, v216, v217
v_cvt_pk_bf16_f32 v229, v218, v219
v_mfma_f32_16x16x32_bf16 a[192:195], v[76:79], v[112:115], a[192:195]
v_cvt_pk_bf16_f32 v230, v220, v221
v_cvt_pk_bf16_f32 v231, v222, v223
v_mfma_f32_16x16x32_bf16 a[196:199], v[72:75], v[100:103], a[196:199]
ds_read_b128 v[64:67], v2 offset:45056
buffer_store_dwordx4 v[228:231], v4, s[8:11], s31 offen offset:1024 sc1
v_mfma_f32_16x16x32_bf16 a[196:199], v[76:79], v[116:119], a[196:199]
v_accvgpr_read_b32 v208, a152
v_accvgpr_read_b32 v209, a153
v_mfma_f32_16x16x32_bf16 a[200:203], v[72:75], v[104:107], a[200:203]
v_accvgpr_read_b32 v210, a154
v_accvgpr_read_b32 v211, a155
v_mfma_f32_16x16x32_bf16 a[200:203], v[76:79], v[120:123], a[200:203]
ds_read_b128 v[68:71], v2 offset:46080
v_accvgpr_read_b32 v212, a168
v_mfma_f32_16x16x32_bf16 a[204:207], v[72:75], v[108:111], a[204:207]
v_accvgpr_read_b32 v213, a169
v_accvgpr_read_b32 v214, a170
v_mfma_f32_16x16x32_bf16 a[204:207], v[76:79], v[124:127], a[204:207]
v_accvgpr_read_b32 v215, a171
s_waitcnt lgkmcnt(4)
v_mfma_f32_16x16x32_bf16 a[192:195], v[48:51], v[128:131], a[192:195]
v_cvt_pk_bf16_f32 v224, v208, v209
v_cvt_pk_bf16_f32 v225, v210, v211
v_mfma_f32_16x16x32_bf16 a[192:195], v[52:55], v[144:147], a[192:195]
v_cvt_pk_bf16_f32 v226, v212, v213
v_cvt_pk_bf16_f32 v227, v214, v215
v_mfma_f32_16x16x32_bf16 a[196:199], v[48:51], v[132:135], a[196:199]
ds_read_b128 v[72:75], v2 offset:47104
buffer_store_dwordx4 v[224:227], v5, s[8:11], s31 offen offset:1024 sc1
v_mfma_f32_16x16x32_bf16 a[196:199], v[52:55], v[148:151], a[196:199]
v_accvgpr_read_b32 v216, a156
v_accvgpr_read_b32 v217, a157
v_mfma_f32_16x16x32_bf16 a[200:203], v[48:51], v[136:139], a[200:203]
v_accvgpr_read_b32 v218, a158
v_accvgpr_read_b32 v219, a159
v_mfma_f32_16x16x32_bf16 a[200:203], v[52:55], v[152:155], a[200:203]
ds_read_b128 v[76:79], v2 offset:48128
v_accvgpr_read_b32 v220, a172
v_mfma_f32_16x16x32_bf16 a[204:207], v[48:51], v[140:143], a[204:207]
v_accvgpr_read_b32 v221, a173
v_accvgpr_read_b32 v222, a174
v_mfma_f32_16x16x32_bf16 a[204:207], v[52:55], v[156:159], a[204:207]
v_accvgpr_read_b32 v223, a175
v_cvt_pk_bf16_f32 v228, v216, v217
v_cvt_pk_bf16_f32 v229, v218, v219
v_cvt_pk_bf16_f32 v230, v220, v221
v_cvt_pk_bf16_f32 v231, v222, v223
buffer_store_dwordx4 v[228:231], v6, s[8:11], s31 offen offset:1024 sc1
s_waitcnt lgkmcnt(4)
v_mfma_f32_16x16x32_bf16 a[208:211], v[56:59], v[96:99], a[208:211]
s_waitcnt vmcnt(24)
v_mfma_f32_16x16x32_bf16 a[208:211], v[60:63], v[112:115], a[208:211]
s_barrier
v_mfma_f32_16x16x32_bf16 a[212:215], v[56:59], v[100:103], a[212:215]
ds_read_b128 v[48:51], v2 offset:49152
v_mfma_f32_16x16x32_bf16 a[212:215], v[60:63], v[116:119], a[212:215]
v_accvgpr_read_b32 v208, a176
v_accvgpr_read_b32 v209, a177
v_mfma_f32_16x16x32_bf16 a[216:219], v[56:59], v[104:107], a[216:219]
v_accvgpr_read_b32 v210, a178
v_accvgpr_read_b32 v211, a179
v_mfma_f32_16x16x32_bf16 a[216:219], v[60:63], v[120:123], a[216:219]
ds_read_b128 v[52:55], v2 offset:50176
v_accvgpr_read_b32 v212, a192
v_mfma_f32_16x16x32_bf16 a[220:223], v[56:59], v[108:111], a[220:223]
v_accvgpr_read_b32 v213, a193
v_accvgpr_read_b32 v214, a194
v_mfma_f32_16x16x32_bf16 a[220:223], v[60:63], v[124:127], a[220:223]
v_accvgpr_read_b32 v215, a195
s_waitcnt lgkmcnt(4)
v_mfma_f32_16x16x32_bf16 a[208:211], v[64:67], v[128:131], a[208:211]
v_cvt_pk_bf16_f32 v224, v208, v209
v_cvt_pk_bf16_f32 v225, v210, v211
v_mfma_f32_16x16x32_bf16 a[208:211], v[68:71], v[144:147], a[208:211]
v_cvt_pk_bf16_f32 v226, v212, v213
v_cvt_pk_bf16_f32 v227, v214, v215
v_mfma_f32_16x16x32_bf16 a[212:215], v[64:67], v[132:135], a[212:215]
ds_read_b128 v[56:59], v2 offset:51200
buffer_store_dwordx4 v[224:227], v2, s[8:11], s31 offen offset:2048 sc1
v_mfma_f32_16x16x32_bf16 a[212:215], v[68:71], v[148:151], a[212:215]
v_accvgpr_read_b32 v216, a180
v_accvgpr_read_b32 v217, a181
v_mfma_f32_16x16x32_bf16 a[216:219], v[64:67], v[136:139], a[216:219]
v_accvgpr_read_b32 v218, a182
v_accvgpr_read_b32 v219, a183
v_mfma_f32_16x16x32_bf16 a[216:219], v[68:71], v[152:155], a[216:219]
ds_read_b128 v[60:63], v2 offset:52224
v_accvgpr_read_b32 v220, a196
v_mfma_f32_16x16x32_bf16 a[220:223], v[64:67], v[140:143], a[220:223]
v_accvgpr_read_b32 v221, a197
v_accvgpr_read_b32 v222, a198
v_mfma_f32_16x16x32_bf16 a[220:223], v[68:71], v[156:159], a[220:223]
v_accvgpr_read_b32 v223, a199
s_waitcnt lgkmcnt(4)
v_mfma_f32_16x16x32_bf16 a[224:227], v[72:75], v[96:99], a[224:227]
v_cvt_pk_bf16_f32 v228, v216, v217
v_cvt_pk_bf16_f32 v229, v218, v219
v_mfma_f32_16x16x32_bf16 a[224:227], v[76:79], v[112:115], a[224:227]
v_cvt_pk_bf16_f32 v230, v220, v221
v_cvt_pk_bf16_f32 v231, v222, v223
v_mfma_f32_16x16x32_bf16 a[228:231], v[72:75], v[100:103], a[228:231]
ds_read_b128 v[64:67], v2 offset:53248
buffer_store_dwordx4 v[228:231], v4, s[8:11], s31 offen offset:2048 sc1
v_mfma_f32_16x16x32_bf16 a[228:231], v[76:79], v[116:119], a[228:231]
v_accvgpr_read_b32 v208, a184
v_accvgpr_read_b32 v209, a185
v_mfma_f32_16x16x32_bf16 a[232:235], v[72:75], v[104:107], a[232:235]
v_accvgpr_read_b32 v210, a186
v_accvgpr_read_b32 v211, a187
v_mfma_f32_16x16x32_bf16 a[232:235], v[76:79], v[120:123], a[232:235]
ds_read_b128 v[68:71], v2 offset:54272
v_accvgpr_read_b32 v212, a200
v_mfma_f32_16x16x32_bf16 a[236:239], v[72:75], v[108:111], a[236:239]
v_accvgpr_read_b32 v213, a201
v_accvgpr_read_b32 v214, a202
v_mfma_f32_16x16x32_bf16 a[236:239], v[76:79], v[124:127], a[236:239]
v_accvgpr_read_b32 v215, a203
s_waitcnt lgkmcnt(4)
v_mfma_f32_16x16x32_bf16 a[224:227], v[48:51], v[128:131], a[224:227]
v_cvt_pk_bf16_f32 v224, v208, v209
v_cvt_pk_bf16_f32 v225, v210, v211
v_mfma_f32_16x16x32_bf16 a[224:227], v[52:55], v[144:147], a[224:227]
v_cvt_pk_bf16_f32 v226, v212, v213
v_cvt_pk_bf16_f32 v227, v214, v215
v_mfma_f32_16x16x32_bf16 a[228:231], v[48:51], v[132:135], a[228:231]
buffer_store_dwordx4 v[224:227], v5, s[8:11], s31 offen offset:2048 sc1
v_mfma_f32_16x16x32_bf16 a[228:231], v[52:55], v[148:151], a[228:231]
v_accvgpr_read_b32 v216, a188
v_accvgpr_read_b32 v217, a189
v_mfma_f32_16x16x32_bf16 a[232:235], v[48:51], v[136:139], a[232:235]
v_accvgpr_read_b32 v218, a190
v_accvgpr_read_b32 v219, a191
v_mfma_f32_16x16x32_bf16 a[232:235], v[52:55], v[152:155], a[232:235]
v_accvgpr_read_b32 v220, a204
v_accvgpr_read_b32 v221, a205
v_mfma_f32_16x16x32_bf16 a[236:239], v[48:51], v[140:143], a[236:239]
v_accvgpr_read_b32 v222, a206
v_accvgpr_read_b32 v223, a207
v_mfma_f32_16x16x32_bf16 a[236:239], v[52:55], v[156:159], a[236:239]
v_cvt_pk_bf16_f32 v228, v216, v217
v_cvt_pk_bf16_f32 v229, v218, v219
v_cvt_pk_bf16_f32 v230, v220, v221
v_cvt_pk_bf16_f32 v231, v222, v223
buffer_store_dwordx4 v[228:231], v6, s[8:11], s31 offen offset:2048 sc1
s_waitcnt lgkmcnt(2)
v_mfma_f32_16x16x32_bf16 a[240:243], v[56:59], v[96:99], a[240:243]
v_mfma_f32_16x16x32_bf16 a[240:243], v[60:63], v[112:115], a[240:243]
v_mfma_f32_16x16x32_bf16 a[244:247], v[56:59], v[100:103], a[244:247]
v_mfma_f32_16x16x32_bf16 a[244:247], v[60:63], v[116:119], a[244:247]
v_accvgpr_read_b32 v208, a208
v_accvgpr_read_b32 v209, a209
v_mfma_f32_16x16x32_bf16 a[248:251], v[56:59], v[104:107], a[248:251]
v_accvgpr_read_b32 v210, a210
v_accvgpr_read_b32 v211, a211
v_mfma_f32_16x16x32_bf16 a[248:251], v[60:63], v[120:123], a[248:251]
v_accvgpr_read_b32 v212, a224
v_accvgpr_read_b32 v213, a225
v_mfma_f32_16x16x32_bf16 a[252:255], v[56:59], v[108:111], a[252:255]
v_accvgpr_read_b32 v214, a226
v_accvgpr_read_b32 v215, a227
v_mfma_f32_16x16x32_bf16 a[252:255], v[60:63], v[124:127], a[252:255]
v_cvt_pk_bf16_f32 v224, v208, v209
s_waitcnt lgkmcnt(0)
v_mfma_f32_16x16x32_bf16 a[240:243], v[64:67], v[128:131], a[240:243]
v_cvt_pk_bf16_f32 v225, v210, v211
v_cvt_pk_bf16_f32 v226, v212, v213
v_mfma_f32_16x16x32_bf16 a[240:243], v[68:71], v[144:147], a[240:243]
v_cvt_pk_bf16_f32 v227, v214, v215
buffer_store_dwordx4 v[224:227], v2, s[8:11], s31 offen offset:3072 sc1
v_mfma_f32_16x16x32_bf16 a[244:247], v[64:67], v[132:135], a[244:247]
v_accvgpr_read_b32 v216, a212
v_accvgpr_read_b32 v217, a213
v_mfma_f32_16x16x32_bf16 a[244:247], v[68:71], v[148:151], a[244:247]
v_accvgpr_read_b32 v218, a214
v_accvgpr_read_b32 v219, a215
v_mfma_f32_16x16x32_bf16 a[248:251], v[64:67], v[136:139], a[248:251]
v_accvgpr_read_b32 v220, a228
v_accvgpr_read_b32 v221, a229
v_mfma_f32_16x16x32_bf16 a[248:251], v[68:71], v[152:155], a[248:251]
v_accvgpr_read_b32 v222, a230
v_accvgpr_read_b32 v223, a231
v_mfma_f32_16x16x32_bf16 a[252:255], v[64:67], v[140:143], a[252:255]
v_cvt_pk_bf16_f32 v228, v216, v217
v_cvt_pk_bf16_f32 v229, v218, v219
v_mfma_f32_16x16x32_bf16 a[252:255], v[68:71], v[156:159], a[252:255]
v_cvt_pk_bf16_f32 v230, v220, v221
s_barrier
v_cvt_pk_bf16_f32 v231, v222, v223
buffer_store_dwordx4 v[228:231], v4, s[8:11], s31 offen offset:3072 sc1
v_accvgpr_read_b32 v208, a216
v_accvgpr_read_b32 v209, a217
v_accvgpr_read_b32 v210, a218
v_accvgpr_read_b32 v211, a219
v_accvgpr_read_b32 v212, a232
v_accvgpr_read_b32 v213, a233
v_accvgpr_read_b32 v214, a234
v_accvgpr_read_b32 v215, a235
v_cvt_pk_bf16_f32 v224, v208, v209
v_cvt_pk_bf16_f32 v225, v210, v211
v_cvt_pk_bf16_f32 v226, v212, v213
v_cvt_pk_bf16_f32 v227, v214, v215
buffer_store_dwordx4 v[224:227], v5, s[8:11], s31 offen offset:3072 sc1
v_accvgpr_read_b32 v216, a220
v_accvgpr_read_b32 v217, a221
v_accvgpr_read_b32 v218, a222
v_accvgpr_read_b32 v219, a223
v_accvgpr_read_b32 v220, a236
v_accvgpr_read_b32 v221, a237
v_accvgpr_read_b32 v222, a238
v_accvgpr_read_b32 v223, a239
v_cvt_pk_bf16_f32 v228, v216, v217
v_cvt_pk_bf16_f32 v229, v218, v219
v_cvt_pk_bf16_f32 v230, v220, v221
v_cvt_pk_bf16_f32 v231, v222, v223
buffer_store_dwordx4 v[228:231], v6, s[8:11], s31 offen offset:3072 sc1
v_accvgpr_read_b32 v208, a240
v_accvgpr_read_b32 v209, a241
v_accvgpr_read_b32 v210, a242
v_accvgpr_read_b32 v211, a243
v_accvgpr_read_b32 v212, a244
v_accvgpr_read_b32 v213, a245
v_accvgpr_read_b32 v214, a246
v_accvgpr_read_b32 v215, a247
v_cvt_pk_bf16_f32 v224, v208, v209
v_cvt_pk_bf16_f32 v225, v210, v211
v_cvt_pk_bf16_f32 v226, v212, v213
v_cvt_pk_bf16_f32 v227, v214, v215
s_nop 0
v_permlane16_swap_b32 v224, v226
v_permlane16_swap_b32 v225, v227
buffer_store_dwordx4 v[224:227], v9, s[8:11], s32 offen sc1
v_accvgpr_read_b32 v216, a248
v_accvgpr_read_b32 v217, a249
v_accvgpr_read_b32 v218, a250
v_accvgpr_read_b32 v219, a251
v_accvgpr_read_b32 v220, a252
v_accvgpr_read_b32 v221, a253
v_accvgpr_read_b32 v222, a254
v_accvgpr_read_b32 v223, a255
v_cvt_pk_bf16_f32 v228, v216, v217
v_cvt_pk_bf16_f32 v229, v218, v219
v_cvt_pk_bf16_f32 v230, v220, v221
v_cvt_pk_bf16_f32 v231, v222, v223
s_nop 0
v_permlane16_swap_b32 v228, v230
v_permlane16_swap_b32 v229, v231
buffer_store_dwordx4 v[228:231], v9, s[8:11], s33 offen sc1
v_mov_b32 v14, 2146435072
v_cmp_eq_u32 vcc, 0, v1
s_nop 1
v_cndmask_b32 v14, v14, 0, vcc
v_mov_b32 v15, 1
s_waitcnt vmcnt(0)
buffer_store_dword v15, v14, s[8:11], s35 offen sc1
s_cmp_eq_u32 s7, 1
s_cbranch_scc1 L_last
s_lshr_b32 s20, s6, 4
s_lshl_b32 s21, s5, 1
s_add_u32 s20, s20, s21
s_and_b32 s21, s6, 15
s_mul_i32 s22, s21, 147456
s_add_u32 s22, s22, 262144
s_mul_i32 s23, s4, 36864
s_add_u32 s22, s22, s23
s_add_u32 m0, s23, 0
s_add_u32 s40, s22, 0
buffer_load_dwordx4 v2, s[8:11], s40 offen offset:0 lds
buffer_load_dwordx4 v2, s[8:11], s40 offen offset:1024 lds
buffer_load_dwordx4 v2, s[8:11], s40 offen offset:2048 lds
buffer_load_dwordx4 v2, s[8:11], s40 offen offset:3072 lds
s_add_u32 m0, s23, 4096
s_add_u32 s40, s22, 4096
buffer_load_dwordx4 v2, s[8:11], s40 offen offset:0 lds
buffer_load_dwordx4 v2, s[8:11], s40 offen offset:1024 lds
buffer_load_dwordx4 v2, s[8:11], s40 offen offset:2048 lds
buffer_load_dwordx4 v2, s[8:11], s40 offen offset:3072 lds
s_add_u32 m0, s23, 8192
s_add_u32 s40, s22, 8192
buffer_load_dwordx4 v2, s[8:11], s40 offen offset:0 lds
buffer_load_dwordx4 v2, s[8:11], s40 offen offset:1024 lds
buffer_load_dwordx4 v2, s[8:11], s40 offen offset:2048 lds
buffer_load_dwordx4 v2, s[8:11], s40 offen offset:3072 lds
s_add_u32 m0, s23, 12288
s_add_u32 s40, s22, 12288
buffer_load_dwordx4 v2, s[8:11], s40 offen offset:0 lds
buffer_load_dwordx4 v2, s[8:11], s40 offen offset:1024 lds
buffer_load_dwordx4 v2, s[8:11], s40 offen offset:2048 lds
buffer_load_dwordx4 v2, s[8:11], s40 offen offset:3072 lds
s_add_u32 m0, s23, 16384
s_add_u32 s40, s22, 16384
buffer_load_dwordx4 v2, s[8:11], s40 offen offset:0 lds
buffer_load_dwordx4 v2, s[8:11], s40 offen offset:1024 lds
buffer_load_dwordx4 v2, s[8:11], s40 offen offset:2048 lds
buffer_load_dwordx4 v2, s[8:11], s40 offen offset:3072 lds
s_add_u32 m0, s23, 20480
s_add_u32 s40, s22, 20480
buffer_load_dwordx4 v2, s[8:11], s40 offen offset:0 lds
buffer_load_dwordx4 v2, s[8:11], s40 offen offset:1024 lds
buffer_load_dwordx4 v2, s[8:11], s40 offen offset:2048 lds
buffer_load_dwordx4 v2, s[8:11], s40 offen offset:3072 lds
s_add_u32 m0, s23, 24576
s_add_u32 s40, s22, 24576
buffer_load_dwordx4 v2, s[8:11], s40 offen offset:0 lds
buffer_load_dwordx4 v2, s[8:11], s40 offen offset:1024 lds
buffer_load_dwordx4 v2, s[8:11], s40 offen offset:2048 lds
buffer_load_dwordx4 v2, s[8:11], s40 offen offset:3072 lds
s_add_u32 m0, s23, 28672
s_add_u32 s40, s22, 28672
buffer_load_dwordx4 v2, s[8:11], s40 offen offset:0 lds
buffer_load_dwordx4 v2, s[8:11], s40 offen offset:1024 lds
buffer_load_dwordx4 v2, s[8:11], s40 offen offset:2048 lds
buffer_load_dwordx4 v2, s[8:11], s40 offen offset:3072 lds
s_add_u32 m0, s23, 32768
s_add_u32 s40, s22, 32768
buffer_load_dwordx4 v2, s[8:11], s40 offen offset:0 lds
buffer_load_dwordx4 v2, s[8:11], s40 offen offset:1024 lds
buffer_load_dwordx4 v2, s[8:11], s40 offen offset:2048 lds
buffer_load_dwordx4 v2, s[8:11], s40 offen offset:3072 lds
s_cmp_eq_u32 s4, 3
s_cbranch_scc1 L_r_side
v_and_b32 v6, 7, v1
v_lshrrev_b32 v7, 3, v1
s_mul_i32 s22, s4, 24
v_add_u32 v7, s22, v7
s_and_b32 s23, s6, 1
s_lshl_b32 s23, s23, 3
v_add_u32 v8, s23, v6
v_lshlrev_b32 v8, 4, v8
v_lshl_add_u32 v4, v7, 8, v8
s_lshl_b32 s24, s5, 4
s_lshr_b32 s25, s6, 1
s_add_u32 s24, s24, s25
s_mul_i32 s20, s24, 18432
s_add_u32 s24, s20, 33480704
s_add_u32 s25, s24, 4096
buffer_load_dwordx4 v[16:19], v4, s[8:11], s24 offen offset:0 sc1
buffer_load_dwordx4 v[20:23], v4, s[8:11], s24 offen offset:2048 sc1
buffer_load_dwordx4 v[24:27], v4, s[8:11], s25 offen offset:0 sc1
s_lshl_b32 s24, s5, 2
s_lshr_b32 s25, s6, 3
s_add_u32 s24, s24, s25
s_lshl_b32 s24, s24, 7
s_add_u32 s24, s24, 32768
v_and_b32 v6, 31, v1
v_lshlrev_b32 v6, 2, v6
s_mov_b32 s52, 0
buffer_load_dword v253, v6, s[8:11], s24 offen sc1
s_sleep 2
buffer_load_dword v254, v6, s[8:11], s24 offen sc1
s_sleep 2
L_poll5:
buffer_load_dword v255, v6, s[8:11], s24 offen sc1
s_waitcnt vmcnt(2)
v_cmp_ne_u32 vcc, 0, v253
s_add_u32 s52, s52, 1
s_cmp_eq_u64 vcc, exec
s_cbranch_scc1 L_got5
buffer_load_dword v253, v6, s[8:11], s24 offen sc1
s_waitcnt vmcnt(2)
v_cmp_ne_u32 vcc, 0, v254
s_add_u32 s52, s52, 1
s_cmp_eq_u64 vcc, exec
s_cbranch_scc1 L_got5
buffer_load_dword v254, v6, s[8:11], s24 offen sc1
s_waitcnt vmcnt(2)
v_cmp_ne_u32 vcc, 0, v255
s_add_u32 s52, s52, 1
s_cmp_eq_u64 vcc, exec
s_cbranch_scc1 L_got5
s_cmp_lt_u32 s52, 0x200000
s_cbranch_scc1 L_poll5
L_got5:
s_add_u32 s24, s20, 76210176
s_add_u32 s25, s24, 4096
buffer_load_dwordx4 v[28:31], v4, s[8:11], s24 offen offset:0 sc1
buffer_load_dwordx4 v[32:35], v4, s[8:11], s24 offen offset:2048 sc1
buffer_load_dwordx4 v[36:39], v4, s[8:11], s25 offen offset:0 sc1
s_add_u32 s24, s20, 78569472
s_add_u32 s25, s24, 4096
buffer_load_dwordx4 v[40:43], v4, s[8:11], s24 offen offset:0 sc1
buffer_load_dwordx4 v[44:47], v4, s[8:11], s24 offen offset:2048 sc1
buffer_load_dwordx4 v[48:51], v4, s[8:11], s25 offen offset:0 sc1
s_add_u32 s24, s20, 80928768
s_add_u32 s25, s24, 4096
buffer_load_dwordx4 v[52:55], v4, s[8:11], s24 offen offset:0 sc1
buffer_load_dwordx4 v[56:59], v4, s[8:11], s24 offen offset:2048 sc1
buffer_load_dwordx4 v[60:63], v4, s[8:11], s25 offen offset:0 sc1
s_add_u32 s24, s20, 83288064
s_add_u32 s25, s24, 4096
buffer_load_dwordx4 v[64:67], v4, s[8:11], s24 offen offset:0 sc1
buffer_load_dwordx4 v[68:71], v4, s[8:11], s24 offen offset:2048 sc1
buffer_load_dwordx4 v[72:75], v4, s[8:11], s25 offen offset:0 sc1
s_add_u32 s24, s20, 85647360
s_add_u32 s25, s24, 4096
buffer_load_dwordx4 v[76:79], v4, s[8:11], s24 offen offset:0 sc1
buffer_load_dwordx4 v[80:83], v4, s[8:11], s24 offen offset:2048 sc1
buffer_load_dwordx4 v[84:87], v4, s[8:11], s25 offen offset:0 sc1
s_add_u32 s24, s20, 88006656
s_add_u32 s25, s24, 4096
buffer_load_dwordx4 v[88:91], v4, s[8:11], s24 offen offset:0 sc1
buffer_load_dwordx4 v[92:95], v4, s[8:11], s24 offen offset:2048 sc1
buffer_load_dwordx4 v[96:99], v4, s[8:11], s25 offen offset:0 sc1
s_add_u32 s24, s20, 90365952
s_add_u32 s25, s24, 4096
buffer_load_dwordx4 v[100:103], v4, s[8:11], s24 offen offset:0 sc1
buffer_load_dwordx4 v[104:107], v4, s[8:11], s24 offen offset:2048 sc1
buffer_load_dwordx4 v[108:111], v4, s[8:11], s25 offen offset:0 sc1
s_add_u32 s24, s20, 92725248
s_add_u32 s25, s24, 4096
buffer_load_dwordx4 v[112:115], v4, s[8:11], s24 offen offset:0 sc1
buffer_load_dwordx4 v[116:119], v4, s[8:11], s24 offen offset:2048 sc1
buffer_load_dwordx4 v[120:123], v4, s[8:11], s25 offen offset:0 sc1
s_waitcnt vmcnt(26)
v_lshlrev_b32 v128, 16, v16
v_and_b32 v129, 0xffff0000, v16
v_lshlrev_b32 v130, 16, v17
v_and_b32 v131, 0xffff0000, v17
v_lshlrev_b32 v132, 16, v18
v_and_b32 v133, 0xffff0000, v18
v_lshlrev_b32 v134, 16, v19
v_and_b32 v135, 0xffff0000, v19
s_waitcnt vmcnt(25)
v_lshlrev_b32 v136, 16, v20
v_and_b32 v137, 0xffff0000, v20
v_lshlrev_b32 v138, 16, v21
v_and_b32 v139, 0xffff0000, v21
v_lshlrev_b32 v140, 16, v22
v_and_b32 v141, 0xffff0000, v22
v_lshlrev_b32 v142, 16, v23
v_and_b32 v143, 0xffff0000, v23
s_waitcnt vmcnt(24)
v_lshlrev_b32 v144, 16, v24
v_and_b32 v145, 0xffff0000, v24
v_lshlrev_b32 v146, 16, v25
v_and_b32 v147, 0xffff0000, v25
v_lshlrev_b32 v148, 16, v26
v_and_b32 v149, 0xffff0000, v26
v_lshlrev_b32 v150, 16, v27
v_and_b32 v151, 0xffff0000, v27
s_waitcnt vmcnt(23)
v_lshlrev_b32 v6, 16, v28
v_and_b32 v7, 0xffff0000, v28
v_add_f32 v128, v128, v6
v_add_f32 v129, v129, v7
v_lshlrev_b32 v8, 16, v29
v_and_b32 v9, 0xffff0000, v29
v_add_f32 v130, v130, v8
v_add_f32 v131, v131, v9
v_lshlrev_b32 v6, 16, v30
v_and_b32 v7, 0xffff0000, v30
v_add_f32 v132, v132, v6
v_add_f32 v133, v133, v7
v_lshlrev_b32 v8, 16, v31
v_and_b32 v9, 0xffff0000, v31
v_add_f32 v134, v134, v8
v_add_f32 v135, v135, v9
s_waitcnt vmcnt(22)
v_lshlrev_b32 v6, 16, v32
v_and_b32 v7, 0xffff0000, v32
v_add_f32 v136, v136, v6
v_add_f32 v137, v137, v7
v_lshlrev_b32 v8, 16, v33
v_and_b32 v9, 0xffff0000, v33
v_add_f32 v138, v138, v8
v_add_f32 v139, v139, v9
v_lshlrev_b32 v6, 16, v34
v_and_b32 v7, 0xffff0000, v34
v_add_f32 v140, v140, v6
v_add_f32 v141, v141, v7
v_lshlrev_b32 v8, 16, v35
v_and_b32 v9, 0xffff0000, v35
v_add_f32 v142, v142, v8
v_add_f32 v143, v143, v9
s_waitcnt vmcnt(21)
v_lshlrev_b32 v6, 16, v36
v_and_b32 v7, 0xffff0000, v36
v_add_f32 v144, v144, v6
v_add_f32 v145, v145, v7
v_lshlrev_b32 v8, 16, v37
v_and_b32 v9, 0xffff0000, v37
v_add_f32 v146, v146, v8
v_add_f32 v147, v147, v9
v_lshlrev_b32 v6, 16, v38
v_and_b32 v7, 0xffff0000, v38
v_add_f32 v148, v148, v6
v_add_f32 v149, v149, v7
v_lshlrev_b32 v8, 16, v39
v_and_b32 v9, 0xffff0000, v39
v_add_f32 v150, v150, v8
v_add_f32 v151, v151, v9
s_waitcnt vmcnt(20)
v_lshlrev_b32 v6, 16, v40
v_and_b32 v7, 0xffff0000, v40
v_add_f32 v128, v128, v6
v_add_f32 v129, v129, v7
v_lshlrev_b32 v8, 16, v41
v_and_b32 v9, 0xffff0000, v41
v_add_f32 v130, v130, v8
v_add_f32 v131, v131, v9
v_lshlrev_b32 v6, 16, v42
v_and_b32 v7, 0xffff0000, v42
v_add_f32 v132, v132, v6
v_add_f32 v133, v133, v7
v_lshlrev_b32 v8, 16, v43
v_and_b32 v9, 0xffff0000, v43
v_add_f32 v134, v134, v8
v_add_f32 v135, v135, v9
s_waitcnt vmcnt(19)
v_lshlrev_b32 v6, 16, v44
v_and_b32 v7, 0xffff0000, v44
v_add_f32 v136, v136, v6
v_add_f32 v137, v137, v7
v_lshlrev_b32 v8, 16, v45
v_and_b32 v9, 0xffff0000, v45
v_add_f32 v138, v138, v8
v_add_f32 v139, v139, v9
v_lshlrev_b32 v6, 16, v46
v_and_b32 v7, 0xffff0000, v46
v_add_f32 v140, v140, v6
v_add_f32 v141, v141, v7
v_lshlrev_b32 v8, 16, v47
v_and_b32 v9, 0xffff0000, v47
v_add_f32 v142, v142, v8
v_add_f32 v143, v143, v9
s_waitcnt vmcnt(18)
v_lshlrev_b32 v6, 16, v48
v_and_b32 v7, 0xffff0000, v48
v_add_f32 v144, v144, v6
v_add_f32 v145, v145, v7
v_lshlrev_b32 v8, 16, v49
v_and_b32 v9, 0xffff0000, v49
v_add_f32 v146, v146, v8
v_add_f32 v147, v147, v9
v_lshlrev_b32 v6, 16, v50
v_and_b32 v7, 0xffff0000, v50
v_add_f32 v148, v148, v6
v_add_f32 v149, v149, v7
v_lshlrev_b32 v8, 16, v51
v_and_b32 v9, 0xffff0000, v51
v_add_f32 v150, v150, v8
v_add_f32 v151, v151, v9
s_waitcnt vmcnt(17)
v_lshlrev_b32 v6, 16, v52
v_and_b32 v7, 0xffff0000, v52
v_add_f32 v128, v128, v6
v_add_f32 v129, v129, v7
v_lshlrev_b32 v8, 16, v53
v_and_b32 v9, 0xffff0000, v53
v_add_f32 v130, v130, v8
v_add_f32 v131, v131, v9
v_lshlrev_b32 v6, 16, v54
v_and_b32 v7, 0xffff0000, v54
v_add_f32 v132, v132, v6
v_add_f32 v133, v133, v7
v_lshlrev_b32 v8, 16, v55
v_and_b32 v9, 0xffff0000, v55
v_add_f32 v134, v134, v8
v_add_f32 v135, v135, v9
s_waitcnt vmcnt(16)
v_lshlrev_b32 v6, 16, v56
v_and_b32 v7, 0xffff0000, v56
v_add_f32 v136, v136, v6
v_add_f32 v137, v137, v7
v_lshlrev_b32 v8, 16, v57
v_and_b32 v9, 0xffff0000, v57
v_add_f32 v138, v138, v8
v_add_f32 v139, v139, v9
v_lshlrev_b32 v6, 16, v58
v_and_b32 v7, 0xffff0000, v58
v_add_f32 v140, v140, v6
v_add_f32 v141, v141, v7
v_lshlrev_b32 v8, 16, v59
v_and_b32 v9, 0xffff0000, v59
v_add_f32 v142, v142, v8
v_add_f32 v143, v143, v9
s_waitcnt vmcnt(15)
v_lshlrev_b32 v6, 16, v60
v_and_b32 v7, 0xffff0000, v60
v_add_f32 v144, v144, v6
v_add_f32 v145, v145, v7
v_lshlrev_b32 v8, 16, v61
v_and_b32 v9, 0xffff0000, v61
v_add_f32 v146, v146, v8
v_add_f32 v147, v147, v9
v_lshlrev_b32 v6, 16, v62
v_and_b32 v7, 0xffff0000, v62
v_add_f32 v148, v148, v6
v_add_f32 v149, v149, v7
v_lshlrev_b32 v8, 16, v63
v_and_b32 v9, 0xffff0000, v63
v_add_f32 v150, v150, v8
v_add_f32 v151, v151, v9
s_waitcnt vmcnt(14)
v_lshlrev_b32 v6, 16, v64
v_and_b32 v7, 0xffff0000, v64
v_add_f32 v128, v128, v6
v_add_f32 v129, v129, v7
v_lshlrev_b32 v8, 16, v65
v_and_b32 v9, 0xffff0000, v65
v_add_f32 v130, v130, v8
v_add_f32 v131, v131, v9
v_lshlrev_b32 v6, 16, v66
v_and_b32 v7, 0xffff0000, v66
v_add_f32 v132, v132, v6
v_add_f32 v133, v133, v7
v_lshlrev_b32 v8, 16, v67
v_and_b32 v9, 0xffff0000, v67
v_add_f32 v134, v134, v8
v_add_f32 v135, v135, v9
s_waitcnt vmcnt(13)
v_lshlrev_b32 v6, 16, v68
v_and_b32 v7, 0xffff0000, v68
v_add_f32 v136, v136, v6
v_add_f32 v137, v137, v7
v_lshlrev_b32 v8, 16, v69
v_and_b32 v9, 0xffff0000, v69
v_add_f32 v138, v138, v8
v_add_f32 v139, v139, v9
v_lshlrev_b32 v6, 16, v70
v_and_b32 v7, 0xffff0000, v70
v_add_f32 v140, v140, v6
v_add_f32 v141, v141, v7
v_lshlrev_b32 v8, 16, v71
v_and_b32 v9, 0xffff0000, v71
v_add_f32 v142, v142, v8
v_add_f32 v143, v143, v9
s_waitcnt vmcnt(12)
v_lshlrev_b32 v6, 16, v72
v_and_b32 v7, 0xffff0000, v72
v_add_f32 v144, v144, v6
v_add_f32 v145, v145, v7
v_lshlrev_b32 v8, 16, v73
v_and_b32 v9, 0xffff0000, v73
v_add_f32 v146, v146, v8
v_add_f32 v147, v147, v9
v_lshlrev_b32 v6, 16, v74
v_and_b32 v7, 0xffff0000, v74
v_add_f32 v148, v148, v6
v_add_f32 v149, v149, v7
v_lshlrev_b32 v8, 16, v75
v_and_b32 v9, 0xffff0000, v75
v_add_f32 v150, v150, v8
v_add_f32 v151, v151, v9
s_waitcnt vmcnt(11)
v_lshlrev_b32 v6, 16, v76
v_and_b32 v7, 0xffff0000, v76
v_add_f32 v128, v128, v6
v_add_f32 v129, v129, v7
v_lshlrev_b32 v8, 16, v77
v_and_b32 v9, 0xffff0000, v77
v_add_f32 v130, v130, v8
v_add_f32 v131, v131, v9
v_lshlrev_b32 v6, 16, v78
v_and_b32 v7, 0xffff0000, v78
v_add_f32 v132, v132, v6
v_add_f32 v133, v133, v7
v_lshlrev_b32 v8, 16, v79
v_and_b32 v9, 0xffff0000, v79
v_add_f32 v134, v134, v8
v_add_f32 v135, v135, v9
s_waitcnt vmcnt(10)
v_lshlrev_b32 v6, 16, v80
v_and_b32 v7, 0xffff0000, v80
v_add_f32 v136, v136, v6
v_add_f32 v137, v137, v7
v_lshlrev_b32 v8, 16, v81
v_and_b32 v9, 0xffff0000, v81
v_add_f32 v138, v138, v8
v_add_f32 v139, v139, v9
v_lshlrev_b32 v6, 16, v82
v_and_b32 v7, 0xffff0000, v82
v_add_f32 v140, v140, v6
v_add_f32 v141, v141, v7
v_lshlrev_b32 v8, 16, v83
v_and_b32 v9, 0xffff0000, v83
v_add_f32 v142, v142, v8
v_add_f32 v143, v143, v9
s_waitcnt vmcnt(9)
v_lshlrev_b32 v6, 16, v84
v_and_b32 v7, 0xffff0000, v84
v_add_f32 v144, v144, v6
v_add_f32 v145, v145, v7
v_lshlrev_b32 v8, 16, v85
v_and_b32 v9, 0xffff0000, v85
v_add_f32 v146, v146, v8
v_add_f32 v147, v147, v9
v_lshlrev_b32 v6, 16, v86
v_and_b32 v7, 0xffff0000, v86
v_add_f32 v148, v148, v6
v_add_f32 v149, v149, v7
v_lshlrev_b32 v8, 16, v87
v_and_b32 v9, 0xffff0000, v87
v_add_f32 v150, v150, v8
v_add_f32 v151, v151, v9
s_waitcnt vmcnt(8)
v_lshlrev_b32 v6, 16, v88
v_and_b32 v7, 0xffff0000, v88
v_add_f32 v128, v128, v6
v_add_f32 v129, v129, v7
v_lshlrev_b32 v8, 16, v89
v_and_b32 v9, 0xffff0000, v89
v_add_f32 v130, v130, v8
v_add_f32 v131, v131, v9
v_lshlrev_b32 v6, 16, v90
v_and_b32 v7, 0xffff0000, v90
v_add_f32 v132, v132, v6
v_add_f32 v133, v133, v7
v_lshlrev_b32 v8, 16, v91
v_and_b32 v9, 0xffff0000, v91
v_add_f32 v134, v134, v8
v_add_f32 v135, v135, v9
s_waitcnt vmcnt(7)
v_lshlrev_b32 v6, 16, v92
v_and_b32 v7, 0xffff0000, v92
v_add_f32 v136, v136, v6
v_add_f32 v137, v137, v7
v_lshlrev_b32 v8, 16, v93
v_and_b32 v9, 0xffff0000, v93
v_add_f32 v138, v138, v8
v_add_f32 v139, v139, v9
v_lshlrev_b32 v6, 16, v94
v_and_b32 v7, 0xffff0000, v94
v_add_f32 v140, v140, v6
v_add_f32 v141, v141, v7
v_lshlrev_b32 v8, 16, v95
v_and_b32 v9, 0xffff0000, v95
v_add_f32 v142, v142, v8
v_add_f32 v143, v143, v9
s_waitcnt vmcnt(6)
v_lshlrev_b32 v6, 16, v96
v_and_b32 v7, 0xffff0000, v96
v_add_f32 v144, v144, v6
v_add_f32 v145, v145, v7
v_lshlrev_b32 v8, 16, v97
v_and_b32 v9, 0xffff0000, v97
v_add_f32 v146, v146, v8
v_add_f32 v147, v147, v9
v_lshlrev_b32 v6, 16, v98
v_and_b32 v7, 0xffff0000, v98
v_add_f32 v148, v148, v6
v_add_f32 v149, v149, v7
v_lshlrev_b32 v8, 16, v99
v_and_b32 v9, 0xffff0000, v99
v_add_f32 v150, v150, v8
v_add_f32 v151, v151, v9
s_waitcnt vmcnt(5)
v_lshlrev_b32 v6, 16, v100
v_and_b32 v7, 0xffff0000, v100
v_add_f32 v128, v128, v6
v_add_f32 v129, v129, v7
v_lshlrev_b32 v8, 16, v101
v_and_b32 v9, 0xffff0000, v101
v_add_f32 v130, v130, v8
v_add_f32 v131, v131, v9
v_lshlrev_b32 v6, 16, v102
v_and_b32 v7, 0xffff0000, v102
v_add_f32 v132, v132, v6
v_add_f32 v133, v133, v7
v_lshlrev_b32 v8, 16, v103
v_and_b32 v9, 0xffff0000, v103
v_add_f32 v134, v134, v8
v_add_f32 v135, v135, v9
s_waitcnt vmcnt(4)
v_lshlrev_b32 v6, 16, v104
v_and_b32 v7, 0xffff0000, v104
v_add_f32 v136, v136, v6
v_add_f32 v137, v137, v7
v_lshlrev_b32 v8, 16, v105
v_and_b32 v9, 0xffff0000, v105
v_add_f32 v138, v138, v8
v_add_f32 v139, v139, v9
v_lshlrev_b32 v6, 16, v106
v_and_b32 v7, 0xffff0000, v106
v_add_f32 v140, v140, v6
v_add_f32 v141, v141, v7
v_lshlrev_b32 v8, 16, v107
v_and_b32 v9, 0xffff0000, v107
v_add_f32 v142, v142, v8
v_add_f32 v143, v143, v9
s_waitcnt vmcnt(3)
v_lshlrev_b32 v6, 16, v108
v_and_b32 v7, 0xffff0000, v108
v_add_f32 v144, v144, v6
v_add_f32 v145, v145, v7
v_lshlrev_b32 v8, 16, v109
v_and_b32 v9, 0xffff0000, v109
v_add_f32 v146, v146, v8
v_add_f32 v147, v147, v9
v_lshlrev_b32 v6, 16, v110
v_and_b32 v7, 0xffff0000, v110
v_add_f32 v148, v148, v6
v_add_f32 v149, v149, v7
v_lshlrev_b32 v8, 16, v111
v_and_b32 v9, 0xffff0000, v111
v_add_f32 v150, v150, v8
v_add_f32 v151, v151, v9
s_waitcnt vmcnt(2)
v_lshlrev_b32 v6, 16, v112
v_and_b32 v7, 0xffff0000, v112
v_add_f32 v128, v128, v6
v_add_f32 v129, v129, v7
v_lshlrev_b32 v8, 16, v113
v_and_b32 v9, 0xffff0000, v113
v_add_f32 v130, v130, v8
v_add_f32 v131, v131, v9
v_lshlrev_b32 v6, 16, v114
v_and_b32 v7, 0xffff0000, v114
v_add_f32 v132, v132, v6
v_add_f32 v133, v133, v7
v_lshlrev_b32 v8, 16, v115
v_and_b32 v9, 0xffff0000, v115
v_add_f32 v134, v134, v8
v_add_f32 v135, v135, v9
s_waitcnt vmcnt(1)
v_lshlrev_b32 v6, 16, v116
v_and_b32 v7, 0xffff0000, v116
v_add_f32 v136, v136, v6
v_add_f32 v137, v137, v7
v_lshlrev_b32 v8, 16, v117
v_and_b32 v9, 0xffff0000, v117
v_add_f32 v138, v138, v8
v_add_f32 v139, v139, v9
v_lshlrev_b32 v6, 16, v118
v_and_b32 v7, 0xffff0000, v118
v_add_f32 v140, v140, v6
v_add_f32 v141, v141, v7
v_lshlrev_b32 v8, 16, v119
v_and_b32 v9, 0xffff0000, v119
v_add_f32 v142, v142, v8
v_add_f32 v143, v143, v9
s_waitcnt vmcnt(0)
v_lshlrev_b32 v6, 16, v120
v_and_b32 v7, 0xffff0000, v120
v_add_f32 v144, v144, v6
v_add_f32 v145, v145, v7
v_lshlrev_b32 v8, 16, v121
v_and_b32 v9, 0xffff0000, v121
v_add_f32 v146, v146, v8
v_add_f32 v147, v147, v9
v_lshlrev_b32 v6, 16, v122
v_and_b32 v7, 0xffff0000, v122
v_add_f32 v148, v148, v6
v_add_f32 v149, v149, v7
v_lshlrev_b32 v8, 16, v123
v_and_b32 v9, 0xffff0000, v123
v_add_f32 v150, v150, v8
v_add_f32 v151, v151, v9
v_cvt_pk_bf16_f32 v152, v128, v129
v_cvt_pk_bf16_f32 v153, v130, v131
v_cvt_pk_bf16_f32 v154, v132, v133
v_cvt_pk_bf16_f32 v155, v134, v135
v_cvt_pk_bf16_f32 v156, v136, v137
v_cvt_pk_bf16_f32 v157, v138, v139
v_cvt_pk_bf16_f32 v158, v140, v141
v_cvt_pk_bf16_f32 v159, v142, v143
v_cvt_pk_bf16_f32 v160, v144, v145
v_cvt_pk_bf16_f32 v161, v146, v147
v_cvt_pk_bf16_f32 v162, v148, v149
v_cvt_pk_bf16_f32 v163, v150, v151
s_add_u32 s24, s20, 26402816
s_add_u32 s25, s24, 4096
buffer_store_dwordx4 v[152:155], v4, s[8:11], s24 offen offset:0 sc1
buffer_store_dwordx4 v[156:159], v4, s[8:11], s24 offen offset:2048 sc1
buffer_store_dwordx4 v[160:163], v4, s[8:11], s25 offen offset:0 sc1
v_add_f32 v6, v128, v129
v_mul_f32 v7, v128, v128
v_mul_f32 v9, v129, v129
v_mov_b32 v8, 0
v_add_f32 v6, v6, v130
v_add_f32 v8, v8, v131
v_fmac_f32 v7, v130, v130
v_fmac_f32 v9, v131, v131
v_add_f32 v6, v6, v132
v_add_f32 v8, v8, v133
v_fmac_f32 v7, v132, v132
v_fmac_f32 v9, v133, v133
v_add_f32 v6, v6, v134
v_add_f32 v8, v8, v135
v_fmac_f32 v7, v134, v134
v_fmac_f32 v9, v135, v135
v_add_f32 v6, v6, v136
v_add_f32 v8, v8, v137
v_fmac_f32 v7, v136, v136
v_fmac_f32 v9, v137, v137
v_add_f32 v6, v6, v138
v_add_f32 v8, v8, v139
v_fmac_f32 v7, v138, v138
v_fmac_f32 v9, v139, v139
v_add_f32 v6, v6, v140
v_add_f32 v8, v8, v141
v_fmac_f32 v7, v140, v140
v_fmac_f32 v9, v141, v141
v_add_f32 v6, v6, v142
v_add_f32 v8, v8, v143
v_fmac_f32 v7, v142, v142
v_fmac_f32 v9, v143, v143
v_add_f32 v6, v6, v144
v_add_f32 v8, v8, v145
v_fmac_f32 v7, v144, v144
v_fmac_f32 v9, v145, v145
v_add_f32 v6, v6, v146
v_add_f32 v8, v8, v147
v_fmac_f32 v7, v146, v146
v_fmac_f32 v9, v147, v147
v_add_f32 v6, v6, v148
v_add_f32 v8, v8, v149
v_fmac_f32 v7, v148, v148
v_fmac_f32 v9, v149, v149
v_add_f32 v6, v6, v150
v_add_f32 v8, v8, v151
v_fmac_f32 v7, v150, v150
v_fmac_f32 v9, v151, v151
v_add_f32 v6, v6, v8
v_add_f32 v7, v7, v9
s_nop 0
v_add_f32_dpp v6, v6, v6 row_ror:8 row_mask:0xf bank_mask:0xf
v_add_f32_dpp v7, v7, v7 row_ror:8 row_mask:0xf bank_mask:0xf
v_mov_b32 v8, v6
v_mov_b32 v9, v7
s_nop 0
v_permlane16_swap_b32 v6, v8
v_permlane16_swap_b32 v7, v9
v_add_f32 v6, v6, v8
v_add_f32 v7, v7, v9
v_mov_b32 v8, v6
v_mov_b32 v9, v7
s_nop 0
v_permlane32_swap_b32 v6, v8
v_permlane32_swap_b32 v7, v9
v_add_f32 v6, v6, v8
v_add_f32 v7, v7, v9
v_and_b32 v10, 7, v1
v_lshlrev_b32 v10, 3, v10
v_add_u32 v10, 147456, v10
s_lshl_b32 s24, s4, 6
v_add_u32 v11, s24, v10
ds_write_b64 v11, v[6:7]
s_waitcnt lgkmcnt(0)
s_barrier
ds_read_b64 v[6:7], v10
ds_read_b64 v[8:9], v10 offset:64
ds_read_b64 v[12:13], v10 offset:128
s_waitcnt lgkmcnt(0)
v_add_f32 v6, v6, v8
v_add_f32 v7, v7, v9
v_add_f32 v6, v6, v12
v_add_f32 v7, v7, v13
v_mul_f32 v6, 0x3ae38e39, v6
v_mul_f32 v7, 0x3ae38e39, v7
v_fma_f32 v7, -v6, v6, v7
v_max_f32 v7, 0, v7
v_add_f32 v7, 0x3727c5ac, v7
v_rsq_f32 v7, v7
s_nop 0
v_mul_f32 v6, v6, v7
v_fma_f32 v128, v128, v7, -v6
v_fma_f32 v129, v129, v7, -v6
v_fma_f32 v130, v130, v7, -v6
v_fma_f32 v131, v131, v7, -v6
v_fma_f32 v132, v132, v7, -v6
v_fma_f32 v133, v133, v7, -v6
v_fma_f32 v134, v134, v7, -v6
v_fma_f32 v135, v135, v7, -v6
v_fma_f32 v136, v136, v7, -v6
v_fma_f32 v137, v137, v7, -v6
v_fma_f32 v138, v138, v7, -v6
v_fma_f32 v139, v139, v7, -v6
v_fma_f32 v140, v140, v7, -v6
v_fma_f32 v141, v141, v7, -v6
v_fma_f32 v142, v142, v7, -v6
v_fma_f32 v143, v143, v7, -v6
v_fma_f32 v144, v144, v7, -v6
v_fma_f32 v145, v145, v7, -v6
v_fma_f32 v146, v146, v7, -v6
v_fma_f32 v147, v147, v7, -v6
v_fma_f32 v148, v148, v7, -v6
v_fma_f32 v149, v149, v7, -v6
v_fma_f32 v150, v150, v7, -v6
v_fma_f32 v151, v151, v7, -v6
v_cvt_pk_bf16_f32 v168, v128, v129
v_cvt_pk_bf16_f32 v169, v130, v131
v_cvt_pk_bf16_f32 v170, v132, v133
v_cvt_pk_bf16_f32 v171, v134, v135
v_cvt_pk_bf16_f32 v172, v136, v137
v_cvt_pk_bf16_f32 v173, v138, v139
v_cvt_pk_bf16_f32 v174, v140, v141
v_cvt_pk_bf16_f32 v175, v142, v143
v_cvt_pk_bf16_f32 v176, v144, v145
v_cvt_pk_bf16_f32 v177, v146, v147
v_cvt_pk_bf16_f32 v178, v148, v149
v_cvt_pk_bf16_f32 v179, v150, v151
s_add_u32 s24, s20, 21684224
s_add_u32 s25, s24, 4096
buffer_store_dwordx4 v[168:171], v4, s[8:11], s24 offen offset:0 sc1
buffer_store_dwordx4 v[172:175], v4, s[8:11], s24 offen offset:2048 sc1
buffer_store_dwordx4 v[176:179], v4, s[8:11], s25 offen offset:0 sc1
s_lshl_b32 s24, s5, 4
s_lshr_b32 s25, s6, 1
s_add_u32 s24, s24, s25
s_lshl_b32 s24, s24, 3
s_and_b32 s25, s6, 1
s_mul_i32 s25, s25, 3
s_add_u32 s24, s24, s25
s_add_u32 s24, s24, s4
s_lshl_b32 s24, s24, 2
s_add_u32 s24, s24, 106496
v_mov_b32 v14, 2146435072
v_cmp_eq_u32 vcc, 0, v1
s_nop 1
v_cndmask_b32 v14, v14, 0, vcc
v_mov_b32 v15, 1
s_waitcnt vmcnt(0)
buffer_store_dword v15, v14, s[8:11], s24 offen sc1
s_branch L_r_done
L_r_side:
s_barrier
s_waitcnt vmcnt(0)
L_r_done:
s_barrier
s_mov_b32 s70, 21684224
s_mov_b32 s71, 26402816
s_mov_b32 s72, 31121408
s_mov_b32 s73, 35840000
s_mov_b32 s74, 38330368
s_mov_b32 s75, 57335808
s_mov_b32 s76, 95084544
s_mov_b32 s77, 65536
s_mov_b32 s7, 1
s_branch L_layer
L_last:
s_cmp_eq_u32 s4, 3
s_cbranch_scc1 L_end
v_and_b32 v6, 7, v1
v_lshrrev_b32 v7, 3, v1
s_mul_i32 s22, s4, 24
v_add_u32 v7, s22, v7
s_and_b32 s23, s6, 1
s_lshl_b32 s23, s23, 3
v_add_u32 v8, s23, v6
v_lshlrev_b32 v8, 4, v8
v_lshl_add_u32 v4, v7, 8, v8
s_lshl_b32 s24, s5, 4
s_lshr_b32 s25, s6, 1
s_add_u32 s24, s24, s25
s_mul_i32 s20, s24, 18432
s_lshl_b32 s24, s5, 8
s_lshl_b32 s25, s6, 3
s_add_u32 s24, s24, s25
s_and_b32 s25, s24, 1023
s_lshl_b32 s25, s25, 1
s_lshr_b32 s24, s24, 10
s_add_u32 s24, s24, s25
s_mul_i32 s21, s24, 1152
v_mul_u32_u24 v8, 2304, v6
v_lshl_add_u32 v5, v7, 4, v8
s_load_dwordx2 s[12:13], s[0:1], 56
s_waitcnt lgkmcnt(0)
s_mov_b32 s16, s12
s_and_b32 s17, s13, 0xffff
s_mov_b32 s18, 2359296
s_mov_b32 s19, 0x20000
s_add_u32 s24, s20, 35840000
s_add_u32 s25, s24, 4096
buffer_load_dwordx4 v[16:19], v4, s[8:11], s24 offen offset:0 sc1
buffer_load_dwordx4 v[20:23], v4, s[8:11], s24 offen offset:2048 sc1
buffer_load_dwordx4 v[24:27], v4, s[8:11], s25 offen offset:0 sc1
s_lshl_b32 s24, s5, 2
s_lshr_b32 s25, s6, 3
s_add_u32 s24, s24, s25
s_lshl_b32 s24, s24, 7
s_add_u32 s24, s24, 98304
v_and_b32 v6, 31, v1
v_lshlrev_b32 v6, 2, v6
s_mov_b32 s52, 0
buffer_load_dword v253, v6, s[8:11], s24 offen sc1
s_sleep 2
buffer_load_dword v254, v6, s[8:11], s24 offen sc1
s_sleep 2
L_poll6:
buffer_load_dword v255, v6, s[8:11], s24 offen sc1
s_waitcnt vmcnt(2)
v_cmp_ne_u32 vcc, 0, v253
s_add_u32 s52, s52, 1
s_cmp_eq_u64 vcc, exec
s_cbranch_scc1 L_got6
buffer_load_dword v253, v6, s[8:11], s24 offen sc1
s_waitcnt vmcnt(2)
v_cmp_ne_u32 vcc, 0, v254
s_add_u32 s52, s52, 1
s_cmp_eq_u64 vcc, exec
s_cbranch_scc1 L_got6
buffer_load_dword v254, v6, s[8:11], s24 offen sc1
s_waitcnt vmcnt(2)
v_cmp_ne_u32 vcc, 0, v255
s_add_u32 s52, s52, 1
s_cmp_eq_u64 vcc, exec
s_cbranch_scc1 L_got6
s_cmp_lt_u32 s52, 0x200000
s_cbranch_scc1 L_poll6
L_got6:
s_add_u32 s24, s20, 95084544
s_add_u32 s25, s24, 4096
buffer_load_dwordx4 v[28:31], v4, s[8:11], s24 offen offset:0 sc1
buffer_load_dwordx4 v[32:35], v4, s[8:11], s24 offen offset:2048 sc1
buffer_load_dwordx4 v[36:39], v4, s[8:11], s25 offen offset:0 sc1
s_add_u32 s24, s20, 97443840
s_add_u32 s25, s24, 4096
buffer_load_dwordx4 v[40:43], v4, s[8:11], s24 offen offset:0 sc1
buffer_load_dwordx4 v[44:47], v4, s[8:11], s24 offen offset:2048 sc1
buffer_load_dwordx4 v[48:51], v4, s[8:11], s25 offen offset:0 sc1
s_add_u32 s24, s20, 99803136
s_add_u32 s25, s24, 4096
buffer_load_dwordx4 v[52:55], v4, s[8:11], s24 offen offset:0 sc1
buffer_load_dwordx4 v[56:59], v4, s[8:11], s24 offen offset:2048 sc1
buffer_load_dwordx4 v[60:63], v4, s[8:11], s25 offen offset:0 sc1
s_add_u32 s24, s20, 102162432
s_add_u32 s25, s24, 4096
buffer_load_dwordx4 v[64:67], v4, s[8:11], s24 offen offset:0 sc1
buffer_load_dwordx4 v[68:71], v4, s[8:11], s24 offen offset:2048 sc1
buffer_load_dwordx4 v[72:75], v4, s[8:11], s25 offen offset:0 sc1
s_add_u32 s24, s20, 104521728
s_add_u32 s25, s24, 4096
buffer_load_dwordx4 v[76:79], v4, s[8:11], s24 offen offset:0 sc1
buffer_load_dwordx4 v[80:83], v4, s[8:11], s24 offen offset:2048 sc1
buffer_load_dwordx4 v[84:87], v4, s[8:11], s25 offen offset:0 sc1
s_add_u32 s24, s20, 106881024
s_add_u32 s25, s24, 4096
buffer_load_dwordx4 v[88:91], v4, s[8:11], s24 offen offset:0 sc1
buffer_load_dwordx4 v[92:95], v4, s[8:11], s24 offen offset:2048 sc1
buffer_load_dwordx4 v[96:99], v4, s[8:11], s25 offen offset:0 sc1
s_add_u32 s24, s20, 109240320
s_add_u32 s25, s24, 4096
buffer_load_dwordx4 v[100:103], v4, s[8:11], s24 offen offset:0 sc1
buffer_load_dwordx4 v[104:107], v4, s[8:11], s24 offen offset:2048 sc1
buffer_load_dwordx4 v[108:111], v4, s[8:11], s25 offen offset:0 sc1
s_add_u32 s24, s20, 111599616
s_add_u32 s25, s24, 4096
buffer_load_dwordx4 v[112:115], v4, s[8:11], s24 offen offset:0 sc1
buffer_load_dwordx4 v[116:119], v4, s[8:11], s24 offen offset:2048 sc1
buffer_load_dwordx4 v[120:123], v4, s[8:11], s25 offen offset:0 sc1
s_waitcnt vmcnt(26)
v_lshlrev_b32 v128, 16, v16
v_and_b32 v129, 0xffff0000, v16
v_lshlrev_b32 v130, 16, v17
v_and_b32 v131, 0xffff0000, v17
v_lshlrev_b32 v132, 16, v18
v_and_b32 v133, 0xffff0000, v18
v_lshlrev_b32 v134, 16, v19
v_and_b32 v135, 0xffff0000, v19
s_waitcnt vmcnt(25)
v_lshlrev_b32 v136, 16, v20
v_and_b32 v137, 0xffff0000, v20
v_lshlrev_b32 v138, 16, v21
v_and_b32 v139, 0xffff0000, v21
v_lshlrev_b32 v140, 16, v22
v_and_b32 v141, 0xffff0000, v22
v_lshlrev_b32 v142, 16, v23
v_and_b32 v143, 0xffff0000, v23
s_waitcnt vmcnt(24)
v_lshlrev_b32 v144, 16, v24
v_and_b32 v145, 0xffff0000, v24
v_lshlrev_b32 v146, 16, v25
v_and_b32 v147, 0xffff0000, v25
v_lshlrev_b32 v148, 16, v26
v_and_b32 v149, 0xffff0000, v26
v_lshlrev_b32 v150, 16, v27
v_and_b32 v151, 0xffff0000, v27
s_waitcnt vmcnt(23)
v_lshlrev_b32 v6, 16, v28
v_and_b32 v7, 0xffff0000, v28
v_add_f32 v128, v128, v6
v_add_f32 v129, v129, v7
v_lshlrev_b32 v8, 16, v29
v_and_b32 v9, 0xffff0000, v29
v_add_f32 v130, v130, v8
v_add_f32 v131, v131, v9
v_lshlrev_b32 v6, 16, v30
v_and_b32 v7, 0xffff0000, v30
v_add_f32 v132, v132, v6
v_add_f32 v133, v133, v7
v_lshlrev_b32 v8, 16, v31
v_and_b32 v9, 0xffff0000, v31
v_add_f32 v134, v134, v8
v_add_f32 v135, v135, v9
s_waitcnt vmcnt(22)
v_lshlrev_b32 v6, 16, v32
v_and_b32 v7, 0xffff0000, v32
v_add_f32 v136, v136, v6
v_add_f32 v137, v137, v7
v_lshlrev_b32 v8, 16, v33
v_and_b32 v9, 0xffff0000, v33
v_add_f32 v138, v138, v8
v_add_f32 v139, v139, v9
v_lshlrev_b32 v6, 16, v34
v_and_b32 v7, 0xffff0000, v34
v_add_f32 v140, v140, v6
v_add_f32 v141, v141, v7
v_lshlrev_b32 v8, 16, v35
v_and_b32 v9, 0xffff0000, v35
v_add_f32 v142, v142, v8
v_add_f32 v143, v143, v9
s_waitcnt vmcnt(21)
v_lshlrev_b32 v6, 16, v36
v_and_b32 v7, 0xffff0000, v36
v_add_f32 v144, v144, v6
v_add_f32 v145, v145, v7
v_lshlrev_b32 v8, 16, v37
v_and_b32 v9, 0xffff0000, v37
v_add_f32 v146, v146, v8
v_add_f32 v147, v147, v9
v_lshlrev_b32 v6, 16, v38
v_and_b32 v7, 0xffff0000, v38
v_add_f32 v148, v148, v6
v_add_f32 v149, v149, v7
v_lshlrev_b32 v8, 16, v39
v_and_b32 v9, 0xffff0000, v39
v_add_f32 v150, v150, v8
v_add_f32 v151, v151, v9
s_waitcnt vmcnt(20)
v_lshlrev_b32 v6, 16, v40
v_and_b32 v7, 0xffff0000, v40
v_add_f32 v128, v128, v6
v_add_f32 v129, v129, v7
v_lshlrev_b32 v8, 16, v41
v_and_b32 v9, 0xffff0000, v41
v_add_f32 v130, v130, v8
v_add_f32 v131, v131, v9
v_lshlrev_b32 v6, 16, v42
v_and_b32 v7, 0xffff0000, v42
v_add_f32 v132, v132, v6
v_add_f32 v133, v133, v7
v_lshlrev_b32 v8, 16, v43
v_and_b32 v9, 0xffff0000, v43
v_add_f32 v134, v134, v8
v_add_f32 v135, v135, v9
s_waitcnt vmcnt(19)
v_lshlrev_b32 v6, 16, v44
v_and_b32 v7, 0xffff0000, v44
v_add_f32 v136, v136, v6
v_add_f32 v137, v137, v7
v_lshlrev_b32 v8, 16, v45
v_and_b32 v9, 0xffff0000, v45
v_add_f32 v138, v138, v8
v_add_f32 v139, v139, v9
v_lshlrev_b32 v6, 16, v46
v_and_b32 v7, 0xffff0000, v46
v_add_f32 v140, v140, v6
v_add_f32 v141, v141, v7
v_lshlrev_b32 v8, 16, v47
v_and_b32 v9, 0xffff0000, v47
v_add_f32 v142, v142, v8
v_add_f32 v143, v143, v9
s_waitcnt vmcnt(18)
v_lshlrev_b32 v6, 16, v48
v_and_b32 v7, 0xffff0000, v48
v_add_f32 v144, v144, v6
v_add_f32 v145, v145, v7
v_lshlrev_b32 v8, 16, v49
v_and_b32 v9, 0xffff0000, v49
v_add_f32 v146, v146, v8
v_add_f32 v147, v147, v9
v_lshlrev_b32 v6, 16, v50
v_and_b32 v7, 0xffff0000, v50
v_add_f32 v148, v148, v6
v_add_f32 v149, v149, v7
v_lshlrev_b32 v8, 16, v51
v_and_b32 v9, 0xffff0000, v51
v_add_f32 v150, v150, v8
v_add_f32 v151, v151, v9
s_waitcnt vmcnt(17)
v_lshlrev_b32 v6, 16, v52
v_and_b32 v7, 0xffff0000, v52
v_add_f32 v128, v128, v6
v_add_f32 v129, v129, v7
v_lshlrev_b32 v8, 16, v53
v_and_b32 v9, 0xffff0000, v53
v_add_f32 v130, v130, v8
v_add_f32 v131, v131, v9
v_lshlrev_b32 v6, 16, v54
v_and_b32 v7, 0xffff0000, v54
v_add_f32 v132, v132, v6
v_add_f32 v133, v133, v7
v_lshlrev_b32 v8, 16, v55
v_and_b32 v9, 0xffff0000, v55
v_add_f32 v134, v134, v8
v_add_f32 v135, v135, v9
s_waitcnt vmcnt(16)
v_lshlrev_b32 v6, 16, v56
v_and_b32 v7, 0xffff0000, v56
v_add_f32 v136, v136, v6
v_add_f32 v137, v137, v7
v_lshlrev_b32 v8, 16, v57
v_and_b32 v9, 0xffff0000, v57
v_add_f32 v138, v138, v8
v_add_f32 v139, v139, v9
v_lshlrev_b32 v6, 16, v58
v_and_b32 v7, 0xffff0000, v58
v_add_f32 v140, v140, v6
v_add_f32 v141, v141, v7
v_lshlrev_b32 v8, 16, v59
v_and_b32 v9, 0xffff0000, v59
v_add_f32 v142, v142, v8
v_add_f32 v143, v143, v9
s_waitcnt vmcnt(15)
v_lshlrev_b32 v6, 16, v60
v_and_b32 v7, 0xffff0000, v60
v_add_f32 v144, v144, v6
v_add_f32 v145, v145, v7
v_lshlrev_b32 v8, 16, v61
v_and_b32 v9, 0xffff0000, v61
v_add_f32 v146, v146, v8
v_add_f32 v147, v147, v9
v_lshlrev_b32 v6, 16, v62
v_and_b32 v7, 0xffff0000, v62
v_add_f32 v148, v148, v6
v_add_f32 v149, v149, v7
v_lshlrev_b32 v8, 16, v63
v_and_b32 v9, 0xffff0000, v63
v_add_f32 v150, v150, v8
v_add_f32 v151, v151, v9
s_waitcnt vmcnt(14)
v_lshlrev_b32 v6, 16, v64
v_and_b32 v7, 0xffff0000, v64
v_add_f32 v128, v128, v6
v_add_f32 v129, v129, v7
v_lshlrev_b32 v8, 16, v65
v_and_b32 v9, 0xffff0000, v65
v_add_f32 v130, v130, v8
v_add_f32 v131, v131, v9
v_lshlrev_b32 v6, 16, v66
v_and_b32 v7, 0xffff0000, v66
v_add_f32 v132, v132, v6
v_add_f32 v133, v133, v7
v_lshlrev_b32 v8, 16, v67
v_and_b32 v9, 0xffff0000, v67
v_add_f32 v134, v134, v8
v_add_f32 v135, v135, v9
s_waitcnt vmcnt(13)
v_lshlrev_b32 v6, 16, v68
v_and_b32 v7, 0xffff0000, v68
v_add_f32 v136, v136, v6
v_add_f32 v137, v137, v7
v_lshlrev_b32 v8, 16, v69
v_and_b32 v9, 0xffff0000, v69
v_add_f32 v138, v138, v8
v_add_f32 v139, v139, v9
v_lshlrev_b32 v6, 16, v70
v_and_b32 v7, 0xffff0000, v70
v_add_f32 v140, v140, v6
v_add_f32 v141, v141, v7
v_lshlrev_b32 v8, 16, v71
v_and_b32 v9, 0xffff0000, v71
v_add_f32 v142, v142, v8
v_add_f32 v143, v143, v9
s_waitcnt vmcnt(12)
v_lshlrev_b32 v6, 16, v72
v_and_b32 v7, 0xffff0000, v72
v_add_f32 v144, v144, v6
v_add_f32 v145, v145, v7
v_lshlrev_b32 v8, 16, v73
v_and_b32 v9, 0xffff0000, v73
v_add_f32 v146, v146, v8
v_add_f32 v147, v147, v9
v_lshlrev_b32 v6, 16, v74
v_and_b32 v7, 0xffff0000, v74
v_add_f32 v148, v148, v6
v_add_f32 v149, v149, v7
v_lshlrev_b32 v8, 16, v75
v_and_b32 v9, 0xffff0000, v75
v_add_f32 v150, v150, v8
v_add_f32 v151, v151, v9
s_waitcnt vmcnt(11)
v_lshlrev_b32 v6, 16, v76
v_and_b32 v7, 0xffff0000, v76
v_add_f32 v128, v128, v6
v_add_f32 v129, v129, v7
v_lshlrev_b32 v8, 16, v77
v_and_b32 v9, 0xffff0000, v77
v_add_f32 v130, v130, v8
v_add_f32 v131, v131, v9
v_lshlrev_b32 v6, 16, v78
v_and_b32 v7, 0xffff0000, v78
v_add_f32 v132, v132, v6
v_add_f32 v133, v133, v7
v_lshlrev_b32 v8, 16, v79
v_and_b32 v9, 0xffff0000, v79
v_add_f32 v134, v134, v8
v_add_f32 v135, v135, v9
s_waitcnt vmcnt(10)
v_lshlrev_b32 v6, 16, v80
v_and_b32 v7, 0xffff0000, v80
v_add_f32 v136, v136, v6
v_add_f32 v137, v137, v7
v_lshlrev_b32 v8, 16, v81
v_and_b32 v9, 0xffff0000, v81
v_add_f32 v138, v138, v8
v_add_f32 v139, v139, v9
v_lshlrev_b32 v6, 16, v82
v_and_b32 v7, 0xffff0000, v82
v_add_f32 v140, v140, v6
v_add_f32 v141, v141, v7
v_lshlrev_b32 v8, 16, v83
v_and_b32 v9, 0xffff0000, v83
v_add_f32 v142, v142, v8
v_add_f32 v143, v143, v9
s_waitcnt vmcnt(9)
v_lshlrev_b32 v6, 16, v84
v_and_b32 v7, 0xffff0000, v84
v_add_f32 v144, v144, v6
v_add_f32 v145, v145, v7
v_lshlrev_b32 v8, 16, v85
v_and_b32 v9, 0xffff0000, v85
v_add_f32 v146, v146, v8
v_add_f32 v147, v147, v9
v_lshlrev_b32 v6, 16, v86
v_and_b32 v7, 0xffff0000, v86
v_add_f32 v148, v148, v6
v_add_f32 v149, v149, v7
v_lshlrev_b32 v8, 16, v87
v_and_b32 v9, 0xffff0000, v87
v_add_f32 v150, v150, v8
v_add_f32 v151, v151, v9
s_waitcnt vmcnt(8)
v_lshlrev_b32 v6, 16, v88
v_and_b32 v7, 0xffff0000, v88
v_add_f32 v128, v128, v6
v_add_f32 v129, v129, v7
v_lshlrev_b32 v8, 16, v89
v_and_b32 v9, 0xffff0000, v89
v_add_f32 v130, v130, v8
v_add_f32 v131, v131, v9
v_lshlrev_b32 v6, 16, v90
v_and_b32 v7, 0xffff0000, v90
v_add_f32 v132, v132, v6
v_add_f32 v133, v133, v7
v_lshlrev_b32 v8, 16, v91
v_and_b32 v9, 0xffff0000, v91
v_add_f32 v134, v134, v8
v_add_f32 v135, v135, v9
s_waitcnt vmcnt(7)
v_lshlrev_b32 v6, 16, v92
v_and_b32 v7, 0xffff0000, v92
v_add_f32 v136, v136, v6
v_add_f32 v137, v137, v7
v_lshlrev_b32 v8, 16, v93
v_and_b32 v9, 0xffff0000, v93
v_add_f32 v138, v138, v8
v_add_f32 v139, v139, v9
v_lshlrev_b32 v6, 16, v94
v_and_b32 v7, 0xffff0000, v94
v_add_f32 v140, v140, v6
v_add_f32 v141, v141, v7
v_lshlrev_b32 v8, 16, v95
v_and_b32 v9, 0xffff0000, v95
v_add_f32 v142, v142, v8
v_add_f32 v143, v143, v9
s_waitcnt vmcnt(6)
v_lshlrev_b32 v6, 16, v96
v_and_b32 v7, 0xffff0000, v96
v_add_f32 v144, v144, v6
v_add_f32 v145, v145, v7
v_lshlrev_b32 v8, 16, v97
v_and_b32 v9, 0xffff0000, v97
v_add_f32 v146, v146, v8
v_add_f32 v147, v147, v9
v_lshlrev_b32 v6, 16, v98
v_and_b32 v7, 0xffff0000, v98
v_add_f32 v148, v148, v6
v_add_f32 v149, v149, v7
v_lshlrev_b32 v8, 16, v99
v_and_b32 v9, 0xffff0000, v99
v_add_f32 v150, v150, v8
v_add_f32 v151, v151, v9
s_waitcnt vmcnt(5)
v_lshlrev_b32 v6, 16, v100
v_and_b32 v7, 0xffff0000, v100
v_add_f32 v128, v128, v6
v_add_f32 v129, v129, v7
v_lshlrev_b32 v8, 16, v101
v_and_b32 v9, 0xffff0000, v101
v_add_f32 v130, v130, v8
v_add_f32 v131, v131, v9
v_lshlrev_b32 v6, 16, v102
v_and_b32 v7, 0xffff0000, v102
v_add_f32 v132, v132, v6
v_add_f32 v133, v133, v7
v_lshlrev_b32 v8, 16, v103
v_and_b32 v9, 0xffff0000, v103
v_add_f32 v134, v134, v8
v_add_f32 v135, v135, v9
s_waitcnt vmcnt(4)
v_lshlrev_b32 v6, 16, v104
v_and_b32 v7, 0xffff0000, v104
v_add_f32 v136, v136, v6
v_add_f32 v137, v137, v7
v_lshlrev_b32 v8, 16, v105
v_and_b32 v9, 0xffff0000, v105
v_add_f32 v138, v138, v8
v_add_f32 v139, v139, v9
v_lshlrev_b32 v6, 16, v106
v_and_b32 v7, 0xffff0000, v106
v_add_f32 v140, v140, v6
v_add_f32 v141, v141, v7
v_lshlrev_b32 v8, 16, v107
v_and_b32 v9, 0xffff0000, v107
v_add_f32 v142, v142, v8
v_add_f32 v143, v143, v9
s_waitcnt vmcnt(3)
v_lshlrev_b32 v6, 16, v108
v_and_b32 v7, 0xffff0000, v108
v_add_f32 v144, v144, v6
v_add_f32 v145, v145, v7
v_lshlrev_b32 v8, 16, v109
v_and_b32 v9, 0xffff0000, v109
v_add_f32 v146, v146, v8
v_add_f32 v147, v147, v9
v_lshlrev_b32 v6, 16, v110
v_and_b32 v7, 0xffff0000, v110
v_add_f32 v148, v148, v6
v_add_f32 v149, v149, v7
v_lshlrev_b32 v8, 16, v111
v_and_b32 v9, 0xffff0000, v111
v_add_f32 v150, v150, v8
v_add_f32 v151, v151, v9
s_waitcnt vmcnt(2)
v_lshlrev_b32 v6, 16, v112
v_and_b32 v7, 0xffff0000, v112
v_add_f32 v128, v128, v6
v_add_f32 v129, v129, v7
v_lshlrev_b32 v8, 16, v113
v_and_b32 v9, 0xffff0000, v113
v_add_f32 v130, v130, v8
v_add_f32 v131, v131, v9
v_lshlrev_b32 v6, 16, v114
v_and_b32 v7, 0xffff0000, v114
v_add_f32 v132, v132, v6
v_add_f32 v133, v133, v7
v_lshlrev_b32 v8, 16, v115
v_and_b32 v9, 0xffff0000, v115
v_add_f32 v134, v134, v8
v_add_f32 v135, v135, v9
s_waitcnt vmcnt(1)
v_lshlrev_b32 v6, 16, v116
v_and_b32 v7, 0xffff0000, v116
v_add_f32 v136, v136, v6
v_add_f32 v137, v137, v7
v_lshlrev_b32 v8, 16, v117
v_and_b32 v9, 0xffff0000, v117
v_add_f32 v138, v138, v8
v_add_f32 v139, v139, v9
v_lshlrev_b32 v6, 16, v118
v_and_b32 v7, 0xffff0000, v118
v_add_f32 v140, v140, v6
v_add_f32 v141, v141, v7
v_lshlrev_b32 v8, 16, v119
v_and_b32 v9, 0xffff0000, v119
v_add_f32 v142, v142, v8
v_add_f32 v143, v143, v9
s_waitcnt vmcnt(0)
v_lshlrev_b32 v6, 16, v120
v_and_b32 v7, 0xffff0000, v120
v_add_f32 v144, v144, v6
v_add_f32 v145, v145, v7
v_lshlrev_b32 v8, 16, v121
v_and_b32 v9, 0xffff0000, v121
v_add_f32 v146, v146, v8
v_add_f32 v147, v147, v9
v_lshlrev_b32 v6, 16, v122
v_and_b32 v7, 0xffff0000, v122
v_add_f32 v148, v148, v6
v_add_f32 v149, v149, v7
v_lshlrev_b32 v8, 16, v123
v_and_b32 v9, 0xffff0000, v123
v_add_f32 v150, v150, v8
v_add_f32 v151, v151, v9
v_cvt_pk_bf16_f32 v152, v128, v129
v_cvt_pk_bf16_f32 v153, v130, v131
v_cvt_pk_bf16_f32 v154, v132, v133
v_cvt_pk_bf16_f32 v155, v134, v135
v_cvt_pk_bf16_f32 v156, v136, v137
v_cvt_pk_bf16_f32 v157, v138, v139
v_cvt_pk_bf16_f32 v158, v140, v141
v_cvt_pk_bf16_f32 v159, v142, v143
v_cvt_pk_bf16_f32 v160, v144, v145
v_cvt_pk_bf16_f32 v161, v146, v147
v_cvt_pk_bf16_f32 v162, v148, v149
v_cvt_pk_bf16_f32 v163, v150, v151
buffer_store_dwordx4 v[152:155], v5, s[16:19], s21 offen offset:0
buffer_store_dwordx4 v[156:159], v5, s[16:19], s21 offen offset:128
buffer_store_dwordx4 v[160:163], v5, s[16:19], s21 offen offset:256
L_end:
s_endpgm
L_f_slow1:
s_mov_b32 s52, 0
L_f_spin1:
buffer_load_dword v13, v11, s[8:11], s34 offen sc1
s_add_u32 s52, s52, 1
s_waitcnt vmcnt(0)
v_cmp_le_u32 vcc, 1, v13
s_cmp_gt_u32 s52, 0x100000
s_cbranch_scc1 L_f_back1
s_cmp_eq_u64 vcc, exec
s_cbranch_scc0 L_f_spin1
s_branch L_f_back1
L_f_slow2:
s_mov_b32 s52, 0
L_f_spin2:
buffer_load_dword v13, v11, s[8:11], s34 offen sc1
s_add_u32 s52, s52, 1
s_waitcnt vmcnt(0)
v_cmp_le_u32 vcc, 2, v13
s_cmp_gt_u32 s52, 0x100000
s_cbranch_scc1 L_f_back2
s_cmp_eq_u64 vcc, exec
s_cbranch_scc0 L_f_spin2
s_branch L_f_back2
L_f_slow3:
s_mov_b32 s52, 0
L_f_spin3:
buffer_load_dword v13, v11, s[8:11], s34 offen sc1
s_add_u32 s52, s52, 1
s_waitcnt vmcnt(0)
v_cmp_le_u32 vcc, 3, v13
s_cmp_gt_u32 s52, 0x100000
s_cbranch_scc1 L_f_back3
s_cmp_eq_u64 vcc, exec
s_cbranch_scc0 L_f_spin3
s_branch L_f_back3
.section .rodata,"a"
.p2align 6
.amdhsa_kernel prep_kernel
  .amdhsa_next_free_vgpr 184
  .amdhsa_next_free_sgpr 102
  .amdhsa_accum_offset 184
  .amdhsa_group_segment_fixed_size 0
  .amdhsa_kernarg_size 80
  .amdhsa_user_sgpr_count 2
  .amdhsa_user_sgpr_kernarg_segment_ptr 1
  .amdhsa_system_sgpr_workgroup_id_x 1
.end_amdhsa_kernel
.p2align 6
.amdhsa_kernel main_kernel
  .amdhsa_next_free_vgpr 512
  .amdhsa_next_free_sgpr 102
  .amdhsa_accum_offset 256
  .amdhsa_group_segment_fixed_size 0
  .amdhsa_kernarg_size 80
  .amdhsa_user_sgpr_count 2
  .amdhsa_user_sgpr_kernarg_segment_ptr 1
  .amdhsa_system_sgpr_workgroup_id_x 1
.end_amdhsa_kernel
```

```asm
; @launch kernel=prep_kernel grid=(258,1,1) block=(256,1,1) lds=1024
; @launch kernel=main_kernel grid=(256,1,1) block=(256,1,1) lds=159744
.amdgcn_target "amdgcn-amd-amdhsa--gfx950"
.text
.p2align 8
.globl prep_kernel
.type prep_kernel,@function
prep_kernel:
s_cmp_ge_u32 s2, 258
s_cbranch_scc1 L_prep_end
s_load_dwordx2 s[12:13], s[0:1], 72
v_and_b32 v1, 63, v0
v_lshrrev_b32 v3, 6, v0
v_lshlrev_b32 v2, 4, v1
v_readfirstlane_b32 s4, v3
s_and_b32 s5, s2, 7
s_lshr_b32 s6, s2, 3
s_waitcnt lgkmcnt(0)
s_mov_b32 s8, s12
s_and_b32 s9, s13, 0xffff
s_mov_b32 s10, 268435456
s_mov_b32 s11, 0x20000
s_cmp_ge_u32 s2, 256
s_cbranch_scc1 L_prep_pack
s_lshl_b32 s20, s2, 13
s_add_u32 s20, s20, 0
v_lshlrev_b32 v4, 7, v1
v_mov_b32 v5, 0
buffer_store_dword v5, v4, s[8:11], s20 offen
s_cmp_eq_u32 s4, 3
s_cbranch_scc1 L_prep_idle
v_and_b32 v6, 7, v1
v_lshrrev_b32 v7, 3, v1
s_mul_i32 s22, s4, 24
v_add_u32 v7, s22, v7
s_and_b32 s23, s6, 1
s_lshl_b32 s23, s23, 3
v_add_u32 v8, s23, v6
v_lshlrev_b32 v8, 4, v8
v_lshl_add_u32 v4, v7, 8, v8
s_lshl_b32 s24, s5, 4
s_lshr_b32 s25, s6, 1
s_add_u32 s24, s24, s25
s_mul_i32 s20, s24, 18432
s_lshl_b32 s24, s5, 8
s_lshl_b32 s25, s6, 3
s_add_u32 s24, s24, s25
s_and_b32 s25, s24, 1023
s_lshl_b32 s25, s25, 1
s_lshr_b32 s24, s24, 10
s_add_u32 s24, s24, s25
s_mul_i32 s21, s24, 1152
v_mul_u32_u24 v8, 2304, v6
v_lshl_add_u32 v5, v7, 4, v8
s_load_dwordx2 s[12:13], s[0:1], 0
s_waitcnt lgkmcnt(0)
s_mov_b32 s16, s12
s_and_b32 s17, s13, 0xffff
s_mov_b32 s18, 2359296
s_mov_b32 s19, 0x20000
buffer_load_dwordx4 v[16:19], v5, s[16:19], s21 offen offset:0
buffer_load_dwordx4 v[20:23], v5, s[16:19], s21 offen offset:128
buffer_load_dwordx4 v[24:27], v5, s[16:19], s21 offen offset:256
s_waitcnt vmcnt(2)
v_lshlrev_b32 v128, 16, v16
v_and_b32 v129, 0xffff0000, v16
v_lshlrev_b32 v130, 16, v17
v_and_b32 v131, 0xffff0000, v17
v_lshlrev_b32 v132, 16, v18
v_and_b32 v133, 0xffff0000, v18
v_lshlrev_b32 v134, 16, v19
v_and_b32 v135, 0xffff0000, v19
s_waitcnt vmcnt(1)
v_lshlrev_b32 v136, 16, v20
v_and_b32 v137, 0xffff0000, v20
v_lshlrev_b32 v138, 16, v21
v_and_b32 v139, 0xffff0000, v21
v_lshlrev_b32 v140, 16, v22
v_and_b32 v141, 0xffff0000, v22
v_lshlrev_b32 v142, 16, v23
v_and_b32 v143, 0xffff0000, v23
s_waitcnt vmcnt(0)
v_lshlrev_b32 v144, 16, v24
v_and_b32 v145, 0xffff0000, v24
v_lshlrev_b32 v146, 16, v25
v_and_b32 v147, 0xffff0000, v25
v_lshlrev_b32 v148, 16, v26
v_and_b32 v149, 0xffff0000, v26
v_lshlrev_b32 v150, 16, v27
v_and_b32 v151, 0xffff0000, v27
s_add_u32 s24, s20, 27975680
s_add_u32 s25, s24, 4096
buffer_store_dwordx4 v[16:19], v4, s[8:11], s24 offen offset:0
buffer_store_dwordx4 v[20:23], v4, s[8:11], s24 offen offset:2048
buffer_store_dwordx4 v[24:27], v4, s[8:11], s25 offen offset:0
v_add_f32 v6, v128, v129
v_mul_f32 v7, v128, v128
v_mul_f32 v9, v129, v129
v_mov_b32 v8, 0
v_add_f32 v6, v6, v130
v_add_f32 v8, v8, v131
v_fmac_f32 v7, v130, v130
v_fmac_f32 v9, v131, v131
v_add_f32 v6, v6, v132
v_add_f32 v8, v8, v133
v_fmac_f32 v7, v132, v132
v_fmac_f32 v9, v133, v133
v_add_f32 v6, v6, v134
v_add_f32 v8, v8, v135
v_fmac_f32 v7, v134, v134
v_fmac_f32 v9, v135, v135
v_add_f32 v6, v6, v136
v_add_f32 v8, v8, v137
v_fmac_f32 v7, v136, v136
v_fmac_f32 v9, v137, v137
v_add_f32 v6, v6, v138
v_add_f32 v8, v8, v139
v_fmac_f32 v7, v138, v138
v_fmac_f32 v9, v139, v139
v_add_f32 v6, v6, v140
v_add_f32 v8, v8, v141
v_fmac_f32 v7, v140, v140
v_fmac_f32 v9, v141, v141
v_add_f32 v6, v6, v142
v_add_f32 v8, v8, v143
v_fmac_f32 v7, v142, v142
v_fmac_f32 v9, v143, v143
v_add_f32 v6, v6, v144
v_add_f32 v8, v8, v145
v_fmac_f32 v7, v144, v144
v_fmac_f32 v9, v145, v145
v_add_f32 v6, v6, v146
v_add_f32 v8, v8, v147
v_fmac_f32 v7, v146, v146
v_fmac_f32 v9, v147, v147
v_add_f32 v6, v6, v148
v_add_f32 v8, v8, v149
v_fmac_f32 v7, v148, v148
v_fmac_f32 v9, v149, v149
v_add_f32 v6, v6, v150
v_add_f32 v8, v8, v151
v_fmac_f32 v7, v150, v150
v_fmac_f32 v9, v151, v151
v_add_f32 v6, v6, v8
v_add_f32 v7, v7, v9
s_nop 0
v_add_f32_dpp v6, v6, v6 row_ror:8 row_mask:0xf bank_mask:0xf
v_add_f32_dpp v7, v7, v7 row_ror:8 row_mask:0xf bank_mask:0xf
v_mov_b32 v8, v6
v_mov_b32 v9, v7
s_nop 0
v_permlane16_swap_b32 v6, v8
v_permlane16_swap_b32 v7, v9
v_add_f32 v6, v6, v8
v_add_f32 v7, v7, v9
v_mov_b32 v8, v6
v_mov_b32 v9, v7
s_nop 0
v_permlane32_swap_b32 v6, v8
v_permlane32_swap_b32 v7, v9
v_add_f32 v6, v6, v8
v_add_f32 v7, v7, v9
v_and_b32 v10, 7, v1
v_lshlrev_b32 v10, 3, v10
v_add_u32 v10, 0, v10
s_lshl_b32 s24, s4, 6
v_add_u32 v11, s24, v10
ds_write_b64 v11, v[6:7]
s_waitcnt lgkmcnt(0)
s_barrier
ds_read_b64 v[6:7], v10
ds_read_b64 v[8:9], v10 offset:64
ds_read_b64 v[12:13], v10 offset:128
s_waitcnt lgkmcnt(0)
v_add_f32 v6, v6, v8
v_add_f32 v7, v7, v9
v_add_f32 v6, v6, v12
v_add_f32 v7, v7, v13
v_mul_f32 v6, 0x3ae38e39, v6
v_mul_f32 v7, 0x3ae38e39, v7
v_fma_f32 v7, -v6, v6, v7
v_max_f32 v7, 0, v7
v_add_f32 v7, 0x3727c5ac, v7
v_rsq_f32 v7, v7
s_nop 0
v_mul_f32 v6, v6, v7
v_fma_f32 v128, v128, v7, -v6
v_fma_f32 v129, v129, v7, -v6
v_fma_f32 v130, v130, v7, -v6
v_fma_f32 v131, v131, v7, -v6
v_fma_f32 v132, v132, v7, -v6
v_fma_f32 v133, v133, v7, -v6
v_fma_f32 v134, v134, v7, -v6
v_fma_f32 v135, v135, v7, -v6
v_fma_f32 v136, v136, v7, -v6
v_fma_f32 v137, v137, v7, -v6
v_fma_f32 v138, v138, v7, -v6
v_fma_f32 v139, v139, v7, -v6
v_fma_f32 v140, v140, v7, -v6
v_fma_f32 v141, v141, v7, -v6
v_fma_f32 v142, v142, v7, -v6
v_fma_f32 v143, v143, v7, -v6
v_fma_f32 v144, v144, v7, -v6
v_fma_f32 v145, v145, v7, -v6
v_fma_f32 v146, v146, v7, -v6
v_fma_f32 v147, v147, v7, -v6
v_fma_f32 v148, v148, v7, -v6
v_fma_f32 v149, v149, v7, -v6
v_fma_f32 v150, v150, v7, -v6
v_fma_f32 v151, v151, v7, -v6
v_cvt_pk_bf16_f32 v168, v128, v129
v_cvt_pk_bf16_f32 v169, v130, v131
v_cvt_pk_bf16_f32 v170, v132, v133
v_cvt_pk_bf16_f32 v171, v134, v135
v_cvt_pk_bf16_f32 v172, v136, v137
v_cvt_pk_bf16_f32 v173, v138, v139
v_cvt_pk_bf16_f32 v174, v140, v141
v_cvt_pk_bf16_f32 v175, v142, v143
v_cvt_pk_bf16_f32 v176, v144, v145
v_cvt_pk_bf16_f32 v177, v146, v147
v_cvt_pk_bf16_f32 v178, v148, v149
v_cvt_pk_bf16_f32 v179, v150, v151
s_add_u32 s24, s20, 23257088
s_add_u32 s25, s24, 4096
buffer_store_dwordx4 v[168:171], v4, s[8:11], s24 offen offset:0
buffer_store_dwordx4 v[172:175], v4, s[8:11], s24 offen offset:2048
buffer_store_dwordx4 v[176:179], v4, s[8:11], s25 offen offset:0
s_branch L_prep_pack
L_prep_idle:
s_lshl_b32 s20, s6, 22
v_lshlrev_b32 v4, 16, v1
buffer_load_dword v5, v4, s[8:11], s20 offen
s_barrier
L_prep_pack:
s_waitcnt vmcnt(0)
s_lshl_b32 s20, s2, 2
s_add_u32 s20, s20, s4
v_and_b32 v6, 15, v1
v_lshrrev_b32 v7, 4, v1
v_lshrrev_b32 v8, 2, v6
v_and_b32 v9, 3, v6
v_lshl_add_u32 v10, v8, 3, v9
s_cmp_ge_u32 s20, 992
s_cbranch_scc1 L_pack_o
s_cmp_ge_u32 s20, 864
s_cbranch_scc1 L_pack_q
s_cmp_ge_u32 s20, 576
s_cbranch_scc1 L_pack_d
s_mul_i32 s21, s2, 911
s_lshr_b32 s21, s21, 16
s_mul_i32 s22, s21, 72
s_sub_u32 s22, s2, s22
s_mul_i32 s23, s22, 7282
s_lshr_b32 s23, s23, 16
s_mul_i32 s24, s23, 9
s_sub_u32 s24, s22, s24
s_lshl_b32 s24, s24, 2
s_add_u32 s24, s24, s4
s_load_dwordx4 s[36:39], s[0:1], 32
s_waitcnt lgkmcnt(0)
s_cmp_eq_u32 s21, 0
s_cselect_b64 s[12:13], s[36:37], s[38:39]
s_mov_b32 s16, s12
s_and_b32 s17, s13, 0xffff
s_mov_b32 s18, 5308416
s_mov_b32 s19, 0x20000
s_lshr_b32 s26, s24, 1
s_lshl_b32 s26, s26, 5
s_and_b32 s27, s24, 1
s_lshl_b32 s27, s27, 2
s_add_u32 s26, s26, s27
s_mul_i32 s27, s23, 576
s_add_u32 s26, s26, s27
v_add_u32 v11, s26, v10
v_lshlrev_b32 v11, 1, v11
v_mul_u32_u24 v12, 73728, v7
v_add_u32 v4, v11, v12
s_mul_i32 s27, s24, 7282
s_lshr_b32 s27, s27, 16
s_mul_i32 s28, s27, 9
s_sub_u32 s28, s24, s28
s_add_u32 s29, s28, 1
s_cmp_eq_u32 s29, 9
s_cselect_b32 s29, 0, s29
s_and_b32 s30, s27, 1
s_cmp_eq_u32 s30, 0
s_cselect_b32 s28, s29, s28
s_lshl_b32 s29, s23, 2
s_add_u32 s29, s29, s27
s_mul_i32 s29, s29, 497664
s_mul_i32 s30, s28, 36864
s_lshl_b32 s33, s28, 12
s_cmp_lt_u32 s28, 2
s_cselect_b32 s30, s33, s30
s_cselect_b32 s32, 2, 1
s_lshl_b32 s32, s32, 12
s_add_u32 s29, s29, s30
s_lshl_b32 s21, s21, 11
s_add_u32 s29, s29, s21
s_add_u32 s29, s29, 7299072
s_mov_b32 s40, 0
buffer_load_ushort v16, v4, s[16:19], s40 offen
s_mov_b32 s40, 9216
buffer_load_ushort v17, v4, s[16:19], s40 offen
s_mov_b32 s40, 18432
buffer_load_ushort v18, v4, s[16:19], s40 offen
s_mov_b32 s40, 27648
buffer_load_ushort v19, v4, s[16:19], s40 offen
s_mov_b32 s40, 36864
buffer_load_ushort v20, v4, s[16:19], s40 offen
s_mov_b32 s40, 46080
buffer_load_ushort v21, v4, s[16:19], s40 offen
s_mov_b32 s40, 55296
buffer_load_ushort v22, v4, s[16:19], s40 offen
s_mov_b32 s40, 64512
buffer_load_ushort v23, v4, s[16:19], s40 offen
s_mov_b32 s40, 294912
buffer_load_ushort v24, v4, s[16:19], s40 offen
s_mov_b32 s40, 304128
buffer_load_ushort v25, v4, s[16:19], s40 offen
s_mov_b32 s40, 313344
buffer_load_ushort v26, v4, s[16:19], s40 offen
s_mov_b32 s40, 322560
buffer_load_ushort v27, v4, s[16:19], s40 offen
s_mov_b32 s40, 331776
buffer_load_ushort v28, v4, s[16:19], s40 offen
s_mov_b32 s40, 340992
buffer_load_ushort v29, v4, s[16:19], s40 offen
s_mov_b32 s40, 350208
buffer_load_ushort v30, v4, s[16:19], s40 offen
s_mov_b32 s40, 359424
buffer_load_ushort v31, v4, s[16:19], s40 offen
s_mov_b32 s40, 589824
buffer_load_ushort v32, v4, s[16:19], s40 offen
s_mov_b32 s40, 599040
buffer_load_ushort v33, v4, s[16:19], s40 offen
s_mov_b32 s40, 608256
buffer_load_ushort v34, v4, s[16:19], s40 offen
s_mov_b32 s40, 617472
buffer_load_ushort v35, v4, s[16:19], s40 offen
s_mov_b32 s40, 626688
buffer_load_ushort v36, v4, s[16:19], s40 offen
s_mov_b32 s40, 635904
buffer_load_ushort v37, v4, s[16:19], s40 offen
s_mov_b32 s40, 645120
buffer_load_ushort v38, v4, s[16:19], s40 offen
s_mov_b32 s40, 654336
buffer_load_ushort v39, v4, s[16:19], s40 offen
s_mov_b32 s40, 884736
buffer_load_ushort v40, v4, s[16:19], s40 offen
s_mov_b32 s40, 893952
buffer_load_ushort v41, v4, s[16:19], s40 offen
s_mov_b32 s40, 903168
buffer_load_ushort v42, v4, s[16:19], s40 offen
s_mov_b32 s40, 912384
buffer_load_ushort v43, v4, s[16:19], s40 offen
s_mov_b32 s40, 921600
buffer_load_ushort v44, v4, s[16:19], s40 offen
s_mov_b32 s40, 930816
buffer_load_ushort v45, v4, s[16:19], s40 offen
s_mov_b32 s40, 940032
buffer_load_ushort v46, v4, s[16:19], s40 offen
s_mov_b32 s40, 949248
buffer_load_ushort v47, v4, s[16:19], s40 offen
s_mov_b32 s40, 1179648
buffer_load_ushort v48, v4, s[16:19], s40 offen
s_mov_b32 s40, 1188864
buffer_load_ushort v49, v4, s[16:19], s40 offen
s_mov_b32 s40, 1198080
buffer_load_ushort v50, v4, s[16:19], s40 offen
s_mov_b32 s40, 1207296
buffer_load_ushort v51, v4, s[16:19], s40 offen
s_mov_b32 s40, 1216512
buffer_load_ushort v52, v4, s[16:19], s40 offen
s_mov_b32 s40, 1225728
buffer_load_ushort v53, v4, s[16:19], s40 offen
s_mov_b32 s40, 1234944
buffer_load_ushort v54, v4, s[16:19], s40 offen
s_mov_b32 s40, 1244160
buffer_load_ushort v55, v4, s[16:19], s40 offen
s_mov_b32 s40, 1474560
buffer_load_ushort v56, v4, s[16:19], s40 offen
s_mov_b32 s40, 1483776
buffer_load_ushort v57, v4, s[16:19], s40 offen
s_mov_b32 s40, 1492992
buffer_load_ushort v58, v4, s[16:19], s40 offen
s_mov_b32 s40, 1502208
buffer_load_ushort v59, v4, s[16:19], s40 offen
s_mov_b32 s40, 1511424
buffer_load_ushort v60, v4, s[16:19], s40 offen
s_mov_b32 s40, 1520640
buffer_load_ushort v61, v4, s[16:19], s40 offen
s_mov_b32 s40, 1529856
buffer_load_ushort v62, v4, s[16:19], s40 offen
s_mov_b32 s40, 1539072
buffer_load_ushort v63, v4, s[16:19], s40 offen
s_waitcnt vmcnt(40)
v_lshl_or_b32 v80, v17, 16, v16
v_lshl_or_b32 v81, v19, 16, v18
v_lshl_or_b32 v82, v21, 16, v20
v_lshl_or_b32 v83, v23, 16, v22
s_waitcnt vmcnt(32)
v_lshl_or_b32 v84, v25, 16, v24
v_lshl_or_b32 v85, v27, 16, v26
v_lshl_or_b32 v86, v29, 16, v28
v_lshl_or_b32 v87, v31, 16, v30
s_waitcnt vmcnt(24)
v_lshl_or_b32 v88, v33, 16, v32
v_lshl_or_b32 v89, v35, 16, v34
v_lshl_or_b32 v90, v37, 16, v36
v_lshl_or_b32 v91, v39, 16, v38
s_waitcnt vmcnt(16)
v_lshl_or_b32 v92, v41, 16, v40
v_lshl_or_b32 v93, v43, 16, v42
v_lshl_or_b32 v94, v45, 16, v44
v_lshl_or_b32 v95, v47, 16, v46
s_waitcnt vmcnt(8)
v_lshl_or_b32 v96, v49, 16, v48
v_lshl_or_b32 v97, v51, 16, v50
v_lshl_or_b32 v98, v53, 16, v52
v_lshl_or_b32 v99, v55, 16, v54
s_waitcnt vmcnt(0)
v_lshl_or_b32 v100, v57, 16, v56
v_lshl_or_b32 v101, v59, 16, v58
v_lshl_or_b32 v102, v61, 16, v60
v_lshl_or_b32 v103, v63, 16, v62
s_mov_b32 s40, 1769472
buffer_load_ushort v16, v4, s[16:19], s40 offen
s_mov_b32 s40, 1778688
buffer_load_ushort v17, v4, s[16:19], s40 offen
s_mov_b32 s40, 1787904
buffer_load_ushort v18, v4, s[16:19], s40 offen
s_mov_b32 s40, 1797120
buffer_load_ushort v19, v4, s[16:19], s40 offen
s_mov_b32 s40, 1806336
buffer_load_ushort v20, v4, s[16:19], s40 offen
s_mov_b32 s40, 1815552
buffer_load_ushort v21, v4, s[16:19], s40 offen
s_mov_b32 s40, 1824768
buffer_load_ushort v22, v4, s[16:19], s40 offen
s_mov_b32 s40, 1833984
buffer_load_ushort v23, v4, s[16:19], s40 offen
s_mov_b32 s40, 2064384
buffer_load_ushort v24, v4, s[16:19], s40 offen
s_mov_b32 s40, 2073600
buffer_load_ushort v25, v4, s[16:19], s40 offen
s_mov_b32 s40, 2082816
buffer_load_ushort v26, v4, s[16:19], s40 offen
s_mov_b32 s40, 2092032
buffer_load_ushort v27, v4, s[16:19], s40 offen
s_mov_b32 s40, 2101248
buffer_load_ushort v28, v4, s[16:19], s40 offen
s_mov_b32 s40, 2110464
buffer_load_ushort v29, v4, s[16:19], s40 offen
s_mov_b32 s40, 2119680
buffer_load_ushort v30, v4, s[16:19], s40 offen
s_mov_b32 s40, 2128896
buffer_load_ushort v31, v4, s[16:19], s40 offen
s_mov_b32 s40, 2359296
buffer_load_ushort v32, v4, s[16:19], s40 offen
s_mov_b32 s40, 2368512
buffer_load_ushort v33, v4, s[16:19], s40 offen
s_mov_b32 s40, 2377728
buffer_load_ushort v34, v4, s[16:19], s40 offen
s_mov_b32 s40, 2386944
buffer_load_ushort v35, v4, s[16:19], s40 offen
s_mov_b32 s40, 2396160
buffer_load_ushort v36, v4, s[16:19], s40 offen
s_mov_b32 s40, 2405376
buffer_load_ushort v37, v4, s[16:19], s40 offen
s_mov_b32 s40, 2414592
buffer_load_ushort v38, v4, s[16:19], s40 offen
s_mov_b32 s40, 2423808
buffer_load_ushort v39, v4, s[16:19], s40 offen
s_mov_b32 s40, 2654208
buffer_load_ushort v40, v4, s[16:19], s40 offen
s_mov_b32 s40, 2663424
buffer_load_ushort v41, v4, s[16:19], s40 offen
s_mov_b32 s40, 2672640
buffer_load_ushort v42, v4, s[16:19], s40 offen
s_mov_b32 s40, 2681856
buffer_load_ushort v43, v4, s[16:19], s40 offen
s_mov_b32 s40, 2691072
buffer_load_ushort v44, v4, s[16:19], s40 offen
s_mov_b32 s40, 2700288
buffer_load_ushort v45, v4, s[16:19], s40 offen
s_mov_b32 s40, 2709504
buffer_load_ushort v46, v4, s[16:19], s40 offen
s_mov_b32 s40, 2718720
buffer_load_ushort v47, v4, s[16:19], s40 offen
s_mov_b32 s40, 2949120
buffer_load_ushort v48, v4, s[16:19], s40 offen
s_mov_b32 s40, 2958336
buffer_load_ushort v49, v4, s[16:19], s40 offen
s_mov_b32 s40, 2967552
buffer_load_ushort v50, v4, s[16:19], s40 offen
s_mov_b32 s40, 2976768
buffer_load_ushort v51, v4, s[16:19], s40 offen
s_mov_b32 s40, 2985984
buffer_load_ushort v52, v4, s[16:19], s40 offen
s_mov_b32 s40, 2995200
buffer_load_ushort v53, v4, s[16:19], s40 offen
s_mov_b32 s40, 3004416
buffer_load_ushort v54, v4, s[16:19], s40 offen
s_mov_b32 s40, 3013632
buffer_load_ushort v55, v4, s[16:19], s40 offen
s_mov_b32 s40, 3244032
buffer_load_ushort v56, v4, s[16:19], s40 offen
s_mov_b32 s40, 3253248
buffer_load_ushort v57, v4, s[16:19], s40 offen
s_mov_b32 s40, 3262464
buffer_load_ushort v58, v4, s[16:19], s40 offen
s_mov_b32 s40, 3271680
buffer_load_ushort v59, v4, s[16:19], s40 offen
s_mov_b32 s40, 3280896
buffer_load_ushort v60, v4, s[16:19], s40 offen
s_mov_b32 s40, 3290112
buffer_load_ushort v61, v4, s[16:19], s40 offen
s_mov_b32 s40, 3299328
buffer_load_ushort v62, v4, s[16:19], s40 offen
s_mov_b32 s40, 3308544
buffer_load_ushort v63, v4, s[16:19], s40 offen
s_waitcnt vmcnt(40)
v_lshl_or_b32 v104, v17, 16, v16
v_lshl_or_b32 v105, v19, 16, v18
v_lshl_or_b32 v106, v21, 16, v20
v_lshl_or_b32 v107, v23, 16, v22
s_waitcnt vmcnt(32)
v_lshl_or_b32 v108, v25, 16, v24
v_lshl_or_b32 v109, v27, 16, v26
v_lshl_or_b32 v110, v29, 16, v28
v_lshl_or_b32 v111, v31, 16, v30
s_waitcnt vmcnt(24)
v_lshl_or_b32 v112, v33, 16, v32
v_lshl_or_b32 v113, v35, 16, v34
v_lshl_or_b32 v114, v37, 16, v36
v_lshl_or_b32 v115, v39, 16, v38
s_waitcnt vmcnt(16)
v_lshl_or_b32 v116, v41, 16, v40
v_lshl_or_b32 v117, v43, 16, v42
v_lshl_or_b32 v118, v45, 16, v44
v_lshl_or_b32 v119, v47, 16, v46
s_waitcnt vmcnt(8)
v_lshl_or_b32 v120, v49, 16, v48
v_lshl_or_b32 v121, v51, 16, v50
v_lshl_or_b32 v122, v53, 16, v52
v_lshl_or_b32 v123, v55, 16, v54
s_waitcnt vmcnt(0)
v_lshl_or_b32 v124, v57, 16, v56
v_lshl_or_b32 v125, v59, 16, v58
v_lshl_or_b32 v126, v61, 16, v60
v_lshl_or_b32 v127, v63, 16, v62
s_mov_b32 s40, 3538944
buffer_load_ushort v16, v4, s[16:19], s40 offen
s_mov_b32 s40, 3548160
buffer_load_ushort v17, v4, s[16:19], s40 offen
s_mov_b32 s40, 3557376
buffer_load_ushort v18, v4, s[16:19], s40 offen
s_mov_b32 s40, 3566592
buffer_load_ushort v19, v4, s[16:19], s40 offen
s_mov_b32 s40, 3575808
buffer_load_ushort v20, v4, s[16:19], s40 offen
s_mov_b32 s40, 3585024
buffer_load_ushort v21, v4, s[16:19], s40 offen
s_mov_b32 s40, 3594240
buffer_load_ushort v22, v4, s[16:19], s40 offen
s_mov_b32 s40, 3603456
buffer_load_ushort v23, v4, s[16:19], s40 offen
s_mov_b32 s40, 3833856
buffer_load_ushort v24, v4, s[16:19], s40 offen
s_mov_b32 s40, 3843072
buffer_load_ushort v25, v4, s[16:19], s40 offen
s_mov_b32 s40, 3852288
buffer_load_ushort v26, v4, s[16:19], s40 offen
s_mov_b32 s40, 3861504
buffer_load_ushort v27, v4, s[16:19], s40 offen
s_mov_b32 s40, 3870720
buffer_load_ushort v28, v4, s[16:19], s40 offen
s_mov_b32 s40, 3879936
buffer_load_ushort v29, v4, s[16:19], s40 offen
s_mov_b32 s40, 3889152
buffer_load_ushort v30, v4, s[16:19], s40 offen
s_mov_b32 s40, 3898368
buffer_load_ushort v31, v4, s[16:19], s40 offen
s_mov_b32 s40, 4128768
buffer_load_ushort v32, v4, s[16:19], s40 offen
s_mov_b32 s40, 4137984
buffer_load_ushort v33, v4, s[16:19], s40 offen
s_mov_b32 s40, 4147200
buffer_load_ushort v34, v4, s[16:19], s40 offen
s_mov_b32 s40, 4156416
buffer_load_ushort v35, v4, s[16:19], s40 offen
s_mov_b32 s40, 4165632
buffer_load_ushort v36, v4, s[16:19], s40 offen
s_mov_b32 s40, 4174848
buffer_load_ushort v37, v4, s[16:19], s40 offen
s_mov_b32 s40, 4184064
buffer_load_ushort v38, v4, s[16:19], s40 offen
s_mov_b32 s40, 4193280
buffer_load_ushort v39, v4, s[16:19], s40 offen
s_mov_b32 s40, 4423680
buffer_load_ushort v40, v4, s[16:19], s40 offen
s_mov_b32 s40, 4432896
buffer_load_ushort v41, v4, s[16:19], s40 offen
s_mov_b32 s40, 4442112
buffer_load_ushort v42, v4, s[16:19], s40 offen
s_mov_b32 s40, 4451328
buffer_load_ushort v43, v4, s[16:19], s40 offen
s_mov_b32 s40, 4460544
buffer_load_ushort v44, v4, s[16:19], s40 offen
s_mov_b32 s40, 4469760
buffer_load_ushort v45, v4, s[16:19], s40 offen
s_mov_b32 s40, 4478976
buffer_load_ushort v46, v4, s[16:19], s40 offen
s_mov_b32 s40, 4488192
buffer_load_ushort v47, v4, s[16:19], s40 offen
s_mov_b32 s40, 4718592
buffer_load_ushort v48, v4, s[16:19], s40 offen
s_mov_b32 s40, 4727808
buffer_load_ushort v49, v4, s[16:19], s40 offen
s_mov_b32 s40, 4737024
buffer_load_ushort v50, v4, s[16:19], s40 offen
s_mov_b32 s40, 4746240
buffer_load_ushort v51, v4, s[16:19], s40 offen
s_mov_b32 s40, 4755456
buffer_load_ushort v52, v4, s[16:19], s40 offen
s_mov_b32 s40, 4764672
buffer_load_ushort v53, v4, s[16:19], s40 offen
s_mov_b32 s40, 4773888
buffer_load_ushort v54, v4, s[16:19], s40 offen
s_mov_b32 s40, 4783104
buffer_load_ushort v55, v4, s[16:19], s40 offen
s_mov_b32 s40, 5013504
buffer_load_ushort v56, v4, s[16:19], s40 offen
s_mov_b32 s40, 5022720
buffer_load_ushort v57, v4, s[16:19], s40 offen
s_mov_b32 s40, 5031936
buffer_load_ushort v58, v4, s[16:19], s40 offen
s_mov_b32 s40, 5041152
buffer_load_ushort v59, v4, s[16:19], s40 offen
s_mov_b32 s40, 5050368
buffer_load_ushort v60, v4, s[16:19], s40 offen
s_mov_b32 s40, 5059584
buffer_load_ushort v61, v4, s[16:19], s40 offen
s_mov_b32 s40, 5068800
buffer_load_ushort v62, v4, s[16:19], s40 offen
s_mov_b32 s40, 5078016
buffer_load_ushort v63, v4, s[16:19], s40 offen
s_waitcnt vmcnt(40)
v_lshl_or_b32 v128, v17, 16, v16
v_lshl_or_b32 v129, v19, 16, v18
v_lshl_or_b32 v130, v21, 16, v20
v_lshl_or_b32 v131, v23, 16, v22
s_waitcnt vmcnt(32)
v_lshl_or_b32 v132, v25, 16, v24
v_lshl_or_b32 v133, v27, 16, v26
v_lshl_or_b32 v134, v29, 16, v28
v_lshl_or_b32 v135, v31, 16, v30
s_waitcnt vmcnt(24)
v_lshl_or_b32 v136, v33, 16, v32
v_lshl_or_b32 v137, v35, 16, v34
v_lshl_or_b32 v138, v37, 16, v36
v_lshl_or_b32 v139, v39, 16, v38
s_waitcnt vmcnt(16)
v_lshl_or_b32 v140, v41, 16, v40
v_lshl_or_b32 v141, v43, 16, v42
v_lshl_or_b32 v142, v45, 16, v44
v_lshl_or_b32 v143, v47, 16, v46
s_waitcnt vmcnt(8)
v_lshl_or_b32 v144, v49, 16, v48
v_lshl_or_b32 v145, v51, 16, v50
v_lshl_or_b32 v146, v53, 16, v52
v_lshl_or_b32 v147, v55, 16, v54
s_waitcnt vmcnt(0)
v_lshl_or_b32 v148, v57, 16, v56
v_lshl_or_b32 v149, v59, 16, v58
v_lshl_or_b32 v150, v61, 16, v60
v_lshl_or_b32 v151, v63, 16, v62
s_mov_b32 s31, 0x3f803f80
v_mov_b32 v12, 0
v_mov_b32 v13, 0
v_dot2_f32_bf16 v12, v80, s31, v12
v_dot2_f32_bf16 v13, v81, s31, v13
v_dot2_f32_bf16 v12, v82, s31, v12
v_dot2_f32_bf16 v13, v83, s31, v13
v_dot2_f32_bf16 v12, v84, s31, v12
v_dot2_f32_bf16 v13, v85, s31, v13
v_dot2_f32_bf16 v12, v86, s31, v12
v_dot2_f32_bf16 v13, v87, s31, v13
v_dot2_f32_bf16 v12, v88, s31, v12
v_dot2_f32_bf16 v13, v89, s31, v13
v_dot2_f32_bf16 v12, v90, s31, v12
v_dot2_f32_bf16 v13, v91, s31, v13
v_dot2_f32_bf16 v12, v92, s31, v12
v_dot2_f32_bf16 v13, v93, s31, v13
v_dot2_f32_bf16 v12, v94, s31, v12
v_dot2_f32_bf16 v13, v95, s31, v13
v_dot2_f32_bf16 v12, v96, s31, v12
v_dot2_f32_bf16 v13, v97, s31, v13
v_dot2_f32_bf16 v12, v98, s31, v12
v_dot2_f32_bf16 v13, v99, s31, v13
v_dot2_f32_bf16 v12, v100, s31, v12
v_dot2_f32_bf16 v13, v101, s31, v13
v_dot2_f32_bf16 v12, v102, s31, v12
v_dot2_f32_bf16 v13, v103, s31, v13
v_dot2_f32_bf16 v12, v104, s31, v12
v_dot2_f32_bf16 v13, v105, s31, v13
v_dot2_f32_bf16 v12, v106, s31, v12
v_dot2_f32_bf16 v13, v107, s31, v13
v_dot2_f32_bf16 v12, v108, s31, v12
v_dot2_f32_bf16 v13, v109, s31, v13
v_dot2_f32_bf16 v12, v110, s31, v12
v_dot2_f32_bf16 v13, v111, s31, v13
v_dot2_f32_bf16 v12, v112, s31, v12
v_dot2_f32_bf16 v13, v113, s31, v13
v_dot2_f32_bf16 v12, v114, s31, v12
v_dot2_f32_bf16 v13, v115, s31, v13
v_dot2_f32_bf16 v12, v116, s31, v12
v_dot2_f32_bf16 v13, v117, s31, v13
v_dot2_f32_bf16 v12, v118, s31, v12
v_dot2_f32_bf16 v13, v119, s31, v13
v_dot2_f32_bf16 v12, v120, s31, v12
v_dot2_f32_bf16 v13, v121, s31, v13
v_dot2_f32_bf16 v12, v122, s31, v12
v_dot2_f32_bf16 v13, v123, s31, v13
v_dot2_f32_bf16 v12, v124, s31, v12
v_dot2_f32_bf16 v13, v125, s31, v13
v_dot2_f32_bf16 v12, v126, s31, v12
v_dot2_f32_bf16 v13, v127, s31, v13
v_dot2_f32_bf16 v12, v128, s31, v12
v_dot2_f32_bf16 v13, v129, s31, v13
v_dot2_f32_bf16 v12, v130, s31, v12
v_dot2_f32_bf16 v13, v131, s31, v13
v_dot2_f32_bf16 v12, v132, s31, v12
v_dot2_f32_bf16 v13, v133, s31, v13
v_dot2_f32_bf16 v12, v134, s31, v12
v_dot2_f32_bf16 v13, v135, s31, v13
v_dot2_f32_bf16 v12, v136, s31, v12
v_dot2_f32_bf16 v13, v137, s31, v13
v_dot2_f32_bf16 v12, v138, s31, v12
v_dot2_f32_bf16 v13, v139, s31, v13
v_dot2_f32_bf16 v12, v140, s31, v12
v_dot2_f32_bf16 v13, v141, s31, v13
v_dot2_f32_bf16 v12, v142, s31, v12
v_dot2_f32_bf16 v13, v143, s31, v13
v_dot2_f32_bf16 v12, v144, s31, v12
v_dot2_f32_bf16 v13, v145, s31, v13
v_dot2_f32_bf16 v12, v146, s31, v12
v_dot2_f32_bf16 v13, v147, s31, v13
v_dot2_f32_bf16 v12, v148, s31, v12
v_dot2_f32_bf16 v13, v149, s31, v13
v_dot2_f32_bf16 v12, v150, s31, v12
v_dot2_f32_bf16 v13, v151, s31, v13
s_nop 2
v_add_f32 v12, v12, v13
v_mov_b32 v13, v12
s_nop 1
v_permlane16_swap_b32 v12, v13
v_add_f32 v12, v12, v13
v_mov_b32 v13, v12
s_nop 1
v_permlane32_swap_b32 v12, v13
v_add_f32 v12, v12, v13
v_mul_f32 v12, 0x3ae38e39, v12
v_lshlrev_b32 v16, 16, v80
v_and_b32 v17, 0xffff0000, v80
v_sub_f32 v16, v16, v12
v_sub_f32 v17, v17, v12
v_cvt_pk_bf16_f32 v80, v16, v17
v_lshlrev_b32 v18, 16, v81
v_and_b32 v19, 0xffff0000, v81
v_sub_f32 v18, v18, v12
v_sub_f32 v19, v19, v12
v_cvt_pk_bf16_f32 v81, v18, v19
v_lshlrev_b32 v20, 16, v82
v_and_b32 v21, 0xffff0000, v82
v_sub_f32 v20, v20, v12
v_sub_f32 v21, v21, v12
v_cvt_pk_bf16_f32 v82, v20, v21
v_lshlrev_b32 v22, 16, v83
v_and_b32 v23, 0xffff0000, v83
v_sub_f32 v22, v22, v12
v_sub_f32 v23, v23, v12
v_cvt_pk_bf16_f32 v83, v22, v23
v_lshlrev_b32 v16, 16, v84
v_and_b32 v17, 0xffff0000, v84
v_sub_f32 v16, v16, v12
v_sub_f32 v17, v17, v12
v_cvt_pk_bf16_f32 v84, v16, v17
v_lshlrev_b32 v18, 16, v85
v_and_b32 v19, 0xffff0000, v85
v_sub_f32 v18, v18, v12
v_sub_f32 v19, v19, v12
v_cvt_pk_bf16_f32 v85, v18, v19
v_lshlrev_b32 v20, 16, v86
v_and_b32 v21, 0xffff0000, v86
v_sub_f32 v20, v20, v12
v_sub_f32 v21, v21, v12
v_cvt_pk_bf16_f32 v86, v20, v21
v_lshlrev_b32 v22, 16, v87
v_and_b32 v23, 0xffff0000, v87
v_sub_f32 v22, v22, v12
v_sub_f32 v23, v23, v12
v_cvt_pk_bf16_f32 v87, v22, v23
v_lshlrev_b32 v16, 16, v88
v_and_b32 v17, 0xffff0000, v88
v_sub_f32 v16, v16, v12
v_sub_f32 v17, v17, v12
v_cvt_pk_bf16_f32 v88, v16, v17
v_lshlrev_b32 v18, 16, v89
v_and_b32 v19, 0xffff0000, v89
v_sub_f32 v18, v18, v12
v_sub_f32 v19, v19, v12
v_cvt_pk_bf16_f32 v89, v18, v19
v_lshlrev_b32 v20, 16, v90
v_and_b32 v21, 0xffff0000, v90
v_sub_f32 v20, v20, v12
v_sub_f32 v21, v21, v12
v_cvt_pk_bf16_f32 v90, v20, v21
v_lshlrev_b32 v22, 16, v91
v_and_b32 v23, 0xffff0000, v91
v_sub_f32 v22, v22, v12
v_sub_f32 v23, v23, v12
v_cvt_pk_bf16_f32 v91, v22, v23
v_lshlrev_b32 v16, 16, v92
v_and_b32 v17, 0xffff0000, v92
v_sub_f32 v16, v16, v12
v_sub_f32 v17, v17, v12
v_cvt_pk_bf16_f32 v92, v16, v17
v_lshlrev_b32 v18, 16, v93
v_and_b32 v19, 0xffff0000, v93
v_sub_f32 v18, v18, v12
v_sub_f32 v19, v19, v12
v_cvt_pk_bf16_f32 v93, v18, v19
v_lshlrev_b32 v20, 16, v94
v_and_b32 v21, 0xffff0000, v94
v_sub_f32 v20, v20, v12
v_sub_f32 v21, v21, v12
v_cvt_pk_bf16_f32 v94, v20, v21
v_lshlrev_b32 v22, 16, v95
v_and_b32 v23, 0xffff0000, v95
v_sub_f32 v22, v22, v12
v_sub_f32 v23, v23, v12
v_cvt_pk_bf16_f32 v95, v22, v23
v_lshlrev_b32 v16, 16, v96
v_and_b32 v17, 0xffff0000, v96
v_sub_f32 v16, v16, v12
v_sub_f32 v17, v17, v12
v_cvt_pk_bf16_f32 v96, v16, v17
v_lshlrev_b32 v18, 16, v97
v_and_b32 v19, 0xffff0000, v97
v_sub_f32 v18, v18, v12
v_sub_f32 v19, v19, v12
v_cvt_pk_bf16_f32 v97, v18, v19
v_lshlrev_b32 v20, 16, v98
v_and_b32 v21, 0xffff0000, v98
v_sub_f32 v20, v20, v12
v_sub_f32 v21, v21, v12
v_cvt_pk_bf16_f32 v98, v20, v21
v_lshlrev_b32 v22, 16, v99
v_and_b32 v23, 0xffff0000, v99
v_sub_f32 v22, v22, v12
v_sub_f32 v23, v23, v12
v_cvt_pk_bf16_f32 v99, v22, v23
v_lshlrev_b32 v16, 16, v100
v_and_b32 v17, 0xffff0000, v100
v_sub_f32 v16, v16, v12
v_sub_f32 v17, v17, v12
v_cvt_pk_bf16_f32 v100, v16, v17
v_lshlrev_b32 v18, 16, v101
v_and_b32 v19, 0xffff0000, v101
v_sub_f32 v18, v18, v12
v_sub_f32 v19, v19, v12
v_cvt_pk_bf16_f32 v101, v18, v19
v_lshlrev_b32 v20, 16, v102
v_and_b32 v21, 0xffff0000, v102
v_sub_f32 v20, v20, v12
v_sub_f32 v21, v21, v12
v_cvt_pk_bf16_f32 v102, v20, v21
v_lshlrev_b32 v22, 16, v103
v_and_b32 v23, 0xffff0000, v103
v_sub_f32 v22, v22, v12
v_sub_f32 v23, v23, v12
v_cvt_pk_bf16_f32 v103, v22, v23
v_lshlrev_b32 v16, 16, v104
v_and_b32 v17, 0xffff0000, v104
v_sub_f32 v16, v16, v12
v_sub_f32 v17, v17, v12
v_cvt_pk_bf16_f32 v104, v16, v17
v_lshlrev_b32 v18, 16, v105
v_and_b32 v19, 0xffff0000, v105
v_sub_f32 v18, v18, v12
v_sub_f32 v19, v19, v12
v_cvt_pk_bf16_f32 v105, v18, v19
v_lshlrev_b32 v20, 16, v106
v_and_b32 v21, 0xffff0000, v106
v_sub_f32 v20, v20, v12
v_sub_f32 v21, v21, v12
v_cvt_pk_bf16_f32 v106, v20, v21
v_lshlrev_b32 v22, 16, v107
v_and_b32 v23, 0xffff0000, v107
v_sub_f32 v22, v22, v12
v_sub_f32 v23, v23, v12
v_cvt_pk_bf16_f32 v107, v22, v23
v_lshlrev_b32 v16, 16, v108
v_and_b32 v17, 0xffff0000, v108
v_sub_f32 v16, v16, v12
v_sub_f32 v17, v17, v12
v_cvt_pk_bf16_f32 v108, v16, v17
v_lshlrev_b32 v18, 16, v109
v_and_b32 v19, 0xffff0000, v109
v_sub_f32 v18, v18, v12
v_sub_f32 v19, v19, v12
v_cvt_pk_bf16_f32 v109, v18, v19
v_lshlrev_b32 v20, 16, v110
v_and_b32 v21, 0xffff0000, v110
v_sub_f32 v20, v20, v12
v_sub_f32 v21, v21, v12
v_cvt_pk_bf16_f32 v110, v20, v21
v_lshlrev_b32 v22, 16, v111
v_and_b32 v23, 0xffff0000, v111
v_sub_f32 v22, v22, v12
v_sub_f32 v23, v23, v12
v_cvt_pk_bf16_f32 v111, v22, v23
v_lshlrev_b32 v16, 16, v112
v_and_b32 v17, 0xffff0000, v112
v_sub_f32 v16, v16, v12
v_sub_f32 v17, v17, v12
v_cvt_pk_bf16_f32 v112, v16, v17
v_lshlrev_b32 v18, 16, v113
v_and_b32 v19, 0xffff0000, v113
v_sub_f32 v18, v18, v12
v_sub_f32 v19, v19, v12
v_cvt_pk_bf16_f32 v113, v18, v19
v_lshlrev_b32 v20, 16, v114
v_and_b32 v21, 0xffff0000, v114
v_sub_f32 v20, v20, v12
v_sub_f32 v21, v21, v12
v_cvt_pk_bf16_f32 v114, v20, v21
v_lshlrev_b32 v22, 16, v115
v_and_b32 v23, 0xffff0000, v115
v_sub_f32 v22, v22, v12
v_sub_f32 v23, v23, v12
v_cvt_pk_bf16_f32 v115, v22, v23
v_lshlrev_b32 v16, 16, v116
v_and_b32 v17, 0xffff0000, v116
v_sub_f32 v16, v16, v12
v_sub_f32 v17, v17, v12
v_cvt_pk_bf16_f32 v116, v16, v17
v_lshlrev_b32 v18, 16, v117
v_and_b32 v19, 0xffff0000, v117
v_sub_f32 v18, v18, v12
v_sub_f32 v19, v19, v12
v_cvt_pk_bf16_f32 v117, v18, v19
v_lshlrev_b32 v20, 16, v118
v_and_b32 v21, 0xffff0000, v118
v_sub_f32 v20, v20, v12
v_sub_f32 v21, v21, v12
v_cvt_pk_bf16_f32 v118, v20, v21
v_lshlrev_b32 v22, 16, v119
v_and_b32 v23, 0xffff0000, v119
v_sub_f32 v22, v22, v12
v_sub_f32 v23, v23, v12
v_cvt_pk_bf16_f32 v119, v22, v23
v_lshlrev_b32 v16, 16, v120
v_and_b32 v17, 0xffff0000, v120
v_sub_f32 v16, v16, v12
v_sub_f32 v17, v17, v12
v_cvt_pk_bf16_f32 v120, v16, v17
v_lshlrev_b32 v18, 16, v121
v_and_b32 v19, 0xffff0000, v121
v_sub_f32 v18, v18, v12
v_sub_f32 v19, v19, v12
v_cvt_pk_bf16_f32 v121, v18, v19
v_lshlrev_b32 v20, 16, v122
v_and_b32 v21, 0xffff0000, v122
v_sub_f32 v20, v20, v12
v_sub_f32 v21, v21, v12
v_cvt_pk_bf16_f32 v122, v20, v21
v_lshlrev_b32 v22, 16, v123
v_and_b32 v23, 0xffff0000, v123
v_sub_f32 v22, v22, v12
v_sub_f32 v23, v23, v12
v_cvt_pk_bf16_f32 v123, v22, v23
v_lshlrev_b32 v16, 16, v124
v_and_b32 v17, 0xffff0000, v124
v_sub_f32 v16, v16, v12
v_sub_f32 v17, v17, v12
v_cvt_pk_bf16_f32 v124, v16, v17
v_lshlrev_b32 v18, 16, v125
v_and_b32 v19, 0xffff0000, v125
v_sub_f32 v18, v18, v12
v_sub_f32 v19, v19, v12
v_cvt_pk_bf16_f32 v125, v18, v19
v_lshlrev_b32 v20, 16, v126
v_and_b32 v21, 0xffff0000, v126
v_sub_f32 v20, v20, v12
v_sub_f32 v21, v21, v12
v_cvt_pk_bf16_f32 v126, v20, v21
v_lshlrev_b32 v22, 16, v127
v_and_b32 v23, 0xffff0000, v127
v_sub_f32 v22, v22, v12
v_sub_f32 v23, v23, v12
v_cvt_pk_bf16_f32 v127, v22, v23
v_lshlrev_b32 v16, 16, v128
v_and_b32 v17, 0xffff0000, v128
v_sub_f32 v16, v16, v12
v_sub_f32 v17, v17, v12
v_cvt_pk_bf16_f32 v128, v16, v17
v_lshlrev_b32 v18, 16, v129
v_and_b32 v19, 0xffff0000, v129
v_sub_f32 v18, v18, v12
v_sub_f32 v19, v19, v12
v_cvt_pk_bf16_f32 v129, v18, v19
v_lshlrev_b32 v20, 16, v130
v_and_b32 v21, 0xffff0000, v130
v_sub_f32 v20, v20, v12
v_sub_f32 v21, v21, v12
v_cvt_pk_bf16_f32 v130, v20, v21
v_lshlrev_b32 v22, 16, v131
v_and_b32 v23, 0xffff0000, v131
v_sub_f32 v22, v22, v12
v_sub_f32 v23, v23, v12
v_cvt_pk_bf16_f32 v131, v22, v23
v_lshlrev_b32 v16, 16, v132
v_and_b32 v17, 0xffff0000, v132
v_sub_f32 v16, v16, v12
v_sub_f32 v17, v17, v12
v_cvt_pk_bf16_f32 v132, v16, v17
v_lshlrev_b32 v18, 16, v133
v_and_b32 v19, 0xffff0000, v133
v_sub_f32 v18, v18, v12
v_sub_f32 v19, v19, v12
v_cvt_pk_bf16_f32 v133, v18, v19
v_lshlrev_b32 v20, 16, v134
v_and_b32 v21, 0xffff0000, v134
v_sub_f32 v20, v20, v12
v_sub_f32 v21, v21, v12
v_cvt_pk_bf16_f32 v134, v20, v21
v_lshlrev_b32 v22, 16, v135
v_and_b32 v23, 0xffff0000, v135
v_sub_f32 v22, v22, v12
v_sub_f32 v23, v23, v12
v_cvt_pk_bf16_f32 v135, v22, v23
v_lshlrev_b32 v16, 16, v136
v_and_b32 v17, 0xffff0000, v136
v_sub_f32 v16, v16, v12
v_sub_f32 v17, v17, v12
v_cvt_pk_bf16_f32 v136, v16, v17
v_lshlrev_b32 v18, 16, v137
v_and_b32 v19, 0xffff0000, v137
v_sub_f32 v18, v18, v12
v_sub_f32 v19, v19, v12
v_cvt_pk_bf16_f32 v137, v18, v19
v_lshlrev_b32 v20, 16, v138
v_and_b32 v21, 0xffff0000, v138
v_sub_f32 v20, v20, v12
v_sub_f32 v21, v21, v12
v_cvt_pk_bf16_f32 v138, v20, v21
v_lshlrev_b32 v22, 16, v139
v_and_b32 v23, 0xffff0000, v139
v_sub_f32 v22, v22, v12
v_sub_f32 v23, v23, v12
v_cvt_pk_bf16_f32 v139, v22, v23
v_lshlrev_b32 v16, 16, v140
v_and_b32 v17, 0xffff0000, v140
v_sub_f32 v16, v16, v12
v_sub_f32 v17, v17, v12
v_cvt_pk_bf16_f32 v140, v16, v17
v_lshlrev_b32 v18, 16, v141
v_and_b32 v19, 0xffff0000, v141
v_sub_f32 v18, v18, v12
v_sub_f32 v19, v19, v12
v_cvt_pk_bf16_f32 v141, v18, v19
v_lshlrev_b32 v20, 16, v142
v_and_b32 v21, 0xffff0000, v142
v_sub_f32 v20, v20, v12
v_sub_f32 v21, v21, v12
v_cvt_pk_bf16_f32 v142, v20, v21
v_lshlrev_b32 v22, 16, v143
v_and_b32 v23, 0xffff0000, v143
v_sub_f32 v22, v22, v12
v_sub_f32 v23, v23, v12
v_cvt_pk_bf16_f32 v143, v22, v23
v_lshlrev_b32 v16, 16, v144
v_and_b32 v17, 0xffff0000, v144
v_sub_f32 v16, v16, v12
v_sub_f32 v17, v17, v12
v_cvt_pk_bf16_f32 v144, v16, v17
v_lshlrev_b32 v18, 16, v145
v_and_b32 v19, 0xffff0000, v145
v_sub_f32 v18, v18, v12
v_sub_f32 v19, v19, v12
v_cvt_pk_bf16_f32 v145, v18, v19
v_lshlrev_b32 v20, 16, v146
v_and_b32 v21, 0xffff0000, v146
v_sub_f32 v20, v20, v12
v_sub_f32 v21, v21, v12
v_cvt_pk_bf16_f32 v146, v20, v21
v_lshlrev_b32 v22, 16, v147
v_and_b32 v23, 0xffff0000, v147
v_sub_f32 v22, v22, v12
v_sub_f32 v23, v23, v12
v_cvt_pk_bf16_f32 v147, v22, v23
v_lshlrev_b32 v16, 16, v148
v_and_b32 v17, 0xffff0000, v148
v_sub_f32 v16, v16, v12
v_sub_f32 v17, v17, v12
v_cvt_pk_bf16_f32 v148, v16, v17
v_lshlrev_b32 v18, 16, v149
v_and_b32 v19, 0xffff0000, v149
v_sub_f32 v18, v18, v12
v_sub_f32 v19, v19, v12
v_cvt_pk_bf16_f32 v149, v18, v19
v_lshlrev_b32 v20, 16, v150
v_and_b32 v21, 0xffff0000, v150
v_sub_f32 v20, v20, v12
v_sub_f32 v21, v21, v12
v_cvt_pk_bf16_f32 v150, v20, v21
v_lshlrev_b32 v22, 16, v151
v_and_b32 v23, 0xffff0000, v151
v_sub_f32 v22, v22, v12
v_sub_f32 v23, v23, v12
v_cvt_pk_bf16_f32 v151, v22, v23
s_add_u32 s40, s29, 0
buffer_store_dwordx4 v[80:83], v2, s[8:11], s40 offen
s_add_u32 s40, s29, 1024
buffer_store_dwordx4 v[84:87], v2, s[8:11], s40 offen
s_add_u32 s29, s29, s32
s_add_u32 s40, s29, 0
buffer_store_dwordx4 v[88:91], v2, s[8:11], s40 offen
s_add_u32 s40, s29, 1024
buffer_store_dwordx4 v[92:95], v2, s[8:11], s40 offen
s_add_u32 s29, s29, s32
s_add_u32 s40, s29, 0
buffer_store_dwordx4 v[96:99], v2, s[8:11], s40 offen
s_add_u32 s40, s29, 1024
buffer_store_dwordx4 v[100:103], v2, s[8:11], s40 offen
s_add_u32 s29, s29, s32
s_add_u32 s40, s29, 0
buffer_store_dwordx4 v[104:107], v2, s[8:11], s40 offen
s_add_u32 s40, s29, 1024
buffer_store_dwordx4 v[108:111], v2, s[8:11], s40 offen
s_add_u32 s29, s29, s32
s_add_u32 s40, s29, 0
buffer_store_dwordx4 v[112:115], v2, s[8:11], s40 offen
s_add_u32 s40, s29, 1024
buffer_store_dwordx4 v[116:119], v2, s[8:11], s40 offen
s_add_u32 s29, s29, s32
s_add_u32 s40, s29, 0
buffer_store_dwordx4 v[120:123], v2, s[8:11], s40 offen
s_add_u32 s40, s29, 1024
buffer_store_dwordx4 v[124:127], v2, s[8:11], s40 offen
s_add_u32 s29, s29, s32
s_add_u32 s40, s29, 0
buffer_store_dwordx4 v[128:131], v2, s[8:11], s40 offen
s_add_u32 s40, s29, 1024
buffer_store_dwordx4 v[132:135], v2, s[8:11], s40 offen
s_add_u32 s29, s29, s32
s_add_u32 s40, s29, 0
buffer_store_dwordx4 v[136:139], v2, s[8:11], s40 offen
s_add_u32 s40, s29, 1024
buffer_store_dwordx4 v[140:143], v2, s[8:11], s40 offen
s_add_u32 s29, s29, s32
s_add_u32 s40, s29, 0
buffer_store_dwordx4 v[144:147], v2, s[8:11], s40 offen
s_add_u32 s40, s29, 1024
buffer_store_dwordx4 v[148:151], v2, s[8:11], s40 offen
s_branch L_prep_end
L_pack_d:
s_sub_u32 s20, s20, 576
s_mul_i32 s21, s20, 7282
s_lshr_b32 s21, s21, 16
s_mul_i32 s22, s21, 9
s_sub_u32 s22, s20, s22
s_lshr_b32 s23, s21, 2
s_and_b32 s24, s21, 3
s_load_dwordx2 s[12:13], s[0:1], 48
s_waitcnt lgkmcnt(0)
s_mov_b32 s16, s12
s_and_b32 s17, s13, 0xffff
s_mov_b32 s18, 5308416
s_mov_b32 s19, 0x20000
s_lshr_b32 s25, s22, 1
s_lshl_b32 s25, s25, 5
s_and_b32 s26, s22, 1
s_lshl_b32 s26, s26, 2
s_add_u32 s25, s25, s26
s_mul_i32 s26, s24, 144
s_add_u32 s25, s25, s26
s_cmp_eq_u32 s22, 8
s_cselect_b64 vcc, -1, 0
v_cndmask_b32 v11, v10, v6, vcc
v_add_u32 v11, s25, v11
v_lshlrev_b32 v11, 1, v11
v_mul_u32_u24 v12, 9216, v7
v_add_u32 v4, v11, v12
s_mul_i32 s26, s23, 663552
s_add_u32 s27, s24, 0
s_and_b32 s27, s27, 3
s_mul_i32 s27, s27, 9
s_add_u32 s27, s27, 1
s_lshr_b32 s27, s27, 1
s_mul_i32 s27, s27, 36864
s_add_u32 s32, s26, s27
s_add_u32 s27, s24, 1
s_and_b32 s27, s27, 3
s_mul_i32 s27, s27, 9
s_add_u32 s27, s27, 1
s_lshr_b32 s27, s27, 1
s_mul_i32 s27, s27, 36864
s_add_u32 s33, s26, s27
s_add_u32 s27, s24, 2
s_and_b32 s27, s27, 3
s_mul_i32 s27, s27, 9
s_add_u32 s27, s27, 1
s_lshr_b32 s27, s27, 1
s_mul_i32 s27, s27, 36864
s_add_u32 s34, s26, s27
s_add_u32 s27, s24, 3
s_and_b32 s27, s27, 3
s_mul_i32 s27, s27, 9
s_add_u32 s27, s27, 1
s_lshr_b32 s27, s27, 1
s_mul_i32 s27, s27, 36864
s_add_u32 s35, s26, s27
s_add_u32 s40, s32, 0
buffer_load_ushort v16, v4, s[16:19], s40 offen
s_add_u32 s40, s32, 1152
buffer_load_ushort v17, v4, s[16:19], s40 offen
s_add_u32 s40, s32, 2304
buffer_load_ushort v18, v4, s[16:19], s40 offen
s_add_u32 s40, s32, 3456
buffer_load_ushort v19, v4, s[16:19], s40 offen
s_add_u32 s40, s32, 4608
buffer_load_ushort v20, v4, s[16:19], s40 offen
s_add_u32 s40, s32, 5760
buffer_load_ushort v21, v4, s[16:19], s40 offen
s_add_u32 s40, s32, 6912
buffer_load_ushort v22, v4, s[16:19], s40 offen
s_add_u32 s40, s32, 8064
buffer_load_ushort v23, v4, s[16:19], s40 offen
s_add_u32 s40, s32, 36864
buffer_load_ushort v24, v4, s[16:19], s40 offen
s_add_u32 s40, s32, 38016
buffer_load_ushort v25, v4, s[16:19], s40 offen
s_add_u32 s40, s32, 39168
buffer_load_ushort v26, v4, s[16:19], s40 offen
s_add_u32 s40, s32, 40320
buffer_load_ushort v27, v4, s[16:19], s40 offen
s_add_u32 s40, s32, 41472
buffer_load_ushort v28, v4, s[16:19], s40 offen
s_add_u32 s40, s32, 42624
buffer_load_ushort v29, v4, s[16:19], s40 offen
s_add_u32 s40, s32, 43776
buffer_load_ushort v30, v4, s[16:19], s40 offen
s_add_u32 s40, s32, 44928
buffer_load_ushort v31, v4, s[16:19], s40 offen
s_add_u32 s40, s32, 73728
buffer_load_ushort v32, v4, s[16:19], s40 offen
s_add_u32 s40, s32, 74880
buffer_load_ushort v33, v4, s[16:19], s40 offen
s_add_u32 s40, s32, 76032
buffer_load_ushort v34, v4, s[16:19], s40 offen
s_add_u32 s40, s32, 77184
buffer_load_ushort v35, v4, s[16:19], s40 offen
s_add_u32 s40, s32, 78336
buffer_load_ushort v36, v4, s[16:19], s40 offen
s_add_u32 s40, s32, 79488
buffer_load_ushort v37, v4, s[16:19], s40 offen
s_add_u32 s40, s32, 80640
buffer_load_ushort v38, v4, s[16:19], s40 offen
s_add_u32 s40, s32, 81792
buffer_load_ushort v39, v4, s[16:19], s40 offen
s_add_u32 s40, s33, 0
buffer_load_ushort v40, v4, s[16:19], s40 offen
s_add_u32 s40, s33, 1152
buffer_load_ushort v41, v4, s[16:19], s40 offen
s_add_u32 s40, s33, 2304
buffer_load_ushort v42, v4, s[16:19], s40 offen
s_add_u32 s40, s33, 3456
buffer_load_ushort v43, v4, s[16:19], s40 offen
s_add_u32 s40, s33, 4608
buffer_load_ushort v44, v4, s[16:19], s40 offen
s_add_u32 s40, s33, 5760
buffer_load_ushort v45, v4, s[16:19], s40 offen
s_add_u32 s40, s33, 6912
buffer_load_ushort v46, v4, s[16:19], s40 offen
s_add_u32 s40, s33, 8064
buffer_load_ushort v47, v4, s[16:19], s40 offen
s_add_u32 s40, s34, 0
buffer_load_ushort v48, v4, s[16:19], s40 offen
s_add_u32 s40, s34, 1152
buffer_load_ushort v49, v4, s[16:19], s40 offen
s_add_u32 s40, s34, 2304
buffer_load_ushort v50, v4, s[16:19], s40 offen
s_add_u32 s40, s34, 3456
buffer_load_ushort v51, v4, s[16:19], s40 offen
s_add_u32 s40, s34, 4608
buffer_load_ushort v52, v4, s[16:19], s40 offen
s_add_u32 s40, s34, 5760
buffer_load_ushort v53, v4, s[16:19], s40 offen
s_add_u32 s40, s34, 6912
buffer_load_ushort v54, v4, s[16:19], s40 offen
s_add_u32 s40, s34, 8064
buffer_load_ushort v55, v4, s[16:19], s40 offen
s_add_u32 s40, s35, 0
buffer_load_ushort v56, v4, s[16:19], s40 offen
s_add_u32 s40, s35, 1152
buffer_load_ushort v57, v4, s[16:19], s40 offen
s_add_u32 s40, s35, 2304
buffer_load_ushort v58, v4, s[16:19], s40 offen
s_add_u32 s40, s35, 3456
buffer_load_ushort v59, v4, s[16:19], s40 offen
s_add_u32 s40, s35, 4608
buffer_load_ushort v60, v4, s[16:19], s40 offen
s_add_u32 s40, s35, 5760
buffer_load_ushort v61, v4, s[16:19], s40 offen
s_add_u32 s40, s35, 6912
buffer_load_ushort v62, v4, s[16:19], s40 offen
s_add_u32 s40, s35, 8064
buffer_load_ushort v63, v4, s[16:19], s40 offen
s_waitcnt vmcnt(40)
v_lshl_or_b32 v80, v17, 16, v16
v_lshl_or_b32 v81, v19, 16, v18
v_lshl_or_b32 v82, v21, 16, v20
v_lshl_or_b32 v83, v23, 16, v22
s_waitcnt vmcnt(32)
v_lshl_or_b32 v84, v25, 16, v24
v_lshl_or_b32 v85, v27, 16, v26
v_lshl_or_b32 v86, v29, 16, v28
v_lshl_or_b32 v87, v31, 16, v30
s_waitcnt vmcnt(24)
v_lshl_or_b32 v88, v33, 16, v32
v_lshl_or_b32 v89, v35, 16, v34
v_lshl_or_b32 v90, v37, 16, v36
v_lshl_or_b32 v91, v39, 16, v38
s_waitcnt vmcnt(16)
v_lshl_or_b32 v92, v41, 16, v40
v_lshl_or_b32 v93, v43, 16, v42
v_lshl_or_b32 v94, v45, 16, v44
v_lshl_or_b32 v95, v47, 16, v46
s_waitcnt vmcnt(8)
v_lshl_or_b32 v96, v49, 16, v48
v_lshl_or_b32 v97, v51, 16, v50
v_lshl_or_b32 v98, v53, 16, v52
v_lshl_or_b32 v99, v55, 16, v54
s_waitcnt vmcnt(0)
v_lshl_or_b32 v100, v57, 16, v56
v_lshl_or_b32 v101, v59, 16, v58
v_lshl_or_b32 v102, v61, 16, v60
v_lshl_or_b32 v103, v63, 16, v62
s_add_u32 s40, s33, 36864
buffer_load_ushort v16, v4, s[16:19], s40 offen
s_add_u32 s40, s33, 38016
buffer_load_ushort v17, v4, s[16:19], s40 offen
s_add_u32 s40, s33, 39168
buffer_load_ushort v18, v4, s[16:19], s40 offen
s_add_u32 s40, s33, 40320
buffer_load_ushort v19, v4, s[16:19], s40 offen
s_add_u32 s40, s33, 41472
buffer_load_ushort v20, v4, s[16:19], s40 offen
s_add_u32 s40, s33, 42624
buffer_load_ushort v21, v4, s[16:19], s40 offen
s_add_u32 s40, s33, 43776
buffer_load_ushort v22, v4, s[16:19], s40 offen
s_add_u32 s40, s33, 44928
buffer_load_ushort v23, v4, s[16:19], s40 offen
s_add_u32 s40, s34, 36864
buffer_load_ushort v24, v4, s[16:19], s40 offen
s_add_u32 s40, s34, 38016
buffer_load_ushort v25, v4, s[16:19], s40 offen
s_add_u32 s40, s34, 39168
buffer_load_ushort v26, v4, s[16:19], s40 offen
s_add_u32 s40, s34, 40320
buffer_load_ushort v27, v4, s[16:19], s40 offen
s_add_u32 s40, s34, 41472
buffer_load_ushort v28, v4, s[16:19], s40 offen
s_add_u32 s40, s34, 42624
buffer_load_ushort v29, v4, s[16:19], s40 offen
s_add_u32 s40, s34, 43776
buffer_load_ushort v30, v4, s[16:19], s40 offen
s_add_u32 s40, s34, 44928
buffer_load_ushort v31, v4, s[16:19], s40 offen
s_add_u32 s40, s35, 36864
buffer_load_ushort v32, v4, s[16:19], s40 offen
s_add_u32 s40, s35, 38016
buffer_load_ushort v33, v4, s[16:19], s40 offen
s_add_u32 s40, s35, 39168
buffer_load_ushort v34, v4, s[16:19], s40 offen
s_add_u32 s40, s35, 40320
buffer_load_ushort v35, v4, s[16:19], s40 offen
s_add_u32 s40, s35, 41472
buffer_load_ushort v36, v4, s[16:19], s40 offen
s_add_u32 s40, s35, 42624
buffer_load_ushort v37, v4, s[16:19], s40 offen
s_add_u32 s40, s35, 43776
buffer_load_ushort v38, v4, s[16:19], s40 offen
s_add_u32 s40, s35, 44928
buffer_load_ushort v39, v4, s[16:19], s40 offen
s_add_u32 s40, s26, 147456
buffer_load_ushort v40, v4, s[16:19], s40 offen
s_add_u32 s40, s26, 148608
buffer_load_ushort v41, v4, s[16:19], s40 offen
s_add_u32 s40, s26, 149760
buffer_load_ushort v42, v4, s[16:19], s40 offen
s_add_u32 s40, s26, 150912
buffer_load_ushort v43, v4, s[16:19], s40 offen
s_add_u32 s40, s26, 152064
buffer_load_ushort v44, v4, s[16:19], s40 offen
s_add_u32 s40, s26, 153216
buffer_load_ushort v45, v4, s[16:19], s40 offen
s_add_u32 s40, s26, 154368
buffer_load_ushort v46, v4, s[16:19], s40 offen
s_add_u32 s40, s26, 155520
buffer_load_ushort v47, v4, s[16:19], s40 offen
s_add_u32 s40, s26, 479232
buffer_load_ushort v48, v4, s[16:19], s40 offen
s_add_u32 s40, s26, 480384
buffer_load_ushort v49, v4, s[16:19], s40 offen
s_add_u32 s40, s26, 481536
buffer_load_ushort v50, v4, s[16:19], s40 offen
s_add_u32 s40, s26, 482688
buffer_load_ushort v51, v4, s[16:19], s40 offen
s_add_u32 s40, s26, 483840
buffer_load_ushort v52, v4, s[16:19], s40 offen
s_add_u32 s40, s26, 484992
buffer_load_ushort v53, v4, s[16:19], s40 offen
s_add_u32 s40, s26, 486144
buffer_load_ushort v54, v4, s[16:19], s40 offen
s_add_u32 s40, s26, 487296
buffer_load_ushort v55, v4, s[16:19], s40 offen
s_add_u32 s40, s32, 110592
buffer_load_ushort v56, v4, s[16:19], s40 offen
s_add_u32 s40, s32, 111744
buffer_load_ushort v57, v4, s[16:19], s40 offen
s_add_u32 s40, s32, 112896
buffer_load_ushort v58, v4, s[16:19], s40 offen
s_add_u32 s40, s32, 114048
buffer_load_ushort v59, v4, s[16:19], s40 offen
s_add_u32 s40, s32, 115200
buffer_load_ushort v60, v4, s[16:19], s40 offen
s_add_u32 s40, s32, 116352
buffer_load_ushort v61, v4, s[16:19], s40 offen
s_add_u32 s40, s32, 117504
buffer_load_ushort v62, v4, s[16:19], s40 offen
s_add_u32 s40, s32, 118656
buffer_load_ushort v63, v4, s[16:19], s40 offen
s_waitcnt vmcnt(40)
v_lshl_or_b32 v104, v17, 16, v16
v_lshl_or_b32 v105, v19, 16, v18
v_lshl_or_b32 v106, v21, 16, v20
v_lshl_or_b32 v107, v23, 16, v22
s_waitcnt vmcnt(32)
v_lshl_or_b32 v108, v25, 16, v24
v_lshl_or_b32 v109, v27, 16, v26
v_lshl_or_b32 v110, v29, 16, v28
v_lshl_or_b32 v111, v31, 16, v30
s_waitcnt vmcnt(24)
v_lshl_or_b32 v112, v33, 16, v32
v_lshl_or_b32 v113, v35, 16, v34
v_lshl_or_b32 v114, v37, 16, v36
v_lshl_or_b32 v115, v39, 16, v38
s_waitcnt vmcnt(16)
v_lshl_or_b32 v116, v41, 16, v40
v_lshl_or_b32 v117, v43, 16, v42
v_lshl_or_b32 v118, v45, 16, v44
v_lshl_or_b32 v119, v47, 16, v46
s_waitcnt vmcnt(8)
v_lshl_or_b32 v120, v49, 16, v48
v_lshl_or_b32 v121, v51, 16, v50
v_lshl_or_b32 v122, v53, 16, v52
v_lshl_or_b32 v123, v55, 16, v54
s_waitcnt vmcnt(0)
v_lshl_or_b32 v124, v57, 16, v56
v_lshl_or_b32 v125, v59, 16, v58
v_lshl_or_b32 v126, v61, 16, v60
v_lshl_or_b32 v127, v63, 16, v62
s_add_u32 s40, s33, 73728
buffer_load_ushort v16, v4, s[16:19], s40 offen
s_add_u32 s40, s33, 74880
buffer_load_ushort v17, v4, s[16:19], s40 offen
s_add_u32 s40, s33, 76032
buffer_load_ushort v18, v4, s[16:19], s40 offen
s_add_u32 s40, s33, 77184
buffer_load_ushort v19, v4, s[16:19], s40 offen
s_add_u32 s40, s33, 78336
buffer_load_ushort v20, v4, s[16:19], s40 offen
s_add_u32 s40, s33, 79488
buffer_load_ushort v21, v4, s[16:19], s40 offen
s_add_u32 s40, s33, 80640
buffer_load_ushort v22, v4, s[16:19], s40 offen
s_add_u32 s40, s33, 81792
buffer_load_ushort v23, v4, s[16:19], s40 offen
s_add_u32 s40, s34, 73728
buffer_load_ushort v24, v4, s[16:19], s40 offen
s_add_u32 s40, s34, 74880
buffer_load_ushort v25, v4, s[16:19], s40 offen
s_add_u32 s40, s34, 76032
buffer_load_ushort v26, v4, s[16:19], s40 offen
s_add_u32 s40, s34, 77184
buffer_load_ushort v27, v4, s[16:19], s40 offen
s_add_u32 s40, s34, 78336
buffer_load_ushort v28, v4, s[16:19], s40 offen
s_add_u32 s40, s34, 79488
buffer_load_ushort v29, v4, s[16:19], s40 offen
s_add_u32 s40, s34, 80640
buffer_load_ushort v30, v4, s[16:19], s40 offen
s_add_u32 s40, s34, 81792
buffer_load_ushort v31, v4, s[16:19], s40 offen
s_add_u32 s40, s35, 73728
buffer_load_ushort v32, v4, s[16:19], s40 offen
s_add_u32 s40, s35, 74880
buffer_load_ushort v33, v4, s[16:19], s40 offen
s_add_u32 s40, s35, 76032
buffer_load_ushort v34, v4, s[16:19], s40 offen
s_add_u32 s40, s35, 77184
buffer_load_ushort v35, v4, s[16:19], s40 offen
s_add_u32 s40, s35, 78336
buffer_load_ushort v36, v4, s[16:19], s40 offen
s_add_u32 s40, s35, 79488
buffer_load_ushort v37, v4, s[16:19], s40 offen
s_add_u32 s40, s35, 80640
buffer_load_ushort v38, v4, s[16:19], s40 offen
s_add_u32 s40, s35, 81792
buffer_load_ushort v39, v4, s[16:19], s40 offen
s_add_u32 s40, s33, 110592
buffer_load_ushort v40, v4, s[16:19], s40 offen
s_add_u32 s40, s33, 111744
buffer_load_ushort v41, v4, s[16:19], s40 offen
s_add_u32 s40, s33, 112896
buffer_load_ushort v42, v4, s[16:19], s40 offen
s_add_u32 s40, s33, 114048
buffer_load_ushort v43, v4, s[16:19], s40 offen
s_add_u32 s40, s33, 115200
buffer_load_ushort v44, v4, s[16:19], s40 offen
s_add_u32 s40, s33, 116352
buffer_load_ushort v45, v4, s[16:19], s40 offen
s_add_u32 s40, s33, 117504
buffer_load_ushort v46, v4, s[16:19], s40 offen
s_add_u32 s40, s33, 118656
buffer_load_ushort v47, v4, s[16:19], s40 offen
s_add_u32 s40, s34, 110592
buffer_load_ushort v48, v4, s[16:19], s40 offen
s_add_u32 s40, s34, 111744
buffer_load_ushort v49, v4, s[16:19], s40 offen
s_add_u32 s40, s34, 112896
buffer_load_ushort v50, v4, s[16:19], s40 offen
s_add_u32 s40, s34, 114048
buffer_load_ushort v51, v4, s[16:19], s40 offen
s_add_u32 s40, s34, 115200
buffer_load_ushort v52, v4, s[16:19], s40 offen
s_add_u32 s40, s34, 116352
buffer_load_ushort v53, v4, s[16:19], s40 offen
s_add_u32 s40, s34, 117504
buffer_load_ushort v54, v4, s[16:19], s40 offen
s_add_u32 s40, s34, 118656
buffer_load_ushort v55, v4, s[16:19], s40 offen
s_add_u32 s40, s35, 110592
buffer_load_ushort v56, v4, s[16:19], s40 offen
s_add_u32 s40, s35, 111744
buffer_load_ushort v57, v4, s[16:19], s40 offen
s_add_u32 s40, s35, 112896
buffer_load_ushort v58, v4, s[16:19], s40 offen
s_add_u32 s40, s35, 114048
buffer_load_ushort v59, v4, s[16:19], s40 offen
s_add_u32 s40, s35, 115200
buffer_load_ushort v60, v4, s[16:19], s40 offen
s_add_u32 s40, s35, 116352
buffer_load_ushort v61, v4, s[16:19], s40 offen
s_add_u32 s40, s35, 117504
buffer_load_ushort v62, v4, s[16:19], s40 offen
s_add_u32 s40, s35, 118656
buffer_load_ushort v63, v4, s[16:19], s40 offen
s_waitcnt vmcnt(40)
v_lshl_or_b32 v128, v17, 16, v16
v_lshl_or_b32 v129, v19, 16, v18
v_lshl_or_b32 v130, v21, 16, v20
v_lshl_or_b32 v131, v23, 16, v22
s_waitcnt vmcnt(32)
v_lshl_or_b32 v132, v25, 16, v24
v_lshl_or_b32 v133, v27, 16, v26
v_lshl_or_b32 v134, v29, 16, v28
v_lshl_or_b32 v135, v31, 16, v30
s_waitcnt vmcnt(24)
v_lshl_or_b32 v136, v33, 16, v32
v_lshl_or_b32 v137, v35, 16, v34
v_lshl_or_b32 v138, v37, 16, v36
v_lshl_or_b32 v139, v39, 16, v38
s_waitcnt vmcnt(16)
v_lshl_or_b32 v140, v41, 16, v40
v_lshl_or_b32 v141, v43, 16, v42
v_lshl_or_b32 v142, v45, 16, v44
v_lshl_or_b32 v143, v47, 16, v46
s_waitcnt vmcnt(8)
v_lshl_or_b32 v144, v49, 16, v48
v_lshl_or_b32 v145, v51, 16, v50
v_lshl_or_b32 v146, v53, 16, v52
v_lshl_or_b32 v147, v55, 16, v54
s_waitcnt vmcnt(0)
v_lshl_or_b32 v148, v57, 16, v56
v_lshl_or_b32 v149, v59, 16, v58
v_lshl_or_b32 v150, v61, 16, v60
v_lshl_or_b32 v151, v63, 16, v62
s_mul_i32 s29, s21, 497664
s_add_u32 s29, s29, 7630848
s_lshl_b32 s30, s22, 11
s_add_u32 s30, s30, s29
s_lshl_b32 s31, s22, 12
s_add_u32 s31, s31, s29
s_add_u32 s40, s30, 0
buffer_store_dwordx4 v[80:83], v2, s[8:11], s40 offen
s_add_u32 s40, s30, 1024
buffer_store_dwordx4 v[84:87], v2, s[8:11], s40 offen
s_add_u32 s40, s30, 18432
buffer_store_dwordx4 v[88:91], v2, s[8:11], s40 offen
s_add_u32 s40, s30, 19456
buffer_store_dwordx4 v[92:95], v2, s[8:11], s40 offen
s_add_u32 s40, s30, 36864
buffer_store_dwordx4 v[96:99], v2, s[8:11], s40 offen
s_add_u32 s40, s30, 37888
buffer_store_dwordx4 v[100:103], v2, s[8:11], s40 offen
s_add_u32 s40, s30, 55296
buffer_store_dwordx4 v[104:107], v2, s[8:11], s40 offen
s_add_u32 s40, s30, 56320
buffer_store_dwordx4 v[108:111], v2, s[8:11], s40 offen
s_add_u32 s40, s30, 73728
buffer_store_dwordx4 v[112:115], v2, s[8:11], s40 offen
s_add_u32 s40, s30, 74752
buffer_store_dwordx4 v[116:119], v2, s[8:11], s40 offen
s_add_u32 s40, s30, 92160
buffer_store_dwordx4 v[120:123], v2, s[8:11], s40 offen
s_add_u32 s40, s30, 93184
buffer_store_dwordx4 v[124:127], v2, s[8:11], s40 offen
s_add_u32 s40, s30, 110592
buffer_store_dwordx4 v[128:131], v2, s[8:11], s40 offen
s_add_u32 s40, s30, 111616
buffer_store_dwordx4 v[132:135], v2, s[8:11], s40 offen
s_add_u32 s40, s31, 129024
buffer_store_dwordx4 v[136:139], v2, s[8:11], s40 offen
s_add_u32 s40, s31, 130048
buffer_store_dwordx4 v[140:143], v2, s[8:11], s40 offen
s_add_u32 s40, s31, 131072
buffer_store_dwordx4 v[144:147], v2, s[8:11], s40 offen
s_add_u32 s40, s31, 132096
buffer_store_dwordx4 v[148:151], v2, s[8:11], s40 offen
s_branch L_prep_end
L_pack_q:
s_sub_u32 s20, s20, 864
s_lshr_b32 s21, s20, 3
s_and_b32 s22, s20, 7
s_load_dwordx2 s[12:13], s[0:1], 8
s_waitcnt lgkmcnt(0)
s_mov_b32 s16, s12
s_and_b32 s17, s13, 0xffff
s_mov_b32 s18, 1990656
s_mov_b32 s19, 0x20000
s_mov_b32 s23, 0
s_cmp_eq_u32 s22, 0
s_cselect_b32 s23, 0, s23
s_cmp_eq_u32 s22, 1
s_cselect_b32 s23, 18, s23
s_cmp_eq_u32 s22, 2
s_cselect_b32 s23, 576, s23
s_cmp_eq_u32 s22, 3
s_cselect_b32 s23, 594, s23
s_cmp_eq_u32 s22, 4
s_cselect_b32 s23, 16, s23
s_cmp_eq_u32 s22, 5
s_cselect_b32 s23, 1152, s23
s_cmp_eq_u32 s22, 6
s_cselect_b32 s23, 1170, s23
s_cmp_eq_u32 s22, 7
s_cselect_b32 s23, 1168, s23
s_mul_i32 s24, s21, 36
s_add_u32 s23, s23, s24
v_and_b32 v11, 1, v6
v_bfe_u32 v12, v6, 1, 1
v_mul_u32_u24 v12, 18, v12
v_add_u32 v11, v11, v12
v_mul_u32_u24 v12, 576, v8
v_add_u32 v11, v11, v12
s_mov_b32 s24, 16
s_cmp_eq_u32 s22, 4
s_cselect_b32 s24, 8, s24
s_cmp_eq_u32 s22, 7
s_cselect_b32 s24, 4, s24
s_cmp_lg_u32 s24, 16
s_cselect_b64 vcc, -1, 0
v_cndmask_b32 v11, v6, v11, vcc
v_add_u32 v11, s23, v11
v_lshlrev_b32 v11, 1, v11
v_mul_u32_u24 v12, 27648, v7
v_add_u32 v11, v11, v12
v_mov_b32 v12, 2146435072
v_cmp_gt_u32 vcc, s24, v6
s_nop 1
v_cndmask_b32 v4, v12, v11, vcc
s_mov_b32 s40, 0
buffer_load_ushort v16, v4, s[16:19], s40 offen
s_mov_b32 s40, 3456
buffer_load_ushort v17, v4, s[16:19], s40 offen
s_mov_b32 s40, 6912
buffer_load_ushort v18, v4, s[16:19], s40 offen
s_mov_b32 s40, 10368
buffer_load_ushort v19, v4, s[16:19], s40 offen
s_mov_b32 s40, 13824
buffer_load_ushort v20, v4, s[16:19], s40 offen
s_mov_b32 s40, 17280
buffer_load_ushort v21, v4, s[16:19], s40 offen
s_mov_b32 s40, 20736
buffer_load_ushort v22, v4, s[16:19], s40 offen
s_mov_b32 s40, 24192
buffer_load_ushort v23, v4, s[16:19], s40 offen
s_mov_b32 s40, 110592
buffer_load_ushort v24, v4, s[16:19], s40 offen
s_mov_b32 s40, 114048
buffer_load_ushort v25, v4, s[16:19], s40 offen
s_mov_b32 s40, 117504
buffer_load_ushort v26, v4, s[16:19], s40 offen
s_mov_b32 s40, 120960
buffer_load_ushort v27, v4, s[16:19], s40 offen
s_mov_b32 s40, 124416
buffer_load_ushort v28, v4, s[16:19], s40 offen
s_mov_b32 s40, 127872
buffer_load_ushort v29, v4, s[16:19], s40 offen
s_mov_b32 s40, 131328
buffer_load_ushort v30, v4, s[16:19], s40 offen
s_mov_b32 s40, 134784
buffer_load_ushort v31, v4, s[16:19], s40 offen
s_mov_b32 s40, 221184
buffer_load_ushort v32, v4, s[16:19], s40 offen
s_mov_b32 s40, 224640
buffer_load_ushort v33, v4, s[16:19], s40 offen
s_mov_b32 s40, 228096
buffer_load_ushort v34, v4, s[16:19], s40 offen
s_mov_b32 s40, 231552
buffer_load_ushort v35, v4, s[16:19], s40 offen
s_mov_b32 s40, 235008
buffer_load_ushort v36, v4, s[16:19], s40 offen
s_mov_b32 s40, 238464
buffer_load_ushort v37, v4, s[16:19], s40 offen
s_mov_b32 s40, 241920
buffer_load_ushort v38, v4, s[16:19], s40 offen
s_mov_b32 s40, 245376
buffer_load_ushort v39, v4, s[16:19], s40 offen
s_mov_b32 s40, 331776
buffer_load_ushort v40, v4, s[16:19], s40 offen
s_mov_b32 s40, 335232
buffer_load_ushort v41, v4, s[16:19], s40 offen
s_mov_b32 s40, 338688
buffer_load_ushort v42, v4, s[16:19], s40 offen
s_mov_b32 s40, 342144
buffer_load_ushort v43, v4, s[16:19], s40 offen
s_mov_b32 s40, 345600
buffer_load_ushort v44, v4, s[16:19], s40 offen
s_mov_b32 s40, 349056
buffer_load_ushort v45, v4, s[16:19], s40 offen
s_mov_b32 s40, 352512
buffer_load_ushort v46, v4, s[16:19], s40 offen
s_mov_b32 s40, 355968
buffer_load_ushort v47, v4, s[16:19], s40 offen
s_mov_b32 s40, 442368
buffer_load_ushort v48, v4, s[16:19], s40 offen
s_mov_b32 s40, 445824
buffer_load_ushort v49, v4, s[16:19], s40 offen
s_mov_b32 s40, 449280
buffer_load_ushort v50, v4, s[16:19], s40 offen
s_mov_b32 s40, 452736
buffer_load_ushort v51, v4, s[16:19], s40 offen
s_mov_b32 s40, 456192
buffer_load_ushort v52, v4, s[16:19], s40 offen
s_mov_b32 s40, 459648
buffer_load_ushort v53, v4, s[16:19], s40 offen
s_mov_b32 s40, 463104
buffer_load_ushort v54, v4, s[16:19], s40 offen
s_mov_b32 s40, 466560
buffer_load_ushort v55, v4, s[16:19], s40 offen
s_mov_b32 s40, 552960
buffer_load_ushort v56, v4, s[16:19], s40 offen
s_mov_b32 s40, 556416
buffer_load_ushort v57, v4, s[16:19], s40 offen
s_mov_b32 s40, 559872
buffer_load_ushort v58, v4, s[16:19], s40 offen
s_mov_b32 s40, 563328
buffer_load_ushort v59, v4, s[16:19], s40 offen
s_mov_b32 s40, 566784
buffer_load_ushort v60, v4, s[16:19], s40 offen
s_mov_b32 s40, 570240
buffer_load_ushort v61, v4, s[16:19], s40 offen
s_mov_b32 s40, 573696
buffer_load_ushort v62, v4, s[16:19], s40 offen
s_mov_b32 s40, 577152
buffer_load_ushort v63, v4, s[16:19], s40 offen
s_waitcnt vmcnt(40)
v_lshl_or_b32 v80, v17, 16, v16
v_lshl_or_b32 v81, v19, 16, v18
v_lshl_or_b32 v82, v21, 16, v20
v_lshl_or_b32 v83, v23, 16, v22
s_waitcnt vmcnt(32)
v_lshl_or_b32 v84, v25, 16, v24
v_lshl_or_b32 v85, v27, 16, v26
v_lshl_or_b32 v86, v29, 16, v28
v_lshl_or_b32 v87, v31, 16, v30
s_waitcnt vmcnt(24)
v_lshl_or_b32 v88, v33, 16, v32
v_lshl_or_b32 v89, v35, 16, v34
v_lshl_or_b32 v90, v37, 16, v36
v_lshl_or_b32 v91, v39, 16, v38
s_waitcnt vmcnt(16)
v_lshl_or_b32 v92, v41, 16, v40
v_lshl_or_b32 v93, v43, 16, v42
v_lshl_or_b32 v94, v45, 16, v44
v_lshl_or_b32 v95, v47, 16, v46
s_waitcnt vmcnt(8)
v_lshl_or_b32 v96, v49, 16, v48
v_lshl_or_b32 v97, v51, 16, v50
v_lshl_or_b32 v98, v53, 16, v52
v_lshl_or_b32 v99, v55, 16, v54
s_waitcnt vmcnt(0)
v_lshl_or_b32 v100, v57, 16, v56
v_lshl_or_b32 v101, v59, 16, v58
v_lshl_or_b32 v102, v61, 16, v60
v_lshl_or_b32 v103, v63, 16, v62
s_mov_b32 s40, 663552
buffer_load_ushort v16, v4, s[16:19], s40 offen
s_mov_b32 s40, 667008
buffer_load_ushort v17, v4, s[16:19], s40 offen
s_mov_b32 s40, 670464
buffer_load_ushort v18, v4, s[16:19], s40 offen
s_mov_b32 s40, 673920
buffer_load_ushort v19, v4, s[16:19], s40 offen
s_mov_b32 s40, 677376
buffer_load_ushort v20, v4, s[16:19], s40 offen
s_mov_b32 s40, 680832
buffer_load_ushort v21, v4, s[16:19], s40 offen
s_mov_b32 s40, 684288
buffer_load_ushort v22, v4, s[16:19], s40 offen
s_mov_b32 s40, 687744
buffer_load_ushort v23, v4, s[16:19], s40 offen
s_mov_b32 s40, 774144
buffer_load_ushort v24, v4, s[16:19], s40 offen
s_mov_b32 s40, 777600
buffer_load_ushort v25, v4, s[16:19], s40 offen
s_mov_b32 s40, 781056
buffer_load_ushort v26, v4, s[16:19], s40 offen
s_mov_b32 s40, 784512
buffer_load_ushort v27, v4, s[16:19], s40 offen
s_mov_b32 s40, 787968
buffer_load_ushort v28, v4, s[16:19], s40 offen
s_mov_b32 s40, 791424
buffer_load_ushort v29, v4, s[16:19], s40 offen
s_mov_b32 s40, 794880
buffer_load_ushort v30, v4, s[16:19], s40 offen
s_mov_b32 s40, 798336
buffer_load_ushort v31, v4, s[16:19], s40 offen
s_mov_b32 s40, 884736
buffer_load_ushort v32, v4, s[16:19], s40 offen
s_mov_b32 s40, 888192
buffer_load_ushort v33, v4, s[16:19], s40 offen
s_mov_b32 s40, 891648
buffer_load_ushort v34, v4, s[16:19], s40 offen
s_mov_b32 s40, 895104
buffer_load_ushort v35, v4, s[16:19], s40 offen
s_mov_b32 s40, 898560
buffer_load_ushort v36, v4, s[16:19], s40 offen
s_mov_b32 s40, 902016
buffer_load_ushort v37, v4, s[16:19], s40 offen
s_mov_b32 s40, 905472
buffer_load_ushort v38, v4, s[16:19], s40 offen
s_mov_b32 s40, 908928
buffer_load_ushort v39, v4, s[16:19], s40 offen
s_mov_b32 s40, 995328
buffer_load_ushort v40, v4, s[16:19], s40 offen
s_mov_b32 s40, 998784
buffer_load_ushort v41, v4, s[16:19], s40 offen
s_mov_b32 s40, 1002240
buffer_load_ushort v42, v4, s[16:19], s40 offen
s_mov_b32 s40, 1005696
buffer_load_ushort v43, v4, s[16:19], s40 offen
s_mov_b32 s40, 1009152
buffer_load_ushort v44, v4, s[16:19], s40 offen
s_mov_b32 s40, 1012608
buffer_load_ushort v45, v4, s[16:19], s40 offen
s_mov_b32 s40, 1016064
buffer_load_ushort v46, v4, s[16:19], s40 offen
s_mov_b32 s40, 1019520
buffer_load_ushort v47, v4, s[16:19], s40 offen
s_mov_b32 s40, 1105920
buffer_load_ushort v48, v4, s[16:19], s40 offen
s_mov_b32 s40, 1109376
buffer_load_ushort v49, v4, s[16:19], s40 offen
s_mov_b32 s40, 1112832
buffer_load_ushort v50, v4, s[16:19], s40 offen
s_mov_b32 s40, 1116288
buffer_load_ushort v51, v4, s[16:19], s40 offen
s_mov_b32 s40, 1119744
buffer_load_ushort v52, v4, s[16:19], s40 offen
s_mov_b32 s40, 1123200
buffer_load_ushort v53, v4, s[16:19], s40 offen
s_mov_b32 s40, 1126656
buffer_load_ushort v54, v4, s[16:19], s40 offen
s_mov_b32 s40, 1130112
buffer_load_ushort v55, v4, s[16:19], s40 offen
s_mov_b32 s40, 1216512
buffer_load_ushort v56, v4, s[16:19], s40 offen
s_mov_b32 s40, 1219968
buffer_load_ushort v57, v4, s[16:19], s40 offen
s_mov_b32 s40, 1223424
buffer_load_ushort v58, v4, s[16:19], s40 offen
s_mov_b32 s40, 1226880
buffer_load_ushort v59, v4, s[16:19], s40 offen
s_mov_b32 s40, 1230336
buffer_load_ushort v60, v4, s[16:19], s40 offen
s_mov_b32 s40, 1233792
buffer_load_ushort v61, v4, s[16:19], s40 offen
s_mov_b32 s40, 1237248
buffer_load_ushort v62, v4, s[16:19], s40 offen
s_mov_b32 s40, 1240704
buffer_load_ushort v63, v4, s[16:19], s40 offen
s_waitcnt vmcnt(40)
v_lshl_or_b32 v104, v17, 16, v16
v_lshl_or_b32 v105, v19, 16, v18
v_lshl_or_b32 v106, v21, 16, v20
v_lshl_or_b32 v107, v23, 16, v22
s_waitcnt vmcnt(32)
v_lshl_or_b32 v108, v25, 16, v24
v_lshl_or_b32 v109, v27, 16, v26
v_lshl_or_b32 v110, v29, 16, v28
v_lshl_or_b32 v111, v31, 16, v30
s_waitcnt vmcnt(24)
v_lshl_or_b32 v112, v33, 16, v32
v_lshl_or_b32 v113, v35, 16, v34
v_lshl_or_b32 v114, v37, 16, v36
v_lshl_or_b32 v115, v39, 16, v38
s_waitcnt vmcnt(16)
v_lshl_or_b32 v116, v41, 16, v40
v_lshl_or_b32 v117, v43, 16, v42
v_lshl_or_b32 v118, v45, 16, v44
v_lshl_or_b32 v119, v47, 16, v46
s_waitcnt vmcnt(8)
v_lshl_or_b32 v120, v49, 16, v48
v_lshl_or_b32 v121, v51, 16, v50
v_lshl_or_b32 v122, v53, 16, v52
v_lshl_or_b32 v123, v55, 16, v54
s_waitcnt vmcnt(0)
v_lshl_or_b32 v124, v57, 16, v56
v_lshl_or_b32 v125, v59, 16, v58
v_lshl_or_b32 v126, v61, 16, v60
v_lshl_or_b32 v127, v63, 16, v62
s_mov_b32 s40, 1327104
buffer_load_ushort v16, v4, s[16:19], s40 offen
s_mov_b32 s40, 1330560
buffer_load_ushort v17, v4, s[16:19], s40 offen
s_mov_b32 s40, 1334016
buffer_load_ushort v18, v4, s[16:19], s40 offen
s_mov_b32 s40, 1337472
buffer_load_ushort v19, v4, s[16:19], s40 offen
s_mov_b32 s40, 1340928
buffer_load_ushort v20, v4, s[16:19], s40 offen
s_mov_b32 s40, 1344384
buffer_load_ushort v21, v4, s[16:19], s40 offen
s_mov_b32 s40, 1347840
buffer_load_ushort v22, v4, s[16:19], s40 offen
s_mov_b32 s40, 1351296
buffer_load_ushort v23, v4, s[16:19], s40 offen
s_mov_b32 s40, 1437696
buffer_load_ushort v24, v4, s[16:19], s40 offen
s_mov_b32 s40, 1441152
buffer_load_ushort v25, v4, s[16:19], s40 offen
s_mov_b32 s40, 1444608
buffer_load_ushort v26, v4, s[16:19], s40 offen
s_mov_b32 s40, 1448064
buffer_load_ushort v27, v4, s[16:19], s40 offen
s_mov_b32 s40, 1451520
buffer_load_ushort v28, v4, s[16:19], s40 offen
s_mov_b32 s40, 1454976
buffer_load_ushort v29, v4, s[16:19], s40 offen
s_mov_b32 s40, 1458432
buffer_load_ushort v30, v4, s[16:19], s40 offen
s_mov_b32 s40, 1461888
buffer_load_ushort v31, v4, s[16:19], s40 offen
s_mov_b32 s40, 1548288
buffer_load_ushort v32, v4, s[16:19], s40 offen
s_mov_b32 s40, 1551744
buffer_load_ushort v33, v4, s[16:19], s40 offen
s_mov_b32 s40, 1555200
buffer_load_ushort v34, v4, s[16:19], s40 offen
s_mov_b32 s40, 1558656
buffer_load_ushort v35, v4, s[16:19], s40 offen
s_mov_b32 s40, 1562112
buffer_load_ushort v36, v4, s[16:19], s40 offen
s_mov_b32 s40, 1565568
buffer_load_ushort v37, v4, s[16:19], s40 offen
s_mov_b32 s40, 1569024
buffer_load_ushort v38, v4, s[16:19], s40 offen
s_mov_b32 s40, 1572480
buffer_load_ushort v39, v4, s[16:19], s40 offen
s_mov_b32 s40, 1658880
buffer_load_ushort v40, v4, s[16:19], s40 offen
s_mov_b32 s40, 1662336
buffer_load_ushort v41, v4, s[16:19], s40 offen
s_mov_b32 s40, 1665792
buffer_load_ushort v42, v4, s[16:19], s40 offen
s_mov_b32 s40, 1669248
buffer_load_ushort v43, v4, s[16:19], s40 offen
s_mov_b32 s40, 1672704
buffer_load_ushort v44, v4, s[16:19], s40 offen
s_mov_b32 s40, 1676160
buffer_load_ushort v45, v4, s[16:19], s40 offen
s_mov_b32 s40, 1679616
buffer_load_ushort v46, v4, s[16:19], s40 offen
s_mov_b32 s40, 1683072
buffer_load_ushort v47, v4, s[16:19], s40 offen
s_mov_b32 s40, 1769472
buffer_load_ushort v48, v4, s[16:19], s40 offen
s_mov_b32 s40, 1772928
buffer_load_ushort v49, v4, s[16:19], s40 offen
s_mov_b32 s40, 1776384
buffer_load_ushort v50, v4, s[16:19], s40 offen
s_mov_b32 s40, 1779840
buffer_load_ushort v51, v4, s[16:19], s40 offen
s_mov_b32 s40, 1783296
buffer_load_ushort v52, v4, s[16:19], s40 offen
s_mov_b32 s40, 1786752
buffer_load_ushort v53, v4, s[16:19], s40 offen
s_mov_b32 s40, 1790208
buffer_load_ushort v54, v4, s[16:19], s40 offen
s_mov_b32 s40, 1793664
buffer_load_ushort v55, v4, s[16:19], s40 offen
s_mov_b32 s40, 1880064
buffer_load_ushort v56, v4, s[16:19], s40 offen
s_mov_b32 s40, 1883520
buffer_load_ushort v57, v4, s[16:19], s40 offen
s_mov_b32 s40, 1886976
buffer_load_ushort v58, v4, s[16:19], s40 offen
s_mov_b32 s40, 1890432
buffer_load_ushort v59, v4, s[16:19], s40 offen
s_mov_b32 s40, 1893888
buffer_load_ushort v60, v4, s[16:19], s40 offen
s_mov_b32 s40, 1897344
buffer_load_ushort v61, v4, s[16:19], s40 offen
s_mov_b32 s40, 1900800
buffer_load_ushort v62, v4, s[16:19], s40 offen
s_mov_b32 s40, 1904256
buffer_load_ushort v63, v4, s[16:19], s40 offen
s_waitcnt vmcnt(40)
v_lshl_or_b32 v128, v17, 16, v16
v_lshl_or_b32 v129, v19, 16, v18
v_lshl_or_b32 v130, v21, 16, v20
v_lshl_or_b32 v131, v23, 16, v22
s_waitcnt vmcnt(32)
v_lshl_or_b32 v132, v25, 16, v24
v_lshl_or_b32 v133, v27, 16, v26
v_lshl_or_b32 v134, v29, 16, v28
v_lshl_or_b32 v135, v31, 16, v30
s_waitcnt vmcnt(24)
v_lshl_or_b32 v136, v33, 16, v32
v_lshl_or_b32 v137, v35, 16, v34
v_lshl_or_b32 v138, v37, 16, v36
v_lshl_or_b32 v139, v39, 16, v38
s_waitcnt vmcnt(16)
v_lshl_or_b32 v140, v41, 16, v40
v_lshl_or_b32 v141, v43, 16, v42
v_lshl_or_b32 v142, v45, 16, v44
v_lshl_or_b32 v143, v47, 16, v46
s_waitcnt vmcnt(8)
v_lshl_or_b32 v144, v49, 16, v48
v_lshl_or_b32 v145, v51, 16, v50
v_lshl_or_b32 v146, v53, 16, v52
v_lshl_or_b32 v147, v55, 16, v54
s_waitcnt vmcnt(0)
v_lshl_or_b32 v148, v57, 16, v56
v_lshl_or_b32 v149, v59, 16, v58
v_lshl_or_b32 v150, v61, 16, v60
v_lshl_or_b32 v151, v63, 16, v62
s_mul_i32 s29, s21, 147456
s_lshl_b32 s30, s22, 10
s_add_u32 s29, s29, s30
s_add_u32 s29, s29, 4194304
s_add_u32 s40, s29, 0
buffer_store_dwordx4 v[80:83], v2, s[8:11], s40 offen
s_add_u32 s40, s29, 8192
buffer_store_dwordx4 v[84:87], v2, s[8:11], s40 offen
s_add_u32 s40, s29, 16384
buffer_store_dwordx4 v[88:91], v2, s[8:11], s40 offen
s_add_u32 s40, s29, 24576
buffer_store_dwordx4 v[92:95], v2, s[8:11], s40 offen
s_add_u32 s40, s29, 32768
buffer_store_dwordx4 v[96:99], v2, s[8:11], s40 offen
s_add_u32 s40, s29, 40960
buffer_store_dwordx4 v[100:103], v2, s[8:11], s40 offen
s_add_u32 s40, s29, 49152
buffer_store_dwordx4 v[104:107], v2, s[8:11], s40 offen
s_add_u32 s40, s29, 57344
buffer_store_dwordx4 v[108:111], v2, s[8:11], s40 offen
s_add_u32 s40, s29, 65536
buffer_store_dwordx4 v[112:115], v2, s[8:11], s40 offen
s_add_u32 s40, s29, 73728
buffer_store_dwordx4 v[116:119], v2, s[8:11], s40 offen
s_add_u32 s40, s29, 81920
buffer_store_dwordx4 v[120:123], v2, s[8:11], s40 offen
s_add_u32 s40, s29, 90112
buffer_store_dwordx4 v[124:127], v2, s[8:11], s40 offen
s_add_u32 s40, s29, 98304
buffer_store_dwordx4 v[128:131], v2, s[8:11], s40 offen
s_add_u32 s40, s29, 106496
buffer_store_dwordx4 v[132:135], v2, s[8:11], s40 offen
s_add_u32 s40, s29, 114688
buffer_store_dwordx4 v[136:139], v2, s[8:11], s40 offen
s_add_u32 s40, s29, 122880
buffer_store_dwordx4 v[140:143], v2, s[8:11], s40 offen
s_add_u32 s40, s29, 131072
buffer_store_dwordx4 v[144:147], v2, s[8:11], s40 offen
s_add_u32 s40, s29, 139264
buffer_store_dwordx4 v[148:151], v2, s[8:11], s40 offen
s_branch L_prep_end
L_pack_o:
s_sub_u32 s20, s20, 992
s_mul_i32 s21, s20, 13108
s_lshr_b32 s21, s21, 16
s_mul_i32 s22, s21, 5
s_sub_u32 s22, s20, s22
s_load_dwordx2 s[12:13], s[0:1], 16
s_waitcnt lgkmcnt(0)
s_mov_b32 s16, s12
s_and_b32 s17, s13, 0xffff
s_mov_b32 s18, 663552
s_mov_b32 s19, 0x20000
s_lshr_b32 s25, s22, 1
s_lshl_b32 s25, s25, 5
s_and_b32 s26, s22, 1
s_lshl_b32 s26, s26, 2
s_add_u32 s25, s25, s26
s_mul_i32 s26, s21, 72
s_add_u32 s25, s25, s26
s_cmp_eq_u32 s22, 4
s_cselect_b64 vcc, -1, 0
s_cselect_b32 s24, 8, 16
v_cndmask_b32 v11, v10, v6, vcc
v_add_u32 v11, s25, v11
v_lshlrev_b32 v11, 1, v11
v_mov_b32 v12, 2146435072
v_cmp_gt_u32 vcc, s24, v6
s_nop 1
v_cndmask_b32 v11, v12, v11, vcc
v_mul_u32_u24 v12, 4608, v7
v_add_u32 v4, v11, v12
v_mul_u32_u24 v12, 82944, v7
v_add_u32 v5, v11, v12
s_mov_b32 s40, 0
buffer_load_ushort v16, v4, s[16:19], s40 offen
s_mov_b32 s40, 1152
buffer_load_ushort v17, v4, s[16:19], s40 offen
s_mov_b32 s40, 2304
buffer_load_ushort v18, v4, s[16:19], s40 offen
s_mov_b32 s40, 3456
buffer_load_ushort v19, v4, s[16:19], s40 offen
s_mov_b32 s40, 20736
buffer_load_ushort v20, v4, s[16:19], s40 offen
s_mov_b32 s40, 21888
buffer_load_ushort v21, v4, s[16:19], s40 offen
s_mov_b32 s40, 23040
buffer_load_ushort v22, v4, s[16:19], s40 offen
s_mov_b32 s40, 24192
buffer_load_ushort v23, v4, s[16:19], s40 offen
s_mov_b32 s40, 41472
buffer_load_ushort v24, v4, s[16:19], s40 offen
s_mov_b32 s40, 42624
buffer_load_ushort v25, v4, s[16:19], s40 offen
s_mov_b32 s40, 43776
buffer_load_ushort v26, v4, s[16:19], s40 offen
s_mov_b32 s40, 44928
buffer_load_ushort v27, v4, s[16:19], s40 offen
s_mov_b32 s40, 62208
buffer_load_ushort v28, v4, s[16:19], s40 offen
s_mov_b32 s40, 63360
buffer_load_ushort v29, v4, s[16:19], s40 offen
s_mov_b32 s40, 64512
buffer_load_ushort v30, v4, s[16:19], s40 offen
s_mov_b32 s40, 65664
buffer_load_ushort v31, v4, s[16:19], s40 offen
s_mov_b32 s40, 82944
buffer_load_ushort v32, v4, s[16:19], s40 offen
s_mov_b32 s40, 84096
buffer_load_ushort v33, v4, s[16:19], s40 offen
s_mov_b32 s40, 85248
buffer_load_ushort v34, v4, s[16:19], s40 offen
s_mov_b32 s40, 86400
buffer_load_ushort v35, v4, s[16:19], s40 offen
s_mov_b32 s40, 103680
buffer_load_ushort v36, v4, s[16:19], s40 offen
s_mov_b32 s40, 104832
buffer_load_ushort v37, v4, s[16:19], s40 offen
s_mov_b32 s40, 105984
buffer_load_ushort v38, v4, s[16:19], s40 offen
s_mov_b32 s40, 107136
buffer_load_ushort v39, v4, s[16:19], s40 offen
s_mov_b32 s40, 124416
buffer_load_ushort v40, v4, s[16:19], s40 offen
s_mov_b32 s40, 125568
buffer_load_ushort v41, v4, s[16:19], s40 offen
s_mov_b32 s40, 126720
buffer_load_ushort v42, v4, s[16:19], s40 offen
s_mov_b32 s40, 127872
buffer_load_ushort v43, v4, s[16:19], s40 offen
s_mov_b32 s40, 145152
buffer_load_ushort v44, v4, s[16:19], s40 offen
s_mov_b32 s40, 146304
buffer_load_ushort v45, v4, s[16:19], s40 offen
s_mov_b32 s40, 147456
buffer_load_ushort v46, v4, s[16:19], s40 offen
s_mov_b32 s40, 148608
buffer_load_ushort v47, v4, s[16:19], s40 offen
s_mov_b32 s40, 165888
buffer_load_ushort v48, v4, s[16:19], s40 offen
s_mov_b32 s40, 167040
buffer_load_ushort v49, v4, s[16:19], s40 offen
s_mov_b32 s40, 168192
buffer_load_ushort v50, v4, s[16:19], s40 offen
s_mov_b32 s40, 169344
buffer_load_ushort v51, v4, s[16:19], s40 offen
s_mov_b32 s40, 186624
buffer_load_ushort v52, v4, s[16:19], s40 offen
s_mov_b32 s40, 187776
buffer_load_ushort v53, v4, s[16:19], s40 offen
s_mov_b32 s40, 188928
buffer_load_ushort v54, v4, s[16:19], s40 offen
s_mov_b32 s40, 190080
buffer_load_ushort v55, v4, s[16:19], s40 offen
s_mov_b32 s40, 207360
buffer_load_ushort v56, v4, s[16:19], s40 offen
s_mov_b32 s40, 208512
buffer_load_ushort v57, v4, s[16:19], s40 offen
s_mov_b32 s40, 209664
buffer_load_ushort v58, v4, s[16:19], s40 offen
s_mov_b32 s40, 210816
buffer_load_ushort v59, v4, s[16:19], s40 offen
s_mov_b32 s40, 228096
buffer_load_ushort v60, v4, s[16:19], s40 offen
s_mov_b32 s40, 229248
buffer_load_ushort v61, v4, s[16:19], s40 offen
s_mov_b32 s40, 230400
buffer_load_ushort v62, v4, s[16:19], s40 offen
s_mov_b32 s40, 231552
buffer_load_ushort v63, v4, s[16:19], s40 offen
s_waitcnt vmcnt(40)
v_lshl_or_b32 v80, v17, 16, v16
v_lshl_or_b32 v81, v19, 16, v18
v_lshl_or_b32 v82, v21, 16, v20
v_lshl_or_b32 v83, v23, 16, v22
s_waitcnt vmcnt(32)
v_lshl_or_b32 v84, v25, 16, v24
v_lshl_or_b32 v85, v27, 16, v26
v_lshl_or_b32 v86, v29, 16, v28
v_lshl_or_b32 v87, v31, 16, v30
s_waitcnt vmcnt(24)
v_lshl_or_b32 v88, v33, 16, v32
v_lshl_or_b32 v89, v35, 16, v34
v_lshl_or_b32 v90, v37, 16, v36
v_lshl_or_b32 v91, v39, 16, v38
s_waitcnt vmcnt(16)
v_lshl_or_b32 v92, v41, 16, v40
v_lshl_or_b32 v93, v43, 16, v42
v_lshl_or_b32 v94, v45, 16, v44
v_lshl_or_b32 v95, v47, 16, v46
s_waitcnt vmcnt(8)
v_lshl_or_b32 v96, v49, 16, v48
v_lshl_or_b32 v97, v51, 16, v50
v_lshl_or_b32 v98, v53, 16, v52
v_lshl_or_b32 v99, v55, 16, v54
s_waitcnt vmcnt(0)
v_lshl_or_b32 v100, v57, 16, v56
v_lshl_or_b32 v101, v59, 16, v58
v_lshl_or_b32 v102, v61, 16, v60
v_lshl_or_b32 v103, v63, 16, v62
s_mov_b32 s40, 248832
buffer_load_ushort v16, v4, s[16:19], s40 offen
s_mov_b32 s40, 249984
buffer_load_ushort v17, v4, s[16:19], s40 offen
s_mov_b32 s40, 251136
buffer_load_ushort v18, v4, s[16:19], s40 offen
s_mov_b32 s40, 252288
buffer_load_ushort v19, v4, s[16:19], s40 offen
s_mov_b32 s40, 269568
buffer_load_ushort v20, v4, s[16:19], s40 offen
s_mov_b32 s40, 270720
buffer_load_ushort v21, v4, s[16:19], s40 offen
s_mov_b32 s40, 271872
buffer_load_ushort v22, v4, s[16:19], s40 offen
s_mov_b32 s40, 273024
buffer_load_ushort v23, v4, s[16:19], s40 offen
s_mov_b32 s40, 290304
buffer_load_ushort v24, v4, s[16:19], s40 offen
s_mov_b32 s40, 291456
buffer_load_ushort v25, v4, s[16:19], s40 offen
s_mov_b32 s40, 292608
buffer_load_ushort v26, v4, s[16:19], s40 offen
s_mov_b32 s40, 293760
buffer_load_ushort v27, v4, s[16:19], s40 offen
s_mov_b32 s40, 311040
buffer_load_ushort v28, v4, s[16:19], s40 offen
s_mov_b32 s40, 312192
buffer_load_ushort v29, v4, s[16:19], s40 offen
s_mov_b32 s40, 313344
buffer_load_ushort v30, v4, s[16:19], s40 offen
s_mov_b32 s40, 314496
buffer_load_ushort v31, v4, s[16:19], s40 offen
s_mov_b32 s40, 331776
buffer_load_ushort v32, v4, s[16:19], s40 offen
s_mov_b32 s40, 332928
buffer_load_ushort v33, v4, s[16:19], s40 offen
s_mov_b32 s40, 334080
buffer_load_ushort v34, v4, s[16:19], s40 offen
s_mov_b32 s40, 335232
buffer_load_ushort v35, v4, s[16:19], s40 offen
s_mov_b32 s40, 352512
buffer_load_ushort v36, v4, s[16:19], s40 offen
s_mov_b32 s40, 353664
buffer_load_ushort v37, v4, s[16:19], s40 offen
s_mov_b32 s40, 354816
buffer_load_ushort v38, v4, s[16:19], s40 offen
s_mov_b32 s40, 355968
buffer_load_ushort v39, v4, s[16:19], s40 offen
s_mov_b32 s40, 373248
buffer_load_ushort v40, v4, s[16:19], s40 offen
s_mov_b32 s40, 374400
buffer_load_ushort v41, v4, s[16:19], s40 offen
s_mov_b32 s40, 375552
buffer_load_ushort v42, v4, s[16:19], s40 offen
s_mov_b32 s40, 376704
buffer_load_ushort v43, v4, s[16:19], s40 offen
s_mov_b32 s40, 393984
buffer_load_ushort v44, v4, s[16:19], s40 offen
s_mov_b32 s40, 395136
buffer_load_ushort v45, v4, s[16:19], s40 offen
s_mov_b32 s40, 396288
buffer_load_ushort v46, v4, s[16:19], s40 offen
s_mov_b32 s40, 397440
buffer_load_ushort v47, v4, s[16:19], s40 offen
s_mov_b32 s40, 414720
buffer_load_ushort v48, v4, s[16:19], s40 offen
s_mov_b32 s40, 415872
buffer_load_ushort v49, v4, s[16:19], s40 offen
s_mov_b32 s40, 417024
buffer_load_ushort v50, v4, s[16:19], s40 offen
s_mov_b32 s40, 418176
buffer_load_ushort v51, v4, s[16:19], s40 offen
s_mov_b32 s40, 435456
buffer_load_ushort v52, v4, s[16:19], s40 offen
s_mov_b32 s40, 436608
buffer_load_ushort v53, v4, s[16:19], s40 offen
s_mov_b32 s40, 437760
buffer_load_ushort v54, v4, s[16:19], s40 offen
s_mov_b32 s40, 438912
buffer_load_ushort v55, v4, s[16:19], s40 offen
s_mov_b32 s40, 456192
buffer_load_ushort v56, v4, s[16:19], s40 offen
s_mov_b32 s40, 457344
buffer_load_ushort v57, v4, s[16:19], s40 offen
s_mov_b32 s40, 458496
buffer_load_ushort v58, v4, s[16:19], s40 offen
s_mov_b32 s40, 459648
buffer_load_ushort v59, v4, s[16:19], s40 offen
s_mov_b32 s40, 476928
buffer_load_ushort v60, v4, s[16:19], s40 offen
s_mov_b32 s40, 478080
buffer_load_ushort v61, v4, s[16:19], s40 offen
s_mov_b32 s40, 479232
buffer_load_ushort v62, v4, s[16:19], s40 offen
s_mov_b32 s40, 480384
buffer_load_ushort v63, v4, s[16:19], s40 offen
s_waitcnt vmcnt(40)
v_lshl_or_b32 v104, v17, 16, v16
v_lshl_or_b32 v105, v19, 16, v18
v_lshl_or_b32 v106, v21, 16, v20
v_lshl_or_b32 v107, v23, 16, v22
s_waitcnt vmcnt(32)
v_lshl_or_b32 v108, v25, 16, v24
v_lshl_or_b32 v109, v27, 16, v26
v_lshl_or_b32 v110, v29, 16, v28
v_lshl_or_b32 v111, v31, 16, v30
s_waitcnt vmcnt(24)
v_lshl_or_b32 v112, v33, 16, v32
v_lshl_or_b32 v113, v35, 16, v34
v_lshl_or_b32 v114, v37, 16, v36
v_lshl_or_b32 v115, v39, 16, v38
s_waitcnt vmcnt(16)
v_lshl_or_b32 v116, v41, 16, v40
v_lshl_or_b32 v117, v43, 16, v42
v_lshl_or_b32 v118, v45, 16, v44
v_lshl_or_b32 v119, v47, 16, v46
s_waitcnt vmcnt(8)
v_lshl_or_b32 v120, v49, 16, v48
v_lshl_or_b32 v121, v51, 16, v50
v_lshl_or_b32 v122, v53, 16, v52
v_lshl_or_b32 v123, v55, 16, v54
s_waitcnt vmcnt(0)
v_lshl_or_b32 v124, v57, 16, v56
v_lshl_or_b32 v125, v59, 16, v58
v_lshl_or_b32 v126, v61, 16, v60
v_lshl_or_b32 v127, v63, 16, v62
s_mov_b32 s40, 497664
buffer_load_ushort v16, v4, s[16:19], s40 offen
s_mov_b32 s40, 498816
buffer_load_ushort v17, v4, s[16:19], s40 offen
s_mov_b32 s40, 499968
buffer_load_ushort v18, v4, s[16:19], s40 offen
s_mov_b32 s40, 501120
buffer_load_ushort v19, v4, s[16:19], s40 offen
s_mov_b32 s40, 518400
buffer_load_ushort v20, v4, s[16:19], s40 offen
s_mov_b32 s40, 519552
buffer_load_ushort v21, v4, s[16:19], s40 offen
s_mov_b32 s40, 520704
buffer_load_ushort v22, v4, s[16:19], s40 offen
s_mov_b32 s40, 521856
buffer_load_ushort v23, v4, s[16:19], s40 offen
s_mov_b32 s40, 539136
buffer_load_ushort v24, v4, s[16:19], s40 offen
s_mov_b32 s40, 540288
buffer_load_ushort v25, v4, s[16:19], s40 offen
s_mov_b32 s40, 541440
buffer_load_ushort v26, v4, s[16:19], s40 offen
s_mov_b32 s40, 542592
buffer_load_ushort v27, v4, s[16:19], s40 offen
s_mov_b32 s40, 559872
buffer_load_ushort v28, v4, s[16:19], s40 offen
s_mov_b32 s40, 561024
buffer_load_ushort v29, v4, s[16:19], s40 offen
s_mov_b32 s40, 562176
buffer_load_ushort v30, v4, s[16:19], s40 offen
s_mov_b32 s40, 563328
buffer_load_ushort v31, v4, s[16:19], s40 offen
s_mov_b32 s40, 580608
buffer_load_ushort v32, v4, s[16:19], s40 offen
s_mov_b32 s40, 581760
buffer_load_ushort v33, v4, s[16:19], s40 offen
s_mov_b32 s40, 582912
buffer_load_ushort v34, v4, s[16:19], s40 offen
s_mov_b32 s40, 584064
buffer_load_ushort v35, v4, s[16:19], s40 offen
s_mov_b32 s40, 601344
buffer_load_ushort v36, v4, s[16:19], s40 offen
s_mov_b32 s40, 602496
buffer_load_ushort v37, v4, s[16:19], s40 offen
s_mov_b32 s40, 603648
buffer_load_ushort v38, v4, s[16:19], s40 offen
s_mov_b32 s40, 604800
buffer_load_ushort v39, v4, s[16:19], s40 offen
s_mov_b32 s40, 622080
buffer_load_ushort v40, v4, s[16:19], s40 offen
s_mov_b32 s40, 623232
buffer_load_ushort v41, v4, s[16:19], s40 offen
s_mov_b32 s40, 624384
buffer_load_ushort v42, v4, s[16:19], s40 offen
s_mov_b32 s40, 625536
buffer_load_ushort v43, v4, s[16:19], s40 offen
s_mov_b32 s40, 642816
buffer_load_ushort v44, v4, s[16:19], s40 offen
s_mov_b32 s40, 643968
buffer_load_ushort v45, v4, s[16:19], s40 offen
s_mov_b32 s40, 645120
buffer_load_ushort v46, v4, s[16:19], s40 offen
s_mov_b32 s40, 646272
buffer_load_ushort v47, v4, s[16:19], s40 offen
s_mov_b32 s40, 18432
buffer_load_ushort v48, v5, s[16:19], s40 offen
s_mov_b32 s40, 19584
buffer_load_ushort v49, v5, s[16:19], s40 offen
s_mov_b32 s40, 39168
buffer_load_ushort v50, v5, s[16:19], s40 offen
s_mov_b32 s40, 40320
buffer_load_ushort v51, v5, s[16:19], s40 offen
s_mov_b32 s40, 59904
buffer_load_ushort v52, v5, s[16:19], s40 offen
s_mov_b32 s40, 61056
buffer_load_ushort v53, v5, s[16:19], s40 offen
s_mov_b32 s40, 80640
buffer_load_ushort v54, v5, s[16:19], s40 offen
s_mov_b32 s40, 81792
buffer_load_ushort v55, v5, s[16:19], s40 offen
s_mov_b32 s40, 350208
buffer_load_ushort v56, v5, s[16:19], s40 offen
s_mov_b32 s40, 351360
buffer_load_ushort v57, v5, s[16:19], s40 offen
s_mov_b32 s40, 370944
buffer_load_ushort v58, v5, s[16:19], s40 offen
s_mov_b32 s40, 372096
buffer_load_ushort v59, v5, s[16:19], s40 offen
s_mov_b32 s40, 391680
buffer_load_ushort v60, v5, s[16:19], s40 offen
s_mov_b32 s40, 392832
buffer_load_ushort v61, v5, s[16:19], s40 offen
s_mov_b32 s40, 412416
buffer_load_ushort v62, v5, s[16:19], s40 offen
s_mov_b32 s40, 413568
buffer_load_ushort v63, v5, s[16:19], s40 offen
s_waitcnt vmcnt(40)
v_lshl_or_b32 v128, v17, 16, v16
v_lshl_or_b32 v129, v19, 16, v18
v_lshl_or_b32 v130, v21, 16, v20
v_lshl_or_b32 v131, v23, 16, v22
s_waitcnt vmcnt(32)
v_lshl_or_b32 v132, v25, 16, v24
v_lshl_or_b32 v133, v27, 16, v26
v_lshl_or_b32 v134, v29, 16, v28
v_lshl_or_b32 v135, v31, 16, v30
s_waitcnt vmcnt(24)
v_lshl_or_b32 v136, v33, 16, v32
v_lshl_or_b32 v137, v35, 16, v34
v_lshl_or_b32 v138, v37, 16, v36
v_lshl_or_b32 v139, v39, 16, v38
s_waitcnt vmcnt(16)
v_lshl_or_b32 v140, v41, 16, v40
v_lshl_or_b32 v141, v43, 16, v42
v_lshl_or_b32 v142, v45, 16, v44
v_lshl_or_b32 v143, v47, 16, v46
s_waitcnt vmcnt(8)
v_lshl_or_b32 v144, v49, 16, v48
v_lshl_or_b32 v145, v51, 16, v50
v_lshl_or_b32 v146, v53, 16, v52
v_lshl_or_b32 v147, v55, 16, v54
s_waitcnt vmcnt(0)
v_lshl_or_b32 v148, v57, 16, v56
v_lshl_or_b32 v149, v59, 16, v58
v_lshl_or_b32 v150, v61, 16, v60
v_lshl_or_b32 v151, v63, 16, v62
s_mul_i32 s29, s21, 92160
s_lshl_b32 s30, s22, 10
s_add_u32 s29, s29, s30
s_add_u32 s29, s29, 6553600
s_add_u32 s40, s29, 0
buffer_store_dwordx4 v[80:83], v2, s[8:11], s40 offen
s_add_u32 s40, s29, 5120
buffer_store_dwordx4 v[84:87], v2, s[8:11], s40 offen
s_add_u32 s40, s29, 10240
buffer_store_dwordx4 v[88:91], v2, s[8:11], s40 offen
s_add_u32 s40, s29, 15360
buffer_store_dwordx4 v[92:95], v2, s[8:11], s40 offen
s_add_u32 s40, s29, 20480
buffer_store_dwordx4 v[96:99], v2, s[8:11], s40 offen
s_add_u32 s40, s29, 25600
buffer_store_dwordx4 v[100:103], v2, s[8:11], s40 offen
s_add_u32 s40, s29, 30720
buffer_store_dwordx4 v[104:107], v2, s[8:11], s40 offen
s_add_u32 s40, s29, 35840
buffer_store_dwordx4 v[108:111], v2, s[8:11], s40 offen
s_add_u32 s40, s29, 40960
buffer_store_dwordx4 v[112:115], v2, s[8:11], s40 offen
s_add_u32 s40, s29, 46080
buffer_store_dwordx4 v[116:119], v2, s[8:11], s40 offen
s_add_u32 s40, s29, 51200
buffer_store_dwordx4 v[120:123], v2, s[8:11], s40 offen
s_add_u32 s40, s29, 56320
buffer_store_dwordx4 v[124:127], v2, s[8:11], s40 offen
s_add_u32 s40, s29, 61440
buffer_store_dwordx4 v[128:131], v2, s[8:11], s40 offen
s_add_u32 s40, s29, 66560
buffer_store_dwordx4 v[132:135], v2, s[8:11], s40 offen
s_add_u32 s40, s29, 71680
buffer_store_dwordx4 v[136:139], v2, s[8:11], s40 offen
s_add_u32 s40, s29, 76800
buffer_store_dwordx4 v[140:143], v2, s[8:11], s40 offen
s_add_u32 s40, s29, 81920
buffer_store_dwordx4 v[144:147], v2, s[8:11], s40 offen
s_add_u32 s40, s29, 87040
buffer_store_dwordx4 v[148:151], v2, s[8:11], s40 offen
L_prep_end:
s_endpgm
.p2align 8
.globl main_kernel
.type main_kernel,@function
main_kernel:
s_cmp_ge_u32 s2, 256
s_cbranch_scc1 L_end
s_load_dwordx2 s[12:13], s[0:1], 72
v_and_b32 v1, 63, v0
v_lshrrev_b32 v3, 6, v0
v_lshlrev_b32 v2, 4, v1
v_readfirstlane_b32 s4, v3
s_and_b32 s5, s2, 7
s_lshr_b32 s6, s2, 3
s_waitcnt lgkmcnt(0)
s_mov_b32 s8, s12
s_and_b32 s9, s13, 0xffff
s_mov_b32 s10, 268435456
s_mov_b32 s11, 0x20000
s_mov_b32 s70, 23257088
s_mov_b32 s71, 27975680
s_mov_b32 s72, 32694272
s_mov_b32 s73, 37412864
s_mov_b32 s74, 42131456
s_mov_b32 s75, 42393600
s_mov_b32 s76, 80142336
s_mov_b32 s77, 0
s_mov_b32 s7, 0
s_lshr_b32 s20, s5, 2
s_lshl_b32 s20, s20, 3
s_lshr_b32 s21, s6, 2
s_add_u32 s20, s20, s21
s_and_b32 s21, s5, 3
s_lshl_b32 s21, s21, 2
s_and_b32 s22, s6, 3
s_add_u32 s21, s21, s22
s_mul_i32 s22, s21, 147456
s_add_u32 s22, s22, 4194304
s_mul_i32 s23, s4, 36864
s_add_u32 s22, s22, s23
s_add_u32 m0, s23, 0
s_add_u32 s40, s22, 0
buffer_load_dwordx4 v2, s[8:11], s40 offen offset:0 lds
buffer_load_dwordx4 v2, s[8:11], s40 offen offset:1024 lds
buffer_load_dwordx4 v2, s[8:11], s40 offen offset:2048 lds
buffer_load_dwordx4 v2, s[8:11], s40 offen offset:3072 lds
s_add_u32 m0, s23, 4096
s_add_u32 s40, s22, 4096
buffer_load_dwordx4 v2, s[8:11], s40 offen offset:0 lds
buffer_load_dwordx4 v2, s[8:11], s40 offen offset:1024 lds
buffer_load_dwordx4 v2, s[8:11], s40 offen offset:2048 lds
buffer_load_dwordx4 v2, s[8:11], s40 offen offset:3072 lds
s_add_u32 m0, s23, 8192
s_add_u32 s40, s22, 8192
buffer_load_dwordx4 v2, s[8:11], s40 offen offset:0 lds
buffer_load_dwordx4 v2, s[8:11], s40 offen offset:1024 lds
buffer_load_dwordx4 v2, s[8:11], s40 offen offset:2048 lds
buffer_load_dwordx4 v2, s[8:11], s40 offen offset:3072 lds
s_add_u32 m0, s23, 12288
s_add_u32 s40, s22, 12288
buffer_load_dwordx4 v2, s[8:11], s40 offen offset:0 lds
buffer_load_dwordx4 v2, s[8:11], s40 offen offset:1024 lds
buffer_load_dwordx4 v2, s[8:11], s40 offen offset:2048 lds
buffer_load_dwordx4 v2, s[8:11], s40 offen offset:3072 lds
s_add_u32 m0, s23, 16384
s_add_u32 s40, s22, 16384
buffer_load_dwordx4 v2, s[8:11], s40 offen offset:0 lds
buffer_load_dwordx4 v2, s[8:11], s40 offen offset:1024 lds
buffer_load_dwordx4 v2, s[8:11], s40 offen offset:2048 lds
buffer_load_dwordx4 v2, s[8:11], s40 offen offset:3072 lds
s_add_u32 m0, s23, 20480
s_add_u32 s40, s22, 20480
buffer_load_dwordx4 v2, s[8:11], s40 offen offset:0 lds
buffer_load_dwordx4 v2, s[8:11], s40 offen offset:1024 lds
buffer_load_dwordx4 v2, s[8:11], s40 offen offset:2048 lds
buffer_load_dwordx4 v2, s[8:11], s40 offen offset:3072 lds
s_add_u32 m0, s23, 24576
s_add_u32 s40, s22, 24576
buffer_load_dwordx4 v2, s[8:11], s40 offen offset:0 lds
buffer_load_dwordx4 v2, s[8:11], s40 offen offset:1024 lds
buffer_load_dwordx4 v2, s[8:11], s40 offen offset:2048 lds
buffer_load_dwordx4 v2, s[8:11], s40 offen offset:3072 lds
s_add_u32 m0, s23, 28672
s_add_u32 s40, s22, 28672
buffer_load_dwordx4 v2, s[8:11], s40 offen offset:0 lds
buffer_load_dwordx4 v2, s[8:11], s40 offen offset:1024 lds
buffer_load_dwordx4 v2, s[8:11], s40 offen offset:2048 lds
buffer_load_dwordx4 v2, s[8:11], s40 offen offset:3072 lds
s_add_u32 m0, s23, 32768
s_add_u32 s40, s22, 32768
buffer_load_dwordx4 v2, s[8:11], s40 offen offset:0 lds
buffer_load_dwordx4 v2, s[8:11], s40 offen offset:1024 lds
buffer_load_dwordx4 v2, s[8:11], s40 offen offset:2048 lds
buffer_load_dwordx4 v2, s[8:11], s40 offen offset:3072 lds
L_layer:
s_lshr_b32 s20, s5, 2
s_lshl_b32 s20, s20, 3
s_lshr_b32 s21, s6, 2
s_add_u32 s20, s20, s21
s_and_b32 s21, s5, 3
s_lshl_b32 s21, s21, 2
s_and_b32 s22, s6, 3
s_add_u32 s21, s21, s22
s_lshl_b32 s24, s20, 3
s_sub_u32 s25, s24, 1
s_max_i32 s35, s25, 0
s_mul_i32 s25, s35, 18432
s_lshl_b32 s26, s4, 1
s_add_u32 s36, s24, s26
s_mul_i32 s24, s36, 18432
s_add_u32 s26, s24, s70
s_add_u32 s27, s26, 18432
s_add_u32 s28, s25, s70
v_add_u32 v4, 0x10000, v2
v_add_u32 v5, 0x20000, v2
s_cmp_eq_u32 s4, 3
s_cselect_b32 s29, 0, s4
s_cselect_b32 s31, 16, 9
s_lshl_b32 s30, s29, 10
v_and_b32 v12, 15, v1
v_mov_b32 v13, 2146435072
v_cmp_le_u32 vcc, s31, v12
s_nop 1
v_cndmask_b32 v19, v13, v2, vcc
s_add_u32 s31, s30, 2048
v_add_u32 v6, s31, v2
v_add_u32 v7, s31, v4
v_add_u32 v8, s31, v5
s_add_u32 s31, s30, 5120
v_add_u32 v9, s31, v2
v_add_u32 v10, s31, v4
v_add_u32 v11, s31, v5
s_cmp_eq_u32 s7, 0
s_cbranch_scc1 L_a1go1
v_mul_u32_u24 v14, 43, v1
v_lshrrev_b32 v14, 8, v14
v_mul_u32_u24 v15, 6, v14
v_sub_u32 v15, v1, v15
v_cmp_eq_u32 vcc, 1, v14
v_mov_b32 v16, s36
s_nop 0
v_addc_co_u32 v16, vcc, 0, v16, vcc
v_cmp_eq_u32 vcc, 2, v14
v_mov_b32 v17, s35
s_nop 0
v_cndmask_b32 v16, v16, v17, vcc
v_lshlrev_b32 v16, 3, v16
v_add_lshl_u32 v16, v16, v15, 7
s_add_u32 s22, s77, 524288
s_mov_b32 s52, 0
L_poll2:
buffer_load_dword v253, v16, s[8:11], s22 offen sc1
s_add_u32 s52, s52, 1
s_waitcnt vmcnt(0)
v_cmp_eq_u32 vcc, 0, v253
s_cmp_ge_u32 s52, 0x100000
s_cbranch_scc1 L_got2
s_and_b64 exec, exec, vcc
s_cbranch_execnz L_poll2
L_got2:
s_mov_b64 exec, -1
L_a1go1:
buffer_load_dwordx4 a[0:3], v2, s[8:11], s26 offen offset:0 sc1
buffer_load_dwordx4 a[72:75], v2, s[8:11], s27 offen offset:0 sc1
buffer_load_dwordx4 a[144:147], v19, s[8:11], s28 offen offset:0 sc1
buffer_load_dwordx4 a[4:7], v2, s[8:11], s26 offen offset:1024 sc1
buffer_load_dwordx4 a[76:79], v2, s[8:11], s27 offen offset:1024 sc1
buffer_load_dwordx4 a[148:151], v19, s[8:11], s28 offen offset:1024 sc1
buffer_load_dwordx4 a[8:11], v2, s[8:11], s26 offen offset:2048 sc1
buffer_load_dwordx4 a[80:83], v2, s[8:11], s27 offen offset:2048 sc1
buffer_load_dwordx4 a[152:155], v19, s[8:11], s28 offen offset:2048 sc1
buffer_load_dwordx4 a[12:15], v2, s[8:11], s26 offen offset:3072 sc1
buffer_load_dwordx4 a[84:87], v2, s[8:11], s27 offen offset:3072 sc1
buffer_load_dwordx4 a[156:159], v19, s[8:11], s28 offen offset:3072 sc1
s_add_u32 s26, s26, 4096
s_add_u32 s27, s27, 4096
s_add_u32 s28, s28, 4096
buffer_load_dwordx4 a[16:19], v2, s[8:11], s26 offen offset:0 sc1
buffer_load_dwordx4 a[88:91], v2, s[8:11], s27 offen offset:0 sc1
buffer_load_dwordx4 a[160:163], v19, s[8:11], s28 offen offset:0 sc1
buffer_load_dwordx4 a[20:23], v2, s[8:11], s26 offen offset:1024 sc1
buffer_load_dwordx4 a[92:95], v2, s[8:11], s27 offen offset:1024 sc1
buffer_load_dwordx4 a[164:167], v19, s[8:11], s28 offen offset:1024 sc1
buffer_load_dwordx4 a[24:27], v2, s[8:11], s26 offen offset:2048 sc1
buffer_load_dwordx4 a[96:99], v2, s[8:11], s27 offen offset:2048 sc1
buffer_load_dwordx4 a[168:171], v19, s[8:11], s28 offen offset:2048 sc1
buffer_load_dwordx4 a[28:31], v2, s[8:11], s26 offen offset:3072 sc1
buffer_load_dwordx4 a[100:103], v2, s[8:11], s27 offen offset:3072 sc1
buffer_load_dwordx4 a[172:175], v19, s[8:11], s28 offen offset:3072 sc1
v_lshrrev_b32 v13, 4, v1
v_lshlrev_b32 v14, 2, v13
v_sub_u32 v14, v12, v14
v_subrev_u32 v15, 0, v14
v_cmp_gt_u32 s[52:53], 8, v15
v_cmp_gt_i32 s[44:45], -8, v15
v_subrev_u32 v15, 1, v14
v_cmp_gt_u32 s[54:55], 8, v15
v_cmp_gt_i32 s[46:47], -8, v15
v_subrev_u32 v15, 2, v14
v_cmp_gt_u32 s[56:57], 8, v15
v_cmp_gt_i32 s[48:49], -8, v15
v_subrev_u32 v15, 3, v14
v_cmp_gt_u32 s[58:59], 8, v15
v_cmp_gt_i32 s[50:51], -8, v15
s_and_b32 s31, s20, 7
s_or_b32 s31, s31, s4
s_cmp_eq_u32 s31, 0
s_cselect_b64 s[60:61], 0, s[44:45]
s_cselect_b64 s[62:63], 0, s[46:47]
s_cselect_b64 s[64:65], 0, s[48:49]
s_cselect_b64 s[66:67], 0, s[50:51]
s_cmp_eq_u32 s7, 0
s_cbranch_scc0 L_a1w1
s_waitcnt vmcnt(24)
s_barrier
L_a1w1:
ds_read_b128 a[216:219], v2 offset:0
ds_read_b128 a[220:223], v2 offset:8192
ds_read_b128 a[224:227], v2 offset:1024
ds_read_b128 a[228:231], v2 offset:9216
ds_read_b128 a[232:235], v2 offset:2048
ds_read_b128 a[236:239], v2 offset:10240
s_waitcnt vmcnt(18)
s_waitcnt lgkmcnt(4)
v_mfma_f32_16x16x32_bf16 v[32:35], a[216:219], a[0:3], 0
s_add_u32 s26, s26, 4096
s_add_u32 s27, s27, 4096
s_add_u32 s28, s28, 4096
buffer_load_dwordx4 a[32:35], v2, s[8:11], s26 offen offset:0 sc1
v_mfma_f32_16x16x32_bf16 v[32:35], a[220:223], a[4:7], v[32:35]
ds_read_b128 a[240:243], v2 offset:3072
v_mfma_f32_16x16x32_bf16 v[36:39], a[216:219], a[72:75], 0
v_mfma_f32_16x16x32_bf16 v[36:39], a[220:223], a[76:79], v[36:39]
ds_read_b128 a[244:247], v2 offset:11264
s_waitcnt lgkmcnt(4)
v_mfma_f32_16x16x32_bf16 v[40:43], a[224:227], a[0:3], 0
buffer_load_dwordx4 a[104:107], v2, s[8:11], s27 offen offset:0 sc1
v_mfma_f32_16x16x32_bf16 v[40:43], a[228:231], a[4:7], v[40:43]
ds_read_b128 a[216:219], v2 offset:4096
v_mfma_f32_16x16x32_bf16 v[44:47], a[224:227], a[72:75], 0
v_mfma_f32_16x16x32_bf16 v[44:47], a[228:231], a[76:79], v[44:47]
ds_read_b128 a[220:223], v2 offset:12288
s_waitcnt lgkmcnt(4)
v_mfma_f32_16x16x32_bf16 v[48:51], a[232:235], a[0:3], 0
buffer_load_dwordx4 a[176:179], v19, s[8:11], s28 offen offset:0 sc1
v_mfma_f32_16x16x32_bf16 v[48:51], a[236:239], a[4:7], v[48:51]
ds_read_b128 a[224:227], v2 offset:5120
v_mfma_f32_16x16x32_bf16 v[52:55], a[232:235], a[72:75], 0
v_mfma_f32_16x16x32_bf16 v[52:55], a[236:239], a[76:79], v[52:55]
ds_read_b128 a[228:231], v2 offset:13312
s_waitcnt lgkmcnt(4)
v_mfma_f32_16x16x32_bf16 v[56:59], a[240:243], a[0:3], 0
buffer_load_dwordx4 a[36:39], v2, s[8:11], s26 offen offset:1024 sc1
v_mfma_f32_16x16x32_bf16 v[56:59], a[244:247], a[4:7], v[56:59]
ds_read_b128 a[232:235], v2 offset:6144
v_mfma_f32_16x16x32_bf16 v[60:63], a[240:243], a[72:75], 0
v_mfma_f32_16x16x32_bf16 v[60:63], a[244:247], a[76:79], v[60:63]
ds_read_b128 a[236:239], v2 offset:14336
s_waitcnt lgkmcnt(4)
v_mfma_f32_16x16x32_bf16 v[64:67], a[216:219], a[0:3], 0
buffer_load_dwordx4 a[108:111], v2, s[8:11], s27 offen offset:1024 sc1
v_mfma_f32_16x16x32_bf16 v[64:67], a[220:223], a[4:7], v[64:67]
ds_read_b128 a[240:243], v2 offset:7168
v_mfma_f32_16x16x32_bf16 v[68:71], a[216:219], a[72:75], 0
v_mfma_f32_16x16x32_bf16 v[68:71], a[220:223], a[76:79], v[68:71]
ds_read_b128 a[244:247], v2 offset:15360
s_waitcnt lgkmcnt(4)
v_mfma_f32_16x16x32_bf16 v[72:75], a[0:3], a[224:227], 0
buffer_load_dwordx4 a[180:183], v19, s[8:11], s28 offen offset:1024 sc1
v_mfma_f32_16x16x32_bf16 v[72:75], a[4:7], a[228:231], v[72:75]
ds_read_b128 a[216:219], v6 offset:0
v_mfma_f32_16x16x32_bf16 v[76:79], a[72:75], a[224:227], 0
v_mfma_f32_16x16x32_bf16 v[76:79], a[76:79], a[228:231], v[76:79]
ds_read_b128 a[220:223], v6 offset:8192
s_waitcnt lgkmcnt(4)
v_mfma_f32_16x16x32_bf16 v[80:83], a[0:3], a[232:235], 0
buffer_load_dwordx4 a[40:43], v2, s[8:11], s26 offen offset:2048 sc1
v_mfma_f32_16x16x32_bf16 v[80:83], a[4:7], a[236:239], v[80:83]
ds_read_b128 a[224:227], v9 offset:0
v_mfma_f32_16x16x32_bf16 v[84:87], a[72:75], a[232:235], 0
v_mfma_f32_16x16x32_bf16 v[84:87], a[76:79], a[236:239], v[84:87]
ds_read_b128 a[228:231], v9 offset:8192
s_waitcnt lgkmcnt(4)
v_mfma_f32_16x16x32_bf16 v[88:91], a[0:3], a[240:243], 0
buffer_load_dwordx4 a[112:115], v2, s[8:11], s27 offen offset:2048 sc1
v_mfma_f32_16x16x32_bf16 v[88:91], a[4:7], a[244:247], v[88:91]
ds_read_b128 a[232:235], v2 offset:16384
v_mfma_f32_16x16x32_bf16 v[92:95], a[72:75], a[240:243], 0
v_mfma_f32_16x16x32_bf16 v[92:95], a[76:79], a[244:247], v[92:95]
ds_read_b128 a[236:239], v2 offset:24576
s_waitcnt lgkmcnt(4)
v_mfma_f32_16x16x32_bf16 v[96:99], a[216:219], a[144:147], 0
ds_read_b128 a[240:243], v2 offset:17408
buffer_load_dwordx4 a[184:187], v19, s[8:11], s28 offen offset:2048 sc1
v_mfma_f32_16x16x32_bf16 v[96:99], a[220:223], a[148:151], v[96:99]
ds_read_b128 a[244:247], v2 offset:25600
s_waitcnt lgkmcnt(4)
v_mfma_f32_16x16x32_bf16 v[100:103], a[144:147], a[224:227], 0
ds_read_b128 a[216:219], v2 offset:18432
v_mfma_f32_16x16x32_bf16 v[100:103], a[148:151], a[228:231], v[100:103]
ds_read_b128 a[220:223], v2 offset:26624
s_waitcnt vmcnt(21)
s_waitcnt lgkmcnt(4)
v_mfma_f32_16x16x32_bf16 v[32:35], a[232:235], a[8:11], v[32:35]
buffer_load_dwordx4 a[44:47], v2, s[8:11], s26 offen offset:3072 sc1
v_mfma_f32_16x16x32_bf16 v[32:35], a[236:239], a[12:15], v[32:35]
ds_read_b128 a[224:227], v2 offset:19456
v_mfma_f32_16x16x32_bf16 v[36:39], a[232:235], a[80:83], v[36:39]
v_mfma_f32_16x16x32_bf16 v[36:39], a[236:239], a[84:87], v[36:39]
ds_read_b128 a[228:231], v2 offset:27648
s_waitcnt lgkmcnt(4)
v_mfma_f32_16x16x32_bf16 v[40:43], a[240:243], a[8:11], v[40:43]
buffer_load_dwordx4 a[116:119], v2, s[8:11], s27 offen offset:3072 sc1
v_mfma_f32_16x16x32_bf16 v[40:43], a[244:247], a[12:15], v[40:43]
ds_read_b128 a[232:235], v2 offset:20480
v_mfma_f32_16x16x32_bf16 v[44:47], a[240:243], a[80:83], v[44:47]
v_mfma_f32_16x16x32_bf16 v[44:47], a[244:247], a[84:87], v[44:47]
ds_read_b128 a[236:239], v2 offset:28672
s_waitcnt lgkmcnt(4)
v_mfma_f32_16x16x32_bf16 v[48:51], a[216:219], a[8:11], v[48:51]
buffer_load_dwordx4 a[188:191], v19, s[8:11], s28 offen offset:3072 sc1
v_mfma_f32_16x16x32_bf16 v[48:51], a[220:223], a[12:15], v[48:51]
ds_read_b128 a[240:243], v2 offset:21504
v_mfma_f32_16x16x32_bf16 v[52:55], a[216:219], a[80:83], v[52:55]
v_mfma_f32_16x16x32_bf16 v[52:55], a[220:223], a[84:87], v[52:55]
ds_read_b128 a[244:247], v2 offset:29696
s_waitcnt lgkmcnt(4)
v_mfma_f32_16x16x32_bf16 v[56:59], a[224:227], a[8:11], v[56:59]
s_add_u32 s26, s26, 4096
s_add_u32 s27, s27, 4096
s_add_u32 s28, s28, 4096
buffer_load_dwordx4 a[48:51], v2, s[8:11], s26 offen offset:0 sc1
v_mfma_f32_16x16x32_bf16 v[56:59], a[228:231], a[12:15], v[56:59]
ds_read_b128 a[216:219], v2 offset:22528
v_mfma_f32_16x16x32_bf16 v[60:63], a[224:227], a[80:83], v[60:63]
v_mfma_f32_16x16x32_bf16 v[60:63], a[228:231], a[84:87], v[60:63]
ds_read_b128 a[220:223], v2 offset:30720
s_waitcnt lgkmcnt(4)
v_mfma_f32_16x16x32_bf16 v[64:67], a[232:235], a[8:11], v[64:67]
buffer_load_dwordx4 a[120:123], v2, s[8:11], s27 offen offset:0 sc1
v_mfma_f32_16x16x32_bf16 v[64:67], a[236:239], a[12:15], v[64:67]
ds_read_b128 a[224:227], v2 offset:23552
v_mfma_f32_16x16x32_bf16 v[68:71], a[232:235], a[80:83], v[68:71]
v_mfma_f32_16x16x32_bf16 v[68:71], a[236:239], a[84:87], v[68:71]
ds_read_b128 a[228:231], v2 offset:31744
s_waitcnt lgkmcnt(4)
v_mfma_f32_16x16x32_bf16 v[72:75], a[8:11], a[240:243], v[72:75]
buffer_load_dwordx4 a[192:195], v19, s[8:11], s28 offen offset:0 sc1
v_mfma_f32_16x16x32_bf16 v[72:75], a[12:15], a[244:247], v[72:75]
ds_read_b128 a[232:235], v6 offset:16384
v_mfma_f32_16x16x32_bf16 v[76:79], a[80:83], a[240:243], v[76:79]
v_mfma_f32_16x16x32_bf16 v[76:79], a[84:87], a[244:247], v[76:79]
ds_read_b128 a[236:239], v6 offset:24576
s_waitcnt lgkmcnt(4)
v_mfma_f32_16x16x32_bf16 v[80:83], a[8:11], a[216:219], v[80:83]
buffer_load_dwordx4 a[52:55], v2, s[8:11], s26 offen offset:1024 sc1
v_mfma_f32_16x16x32_bf16 v[80:83], a[12:15], a[220:223], v[80:83]
ds_read_b128 a[240:243], v9 offset:16384
v_mfma_f32_16x16x32_bf16 v[84:87], a[80:83], a[216:219], v[84:87]
v_mfma_f32_16x16x32_bf16 v[84:87], a[84:87], a[220:223], v[84:87]
ds_read_b128 a[244:247], v9 offset:24576
s_waitcnt lgkmcnt(4)
v_mfma_f32_16x16x32_bf16 v[88:91], a[8:11], a[224:227], v[88:91]
buffer_load_dwordx4 a[124:127], v2, s[8:11], s27 offen offset:1024 sc1
v_mfma_f32_16x16x32_bf16 v[88:91], a[12:15], a[228:231], v[88:91]
ds_read_b128 a[216:219], v2 offset:32768
v_mfma_f32_16x16x32_bf16 v[92:95], a[80:83], a[224:227], v[92:95]
v_mfma_f32_16x16x32_bf16 v[92:95], a[84:87], a[228:231], v[92:95]
ds_read_b128 a[220:223], v2 offset:40960
s_waitcnt lgkmcnt(4)
v_mfma_f32_16x16x32_bf16 v[96:99], a[232:235], a[152:155], v[96:99]
ds_read_b128 a[224:227], v2 offset:33792
buffer_load_dwordx4 a[196:199], v19, s[8:11], s28 offen offset:1024 sc1
v_mfma_f32_16x16x32_bf16 v[96:99], a[236:239], a[156:159], v[96:99]
ds_read_b128 a[228:231], v2 offset:41984
s_waitcnt lgkmcnt(4)
v_mfma_f32_16x16x32_bf16 v[100:103], a[152:155], a[240:243], v[100:103]
ds_read_b128 a[232:235], v2 offset:34816
v_mfma_f32_16x16x32_bf16 v[100:103], a[156:159], a[244:247], v[100:103]
ds_read_b128 a[236:239], v2 offset:43008
s_waitcnt vmcnt(24)
s_waitcnt lgkmcnt(4)
v_mfma_f32_16x16x32_bf16 v[32:35], a[216:219], a[16:19], v[32:35]
buffer_load_dwordx4 a[56:59], v2, s[8:11], s26 offen offset:2048 sc1
v_mfma_f32_16x16x32_bf16 v[32:35], a[220:223], a[20:23], v[32:35]
ds_read_b128 a[240:243], v2 offset:35840
v_mfma_f32_16x16x32_bf16 v[36:39], a[216:219], a[88:91], v[36:39]
v_mfma_f32_16x16x32_bf16 v[36:39], a[220:223], a[92:95], v[36:39]
ds_read_b128 a[244:247], v2 offset:44032
s_waitcnt lgkmcnt(4)
v_mfma_f32_16x16x32_bf16 v[40:43], a[224:227], a[16:19], v[40:43]
buffer_load_dwordx4 a[128:131], v2, s[8:11], s27 offen offset:2048 sc1
v_mfma_f32_16x16x32_bf16 v[40:43], a[228:231], a[20:23], v[40:43]
ds_read_b128 a[216:219], v2 offset:36864
v_mfma_f32_16x16x32_bf16 v[44:47], a[224:227], a[88:91], v[44:47]
v_mfma_f32_16x16x32_bf16 v[44:47], a[228:231], a[92:95], v[44:47]
ds_read_b128 a[220:223], v2 offset:45056
s_waitcnt lgkmcnt(4)
v_mfma_f32_16x16x32_bf16 v[48:51], a[232:235], a[16:19], v[48:51]
buffer_load_dwordx4 a[200:203], v19, s[8:11], s28 offen offset:2048 sc1
v_mfma_f32_16x16x32_bf16 v[48:51], a[236:239], a[20:23], v[48:51]
ds_read_b128 a[224:227], v2 offset:37888
v_mfma_f32_16x16x32_bf16 v[52:55], a[232:235], a[88:91], v[52:55]
v_mfma_f32_16x16x32_bf16 v[52:55], a[236:239], a[92:95], v[52:55]
ds_read_b128 a[228:231], v2 offset:46080
s_waitcnt lgkmcnt(4)
v_mfma_f32_16x16x32_bf16 v[56:59], a[240:243], a[16:19], v[56:59]
buffer_load_dwordx4 a[60:63], v2, s[8:11], s26 offen offset:3072 sc1
v_mfma_f32_16x16x32_bf16 v[56:59], a[244:247], a[20:23], v[56:59]
ds_read_b128 a[232:235], v2 offset:38912
v_mfma_f32_16x16x32_bf16 v[60:63], a[240:243], a[88:91], v[60:63]
v_mfma_f32_16x16x32_bf16 v[60:63], a[244:247], a[92:95], v[60:63]
ds_read_b128 a[236:239], v2 offset:47104
s_waitcnt lgkmcnt(4)
v_mfma_f32_16x16x32_bf16 v[64:67], a[216:219], a[16:19], v[64:67]
buffer_load_dwordx4 a[132:135], v2, s[8:11], s27 offen offset:3072 sc1
v_mfma_f32_16x16x32_bf16 v[64:67], a[220:223], a[20:23], v[64:67]
ds_read_b128 a[240:243], v2 offset:39936
v_mfma_f32_16x16x32_bf16 v[68:71], a[216:219], a[88:91], v[68:71]
v_mfma_f32_16x16x32_bf16 v[68:71], a[220:223], a[92:95], v[68:71]
ds_read_b128 a[244:247], v2 offset:48128
s_waitcnt lgkmcnt(4)
v_mfma_f32_16x16x32_bf16 v[72:75], a[16:19], a[224:227], v[72:75]
buffer_load_dwordx4 a[204:207], v19, s[8:11], s28 offen offset:3072 sc1
v_mfma_f32_16x16x32_bf16 v[72:75], a[20:23], a[228:231], v[72:75]
ds_read_b128 a[216:219], v6 offset:32768
v_mfma_f32_16x16x32_bf16 v[76:79], a[88:91], a[224:227], v[76:79]
v_mfma_f32_16x16x32_bf16 v[76:79], a[92:95], a[228:231], v[76:79]
ds_read_b128 a[220:223], v6 offset:40960
s_waitcnt lgkmcnt(4)
v_mfma_f32_16x16x32_bf16 v[80:83], a[16:19], a[232:235], v[80:83]
s_add_u32 s26, s26, 4096
s_add_u32 s27, s27, 4096
s_add_u32 s28, s28, 4096
buffer_load_dwordx4 a[64:67], v2, s[8:11], s26 offen offset:0 sc1
v_mfma_f32_16x16x32_bf16 v[80:83], a[20:23], a[236:239], v[80:83]
ds_read_b128 a[224:227], v9 offset:32768
v_mfma_f32_16x16x32_bf16 v[84:87], a[88:91], a[232:235], v[84:87]
v_mfma_f32_16x16x32_bf16 v[84:87], a[92:95], a[236:239], v[84:87]
ds_read_b128 a[228:231], v9 offset:40960
s_waitcnt lgkmcnt(4)
v_mfma_f32_16x16x32_bf16 v[88:91], a[16:19], a[240:243], v[88:91]
buffer_load_dwordx4 a[136:139], v2, s[8:11], s27 offen offset:0 sc1
v_mfma_f32_16x16x32_bf16 v[88:91], a[20:23], a[244:247], v[88:91]
ds_read_b128 a[232:235], v2 offset:49152
v_mfma_f32_16x16x32_bf16 v[92:95], a[88:91], a[240:243], v[92:95]
v_mfma_f32_16x16x32_bf16 v[92:95], a[92:95], a[244:247], v[92:95]
ds_read_b128 a[236:239], v2 offset:57344
s_waitcnt lgkmcnt(4)
v_mfma_f32_16x16x32_bf16 v[96:99], a[216:219], a[160:163], v[96:99]
ds_read_b128 a[240:243], v2 offset:50176
buffer_load_dwordx4 a[208:211], v19, s[8:11], s28 offen offset:0 sc1
v_mfma_f32_16x16x32_bf16 v[96:99], a[220:223], a[164:167], v[96:99]
ds_read_b128 a[244:247], v2 offset:58368
s_waitcnt lgkmcnt(4)
v_mfma_f32_16x16x32_bf16 v[100:103], a[160:163], a[224:227], v[100:103]
ds_read_b128 a[216:219], v2 offset:51200
v_mfma_f32_16x16x32_bf16 v[100:103], a[164:167], a[228:231], v[100:103]
ds_read_b128 a[220:223], v2 offset:59392
s_waitcnt vmcnt(27)
s_waitcnt lgkmcnt(4)
v_mfma_f32_16x16x32_bf16 v[32:35], a[232:235], a[24:27], v[32:35]
buffer_load_dwordx4 a[68:71], v2, s[8:11], s26 offen offset:1024 sc1
v_mfma_f32_16x16x32_bf16 v[32:35], a[236:239], a[28:31], v[32:35]
ds_read_b128 a[224:227], v2 offset:52224
v_mfma_f32_16x16x32_bf16 v[36:39], a[232:235], a[96:99], v[36:39]
v_mfma_f32_16x16x32_bf16 v[36:39], a[236:239], a[100:103], v[36:39]
ds_read_b128 a[228:231], v2 offset:60416
s_waitcnt lgkmcnt(4)
v_mfma_f32_16x16x32_bf16 v[40:43], a[240:243], a[24:27], v[40:43]
buffer_load_dwordx4 a[140:143], v2, s[8:11], s27 offen offset:1024 sc1
v_mfma_f32_16x16x32_bf16 v[40:43], a[244:247], a[28:31], v[40:43]
ds_read_b128 a[232:235], v2 offset:53248
v_mfma_f32_16x16x32_bf16 v[44:47], a[240:243], a[96:99], v[44:47]
v_mfma_f32_16x16x32_bf16 v[44:47], a[244:247], a[100:103], v[44:47]
ds_read_b128 a[236:239], v2 offset:61440
s_waitcnt lgkmcnt(4)
v_mfma_f32_16x16x32_bf16 v[48:51], a[216:219], a[24:27], v[48:51]
buffer_load_dwordx4 a[212:215], v19, s[8:11], s28 offen offset:1024 sc1
v_mfma_f32_16x16x32_bf16 v[48:51], a[220:223], a[28:31], v[48:51]
ds_read_b128 a[240:243], v2 offset:54272
v_mfma_f32_16x16x32_bf16 v[52:55], a[216:219], a[96:99], v[52:55]
v_mfma_f32_16x16x32_bf16 v[52:55], a[220:223], a[100:103], v[52:55]
ds_read_b128 a[244:247], v2 offset:62464
s_waitcnt lgkmcnt(4)
v_mfma_f32_16x16x32_bf16 v[56:59], a[224:227], a[24:27], v[56:59]
v_mfma_f32_16x16x32_bf16 v[56:59], a[228:231], a[28:31], v[56:59]
ds_read_b128 a[216:219], v2 offset:55296
v_mfma_f32_16x16x32_bf16 v[60:63], a[224:227], a[96:99], v[60:63]
v_mfma_f32_16x16x32_bf16 v[60:63], a[228:231], a[100:103], v[60:63]
ds_read_b128 a[220:223], v2 offset:63488
s_waitcnt lgkmcnt(4)
v_mfma_f32_16x16x32_bf16 v[64:67], a[232:235], a[24:27], v[64:67]
v_mfma_f32_16x16x32_bf16 v[64:67], a[236:239], a[28:31], v[64:67]
ds_read_b128 a[224:227], v2 offset:56320
v_mfma_f32_16x16x32_bf16 v[68:71], a[232:235], a[96:99], v[68:71]
v_mfma_f32_16x16x32_bf16 v[68:71], a[236:239], a[100:103], v[68:71]
ds_read_b128 a[228:231], v2 offset:64512
s_waitcnt lgkmcnt(4)
v_mfma_f32_16x16x32_bf16 v[72:75], a[24:27], a[240:243], v[72:75]
v_mfma_f32_16x16x32_bf16 v[72:75], a[28:31], a[244:247], v[72:75]
ds_read_b128 a[232:235], v6 offset:49152
v_mfma_f32_16x16x32_bf16 v[76:79], a[96:99], a[240:243], v[76:79]
v_mfma_f32_16x16x32_bf16 v[76:79], a[100:103], a[244:247], v[76:79]
ds_read_b128 a[236:239], v6 offset:57344
s_waitcnt lgkmcnt(4)
v_mfma_f32_16x16x32_bf16 v[80:83], a[24:27], a[216:219], v[80:83]
v_mfma_f32_16x16x32_bf16 v[80:83], a[28:31], a[220:223], v[80:83]
ds_read_b128 a[240:243], v9 offset:49152
v_mfma_f32_16x16x32_bf16 v[84:87], a[96:99], a[216:219], v[84:87]
v_mfma_f32_16x16x32_bf16 v[84:87], a[100:103], a[220:223], v[84:87]
ds_read_b128 a[244:247], v9 offset:57344
s_waitcnt lgkmcnt(4)
v_mfma_f32_16x16x32_bf16 v[88:91], a[24:27], a[224:227], v[88:91]
v_mfma_f32_16x16x32_bf16 v[88:91], a[28:31], a[228:231], v[88:91]
ds_read_b128 a[216:219], v4 offset:0
v_mfma_f32_16x16x32_bf16 v[92:95], a[96:99], a[224:227], v[92:95]
v_mfma_f32_16x16x32_bf16 v[92:95], a[100:103], a[228:231], v[92:95]
ds_read_b128 a[220:223], v4 offset:8192
s_waitcnt lgkmcnt(4)
v_mfma_f32_16x16x32_bf16 v[96:99], a[232:235], a[168:171], v[96:99]
ds_read_b128 a[224:227], v4 offset:1024
v_mfma_f32_16x16x32_bf16 v[96:99], a[236:239], a[172:175], v[96:99]
ds_read_b128 a[228:231], v4 offset:9216
s_waitcnt lgkmcnt(4)
v_mfma_f32_16x16x32_bf16 v[100:103], a[168:171], a[240:243], v[100:103]
ds_read_b128 a[232:235], v4 offset:2048
v_mfma_f32_16x16x32_bf16 v[100:103], a[172:175], a[244:247], v[100:103]
ds_read_b128 a[236:239], v4 offset:10240
s_waitcnt vmcnt(24)
s_waitcnt lgkmcnt(4)
v_mfma_f32_16x16x32_bf16 v[32:35], a[216:219], a[32:35], v[32:35]
v_mfma_f32_16x16x32_bf16 v[32:35], a[220:223], a[36:39], v[32:35]
ds_read_b128 a[240:243], v4 offset:3072
v_mfma_f32_16x16x32_bf16 v[36:39], a[216:219], a[104:107], v[36:39]
v_mfma_f32_16x16x32_bf16 v[36:39], a[220:223], a[108:111], v[36:39]
ds_read_b128 a[244:247], v4 offset:11264
s_waitcnt lgkmcnt(4)
v_mfma_f32_16x16x32_bf16 v[40:43], a[224:227], a[32:35], v[40:43]
v_mfma_f32_16x16x32_bf16 v[40:43], a[228:231], a[36:39], v[40:43]
ds_read_b128 a[216:219], v4 offset:4096
v_mfma_f32_16x16x32_bf16 v[44:47], a[224:227], a[104:107], v[44:47]
v_mfma_f32_16x16x32_bf16 v[44:47], a[228:231], a[108:111], v[44:47]
ds_read_b128 a[220:223], v4 offset:12288
s_waitcnt lgkmcnt(4)
v_mfma_f32_16x16x32_bf16 v[48:51], a[232:235], a[32:35], v[48:51]
v_mfma_f32_16x16x32_bf16 v[48:51], a[236:239], a[36:39], v[48:51]
ds_read_b128 a[224:227], v4 offset:5120
v_mfma_f32_16x16x32_bf16 v[52:55], a[232:235], a[104:107], v[52:55]
v_mfma_f32_16x16x32_bf16 v[52:55], a[236:239], a[108:111], v[52:55]
ds_read_b128 a[228:231], v4 offset:13312
s_waitcnt lgkmcnt(4)
v_mfma_f32_16x16x32_bf16 v[56:59], a[240:243], a[32:35], v[56:59]
v_mfma_f32_16x16x32_bf16 v[56:59], a[244:247], a[36:39], v[56:59]
ds_read_b128 a[232:235], v4 offset:6144
v_mfma_f32_16x16x32_bf16 v[60:63], a[240:243], a[104:107], v[60:63]
v_mfma_f32_16x16x32_bf16 v[60:63], a[244:247], a[108:111], v[60:63]
ds_read_b128 a[236:239], v4 offset:14336
s_waitcnt lgkmcnt(4)
v_mfma_f32_16x16x32_bf16 v[64:67], a[216:219], a[32:35], v[64:67]
v_mfma_f32_16x16x32_bf16 v[64:67], a[220:223], a[36:39], v[64:67]
ds_read_b128 a[240:243], v4 offset:7168
v_mfma_f32_16x16x32_bf16 v[68:71], a[216:219], a[104:107], v[68:71]
v_mfma_f32_16x16x32_bf16 v[68:71], a[220:223], a[108:111], v[68:71]
ds_read_b128 a[244:247], v4 offset:15360
s_waitcnt lgkmcnt(4)
v_mfma_f32_16x16x32_bf16 v[72:75], a[32:35], a[224:227], v[72:75]
v_mfma_f32_16x16x32_bf16 v[72:75], a[36:39], a[228:231], v[72:75]
ds_read_b128 a[216:219], v7 offset:0
v_mfma_f32_16x16x32_bf16 v[76:79], a[104:107], a[224:227], v[76:79]
v_mfma_f32_16x16x32_bf16 v[76:79], a[108:111], a[228:231], v[76:79]
ds_read_b128 a[220:223], v7 offset:8192
s_waitcnt lgkmcnt(4)
v_mfma_f32_16x16x32_bf16 v[80:83], a[32:35], a[232:235], v[80:83]
v_mfma_f32_16x16x32_bf16 v[80:83], a[36:39], a[236:239], v[80:83]
ds_read_b128 a[224:227], v10 offset:0
v_mfma_f32_16x16x32_bf16 v[84:87], a[104:107], a[232:235], v[84:87]
v_mfma_f32_16x16x32_bf16 v[84:87], a[108:111], a[236:239], v[84:87]
ds_read_b128 a[228:231], v10 offset:8192
s_waitcnt lgkmcnt(4)
v_mfma_f32_16x16x32_bf16 v[88:91], a[32:35], a[240:243], v[88:91]
v_mfma_f32_16x16x32_bf16 v[88:91], a[36:39], a[244:247], v[88:91]
ds_read_b128 a[232:235], v4 offset:16384
v_mfma_f32_16x16x32_bf16 v[92:95], a[104:107], a[240:243], v[92:95]
v_mfma_f32_16x16x32_bf16 v[92:95], a[108:111], a[244:247], v[92:95]
ds_read_b128 a[236:239], v4 offset:24576
s_waitcnt lgkmcnt(4)
v_mfma_f32_16x16x32_bf16 v[96:99], a[216:219], a[176:179], v[96:99]
ds_read_b128 a[240:243], v4 offset:17408
v_mfma_f32_16x16x32_bf16 v[96:99], a[220:223], a[180:183], v[96:99]
ds_read_b128 a[244:247], v4 offset:25600
s_waitcnt lgkmcnt(4)
v_mfma_f32_16x16x32_bf16 v[100:103], a[176:179], a[224:227], v[100:103]
ds_read_b128 a[216:219], v4 offset:18432
v_mfma_f32_16x16x32_bf16 v[100:103], a[180:183], a[228:231], v[100:103]
ds_read_b128 a[220:223], v4 offset:26624
s_waitcnt vmcnt(18)
s_waitcnt lgkmcnt(4)
v_mfma_f32_16x16x32_bf16 v[32:35], a[232:235], a[40:43], v[32:35]
v_mfma_f32_16x16x32_bf16 v[32:35], a[236:239], a[44:47], v[32:35]
ds_read_b128 a[224:227], v4 offset:19456
v_mfma_f32_16x16x32_bf16 v[36:39], a[232:235], a[112:115], v[36:39]
v_mfma_f32_16x16x32_bf16 v[36:39], a[236:239], a[116:119], v[36:39]
ds_read_b128 a[228:231], v4 offset:27648
s_waitcnt lgkmcnt(4)
v_mfma_f32_16x16x32_bf16 v[40:43], a[240:243], a[40:43], v[40:43]
v_mfma_f32_16x16x32_bf16 v[40:43], a[244:247], a[44:47], v[40:43]
ds_read_b128 a[232:235], v4 offset:20480
v_mfma_f32_16x16x32_bf16 v[44:47], a[240:243], a[112:115], v[44:47]
v_mfma_f32_16x16x32_bf16 v[44:47], a[244:247], a[116:119], v[44:47]
ds_read_b128 a[236:239], v4 offset:28672
s_waitcnt lgkmcnt(4)
v_mfma_f32_16x16x32_bf16 v[48:51], a[216:219], a[40:43], v[48:51]
v_mfma_f32_16x16x32_bf16 v[48:51], a[220:223], a[44:47], v[48:51]
ds_read_b128 a[240:243], v4 offset:21504
v_mfma_f32_16x16x32_bf16 v[52:55], a[216:219], a[112:115], v[52:55]
v_mfma_f32_16x16x32_bf16 v[52:55], a[220:223], a[116:119], v[52:55]
ds_read_b128 a[244:247], v4 offset:29696
s_waitcnt lgkmcnt(4)
v_mfma_f32_16x16x32_bf16 v[56:59], a[224:227], a[40:43], v[56:59]
v_mfma_f32_16x16x32_bf16 v[56:59], a[228:231], a[44:47], v[56:59]
ds_read_b128 a[216:219], v4 offset:22528
v_mfma_f32_16x16x32_bf16 v[60:63], a[224:227], a[112:115], v[60:63]
v_mfma_f32_16x16x32_bf16 v[60:63], a[228:231], a[116:119], v[60:63]
ds_read_b128 a[220:223], v4 offset:30720
s_waitcnt lgkmcnt(4)
v_mfma_f32_16x16x32_bf16 v[64:67], a[232:235], a[40:43], v[64:67]
v_mfma_f32_16x16x32_bf16 v[64:67], a[236:239], a[44:47], v[64:67]
ds_read_b128 a[224:227], v4 offset:23552
v_mfma_f32_16x16x32_bf16 v[68:71], a[232:235], a[112:115], v[68:71]
v_mfma_f32_16x16x32_bf16 v[68:71], a[236:239], a[116:119], v[68:71]
ds_read_b128 a[228:231], v4 offset:31744
s_waitcnt lgkmcnt(4)
v_mfma_f32_16x16x32_bf16 v[72:75], a[40:43], a[240:243], v[72:75]
v_mfma_f32_16x16x32_bf16 v[72:75], a[44:47], a[244:247], v[72:75]
ds_read_b128 a[232:235], v7 offset:16384
v_mfma_f32_16x16x32_bf16 v[76:79], a[112:115], a[240:243], v[76:79]
v_mfma_f32_16x16x32_bf16 v[76:79], a[116:119], a[244:247], v[76:79]
ds_read_b128 a[236:239], v7 offset:24576
s_waitcnt lgkmcnt(4)
v_mfma_f32_16x16x32_bf16 v[80:83], a[40:43], a[216:219], v[80:83]
v_mfma_f32_16x16x32_bf16 v[80:83], a[44:47], a[220:223], v[80:83]
ds_read_b128 a[240:243], v10 offset:16384
v_mfma_f32_16x16x32_bf16 v[84:87], a[112:115], a[216:219], v[84:87]
v_mfma_f32_16x16x32_bf16 v[84:87], a[116:119], a[220:223], v[84:87]
ds_read_b128 a[244:247], v10 offset:24576
s_waitcnt lgkmcnt(4)
v_mfma_f32_16x16x32_bf16 v[88:91], a[40:43], a[224:227], v[88:91]
v_mfma_f32_16x16x32_bf16 v[88:91], a[44:47], a[228:231], v[88:91]
ds_read_b128 a[216:219], v4 offset:32768
v_mfma_f32_16x16x32_bf16 v[92:95], a[112:115], a[224:227], v[92:95]
v_mfma_f32_16x16x32_bf16 v[92:95], a[116:119], a[228:231], v[92:95]
ds_read_b128 a[220:223], v4 offset:40960
s_waitcnt lgkmcnt(4)
v_mfma_f32_16x16x32_bf16 v[96:99], a[232:235], a[184:187], v[96:99]
ds_read_b128 a[224:227], v4 offset:33792
v_mfma_f32_16x16x32_bf16 v[96:99], a[236:239], a[188:191], v[96:99]
ds_read_b128 a[228:231], v4 offset:41984
s_waitcnt lgkmcnt(4)
v_mfma_f32_16x16x32_bf16 v[100:103], a[184:187], a[240:243], v[100:103]
ds_read_b128 a[232:235], v4 offset:34816
v_mfma_f32_16x16x32_bf16 v[100:103], a[188:191], a[244:247], v[100:103]
ds_read_b128 a[236:239], v4 offset:43008
s_waitcnt vmcnt(12)
s_waitcnt lgkmcnt(4)
v_mfma_f32_16x16x32_bf16 v[32:35], a[216:219], a[48:51], v[32:35]
v_mfma_f32_16x16x32_bf16 v[32:35], a[220:223], a[52:55], v[32:35]
ds_read_b128 a[240:243], v4 offset:35840
v_mfma_f32_16x16x32_bf16 v[36:39], a[216:219], a[120:123], v[36:39]
v_mfma_f32_16x16x32_bf16 v[36:39], a[220:223], a[124:127], v[36:39]
ds_read_b128 a[244:247], v4 offset:44032
s_waitcnt lgkmcnt(4)
v_mfma_f32_16x16x32_bf16 v[40:43], a[224:227], a[48:51], v[40:43]
v_mfma_f32_16x16x32_bf16 v[40:43], a[228:231], a[52:55], v[40:43]
ds_read_b128 a[216:219], v4 offset:36864
v_mfma_f32_16x16x32_bf16 v[44:47], a[224:227], a[120:123], v[44:47]
v_mfma_f32_16x16x32_bf16 v[44:47], a[228:231], a[124:127], v[44:47]
ds_read_b128 a[220:223], v4 offset:45056
s_waitcnt lgkmcnt(4)
v_mfma_f32_16x16x32_bf16 v[48:51], a[232:235], a[48:51], v[48:51]
v_mfma_f32_16x16x32_bf16 v[48:51], a[236:239], a[52:55], v[48:51]
ds_read_b128 a[224:227], v4 offset:37888
v_mfma_f32_16x16x32_bf16 v[52:55], a[232:235], a[120:123], v[52:55]
v_mfma_f32_16x16x32_bf16 v[52:55], a[236:239], a[124:127], v[52:55]
ds_read_b128 a[228:231], v4 offset:46080
s_waitcnt lgkmcnt(4)
v_mfma_f32_16x16x32_bf16 v[56:59], a[240:243], a[48:51], v[56:59]
v_mfma_f32_16x16x32_bf16 v[56:59], a[244:247], a[52:55], v[56:59]
ds_read_b128 a[232:235], v4 offset:38912
v_mfma_f32_16x16x32_bf16 v[60:63], a[240:243], a[120:123], v[60:63]
v_mfma_f32_16x16x32_bf16 v[60:63], a[244:247], a[124:127], v[60:63]
ds_read_b128 a[236:239], v4 offset:47104
s_waitcnt lgkmcnt(4)
v_mfma_f32_16x16x32_bf16 v[64:67], a[216:219], a[48:51], v[64:67]
v_mfma_f32_16x16x32_bf16 v[64:67], a[220:223], a[52:55], v[64:67]
ds_read_b128 a[240:243], v4 offset:39936
v_mfma_f32_16x16x32_bf16 v[68:71], a[216:219], a[120:123], v[68:71]
v_mfma_f32_16x16x32_bf16 v[68:71], a[220:223], a[124:127], v[68:71]
ds_read_b128 a[244:247], v4 offset:48128
s_waitcnt lgkmcnt(4)
v_mfma_f32_16x16x32_bf16 v[72:75], a[48:51], a[224:227], v[72:75]
v_mfma_f32_16x16x32_bf16 v[72:75], a[52:55], a[228:231], v[72:75]
ds_read_b128 a[216:219], v7 offset:32768
v_mfma_f32_16x16x32_bf16 v[76:79], a[120:123], a[224:227], v[76:79]
v_mfma_f32_16x16x32_bf16 v[76:79], a[124:127], a[228:231], v[76:79]
ds_read_b128 a[220:223], v7 offset:40960
s_waitcnt lgkmcnt(4)
v_mfma_f32_16x16x32_bf16 v[80:83], a[48:51], a[232:235], v[80:83]
v_mfma_f32_16x16x32_bf16 v[80:83], a[52:55], a[236:239], v[80:83]
ds_read_b128 a[224:227], v10 offset:32768
v_mfma_f32_16x16x32_bf16 v[84:87], a[120:123], a[232:235], v[84:87]
v_mfma_f32_16x16x32_bf16 v[84:87], a[124:127], a[236:239], v[84:87]
ds_read_b128 a[228:231], v10 offset:40960
s_waitcnt lgkmcnt(4)
v_mfma_f32_16x16x32_bf16 v[88:91], a[48:51], a[240:243], v[88:91]
v_mfma_f32_16x16x32_bf16 v[88:91], a[52:55], a[244:247], v[88:91]
ds_read_b128 a[232:235], v4 offset:49152
v_mfma_f32_16x16x32_bf16 v[92:95], a[120:123], a[240:243], v[92:95]
v_mfma_f32_16x16x32_bf16 v[92:95], a[124:127], a[244:247], v[92:95]
ds_read_b128 a[236:239], v4 offset:57344
s_waitcnt lgkmcnt(4)
v_mfma_f32_16x16x32_bf16 v[96:99], a[216:219], a[192:195], v[96:99]
ds_read_b128 a[240:243], v4 offset:50176
v_mfma_f32_16x16x32_bf16 v[96:99], a[220:223], a[196:199], v[96:99]
ds_read_b128 a[244:247], v4 offset:58368
s_waitcnt lgkmcnt(4)
v_mfma_f32_16x16x32_bf16 v[100:103], a[192:195], a[224:227], v[100:103]
ds_read_b128 a[216:219], v4 offset:51200
v_mfma_f32_16x16x32_bf16 v[100:103], a[196:199], a[228:231], v[100:103]
ds_read_b128 a[220:223], v4 offset:59392
s_waitcnt vmcnt(6)
s_waitcnt lgkmcnt(4)
v_mfma_f32_16x16x32_bf16 v[32:35], a[232:235], a[56:59], v[32:35]
v_mfma_f32_16x16x32_bf16 v[32:35], a[236:239], a[60:63], v[32:35]
ds_read_b128 a[224:227], v4 offset:52224
v_mfma_f32_16x16x32_bf16 v[36:39], a[232:235], a[128:131], v[36:39]
v_mfma_f32_16x16x32_bf16 v[36:39], a[236:239], a[132:135], v[36:39]
ds_read_b128 a[228:231], v4 offset:60416
s_waitcnt lgkmcnt(4)
v_mfma_f32_16x16x32_bf16 v[40:43], a[240:243], a[56:59], v[40:43]
v_mfma_f32_16x16x32_bf16 v[40:43], a[244:247], a[60:63], v[40:43]
ds_read_b128 a[232:235], v4 offset:53248
v_mfma_f32_16x16x32_bf16 v[44:47], a[240:243], a[128:131], v[44:47]
v_mfma_f32_16x16x32_bf16 v[44:47], a[244:247], a[132:135], v[44:47]
ds_read_b128 a[236:239], v4 offset:61440
s_waitcnt lgkmcnt(4)
v_mfma_f32_16x16x32_bf16 v[48:51], a[216:219], a[56:59], v[48:51]
v_mfma_f32_16x16x32_bf16 v[48:51], a[220:223], a[60:63], v[48:51]
ds_read_b128 a[240:243], v4 offset:54272
v_mfma_f32_16x16x32_bf16 v[52:55], a[216:219], a[128:131], v[52:55]
v_mfma_f32_16x16x32_bf16 v[52:55], a[220:223], a[132:135], v[52:55]
ds_read_b128 a[244:247], v4 offset:62464
s_waitcnt lgkmcnt(4)
v_mfma_f32_16x16x32_bf16 v[56:59], a[224:227], a[56:59], v[56:59]
v_mfma_f32_16x16x32_bf16 v[56:59], a[228:231], a[60:63], v[56:59]
ds_read_b128 a[216:219], v4 offset:55296
v_mfma_f32_16x16x32_bf16 v[60:63], a[224:227], a[128:131], v[60:63]
v_mfma_f32_16x16x32_bf16 v[60:63], a[228:231], a[132:135], v[60:63]
ds_read_b128 a[220:223], v4 offset:63488
s_waitcnt lgkmcnt(4)
v_mfma_f32_16x16x32_bf16 v[64:67], a[232:235], a[56:59], v[64:67]
v_mfma_f32_16x16x32_bf16 v[64:67], a[236:239], a[60:63], v[64:67]
ds_read_b128 a[224:227], v4 offset:56320
v_mfma_f32_16x16x32_bf16 v[68:71], a[232:235], a[128:131], v[68:71]
v_mfma_f32_16x16x32_bf16 v[68:71], a[236:239], a[132:135], v[68:71]
ds_read_b128 a[228:231], v4 offset:64512
s_waitcnt lgkmcnt(4)
v_mfma_f32_16x16x32_bf16 v[72:75], a[56:59], a[240:243], v[72:75]
v_mfma_f32_16x16x32_bf16 v[72:75], a[60:63], a[244:247], v[72:75]
ds_read_b128 a[232:235], v7 offset:49152
v_mfma_f32_16x16x32_bf16 v[76:79], a[128:131], a[240:243], v[76:79]
v_mfma_f32_16x16x32_bf16 v[76:79], a[132:135], a[244:247], v[76:79]
ds_read_b128 a[236:239], v7 offset:57344
s_waitcnt lgkmcnt(4)
v_mfma_f32_16x16x32_bf16 v[80:83], a[56:59], a[216:219], v[80:83]
v_mfma_f32_16x16x32_bf16 v[80:83], a[60:63], a[220:223], v[80:83]
ds_read_b128 a[240:243], v10 offset:49152
v_mfma_f32_16x16x32_bf16 v[84:87], a[128:131], a[216:219], v[84:87]
v_mfma_f32_16x16x32_bf16 v[84:87], a[132:135], a[220:223], v[84:87]
ds_read_b128 a[244:247], v10 offset:57344
s_waitcnt lgkmcnt(4)
v_mfma_f32_16x16x32_bf16 v[88:91], a[56:59], a[224:227], v[88:91]
v_mfma_f32_16x16x32_bf16 v[88:91], a[60:63], a[228:231], v[88:91]
ds_read_b128 a[216:219], v5 offset:0
v_mfma_f32_16x16x32_bf16 v[92:95], a[128:131], a[224:227], v[92:95]
v_mfma_f32_16x16x32_bf16 v[92:95], a[132:135], a[228:231], v[92:95]
ds_read_b128 a[220:223], v5 offset:8192
s_waitcnt lgkmcnt(4)
v_mfma_f32_16x16x32_bf16 v[96:99], a[232:235], a[200:203], v[96:99]
ds_read_b128 a[224:227], v5 offset:1024
v_mfma_f32_16x16x32_bf16 v[96:99], a[236:239], a[204:207], v[96:99]
ds_read_b128 a[228:231], v5 offset:9216
s_waitcnt lgkmcnt(4)
v_mfma_f32_16x16x32_bf16 v[100:103], a[200:203], a[240:243], v[100:103]
ds_read_b128 a[232:235], v5 offset:2048
v_mfma_f32_16x16x32_bf16 v[100:103], a[204:207], a[244:247], v[100:103]
ds_read_b128 a[236:239], v5 offset:10240
s_waitcnt vmcnt(0)
s_waitcnt lgkmcnt(4)
v_mfma_f32_16x16x32_bf16 v[32:35], a[216:219], a[64:67], v[32:35]
v_mfma_f32_16x16x32_bf16 v[32:35], a[220:223], a[68:71], v[32:35]
ds_read_b128 a[240:243], v5 offset:3072
v_mfma_f32_16x16x32_bf16 v[36:39], a[216:219], a[136:139], v[36:39]
v_mfma_f32_16x16x32_bf16 v[36:39], a[220:223], a[140:143], v[36:39]
ds_read_b128 a[244:247], v5 offset:11264
s_waitcnt lgkmcnt(4)
v_mfma_f32_16x16x32_bf16 v[40:43], a[224:227], a[64:67], v[40:43]
v_mfma_f32_16x16x32_bf16 v[40:43], a[228:231], a[68:71], v[40:43]
ds_read_b128 a[216:219], v5 offset:4096
v_mfma_f32_16x16x32_bf16 v[44:47], a[224:227], a[136:139], v[44:47]
v_mfma_f32_16x16x32_bf16 v[44:47], a[228:231], a[140:143], v[44:47]
ds_read_b128 a[220:223], v5 offset:12288
s_waitcnt lgkmcnt(4)
v_mfma_f32_16x16x32_bf16 v[48:51], a[232:235], a[64:67], v[48:51]
v_mfma_f32_16x16x32_bf16 v[48:51], a[236:239], a[68:71], v[48:51]
ds_read_b128 a[224:227], v5 offset:5120
v_mfma_f32_16x16x32_bf16 v[52:55], a[232:235], a[136:139], v[52:55]
v_mfma_f32_16x16x32_bf16 v[52:55], a[236:239], a[140:143], v[52:55]
ds_read_b128 a[228:231], v5 offset:13312
s_waitcnt lgkmcnt(4)
v_mfma_f32_16x16x32_bf16 v[56:59], a[240:243], a[64:67], v[56:59]
v_mfma_f32_16x16x32_bf16 v[56:59], a[244:247], a[68:71], v[56:59]
ds_read_b128 a[232:235], v5 offset:6144
v_mfma_f32_16x16x32_bf16 v[60:63], a[240:243], a[136:139], v[60:63]
v_mfma_f32_16x16x32_bf16 v[60:63], a[244:247], a[140:143], v[60:63]
ds_read_b128 a[236:239], v5 offset:14336
s_waitcnt lgkmcnt(4)
v_mfma_f32_16x16x32_bf16 v[64:67], a[216:219], a[64:67], v[64:67]
v_mfma_f32_16x16x32_bf16 v[64:67], a[220:223], a[68:71], v[64:67]
ds_read_b128 a[240:243], v5 offset:7168
v_mfma_f32_16x16x32_bf16 v[68:71], a[216:219], a[136:139], v[68:71]
v_mfma_f32_16x16x32_bf16 v[68:71], a[220:223], a[140:143], v[68:71]
ds_read_b128 a[244:247], v5 offset:15360
s_waitcnt lgkmcnt(4)
v_mfma_f32_16x16x32_bf16 v[72:75], a[64:67], a[224:227], v[72:75]
v_mfma_f32_16x16x32_bf16 v[72:75], a[68:71], a[228:231], v[72:75]
ds_read_b128 a[216:219], v8 offset:0
v_mfma_f32_16x16x32_bf16 v[76:79], a[136:139], a[224:227], v[76:79]
v_mfma_f32_16x16x32_bf16 v[76:79], a[140:143], a[228:231], v[76:79]
ds_read_b128 a[220:223], v8 offset:8192
s_waitcnt lgkmcnt(4)
v_mfma_f32_16x16x32_bf16 v[80:83], a[64:67], a[232:235], v[80:83]
v_mfma_f32_16x16x32_bf16 v[80:83], a[68:71], a[236:239], v[80:83]
ds_read_b128 a[224:227], v11 offset:0
v_mfma_f32_16x16x32_bf16 v[84:87], a[136:139], a[232:235], v[84:87]
v_mfma_f32_16x16x32_bf16 v[84:87], a[140:143], a[236:239], v[84:87]
ds_read_b128 a[228:231], v11 offset:8192
s_waitcnt lgkmcnt(4)
v_mfma_f32_16x16x32_bf16 v[88:91], a[64:67], a[240:243], v[88:91]
v_mfma_f32_16x16x32_bf16 v[88:91], a[68:71], a[244:247], v[88:91]
v_mfma_f32_16x16x32_bf16 v[92:95], a[136:139], a[240:243], v[92:95]
v_mfma_f32_16x16x32_bf16 v[92:95], a[140:143], a[244:247], v[92:95]
s_waitcnt lgkmcnt(2)
v_mfma_f32_16x16x32_bf16 v[96:99], a[216:219], a[208:211], v[96:99]
v_mfma_f32_16x16x32_bf16 v[96:99], a[220:223], a[212:215], v[96:99]
s_waitcnt lgkmcnt(0)
v_mfma_f32_16x16x32_bf16 v[100:103], a[208:211], a[224:227], v[100:103]
v_mfma_f32_16x16x32_bf16 v[100:103], a[212:215], a[228:231], v[100:103]
v_cvt_pk_bf16_f32 v116, v52, v53
v_cvt_pk_bf16_f32 v117, v54, v55
v_cvt_pk_bf16_f32 v120, v60, v61
v_cvt_pk_bf16_f32 v121, v62, v63
v_cvt_pk_bf16_f32 v160, v68, v69
v_cvt_pk_bf16_f32 v161, v70, v71
v_cvt_pk_bf16_f32 v126, v76, v77
v_cvt_pk_bf16_f32 v127, v78, v79
v_cvt_pk_bf16_f32 v132, v84, v85
v_cvt_pk_bf16_f32 v133, v86, v87
v_cvt_pk_bf16_f32 v138, v92, v93
v_cvt_pk_bf16_f32 v139, v94, v95
v_cvt_pk_bf16_f32 v156, v96, v97
v_cvt_pk_bf16_f32 v157, v98, v99
v_cvt_pk_bf16_f32 v158, v100, v101
v_cvt_pk_bf16_f32 v159, v102, v103
v_lshlrev_b32 v14, 3, v1
s_mul_i32 s31, s4, 3072
s_add_u32 s32, s31, 147456
v_add_u32 v15, s32, v14
s_lshl_b32 s33, s29, 9
s_add_u32 s33, s33, 147456
v_add_u32 v16, s33, v14
s_cmp_eq_u32 s4, 3
s_cbranch_scc1 L_a1_noxch
ds_write_b64 v16, v[156:157]
ds_write_b64 v16, v[158:159] offset:1536
ds_write_b64 v15, v[116:117] offset:3072
ds_write_b64 v15, v[120:121] offset:3584
ds_write_b64 v15, v[160:161] offset:4096
ds_write_b64 v15, v[126:127] offset:4608
ds_write_b64 v15, v[132:133] offset:5120
ds_write_b64 v15, v[138:139] offset:5632
L_a1_noxch:
v_cvt_pk_bf16_f32 v110, v48, v49
v_cvt_pk_bf16_f32 v111, v50, v51
v_cvt_pk_bf16_f32 v114, v56, v57
v_cvt_pk_bf16_f32 v115, v58, v59
v_cvt_pk_bf16_f32 v124, v72, v73
v_cvt_pk_bf16_f32 v125, v74, v75
v_cvt_pk_bf16_f32 v130, v80, v81
v_cvt_pk_bf16_f32 v131, v82, v83
v_cvt_pk_bf16_f32 v136, v88, v89
v_cvt_pk_bf16_f32 v137, v90, v91
v_cvt_pk_bf16_f32 v140, v32, v33
v_cvt_pk_bf16_f32 v141, v34, v35
v_cvt_pk_bf16_f32 v146, v40, v41
v_cvt_pk_bf16_f32 v147, v42, v43
v_cvt_pk_bf16_f32 v142, v64, v65
v_cvt_pk_bf16_f32 v145, v66, v67
v_mov_b32 v143, 0
v_mov_b32 v144, 0
v_mov_b32 v112, 0
v_mov_b32 v113, 0
s_nop 0
v_permlane16_swap_b32 v142, v112
v_permlane16_swap_b32 v145, v113
v_cvt_pk_bf16_f32 v148, v36, v37
v_cvt_pk_bf16_f32 v149, v38, v39
v_cvt_pk_bf16_f32 v154, v44, v45
v_cvt_pk_bf16_f32 v155, v46, v47
v_cvt_pk_bf16_f32 v150, v68, v69
v_cvt_pk_bf16_f32 v153, v70, v71
v_mov_b32 v151, 0
v_mov_b32 v152, 0
v_mov_b32 v118, 0
v_mov_b32 v119, 0
s_nop 0
v_permlane16_swap_b32 v150, v118
v_permlane16_swap_b32 v153, v119
v_add_u32 v17, 16, v12
v_add_u32 v18, 32, v12
v_cmp_gt_u32 vcc, 16, v1
s_nop 1
v_cndmask_b32 v17, v18, v17, vcc
v_lshlrev_b32 v17, 3, v17
v_add_u32 v17, s32, v17
s_waitcnt lgkmcnt(0)
s_barrier
ds_read_b64 v[104:105], v15
ds_read_b64 v[108:109], v15 offset:512
ds_read_b64 v[106:107], v17 offset:1024
ds_read_b64 v[122:123], v15 offset:1536
ds_read_b64 v[128:129], v15 offset:2048
ds_read_b64 v[134:135], v15 offset:2560
v_mfma_f32_16x16x32_bf16 v[32:35], v[110:113], v[148:151], 0
v_mfma_f32_16x16x32_bf16 v[36:39], v[116:119], v[148:151], 0
v_mfma_f32_16x16x32_bf16 v[40:43], v[112:115], v[152:155], 0
v_mfma_f32_16x16x32_bf16 v[44:47], v[118:121], v[152:155], 0
s_waitcnt lgkmcnt(0)
v_mfma_f32_16x16x32_bf16 v[48:51], v[104:107], v[140:143], 0
v_mfma_f32_16x16x32_bf16 v[52:55], v[110:113], v[140:143], 0
v_mfma_f32_16x16x32_bf16 v[56:59], v[106:109], v[144:147], 0
v_mfma_f32_16x16x32_bf16 v[60:63], v[112:115], v[144:147], 0
v_mov_b32 v18, 0xff61b1e6
s_mov_b32 s34, 0x3eae1a93
v_cndmask_b32 v32, v18, v32, s[44:45]
v_cndmask_b32 v40, v18, v40, s[44:45]
s_nop 0
v_cndmask_b32 v48, v18, v48, s[60:61]
s_nop 0
v_cndmask_b32 v56, v18, v56, s[60:61]
v_cndmask_b32 v33, v18, v33, s[46:47]
v_cndmask_b32 v41, v18, v41, s[46:47]
v_cndmask_b32 v49, v18, v49, s[62:63]
v_cndmask_b32 v57, v18, v57, s[62:63]
v_cndmask_b32 v34, v18, v34, s[48:49]
v_cndmask_b32 v42, v18, v42, s[48:49]
v_cndmask_b32 v50, v18, v50, s[64:65]
v_cndmask_b32 v58, v18, v58, s[64:65]
v_cndmask_b32 v35, v18, v35, s[50:51]
v_cndmask_b32 v43, v18, v43, s[50:51]
v_cndmask_b32 v51, v18, v51, s[66:67]
v_cndmask_b32 v59, v18, v59, s[66:67]
v_cndmask_b32 v36, v18, v36, s[52:53]
v_cndmask_b32 v44, v18, v44, s[52:53]
v_cndmask_b32 v52, v18, v52, s[52:53]
v_cndmask_b32 v60, v18, v60, s[52:53]
v_cndmask_b32 v37, v18, v37, s[54:55]
v_cndmask_b32 v45, v18, v45, s[54:55]
v_cndmask_b32 v53, v18, v53, s[54:55]
v_cndmask_b32 v61, v18, v61, s[54:55]
v_cndmask_b32 v38, v18, v38, s[56:57]
v_cndmask_b32 v46, v18, v46, s[56:57]
v_cndmask_b32 v54, v18, v54, s[56:57]
v_cndmask_b32 v62, v18, v62, s[56:57]
v_cndmask_b32 v39, v18, v39, s[58:59]
v_cndmask_b32 v47, v18, v47, s[58:59]
v_cndmask_b32 v55, v18, v55, s[58:59]
v_cndmask_b32 v63, v18, v63, s[58:59]
v_max3_f32 v20, v32, v33, v34
v_max3_f32 v21, v40, v41, v42
v_max3_f32 v22, v48, v49, v50
v_max3_f32 v23, v56, v57, v58
v_max3_f32 v20, v20, v35, v36
v_max3_f32 v21, v21, v43, v44
v_max3_f32 v22, v22, v51, v52
v_max3_f32 v23, v23, v59, v60
v_max3_f32 v20, v20, v37, v38
v_max3_f32 v21, v21, v45, v46
v_max3_f32 v22, v22, v53, v54
v_max3_f32 v23, v23, v61, v62
v_max_f32 v20, v20, v39
v_max_f32 v21, v21, v47
v_max_f32 v22, v22, v55
v_max_f32 v23, v23, v63
v_mov_b32 v24, v20
v_mov_b32 v25, v21
v_mov_b32 v26, v22
v_mov_b32 v27, v23
v_permlane16_swap_b32 v20, v24
v_permlane16_swap_b32 v21, v25
v_permlane16_swap_b32 v22, v26
v_permlane16_swap_b32 v23, v27
v_max_f32 v20, v20, v24
v_max_f32 v21, v21, v25
v_max_f32 v22, v22, v26
v_max_f32 v23, v23, v27
v_mov_b32 v24, v20
v_mov_b32 v25, v21
v_mov_b32 v26, v22
v_mov_b32 v27, v23
v_permlane32_swap_b32 v20, v24
v_permlane32_swap_b32 v21, v25
v_permlane32_swap_b32 v22, v26
v_permlane32_swap_b32 v23, v27
v_max_f32 v20, v20, v24
v_max_f32 v21, v21, v25
v_max_f32 v22, v22, v26
v_max_f32 v23, v23, v27
v_mul_f32 v20, s34, v20
v_mul_f32 v21, s34, v21
v_mul_f32 v22, s34, v22
v_mul_f32 v23, s34, v23
v_fma_f32 v32, v32, s34, -v20
v_fma_f32 v40, v40, s34, -v21
v_fma_f32 v48, v48, s34, -v22
v_fma_f32 v56, v56, s34, -v23
v_exp_f32 v32, v32
v_exp_f32 v40, v40
v_exp_f32 v48, v48
v_exp_f32 v56, v56
v_fma_f32 v33, v33, s34, -v20
v_fma_f32 v41, v41, s34, -v21
v_fma_f32 v49, v49, s34, -v22
v_fma_f32 v57, v57, s34, -v23
v_exp_f32 v33, v33
v_exp_f32 v41, v41
v_exp_f32 v49, v49
v_exp_f32 v57, v57
v_fma_f32 v34, v34, s34, -v20
v_fma_f32 v42, v42, s34, -v21
v_fma_f32 v50, v50, s34, -v22
v_fma_f32 v58, v58, s34, -v23
v_exp_f32 v34, v34
v_exp_f32 v42, v42
v_exp_f32 v50, v50
v_exp_f32 v58, v58
v_fma_f32 v35, v35, s34, -v20
v_fma_f32 v43, v43, s34, -v21
v_fma_f32 v51, v51, s34, -v22
v_fma_f32 v59, v59, s34, -v23
v_exp_f32 v35, v35
v_exp_f32 v43, v43
v_exp_f32 v51, v51
v_exp_f32 v59, v59
v_fma_f32 v36, v36, s34, -v20
v_fma_f32 v44, v44, s34, -v21
v_fma_f32 v52, v52, s34, -v22
v_fma_f32 v60, v60, s34, -v23
v_exp_f32 v36, v36
v_exp_f32 v44, v44
v_exp_f32 v52, v52
v_exp_f32 v60, v60
v_fma_f32 v37, v37, s34, -v20
v_fma_f32 v45, v45, s34, -v21
v_fma_f32 v53, v53, s34, -v22
v_fma_f32 v61, v61, s34, -v23
v_exp_f32 v37, v37
v_exp_f32 v45, v45
v_exp_f32 v53, v53
v_exp_f32 v61, v61
v_fma_f32 v38, v38, s34, -v20
v_fma_f32 v46, v46, s34, -v21
v_fma_f32 v54, v54, s34, -v22
v_fma_f32 v62, v62, s34, -v23
v_exp_f32 v38, v38
v_exp_f32 v46, v46
v_exp_f32 v54, v54
v_exp_f32 v62, v62
v_fma_f32 v39, v39, s34, -v20
v_fma_f32 v47, v47, s34, -v21
v_fma_f32 v55, v55, s34, -v22
v_fma_f32 v63, v63, s34, -v23
v_exp_f32 v39, v39
v_exp_f32 v47, v47
v_exp_f32 v55, v55
v_exp_f32 v63, v63
v_add_f32 v28, v32, v33
v_add_f32 v29, v40, v41
v_add_f32 v30, v48, v49
v_add_f32 v31, v56, v57
v_add_f32 v28, v28, v34
v_add_f32 v29, v29, v42
v_add_f32 v30, v30, v50
v_add_f32 v31, v31, v58
v_add_f32 v28, v28, v35
v_add_f32 v29, v29, v43
v_add_f32 v30, v30, v51
v_add_f32 v31, v31, v59
v_add_f32 v28, v28, v36
v_add_f32 v29, v29, v44
v_add_f32 v30, v30, v52
v_add_f32 v31, v31, v60
v_add_f32 v28, v28, v37
v_add_f32 v29, v29, v45
v_add_f32 v30, v30, v53
v_add_f32 v31, v31, v61
v_add_f32 v28, v28, v38
v_add_f32 v29, v29, v46
v_add_f32 v30, v30, v54
v_add_f32 v31, v31, v62
v_add_f32 v28, v28, v39
v_add_f32 v29, v29, v47
v_add_f32 v30, v30, v55
v_add_f32 v31, v31, v63
v_mov_b32 v24, v28
v_mov_b32 v25, v29
v_mov_b32 v26, v30
v_mov_b32 v27, v31
v_permlane16_swap_b32 v28, v24
v_permlane16_swap_b32 v29, v25
v_permlane16_swap_b32 v30, v26
v_permlane16_swap_b32 v31, v27
v_add_f32 v28, v28, v24
v_add_f32 v29, v29, v25
v_add_f32 v30, v30, v26
v_add_f32 v31, v31, v27
v_mov_b32 v24, v28
v_mov_b32 v25, v29
v_mov_b32 v26, v30
v_mov_b32 v27, v31
v_permlane32_swap_b32 v28, v24
v_permlane32_swap_b32 v29, v25
v_permlane32_swap_b32 v30, v26
v_permlane32_swap_b32 v31, v27
v_add_f32 v28, v28, v24
v_add_f32 v29, v29, v25
v_add_f32 v30, v30, v26
v_add_f32 v31, v31, v27
v_rcp_f32 v28, v28
v_rcp_f32 v29, v29
v_rcp_f32 v30, v30
v_rcp_f32 v31, v31
v_mul_f32 v32, v32, v28
v_mul_f32 v40, v40, v29
v_mul_f32 v48, v48, v30
v_mul_f32 v56, v56, v31
v_mul_f32 v33, v33, v28
v_mul_f32 v41, v41, v29
v_mul_f32 v49, v49, v30
v_mul_f32 v57, v57, v31
v_mul_f32 v34, v34, v28
v_mul_f32 v42, v42, v29
v_mul_f32 v50, v50, v30
v_mul_f32 v58, v58, v31
v_mul_f32 v35, v35, v28
v_mul_f32 v43, v43, v29
v_mul_f32 v51, v51, v30
v_mul_f32 v59, v59, v31
v_mul_f32 v36, v36, v28
v_mul_f32 v44, v44, v29
v_mul_f32 v52, v52, v30
v_mul_f32 v60, v60, v31
v_mul_f32 v37, v37, v28
v_mul_f32 v45, v45, v29
v_mul_f32 v53, v53, v30
v_mul_f32 v61, v61, v31
v_mul_f32 v38, v38, v28
v_mul_f32 v46, v46, v29
v_mul_f32 v54, v54, v30
v_mul_f32 v62, v62, v31
v_mul_f32 v39, v39, v28
v_mul_f32 v47, v47, v29
v_mul_f32 v55, v55, v30
v_mul_f32 v63, v63, v31
v_cvt_pk_bf16_f32 v64, v32, v33
v_cvt_pk_bf16_f32 v65, v34, v35
v_cvt_pk_bf16_f32 v66, v36, v37
v_cvt_pk_bf16_f32 v67, v38, v39
v_cvt_pk_bf16_f32 v68, v40, v41
v_cvt_pk_bf16_f32 v69, v42, v43
v_cvt_pk_bf16_f32 v70, v44, v45
v_cvt_pk_bf16_f32 v71, v46, v47
v_cvt_pk_bf16_f32 v72, v48, v49
v_cvt_pk_bf16_f32 v73, v50, v51
v_cvt_pk_bf16_f32 v74, v52, v53
v_cvt_pk_bf16_f32 v75, v54, v55
v_cvt_pk_bf16_f32 v76, v56, v57
v_cvt_pk_bf16_f32 v77, v58, v59
v_cvt_pk_bf16_f32 v78, v60, v61
v_cvt_pk_bf16_f32 v79, v62, v63
v_mfma_f32_16x16x32_bf16 v[80:83], v[124:127], v[64:67], 0
v_mfma_f32_16x16x32_bf16 v[84:87], v[136:139], v[64:67], 0
v_mfma_f32_16x16x32_bf16 v[88:91], v[130:133], v[68:71], 0
v_mfma_f32_16x16x32_bf16 v[92:95], v[136:139], v[68:71], 0
v_mfma_f32_16x16x32_bf16 v[96:99], v[122:125], v[72:75], 0
v_mfma_f32_16x16x32_bf16 v[100:103], v[134:137], v[72:75], 0
v_mfma_f32_16x16x32_bf16 v[164:167], v[128:131], v[76:79], 0
v_mfma_f32_16x16x32_bf16 v[168:171], v[134:137], v[76:79], 0
v_lshlrev_b32 v14, 3, v12
v_mov_b32 v15, 2146435072
v_cmp_gt_u32 vcc, 16, v1
s_nop 1
v_cndmask_b32 v14, v15, v14, vcc
s_add_u32 s26, s24, s72
s_lshl_b32 s27, s21, 10
s_add_u32 s27, s27, s26
s_lshl_b32 s28, s21, 7
s_add_u32 s28, s28, 16384
s_add_u32 s28, s28, s26
s_add_u32 s30, s27, 18432
s_add_u32 s31, s28, 18432
v_cvt_pk_bf16_f32 v180, v80, v81
v_cvt_pk_bf16_f32 v181, v82, v83
v_cvt_pk_bf16_f32 v182, v88, v89
v_cvt_pk_bf16_f32 v183, v90, v91
v_cvt_pk_bf16_f32 v184, v84, v85
v_cvt_pk_bf16_f32 v185, v94, v95
buffer_store_dwordx4 v[180:183], v2, s[8:11], s30 offen sc1
buffer_store_dwordx2 v[184:185], v14, s[8:11], s31 offen sc1
v_cvt_pk_bf16_f32 v172, v96, v97
v_cvt_pk_bf16_f32 v173, v98, v99
v_cvt_pk_bf16_f32 v174, v164, v165
v_cvt_pk_bf16_f32 v175, v166, v167
v_cvt_pk_bf16_f32 v176, v100, v101
v_cvt_pk_bf16_f32 v177, v170, v171
buffer_store_dwordx4 v[172:175], v2, s[8:11], s27 offen sc1
buffer_store_dwordx2 v[176:177], v14, s[8:11], s28 offen sc1
s_lshl_b32 s26, s20, 2
s_add_u32 s26, s26, s4
s_lshl_b32 s26, s26, 4
s_add_u32 s26, s26, s21
s_lshl_b32 s26, s26, 7
s_add_u32 s26, s26, s77
s_add_u32 s26, s26, 131072
s_and_b32 s37, s6, 7
s_mul_i32 s37, s37, 92160
s_mul_i32 s38, s4, 23552
s_add_u32 s37, s37, s38
s_add_u32 s37, s37, 6553600
v_mov_b32 v14, 2146435072
v_cmp_eq_u32 vcc, 0, v1
s_nop 1
v_cndmask_b32 v14, v14, 0, vcc
v_mov_b32 v15, 1
s_add_u32 m0, s38, 0
s_add_u32 s40, s37, 0
buffer_load_dwordx4 v2, s[8:11], s40 offen offset:0 lds
buffer_load_dwordx4 v2, s[8:11], s40 offen offset:1024 lds
buffer_load_dwordx4 v2, s[8:11], s40 offen offset:2048 lds
buffer_load_dwordx4 v2, s[8:11], s40 offen offset:3072 lds
s_add_u32 m0, s38, 4096
s_add_u32 s40, s37, 4096
buffer_load_dwordx4 v2, s[8:11], s40 offen offset:0 lds
buffer_load_dwordx4 v2, s[8:11], s40 offen offset:1024 lds
buffer_load_dwordx4 v2, s[8:11], s40 offen offset:2048 lds
buffer_load_dwordx4 v2, s[8:11], s40 offen offset:3072 lds
s_waitcnt vmcnt(8)
buffer_store_dword v15, v14, s[8:11], s26 offen sc1
s_add_u32 m0, s38, 8192
s_add_u32 s40, s37, 8192
buffer_load_dwordx4 v2, s[8:11], s40 offen offset:0 lds
buffer_load_dwordx4 v2, s[8:11], s40 offen offset:1024 lds
buffer_load_dwordx4 v2, s[8:11], s40 offen offset:2048 lds
buffer_load_dwordx4 v2, s[8:11], s40 offen offset:3072 lds
s_add_u32 m0, s38, 12288
s_add_u32 s40, s37, 12288
buffer_load_dwordx4 v2, s[8:11], s40 offen offset:0 lds
buffer_load_dwordx4 v2, s[8:11], s40 offen offset:1024 lds
buffer_load_dwordx4 v2, s[8:11], s40 offen offset:2048 lds
buffer_load_dwordx4 v2, s[8:11], s40 offen offset:3072 lds
s_add_u32 m0, s38, 16384
s_add_u32 s40, s37, 16384
buffer_load_dwordx4 v2, s[8:11], s40 offen offset:0 lds
buffer_load_dwordx4 v2, s[8:11], s40 offen offset:1024 lds
buffer_load_dwordx4 v2, s[8:11], s40 offen offset:2048 lds
buffer_load_dwordx4 v2, s[8:11], s40 offen offset:3072 lds
s_add_u32 m0, s38, 20480
s_add_u32 s40, s37, 20480
buffer_load_dwordx4 v2, s[8:11], s40 offen offset:0 lds
buffer_load_dwordx4 v2, s[8:11], s40 offen offset:1024 lds
buffer_load_dwordx4 v2, s[8:11], s40 offen offset:2048 lds
s_lshr_b32 s20, s6, 3
s_lshl_b32 s21, s5, 2
s_add_u32 s20, s20, s21
s_lshl_b32 s20, s20, 2
s_add_u32 s20, s20, s4
s_and_b32 s21, s6, 7
s_mul_i32 s24, s20, 18432
s_add_u32 s25, s24, s72
s_mul_i32 s26, s21, 2304
s_add_u32 s26, s26, s24
s_add_u32 s27, s26, s71
v_and_b32 v6, 15, v1
v_lshrrev_b32 v7, 4, v1
v_lshlrev_b32 v8, 4, v6
v_lshl_add_u32 v8, v7, 3, v8
v_add_u32 v8, 2048, v8
v_mov_b32 v9, 2146435072
v_cmp_gt_u32 vcc, 32, v1
s_nop 1
v_cndmask_b32 v4, v9, v8, vcc
v_add_u32 v5, 0x10000, v2
s_lshr_b32 s22, s20, 1
s_lshl_b32 s22, s22, 11
s_add_u32 s22, s22, s77
s_add_u32 s22, s22, 131072
v_lshlrev_b32 v10, 7, v6
v_lshlrev_b32 v11, 3, v6
v_lshl_add_u32 v11, v7, 8, v11
s_mov_b32 s52, 0
L_poll3:
buffer_load_dword v253, v10, s[8:11], s22 offen sc1
s_add_u32 s52, s52, 1
s_waitcnt vmcnt(0)
v_cmp_eq_u32 vcc, 0, v253
s_cmp_ge_u32 s52, 0x100000
s_cbranch_scc1 L_got3
s_and_b64 exec, exec, vcc
s_cbranch_execnz L_poll3
L_got3:
s_mov_b64 exec, -1
buffer_load_dwordx4 a[0:3], v2, s[8:11], s25 offen offset:0 sc1
buffer_load_dwordx4 a[4:7], v2, s[8:11], s25 offen offset:1024 sc1
buffer_load_dwordx4 a[8:11], v2, s[8:11], s25 offen offset:2048 sc1
buffer_load_dwordx4 a[12:15], v2, s[8:11], s25 offen offset:3072 sc1
s_add_u32 s25, s25, 4096
buffer_load_dwordx4 a[16:19], v2, s[8:11], s25 offen offset:0 sc1
buffer_load_dwordx4 a[20:23], v2, s[8:11], s25 offen offset:1024 sc1
buffer_load_dwordx4 a[24:27], v2, s[8:11], s25 offen offset:2048 sc1
buffer_load_dwordx4 a[28:31], v2, s[8:11], s25 offen offset:3072 sc1
s_add_u32 s25, s25, 4096
buffer_load_dwordx4 a[32:35], v2, s[8:11], s25 offen offset:0 sc1
buffer_load_dwordx4 a[36:39], v2, s[8:11], s25 offen offset:1024 sc1
buffer_load_dwordx4 a[40:43], v2, s[8:11], s25 offen offset:2048 sc1
buffer_load_dwordx4 a[44:47], v2, s[8:11], s25 offen offset:3072 sc1
s_barrier
ds_read_b128 a[216:219], v2 offset:0
ds_read_b128 a[220:223], v2 offset:5120
ds_read_b128 a[224:227], v2 offset:1024
ds_read_b128 a[228:231], v2 offset:6144
ds_read_b128 a[232:235], v2 offset:2048
ds_read_b128 a[236:239], v2 offset:7168
s_waitcnt vmcnt(10)
s_waitcnt lgkmcnt(4)
v_mfma_f32_16x16x32_bf16 v[32:35], a[216:219], a[0:3], 0
ds_read_b128 a[240:243], v2 offset:3072
v_mfma_f32_16x16x32_bf16 v[32:35], a[220:223], a[4:7], v[32:35]
ds_read_b128 a[244:247], v2 offset:8192
s_add_u32 s25, s25, 4096
buffer_load_dwordx4 a[48:51], v2, s[8:11], s25 offen offset:0 sc1
s_waitcnt lgkmcnt(4)
v_mfma_f32_16x16x32_bf16 v[36:39], a[224:227], a[0:3], 0
ds_read_b128 a[216:219], v2 offset:4096
v_mfma_f32_16x16x32_bf16 v[36:39], a[228:231], a[4:7], v[36:39]
ds_read_b128 a[220:223], v2 offset:9216
s_waitcnt lgkmcnt(4)
v_mfma_f32_16x16x32_bf16 v[40:43], a[232:235], a[0:3], 0
ds_read_b128 a[224:227], v2 offset:10240
v_mfma_f32_16x16x32_bf16 v[40:43], a[236:239], a[4:7], v[40:43]
ds_read_b128 a[228:231], v2 offset:15360
buffer_load_dwordx4 a[52:55], v2, s[8:11], s25 offen offset:1024 sc1
s_waitcnt lgkmcnt(4)
v_mfma_f32_16x16x32_bf16 v[44:47], a[240:243], a[0:3], 0
ds_read_b128 a[232:235], v2 offset:11264
v_mfma_f32_16x16x32_bf16 v[44:47], a[244:247], a[4:7], v[44:47]
ds_read_b128 a[236:239], v2 offset:16384
s_waitcnt lgkmcnt(4)
v_mfma_f32_16x16x32_bf16 v[48:51], a[216:219], a[0:3], 0
ds_read_b128 a[240:243], v2 offset:12288
v_mfma_f32_16x16x32_bf16 v[48:51], a[220:223], a[4:7], v[48:51]
ds_read_b128 a[244:247], v2 offset:17408
buffer_load_dwordx4 a[56:59], v2, s[8:11], s25 offen offset:2048 sc1
s_waitcnt vmcnt(11)
s_waitcnt lgkmcnt(4)
v_mfma_f32_16x16x32_bf16 v[32:35], a[224:227], a[8:11], v[32:35]
ds_read_b128 a[216:219], v2 offset:13312
v_mfma_f32_16x16x32_bf16 v[32:35], a[228:231], a[12:15], v[32:35]
ds_read_b128 a[220:223], v2 offset:18432
s_waitcnt lgkmcnt(4)
v_mfma_f32_16x16x32_bf16 v[36:39], a[232:235], a[8:11], v[36:39]
ds_read_b128 a[224:227], v2 offset:14336
v_mfma_f32_16x16x32_bf16 v[36:39], a[236:239], a[12:15], v[36:39]
ds_read_b128 a[228:231], v2 offset:19456
buffer_load_dwordx4 a[60:63], v2, s[8:11], s25 offen offset:3072 sc1
s_waitcnt lgkmcnt(4)
v_mfma_f32_16x16x32_bf16 v[40:43], a[240:243], a[8:11], v[40:43]
ds_read_b128 a[232:235], v2 offset:20480
v_mfma_f32_16x16x32_bf16 v[40:43], a[244:247], a[12:15], v[40:43]
ds_read_b128 a[236:239], v2 offset:25600
s_waitcnt lgkmcnt(4)
v_mfma_f32_16x16x32_bf16 v[44:47], a[216:219], a[8:11], v[44:47]
ds_read_b128 a[240:243], v2 offset:21504
v_mfma_f32_16x16x32_bf16 v[44:47], a[220:223], a[12:15], v[44:47]
ds_read_b128 a[244:247], v2 offset:26624
s_add_u32 s25, s25, 4096
buffer_load_dwordx2 a[64:65], v11, s[8:11], s25 offen offset:0 sc1
buffer_load_dwordx2 a[66:67], v11, s[8:11], s25 offen offset:128 sc1
s_waitcnt lgkmcnt(4)
v_mfma_f32_16x16x32_bf16 v[48:51], a[224:227], a[8:11], v[48:51]
ds_read_b128 a[216:219], v2 offset:22528
v_mfma_f32_16x16x32_bf16 v[48:51], a[228:231], a[12:15], v[48:51]
ds_read_b128 a[220:223], v2 offset:27648
s_waitcnt vmcnt(12)
s_waitcnt lgkmcnt(4)
v_mfma_f32_16x16x32_bf16 v[32:35], a[232:235], a[16:19], v[32:35]
ds_read_b128 a[224:227], v2 offset:23552
v_mfma_f32_16x16x32_bf16 v[32:35], a[236:239], a[20:23], v[32:35]
ds_read_b128 a[228:231], v2 offset:28672
buffer_load_dwordx2 a[68:69], v11, s[8:11], s25 offen offset:1024 sc1
buffer_load_dwordx2 a[70:71], v11, s[8:11], s25 offen offset:1152 sc1
s_waitcnt lgkmcnt(4)
v_mfma_f32_16x16x32_bf16 v[36:39], a[240:243], a[16:19], v[36:39]
ds_read_b128 a[232:235], v2 offset:24576
v_mfma_f32_16x16x32_bf16 v[36:39], a[244:247], a[20:23], v[36:39]
ds_read_b128 a[236:239], v2 offset:29696
s_waitcnt lgkmcnt(4)
v_mfma_f32_16x16x32_bf16 v[40:43], a[216:219], a[16:19], v[40:43]
ds_read_b128 a[240:243], v2 offset:30720
v_mfma_f32_16x16x32_bf16 v[40:43], a[220:223], a[20:23], v[40:43]
ds_read_b128 a[244:247], v2 offset:35840
buffer_load_dwordx4 v[56:59], v2, s[8:11], s27 offen sc1
s_waitcnt lgkmcnt(4)
v_mfma_f32_16x16x32_bf16 v[44:47], a[224:227], a[16:19], v[44:47]
ds_read_b128 a[216:219], v2 offset:31744
v_mfma_f32_16x16x32_bf16 v[44:47], a[228:231], a[20:23], v[44:47]
ds_read_b128 a[220:223], v2 offset:36864
s_waitcnt lgkmcnt(4)
v_mfma_f32_16x16x32_bf16 v[48:51], a[232:235], a[16:19], v[48:51]
ds_read_b128 a[224:227], v2 offset:32768
v_mfma_f32_16x16x32_bf16 v[48:51], a[236:239], a[20:23], v[48:51]
ds_read_b128 a[228:231], v2 offset:37888
buffer_load_dwordx4 v[60:63], v2, s[8:11], s27 offen offset:1024 sc1
s_waitcnt vmcnt(14)
s_waitcnt lgkmcnt(4)
v_mfma_f32_16x16x32_bf16 v[32:35], a[240:243], a[24:27], v[32:35]
ds_read_b128 a[232:235], v2 offset:33792
v_mfma_f32_16x16x32_bf16 v[32:35], a[244:247], a[28:31], v[32:35]
ds_read_b128 a[236:239], v2 offset:38912
s_waitcnt lgkmcnt(4)
v_mfma_f32_16x16x32_bf16 v[36:39], a[216:219], a[24:27], v[36:39]
ds_read_b128 a[240:243], v2 offset:34816
v_mfma_f32_16x16x32_bf16 v[36:39], a[220:223], a[28:31], v[36:39]
ds_read_b128 a[244:247], v2 offset:39936
buffer_load_dwordx2 v[64:65], v4, s[8:11], s27 offen sc1
s_waitcnt lgkmcnt(4)
v_mfma_f32_16x16x32_bf16 v[40:43], a[224:227], a[24:27], v[40:43]
ds_read_b128 a[216:219], v2 offset:40960
v_mfma_f32_16x16x32_bf16 v[40:43], a[228:231], a[28:31], v[40:43]
ds_read_b128 a[220:223], v2 offset:46080
s_waitcnt lgkmcnt(4)
v_mfma_f32_16x16x32_bf16 v[44:47], a[232:235], a[24:27], v[44:47]
ds_read_b128 a[224:227], v2 offset:41984
v_mfma_f32_16x16x32_bf16 v[44:47], a[236:239], a[28:31], v[44:47]
ds_read_b128 a[228:231], v2 offset:47104
s_waitcnt lgkmcnt(4)
v_mfma_f32_16x16x32_bf16 v[48:51], a[240:243], a[24:27], v[48:51]
ds_read_b128 a[232:235], v2 offset:43008
v_mfma_f32_16x16x32_bf16 v[48:51], a[244:247], a[28:31], v[48:51]
ds_read_b128 a[236:239], v2 offset:48128
s_waitcnt vmcnt(13)
s_waitcnt lgkmcnt(4)
v_mfma_f32_16x16x32_bf16 v[32:35], a[216:219], a[32:35], v[32:35]
ds_read_b128 a[240:243], v2 offset:44032
v_mfma_f32_16x16x32_bf16 v[32:35], a[220:223], a[36:39], v[32:35]
ds_read_b128 a[244:247], v2 offset:49152
s_waitcnt lgkmcnt(4)
v_mfma_f32_16x16x32_bf16 v[36:39], a[224:227], a[32:35], v[36:39]
ds_read_b128 a[216:219], v2 offset:45056
v_mfma_f32_16x16x32_bf16 v[36:39], a[228:231], a[36:39], v[36:39]
ds_read_b128 a[220:223], v2 offset:50176
s_waitcnt lgkmcnt(4)
v_mfma_f32_16x16x32_bf16 v[40:43], a[232:235], a[32:35], v[40:43]
ds_read_b128 a[224:227], v2 offset:51200
v_mfma_f32_16x16x32_bf16 v[40:43], a[236:239], a[36:39], v[40:43]
ds_read_b128 a[228:231], v2 offset:56320
s_waitcnt lgkmcnt(4)
v_mfma_f32_16x16x32_bf16 v[44:47], a[240:243], a[32:35], v[44:47]
ds_read_b128 a[232:235], v2 offset:52224
v_mfma_f32_16x16x32_bf16 v[44:47], a[244:247], a[36:39], v[44:47]
ds_read_b128 a[236:239], v2 offset:57344
s_waitcnt lgkmcnt(4)
v_mfma_f32_16x16x32_bf16 v[48:51], a[216:219], a[32:35], v[48:51]
ds_read_b128 a[240:243], v2 offset:53248
v_mfma_f32_16x16x32_bf16 v[48:51], a[220:223], a[36:39], v[48:51]
ds_read_b128 a[244:247], v2 offset:58368
s_waitcnt vmcnt(11)
s_waitcnt lgkmcnt(4)
v_mfma_f32_16x16x32_bf16 v[32:35], a[224:227], a[40:43], v[32:35]
ds_read_b128 a[216:219], v2 offset:54272
v_mfma_f32_16x16x32_bf16 v[32:35], a[228:231], a[44:47], v[32:35]
ds_read_b128 a[220:223], v2 offset:59392
s_waitcnt lgkmcnt(4)
v_mfma_f32_16x16x32_bf16 v[36:39], a[232:235], a[40:43], v[36:39]
ds_read_b128 a[224:227], v2 offset:55296
v_mfma_f32_16x16x32_bf16 v[36:39], a[236:239], a[44:47], v[36:39]
ds_read_b128 a[228:231], v2 offset:60416
s_waitcnt lgkmcnt(4)
v_mfma_f32_16x16x32_bf16 v[40:43], a[240:243], a[40:43], v[40:43]
ds_read_b128 a[232:235], v2 offset:61440
v_mfma_f32_16x16x32_bf16 v[40:43], a[244:247], a[44:47], v[40:43]
ds_read_b128 a[236:239], v5 offset:1024
s_waitcnt lgkmcnt(4)
v_mfma_f32_16x16x32_bf16 v[44:47], a[216:219], a[40:43], v[44:47]
ds_read_b128 a[240:243], v2 offset:62464
v_mfma_f32_16x16x32_bf16 v[44:47], a[220:223], a[44:47], v[44:47]
ds_read_b128 a[244:247], v5 offset:2048
s_waitcnt lgkmcnt(4)
v_mfma_f32_16x16x32_bf16 v[48:51], a[224:227], a[40:43], v[48:51]
ds_read_b128 a[216:219], v2 offset:63488
v_mfma_f32_16x16x32_bf16 v[48:51], a[228:231], a[44:47], v[48:51]
ds_read_b128 a[220:223], v5 offset:3072
s_waitcnt vmcnt(9)
s_waitcnt lgkmcnt(4)
v_mfma_f32_16x16x32_bf16 v[32:35], a[232:235], a[48:51], v[32:35]
ds_read_b128 a[224:227], v2 offset:64512
v_mfma_f32_16x16x32_bf16 v[32:35], a[236:239], a[52:55], v[32:35]
ds_read_b128 a[228:231], v5 offset:4096
s_waitcnt lgkmcnt(4)
v_mfma_f32_16x16x32_bf16 v[36:39], a[240:243], a[48:51], v[36:39]
ds_read_b128 a[232:235], v5 offset:0
v_mfma_f32_16x16x32_bf16 v[36:39], a[244:247], a[52:55], v[36:39]
ds_read_b128 a[236:239], v5 offset:5120
s_waitcnt lgkmcnt(4)
v_mfma_f32_16x16x32_bf16 v[40:43], a[216:219], a[48:51], v[40:43]
ds_read_b128 a[240:243], v5 offset:6144
v_mfma_f32_16x16x32_bf16 v[40:43], a[220:223], a[52:55], v[40:43]
ds_read_b128 a[244:247], v5 offset:11264
s_waitcnt lgkmcnt(4)
v_mfma_f32_16x16x32_bf16 v[44:47], a[224:227], a[48:51], v[44:47]
ds_read_b128 a[216:219], v5 offset:7168
v_mfma_f32_16x16x32_bf16 v[44:47], a[228:231], a[52:55], v[44:47]
ds_read_b128 a[220:223], v5 offset:12288
s_waitcnt lgkmcnt(4)
v_mfma_f32_16x16x32_bf16 v[48:51], a[232:235], a[48:51], v[48:51]
ds_read_b128 a[224:227], v5 offset:8192
v_mfma_f32_16x16x32_bf16 v[48:51], a[236:239], a[52:55], v[48:51]
ds_read_b128 a[228:231], v5 offset:13312
s_waitcnt vmcnt(7)
s_waitcnt lgkmcnt(4)
v_mfma_f32_16x16x32_bf16 v[32:35], a[240:243], a[56:59], v[32:35]
ds_read_b128 a[232:235], v5 offset:9216
v_mfma_f32_16x16x32_bf16 v[32:35], a[244:247], a[60:63], v[32:35]
ds_read_b128 a[236:239], v5 offset:14336
s_waitcnt lgkmcnt(4)
v_mfma_f32_16x16x32_bf16 v[36:39], a[216:219], a[56:59], v[36:39]
ds_read_b128 a[240:243], v5 offset:10240
v_mfma_f32_16x16x32_bf16 v[36:39], a[220:223], a[60:63], v[36:39]
ds_read_b128 a[244:247], v5 offset:15360
s_waitcnt lgkmcnt(4)
v_mfma_f32_16x16x32_bf16 v[40:43], a[224:227], a[56:59], v[40:43]
ds_read_b128 a[216:219], v5 offset:16384
v_mfma_f32_16x16x32_bf16 v[40:43], a[228:231], a[60:63], v[40:43]
ds_read_b128 a[220:223], v5 offset:21504
s_waitcnt lgkmcnt(4)
v_mfma_f32_16x16x32_bf16 v[44:47], a[232:235], a[56:59], v[44:47]
ds_read_b128 a[224:227], v5 offset:17408
v_mfma_f32_16x16x32_bf16 v[44:47], a[236:239], a[60:63], v[44:47]
ds_read_b128 a[228:231], v5 offset:22528
s_waitcnt lgkmcnt(4)
v_mfma_f32_16x16x32_bf16 v[48:51], a[240:243], a[56:59], v[48:51]
ds_read_b128 a[232:235], v5 offset:18432
v_mfma_f32_16x16x32_bf16 v[48:51], a[244:247], a[60:63], v[48:51]
ds_read_b128 a[236:239], v5 offset:23552
s_waitcnt vmcnt(3)
s_waitcnt lgkmcnt(4)
v_mfma_f32_16x16x32_bf16 v[32:35], a[216:219], a[64:67], v[32:35]
ds_read_b128 a[240:243], v5 offset:19456
v_mfma_f32_16x16x32_bf16 v[32:35], a[220:223], a[68:71], v[32:35]
ds_read_b128 a[244:247], v5 offset:24576
s_waitcnt lgkmcnt(4)
v_mfma_f32_16x16x32_bf16 v[36:39], a[224:227], a[64:67], v[36:39]
ds_read_b128 a[216:219], v5 offset:20480
v_mfma_f32_16x16x32_bf16 v[36:39], a[228:231], a[68:71], v[36:39]
ds_read_b128 a[220:223], v5 offset:25600
s_waitcnt lgkmcnt(4)
v_mfma_f32_16x16x32_bf16 v[40:43], a[232:235], a[64:67], v[40:43]
v_mfma_f32_16x16x32_bf16 v[40:43], a[236:239], a[68:71], v[40:43]
s_waitcnt lgkmcnt(2)
v_mfma_f32_16x16x32_bf16 v[44:47], a[240:243], a[64:67], v[44:47]
v_mfma_f32_16x16x32_bf16 v[44:47], a[244:247], a[68:71], v[44:47]
s_waitcnt lgkmcnt(0)
v_mfma_f32_16x16x32_bf16 v[48:51], a[216:219], a[64:67], v[48:51]
v_mfma_f32_16x16x32_bf16 v[48:51], a[220:223], a[68:71], v[48:51]
s_waitcnt vmcnt(0)
v_lshlrev_b32 v68, 16, v56
v_and_b32 v69, 0xffff0000, v56
v_add_f32 v32, v32, v68
v_add_f32 v33, v33, v69
v_lshlrev_b32 v70, 16, v57
v_and_b32 v71, 0xffff0000, v57
v_add_f32 v34, v34, v70
v_add_f32 v35, v35, v71
v_lshlrev_b32 v72, 16, v58
v_and_b32 v73, 0xffff0000, v58
v_add_f32 v36, v36, v72
v_add_f32 v37, v37, v73
v_lshlrev_b32 v74, 16, v59
v_and_b32 v75, 0xffff0000, v59
v_add_f32 v38, v38, v74
v_add_f32 v39, v39, v75
v_lshlrev_b32 v68, 16, v60
v_and_b32 v69, 0xffff0000, v60
v_add_f32 v40, v40, v68
v_add_f32 v41, v41, v69
v_lshlrev_b32 v70, 16, v61
v_and_b32 v71, 0xffff0000, v61
v_add_f32 v42, v42, v70
v_add_f32 v43, v43, v71
v_lshlrev_b32 v72, 16, v62
v_and_b32 v73, 0xffff0000, v62
v_add_f32 v44, v44, v72
v_add_f32 v45, v45, v73
v_lshlrev_b32 v74, 16, v63
v_and_b32 v75, 0xffff0000, v63
v_add_f32 v46, v46, v74
v_add_f32 v47, v47, v75
v_lshlrev_b32 v68, 16, v64
v_and_b32 v69, 0xffff0000, v64
v_add_f32 v48, v48, v68
v_add_f32 v49, v49, v69
v_lshlrev_b32 v70, 16, v65
v_and_b32 v71, 0xffff0000, v65
v_add_f32 v50, v50, v70
v_add_f32 v51, v51, v71
v_cvt_pk_bf16_f32 v80, v32, v33
v_cvt_pk_bf16_f32 v81, v34, v35
v_cvt_pk_bf16_f32 v82, v36, v37
v_cvt_pk_bf16_f32 v83, v38, v39
v_cvt_pk_bf16_f32 v84, v40, v41
v_cvt_pk_bf16_f32 v85, v42, v43
v_cvt_pk_bf16_f32 v86, v44, v45
v_cvt_pk_bf16_f32 v87, v46, v47
v_cvt_pk_bf16_f32 v88, v48, v49
v_cvt_pk_bf16_f32 v89, v50, v51
s_add_u32 s27, s26, s73
buffer_store_dwordx4 v[80:83], v2, s[8:11], s27 offen sc1
buffer_store_dwordx4 v[84:87], v2, s[8:11], s27 offen offset:1024 sc1
buffer_store_dwordx2 v[88:89], v4, s[8:11], s27 offen sc1
v_add_f32 v10, v32, v33
v_mul_f32 v11, v32, v32
v_mul_f32 v13, v33, v33
v_mov_b32 v12, 0
v_add_f32 v10, v10, v34
v_add_f32 v12, v12, v35
v_fmac_f32 v11, v34, v34
v_fmac_f32 v13, v35, v35
v_add_f32 v10, v10, v36
v_add_f32 v12, v12, v37
v_fmac_f32 v11, v36, v36
v_fmac_f32 v13, v37, v37
v_add_f32 v10, v10, v38
v_add_f32 v12, v12, v39
v_fmac_f32 v11, v38, v38
v_fmac_f32 v13, v39, v39
v_add_f32 v10, v10, v40
v_add_f32 v12, v12, v41
v_fmac_f32 v11, v40, v40
v_fmac_f32 v13, v41, v41
v_add_f32 v10, v10, v42
v_add_f32 v12, v12, v43
v_fmac_f32 v11, v42, v42
v_fmac_f32 v13, v43, v43
v_add_f32 v10, v10, v44
v_add_f32 v12, v12, v45
v_fmac_f32 v11, v44, v44
v_fmac_f32 v13, v45, v45
v_add_f32 v10, v10, v46
v_add_f32 v12, v12, v47
v_fmac_f32 v11, v46, v46
v_fmac_f32 v13, v47, v47
v_add_f32 v10, v10, v48
v_add_f32 v12, v12, v49
v_fmac_f32 v11, v48, v48
v_fmac_f32 v13, v49, v49
v_add_f32 v10, v10, v50
v_add_f32 v12, v12, v51
v_fmac_f32 v11, v50, v50
v_fmac_f32 v13, v51, v51
v_add_f32 v10, v10, v12
v_add_f32 v11, v11, v13
v_mov_b32 v12, v10
v_mov_b32 v13, v11
s_nop 0
v_permlane16_swap_b32 v10, v12
v_permlane16_swap_b32 v11, v13
v_add_f32 v10, v10, v12
v_add_f32 v11, v11, v13
v_mov_b32 v12, v10
v_mov_b32 v13, v11
s_nop 0
v_permlane32_swap_b32 v10, v12
v_permlane32_swap_b32 v11, v13
v_add_f32 v10, v10, v12
v_add_f32 v11, v11, v13
v_lshlrev_b32 v8, 3, v6
v_cmp_gt_u32 vcc, 16, v1
s_nop 1
v_cndmask_b32 v8, v9, v8, vcc
s_lshl_b32 s27, s20, 10
s_lshl_b32 s28, s21, 7
s_add_u32 s27, s27, s28
s_add_u32 s27, s27, s74
buffer_store_dwordx2 v[10:11], v8, s[8:11], s27 offen sc1
s_lshr_b32 s27, s20, 2
s_lshl_b32 s27, s27, 3
s_add_u32 s27, s27, s21
s_lshl_b32 s27, s27, 2
s_add_u32 s27, s27, s4
s_lshl_b32 s27, s27, 7
s_add_u32 s27, s27, s77
s_add_u32 s27, s27, 262144
v_mov_b32 v14, 2146435072
v_cmp_eq_u32 vcc, 0, v1
s_nop 1
v_cndmask_b32 v14, v14, 0, vcc
v_mov_b32 v15, 1
s_waitcnt vmcnt(0)
buffer_store_dword v15, v14, s[8:11], s27 offen sc1
s_barrier
s_lshr_b32 s40, s6, 2
s_lshl_b32 s41, s5, 2
s_and_b32 s42, s6, 3
s_add_u32 s41, s41, s42
s_lshr_b32 s42, s41, 2
s_and_b32 s43, s41, 3
s_mul_i32 s22, s4, 6144
s_mul_i32 s21, s41, 497664
s_add_u32 s21, s21, s22
s_add_u32 s21, s21, 7299072
v_add_u32 v3, s21, v2
s_add_u32 m0, s22, 0
s_nop 0
buffer_load_dwordx4 v3, s[8:11], 0 offen offset:0 lds
buffer_load_dwordx4 v3, s[8:11], 0 offen offset:1024 lds
buffer_load_dwordx4 v3, s[8:11], 0 offen offset:2048 lds
buffer_load_dwordx4 v3, s[8:11], 0 offen offset:3072 lds
s_add_u32 m0, s22, 4096
v_add_u32 v3, 4096, v3
buffer_load_dwordx4 v3, s[8:11], 0 offen offset:0 lds
buffer_load_dwordx4 v3, s[8:11], 0 offen offset:1024 lds
s_add_u32 m0, s22, 24576
v_add_u32 v3, 20480, v3
buffer_load_dwordx4 v3, s[8:11], 0 offen offset:0 lds
buffer_load_dwordx4 v3, s[8:11], 0 offen offset:1024 lds
buffer_load_dwordx4 v3, s[8:11], 0 offen offset:2048 lds
buffer_load_dwordx4 v3, s[8:11], 0 offen offset:3072 lds
s_add_u32 m0, s22, 28672
v_add_u32 v3, 4096, v3
buffer_load_dwordx4 v3, s[8:11], 0 offen offset:0 lds
buffer_load_dwordx4 v3, s[8:11], 0 offen offset:1024 lds
s_add_u32 m0, s22, 49152
v_add_u32 v3, 20480, v3
buffer_load_dwordx4 v3, s[8:11], 0 offen offset:0 lds
buffer_load_dwordx4 v3, s[8:11], 0 offen offset:1024 lds
buffer_load_dwordx4 v3, s[8:11], 0 offen offset:2048 lds
buffer_load_dwordx4 v3, s[8:11], 0 offen offset:3072 lds
s_add_u32 m0, s22, 53248
v_add_u32 v3, 4096, v3
buffer_load_dwordx4 v3, s[8:11], 0 offen offset:0 lds
buffer_load_dwordx4 v3, s[8:11], 0 offen offset:1024 lds
s_add_u32 m0, s22, 73728
v_add_u32 v3, 20480, v3
buffer_load_dwordx4 v3, s[8:11], 0 offen offset:0 lds
buffer_load_dwordx4 v3, s[8:11], 0 offen offset:1024 lds
buffer_load_dwordx4 v3, s[8:11], 0 offen offset:2048 lds
buffer_load_dwordx4 v3, s[8:11], 0 offen offset:3072 lds
s_add_u32 m0, s22, 77824
v_add_u32 v3, 4096, v3
buffer_load_dwordx4 v3, s[8:11], 0 offen offset:0 lds
buffer_load_dwordx4 v3, s[8:11], 0 offen offset:1024 lds
s_lshl_b32 s44, s40, 4
s_lshl_b32 s45, s4, 2
s_add_u32 s44, s44, s45
s_mul_i32 s46, s44, 18432
s_add_u32 s20, s46, s73
v_add_u32 v4, 18432, v2
v_add_u32 v5, 36864, v2
v_add_u32 v6, 55296, v2
v_lshlrev_b32 v244, 3, v1
v_add_u32 v245, 18432, v244
v_add_u32 v246, 36864, v244
v_add_u32 v247, 55296, v244
v_and_b32 v13, 15, v1
v_lshrrev_b32 v14, 4, v1
v_add_u32 v7, 0x10000, v2
v_add_u32 v8, 0x20000, v2
v_and_b32 v9, 1, v14
v_mul_u32_u24 v9, 18432, v9
v_lshrrev_b32 v15, 1, v14
v_lshlrev_b32 v15, 8, v15
v_lshl_add_u32 v15, v13, 4, v15
v_add_u32 v9, v9, v15
v_and_b32 v11, 3, v1
v_lshlrev_b32 v11, 7, v11
s_lshl_b32 s49, s43, 7
v_mov_b32 v10, 2146435072
v_mov_b32 v15, s49
v_cmp_eq_u32 vcc, 0, v1
s_nop 1
v_cndmask_b32 v10, v10, v15, vcc
s_lshl_b32 s49, s40, 3
s_add_u32 s49, s49, s42
s_lshl_b32 s50, s49, 2
s_add_u32 s50, s50, s4
s_lshl_b32 s50, s50, 9
s_add_u32 s34, s50, s77
s_add_u32 s34, s34, 0
s_lshl_b32 s49, s49, 4
s_add_u32 s49, s49, s45
s_mul_i32 s49, s49, 18432
s_add_u32 s49, s49, s75
s_add_u32 s50, s43, 0
s_and_b32 s50, s50, 3
s_mul_i32 s50, s50, 9
s_add_u32 s50, s50, 1
s_lshr_b32 s50, s50, 1
s_lshl_b32 s50, s50, 10
s_add_u32 s24, s49, s50
s_add_u32 s50, s43, 1
s_and_b32 s50, s50, 3
s_mul_i32 s50, s50, 9
s_add_u32 s50, s50, 1
s_lshr_b32 s50, s50, 1
s_lshl_b32 s50, s50, 10
s_add_u32 s25, s49, s50
s_add_u32 s50, s43, 2
s_and_b32 s50, s50, 3
s_mul_i32 s50, s50, 9
s_add_u32 s50, s50, 1
s_lshr_b32 s50, s50, 1
s_lshl_b32 s50, s50, 10
s_add_u32 s26, s49, s50
s_add_u32 s50, s43, 3
s_and_b32 s50, s50, 3
s_mul_i32 s50, s50, 9
s_add_u32 s50, s50, 1
s_lshr_b32 s50, s50, 1
s_lshl_b32 s50, s50, 10
s_add_u32 s27, s49, s50
s_add_u32 s28, s49, 4096
s_add_u32 s29, s49, 13312
s_cmp_ge_u32 s43, 2
s_cselect_b32 s50, s29, s28
s_and_b32 s51, s43, 1
s_lshl_b32 s51, s51, 9
s_add_u32 s30, s50, s51
s_mul_i32 s50, s42, 2359296
s_add_u32 s50, s50, s46
s_mul_i32 s51, s43, 4608
s_add_u32 s50, s50, s51
s_add_u32 s31, s50, s76
s_add_u32 s32, s31, 4096
s_add_u32 s33, s32, 36864
s_lshl_b32 s35, s40, 2
s_add_u32 s35, s35, s4
s_lshl_b32 s35, s35, 5
s_add_u32 s35, s35, s41
s_lshl_b32 s35, s35, 7
s_add_u32 s35, s35, s77
s_add_u32 s35, s35, 393216
v_lshlrev_b32 v15, 3, v13
v_lshl_add_u32 v15, v14, 8, v15
s_lshl_b32 s47, s44, 10
s_add_u32 s47, s47, s74
s_lshl_b32 s49, s44, 10
s_add_u32 s49, s49, s77
s_add_u32 s49, s49, 262144
v_and_b32 v16, 31, v1
v_lshlrev_b32 v16, 7, v16
s_mov_b32 s52, 0
L_poll4:
buffer_load_dword v253, v16, s[8:11], s49 offen sc1
s_add_u32 s52, s52, 1
s_waitcnt vmcnt(0)
v_cmp_eq_u32 vcc, 0, v253
s_cmp_ge_u32 s52, 0x100000
s_cbranch_scc1 L_got4
s_and_b64 exec, exec, vcc
s_cbranch_execnz L_poll4
L_got4:
s_mov_b64 exec, -1
s_add_u32 s48, s20, 0
buffer_load_dwordx4 a[0:3], v2, s[8:11], s48 offen offset:0 sc1
buffer_load_dwordx4 a[4:7], v4, s[8:11], s48 offen offset:0 sc1
buffer_load_dwordx4 a[8:11], v5, s[8:11], s48 offen offset:0 sc1
buffer_load_dwordx4 a[12:15], v6, s[8:11], s48 offen offset:0 sc1
buffer_load_dwordx4 a[16:19], v2, s[8:11], s48 offen offset:1024 sc1
buffer_load_dwordx4 a[20:23], v4, s[8:11], s48 offen offset:1024 sc1
buffer_load_dwordx4 a[24:27], v5, s[8:11], s48 offen offset:1024 sc1
buffer_load_dwordx4 a[28:31], v6, s[8:11], s48 offen offset:1024 sc1
buffer_load_dwordx2 v[144:145], v15, s[8:11], s47 offen offset:0 sc1
buffer_load_dwordx2 v[146:147], v15, s[8:11], s47 offen offset:128 sc1
buffer_load_dwordx2 v[148:149], v15, s[8:11], s47 offen offset:1024 sc1
buffer_load_dwordx2 v[150:151], v15, s[8:11], s47 offen offset:1152 sc1
buffer_load_dwordx2 v[152:153], v15, s[8:11], s47 offen offset:2048 sc1
buffer_load_dwordx2 v[154:155], v15, s[8:11], s47 offen offset:2176 sc1
buffer_load_dwordx2 v[156:157], v15, s[8:11], s47 offen offset:3072 sc1
buffer_load_dwordx2 v[158:159], v15, s[8:11], s47 offen offset:3200 sc1
buffer_load_dwordx4 a[32:35], v2, s[8:11], s48 offen offset:2048 sc1
buffer_load_dwordx4 a[36:39], v4, s[8:11], s48 offen offset:2048 sc1
buffer_load_dwordx4 a[40:43], v5, s[8:11], s48 offen offset:2048 sc1
buffer_load_dwordx4 a[44:47], v6, s[8:11], s48 offen offset:2048 sc1
buffer_load_dwordx4 a[48:51], v2, s[8:11], s48 offen offset:3072 sc1
buffer_load_dwordx4 a[52:55], v4, s[8:11], s48 offen offset:3072 sc1
buffer_load_dwordx4 a[56:59], v5, s[8:11], s48 offen offset:3072 sc1
buffer_load_dwordx4 a[60:63], v6, s[8:11], s48 offen offset:3072 sc1
s_add_u32 s48, s20, 4096
buffer_load_dwordx4 a[64:67], v2, s[8:11], s48 offen offset:0 sc1
buffer_load_dwordx4 a[68:71], v4, s[8:11], s48 offen offset:0 sc1
buffer_load_dwordx4 a[72:75], v5, s[8:11], s48 offen offset:0 sc1
buffer_load_dwordx4 a[76:79], v6, s[8:11], s48 offen offset:0 sc1
s_barrier
ds_read_b128 v[48:51], v2 offset:0
ds_read_b128 v[52:55], v2 offset:1024
ds_read_b128 v[56:59], v2 offset:2048
ds_read_b128 v[60:63], v2 offset:3072
ds_read_b128 v[64:67], v2 offset:4096
ds_read_b128 v[68:71], v2 offset:5120
s_waitcnt vmcnt(20)
s_waitcnt lgkmcnt(4)
v_mfma_f32_16x16x32_bf16 v[80:83], v[48:51], a[0:3], 0
buffer_load_dwordx4 a[80:83], v2, s[8:11], s48 offen offset:1024 sc1
v_mfma_f32_16x16x32_bf16 v[80:83], v[52:55], a[16:19], v[80:83]
v_mfma_f32_16x16x32_bf16 v[84:87], v[48:51], a[4:7], 0
ds_read_b128 v[72:75], v2 offset:6144
v_mfma_f32_16x16x32_bf16 v[84:87], v[52:55], a[20:23], v[84:87]
v_mfma_f32_16x16x32_bf16 v[88:91], v[48:51], a[8:11], 0
buffer_load_dwordx4 a[84:87], v4, s[8:11], s48 offen offset:1024 sc1
v_mfma_f32_16x16x32_bf16 v[88:91], v[52:55], a[24:27], v[88:91]
ds_read_b128 v[76:79], v2 offset:7168
v_mfma_f32_16x16x32_bf16 v[92:95], v[48:51], a[12:15], 0
v_mfma_f32_16x16x32_bf16 v[92:95], v[52:55], a[28:31], v[92:95]
s_waitcnt lgkmcnt(4)
v_mfma_f32_16x16x32_bf16 v[96:99], v[56:59], a[0:3], 0
buffer_load_dwordx4 a[88:91], v5, s[8:11], s48 offen offset:1024 sc1
v_mfma_f32_16x16x32_bf16 v[96:99], v[60:63], a[16:19], v[96:99]
v_mfma_f32_16x16x32_bf16 v[100:103], v[56:59], a[4:7], 0
ds_read_b128 v[48:51], v2 offset:8192
v_mfma_f32_16x16x32_bf16 v[100:103], v[60:63], a[20:23], v[100:103]
v_mfma_f32_16x16x32_bf16 v[104:107], v[56:59], a[8:11], 0
buffer_load_dwordx4 a[92:95], v6, s[8:11], s48 offen offset:1024 sc1
v_mfma_f32_16x16x32_bf16 v[104:107], v[60:63], a[24:27], v[104:107]
ds_read_b128 v[52:55], v2 offset:9216
v_mfma_f32_16x16x32_bf16 v[108:111], v[56:59], a[12:15], 0
v_mfma_f32_16x16x32_bf16 v[108:111], v[60:63], a[28:31], v[108:111]
s_waitcnt lgkmcnt(4)
v_mfma_f32_16x16x32_bf16 v[112:115], v[64:67], a[0:3], 0
buffer_load_dwordx4 a[96:99], v2, s[8:11], s48 offen offset:2048 sc1
v_mfma_f32_16x16x32_bf16 v[112:115], v[68:71], a[16:19], v[112:115]
v_mfma_f32_16x16x32_bf16 v[116:119], v[64:67], a[4:7], 0
ds_read_b128 v[56:59], v2 offset:10240
v_mfma_f32_16x16x32_bf16 v[116:119], v[68:71], a[20:23], v[116:119]
v_mfma_f32_16x16x32_bf16 v[120:123], v[64:67], a[8:11], 0
buffer_load_dwordx4 a[100:103], v4, s[8:11], s48 offen offset:2048 sc1
v_mfma_f32_16x16x32_bf16 v[120:123], v[68:71], a[24:27], v[120:123]
ds_read_b128 v[60:63], v2 offset:11264
v_mfma_f32_16x16x32_bf16 v[124:127], v[64:67], a[12:15], 0
v_mfma_f32_16x16x32_bf16 v[124:127], v[68:71], a[28:31], v[124:127]
s_waitcnt lgkmcnt(4)
v_mfma_f32_16x16x32_bf16 v[128:131], v[72:75], a[0:3], 0
buffer_load_dwordx4 a[104:107], v5, s[8:11], s48 offen offset:2048 sc1
v_mfma_f32_16x16x32_bf16 v[128:131], v[76:79], a[16:19], v[128:131]
v_mfma_f32_16x16x32_bf16 v[132:135], v[72:75], a[4:7], 0
ds_read_b128 v[64:67], v2 offset:12288
v_mfma_f32_16x16x32_bf16 v[132:135], v[76:79], a[20:23], v[132:135]
v_mfma_f32_16x16x32_bf16 v[136:139], v[72:75], a[8:11], 0
buffer_load_dwordx4 a[108:111], v6, s[8:11], s48 offen offset:2048 sc1
v_mfma_f32_16x16x32_bf16 v[136:139], v[76:79], a[24:27], v[136:139]
ds_read_b128 v[68:71], v2 offset:13312
v_mfma_f32_16x16x32_bf16 v[140:143], v[72:75], a[12:15], 0
v_mfma_f32_16x16x32_bf16 v[140:143], v[76:79], a[28:31], v[140:143]
s_waitcnt vmcnt(12)
s_waitcnt lgkmcnt(4)
v_mfma_f32_16x16x32_bf16 v[80:83], v[48:51], a[32:35], v[80:83]
buffer_load_dwordx4 a[112:115], v2, s[8:11], s48 offen offset:3072 sc1
v_mfma_f32_16x16x32_bf16 v[80:83], v[52:55], a[48:51], v[80:83]
v_mfma_f32_16x16x32_bf16 v[84:87], v[48:51], a[36:39], v[84:87]
ds_read_b128 v[72:75], v2 offset:14336
v_mfma_f32_16x16x32_bf16 v[84:87], v[52:55], a[52:55], v[84:87]
v_mfma_f32_16x16x32_bf16 v[88:91], v[48:51], a[40:43], v[88:91]
buffer_load_dwordx4 a[116:119], v4, s[8:11], s48 offen offset:3072 sc1
v_mfma_f32_16x16x32_bf16 v[88:91], v[52:55], a[56:59], v[88:91]
ds_read_b128 v[76:79], v2 offset:15360
v_mfma_f32_16x16x32_bf16 v[92:95], v[48:51], a[44:47], v[92:95]
v_mfma_f32_16x16x32_bf16 v[92:95], v[52:55], a[60:63], v[92:95]
s_waitcnt lgkmcnt(4)
v_mfma_f32_16x16x32_bf16 v[96:99], v[56:59], a[32:35], v[96:99]
buffer_load_dwordx4 a[120:123], v5, s[8:11], s48 offen offset:3072 sc1
v_mfma_f32_16x16x32_bf16 v[96:99], v[60:63], a[48:51], v[96:99]
v_mfma_f32_16x16x32_bf16 v[100:103], v[56:59], a[36:39], v[100:103]
ds_read_b128 v[48:51], v2 offset:16384
v_mfma_f32_16x16x32_bf16 v[100:103], v[60:63], a[52:55], v[100:103]
v_mfma_f32_16x16x32_bf16 v[104:107], v[56:59], a[40:43], v[104:107]
buffer_load_dwordx4 a[124:127], v6, s[8:11], s48 offen offset:3072 sc1
v_mfma_f32_16x16x32_bf16 v[104:107], v[60:63], a[56:59], v[104:107]
ds_read_b128 v[52:55], v2 offset:17408
s_add_u32 s48, s20, 8192
v_mfma_f32_16x16x32_bf16 v[108:111], v[56:59], a[44:47], v[108:111]
v_mfma_f32_16x16x32_bf16 v[108:111], v[60:63], a[60:63], v[108:111]
s_waitcnt lgkmcnt(4)
v_mfma_f32_16x16x32_bf16 v[112:115], v[64:67], a[32:35], v[112:115]
buffer_load_dwordx4 a[128:131], v2, s[8:11], s48 offen offset:0 sc1
v_mfma_f32_16x16x32_bf16 v[112:115], v[68:71], a[48:51], v[112:115]
v_mfma_f32_16x16x32_bf16 v[116:119], v[64:67], a[36:39], v[116:119]
ds_read_b128 v[56:59], v2 offset:18432
v_mfma_f32_16x16x32_bf16 v[116:119], v[68:71], a[52:55], v[116:119]
v_mfma_f32_16x16x32_bf16 v[120:123], v[64:67], a[40:43], v[120:123]
buffer_load_dwordx4 a[132:135], v4, s[8:11], s48 offen offset:0 sc1
v_mfma_f32_16x16x32_bf16 v[120:123], v[68:71], a[56:59], v[120:123]
ds_read_b128 v[60:63], v2 offset:19456
v_mfma_f32_16x16x32_bf16 v[124:127], v[64:67], a[44:47], v[124:127]
v_mfma_f32_16x16x32_bf16 v[124:127], v[68:71], a[60:63], v[124:127]
s_waitcnt lgkmcnt(4)
v_mfma_f32_16x16x32_bf16 v[128:131], v[72:75], a[32:35], v[128:131]
buffer_load_dwordx4 a[136:139], v5, s[8:11], s48 offen offset:0 sc1
v_mfma_f32_16x16x32_bf16 v[128:131], v[76:79], a[48:51], v[128:131]
v_mfma_f32_16x16x32_bf16 v[132:135], v[72:75], a[36:39], v[132:135]
ds_read_b128 v[64:67], v2 offset:20480
v_mfma_f32_16x16x32_bf16 v[132:135], v[76:79], a[52:55], v[132:135]
v_mfma_f32_16x16x32_bf16 v[136:139], v[72:75], a[40:43], v[136:139]
buffer_load_dwordx4 a[140:143], v6, s[8:11], s48 offen offset:0 sc1
v_mfma_f32_16x16x32_bf16 v[136:139], v[76:79], a[56:59], v[136:139]
ds_read_b128 v[68:71], v2 offset:21504
v_mfma_f32_16x16x32_bf16 v[140:143], v[72:75], a[44:47], v[140:143]
v_mfma_f32_16x16x32_bf16 v[140:143], v[76:79], a[60:63], v[140:143]
s_waitcnt vmcnt(12)
s_waitcnt lgkmcnt(4)
v_mfma_f32_16x16x32_bf16 v[80:83], v[48:51], a[64:67], v[80:83]
buffer_load_dwordx4 a[144:147], v2, s[8:11], s48 offen offset:1024 sc1
v_mfma_f32_16x16x32_bf16 v[80:83], v[52:55], a[80:83], v[80:83]
v_mfma_f32_16x16x32_bf16 v[84:87], v[48:51], a[68:71], v[84:87]
ds_read_b128 v[72:75], v2 offset:22528
v_mfma_f32_16x16x32_bf16 v[84:87], v[52:55], a[84:87], v[84:87]
v_add_f32 v144, v144, v146
v_add_f32 v145, v145, v147
v_mfma_f32_16x16x32_bf16 v[88:91], v[48:51], a[72:75], v[88:91]
buffer_load_dwordx4 a[148:151], v4, s[8:11], s48 offen offset:1024 sc1
v_mfma_f32_16x16x32_bf16 v[88:91], v[52:55], a[88:91], v[88:91]
ds_read_b128 v[76:79], v2 offset:23552
v_add_f32 v148, v148, v150
v_mfma_f32_16x16x32_bf16 v[92:95], v[48:51], a[76:79], v[92:95]
v_add_f32 v149, v149, v151
v_add_f32 v152, v152, v154
v_mfma_f32_16x16x32_bf16 v[92:95], v[52:55], a[92:95], v[92:95]
v_add_f32 v153, v153, v155
s_waitcnt lgkmcnt(4)
v_mfma_f32_16x16x32_bf16 v[96:99], v[56:59], a[64:67], v[96:99]
buffer_load_dwordx4 a[152:155], v5, s[8:11], s48 offen offset:1024 sc1
v_mfma_f32_16x16x32_bf16 v[96:99], v[60:63], a[80:83], v[96:99]
s_barrier
v_mfma_f32_16x16x32_bf16 v[100:103], v[56:59], a[68:71], v[100:103]
ds_read_b128 v[48:51], v2 offset:24576
v_add_f32 v156, v156, v158
v_mfma_f32_16x16x32_bf16 v[100:103], v[60:63], a[84:87], v[100:103]
v_add_f32 v157, v157, v159
v_mov_b32 v160, v144
v_mfma_f32_16x16x32_bf16 v[104:107], v[56:59], a[72:75], v[104:107]
buffer_load_dwordx4 a[156:159], v6, s[8:11], s48 offen offset:1024 sc1
v_mfma_f32_16x16x32_bf16 v[104:107], v[60:63], a[88:91], v[104:107]
ds_read_b128 v[52:55], v2 offset:25600
v_mov_b32 v161, v145
v_mfma_f32_16x16x32_bf16 v[108:111], v[56:59], a[76:79], v[108:111]
v_mov_b32 v162, v148
v_mov_b32 v163, v149
v_mfma_f32_16x16x32_bf16 v[108:111], v[60:63], a[92:95], v[108:111]
v_mov_b32 v164, v152
s_waitcnt lgkmcnt(4)
v_mfma_f32_16x16x32_bf16 v[112:115], v[64:67], a[64:67], v[112:115]
buffer_load_dwordx4 a[160:163], v2, s[8:11], s48 offen offset:2048 sc1
v_mfma_f32_16x16x32_bf16 v[112:115], v[68:71], a[80:83], v[112:115]
v_mov_b32 v165, v153
v_mov_b32 v166, v156
v_mfma_f32_16x16x32_bf16 v[116:119], v[64:67], a[68:71], v[116:119]
ds_read_b128 v[56:59], v2 offset:26624
v_mov_b32 v167, v157
v_mfma_f32_16x16x32_bf16 v[116:119], v[68:71], a[84:87], v[116:119]
v_permlane16_swap_b32 v144, v160
v_permlane16_swap_b32 v145, v161
v_mfma_f32_16x16x32_bf16 v[120:123], v[64:67], a[72:75], v[120:123]
buffer_load_dwordx4 a[164:167], v4, s[8:11], s48 offen offset:2048 sc1
v_mfma_f32_16x16x32_bf16 v[120:123], v[68:71], a[88:91], v[120:123]
ds_read_b128 v[60:63], v2 offset:27648
v_permlane16_swap_b32 v148, v162
v_mfma_f32_16x16x32_bf16 v[124:127], v[64:67], a[76:79], v[124:127]
v_permlane16_swap_b32 v149, v163
v_permlane16_swap_b32 v152, v164
v_mfma_f32_16x16x32_bf16 v[124:127], v[68:71], a[92:95], v[124:127]
v_permlane16_swap_b32 v153, v165
s_waitcnt lgkmcnt(4)
v_mfma_f32_16x16x32_bf16 v[128:131], v[72:75], a[64:67], v[128:131]
buffer_load_dwordx4 a[168:171], v5, s[8:11], s48 offen offset:2048 sc1
v_mfma_f32_16x16x32_bf16 v[128:131], v[76:79], a[80:83], v[128:131]
v_permlane16_swap_b32 v156, v166
v_permlane16_swap_b32 v157, v167
v_mfma_f32_16x16x32_bf16 v[132:135], v[72:75], a[68:71], v[132:135]
ds_read_b128 v[64:67], v2 offset:28672
v_add_f32 v144, v144, v160
v_mfma_f32_16x16x32_bf16 v[132:135], v[76:79], a[84:87], v[132:135]
v_add_f32 v145, v145, v161
v_add_f32 v148, v148, v162
v_mfma_f32_16x16x32_bf16 v[136:139], v[72:75], a[72:75], v[136:139]
buffer_load_dwordx4 a[172:175], v6, s[8:11], s48 offen offset:2048 sc1
v_mfma_f32_16x16x32_bf16 v[136:139], v[76:79], a[88:91], v[136:139]
ds_read_b128 v[68:71], v2 offset:29696
v_add_f32 v149, v149, v163
v_mfma_f32_16x16x32_bf16 v[140:143], v[72:75], a[76:79], v[140:143]
v_add_f32 v152, v152, v164
v_add_f32 v153, v153, v165
v_mfma_f32_16x16x32_bf16 v[140:143], v[76:79], a[92:95], v[140:143]
v_add_f32 v156, v156, v166
s_waitcnt vmcnt(12)
s_waitcnt lgkmcnt(4)
v_mfma_f32_16x16x32_bf16 v[80:83], v[48:51], a[96:99], v[80:83]
buffer_load_dwordx4 a[176:179], v2, s[8:11], s48 offen offset:3072 sc1
v_mfma_f32_16x16x32_bf16 v[80:83], v[52:55], a[112:115], v[80:83]
v_add_f32 v157, v157, v167
v_mov_b32 v160, v144
v_mfma_f32_16x16x32_bf16 v[84:87], v[48:51], a[100:103], v[84:87]
ds_read_b128 v[72:75], v2 offset:30720
v_mov_b32 v161, v145
v_mfma_f32_16x16x32_bf16 v[84:87], v[52:55], a[116:119], v[84:87]
v_mov_b32 v162, v148
v_mov_b32 v163, v149
v_mfma_f32_16x16x32_bf16 v[88:91], v[48:51], a[104:107], v[88:91]
buffer_load_dwordx4 a[180:183], v4, s[8:11], s48 offen offset:3072 sc1
v_mfma_f32_16x16x32_bf16 v[88:91], v[52:55], a[120:123], v[88:91]
ds_read_b128 v[76:79], v2 offset:31744
v_mov_b32 v164, v152
v_mfma_f32_16x16x32_bf16 v[92:95], v[48:51], a[108:111], v[92:95]
v_mov_b32 v165, v153
v_mov_b32 v166, v156
v_mfma_f32_16x16x32_bf16 v[92:95], v[52:55], a[124:127], v[92:95]
v_mov_b32 v167, v157
s_waitcnt lgkmcnt(4)
v_mfma_f32_16x16x32_bf16 v[96:99], v[56:59], a[96:99], v[96:99]
buffer_load_dwordx4 a[184:187], v5, s[8:11], s48 offen offset:3072 sc1
v_mfma_f32_16x16x32_bf16 v[96:99], v[60:63], a[112:115], v[96:99]
v_permlane32_swap_b32 v144, v160
v_permlane32_swap_b32 v145, v161
v_mfma_f32_16x16x32_bf16 v[100:103], v[56:59], a[100:103], v[100:103]
ds_read_b128 v[48:51], v2 offset:32768
v_permlane32_swap_b32 v148, v162
v_mfma_f32_16x16x32_bf16 v[100:103], v[60:63], a[116:119], v[100:103]
v_permlane32_swap_b32 v149, v163
v_permlane32_swap_b32 v152, v164
v_mfma_f32_16x16x32_bf16 v[104:107], v[56:59], a[104:107], v[104:107]
buffer_load_dwordx4 a[188:191], v6, s[8:11], s48 offen offset:3072 sc1
v_mfma_f32_16x16x32_bf16 v[104:107], v[60:63], a[120:123], v[104:107]
ds_read_b128 v[52:55], v2 offset:33792
s_add_u32 s48, s20, 12288
v_mfma_f32_16x16x32_bf16 v[108:111], v[56:59], a[108:111], v[108:111]
v_permlane32_swap_b32 v153, v165
v_permlane32_swap_b32 v156, v166
v_mfma_f32_16x16x32_bf16 v[108:111], v[60:63], a[124:127], v[108:111]
v_permlane32_swap_b32 v157, v167
s_waitcnt lgkmcnt(4)
v_mfma_f32_16x16x32_bf16 v[112:115], v[64:67], a[96:99], v[112:115]
buffer_load_dwordx4 a[192:195], v2, s[8:11], s48 offen offset:0 sc1
v_mfma_f32_16x16x32_bf16 v[112:115], v[68:71], a[112:115], v[112:115]
v_add_f32 v144, v144, v160
v_add_f32 v145, v145, v161
v_mfma_f32_16x16x32_bf16 v[116:119], v[64:67], a[100:103], v[116:119]
ds_read_b128 v[56:59], v2 offset:34816
v_add_f32 v148, v148, v162
v_mfma_f32_16x16x32_bf16 v[116:119], v[68:71], a[116:119], v[116:119]
v_add_f32 v149, v149, v163
v_add_f32 v152, v152, v164
v_mfma_f32_16x16x32_bf16 v[120:123], v[64:67], a[104:107], v[120:123]
buffer_load_dwordx4 a[196:199], v4, s[8:11], s48 offen offset:0 sc1
v_mfma_f32_16x16x32_bf16 v[120:123], v[68:71], a[120:123], v[120:123]
ds_read_b128 v[60:63], v2 offset:35840
v_add_f32 v153, v153, v165
v_mfma_f32_16x16x32_bf16 v[124:127], v[64:67], a[108:111], v[124:127]
v_add_f32 v156, v156, v166
v_add_f32 v157, v157, v167
v_mfma_f32_16x16x32_bf16 v[124:127], v[68:71], a[124:127], v[124:127]
v_mul_f32 v144, 0x3ae38e39, v144
s_waitcnt lgkmcnt(4)
v_mfma_f32_16x16x32_bf16 v[128:131], v[72:75], a[96:99], v[128:131]
buffer_load_dwordx4 a[200:203], v5, s[8:11], s48 offen offset:0 sc1
v_mfma_f32_16x16x32_bf16 v[128:131], v[76:79], a[112:115], v[128:131]
v_mul_f32 v148, 0x3ae38e39, v148
v_mul_f32 v152, 0x3ae38e39, v152
v_mfma_f32_16x16x32_bf16 v[132:135], v[72:75], a[100:103], v[132:135]
ds_read_b128 v[64:67], v2 offset:36864
v_mul_f32 v156, 0x3ae38e39, v156
v_mfma_f32_16x16x32_bf16 v[132:135], v[76:79], a[116:119], v[132:135]
v_mul_f32 v145, 0x3ae38e39, v145
v_mul_f32 v149, 0x3ae38e39, v149
v_mfma_f32_16x16x32_bf16 v[136:139], v[72:75], a[104:107], v[136:139]
buffer_load_dwordx4 a[204:207], v6, s[8:11], s48 offen offset:0 sc1
v_mfma_f32_16x16x32_bf16 v[136:139], v[76:79], a[120:123], v[136:139]
ds_read_b128 v[68:71], v2 offset:37888
v_mul_f32 v153, 0x3ae38e39, v153
v_mfma_f32_16x16x32_bf16 v[140:143], v[72:75], a[108:111], v[140:143]
v_mul_f32 v157, 0x3ae38e39, v157
v_fma_f32 v145, -v144, v144, v145
v_mfma_f32_16x16x32_bf16 v[140:143], v[76:79], a[124:127], v[140:143]
v_fma_f32 v149, -v148, v148, v149
s_waitcnt vmcnt(12)
s_waitcnt lgkmcnt(4)
v_mfma_f32_16x16x32_bf16 v[80:83], v[48:51], a[128:131], v[80:83]
buffer_load_dwordx4 a[208:211], v2, s[8:11], s48 offen offset:1024 sc1
v_mfma_f32_16x16x32_bf16 v[80:83], v[52:55], a[144:147], v[80:83]
v_fma_f32 v153, -v152, v152, v153
v_fma_f32 v157, -v156, v156, v157
v_mfma_f32_16x16x32_bf16 v[84:87], v[48:51], a[132:135], v[84:87]
ds_read_b128 v[72:75], v2 offset:38912
v_max_f32 v145, 0, v145
v_mfma_f32_16x16x32_bf16 v[84:87], v[52:55], a[148:151], v[84:87]
v_max_f32 v149, 0, v149
v_max_f32 v153, 0, v153
v_mfma_f32_16x16x32_bf16 v[88:91], v[48:51], a[136:139], v[88:91]
buffer_load_dwordx4 a[212:215], v4, s[8:11], s48 offen offset:1024 sc1
v_mfma_f32_16x16x32_bf16 v[88:91], v[52:55], a[152:155], v[88:91]
ds_read_b128 v[76:79], v2 offset:39936
v_max_f32 v157, 0, v157
v_mfma_f32_16x16x32_bf16 v[92:95], v[48:51], a[140:143], v[92:95]
v_add_f32 v234, 0x3727c5ac, v145
v_add_f32 v237, 0x3727c5ac, v149
v_mfma_f32_16x16x32_bf16 v[92:95], v[52:55], a[156:159], v[92:95]
v_add_f32 v240, 0x3727c5ac, v153
s_waitcnt lgkmcnt(4)
v_mfma_f32_16x16x32_bf16 v[96:99], v[56:59], a[128:131], v[96:99]
buffer_load_dwordx4 a[216:219], v5, s[8:11], s48 offen offset:1024 sc1
v_mfma_f32_16x16x32_bf16 v[96:99], v[60:63], a[144:147], v[96:99]
v_add_f32 v243, 0x3727c5ac, v157
v_mfma_f32_16x16x32_bf16 v[100:103], v[56:59], a[132:135], v[100:103]
ds_read_b128 v[48:51], v2 offset:40960
v_mfma_f32_16x16x32_bf16 v[100:103], v[60:63], a[148:151], v[100:103]
v_rsq_f32 v144, v234
v_mfma_f32_16x16x32_bf16 v[104:107], v[56:59], a[136:139], v[104:107]
buffer_load_dwordx4 a[220:223], v6, s[8:11], s48 offen offset:1024 sc1
v_mfma_f32_16x16x32_bf16 v[104:107], v[60:63], a[152:155], v[104:107]
ds_read_b128 v[52:55], v2 offset:41984
v_mul_f32 v232, 0xc0135761, v144
v_mfma_f32_16x16x32_bf16 v[108:111], v[56:59], a[140:143], v[108:111]
v_rsq_f32 v148, v237
v_mfma_f32_16x16x32_bf16 v[108:111], v[60:63], a[156:159], v[108:111]
v_mul_f32 v235, 0xc0135761, v148
s_waitcnt lgkmcnt(4)
v_mfma_f32_16x16x32_bf16 v[112:115], v[64:67], a[128:131], v[112:115]
buffer_load_dwordx4 a[224:227], v2, s[8:11], s48 offen offset:2048 sc1
v_mfma_f32_16x16x32_bf16 v[112:115], v[68:71], a[144:147], v[112:115]
v_rsq_f32 v152, v240
v_mfma_f32_16x16x32_bf16 v[116:119], v[64:67], a[132:135], v[116:119]
ds_read_b128 v[56:59], v2 offset:43008
v_mul_f32 v238, 0xc0135761, v152
v_mfma_f32_16x16x32_bf16 v[116:119], v[68:71], a[148:151], v[116:119]
v_rsq_f32 v156, v243
v_mfma_f32_16x16x32_bf16 v[120:123], v[64:67], a[136:139], v[120:123]
buffer_load_dwordx4 a[228:231], v4, s[8:11], s48 offen offset:2048 sc1
v_mfma_f32_16x16x32_bf16 v[120:123], v[68:71], a[152:155], v[120:123]
ds_read_b128 v[60:63], v2 offset:44032
v_mul_f32 v241, 0xc0135761, v156
v_mfma_f32_16x16x32_bf16 v[124:127], v[64:67], a[140:143], v[124:127]
v_mul_f32 v145, v144, v144
v_mul_f32 v149, v148, v148
v_mfma_f32_16x16x32_bf16 v[124:127], v[68:71], a[156:159], v[124:127]
v_mul_f32 v153, v152, v152
s_waitcnt lgkmcnt(4)
v_mfma_f32_16x16x32_bf16 v[128:131], v[72:75], a[128:131], v[128:131]
buffer_load_dwordx4 a[232:235], v5, s[8:11], s48 offen offset:2048 sc1
v_mfma_f32_16x16x32_bf16 v[128:131], v[76:79], a[144:147], v[128:131]
v_mul_f32 v157, v156, v156
v_mul_f32 v145, v145, v144
v_mfma_f32_16x16x32_bf16 v[132:135], v[72:75], a[132:135], v[132:135]
ds_read_b128 v[64:67], v2 offset:45056
v_mul_f32 v149, v149, v148
v_mfma_f32_16x16x32_bf16 v[132:135], v[76:79], a[148:151], v[132:135]
v_mul_f32 v153, v153, v152
v_mul_f32 v157, v157, v156
v_mfma_f32_16x16x32_bf16 v[136:139], v[72:75], a[136:139], v[136:139]
buffer_load_dwordx4 a[236:239], v6, s[8:11], s48 offen offset:2048 sc1
v_mfma_f32_16x16x32_bf16 v[136:139], v[76:79], a[152:155], v[136:139]
ds_read_b128 v[68:71], v2 offset:46080
v_mul_f32 v233, 0xbdd2d3e8, v145
v_mfma_f32_16x16x32_bf16 v[140:143], v[72:75], a[140:143], v[140:143]
v_mul_f32 v236, 0xbdd2d3e8, v149
v_mul_f32 v239, 0xbdd2d3e8, v153
v_mfma_f32_16x16x32_bf16 v[140:143], v[76:79], a[156:159], v[140:143]
v_mul_f32 v242, 0xbdd2d3e8, v157
s_waitcnt vmcnt(12)
s_waitcnt lgkmcnt(4)
v_mfma_f32_16x16x32_bf16 v[80:83], v[48:51], a[160:163], v[80:83]
buffer_load_dwordx4 a[240:243], v2, s[8:11], s48 offen offset:3072 sc1
v_mfma_f32_16x16x32_bf16 v[80:83], v[52:55], a[176:179], v[80:83]
v_mfma_f32_16x16x32_bf16 v[84:87], v[48:51], a[164:167], v[84:87]
ds_read_b128 v[72:75], v2 offset:47104
v_mfma_f32_16x16x32_bf16 v[84:87], v[52:55], a[180:183], v[84:87]
v_mfma_f32_16x16x32_bf16 v[88:91], v[48:51], a[168:171], v[88:91]
buffer_load_dwordx4 a[244:247], v4, s[8:11], s48 offen offset:3072 sc1
v_mfma_f32_16x16x32_bf16 v[88:91], v[52:55], a[184:187], v[88:91]
ds_read_b128 v[76:79], v2 offset:48128
v_mfma_f32_16x16x32_bf16 v[92:95], v[48:51], a[172:175], v[92:95]
v_mfma_f32_16x16x32_bf16 v[92:95], v[52:55], a[188:191], v[92:95]
s_waitcnt lgkmcnt(4)
v_mfma_f32_16x16x32_bf16 v[96:99], v[56:59], a[160:163], v[96:99]
buffer_load_dwordx4 a[248:251], v5, s[8:11], s48 offen offset:3072 sc1
v_mfma_f32_16x16x32_bf16 v[96:99], v[60:63], a[176:179], v[96:99]
s_barrier
v_mfma_f32_16x16x32_bf16 v[100:103], v[56:59], a[164:167], v[100:103]
ds_read_b128 v[48:51], v2 offset:49152
v_mfma_f32_16x16x32_bf16 v[100:103], v[60:63], a[180:183], v[100:103]
v_mfma_f32_16x16x32_bf16 v[104:107], v[56:59], a[168:171], v[104:107]
buffer_load_dwordx4 a[252:255], v6, s[8:11], s48 offen offset:3072 sc1
v_mfma_f32_16x16x32_bf16 v[104:107], v[60:63], a[184:187], v[104:107]
ds_read_b128 v[52:55], v2 offset:50176
s_add_u32 s48, s20, 16384
v_mfma_f32_16x16x32_bf16 v[108:111], v[56:59], a[172:175], v[108:111]
v_mfma_f32_16x16x32_bf16 v[108:111], v[60:63], a[188:191], v[108:111]
s_waitcnt lgkmcnt(4)
v_mfma_f32_16x16x32_bf16 v[112:115], v[64:67], a[160:163], v[112:115]
buffer_load_dwordx4 v[16:19], v2, s[8:11], s48 offen offset:0 sc1
v_mfma_f32_16x16x32_bf16 v[112:115], v[68:71], a[176:179], v[112:115]
v_mfma_f32_16x16x32_bf16 v[116:119], v[64:67], a[164:167], v[116:119]
ds_read_b128 v[56:59], v2 offset:51200
v_mfma_f32_16x16x32_bf16 v[116:119], v[68:71], a[180:183], v[116:119]
v_mfma_f32_16x16x32_bf16 v[120:123], v[64:67], a[168:171], v[120:123]
buffer_load_dwordx4 v[20:23], v4, s[8:11], s48 offen offset:0 sc1
v_mfma_f32_16x16x32_bf16 v[120:123], v[68:71], a[184:187], v[120:123]
ds_read_b128 v[60:63], v2 offset:52224
v_mfma_f32_16x16x32_bf16 v[124:127], v[64:67], a[172:175], v[124:127]
v_mfma_f32_16x16x32_bf16 v[124:127], v[68:71], a[188:191], v[124:127]
s_waitcnt lgkmcnt(4)
v_mfma_f32_16x16x32_bf16 v[128:131], v[72:75], a[160:163], v[128:131]
buffer_load_dwordx4 v[24:27], v5, s[8:11], s48 offen offset:0 sc1
v_mfma_f32_16x16x32_bf16 v[128:131], v[76:79], a[176:179], v[128:131]
v_mfma_f32_16x16x32_bf16 v[132:135], v[72:75], a[164:167], v[132:135]
ds_read_b128 v[64:67], v2 offset:53248
v_mfma_f32_16x16x32_bf16 v[132:135], v[76:79], a[180:183], v[132:135]
v_mfma_f32_16x16x32_bf16 v[136:139], v[72:75], a[168:171], v[136:139]
buffer_load_dwordx4 v[28:31], v6, s[8:11], s48 offen offset:0 sc1
v_mfma_f32_16x16x32_bf16 v[136:139], v[76:79], a[184:187], v[136:139]
ds_read_b128 v[68:71], v2 offset:54272
v_mfma_f32_16x16x32_bf16 v[140:143], v[72:75], a[172:175], v[140:143]
v_mfma_f32_16x16x32_bf16 v[140:143], v[76:79], a[188:191], v[140:143]
s_waitcnt vmcnt(12)
s_waitcnt lgkmcnt(4)
v_mfma_f32_16x16x32_bf16 v[80:83], v[48:51], a[192:195], v[80:83]
buffer_load_dwordx4 v[32:35], v2, s[8:11], s48 offen offset:1024 sc1
v_mfma_f32_16x16x32_bf16 v[80:83], v[52:55], a[208:211], v[80:83]
v_mfma_f32_16x16x32_bf16 v[84:87], v[48:51], a[196:199], v[84:87]
ds_read_b128 v[72:75], v2 offset:55296
v_mfma_f32_16x16x32_bf16 v[84:87], v[52:55], a[212:215], v[84:87]
v_mfma_f32_16x16x32_bf16 v[88:91], v[48:51], a[200:203], v[88:91]
buffer_load_dwordx4 v[36:39], v4, s[8:11], s48 offen offset:1024 sc1
v_mfma_f32_16x16x32_bf16 v[88:91], v[52:55], a[216:219], v[88:91]
ds_read_b128 v[76:79], v2 offset:56320
v_mfma_f32_16x16x32_bf16 v[92:95], v[48:51], a[204:207], v[92:95]
v_mfma_f32_16x16x32_bf16 v[92:95], v[52:55], a[220:223], v[92:95]
s_waitcnt lgkmcnt(4)
v_mfma_f32_16x16x32_bf16 v[96:99], v[56:59], a[192:195], v[96:99]
buffer_load_dwordx4 v[40:43], v5, s[8:11], s48 offen offset:1024 sc1
v_mfma_f32_16x16x32_bf16 v[96:99], v[60:63], a[208:211], v[96:99]
v_mfma_f32_16x16x32_bf16 v[100:103], v[56:59], a[196:199], v[100:103]
ds_read_b128 v[48:51], v2 offset:57344
v_mfma_f32_16x16x32_bf16 v[100:103], v[60:63], a[212:215], v[100:103]
v_mfma_f32_16x16x32_bf16 v[104:107], v[56:59], a[200:203], v[104:107]
buffer_load_dwordx4 v[44:47], v6, s[8:11], s48 offen offset:1024 sc1
v_mfma_f32_16x16x32_bf16 v[104:107], v[60:63], a[216:219], v[104:107]
ds_read_b128 v[52:55], v2 offset:58368
s_add_u32 m0, s22, 98304
v_mfma_f32_16x16x32_bf16 v[108:111], v[56:59], a[204:207], v[108:111]
v_add_u32 v3, 20480, v3
v_mfma_f32_16x16x32_bf16 v[108:111], v[60:63], a[220:223], v[108:111]
s_waitcnt lgkmcnt(4)
v_mfma_f32_16x16x32_bf16 v[112:115], v[64:67], a[192:195], v[112:115]
buffer_load_dwordx4 v3, s[8:11], 0 offen offset:0 lds
v_mfma_f32_16x16x32_bf16 v[112:115], v[68:71], a[208:211], v[112:115]
v_mfma_f32_16x16x32_bf16 v[116:119], v[64:67], a[196:199], v[116:119]
ds_read_b128 v[56:59], v2 offset:59392
v_mfma_f32_16x16x32_bf16 v[116:119], v[68:71], a[212:215], v[116:119]
v_mfma_f32_16x16x32_bf16 v[120:123], v[64:67], a[200:203], v[120:123]
buffer_load_dwordx4 v3, s[8:11], 0 offen offset:1024 lds
v_mfma_f32_16x16x32_bf16 v[120:123], v[68:71], a[216:219], v[120:123]
ds_read_b128 v[60:63], v2 offset:60416
v_mfma_f32_16x16x32_bf16 v[124:127], v[64:67], a[204:207], v[124:127]
v_mfma_f32_16x16x32_bf16 v[124:127], v[68:71], a[220:223], v[124:127]
s_waitcnt lgkmcnt(4)
v_mfma_f32_16x16x32_bf16 v[128:131], v[72:75], a[192:195], v[128:131]
buffer_load_dwordx4 v3, s[8:11], 0 offen offset:2048 lds
v_mfma_f32_16x16x32_bf16 v[128:131], v[76:79], a[208:211], v[128:131]
v_mfma_f32_16x16x32_bf16 v[132:135], v[72:75], a[196:199], v[132:135]
ds_read_b128 v[64:67], v2 offset:61440
v_mfma_f32_16x16x32_bf16 v[132:135], v[76:79], a[212:215], v[132:135]
v_mfma_f32_16x16x32_bf16 v[136:139], v[72:75], a[200:203], v[136:139]
buffer_load_dwordx4 v3, s[8:11], 0 offen offset:3072 lds
v_mfma_f32_16x16x32_bf16 v[136:139], v[76:79], a[216:219], v[136:139]
ds_read_b128 v[68:71], v2 offset:62464
s_add_u32 m0, s22, 102400
v_mfma_f32_16x16x32_bf16 v[140:143], v[72:75], a[204:207], v[140:143]
v_add_u32 v3, 4096, v3
v_mfma_f32_16x16x32_bf16 v[140:143], v[76:79], a[220:223], v[140:143]
s_waitcnt vmcnt(12)
s_waitcnt lgkmcnt(4)
v_mfma_f32_16x16x32_bf16 v[80:83], v[48:51], a[224:227], v[80:83]
buffer_load_dwordx4 v3, s[8:11], 0 offen offset:0 lds
v_mfma_f32_16x16x32_bf16 v[80:83], v[52:55], a[240:243], v[80:83]
v_mfma_f32_16x16x32_bf16 v[84:87], v[48:51], a[228:231], v[84:87]
ds_read_b128 v[72:75], v2 offset:63488
v_mfma_f32_16x16x32_bf16 v[84:87], v[52:55], a[244:247], v[84:87]
v_mfma_f32_16x16x32_bf16 v[88:91], v[48:51], a[232:235], v[88:91]
buffer_load_dwordx4 v3, s[8:11], 0 offen offset:1024 lds
v_mfma_f32_16x16x32_bf16 v[88:91], v[52:55], a[248:251], v[88:91]
ds_read_b128 v[76:79], v2 offset:64512
s_add_u32 m0, s22, 122880
v_mfma_f32_16x16x32_bf16 v[92:95], v[48:51], a[236:239], v[92:95]
v_add_u32 v3, 20480, v3
v_mfma_f32_16x16x32_bf16 v[92:95], v[52:55], a[252:255], v[92:95]
s_waitcnt lgkmcnt(4)
v_mfma_f32_16x16x32_bf16 v[96:99], v[56:59], a[224:227], v[96:99]
buffer_load_dwordx4 v3, s[8:11], 0 offen offset:0 lds
v_mfma_f32_16x16x32_bf16 v[96:99], v[60:63], a[240:243], v[96:99]
v_mfma_f32_16x16x32_bf16 v[100:103], v[56:59], a[228:231], v[100:103]
ds_read_b128 v[48:51], v7 offset:0
v_mfma_f32_16x16x32_bf16 v[100:103], v[60:63], a[244:247], v[100:103]
v_mfma_f32_16x16x32_bf16 v[104:107], v[56:59], a[232:235], v[104:107]
buffer_load_dwordx4 v3, s[8:11], 0 offen offset:1024 lds
v_mfma_f32_16x16x32_bf16 v[104:107], v[60:63], a[248:251], v[104:107]
ds_read_b128 v[52:55], v7 offset:1024
v_mfma_f32_16x16x32_bf16 v[108:111], v[56:59], a[236:239], v[108:111]
v_mfma_f32_16x16x32_bf16 v[108:111], v[60:63], a[252:255], v[108:111]
s_waitcnt lgkmcnt(4)
v_mfma_f32_16x16x32_bf16 v[112:115], v[64:67], a[224:227], v[112:115]
buffer_load_dwordx4 v3, s[8:11], 0 offen offset:2048 lds
v_mfma_f32_16x16x32_bf16 v[112:115], v[68:71], a[240:243], v[112:115]
v_mfma_f32_16x16x32_bf16 v[116:119], v[64:67], a[228:231], v[116:119]
ds_read_b128 v[56:59], v7 offset:2048
v_mfma_f32_16x16x32_bf16 v[116:119], v[68:71], a[244:247], v[116:119]
v_mfma_f32_16x16x32_bf16 v[120:123], v[64:67], a[232:235], v[120:123]
buffer_load_dwordx4 v3, s[8:11], 0 offen offset:3072 lds
v_mfma_f32_16x16x32_bf16 v[120:123], v[68:71], a[248:251], v[120:123]
ds_read_b128 v[60:63], v7 offset:3072
s_add_u32 m0, s22, 126976
v_mfma_f32_16x16x32_bf16 v[124:127], v[64:67], a[236:239], v[124:127]
v_add_u32 v3, 4096, v3
v_mfma_f32_16x16x32_bf16 v[124:127], v[68:71], a[252:255], v[124:127]
s_waitcnt lgkmcnt(4)
v_mfma_f32_16x16x32_bf16 v[128:131], v[72:75], a[224:227], v[128:131]
buffer_load_dwordx4 v3, s[8:11], 0 offen offset:0 lds
v_mfma_f32_16x16x32_bf16 v[128:131], v[76:79], a[240:243], v[128:131]
v_mfma_f32_16x16x32_bf16 v[132:135], v[72:75], a[228:231], v[132:135]
ds_read_b128 v[64:67], v7 offset:4096
v_mfma_f32_16x16x32_bf16 v[132:135], v[76:79], a[244:247], v[132:135]
v_mfma_f32_16x16x32_bf16 v[136:139], v[72:75], a[232:235], v[136:139]
buffer_load_dwordx4 v3, s[8:11], 0 offen offset:1024 lds
v_mfma_f32_16x16x32_bf16 v[136:139], v[76:79], a[248:251], v[136:139]
ds_read_b128 v[68:71], v7 offset:5120
s_add_u32 m0, s22, 0
v_mfma_f32_16x16x32_bf16 v[140:143], v[72:75], a[236:239], v[140:143]
v_add_u32 v3, 20480, v3
v_mfma_f32_16x16x32_bf16 v[140:143], v[76:79], a[252:255], v[140:143]
s_waitcnt vmcnt(12)
s_waitcnt lgkmcnt(4)
v_mfma_f32_16x16x32_bf16 v[80:83], v[48:51], v[16:19], v[80:83]
buffer_load_dwordx4 v3, s[8:11], 0 offen offset:0 lds
v_mfma_f32_16x16x32_bf16 v[80:83], v[52:55], v[32:35], v[80:83]
v_mfma_f32_16x16x32_bf16 v[84:87], v[48:51], v[20:23], v[84:87]
ds_read_b128 v[72:75], v7 offset:6144
v_mfma_f32_16x16x32_bf16 v[84:87], v[52:55], v[36:39], v[84:87]
v_mfma_f32_16x16x32_bf16 v[88:91], v[48:51], v[24:27], v[88:91]
buffer_load_dwordx4 v3, s[8:11], 0 offen offset:1024 lds
v_mfma_f32_16x16x32_bf16 v[88:91], v[52:55], v[40:43], v[88:91]
ds_read_b128 v[76:79], v7 offset:7168
v_mfma_f32_16x16x32_bf16 v[92:95], v[48:51], v[28:31], v[92:95]
v_mfma_f32_16x16x32_bf16 v[92:95], v[52:55], v[44:47], v[92:95]
s_waitcnt lgkmcnt(4)
v_mfma_f32_16x16x32_bf16 v[96:99], v[56:59], v[16:19], v[96:99]
buffer_load_dwordx4 v3, s[8:11], 0 offen offset:2048 lds
v_mfma_f32_16x16x32_bf16 v[96:99], v[60:63], v[32:35], v[96:99]
s_barrier
v_mfma_f32_16x16x32_bf16 v[100:103], v[56:59], v[20:23], v[100:103]
ds_read_b128 v[48:51], v7 offset:8192
v_mfma_f32_16x16x32_bf16 v[100:103], v[60:63], v[36:39], v[100:103]
v_mfma_f32_16x16x32_bf16 v[104:107], v[56:59], v[24:27], v[104:107]
buffer_load_dwordx4 v3, s[8:11], 0 offen offset:3072 lds
v_mfma_f32_16x16x32_bf16 v[104:107], v[60:63], v[40:43], v[104:107]
ds_read_b128 v[52:55], v7 offset:9216
s_add_u32 m0, s22, 4096
v_mfma_f32_16x16x32_bf16 v[108:111], v[56:59], v[28:31], v[108:111]
v_add_u32 v3, 4096, v3
v_mfma_f32_16x16x32_bf16 v[108:111], v[60:63], v[44:47], v[108:111]
s_waitcnt lgkmcnt(4)
v_mfma_f32_16x16x32_bf16 v[112:115], v[64:67], v[16:19], v[112:115]
buffer_load_dwordx4 v3, s[8:11], 0 offen offset:0 lds
v_mfma_f32_16x16x32_bf16 v[112:115], v[68:71], v[32:35], v[112:115]
v_mfma_f32_16x16x32_bf16 v[116:119], v[64:67], v[20:23], v[116:119]
ds_read_b128 v[56:59], v7 offset:10240
v_mfma_f32_16x16x32_bf16 v[116:119], v[68:71], v[36:39], v[116:119]
v_mfma_f32_16x16x32_bf16 v[120:123], v[64:67], v[24:27], v[120:123]
buffer_load_dwordx4 v3, s[8:11], 0 offen offset:1024 lds
v_mfma_f32_16x16x32_bf16 v[120:123], v[68:71], v[40:43], v[120:123]
ds_read_b128 v[60:63], v7 offset:11264
s_add_u32 m0, s22, 24576
v_mfma_f32_16x16x32_bf16 v[124:127], v[64:67], v[28:31], v[124:127]
v_add_u32 v3, 20480, v3
v_mfma_f32_16x16x32_bf16 v[124:127], v[68:71], v[44:47], v[124:127]
s_waitcnt lgkmcnt(4)
v_mfma_f32_16x16x32_bf16 v[128:131], v[72:75], v[16:19], v[128:131]
buffer_load_dwordx4 v3, s[8:11], 0 offen offset:0 lds
v_mfma_f32_16x16x32_bf16 v[128:131], v[76:79], v[32:35], v[128:131]
v_mfma_f32_16x16x32_bf16 v[132:135], v[72:75], v[20:23], v[132:135]
ds_read_b128 v[64:67], v7 offset:12288
v_mfma_f32_16x16x32_bf16 v[132:135], v[76:79], v[36:39], v[132:135]
v_mfma_f32_16x16x32_bf16 v[136:139], v[72:75], v[24:27], v[136:139]
buffer_load_dwordx4 v3, s[8:11], 0 offen offset:1024 lds
v_mfma_f32_16x16x32_bf16 v[136:139], v[76:79], v[40:43], v[136:139]
ds_read_b128 v[68:71], v7 offset:13312
v_mfma_f32_16x16x32_bf16 v[140:143], v[72:75], v[28:31], v[140:143]
v_mfma_f32_16x16x32_bf16 v[140:143], v[76:79], v[44:47], v[140:143]
s_waitcnt lgkmcnt(4)
v_mfma_f32_16x16x32_bf16 v[176:179], v[48:51], a[0:3], 0
buffer_load_dwordx4 v3, s[8:11], 0 offen offset:2048 lds
v_mfma_f32_16x16x32_bf16 v[176:179], v[52:55], a[16:19], v[176:179]
v_mfma_f32_16x16x32_bf16 v[180:183], v[48:51], a[4:7], 0
ds_read_b128 v[72:75], v7 offset:14336
v_mfma_f32_16x16x32_bf16 v[180:183], v[52:55], a[20:23], v[180:183]
v_mul_f32 v208, v80, v80
v_mul_f32 v210, v81, v81
v_mfma_f32_16x16x32_bf16 v[184:187], v[48:51], a[8:11], 0
buffer_load_dwordx4 v3, s[8:11], 0 offen offset:3072 lds
v_mfma_f32_16x16x32_bf16 v[184:187], v[52:55], a[24:27], v[184:187]
ds_read_b128 v[76:79], v7 offset:15360
s_add_u32 m0, s22, 28672
v_mfma_f32_16x16x32_bf16 v[188:191], v[48:51], a[12:15], 0
v_add_u32 v3, 4096, v3
v_fma_f32 v208, v208, v233, v232
v_mfma_f32_16x16x32_bf16 v[188:191], v[52:55], a[28:31], v[188:191]
v_fma_f32 v210, v210, v233, v232
s_waitcnt lgkmcnt(4)
v_mfma_f32_16x16x32_bf16 v[192:195], v[56:59], a[0:3], 0
buffer_load_dwordx4 v3, s[8:11], 0 offen offset:0 lds
v_mfma_f32_16x16x32_bf16 v[192:195], v[60:63], a[16:19], v[192:195]
v_mul_f32 v208, v208, v80
v_mul_f32 v210, v210, v81
v_mfma_f32_16x16x32_bf16 v[196:199], v[56:59], a[4:7], 0
ds_read_b128 v[48:51], v7 offset:16384
v_mul_f32 v209, v80, v96
v_mfma_f32_16x16x32_bf16 v[196:199], v[60:63], a[20:23], v[196:199]
v_exp_f32 v208, v208
v_mfma_f32_16x16x32_bf16 v[200:203], v[56:59], a[8:11], 0
buffer_load_dwordx4 v3, s[8:11], 0 offen offset:1024 lds
v_mfma_f32_16x16x32_bf16 v[200:203], v[60:63], a[24:27], v[200:203]
ds_read_b128 v[52:55], v7 offset:17408
v_mul_f32 v211, v81, v97
v_mfma_f32_16x16x32_bf16 v[204:207], v[56:59], a[12:15], 0
v_exp_f32 v210, v210
v_mfma_f32_16x16x32_bf16 v[204:207], v[60:63], a[28:31], v[204:207]
v_fma_f32 v208, v208, v234, v234
s_waitcnt lgkmcnt(4)
v_mfma_f32_16x16x32_bf16 v[176:179], v[64:67], a[32:35], v[176:179]
v_fma_f32 v210, v210, v234, v234
v_mul_f32 v212, v82, v82
v_mfma_f32_16x16x32_bf16 v[176:179], v[68:71], a[48:51], v[176:179]
v_rcp_f32 v208, v208
v_mfma_f32_16x16x32_bf16 v[180:183], v[64:67], a[36:39], v[180:183]
ds_read_b128 v[56:59], v7 offset:18432
v_mul_f32 v209, v209, v208
v_mfma_f32_16x16x32_bf16 v[180:183], v[68:71], a[52:55], v[180:183]
v_rcp_f32 v210, v210
v_mfma_f32_16x16x32_bf16 v[184:187], v[64:67], a[40:43], v[184:187]
v_mul_f32 v211, v211, v210
v_cvt_pk_bf16_f32 v224, v209, v211
v_mfma_f32_16x16x32_bf16 v[184:187], v[68:71], a[56:59], v[184:187]
ds_read_b128 v[60:63], v7 offset:19456
v_mul_f32 v214, v83, v83
v_mfma_f32_16x16x32_bf16 v[188:191], v[64:67], a[44:47], v[188:191]
v_fma_f32 v212, v212, v233, v232
v_fma_f32 v214, v214, v233, v232
v_mfma_f32_16x16x32_bf16 v[188:191], v[68:71], a[60:63], v[188:191]
v_mul_f32 v212, v212, v82
s_waitcnt lgkmcnt(4)
v_mfma_f32_16x16x32_bf16 v[192:195], v[72:75], a[32:35], v[192:195]
v_mul_f32 v214, v214, v83
v_mul_f32 v213, v82, v98
v_mfma_f32_16x16x32_bf16 v[192:195], v[76:79], a[48:51], v[192:195]
v_exp_f32 v212, v212
v_mfma_f32_16x16x32_bf16 v[196:199], v[72:75], a[36:39], v[196:199]
ds_read_b128 v[64:67], v7 offset:20480
v_mul_f32 v215, v83, v99
v_mfma_f32_16x16x32_bf16 v[196:199], v[76:79], a[52:55], v[196:199]
v_exp_f32 v214, v214
v_mfma_f32_16x16x32_bf16 v[200:203], v[72:75], a[40:43], v[200:203]
v_fma_f32 v212, v212, v234, v234
v_fma_f32 v214, v214, v234, v234
v_mfma_f32_16x16x32_bf16 v[200:203], v[76:79], a[56:59], v[200:203]
ds_read_b128 v[68:71], v7 offset:21504
v_mul_f32 v208, v84, v84
v_mfma_f32_16x16x32_bf16 v[204:207], v[72:75], a[44:47], v[204:207]
v_rcp_f32 v212, v212
v_mfma_f32_16x16x32_bf16 v[204:207], v[76:79], a[60:63], v[204:207]
v_mul_f32 v213, v213, v212
s_waitcnt lgkmcnt(4)
v_mfma_f32_16x16x32_bf16 v[176:179], v[48:51], a[64:67], v[176:179]
v_rcp_f32 v214, v214
v_mfma_f32_16x16x32_bf16 v[176:179], v[52:55], a[80:83], v[176:179]
v_mul_f32 v215, v215, v214
v_cvt_pk_bf16_f32 v225, v213, v215
v_mfma_f32_16x16x32_bf16 v[180:183], v[48:51], a[68:71], v[180:183]
ds_read_b128 v[72:75], v7 offset:22528
v_mul_f32 v210, v85, v85
v_mfma_f32_16x16x32_bf16 v[180:183], v[52:55], a[84:87], v[180:183]
buffer_store_dwordx2 v[224:225], v244, s[8:11], s30 offen sc1
v_mfma_f32_16x16x32_bf16 v[184:187], v[48:51], a[72:75], v[184:187]
v_fma_f32 v208, v208, v236, v235
v_fma_f32 v210, v210, v236, v235
v_mfma_f32_16x16x32_bf16 v[184:187], v[52:55], a[88:91], v[184:187]
ds_read_b128 v[76:79], v7 offset:23552
v_mul_f32 v208, v208, v84
v_mfma_f32_16x16x32_bf16 v[188:191], v[48:51], a[76:79], v[188:191]
v_mul_f32 v210, v210, v85
v_mul_f32 v209, v84, v100
v_mfma_f32_16x16x32_bf16 v[188:191], v[52:55], a[92:95], v[188:191]
v_mul_f32 v211, v85, v101
s_waitcnt lgkmcnt(4)
v_mfma_f32_16x16x32_bf16 v[192:195], v[56:59], a[64:67], v[192:195]
v_exp_f32 v208, v208
v_mfma_f32_16x16x32_bf16 v[192:195], v[60:63], a[80:83], v[192:195]
v_exp_f32 v210, v210
v_mfma_f32_16x16x32_bf16 v[196:199], v[56:59], a[68:71], v[196:199]
ds_read_b128 v[48:51], v7 offset:24576
v_fma_f32 v208, v208, v237, v237
v_mfma_f32_16x16x32_bf16 v[196:199], v[60:63], a[84:87], v[196:199]
v_fma_f32 v210, v210, v237, v237
v_mul_f32 v212, v86, v86
v_mfma_f32_16x16x32_bf16 v[200:203], v[56:59], a[72:75], v[200:203]
v_rcp_f32 v208, v208
v_mfma_f32_16x16x32_bf16 v[200:203], v[60:63], a[88:91], v[200:203]
ds_read_b128 v[52:55], v7 offset:25600
v_mul_f32 v209, v209, v208
v_mfma_f32_16x16x32_bf16 v[204:207], v[56:59], a[76:79], v[204:207]
v_rcp_f32 v210, v210
v_mfma_f32_16x16x32_bf16 v[204:207], v[60:63], a[92:95], v[204:207]
v_mul_f32 v211, v211, v210
s_waitcnt lgkmcnt(4)
v_mfma_f32_16x16x32_bf16 v[176:179], v[64:67], a[96:99], v[176:179]
v_cvt_pk_bf16_f32 v226, v209, v211
v_mul_f32 v214, v87, v87
v_mfma_f32_16x16x32_bf16 v[176:179], v[68:71], a[112:115], v[176:179]
v_fma_f32 v212, v212, v236, v235
v_fma_f32 v214, v214, v236, v235
v_mfma_f32_16x16x32_bf16 v[180:183], v[64:67], a[100:103], v[180:183]
ds_read_b128 v[56:59], v7 offset:26624
v_mul_f32 v212, v212, v86
v_mfma_f32_16x16x32_bf16 v[180:183], v[68:71], a[116:119], v[180:183]
v_mul_f32 v214, v214, v87
v_mul_f32 v213, v86, v102
v_mfma_f32_16x16x32_bf16 v[184:187], v[64:67], a[104:107], v[184:187]
v_exp_f32 v212, v212
v_mfma_f32_16x16x32_bf16 v[184:187], v[68:71], a[120:123], v[184:187]
ds_read_b128 v[60:63], v7 offset:27648
v_mul_f32 v215, v87, v103
v_mfma_f32_16x16x32_bf16 v[188:191], v[64:67], a[108:111], v[188:191]
v_exp_f32 v214, v214
v_mfma_f32_16x16x32_bf16 v[188:191], v[68:71], a[124:127], v[188:191]
v_fma_f32 v212, v212, v237, v237
s_waitcnt lgkmcnt(4)
v_mfma_f32_16x16x32_bf16 v[192:195], v[72:75], a[96:99], v[192:195]
v_fma_f32 v214, v214, v237, v237
v_mul_f32 v208, v88, v88
v_mfma_f32_16x16x32_bf16 v[192:195], v[76:79], a[112:115], v[192:195]
v_rcp_f32 v212, v212
v_mfma_f32_16x16x32_bf16 v[196:199], v[72:75], a[100:103], v[196:199]
ds_read_b128 v[64:67], v7 offset:28672
v_mul_f32 v213, v213, v212
v_mfma_f32_16x16x32_bf16 v[196:199], v[76:79], a[116:119], v[196:199]
v_rcp_f32 v214, v214
v_mfma_f32_16x16x32_bf16 v[200:203], v[72:75], a[104:107], v[200:203]
v_mul_f32 v215, v215, v214
v_cvt_pk_bf16_f32 v227, v213, v215
v_mfma_f32_16x16x32_bf16 v[200:203], v[76:79], a[120:123], v[200:203]
ds_read_b128 v[68:71], v7 offset:29696
v_mul_f32 v210, v89, v89
v_mfma_f32_16x16x32_bf16 v[204:207], v[72:75], a[108:111], v[204:207]
buffer_store_dwordx2 v[226:227], v245, s[8:11], s30 offen sc1
v_mfma_f32_16x16x32_bf16 v[204:207], v[76:79], a[124:127], v[204:207]
v_fma_f32 v208, v208, v239, v238
s_waitcnt lgkmcnt(4)
v_mfma_f32_16x16x32_bf16 v[176:179], v[48:51], a[128:131], v[176:179]
v_fma_f32 v210, v210, v239, v238
v_mul_f32 v208, v208, v88
v_mfma_f32_16x16x32_bf16 v[176:179], v[52:55], a[144:147], v[176:179]
v_mul_f32 v210, v210, v89
v_mul_f32 v209, v88, v104
v_mfma_f32_16x16x32_bf16 v[180:183], v[48:51], a[132:135], v[180:183]
ds_read_b128 v[72:75], v7 offset:30720
v_mul_f32 v211, v89, v105
v_mfma_f32_16x16x32_bf16 v[180:183], v[52:55], a[148:151], v[180:183]
v_exp_f32 v208, v208
v_mfma_f32_16x16x32_bf16 v[184:187], v[48:51], a[136:139], v[184:187]
v_exp_f32 v210, v210
v_mfma_f32_16x16x32_bf16 v[184:187], v[52:55], a[152:155], v[184:187]
ds_read_b128 v[76:79], v7 offset:31744
v_fma_f32 v208, v208, v240, v240
v_mfma_f32_16x16x32_bf16 v[188:191], v[48:51], a[140:143], v[188:191]
v_fma_f32 v210, v210, v240, v240
v_mul_f32 v212, v90, v90
v_mfma_f32_16x16x32_bf16 v[188:191], v[52:55], a[156:159], v[188:191]
v_mul_f32 v214, v91, v91
s_waitcnt lgkmcnt(4)
v_mfma_f32_16x16x32_bf16 v[192:195], v[56:59], a[128:131], v[192:195]
s_waitcnt vmcnt(20)
v_fma_f32 v212, v212, v239, v238
v_mfma_f32_16x16x32_bf16 v[192:195], v[60:63], a[144:147], v[192:195]
s_barrier
v_mfma_f32_16x16x32_bf16 v[196:199], v[56:59], a[132:135], v[196:199]
ds_read_b128 v[48:51], v7 offset:32768
s_add_u32 m0, s22, 49152
v_mfma_f32_16x16x32_bf16 v[196:199], v[60:63], a[148:151], v[196:199]
v_add_u32 v3, 20480, v3
buffer_load_dwordx4 v3, s[8:11], 0 offen offset:0 lds
v_mfma_f32_16x16x32_bf16 v[200:203], v[56:59], a[136:139], v[200:203]
v_rcp_f32 v208, v208
v_mfma_f32_16x16x32_bf16 v[200:203], v[60:63], a[152:155], v[200:203]
ds_read_b128 v[52:55], v7 offset:33792
v_mul_f32 v209, v209, v208
v_mfma_f32_16x16x32_bf16 v[204:207], v[56:59], a[140:143], v[204:207]
v_rcp_f32 v210, v210
v_mfma_f32_16x16x32_bf16 v[204:207], v[60:63], a[156:159], v[204:207]
v_mul_f32 v211, v211, v210
s_waitcnt lgkmcnt(4)
v_mfma_f32_16x16x32_bf16 v[176:179], v[64:67], a[160:163], v[176:179]
buffer_load_dwordx4 v3, s[8:11], 0 offen offset:1024 lds
v_mfma_f32_16x16x32_bf16 v[176:179], v[68:71], a[176:179], v[176:179]
v_cvt_pk_bf16_f32 v228, v209, v211
v_fma_f32 v214, v214, v239, v238
v_mfma_f32_16x16x32_bf16 v[180:183], v[64:67], a[164:167], v[180:183]
ds_read_b128 v[56:59], v7 offset:34816
v_mul_f32 v212, v212, v90
v_mfma_f32_16x16x32_bf16 v[180:183], v[68:71], a[180:183], v[180:183]
v_mul_f32 v214, v214, v91
v_mul_f32 v213, v90, v106
v_mfma_f32_16x16x32_bf16 v[184:187], v[64:67], a[168:171], v[184:187]
buffer_load_dwordx4 v3, s[8:11], 0 offen offset:2048 lds
v_mfma_f32_16x16x32_bf16 v[184:187], v[68:71], a[184:187], v[184:187]
ds_read_b128 v[60:63], v7 offset:35840
v_mul_f32 v215, v91, v107
v_mfma_f32_16x16x32_bf16 v[188:191], v[64:67], a[172:175], v[188:191]
v_exp_f32 v212, v212
v_mfma_f32_16x16x32_bf16 v[188:191], v[68:71], a[188:191], v[188:191]
v_fma_f32 v212, v212, v240, v240
s_waitcnt lgkmcnt(4)
v_mfma_f32_16x16x32_bf16 v[192:195], v[72:75], a[160:163], v[192:195]
buffer_load_dwordx4 v3, s[8:11], 0 offen offset:3072 lds
v_mfma_f32_16x16x32_bf16 v[192:195], v[76:79], a[176:179], v[192:195]
s_add_u32 m0, s22, 53248
v_add_u32 v3, 4096, v3
v_mfma_f32_16x16x32_bf16 v[196:199], v[72:75], a[164:167], v[196:199]
ds_read_b128 v[64:67], v7 offset:36864
v_mul_f32 v208, v92, v92
v_mfma_f32_16x16x32_bf16 v[196:199], v[76:79], a[180:183], v[196:199]
v_exp_f32 v214, v214
v_mfma_f32_16x16x32_bf16 v[200:203], v[72:75], a[168:171], v[200:203]
buffer_load_dwordx4 v3, s[8:11], 0 offen offset:0 lds
v_mfma_f32_16x16x32_bf16 v[200:203], v[76:79], a[184:187], v[200:203]
ds_read_b128 v[68:71], v7 offset:37888
v_fma_f32 v214, v214, v240, v240
v_mfma_f32_16x16x32_bf16 v[204:207], v[72:75], a[172:175], v[204:207]
v_rcp_f32 v212, v212
v_mfma_f32_16x16x32_bf16 v[204:207], v[76:79], a[188:191], v[204:207]
v_mul_f32 v213, v213, v212
s_waitcnt lgkmcnt(4)
v_mfma_f32_16x16x32_bf16 v[176:179], v[48:51], a[192:195], v[176:179]
buffer_load_dwordx4 v3, s[8:11], 0 offen offset:1024 lds
v_mfma_f32_16x16x32_bf16 v[176:179], v[52:55], a[208:211], v[176:179]
v_rcp_f32 v214, v214
v_mfma_f32_16x16x32_bf16 v[180:183], v[48:51], a[196:199], v[180:183]
ds_read_b128 v[72:75], v7 offset:38912
v_mul_f32 v215, v215, v214
v_mfma_f32_16x16x32_bf16 v[180:183], v[52:55], a[212:215], v[180:183]
v_cvt_pk_bf16_f32 v229, v213, v215
v_mul_f32 v210, v93, v93
v_mfma_f32_16x16x32_bf16 v[184:187], v[48:51], a[200:203], v[184:187]
buffer_store_dwordx2 v[228:229], v246, s[8:11], s30 offen sc1
v_mfma_f32_16x16x32_bf16 v[184:187], v[52:55], a[216:219], v[184:187]
ds_read_b128 v[76:79], v7 offset:39936
v_fma_f32 v208, v208, v242, v241
v_mfma_f32_16x16x32_bf16 v[188:191], v[48:51], a[204:207], v[188:191]
v_fma_f32 v210, v210, v242, v241
v_mul_f32 v208, v208, v92
v_mfma_f32_16x16x32_bf16 v[188:191], v[52:55], a[220:223], v[188:191]
v_mul_f32 v210, v210, v93
s_waitcnt lgkmcnt(4)
v_mfma_f32_16x16x32_bf16 v[192:195], v[56:59], a[192:195], v[192:195]
v_exp_f32 v208, v208
v_mfma_f32_16x16x32_bf16 v[192:195], v[60:63], a[208:211], v[192:195]
v_exp_f32 v210, v210
v_mfma_f32_16x16x32_bf16 v[196:199], v[56:59], a[196:199], v[196:199]
ds_read_b128 v[48:51], v7 offset:40960
v_mul_f32 v209, v92, v108
v_mfma_f32_16x16x32_bf16 v[196:199], v[60:63], a[212:215], v[196:199]
v_mul_f32 v211, v93, v109
v_fma_f32 v208, v208, v243, v243
v_mfma_f32_16x16x32_bf16 v[200:203], v[56:59], a[200:203], v[200:203]
v_fma_f32 v210, v210, v243, v243
v_mul_f32 v212, v94, v94
v_mfma_f32_16x16x32_bf16 v[200:203], v[60:63], a[216:219], v[200:203]
ds_read_b128 v[52:55], v7 offset:41984
v_mul_f32 v214, v95, v95
v_mfma_f32_16x16x32_bf16 v[204:207], v[56:59], a[204:207], v[204:207]
v_rcp_f32 v208, v208
v_mfma_f32_16x16x32_bf16 v[204:207], v[60:63], a[220:223], v[204:207]
v_mul_f32 v209, v209, v208
s_waitcnt lgkmcnt(4)
v_mfma_f32_16x16x32_bf16 v[176:179], v[64:67], a[224:227], v[176:179]
v_rcp_f32 v210, v210
v_mfma_f32_16x16x32_bf16 v[176:179], v[68:71], a[240:243], v[176:179]
v_mul_f32 v211, v211, v210
v_cvt_pk_bf16_f32 v230, v209, v211
v_mfma_f32_16x16x32_bf16 v[180:183], v[64:67], a[228:231], v[180:183]
ds_read_b128 v[56:59], v7 offset:43008
v_fma_f32 v212, v212, v242, v241
v_mfma_f32_16x16x32_bf16 v[180:183], v[68:71], a[244:247], v[180:183]
v_fma_f32 v214, v214, v242, v241
v_mul_f32 v212, v212, v94
v_mfma_f32_16x16x32_bf16 v[184:187], v[64:67], a[232:235], v[184:187]
v_mul_f32 v214, v214, v95
v_mul_f32 v213, v94, v110
v_mfma_f32_16x16x32_bf16 v[184:187], v[68:71], a[248:251], v[184:187]
ds_read_b128 v[60:63], v7 offset:44032
v_mul_f32 v215, v95, v111
v_mfma_f32_16x16x32_bf16 v[188:191], v[64:67], a[236:239], v[188:191]
v_exp_f32 v212, v212
v_mfma_f32_16x16x32_bf16 v[188:191], v[68:71], a[252:255], v[188:191]
v_fma_f32 v212, v212, v243, v243
s_waitcnt lgkmcnt(4)
v_mfma_f32_16x16x32_bf16 v[192:195], v[72:75], a[224:227], v[192:195]
v_exp_f32 v214, v214
v_mfma_f32_16x16x32_bf16 v[192:195], v[76:79], a[240:243], v[192:195]
v_fma_f32 v214, v214, v243, v243
v_mul_f32 v208, v112, v112
v_mfma_f32_16x16x32_bf16 v[196:199], v[72:75], a[228:231], v[196:199]
ds_read_b128 v[64:67], v7 offset:45056
v_mul_f32 v210, v113, v113
v_mfma_f32_16x16x32_bf16 v[196:199], v[76:79], a[244:247], v[196:199]
v_rcp_f32 v212, v212
v_mfma_f32_16x16x32_bf16 v[200:203], v[72:75], a[232:235], v[200:203]
v_rcp_f32 v214, v214
v_mfma_f32_16x16x32_bf16 v[200:203], v[76:79], a[248:251], v[200:203]
ds_read_b128 v[68:71], v7 offset:46080
v_mul_f32 v213, v213, v212
v_mfma_f32_16x16x32_bf16 v[204:207], v[72:75], a[236:239], v[204:207]
v_mul_f32 v215, v215, v214
v_cvt_pk_bf16_f32 v231, v213, v215
v_mfma_f32_16x16x32_bf16 v[204:207], v[76:79], a[252:255], v[204:207]
v_fma_f32 v208, v208, v233, v232
s_waitcnt lgkmcnt(4)
v_mfma_f32_16x16x32_bf16 v[176:179], v[48:51], v[16:19], v[176:179]
buffer_store_dwordx2 v[230:231], v247, s[8:11], s30 offen sc1
v_mfma_f32_16x16x32_bf16 v[176:179], v[52:55], v[32:35], v[176:179]
v_fma_f32 v210, v210, v233, v232
v_mul_f32 v208, v208, v112
v_mfma_f32_16x16x32_bf16 v[180:183], v[48:51], v[20:23], v[180:183]
ds_read_b128 v[72:75], v7 offset:47104
v_mul_f32 v210, v210, v113
v_mfma_f32_16x16x32_bf16 v[180:183], v[52:55], v[36:39], v[180:183]
v_exp_f32 v208, v208
v_mfma_f32_16x16x32_bf16 v[184:187], v[48:51], v[24:27], v[184:187]
v_exp_f32 v210, v210
v_mfma_f32_16x16x32_bf16 v[184:187], v[52:55], v[40:43], v[184:187]
ds_read_b128 v[76:79], v7 offset:48128
v_mul_f32 v209, v112, v128
v_mfma_f32_16x16x32_bf16 v[188:191], v[48:51], v[28:31], v[188:191]
v_mul_f32 v211, v113, v129
v_fma_f32 v208, v208, v234, v234
v_mfma_f32_16x16x32_bf16 v[188:191], v[52:55], v[44:47], v[188:191]
v_fma_f32 v210, v210, v234, v234
s_waitcnt lgkmcnt(4)
v_mfma_f32_16x16x32_bf16 v[192:195], v[56:59], v[16:19], v[192:195]
v_rcp_f32 v208, v208
v_mfma_f32_16x16x32_bf16 v[192:195], v[60:63], v[32:35], v[192:195]
v_rcp_f32 v210, v210
v_mfma_f32_16x16x32_bf16 v[196:199], v[56:59], v[20:23], v[196:199]
ds_read_b128 v[48:51], v7 offset:49152
v_mul_f32 v209, v209, v208
v_mfma_f32_16x16x32_bf16 v[196:199], v[60:63], v[36:39], v[196:199]
v_mul_f32 v211, v211, v210
v_cvt_pk_bf16_f32 v144, v209, v211
v_mfma_f32_16x16x32_bf16 v[200:203], v[56:59], v[24:27], v[200:203]
v_mul_f32 v212, v114, v114
v_mul_f32 v214, v115, v115
v_mfma_f32_16x16x32_bf16 v[200:203], v[60:63], v[40:43], v[200:203]
ds_read_b128 v[52:55], v7 offset:50176
v_fma_f32 v212, v212, v233, v232
v_mfma_f32_16x16x32_bf16 v[204:207], v[56:59], v[28:31], v[204:207]
v_fma_f32 v214, v214, v233, v232
v_mul_f32 v212, v212, v114
v_mfma_f32_16x16x32_bf16 v[204:207], v[60:63], v[44:47], v[204:207]
v_mul_f32 v214, v214, v115
s_waitcnt lgkmcnt(4)
v_mfma_f32_16x16x32_bf16 v[80:83], v[64:67], a[0:3], 0
v_exp_f32 v212, v212
v_mfma_f32_16x16x32_bf16 v[80:83], v[68:71], a[16:19], v[80:83]
v_exp_f32 v214, v214
v_mfma_f32_16x16x32_bf16 v[84:87], v[64:67], a[4:7], 0
ds_read_b128 v[56:59], v7 offset:51200
v_mul_f32 v213, v114, v130
v_mfma_f32_16x16x32_bf16 v[84:87], v[68:71], a[20:23], v[84:87]
v_mul_f32 v215, v115, v131
v_fma_f32 v212, v212, v234, v234
v_mfma_f32_16x16x32_bf16 v[88:91], v[64:67], a[8:11], 0
v_fma_f32 v214, v214, v234, v234
v_mul_f32 v208, v116, v116
v_mfma_f32_16x16x32_bf16 v[88:91], v[68:71], a[24:27], v[88:91]
ds_read_b128 v[60:63], v7 offset:52224
v_mul_f32 v210, v117, v117
v_mfma_f32_16x16x32_bf16 v[92:95], v[64:67], a[12:15], 0
v_rcp_f32 v212, v212
v_mfma_f32_16x16x32_bf16 v[92:95], v[68:71], a[28:31], v[92:95]
v_mul_f32 v213, v213, v212
s_waitcnt lgkmcnt(4)
v_mfma_f32_16x16x32_bf16 v[96:99], v[72:75], a[0:3], 0
v_rcp_f32 v214, v214
v_mfma_f32_16x16x32_bf16 v[96:99], v[76:79], a[16:19], v[96:99]
v_mul_f32 v215, v215, v214
v_cvt_pk_bf16_f32 v145, v213, v215
v_mfma_f32_16x16x32_bf16 v[100:103], v[72:75], a[4:7], 0
ds_read_b128 v[64:67], v7 offset:53248
v_fma_f32 v208, v208, v236, v235
v_mfma_f32_16x16x32_bf16 v[100:103], v[76:79], a[20:23], v[100:103]
v_fma_f32 v210, v210, v236, v235
v_mul_f32 v208, v208, v116
v_mfma_f32_16x16x32_bf16 v[104:107], v[72:75], a[8:11], 0
v_mul_f32 v210, v210, v117
v_mul_f32 v209, v116, v132
v_mfma_f32_16x16x32_bf16 v[104:107], v[76:79], a[24:27], v[104:107]
ds_read_b128 v[68:71], v7 offset:54272
v_mul_f32 v211, v117, v133
v_mfma_f32_16x16x32_bf16 v[108:111], v[72:75], a[12:15], 0
v_exp_f32 v208, v208
v_mfma_f32_16x16x32_bf16 v[108:111], v[76:79], a[28:31], v[108:111]
v_fma_f32 v208, v208, v237, v237
s_waitcnt lgkmcnt(4)
v_mfma_f32_16x16x32_bf16 v[80:83], v[48:51], a[32:35], v[80:83]
v_exp_f32 v210, v210
v_mfma_f32_16x16x32_bf16 v[80:83], v[52:55], a[48:51], v[80:83]
v_fma_f32 v210, v210, v237, v237
v_mul_f32 v212, v118, v118
v_mfma_f32_16x16x32_bf16 v[84:87], v[48:51], a[36:39], v[84:87]
ds_read_b128 v[72:75], v7 offset:55296
v_mul_f32 v214, v119, v119
v_mfma_f32_16x16x32_bf16 v[84:87], v[52:55], a[52:55], v[84:87]
v_rcp_f32 v208, v208
v_mfma_f32_16x16x32_bf16 v[88:91], v[48:51], a[40:43], v[88:91]
v_rcp_f32 v210, v210
v_mfma_f32_16x16x32_bf16 v[88:91], v[52:55], a[56:59], v[88:91]
ds_read_b128 v[76:79], v7 offset:56320
v_mul_f32 v209, v209, v208
v_mfma_f32_16x16x32_bf16 v[92:95], v[48:51], a[44:47], v[92:95]
v_mul_f32 v211, v211, v210
v_cvt_pk_bf16_f32 v148, v209, v211
v_mfma_f32_16x16x32_bf16 v[92:95], v[52:55], a[60:63], v[92:95]
v_fma_f32 v212, v212, v236, v235
s_waitcnt lgkmcnt(4)
v_mfma_f32_16x16x32_bf16 v[96:99], v[56:59], a[32:35], v[96:99]
s_waitcnt vmcnt(22)
v_fma_f32 v214, v214, v236, v235
v_mfma_f32_16x16x32_bf16 v[96:99], v[60:63], a[48:51], v[96:99]
s_barrier
v_mfma_f32_16x16x32_bf16 v[100:103], v[56:59], a[36:39], v[100:103]
ds_read_b128 v[48:51], v7 offset:57344
s_add_u32 m0, s22, 73728
v_mfma_f32_16x16x32_bf16 v[100:103], v[60:63], a[52:55], v[100:103]
v_add_u32 v3, 20480, v3
buffer_load_dwordx4 v3, s[8:11], 0 offen offset:0 lds
v_mfma_f32_16x16x32_bf16 v[104:107], v[56:59], a[40:43], v[104:107]
v_mul_f32 v212, v212, v118
v_mul_f32 v214, v214, v119
v_mfma_f32_16x16x32_bf16 v[104:107], v[60:63], a[56:59], v[104:107]
ds_read_b128 v[52:55], v7 offset:58368
v_mul_f32 v213, v118, v134
v_mfma_f32_16x16x32_bf16 v[108:111], v[56:59], a[44:47], v[108:111]
v_exp_f32 v212, v212
v_mfma_f32_16x16x32_bf16 v[108:111], v[60:63], a[60:63], v[108:111]
v_mul_f32 v215, v119, v135
s_waitcnt lgkmcnt(4)
v_mfma_f32_16x16x32_bf16 v[80:83], v[64:67], a[64:67], v[80:83]
buffer_load_dwordx4 v3, s[8:11], 0 offen offset:1024 lds
v_mfma_f32_16x16x32_bf16 v[80:83], v[68:71], a[80:83], v[80:83]
v_exp_f32 v214, v214
v_mfma_f32_16x16x32_bf16 v[84:87], v[64:67], a[68:71], v[84:87]
ds_read_b128 v[56:59], v7 offset:59392
v_fma_f32 v212, v212, v237, v237
v_mfma_f32_16x16x32_bf16 v[84:87], v[68:71], a[84:87], v[84:87]
v_fma_f32 v214, v214, v237, v237
v_mul_f32 v208, v120, v120
v_mfma_f32_16x16x32_bf16 v[88:91], v[64:67], a[72:75], v[88:91]
buffer_load_dwordx4 v3, s[8:11], 0 offen offset:2048 lds
v_mfma_f32_16x16x32_bf16 v[88:91], v[68:71], a[88:91], v[88:91]
ds_read_b128 v[60:63], v7 offset:60416
v_mul_f32 v210, v121, v121
v_mfma_f32_16x16x32_bf16 v[92:95], v[64:67], a[76:79], v[92:95]
v_rcp_f32 v212, v212
v_mfma_f32_16x16x32_bf16 v[92:95], v[68:71], a[92:95], v[92:95]
v_mul_f32 v213, v213, v212
s_waitcnt lgkmcnt(4)
v_mfma_f32_16x16x32_bf16 v[96:99], v[72:75], a[64:67], v[96:99]
buffer_load_dwordx4 v3, s[8:11], 0 offen offset:3072 lds
v_mfma_f32_16x16x32_bf16 v[96:99], v[76:79], a[80:83], v[96:99]
s_add_u32 m0, s22, 77824
v_add_u32 v3, 4096, v3
v_mfma_f32_16x16x32_bf16 v[100:103], v[72:75], a[68:71], v[100:103]
ds_read_b128 v[64:67], v7 offset:61440
v_fma_f32 v208, v208, v239, v238
v_mfma_f32_16x16x32_bf16 v[100:103], v[76:79], a[84:87], v[100:103]
v_rcp_f32 v214, v214
v_mfma_f32_16x16x32_bf16 v[104:107], v[72:75], a[72:75], v[104:107]
buffer_load_dwordx4 v3, s[8:11], 0 offen offset:0 lds
v_mfma_f32_16x16x32_bf16 v[104:107], v[76:79], a[88:91], v[104:107]
ds_read_b128 v[68:71], v7 offset:62464
v_mul_f32 v215, v215, v214
v_mfma_f32_16x16x32_bf16 v[108:111], v[72:75], a[76:79], v[108:111]
v_cvt_pk_bf16_f32 v149, v213, v215
v_fma_f32 v210, v210, v239, v238
v_mfma_f32_16x16x32_bf16 v[108:111], v[76:79], a[92:95], v[108:111]
v_mul_f32 v208, v208, v120
s_waitcnt lgkmcnt(4)
v_mfma_f32_16x16x32_bf16 v[80:83], v[48:51], a[96:99], v[80:83]
buffer_load_dwordx4 v3, s[8:11], 0 offen offset:1024 lds
v_mfma_f32_16x16x32_bf16 v[80:83], v[52:55], a[112:115], v[80:83]
v_mul_f32 v210, v210, v121
v_mul_f32 v209, v120, v136
v_mfma_f32_16x16x32_bf16 v[84:87], v[48:51], a[100:103], v[84:87]
ds_read_b128 v[72:75], v7 offset:63488
v_mul_f32 v211, v121, v137
v_mfma_f32_16x16x32_bf16 v[84:87], v[52:55], a[116:119], v[84:87]
v_exp_f32 v208, v208
v_mfma_f32_16x16x32_bf16 v[88:91], v[48:51], a[104:107], v[88:91]
v_exp_f32 v210, v210
v_mfma_f32_16x16x32_bf16 v[88:91], v[52:55], a[120:123], v[88:91]
ds_read_b128 v[76:79], v7 offset:64512
v_fma_f32 v208, v208, v240, v240
v_mfma_f32_16x16x32_bf16 v[92:95], v[48:51], a[108:111], v[92:95]
v_fma_f32 v210, v210, v240, v240
v_mul_f32 v212, v122, v122
v_mfma_f32_16x16x32_bf16 v[92:95], v[52:55], a[124:127], v[92:95]
v_mul_f32 v214, v123, v123
s_waitcnt lgkmcnt(4)
v_mfma_f32_16x16x32_bf16 v[96:99], v[56:59], a[96:99], v[96:99]
v_rcp_f32 v208, v208
v_mfma_f32_16x16x32_bf16 v[96:99], v[60:63], a[112:115], v[96:99]
v_rcp_f32 v210, v210
v_mfma_f32_16x16x32_bf16 v[100:103], v[56:59], a[100:103], v[100:103]
ds_read_b128 v[48:51], v8 offset:0
v_mul_f32 v209, v209, v208
v_mfma_f32_16x16x32_bf16 v[100:103], v[60:63], a[116:119], v[100:103]
v_mul_f32 v211, v211, v210
v_cvt_pk_bf16_f32 v152, v209, v211
v_mfma_f32_16x16x32_bf16 v[104:107], v[56:59], a[104:107], v[104:107]
v_fma_f32 v212, v212, v239, v238
v_fma_f32 v214, v214, v239, v238
v_mfma_f32_16x16x32_bf16 v[104:107], v[60:63], a[120:123], v[104:107]
ds_read_b128 v[52:55], v8 offset:1024
v_mul_f32 v212, v212, v122
v_mfma_f32_16x16x32_bf16 v[108:111], v[56:59], a[108:111], v[108:111]
v_mul_f32 v214, v214, v123
v_mul_f32 v213, v122, v138
v_mfma_f32_16x16x32_bf16 v[108:111], v[60:63], a[124:127], v[108:111]
v_mul_f32 v215, v123, v139
s_waitcnt lgkmcnt(4)
v_mfma_f32_16x16x32_bf16 v[80:83], v[64:67], a[128:131], v[80:83]
v_exp_f32 v212, v212
v_mfma_f32_16x16x32_bf16 v[80:83], v[68:71], a[144:147], v[80:83]
v_exp_f32 v214, v214
v_mfma_f32_16x16x32_bf16 v[84:87], v[64:67], a[132:135], v[84:87]
ds_read_b128 v[56:59], v8 offset:2048
v_fma_f32 v212, v212, v240, v240
v_mfma_f32_16x16x32_bf16 v[84:87], v[68:71], a[148:151], v[84:87]
v_fma_f32 v214, v214, v240, v240
v_mul_f32 v208, v124, v124
v_mfma_f32_16x16x32_bf16 v[88:91], v[64:67], a[136:139], v[88:91]
v_rcp_f32 v212, v212
v_mfma_f32_16x16x32_bf16 v[88:91], v[68:71], a[152:155], v[88:91]
ds_read_b128 v[60:63], v8 offset:3072
v_mul_f32 v213, v213, v212
v_mfma_f32_16x16x32_bf16 v[92:95], v[64:67], a[140:143], v[92:95]
v_rcp_f32 v214, v214
v_mfma_f32_16x16x32_bf16 v[92:95], v[68:71], a[156:159], v[92:95]
v_mul_f32 v215, v215, v214
s_waitcnt lgkmcnt(4)
v_mfma_f32_16x16x32_bf16 v[96:99], v[72:75], a[128:131], v[96:99]
v_cvt_pk_bf16_f32 v153, v213, v215
v_mul_f32 v210, v125, v125
v_mfma_f32_16x16x32_bf16 v[96:99], v[76:79], a[144:147], v[96:99]
v_fma_f32 v208, v208, v242, v241
v_fma_f32 v210, v210, v242, v241
v_mfma_f32_16x16x32_bf16 v[100:103], v[72:75], a[132:135], v[100:103]
ds_read_b128 v[64:67], v8 offset:4096
v_mul_f32 v208, v208, v124
v_mfma_f32_16x16x32_bf16 v[100:103], v[76:79], a[148:151], v[100:103]
v_mul_f32 v210, v210, v125
v_mul_f32 v209, v124, v140
v_mfma_f32_16x16x32_bf16 v[104:107], v[72:75], a[136:139], v[104:107]
v_exp_f32 v208, v208
v_mfma_f32_16x16x32_bf16 v[104:107], v[76:79], a[152:155], v[104:107]
ds_read_b128 v[68:71], v8 offset:5120
v_mul_f32 v211, v125, v141
v_mfma_f32_16x16x32_bf16 v[108:111], v[72:75], a[140:143], v[108:111]
v_exp_f32 v210, v210
v_mfma_f32_16x16x32_bf16 v[108:111], v[76:79], a[156:159], v[108:111]
v_fma_f32 v208, v208, v243, v243
s_waitcnt lgkmcnt(4)
v_mfma_f32_16x16x32_bf16 v[80:83], v[48:51], a[160:163], v[80:83]
v_fma_f32 v210, v210, v243, v243
v_mul_f32 v212, v126, v126
v_mfma_f32_16x16x32_bf16 v[80:83], v[52:55], a[176:179], v[80:83]
v_rcp_f32 v208, v208
v_mfma_f32_16x16x32_bf16 v[84:87], v[48:51], a[164:167], v[84:87]
ds_read_b128 v[72:75], v8 offset:6144
v_mul_f32 v209, v209, v208
v_mfma_f32_16x16x32_bf16 v[84:87], v[52:55], a[180:183], v[84:87]
v_rcp_f32 v210, v210
v_mfma_f32_16x16x32_bf16 v[88:91], v[48:51], a[168:171], v[88:91]
v_mul_f32 v211, v211, v210
v_cvt_pk_bf16_f32 v156, v209, v211
v_mfma_f32_16x16x32_bf16 v[88:91], v[52:55], a[184:187], v[88:91]
ds_read_b128 v[76:79], v8 offset:7168
v_mul_f32 v214, v127, v127
v_mfma_f32_16x16x32_bf16 v[92:95], v[48:51], a[172:175], v[92:95]
v_fma_f32 v212, v212, v242, v241
v_fma_f32 v214, v214, v242, v241
v_mfma_f32_16x16x32_bf16 v[92:95], v[52:55], a[188:191], v[92:95]
v_mul_f32 v212, v212, v126
s_waitcnt lgkmcnt(4)
v_mfma_f32_16x16x32_bf16 v[96:99], v[56:59], a[160:163], v[96:99]
v_mul_f32 v214, v214, v127
v_mul_f32 v213, v126, v142
v_mfma_f32_16x16x32_bf16 v[96:99], v[60:63], a[176:179], v[96:99]
v_exp_f32 v212, v212
v_mfma_f32_16x16x32_bf16 v[100:103], v[56:59], a[164:167], v[100:103]
ds_read_b128 v[48:51], v8 offset:8192
v_mul_f32 v215, v127, v143
v_mfma_f32_16x16x32_bf16 v[100:103], v[60:63], a[180:183], v[100:103]
v_exp_f32 v214, v214
v_mfma_f32_16x16x32_bf16 v[104:107], v[56:59], a[168:171], v[104:107]
v_fma_f32 v212, v212, v243, v243
v_fma_f32 v214, v214, v243, v243
v_mfma_f32_16x16x32_bf16 v[104:107], v[60:63], a[184:187], v[104:107]
ds_read_b128 v[52:55], v8 offset:9216
v_mul_f32 v216, v176, v176
v_mfma_f32_16x16x32_bf16 v[108:111], v[56:59], a[172:175], v[108:111]
v_rcp_f32 v212, v212
v_mfma_f32_16x16x32_bf16 v[108:111], v[60:63], a[188:191], v[108:111]
v_mul_f32 v213, v213, v212
s_waitcnt lgkmcnt(4)
v_mfma_f32_16x16x32_bf16 v[80:83], v[64:67], a[192:195], v[80:83]
v_rcp_f32 v214, v214
v_mfma_f32_16x16x32_bf16 v[80:83], v[68:71], a[208:211], v[80:83]
v_mul_f32 v215, v215, v214
v_cvt_pk_bf16_f32 v157, v213, v215
v_mfma_f32_16x16x32_bf16 v[84:87], v[64:67], a[196:199], v[84:87]
ds_read_b128 v[56:59], v8 offset:10240
v_mul_f32 v218, v177, v177
v_mfma_f32_16x16x32_bf16 v[84:87], v[68:71], a[212:215], v[84:87]
v_fma_f32 v216, v216, v233, v232
v_fma_f32 v218, v218, v233, v232
v_mfma_f32_16x16x32_bf16 v[88:91], v[64:67], a[200:203], v[88:91]
v_mul_f32 v216, v216, v176
v_mul_f32 v218, v218, v177
v_mfma_f32_16x16x32_bf16 v[88:91], v[68:71], a[216:219], v[88:91]
ds_read_b128 v[60:63], v8 offset:11264
v_mul_f32 v217, v176, v192
v_mfma_f32_16x16x32_bf16 v[92:95], v[64:67], a[204:207], v[92:95]
v_exp_f32 v216, v216
v_mfma_f32_16x16x32_bf16 v[92:95], v[68:71], a[220:223], v[92:95]
v_mul_f32 v219, v177, v193
s_waitcnt lgkmcnt(4)
v_mfma_f32_16x16x32_bf16 v[96:99], v[72:75], a[192:195], v[96:99]
v_exp_f32 v218, v218
v_mfma_f32_16x16x32_bf16 v[96:99], v[76:79], a[208:211], v[96:99]
v_fma_f32 v216, v216, v234, v234
v_fma_f32 v218, v218, v234, v234
v_mfma_f32_16x16x32_bf16 v[100:103], v[72:75], a[196:199], v[100:103]
ds_read_b128 v[64:67], v8 offset:12288
v_mul_f32 v220, v178, v178
v_mfma_f32_16x16x32_bf16 v[100:103], v[76:79], a[212:215], v[100:103]
v_rcp_f32 v216, v216
v_mfma_f32_16x16x32_bf16 v[104:107], v[72:75], a[200:203], v[104:107]
v_rcp_f32 v218, v218
v_mfma_f32_16x16x32_bf16 v[104:107], v[76:79], a[216:219], v[104:107]
ds_read_b128 v[68:71], v8 offset:13312
v_mul_f32 v217, v217, v216
v_mfma_f32_16x16x32_bf16 v[108:111], v[72:75], a[204:207], v[108:111]
v_mul_f32 v219, v219, v218
v_cvt_pk_bf16_f32 v146, v217, v219
v_mfma_f32_16x16x32_bf16 v[108:111], v[76:79], a[220:223], v[108:111]
v_mul_f32 v222, v179, v179
s_waitcnt lgkmcnt(4)
v_mfma_f32_16x16x32_bf16 v[80:83], v[48:51], a[224:227], v[80:83]
v_fma_f32 v220, v220, v233, v232
v_fma_f32 v222, v222, v233, v232
v_mfma_f32_16x16x32_bf16 v[80:83], v[52:55], a[240:243], v[80:83]
v_mul_f32 v220, v220, v178
v_mul_f32 v222, v222, v179
v_mfma_f32_16x16x32_bf16 v[84:87], v[48:51], a[228:231], v[84:87]
ds_read_b128 v[72:75], v8 offset:14336
v_mul_f32 v221, v178, v194
v_mfma_f32_16x16x32_bf16 v[84:87], v[52:55], a[244:247], v[84:87]
v_exp_f32 v220, v220
v_mfma_f32_16x16x32_bf16 v[88:91], v[48:51], a[232:235], v[88:91]
v_exp_f32 v222, v222
v_mfma_f32_16x16x32_bf16 v[88:91], v[52:55], a[248:251], v[88:91]
ds_read_b128 v[76:79], v8 offset:15360
v_mul_f32 v223, v179, v195
v_mfma_f32_16x16x32_bf16 v[92:95], v[48:51], a[236:239], v[92:95]
v_fma_f32 v220, v220, v234, v234
v_fma_f32 v222, v222, v234, v234
v_mfma_f32_16x16x32_bf16 v[92:95], v[52:55], a[252:255], v[92:95]
v_mul_f32 v216, v180, v180
s_waitcnt lgkmcnt(4)
v_mfma_f32_16x16x32_bf16 v[96:99], v[56:59], a[224:227], v[96:99]
s_waitcnt vmcnt(22)
v_mul_f32 v218, v181, v181
v_mfma_f32_16x16x32_bf16 v[96:99], v[60:63], a[240:243], v[96:99]
s_barrier
v_mfma_f32_16x16x32_bf16 v[100:103], v[56:59], a[228:231], v[100:103]
ds_read_b128 v[48:51], v2 offset:0
s_add_u32 m0, s22, 98304
v_mfma_f32_16x16x32_bf16 v[100:103], v[60:63], a[244:247], v[100:103]
v_add_u32 v3, 20480, v3
buffer_load_dwordx4 v3, s[8:11], 0 offen offset:0 lds
v_mfma_f32_16x16x32_bf16 v[104:107], v[56:59], a[232:235], v[104:107]
v_rcp_f32 v220, v220
v_mfma_f32_16x16x32_bf16 v[104:107], v[60:63], a[248:251], v[104:107]
ds_read_b128 v[52:55], v2 offset:1024
v_mul_f32 v221, v221, v220
v_mfma_f32_16x16x32_bf16 v[108:111], v[56:59], a[236:239], v[108:111]
v_rcp_f32 v222, v222
v_mfma_f32_16x16x32_bf16 v[108:111], v[60:63], a[252:255], v[108:111]
v_mul_f32 v223, v223, v222
s_waitcnt lgkmcnt(4)
v_mfma_f32_16x16x32_bf16 v[80:83], v[64:67], v[16:19], v[80:83]
buffer_load_dwordx4 v3, s[8:11], 0 offen offset:1024 lds
v_mfma_f32_16x16x32_bf16 v[80:83], v[68:71], v[32:35], v[80:83]
v_cvt_pk_bf16_f32 v147, v221, v223
v_fma_f32 v216, v216, v236, v235
v_mfma_f32_16x16x32_bf16 v[84:87], v[64:67], v[20:23], v[84:87]
ds_read_b128 v[56:59], v2 offset:2048
v_fma_f32 v218, v218, v236, v235
v_mfma_f32_16x16x32_bf16 v[84:87], v[68:71], v[36:39], v[84:87]
buffer_store_dwordx4 v[144:147], v2, s[8:11], s24 offen offset:0 sc1
v_mfma_f32_16x16x32_bf16 v[88:91], v[64:67], v[24:27], v[88:91]
v_mul_f32 v216, v216, v180
v_mul_f32 v218, v218, v181
v_mfma_f32_16x16x32_bf16 v[88:91], v[68:71], v[40:43], v[88:91]
ds_read_b128 v[60:63], v2 offset:3072
v_mul_f32 v217, v180, v196
v_mfma_f32_16x16x32_bf16 v[92:95], v[64:67], v[28:31], v[92:95]
v_exp_f32 v216, v216
v_mfma_f32_16x16x32_bf16 v[92:95], v[68:71], v[44:47], v[92:95]
v_mul_f32 v219, v181, v197
s_waitcnt lgkmcnt(4)
v_mfma_f32_16x16x32_bf16 v[96:99], v[72:75], v[16:19], v[96:99]
buffer_load_dwordx4 v3, s[8:11], 0 offen offset:2048 lds
v_mfma_f32_16x16x32_bf16 v[96:99], v[76:79], v[32:35], v[96:99]
v_exp_f32 v218, v218
v_mfma_f32_16x16x32_bf16 v[100:103], v[72:75], v[20:23], v[100:103]
ds_read_b128 v[64:67], v2 offset:4096
v_fma_f32 v216, v216, v237, v237
v_mfma_f32_16x16x32_bf16 v[100:103], v[76:79], v[36:39], v[100:103]
v_fma_f32 v218, v218, v237, v237
v_mul_f32 v220, v182, v182
v_mfma_f32_16x16x32_bf16 v[104:107], v[72:75], v[24:27], v[104:107]
buffer_load_dwordx4 v3, s[8:11], 0 offen offset:3072 lds
v_mfma_f32_16x16x32_bf16 v[104:107], v[76:79], v[40:43], v[104:107]
ds_read_b128 v[68:71], v2 offset:5120
s_add_u32 m0, s22, 102400
v_mfma_f32_16x16x32_bf16 v[108:111], v[72:75], v[28:31], v[108:111]
v_add_u32 v3, 4096, v3
v_mul_f32 v222, v183, v183
v_mfma_f32_16x16x32_bf16 v[108:111], v[76:79], v[44:47], v[108:111]
v_fma_f32 v220, v220, v236, v235
s_waitcnt lgkmcnt(4)
v_mfma_f32_16x16x32_bf16 v[112:115], v[48:51], a[0:3], 0
buffer_load_dwordx4 v3, s[8:11], 0 offen offset:0 lds
v_mfma_f32_16x16x32_bf16 v[112:115], v[52:55], a[16:19], v[112:115]
v_rcp_f32 v216, v216
v_mfma_f32_16x16x32_bf16 v[116:119], v[48:51], a[4:7], 0
ds_read_b128 v[72:75], v2 offset:6144
v_mul_f32 v217, v217, v216
v_mfma_f32_16x16x32_bf16 v[116:119], v[52:55], a[20:23], v[116:119]
v_mul_f32 v208, v80, v80
v_mul_f32 v210, v81, v81
v_mfma_f32_16x16x32_bf16 v[120:123], v[48:51], a[8:11], 0
buffer_load_dwordx4 v3, s[8:11], 0 offen offset:1024 lds
v_mfma_f32_16x16x32_bf16 v[120:123], v[52:55], a[24:27], v[120:123]
ds_read_b128 v[76:79], v2 offset:7168
v_fma_f32 v208, v208, v233, v232
v_mfma_f32_16x16x32_bf16 v[124:127], v[48:51], a[12:15], 0
v_fma_f32 v210, v210, v233, v232
v_mul_f32 v208, v208, v80
v_mfma_f32_16x16x32_bf16 v[124:127], v[52:55], a[28:31], v[124:127]
v_mul_f32 v210, v210, v81
s_waitcnt lgkmcnt(4)
v_mfma_f32_16x16x32_bf16 v[128:131], v[56:59], a[0:3], 0
v_exp_f32 v208, v208
v_mfma_f32_16x16x32_bf16 v[128:131], v[60:63], a[16:19], v[128:131]
v_exp_f32 v210, v210
v_mfma_f32_16x16x32_bf16 v[132:135], v[56:59], a[4:7], 0
ds_read_b128 v[48:51], v2 offset:8192
v_mul_f32 v209, v80, v96
v_mfma_f32_16x16x32_bf16 v[132:135], v[60:63], a[20:23], v[132:135]
v_mul_f32 v211, v81, v97
v_fma_f32 v208, v208, v234, v234
v_mfma_f32_16x16x32_bf16 v[136:139], v[56:59], a[8:11], 0
v_fma_f32 v210, v210, v234, v234
v_mul_f32 v212, v82, v82
v_mfma_f32_16x16x32_bf16 v[136:139], v[60:63], a[24:27], v[136:139]
ds_read_b128 v[52:55], v2 offset:9216
v_mul_f32 v214, v83, v83
v_mfma_f32_16x16x32_bf16 v[140:143], v[56:59], a[12:15], 0
v_rcp_f32 v208, v208
v_mfma_f32_16x16x32_bf16 v[140:143], v[60:63], a[28:31], v[140:143]
v_mul_f32 v209, v209, v208
s_waitcnt lgkmcnt(4)
v_mfma_f32_16x16x32_bf16 v[112:115], v[64:67], a[32:35], v[112:115]
v_rcp_f32 v210, v210
v_mfma_f32_16x16x32_bf16 v[112:115], v[68:71], a[48:51], v[112:115]
v_mul_f32 v211, v211, v210
v_cvt_pk_bf16_f32 v160, v209, v211
v_mfma_f32_16x16x32_bf16 v[116:119], v[64:67], a[36:39], v[116:119]
ds_read_b128 v[56:59], v2 offset:10240
v_fma_f32 v212, v212, v233, v232
v_mfma_f32_16x16x32_bf16 v[116:119], v[68:71], a[52:55], v[116:119]
v_fma_f32 v214, v214, v233, v232
v_mul_f32 v212, v212, v82
v_mfma_f32_16x16x32_bf16 v[120:123], v[64:67], a[40:43], v[120:123]
v_mul_f32 v214, v214, v83
v_mul_f32 v213, v82, v98
v_mfma_f32_16x16x32_bf16 v[120:123], v[68:71], a[56:59], v[120:123]
ds_read_b128 v[60:63], v2 offset:11264
v_mul_f32 v215, v83, v99
v_mfma_f32_16x16x32_bf16 v[124:127], v[64:67], a[44:47], v[124:127]
v_exp_f32 v212, v212
v_mfma_f32_16x16x32_bf16 v[124:127], v[68:71], a[60:63], v[124:127]
v_fma_f32 v212, v212, v234, v234
s_waitcnt lgkmcnt(4)
v_mfma_f32_16x16x32_bf16 v[128:131], v[72:75], a[32:35], v[128:131]
v_exp_f32 v214, v214
v_mfma_f32_16x16x32_bf16 v[128:131], v[76:79], a[48:51], v[128:131]
v_fma_f32 v214, v214, v234, v234
v_mul_f32 v208, v84, v84
v_mfma_f32_16x16x32_bf16 v[132:135], v[72:75], a[36:39], v[132:135]
ds_read_b128 v[64:67], v2 offset:12288
v_mul_f32 v210, v85, v85
v_mfma_f32_16x16x32_bf16 v[132:135], v[76:79], a[52:55], v[132:135]
v_rcp_f32 v212, v212
v_mfma_f32_16x16x32_bf16 v[136:139], v[72:75], a[40:43], v[136:139]
v_rcp_f32 v214, v214
v_mfma_f32_16x16x32_bf16 v[136:139], v[76:79], a[56:59], v[136:139]
ds_read_b128 v[68:71], v2 offset:13312
v_mul_f32 v213, v213, v212
v_mfma_f32_16x16x32_bf16 v[140:143], v[72:75], a[44:47], v[140:143]
v_mul_f32 v215, v215, v214
v_cvt_pk_bf16_f32 v161, v213, v215
v_mfma_f32_16x16x32_bf16 v[140:143], v[76:79], a[60:63], v[140:143]
v_fma_f32 v208, v208, v236, v235
s_waitcnt lgkmcnt(4)
v_mfma_f32_16x16x32_bf16 v[112:115], v[48:51], a[64:67], v[112:115]
v_fma_f32 v210, v210, v236, v235
v_mul_f32 v208, v208, v84
v_mfma_f32_16x16x32_bf16 v[112:115], v[52:55], a[80:83], v[112:115]
v_mul_f32 v210, v210, v85
v_mul_f32 v209, v84, v100
v_mfma_f32_16x16x32_bf16 v[116:119], v[48:51], a[68:71], v[116:119]
ds_read_b128 v[72:75], v2 offset:14336
v_mul_f32 v211, v85, v101
v_mfma_f32_16x16x32_bf16 v[116:119], v[52:55], a[84:87], v[116:119]
v_exp_f32 v208, v208
v_mfma_f32_16x16x32_bf16 v[120:123], v[48:51], a[72:75], v[120:123]
v_exp_f32 v210, v210
v_mfma_f32_16x16x32_bf16 v[120:123], v[52:55], a[88:91], v[120:123]
ds_read_b128 v[76:79], v2 offset:15360
v_fma_f32 v208, v208, v237, v237
v_mfma_f32_16x16x32_bf16 v[124:127], v[48:51], a[76:79], v[124:127]
v_fma_f32 v210, v210, v237, v237
v_mul_f32 v212, v86, v86
v_mfma_f32_16x16x32_bf16 v[124:127], v[52:55], a[92:95], v[124:127]
v_mul_f32 v214, v87, v87
s_waitcnt lgkmcnt(4)
v_mfma_f32_16x16x32_bf16 v[128:131], v[56:59], a[64:67], v[128:131]
v_rcp_f32 v208, v208
v_mfma_f32_16x16x32_bf16 v[128:131], v[60:63], a[80:83], v[128:131]
v_rcp_f32 v210, v210
v_mfma_f32_16x16x32_bf16 v[132:135], v[56:59], a[68:71], v[132:135]
ds_read_b128 v[48:51], v2 offset:16384
v_mul_f32 v209, v209, v208
v_mfma_f32_16x16x32_bf16 v[132:135], v[60:63], a[84:87], v[132:135]
v_mul_f32 v211, v211, v210
v_cvt_pk_bf16_f32 v164, v209, v211
v_mfma_f32_16x16x32_bf16 v[136:139], v[56:59], a[72:75], v[136:139]
v_fma_f32 v212, v212, v236, v235
v_fma_f32 v214, v214, v236, v235
v_mfma_f32_16x16x32_bf16 v[136:139], v[60:63], a[88:91], v[136:139]
ds_read_b128 v[52:55], v2 offset:17408
v_mul_f32 v212, v212, v86
v_mfma_f32_16x16x32_bf16 v[140:143], v[56:59], a[76:79], v[140:143]
v_mul_f32 v214, v214, v87
v_mul_f32 v213, v86, v102
v_mfma_f32_16x16x32_bf16 v[140:143], v[60:63], a[92:95], v[140:143]
v_mul_f32 v215, v87, v103
s_waitcnt lgkmcnt(4)
v_mfma_f32_16x16x32_bf16 v[112:115], v[64:67], a[96:99], v[112:115]
v_exp_f32 v212, v212
v_mfma_f32_16x16x32_bf16 v[112:115], v[68:71], a[112:115], v[112:115]
v_exp_f32 v214, v214
v_mfma_f32_16x16x32_bf16 v[116:119], v[64:67], a[100:103], v[116:119]
ds_read_b128 v[56:59], v2 offset:18432
v_fma_f32 v212, v212, v237, v237
v_mfma_f32_16x16x32_bf16 v[116:119], v[68:71], a[116:119], v[116:119]
v_fma_f32 v214, v214, v237, v237
v_mul_f32 v208, v88, v88
v_mfma_f32_16x16x32_bf16 v[120:123], v[64:67], a[104:107], v[120:123]
v_rcp_f32 v212, v212
v_mfma_f32_16x16x32_bf16 v[120:123], v[68:71], a[120:123], v[120:123]
ds_read_b128 v[60:63], v2 offset:19456
v_mul_f32 v213, v213, v212
v_mfma_f32_16x16x32_bf16 v[124:127], v[64:67], a[108:111], v[124:127]
v_rcp_f32 v214, v214
v_mfma_f32_16x16x32_bf16 v[124:127], v[68:71], a[124:127], v[124:127]
v_mul_f32 v215, v215, v214
s_waitcnt lgkmcnt(4)
v_mfma_f32_16x16x32_bf16 v[128:131], v[72:75], a[96:99], v[128:131]
v_cvt_pk_bf16_f32 v165, v213, v215
v_mul_f32 v210, v89, v89
v_mfma_f32_16x16x32_bf16 v[128:131], v[76:79], a[112:115], v[128:131]
v_fma_f32 v208, v208, v239, v238
v_fma_f32 v210, v210, v239, v238
v_mfma_f32_16x16x32_bf16 v[132:135], v[72:75], a[100:103], v[132:135]
ds_read_b128 v[64:67], v2 offset:20480
v_mul_f32 v208, v208, v88
v_mfma_f32_16x16x32_bf16 v[132:135], v[76:79], a[116:119], v[132:135]
v_mul_f32 v210, v210, v89
v_mul_f32 v209, v88, v104
v_mfma_f32_16x16x32_bf16 v[136:139], v[72:75], a[104:107], v[136:139]
v_exp_f32 v208, v208
v_mfma_f32_16x16x32_bf16 v[136:139], v[76:79], a[120:123], v[136:139]
ds_read_b128 v[68:71], v2 offset:21504
v_mul_f32 v211, v89, v105
v_mfma_f32_16x16x32_bf16 v[140:143], v[72:75], a[108:111], v[140:143]
v_exp_f32 v210, v210
v_mfma_f32_16x16x32_bf16 v[140:143], v[76:79], a[124:127], v[140:143]
v_fma_f32 v208, v208, v240, v240
s_waitcnt lgkmcnt(4)
v_mfma_f32_16x16x32_bf16 v[112:115], v[48:51], a[128:131], v[112:115]
v_fma_f32 v210, v210, v240, v240
v_mul_f32 v212, v90, v90
v_mfma_f32_16x16x32_bf16 v[112:115], v[52:55], a[144:147], v[112:115]
v_rcp_f32 v208, v208
v_mfma_f32_16x16x32_bf16 v[116:119], v[48:51], a[132:135], v[116:119]
ds_read_b128 v[72:75], v2 offset:22528
v_mul_f32 v209, v209, v208
v_mfma_f32_16x16x32_bf16 v[116:119], v[52:55], a[148:151], v[116:119]
v_rcp_f32 v210, v210
v_mfma_f32_16x16x32_bf16 v[120:123], v[48:51], a[136:139], v[120:123]
v_mul_f32 v211, v211, v210
v_cvt_pk_bf16_f32 v168, v209, v211
v_mfma_f32_16x16x32_bf16 v[120:123], v[52:55], a[152:155], v[120:123]
ds_read_b128 v[76:79], v2 offset:23552
v_mul_f32 v214, v91, v91
v_mfma_f32_16x16x32_bf16 v[124:127], v[48:51], a[140:143], v[124:127]
v_fma_f32 v212, v212, v239, v238
v_fma_f32 v214, v214, v239, v238
v_mfma_f32_16x16x32_bf16 v[124:127], v[52:55], a[156:159], v[124:127]
v_mul_f32 v212, v212, v90
s_waitcnt lgkmcnt(4)
v_mfma_f32_16x16x32_bf16 v[128:131], v[56:59], a[128:131], v[128:131]
s_waitcnt vmcnt(23)
v_mul_f32 v214, v214, v91
v_mfma_f32_16x16x32_bf16 v[128:131], v[60:63], a[144:147], v[128:131]
s_barrier
v_mfma_f32_16x16x32_bf16 v[132:135], v[56:59], a[132:135], v[132:135]
ds_read_b128 v[48:51], v2 offset:24576
s_add_u32 m0, s22, 122880
v_mfma_f32_16x16x32_bf16 v[132:135], v[60:63], a[148:151], v[132:135]
v_add_u32 v3, 20480, v3
buffer_load_dwordx4 v3, s[8:11], 0 offen offset:0 lds
v_mfma_f32_16x16x32_bf16 v[136:139], v[56:59], a[136:139], v[136:139]
v_exp_f32 v212, v212
v_mfma_f32_16x16x32_bf16 v[136:139], v[60:63], a[152:155], v[136:139]
ds_read_b128 v[52:55], v2 offset:25600
v_mul_f32 v213, v90, v106
v_mfma_f32_16x16x32_bf16 v[140:143], v[56:59], a[140:143], v[140:143]
v_exp_f32 v214, v214
v_mfma_f32_16x16x32_bf16 v[140:143], v[60:63], a[156:159], v[140:143]
v_mul_f32 v215, v91, v107
s_waitcnt lgkmcnt(4)
v_mfma_f32_16x16x32_bf16 v[112:115], v[64:67], a[160:163], v[112:115]
buffer_load_dwordx4 v3, s[8:11], 0 offen offset:1024 lds
v_mfma_f32_16x16x32_bf16 v[112:115], v[68:71], a[176:179], v[112:115]
v_fma_f32 v212, v212, v240, v240
v_fma_f32 v214, v214, v240, v240
v_mfma_f32_16x16x32_bf16 v[116:119], v[64:67], a[164:167], v[116:119]
ds_read_b128 v[56:59], v2 offset:26624
v_mul_f32 v208, v92, v92
v_mfma_f32_16x16x32_bf16 v[116:119], v[68:71], a[180:183], v[116:119]
v_rcp_f32 v212, v212
v_mfma_f32_16x16x32_bf16 v[120:123], v[64:67], a[168:171], v[120:123]
buffer_load_dwordx4 v3, s[8:11], 0 offen offset:2048 lds
v_mfma_f32_16x16x32_bf16 v[120:123], v[68:71], a[184:187], v[120:123]
ds_read_b128 v[60:63], v2 offset:27648
v_mul_f32 v213, v213, v212
v_mfma_f32_16x16x32_bf16 v[124:127], v[64:67], a[172:175], v[124:127]
v_rcp_f32 v214, v214
v_mfma_f32_16x16x32_bf16 v[124:127], v[68:71], a[188:191], v[124:127]
v_mul_f32 v215, v215, v214
s_waitcnt lgkmcnt(4)
v_mfma_f32_16x16x32_bf16 v[128:131], v[72:75], a[160:163], v[128:131]
buffer_load_dwordx4 v3, s[8:11], 0 offen offset:3072 lds
v_mfma_f32_16x16x32_bf16 v[128:131], v[76:79], a[176:179], v[128:131]
s_add_u32 m0, s22, 126976
v_add_u32 v3, 4096, v3
v_mfma_f32_16x16x32_bf16 v[132:135], v[72:75], a[164:167], v[132:135]
ds_read_b128 v[64:67], v2 offset:28672
v_cvt_pk_bf16_f32 v169, v213, v215
v_mfma_f32_16x16x32_bf16 v[132:135], v[76:79], a[180:183], v[132:135]
v_mul_f32 v210, v93, v93
v_fma_f32 v208, v208, v242, v241
v_mfma_f32_16x16x32_bf16 v[136:139], v[72:75], a[168:171], v[136:139]
buffer_load_dwordx4 v3, s[8:11], 0 offen offset:0 lds
v_mfma_f32_16x16x32_bf16 v[136:139], v[76:79], a[184:187], v[136:139]
ds_read_b128 v[68:71], v2 offset:29696
v_fma_f32 v210, v210, v242, v241
v_mfma_f32_16x16x32_bf16 v[140:143], v[72:75], a[172:175], v[140:143]
v_mul_f32 v208, v208, v92
v_mul_f32 v210, v210, v93
v_mfma_f32_16x16x32_bf16 v[140:143], v[76:79], a[188:191], v[140:143]
v_mul_f32 v209, v92, v108
s_waitcnt lgkmcnt(4)
v_mfma_f32_16x16x32_bf16 v[112:115], v[48:51], a[192:195], v[112:115]
buffer_load_dwordx4 v3, s[8:11], 0 offen offset:1024 lds
v_mfma_f32_16x16x32_bf16 v[112:115], v[52:55], a[208:211], v[112:115]
v_exp_f32 v208, v208
v_mfma_f32_16x16x32_bf16 v[116:119], v[48:51], a[196:199], v[116:119]
ds_read_b128 v[72:75], v2 offset:30720
v_mul_f32 v211, v93, v109
v_mfma_f32_16x16x32_bf16 v[116:119], v[52:55], a[212:215], v[116:119]
v_exp_f32 v210, v210
v_mfma_f32_16x16x32_bf16 v[120:123], v[48:51], a[200:203], v[120:123]
v_fma_f32 v208, v208, v243, v243
v_fma_f32 v210, v210, v243, v243
v_mfma_f32_16x16x32_bf16 v[120:123], v[52:55], a[216:219], v[120:123]
ds_read_b128 v[76:79], v2 offset:31744
v_mul_f32 v212, v94, v94
v_mfma_f32_16x16x32_bf16 v[124:127], v[48:51], a[204:207], v[124:127]
v_rcp_f32 v208, v208
v_mfma_f32_16x16x32_bf16 v[124:127], v[52:55], a[220:223], v[124:127]
v_mul_f32 v209, v209, v208
s_waitcnt lgkmcnt(4)
v_mfma_f32_16x16x32_bf16 v[128:131], v[56:59], a[192:195], v[128:131]
v_rcp_f32 v210, v210
v_mfma_f32_16x16x32_bf16 v[128:131], v[60:63], a[208:211], v[128:131]
v_mul_f32 v211, v211, v210
v_cvt_pk_bf16_f32 v172, v209, v211
v_mfma_f32_16x16x32_bf16 v[132:135], v[56:59], a[196:199], v[132:135]
ds_read_b128 v[48:51], v2 offset:32768
v_mul_f32 v214, v95, v95
v_mfma_f32_16x16x32_bf16 v[132:135], v[60:63], a[212:215], v[132:135]
v_fma_f32 v212, v212, v242, v241
v_fma_f32 v214, v214, v242, v241
v_mfma_f32_16x16x32_bf16 v[136:139], v[56:59], a[200:203], v[136:139]
v_mul_f32 v212, v212, v94
v_mul_f32 v214, v214, v95
v_mfma_f32_16x16x32_bf16 v[136:139], v[60:63], a[216:219], v[136:139]
ds_read_b128 v[52:55], v2 offset:33792
v_mul_f32 v213, v94, v110
v_mfma_f32_16x16x32_bf16 v[140:143], v[56:59], a[204:207], v[140:143]
v_exp_f32 v212, v212
v_mfma_f32_16x16x32_bf16 v[140:143], v[60:63], a[220:223], v[140:143]
v_mul_f32 v215, v95, v111
s_waitcnt lgkmcnt(4)
v_mfma_f32_16x16x32_bf16 v[112:115], v[64:67], a[224:227], v[112:115]
v_exp_f32 v214, v214
v_mfma_f32_16x16x32_bf16 v[112:115], v[68:71], a[240:243], v[112:115]
v_fma_f32 v212, v212, v243, v243
v_fma_f32 v214, v214, v243, v243
v_mfma_f32_16x16x32_bf16 v[116:119], v[64:67], a[228:231], v[116:119]
ds_read_b128 v[56:59], v2 offset:34816
v_fma_f32 v222, v222, v236, v235
v_mfma_f32_16x16x32_bf16 v[116:119], v[68:71], a[244:247], v[116:119]
v_rcp_f32 v212, v212
v_mfma_f32_16x16x32_bf16 v[120:123], v[64:67], a[232:235], v[120:123]
v_rcp_f32 v214, v214
v_mfma_f32_16x16x32_bf16 v[120:123], v[68:71], a[248:251], v[120:123]
ds_read_b128 v[60:63], v2 offset:35840
v_mul_f32 v213, v213, v212
v_mfma_f32_16x16x32_bf16 v[124:127], v[64:67], a[236:239], v[124:127]
v_mul_f32 v215, v215, v214
v_cvt_pk_bf16_f32 v173, v213, v215
v_mfma_f32_16x16x32_bf16 v[124:127], v[68:71], a[252:255], v[124:127]
v_mul_f32 v220, v220, v182
s_waitcnt lgkmcnt(4)
v_mfma_f32_16x16x32_bf16 v[128:131], v[72:75], a[224:227], v[128:131]
v_rcp_f32 v218, v218
v_mfma_f32_16x16x32_bf16 v[128:131], v[76:79], a[240:243], v[128:131]
v_mul_f32 v219, v219, v218
v_cvt_pk_bf16_f32 v150, v217, v219
v_mfma_f32_16x16x32_bf16 v[132:135], v[72:75], a[228:231], v[132:135]
ds_read_b128 v[64:67], v2 offset:36864
v_mul_f32 v222, v222, v183
v_mfma_f32_16x16x32_bf16 v[132:135], v[76:79], a[244:247], v[132:135]
v_exp_f32 v220, v220
v_mfma_f32_16x16x32_bf16 v[136:139], v[72:75], a[232:235], v[136:139]
v_exp_f32 v222, v222
v_mfma_f32_16x16x32_bf16 v[136:139], v[76:79], a[248:251], v[136:139]
ds_read_b128 v[68:71], v2 offset:37888
v_mul_f32 v221, v182, v198
v_mfma_f32_16x16x32_bf16 v[140:143], v[72:75], a[236:239], v[140:143]
v_mul_f32 v223, v183, v199
v_fma_f32 v220, v220, v237, v237
v_mfma_f32_16x16x32_bf16 v[140:143], v[76:79], a[252:255], v[140:143]
v_fma_f32 v222, v222, v237, v237
s_waitcnt lgkmcnt(4)
v_mfma_f32_16x16x32_bf16 v[112:115], v[48:51], v[16:19], v[112:115]
v_rcp_f32 v220, v220
v_mfma_f32_16x16x32_bf16 v[112:115], v[52:55], v[32:35], v[112:115]
v_rcp_f32 v222, v222
v_mfma_f32_16x16x32_bf16 v[116:119], v[48:51], v[20:23], v[116:119]
ds_read_b128 v[72:75], v2 offset:38912
v_mul_f32 v221, v221, v220
v_mfma_f32_16x16x32_bf16 v[116:119], v[52:55], v[36:39], v[116:119]
v_mul_f32 v223, v223, v222
v_cvt_pk_bf16_f32 v151, v221, v223
v_mfma_f32_16x16x32_bf16 v[120:123], v[48:51], v[24:27], v[120:123]
buffer_store_dwordx4 v[148:151], v4, s[8:11], s24 offen offset:0 sc1
v_mfma_f32_16x16x32_bf16 v[120:123], v[52:55], v[40:43], v[120:123]
ds_read_b128 v[76:79], v2 offset:39936
v_mul_f32 v216, v184, v184
v_mfma_f32_16x16x32_bf16 v[124:127], v[48:51], v[28:31], v[124:127]
v_mul_f32 v218, v185, v185
v_fma_f32 v216, v216, v239, v238
v_mfma_f32_16x16x32_bf16 v[124:127], v[52:55], v[44:47], v[124:127]
v_fma_f32 v218, v218, v239, v238
s_waitcnt lgkmcnt(4)
v_mfma_f32_16x16x32_bf16 v[128:131], v[56:59], v[16:19], v[128:131]
v_mul_f32 v216, v216, v184
v_mul_f32 v218, v218, v185
v_mfma_f32_16x16x32_bf16 v[128:131], v[60:63], v[32:35], v[128:131]
v_exp_f32 v216, v216
v_mfma_f32_16x16x32_bf16 v[132:135], v[56:59], v[20:23], v[132:135]
ds_read_b128 v[48:51], v2 offset:40960
v_mul_f32 v217, v184, v200
v_mfma_f32_16x16x32_bf16 v[132:135], v[60:63], v[36:39], v[132:135]
v_exp_f32 v218, v218
v_mfma_f32_16x16x32_bf16 v[136:139], v[56:59], v[24:27], v[136:139]
v_mul_f32 v219, v185, v201
v_fma_f32 v216, v216, v240, v240
v_mfma_f32_16x16x32_bf16 v[136:139], v[60:63], v[40:43], v[136:139]
ds_read_b128 v[52:55], v2 offset:41984
v_fma_f32 v218, v218, v240, v240
v_mfma_f32_16x16x32_bf16 v[140:143], v[56:59], v[28:31], v[140:143]
v_rcp_f32 v216, v216
v_mfma_f32_16x16x32_bf16 v[140:143], v[60:63], v[44:47], v[140:143]
v_mul_f32 v217, v217, v216
s_waitcnt lgkmcnt(4)
v_mfma_f32_16x16x32_bf16 v[80:83], v[64:67], a[0:3], 0
v_rcp_f32 v218, v218
v_mfma_f32_16x16x32_bf16 v[80:83], v[68:71], a[16:19], v[80:83]
v_mul_f32 v219, v219, v218
v_cvt_pk_bf16_f32 v154, v217, v219
v_mfma_f32_16x16x32_bf16 v[84:87], v[64:67], a[4:7], 0
ds_read_b128 v[56:59], v2 offset:43008
v_mul_f32 v220, v186, v186
v_mfma_f32_16x16x32_bf16 v[84:87], v[68:71], a[20:23], v[84:87]
v_mul_f32 v208, v112, v112
v_mul_f32 v210, v113, v113
v_mfma_f32_16x16x32_bf16 v[88:91], v[64:67], a[8:11], 0
v_fma_f32 v208, v208, v233, v232
v_fma_f32 v210, v210, v233, v232
v_mfma_f32_16x16x32_bf16 v[88:91], v[68:71], a[24:27], v[88:91]
ds_read_b128 v[60:63], v2 offset:44032
v_mul_f32 v208, v208, v112
v_mfma_f32_16x16x32_bf16 v[92:95], v[64:67], a[12:15], 0
v_mul_f32 v210, v210, v113
v_mul_f32 v209, v112, v128
v_mfma_f32_16x16x32_bf16 v[92:95], v[68:71], a[28:31], v[92:95]
v_mul_f32 v211, v113, v129
s_waitcnt lgkmcnt(4)
v_mfma_f32_16x16x32_bf16 v[96:99], v[72:75], a[0:3], 0
v_exp_f32 v208, v208
v_mfma_f32_16x16x32_bf16 v[96:99], v[76:79], a[16:19], v[96:99]
v_exp_f32 v210, v210
v_mfma_f32_16x16x32_bf16 v[100:103], v[72:75], a[4:7], 0
ds_read_b128 v[64:67], v2 offset:45056
v_fma_f32 v208, v208, v234, v234
v_mfma_f32_16x16x32_bf16 v[100:103], v[76:79], a[20:23], v[100:103]
v_fma_f32 v210, v210, v234, v234
v_mul_f32 v212, v114, v114
v_mfma_f32_16x16x32_bf16 v[104:107], v[72:75], a[8:11], 0
v_rcp_f32 v208, v208
v_mfma_f32_16x16x32_bf16 v[104:107], v[76:79], a[24:27], v[104:107]
ds_read_b128 v[68:71], v2 offset:46080
v_mul_f32 v209, v209, v208
v_mfma_f32_16x16x32_bf16 v[108:111], v[72:75], a[12:15], 0
v_rcp_f32 v210, v210
v_mfma_f32_16x16x32_bf16 v[108:111], v[76:79], a[28:31], v[108:111]
v_mul_f32 v211, v211, v210
s_waitcnt lgkmcnt(4)
v_mfma_f32_16x16x32_bf16 v[80:83], v[48:51], a[32:35], v[80:83]
v_cvt_pk_bf16_f32 v162, v209, v211
v_mul_f32 v214, v115, v115
v_mfma_f32_16x16x32_bf16 v[80:83], v[52:55], a[48:51], v[80:83]
v_fma_f32 v212, v212, v233, v232
v_fma_f32 v214, v214, v233, v232
v_mfma_f32_16x16x32_bf16 v[84:87], v[48:51], a[36:39], v[84:87]
ds_read_b128 v[72:75], v2 offset:47104
v_mul_f32 v212, v212, v114
v_mfma_f32_16x16x32_bf16 v[84:87], v[52:55], a[52:55], v[84:87]
v_mul_f32 v214, v214, v115
v_mul_f32 v213, v114, v130
v_mfma_f32_16x16x32_bf16 v[88:91], v[48:51], a[40:43], v[88:91]
v_exp_f32 v212, v212
v_mfma_f32_16x16x32_bf16 v[88:91], v[52:55], a[56:59], v[88:91]
ds_read_b128 v[76:79], v2 offset:48128
v_mul_f32 v215, v115, v131
v_mfma_f32_16x16x32_bf16 v[92:95], v[48:51], a[44:47], v[92:95]
v_exp_f32 v214, v214
v_mfma_f32_16x16x32_bf16 v[92:95], v[52:55], a[60:63], v[92:95]
v_fma_f32 v212, v212, v234, v234
s_waitcnt lgkmcnt(4)
v_mfma_f32_16x16x32_bf16 v[96:99], v[56:59], a[32:35], v[96:99]
s_waitcnt vmcnt(22)
v_fma_f32 v214, v214, v234, v234
v_mfma_f32_16x16x32_bf16 v[96:99], v[60:63], a[48:51], v[96:99]
s_barrier
v_mfma_f32_16x16x32_bf16 v[100:103], v[56:59], a[36:39], v[100:103]
ds_read_b128 v[48:51], v2 offset:49152
s_add_u32 m0, s22, 0
v_mfma_f32_16x16x32_bf16 v[100:103], v[60:63], a[52:55], v[100:103]
v_add_u32 v3, 20480, v3
buffer_load_dwordx4 v3, s[8:11], 0 offen offset:0 lds
v_mfma_f32_16x16x32_bf16 v[104:107], v[56:59], a[40:43], v[104:107]
v_rcp_f32 v212, v212
v_mfma_f32_16x16x32_bf16 v[104:107], v[60:63], a[56:59], v[104:107]
ds_read_b128 v[52:55], v2 offset:50176
v_mul_f32 v213, v213, v212
v_mfma_f32_16x16x32_bf16 v[108:111], v[56:59], a[44:47], v[108:111]
v_rcp_f32 v214, v214
v_mfma_f32_16x16x32_bf16 v[108:111], v[60:63], a[60:63], v[108:111]
v_mul_f32 v215, v215, v214
s_waitcnt lgkmcnt(4)
v_mfma_f32_16x16x32_bf16 v[80:83], v[64:67], a[64:67], v[80:83]
buffer_load_dwordx4 v3, s[8:11], 0 offen offset:1024 lds
v_mfma_f32_16x16x32_bf16 v[80:83], v[68:71], a[80:83], v[80:83]
v_cvt_pk_bf16_f32 v163, v213, v215
v_mul_f32 v208, v116, v116
v_mfma_f32_16x16x32_bf16 v[84:87], v[64:67], a[68:71], v[84:87]
ds_read_b128 v[56:59], v2 offset:51200
v_mul_f32 v210, v117, v117
v_mfma_f32_16x16x32_bf16 v[84:87], v[68:71], a[84:87], v[84:87]
buffer_store_dwordx4 v[160:163], v2, s[8:11], s24 offen offset:1024 sc1
v_mfma_f32_16x16x32_bf16 v[88:91], v[64:67], a[72:75], v[88:91]
v_fma_f32 v208, v208, v236, v235
v_fma_f32 v210, v210, v236, v235
v_mfma_f32_16x16x32_bf16 v[88:91], v[68:71], a[88:91], v[88:91]
ds_read_b128 v[60:63], v2 offset:52224
v_mul_f32 v208, v208, v116
v_mfma_f32_16x16x32_bf16 v[92:95], v[64:67], a[76:79], v[92:95]
v_mul_f32 v210, v210, v117
v_mul_f32 v209, v116, v132
v_mfma_f32_16x16x32_bf16 v[92:95], v[68:71], a[92:95], v[92:95]
v_mul_f32 v211, v117, v133
s_waitcnt lgkmcnt(4)
v_mfma_f32_16x16x32_bf16 v[96:99], v[72:75], a[64:67], v[96:99]
buffer_load_dwordx4 v3, s[8:11], 0 offen offset:2048 lds
v_mfma_f32_16x16x32_bf16 v[96:99], v[76:79], a[80:83], v[96:99]
v_exp_f32 v208, v208
v_mfma_f32_16x16x32_bf16 v[100:103], v[72:75], a[68:71], v[100:103]
ds_read_b128 v[64:67], v2 offset:53248
v_fma_f32 v208, v208, v237, v237
v_mfma_f32_16x16x32_bf16 v[100:103], v[76:79], a[84:87], v[100:103]
v_exp_f32 v210, v210
v_mfma_f32_16x16x32_bf16 v[104:107], v[72:75], a[72:75], v[104:107]
buffer_load_dwordx4 v3, s[8:11], 0 offen offset:3072 lds
v_mfma_f32_16x16x32_bf16 v[104:107], v[76:79], a[88:91], v[104:107]
ds_read_b128 v[68:71], v2 offset:54272
s_add_u32 m0, s22, 4096
v_mfma_f32_16x16x32_bf16 v[108:111], v[72:75], a[76:79], v[108:111]
v_add_u32 v3, 4096, v3
v_fma_f32 v210, v210, v237, v237
v_mfma_f32_16x16x32_bf16 v[108:111], v[76:79], a[92:95], v[108:111]
v_mul_f32 v212, v118, v118
s_waitcnt lgkmcnt(4)
v_mfma_f32_16x16x32_bf16 v[80:83], v[48:51], a[96:99], v[80:83]
buffer_load_dwordx4 v3, s[8:11], 0 offen offset:0 lds
v_mfma_f32_16x16x32_bf16 v[80:83], v[52:55], a[112:115], v[80:83]
v_rcp_f32 v208, v208
v_mfma_f32_16x16x32_bf16 v[84:87], v[48:51], a[100:103], v[84:87]
ds_read_b128 v[72:75], v2 offset:55296
v_mul_f32 v209, v209, v208
v_mfma_f32_16x16x32_bf16 v[84:87], v[52:55], a[116:119], v[84:87]
v_rcp_f32 v210, v210
v_mfma_f32_16x16x32_bf16 v[88:91], v[48:51], a[104:107], v[88:91]
buffer_load_dwordx4 v3, s[8:11], 0 offen offset:1024 lds
v_mfma_f32_16x16x32_bf16 v[88:91], v[52:55], a[120:123], v[88:91]
ds_read_b128 v[76:79], v2 offset:56320
v_mul_f32 v211, v211, v210
v_mfma_f32_16x16x32_bf16 v[92:95], v[48:51], a[108:111], v[92:95]
v_cvt_pk_bf16_f32 v166, v209, v211
v_mul_f32 v214, v119, v119
v_mfma_f32_16x16x32_bf16 v[92:95], v[52:55], a[124:127], v[92:95]
v_fma_f32 v212, v212, v236, v235
s_waitcnt lgkmcnt(4)
v_mfma_f32_16x16x32_bf16 v[96:99], v[56:59], a[96:99], v[96:99]
v_fma_f32 v214, v214, v236, v235
v_mul_f32 v212, v212, v118
v_mfma_f32_16x16x32_bf16 v[96:99], v[60:63], a[112:115], v[96:99]
v_mul_f32 v214, v214, v119
v_mul_f32 v213, v118, v134
v_mfma_f32_16x16x32_bf16 v[100:103], v[56:59], a[100:103], v[100:103]
ds_read_b128 v[48:51], v2 offset:57344
v_mul_f32 v215, v119, v135
v_mfma_f32_16x16x32_bf16 v[100:103], v[60:63], a[116:119], v[100:103]
v_exp_f32 v212, v212
v_mfma_f32_16x16x32_bf16 v[104:107], v[56:59], a[104:107], v[104:107]
v_exp_f32 v214, v214
v_mfma_f32_16x16x32_bf16 v[104:107], v[60:63], a[120:123], v[104:107]
ds_read_b128 v[52:55], v2 offset:58368
v_fma_f32 v212, v212, v237, v237
v_mfma_f32_16x16x32_bf16 v[108:111], v[56:59], a[108:111], v[108:111]
v_fma_f32 v214, v214, v237, v237
v_mul_f32 v208, v120, v120
v_mfma_f32_16x16x32_bf16 v[108:111], v[60:63], a[124:127], v[108:111]
v_mul_f32 v210, v121, v121
s_waitcnt lgkmcnt(4)
v_mfma_f32_16x16x32_bf16 v[80:83], v[64:67], a[128:131], v[80:83]
v_rcp_f32 v212, v212
v_mfma_f32_16x16x32_bf16 v[80:83], v[68:71], a[144:147], v[80:83]
v_rcp_f32 v214, v214
v_mfma_f32_16x16x32_bf16 v[84:87], v[64:67], a[132:135], v[84:87]
ds_read_b128 v[56:59], v2 offset:59392
v_mul_f32 v213, v213, v212
v_mfma_f32_16x16x32_bf16 v[84:87], v[68:71], a[148:151], v[84:87]
v_mul_f32 v215, v215, v214
v_cvt_pk_bf16_f32 v167, v213, v215
v_mfma_f32_16x16x32_bf16 v[88:91], v[64:67], a[136:139], v[88:91]
buffer_store_dwordx4 v[164:167], v4, s[8:11], s24 offen offset:1024 sc1
v_mfma_f32_16x16x32_bf16 v[88:91], v[68:71], a[152:155], v[88:91]
ds_read_b128 v[60:63], v2 offset:60416
v_fma_f32 v208, v208, v239, v238
v_mfma_f32_16x16x32_bf16 v[92:95], v[64:67], a[140:143], v[92:95]
v_fma_f32 v210, v210, v239, v238
v_mul_f32 v208, v208, v120
v_mfma_f32_16x16x32_bf16 v[92:95], v[68:71], a[156:159], v[92:95]
v_mul_f32 v210, v210, v121
s_waitcnt lgkmcnt(4)
v_mfma_f32_16x16x32_bf16 v[96:99], v[72:75], a[128:131], v[96:99]
v_exp_f32 v208, v208
v_mfma_f32_16x16x32_bf16 v[96:99], v[76:79], a[144:147], v[96:99]
v_exp_f32 v210, v210
v_mfma_f32_16x16x32_bf16 v[100:103], v[72:75], a[132:135], v[100:103]
ds_read_b128 v[64:67], v2 offset:61440
v_mul_f32 v209, v120, v136
v_mfma_f32_16x16x32_bf16 v[100:103], v[76:79], a[148:151], v[100:103]
v_mul_f32 v211, v121, v137
v_fma_f32 v208, v208, v240, v240
v_mfma_f32_16x16x32_bf16 v[104:107], v[72:75], a[136:139], v[104:107]
v_fma_f32 v210, v210, v240, v240
v_mul_f32 v212, v122, v122
v_mfma_f32_16x16x32_bf16 v[104:107], v[76:79], a[152:155], v[104:107]
ds_read_b128 v[68:71], v2 offset:62464
v_mul_f32 v214, v123, v123
v_mfma_f32_16x16x32_bf16 v[108:111], v[72:75], a[140:143], v[108:111]
v_rcp_f32 v208, v208
v_mfma_f32_16x16x32_bf16 v[108:111], v[76:79], a[156:159], v[108:111]
v_mul_f32 v209, v209, v208
s_waitcnt lgkmcnt(4)
v_mfma_f32_16x16x32_bf16 v[80:83], v[48:51], a[160:163], v[80:83]
v_rcp_f32 v210, v210
v_mfma_f32_16x16x32_bf16 v[80:83], v[52:55], a[176:179], v[80:83]
v_mul_f32 v211, v211, v210
v_cvt_pk_bf16_f32 v170, v209, v211
v_mfma_f32_16x16x32_bf16 v[84:87], v[48:51], a[164:167], v[84:87]
ds_read_b128 v[72:75], v2 offset:63488
v_fma_f32 v212, v212, v239, v238
v_mfma_f32_16x16x32_bf16 v[84:87], v[52:55], a[180:183], v[84:87]
v_fma_f32 v214, v214, v239, v238
v_mul_f32 v212, v212, v122
v_mfma_f32_16x16x32_bf16 v[88:91], v[48:51], a[168:171], v[88:91]
v_mul_f32 v214, v214, v123
v_mul_f32 v213, v122, v138
v_mfma_f32_16x16x32_bf16 v[88:91], v[52:55], a[184:187], v[88:91]
ds_read_b128 v[76:79], v2 offset:64512
v_mul_f32 v215, v123, v139
v_mfma_f32_16x16x32_bf16 v[92:95], v[48:51], a[172:175], v[92:95]
v_exp_f32 v212, v212
v_mfma_f32_16x16x32_bf16 v[92:95], v[52:55], a[188:191], v[92:95]
v_fma_f32 v212, v212, v240, v240
s_waitcnt lgkmcnt(4)
v_mfma_f32_16x16x32_bf16 v[96:99], v[56:59], a[160:163], v[96:99]
v_exp_f32 v214, v214
v_mfma_f32_16x16x32_bf16 v[96:99], v[60:63], a[176:179], v[96:99]
v_fma_f32 v214, v214, v240, v240
v_mul_f32 v208, v124, v124
v_mfma_f32_16x16x32_bf16 v[100:103], v[56:59], a[164:167], v[100:103]
ds_read_b128 v[48:51], v7 offset:0
v_mul_f32 v210, v125, v125
v_mfma_f32_16x16x32_bf16 v[100:103], v[60:63], a[180:183], v[100:103]
v_rcp_f32 v212, v212
v_mfma_f32_16x16x32_bf16 v[104:107], v[56:59], a[168:171], v[104:107]
v_rcp_f32 v214, v214
v_mfma_f32_16x16x32_bf16 v[104:107], v[60:63], a[184:187], v[104:107]
ds_read_b128 v[52:55], v7 offset:1024
v_mul_f32 v213, v213, v212
v_mfma_f32_16x16x32_bf16 v[108:111], v[56:59], a[172:175], v[108:111]
v_mul_f32 v215, v215, v214
v_cvt_pk_bf16_f32 v171, v213, v215
v_mfma_f32_16x16x32_bf16 v[108:111], v[60:63], a[188:191], v[108:111]
v_fma_f32 v208, v208, v242, v241
s_waitcnt lgkmcnt(4)
v_mfma_f32_16x16x32_bf16 v[80:83], v[64:67], a[192:195], v[80:83]
buffer_store_dwordx4 v[168:171], v5, s[8:11], s24 offen offset:1024 sc1
v_mfma_f32_16x16x32_bf16 v[80:83], v[68:71], a[208:211], v[80:83]
v_fma_f32 v210, v210, v242, v241
v_mul_f32 v208, v208, v124
v_mfma_f32_16x16x32_bf16 v[84:87], v[64:67], a[196:199], v[84:87]
ds_read_b128 v[56:59], v7 offset:2048
v_mul_f32 v210, v210, v125
v_mfma_f32_16x16x32_bf16 v[84:87], v[68:71], a[212:215], v[84:87]
v_exp_f32 v208, v208
v_mfma_f32_16x16x32_bf16 v[88:91], v[64:67], a[200:203], v[88:91]
v_exp_f32 v210, v210
v_mfma_f32_16x16x32_bf16 v[88:91], v[68:71], a[216:219], v[88:91]
ds_read_b128 v[60:63], v7 offset:3072
v_mul_f32 v209, v124, v140
v_mfma_f32_16x16x32_bf16 v[92:95], v[64:67], a[204:207], v[92:95]
v_mul_f32 v211, v125, v141
v_fma_f32 v208, v208, v243, v243
v_mfma_f32_16x16x32_bf16 v[92:95], v[68:71], a[220:223], v[92:95]
v_fma_f32 v210, v210, v243, v243
s_waitcnt lgkmcnt(4)
v_mfma_f32_16x16x32_bf16 v[96:99], v[72:75], a[192:195], v[96:99]
v_rcp_f32 v208, v208
v_mfma_f32_16x16x32_bf16 v[96:99], v[76:79], a[208:211], v[96:99]
v_rcp_f32 v210, v210
v_mfma_f32_16x16x32_bf16 v[100:103], v[72:75], a[196:199], v[100:103]
ds_read_b128 v[64:67], v7 offset:4096
v_mul_f32 v209, v209, v208
v_mfma_f32_16x16x32_bf16 v[100:103], v[76:79], a[212:215], v[100:103]
v_mul_f32 v211, v211, v210
v_cvt_pk_bf16_f32 v174, v209, v211
v_mfma_f32_16x16x32_bf16 v[104:107], v[72:75], a[200:203], v[104:107]
v_mul_f32 v212, v126, v126
v_mul_f32 v214, v127, v127
v_mfma_f32_16x16x32_bf16 v[104:107], v[76:79], a[216:219], v[104:107]
ds_read_b128 v[68:71], v7 offset:5120
v_fma_f32 v212, v212, v242, v241
v_mfma_f32_16x16x32_bf16 v[108:111], v[72:75], a[204:207], v[108:111]
v_fma_f32 v214, v214, v242, v241
v_mul_f32 v212, v212, v126
v_mfma_f32_16x16x32_bf16 v[108:111], v[76:79], a[220:223], v[108:111]
v_mul_f32 v214, v214, v127
s_waitcnt lgkmcnt(4)
v_mfma_f32_16x16x32_bf16 v[80:83], v[48:51], a[224:227], v[80:83]
v_exp_f32 v212, v212
v_mfma_f32_16x16x32_bf16 v[80:83], v[52:55], a[240:243], v[80:83]
v_exp_f32 v214, v214
v_mfma_f32_16x16x32_bf16 v[84:87], v[48:51], a[228:231], v[84:87]
ds_read_b128 v[72:75], v7 offset:6144
v_mul_f32 v213, v126, v142
v_mfma_f32_16x16x32_bf16 v[84:87], v[52:55], a[244:247], v[84:87]
v_mul_f32 v215, v127, v143
v_fma_f32 v212, v212, v243, v243
v_mfma_f32_16x16x32_bf16 v[88:91], v[48:51], a[232:235], v[88:91]
v_fma_f32 v214, v214, v243, v243
v_mul_f32 v222, v187, v187
v_mfma_f32_16x16x32_bf16 v[88:91], v[52:55], a[248:251], v[88:91]
ds_read_b128 v[76:79], v7 offset:7168
v_fma_f32 v220, v220, v239, v238
v_mfma_f32_16x16x32_bf16 v[92:95], v[48:51], a[236:239], v[92:95]
v_rcp_f32 v212, v212
v_mfma_f32_16x16x32_bf16 v[92:95], v[52:55], a[252:255], v[92:95]
v_mul_f32 v213, v213, v212
s_waitcnt lgkmcnt(4)
v_mfma_f32_16x16x32_bf16 v[96:99], v[56:59], a[224:227], v[96:99]
s_waitcnt vmcnt(23)
v_fma_f32 v222, v222, v239, v238
v_mfma_f32_16x16x32_bf16 v[96:99], v[60:63], a[240:243], v[96:99]
s_barrier
v_mfma_f32_16x16x32_bf16 v[100:103], v[56:59], a[228:231], v[100:103]
ds_read_b128 v[48:51], v7 offset:8192
s_add_u32 m0, s22, 24576
v_mfma_f32_16x16x32_bf16 v[100:103], v[60:63], a[244:247], v[100:103]
v_add_u32 v3, 20480, v3
buffer_load_dwordx4 v3, s[8:11], 0 offen offset:0 lds
v_mfma_f32_16x16x32_bf16 v[104:107], v[56:59], a[232:235], v[104:107]
v_rcp_f32 v214, v214
v_mfma_f32_16x16x32_bf16 v[104:107], v[60:63], a[248:251], v[104:107]
ds_read_b128 v[52:55], v7 offset:9216
v_mul_f32 v215, v215, v214
v_mfma_f32_16x16x32_bf16 v[108:111], v[56:59], a[236:239], v[108:111]
v_cvt_pk_bf16_f32 v175, v213, v215
v_mul_f32 v220, v220, v186
v_mfma_f32_16x16x32_bf16 v[108:111], v[60:63], a[252:255], v[108:111]
v_mul_f32 v222, v222, v187
s_waitcnt lgkmcnt(4)
v_mfma_f32_16x16x32_bf16 v[80:83], v[64:67], v[16:19], v[80:83]
buffer_load_dwordx4 v3, s[8:11], 0 offen offset:1024 lds
v_mfma_f32_16x16x32_bf16 v[80:83], v[68:71], v[32:35], v[80:83]
v_exp_f32 v220, v220
v_mfma_f32_16x16x32_bf16 v[84:87], v[64:67], v[20:23], v[84:87]
ds_read_b128 v[56:59], v7 offset:10240
v_mul_f32 v221, v186, v202
v_mfma_f32_16x16x32_bf16 v[84:87], v[68:71], v[36:39], v[84:87]
buffer_store_dwordx4 v[172:175], v6, s[8:11], s24 offen offset:1024 sc1
v_mfma_f32_16x16x32_bf16 v[88:91], v[64:67], v[24:27], v[88:91]
v_exp_f32 v222, v222
v_mfma_f32_16x16x32_bf16 v[88:91], v[68:71], v[40:43], v[88:91]
ds_read_b128 v[60:63], v7 offset:11264
v_mul_f32 v223, v187, v203
v_mfma_f32_16x16x32_bf16 v[92:95], v[64:67], v[28:31], v[92:95]
v_fma_f32 v220, v220, v240, v240
v_fma_f32 v222, v222, v240, v240
v_mfma_f32_16x16x32_bf16 v[92:95], v[68:71], v[44:47], v[92:95]
v_mul_f32 v216, v188, v188
s_waitcnt lgkmcnt(4)
v_mfma_f32_16x16x32_bf16 v[96:99], v[72:75], v[16:19], v[96:99]
buffer_load_dwordx4 v3, s[8:11], 0 offen offset:2048 lds
v_mfma_f32_16x16x32_bf16 v[96:99], v[76:79], v[32:35], v[96:99]
v_rcp_f32 v220, v220
v_mfma_f32_16x16x32_bf16 v[100:103], v[72:75], v[20:23], v[100:103]
ds_read_b128 v[64:67], v7 offset:12288
v_mul_f32 v221, v221, v220
v_mfma_f32_16x16x32_bf16 v[100:103], v[76:79], v[36:39], v[100:103]
v_rcp_f32 v222, v222
v_mfma_f32_16x16x32_bf16 v[104:107], v[72:75], v[24:27], v[104:107]
buffer_load_dwordx4 v3, s[8:11], 0 offen offset:3072 lds
v_mfma_f32_16x16x32_bf16 v[104:107], v[76:79], v[40:43], v[104:107]
ds_read_b128 v[68:71], v7 offset:13312
s_add_u32 m0, s22, 28672
v_mfma_f32_16x16x32_bf16 v[108:111], v[72:75], v[28:31], v[108:111]
v_add_u32 v3, 4096, v3
v_mul_f32 v223, v223, v222
v_mfma_f32_16x16x32_bf16 v[108:111], v[76:79], v[44:47], v[108:111]
v_cvt_pk_bf16_f32 v155, v221, v223
s_waitcnt lgkmcnt(4)
v_mfma_f32_16x16x32_bf16 v[112:115], v[48:51], a[0:3], 0
buffer_load_dwordx4 v3, s[8:11], 0 offen offset:0 lds
v_mfma_f32_16x16x32_bf16 v[112:115], v[52:55], a[16:19], v[112:115]
v_mul_f32 v218, v189, v189
v_fma_f32 v216, v216, v242, v241
v_mfma_f32_16x16x32_bf16 v[116:119], v[48:51], a[4:7], 0
ds_read_b128 v[72:75], v7 offset:14336
v_fma_f32 v218, v218, v242, v241
v_mfma_f32_16x16x32_bf16 v[116:119], v[52:55], a[20:23], v[116:119]
buffer_store_dwordx4 v[152:155], v5, s[8:11], s24 offen offset:0 sc1
v_mfma_f32_16x16x32_bf16 v[120:123], v[48:51], a[8:11], 0
v_mul_f32 v216, v216, v188
v_mul_f32 v218, v218, v189
v_mfma_f32_16x16x32_bf16 v[120:123], v[52:55], a[24:27], v[120:123]
ds_read_b128 v[76:79], v7 offset:15360
v_mul_f32 v217, v188, v204
v_mfma_f32_16x16x32_bf16 v[124:127], v[48:51], a[12:15], 0
v_exp_f32 v216, v216
v_mfma_f32_16x16x32_bf16 v[124:127], v[52:55], a[28:31], v[124:127]
v_mul_f32 v219, v189, v205
s_waitcnt lgkmcnt(4)
v_mfma_f32_16x16x32_bf16 v[128:131], v[56:59], a[0:3], 0
buffer_load_dwordx4 v3, s[8:11], 0 offen offset:1024 lds
v_mfma_f32_16x16x32_bf16 v[128:131], v[60:63], a[16:19], v[128:131]
v_exp_f32 v218, v218
v_mfma_f32_16x16x32_bf16 v[132:135], v[56:59], a[4:7], 0
ds_read_b128 v[48:51], v7 offset:16384
v_fma_f32 v216, v216, v243, v243
v_mfma_f32_16x16x32_bf16 v[132:135], v[60:63], a[20:23], v[132:135]
v_fma_f32 v218, v218, v243, v243
v_mul_f32 v220, v190, v190
v_mfma_f32_16x16x32_bf16 v[136:139], v[56:59], a[8:11], 0
v_rcp_f32 v216, v216
v_mfma_f32_16x16x32_bf16 v[136:139], v[60:63], a[24:27], v[136:139]
ds_read_b128 v[52:55], v7 offset:17408
v_mul_f32 v217, v217, v216
v_mfma_f32_16x16x32_bf16 v[140:143], v[56:59], a[12:15], 0
v_rcp_f32 v218, v218
v_mfma_f32_16x16x32_bf16 v[140:143], v[60:63], a[28:31], v[140:143]
v_mul_f32 v219, v219, v218
s_waitcnt lgkmcnt(4)
v_mfma_f32_16x16x32_bf16 v[112:115], v[64:67], a[32:35], v[112:115]
v_cvt_pk_bf16_f32 v158, v217, v219
v_mul_f32 v222, v191, v191
v_mfma_f32_16x16x32_bf16 v[112:115], v[68:71], a[48:51], v[112:115]
v_fma_f32 v220, v220, v242, v241
v_fma_f32 v222, v222, v242, v241
v_mfma_f32_16x16x32_bf16 v[116:119], v[64:67], a[36:39], v[116:119]
ds_read_b128 v[56:59], v7 offset:18432
v_mul_f32 v220, v220, v190
v_mfma_f32_16x16x32_bf16 v[116:119], v[68:71], a[52:55], v[116:119]
v_mul_f32 v222, v222, v191
v_mul_f32 v221, v190, v206
v_mfma_f32_16x16x32_bf16 v[120:123], v[64:67], a[40:43], v[120:123]
v_exp_f32 v220, v220
v_mfma_f32_16x16x32_bf16 v[120:123], v[68:71], a[56:59], v[120:123]
ds_read_b128 v[60:63], v7 offset:19456
v_mul_f32 v223, v191, v207
v_mfma_f32_16x16x32_bf16 v[124:127], v[64:67], a[44:47], v[124:127]
v_exp_f32 v222, v222
v_mfma_f32_16x16x32_bf16 v[124:127], v[68:71], a[60:63], v[124:127]
v_fma_f32 v220, v220, v243, v243
s_waitcnt lgkmcnt(4)
v_mfma_f32_16x16x32_bf16 v[128:131], v[72:75], a[32:35], v[128:131]
v_fma_f32 v222, v222, v243, v243
v_mfma_f32_16x16x32_bf16 v[128:131], v[76:79], a[48:51], v[128:131]
v_rcp_f32 v220, v220
v_mfma_f32_16x16x32_bf16 v[132:135], v[72:75], a[36:39], v[132:135]
ds_read_b128 v[64:67], v7 offset:20480
v_mul_f32 v221, v221, v220
v_mfma_f32_16x16x32_bf16 v[132:135], v[76:79], a[52:55], v[132:135]
v_rcp_f32 v222, v222
v_mfma_f32_16x16x32_bf16 v[136:139], v[72:75], a[40:43], v[136:139]
v_mul_f32 v223, v223, v222
v_cvt_pk_bf16_f32 v159, v221, v223
v_mfma_f32_16x16x32_bf16 v[136:139], v[76:79], a[56:59], v[136:139]
ds_read_b128 v[68:71], v7 offset:21504
v_mfma_f32_16x16x32_bf16 v[140:143], v[72:75], a[44:47], v[140:143]
buffer_store_dwordx4 v[156:159], v6, s[8:11], s24 offen offset:0 sc1
v_mfma_f32_16x16x32_bf16 v[140:143], v[76:79], a[60:63], v[140:143]
v_mul_f32 v208, v80, v80
s_waitcnt lgkmcnt(4)
v_mfma_f32_16x16x32_bf16 v[112:115], v[48:51], a[64:67], v[112:115]
v_mul_f32 v210, v81, v81
v_fma_f32 v208, v208, v233, v232
v_mfma_f32_16x16x32_bf16 v[112:115], v[52:55], a[80:83], v[112:115]
v_fma_f32 v210, v210, v233, v232
v_mul_f32 v208, v208, v80
v_mfma_f32_16x16x32_bf16 v[116:119], v[48:51], a[68:71], v[116:119]
ds_read_b128 v[72:75], v7 offset:22528
v_mul_f32 v210, v210, v81
v_mfma_f32_16x16x32_bf16 v[116:119], v[52:55], a[84:87], v[116:119]
v_exp_f32 v208, v208
v_mfma_f32_16x16x32_bf16 v[120:123], v[48:51], a[72:75], v[120:123]
v_exp_f32 v210, v210
v_mfma_f32_16x16x32_bf16 v[120:123], v[52:55], a[88:91], v[120:123]
ds_read_b128 v[76:79], v7 offset:23552
v_mul_f32 v209, v80, v96
v_mfma_f32_16x16x32_bf16 v[124:127], v[48:51], a[76:79], v[124:127]
v_mul_f32 v211, v81, v97
v_fma_f32 v208, v208, v234, v234
v_mfma_f32_16x16x32_bf16 v[124:127], v[52:55], a[92:95], v[124:127]
v_fma_f32 v210, v210, v234, v234
s_waitcnt lgkmcnt(4)
v_mfma_f32_16x16x32_bf16 v[128:131], v[56:59], a[64:67], v[128:131]
v_rcp_f32 v208, v208
v_mfma_f32_16x16x32_bf16 v[128:131], v[60:63], a[80:83], v[128:131]
v_rcp_f32 v210, v210
v_mfma_f32_16x16x32_bf16 v[132:135], v[56:59], a[68:71], v[132:135]
ds_read_b128 v[48:51], v7 offset:24576
v_mul_f32 v209, v209, v208
v_mfma_f32_16x16x32_bf16 v[132:135], v[60:63], a[84:87], v[132:135]
v_mul_f32 v211, v211, v210
v_cvt_pk_bf16_f32 v176, v209, v211
v_mfma_f32_16x16x32_bf16 v[136:139], v[56:59], a[72:75], v[136:139]
v_mul_f32 v212, v82, v82
v_mul_f32 v214, v83, v83
v_mfma_f32_16x16x32_bf16 v[136:139], v[60:63], a[88:91], v[136:139]
ds_read_b128 v[52:55], v7 offset:25600
v_fma_f32 v212, v212, v233, v232
v_mfma_f32_16x16x32_bf16 v[140:143], v[56:59], a[76:79], v[140:143]
v_fma_f32 v214, v214, v233, v232
v_mul_f32 v212, v212, v82
v_mfma_f32_16x16x32_bf16 v[140:143], v[60:63], a[92:95], v[140:143]
v_mul_f32 v214, v214, v83
s_waitcnt lgkmcnt(4)
v_mfma_f32_16x16x32_bf16 v[112:115], v[64:67], a[96:99], v[112:115]
v_exp_f32 v212, v212
v_mfma_f32_16x16x32_bf16 v[112:115], v[68:71], a[112:115], v[112:115]
v_exp_f32 v214, v214
v_mfma_f32_16x16x32_bf16 v[116:119], v[64:67], a[100:103], v[116:119]
ds_read_b128 v[56:59], v7 offset:26624
v_mul_f32 v213, v82, v98
v_mfma_f32_16x16x32_bf16 v[116:119], v[68:71], a[116:119], v[116:119]
v_mul_f32 v215, v83, v99
v_fma_f32 v212, v212, v234, v234
v_mfma_f32_16x16x32_bf16 v[120:123], v[64:67], a[104:107], v[120:123]
v_fma_f32 v214, v214, v234, v234
v_mul_f32 v208, v84, v84
v_mfma_f32_16x16x32_bf16 v[120:123], v[68:71], a[120:123], v[120:123]
ds_read_b128 v[60:63], v7 offset:27648
v_mul_f32 v210, v85, v85
v_mfma_f32_16x16x32_bf16 v[124:127], v[64:67], a[108:111], v[124:127]
v_rcp_f32 v212, v212
v_mfma_f32_16x16x32_bf16 v[124:127], v[68:71], a[124:127], v[124:127]
v_mul_f32 v213, v213, v212
s_waitcnt lgkmcnt(4)
v_mfma_f32_16x16x32_bf16 v[128:131], v[72:75], a[96:99], v[128:131]
v_rcp_f32 v214, v214
v_mfma_f32_16x16x32_bf16 v[128:131], v[76:79], a[112:115], v[128:131]
v_mul_f32 v215, v215, v214
v_cvt_pk_bf16_f32 v177, v213, v215
v_mfma_f32_16x16x32_bf16 v[132:135], v[72:75], a[100:103], v[132:135]
ds_read_b128 v[64:67], v7 offset:28672
v_fma_f32 v208, v208, v236, v235
v_mfma_f32_16x16x32_bf16 v[132:135], v[76:79], a[116:119], v[132:135]
v_fma_f32 v210, v210, v236, v235
v_mul_f32 v208, v208, v84
v_mfma_f32_16x16x32_bf16 v[136:139], v[72:75], a[104:107], v[136:139]
v_mul_f32 v210, v210, v85
v_mul_f32 v209, v84, v100
v_mfma_f32_16x16x32_bf16 v[136:139], v[76:79], a[120:123], v[136:139]
ds_read_b128 v[68:71], v7 offset:29696
v_mul_f32 v211, v85, v101
v_mfma_f32_16x16x32_bf16 v[140:143], v[72:75], a[108:111], v[140:143]
v_exp_f32 v208, v208
v_mfma_f32_16x16x32_bf16 v[140:143], v[76:79], a[124:127], v[140:143]
v_fma_f32 v208, v208, v237, v237
s_waitcnt lgkmcnt(4)
v_mfma_f32_16x16x32_bf16 v[112:115], v[48:51], a[128:131], v[112:115]
v_exp_f32 v210, v210
v_mfma_f32_16x16x32_bf16 v[112:115], v[52:55], a[144:147], v[112:115]
v_fma_f32 v210, v210, v237, v237
v_mul_f32 v212, v86, v86
v_mfma_f32_16x16x32_bf16 v[116:119], v[48:51], a[132:135], v[116:119]
ds_read_b128 v[72:75], v7 offset:30720
v_mul_f32 v214, v87, v87
v_mfma_f32_16x16x32_bf16 v[116:119], v[52:55], a[148:151], v[116:119]
v_rcp_f32 v208, v208
v_mfma_f32_16x16x32_bf16 v[120:123], v[48:51], a[136:139], v[120:123]
v_rcp_f32 v210, v210
v_mfma_f32_16x16x32_bf16 v[120:123], v[52:55], a[152:155], v[120:123]
ds_read_b128 v[76:79], v7 offset:31744
v_mul_f32 v209, v209, v208
v_mfma_f32_16x16x32_bf16 v[124:127], v[48:51], a[140:143], v[124:127]
v_mul_f32 v211, v211, v210
v_cvt_pk_bf16_f32 v180, v209, v211
v_mfma_f32_16x16x32_bf16 v[124:127], v[52:55], a[156:159], v[124:127]
v_fma_f32 v212, v212, v236, v235
s_waitcnt lgkmcnt(4)
v_mfma_f32_16x16x32_bf16 v[128:131], v[56:59], a[128:131], v[128:131]
s_waitcnt vmcnt(25)
v_fma_f32 v214, v214, v236, v235
v_mfma_f32_16x16x32_bf16 v[128:131], v[60:63], a[144:147], v[128:131]
s_barrier
v_mfma_f32_16x16x32_bf16 v[132:135], v[56:59], a[132:135], v[132:135]
ds_read_b128 v[48:51], v7 offset:32768
s_add_u32 m0, s22, 49152
v_mfma_f32_16x16x32_bf16 v[132:135], v[60:63], a[148:151], v[132:135]
v_add_u32 v3, 20480, v3
buffer_load_dwordx4 v3, s[8:11], 0 offen offset:0 lds
v_mfma_f32_16x16x32_bf16 v[136:139], v[56:59], a[136:139], v[136:139]
v_mul_f32 v212, v212, v86
v_mul_f32 v214, v214, v87
v_mfma_f32_16x16x32_bf16 v[136:139], v[60:63], a[152:155], v[136:139]
ds_read_b128 v[52:55], v7 offset:33792
v_mul_f32 v213, v86, v102
v_mfma_f32_16x16x32_bf16 v[140:143], v[56:59], a[140:143], v[140:143]
v_exp_f32 v212, v212
v_mfma_f32_16x16x32_bf16 v[140:143], v[60:63], a[156:159], v[140:143]
v_mul_f32 v215, v87, v103
s_waitcnt lgkmcnt(4)
v_mfma_f32_16x16x32_bf16 v[112:115], v[64:67], a[160:163], v[112:115]
buffer_load_dwordx4 v3, s[8:11], 0 offen offset:1024 lds
v_mfma_f32_16x16x32_bf16 v[112:115], v[68:71], a[176:179], v[112:115]
v_exp_f32 v214, v214
v_mfma_f32_16x16x32_bf16 v[116:119], v[64:67], a[164:167], v[116:119]
ds_read_b128 v[56:59], v7 offset:34816
v_fma_f32 v212, v212, v237, v237
v_mfma_f32_16x16x32_bf16 v[116:119], v[68:71], a[180:183], v[116:119]
v_fma_f32 v214, v214, v237, v237
v_mul_f32 v208, v88, v88
v_mfma_f32_16x16x32_bf16 v[120:123], v[64:67], a[168:171], v[120:123]
buffer_load_dwordx4 v3, s[8:11], 0 offen offset:2048 lds
v_mfma_f32_16x16x32_bf16 v[120:123], v[68:71], a[184:187], v[120:123]
ds_read_b128 v[60:63], v7 offset:35840
v_mul_f32 v210, v89, v89
v_mfma_f32_16x16x32_bf16 v[124:127], v[64:67], a[172:175], v[124:127]
v_rcp_f32 v212, v212
v_mfma_f32_16x16x32_bf16 v[124:127], v[68:71], a[188:191], v[124:127]
v_mul_f32 v213, v213, v212
s_waitcnt lgkmcnt(4)
v_mfma_f32_16x16x32_bf16 v[128:131], v[72:75], a[160:163], v[128:131]
buffer_load_dwordx4 v3, s[8:11], 0 offen offset:3072 lds
v_mfma_f32_16x16x32_bf16 v[128:131], v[76:79], a[176:179], v[128:131]
s_add_u32 m0, s22, 53248
v_add_u32 v3, 4096, v3
v_mfma_f32_16x16x32_bf16 v[132:135], v[72:75], a[164:167], v[132:135]
ds_read_b128 v[64:67], v7 offset:36864
v_fma_f32 v208, v208, v239, v238
v_mfma_f32_16x16x32_bf16 v[132:135], v[76:79], a[180:183], v[132:135]
v_rcp_f32 v214, v214
v_mfma_f32_16x16x32_bf16 v[136:139], v[72:75], a[168:171], v[136:139]
buffer_load_dwordx4 v3, s[8:11], 0 offen offset:0 lds
v_mfma_f32_16x16x32_bf16 v[136:139], v[76:79], a[184:187], v[136:139]
ds_read_b128 v[68:71], v7 offset:37888
v_mul_f32 v215, v215, v214
v_mfma_f32_16x16x32_bf16 v[140:143], v[72:75], a[172:175], v[140:143]
v_cvt_pk_bf16_f32 v181, v213, v215
v_fma_f32 v210, v210, v239, v238
v_mfma_f32_16x16x32_bf16 v[140:143], v[76:79], a[188:191], v[140:143]
v_mul_f32 v208, v208, v88
s_waitcnt lgkmcnt(4)
v_mfma_f32_16x16x32_bf16 v[112:115], v[48:51], a[192:195], v[112:115]
buffer_load_dwordx4 v3, s[8:11], 0 offen offset:1024 lds
v_mfma_f32_16x16x32_bf16 v[112:115], v[52:55], a[208:211], v[112:115]
v_mul_f32 v210, v210, v89
v_mul_f32 v209, v88, v104
v_mfma_f32_16x16x32_bf16 v[116:119], v[48:51], a[196:199], v[116:119]
ds_read_b128 v[72:75], v7 offset:38912
v_mul_f32 v211, v89, v105
v_mfma_f32_16x16x32_bf16 v[116:119], v[52:55], a[212:215], v[116:119]
v_exp_f32 v208, v208
v_mfma_f32_16x16x32_bf16 v[120:123], v[48:51], a[200:203], v[120:123]
v_exp_f32 v210, v210
v_mfma_f32_16x16x32_bf16 v[120:123], v[52:55], a[216:219], v[120:123]
ds_read_b128 v[76:79], v7 offset:39936
v_fma_f32 v208, v208, v240, v240
v_mfma_f32_16x16x32_bf16 v[124:127], v[48:51], a[204:207], v[124:127]
v_fma_f32 v210, v210, v240, v240
v_mul_f32 v212, v90, v90
v_mfma_f32_16x16x32_bf16 v[124:127], v[52:55], a[220:223], v[124:127]
v_mul_f32 v214, v91, v91
s_waitcnt lgkmcnt(4)
v_mfma_f32_16x16x32_bf16 v[128:131], v[56:59], a[192:195], v[128:131]
v_mov_b32 v12, 1
s_waitcnt vmcnt(6)
buffer_store_dword v12, v10, s[8:11], s34 offen sc1
v_mfma_f32_16x16x32_bf16 v[128:131], v[60:63], a[208:211], v[128:131]
v_rcp_f32 v208, v208
v_mfma_f32_16x16x32_bf16 v[132:135], v[56:59], a[196:199], v[132:135]
ds_read_b128 v[48:51], v7 offset:40960
v_mul_f32 v209, v209, v208
v_mfma_f32_16x16x32_bf16 v[132:135], v[60:63], a[212:215], v[132:135]
v_rcp_f32 v210, v210
v_mfma_f32_16x16x32_bf16 v[136:139], v[56:59], a[200:203], v[136:139]
v_mul_f32 v211, v211, v210
v_cvt_pk_bf16_f32 v184, v209, v211
v_mfma_f32_16x16x32_bf16 v[136:139], v[60:63], a[216:219], v[136:139]
ds_read_b128 v[52:55], v7 offset:41984
v_fma_f32 v212, v212, v239, v238
v_mfma_f32_16x16x32_bf16 v[140:143], v[56:59], a[204:207], v[140:143]
v_fma_f32 v214, v214, v239, v238
v_mul_f32 v212, v212, v90
v_mfma_f32_16x16x32_bf16 v[140:143], v[60:63], a[220:223], v[140:143]
v_mul_f32 v214, v214, v91
s_waitcnt lgkmcnt(4)
v_mfma_f32_16x16x32_bf16 v[112:115], v[64:67], a[224:227], v[112:115]
v_exp_f32 v212, v212
v_mfma_f32_16x16x32_bf16 v[112:115], v[68:71], a[240:243], v[112:115]
v_exp_f32 v214, v214
v_mfma_f32_16x16x32_bf16 v[116:119], v[64:67], a[228:231], v[116:119]
ds_read_b128 v[56:59], v7 offset:43008
v_mul_f32 v213, v90, v106
v_mfma_f32_16x16x32_bf16 v[116:119], v[68:71], a[244:247], v[116:119]
v_mul_f32 v215, v91, v107
v_fma_f32 v212, v212, v240, v240
v_mfma_f32_16x16x32_bf16 v[120:123], v[64:67], a[232:235], v[120:123]
v_fma_f32 v214, v214, v240, v240
v_mul_f32 v208, v92, v92
v_mfma_f32_16x16x32_bf16 v[120:123], v[68:71], a[248:251], v[120:123]
ds_read_b128 v[60:63], v7 offset:44032
v_rcp_f32 v212, v212
v_mfma_f32_16x16x32_bf16 v[124:127], v[64:67], a[236:239], v[124:127]
v_rcp_f32 v214, v214
v_mfma_f32_16x16x32_bf16 v[124:127], v[68:71], a[252:255], v[124:127]
v_mul_f32 v213, v213, v212
s_waitcnt lgkmcnt(4)
v_mfma_f32_16x16x32_bf16 v[128:131], v[72:75], a[224:227], v[128:131]
v_mul_f32 v215, v215, v214
v_cvt_pk_bf16_f32 v185, v213, v215
v_mfma_f32_16x16x32_bf16 v[128:131], v[76:79], a[240:243], v[128:131]
v_mul_f32 v210, v93, v93
v_fma_f32 v208, v208, v242, v241
v_mfma_f32_16x16x32_bf16 v[132:135], v[72:75], a[228:231], v[132:135]
ds_read_b128 v[64:67], v7 offset:45056
v_fma_f32 v210, v210, v242, v241
v_mfma_f32_16x16x32_bf16 v[132:135], v[76:79], a[244:247], v[132:135]
v_mul_f32 v208, v208, v92
v_mul_f32 v210, v210, v93
v_mfma_f32_16x16x32_bf16 v[136:139], v[72:75], a[232:235], v[136:139]
v_exp_f32 v208, v208
v_mfma_f32_16x16x32_bf16 v[136:139], v[76:79], a[248:251], v[136:139]
ds_read_b128 v[68:71], v7 offset:46080
v_exp_f32 v210, v210
v_mfma_f32_16x16x32_bf16 v[140:143], v[72:75], a[236:239], v[140:143]
v_mul_f32 v209, v92, v108
v_mul_f32 v211, v93, v109
v_mfma_f32_16x16x32_bf16 v[140:143], v[76:79], a[252:255], v[140:143]
v_fma_f32 v208, v208, v243, v243
s_waitcnt lgkmcnt(4)
v_mfma_f32_16x16x32_bf16 v[112:115], v[48:51], v[16:19], v[112:115]
v_fma_f32 v210, v210, v243, v243
v_rcp_f32 v208, v208
v_mfma_f32_16x16x32_bf16 v[112:115], v[52:55], v[32:35], v[112:115]
v_rcp_f32 v210, v210
v_mfma_f32_16x16x32_bf16 v[116:119], v[48:51], v[20:23], v[116:119]
ds_read_b128 v[72:75], v7 offset:47104
v_mul_f32 v209, v209, v208
v_mfma_f32_16x16x32_bf16 v[116:119], v[52:55], v[36:39], v[116:119]
v_mul_f32 v211, v211, v210
v_cvt_pk_bf16_f32 v188, v209, v211
v_mfma_f32_16x16x32_bf16 v[120:123], v[48:51], v[24:27], v[120:123]
v_mul_f32 v212, v94, v94
v_mul_f32 v214, v95, v95
v_mfma_f32_16x16x32_bf16 v[120:123], v[52:55], v[40:43], v[120:123]
ds_read_b128 v[76:79], v7 offset:48128
v_fma_f32 v212, v212, v242, v241
v_mfma_f32_16x16x32_bf16 v[124:127], v[48:51], v[28:31], v[124:127]
v_fma_f32 v214, v214, v242, v241
v_mul_f32 v212, v212, v94
v_mfma_f32_16x16x32_bf16 v[124:127], v[52:55], v[44:47], v[124:127]
v_mul_f32 v214, v214, v95
s_waitcnt lgkmcnt(4)
v_mfma_f32_16x16x32_bf16 v[128:131], v[56:59], v[16:19], v[128:131]
v_exp_f32 v212, v212
v_mfma_f32_16x16x32_bf16 v[128:131], v[60:63], v[32:35], v[128:131]
v_exp_f32 v214, v214
v_mfma_f32_16x16x32_bf16 v[132:135], v[56:59], v[20:23], v[132:135]
ds_read_b128 v[48:51], v7 offset:49152
v_mul_f32 v213, v94, v110
v_mfma_f32_16x16x32_bf16 v[132:135], v[60:63], v[36:39], v[132:135]
v_mul_f32 v215, v95, v111
v_fma_f32 v212, v212, v243, v243
v_mfma_f32_16x16x32_bf16 v[136:139], v[56:59], v[24:27], v[136:139]
v_fma_f32 v214, v214, v243, v243
v_rcp_f32 v212, v212
v_mfma_f32_16x16x32_bf16 v[136:139], v[60:63], v[40:43], v[136:139]
ds_read_b128 v[52:55], v7 offset:50176
v_rcp_f32 v214, v214
v_mfma_f32_16x16x32_bf16 v[140:143], v[56:59], v[28:31], v[140:143]
v_mul_f32 v213, v213, v212
v_mul_f32 v215, v215, v214
v_mfma_f32_16x16x32_bf16 v[140:143], v[60:63], v[44:47], v[140:143]
v_cvt_pk_bf16_f32 v189, v213, v215
s_waitcnt lgkmcnt(4)
v_mfma_f32_16x16x32_bf16 v[80:83], v[64:67], a[0:3], 0
v_mfma_f32_16x16x32_bf16 v[80:83], v[68:71], a[16:19], v[80:83]
v_mfma_f32_16x16x32_bf16 v[84:87], v[64:67], a[4:7], 0
ds_read_b128 v[56:59], v7 offset:51200
v_mfma_f32_16x16x32_bf16 v[84:87], v[68:71], a[20:23], v[84:87]
v_mul_f32 v208, v112, v112
v_mul_f32 v210, v113, v113
v_mfma_f32_16x16x32_bf16 v[88:91], v[64:67], a[8:11], 0
v_fma_f32 v208, v208, v233, v232
v_fma_f32 v210, v210, v233, v232
v_mfma_f32_16x16x32_bf16 v[88:91], v[68:71], a[24:27], v[88:91]
ds_read_b128 v[60:63], v7 offset:52224
v_mul_f32 v208, v208, v112
v_mfma_f32_16x16x32_bf16 v[92:95], v[64:67], a[12:15], 0
v_mul_f32 v210, v210, v113
v_mul_f32 v209, v112, v128
v_mfma_f32_16x16x32_bf16 v[92:95], v[68:71], a[28:31], v[92:95]
v_mul_f32 v211, v113, v129
s_waitcnt lgkmcnt(4)
v_mfma_f32_16x16x32_bf16 v[96:99], v[72:75], a[0:3], 0
v_exp_f32 v208, v208
v_mfma_f32_16x16x32_bf16 v[96:99], v[76:79], a[16:19], v[96:99]
v_exp_f32 v210, v210
v_mfma_f32_16x16x32_bf16 v[100:103], v[72:75], a[4:7], 0
ds_read_b128 v[64:67], v7 offset:53248
v_fma_f32 v208, v208, v234, v234
v_mfma_f32_16x16x32_bf16 v[100:103], v[76:79], a[20:23], v[100:103]
v_fma_f32 v210, v210, v234, v234
v_mul_f32 v212, v114, v114
v_mfma_f32_16x16x32_bf16 v[104:107], v[72:75], a[8:11], 0
v_rcp_f32 v208, v208
v_mfma_f32_16x16x32_bf16 v[104:107], v[76:79], a[24:27], v[104:107]
ds_read_b128 v[68:71], v7 offset:54272
v_mul_f32 v209, v209, v208
v_mfma_f32_16x16x32_bf16 v[108:111], v[72:75], a[12:15], 0
v_rcp_f32 v210, v210
v_mfma_f32_16x16x32_bf16 v[108:111], v[76:79], a[28:31], v[108:111]
v_mul_f32 v211, v211, v210
s_waitcnt lgkmcnt(4)
v_mfma_f32_16x16x32_bf16 v[80:83], v[48:51], a[32:35], v[80:83]
v_cvt_pk_bf16_f32 v178, v209, v211
v_mul_f32 v214, v115, v115
v_mfma_f32_16x16x32_bf16 v[80:83], v[52:55], a[48:51], v[80:83]
v_fma_f32 v212, v212, v233, v232
v_fma_f32 v214, v214, v233, v232
v_mfma_f32_16x16x32_bf16 v[84:87], v[48:51], a[36:39], v[84:87]
ds_read_b128 v[72:75], v7 offset:55296
v_mul_f32 v212, v212, v114
v_mfma_f32_16x16x32_bf16 v[84:87], v[52:55], a[52:55], v[84:87]
v_mul_f32 v214, v214, v115
v_mul_f32 v213, v114, v130
v_mfma_f32_16x16x32_bf16 v[88:91], v[48:51], a[40:43], v[88:91]
v_exp_f32 v212, v212
v_mfma_f32_16x16x32_bf16 v[88:91], v[52:55], a[56:59], v[88:91]
ds_read_b128 v[76:79], v7 offset:56320
v_mul_f32 v215, v115, v131
v_mfma_f32_16x16x32_bf16 v[92:95], v[48:51], a[44:47], v[92:95]
v_exp_f32 v214, v214
v_mfma_f32_16x16x32_bf16 v[92:95], v[52:55], a[60:63], v[92:95]
v_fma_f32 v212, v212, v234, v234
s_waitcnt lgkmcnt(4)
v_mfma_f32_16x16x32_bf16 v[96:99], v[56:59], a[32:35], v[96:99]
s_waitcnt vmcnt(26)
v_fma_f32 v214, v214, v234, v234
v_mfma_f32_16x16x32_bf16 v[96:99], v[60:63], a[48:51], v[96:99]
s_barrier
v_mfma_f32_16x16x32_bf16 v[100:103], v[56:59], a[36:39], v[100:103]
ds_read_b128 v[48:51], v7 offset:57344
s_add_u32 m0, s22, 73728
v_mfma_f32_16x16x32_bf16 v[100:103], v[60:63], a[52:55], v[100:103]
v_add_u32 v3, 20480, v3
buffer_load_dwordx4 v3, s[8:11], 0 offen offset:0 lds
v_mfma_f32_16x16x32_bf16 v[104:107], v[56:59], a[40:43], v[104:107]
v_rcp_f32 v212, v212
v_mfma_f32_16x16x32_bf16 v[104:107], v[60:63], a[56:59], v[104:107]
ds_read_b128 v[52:55], v7 offset:58368
v_mul_f32 v213, v213, v212
v_mfma_f32_16x16x32_bf16 v[108:111], v[56:59], a[44:47], v[108:111]
v_rcp_f32 v214, v214
v_mfma_f32_16x16x32_bf16 v[108:111], v[60:63], a[60:63], v[108:111]
v_mul_f32 v215, v215, v214
s_waitcnt lgkmcnt(4)
v_mfma_f32_16x16x32_bf16 v[80:83], v[64:67], a[64:67], v[80:83]
buffer_load_dwordx4 v3, s[8:11], 0 offen offset:1024 lds
v_mfma_f32_16x16x32_bf16 v[80:83], v[68:71], a[80:83], v[80:83]
v_cvt_pk_bf16_f32 v179, v213, v215
v_mul_f32 v208, v116, v116
v_mfma_f32_16x16x32_bf16 v[84:87], v[64:67], a[68:71], v[84:87]
ds_read_b128 v[56:59], v7 offset:59392
v_mul_f32 v210, v117, v117
v_mfma_f32_16x16x32_bf16 v[84:87], v[68:71], a[84:87], v[84:87]
buffer_store_dwordx4 v[176:179], v2, s[8:11], s24 offen offset:2048 sc1
v_mfma_f32_16x16x32_bf16 v[88:91], v[64:67], a[72:75], v[88:91]
v_fma_f32 v208, v208, v236, v235
v_fma_f32 v210, v210, v236, v235
v_mfma_f32_16x16x32_bf16 v[88:91], v[68:71], a[88:91], v[88:91]
ds_read_b128 v[60:63], v7 offset:60416
v_mul_f32 v208, v208, v116
v_mfma_f32_16x16x32_bf16 v[92:95], v[64:67], a[76:79], v[92:95]
v_mul_f32 v210, v210, v117
v_mul_f32 v209, v116, v132
v_mfma_f32_16x16x32_bf16 v[92:95], v[68:71], a[92:95], v[92:95]
v_mul_f32 v211, v117, v133
s_waitcnt lgkmcnt(4)
v_mfma_f32_16x16x32_bf16 v[96:99], v[72:75], a[64:67], v[96:99]
buffer_load_dwordx4 v3, s[8:11], 0 offen offset:2048 lds
v_mfma_f32_16x16x32_bf16 v[96:99], v[76:79], a[80:83], v[96:99]
v_exp_f32 v208, v208
v_mfma_f32_16x16x32_bf16 v[100:103], v[72:75], a[68:71], v[100:103]
ds_read_b128 v[64:67], v7 offset:61440
v_fma_f32 v208, v208, v237, v237
v_mfma_f32_16x16x32_bf16 v[100:103], v[76:79], a[84:87], v[100:103]
v_exp_f32 v210, v210
v_mfma_f32_16x16x32_bf16 v[104:107], v[72:75], a[72:75], v[104:107]
buffer_load_dwordx4 v3, s[8:11], 0 offen offset:3072 lds
v_mfma_f32_16x16x32_bf16 v[104:107], v[76:79], a[88:91], v[104:107]
ds_read_b128 v[68:71], v7 offset:62464
s_add_u32 m0, s22, 77824
v_mfma_f32_16x16x32_bf16 v[108:111], v[72:75], a[76:79], v[108:111]
v_add_u32 v3, 4096, v3
v_fma_f32 v210, v210, v237, v237
v_mfma_f32_16x16x32_bf16 v[108:111], v[76:79], a[92:95], v[108:111]
v_mul_f32 v212, v118, v118
s_waitcnt lgkmcnt(4)
v_mfma_f32_16x16x32_bf16 v[80:83], v[48:51], a[96:99], v[80:83]
buffer_load_dwordx4 v3, s[8:11], 0 offen offset:0 lds
v_mfma_f32_16x16x32_bf16 v[80:83], v[52:55], a[112:115], v[80:83]
v_rcp_f32 v208, v208
v_mfma_f32_16x16x32_bf16 v[84:87], v[48:51], a[100:103], v[84:87]
ds_read_b128 v[72:75], v7 offset:63488
v_mul_f32 v209, v209, v208
v_mfma_f32_16x16x32_bf16 v[84:87], v[52:55], a[116:119], v[84:87]
v_rcp_f32 v210, v210
v_mfma_f32_16x16x32_bf16 v[88:91], v[48:51], a[104:107], v[88:91]
buffer_load_dwordx4 v3, s[8:11], 0 offen offset:1024 lds
v_mfma_f32_16x16x32_bf16 v[88:91], v[52:55], a[120:123], v[88:91]
ds_read_b128 v[76:79], v7 offset:64512
v_mul_f32 v211, v211, v210
v_mfma_f32_16x16x32_bf16 v[92:95], v[48:51], a[108:111], v[92:95]
v_cvt_pk_bf16_f32 v182, v209, v211
v_mul_f32 v214, v119, v119
v_mfma_f32_16x16x32_bf16 v[92:95], v[52:55], a[124:127], v[92:95]
v_fma_f32 v212, v212, v236, v235
s_waitcnt lgkmcnt(4)
v_mfma_f32_16x16x32_bf16 v[96:99], v[56:59], a[96:99], v[96:99]
buffer_load_dword v13, v11, s[8:11], s34 offen sc1
v_mfma_f32_16x16x32_bf16 v[96:99], v[60:63], a[112:115], v[96:99]
v_fma_f32 v214, v214, v236, v235
v_mul_f32 v212, v212, v118
v_mfma_f32_16x16x32_bf16 v[100:103], v[56:59], a[100:103], v[100:103]
ds_read_b128 v[48:51], v8 offset:0
v_mul_f32 v214, v214, v119
v_mfma_f32_16x16x32_bf16 v[100:103], v[60:63], a[116:119], v[100:103]
v_exp_f32 v212, v212
v_mfma_f32_16x16x32_bf16 v[104:107], v[56:59], a[104:107], v[104:107]
v_exp_f32 v214, v214
v_mfma_f32_16x16x32_bf16 v[104:107], v[60:63], a[120:123], v[104:107]
ds_read_b128 v[52:55], v8 offset:1024
v_mul_f32 v213, v118, v134
v_mfma_f32_16x16x32_bf16 v[108:111], v[56:59], a[108:111], v[108:111]
v_mul_f32 v215, v119, v135
v_fma_f32 v212, v212, v237, v237
v_mfma_f32_16x16x32_bf16 v[108:111], v[60:63], a[124:127], v[108:111]
v_fma_f32 v214, v214, v237, v237
s_waitcnt lgkmcnt(4)
v_mfma_f32_16x16x32_bf16 v[80:83], v[64:67], a[128:131], v[80:83]
v_rcp_f32 v212, v212
v_mfma_f32_16x16x32_bf16 v[80:83], v[68:71], a[144:147], v[80:83]
v_rcp_f32 v214, v214
v_mfma_f32_16x16x32_bf16 v[84:87], v[64:67], a[132:135], v[84:87]
ds_read_b128 v[56:59], v8 offset:2048
v_mul_f32 v213, v213, v212
v_mfma_f32_16x16x32_bf16 v[84:87], v[68:71], a[148:151], v[84:87]
v_mul_f32 v215, v215, v214
v_cvt_pk_bf16_f32 v183, v213, v215
v_mfma_f32_16x16x32_bf16 v[88:91], v[64:67], a[136:139], v[88:91]
buffer_store_dwordx4 v[180:183], v4, s[8:11], s24 offen offset:2048 sc1
v_mfma_f32_16x16x32_bf16 v[88:91], v[68:71], a[152:155], v[88:91]
ds_read_b128 v[60:63], v8 offset:3072
v_mul_f32 v208, v120, v120
v_mfma_f32_16x16x32_bf16 v[92:95], v[64:67], a[140:143], v[92:95]
v_mul_f32 v210, v121, v121
v_fma_f32 v208, v208, v239, v238
v_mfma_f32_16x16x32_bf16 v[92:95], v[68:71], a[156:159], v[92:95]
v_fma_f32 v210, v210, v239, v238
s_waitcnt lgkmcnt(4)
v_mfma_f32_16x16x32_bf16 v[96:99], v[72:75], a[128:131], v[96:99]
v_mul_f32 v208, v208, v120
v_mul_f32 v210, v210, v121
v_mfma_f32_16x16x32_bf16 v[96:99], v[76:79], a[144:147], v[96:99]
v_exp_f32 v208, v208
v_mfma_f32_16x16x32_bf16 v[100:103], v[72:75], a[132:135], v[100:103]
ds_read_b128 v[64:67], v8 offset:4096
v_mul_f32 v209, v120, v136
v_mfma_f32_16x16x32_bf16 v[100:103], v[76:79], a[148:151], v[100:103]
v_exp_f32 v210, v210
v_mfma_f32_16x16x32_bf16 v[104:107], v[72:75], a[136:139], v[104:107]
v_mul_f32 v211, v121, v137
v_fma_f32 v208, v208, v240, v240
v_mfma_f32_16x16x32_bf16 v[104:107], v[76:79], a[152:155], v[104:107]
ds_read_b128 v[68:71], v8 offset:5120
v_fma_f32 v210, v210, v240, v240
v_mfma_f32_16x16x32_bf16 v[108:111], v[72:75], a[140:143], v[108:111]
v_rcp_f32 v208, v208
v_mfma_f32_16x16x32_bf16 v[108:111], v[76:79], a[156:159], v[108:111]
v_mul_f32 v209, v209, v208
s_waitcnt lgkmcnt(4)
v_mfma_f32_16x16x32_bf16 v[80:83], v[48:51], a[160:163], v[80:83]
v_rcp_f32 v210, v210
v_mfma_f32_16x16x32_bf16 v[80:83], v[52:55], a[176:179], v[80:83]
v_mul_f32 v211, v211, v210
v_cvt_pk_bf16_f32 v186, v209, v211
v_mfma_f32_16x16x32_bf16 v[84:87], v[48:51], a[164:167], v[84:87]
ds_read_b128 v[72:75], v8 offset:6144
v_mul_f32 v212, v122, v122
v_mfma_f32_16x16x32_bf16 v[84:87], v[52:55], a[180:183], v[84:87]
v_mul_f32 v214, v123, v123
v_fma_f32 v212, v212, v239, v238
v_mfma_f32_16x16x32_bf16 v[88:91], v[48:51], a[168:171], v[88:91]
v_fma_f32 v214, v214, v239, v238
v_mul_f32 v212, v212, v122
v_mfma_f32_16x16x32_bf16 v[88:91], v[52:55], a[184:187], v[88:91]
ds_read_b128 v[76:79], v8 offset:7168
v_mul_f32 v214, v214, v123
v_mfma_f32_16x16x32_bf16 v[92:95], v[48:51], a[172:175], v[92:95]
v_exp_f32 v212, v212
v_mfma_f32_16x16x32_bf16 v[92:95], v[52:55], a[188:191], v[92:95]
v_mul_f32 v213, v122, v138
s_waitcnt lgkmcnt(4)
v_mfma_f32_16x16x32_bf16 v[96:99], v[56:59], a[160:163], v[96:99]
v_exp_f32 v214, v214
v_mfma_f32_16x16x32_bf16 v[96:99], v[60:63], a[176:179], v[96:99]
v_mul_f32 v215, v123, v139
v_fma_f32 v212, v212, v240, v240
v_mfma_f32_16x16x32_bf16 v[100:103], v[56:59], a[164:167], v[100:103]
ds_read_b128 v[48:51], v8 offset:8192
v_fma_f32 v214, v214, v240, v240
v_mfma_f32_16x16x32_bf16 v[100:103], v[60:63], a[180:183], v[100:103]
v_rcp_f32 v212, v212
v_mfma_f32_16x16x32_bf16 v[104:107], v[56:59], a[168:171], v[104:107]
v_mfma_f32_16x16x32_bf16 v[104:107], v[60:63], a[184:187], v[104:107]
ds_read_b128 v[52:55], v8 offset:9216
v_mul_f32 v213, v213, v212
v_mfma_f32_16x16x32_bf16 v[108:111], v[56:59], a[172:175], v[108:111]
v_rcp_f32 v214, v214
v_mfma_f32_16x16x32_bf16 v[108:111], v[60:63], a[188:191], v[108:111]
s_waitcnt lgkmcnt(4)
v_mfma_f32_16x16x32_bf16 v[80:83], v[64:67], a[192:195], v[80:83]
v_mul_f32 v215, v215, v214
v_cvt_pk_bf16_f32 v187, v213, v215
v_mfma_f32_16x16x32_bf16 v[80:83], v[68:71], a[208:211], v[80:83]
buffer_store_dwordx4 v[184:187], v5, s[8:11], s24 offen offset:2048 sc1
v_mfma_f32_16x16x32_bf16 v[84:87], v[64:67], a[196:199], v[84:87]
ds_read_b128 v[56:59], v8 offset:10240
v_mfma_f32_16x16x32_bf16 v[84:87], v[68:71], a[212:215], v[84:87]
v_mul_f32 v208, v124, v124
v_mul_f32 v210, v125, v125
v_mfma_f32_16x16x32_bf16 v[88:91], v[64:67], a[200:203], v[88:91]
v_mfma_f32_16x16x32_bf16 v[88:91], v[68:71], a[216:219], v[88:91]
ds_read_b128 v[60:63], v8 offset:11264
v_fma_f32 v208, v208, v242, v241
v_mfma_f32_16x16x32_bf16 v[92:95], v[64:67], a[204:207], v[92:95]
v_fma_f32 v210, v210, v242, v241
v_mul_f32 v208, v208, v124
v_mfma_f32_16x16x32_bf16 v[92:95], v[68:71], a[220:223], v[92:95]
v_mul_f32 v210, v210, v125
s_waitcnt lgkmcnt(4)
v_mfma_f32_16x16x32_bf16 v[96:99], v[72:75], a[192:195], v[96:99]
v_exp_f32 v208, v208
v_mfma_f32_16x16x32_bf16 v[96:99], v[76:79], a[208:211], v[96:99]
v_mfma_f32_16x16x32_bf16 v[100:103], v[72:75], a[196:199], v[100:103]
ds_read_b128 v[64:67], v8 offset:12288
v_mul_f32 v209, v124, v140
v_mfma_f32_16x16x32_bf16 v[100:103], v[76:79], a[212:215], v[100:103]
v_exp_f32 v210, v210
v_mfma_f32_16x16x32_bf16 v[104:107], v[72:75], a[200:203], v[104:107]
v_mfma_f32_16x16x32_bf16 v[104:107], v[76:79], a[216:219], v[104:107]
ds_read_b128 v[68:71], v8 offset:13312
v_mul_f32 v211, v125, v141
v_mfma_f32_16x16x32_bf16 v[108:111], v[72:75], a[204:207], v[108:111]
v_fma_f32 v208, v208, v243, v243
v_fma_f32 v210, v210, v243, v243
v_mfma_f32_16x16x32_bf16 v[108:111], v[76:79], a[220:223], v[108:111]
v_mul_f32 v212, v126, v126
s_waitcnt lgkmcnt(4)
v_mfma_f32_16x16x32_bf16 v[80:83], v[48:51], a[224:227], v[80:83]
v_rcp_f32 v208, v208
v_mfma_f32_16x16x32_bf16 v[80:83], v[52:55], a[240:243], v[80:83]
v_mfma_f32_16x16x32_bf16 v[84:87], v[48:51], a[228:231], v[84:87]
ds_read_b128 v[72:75], v8 offset:14336
v_mul_f32 v209, v209, v208
v_mfma_f32_16x16x32_bf16 v[84:87], v[52:55], a[244:247], v[84:87]
v_rcp_f32 v210, v210
v_mfma_f32_16x16x32_bf16 v[88:91], v[48:51], a[232:235], v[88:91]
v_mul_f32 v211, v211, v210
v_cvt_pk_bf16_f32 v190, v209, v211
v_mfma_f32_16x16x32_bf16 v[88:91], v[52:55], a[248:251], v[88:91]
ds_read_b128 v[76:79], v8 offset:15360
v_mfma_f32_16x16x32_bf16 v[92:95], v[48:51], a[236:239], v[92:95]
v_mul_f32 v214, v127, v127
v_fma_f32 v212, v212, v242, v241
v_mfma_f32_16x16x32_bf16 v[92:95], v[52:55], a[252:255], v[92:95]
s_waitcnt lgkmcnt(4)
v_mfma_f32_16x16x32_bf16 v[96:99], v[56:59], a[224:227], v[96:99]
s_waitcnt vmcnt(28)
v_fma_f32 v214, v214, v242, v241
v_mfma_f32_16x16x32_bf16 v[96:99], v[60:63], a[240:243], v[96:99]
s_barrier
v_mfma_f32_16x16x32_bf16 v[100:103], v[56:59], a[228:231], v[100:103]
ds_read_b128 v[48:51], v2 offset:0
s_add_u32 m0, s22, 98304
v_mfma_f32_16x16x32_bf16 v[100:103], v[60:63], a[244:247], v[100:103]
v_add_u32 v3, 20480, v3
buffer_load_dwordx4 v3, s[8:11], 0 offen offset:0 lds
v_mfma_f32_16x16x32_bf16 v[104:107], v[56:59], a[232:235], v[104:107]
v_mul_f32 v212, v212, v126
v_mul_f32 v214, v214, v127
v_mfma_f32_16x16x32_bf16 v[104:107], v[60:63], a[248:251], v[104:107]
ds_read_b128 v[52:55], v2 offset:1024
v_mul_f32 v213, v126, v142
v_mfma_f32_16x16x32_bf16 v[108:111], v[56:59], a[236:239], v[108:111]
v_exp_f32 v212, v212
v_mfma_f32_16x16x32_bf16 v[108:111], v[60:63], a[252:255], v[108:111]
v_mul_f32 v215, v127, v143
s_waitcnt lgkmcnt(4)
v_mfma_f32_16x16x32_bf16 v[80:83], v[64:67], v[16:19], v[80:83]
buffer_load_dwordx4 v3, s[8:11], 0 offen offset:1024 lds
v_mfma_f32_16x16x32_bf16 v[80:83], v[68:71], v[32:35], v[80:83]
v_exp_f32 v214, v214
v_mfma_f32_16x16x32_bf16 v[84:87], v[64:67], v[20:23], v[84:87]
ds_read_b128 v[56:59], v2 offset:2048
v_fma_f32 v212, v212, v243, v243
v_mfma_f32_16x16x32_bf16 v[84:87], v[68:71], v[36:39], v[84:87]
v_fma_f32 v214, v214, v243, v243
v_mfma_f32_16x16x32_bf16 v[88:91], v[64:67], v[24:27], v[88:91]
buffer_load_dwordx4 v3, s[8:11], 0 offen offset:2048 lds
v_mfma_f32_16x16x32_bf16 v[88:91], v[68:71], v[40:43], v[88:91]
ds_read_b128 v[60:63], v2 offset:3072
v_mfma_f32_16x16x32_bf16 v[92:95], v[64:67], v[28:31], v[92:95]
v_rcp_f32 v212, v212
v_mfma_f32_16x16x32_bf16 v[92:95], v[68:71], v[44:47], v[92:95]
v_mul_f32 v213, v213, v212
s_waitcnt lgkmcnt(4)
v_mfma_f32_16x16x32_bf16 v[96:99], v[72:75], v[16:19], v[96:99]
buffer_load_dwordx4 v3, s[8:11], 0 offen offset:3072 lds
v_mfma_f32_16x16x32_bf16 v[96:99], v[76:79], v[32:35], v[96:99]
s_add_u32 m0, s22, 102400
v_add_u32 v3, 4096, v3
v_mfma_f32_16x16x32_bf16 v[100:103], v[72:75], v[20:23], v[100:103]
ds_read_b128 v[64:67], v2 offset:4096
v_mfma_f32_16x16x32_bf16 v[100:103], v[76:79], v[36:39], v[100:103]
v_rcp_f32 v214, v214
v_mfma_f32_16x16x32_bf16 v[104:107], v[72:75], v[24:27], v[104:107]
buffer_load_dwordx4 v3, s[8:11], 0 offen offset:0 lds
v_mul_f32 v215, v215, v214
v_mfma_f32_16x16x32_bf16 v[104:107], v[76:79], v[40:43], v[104:107]
ds_read_b128 v[68:71], v2 offset:5120
v_cvt_pk_bf16_f32 v191, v213, v215
v_mfma_f32_16x16x32_bf16 v[108:111], v[72:75], v[28:31], v[108:111]
buffer_store_dwordx4 v[188:191], v6, s[8:11], s24 offen offset:2048 sc1
v_mfma_f32_16x16x32_bf16 v[108:111], v[76:79], v[44:47], v[108:111]
s_waitcnt lgkmcnt(4)
v_mfma_f32_16x16x32_bf16 v[112:115], v[48:51], a[0:3], 0
v_mfma_f32_16x16x32_bf16 v[112:115], v[52:55], a[16:19], v[112:115]
v_mfma_f32_16x16x32_bf16 v[116:119], v[48:51], a[4:7], 0
ds_read_b128 v[72:75], v2 offset:6144
v_mfma_f32_16x16x32_bf16 v[116:119], v[52:55], a[20:23], v[116:119]
buffer_load_dwordx4 v3, s[8:11], 0 offen offset:1024 lds
v_mfma_f32_16x16x32_bf16 v[120:123], v[48:51], a[8:11], 0
s_waitcnt vmcnt(9)
v_cmp_le_u32 vcc, 1, v13
s_nop 0
s_cmp_eq_u64 vcc, exec
s_cbranch_scc0 L_f_slow1
L_f_back1:
v_mul_f32 v208, v80, v80
v_mfma_f32_16x16x32_bf16 v[120:123], v[52:55], a[24:27], v[120:123]
ds_read_b128 v[76:79], v2 offset:7168
v_mul_f32 v210, v81, v81
v_mfma_f32_16x16x32_bf16 v[124:127], v[48:51], a[12:15], 0
v_fma_f32 v208, v208, v233, v232
v_fma_f32 v210, v210, v233, v232
v_mfma_f32_16x16x32_bf16 v[124:127], v[52:55], a[28:31], v[124:127]
v_mul_f32 v208, v208, v80
s_waitcnt lgkmcnt(4)
v_mfma_f32_16x16x32_bf16 v[128:131], v[56:59], a[0:3], 0
v_mul_f32 v210, v210, v81
v_mul_f32 v209, v80, v96
v_mfma_f32_16x16x32_bf16 v[128:131], v[60:63], a[16:19], v[128:131]
v_exp_f32 v208, v208
v_mfma_f32_16x16x32_bf16 v[132:135], v[56:59], a[4:7], 0
ds_read_b128 v[48:51], v2 offset:8192
v_mul_f32 v211, v81, v97
v_mfma_f32_16x16x32_bf16 v[132:135], v[60:63], a[20:23], v[132:135]
v_exp_f32 v210, v210
v_mfma_f32_16x16x32_bf16 v[136:139], v[56:59], a[8:11], 0
v_fma_f32 v208, v208, v234, v234
v_fma_f32 v210, v210, v234, v234
v_mfma_f32_16x16x32_bf16 v[136:139], v[60:63], a[24:27], v[136:139]
ds_read_b128 v[52:55], v2 offset:9216
v_mul_f32 v212, v82, v82
v_mfma_f32_16x16x32_bf16 v[140:143], v[56:59], a[12:15], 0
v_rcp_f32 v208, v208
v_mfma_f32_16x16x32_bf16 v[140:143], v[60:63], a[28:31], v[140:143]
v_mul_f32 v209, v209, v208
s_waitcnt lgkmcnt(4)
v_mfma_f32_16x16x32_bf16 v[112:115], v[64:67], a[32:35], v[112:115]
v_rcp_f32 v210, v210
v_mfma_f32_16x16x32_bf16 v[112:115], v[68:71], a[48:51], v[112:115]
v_mul_f32 v211, v211, v210
v_cvt_pk_bf16_f32 v192, v209, v211
v_mfma_f32_16x16x32_bf16 v[116:119], v[64:67], a[36:39], v[116:119]
ds_read_b128 v[56:59], v2 offset:10240
v_mul_f32 v214, v83, v83
v_mfma_f32_16x16x32_bf16 v[116:119], v[68:71], a[52:55], v[116:119]
v_fma_f32 v212, v212, v233, v232
v_fma_f32 v214, v214, v233, v232
v_mfma_f32_16x16x32_bf16 v[120:123], v[64:67], a[40:43], v[120:123]
v_mul_f32 v212, v212, v82
v_mul_f32 v214, v214, v83
v_mfma_f32_16x16x32_bf16 v[120:123], v[68:71], a[56:59], v[120:123]
ds_read_b128 v[60:63], v2 offset:11264
v_mul_f32 v213, v82, v98
v_mfma_f32_16x16x32_bf16 v[124:127], v[64:67], a[44:47], v[124:127]
v_exp_f32 v212, v212
v_mfma_f32_16x16x32_bf16 v[124:127], v[68:71], a[60:63], v[124:127]
v_mul_f32 v215, v83, v99
s_waitcnt lgkmcnt(4)
v_mfma_f32_16x16x32_bf16 v[128:131], v[72:75], a[32:35], v[128:131]
buffer_load_dwordx4 a[0:3], v2, s[8:11], s25 offen offset:0 sc1
v_mfma_f32_16x16x32_bf16 v[128:131], v[76:79], a[48:51], v[128:131]
v_exp_f32 v214, v214
v_mfma_f32_16x16x32_bf16 v[132:135], v[72:75], a[36:39], v[132:135]
ds_read_b128 v[64:67], v2 offset:12288
v_fma_f32 v212, v212, v234, v234
v_mfma_f32_16x16x32_bf16 v[132:135], v[76:79], a[52:55], v[132:135]
v_fma_f32 v214, v214, v234, v234
v_mul_f32 v208, v84, v84
v_mfma_f32_16x16x32_bf16 v[136:139], v[72:75], a[40:43], v[136:139]
buffer_load_dwordx4 a[4:7], v4, s[8:11], s25 offen offset:0 sc1
v_mfma_f32_16x16x32_bf16 v[136:139], v[76:79], a[56:59], v[136:139]
ds_read_b128 v[68:71], v2 offset:13312
v_mul_f32 v210, v85, v85
v_mfma_f32_16x16x32_bf16 v[140:143], v[72:75], a[44:47], v[140:143]
v_rcp_f32 v212, v212
v_mfma_f32_16x16x32_bf16 v[140:143], v[76:79], a[60:63], v[140:143]
v_mul_f32 v213, v213, v212
s_waitcnt lgkmcnt(4)
v_mfma_f32_16x16x32_bf16 v[112:115], v[48:51], a[64:67], v[112:115]
buffer_load_dwordx4 a[8:11], v5, s[8:11], s25 offen offset:0 sc1
v_mfma_f32_16x16x32_bf16 v[112:115], v[52:55], a[80:83], v[112:115]
v_rcp_f32 v214, v214
v_mfma_f32_16x16x32_bf16 v[116:119], v[48:51], a[68:71], v[116:119]
ds_read_b128 v[72:75], v2 offset:14336
v_mul_f32 v215, v215, v214
v_mfma_f32_16x16x32_bf16 v[116:119], v[52:55], a[84:87], v[116:119]
v_cvt_pk_bf16_f32 v193, v213, v215
v_fma_f32 v208, v208, v236, v235
v_mfma_f32_16x16x32_bf16 v[120:123], v[48:51], a[72:75], v[120:123]
buffer_load_dwordx4 a[12:15], v6, s[8:11], s25 offen offset:0 sc1
v_mfma_f32_16x16x32_bf16 v[120:123], v[52:55], a[88:91], v[120:123]
ds_read_b128 v[76:79], v2 offset:15360
v_fma_f32 v210, v210, v236, v235
v_mfma_f32_16x16x32_bf16 v[124:127], v[48:51], a[76:79], v[124:127]
v_mul_f32 v208, v208, v84
v_mul_f32 v210, v210, v85
v_mfma_f32_16x16x32_bf16 v[124:127], v[52:55], a[92:95], v[124:127]
v_mul_f32 v209, v84, v100
s_waitcnt lgkmcnt(4)
v_mfma_f32_16x16x32_bf16 v[128:131], v[56:59], a[64:67], v[128:131]
v_exp_f32 v208, v208
v_mfma_f32_16x16x32_bf16 v[128:131], v[60:63], a[80:83], v[128:131]
v_exp_f32 v210, v210
v_mfma_f32_16x16x32_bf16 v[132:135], v[56:59], a[68:71], v[132:135]
ds_read_b128 v[48:51], v2 offset:16384
v_mul_f32 v211, v85, v101
v_mfma_f32_16x16x32_bf16 v[132:135], v[60:63], a[84:87], v[132:135]
v_fma_f32 v208, v208, v237, v237
v_fma_f32 v210, v210, v237, v237
v_mfma_f32_16x16x32_bf16 v[136:139], v[56:59], a[72:75], v[136:139]
v_rcp_f32 v208, v208
v_mfma_f32_16x16x32_bf16 v[136:139], v[60:63], a[88:91], v[136:139]
ds_read_b128 v[52:55], v2 offset:17408
v_mul_f32 v209, v209, v208
v_mfma_f32_16x16x32_bf16 v[140:143], v[56:59], a[76:79], v[140:143]
v_rcp_f32 v210, v210
v_mfma_f32_16x16x32_bf16 v[140:143], v[60:63], a[92:95], v[140:143]
v_mul_f32 v211, v211, v210
s_waitcnt lgkmcnt(4)
v_mfma_f32_16x16x32_bf16 v[112:115], v[64:67], a[96:99], v[112:115]
v_mov_b32 v12, 2
s_waitcnt vmcnt(5)
buffer_store_dword v12, v10, s[8:11], s34 offen sc1
v_mfma_f32_16x16x32_bf16 v[112:115], v[68:71], a[112:115], v[112:115]
v_cvt_pk_bf16_f32 v196, v209, v211
v_mul_f32 v212, v86, v86
v_mfma_f32_16x16x32_bf16 v[116:119], v[64:67], a[100:103], v[116:119]
ds_read_b128 v[56:59], v2 offset:18432
v_mul_f32 v214, v87, v87
v_mfma_f32_16x16x32_bf16 v[116:119], v[68:71], a[116:119], v[116:119]
v_fma_f32 v212, v212, v236, v235
v_fma_f32 v214, v214, v236, v235
v_mfma_f32_16x16x32_bf16 v[120:123], v[64:67], a[104:107], v[120:123]
buffer_load_dwordx4 a[16:19], v2, s[8:11], s26 offen offset:0 sc1
v_mfma_f32_16x16x32_bf16 v[120:123], v[68:71], a[120:123], v[120:123]
ds_read_b128 v[60:63], v2 offset:19456
v_mul_f32 v212, v212, v86
v_mfma_f32_16x16x32_bf16 v[124:127], v[64:67], a[108:111], v[124:127]
v_mul_f32 v214, v214, v87
v_mul_f32 v213, v86, v102
v_mfma_f32_16x16x32_bf16 v[124:127], v[68:71], a[124:127], v[124:127]
v_mul_f32 v215, v87, v103
s_waitcnt lgkmcnt(4)
v_mfma_f32_16x16x32_bf16 v[128:131], v[72:75], a[96:99], v[128:131]
buffer_load_dwordx4 a[20:23], v4, s[8:11], s26 offen offset:0 sc1
v_mfma_f32_16x16x32_bf16 v[128:131], v[76:79], a[112:115], v[128:131]
v_exp_f32 v212, v212
v_mfma_f32_16x16x32_bf16 v[132:135], v[72:75], a[100:103], v[132:135]
ds_read_b128 v[64:67], v2 offset:20480
v_fma_f32 v212, v212, v237, v237
v_mfma_f32_16x16x32_bf16 v[132:135], v[76:79], a[116:119], v[132:135]
v_exp_f32 v214, v214
v_mfma_f32_16x16x32_bf16 v[136:139], v[72:75], a[104:107], v[136:139]
buffer_load_dwordx4 a[24:27], v5, s[8:11], s26 offen offset:0 sc1
v_mfma_f32_16x16x32_bf16 v[136:139], v[76:79], a[120:123], v[136:139]
ds_read_b128 v[68:71], v2 offset:21504
v_fma_f32 v214, v214, v237, v237
v_mfma_f32_16x16x32_bf16 v[140:143], v[72:75], a[108:111], v[140:143]
v_rcp_f32 v212, v212
v_mfma_f32_16x16x32_bf16 v[140:143], v[76:79], a[124:127], v[140:143]
v_mul_f32 v213, v213, v212
s_waitcnt lgkmcnt(4)
v_mfma_f32_16x16x32_bf16 v[112:115], v[48:51], a[128:131], v[112:115]
buffer_load_dwordx4 a[28:31], v6, s[8:11], s26 offen offset:0 sc1
v_mfma_f32_16x16x32_bf16 v[112:115], v[52:55], a[144:147], v[112:115]
v_rcp_f32 v214, v214
v_mfma_f32_16x16x32_bf16 v[116:119], v[48:51], a[132:135], v[116:119]
ds_read_b128 v[72:75], v2 offset:22528
v_mul_f32 v215, v215, v214
v_mfma_f32_16x16x32_bf16 v[116:119], v[52:55], a[148:151], v[116:119]
v_cvt_pk_bf16_f32 v197, v213, v215
v_mul_f32 v208, v88, v88
v_mfma_f32_16x16x32_bf16 v[120:123], v[48:51], a[136:139], v[120:123]
v_mul_f32 v210, v89, v89
v_fma_f32 v208, v208, v239, v238
v_mfma_f32_16x16x32_bf16 v[120:123], v[52:55], a[152:155], v[120:123]
ds_read_b128 v[76:79], v2 offset:23552
v_fma_f32 v210, v210, v239, v238
v_mfma_f32_16x16x32_bf16 v[124:127], v[48:51], a[140:143], v[124:127]
v_mul_f32 v208, v208, v88
v_mul_f32 v210, v210, v89
v_mfma_f32_16x16x32_bf16 v[124:127], v[52:55], a[156:159], v[124:127]
v_mul_f32 v209, v88, v104
s_waitcnt lgkmcnt(4)
v_mfma_f32_16x16x32_bf16 v[128:131], v[56:59], a[128:131], v[128:131]
s_waitcnt vmcnt(34)
buffer_load_dwordx4 a[32:35], v2, s[8:11], s27 offen offset:0 sc1
v_mfma_f32_16x16x32_bf16 v[128:131], v[60:63], a[144:147], v[128:131]
s_barrier
v_mfma_f32_16x16x32_bf16 v[132:135], v[56:59], a[132:135], v[132:135]
ds_read_b128 v[48:51], v2 offset:24576
v_mul_f32 v211, v89, v105
v_mfma_f32_16x16x32_bf16 v[132:135], v[60:63], a[148:151], v[132:135]
v_exp_f32 v208, v208
v_mfma_f32_16x16x32_bf16 v[136:139], v[56:59], a[136:139], v[136:139]
buffer_load_dwordx4 a[36:39], v4, s[8:11], s27 offen offset:0 sc1
v_mfma_f32_16x16x32_bf16 v[136:139], v[60:63], a[152:155], v[136:139]
ds_read_b128 v[52:55], v2 offset:25600
v_fma_f32 v208, v208, v240, v240
v_mfma_f32_16x16x32_bf16 v[140:143], v[56:59], a[140:143], v[140:143]
v_exp_f32 v210, v210
v_mfma_f32_16x16x32_bf16 v[140:143], v[60:63], a[156:159], v[140:143]
v_fma_f32 v210, v210, v240, v240
s_waitcnt lgkmcnt(4)
v_mfma_f32_16x16x32_bf16 v[112:115], v[64:67], a[160:163], v[112:115]
buffer_load_dwordx4 a[40:43], v5, s[8:11], s27 offen offset:0 sc1
v_mfma_f32_16x16x32_bf16 v[112:115], v[68:71], a[176:179], v[112:115]
v_rcp_f32 v208, v208
v_mfma_f32_16x16x32_bf16 v[116:119], v[64:67], a[164:167], v[116:119]
ds_read_b128 v[56:59], v2 offset:26624
v_mul_f32 v209, v209, v208
v_mfma_f32_16x16x32_bf16 v[116:119], v[68:71], a[180:183], v[116:119]
v_rcp_f32 v210, v210
v_mfma_f32_16x16x32_bf16 v[120:123], v[64:67], a[168:171], v[120:123]
buffer_load_dwordx4 a[44:47], v6, s[8:11], s27 offen offset:0 sc1
v_mfma_f32_16x16x32_bf16 v[120:123], v[68:71], a[184:187], v[120:123]
ds_read_b128 v[60:63], v2 offset:27648
s_add_u32 m0, s22, 122880
v_mfma_f32_16x16x32_bf16 v[124:127], v[64:67], a[172:175], v[124:127]
v_add_u32 v3, 20480, v3
v_mul_f32 v211, v211, v210
v_mfma_f32_16x16x32_bf16 v[124:127], v[68:71], a[188:191], v[124:127]
v_cvt_pk_bf16_f32 v200, v209, v211
s_waitcnt lgkmcnt(4)
v_mfma_f32_16x16x32_bf16 v[128:131], v[72:75], a[160:163], v[128:131]
buffer_load_dwordx4 v3, s[8:11], 0 offen offset:0 lds
v_mfma_f32_16x16x32_bf16 v[128:131], v[76:79], a[176:179], v[128:131]
v_mul_f32 v212, v90, v90
v_mul_f32 v214, v91, v91
v_mfma_f32_16x16x32_bf16 v[132:135], v[72:75], a[164:167], v[132:135]
ds_read_b128 v[64:67], v2 offset:28672
v_fma_f32 v212, v212, v239, v238
v_mfma_f32_16x16x32_bf16 v[132:135], v[76:79], a[180:183], v[132:135]
v_fma_f32 v214, v214, v239, v238
v_mul_f32 v212, v212, v90
v_mfma_f32_16x16x32_bf16 v[136:139], v[72:75], a[168:171], v[136:139]
buffer_load_dwordx4 v3, s[8:11], 0 offen offset:1024 lds
v_mfma_f32_16x16x32_bf16 v[136:139], v[76:79], a[184:187], v[136:139]
ds_read_b128 v[68:71], v2 offset:29696
v_mul_f32 v214, v214, v91
v_mfma_f32_16x16x32_bf16 v[140:143], v[72:75], a[172:175], v[140:143]
v_exp_f32 v212, v212
v_mfma_f32_16x16x32_bf16 v[140:143], v[76:79], a[188:191], v[140:143]
v_mul_f32 v213, v90, v106
s_waitcnt lgkmcnt(4)
v_mfma_f32_16x16x32_bf16 v[112:115], v[48:51], a[192:195], v[112:115]
buffer_load_dwordx4 v3, s[8:11], 0 offen offset:2048 lds
v_mfma_f32_16x16x32_bf16 v[112:115], v[52:55], a[208:211], v[112:115]
v_exp_f32 v214, v214
v_mfma_f32_16x16x32_bf16 v[116:119], v[48:51], a[196:199], v[116:119]
ds_read_b128 v[72:75], v2 offset:30720
v_mul_f32 v215, v91, v107
v_mfma_f32_16x16x32_bf16 v[116:119], v[52:55], a[212:215], v[116:119]
v_fma_f32 v212, v212, v240, v240
v_fma_f32 v214, v214, v240, v240
v_mfma_f32_16x16x32_bf16 v[120:123], v[48:51], a[200:203], v[120:123]
buffer_load_dwordx4 v3, s[8:11], 0 offen offset:3072 lds
v_mfma_f32_16x16x32_bf16 v[120:123], v[52:55], a[216:219], v[120:123]
ds_read_b128 v[76:79], v2 offset:31744
s_add_u32 m0, s22, 126976
v_mfma_f32_16x16x32_bf16 v[124:127], v[48:51], a[204:207], v[124:127]
v_add_u32 v3, 4096, v3
v_mul_f32 v208, v92, v92
v_mfma_f32_16x16x32_bf16 v[124:127], v[52:55], a[220:223], v[124:127]
v_mul_f32 v210, v93, v93
s_waitcnt lgkmcnt(4)
v_mfma_f32_16x16x32_bf16 v[128:131], v[56:59], a[192:195], v[128:131]
buffer_load_dwordx4 v3, s[8:11], 0 offen offset:0 lds
v_mfma_f32_16x16x32_bf16 v[128:131], v[60:63], a[208:211], v[128:131]
v_rcp_f32 v212, v212
v_mfma_f32_16x16x32_bf16 v[132:135], v[56:59], a[196:199], v[132:135]
ds_read_b128 v[48:51], v2 offset:32768
v_mul_f32 v213, v213, v212
v_mfma_f32_16x16x32_bf16 v[132:135], v[60:63], a[212:215], v[132:135]
v_rcp_f32 v214, v214
v_mfma_f32_16x16x32_bf16 v[136:139], v[56:59], a[200:203], v[136:139]
buffer_load_dwordx4 v3, s[8:11], 0 offen offset:1024 lds
v_mfma_f32_16x16x32_bf16 v[136:139], v[60:63], a[216:219], v[136:139]
ds_read_b128 v[52:55], v2 offset:33792
v_mul_f32 v215, v215, v214
v_mfma_f32_16x16x32_bf16 v[140:143], v[56:59], a[204:207], v[140:143]
v_cvt_pk_bf16_f32 v201, v213, v215
v_fma_f32 v208, v208, v242, v241
v_mfma_f32_16x16x32_bf16 v[140:143], v[60:63], a[220:223], v[140:143]
v_fma_f32 v210, v210, v242, v241
s_waitcnt lgkmcnt(4)
v_mfma_f32_16x16x32_bf16 v[112:115], v[64:67], a[224:227], v[112:115]
buffer_load_dwordx4 a[48:51], v2, s[8:11], s25 offen offset:1024 sc1
v_mfma_f32_16x16x32_bf16 v[112:115], v[68:71], a[240:243], v[112:115]
v_mul_f32 v208, v208, v92
v_mul_f32 v210, v210, v93
v_mfma_f32_16x16x32_bf16 v[116:119], v[64:67], a[228:231], v[116:119]
ds_read_b128 v[56:59], v2 offset:34816
v_mul_f32 v209, v92, v108
v_mfma_f32_16x16x32_bf16 v[116:119], v[68:71], a[244:247], v[116:119]
v_exp_f32 v208, v208
v_mfma_f32_16x16x32_bf16 v[120:123], v[64:67], a[232:235], v[120:123]
buffer_load_dwordx4 a[52:55], v4, s[8:11], s25 offen offset:1024 sc1
v_mfma_f32_16x16x32_bf16 v[120:123], v[68:71], a[248:251], v[120:123]
ds_read_b128 v[60:63], v2 offset:35840
v_mul_f32 v211, v93, v109
v_mfma_f32_16x16x32_bf16 v[124:127], v[64:67], a[236:239], v[124:127]
v_exp_f32 v210, v210
v_mfma_f32_16x16x32_bf16 v[124:127], v[68:71], a[252:255], v[124:127]
v_fma_f32 v208, v208, v243, v243
s_waitcnt lgkmcnt(4)
v_mfma_f32_16x16x32_bf16 v[128:131], v[72:75], a[224:227], v[128:131]
buffer_load_dwordx4 a[56:59], v5, s[8:11], s25 offen offset:1024 sc1
v_mfma_f32_16x16x32_bf16 v[128:131], v[76:79], a[240:243], v[128:131]
v_fma_f32 v210, v210, v243, v243
v_mul_f32 v212, v94, v94
v_mfma_f32_16x16x32_bf16 v[132:135], v[72:75], a[228:231], v[132:135]
ds_read_b128 v[64:67], v2 offset:36864
v_mul_f32 v214, v95, v95
v_mfma_f32_16x16x32_bf16 v[132:135], v[76:79], a[244:247], v[132:135]
v_rcp_f32 v208, v208
v_mfma_f32_16x16x32_bf16 v[136:139], v[72:75], a[232:235], v[136:139]
buffer_load_dwordx4 a[60:63], v6, s[8:11], s25 offen offset:1024 sc1
v_mfma_f32_16x16x32_bf16 v[136:139], v[76:79], a[248:251], v[136:139]
ds_read_b128 v[68:71], v2 offset:37888
v_mul_f32 v209, v209, v208
v_mfma_f32_16x16x32_bf16 v[140:143], v[72:75], a[236:239], v[140:143]
v_rcp_f32 v210, v210
v_mfma_f32_16x16x32_bf16 v[140:143], v[76:79], a[252:255], v[140:143]
v_mul_f32 v211, v211, v210
s_waitcnt lgkmcnt(4)
v_mfma_f32_16x16x32_bf16 v[112:115], v[48:51], v[16:19], v[112:115]
buffer_load_dwordx4 a[64:67], v2, s[8:11], s26 offen offset:1024 sc1
v_mfma_f32_16x16x32_bf16 v[112:115], v[52:55], v[32:35], v[112:115]
v_cvt_pk_bf16_f32 v204, v209, v211
v_fma_f32 v212, v212, v242, v241
v_mfma_f32_16x16x32_bf16 v[116:119], v[48:51], v[20:23], v[116:119]
ds_read_b128 v[72:75], v2 offset:38912
v_fma_f32 v214, v214, v242, v241
v_mfma_f32_16x16x32_bf16 v[116:119], v[52:55], v[36:39], v[116:119]
v_mul_f32 v212, v212, v94
v_mul_f32 v214, v214, v95
v_mfma_f32_16x16x32_bf16 v[120:123], v[48:51], v[24:27], v[120:123]
buffer_load_dwordx4 a[68:71], v4, s[8:11], s26 offen offset:1024 sc1
v_mfma_f32_16x16x32_bf16 v[120:123], v[52:55], v[40:43], v[120:123]
ds_read_b128 v[76:79], v2 offset:39936
v_mul_f32 v213, v94, v110
v_mfma_f32_16x16x32_bf16 v[124:127], v[48:51], v[28:31], v[124:127]
v_exp_f32 v212, v212
v_mfma_f32_16x16x32_bf16 v[124:127], v[52:55], v[44:47], v[124:127]
v_mul_f32 v215, v95, v111
s_waitcnt lgkmcnt(4)
v_mfma_f32_16x16x32_bf16 v[128:131], v[56:59], v[16:19], v[128:131]
buffer_load_dwordx4 a[72:75], v5, s[8:11], s26 offen offset:1024 sc1
v_mfma_f32_16x16x32_bf16 v[128:131], v[60:63], v[32:35], v[128:131]
v_exp_f32 v214, v214
v_mfma_f32_16x16x32_bf16 v[132:135], v[56:59], v[20:23], v[132:135]
ds_read_b128 v[48:51], v2 offset:40960
v_fma_f32 v212, v212, v243, v243
v_mfma_f32_16x16x32_bf16 v[132:135], v[60:63], v[36:39], v[132:135]
v_fma_f32 v214, v214, v243, v243
v_mfma_f32_16x16x32_bf16 v[136:139], v[56:59], v[24:27], v[136:139]
buffer_load_dwordx4 a[76:79], v6, s[8:11], s26 offen offset:1024 sc1
v_mfma_f32_16x16x32_bf16 v[136:139], v[60:63], v[40:43], v[136:139]
ds_read_b128 v[52:55], v2 offset:41984
v_mfma_f32_16x16x32_bf16 v[140:143], v[56:59], v[28:31], v[140:143]
v_rcp_f32 v212, v212
v_mfma_f32_16x16x32_bf16 v[140:143], v[60:63], v[44:47], v[140:143]
v_mul_f32 v213, v213, v212
s_waitcnt lgkmcnt(4)
v_mfma_f32_16x16x32_bf16 a[112:115], v[64:67], v[144:147], 0
buffer_load_dwordx4 a[80:83], v2, s[8:11], s27 offen offset:1024 sc1
v_mfma_f32_16x16x32_bf16 a[112:115], v[68:71], v[160:163], a[112:115]
v_rcp_f32 v214, v214
v_mfma_f32_16x16x32_bf16 a[116:119], v[64:67], v[148:151], 0
ds_read_b128 v[56:59], v2 offset:43008
v_mul_f32 v215, v215, v214
v_mfma_f32_16x16x32_bf16 a[116:119], v[68:71], v[164:167], a[116:119]
v_cvt_pk_bf16_f32 v205, v213, v215
v_mfma_f32_16x16x32_bf16 a[120:123], v[64:67], v[152:155], 0
buffer_load_dwordx4 a[84:87], v4, s[8:11], s27 offen offset:1024 sc1
v_mfma_f32_16x16x32_bf16 a[120:123], v[68:71], v[168:171], a[120:123]
ds_read_b128 v[60:63], v2 offset:44032
v_mul_f32 v208, v112, v112
v_mfma_f32_16x16x32_bf16 a[124:127], v[64:67], v[156:159], 0
v_mul_f32 v210, v113, v113
v_fma_f32 v208, v208, v233, v232
v_mfma_f32_16x16x32_bf16 a[124:127], v[68:71], v[172:175], a[124:127]
v_fma_f32 v210, v210, v233, v232
s_waitcnt lgkmcnt(4)
v_mfma_f32_16x16x32_bf16 a[128:131], v[72:75], v[144:147], 0
buffer_load_dwordx4 a[88:91], v5, s[8:11], s27 offen offset:1024 sc1
v_mfma_f32_16x16x32_bf16 a[128:131], v[76:79], v[160:163], a[128:131]
v_mul_f32 v208, v208, v112
v_mul_f32 v210, v210, v113
v_mfma_f32_16x16x32_bf16 a[132:135], v[72:75], v[148:151], 0
ds_read_b128 v[64:67], v2 offset:45056
v_mul_f32 v209, v112, v128
v_mfma_f32_16x16x32_bf16 a[132:135], v[76:79], v[164:167], a[132:135]
v_exp_f32 v208, v208
v_mfma_f32_16x16x32_bf16 a[136:139], v[72:75], v[152:155], 0
buffer_load_dwordx4 a[92:95], v6, s[8:11], s27 offen offset:1024 sc1
v_mfma_f32_16x16x32_bf16 a[136:139], v[76:79], v[168:171], a[136:139]
ds_read_b128 v[68:71], v2 offset:46080
v_mul_f32 v211, v113, v129
v_mfma_f32_16x16x32_bf16 a[140:143], v[72:75], v[156:159], 0
v_exp_f32 v210, v210
v_mfma_f32_16x16x32_bf16 a[140:143], v[76:79], v[172:175], a[140:143]
v_fma_f32 v208, v208, v234, v234
s_waitcnt lgkmcnt(4)
v_mfma_f32_16x16x32_bf16 a[144:147], v[48:51], v[144:147], 0
v_fma_f32 v210, v210, v234, v234
v_mul_f32 v212, v114, v114
v_mfma_f32_16x16x32_bf16 a[144:147], v[52:55], v[160:163], a[144:147]
v_rcp_f32 v208, v208
v_mfma_f32_16x16x32_bf16 a[148:151], v[48:51], v[148:151], 0
ds_read_b128 v[72:75], v2 offset:47104
v_mul_f32 v209, v209, v208
v_mfma_f32_16x16x32_bf16 a[148:151], v[52:55], v[164:167], a[148:151]
v_rcp_f32 v210, v210
v_mfma_f32_16x16x32_bf16 a[152:155], v[48:51], v[152:155], 0
v_mul_f32 v211, v211, v210
v_cvt_pk_bf16_f32 v194, v209, v211
v_mfma_f32_16x16x32_bf16 a[152:155], v[52:55], v[168:171], a[152:155]
ds_read_b128 v[76:79], v2 offset:48128
v_mul_f32 v214, v115, v115
v_mfma_f32_16x16x32_bf16 a[156:159], v[48:51], v[156:159], 0
v_fma_f32 v212, v212, v233, v232
v_fma_f32 v214, v214, v233, v232
v_mfma_f32_16x16x32_bf16 a[156:159], v[52:55], v[172:175], a[156:159]
v_mul_f32 v212, v212, v114
s_waitcnt lgkmcnt(4)
v_mfma_f32_16x16x32_bf16 a[160:163], v[56:59], v[144:147], 0
s_waitcnt vmcnt(49)
buffer_load_dwordx2 a[96:97], v244, s[8:11], s28 offen offset:0 sc1
v_mfma_f32_16x16x32_bf16 a[160:163], v[60:63], v[160:163], a[160:163]
s_barrier
v_mfma_f32_16x16x32_bf16 a[164:167], v[56:59], v[148:151], 0
ds_read_b128 v[48:51], v2 offset:49152
v_mul_f32 v214, v214, v115
v_mfma_f32_16x16x32_bf16 a[164:167], v[60:63], v[164:167], a[164:167]
v_exp_f32 v212, v212
v_mfma_f32_16x16x32_bf16 a[168:171], v[56:59], v[152:155], 0
buffer_load_dwordx2 a[98:99], v244, s[8:11], s28 offen offset:512 sc1
v_mfma_f32_16x16x32_bf16 a[168:171], v[60:63], v[168:171], a[168:171]
ds_read_b128 v[52:55], v2 offset:50176
v_mul_f32 v213, v114, v130
v_mfma_f32_16x16x32_bf16 a[172:175], v[56:59], v[156:159], 0
v_exp_f32 v214, v214
v_mfma_f32_16x16x32_bf16 a[172:175], v[60:63], v[172:175], a[172:175]
v_mul_f32 v215, v115, v131
s_waitcnt lgkmcnt(4)
v_mfma_f32_16x16x32_bf16 a[176:179], v[64:67], v[144:147], 0
buffer_load_dwordx2 a[100:101], v245, s[8:11], s28 offen offset:0 sc1
v_mfma_f32_16x16x32_bf16 a[176:179], v[68:71], v[160:163], a[176:179]
v_fma_f32 v212, v212, v234, v234
v_fma_f32 v214, v214, v234, v234
v_mfma_f32_16x16x32_bf16 a[180:183], v[64:67], v[148:151], 0
ds_read_b128 v[56:59], v2 offset:51200
v_mul_f32 v208, v116, v116
v_mfma_f32_16x16x32_bf16 a[180:183], v[68:71], v[164:167], a[180:183]
v_rcp_f32 v212, v212
v_mfma_f32_16x16x32_bf16 a[184:187], v[64:67], v[152:155], 0
buffer_load_dwordx2 a[102:103], v245, s[8:11], s28 offen offset:512 sc1
v_mfma_f32_16x16x32_bf16 a[184:187], v[68:71], v[168:171], a[184:187]
ds_read_b128 v[60:63], v2 offset:52224
v_mul_f32 v213, v213, v212
v_mfma_f32_16x16x32_bf16 a[188:191], v[64:67], v[156:159], 0
v_rcp_f32 v214, v214
v_mfma_f32_16x16x32_bf16 a[188:191], v[68:71], v[172:175], a[188:191]
v_mul_f32 v215, v215, v214
s_waitcnt lgkmcnt(4)
v_mfma_f32_16x16x32_bf16 a[192:195], v[72:75], v[144:147], 0
buffer_load_dwordx2 a[104:105], v246, s[8:11], s28 offen offset:0 sc1
v_mfma_f32_16x16x32_bf16 a[192:195], v[76:79], v[160:163], a[192:195]
v_cvt_pk_bf16_f32 v195, v213, v215
v_mul_f32 v210, v117, v117
v_mfma_f32_16x16x32_bf16 a[196:199], v[72:75], v[148:151], 0
ds_read_b128 v[64:67], v2 offset:53248
v_fma_f32 v208, v208, v236, v235
v_mfma_f32_16x16x32_bf16 a[196:199], v[76:79], v[164:167], a[196:199]
buffer_store_dwordx4 v[192:195], v2, s[8:11], s24 offen offset:3072 sc1
v_mfma_f32_16x16x32_bf16 a[200:203], v[72:75], v[152:155], 0
v_fma_f32 v210, v210, v236, v235
v_mul_f32 v208, v208, v116
v_mfma_f32_16x16x32_bf16 a[200:203], v[76:79], v[168:171], a[200:203]
ds_read_b128 v[68:71], v2 offset:54272
v_mul_f32 v210, v210, v117
v_mfma_f32_16x16x32_bf16 a[204:207], v[72:75], v[156:159], 0
v_exp_f32 v208, v208
v_mfma_f32_16x16x32_bf16 a[204:207], v[76:79], v[172:175], a[204:207]
v_mul_f32 v209, v116, v132
s_waitcnt lgkmcnt(4)
v_mfma_f32_16x16x32_bf16 a[208:211], v[48:51], v[144:147], 0
buffer_load_dwordx2 a[106:107], v246, s[8:11], s28 offen offset:512 sc1
v_mfma_f32_16x16x32_bf16 a[208:211], v[52:55], v[160:163], a[208:211]
v_exp_f32 v210, v210
v_mfma_f32_16x16x32_bf16 a[212:215], v[48:51], v[148:151], 0
ds_read_b128 v[72:75], v2 offset:55296
v_mul_f32 v211, v117, v133
v_mfma_f32_16x16x32_bf16 a[212:215], v[52:55], v[164:167], a[212:215]
v_fma_f32 v208, v208, v237, v237
v_fma_f32 v210, v210, v237, v237
v_mfma_f32_16x16x32_bf16 a[216:219], v[48:51], v[152:155], 0
buffer_load_dwordx2 a[108:109], v247, s[8:11], s28 offen offset:0 sc1
v_mfma_f32_16x16x32_bf16 a[216:219], v[52:55], v[168:171], a[216:219]
ds_read_b128 v[76:79], v2 offset:56320
v_mul_f32 v212, v118, v118
v_mfma_f32_16x16x32_bf16 a[220:223], v[48:51], v[156:159], 0
v_rcp_f32 v208, v208
v_mfma_f32_16x16x32_bf16 a[220:223], v[52:55], v[172:175], a[220:223]
v_mul_f32 v209, v209, v208
s_waitcnt lgkmcnt(4)
v_mfma_f32_16x16x32_bf16 a[224:227], v[56:59], v[144:147], 0
buffer_load_dwordx2 a[110:111], v247, s[8:11], s28 offen offset:512 sc1
v_mfma_f32_16x16x32_bf16 a[224:227], v[60:63], v[160:163], a[224:227]
s_add_u32 m0, s22, 0
v_add_u32 v3, 20480, v3
v_mfma_f32_16x16x32_bf16 a[228:231], v[56:59], v[148:151], 0
ds_read_b128 v[48:51], v2 offset:57344
v_mul_f32 v214, v119, v119
v_mfma_f32_16x16x32_bf16 a[228:231], v[60:63], v[164:167], a[228:231]
v_rcp_f32 v210, v210
v_mfma_f32_16x16x32_bf16 a[232:235], v[56:59], v[152:155], 0
buffer_load_dwordx4 v3, s[8:11], 0 offen offset:0 lds
v_mfma_f32_16x16x32_bf16 a[232:235], v[60:63], v[168:171], a[232:235]
ds_read_b128 v[52:55], v2 offset:58368
v_mul_f32 v211, v211, v210
v_mfma_f32_16x16x32_bf16 a[236:239], v[56:59], v[156:159], 0
v_cvt_pk_bf16_f32 v198, v209, v211
v_fma_f32 v212, v212, v236, v235
v_mfma_f32_16x16x32_bf16 a[236:239], v[60:63], v[172:175], a[236:239]
v_fma_f32 v214, v214, v236, v235
s_waitcnt lgkmcnt(4)
v_mfma_f32_16x16x32_bf16 a[240:243], v[64:67], v[144:147], 0
buffer_load_dwordx4 v3, s[8:11], 0 offen offset:1024 lds
v_mfma_f32_16x16x32_bf16 a[240:243], v[68:71], v[160:163], a[240:243]
v_mul_f32 v212, v212, v118
v_mul_f32 v214, v214, v119
v_mfma_f32_16x16x32_bf16 a[244:247], v[64:67], v[148:151], 0
ds_read_b128 v[56:59], v2 offset:59392
v_mul_f32 v213, v118, v134
v_mfma_f32_16x16x32_bf16 a[244:247], v[68:71], v[164:167], a[244:247]
v_exp_f32 v212, v212
v_mfma_f32_16x16x32_bf16 a[248:251], v[64:67], v[152:155], 0
buffer_load_dwordx4 v3, s[8:11], 0 offen offset:2048 lds
v_mfma_f32_16x16x32_bf16 a[248:251], v[68:71], v[168:171], a[248:251]
ds_read_b128 v[60:63], v2 offset:60416
v_mul_f32 v215, v119, v135
v_mfma_f32_16x16x32_bf16 a[252:255], v[64:67], v[156:159], 0
v_exp_f32 v214, v214
v_mfma_f32_16x16x32_bf16 a[252:255], v[68:71], v[172:175], a[252:255]
v_fma_f32 v212, v212, v237, v237
s_waitcnt vmcnt(39)
s_waitcnt lgkmcnt(4)
v_mfma_f32_16x16x32_bf16 a[112:115], v[72:75], v[176:179], a[112:115]
buffer_load_dwordx4 v3, s[8:11], 0 offen offset:3072 lds
v_mfma_f32_16x16x32_bf16 a[112:115], v[76:79], a[0:3], a[112:115]
s_add_u32 m0, s22, 4096
v_add_u32 v3, 4096, v3
v_mfma_f32_16x16x32_bf16 a[116:119], v[72:75], v[180:183], a[116:119]
ds_read_b128 v[64:67], v2 offset:61440
v_fma_f32 v214, v214, v237, v237
v_mfma_f32_16x16x32_bf16 a[116:119], v[76:79], a[4:7], a[116:119]
v_rcp_f32 v212, v212
v_mfma_f32_16x16x32_bf16 a[120:123], v[72:75], v[184:187], a[120:123]
buffer_load_dwordx4 v3, s[8:11], 0 offen offset:0 lds
v_mfma_f32_16x16x32_bf16 a[120:123], v[76:79], a[8:11], a[120:123]
ds_read_b128 v[68:71], v2 offset:62464
v_mul_f32 v213, v213, v212
v_mfma_f32_16x16x32_bf16 a[124:127], v[72:75], v[188:191], a[124:127]
v_rcp_f32 v214, v214
v_mfma_f32_16x16x32_bf16 a[124:127], v[76:79], a[12:15], a[124:127]
v_mul_f32 v215, v215, v214
s_waitcnt lgkmcnt(4)
v_mfma_f32_16x16x32_bf16 a[128:131], v[48:51], v[176:179], a[128:131]
buffer_load_dwordx4 v3, s[8:11], 0 offen offset:1024 lds
v_mfma_f32_16x16x32_bf16 a[128:131], v[52:55], a[0:3], a[128:131]
v_cvt_pk_bf16_f32 v199, v213, v215
v_mul_f32 v208, v120, v120
v_mfma_f32_16x16x32_bf16 a[132:135], v[48:51], v[180:183], a[132:135]
ds_read_b128 v[72:75], v2 offset:63488
v_mul_f32 v210, v121, v121
v_mfma_f32_16x16x32_bf16 a[132:135], v[52:55], a[4:7], a[132:135]
buffer_store_dwordx4 v[196:199], v4, s[8:11], s24 offen offset:3072 sc1
v_mfma_f32_16x16x32_bf16 a[136:139], v[48:51], v[184:187], a[136:139]
v_fma_f32 v208, v208, v239, v238
v_fma_f32 v210, v210, v239, v238
v_mfma_f32_16x16x32_bf16 a[136:139], v[52:55], a[8:11], a[136:139]
ds_read_b128 v[76:79], v2 offset:64512
v_mul_f32 v208, v208, v120
v_mfma_f32_16x16x32_bf16 a[140:143], v[48:51], v[188:191], a[140:143]
v_mul_f32 v210, v210, v121
v_mul_f32 v209, v120, v136
v_mfma_f32_16x16x32_bf16 a[140:143], v[52:55], a[12:15], a[140:143]
v_mul_f32 v211, v121, v137
s_waitcnt lgkmcnt(4)
v_mfma_f32_16x16x32_bf16 a[144:147], v[56:59], v[176:179], a[144:147]
buffer_load_dword v13, v11, s[8:11], s34 offen sc1
v_mfma_f32_16x16x32_bf16 a[144:147], v[60:63], a[0:3], a[144:147]
v_exp_f32 v208, v208
v_mfma_f32_16x16x32_bf16 a[148:151], v[56:59], v[180:183], a[148:151]
ds_read_b128 v[48:51], v7 offset:0
v_fma_f32 v208, v208, v240, v240
v_mfma_f32_16x16x32_bf16 a[148:151], v[60:63], a[4:7], a[148:151]
v_exp_f32 v210, v210
v_mfma_f32_16x16x32_bf16 a[152:155], v[56:59], v[184:187], a[152:155]
buffer_load_dwordx2 v[16:17], v244, s[8:11], s29 offen offset:0 sc1
v_mfma_f32_16x16x32_bf16 a[152:155], v[60:63], a[8:11], a[152:155]
ds_read_b128 v[52:55], v7 offset:1024
v_fma_f32 v210, v210, v240, v240
v_mfma_f32_16x16x32_bf16 a[156:159], v[56:59], v[188:191], a[156:159]
v_rcp_f32 v208, v208
v_mfma_f32_16x16x32_bf16 a[156:159], v[60:63], a[12:15], a[156:159]
v_mul_f32 v209, v209, v208
s_waitcnt lgkmcnt(4)
v_mfma_f32_16x16x32_bf16 a[160:163], v[64:67], v[176:179], a[160:163]
buffer_load_dwordx2 v[18:19], v244, s[8:11], s29 offen offset:512 sc1
v_mfma_f32_16x16x32_bf16 a[160:163], v[68:71], a[0:3], a[160:163]
v_rcp_f32 v210, v210
v_mfma_f32_16x16x32_bf16 a[164:167], v[64:67], v[180:183], a[164:167]
ds_read_b128 v[56:59], v7 offset:2048
v_mul_f32 v211, v211, v210
v_mfma_f32_16x16x32_bf16 a[164:167], v[68:71], a[4:7], a[164:167]
v_cvt_pk_bf16_f32 v202, v209, v211
v_mul_f32 v212, v122, v122
v_mfma_f32_16x16x32_bf16 a[168:171], v[64:67], v[184:187], a[168:171]
buffer_load_dwordx2 v[20:21], v245, s[8:11], s29 offen offset:0 sc1
v_mfma_f32_16x16x32_bf16 a[168:171], v[68:71], a[8:11], a[168:171]
ds_read_b128 v[60:63], v7 offset:3072
v_mul_f32 v214, v123, v123
v_mfma_f32_16x16x32_bf16 a[172:175], v[64:67], v[188:191], a[172:175]
v_fma_f32 v212, v212, v239, v238
v_fma_f32 v214, v214, v239, v238
v_mfma_f32_16x16x32_bf16 a[172:175], v[68:71], a[12:15], a[172:175]
v_mul_f32 v212, v212, v122
s_waitcnt lgkmcnt(4)
v_mfma_f32_16x16x32_bf16 a[176:179], v[72:75], v[176:179], a[176:179]
buffer_load_dwordx2 v[22:23], v245, s[8:11], s29 offen offset:512 sc1
v_mfma_f32_16x16x32_bf16 a[176:179], v[76:79], a[0:3], a[176:179]
v_mul_f32 v214, v214, v123
v_mul_f32 v213, v122, v138
v_mfma_f32_16x16x32_bf16 a[180:183], v[72:75], v[180:183], a[180:183]
ds_read_b128 v[64:67], v7 offset:4096
v_mul_f32 v215, v123, v139
v_mfma_f32_16x16x32_bf16 a[180:183], v[76:79], a[4:7], a[180:183]
v_exp_f32 v212, v212
v_mfma_f32_16x16x32_bf16 a[184:187], v[72:75], v[184:187], a[184:187]
buffer_load_dwordx2 v[24:25], v246, s[8:11], s29 offen offset:0 sc1
v_mfma_f32_16x16x32_bf16 a[184:187], v[76:79], a[8:11], a[184:187]
ds_read_b128 v[68:71], v7 offset:5120
v_fma_f32 v212, v212, v240, v240
v_mfma_f32_16x16x32_bf16 a[188:191], v[72:75], v[188:191], a[188:191]
v_exp_f32 v214, v214
v_mfma_f32_16x16x32_bf16 a[188:191], v[76:79], a[12:15], a[188:191]
v_fma_f32 v214, v214, v240, v240
s_waitcnt lgkmcnt(4)
v_mfma_f32_16x16x32_bf16 a[192:195], v[48:51], v[176:179], a[192:195]
buffer_load_dwordx2 v[26:27], v246, s[8:11], s29 offen offset:512 sc1
v_mfma_f32_16x16x32_bf16 a[192:195], v[52:55], a[0:3], a[192:195]
v_rcp_f32 v212, v212
v_mfma_f32_16x16x32_bf16 a[196:199], v[48:51], v[180:183], a[196:199]
ds_read_b128 v[72:75], v7 offset:6144
v_mul_f32 v213, v213, v212
v_mfma_f32_16x16x32_bf16 a[196:199], v[52:55], a[4:7], a[196:199]
v_rcp_f32 v214, v214
v_mfma_f32_16x16x32_bf16 a[200:203], v[48:51], v[184:187], a[200:203]
buffer_load_dwordx2 v[28:29], v247, s[8:11], s29 offen offset:0 sc1
v_mfma_f32_16x16x32_bf16 a[200:203], v[52:55], a[8:11], a[200:203]
ds_read_b128 v[76:79], v7 offset:7168
v_mul_f32 v215, v215, v214
v_mfma_f32_16x16x32_bf16 a[204:207], v[48:51], v[188:191], a[204:207]
v_cvt_pk_bf16_f32 v203, v213, v215
v_mul_f32 v208, v124, v124
v_mfma_f32_16x16x32_bf16 a[204:207], v[52:55], a[12:15], a[204:207]
v_mul_f32 v210, v125, v125
s_waitcnt lgkmcnt(4)
v_mfma_f32_16x16x32_bf16 a[208:211], v[56:59], v[176:179], a[208:211]
s_waitcnt vmcnt(63)
v_fma_f32 v208, v208, v242, v241
v_mfma_f32_16x16x32_bf16 a[208:211], v[60:63], a[0:3], a[208:211]
s_barrier
v_mfma_f32_16x16x32_bf16 a[212:215], v[56:59], v[180:183], a[212:215]
ds_read_b128 v[48:51], v7 offset:8192
v_fma_f32 v210, v210, v242, v241
v_mfma_f32_16x16x32_bf16 a[212:215], v[60:63], a[4:7], a[212:215]
buffer_load_dwordx2 v[30:31], v247, s[8:11], s29 offen offset:512 sc1
v_mfma_f32_16x16x32_bf16 a[216:219], v[56:59], v[184:187], a[216:219]
s_add_u32 m0, s22, 24576
v_add_u32 v3, 20480, v3
v_mfma_f32_16x16x32_bf16 a[216:219], v[60:63], a[8:11], a[216:219]
ds_read_b128 v[52:55], v7 offset:9216
v_mul_f32 v208, v208, v124
v_mfma_f32_16x16x32_bf16 a[220:223], v[56:59], v[188:191], a[220:223]
buffer_store_dwordx4 v[200:203], v5, s[8:11], s24 offen offset:3072 sc1
v_mfma_f32_16x16x32_bf16 a[220:223], v[60:63], a[12:15], a[220:223]
v_mul_f32 v210, v210, v125
s_waitcnt lgkmcnt(4)
v_mfma_f32_16x16x32_bf16 a[224:227], v[64:67], v[176:179], a[224:227]
v_exp_f32 v208, v208
v_mfma_f32_16x16x32_bf16 a[224:227], v[68:71], a[0:3], a[224:227]
v_exp_f32 v210, v210
v_mfma_f32_16x16x32_bf16 a[228:231], v[64:67], v[180:183], a[228:231]
ds_read_b128 v[56:59], v7 offset:10240
v_mul_f32 v209, v124, v140
v_mfma_f32_16x16x32_bf16 a[228:231], v[68:71], a[4:7], a[228:231]
buffer_load_dwordx4 v3, s[8:11], 0 offen offset:0 lds
v_mfma_f32_16x16x32_bf16 a[232:235], v[64:67], v[184:187], a[232:235]
v_mul_f32 v211, v125, v141
v_fma_f32 v208, v208, v243, v243
v_mfma_f32_16x16x32_bf16 a[232:235], v[68:71], a[8:11], a[232:235]
ds_read_b128 v[60:63], v7 offset:11264
v_fma_f32 v210, v210, v243, v243
v_mfma_f32_16x16x32_bf16 a[236:239], v[64:67], v[188:191], a[236:239]
v_rcp_f32 v208, v208
v_mfma_f32_16x16x32_bf16 a[236:239], v[68:71], a[12:15], a[236:239]
v_mul_f32 v209, v209, v208
s_waitcnt lgkmcnt(4)
v_mfma_f32_16x16x32_bf16 a[240:243], v[72:75], v[176:179], a[240:243]
buffer_load_dwordx4 v3, s[8:11], 0 offen offset:1024 lds
v_rcp_f32 v210, v210
v_mfma_f32_16x16x32_bf16 a[240:243], v[76:79], a[0:3], a[240:243]
v_mul_f32 v211, v211, v210
v_cvt_pk_bf16_f32 v206, v209, v211
v_mfma_f32_16x16x32_bf16 a[244:247], v[72:75], v[180:183], a[244:247]
ds_read_b128 v[64:67], v7 offset:12288
v_mul_f32 v212, v126, v126
v_mfma_f32_16x16x32_bf16 a[244:247], v[76:79], a[4:7], a[244:247]
v_mul_f32 v214, v127, v127
v_fma_f32 v212, v212, v242, v241
v_mfma_f32_16x16x32_bf16 a[248:251], v[72:75], v[184:187], a[248:251]
buffer_load_dwordx4 v3, s[8:11], 0 offen offset:2048 lds
v_fma_f32 v214, v214, v242, v241
v_mfma_f32_16x16x32_bf16 a[248:251], v[76:79], a[8:11], a[248:251]
ds_read_b128 v[68:71], v7 offset:13312
v_mul_f32 v212, v212, v126
v_mfma_f32_16x16x32_bf16 a[252:255], v[72:75], v[188:191], a[252:255]
v_mul_f32 v214, v214, v127
v_exp_f32 v212, v212
v_mfma_f32_16x16x32_bf16 a[252:255], v[76:79], a[12:15], a[252:255]
v_exp_f32 v214, v214
s_waitcnt vmcnt(47)
s_waitcnt lgkmcnt(4)
v_mfma_f32_16x16x32_bf16 a[112:115], v[48:51], a[16:19], a[112:115]
buffer_load_dwordx4 v3, s[8:11], 0 offen offset:3072 lds
v_mul_f32 v213, v126, v142
v_mfma_f32_16x16x32_bf16 a[112:115], v[52:55], a[32:35], a[112:115]
s_add_u32 m0, s22, 28672
v_add_u32 v3, 4096, v3
v_mul_f32 v215, v127, v143
v_mfma_f32_16x16x32_bf16 a[116:119], v[48:51], a[20:23], a[116:119]
ds_read_b128 v[72:75], v7 offset:14336
v_fma_f32 v212, v212, v243, v243
v_mfma_f32_16x16x32_bf16 a[116:119], v[52:55], a[36:39], a[116:119]
v_fma_f32 v214, v214, v243, v243
v_rcp_f32 v212, v212
v_mfma_f32_16x16x32_bf16 a[120:123], v[48:51], a[24:27], a[120:123]
buffer_load_dwordx4 v3, s[8:11], 0 offen offset:0 lds
v_rcp_f32 v214, v214
v_mfma_f32_16x16x32_bf16 a[120:123], v[52:55], a[40:43], a[120:123]
ds_read_b128 v[76:79], v7 offset:15360
v_mul_f32 v213, v213, v212
v_mfma_f32_16x16x32_bf16 a[124:127], v[48:51], a[28:31], a[124:127]
v_mul_f32 v215, v215, v214
v_cvt_pk_bf16_f32 v207, v213, v215
v_mfma_f32_16x16x32_bf16 a[124:127], v[52:55], a[44:47], a[124:127]
buffer_store_dwordx4 v[204:207], v6, s[8:11], s24 offen offset:3072 sc1
s_waitcnt lgkmcnt(4)
v_mfma_f32_16x16x32_bf16 a[128:131], v[56:59], a[16:19], a[128:131]
v_mfma_f32_16x16x32_bf16 a[128:131], v[60:63], a[32:35], a[128:131]
v_mfma_f32_16x16x32_bf16 a[132:135], v[56:59], a[20:23], a[132:135]
ds_read_b128 v[48:51], v7 offset:16384
v_mfma_f32_16x16x32_bf16 a[132:135], v[60:63], a[36:39], a[132:135]
buffer_load_dwordx4 v3, s[8:11], 0 offen offset:1024 lds
v_mfma_f32_16x16x32_bf16 a[136:139], v[56:59], a[24:27], a[136:139]
s_waitcnt vmcnt(16)
v_cmp_le_u32 vcc, 2, v13
s_nop 0
s_cmp_eq_u64 vcc, exec
s_cbranch_scc0 L_f_slow2
L_f_back2:
v_mfma_f32_16x16x32_bf16 a[136:139], v[60:63], a[40:43], a[136:139]
ds_read_b128 v[52:55], v7 offset:17408
v_mfma_f32_16x16x32_bf16 a[140:143], v[56:59], a[28:31], a[140:143]
v_mfma_f32_16x16x32_bf16 a[140:143], v[60:63], a[44:47], a[140:143]
s_waitcnt lgkmcnt(4)
v_mfma_f32_16x16x32_bf16 a[144:147], v[64:67], a[16:19], a[144:147]
buffer_load_dwordx4 v[32:35], v2, s[8:11], s25 offen offset:2048 sc1
v_mfma_f32_16x16x32_bf16 a[144:147], v[68:71], a[32:35], a[144:147]
v_mfma_f32_16x16x32_bf16 a[148:151], v[64:67], a[20:23], a[148:151]
ds_read_b128 v[56:59], v7 offset:18432
v_mfma_f32_16x16x32_bf16 a[148:151], v[68:71], a[36:39], a[148:151]
v_mfma_f32_16x16x32_bf16 a[152:155], v[64:67], a[24:27], a[152:155]
buffer_load_dwordx4 v[36:39], v4, s[8:11], s25 offen offset:2048 sc1
v_mfma_f32_16x16x32_bf16 a[152:155], v[68:71], a[40:43], a[152:155]
ds_read_b128 v[60:63], v7 offset:19456
v_mfma_f32_16x16x32_bf16 a[156:159], v[64:67], a[28:31], a[156:159]
v_mfma_f32_16x16x32_bf16 a[156:159], v[68:71], a[44:47], a[156:159]
s_waitcnt lgkmcnt(4)
v_mfma_f32_16x16x32_bf16 a[160:163], v[72:75], a[16:19], a[160:163]
buffer_load_dwordx4 v[40:43], v5, s[8:11], s25 offen offset:2048 sc1
v_mfma_f32_16x16x32_bf16 a[160:163], v[76:79], a[32:35], a[160:163]
v_mfma_f32_16x16x32_bf16 a[164:167], v[72:75], a[20:23], a[164:167]
ds_read_b128 v[64:67], v7 offset:20480
v_mfma_f32_16x16x32_bf16 a[164:167], v[76:79], a[36:39], a[164:167]
v_mfma_f32_16x16x32_bf16 a[168:171], v[72:75], a[24:27], a[168:171]
buffer_load_dwordx4 v[44:47], v6, s[8:11], s25 offen offset:2048 sc1
v_mfma_f32_16x16x32_bf16 a[168:171], v[76:79], a[40:43], a[168:171]
ds_read_b128 v[68:71], v7 offset:21504
v_mfma_f32_16x16x32_bf16 a[172:175], v[72:75], a[28:31], a[172:175]
v_mfma_f32_16x16x32_bf16 a[172:175], v[76:79], a[44:47], a[172:175]
s_waitcnt lgkmcnt(4)
v_mfma_f32_16x16x32_bf16 a[176:179], v[48:51], a[16:19], a[176:179]
buffer_load_dwordx4 v[80:83], v2, s[8:11], s26 offen offset:2048 sc1
v_mfma_f32_16x16x32_bf16 a[176:179], v[52:55], a[32:35], a[176:179]
v_mfma_f32_16x16x32_bf16 a[180:183], v[48:51], a[20:23], a[180:183]
ds_read_b128 v[72:75], v7 offset:22528
v_mfma_f32_16x16x32_bf16 a[180:183], v[52:55], a[36:39], a[180:183]
v_mfma_f32_16x16x32_bf16 a[184:187], v[48:51], a[24:27], a[184:187]
buffer_load_dwordx4 v[84:87], v4, s[8:11], s26 offen offset:2048 sc1
v_mfma_f32_16x16x32_bf16 a[184:187], v[52:55], a[40:43], a[184:187]
ds_read_b128 v[76:79], v7 offset:23552
v_mfma_f32_16x16x32_bf16 a[188:191], v[48:51], a[28:31], a[188:191]
v_mfma_f32_16x16x32_bf16 a[188:191], v[52:55], a[44:47], a[188:191]
s_waitcnt lgkmcnt(4)
v_mfma_f32_16x16x32_bf16 a[192:195], v[56:59], a[16:19], a[192:195]
buffer_load_dwordx4 v[88:91], v5, s[8:11], s26 offen offset:2048 sc1
v_mfma_f32_16x16x32_bf16 a[192:195], v[60:63], a[32:35], a[192:195]
v_mfma_f32_16x16x32_bf16 a[196:199], v[56:59], a[20:23], a[196:199]
ds_read_b128 v[48:51], v7 offset:24576
v_mfma_f32_16x16x32_bf16 a[196:199], v[60:63], a[36:39], a[196:199]
v_mfma_f32_16x16x32_bf16 a[200:203], v[56:59], a[24:27], a[200:203]
buffer_load_dwordx4 v[92:95], v6, s[8:11], s26 offen offset:2048 sc1
v_mfma_f32_16x16x32_bf16 a[200:203], v[60:63], a[40:43], a[200:203]
ds_read_b128 v[52:55], v7 offset:25600
v_mfma_f32_16x16x32_bf16 a[204:207], v[56:59], a[28:31], a[204:207]
v_mfma_f32_16x16x32_bf16 a[204:207], v[60:63], a[44:47], a[204:207]
s_waitcnt lgkmcnt(4)
v_mfma_f32_16x16x32_bf16 a[208:211], v[64:67], a[16:19], a[208:211]
buffer_load_dwordx4 v[96:99], v2, s[8:11], s27 offen offset:2048 sc1
v_mfma_f32_16x16x32_bf16 a[208:211], v[68:71], a[32:35], a[208:211]
v_mfma_f32_16x16x32_bf16 a[212:215], v[64:67], a[20:23], a[212:215]
ds_read_b128 v[56:59], v7 offset:26624
v_mfma_f32_16x16x32_bf16 a[212:215], v[68:71], a[36:39], a[212:215]
v_mfma_f32_16x16x32_bf16 a[216:219], v[64:67], a[24:27], a[216:219]
buffer_load_dwordx4 v[100:103], v4, s[8:11], s27 offen offset:2048 sc1
v_mfma_f32_16x16x32_bf16 a[216:219], v[68:71], a[40:43], a[216:219]
ds_read_b128 v[60:63], v7 offset:27648
v_mfma_f32_16x16x32_bf16 a[220:223], v[64:67], a[28:31], a[220:223]
v_mfma_f32_16x16x32_bf16 a[220:223], v[68:71], a[44:47], a[220:223]
s_waitcnt lgkmcnt(4)
v_mfma_f32_16x16x32_bf16 a[224:227], v[72:75], a[16:19], a[224:227]
buffer_load_dwordx4 v[104:107], v5, s[8:11], s27 offen offset:2048 sc1
v_mfma_f32_16x16x32_bf16 a[224:227], v[76:79], a[32:35], a[224:227]
v_mfma_f32_16x16x32_bf16 a[228:231], v[72:75], a[20:23], a[228:231]
ds_read_b128 v[64:67], v7 offset:28672
v_mfma_f32_16x16x32_bf16 a[228:231], v[76:79], a[36:39], a[228:231]
v_mfma_f32_16x16x32_bf16 a[232:235], v[72:75], a[24:27], a[232:235]
buffer_load_dwordx4 v[108:111], v6, s[8:11], s27 offen offset:2048 sc1
v_mfma_f32_16x16x32_bf16 a[232:235], v[76:79], a[40:43], a[232:235]
ds_read_b128 v[68:71], v7 offset:29696
v_mov_b32 v12, 3
v_mfma_f32_16x16x32_bf16 a[236:239], v[72:75], a[28:31], a[236:239]
s_waitcnt vmcnt(13)
v_mfma_f32_16x16x32_bf16 a[236:239], v[76:79], a[44:47], a[236:239]
s_waitcnt lgkmcnt(4)
v_mfma_f32_16x16x32_bf16 a[240:243], v[48:51], a[16:19], a[240:243]
buffer_store_dword v12, v10, s[8:11], s34 offen sc1
v_mfma_f32_16x16x32_bf16 a[240:243], v[52:55], a[32:35], a[240:243]
s_mul_i32 s48, s7, 2146435072
s_lshl_b32 s49, s6, 2
v_mfma_f32_16x16x32_bf16 a[244:247], v[48:51], a[20:23], a[244:247]
ds_read_b128 v[72:75], v7 offset:30720
s_add_u32 s49, s49, s4
v_mfma_f32_16x16x32_bf16 a[244:247], v[52:55], a[36:39], a[244:247]
s_mul_i32 s50, s49, 6144
s_add_u32 s50, s50, s48
v_mfma_f32_16x16x32_bf16 a[248:251], v[48:51], a[24:27], a[248:251]
s_add_u32 s50, s50, 6553600
s_mul_i32 s49, s49, 5120
v_mfma_f32_16x16x32_bf16 a[248:251], v[52:55], a[40:43], a[248:251]
ds_read_b128 v[76:79], v7 offset:31744
s_add_u32 s48, s48, s49
v_mfma_f32_16x16x32_bf16 a[252:255], v[48:51], a[28:31], a[252:255]
s_and_b32 s49, s5, 3
s_mul_i32 s49, s49, 589824
v_mfma_f32_16x16x32_bf16 a[252:255], v[52:55], a[44:47], a[252:255]
s_add_u32 s48, s48, s49
s_waitcnt vmcnt(50)
s_waitcnt lgkmcnt(4)
v_mfma_f32_16x16x32_bf16 a[112:115], v[56:59], a[48:51], a[112:115]
s_waitcnt vmcnt(63)
s_add_u32 s48, s48, 4194304
buffer_load_dwordx4 v[248:251], v2, s[8:11], s48 offen offset:0
v_mfma_f32_16x16x32_bf16 a[112:115], v[60:63], a[64:67], a[112:115]
s_barrier
v_mfma_f32_16x16x32_bf16 a[116:119], v[56:59], a[52:55], a[116:119]
ds_read_b128 v[48:51], v7 offset:32768
v_mfma_f32_16x16x32_bf16 a[116:119], v[60:63], a[68:71], a[116:119]
v_mfma_f32_16x16x32_bf16 a[120:123], v[56:59], a[56:59], a[120:123]
buffer_load_dwordx4 v[248:251], v2, s[8:11], s48 offen offset:1024
v_mfma_f32_16x16x32_bf16 a[120:123], v[60:63], a[72:75], a[120:123]
ds_read_b128 v[52:55], v7 offset:33792
v_mfma_f32_16x16x32_bf16 a[124:127], v[56:59], a[60:63], a[124:127]
v_mfma_f32_16x16x32_bf16 a[124:127], v[60:63], a[76:79], a[124:127]
s_waitcnt lgkmcnt(4)
v_mfma_f32_16x16x32_bf16 a[128:131], v[64:67], a[48:51], a[128:131]
buffer_load_dwordx4 v[248:251], v2, s[8:11], s48 offen offset:2048
v_mfma_f32_16x16x32_bf16 a[128:131], v[68:71], a[64:67], a[128:131]
v_mfma_f32_16x16x32_bf16 a[132:135], v[64:67], a[52:55], a[132:135]
ds_read_b128 v[56:59], v7 offset:34816
v_mfma_f32_16x16x32_bf16 a[132:135], v[68:71], a[68:71], a[132:135]
v_mfma_f32_16x16x32_bf16 a[136:139], v[64:67], a[56:59], a[136:139]
buffer_load_dwordx4 v[248:251], v2, s[8:11], s48 offen offset:3072
v_mfma_f32_16x16x32_bf16 a[136:139], v[68:71], a[72:75], a[136:139]
ds_read_b128 v[60:63], v7 offset:35840
s_add_u32 s48, s48, 4096
v_mfma_f32_16x16x32_bf16 a[140:143], v[64:67], a[60:63], a[140:143]
v_mfma_f32_16x16x32_bf16 a[140:143], v[68:71], a[76:79], a[140:143]
s_waitcnt lgkmcnt(4)
v_mfma_f32_16x16x32_bf16 a[144:147], v[72:75], a[48:51], a[144:147]
buffer_load_dwordx4 v[248:251], v2, s[8:11], s48 offen offset:0
v_mfma_f32_16x16x32_bf16 a[144:147], v[76:79], a[64:67], a[144:147]
v_mfma_f32_16x16x32_bf16 a[148:151], v[72:75], a[52:55], a[148:151]
ds_read_b128 v[64:67], v7 offset:36864
v_mfma_f32_16x16x32_bf16 a[148:151], v[76:79], a[68:71], a[148:151]
v_mfma_f32_16x16x32_bf16 a[152:155], v[72:75], a[56:59], a[152:155]
buffer_load_dwordx4 v[248:251], v2, s[8:11], s50 offen offset:0
v_mfma_f32_16x16x32_bf16 a[152:155], v[76:79], a[72:75], a[152:155]
ds_read_b128 v[68:71], v7 offset:37888
v_mfma_f32_16x16x32_bf16 a[156:159], v[72:75], a[60:63], a[156:159]
v_mfma_f32_16x16x32_bf16 a[156:159], v[76:79], a[76:79], a[156:159]
s_waitcnt lgkmcnt(4)
v_mfma_f32_16x16x32_bf16 a[160:163], v[48:51], a[48:51], a[160:163]
buffer_load_dwordx4 v[248:251], v2, s[8:11], s50 offen offset:1024
v_mfma_f32_16x16x32_bf16 a[160:163], v[52:55], a[64:67], a[160:163]
v_mfma_f32_16x16x32_bf16 a[164:167], v[48:51], a[52:55], a[164:167]
ds_read_b128 v[72:75], v7 offset:38912
v_mfma_f32_16x16x32_bf16 a[164:167], v[52:55], a[68:71], a[164:167]
v_mfma_f32_16x16x32_bf16 a[168:171], v[48:51], a[56:59], a[168:171]
buffer_load_dwordx4 v[248:251], v2, s[8:11], s50 offen offset:2048
v_mfma_f32_16x16x32_bf16 a[168:171], v[52:55], a[72:75], a[168:171]
ds_read_b128 v[76:79], v7 offset:39936
v_mfma_f32_16x16x32_bf16 a[172:175], v[48:51], a[60:63], a[172:175]
v_mfma_f32_16x16x32_bf16 a[172:175], v[52:55], a[76:79], a[172:175]
s_waitcnt lgkmcnt(4)
v_mfma_f32_16x16x32_bf16 a[176:179], v[56:59], a[48:51], a[176:179]
buffer_load_dwordx4 v[248:251], v2, s[8:11], s50 offen offset:3072
v_mfma_f32_16x16x32_bf16 a[176:179], v[60:63], a[64:67], a[176:179]
s_add_u32 s50, s50, 4096
v_mfma_f32_16x16x32_bf16 a[180:183], v[56:59], a[52:55], a[180:183]
ds_read_b128 v[48:51], v7 offset:40960
v_mfma_f32_16x16x32_bf16 a[180:183], v[60:63], a[68:71], a[180:183]
v_mfma_f32_16x16x32_bf16 a[184:187], v[56:59], a[56:59], a[184:187]
buffer_load_dwordx4 v[248:251], v2, s[8:11], s50 offen offset:0
v_mfma_f32_16x16x32_bf16 a[184:187], v[60:63], a[72:75], a[184:187]
ds_read_b128 v[52:55], v7 offset:41984
v_mfma_f32_16x16x32_bf16 a[188:191], v[56:59], a[60:63], a[188:191]
v_mfma_f32_16x16x32_bf16 a[188:191], v[60:63], a[76:79], a[188:191]
s_waitcnt lgkmcnt(4)
v_mfma_f32_16x16x32_bf16 a[192:195], v[64:67], a[48:51], a[192:195]
buffer_load_dwordx4 v[248:251], v2, s[8:11], s50 offen offset:1024
v_mfma_f32_16x16x32_bf16 a[192:195], v[68:71], a[64:67], a[192:195]
s_add_u32 m0, s22, 49152
v_add_u32 v3, 20480, v3
v_mfma_f32_16x16x32_bf16 a[196:199], v[64:67], a[52:55], a[196:199]
ds_read_b128 v[56:59], v7 offset:43008
v_mfma_f32_16x16x32_bf16 a[196:199], v[68:71], a[68:71], a[196:199]
v_mfma_f32_16x16x32_bf16 a[200:203], v[64:67], a[56:59], a[200:203]
buffer_load_dwordx4 v3, s[8:11], 0 offen offset:0 lds
v_mfma_f32_16x16x32_bf16 a[200:203], v[68:71], a[72:75], a[200:203]
ds_read_b128 v[60:63], v7 offset:44032
v_mfma_f32_16x16x32_bf16 a[204:207], v[64:67], a[60:63], a[204:207]
v_mfma_f32_16x16x32_bf16 a[204:207], v[68:71], a[76:79], a[204:207]
s_waitcnt lgkmcnt(4)
v_mfma_f32_16x16x32_bf16 a[208:211], v[72:75], a[48:51], a[208:211]
buffer_load_dwordx4 v3, s[8:11], 0 offen offset:1024 lds
v_mfma_f32_16x16x32_bf16 a[208:211], v[76:79], a[64:67], a[208:211]
v_mfma_f32_16x16x32_bf16 a[212:215], v[72:75], a[52:55], a[212:215]
ds_read_b128 v[64:67], v7 offset:45056
v_mfma_f32_16x16x32_bf16 a[212:215], v[76:79], a[68:71], a[212:215]
v_mfma_f32_16x16x32_bf16 a[216:219], v[72:75], a[56:59], a[216:219]
buffer_load_dwordx4 v3, s[8:11], 0 offen offset:2048 lds
v_mfma_f32_16x16x32_bf16 a[216:219], v[76:79], a[72:75], a[216:219]
ds_read_b128 v[68:71], v7 offset:46080
v_mfma_f32_16x16x32_bf16 a[220:223], v[72:75], a[60:63], a[220:223]
v_mfma_f32_16x16x32_bf16 a[220:223], v[76:79], a[76:79], a[220:223]
s_waitcnt lgkmcnt(4)
v_mfma_f32_16x16x32_bf16 a[224:227], v[48:51], a[48:51], a[224:227]
buffer_load_dwordx4 v3, s[8:11], 0 offen offset:3072 lds
v_mfma_f32_16x16x32_bf16 a[224:227], v[52:55], a[64:67], a[224:227]
s_add_u32 m0, s22, 53248
v_add_u32 v3, 4096, v3
v_mfma_f32_16x16x32_bf16 a[228:231], v[48:51], a[52:55], a[228:231]
ds_read_b128 v[72:75], v7 offset:47104
v_mfma_f32_16x16x32_bf16 a[228:231], v[52:55], a[68:71], a[228:231]
v_mfma_f32_16x16x32_bf16 a[232:235], v[48:51], a[56:59], a[232:235]
buffer_load_dwordx4 v3, s[8:11], 0 offen offset:0 lds
v_mfma_f32_16x16x32_bf16 a[232:235], v[52:55], a[72:75], a[232:235]
ds_read_b128 v[76:79], v7 offset:48128
v_mfma_f32_16x16x32_bf16 a[236:239], v[48:51], a[60:63], a[236:239]
v_mfma_f32_16x16x32_bf16 a[236:239], v[52:55], a[76:79], a[236:239]
s_waitcnt lgkmcnt(4)
v_mfma_f32_16x16x32_bf16 a[240:243], v[56:59], a[48:51], a[240:243]
buffer_load_dwordx4 v3, s[8:11], 0 offen offset:1024 lds
v_mfma_f32_16x16x32_bf16 a[240:243], v[60:63], a[64:67], a[240:243]
v_mfma_f32_16x16x32_bf16 a[244:247], v[56:59], a[52:55], a[244:247]
ds_read_b128 v[48:51], v7 offset:49152
v_mfma_f32_16x16x32_bf16 a[244:247], v[60:63], a[68:71], a[244:247]
v_mfma_f32_16x16x32_bf16 a[248:251], v[56:59], a[56:59], a[248:251]
v_mfma_f32_16x16x32_bf16 a[248:251], v[60:63], a[72:75], a[248:251]
ds_read_b128 v[52:55], v7 offset:50176
v_mfma_f32_16x16x32_bf16 a[252:255], v[56:59], a[60:63], a[252:255]
v_mfma_f32_16x16x32_bf16 a[252:255], v[60:63], a[76:79], a[252:255]
s_waitcnt vmcnt(54)
s_waitcnt lgkmcnt(4)
v_mfma_f32_16x16x32_bf16 a[112:115], v[64:67], a[80:83], a[112:115]
buffer_load_dword v13, v11, s[8:11], s34 offen sc1
v_mfma_f32_16x16x32_bf16 a[112:115], v[68:71], a[96:99], a[112:115]
v_mfma_f32_16x16x32_bf16 a[116:119], v[64:67], a[84:87], a[116:119]
ds_read_b128 v[56:59], v7 offset:51200
v_mfma_f32_16x16x32_bf16 a[116:119], v[68:71], a[100:103], a[116:119]
v_mfma_f32_16x16x32_bf16 a[120:123], v[64:67], a[88:91], a[120:123]
v_mfma_f32_16x16x32_bf16 a[120:123], v[68:71], a[104:107], a[120:123]
ds_read_b128 v[60:63], v7 offset:52224
v_mfma_f32_16x16x32_bf16 a[124:127], v[64:67], a[92:95], a[124:127]
v_mfma_f32_16x16x32_bf16 a[124:127], v[68:71], a[108:111], a[124:127]
s_waitcnt lgkmcnt(4)
v_mfma_f32_16x16x32_bf16 a[128:131], v[72:75], a[80:83], a[128:131]
v_mfma_f32_16x16x32_bf16 a[128:131], v[76:79], a[96:99], a[128:131]
v_mfma_f32_16x16x32_bf16 a[132:135], v[72:75], a[84:87], a[132:135]
ds_read_b128 v[64:67], v7 offset:53248
v_mfma_f32_16x16x32_bf16 a[132:135], v[76:79], a[100:103], a[132:135]
v_mfma_f32_16x16x32_bf16 a[136:139], v[72:75], a[88:91], a[136:139]
v_mfma_f32_16x16x32_bf16 a[136:139], v[76:79], a[104:107], a[136:139]
ds_read_b128 v[68:71], v7 offset:54272
v_mfma_f32_16x16x32_bf16 a[140:143], v[72:75], a[92:95], a[140:143]
v_mfma_f32_16x16x32_bf16 a[140:143], v[76:79], a[108:111], a[140:143]
s_waitcnt lgkmcnt(4)
v_mfma_f32_16x16x32_bf16 a[144:147], v[48:51], a[80:83], a[144:147]
v_mfma_f32_16x16x32_bf16 a[144:147], v[52:55], a[96:99], a[144:147]
v_mfma_f32_16x16x32_bf16 a[148:151], v[48:51], a[84:87], a[148:151]
ds_read_b128 v[72:75], v7 offset:55296
v_mfma_f32_16x16x32_bf16 a[148:151], v[52:55], a[100:103], a[148:151]
v_mfma_f32_16x16x32_bf16 a[152:155], v[48:51], a[88:91], a[152:155]
v_mfma_f32_16x16x32_bf16 a[152:155], v[52:55], a[104:107], a[152:155]
ds_read_b128 v[76:79], v7 offset:56320
v_mfma_f32_16x16x32_bf16 a[156:159], v[48:51], a[92:95], a[156:159]
v_mfma_f32_16x16x32_bf16 a[156:159], v[52:55], a[108:111], a[156:159]
s_waitcnt lgkmcnt(4)
v_mfma_f32_16x16x32_bf16 a[160:163], v[56:59], a[80:83], a[160:163]
s_waitcnt vmcnt(63)
v_mfma_f32_16x16x32_bf16 a[160:163], v[60:63], a[96:99], a[160:163]
s_barrier
v_mfma_f32_16x16x32_bf16 a[164:167], v[56:59], a[84:87], a[164:167]
ds_read_b128 v[48:51], v7 offset:57344
v_mfma_f32_16x16x32_bf16 a[164:167], v[60:63], a[100:103], a[164:167]
v_mfma_f32_16x16x32_bf16 a[168:171], v[56:59], a[88:91], a[168:171]
v_mfma_f32_16x16x32_bf16 a[168:171], v[60:63], a[104:107], a[168:171]
ds_read_b128 v[52:55], v7 offset:58368
v_mfma_f32_16x16x32_bf16 a[172:175], v[56:59], a[92:95], a[172:175]
v_mfma_f32_16x16x32_bf16 a[172:175], v[60:63], a[108:111], a[172:175]
s_waitcnt lgkmcnt(4)
v_mfma_f32_16x16x32_bf16 a[176:179], v[64:67], a[80:83], a[176:179]
v_mfma_f32_16x16x32_bf16 a[176:179], v[68:71], a[96:99], a[176:179]
v_mfma_f32_16x16x32_bf16 a[180:183], v[64:67], a[84:87], a[180:183]
ds_read_b128 v[56:59], v7 offset:59392
v_mfma_f32_16x16x32_bf16 a[180:183], v[68:71], a[100:103], a[180:183]
v_mfma_f32_16x16x32_bf16 a[184:187], v[64:67], a[88:91], a[184:187]
v_mfma_f32_16x16x32_bf16 a[184:187], v[68:71], a[104:107], a[184:187]
ds_read_b128 v[60:63], v7 offset:60416
v_mfma_f32_16x16x32_bf16 a[188:191], v[64:67], a[92:95], a[188:191]
v_mfma_f32_16x16x32_bf16 a[188:191], v[68:71], a[108:111], a[188:191]
s_waitcnt lgkmcnt(4)
v_mfma_f32_16x16x32_bf16 a[192:195], v[72:75], a[80:83], a[192:195]
v_mfma_f32_16x16x32_bf16 a[192:195], v[76:79], a[96:99], a[192:195]
v_mfma_f32_16x16x32_bf16 a[196:199], v[72:75], a[84:87], a[196:199]
ds_read_b128 v[64:67], v7 offset:61440
v_mfma_f32_16x16x32_bf16 a[196:199], v[76:79], a[100:103], a[196:199]
v_mfma_f32_16x16x32_bf16 a[200:203], v[72:75], a[88:91], a[200:203]
v_mfma_f32_16x16x32_bf16 a[200:203], v[76:79], a[104:107], a[200:203]
ds_read_b128 v[68:71], v7 offset:62464
v_mfma_f32_16x16x32_bf16 a[204:207], v[72:75], a[92:95], a[204:207]
v_mfma_f32_16x16x32_bf16 a[204:207], v[76:79], a[108:111], a[204:207]
s_waitcnt lgkmcnt(4)
v_mfma_f32_16x16x32_bf16 a[208:211], v[48:51], a[80:83], a[208:211]
v_mfma_f32_16x16x32_bf16 a[208:211], v[52:55], a[96:99], a[208:211]
v_mfma_f32_16x16x32_bf16 a[212:215], v[48:51], a[84:87], a[212:215]
ds_read_b128 v[72:75], v7 offset:63488
v_mfma_f32_16x16x32_bf16 a[212:215], v[52:55], a[100:103], a[212:215]
v_mfma_f32_16x16x32_bf16 a[216:219], v[48:51], a[88:91], a[216:219]
v_mfma_f32_16x16x32_bf16 a[216:219], v[52:55], a[104:107], a[216:219]
ds_read_b128 v[76:79], v7 offset:64512
v_mfma_f32_16x16x32_bf16 a[220:223], v[48:51], a[92:95], a[220:223]
v_mfma_f32_16x16x32_bf16 a[220:223], v[52:55], a[108:111], a[220:223]
s_waitcnt lgkmcnt(4)
v_mfma_f32_16x16x32_bf16 a[224:227], v[56:59], a[80:83], a[224:227]
v_mfma_f32_16x16x32_bf16 a[224:227], v[60:63], a[96:99], a[224:227]
v_mfma_f32_16x16x32_bf16 a[228:231], v[56:59], a[84:87], a[228:231]
ds_read_b128 v[48:51], v8 offset:0
v_mfma_f32_16x16x32_bf16 a[228:231], v[60:63], a[100:103], a[228:231]
v_mfma_f32_16x16x32_bf16 a[232:235], v[56:59], a[88:91], a[232:235]
v_mfma_f32_16x16x32_bf16 a[232:235], v[60:63], a[104:107], a[232:235]
ds_read_b128 v[52:55], v8 offset:1024
v_mfma_f32_16x16x32_bf16 a[236:239], v[56:59], a[92:95], a[236:239]
v_mfma_f32_16x16x32_bf16 a[236:239], v[60:63], a[108:111], a[236:239]
s_waitcnt lgkmcnt(4)
v_mfma_f32_16x16x32_bf16 a[240:243], v[64:67], a[80:83], a[240:243]
v_mfma_f32_16x16x32_bf16 a[240:243], v[68:71], a[96:99], a[240:243]
v_mfma_f32_16x16x32_bf16 a[244:247], v[64:67], a[84:87], a[244:247]
ds_read_b128 v[56:59], v8 offset:2048
v_mfma_f32_16x16x32_bf16 a[244:247], v[68:71], a[100:103], a[244:247]
v_mfma_f32_16x16x32_bf16 a[248:251], v[64:67], a[88:91], a[248:251]
v_mfma_f32_16x16x32_bf16 a[248:251], v[68:71], a[104:107], a[248:251]
ds_read_b128 v[60:63], v8 offset:3072
v_mfma_f32_16x16x32_bf16 a[252:255], v[64:67], a[92:95], a[252:255]
v_mfma_f32_16x16x32_bf16 a[252:255], v[68:71], a[108:111], a[252:255]
s_waitcnt vmcnt(39)
s_waitcnt lgkmcnt(4)
v_mfma_f32_16x16x32_bf16 a[112:115], v[72:75], v[16:19], a[112:115]
v_mfma_f32_16x16x32_bf16 a[112:115], v[76:79], v[192:195], a[112:115]
v_mfma_f32_16x16x32_bf16 a[116:119], v[72:75], v[20:23], a[116:119]
ds_read_b128 v[64:67], v8 offset:4096
v_mfma_f32_16x16x32_bf16 a[116:119], v[76:79], v[196:199], a[116:119]
v_mfma_f32_16x16x32_bf16 a[120:123], v[72:75], v[24:27], a[120:123]
v_mfma_f32_16x16x32_bf16 a[120:123], v[76:79], v[200:203], a[120:123]
ds_read_b128 v[68:71], v8 offset:5120
v_mfma_f32_16x16x32_bf16 a[124:127], v[72:75], v[28:31], a[124:127]
v_mfma_f32_16x16x32_bf16 a[124:127], v[76:79], v[204:207], a[124:127]
s_waitcnt lgkmcnt(4)
v_mfma_f32_16x16x32_bf16 a[128:131], v[48:51], v[16:19], a[128:131]
s_waitcnt vmcnt(0)
v_cmp_le_u32 vcc, 3, v13
s_nop 0
s_cmp_eq_u64 vcc, exec
s_cbranch_scc0 L_f_slow3
L_f_back3:
buffer_load_dwordx4 v[112:115], v2, s[8:11], s25 offen offset:3072 sc1
v_mfma_f32_16x16x32_bf16 a[128:131], v[52:55], v[192:195], a[128:131]
v_mfma_f32_16x16x32_bf16 a[132:135], v[48:51], v[20:23], a[132:135]
ds_read_b128 v[72:75], v8 offset:6144
v_mfma_f32_16x16x32_bf16 a[132:135], v[52:55], v[196:199], a[132:135]
v_mfma_f32_16x16x32_bf16 a[136:139], v[48:51], v[24:27], a[136:139]
buffer_load_dwordx4 v[116:119], v4, s[8:11], s25 offen offset:3072 sc1
v_mfma_f32_16x16x32_bf16 a[136:139], v[52:55], v[200:203], a[136:139]
ds_read_b128 v[76:79], v8 offset:7168
v_mfma_f32_16x16x32_bf16 a[140:143], v[48:51], v[28:31], a[140:143]
v_mfma_f32_16x16x32_bf16 a[140:143], v[52:55], v[204:207], a[140:143]
s_waitcnt lgkmcnt(4)
v_mfma_f32_16x16x32_bf16 a[144:147], v[56:59], v[16:19], a[144:147]
buffer_load_dwordx4 v[120:123], v5, s[8:11], s25 offen offset:3072 sc1
v_mfma_f32_16x16x32_bf16 a[144:147], v[60:63], v[192:195], a[144:147]
v_mfma_f32_16x16x32_bf16 a[148:151], v[56:59], v[20:23], a[148:151]
ds_read_b128 v[48:51], v8 offset:8192
v_mfma_f32_16x16x32_bf16 a[148:151], v[60:63], v[196:199], a[148:151]
v_mfma_f32_16x16x32_bf16 a[152:155], v[56:59], v[24:27], a[152:155]
buffer_load_dwordx4 v[124:127], v6, s[8:11], s25 offen offset:3072 sc1
v_mfma_f32_16x16x32_bf16 a[152:155], v[60:63], v[200:203], a[152:155]
ds_read_b128 v[52:55], v8 offset:9216
v_mfma_f32_16x16x32_bf16 a[156:159], v[56:59], v[28:31], a[156:159]
v_mfma_f32_16x16x32_bf16 a[156:159], v[60:63], v[204:207], a[156:159]
s_waitcnt lgkmcnt(4)
v_mfma_f32_16x16x32_bf16 a[160:163], v[64:67], v[16:19], a[160:163]
buffer_load_dwordx4 v[128:131], v2, s[8:11], s26 offen offset:3072 sc1
v_mfma_f32_16x16x32_bf16 a[160:163], v[68:71], v[192:195], a[160:163]
v_mfma_f32_16x16x32_bf16 a[164:167], v[64:67], v[20:23], a[164:167]
ds_read_b128 v[56:59], v8 offset:10240
v_mfma_f32_16x16x32_bf16 a[164:167], v[68:71], v[196:199], a[164:167]
v_mfma_f32_16x16x32_bf16 a[168:171], v[64:67], v[24:27], a[168:171]
buffer_load_dwordx4 v[132:135], v4, s[8:11], s26 offen offset:3072 sc1
v_mfma_f32_16x16x32_bf16 a[168:171], v[68:71], v[200:203], a[168:171]
ds_read_b128 v[60:63], v8 offset:11264
v_mfma_f32_16x16x32_bf16 a[172:175], v[64:67], v[28:31], a[172:175]
v_mfma_f32_16x16x32_bf16 a[172:175], v[68:71], v[204:207], a[172:175]
s_waitcnt lgkmcnt(4)
v_mfma_f32_16x16x32_bf16 a[176:179], v[72:75], v[16:19], a[176:179]
buffer_load_dwordx4 v[136:139], v5, s[8:11], s26 offen offset:3072 sc1
v_mfma_f32_16x16x32_bf16 a[176:179], v[76:79], v[192:195], a[176:179]
v_mfma_f32_16x16x32_bf16 a[180:183], v[72:75], v[20:23], a[180:183]
ds_read_b128 v[64:67], v8 offset:12288
v_mfma_f32_16x16x32_bf16 a[180:183], v[76:79], v[196:199], a[180:183]
v_mfma_f32_16x16x32_bf16 a[184:187], v[72:75], v[24:27], a[184:187]
buffer_load_dwordx4 v[140:143], v6, s[8:11], s26 offen offset:3072 sc1
v_mfma_f32_16x16x32_bf16 a[184:187], v[76:79], v[200:203], a[184:187]
ds_read_b128 v[68:71], v8 offset:13312
v_mfma_f32_16x16x32_bf16 a[188:191], v[72:75], v[28:31], a[188:191]
v_mfma_f32_16x16x32_bf16 a[188:191], v[76:79], v[204:207], a[188:191]
s_waitcnt lgkmcnt(4)
v_mfma_f32_16x16x32_bf16 a[192:195], v[48:51], v[16:19], a[192:195]
buffer_load_dwordx4 v[144:147], v2, s[8:11], s27 offen offset:3072 sc1
v_mfma_f32_16x16x32_bf16 a[192:195], v[52:55], v[192:195], a[192:195]
v_mfma_f32_16x16x32_bf16 a[196:199], v[48:51], v[20:23], a[196:199]
ds_read_b128 v[72:75], v8 offset:14336
v_mfma_f32_16x16x32_bf16 a[196:199], v[52:55], v[196:199], a[196:199]
v_mfma_f32_16x16x32_bf16 a[200:203], v[48:51], v[24:27], a[200:203]
buffer_load_dwordx4 v[148:151], v4, s[8:11], s27 offen offset:3072 sc1
v_mfma_f32_16x16x32_bf16 a[200:203], v[52:55], v[200:203], a[200:203]
ds_read_b128 v[76:79], v8 offset:15360
v_mfma_f32_16x16x32_bf16 a[204:207], v[48:51], v[28:31], a[204:207]
v_mfma_f32_16x16x32_bf16 a[204:207], v[52:55], v[204:207], a[204:207]
s_waitcnt lgkmcnt(4)
v_mfma_f32_16x16x32_bf16 a[208:211], v[56:59], v[16:19], a[208:211]
s_waitcnt vmcnt(59)
v_mfma_f32_16x16x32_bf16 a[208:211], v[60:63], v[192:195], a[208:211]
s_barrier
v_mfma_f32_16x16x32_bf16 a[212:215], v[56:59], v[20:23], a[212:215]
ds_read_b128 v[48:51], v2 offset:0
v_mfma_f32_16x16x32_bf16 a[212:215], v[60:63], v[196:199], a[212:215]
buffer_load_dwordx4 v[152:155], v5, s[8:11], s27 offen offset:3072 sc1
v_mfma_f32_16x16x32_bf16 a[216:219], v[56:59], v[24:27], a[216:219]
v_mfma_f32_16x16x32_bf16 a[216:219], v[60:63], v[200:203], a[216:219]
ds_read_b128 v[52:55], v2 offset:1024
v_mfma_f32_16x16x32_bf16 a[220:223], v[56:59], v[28:31], a[220:223]
v_mfma_f32_16x16x32_bf16 a[220:223], v[60:63], v[204:207], a[220:223]
s_waitcnt lgkmcnt(4)
v_mfma_f32_16x16x32_bf16 a[224:227], v[64:67], v[16:19], a[224:227]
buffer_load_dwordx4 v[156:159], v6, s[8:11], s27 offen offset:3072 sc1
v_mfma_f32_16x16x32_bf16 a[224:227], v[68:71], v[192:195], a[224:227]
v_mfma_f32_16x16x32_bf16 a[228:231], v[64:67], v[20:23], a[228:231]
ds_read_b128 v[56:59], v2 offset:2048
v_mfma_f32_16x16x32_bf16 a[228:231], v[68:71], v[196:199], a[228:231]
v_mfma_f32_16x16x32_bf16 a[232:235], v[64:67], v[24:27], a[232:235]
v_mfma_f32_16x16x32_bf16 a[232:235], v[68:71], v[200:203], a[232:235]
ds_read_b128 v[60:63], v2 offset:3072
v_mfma_f32_16x16x32_bf16 a[236:239], v[64:67], v[28:31], a[236:239]
v_mfma_f32_16x16x32_bf16 a[236:239], v[68:71], v[204:207], a[236:239]
s_waitcnt lgkmcnt(4)
v_mfma_f32_16x16x32_bf16 a[240:243], v[72:75], v[16:19], a[240:243]
v_mfma_f32_16x16x32_bf16 a[240:243], v[76:79], v[192:195], a[240:243]
v_mfma_f32_16x16x32_bf16 a[244:247], v[72:75], v[20:23], a[244:247]
ds_read_b128 v[64:67], v2 offset:4096
v_mfma_f32_16x16x32_bf16 a[244:247], v[76:79], v[196:199], a[244:247]
v_mfma_f32_16x16x32_bf16 a[248:251], v[72:75], v[24:27], a[248:251]
v_mfma_f32_16x16x32_bf16 a[248:251], v[76:79], v[200:203], a[248:251]
ds_read_b128 v[68:71], v2 offset:5120
v_mfma_f32_16x16x32_bf16 a[252:255], v[72:75], v[28:31], a[252:255]
v_mfma_f32_16x16x32_bf16 a[252:255], v[76:79], v[204:207], a[252:255]
s_waitcnt vmcnt(35)
s_waitcnt lgkmcnt(4)
v_mfma_f32_16x16x32_bf16 a[112:115], v[48:51], v[32:35], a[112:115]
v_mfma_f32_16x16x32_bf16 a[112:115], v[52:55], v[80:83], a[112:115]
v_mfma_f32_16x16x32_bf16 a[116:119], v[48:51], v[36:39], a[116:119]
ds_read_b128 v[72:75], v2 offset:6144
v_mfma_f32_16x16x32_bf16 a[116:119], v[52:55], v[84:87], a[116:119]
v_mfma_f32_16x16x32_bf16 a[120:123], v[48:51], v[40:43], a[120:123]
v_mfma_f32_16x16x32_bf16 a[120:123], v[52:55], v[88:91], a[120:123]
ds_read_b128 v[76:79], v2 offset:7168
v_mfma_f32_16x16x32_bf16 a[124:127], v[48:51], v[44:47], a[124:127]
v_mfma_f32_16x16x32_bf16 a[124:127], v[52:55], v[92:95], a[124:127]
s_waitcnt lgkmcnt(4)
v_mfma_f32_16x16x32_bf16 a[128:131], v[56:59], v[32:35], a[128:131]
v_mfma_f32_16x16x32_bf16 a[128:131], v[60:63], v[80:83], a[128:131]
v_mfma_f32_16x16x32_bf16 a[132:135], v[56:59], v[36:39], a[132:135]
ds_read_b128 v[48:51], v2 offset:8192
v_mfma_f32_16x16x32_bf16 a[132:135], v[60:63], v[84:87], a[132:135]
v_mfma_f32_16x16x32_bf16 a[136:139], v[56:59], v[40:43], a[136:139]
v_mfma_f32_16x16x32_bf16 a[136:139], v[60:63], v[88:91], a[136:139]
ds_read_b128 v[52:55], v2 offset:9216
v_mfma_f32_16x16x32_bf16 a[140:143], v[56:59], v[44:47], a[140:143]
v_mfma_f32_16x16x32_bf16 a[140:143], v[60:63], v[92:95], a[140:143]
s_waitcnt lgkmcnt(4)
v_mfma_f32_16x16x32_bf16 a[144:147], v[64:67], v[32:35], a[144:147]
v_mfma_f32_16x16x32_bf16 a[144:147], v[68:71], v[80:83], a[144:147]
v_mfma_f32_16x16x32_bf16 a[148:151], v[64:67], v[36:39], a[148:151]
ds_read_b128 v[56:59], v2 offset:10240
v_mfma_f32_16x16x32_bf16 a[148:151], v[68:71], v[84:87], a[148:151]
v_mfma_f32_16x16x32_bf16 a[152:155], v[64:67], v[40:43], a[152:155]
v_mfma_f32_16x16x32_bf16 a[152:155], v[68:71], v[88:91], a[152:155]
ds_read_b128 v[60:63], v2 offset:11264
v_mfma_f32_16x16x32_bf16 a[156:159], v[64:67], v[44:47], a[156:159]
v_mfma_f32_16x16x32_bf16 a[156:159], v[68:71], v[92:95], a[156:159]
s_waitcnt lgkmcnt(4)
v_mfma_f32_16x16x32_bf16 a[160:163], v[72:75], v[32:35], a[160:163]
v_mfma_f32_16x16x32_bf16 a[160:163], v[76:79], v[80:83], a[160:163]
v_mfma_f32_16x16x32_bf16 a[164:167], v[72:75], v[36:39], a[164:167]
ds_read_b128 v[64:67], v2 offset:12288
v_mfma_f32_16x16x32_bf16 a[164:167], v[76:79], v[84:87], a[164:167]
v_mfma_f32_16x16x32_bf16 a[168:171], v[72:75], v[40:43], a[168:171]
v_mfma_f32_16x16x32_bf16 a[168:171], v[76:79], v[88:91], a[168:171]
ds_read_b128 v[68:71], v2 offset:13312
v_mfma_f32_16x16x32_bf16 a[172:175], v[72:75], v[44:47], a[172:175]
v_mfma_f32_16x16x32_bf16 a[172:175], v[76:79], v[92:95], a[172:175]
s_waitcnt lgkmcnt(4)
v_mfma_f32_16x16x32_bf16 a[176:179], v[48:51], v[32:35], a[176:179]
v_mfma_f32_16x16x32_bf16 a[176:179], v[52:55], v[80:83], a[176:179]
v_mfma_f32_16x16x32_bf16 a[180:183], v[48:51], v[36:39], a[180:183]
ds_read_b128 v[72:75], v2 offset:14336
v_mfma_f32_16x16x32_bf16 a[180:183], v[52:55], v[84:87], a[180:183]
v_mfma_f32_16x16x32_bf16 a[184:187], v[48:51], v[40:43], a[184:187]
v_mfma_f32_16x16x32_bf16 a[184:187], v[52:55], v[88:91], a[184:187]
ds_read_b128 v[76:79], v2 offset:15360
v_mfma_f32_16x16x32_bf16 a[188:191], v[48:51], v[44:47], a[188:191]
v_mfma_f32_16x16x32_bf16 a[188:191], v[52:55], v[92:95], a[188:191]
s_waitcnt lgkmcnt(4)
v_mfma_f32_16x16x32_bf16 a[192:195], v[56:59], v[32:35], a[192:195]
v_mfma_f32_16x16x32_bf16 a[192:195], v[60:63], v[80:83], a[192:195]
v_mfma_f32_16x16x32_bf16 a[196:199], v[56:59], v[36:39], a[196:199]
ds_read_b128 v[48:51], v2 offset:16384
v_mfma_f32_16x16x32_bf16 a[196:199], v[60:63], v[84:87], a[196:199]
v_mfma_f32_16x16x32_bf16 a[200:203], v[56:59], v[40:43], a[200:203]
v_mfma_f32_16x16x32_bf16 a[200:203], v[60:63], v[88:91], a[200:203]
ds_read_b128 v[52:55], v2 offset:17408
v_mfma_f32_16x16x32_bf16 a[204:207], v[56:59], v[44:47], a[204:207]
v_mfma_f32_16x16x32_bf16 a[204:207], v[60:63], v[92:95], a[204:207]
s_waitcnt lgkmcnt(4)
v_mfma_f32_16x16x32_bf16 a[208:211], v[64:67], v[32:35], a[208:211]
v_mfma_f32_16x16x32_bf16 a[208:211], v[68:71], v[80:83], a[208:211]
v_mfma_f32_16x16x32_bf16 a[212:215], v[64:67], v[36:39], a[212:215]
ds_read_b128 v[56:59], v2 offset:18432
v_mfma_f32_16x16x32_bf16 a[212:215], v[68:71], v[84:87], a[212:215]
v_mfma_f32_16x16x32_bf16 a[216:219], v[64:67], v[40:43], a[216:219]
v_mfma_f32_16x16x32_bf16 a[216:219], v[68:71], v[88:91], a[216:219]
ds_read_b128 v[60:63], v2 offset:19456
v_mfma_f32_16x16x32_bf16 a[220:223], v[64:67], v[44:47], a[220:223]
v_mfma_f32_16x16x32_bf16 a[220:223], v[68:71], v[92:95], a[220:223]
s_waitcnt lgkmcnt(4)
v_mfma_f32_16x16x32_bf16 a[224:227], v[72:75], v[32:35], a[224:227]
v_mfma_f32_16x16x32_bf16 a[224:227], v[76:79], v[80:83], a[224:227]
v_mfma_f32_16x16x32_bf16 a[228:231], v[72:75], v[36:39], a[228:231]
ds_read_b128 v[64:67], v2 offset:20480
v_mfma_f32_16x16x32_bf16 a[228:231], v[76:79], v[84:87], a[228:231]
v_mfma_f32_16x16x32_bf16 a[232:235], v[72:75], v[40:43], a[232:235]
v_mfma_f32_16x16x32_bf16 a[232:235], v[76:79], v[88:91], a[232:235]
ds_read_b128 v[68:71], v2 offset:21504
v_mfma_f32_16x16x32_bf16 a[236:239], v[72:75], v[44:47], a[236:239]
v_mfma_f32_16x16x32_bf16 a[236:239], v[76:79], v[92:95], a[236:239]
s_waitcnt lgkmcnt(4)
v_mfma_f32_16x16x32_bf16 a[240:243], v[48:51], v[32:35], a[240:243]
v_mfma_f32_16x16x32_bf16 a[240:243], v[52:55], v[80:83], a[240:243]
v_mfma_f32_16x16x32_bf16 a[244:247], v[48:51], v[36:39], a[244:247]
ds_read_b128 v[72:75], v2 offset:22528
v_mfma_f32_16x16x32_bf16 a[244:247], v[52:55], v[84:87], a[244:247]
v_mfma_f32_16x16x32_bf16 a[248:251], v[48:51], v[40:43], a[248:251]
v_mfma_f32_16x16x32_bf16 a[248:251], v[52:55], v[88:91], a[248:251]
ds_read_b128 v[76:79], v2 offset:23552
v_mfma_f32_16x16x32_bf16 a[252:255], v[48:51], v[44:47], a[252:255]
v_mfma_f32_16x16x32_bf16 a[252:255], v[52:55], v[92:95], a[252:255]
s_waitcnt vmcnt(8)
s_waitcnt lgkmcnt(4)
v_mfma_f32_16x16x32_bf16 a[112:115], v[56:59], v[96:99], a[112:115]
s_waitcnt vmcnt(43)
v_mfma_f32_16x16x32_bf16 a[112:115], v[60:63], v[112:115], a[112:115]
s_barrier
v_mfma_f32_16x16x32_bf16 a[116:119], v[56:59], v[100:103], a[116:119]
ds_read_b128 v[48:51], v2 offset:24576
v_mfma_f32_16x16x32_bf16 a[116:119], v[60:63], v[116:119], a[116:119]
v_mfma_f32_16x16x32_bf16 a[120:123], v[56:59], v[104:107], a[120:123]
v_mfma_f32_16x16x32_bf16 a[120:123], v[60:63], v[120:123], a[120:123]
ds_read_b128 v[52:55], v2 offset:25600
v_mfma_f32_16x16x32_bf16 a[124:127], v[56:59], v[108:111], a[124:127]
v_mfma_f32_16x16x32_bf16 a[124:127], v[60:63], v[124:127], a[124:127]
s_waitcnt vmcnt(0)
s_waitcnt lgkmcnt(4)
v_mfma_f32_16x16x32_bf16 a[112:115], v[64:67], v[128:131], a[112:115]
v_mfma_f32_16x16x32_bf16 a[112:115], v[68:71], v[144:147], a[112:115]
v_mfma_f32_16x16x32_bf16 a[116:119], v[64:67], v[132:135], a[116:119]
ds_read_b128 v[56:59], v2 offset:26624
v_mfma_f32_16x16x32_bf16 a[116:119], v[68:71], v[148:151], a[116:119]
v_mfma_f32_16x16x32_bf16 a[120:123], v[64:67], v[136:139], a[120:123]
v_mfma_f32_16x16x32_bf16 a[120:123], v[68:71], v[152:155], a[120:123]
ds_read_b128 v[60:63], v2 offset:27648
v_mfma_f32_16x16x32_bf16 a[124:127], v[64:67], v[140:143], a[124:127]
v_mfma_f32_16x16x32_bf16 a[124:127], v[68:71], v[156:159], a[124:127]
s_waitcnt lgkmcnt(4)
v_mfma_f32_16x16x32_bf16 a[128:131], v[72:75], v[96:99], a[128:131]
v_mfma_f32_16x16x32_bf16 a[128:131], v[76:79], v[112:115], a[128:131]
v_mfma_f32_16x16x32_bf16 a[132:135], v[72:75], v[100:103], a[132:135]
ds_read_b128 v[64:67], v2 offset:28672
v_mfma_f32_16x16x32_bf16 a[132:135], v[76:79], v[116:119], a[132:135]
v_mfma_f32_16x16x32_bf16 a[136:139], v[72:75], v[104:107], a[136:139]
v_mfma_f32_16x16x32_bf16 a[136:139], v[76:79], v[120:123], a[136:139]
ds_read_b128 v[68:71], v2 offset:29696
v_mfma_f32_16x16x32_bf16 a[140:143], v[72:75], v[108:111], a[140:143]
v_mfma_f32_16x16x32_bf16 a[140:143], v[76:79], v[124:127], a[140:143]
s_waitcnt lgkmcnt(4)
v_mfma_f32_16x16x32_bf16 a[128:131], v[48:51], v[128:131], a[128:131]
v_mfma_f32_16x16x32_bf16 a[128:131], v[52:55], v[144:147], a[128:131]
v_mfma_f32_16x16x32_bf16 a[132:135], v[48:51], v[132:135], a[132:135]
ds_read_b128 v[72:75], v2 offset:30720
v_mfma_f32_16x16x32_bf16 a[132:135], v[52:55], v[148:151], a[132:135]
v_mfma_f32_16x16x32_bf16 a[136:139], v[48:51], v[136:139], a[136:139]
v_mfma_f32_16x16x32_bf16 a[136:139], v[52:55], v[152:155], a[136:139]
ds_read_b128 v[76:79], v2 offset:31744
v_mfma_f32_16x16x32_bf16 a[140:143], v[48:51], v[140:143], a[140:143]
v_mfma_f32_16x16x32_bf16 a[140:143], v[52:55], v[156:159], a[140:143]
s_waitcnt lgkmcnt(4)
v_mfma_f32_16x16x32_bf16 a[144:147], v[56:59], v[96:99], a[144:147]
v_mfma_f32_16x16x32_bf16 a[144:147], v[60:63], v[112:115], a[144:147]
v_mfma_f32_16x16x32_bf16 a[148:151], v[56:59], v[100:103], a[148:151]
ds_read_b128 v[48:51], v2 offset:32768
v_mfma_f32_16x16x32_bf16 a[148:151], v[60:63], v[116:119], a[148:151]
v_accvgpr_read_b32 v208, a112
v_accvgpr_read_b32 v209, a113
v_mfma_f32_16x16x32_bf16 a[152:155], v[56:59], v[104:107], a[152:155]
v_accvgpr_read_b32 v210, a114
v_accvgpr_read_b32 v211, a115
v_mfma_f32_16x16x32_bf16 a[152:155], v[60:63], v[120:123], a[152:155]
ds_read_b128 v[52:55], v2 offset:33792
v_accvgpr_read_b32 v212, a128
v_mfma_f32_16x16x32_bf16 a[156:159], v[56:59], v[108:111], a[156:159]
v_accvgpr_read_b32 v213, a129
v_accvgpr_read_b32 v214, a130
v_mfma_f32_16x16x32_bf16 a[156:159], v[60:63], v[124:127], a[156:159]
v_accvgpr_read_b32 v215, a131
s_waitcnt lgkmcnt(4)
v_mfma_f32_16x16x32_bf16 a[144:147], v[64:67], v[128:131], a[144:147]
v_cvt_pk_bf16_f32 v224, v208, v209
v_cvt_pk_bf16_f32 v225, v210, v211
v_mfma_f32_16x16x32_bf16 a[144:147], v[68:71], v[144:147], a[144:147]
v_cvt_pk_bf16_f32 v226, v212, v213
v_cvt_pk_bf16_f32 v227, v214, v215
v_mfma_f32_16x16x32_bf16 a[148:151], v[64:67], v[132:135], a[148:151]
ds_read_b128 v[56:59], v2 offset:34816
buffer_store_dwordx4 v[224:227], v2, s[8:11], s31 offen offset:0 sc1
v_mfma_f32_16x16x32_bf16 a[148:151], v[68:71], v[148:151], a[148:151]
v_accvgpr_read_b32 v216, a116
v_accvgpr_read_b32 v217, a117
v_mfma_f32_16x16x32_bf16 a[152:155], v[64:67], v[136:139], a[152:155]
v_accvgpr_read_b32 v218, a118
v_accvgpr_read_b32 v219, a119
v_mfma_f32_16x16x32_bf16 a[152:155], v[68:71], v[152:155], a[152:155]
ds_read_b128 v[60:63], v2 offset:35840
v_accvgpr_read_b32 v220, a132
v_mfma_f32_16x16x32_bf16 a[156:159], v[64:67], v[140:143], a[156:159]
v_accvgpr_read_b32 v221, a133
v_accvgpr_read_b32 v222, a134
v_mfma_f32_16x16x32_bf16 a[156:159], v[68:71], v[156:159], a[156:159]
v_accvgpr_read_b32 v223, a135
s_waitcnt lgkmcnt(4)
v_mfma_f32_16x16x32_bf16 a[160:163], v[72:75], v[96:99], a[160:163]
v_cvt_pk_bf16_f32 v228, v216, v217
v_cvt_pk_bf16_f32 v229, v218, v219
v_mfma_f32_16x16x32_bf16 a[160:163], v[76:79], v[112:115], a[160:163]
v_cvt_pk_bf16_f32 v230, v220, v221
v_cvt_pk_bf16_f32 v231, v222, v223
v_mfma_f32_16x16x32_bf16 a[164:167], v[72:75], v[100:103], a[164:167]
ds_read_b128 v[64:67], v2 offset:36864
buffer_store_dwordx4 v[228:231], v4, s[8:11], s31 offen offset:0 sc1
v_mfma_f32_16x16x32_bf16 a[164:167], v[76:79], v[116:119], a[164:167]
v_accvgpr_read_b32 v208, a120
v_accvgpr_read_b32 v209, a121
v_mfma_f32_16x16x32_bf16 a[168:171], v[72:75], v[104:107], a[168:171]
v_accvgpr_read_b32 v210, a122
v_accvgpr_read_b32 v211, a123
v_mfma_f32_16x16x32_bf16 a[168:171], v[76:79], v[120:123], a[168:171]
ds_read_b128 v[68:71], v2 offset:37888
v_accvgpr_read_b32 v212, a136
v_mfma_f32_16x16x32_bf16 a[172:175], v[72:75], v[108:111], a[172:175]
v_accvgpr_read_b32 v213, a137
v_accvgpr_read_b32 v214, a138
v_mfma_f32_16x16x32_bf16 a[172:175], v[76:79], v[124:127], a[172:175]
v_accvgpr_read_b32 v215, a139
s_waitcnt lgkmcnt(4)
v_mfma_f32_16x16x32_bf16 a[160:163], v[48:51], v[128:131], a[160:163]
v_cvt_pk_bf16_f32 v224, v208, v209
v_cvt_pk_bf16_f32 v225, v210, v211
v_mfma_f32_16x16x32_bf16 a[160:163], v[52:55], v[144:147], a[160:163]
v_cvt_pk_bf16_f32 v226, v212, v213
v_cvt_pk_bf16_f32 v227, v214, v215
v_mfma_f32_16x16x32_bf16 a[164:167], v[48:51], v[132:135], a[164:167]
ds_read_b128 v[72:75], v2 offset:38912
buffer_store_dwordx4 v[224:227], v5, s[8:11], s31 offen offset:0 sc1
v_mfma_f32_16x16x32_bf16 a[164:167], v[52:55], v[148:151], a[164:167]
v_accvgpr_read_b32 v216, a124
v_accvgpr_read_b32 v217, a125
v_mfma_f32_16x16x32_bf16 a[168:171], v[48:51], v[136:139], a[168:171]
v_accvgpr_read_b32 v218, a126
v_accvgpr_read_b32 v219, a127
v_mfma_f32_16x16x32_bf16 a[168:171], v[52:55], v[152:155], a[168:171]
ds_read_b128 v[76:79], v2 offset:39936
v_accvgpr_read_b32 v220, a140
v_mfma_f32_16x16x32_bf16 a[172:175], v[48:51], v[140:143], a[172:175]
v_accvgpr_read_b32 v221, a141
v_accvgpr_read_b32 v222, a142
v_mfma_f32_16x16x32_bf16 a[172:175], v[52:55], v[156:159], a[172:175]
v_accvgpr_read_b32 v223, a143
v_cvt_pk_bf16_f32 v228, v216, v217
v_cvt_pk_bf16_f32 v229, v218, v219
v_cvt_pk_bf16_f32 v230, v220, v221
v_cvt_pk_bf16_f32 v231, v222, v223
buffer_store_dwordx4 v[228:231], v6, s[8:11], s31 offen offset:0 sc1
s_waitcnt lgkmcnt(4)
v_mfma_f32_16x16x32_bf16 a[176:179], v[56:59], v[96:99], a[176:179]
v_mfma_f32_16x16x32_bf16 a[176:179], v[60:63], v[112:115], a[176:179]
v_mfma_f32_16x16x32_bf16 a[180:183], v[56:59], v[100:103], a[180:183]
ds_read_b128 v[48:51], v2 offset:40960
v_mfma_f32_16x16x32_bf16 a[180:183], v[60:63], v[116:119], a[180:183]
v_accvgpr_read_b32 v208, a144
v_accvgpr_read_b32 v209, a145
v_mfma_f32_16x16x32_bf16 a[184:187], v[56:59], v[104:107], a[184:187]
v_accvgpr_read_b32 v210, a146
v_accvgpr_read_b32 v211, a147
v_mfma_f32_16x16x32_bf16 a[184:187], v[60:63], v[120:123], a[184:187]
ds_read_b128 v[52:55], v2 offset:41984
v_accvgpr_read_b32 v212, a160
v_mfma_f32_16x16x32_bf16 a[188:191], v[56:59], v[108:111], a[188:191]
v_accvgpr_read_b32 v213, a161
v_accvgpr_read_b32 v214, a162
v_mfma_f32_16x16x32_bf16 a[188:191], v[60:63], v[124:127], a[188:191]
v_accvgpr_read_b32 v215, a163
s_waitcnt lgkmcnt(4)
v_mfma_f32_16x16x32_bf16 a[176:179], v[64:67], v[128:131], a[176:179]
v_cvt_pk_bf16_f32 v224, v208, v209
v_cvt_pk_bf16_f32 v225, v210, v211
v_mfma_f32_16x16x32_bf16 a[176:179], v[68:71], v[144:147], a[176:179]
v_cvt_pk_bf16_f32 v226, v212, v213
v_cvt_pk_bf16_f32 v227, v214, v215
v_mfma_f32_16x16x32_bf16 a[180:183], v[64:67], v[132:135], a[180:183]
ds_read_b128 v[56:59], v2 offset:43008
buffer_store_dwordx4 v[224:227], v2, s[8:11], s31 offen offset:1024 sc1
v_mfma_f32_16x16x32_bf16 a[180:183], v[68:71], v[148:151], a[180:183]
v_accvgpr_read_b32 v216, a148
v_accvgpr_read_b32 v217, a149
v_mfma_f32_16x16x32_bf16 a[184:187], v[64:67], v[136:139], a[184:187]
v_accvgpr_read_b32 v218, a150
v_accvgpr_read_b32 v219, a151
v_mfma_f32_16x16x32_bf16 a[184:187], v[68:71], v[152:155], a[184:187]
ds_read_b128 v[60:63], v2 offset:44032
v_accvgpr_read_b32 v220, a164
v_mfma_f32_16x16x32_bf16 a[188:191], v[64:67], v[140:143], a[188:191]
v_accvgpr_read_b32 v221, a165
v_accvgpr_read_b32 v222, a166
v_mfma_f32_16x16x32_bf16 a[188:191], v[68:71], v[156:159], a[188:191]
v_accvgpr_read_b32 v223, a167
s_waitcnt lgkmcnt(4)
v_mfma_f32_16x16x32_bf16 a[192:195], v[72:75], v[96:99], a[192:195]
v_cvt_pk_bf16_f32 v228, v216, v217
v_cvt_pk_bf16_f32 v229, v218, v219
v_mfma_f32_16x16x32_bf16 a[192:195], v[76:79], v[112:115], a[192:195]
v_cvt_pk_bf16_f32 v230, v220, v221
v_cvt_pk_bf16_f32 v231, v222, v223
v_mfma_f32_16x16x32_bf16 a[196:199], v[72:75], v[100:103], a[196:199]
ds_read_b128 v[64:67], v2 offset:45056
buffer_store_dwordx4 v[228:231], v4, s[8:11], s31 offen offset:1024 sc1
v_mfma_f32_16x16x32_bf16 a[196:199], v[76:79], v[116:119], a[196:199]
v_accvgpr_read_b32 v208, a152
v_accvgpr_read_b32 v209, a153
v_mfma_f32_16x16x32_bf16 a[200:203], v[72:75], v[104:107], a[200:203]
v_accvgpr_read_b32 v210, a154
v_accvgpr_read_b32 v211, a155
v_mfma_f32_16x16x32_bf16 a[200:203], v[76:79], v[120:123], a[200:203]
ds_read_b128 v[68:71], v2 offset:46080
v_accvgpr_read_b32 v212, a168
v_mfma_f32_16x16x32_bf16 a[204:207], v[72:75], v[108:111], a[204:207]
v_accvgpr_read_b32 v213, a169
v_accvgpr_read_b32 v214, a170
v_mfma_f32_16x16x32_bf16 a[204:207], v[76:79], v[124:127], a[204:207]
v_accvgpr_read_b32 v215, a171
s_waitcnt lgkmcnt(4)
v_mfma_f32_16x16x32_bf16 a[192:195], v[48:51], v[128:131], a[192:195]
v_cvt_pk_bf16_f32 v224, v208, v209
v_cvt_pk_bf16_f32 v225, v210, v211
v_mfma_f32_16x16x32_bf16 a[192:195], v[52:55], v[144:147], a[192:195]
v_cvt_pk_bf16_f32 v226, v212, v213
v_cvt_pk_bf16_f32 v227, v214, v215
v_mfma_f32_16x16x32_bf16 a[196:199], v[48:51], v[132:135], a[196:199]
ds_read_b128 v[72:75], v2 offset:47104
buffer_store_dwordx4 v[224:227], v5, s[8:11], s31 offen offset:1024 sc1
v_mfma_f32_16x16x32_bf16 a[196:199], v[52:55], v[148:151], a[196:199]
v_accvgpr_read_b32 v216, a156
v_accvgpr_read_b32 v217, a157
v_mfma_f32_16x16x32_bf16 a[200:203], v[48:51], v[136:139], a[200:203]
v_accvgpr_read_b32 v218, a158
v_accvgpr_read_b32 v219, a159
v_mfma_f32_16x16x32_bf16 a[200:203], v[52:55], v[152:155], a[200:203]
ds_read_b128 v[76:79], v2 offset:48128
v_accvgpr_read_b32 v220, a172
v_mfma_f32_16x16x32_bf16 a[204:207], v[48:51], v[140:143], a[204:207]
v_accvgpr_read_b32 v221, a173
v_accvgpr_read_b32 v222, a174
v_mfma_f32_16x16x32_bf16 a[204:207], v[52:55], v[156:159], a[204:207]
v_accvgpr_read_b32 v223, a175
v_cvt_pk_bf16_f32 v228, v216, v217
v_cvt_pk_bf16_f32 v229, v218, v219
v_cvt_pk_bf16_f32 v230, v220, v221
v_cvt_pk_bf16_f32 v231, v222, v223
buffer_store_dwordx4 v[228:231], v6, s[8:11], s31 offen offset:1024 sc1
s_waitcnt lgkmcnt(4)
v_mfma_f32_16x16x32_bf16 a[208:211], v[56:59], v[96:99], a[208:211]
s_waitcnt vmcnt(21)
v_mfma_f32_16x16x32_bf16 a[208:211], v[60:63], v[112:115], a[208:211]
s_barrier
v_mfma_f32_16x16x32_bf16 a[212:215], v[56:59], v[100:103], a[212:215]
ds_read_b128 v[48:51], v2 offset:49152
v_mfma_f32_16x16x32_bf16 a[212:215], v[60:63], v[116:119], a[212:215]
v_accvgpr_read_b32 v208, a176
v_accvgpr_read_b32 v209, a177
v_mfma_f32_16x16x32_bf16 a[216:219], v[56:59], v[104:107], a[216:219]
v_accvgpr_read_b32 v210, a178
v_accvgpr_read_b32 v211, a179
v_mfma_f32_16x16x32_bf16 a[216:219], v[60:63], v[120:123], a[216:219]
ds_read_b128 v[52:55], v2 offset:50176
v_accvgpr_read_b32 v212, a192
v_mfma_f32_16x16x32_bf16 a[220:223], v[56:59], v[108:111], a[220:223]
v_accvgpr_read_b32 v213, a193
v_accvgpr_read_b32 v214, a194
v_mfma_f32_16x16x32_bf16 a[220:223], v[60:63], v[124:127], a[220:223]
v_accvgpr_read_b32 v215, a195
s_waitcnt lgkmcnt(4)
v_mfma_f32_16x16x32_bf16 a[208:211], v[64:67], v[128:131], a[208:211]
v_cvt_pk_bf16_f32 v224, v208, v209
v_cvt_pk_bf16_f32 v225, v210, v211
v_mfma_f32_16x16x32_bf16 a[208:211], v[68:71], v[144:147], a[208:211]
v_cvt_pk_bf16_f32 v226, v212, v213
v_cvt_pk_bf16_f32 v227, v214, v215
v_mfma_f32_16x16x32_bf16 a[212:215], v[64:67], v[132:135], a[212:215]
ds_read_b128 v[56:59], v2 offset:51200
buffer_store_dwordx4 v[224:227], v2, s[8:11], s31 offen offset:2048 sc1
v_mfma_f32_16x16x32_bf16 a[212:215], v[68:71], v[148:151], a[212:215]
v_accvgpr_read_b32 v216, a180
v_accvgpr_read_b32 v217, a181
v_mfma_f32_16x16x32_bf16 a[216:219], v[64:67], v[136:139], a[216:219]
v_accvgpr_read_b32 v218, a182
v_accvgpr_read_b32 v219, a183
v_mfma_f32_16x16x32_bf16 a[216:219], v[68:71], v[152:155], a[216:219]
ds_read_b128 v[60:63], v2 offset:52224
v_accvgpr_read_b32 v220, a196
v_mfma_f32_16x16x32_bf16 a[220:223], v[64:67], v[140:143], a[220:223]
v_accvgpr_read_b32 v221, a197
v_accvgpr_read_b32 v222, a198
v_mfma_f32_16x16x32_bf16 a[220:223], v[68:71], v[156:159], a[220:223]
v_accvgpr_read_b32 v223, a199
s_waitcnt lgkmcnt(4)
v_mfma_f32_16x16x32_bf16 a[224:227], v[72:75], v[96:99], a[224:227]
v_cvt_pk_bf16_f32 v228, v216, v217
v_cvt_pk_bf16_f32 v229, v218, v219
v_mfma_f32_16x16x32_bf16 a[224:227], v[76:79], v[112:115], a[224:227]
v_cvt_pk_bf16_f32 v230, v220, v221
v_cvt_pk_bf16_f32 v231, v222, v223
v_mfma_f32_16x16x32_bf16 a[228:231], v[72:75], v[100:103], a[228:231]
ds_read_b128 v[64:67], v2 offset:53248
buffer_store_dwordx4 v[228:231], v4, s[8:11], s31 offen offset:2048 sc1
v_mfma_f32_16x16x32_bf16 a[228:231], v[76:79], v[116:119], a[228:231]
v_accvgpr_read_b32 v208, a184
v_accvgpr_read_b32 v209, a185
v_mfma_f32_16x16x32_bf16 a[232:235], v[72:75], v[104:107], a[232:235]
v_accvgpr_read_b32 v210, a186
v_accvgpr_read_b32 v211, a187
v_mfma_f32_16x16x32_bf16 a[232:235], v[76:79], v[120:123], a[232:235]
ds_read_b128 v[68:71], v2 offset:54272
v_accvgpr_read_b32 v212, a200
v_mfma_f32_16x16x32_bf16 a[236:239], v[72:75], v[108:111], a[236:239]
v_accvgpr_read_b32 v213, a201
v_accvgpr_read_b32 v214, a202
v_mfma_f32_16x16x32_bf16 a[236:239], v[76:79], v[124:127], a[236:239]
v_accvgpr_read_b32 v215, a203
s_waitcnt lgkmcnt(4)
v_mfma_f32_16x16x32_bf16 a[224:227], v[48:51], v[128:131], a[224:227]
v_cvt_pk_bf16_f32 v224, v208, v209
v_cvt_pk_bf16_f32 v225, v210, v211
v_mfma_f32_16x16x32_bf16 a[224:227], v[52:55], v[144:147], a[224:227]
v_cvt_pk_bf16_f32 v226, v212, v213
v_cvt_pk_bf16_f32 v227, v214, v215
v_mfma_f32_16x16x32_bf16 a[228:231], v[48:51], v[132:135], a[228:231]
buffer_store_dwordx4 v[224:227], v5, s[8:11], s31 offen offset:2048 sc1
v_mfma_f32_16x16x32_bf16 a[228:231], v[52:55], v[148:151], a[228:231]
v_accvgpr_read_b32 v216, a188
v_accvgpr_read_b32 v217, a189
v_mfma_f32_16x16x32_bf16 a[232:235], v[48:51], v[136:139], a[232:235]
v_accvgpr_read_b32 v218, a190
v_accvgpr_read_b32 v219, a191
v_mfma_f32_16x16x32_bf16 a[232:235], v[52:55], v[152:155], a[232:235]
v_accvgpr_read_b32 v220, a204
v_accvgpr_read_b32 v221, a205
v_mfma_f32_16x16x32_bf16 a[236:239], v[48:51], v[140:143], a[236:239]
v_accvgpr_read_b32 v222, a206
v_accvgpr_read_b32 v223, a207
v_mfma_f32_16x16x32_bf16 a[236:239], v[52:55], v[156:159], a[236:239]
v_cvt_pk_bf16_f32 v228, v216, v217
v_cvt_pk_bf16_f32 v229, v218, v219
v_cvt_pk_bf16_f32 v230, v220, v221
v_cvt_pk_bf16_f32 v231, v222, v223
buffer_store_dwordx4 v[228:231], v6, s[8:11], s31 offen offset:2048 sc1
s_waitcnt lgkmcnt(2)
v_mfma_f32_16x16x32_bf16 a[240:243], v[56:59], v[96:99], a[240:243]
v_mfma_f32_16x16x32_bf16 a[240:243], v[60:63], v[112:115], a[240:243]
v_mfma_f32_16x16x32_bf16 a[244:247], v[56:59], v[100:103], a[244:247]
v_mfma_f32_16x16x32_bf16 a[244:247], v[60:63], v[116:119], a[244:247]
v_accvgpr_read_b32 v208, a208
v_accvgpr_read_b32 v209, a209
v_mfma_f32_16x16x32_bf16 a[248:251], v[56:59], v[104:107], a[248:251]
v_accvgpr_read_b32 v210, a210
v_accvgpr_read_b32 v211, a211
v_mfma_f32_16x16x32_bf16 a[248:251], v[60:63], v[120:123], a[248:251]
v_accvgpr_read_b32 v212, a224
v_accvgpr_read_b32 v213, a225
v_mfma_f32_16x16x32_bf16 a[252:255], v[56:59], v[108:111], a[252:255]
v_accvgpr_read_b32 v214, a226
v_accvgpr_read_b32 v215, a227
v_mfma_f32_16x16x32_bf16 a[252:255], v[60:63], v[124:127], a[252:255]
v_cvt_pk_bf16_f32 v224, v208, v209
s_waitcnt lgkmcnt(0)
v_mfma_f32_16x16x32_bf16 a[240:243], v[64:67], v[128:131], a[240:243]
v_cvt_pk_bf16_f32 v225, v210, v211
v_cvt_pk_bf16_f32 v226, v212, v213
v_mfma_f32_16x16x32_bf16 a[240:243], v[68:71], v[144:147], a[240:243]
v_cvt_pk_bf16_f32 v227, v214, v215
buffer_store_dwordx4 v[224:227], v2, s[8:11], s31 offen offset:3072 sc1
v_mfma_f32_16x16x32_bf16 a[244:247], v[64:67], v[132:135], a[244:247]
v_accvgpr_read_b32 v216, a212
v_accvgpr_read_b32 v217, a213
v_mfma_f32_16x16x32_bf16 a[244:247], v[68:71], v[148:151], a[244:247]
v_accvgpr_read_b32 v218, a214
v_accvgpr_read_b32 v219, a215
v_mfma_f32_16x16x32_bf16 a[248:251], v[64:67], v[136:139], a[248:251]
v_accvgpr_read_b32 v220, a228
v_accvgpr_read_b32 v221, a229
v_mfma_f32_16x16x32_bf16 a[248:251], v[68:71], v[152:155], a[248:251]
v_accvgpr_read_b32 v222, a230
v_accvgpr_read_b32 v223, a231
v_mfma_f32_16x16x32_bf16 a[252:255], v[64:67], v[140:143], a[252:255]
v_cvt_pk_bf16_f32 v228, v216, v217
v_cvt_pk_bf16_f32 v229, v218, v219
v_mfma_f32_16x16x32_bf16 a[252:255], v[68:71], v[156:159], a[252:255]
v_cvt_pk_bf16_f32 v230, v220, v221
s_barrier
v_cvt_pk_bf16_f32 v231, v222, v223
buffer_store_dwordx4 v[228:231], v4, s[8:11], s31 offen offset:3072 sc1
v_accvgpr_read_b32 v208, a216
v_accvgpr_read_b32 v209, a217
v_accvgpr_read_b32 v210, a218
v_accvgpr_read_b32 v211, a219
v_accvgpr_read_b32 v212, a232
v_accvgpr_read_b32 v213, a233
v_accvgpr_read_b32 v214, a234
v_accvgpr_read_b32 v215, a235
v_cvt_pk_bf16_f32 v224, v208, v209
v_cvt_pk_bf16_f32 v225, v210, v211
v_cvt_pk_bf16_f32 v226, v212, v213
v_cvt_pk_bf16_f32 v227, v214, v215
buffer_store_dwordx4 v[224:227], v5, s[8:11], s31 offen offset:3072 sc1
v_accvgpr_read_b32 v216, a220
v_accvgpr_read_b32 v217, a221
v_accvgpr_read_b32 v218, a222
v_accvgpr_read_b32 v219, a223
v_accvgpr_read_b32 v220, a236
v_accvgpr_read_b32 v221, a237
v_accvgpr_read_b32 v222, a238
v_accvgpr_read_b32 v223, a239
v_cvt_pk_bf16_f32 v228, v216, v217
v_cvt_pk_bf16_f32 v229, v218, v219
v_cvt_pk_bf16_f32 v230, v220, v221
v_cvt_pk_bf16_f32 v231, v222, v223
buffer_store_dwordx4 v[228:231], v6, s[8:11], s31 offen offset:3072 sc1
v_accvgpr_read_b32 v208, a240
v_accvgpr_read_b32 v209, a241
v_accvgpr_read_b32 v210, a242
v_accvgpr_read_b32 v211, a243
v_accvgpr_read_b32 v212, a244
v_accvgpr_read_b32 v213, a245
v_accvgpr_read_b32 v214, a246
v_accvgpr_read_b32 v215, a247
v_cvt_pk_bf16_f32 v224, v208, v209
v_cvt_pk_bf16_f32 v225, v210, v211
v_cvt_pk_bf16_f32 v226, v212, v213
v_cvt_pk_bf16_f32 v227, v214, v215
s_nop 0
v_permlane16_swap_b32 v224, v226
v_permlane16_swap_b32 v225, v227
buffer_store_dwordx4 v[224:227], v9, s[8:11], s32 offen sc1
v_accvgpr_read_b32 v216, a248
v_accvgpr_read_b32 v217, a249
v_accvgpr_read_b32 v218, a250
v_accvgpr_read_b32 v219, a251
v_accvgpr_read_b32 v220, a252
v_accvgpr_read_b32 v221, a253
v_accvgpr_read_b32 v222, a254
v_accvgpr_read_b32 v223, a255
v_cvt_pk_bf16_f32 v228, v216, v217
v_cvt_pk_bf16_f32 v229, v218, v219
v_cvt_pk_bf16_f32 v230, v220, v221
v_cvt_pk_bf16_f32 v231, v222, v223
s_nop 0
v_permlane16_swap_b32 v228, v230
v_permlane16_swap_b32 v229, v231
buffer_store_dwordx4 v[228:231], v9, s[8:11], s33 offen sc1
v_mov_b32 v14, 2146435072
v_cmp_eq_u32 vcc, 0, v1
s_nop 1
v_cndmask_b32 v14, v14, 0, vcc
v_mov_b32 v15, 1
s_waitcnt vmcnt(0)
buffer_store_dword v15, v14, s[8:11], s35 offen sc1
s_cmp_eq_u32 s7, 1
s_cbranch_scc1 L_last
s_lshr_b32 s20, s5, 2
s_lshl_b32 s20, s20, 3
s_lshr_b32 s21, s6, 2
s_add_u32 s20, s20, s21
s_and_b32 s21, s5, 3
s_lshl_b32 s21, s21, 2
s_and_b32 s22, s6, 3
s_add_u32 s21, s21, s22
s_mul_i32 s22, s21, 147456
s_add_u32 s22, s22, 4194304
s_mul_i32 s23, s4, 36864
s_add_u32 s22, s22, s23
s_add_u32 m0, s23, 0
s_add_u32 s40, s22, 0
buffer_load_dwordx4 v2, s[8:11], s40 offen offset:0 lds
buffer_load_dwordx4 v2, s[8:11], s40 offen offset:1024 lds
buffer_load_dwordx4 v2, s[8:11], s40 offen offset:2048 lds
buffer_load_dwordx4 v2, s[8:11], s40 offen offset:3072 lds
s_add_u32 m0, s23, 4096
s_add_u32 s40, s22, 4096
buffer_load_dwordx4 v2, s[8:11], s40 offen offset:0 lds
buffer_load_dwordx4 v2, s[8:11], s40 offen offset:1024 lds
buffer_load_dwordx4 v2, s[8:11], s40 offen offset:2048 lds
buffer_load_dwordx4 v2, s[8:11], s40 offen offset:3072 lds
s_add_u32 m0, s23, 8192
s_add_u32 s40, s22, 8192
buffer_load_dwordx4 v2, s[8:11], s40 offen offset:0 lds
buffer_load_dwordx4 v2, s[8:11], s40 offen offset:1024 lds
buffer_load_dwordx4 v2, s[8:11], s40 offen offset:2048 lds
buffer_load_dwordx4 v2, s[8:11], s40 offen offset:3072 lds
s_add_u32 m0, s23, 12288
s_add_u32 s40, s22, 12288
buffer_load_dwordx4 v2, s[8:11], s40 offen offset:0 lds
buffer_load_dwordx4 v2, s[8:11], s40 offen offset:1024 lds
buffer_load_dwordx4 v2, s[8:11], s40 offen offset:2048 lds
buffer_load_dwordx4 v2, s[8:11], s40 offen offset:3072 lds
s_add_u32 m0, s23, 16384
s_add_u32 s40, s22, 16384
buffer_load_dwordx4 v2, s[8:11], s40 offen offset:0 lds
buffer_load_dwordx4 v2, s[8:11], s40 offen offset:1024 lds
buffer_load_dwordx4 v2, s[8:11], s40 offen offset:2048 lds
buffer_load_dwordx4 v2, s[8:11], s40 offen offset:3072 lds
s_add_u32 m0, s23, 20480
s_add_u32 s40, s22, 20480
buffer_load_dwordx4 v2, s[8:11], s40 offen offset:0 lds
buffer_load_dwordx4 v2, s[8:11], s40 offen offset:1024 lds
buffer_load_dwordx4 v2, s[8:11], s40 offen offset:2048 lds
buffer_load_dwordx4 v2, s[8:11], s40 offen offset:3072 lds
s_add_u32 m0, s23, 24576
s_add_u32 s40, s22, 24576
buffer_load_dwordx4 v2, s[8:11], s40 offen offset:0 lds
buffer_load_dwordx4 v2, s[8:11], s40 offen offset:1024 lds
buffer_load_dwordx4 v2, s[8:11], s40 offen offset:2048 lds
buffer_load_dwordx4 v2, s[8:11], s40 offen offset:3072 lds
s_add_u32 m0, s23, 28672
s_add_u32 s40, s22, 28672
buffer_load_dwordx4 v2, s[8:11], s40 offen offset:0 lds
buffer_load_dwordx4 v2, s[8:11], s40 offen offset:1024 lds
buffer_load_dwordx4 v2, s[8:11], s40 offen offset:2048 lds
buffer_load_dwordx4 v2, s[8:11], s40 offen offset:3072 lds
s_add_u32 m0, s23, 32768
s_add_u32 s40, s22, 32768
buffer_load_dwordx4 v2, s[8:11], s40 offen offset:0 lds
buffer_load_dwordx4 v2, s[8:11], s40 offen offset:1024 lds
buffer_load_dwordx4 v2, s[8:11], s40 offen offset:2048 lds
buffer_load_dwordx4 v2, s[8:11], s40 offen offset:3072 lds
s_cmp_eq_u32 s4, 3
s_cbranch_scc1 L_r_side
v_and_b32 v6, 7, v1
v_lshrrev_b32 v7, 3, v1
s_mul_i32 s22, s4, 24
v_add_u32 v7, s22, v7
s_and_b32 s23, s6, 1
s_lshl_b32 s23, s23, 3
v_add_u32 v8, s23, v6
v_lshlrev_b32 v8, 4, v8
v_lshl_add_u32 v4, v7, 8, v8
s_lshl_b32 s24, s5, 4
s_lshr_b32 s25, s6, 1
s_add_u32 s24, s24, s25
s_mul_i32 s20, s24, 18432
s_add_u32 s24, s20, 37412864
s_add_u32 s25, s24, 4096
buffer_load_dwordx4 v[16:19], v4, s[8:11], s24 offen offset:0 sc1
buffer_load_dwordx4 v[20:23], v4, s[8:11], s24 offen offset:2048 sc1
buffer_load_dwordx4 v[24:27], v4, s[8:11], s25 offen offset:0 sc1
s_lshl_b32 s24, s5, 2
s_lshr_b32 s25, s6, 3
s_add_u32 s24, s24, s25
s_lshl_b32 s24, s24, 12
s_add_u32 s24, s24, 393216
v_and_b32 v6, 31, v1
v_lshlrev_b32 v6, 7, v6
s_mov_b32 s52, 0
L_poll5:
buffer_load_dword v253, v6, s[8:11], s24 offen sc1
s_add_u32 s52, s52, 1
s_waitcnt vmcnt(0)
v_cmp_eq_u32 vcc, 0, v253
s_cmp_ge_u32 s52, 0x100000
s_cbranch_scc1 L_got5
s_and_b64 exec, exec, vcc
s_cbranch_execnz L_poll5
L_got5:
s_mov_b64 exec, -1
s_add_u32 s24, s20, 80142336
s_add_u32 s25, s24, 4096
buffer_load_dwordx4 v[28:31], v4, s[8:11], s24 offen offset:0 sc1
buffer_load_dwordx4 v[32:35], v4, s[8:11], s24 offen offset:2048 sc1
buffer_load_dwordx4 v[36:39], v4, s[8:11], s25 offen offset:0 sc1
s_add_u32 s24, s20, 82501632
s_add_u32 s25, s24, 4096
buffer_load_dwordx4 v[40:43], v4, s[8:11], s24 offen offset:0 sc1
buffer_load_dwordx4 v[44:47], v4, s[8:11], s24 offen offset:2048 sc1
buffer_load_dwordx4 v[48:51], v4, s[8:11], s25 offen offset:0 sc1
s_add_u32 s24, s20, 84860928
s_add_u32 s25, s24, 4096
buffer_load_dwordx4 v[52:55], v4, s[8:11], s24 offen offset:0 sc1
buffer_load_dwordx4 v[56:59], v4, s[8:11], s24 offen offset:2048 sc1
buffer_load_dwordx4 v[60:63], v4, s[8:11], s25 offen offset:0 sc1
s_add_u32 s24, s20, 87220224
s_add_u32 s25, s24, 4096
buffer_load_dwordx4 v[64:67], v4, s[8:11], s24 offen offset:0 sc1
buffer_load_dwordx4 v[68:71], v4, s[8:11], s24 offen offset:2048 sc1
buffer_load_dwordx4 v[72:75], v4, s[8:11], s25 offen offset:0 sc1
s_add_u32 s24, s20, 89579520
s_add_u32 s25, s24, 4096
buffer_load_dwordx4 v[76:79], v4, s[8:11], s24 offen offset:0 sc1
buffer_load_dwordx4 v[80:83], v4, s[8:11], s24 offen offset:2048 sc1
buffer_load_dwordx4 v[84:87], v4, s[8:11], s25 offen offset:0 sc1
s_add_u32 s24, s20, 91938816
s_add_u32 s25, s24, 4096
buffer_load_dwordx4 v[88:91], v4, s[8:11], s24 offen offset:0 sc1
buffer_load_dwordx4 v[92:95], v4, s[8:11], s24 offen offset:2048 sc1
buffer_load_dwordx4 v[96:99], v4, s[8:11], s25 offen offset:0 sc1
s_add_u32 s24, s20, 94298112
s_add_u32 s25, s24, 4096
buffer_load_dwordx4 v[100:103], v4, s[8:11], s24 offen offset:0 sc1
buffer_load_dwordx4 v[104:107], v4, s[8:11], s24 offen offset:2048 sc1
buffer_load_dwordx4 v[108:111], v4, s[8:11], s25 offen offset:0 sc1
s_add_u32 s24, s20, 96657408
s_add_u32 s25, s24, 4096
buffer_load_dwordx4 v[112:115], v4, s[8:11], s24 offen offset:0 sc1
buffer_load_dwordx4 v[116:119], v4, s[8:11], s24 offen offset:2048 sc1
buffer_load_dwordx4 v[120:123], v4, s[8:11], s25 offen offset:0 sc1
s_waitcnt vmcnt(26)
v_lshlrev_b32 v128, 16, v16
v_and_b32 v129, 0xffff0000, v16
v_lshlrev_b32 v130, 16, v17
v_and_b32 v131, 0xffff0000, v17
v_lshlrev_b32 v132, 16, v18
v_and_b32 v133, 0xffff0000, v18
v_lshlrev_b32 v134, 16, v19
v_and_b32 v135, 0xffff0000, v19
s_waitcnt vmcnt(25)
v_lshlrev_b32 v136, 16, v20
v_and_b32 v137, 0xffff0000, v20
v_lshlrev_b32 v138, 16, v21
v_and_b32 v139, 0xffff0000, v21
v_lshlrev_b32 v140, 16, v22
v_and_b32 v141, 0xffff0000, v22
v_lshlrev_b32 v142, 16, v23
v_and_b32 v143, 0xffff0000, v23
s_waitcnt vmcnt(24)
v_lshlrev_b32 v144, 16, v24
v_and_b32 v145, 0xffff0000, v24
v_lshlrev_b32 v146, 16, v25
v_and_b32 v147, 0xffff0000, v25
v_lshlrev_b32 v148, 16, v26
v_and_b32 v149, 0xffff0000, v26
v_lshlrev_b32 v150, 16, v27
v_and_b32 v151, 0xffff0000, v27
s_waitcnt vmcnt(23)
v_lshlrev_b32 v6, 16, v28
v_and_b32 v7, 0xffff0000, v28
v_add_f32 v128, v128, v6
v_add_f32 v129, v129, v7
v_lshlrev_b32 v8, 16, v29
v_and_b32 v9, 0xffff0000, v29
v_add_f32 v130, v130, v8
v_add_f32 v131, v131, v9
v_lshlrev_b32 v6, 16, v30
v_and_b32 v7, 0xffff0000, v30
v_add_f32 v132, v132, v6
v_add_f32 v133, v133, v7
v_lshlrev_b32 v8, 16, v31
v_and_b32 v9, 0xffff0000, v31
v_add_f32 v134, v134, v8
v_add_f32 v135, v135, v9
s_waitcnt vmcnt(22)
v_lshlrev_b32 v6, 16, v32
v_and_b32 v7, 0xffff0000, v32
v_add_f32 v136, v136, v6
v_add_f32 v137, v137, v7
v_lshlrev_b32 v8, 16, v33
v_and_b32 v9, 0xffff0000, v33
v_add_f32 v138, v138, v8
v_add_f32 v139, v139, v9
v_lshlrev_b32 v6, 16, v34
v_and_b32 v7, 0xffff0000, v34
v_add_f32 v140, v140, v6
v_add_f32 v141, v141, v7
v_lshlrev_b32 v8, 16, v35
v_and_b32 v9, 0xffff0000, v35
v_add_f32 v142, v142, v8
v_add_f32 v143, v143, v9
s_waitcnt vmcnt(21)
v_lshlrev_b32 v6, 16, v36
v_and_b32 v7, 0xffff0000, v36
v_add_f32 v144, v144, v6
v_add_f32 v145, v145, v7
v_lshlrev_b32 v8, 16, v37
v_and_b32 v9, 0xffff0000, v37
v_add_f32 v146, v146, v8
v_add_f32 v147, v147, v9
v_lshlrev_b32 v6, 16, v38
v_and_b32 v7, 0xffff0000, v38
v_add_f32 v148, v148, v6
v_add_f32 v149, v149, v7
v_lshlrev_b32 v8, 16, v39
v_and_b32 v9, 0xffff0000, v39
v_add_f32 v150, v150, v8
v_add_f32 v151, v151, v9
s_waitcnt vmcnt(20)
v_lshlrev_b32 v6, 16, v40
v_and_b32 v7, 0xffff0000, v40
v_add_f32 v128, v128, v6
v_add_f32 v129, v129, v7
v_lshlrev_b32 v8, 16, v41
v_and_b32 v9, 0xffff0000, v41
v_add_f32 v130, v130, v8
v_add_f32 v131, v131, v9
v_lshlrev_b32 v6, 16, v42
v_and_b32 v7, 0xffff0000, v42
v_add_f32 v132, v132, v6
v_add_f32 v133, v133, v7
v_lshlrev_b32 v8, 16, v43
v_and_b32 v9, 0xffff0000, v43
v_add_f32 v134, v134, v8
v_add_f32 v135, v135, v9
s_waitcnt vmcnt(19)
v_lshlrev_b32 v6, 16, v44
v_and_b32 v7, 0xffff0000, v44
v_add_f32 v136, v136, v6
v_add_f32 v137, v137, v7
v_lshlrev_b32 v8, 16, v45
v_and_b32 v9, 0xffff0000, v45
v_add_f32 v138, v138, v8
v_add_f32 v139, v139, v9
v_lshlrev_b32 v6, 16, v46
v_and_b32 v7, 0xffff0000, v46
v_add_f32 v140, v140, v6
v_add_f32 v141, v141, v7
v_lshlrev_b32 v8, 16, v47
v_and_b32 v9, 0xffff0000, v47
v_add_f32 v142, v142, v8
v_add_f32 v143, v143, v9
s_waitcnt vmcnt(18)
v_lshlrev_b32 v6, 16, v48
v_and_b32 v7, 0xffff0000, v48
v_add_f32 v144, v144, v6
v_add_f32 v145, v145, v7
v_lshlrev_b32 v8, 16, v49
v_and_b32 v9, 0xffff0000, v49
v_add_f32 v146, v146, v8
v_add_f32 v147, v147, v9
v_lshlrev_b32 v6, 16, v50
v_and_b32 v7, 0xffff0000, v50
v_add_f32 v148, v148, v6
v_add_f32 v149, v149, v7
v_lshlrev_b32 v8, 16, v51
v_and_b32 v9, 0xffff0000, v51
v_add_f32 v150, v150, v8
v_add_f32 v151, v151, v9
s_waitcnt vmcnt(17)
v_lshlrev_b32 v6, 16, v52
v_and_b32 v7, 0xffff0000, v52
v_add_f32 v128, v128, v6
v_add_f32 v129, v129, v7
v_lshlrev_b32 v8, 16, v53
v_and_b32 v9, 0xffff0000, v53
v_add_f32 v130, v130, v8
v_add_f32 v131, v131, v9
v_lshlrev_b32 v6, 16, v54
v_and_b32 v7, 0xffff0000, v54
v_add_f32 v132, v132, v6
v_add_f32 v133, v133, v7
v_lshlrev_b32 v8, 16, v55
v_and_b32 v9, 0xffff0000, v55
v_add_f32 v134, v134, v8
v_add_f32 v135, v135, v9
s_waitcnt vmcnt(16)
v_lshlrev_b32 v6, 16, v56
v_and_b32 v7, 0xffff0000, v56
v_add_f32 v136, v136, v6
v_add_f32 v137, v137, v7
v_lshlrev_b32 v8, 16, v57
v_and_b32 v9, 0xffff0000, v57
v_add_f32 v138, v138, v8
v_add_f32 v139, v139, v9
v_lshlrev_b32 v6, 16, v58
v_and_b32 v7, 0xffff0000, v58
v_add_f32 v140, v140, v6
v_add_f32 v141, v141, v7
v_lshlrev_b32 v8, 16, v59
v_and_b32 v9, 0xffff0000, v59
v_add_f32 v142, v142, v8
v_add_f32 v143, v143, v9
s_waitcnt vmcnt(15)
v_lshlrev_b32 v6, 16, v60
v_and_b32 v7, 0xffff0000, v60
v_add_f32 v144, v144, v6
v_add_f32 v145, v145, v7
v_lshlrev_b32 v8, 16, v61
v_and_b32 v9, 0xffff0000, v61
v_add_f32 v146, v146, v8
v_add_f32 v147, v147, v9
v_lshlrev_b32 v6, 16, v62
v_and_b32 v7, 0xffff0000, v62
v_add_f32 v148, v148, v6
v_add_f32 v149, v149, v7
v_lshlrev_b32 v8, 16, v63
v_and_b32 v9, 0xffff0000, v63
v_add_f32 v150, v150, v8
v_add_f32 v151, v151, v9
s_waitcnt vmcnt(14)
v_lshlrev_b32 v6, 16, v64
v_and_b32 v7, 0xffff0000, v64
v_add_f32 v128, v128, v6
v_add_f32 v129, v129, v7
v_lshlrev_b32 v8, 16, v65
v_and_b32 v9, 0xffff0000, v65
v_add_f32 v130, v130, v8
v_add_f32 v131, v131, v9
v_lshlrev_b32 v6, 16, v66
v_and_b32 v7, 0xffff0000, v66
v_add_f32 v132, v132, v6
v_add_f32 v133, v133, v7
v_lshlrev_b32 v8, 16, v67
v_and_b32 v9, 0xffff0000, v67
v_add_f32 v134, v134, v8
v_add_f32 v135, v135, v9
s_waitcnt vmcnt(13)
v_lshlrev_b32 v6, 16, v68
v_and_b32 v7, 0xffff0000, v68
v_add_f32 v136, v136, v6
v_add_f32 v137, v137, v7
v_lshlrev_b32 v8, 16, v69
v_and_b32 v9, 0xffff0000, v69
v_add_f32 v138, v138, v8
v_add_f32 v139, v139, v9
v_lshlrev_b32 v6, 16, v70
v_and_b32 v7, 0xffff0000, v70
v_add_f32 v140, v140, v6
v_add_f32 v141, v141, v7
v_lshlrev_b32 v8, 16, v71
v_and_b32 v9, 0xffff0000, v71
v_add_f32 v142, v142, v8
v_add_f32 v143, v143, v9
s_waitcnt vmcnt(12)
v_lshlrev_b32 v6, 16, v72
v_and_b32 v7, 0xffff0000, v72
v_add_f32 v144, v144, v6
v_add_f32 v145, v145, v7
v_lshlrev_b32 v8, 16, v73
v_and_b32 v9, 0xffff0000, v73
v_add_f32 v146, v146, v8
v_add_f32 v147, v147, v9
v_lshlrev_b32 v6, 16, v74
v_and_b32 v7, 0xffff0000, v74
v_add_f32 v148, v148, v6
v_add_f32 v149, v149, v7
v_lshlrev_b32 v8, 16, v75
v_and_b32 v9, 0xffff0000, v75
v_add_f32 v150, v150, v8
v_add_f32 v151, v151, v9
s_waitcnt vmcnt(11)
v_lshlrev_b32 v6, 16, v76
v_and_b32 v7, 0xffff0000, v76
v_add_f32 v128, v128, v6
v_add_f32 v129, v129, v7
v_lshlrev_b32 v8, 16, v77
v_and_b32 v9, 0xffff0000, v77
v_add_f32 v130, v130, v8
v_add_f32 v131, v131, v9
v_lshlrev_b32 v6, 16, v78
v_and_b32 v7, 0xffff0000, v78
v_add_f32 v132, v132, v6
v_add_f32 v133, v133, v7
v_lshlrev_b32 v8, 16, v79
v_and_b32 v9, 0xffff0000, v79
v_add_f32 v134, v134, v8
v_add_f32 v135, v135, v9
s_waitcnt vmcnt(10)
v_lshlrev_b32 v6, 16, v80
v_and_b32 v7, 0xffff0000, v80
v_add_f32 v136, v136, v6
v_add_f32 v137, v137, v7
v_lshlrev_b32 v8, 16, v81
v_and_b32 v9, 0xffff0000, v81
v_add_f32 v138, v138, v8
v_add_f32 v139, v139, v9
v_lshlrev_b32 v6, 16, v82
v_and_b32 v7, 0xffff0000, v82
v_add_f32 v140, v140, v6
v_add_f32 v141, v141, v7
v_lshlrev_b32 v8, 16, v83
v_and_b32 v9, 0xffff0000, v83
v_add_f32 v142, v142, v8
v_add_f32 v143, v143, v9
s_waitcnt vmcnt(9)
v_lshlrev_b32 v6, 16, v84
v_and_b32 v7, 0xffff0000, v84
v_add_f32 v144, v144, v6
v_add_f32 v145, v145, v7
v_lshlrev_b32 v8, 16, v85
v_and_b32 v9, 0xffff0000, v85
v_add_f32 v146, v146, v8
v_add_f32 v147, v147, v9
v_lshlrev_b32 v6, 16, v86
v_and_b32 v7, 0xffff0000, v86
v_add_f32 v148, v148, v6
v_add_f32 v149, v149, v7
v_lshlrev_b32 v8, 16, v87
v_and_b32 v9, 0xffff0000, v87
v_add_f32 v150, v150, v8
v_add_f32 v151, v151, v9
s_waitcnt vmcnt(8)
v_lshlrev_b32 v6, 16, v88
v_and_b32 v7, 0xffff0000, v88
v_add_f32 v128, v128, v6
v_add_f32 v129, v129, v7
v_lshlrev_b32 v8, 16, v89
v_and_b32 v9, 0xffff0000, v89
v_add_f32 v130, v130, v8
v_add_f32 v131, v131, v9
v_lshlrev_b32 v6, 16, v90
v_and_b32 v7, 0xffff0000, v90
v_add_f32 v132, v132, v6
v_add_f32 v133, v133, v7
v_lshlrev_b32 v8, 16, v91
v_and_b32 v9, 0xffff0000, v91
v_add_f32 v134, v134, v8
v_add_f32 v135, v135, v9
s_waitcnt vmcnt(7)
v_lshlrev_b32 v6, 16, v92
v_and_b32 v7, 0xffff0000, v92
v_add_f32 v136, v136, v6
v_add_f32 v137, v137, v7
v_lshlrev_b32 v8, 16, v93
v_and_b32 v9, 0xffff0000, v93
v_add_f32 v138, v138, v8
v_add_f32 v139, v139, v9
v_lshlrev_b32 v6, 16, v94
v_and_b32 v7, 0xffff0000, v94
v_add_f32 v140, v140, v6
v_add_f32 v141, v141, v7
v_lshlrev_b32 v8, 16, v95
v_and_b32 v9, 0xffff0000, v95
v_add_f32 v142, v142, v8
v_add_f32 v143, v143, v9
s_waitcnt vmcnt(6)
v_lshlrev_b32 v6, 16, v96
v_and_b32 v7, 0xffff0000, v96
v_add_f32 v144, v144, v6
v_add_f32 v145, v145, v7
v_lshlrev_b32 v8, 16, v97
v_and_b32 v9, 0xffff0000, v97
v_add_f32 v146, v146, v8
v_add_f32 v147, v147, v9
v_lshlrev_b32 v6, 16, v98
v_and_b32 v7, 0xffff0000, v98
v_add_f32 v148, v148, v6
v_add_f32 v149, v149, v7
v_lshlrev_b32 v8, 16, v99
v_and_b32 v9, 0xffff0000, v99
v_add_f32 v150, v150, v8
v_add_f32 v151, v151, v9
s_waitcnt vmcnt(5)
v_lshlrev_b32 v6, 16, v100
v_and_b32 v7, 0xffff0000, v100
v_add_f32 v128, v128, v6
v_add_f32 v129, v129, v7
v_lshlrev_b32 v8, 16, v101
v_and_b32 v9, 0xffff0000, v101
v_add_f32 v130, v130, v8
v_add_f32 v131, v131, v9
v_lshlrev_b32 v6, 16, v102
v_and_b32 v7, 0xffff0000, v102
v_add_f32 v132, v132, v6
v_add_f32 v133, v133, v7
v_lshlrev_b32 v8, 16, v103
v_and_b32 v9, 0xffff0000, v103
v_add_f32 v134, v134, v8
v_add_f32 v135, v135, v9
s_waitcnt vmcnt(4)
v_lshlrev_b32 v6, 16, v104
v_and_b32 v7, 0xffff0000, v104
v_add_f32 v136, v136, v6
v_add_f32 v137, v137, v7
v_lshlrev_b32 v8, 16, v105
v_and_b32 v9, 0xffff0000, v105
v_add_f32 v138, v138, v8
v_add_f32 v139, v139, v9
v_lshlrev_b32 v6, 16, v106
v_and_b32 v7, 0xffff0000, v106
v_add_f32 v140, v140, v6
v_add_f32 v141, v141, v7
v_lshlrev_b32 v8, 16, v107
v_and_b32 v9, 0xffff0000, v107
v_add_f32 v142, v142, v8
v_add_f32 v143, v143, v9
s_waitcnt vmcnt(3)
v_lshlrev_b32 v6, 16, v108
v_and_b32 v7, 0xffff0000, v108
v_add_f32 v144, v144, v6
v_add_f32 v145, v145, v7
v_lshlrev_b32 v8, 16, v109
v_and_b32 v9, 0xffff0000, v109
v_add_f32 v146, v146, v8
v_add_f32 v147, v147, v9
v_lshlrev_b32 v6, 16, v110
v_and_b32 v7, 0xffff0000, v110
v_add_f32 v148, v148, v6
v_add_f32 v149, v149, v7
v_lshlrev_b32 v8, 16, v111
v_and_b32 v9, 0xffff0000, v111
v_add_f32 v150, v150, v8
v_add_f32 v151, v151, v9
s_waitcnt vmcnt(2)
v_lshlrev_b32 v6, 16, v112
v_and_b32 v7, 0xffff0000, v112
v_add_f32 v128, v128, v6
v_add_f32 v129, v129, v7
v_lshlrev_b32 v8, 16, v113
v_and_b32 v9, 0xffff0000, v113
v_add_f32 v130, v130, v8
v_add_f32 v131, v131, v9
v_lshlrev_b32 v6, 16, v114
v_and_b32 v7, 0xffff0000, v114
v_add_f32 v132, v132, v6
v_add_f32 v133, v133, v7
v_lshlrev_b32 v8, 16, v115
v_and_b32 v9, 0xffff0000, v115
v_add_f32 v134, v134, v8
v_add_f32 v135, v135, v9
s_waitcnt vmcnt(1)
v_lshlrev_b32 v6, 16, v116
v_and_b32 v7, 0xffff0000, v116
v_add_f32 v136, v136, v6
v_add_f32 v137, v137, v7
v_lshlrev_b32 v8, 16, v117
v_and_b32 v9, 0xffff0000, v117
v_add_f32 v138, v138, v8
v_add_f32 v139, v139, v9
v_lshlrev_b32 v6, 16, v118
v_and_b32 v7, 0xffff0000, v118
v_add_f32 v140, v140, v6
v_add_f32 v141, v141, v7
v_lshlrev_b32 v8, 16, v119
v_and_b32 v9, 0xffff0000, v119
v_add_f32 v142, v142, v8
v_add_f32 v143, v143, v9
s_waitcnt vmcnt(0)
v_lshlrev_b32 v6, 16, v120
v_and_b32 v7, 0xffff0000, v120
v_add_f32 v144, v144, v6
v_add_f32 v145, v145, v7
v_lshlrev_b32 v8, 16, v121
v_and_b32 v9, 0xffff0000, v121
v_add_f32 v146, v146, v8
v_add_f32 v147, v147, v9
v_lshlrev_b32 v6, 16, v122
v_and_b32 v7, 0xffff0000, v122
v_add_f32 v148, v148, v6
v_add_f32 v149, v149, v7
v_lshlrev_b32 v8, 16, v123
v_and_b32 v9, 0xffff0000, v123
v_add_f32 v150, v150, v8
v_add_f32 v151, v151, v9
v_cvt_pk_bf16_f32 v152, v128, v129
v_cvt_pk_bf16_f32 v153, v130, v131
v_cvt_pk_bf16_f32 v154, v132, v133
v_cvt_pk_bf16_f32 v155, v134, v135
v_cvt_pk_bf16_f32 v156, v136, v137
v_cvt_pk_bf16_f32 v157, v138, v139
v_cvt_pk_bf16_f32 v158, v140, v141
v_cvt_pk_bf16_f32 v159, v142, v143
v_cvt_pk_bf16_f32 v160, v144, v145
v_cvt_pk_bf16_f32 v161, v146, v147
v_cvt_pk_bf16_f32 v162, v148, v149
v_cvt_pk_bf16_f32 v163, v150, v151
s_add_u32 s24, s20, 30334976
s_add_u32 s25, s24, 4096
buffer_store_dwordx4 v[152:155], v4, s[8:11], s24 offen offset:0 sc1
buffer_store_dwordx4 v[156:159], v4, s[8:11], s24 offen offset:2048 sc1
buffer_store_dwordx4 v[160:163], v4, s[8:11], s25 offen offset:0 sc1
v_add_f32 v6, v128, v129
v_mul_f32 v7, v128, v128
v_mul_f32 v9, v129, v129
v_mov_b32 v8, 0
v_add_f32 v6, v6, v130
v_add_f32 v8, v8, v131
v_fmac_f32 v7, v130, v130
v_fmac_f32 v9, v131, v131
v_add_f32 v6, v6, v132
v_add_f32 v8, v8, v133
v_fmac_f32 v7, v132, v132
v_fmac_f32 v9, v133, v133
v_add_f32 v6, v6, v134
v_add_f32 v8, v8, v135
v_fmac_f32 v7, v134, v134
v_fmac_f32 v9, v135, v135
v_add_f32 v6, v6, v136
v_add_f32 v8, v8, v137
v_fmac_f32 v7, v136, v136
v_fmac_f32 v9, v137, v137
v_add_f32 v6, v6, v138
v_add_f32 v8, v8, v139
v_fmac_f32 v7, v138, v138
v_fmac_f32 v9, v139, v139
v_add_f32 v6, v6, v140
v_add_f32 v8, v8, v141
v_fmac_f32 v7, v140, v140
v_fmac_f32 v9, v141, v141
v_add_f32 v6, v6, v142
v_add_f32 v8, v8, v143
v_fmac_f32 v7, v142, v142
v_fmac_f32 v9, v143, v143
v_add_f32 v6, v6, v144
v_add_f32 v8, v8, v145
v_fmac_f32 v7, v144, v144
v_fmac_f32 v9, v145, v145
v_add_f32 v6, v6, v146
v_add_f32 v8, v8, v147
v_fmac_f32 v7, v146, v146
v_fmac_f32 v9, v147, v147
v_add_f32 v6, v6, v148
v_add_f32 v8, v8, v149
v_fmac_f32 v7, v148, v148
v_fmac_f32 v9, v149, v149
v_add_f32 v6, v6, v150
v_add_f32 v8, v8, v151
v_fmac_f32 v7, v150, v150
v_fmac_f32 v9, v151, v151
v_add_f32 v6, v6, v8
v_add_f32 v7, v7, v9
s_nop 0
v_add_f32_dpp v6, v6, v6 row_ror:8 row_mask:0xf bank_mask:0xf
v_add_f32_dpp v7, v7, v7 row_ror:8 row_mask:0xf bank_mask:0xf
v_mov_b32 v8, v6
v_mov_b32 v9, v7
s_nop 0
v_permlane16_swap_b32 v6, v8
v_permlane16_swap_b32 v7, v9
v_add_f32 v6, v6, v8
v_add_f32 v7, v7, v9
v_mov_b32 v8, v6
v_mov_b32 v9, v7
s_nop 0
v_permlane32_swap_b32 v6, v8
v_permlane32_swap_b32 v7, v9
v_add_f32 v6, v6, v8
v_add_f32 v7, v7, v9
v_and_b32 v10, 7, v1
v_lshlrev_b32 v10, 3, v10
v_add_u32 v10, 147456, v10
s_lshl_b32 s24, s4, 6
v_add_u32 v11, s24, v10
ds_write_b64 v11, v[6:7]
s_waitcnt lgkmcnt(0)
s_barrier
ds_read_b64 v[6:7], v10
ds_read_b64 v[8:9], v10 offset:64
ds_read_b64 v[12:13], v10 offset:128
s_waitcnt lgkmcnt(0)
v_add_f32 v6, v6, v8
v_add_f32 v7, v7, v9
v_add_f32 v6, v6, v12
v_add_f32 v7, v7, v13
v_mul_f32 v6, 0x3ae38e39, v6
v_mul_f32 v7, 0x3ae38e39, v7
v_fma_f32 v7, -v6, v6, v7
v_max_f32 v7, 0, v7
v_add_f32 v7, 0x3727c5ac, v7
v_rsq_f32 v7, v7
s_nop 0
v_mul_f32 v6, v6, v7
v_fma_f32 v128, v128, v7, -v6
v_fma_f32 v129, v129, v7, -v6
v_fma_f32 v130, v130, v7, -v6
v_fma_f32 v131, v131, v7, -v6
v_fma_f32 v132, v132, v7, -v6
v_fma_f32 v133, v133, v7, -v6
v_fma_f32 v134, v134, v7, -v6
v_fma_f32 v135, v135, v7, -v6
v_fma_f32 v136, v136, v7, -v6
v_fma_f32 v137, v137, v7, -v6
v_fma_f32 v138, v138, v7, -v6
v_fma_f32 v139, v139, v7, -v6
v_fma_f32 v140, v140, v7, -v6
v_fma_f32 v141, v141, v7, -v6
v_fma_f32 v142, v142, v7, -v6
v_fma_f32 v143, v143, v7, -v6
v_fma_f32 v144, v144, v7, -v6
v_fma_f32 v145, v145, v7, -v6
v_fma_f32 v146, v146, v7, -v6
v_fma_f32 v147, v147, v7, -v6
v_fma_f32 v148, v148, v7, -v6
v_fma_f32 v149, v149, v7, -v6
v_fma_f32 v150, v150, v7, -v6
v_fma_f32 v151, v151, v7, -v6
v_cvt_pk_bf16_f32 v168, v128, v129
v_cvt_pk_bf16_f32 v169, v130, v131
v_cvt_pk_bf16_f32 v170, v132, v133
v_cvt_pk_bf16_f32 v171, v134, v135
v_cvt_pk_bf16_f32 v172, v136, v137
v_cvt_pk_bf16_f32 v173, v138, v139
v_cvt_pk_bf16_f32 v174, v140, v141
v_cvt_pk_bf16_f32 v175, v142, v143
v_cvt_pk_bf16_f32 v176, v144, v145
v_cvt_pk_bf16_f32 v177, v146, v147
v_cvt_pk_bf16_f32 v178, v148, v149
v_cvt_pk_bf16_f32 v179, v150, v151
s_add_u32 s24, s20, 25616384
s_add_u32 s25, s24, 4096
buffer_store_dwordx4 v[168:171], v4, s[8:11], s24 offen offset:0 sc1
buffer_store_dwordx4 v[172:175], v4, s[8:11], s24 offen offset:2048 sc1
buffer_store_dwordx4 v[176:179], v4, s[8:11], s25 offen offset:0 sc1
s_lshl_b32 s24, s5, 4
s_lshr_b32 s25, s6, 1
s_add_u32 s24, s24, s25
s_lshl_b32 s24, s24, 3
s_and_b32 s25, s6, 1
s_mul_i32 s25, s25, 3
s_add_u32 s24, s24, s25
s_add_u32 s24, s24, s4
s_lshl_b32 s24, s24, 7
s_add_u32 s24, s24, 1572864
v_mov_b32 v14, 2146435072
v_cmp_eq_u32 vcc, 0, v1
s_nop 1
v_cndmask_b32 v14, v14, 0, vcc
v_mov_b32 v15, 1
s_waitcnt vmcnt(0)
buffer_store_dword v15, v14, s[8:11], s24 offen sc1
s_branch L_r_done
L_r_side:
s_barrier
s_waitcnt vmcnt(0)
L_r_done:
s_barrier
s_mov_b32 s70, 25616384
s_mov_b32 s71, 30334976
s_mov_b32 s72, 35053568
s_mov_b32 s73, 39772160
s_mov_b32 s74, 42262528
s_mov_b32 s75, 61267968
s_mov_b32 s76, 99016704
s_mov_b32 s77, 1048576
s_mov_b32 s7, 1
s_branch L_layer
L_last:
s_cmp_eq_u32 s4, 3
s_cbranch_scc1 L_end
v_and_b32 v6, 7, v1
v_lshrrev_b32 v7, 3, v1
s_mul_i32 s22, s4, 24
v_add_u32 v7, s22, v7
s_and_b32 s23, s6, 1
s_lshl_b32 s23, s23, 3
v_add_u32 v8, s23, v6
v_lshlrev_b32 v8, 4, v8
v_lshl_add_u32 v4, v7, 8, v8
s_lshl_b32 s24, s5, 4
s_lshr_b32 s25, s6, 1
s_add_u32 s24, s24, s25
s_mul_i32 s20, s24, 18432
s_lshl_b32 s24, s5, 8
s_lshl_b32 s25, s6, 3
s_add_u32 s24, s24, s25
s_and_b32 s25, s24, 1023
s_lshl_b32 s25, s25, 1
s_lshr_b32 s24, s24, 10
s_add_u32 s24, s24, s25
s_mul_i32 s21, s24, 1152
v_mul_u32_u24 v8, 2304, v6
v_lshl_add_u32 v5, v7, 4, v8
s_load_dwordx2 s[12:13], s[0:1], 56
s_waitcnt lgkmcnt(0)
s_mov_b32 s16, s12
s_and_b32 s17, s13, 0xffff
s_mov_b32 s18, 2359296
s_mov_b32 s19, 0x20000
s_add_u32 s24, s20, 39772160
s_add_u32 s25, s24, 4096
buffer_load_dwordx4 v[16:19], v4, s[8:11], s24 offen offset:0 sc1
buffer_load_dwordx4 v[20:23], v4, s[8:11], s24 offen offset:2048 sc1
buffer_load_dwordx4 v[24:27], v4, s[8:11], s25 offen offset:0 sc1
s_lshl_b32 s24, s5, 2
s_lshr_b32 s25, s6, 3
s_add_u32 s24, s24, s25
s_lshl_b32 s24, s24, 12
s_add_u32 s24, s24, 1441792
v_and_b32 v6, 31, v1
v_lshlrev_b32 v6, 7, v6
s_mov_b32 s52, 0
L_poll6:
buffer_load_dword v253, v6, s[8:11], s24 offen sc1
s_add_u32 s52, s52, 1
s_waitcnt vmcnt(0)
v_cmp_eq_u32 vcc, 0, v253
s_cmp_ge_u32 s52, 0x100000
s_cbranch_scc1 L_got6
s_and_b64 exec, exec, vcc
s_cbranch_execnz L_poll6
L_got6:
s_mov_b64 exec, -1
s_add_u32 s24, s20, 99016704
s_add_u32 s25, s24, 4096
buffer_load_dwordx4 v[28:31], v4, s[8:11], s24 offen offset:0 sc1
buffer_load_dwordx4 v[32:35], v4, s[8:11], s24 offen offset:2048 sc1
buffer_load_dwordx4 v[36:39], v4, s[8:11], s25 offen offset:0 sc1
s_add_u32 s24, s20, 101376000
s_add_u32 s25, s24, 4096
buffer_load_dwordx4 v[40:43], v4, s[8:11], s24 offen offset:0 sc1
buffer_load_dwordx4 v[44:47], v4, s[8:11], s24 offen offset:2048 sc1
buffer_load_dwordx4 v[48:51], v4, s[8:11], s25 offen offset:0 sc1
s_add_u32 s24, s20, 103735296
s_add_u32 s25, s24, 4096
buffer_load_dwordx4 v[52:55], v4, s[8:11], s24 offen offset:0 sc1
buffer_load_dwordx4 v[56:59], v4, s[8:11], s24 offen offset:2048 sc1
buffer_load_dwordx4 v[60:63], v4, s[8:11], s25 offen offset:0 sc1
s_add_u32 s24, s20, 106094592
s_add_u32 s25, s24, 4096
buffer_load_dwordx4 v[64:67], v4, s[8:11], s24 offen offset:0 sc1
buffer_load_dwordx4 v[68:71], v4, s[8:11], s24 offen offset:2048 sc1
buffer_load_dwordx4 v[72:75], v4, s[8:11], s25 offen offset:0 sc1
s_add_u32 s24, s20, 108453888
s_add_u32 s25, s24, 4096
buffer_load_dwordx4 v[76:79], v4, s[8:11], s24 offen offset:0 sc1
buffer_load_dwordx4 v[80:83], v4, s[8:11], s24 offen offset:2048 sc1
buffer_load_dwordx4 v[84:87], v4, s[8:11], s25 offen offset:0 sc1
s_add_u32 s24, s20, 110813184
s_add_u32 s25, s24, 4096
buffer_load_dwordx4 v[88:91], v4, s[8:11], s24 offen offset:0 sc1
buffer_load_dwordx4 v[92:95], v4, s[8:11], s24 offen offset:2048 sc1
buffer_load_dwordx4 v[96:99], v4, s[8:11], s25 offen offset:0 sc1
s_add_u32 s24, s20, 113172480
s_add_u32 s25, s24, 4096
buffer_load_dwordx4 v[100:103], v4, s[8:11], s24 offen offset:0 sc1
buffer_load_dwordx4 v[104:107], v4, s[8:11], s24 offen offset:2048 sc1
buffer_load_dwordx4 v[108:111], v4, s[8:11], s25 offen offset:0 sc1
s_add_u32 s24, s20, 115531776
s_add_u32 s25, s24, 4096
buffer_load_dwordx4 v[112:115], v4, s[8:11], s24 offen offset:0 sc1
buffer_load_dwordx4 v[116:119], v4, s[8:11], s24 offen offset:2048 sc1
buffer_load_dwordx4 v[120:123], v4, s[8:11], s25 offen offset:0 sc1
s_waitcnt vmcnt(26)
v_lshlrev_b32 v128, 16, v16
v_and_b32 v129, 0xffff0000, v16
v_lshlrev_b32 v130, 16, v17
v_and_b32 v131, 0xffff0000, v17
v_lshlrev_b32 v132, 16, v18
v_and_b32 v133, 0xffff0000, v18
v_lshlrev_b32 v134, 16, v19
v_and_b32 v135, 0xffff0000, v19
s_waitcnt vmcnt(25)
v_lshlrev_b32 v136, 16, v20
v_and_b32 v137, 0xffff0000, v20
v_lshlrev_b32 v138, 16, v21
v_and_b32 v139, 0xffff0000, v21
v_lshlrev_b32 v140, 16, v22
v_and_b32 v141, 0xffff0000, v22
v_lshlrev_b32 v142, 16, v23
v_and_b32 v143, 0xffff0000, v23
s_waitcnt vmcnt(24)
v_lshlrev_b32 v144, 16, v24
v_and_b32 v145, 0xffff0000, v24
v_lshlrev_b32 v146, 16, v25
v_and_b32 v147, 0xffff0000, v25
v_lshlrev_b32 v148, 16, v26
v_and_b32 v149, 0xffff0000, v26
v_lshlrev_b32 v150, 16, v27
v_and_b32 v151, 0xffff0000, v27
s_waitcnt vmcnt(23)
v_lshlrev_b32 v6, 16, v28
v_and_b32 v7, 0xffff0000, v28
v_add_f32 v128, v128, v6
v_add_f32 v129, v129, v7
v_lshlrev_b32 v8, 16, v29
v_and_b32 v9, 0xffff0000, v29
v_add_f32 v130, v130, v8
v_add_f32 v131, v131, v9
v_lshlrev_b32 v6, 16, v30
v_and_b32 v7, 0xffff0000, v30
v_add_f32 v132, v132, v6
v_add_f32 v133, v133, v7
v_lshlrev_b32 v8, 16, v31
v_and_b32 v9, 0xffff0000, v31
v_add_f32 v134, v134, v8
v_add_f32 v135, v135, v9
s_waitcnt vmcnt(22)
v_lshlrev_b32 v6, 16, v32
v_and_b32 v7, 0xffff0000, v32
v_add_f32 v136, v136, v6
v_add_f32 v137, v137, v7
v_lshlrev_b32 v8, 16, v33
v_and_b32 v9, 0xffff0000, v33
v_add_f32 v138, v138, v8
v_add_f32 v139, v139, v9
v_lshlrev_b32 v6, 16, v34
v_and_b32 v7, 0xffff0000, v34
v_add_f32 v140, v140, v6
v_add_f32 v141, v141, v7
v_lshlrev_b32 v8, 16, v35
v_and_b32 v9, 0xffff0000, v35
v_add_f32 v142, v142, v8
v_add_f32 v143, v143, v9
s_waitcnt vmcnt(21)
v_lshlrev_b32 v6, 16, v36
v_and_b32 v7, 0xffff0000, v36
v_add_f32 v144, v144, v6
v_add_f32 v145, v145, v7
v_lshlrev_b32 v8, 16, v37
v_and_b32 v9, 0xffff0000, v37
v_add_f32 v146, v146, v8
v_add_f32 v147, v147, v9
v_lshlrev_b32 v6, 16, v38
v_and_b32 v7, 0xffff0000, v38
v_add_f32 v148, v148, v6
v_add_f32 v149, v149, v7
v_lshlrev_b32 v8, 16, v39
v_and_b32 v9, 0xffff0000, v39
v_add_f32 v150, v150, v8
v_add_f32 v151, v151, v9
s_waitcnt vmcnt(20)
v_lshlrev_b32 v6, 16, v40
v_and_b32 v7, 0xffff0000, v40
v_add_f32 v128, v128, v6
v_add_f32 v129, v129, v7
v_lshlrev_b32 v8, 16, v41
v_and_b32 v9, 0xffff0000, v41
v_add_f32 v130, v130, v8
v_add_f32 v131, v131, v9
v_lshlrev_b32 v6, 16, v42
v_and_b32 v7, 0xffff0000, v42
v_add_f32 v132, v132, v6
v_add_f32 v133, v133, v7
v_lshlrev_b32 v8, 16, v43
v_and_b32 v9, 0xffff0000, v43
v_add_f32 v134, v134, v8
v_add_f32 v135, v135, v9
s_waitcnt vmcnt(19)
v_lshlrev_b32 v6, 16, v44
v_and_b32 v7, 0xffff0000, v44
v_add_f32 v136, v136, v6
v_add_f32 v137, v137, v7
v_lshlrev_b32 v8, 16, v45
v_and_b32 v9, 0xffff0000, v45
v_add_f32 v138, v138, v8
v_add_f32 v139, v139, v9
v_lshlrev_b32 v6, 16, v46
v_and_b32 v7, 0xffff0000, v46
v_add_f32 v140, v140, v6
v_add_f32 v141, v141, v7
v_lshlrev_b32 v8, 16, v47
v_and_b32 v9, 0xffff0000, v47
v_add_f32 v142, v142, v8
v_add_f32 v143, v143, v9
s_waitcnt vmcnt(18)
v_lshlrev_b32 v6, 16, v48
v_and_b32 v7, 0xffff0000, v48
v_add_f32 v144, v144, v6
v_add_f32 v145, v145, v7
v_lshlrev_b32 v8, 16, v49
v_and_b32 v9, 0xffff0000, v49
v_add_f32 v146, v146, v8
v_add_f32 v147, v147, v9
v_lshlrev_b32 v6, 16, v50
v_and_b32 v7, 0xffff0000, v50
v_add_f32 v148, v148, v6
v_add_f32 v149, v149, v7
v_lshlrev_b32 v8, 16, v51
v_and_b32 v9, 0xffff0000, v51
v_add_f32 v150, v150, v8
v_add_f32 v151, v151, v9
s_waitcnt vmcnt(17)
v_lshlrev_b32 v6, 16, v52
v_and_b32 v7, 0xffff0000, v52
v_add_f32 v128, v128, v6
v_add_f32 v129, v129, v7
v_lshlrev_b32 v8, 16, v53
v_and_b32 v9, 0xffff0000, v53
v_add_f32 v130, v130, v8
v_add_f32 v131, v131, v9
v_lshlrev_b32 v6, 16, v54
v_and_b32 v7, 0xffff0000, v54
v_add_f32 v132, v132, v6
v_add_f32 v133, v133, v7
v_lshlrev_b32 v8, 16, v55
v_and_b32 v9, 0xffff0000, v55
v_add_f32 v134, v134, v8
v_add_f32 v135, v135, v9
s_waitcnt vmcnt(16)
v_lshlrev_b32 v6, 16, v56
v_and_b32 v7, 0xffff0000, v56
v_add_f32 v136, v136, v6
v_add_f32 v137, v137, v7
v_lshlrev_b32 v8, 16, v57
v_and_b32 v9, 0xffff0000, v57
v_add_f32 v138, v138, v8
v_add_f32 v139, v139, v9
v_lshlrev_b32 v6, 16, v58
v_and_b32 v7, 0xffff0000, v58
v_add_f32 v140, v140, v6
v_add_f32 v141, v141, v7
v_lshlrev_b32 v8, 16, v59
v_and_b32 v9, 0xffff0000, v59
v_add_f32 v142, v142, v8
v_add_f32 v143, v143, v9
s_waitcnt vmcnt(15)
v_lshlrev_b32 v6, 16, v60
v_and_b32 v7, 0xffff0000, v60
v_add_f32 v144, v144, v6
v_add_f32 v145, v145, v7
v_lshlrev_b32 v8, 16, v61
v_and_b32 v9, 0xffff0000, v61
v_add_f32 v146, v146, v8
v_add_f32 v147, v147, v9
v_lshlrev_b32 v6, 16, v62
v_and_b32 v7, 0xffff0000, v62
v_add_f32 v148, v148, v6
v_add_f32 v149, v149, v7
v_lshlrev_b32 v8, 16, v63
v_and_b32 v9, 0xffff0000, v63
v_add_f32 v150, v150, v8
v_add_f32 v151, v151, v9
s_waitcnt vmcnt(14)
v_lshlrev_b32 v6, 16, v64
v_and_b32 v7, 0xffff0000, v64
v_add_f32 v128, v128, v6
v_add_f32 v129, v129, v7
v_lshlrev_b32 v8, 16, v65
v_and_b32 v9, 0xffff0000, v65
v_add_f32 v130, v130, v8
v_add_f32 v131, v131, v9
v_lshlrev_b32 v6, 16, v66
v_and_b32 v7, 0xffff0000, v66
v_add_f32 v132, v132, v6
v_add_f32 v133, v133, v7
v_lshlrev_b32 v8, 16, v67
v_and_b32 v9, 0xffff0000, v67
v_add_f32 v134, v134, v8
v_add_f32 v135, v135, v9
s_waitcnt vmcnt(13)
v_lshlrev_b32 v6, 16, v68
v_and_b32 v7, 0xffff0000, v68
v_add_f32 v136, v136, v6
v_add_f32 v137, v137, v7
v_lshlrev_b32 v8, 16, v69
v_and_b32 v9, 0xffff0000, v69
v_add_f32 v138, v138, v8
v_add_f32 v139, v139, v9
v_lshlrev_b32 v6, 16, v70
v_and_b32 v7, 0xffff0000, v70
v_add_f32 v140, v140, v6
v_add_f32 v141, v141, v7
v_lshlrev_b32 v8, 16, v71
v_and_b32 v9, 0xffff0000, v71
v_add_f32 v142, v142, v8
v_add_f32 v143, v143, v9
s_waitcnt vmcnt(12)
v_lshlrev_b32 v6, 16, v72
v_and_b32 v7, 0xffff0000, v72
v_add_f32 v144, v144, v6
v_add_f32 v145, v145, v7
v_lshlrev_b32 v8, 16, v73
v_and_b32 v9, 0xffff0000, v73
v_add_f32 v146, v146, v8
v_add_f32 v147, v147, v9
v_lshlrev_b32 v6, 16, v74
v_and_b32 v7, 0xffff0000, v74
v_add_f32 v148, v148, v6
v_add_f32 v149, v149, v7
v_lshlrev_b32 v8, 16, v75
v_and_b32 v9, 0xffff0000, v75
v_add_f32 v150, v150, v8
v_add_f32 v151, v151, v9
s_waitcnt vmcnt(11)
v_lshlrev_b32 v6, 16, v76
v_and_b32 v7, 0xffff0000, v76
v_add_f32 v128, v128, v6
v_add_f32 v129, v129, v7
v_lshlrev_b32 v8, 16, v77
v_and_b32 v9, 0xffff0000, v77
v_add_f32 v130, v130, v8
v_add_f32 v131, v131, v9
v_lshlrev_b32 v6, 16, v78
v_and_b32 v7, 0xffff0000, v78
v_add_f32 v132, v132, v6
v_add_f32 v133, v133, v7
v_lshlrev_b32 v8, 16, v79
v_and_b32 v9, 0xffff0000, v79
v_add_f32 v134, v134, v8
v_add_f32 v135, v135, v9
s_waitcnt vmcnt(10)
v_lshlrev_b32 v6, 16, v80
v_and_b32 v7, 0xffff0000, v80
v_add_f32 v136, v136, v6
v_add_f32 v137, v137, v7
v_lshlrev_b32 v8, 16, v81
v_and_b32 v9, 0xffff0000, v81
v_add_f32 v138, v138, v8
v_add_f32 v139, v139, v9
v_lshlrev_b32 v6, 16, v82
v_and_b32 v7, 0xffff0000, v82
v_add_f32 v140, v140, v6
v_add_f32 v141, v141, v7
v_lshlrev_b32 v8, 16, v83
v_and_b32 v9, 0xffff0000, v83
v_add_f32 v142, v142, v8
v_add_f32 v143, v143, v9
s_waitcnt vmcnt(9)
v_lshlrev_b32 v6, 16, v84
v_and_b32 v7, 0xffff0000, v84
v_add_f32 v144, v144, v6
v_add_f32 v145, v145, v7
v_lshlrev_b32 v8, 16, v85
v_and_b32 v9, 0xffff0000, v85
v_add_f32 v146, v146, v8
v_add_f32 v147, v147, v9
v_lshlrev_b32 v6, 16, v86
v_and_b32 v7, 0xffff0000, v86
v_add_f32 v148, v148, v6
v_add_f32 v149, v149, v7
v_lshlrev_b32 v8, 16, v87
v_and_b32 v9, 0xffff0000, v87
v_add_f32 v150, v150, v8
v_add_f32 v151, v151, v9
s_waitcnt vmcnt(8)
v_lshlrev_b32 v6, 16, v88
v_and_b32 v7, 0xffff0000, v88
v_add_f32 v128, v128, v6
v_add_f32 v129, v129, v7
v_lshlrev_b32 v8, 16, v89
v_and_b32 v9, 0xffff0000, v89
v_add_f32 v130, v130, v8
v_add_f32 v131, v131, v9
v_lshlrev_b32 v6, 16, v90
v_and_b32 v7, 0xffff0000, v90
v_add_f32 v132, v132, v6
v_add_f32 v133, v133, v7
v_lshlrev_b32 v8, 16, v91
v_and_b32 v9, 0xffff0000, v91
v_add_f32 v134, v134, v8
v_add_f32 v135, v135, v9
s_waitcnt vmcnt(7)
v_lshlrev_b32 v6, 16, v92
v_and_b32 v7, 0xffff0000, v92
v_add_f32 v136, v136, v6
v_add_f32 v137, v137, v7
v_lshlrev_b32 v8, 16, v93
v_and_b32 v9, 0xffff0000, v93
v_add_f32 v138, v138, v8
v_add_f32 v139, v139, v9
v_lshlrev_b32 v6, 16, v94
v_and_b32 v7, 0xffff0000, v94
v_add_f32 v140, v140, v6
v_add_f32 v141, v141, v7
v_lshlrev_b32 v8, 16, v95
v_and_b32 v9, 0xffff0000, v95
v_add_f32 v142, v142, v8
v_add_f32 v143, v143, v9
s_waitcnt vmcnt(6)
v_lshlrev_b32 v6, 16, v96
v_and_b32 v7, 0xffff0000, v96
v_add_f32 v144, v144, v6
v_add_f32 v145, v145, v7
v_lshlrev_b32 v8, 16, v97
v_and_b32 v9, 0xffff0000, v97
v_add_f32 v146, v146, v8
v_add_f32 v147, v147, v9
v_lshlrev_b32 v6, 16, v98
v_and_b32 v7, 0xffff0000, v98
v_add_f32 v148, v148, v6
v_add_f32 v149, v149, v7
v_lshlrev_b32 v8, 16, v99
v_and_b32 v9, 0xffff0000, v99
v_add_f32 v150, v150, v8
v_add_f32 v151, v151, v9
s_waitcnt vmcnt(5)
v_lshlrev_b32 v6, 16, v100
v_and_b32 v7, 0xffff0000, v100
v_add_f32 v128, v128, v6
v_add_f32 v129, v129, v7
v_lshlrev_b32 v8, 16, v101
v_and_b32 v9, 0xffff0000, v101
v_add_f32 v130, v130, v8
v_add_f32 v131, v131, v9
v_lshlrev_b32 v6, 16, v102
v_and_b32 v7, 0xffff0000, v102
v_add_f32 v132, v132, v6
v_add_f32 v133, v133, v7
v_lshlrev_b32 v8, 16, v103
v_and_b32 v9, 0xffff0000, v103
v_add_f32 v134, v134, v8
v_add_f32 v135, v135, v9
s_waitcnt vmcnt(4)
v_lshlrev_b32 v6, 16, v104
v_and_b32 v7, 0xffff0000, v104
v_add_f32 v136, v136, v6
v_add_f32 v137, v137, v7
v_lshlrev_b32 v8, 16, v105
v_and_b32 v9, 0xffff0000, v105
v_add_f32 v138, v138, v8
v_add_f32 v139, v139, v9
v_lshlrev_b32 v6, 16, v106
v_and_b32 v7, 0xffff0000, v106
v_add_f32 v140, v140, v6
v_add_f32 v141, v141, v7
v_lshlrev_b32 v8, 16, v107
v_and_b32 v9, 0xffff0000, v107
v_add_f32 v142, v142, v8
v_add_f32 v143, v143, v9
s_waitcnt vmcnt(3)
v_lshlrev_b32 v6, 16, v108
v_and_b32 v7, 0xffff0000, v108
v_add_f32 v144, v144, v6
v_add_f32 v145, v145, v7
v_lshlrev_b32 v8, 16, v109
v_and_b32 v9, 0xffff0000, v109
v_add_f32 v146, v146, v8
v_add_f32 v147, v147, v9
v_lshlrev_b32 v6, 16, v110
v_and_b32 v7, 0xffff0000, v110
v_add_f32 v148, v148, v6
v_add_f32 v149, v149, v7
v_lshlrev_b32 v8, 16, v111
v_and_b32 v9, 0xffff0000, v111
v_add_f32 v150, v150, v8
v_add_f32 v151, v151, v9
s_waitcnt vmcnt(2)
v_lshlrev_b32 v6, 16, v112
v_and_b32 v7, 0xffff0000, v112
v_add_f32 v128, v128, v6
v_add_f32 v129, v129, v7
v_lshlrev_b32 v8, 16, v113
v_and_b32 v9, 0xffff0000, v113
v_add_f32 v130, v130, v8
v_add_f32 v131, v131, v9
v_lshlrev_b32 v6, 16, v114
v_and_b32 v7, 0xffff0000, v114
v_add_f32 v132, v132, v6
v_add_f32 v133, v133, v7
v_lshlrev_b32 v8, 16, v115
v_and_b32 v9, 0xffff0000, v115
v_add_f32 v134, v134, v8
v_add_f32 v135, v135, v9
s_waitcnt vmcnt(1)
v_lshlrev_b32 v6, 16, v116
v_and_b32 v7, 0xffff0000, v116
v_add_f32 v136, v136, v6
v_add_f32 v137, v137, v7
v_lshlrev_b32 v8, 16, v117
v_and_b32 v9, 0xffff0000, v117
v_add_f32 v138, v138, v8
v_add_f32 v139, v139, v9
v_lshlrev_b32 v6, 16, v118
v_and_b32 v7, 0xffff0000, v118
v_add_f32 v140, v140, v6
v_add_f32 v141, v141, v7
v_lshlrev_b32 v8, 16, v119
v_and_b32 v9, 0xffff0000, v119
v_add_f32 v142, v142, v8
v_add_f32 v143, v143, v9
s_waitcnt vmcnt(0)
v_lshlrev_b32 v6, 16, v120
v_and_b32 v7, 0xffff0000, v120
v_add_f32 v144, v144, v6
v_add_f32 v145, v145, v7
v_lshlrev_b32 v8, 16, v121
v_and_b32 v9, 0xffff0000, v121
v_add_f32 v146, v146, v8
v_add_f32 v147, v147, v9
v_lshlrev_b32 v6, 16, v122
v_and_b32 v7, 0xffff0000, v122
v_add_f32 v148, v148, v6
v_add_f32 v149, v149, v7
v_lshlrev_b32 v8, 16, v123
v_and_b32 v9, 0xffff0000, v123
v_add_f32 v150, v150, v8
v_add_f32 v151, v151, v9
v_cvt_pk_bf16_f32 v152, v128, v129
v_cvt_pk_bf16_f32 v153, v130, v131
v_cvt_pk_bf16_f32 v154, v132, v133
v_cvt_pk_bf16_f32 v155, v134, v135
v_cvt_pk_bf16_f32 v156, v136, v137
v_cvt_pk_bf16_f32 v157, v138, v139
v_cvt_pk_bf16_f32 v158, v140, v141
v_cvt_pk_bf16_f32 v159, v142, v143
v_cvt_pk_bf16_f32 v160, v144, v145
v_cvt_pk_bf16_f32 v161, v146, v147
v_cvt_pk_bf16_f32 v162, v148, v149
v_cvt_pk_bf16_f32 v163, v150, v151
buffer_store_dwordx4 v[152:155], v5, s[16:19], s21 offen offset:0
buffer_store_dwordx4 v[156:159], v5, s[16:19], s21 offen offset:128
buffer_store_dwordx4 v[160:163], v5, s[16:19], s21 offen offset:256
L_end:
s_endpgm
L_f_slow1:
s_mov_b32 s52, 0
L_f_spin1:
buffer_load_dword v13, v11, s[8:11], s34 offen sc1
s_add_u32 s52, s52, 1
s_waitcnt vmcnt(0)
v_cmp_le_u32 vcc, 1, v13
s_cmp_gt_u32 s52, 0x100000
s_cbranch_scc1 L_f_back1
s_cmp_eq_u64 vcc, exec
s_cbranch_scc0 L_f_spin1
s_branch L_f_back1
L_f_slow2:
s_mov_b32 s52, 0
L_f_spin2:
buffer_load_dword v13, v11, s[8:11], s34 offen sc1
s_add_u32 s52, s52, 1
s_waitcnt vmcnt(0)
v_cmp_le_u32 vcc, 2, v13
s_cmp_gt_u32 s52, 0x100000
s_cbranch_scc1 L_f_back2
s_cmp_eq_u64 vcc, exec
s_cbranch_scc0 L_f_spin2
s_branch L_f_back2
L_f_slow3:
s_mov_b32 s52, 0
L_f_spin3:
buffer_load_dword v13, v11, s[8:11], s34 offen sc1
s_add_u32 s52, s52, 1
s_waitcnt vmcnt(0)
v_cmp_le_u32 vcc, 3, v13
s_cmp_gt_u32 s52, 0x100000
s_cbranch_scc1 L_f_back3
s_cmp_eq_u64 vcc, exec
s_cbranch_scc0 L_f_spin3
s_branch L_f_back3
.section .rodata,"a"
.p2align 6
.amdhsa_kernel prep_kernel
  .amdhsa_next_free_vgpr 184
  .amdhsa_next_free_sgpr 102
  .amdhsa_accum_offset 184
  .amdhsa_group_segment_fixed_size 0
  .amdhsa_kernarg_size 80
  .amdhsa_user_sgpr_count 2
  .amdhsa_user_sgpr_kernarg_segment_ptr 1
  .amdhsa_system_sgpr_workgroup_id_x 1
.end_amdhsa_kernel
.p2align 6
.amdhsa_kernel main_kernel
  .amdhsa_next_free_vgpr 512
  .amdhsa_next_free_sgpr 102
  .amdhsa_accum_offset 256
  .amdhsa_group_segment_fixed_size 0
  .amdhsa_kernarg_size 80
  .amdhsa_user_sgpr_count 2
  .amdhsa_user_sgpr_kernarg_segment_ptr 1
  .amdhsa_system_sgpr_workgroup_id_x 1
.end_amdhsa_kernel
```

```asm
; @launch grid=(256,1,1) block=(256,1,1) lds=159744
.amdgcn_target "amdgcn-amd-amdhsa--gfx950"
.text
.p2align 8
.globl interleave_layers__sliding_local_dilated__glu_gated_geglu__prompt_kernel
.type interleave_layers__sliding_local_dilated__glu_gated_geglu__prompt_kernel,@function
interleave_layers__sliding_local_dilated__glu_gated_geglu__prompt_kernel:
s_cmp_ge_u32 s2, 256
s_cbranch_scc1 L_end
s_mov_b32 s70, 23261184
s_mov_b32 s71, 27979776
s_mov_b32 s72, 32698368
s_mov_b32 s73, 37416960
s_mov_b32 s74, 42135552
s_mov_b32 s75, 42397696
s_mov_b32 s76, 80146432
s_mov_b32 s77, 0
s_mov_b32 s7, 0
s_load_dwordx4 s[56:59], s[0:1], 0
s_load_dwordx2 s[60:61], s[0:1], 16
s_load_dwordx4 s[64:67], s[0:1], 32
s_load_dwordx2 s[62:63], s[0:1], 48
s_load_dwordx2 s[26:27], s[0:1], 64
s_load_dwordx2 s[12:13], s[0:1], 72
v_and_b32 v1, 63, v0
v_lshrrev_b32 v3, 6, v0
v_lshlrev_b32 v2, 4, v1
v_readfirstlane_b32 s4, v3
s_and_b32 s5, s2, 7
s_lshr_b32 s6, s2, 3
s_waitcnt lgkmcnt(0)
s_mov_b32 s8, s12
s_and_b32 s9, s13, 0xffff
s_mov_b32 s10, 268435456
s_mov_b32 s11, 0x20000
s_mov_b32 s16, s56
s_and_b32 s17, s57, 0xffff
s_mov_b32 s18, 2359296
s_mov_b32 s19, 0x20000
v_mov_b32 v3, 4194304
buffer_load_dwordx2 v[14:15], v3, s[8:11], 0 offen sc1
v_and_b32 v6, 7, v1
v_lshrrev_b32 v7, 3, v1
s_mul_i32 s22, s4, 24
v_add_u32 v7, s22, v7
s_and_b32 s23, s6, 1
s_lshl_b32 s23, s23, 3
v_add_u32 v8, s23, v6
v_lshlrev_b32 v8, 4, v8
v_lshl_add_u32 v4, v7, 8, v8
s_lshl_b32 s24, s5, 4
s_lshr_b32 s25, s6, 1
s_add_u32 s24, s24, s25
s_mul_i32 s20, s24, 18432
s_lshl_b32 s24, s5, 8
s_lshl_b32 s25, s6, 3
s_add_u32 s24, s24, s25
s_and_b32 s25, s24, 1023
s_lshl_b32 s25, s25, 1
s_lshr_b32 s24, s24, 10
s_add_u32 s24, s24, s25
s_mul_i32 s21, s24, 1152
v_mul_u32_u24 v8, 2304, v6
v_lshl_add_u32 v5, v7, 4, v8
s_cmp_eq_u32 s4, 3
s_cselect_b64 vcc, -1, 0
v_mov_b32 v8, 2146435072
v_cndmask_b32 v4, v4, v8, vcc
v_cndmask_b32 v5, v5, v8, vcc
buffer_load_dwordx4 v[16:19], v5, s[16:19], s21 offen offset:0
buffer_load_dwordx4 v[20:23], v5, s[16:19], s21 offen offset:128
buffer_load_dwordx4 v[24:27], v5, s[16:19], s21 offen offset:256
s_lshl_b32 s40, s6, 2
s_add_u32 s40, s40, s4
v_and_b32 v6, 15, v1
v_lshrrev_b32 v7, 4, v1
v_lshrrev_b32 v8, 2, v6
v_mov_b32 v12, 2146435072
s_lshl_b32 s39, s5, 7
s_add_u32 s39, s39, s40
s_lshl_b32 s39, s39, 7
s_add_u32 s39, s39, 917504
s_cmp_ge_u32 s40, 96
s_cbranch_scc1 L_g_o
s_mov_b32 s44, s58
s_and_b32 s45, s59, 0xffff
s_mov_b32 s46, 1990656
s_mov_b32 s47, 0x20000
s_cmp_ge_u32 s40, 48
s_cselect_b32 s41, 1, 0
s_mul_i32 s42, s41, 48
s_sub_u32 s40, s40, s42
s_mul_i32 s40, s40, 3
s_lshl_b32 s42, s5, 1
s_add_u32 s41, s41, s42
s_mul_i32 s38, s41, 147456
s_lshl_b32 s42, s40, 10
s_add_u32 s38, s38, s42
s_add_u32 s38, s38, 4198400
s_mul_i32 s41, s41, 36
v_and_b32 v9, 1, v6
v_bfe_u32 v10, v6, 1, 1
v_mul_u32_u24 v10, 18, v10
v_add_u32 v9, v9, v10
v_mul_u32_u24 v10, 576, v8
v_add_u32 v9, v9, v10
v_mul_u32_u24 v10, 27648, v7
s_add_u32 s42, s40, 0
s_and_b32 s43, s42, 7
s_lshr_b32 s42, s42, 3
s_mul_i32 s42, s42, 110592
s_mov_b32 s35, 0
s_cmp_eq_u32 s43, 1
s_cselect_b32 s35, 18, s35
s_cmp_eq_u32 s43, 2
s_cselect_b32 s35, 576, s35
s_cmp_eq_u32 s43, 3
s_cselect_b32 s35, 594, s35
s_cmp_eq_u32 s43, 4
s_cselect_b32 s35, 16, s35
s_cmp_eq_u32 s43, 5
s_cselect_b32 s35, 1152, s35
s_cmp_eq_u32 s43, 6
s_cselect_b32 s35, 1170, s35
s_cmp_eq_u32 s43, 7
s_cselect_b32 s35, 1168, s35
s_add_u32 s35, s35, s41
s_mov_b32 s36, 16
s_cmp_eq_u32 s43, 4
s_cselect_b32 s36, 8, s36
s_cmp_eq_u32 s43, 7
s_cselect_b32 s36, 4, s36
s_cmp_lg_u32 s36, 16
s_cselect_b64 vcc, -1, 0
v_cndmask_b32 v11, v6, v9, vcc
v_add_u32 v11, s35, v11
v_lshl_add_u32 v11, v11, 1, v10
v_cmp_gt_u32 vcc, s36, v6
s_nop 1
v_cndmask_b32 v11, v12, v11, vcc
buffer_load_ushort v52, v11, s[44:47], s42 offen
s_add_u32 s42, s42, 3456
buffer_load_ushort v53, v11, s[44:47], s42 offen
s_add_u32 s42, s42, 3456
buffer_load_ushort v54, v11, s[44:47], s42 offen
s_add_u32 s42, s42, 3456
buffer_load_ushort v55, v11, s[44:47], s42 offen
s_add_u32 s42, s42, 3456
buffer_load_ushort v56, v11, s[44:47], s42 offen
s_add_u32 s42, s42, 3456
buffer_load_ushort v57, v11, s[44:47], s42 offen
s_add_u32 s42, s42, 3456
buffer_load_ushort v58, v11, s[44:47], s42 offen
s_add_u32 s42, s42, 3456
buffer_load_ushort v59, v11, s[44:47], s42 offen
s_add_u32 s42, s40, 1
s_and_b32 s43, s42, 7
s_lshr_b32 s42, s42, 3
s_mul_i32 s42, s42, 110592
s_mov_b32 s35, 0
s_cmp_eq_u32 s43, 1
s_cselect_b32 s35, 18, s35
s_cmp_eq_u32 s43, 2
s_cselect_b32 s35, 576, s35
s_cmp_eq_u32 s43, 3
s_cselect_b32 s35, 594, s35
s_cmp_eq_u32 s43, 4
s_cselect_b32 s35, 16, s35
s_cmp_eq_u32 s43, 5
s_cselect_b32 s35, 1152, s35
s_cmp_eq_u32 s43, 6
s_cselect_b32 s35, 1170, s35
s_cmp_eq_u32 s43, 7
s_cselect_b32 s35, 1168, s35
s_add_u32 s35, s35, s41
s_mov_b32 s36, 16
s_cmp_eq_u32 s43, 4
s_cselect_b32 s36, 8, s36
s_cmp_eq_u32 s43, 7
s_cselect_b32 s36, 4, s36
s_cmp_lg_u32 s36, 16
s_cselect_b64 vcc, -1, 0
v_cndmask_b32 v11, v6, v9, vcc
v_add_u32 v11, s35, v11
v_lshl_add_u32 v11, v11, 1, v10
v_cmp_gt_u32 vcc, s36, v6
s_nop 1
v_cndmask_b32 v11, v12, v11, vcc
buffer_load_ushort v60, v11, s[44:47], s42 offen
s_add_u32 s42, s42, 3456
buffer_load_ushort v61, v11, s[44:47], s42 offen
s_add_u32 s42, s42, 3456
buffer_load_ushort v62, v11, s[44:47], s42 offen
s_add_u32 s42, s42, 3456
buffer_load_ushort v63, v11, s[44:47], s42 offen
s_add_u32 s42, s42, 3456
buffer_load_ushort v64, v11, s[44:47], s42 offen
s_add_u32 s42, s42, 3456
buffer_load_ushort v65, v11, s[44:47], s42 offen
s_add_u32 s42, s42, 3456
buffer_load_ushort v66, v11, s[44:47], s42 offen
s_add_u32 s42, s42, 3456
buffer_load_ushort v67, v11, s[44:47], s42 offen
s_add_u32 s42, s40, 2
s_and_b32 s43, s42, 7
s_lshr_b32 s42, s42, 3
s_mul_i32 s42, s42, 110592
s_mov_b32 s35, 0
s_cmp_eq_u32 s43, 1
s_cselect_b32 s35, 18, s35
s_cmp_eq_u32 s43, 2
s_cselect_b32 s35, 576, s35
s_cmp_eq_u32 s43, 3
s_cselect_b32 s35, 594, s35
s_cmp_eq_u32 s43, 4
s_cselect_b32 s35, 16, s35
s_cmp_eq_u32 s43, 5
s_cselect_b32 s35, 1152, s35
s_cmp_eq_u32 s43, 6
s_cselect_b32 s35, 1170, s35
s_cmp_eq_u32 s43, 7
s_cselect_b32 s35, 1168, s35
s_add_u32 s35, s35, s41
s_mov_b32 s36, 16
s_cmp_eq_u32 s43, 4
s_cselect_b32 s36, 8, s36
s_cmp_eq_u32 s43, 7
s_cselect_b32 s36, 4, s36
s_cmp_lg_u32 s36, 16
s_cselect_b64 vcc, -1, 0
v_cndmask_b32 v11, v6, v9, vcc
v_add_u32 v11, s35, v11
v_lshl_add_u32 v11, v11, 1, v10
v_cmp_gt_u32 vcc, s36, v6
s_nop 1
v_cndmask_b32 v11, v12, v11, vcc
buffer_load_ushort v68, v11, s[44:47], s42 offen
s_add_u32 s42, s42, 3456
buffer_load_ushort v69, v11, s[44:47], s42 offen
s_add_u32 s42, s42, 3456
buffer_load_ushort v70, v11, s[44:47], s42 offen
s_add_u32 s42, s42, 3456
buffer_load_ushort v71, v11, s[44:47], s42 offen
s_add_u32 s42, s42, 3456
buffer_load_ushort v72, v11, s[44:47], s42 offen
s_add_u32 s42, s42, 3456
buffer_load_ushort v73, v11, s[44:47], s42 offen
s_add_u32 s42, s42, 3456
buffer_load_ushort v74, v11, s[44:47], s42 offen
s_add_u32 s42, s42, 3456
buffer_load_ushort v75, v11, s[44:47], s42 offen
s_branch L_g_done
L_g_o:
s_mov_b32 s44, s60
s_and_b32 s45, s61, 0xffff
s_mov_b32 s46, 663552
s_mov_b32 s47, 0x20000
s_sub_u32 s40, s40, 96
s_mul_i32 s40, s40, 3
s_mul_i32 s38, s5, 92160
s_lshl_b32 s42, s40, 10
s_add_u32 s38, s38, s42
s_add_u32 s38, s38, 6557696
s_cmp_ge_u32 s40, 90
s_cselect_b32 s38, 2146435072, s38
s_mul_i32 s41, s5, 72
v_and_b32 v9, 3, v6
v_lshl_add_u32 v9, v8, 3, v9
s_add_u32 s42, s40, 0
s_mul_i32 s43, s42, 13108
s_lshr_b32 s43, s43, 16
s_mul_i32 s35, s43, 5
s_sub_u32 s42, s42, s35
s_lshr_b32 s35, s42, 1
s_lshl_b32 s35, s35, 5
s_and_b32 s36, s42, 1
s_lshl_b32 s36, s36, 2
s_add_u32 s35, s35, s36
s_add_u32 s35, s35, s41
s_cmp_eq_u32 s42, 4
s_cselect_b64 vcc, -1, 0
s_cselect_b32 s36, 8, 16
v_cndmask_b32 v11, v9, v6, vcc
v_add_u32 v11, s35, v11
s_mul_i32 s35, s43, 41472
s_sub_u32 s37, s43, 16
s_mul_i32 s37, s37, 331776
s_cmp_lt_u32 s43, 16
s_cselect_b32 s35, s35, s37
s_cselect_b32 s37, 4, 72
s_cselect_b32 s34, 0, 1
s_mul_i32 s37, s37, 1152
v_mul_lo_u32 v10, s37, v7
v_lshl_add_u32 v11, v11, 1, v10
v_cmp_gt_u32 vcc, s36, v6
s_nop 1
v_cndmask_b32 v11, v12, v11, vcc
s_mul_i32 s42, s34, 18432
s_add_u32 s42, s42, 0
s_add_u32 s42, s42, s35
buffer_load_ushort v52, v11, s[44:47], s42 offen
s_mul_i32 s42, s34, 18432
s_add_u32 s42, s42, 1152
s_add_u32 s42, s42, s35
buffer_load_ushort v53, v11, s[44:47], s42 offen
s_mul_i32 s42, s34, 36864
s_add_u32 s42, s42, 2304
s_add_u32 s42, s42, s35
buffer_load_ushort v54, v11, s[44:47], s42 offen
s_mul_i32 s42, s34, 36864
s_add_u32 s42, s42, 3456
s_add_u32 s42, s42, s35
buffer_load_ushort v55, v11, s[44:47], s42 offen
s_mul_i32 s42, s34, 39168
s_add_u32 s42, s42, 20736
s_add_u32 s42, s42, s35
buffer_load_ushort v56, v11, s[44:47], s42 offen
s_mul_i32 s42, s34, 39168
s_add_u32 s42, s42, 21888
s_add_u32 s42, s42, s35
buffer_load_ushort v57, v11, s[44:47], s42 offen
s_mul_i32 s42, s34, 57600
s_add_u32 s42, s42, 23040
s_add_u32 s42, s42, s35
buffer_load_ushort v58, v11, s[44:47], s42 offen
s_mul_i32 s42, s34, 57600
s_add_u32 s42, s42, 24192
s_add_u32 s42, s42, s35
buffer_load_ushort v59, v11, s[44:47], s42 offen
s_add_u32 s42, s40, 1
s_mul_i32 s43, s42, 13108
s_lshr_b32 s43, s43, 16
s_mul_i32 s35, s43, 5
s_sub_u32 s42, s42, s35
s_lshr_b32 s35, s42, 1
s_lshl_b32 s35, s35, 5
s_and_b32 s36, s42, 1
s_lshl_b32 s36, s36, 2
s_add_u32 s35, s35, s36
s_add_u32 s35, s35, s41
s_cmp_eq_u32 s42, 4
s_cselect_b64 vcc, -1, 0
s_cselect_b32 s36, 8, 16
v_cndmask_b32 v11, v9, v6, vcc
v_add_u32 v11, s35, v11
s_mul_i32 s35, s43, 41472
s_sub_u32 s37, s43, 16
s_mul_i32 s37, s37, 331776
s_cmp_lt_u32 s43, 16
s_cselect_b32 s35, s35, s37
s_cselect_b32 s37, 4, 72
s_cselect_b32 s34, 0, 1
s_mul_i32 s37, s37, 1152
v_mul_lo_u32 v10, s37, v7
v_lshl_add_u32 v11, v11, 1, v10
v_cmp_gt_u32 vcc, s36, v6
s_nop 1
v_cndmask_b32 v11, v12, v11, vcc
s_mul_i32 s42, s34, 18432
s_add_u32 s42, s42, 0
s_add_u32 s42, s42, s35
buffer_load_ushort v60, v11, s[44:47], s42 offen
s_mul_i32 s42, s34, 18432
s_add_u32 s42, s42, 1152
s_add_u32 s42, s42, s35
buffer_load_ushort v61, v11, s[44:47], s42 offen
s_mul_i32 s42, s34, 36864
s_add_u32 s42, s42, 2304
s_add_u32 s42, s42, s35
buffer_load_ushort v62, v11, s[44:47], s42 offen
s_mul_i32 s42, s34, 36864
s_add_u32 s42, s42, 3456
s_add_u32 s42, s42, s35
buffer_load_ushort v63, v11, s[44:47], s42 offen
s_mul_i32 s42, s34, 39168
s_add_u32 s42, s42, 20736
s_add_u32 s42, s42, s35
buffer_load_ushort v64, v11, s[44:47], s42 offen
s_mul_i32 s42, s34, 39168
s_add_u32 s42, s42, 21888
s_add_u32 s42, s42, s35
buffer_load_ushort v65, v11, s[44:47], s42 offen
s_mul_i32 s42, s34, 57600
s_add_u32 s42, s42, 23040
s_add_u32 s42, s42, s35
buffer_load_ushort v66, v11, s[44:47], s42 offen
s_mul_i32 s42, s34, 57600
s_add_u32 s42, s42, 24192
s_add_u32 s42, s42, s35
buffer_load_ushort v67, v11, s[44:47], s42 offen
s_add_u32 s42, s40, 2
s_mul_i32 s43, s42, 13108
s_lshr_b32 s43, s43, 16
s_mul_i32 s35, s43, 5
s_sub_u32 s42, s42, s35
s_lshr_b32 s35, s42, 1
s_lshl_b32 s35, s35, 5
s_and_b32 s36, s42, 1
s_lshl_b32 s36, s36, 2
s_add_u32 s35, s35, s36
s_add_u32 s35, s35, s41
s_cmp_eq_u32 s42, 4
s_cselect_b64 vcc, -1, 0
s_cselect_b32 s36, 8, 16
v_cndmask_b32 v11, v9, v6, vcc
v_add_u32 v11, s35, v11
s_mul_i32 s35, s43, 41472
s_sub_u32 s37, s43, 16
s_mul_i32 s37, s37, 331776
s_cmp_lt_u32 s43, 16
s_cselect_b32 s35, s35, s37
s_cselect_b32 s37, 4, 72
s_cselect_b32 s34, 0, 1
s_mul_i32 s37, s37, 1152
v_mul_lo_u32 v10, s37, v7
v_lshl_add_u32 v11, v11, 1, v10
v_cmp_gt_u32 vcc, s36, v6
s_nop 1
v_cndmask_b32 v11, v12, v11, vcc
s_mul_i32 s42, s34, 18432
s_add_u32 s42, s42, 0
s_add_u32 s42, s42, s35
buffer_load_ushort v68, v11, s[44:47], s42 offen
s_mul_i32 s42, s34, 18432
s_add_u32 s42, s42, 1152
s_add_u32 s42, s42, s35
buffer_load_ushort v69, v11, s[44:47], s42 offen
s_mul_i32 s42, s34, 36864
s_add_u32 s42, s42, 2304
s_add_u32 s42, s42, s35
buffer_load_ushort v70, v11, s[44:47], s42 offen
s_mul_i32 s42, s34, 36864
s_add_u32 s42, s42, 3456
s_add_u32 s42, s42, s35
buffer_load_ushort v71, v11, s[44:47], s42 offen
s_mul_i32 s42, s34, 39168
s_add_u32 s42, s42, 20736
s_add_u32 s42, s42, s35
buffer_load_ushort v72, v11, s[44:47], s42 offen
s_mul_i32 s42, s34, 39168
s_add_u32 s42, s42, 21888
s_add_u32 s42, s42, s35
buffer_load_ushort v73, v11, s[44:47], s42 offen
s_mul_i32 s42, s34, 57600
s_add_u32 s42, s42, 23040
s_add_u32 s42, s42, s35
buffer_load_ushort v74, v11, s[44:47], s42 offen
s_mul_i32 s42, s34, 57600
s_add_u32 s42, s42, 24192
s_add_u32 s42, s42, s35
buffer_load_ushort v75, v11, s[44:47], s42 offen
L_g_done:
s_getpc_b64 s[40:41]
s_lshl_b32 s42, s6, 2
s_add_u32 s42, s42, s4
s_lshl_b32 s42, s42, 9
s_min_u32 s42, s42, L_code_end - L_warm_pc - 512
s_add_u32 s40, s40, s42
s_addc_u32 s41, s41, 0
v_lshlrev_b32 v10, 3, v1
v_mov_b32 v11, s41
v_add_co_u32 v10, vcc, s40, v10
s_nop 1
v_addc_co_u32 v11, vcc, 0, v11, vcc
L_warm_pc:
global_load_dwordx2 a[0:1], v[10:11], off
s_cmp_ge_u32 s2, 144
s_cbranch_scc1 L_l_d
s_mul_i32 s40, s2, 911
s_lshr_b32 s40, s40, 16
s_mul_i32 s41, s40, 72
s_sub_u32 s41, s2, s41
s_cmp_eq_u32 s40, 0
s_cselect_b64 s[12:13], s[64:65], s[66:67]
s_mov_b32 s48, s12
s_and_b32 s49, s13, 0xffff
s_mov_b32 s50, 5308416
s_mov_b32 s51, 0x20000
s_lshl_b32 s41, s41, 7
v_lshlrev_b32 v9, 3, v6
v_mul_u32_u24 v10, 73728, v7
v_add3_u32 v9, v9, v10, s41
s_and_b32 s42, s4, 1
s_cmp_eq_u32 s42, 1
s_cselect_b64 vcc, -1, 0
v_cndmask_b32 v10, v9, v12, vcc
s_mul_i32 s42, s4, 9
s_add_u32 s42, s42, 1
s_lshr_b32 s42, s42, 1
s_mul_i32 s42, s42, 294912
buffer_load_dwordx2 v[76:77], v9, s[48:51], s42 offen
s_add_u32 s42, s42, 9216
buffer_load_dwordx2 v[78:79], v9, s[48:51], s42 offen
s_add_u32 s42, s42, 9216
buffer_load_dwordx2 v[80:81], v9, s[48:51], s42 offen
s_add_u32 s42, s42, 9216
buffer_load_dwordx2 v[82:83], v9, s[48:51], s42 offen
s_add_u32 s42, s42, 9216
buffer_load_dwordx2 v[84:85], v9, s[48:51], s42 offen
s_add_u32 s42, s42, 9216
buffer_load_dwordx2 v[86:87], v9, s[48:51], s42 offen
s_add_u32 s42, s42, 9216
buffer_load_dwordx2 v[88:89], v9, s[48:51], s42 offen
s_add_u32 s42, s42, 9216
buffer_load_dwordx2 v[90:91], v9, s[48:51], s42 offen
s_add_u32 s42, s42, 230400
buffer_load_dwordx2 v[92:93], v9, s[48:51], s42 offen
s_add_u32 s42, s42, 9216
buffer_load_dwordx2 v[94:95], v9, s[48:51], s42 offen
s_add_u32 s42, s42, 9216
buffer_load_dwordx2 v[96:97], v9, s[48:51], s42 offen
s_add_u32 s42, s42, 9216
buffer_load_dwordx2 v[98:99], v9, s[48:51], s42 offen
s_add_u32 s42, s42, 9216
buffer_load_dwordx2 v[100:101], v9, s[48:51], s42 offen
s_add_u32 s42, s42, 9216
buffer_load_dwordx2 v[102:103], v9, s[48:51], s42 offen
s_add_u32 s42, s42, 9216
buffer_load_dwordx2 v[104:105], v9, s[48:51], s42 offen
s_add_u32 s42, s42, 9216
buffer_load_dwordx2 v[106:107], v9, s[48:51], s42 offen
s_add_u32 s42, s42, 230400
buffer_load_dwordx2 v[108:109], v9, s[48:51], s42 offen
s_add_u32 s42, s42, 9216
buffer_load_dwordx2 v[110:111], v9, s[48:51], s42 offen
s_add_u32 s42, s42, 9216
buffer_load_dwordx2 v[112:113], v9, s[48:51], s42 offen
s_add_u32 s42, s42, 9216
buffer_load_dwordx2 v[114:115], v9, s[48:51], s42 offen
s_add_u32 s42, s42, 9216
buffer_load_dwordx2 v[116:117], v9, s[48:51], s42 offen
s_add_u32 s42, s42, 9216
buffer_load_dwordx2 v[118:119], v9, s[48:51], s42 offen
s_add_u32 s42, s42, 9216
buffer_load_dwordx2 v[120:121], v9, s[48:51], s42 offen
s_add_u32 s42, s42, 9216
buffer_load_dwordx2 v[122:123], v9, s[48:51], s42 offen
s_add_u32 s42, s42, 230400
buffer_load_dwordx2 v[124:125], v9, s[48:51], s42 offen
s_add_u32 s42, s42, 9216
buffer_load_dwordx2 v[126:127], v9, s[48:51], s42 offen
s_add_u32 s42, s42, 9216
buffer_load_dwordx2 v[128:129], v9, s[48:51], s42 offen
s_add_u32 s42, s42, 9216
buffer_load_dwordx2 v[130:131], v9, s[48:51], s42 offen
s_add_u32 s42, s42, 9216
buffer_load_dwordx2 v[132:133], v9, s[48:51], s42 offen
s_add_u32 s42, s42, 9216
buffer_load_dwordx2 v[134:135], v9, s[48:51], s42 offen
s_add_u32 s42, s42, 9216
buffer_load_dwordx2 v[136:137], v9, s[48:51], s42 offen
s_add_u32 s42, s42, 9216
buffer_load_dwordx2 v[138:139], v9, s[48:51], s42 offen
s_add_u32 s42, s42, 230400
buffer_load_dwordx2 v[140:141], v10, s[48:51], s42 offen
s_add_u32 s42, s42, 9216
buffer_load_dwordx2 v[142:143], v10, s[48:51], s42 offen
s_add_u32 s42, s42, 9216
buffer_load_dwordx2 v[144:145], v10, s[48:51], s42 offen
s_add_u32 s42, s42, 9216
buffer_load_dwordx2 v[146:147], v10, s[48:51], s42 offen
s_add_u32 s42, s42, 9216
buffer_load_dwordx2 v[148:149], v10, s[48:51], s42 offen
s_add_u32 s42, s42, 9216
buffer_load_dwordx2 v[150:151], v10, s[48:51], s42 offen
s_add_u32 s42, s42, 9216
buffer_load_dwordx2 v[152:153], v10, s[48:51], s42 offen
s_add_u32 s42, s42, 9216
buffer_load_dwordx2 v[154:155], v10, s[48:51], s42 offen
s_add_u32 s42, s42, 230400
buffer_load_dword v3, v12, s[48:51], 0 offen
buffer_load_dword v3, v12, s[48:51], 0 offen
buffer_load_dword v3, v12, s[48:51], 0 offen
buffer_load_dword v3, v12, s[48:51], 0 offen
buffer_load_dword v3, v12, s[48:51], 0 offen
buffer_load_dword v3, v12, s[48:51], 0 offen
buffer_load_dword v3, v12, s[48:51], 0 offen
buffer_load_dword v3, v12, s[48:51], 0 offen
s_branch L_l_done
L_l_d:
s_mov_b32 s48, s62
s_and_b32 s49, s63, 0xffff
s_mov_b32 s50, 5308416
s_mov_b32 s51, 0x20000
s_sub_u32 s40, s2, 144
s_mul_i32 s42, s40, 73728
s_mul_i32 s41, s4, 288
v_mul_u32_u24 v10, 18432, v7
v_add_u32 v10, s41, v10
v_lshl_add_u32 v9, v6, 3, v10
v_lshl_add_u32 v10, v6, 1, v10
s_add_u32 s43, s42, 0
buffer_load_dwordx2 v[76:77], v9, s[48:51], s43 offen offset:0
buffer_load_dwordx2 v[92:93], v9, s[48:51], s43 offen offset:128
buffer_load_ushort v108, v10, s[48:51], s43 offen offset:256
s_add_u32 s43, s42, 4608
buffer_load_dwordx2 v[78:79], v9, s[48:51], s43 offen offset:0
buffer_load_dwordx2 v[94:95], v9, s[48:51], s43 offen offset:128
buffer_load_ushort v109, v10, s[48:51], s43 offen offset:256
s_add_u32 s43, s42, 9216
buffer_load_dwordx2 v[80:81], v9, s[48:51], s43 offen offset:0
buffer_load_dwordx2 v[96:97], v9, s[48:51], s43 offen offset:128
buffer_load_ushort v110, v10, s[48:51], s43 offen offset:256
s_add_u32 s43, s42, 13824
buffer_load_dwordx2 v[82:83], v9, s[48:51], s43 offen offset:0
buffer_load_dwordx2 v[98:99], v9, s[48:51], s43 offen offset:128
buffer_load_ushort v111, v10, s[48:51], s43 offen offset:256
s_add_u32 s43, s42, 1152
buffer_load_dwordx2 v[84:85], v9, s[48:51], s43 offen offset:0
buffer_load_dwordx2 v[100:101], v9, s[48:51], s43 offen offset:128
buffer_load_ushort v112, v10, s[48:51], s43 offen offset:256
s_add_u32 s43, s42, 5760
buffer_load_dwordx2 v[86:87], v9, s[48:51], s43 offen offset:0
buffer_load_dwordx2 v[102:103], v9, s[48:51], s43 offen offset:128
buffer_load_ushort v113, v10, s[48:51], s43 offen offset:256
s_add_u32 s43, s42, 10368
buffer_load_dwordx2 v[88:89], v9, s[48:51], s43 offen offset:0
buffer_load_dwordx2 v[104:105], v9, s[48:51], s43 offen offset:128
buffer_load_ushort v114, v10, s[48:51], s43 offen offset:256
s_add_u32 s43, s42, 14976
buffer_load_dwordx2 v[90:91], v9, s[48:51], s43 offen offset:0
buffer_load_dwordx2 v[106:107], v9, s[48:51], s43 offen offset:128
buffer_load_ushort v115, v10, s[48:51], s43 offen offset:256
s_add_u32 s43, s42, 2304
buffer_load_dwordx2 v[116:117], v9, s[48:51], s43 offen offset:0
buffer_load_dwordx2 v[132:133], v9, s[48:51], s43 offen offset:128
buffer_load_ushort v148, v10, s[48:51], s43 offen offset:256
s_add_u32 s43, s42, 6912
buffer_load_dwordx2 v[118:119], v9, s[48:51], s43 offen offset:0
buffer_load_dwordx2 v[134:135], v9, s[48:51], s43 offen offset:128
buffer_load_ushort v149, v10, s[48:51], s43 offen offset:256
s_add_u32 s43, s42, 11520
buffer_load_dwordx2 v[120:121], v9, s[48:51], s43 offen offset:0
buffer_load_dwordx2 v[136:137], v9, s[48:51], s43 offen offset:128
buffer_load_ushort v150, v10, s[48:51], s43 offen offset:256
s_add_u32 s43, s42, 16128
buffer_load_dwordx2 v[122:123], v9, s[48:51], s43 offen offset:0
buffer_load_dwordx2 v[138:139], v9, s[48:51], s43 offen offset:128
buffer_load_ushort v151, v10, s[48:51], s43 offen offset:256
s_add_u32 s43, s42, 3456
buffer_load_dwordx2 v[124:125], v9, s[48:51], s43 offen offset:0
buffer_load_dwordx2 v[140:141], v9, s[48:51], s43 offen offset:128
buffer_load_ushort v152, v10, s[48:51], s43 offen offset:256
s_add_u32 s43, s42, 8064
buffer_load_dwordx2 v[126:127], v9, s[48:51], s43 offen offset:0
buffer_load_dwordx2 v[142:143], v9, s[48:51], s43 offen offset:128
buffer_load_ushort v153, v10, s[48:51], s43 offen offset:256
s_add_u32 s43, s42, 12672
buffer_load_dwordx2 v[128:129], v9, s[48:51], s43 offen offset:0
buffer_load_dwordx2 v[144:145], v9, s[48:51], s43 offen offset:128
buffer_load_ushort v154, v10, s[48:51], s43 offen offset:256
s_add_u32 s43, s42, 17280
buffer_load_dwordx2 v[130:131], v9, s[48:51], s43 offen offset:0
buffer_load_dwordx2 v[146:147], v9, s[48:51], s43 offen offset:128
buffer_load_ushort v155, v10, s[48:51], s43 offen offset:256
L_l_done:
s_waitcnt vmcnt(63)
v_readfirstlane_b32 s40, v14
v_readfirstlane_b32 s41, v15
s_add_u32 s68, s40, 1
s_addc_u32 s69, s41, 0
s_waitcnt vmcnt(63)
v_lshlrev_b32 v28, 16, v16
v_and_b32 v29, 0xffff0000, v16
v_lshlrev_b32 v30, 16, v17
v_and_b32 v31, 0xffff0000, v17
v_lshlrev_b32 v32, 16, v18
v_and_b32 v33, 0xffff0000, v18
v_lshlrev_b32 v34, 16, v19
v_and_b32 v35, 0xffff0000, v19
s_waitcnt vmcnt(63)
v_lshlrev_b32 v36, 16, v20
v_and_b32 v37, 0xffff0000, v20
v_lshlrev_b32 v38, 16, v21
v_and_b32 v39, 0xffff0000, v21
v_lshlrev_b32 v40, 16, v22
v_and_b32 v41, 0xffff0000, v22
v_lshlrev_b32 v42, 16, v23
v_and_b32 v43, 0xffff0000, v23
s_waitcnt vmcnt(63)
v_lshlrev_b32 v44, 16, v24
v_and_b32 v45, 0xffff0000, v24
v_lshlrev_b32 v46, 16, v25
v_and_b32 v47, 0xffff0000, v25
v_lshlrev_b32 v48, 16, v26
v_and_b32 v49, 0xffff0000, v26
v_lshlrev_b32 v50, 16, v27
v_and_b32 v51, 0xffff0000, v27
s_add_u32 s24, s20, 27979776
s_add_u32 s25, s24, 4096
buffer_store_dwordx4 v[16:19], v4, s[8:11], s24 offen offset:0 sc1
buffer_store_dwordx4 v[20:23], v4, s[8:11], s24 offen offset:2048 sc1
buffer_store_dwordx4 v[24:27], v4, s[8:11], s25 offen offset:0 sc1
v_add_f32 v6, v28, v29
v_mul_f32 v7, v28, v28
v_mul_f32 v9, v29, v29
v_mov_b32 v8, 0
v_add_f32 v6, v6, v30
v_add_f32 v8, v8, v31
v_fmac_f32 v7, v30, v30
v_fmac_f32 v9, v31, v31
v_add_f32 v6, v6, v32
v_add_f32 v8, v8, v33
v_fmac_f32 v7, v32, v32
v_fmac_f32 v9, v33, v33
v_add_f32 v6, v6, v34
v_add_f32 v8, v8, v35
v_fmac_f32 v7, v34, v34
v_fmac_f32 v9, v35, v35
v_add_f32 v6, v6, v36
v_add_f32 v8, v8, v37
v_fmac_f32 v7, v36, v36
v_fmac_f32 v9, v37, v37
v_add_f32 v6, v6, v38
v_add_f32 v8, v8, v39
v_fmac_f32 v7, v38, v38
v_fmac_f32 v9, v39, v39
v_add_f32 v6, v6, v40
v_add_f32 v8, v8, v41
v_fmac_f32 v7, v40, v40
v_fmac_f32 v9, v41, v41
v_add_f32 v6, v6, v42
v_add_f32 v8, v8, v43
v_fmac_f32 v7, v42, v42
v_fmac_f32 v9, v43, v43
v_add_f32 v6, v6, v44
v_add_f32 v8, v8, v45
v_fmac_f32 v7, v44, v44
v_fmac_f32 v9, v45, v45
v_add_f32 v6, v6, v46
v_add_f32 v8, v8, v47
v_fmac_f32 v7, v46, v46
v_fmac_f32 v9, v47, v47
v_add_f32 v6, v6, v48
v_add_f32 v8, v8, v49
v_fmac_f32 v7, v48, v48
v_fmac_f32 v9, v49, v49
v_add_f32 v6, v6, v50
v_add_f32 v8, v8, v51
v_fmac_f32 v7, v50, v50
v_fmac_f32 v9, v51, v51
v_add_f32 v6, v6, v8
v_add_f32 v7, v7, v9
s_nop 0
v_add_f32_dpp v6, v6, v6 row_ror:8 row_mask:0xf bank_mask:0xf
v_add_f32_dpp v7, v7, v7 row_ror:8 row_mask:0xf bank_mask:0xf
v_mov_b32 v8, v6
v_mov_b32 v9, v7
s_nop 0
v_permlane16_swap_b32 v6, v8
v_permlane16_swap_b32 v7, v9
v_add_f32 v6, v6, v8
v_add_f32 v7, v7, v9
v_mov_b32 v8, v6
v_mov_b32 v9, v7
s_nop 0
v_permlane32_swap_b32 v6, v8
v_permlane32_swap_b32 v7, v9
v_add_f32 v6, v6, v8
v_add_f32 v7, v7, v9
v_and_b32 v10, 7, v1
v_lshlrev_b32 v10, 3, v10
v_add_u32 v10, 147456, v10
s_lshl_b32 s24, s4, 6
v_add_u32 v11, s24, v10
ds_write_b64 v11, v[6:7]
s_waitcnt lgkmcnt(0)
s_barrier
ds_read_b64 v[6:7], v10
ds_read_b64 v[8:9], v10 offset:64
ds_read_b64 v[12:13], v10 offset:128
s_waitcnt lgkmcnt(0)
v_add_f32 v6, v6, v8
v_add_f32 v7, v7, v9
v_add_f32 v6, v6, v12
v_add_f32 v7, v7, v13
v_mul_f32 v6, 0x3ae38e39, v6
v_mul_f32 v7, 0x3ae38e39, v7
v_fma_f32 v7, -v6, v6, v7
v_max_f32 v7, 0, v7
v_add_f32 v7, 0x3727c5ac, v7
v_rsq_f32 v7, v7
s_nop 0
v_mul_f32 v6, v6, v7
v_fma_f32 v28, v28, v7, -v6
v_fma_f32 v29, v29, v7, -v6
v_fma_f32 v30, v30, v7, -v6
v_fma_f32 v31, v31, v7, -v6
v_fma_f32 v32, v32, v7, -v6
v_fma_f32 v33, v33, v7, -v6
v_fma_f32 v34, v34, v7, -v6
v_fma_f32 v35, v35, v7, -v6
v_fma_f32 v36, v36, v7, -v6
v_fma_f32 v37, v37, v7, -v6
v_fma_f32 v38, v38, v7, -v6
v_fma_f32 v39, v39, v7, -v6
v_fma_f32 v40, v40, v7, -v6
v_fma_f32 v41, v41, v7, -v6
v_fma_f32 v42, v42, v7, -v6
v_fma_f32 v43, v43, v7, -v6
v_fma_f32 v44, v44, v7, -v6
v_fma_f32 v45, v45, v7, -v6
v_fma_f32 v46, v46, v7, -v6
v_fma_f32 v47, v47, v7, -v6
v_fma_f32 v48, v48, v7, -v6
v_fma_f32 v49, v49, v7, -v6
v_fma_f32 v50, v50, v7, -v6
v_fma_f32 v51, v51, v7, -v6
v_cvt_pk_bf16_f32 v16, v28, v29
v_cvt_pk_bf16_f32 v17, v30, v31
v_cvt_pk_bf16_f32 v18, v32, v33
v_cvt_pk_bf16_f32 v19, v34, v35
v_cvt_pk_bf16_f32 v20, v36, v37
v_cvt_pk_bf16_f32 v21, v38, v39
v_cvt_pk_bf16_f32 v22, v40, v41
v_cvt_pk_bf16_f32 v23, v42, v43
v_cvt_pk_bf16_f32 v24, v44, v45
v_cvt_pk_bf16_f32 v25, v46, v47
v_cvt_pk_bf16_f32 v26, v48, v49
v_cvt_pk_bf16_f32 v27, v50, v51
s_add_u32 s24, s20, 23261184
s_add_u32 s25, s24, 4096
buffer_store_dwordx4 v[16:19], v4, s[8:11], s24 offen offset:0 sc1
buffer_store_dwordx4 v[20:23], v4, s[8:11], s24 offen offset:2048 sc1
buffer_store_dwordx4 v[24:27], v4, s[8:11], s25 offen offset:0 sc1
s_lshl_b32 s24, s5, 4
s_lshr_b32 s25, s6, 1
s_add_u32 s24, s24, s25
s_lshl_b32 s24, s24, 3
s_and_b32 s25, s6, 1
s_mul_i32 s25, s25, 3
s_add_u32 s24, s24, s25
s_add_u32 s24, s24, s4
s_lshl_b32 s24, s24, 7
s_add_u32 s24, s24, 786432
s_cmp_eq_u32 s4, 3
s_cselect_b32 s24, 2146435072, s24
s_waitcnt vmcnt(55)
v_lshl_or_b32 v52, v53, 16, v52
v_lshl_or_b32 v53, v55, 16, v54
v_lshl_or_b32 v54, v57, 16, v56
v_lshl_or_b32 v55, v59, 16, v58
buffer_store_dwordx4 v[52:55], v2, s[8:11], s38 offen offset:0 sc1
v_lshl_or_b32 v60, v61, 16, v60
v_lshl_or_b32 v61, v63, 16, v62
v_lshl_or_b32 v62, v65, 16, v64
v_lshl_or_b32 v63, v67, 16, v66
buffer_store_dwordx4 v[60:63], v2, s[8:11], s38 offen offset:1024 sc1
v_lshl_or_b32 v68, v69, 16, v68
v_lshl_or_b32 v69, v71, 16, v70
v_lshl_or_b32 v70, v73, 16, v72
v_lshl_or_b32 v71, v75, 16, v74
buffer_store_dwordx4 v[68:71], v2, s[8:11], s38 offen offset:2048 sc1
v_mov_b32 v13, 2146435072
v_cmp_eq_u32 vcc, 0, v1
v_mov_b32 v14, s68
v_mov_b32 v15, s69
v_cndmask_b32 v13, v13, 0, vcc
s_waitcnt vmcnt(0)
buffer_store_dwordx2 v[14:15], v13, s[8:11], s24 offen sc1
buffer_store_dwordx2 v[14:15], v13, s[8:11], s39 offen sc1
s_mov_b32 s44, s26
s_and_b32 s45, s27, 0xffff
s_mov_b32 s46, 256
s_mov_b32 s47, 0x20000
s_cmp_eq_u32 s4, 0
s_cselect_b32 s40, 0, 4096
v_mov_b32 v3, 1
buffer_atomic_add v3, v13, s[44:47], s40 offen sc1
s_mov_b32 s34, 0x05040100
s_mov_b32 s35, 0x07060302
s_cmp_ge_u32 s2, 144
s_cbranch_scc1 L_t_d
v_mov_b32 v68, 0x3f803f80
v_mov_b32 v69, 0x3f803f80
v_mov_b32 v70, 0x3f803f80
v_mov_b32 v71, 0x3f803f80
v_perm_b32 v176, v78, v76, s34
v_perm_b32 v177, v82, v80, s34
v_perm_b32 v178, v86, v84, s34
v_perm_b32 v179, v90, v88, s34
v_perm_b32 v180, v78, v76, s35
v_perm_b32 v181, v82, v80, s35
v_perm_b32 v182, v86, v84, s35
v_perm_b32 v183, v90, v88, s35
v_perm_b32 v184, v79, v77, s34
v_perm_b32 v185, v83, v81, s34
v_perm_b32 v186, v87, v85, s34
v_perm_b32 v187, v91, v89, s34
v_perm_b32 v188, v79, v77, s35
v_perm_b32 v189, v83, v81, s35
v_perm_b32 v190, v87, v85, s35
v_perm_b32 v191, v91, v89, s35
v_perm_b32 v192, v94, v92, s34
v_perm_b32 v193, v98, v96, s34
v_perm_b32 v194, v102, v100, s34
v_perm_b32 v195, v106, v104, s34
v_perm_b32 v196, v94, v92, s35
v_perm_b32 v197, v98, v96, s35
v_perm_b32 v198, v102, v100, s35
v_perm_b32 v199, v106, v104, s35
v_perm_b32 v200, v95, v93, s34
v_perm_b32 v201, v99, v97, s34
v_perm_b32 v202, v103, v101, s34
v_perm_b32 v203, v107, v105, s34
v_perm_b32 v204, v95, v93, s35
v_perm_b32 v205, v99, v97, s35
v_perm_b32 v206, v103, v101, s35
v_perm_b32 v207, v107, v105, s35
v_perm_b32 v208, v110, v108, s34
v_perm_b32 v209, v114, v112, s34
v_perm_b32 v210, v118, v116, s34
v_perm_b32 v211, v122, v120, s34
v_perm_b32 v212, v110, v108, s35
v_perm_b32 v213, v114, v112, s35
v_perm_b32 v214, v118, v116, s35
v_perm_b32 v215, v122, v120, s35
v_perm_b32 v216, v111, v109, s34
v_perm_b32 v217, v115, v113, s34
v_perm_b32 v218, v119, v117, s34
v_perm_b32 v219, v123, v121, s34
v_perm_b32 v220, v111, v109, s35
v_perm_b32 v221, v115, v113, s35
v_perm_b32 v222, v119, v117, s35
v_perm_b32 v223, v123, v121, s35
v_perm_b32 v224, v126, v124, s34
v_perm_b32 v225, v130, v128, s34
v_perm_b32 v226, v134, v132, s34
v_perm_b32 v227, v138, v136, s34
v_perm_b32 v228, v126, v124, s35
v_perm_b32 v229, v130, v128, s35
v_perm_b32 v230, v134, v132, s35
v_perm_b32 v231, v138, v136, s35
v_perm_b32 v232, v127, v125, s34
v_perm_b32 v233, v131, v129, s34
v_perm_b32 v234, v135, v133, s34
v_perm_b32 v235, v139, v137, s34
v_perm_b32 v236, v127, v125, s35
v_perm_b32 v237, v131, v129, s35
v_perm_b32 v238, v135, v133, s35
v_perm_b32 v239, v139, v137, s35
v_perm_b32 v240, v142, v140, s34
v_perm_b32 v241, v146, v144, s34
v_perm_b32 v242, v150, v148, s34
v_perm_b32 v243, v154, v152, s34
v_perm_b32 v244, v142, v140, s35
v_perm_b32 v245, v146, v144, s35
v_perm_b32 v246, v150, v148, s35
v_perm_b32 v247, v154, v152, s35
v_perm_b32 v248, v143, v141, s34
v_perm_b32 v249, v147, v145, s34
v_perm_b32 v250, v151, v149, s34
v_perm_b32 v251, v155, v153, s34
v_perm_b32 v252, v143, v141, s35
v_perm_b32 v253, v147, v145, s35
v_perm_b32 v254, v151, v149, s35
v_perm_b32 v255, v155, v153, s35
v_mfma_f32_16x16x32_bf16 v[52:55], v[68:71], v[176:179], 0
v_mfma_f32_16x16x32_bf16 v[56:59], v[68:71], v[180:183], 0
v_mfma_f32_16x16x32_bf16 v[60:63], v[68:71], v[184:187], 0
v_mfma_f32_16x16x32_bf16 v[64:67], v[68:71], v[188:191], 0
v_mfma_f32_16x16x32_bf16 v[52:55], v[68:71], v[192:195], v[52:55]
v_mfma_f32_16x16x32_bf16 v[56:59], v[68:71], v[196:199], v[56:59]
v_mfma_f32_16x16x32_bf16 v[60:63], v[68:71], v[200:203], v[60:63]
v_mfma_f32_16x16x32_bf16 v[64:67], v[68:71], v[204:207], v[64:67]
v_mfma_f32_16x16x32_bf16 v[52:55], v[68:71], v[208:211], v[52:55]
v_mfma_f32_16x16x32_bf16 v[56:59], v[68:71], v[212:215], v[56:59]
v_mfma_f32_16x16x32_bf16 v[60:63], v[68:71], v[216:219], v[60:63]
v_mfma_f32_16x16x32_bf16 v[64:67], v[68:71], v[220:223], v[64:67]
v_mfma_f32_16x16x32_bf16 v[52:55], v[68:71], v[224:227], v[52:55]
v_mfma_f32_16x16x32_bf16 v[56:59], v[68:71], v[228:231], v[56:59]
v_mfma_f32_16x16x32_bf16 v[60:63], v[68:71], v[232:235], v[60:63]
v_mfma_f32_16x16x32_bf16 v[64:67], v[68:71], v[236:239], v[64:67]
v_mfma_f32_16x16x32_bf16 v[52:55], v[68:71], v[240:243], v[52:55]
v_mfma_f32_16x16x32_bf16 v[56:59], v[68:71], v[244:247], v[56:59]
v_mfma_f32_16x16x32_bf16 v[60:63], v[68:71], v[248:251], v[60:63]
v_mfma_f32_16x16x32_bf16 v[64:67], v[68:71], v[252:255], v[64:67]
s_mul_i32 s40, s2, 911
s_lshr_b32 s40, s40, 16
s_mul_i32 s41, s40, 72
s_sub_u32 s41, s2, s41
s_mul_i32 s42, s41, 7282
s_lshr_b32 s42, s42, 16
s_mul_i32 s43, s42, 9
s_sub_u32 s41, s41, s43
s_lshl_b32 s41, s41, 2
s_lshl_b32 s42, s42, 2
s_lshl_b32 s40, s40, 11
s_add_u32 s40, s40, 7303168
s_mul_i32 s43, s4, 9
s_add_u32 s43, s43, 1
s_lshr_b32 s43, s43, 1
v_and_b32 v6, 15, v1
v_lshlrev_b32 v6, 4, v6
v_add_u32 v6, 148480, v6
s_lshl_b32 s44, s4, 2
v_add_u32 v7, s44, v6
ds_write_b32 v7, v52 offset:0
ds_write_b32 v7, v56 offset:256
ds_write_b32 v7, v60 offset:512
ds_write_b32 v7, v64 offset:768
s_add_u32 s44, s41, 0
s_mul_i32 s45, s44, 7282
s_lshr_b32 s45, s45, 16
s_mul_i32 s46, s45, 9
s_sub_u32 s44, s44, s46
s_add_u32 s46, s44, 1
s_cmp_eq_u32 s46, 9
s_cselect_b32 s46, 0, s46
s_bitcmp0_b32 s45, 0
s_cselect_b32 s44, s46, s44
s_add_u32 s45, s45, s42
s_mul_i32 s45, s45, 497664
s_add_u32 s45, s45, s40
s_mul_i32 s46, s44, 36864
s_lshl_b32 s47, s44, 12
s_cmp_lt_u32 s44, 2
s_cselect_b32 s46, s47, s46
s_cselect_b32 s47, 13, 12
s_add_u32 s45, s45, s46
s_add_u32 s44, s43, 0
s_lshr_b32 s46, s44, 1
s_lshl_b32 s46, s46, s47
s_and_b32 s44, s44, 1
s_lshl_b32 s44, s44, 10
s_add_u32 s44, s44, s46
s_add_u32 s44, s44, s45
v_add_u32 v156, s44, v2
s_add_u32 s44, s43, 1
s_lshr_b32 s46, s44, 1
s_lshl_b32 s46, s46, s47
s_and_b32 s44, s44, 1
s_lshl_b32 s44, s44, 10
s_add_u32 s44, s44, s46
s_add_u32 s44, s44, s45
v_add_u32 v160, s44, v2
s_add_u32 s44, s43, 2
s_lshr_b32 s46, s44, 1
s_lshl_b32 s46, s46, s47
s_and_b32 s44, s44, 1
s_lshl_b32 s44, s44, 10
s_add_u32 s44, s44, s46
s_add_u32 s44, s44, s45
v_add_u32 v164, s44, v2
s_add_u32 s44, s43, 3
s_lshr_b32 s46, s44, 1
s_lshl_b32 s46, s46, s47
s_and_b32 s44, s44, 1
s_lshl_b32 s44, s44, 10
s_add_u32 s44, s44, s46
s_add_u32 s44, s44, s45
v_add_u32 v168, s44, v2
s_add_u32 s44, s43, 4
s_lshr_b32 s46, s44, 1
s_lshl_b32 s46, s46, s47
s_and_b32 s44, s44, 1
s_lshl_b32 s44, s44, 10
s_add_u32 s44, s44, s46
s_add_u32 s44, s44, s45
s_bitcmp1_b32 s4, 0
s_cselect_b32 s44, 2146435072, s44
v_add_u32 v172, s44, v2
s_add_u32 s44, s41, 1
s_mul_i32 s45, s44, 7282
s_lshr_b32 s45, s45, 16
s_mul_i32 s46, s45, 9
s_sub_u32 s44, s44, s46
s_add_u32 s46, s44, 1
s_cmp_eq_u32 s46, 9
s_cselect_b32 s46, 0, s46
s_bitcmp0_b32 s45, 0
s_cselect_b32 s44, s46, s44
s_add_u32 s45, s45, s42
s_mul_i32 s45, s45, 497664
s_add_u32 s45, s45, s40
s_mul_i32 s46, s44, 36864
s_lshl_b32 s47, s44, 12
s_cmp_lt_u32 s44, 2
s_cselect_b32 s46, s47, s46
s_cselect_b32 s47, 13, 12
s_add_u32 s45, s45, s46
s_add_u32 s44, s43, 0
s_lshr_b32 s46, s44, 1
s_lshl_b32 s46, s46, s47
s_and_b32 s44, s44, 1
s_lshl_b32 s44, s44, 10
s_add_u32 s44, s44, s46
s_add_u32 s44, s44, s45
v_add_u32 v157, s44, v2
s_add_u32 s44, s43, 1
s_lshr_b32 s46, s44, 1
s_lshl_b32 s46, s46, s47
s_and_b32 s44, s44, 1
s_lshl_b32 s44, s44, 10
s_add_u32 s44, s44, s46
s_add_u32 s44, s44, s45
v_add_u32 v161, s44, v2
s_add_u32 s44, s43, 2
s_lshr_b32 s46, s44, 1
s_lshl_b32 s46, s46, s47
s_and_b32 s44, s44, 1
s_lshl_b32 s44, s44, 10
s_add_u32 s44, s44, s46
s_add_u32 s44, s44, s45
v_add_u32 v165, s44, v2
s_add_u32 s44, s43, 3
s_lshr_b32 s46, s44, 1
s_lshl_b32 s46, s46, s47
s_and_b32 s44, s44, 1
s_lshl_b32 s44, s44, 10
s_add_u32 s44, s44, s46
s_add_u32 s44, s44, s45
v_add_u32 v169, s44, v2
s_add_u32 s44, s43, 4
s_lshr_b32 s46, s44, 1
s_lshl_b32 s46, s46, s47
s_and_b32 s44, s44, 1
s_lshl_b32 s44, s44, 10
s_add_u32 s44, s44, s46
s_add_u32 s44, s44, s45
s_bitcmp1_b32 s4, 0
s_cselect_b32 s44, 2146435072, s44
v_add_u32 v173, s44, v2
s_add_u32 s44, s41, 2
s_mul_i32 s45, s44, 7282
s_lshr_b32 s45, s45, 16
s_mul_i32 s46, s45, 9
s_sub_u32 s44, s44, s46
s_add_u32 s46, s44, 1
s_cmp_eq_u32 s46, 9
s_cselect_b32 s46, 0, s46
s_bitcmp0_b32 s45, 0
s_cselect_b32 s44, s46, s44
s_add_u32 s45, s45, s42
s_mul_i32 s45, s45, 497664
s_add_u32 s45, s45, s40
s_mul_i32 s46, s44, 36864
s_lshl_b32 s47, s44, 12
s_cmp_lt_u32 s44, 2
s_cselect_b32 s46, s47, s46
s_cselect_b32 s47, 13, 12
s_add_u32 s45, s45, s46
s_add_u32 s44, s43, 0
s_lshr_b32 s46, s44, 1
s_lshl_b32 s46, s46, s47
s_and_b32 s44, s44, 1
s_lshl_b32 s44, s44, 10
s_add_u32 s44, s44, s46
s_add_u32 s44, s44, s45
v_add_u32 v158, s44, v2
s_add_u32 s44, s43, 1
s_lshr_b32 s46, s44, 1
s_lshl_b32 s46, s46, s47
s_and_b32 s44, s44, 1
s_lshl_b32 s44, s44, 10
s_add_u32 s44, s44, s46
s_add_u32 s44, s44, s45
v_add_u32 v162, s44, v2
s_add_u32 s44, s43, 2
s_lshr_b32 s46, s44, 1
s_lshl_b32 s46, s46, s47
s_and_b32 s44, s44, 1
s_lshl_b32 s44, s44, 10
s_add_u32 s44, s44, s46
s_add_u32 s44, s44, s45
v_add_u32 v166, s44, v2
s_add_u32 s44, s43, 3
s_lshr_b32 s46, s44, 1
s_lshl_b32 s46, s46, s47
s_and_b32 s44, s44, 1
s_lshl_b32 s44, s44, 10
s_add_u32 s44, s44, s46
s_add_u32 s44, s44, s45
v_add_u32 v170, s44, v2
s_add_u32 s44, s43, 4
s_lshr_b32 s46, s44, 1
s_lshl_b32 s46, s46, s47
s_and_b32 s44, s44, 1
s_lshl_b32 s44, s44, 10
s_add_u32 s44, s44, s46
s_add_u32 s44, s44, s45
s_bitcmp1_b32 s4, 0
s_cselect_b32 s44, 2146435072, s44
v_add_u32 v174, s44, v2
s_add_u32 s44, s41, 3
s_mul_i32 s45, s44, 7282
s_lshr_b32 s45, s45, 16
s_mul_i32 s46, s45, 9
s_sub_u32 s44, s44, s46
s_add_u32 s46, s44, 1
s_cmp_eq_u32 s46, 9
s_cselect_b32 s46, 0, s46
s_bitcmp0_b32 s45, 0
s_cselect_b32 s44, s46, s44
s_add_u32 s45, s45, s42
s_mul_i32 s45, s45, 497664
s_add_u32 s45, s45, s40
s_mul_i32 s46, s44, 36864
s_lshl_b32 s47, s44, 12
s_cmp_lt_u32 s44, 2
s_cselect_b32 s46, s47, s46
s_cselect_b32 s47, 13, 12
s_add_u32 s45, s45, s46
s_add_u32 s44, s43, 0
s_lshr_b32 s46, s44, 1
s_lshl_b32 s46, s46, s47
s_and_b32 s44, s44, 1
s_lshl_b32 s44, s44, 10
s_add_u32 s44, s44, s46
s_add_u32 s44, s44, s45
v_add_u32 v159, s44, v2
s_add_u32 s44, s43, 1
s_lshr_b32 s46, s44, 1
s_lshl_b32 s46, s46, s47
s_and_b32 s44, s44, 1
s_lshl_b32 s44, s44, 10
s_add_u32 s44, s44, s46
s_add_u32 s44, s44, s45
v_add_u32 v163, s44, v2
s_add_u32 s44, s43, 2
s_lshr_b32 s46, s44, 1
s_lshl_b32 s46, s46, s47
s_and_b32 s44, s44, 1
s_lshl_b32 s44, s44, 10
s_add_u32 s44, s44, s46
s_add_u32 s44, s44, s45
v_add_u32 v167, s44, v2
s_add_u32 s44, s43, 3
s_lshr_b32 s46, s44, 1
s_lshl_b32 s46, s46, s47
s_and_b32 s44, s44, 1
s_lshl_b32 s44, s44, 10
s_add_u32 s44, s44, s46
s_add_u32 s44, s44, s45
v_add_u32 v171, s44, v2
s_add_u32 s44, s43, 4
s_lshr_b32 s46, s44, 1
s_lshl_b32 s46, s46, s47
s_and_b32 s44, s44, 1
s_lshl_b32 s44, s44, 10
s_add_u32 s44, s44, s46
s_add_u32 s44, s44, s45
s_bitcmp1_b32 s4, 0
s_cselect_b32 s44, 2146435072, s44
v_add_u32 v175, s44, v2
s_waitcnt lgkmcnt(0)
s_barrier
ds_read_b128 v[52:55], v6 offset:0
ds_read_b128 v[56:59], v6 offset:256
ds_read_b128 v[60:63], v6 offset:512
ds_read_b128 v[64:67], v6 offset:768
s_waitcnt lgkmcnt(0)
v_add_f32 v52, v52, v53
v_add_f32 v54, v54, v55
v_add_f32 v56, v56, v57
v_add_f32 v58, v58, v59
v_add_f32 v60, v60, v61
v_add_f32 v62, v62, v63
v_add_f32 v64, v64, v65
v_add_f32 v66, v66, v67
v_add_f32 v52, v52, v54
v_add_f32 v56, v56, v58
v_add_f32 v60, v60, v62
v_add_f32 v64, v64, v66
v_mul_f32 v20, 0x3ae38e39, v52
v_mul_f32 v21, 0x3ae38e39, v56
v_mul_f32 v22, 0x3ae38e39, v60
v_mul_f32 v23, 0x3ae38e39, v64
s_branch L_t_done
L_t_d:
v_mov_b32 v20, 0
v_mov_b32 v21, 0
v_mov_b32 v22, 0
v_mov_b32 v23, 0
v_perm_b32 v176, v78, v76, s34
v_perm_b32 v177, v82, v80, s34
v_perm_b32 v178, v86, v84, s34
v_perm_b32 v179, v90, v88, s34
v_perm_b32 v180, v78, v76, s35
v_perm_b32 v181, v82, v80, s35
v_perm_b32 v182, v86, v84, s35
v_perm_b32 v183, v90, v88, s35
v_perm_b32 v184, v79, v77, s34
v_perm_b32 v185, v83, v81, s34
v_perm_b32 v186, v87, v85, s34
v_perm_b32 v187, v91, v89, s34
v_perm_b32 v188, v79, v77, s35
v_perm_b32 v189, v83, v81, s35
v_perm_b32 v190, v87, v85, s35
v_perm_b32 v191, v91, v89, s35
v_perm_b32 v192, v94, v92, s34
v_perm_b32 v193, v98, v96, s34
v_perm_b32 v194, v102, v100, s34
v_perm_b32 v195, v106, v104, s34
v_perm_b32 v196, v94, v92, s35
v_perm_b32 v197, v98, v96, s35
v_perm_b32 v198, v102, v100, s35
v_perm_b32 v199, v106, v104, s35
v_perm_b32 v200, v95, v93, s34
v_perm_b32 v201, v99, v97, s34
v_perm_b32 v202, v103, v101, s34
v_perm_b32 v203, v107, v105, s34
v_perm_b32 v204, v95, v93, s35
v_perm_b32 v205, v99, v97, s35
v_perm_b32 v206, v103, v101, s35
v_perm_b32 v207, v107, v105, s35
v_lshl_or_b32 v208, v109, 16, v108
v_lshl_or_b32 v209, v111, 16, v110
v_lshl_or_b32 v210, v113, 16, v112
v_lshl_or_b32 v211, v115, 16, v114
v_perm_b32 v212, v118, v116, s34
v_perm_b32 v213, v122, v120, s34
v_perm_b32 v214, v126, v124, s34
v_perm_b32 v215, v130, v128, s34
v_perm_b32 v216, v118, v116, s35
v_perm_b32 v217, v122, v120, s35
v_perm_b32 v218, v126, v124, s35
v_perm_b32 v219, v130, v128, s35
v_perm_b32 v220, v119, v117, s34
v_perm_b32 v221, v123, v121, s34
v_perm_b32 v222, v127, v125, s34
v_perm_b32 v223, v131, v129, s34
v_perm_b32 v224, v119, v117, s35
v_perm_b32 v225, v123, v121, s35
v_perm_b32 v226, v127, v125, s35
v_perm_b32 v227, v131, v129, s35
v_perm_b32 v228, v134, v132, s34
v_perm_b32 v229, v138, v136, s34
v_perm_b32 v230, v142, v140, s34
v_perm_b32 v231, v146, v144, s34
v_perm_b32 v232, v134, v132, s35
v_perm_b32 v233, v138, v136, s35
v_perm_b32 v234, v142, v140, s35
v_perm_b32 v235, v146, v144, s35
v_perm_b32 v236, v135, v133, s34
v_perm_b32 v237, v139, v137, s34
v_perm_b32 v238, v143, v141, s34
v_perm_b32 v239, v147, v145, s34
v_perm_b32 v240, v135, v133, s35
v_perm_b32 v241, v139, v137, s35
v_perm_b32 v242, v143, v141, s35
v_perm_b32 v243, v147, v145, s35
v_lshl_or_b32 v244, v149, 16, v148
v_lshl_or_b32 v245, v151, 16, v150
v_lshl_or_b32 v246, v153, 16, v152
v_lshl_or_b32 v247, v155, 16, v154
s_sub_u32 s40, s2, 144
s_mul_i32 s41, s40, 7282
s_lshr_b32 s41, s41, 16
s_mul_i32 s42, s41, 9
s_sub_u32 s40, s40, s42
s_lshl_b32 s41, s41, 2
s_add_u32 s41, s41, s4
s_mul_i32 s41, s41, 497664
s_add_u32 s41, s41, 7634944
s_cmp_ge_u32 s2, 216
s_cselect_b32 s41, 2146435072, s41
s_lshl_b32 s42, s40, 1
s_add_u32 s42, s42, 0
s_mov_b32 s43, 0
s_cmp_ge_u32 s42, 5
s_addc_u32 s43, s43, 0
s_cmp_ge_u32 s42, 9
s_addc_u32 s43, s43, 0
s_cmp_ge_u32 s42, 14
s_addc_u32 s43, s43, 0
s_mul_i32 s44, s43, 9
s_add_u32 s44, s44, 1
s_lshr_b32 s44, s44, 1
s_sub_u32 s44, s42, s44
s_sub_u32 s43, s43, s4
s_and_b32 s43, s43, 3
s_mul_i32 s45, s44, 3
s_add_u32 s45, s45, 2
s_cmp_ge_u32 s44, 2
s_cselect_b32 s46, 3, 0
s_add_u32 s45, s45, s46
s_add_u32 s45, s45, s43
s_cmp_eq_u32 s44, 3
s_cselect_b32 s46, 11, s44
s_cmp_eq_u32 s43, 0
s_cselect_b32 s45, s46, s45
s_cmp_eq_u32 s42, 4
s_cselect_b32 s45, 9, s45
s_cmp_eq_u32 s42, 13
s_cselect_b32 s45, 10, s45
s_and_b32 s46, s45, 1
s_and_b32 s47, s45, 30
s_mul_i32 s43, s47, 9
s_lshl_b32 s44, s47, 3
s_add_u32 s44, s44, 10
s_cmp_lt_u32 s45, 10
s_cselect_b32 s43, s43, s44
s_add_u32 s43, s43, s46
s_add_u32 s44, s45, 108
s_cmp_lt_u32 s45, 14
s_cselect_b32 s43, s43, s44
s_cselect_b32 s46, 2, 4
s_lshl_b32 s46, s46, 10
s_add_u32 s44, s43, 16
s_add_u32 s47, s45, 144
s_cmp_lt_u32 s45, 10
s_cselect_b32 s44, s44, s47
s_lshl_b32 s43, s43, 10
s_add_u32 s43, s43, s41
s_lshl_b32 s44, s44, 10
s_add_u32 s44, s44, s41
v_add_u32 v156, s43, v2
s_add_u32 s43, s43, s46
v_add_u32 v157, s43, v2
s_add_u32 s43, s43, s46
v_add_u32 v158, s43, v2
s_add_u32 s43, s43, s46
v_add_u32 v159, s43, v2
s_add_u32 s43, s43, s46
v_add_u32 v160, s43, v2
s_add_u32 s43, s43, s46
v_add_u32 v161, s43, v2
s_add_u32 s43, s43, s46
v_add_u32 v162, s43, v2
s_add_u32 s43, s43, s46
v_add_u32 v163, s43, v2
v_add_u32 v164, s44, v2
s_lshl_b32 s42, s40, 1
s_add_u32 s42, s42, 1
s_mov_b32 s43, 0
s_cmp_ge_u32 s42, 5
s_addc_u32 s43, s43, 0
s_cmp_ge_u32 s42, 9
s_addc_u32 s43, s43, 0
s_cmp_ge_u32 s42, 14
s_addc_u32 s43, s43, 0
s_mul_i32 s44, s43, 9
s_add_u32 s44, s44, 1
s_lshr_b32 s44, s44, 1
s_sub_u32 s44, s42, s44
s_sub_u32 s43, s43, s4
s_and_b32 s43, s43, 3
s_mul_i32 s45, s44, 3
s_add_u32 s45, s45, 2
s_cmp_ge_u32 s44, 2
s_cselect_b32 s46, 3, 0
s_add_u32 s45, s45, s46
s_add_u32 s45, s45, s43
s_cmp_eq_u32 s44, 3
s_cselect_b32 s46, 11, s44
s_cmp_eq_u32 s43, 0
s_cselect_b32 s45, s46, s45
s_cmp_eq_u32 s42, 4
s_cselect_b32 s45, 9, s45
s_cmp_eq_u32 s42, 13
s_cselect_b32 s45, 10, s45
s_and_b32 s46, s45, 1
s_and_b32 s47, s45, 30
s_mul_i32 s43, s47, 9
s_lshl_b32 s44, s47, 3
s_add_u32 s44, s44, 10
s_cmp_lt_u32 s45, 10
s_cselect_b32 s43, s43, s44
s_add_u32 s43, s43, s46
s_add_u32 s44, s45, 108
s_cmp_lt_u32 s45, 14
s_cselect_b32 s43, s43, s44
s_cselect_b32 s46, 2, 4
s_lshl_b32 s46, s46, 10
s_add_u32 s44, s43, 16
s_add_u32 s47, s45, 144
s_cmp_lt_u32 s45, 10
s_cselect_b32 s44, s44, s47
s_lshl_b32 s43, s43, 10
s_add_u32 s43, s43, s41
s_lshl_b32 s44, s44, 10
s_add_u32 s44, s44, s41
v_add_u32 v165, s43, v2
s_add_u32 s43, s43, s46
v_add_u32 v166, s43, v2
s_add_u32 s43, s43, s46
v_add_u32 v167, s43, v2
s_add_u32 s43, s43, s46
v_add_u32 v168, s43, v2
s_add_u32 s43, s43, s46
v_add_u32 v169, s43, v2
s_add_u32 s43, s43, s46
v_add_u32 v170, s43, v2
s_add_u32 s43, s43, s46
v_add_u32 v171, s43, v2
s_add_u32 s43, s43, s46
v_add_u32 v172, s43, v2
v_add_u32 v173, s44, v2
v_mov_b32 v174, 2146435072
v_mov_b32 v175, 2146435072
L_t_done:
v_lshlrev_b32 v24, 16, v176
v_and_b32 v25, 0xffff0000, v176
v_sub_f32 v24, v24, v20
v_sub_f32 v25, v25, v20
v_cvt_pk_bf16_f32 v176, v24, v25
v_lshlrev_b32 v26, 16, v177
v_and_b32 v27, 0xffff0000, v177
v_sub_f32 v26, v26, v20
v_sub_f32 v27, v27, v20
v_cvt_pk_bf16_f32 v177, v26, v27
v_lshlrev_b32 v28, 16, v178
v_and_b32 v29, 0xffff0000, v178
v_sub_f32 v28, v28, v20
v_sub_f32 v29, v29, v20
v_cvt_pk_bf16_f32 v178, v28, v29
v_lshlrev_b32 v30, 16, v179
v_and_b32 v31, 0xffff0000, v179
v_sub_f32 v30, v30, v20
v_sub_f32 v31, v31, v20
v_cvt_pk_bf16_f32 v179, v30, v31
v_lshlrev_b32 v24, 16, v180
v_and_b32 v25, 0xffff0000, v180
v_sub_f32 v24, v24, v21
v_sub_f32 v25, v25, v21
v_cvt_pk_bf16_f32 v180, v24, v25
v_lshlrev_b32 v26, 16, v181
v_and_b32 v27, 0xffff0000, v181
v_sub_f32 v26, v26, v21
v_sub_f32 v27, v27, v21
v_cvt_pk_bf16_f32 v181, v26, v27
v_lshlrev_b32 v28, 16, v182
v_and_b32 v29, 0xffff0000, v182
v_sub_f32 v28, v28, v21
v_sub_f32 v29, v29, v21
v_cvt_pk_bf16_f32 v182, v28, v29
v_lshlrev_b32 v30, 16, v183
v_and_b32 v31, 0xffff0000, v183
v_sub_f32 v30, v30, v21
v_sub_f32 v31, v31, v21
v_cvt_pk_bf16_f32 v183, v30, v31
v_lshlrev_b32 v24, 16, v184
v_and_b32 v25, 0xffff0000, v184
v_sub_f32 v24, v24, v22
v_sub_f32 v25, v25, v22
v_cvt_pk_bf16_f32 v184, v24, v25
v_lshlrev_b32 v26, 16, v185
v_and_b32 v27, 0xffff0000, v185
v_sub_f32 v26, v26, v22
v_sub_f32 v27, v27, v22
v_cvt_pk_bf16_f32 v185, v26, v27
v_lshlrev_b32 v28, 16, v186
v_and_b32 v29, 0xffff0000, v186
v_sub_f32 v28, v28, v22
v_sub_f32 v29, v29, v22
v_cvt_pk_bf16_f32 v186, v28, v29
v_lshlrev_b32 v30, 16, v187
v_and_b32 v31, 0xffff0000, v187
v_sub_f32 v30, v30, v22
v_sub_f32 v31, v31, v22
v_cvt_pk_bf16_f32 v187, v30, v31
v_lshlrev_b32 v24, 16, v188
v_and_b32 v25, 0xffff0000, v188
v_sub_f32 v24, v24, v23
v_sub_f32 v25, v25, v23
v_cvt_pk_bf16_f32 v188, v24, v25
v_lshlrev_b32 v26, 16, v189
v_and_b32 v27, 0xffff0000, v189
v_sub_f32 v26, v26, v23
v_sub_f32 v27, v27, v23
v_cvt_pk_bf16_f32 v189, v26, v27
v_lshlrev_b32 v28, 16, v190
v_and_b32 v29, 0xffff0000, v190
v_sub_f32 v28, v28, v23
v_sub_f32 v29, v29, v23
v_cvt_pk_bf16_f32 v190, v28, v29
v_lshlrev_b32 v30, 16, v191
v_and_b32 v31, 0xffff0000, v191
v_sub_f32 v30, v30, v23
v_sub_f32 v31, v31, v23
v_cvt_pk_bf16_f32 v191, v30, v31
v_lshlrev_b32 v24, 16, v192
v_and_b32 v25, 0xffff0000, v192
v_sub_f32 v24, v24, v20
v_sub_f32 v25, v25, v20
v_cvt_pk_bf16_f32 v192, v24, v25
v_lshlrev_b32 v26, 16, v193
v_and_b32 v27, 0xffff0000, v193
v_sub_f32 v26, v26, v20
v_sub_f32 v27, v27, v20
v_cvt_pk_bf16_f32 v193, v26, v27
v_lshlrev_b32 v28, 16, v194
v_and_b32 v29, 0xffff0000, v194
v_sub_f32 v28, v28, v20
v_sub_f32 v29, v29, v20
v_cvt_pk_bf16_f32 v194, v28, v29
v_lshlrev_b32 v30, 16, v195
v_and_b32 v31, 0xffff0000, v195
v_sub_f32 v30, v30, v20
v_sub_f32 v31, v31, v20
v_cvt_pk_bf16_f32 v195, v30, v31
v_lshlrev_b32 v24, 16, v196
v_and_b32 v25, 0xffff0000, v196
v_sub_f32 v24, v24, v21
v_sub_f32 v25, v25, v21
v_cvt_pk_bf16_f32 v196, v24, v25
v_lshlrev_b32 v26, 16, v197
v_and_b32 v27, 0xffff0000, v197
v_sub_f32 v26, v26, v21
v_sub_f32 v27, v27, v21
v_cvt_pk_bf16_f32 v197, v26, v27
v_lshlrev_b32 v28, 16, v198
v_and_b32 v29, 0xffff0000, v198
v_sub_f32 v28, v28, v21
v_sub_f32 v29, v29, v21
v_cvt_pk_bf16_f32 v198, v28, v29
v_lshlrev_b32 v30, 16, v199
v_and_b32 v31, 0xffff0000, v199
v_sub_f32 v30, v30, v21
v_sub_f32 v31, v31, v21
v_cvt_pk_bf16_f32 v199, v30, v31
v_lshlrev_b32 v24, 16, v200
v_and_b32 v25, 0xffff0000, v200
v_sub_f32 v24, v24, v22
v_sub_f32 v25, v25, v22
v_cvt_pk_bf16_f32 v200, v24, v25
v_lshlrev_b32 v26, 16, v201
v_and_b32 v27, 0xffff0000, v201
v_sub_f32 v26, v26, v22
v_sub_f32 v27, v27, v22
v_cvt_pk_bf16_f32 v201, v26, v27
v_lshlrev_b32 v28, 16, v202
v_and_b32 v29, 0xffff0000, v202
v_sub_f32 v28, v28, v22
v_sub_f32 v29, v29, v22
v_cvt_pk_bf16_f32 v202, v28, v29
v_lshlrev_b32 v30, 16, v203
v_and_b32 v31, 0xffff0000, v203
v_sub_f32 v30, v30, v22
v_sub_f32 v31, v31, v22
v_cvt_pk_bf16_f32 v203, v30, v31
v_lshlrev_b32 v24, 16, v204
v_and_b32 v25, 0xffff0000, v204
v_sub_f32 v24, v24, v23
v_sub_f32 v25, v25, v23
v_cvt_pk_bf16_f32 v204, v24, v25
v_lshlrev_b32 v26, 16, v205
v_and_b32 v27, 0xffff0000, v205
v_sub_f32 v26, v26, v23
v_sub_f32 v27, v27, v23
v_cvt_pk_bf16_f32 v205, v26, v27
v_lshlrev_b32 v28, 16, v206
v_and_b32 v29, 0xffff0000, v206
v_sub_f32 v28, v28, v23
v_sub_f32 v29, v29, v23
v_cvt_pk_bf16_f32 v206, v28, v29
v_lshlrev_b32 v30, 16, v207
v_and_b32 v31, 0xffff0000, v207
v_sub_f32 v30, v30, v23
v_sub_f32 v31, v31, v23
v_cvt_pk_bf16_f32 v207, v30, v31
s_lshr_b32 s20, s5, 2
s_lshl_b32 s20, s20, 3
s_lshr_b32 s21, s6, 2
s_add_u32 s20, s20, s21
s_and_b32 s21, s5, 3
s_lshl_b32 s21, s21, 2
s_and_b32 s22, s6, 3
s_add_u32 s21, s21, s22
s_lshl_b32 s24, s20, 3
s_sub_u32 s25, s24, 1
s_max_i32 s35, s25, 0
s_mul_i32 s25, s35, 18432
s_lshl_b32 s26, s4, 1
s_add_u32 s36, s24, s26
s_mul_i32 s24, s36, 18432
s_add_u32 s26, s24, s70
s_add_u32 s27, s26, 18432
s_add_u32 s28, s25, s70
v_add_u32 v4, 0x10000, v2
v_add_u32 v5, 0x20000, v2
s_cmp_eq_u32 s4, 3
s_cselect_b32 s29, 0, s4
s_cselect_b32 s31, 16, 9
s_lshl_b32 s30, s29, 10
v_and_b32 v12, 15, v1
v_mov_b32 v13, 2146435072
v_cmp_le_u32 vcc, s31, v12
s_nop 1
v_cndmask_b32 v19, v13, v2, vcc
s_add_u32 s31, s30, 2048
v_add_u32 v6, s31, v2
v_add_u32 v7, s31, v4
v_add_u32 v8, s31, v5
s_add_u32 s31, s30, 5120
v_add_u32 v9, s31, v2
v_add_u32 v10, s31, v4
v_add_u32 v11, s31, v5
s_lshr_b32 s22, s21, 1
s_lshl_b32 s22, s22, 7
s_and_b32 s23, s21, 1
s_mul_i32 s23, s23, 48
s_add_u32 s22, s22, s23
s_lshl_b32 s22, s22, 7
s_add_u32 s22, s22, 917504
v_min_u32 v16, 47, v1
v_lshlrev_b32 v16, 7, v16
s_mov_b32 s52, 0
L_poll1:
buffer_load_dwordx2 v[14:15], v16, s[8:11], s22 offen sc1
s_add_u32 s52, s52, 1
s_waitcnt vmcnt(0)
v_cmp_ne_u64 vcc, s[68:69], v[14:15]
s_cmp_ge_u32 s52, 0x100000
s_cbranch_scc1 L_got1
s_and_b64 exec, exec, vcc
s_cbranch_execnz L_poll1
L_got1:
s_mov_b64 exec, -1
s_lshr_b32 s20, s5, 2
s_lshl_b32 s20, s20, 3
s_lshr_b32 s21, s6, 2
s_add_u32 s20, s20, s21
s_and_b32 s21, s5, 3
s_lshl_b32 s21, s21, 2
s_and_b32 s22, s6, 3
s_add_u32 s21, s21, s22
s_mul_i32 s22, s21, 147456
s_add_u32 s22, s22, 4198400
s_mul_i32 s23, s4, 36864
s_add_u32 s22, s22, s23
s_add_u32 m0, s23, 0
s_add_u32 s40, s22, 0
buffer_load_dwordx4 v2, s[8:11], s40 offen offset:0 sc1 lds
buffer_load_dwordx4 v2, s[8:11], s40 offen offset:1024 sc1 lds
buffer_load_dwordx4 v2, s[8:11], s40 offen offset:2048 sc1 lds
buffer_load_dwordx4 v2, s[8:11], s40 offen offset:3072 sc1 lds
s_add_u32 m0, s23, 4096
s_add_u32 s40, s22, 4096
buffer_load_dwordx4 v2, s[8:11], s40 offen offset:0 sc1 lds
buffer_load_dwordx4 v2, s[8:11], s40 offen offset:1024 sc1 lds
buffer_load_dwordx4 v2, s[8:11], s40 offen offset:2048 sc1 lds
buffer_load_dwordx4 v2, s[8:11], s40 offen offset:3072 sc1 lds
s_add_u32 m0, s23, 8192
s_add_u32 s40, s22, 8192
buffer_load_dwordx4 v2, s[8:11], s40 offen offset:0 sc1 lds
buffer_load_dwordx4 v2, s[8:11], s40 offen offset:1024 sc1 lds
buffer_load_dwordx4 v2, s[8:11], s40 offen offset:2048 sc1 lds
buffer_load_dwordx4 v2, s[8:11], s40 offen offset:3072 sc1 lds
s_add_u32 m0, s23, 12288
s_add_u32 s40, s22, 12288
buffer_load_dwordx4 v2, s[8:11], s40 offen offset:0 sc1 lds
buffer_load_dwordx4 v2, s[8:11], s40 offen offset:1024 sc1 lds
buffer_load_dwordx4 v2, s[8:11], s40 offen offset:2048 sc1 lds
buffer_load_dwordx4 v2, s[8:11], s40 offen offset:3072 sc1 lds
s_add_u32 m0, s23, 16384
s_add_u32 s40, s22, 16384
buffer_load_dwordx4 v2, s[8:11], s40 offen offset:0 sc1 lds
buffer_load_dwordx4 v2, s[8:11], s40 offen offset:1024 sc1 lds
buffer_load_dwordx4 v2, s[8:11], s40 offen offset:2048 sc1 lds
buffer_load_dwordx4 v2, s[8:11], s40 offen offset:3072 sc1 lds
s_add_u32 m0, s23, 20480
s_add_u32 s40, s22, 20480
buffer_load_dwordx4 v2, s[8:11], s40 offen offset:0 sc1 lds
buffer_load_dwordx4 v2, s[8:11], s40 offen offset:1024 sc1 lds
buffer_load_dwordx4 v2, s[8:11], s40 offen offset:2048 sc1 lds
buffer_load_dwordx4 v2, s[8:11], s40 offen offset:3072 sc1 lds
s_add_u32 m0, s23, 24576
s_add_u32 s40, s22, 24576
buffer_load_dwordx4 v2, s[8:11], s40 offen offset:0 sc1 lds
buffer_load_dwordx4 v2, s[8:11], s40 offen offset:1024 sc1 lds
buffer_load_dwordx4 v2, s[8:11], s40 offen offset:2048 sc1 lds
buffer_load_dwordx4 v2, s[8:11], s40 offen offset:3072 sc1 lds
s_add_u32 m0, s23, 28672
s_add_u32 s40, s22, 28672
buffer_load_dwordx4 v2, s[8:11], s40 offen offset:0 sc1 lds
buffer_load_dwordx4 v2, s[8:11], s40 offen offset:1024 sc1 lds
buffer_load_dwordx4 v2, s[8:11], s40 offen offset:2048 sc1 lds
buffer_load_dwordx4 v2, s[8:11], s40 offen offset:3072 sc1 lds
s_add_u32 m0, s23, 32768
s_add_u32 s40, s22, 32768
buffer_load_dwordx4 v2, s[8:11], s40 offen offset:0 sc1 lds
buffer_load_dwordx4 v2, s[8:11], s40 offen offset:1024 sc1 lds
buffer_load_dwordx4 v2, s[8:11], s40 offen offset:2048 sc1 lds
buffer_load_dwordx4 v2, s[8:11], s40 offen offset:3072 sc1 lds
v_mul_u32_u24 v14, 43, v1
v_lshrrev_b32 v14, 8, v14
v_mul_u32_u24 v15, 6, v14
v_sub_u32 v15, v1, v15
v_cmp_eq_u32 vcc, 1, v14
v_mov_b32 v16, s36
s_nop 0
v_addc_co_u32 v16, vcc, 0, v16, vcc
v_cmp_eq_u32 vcc, 2, v14
v_mov_b32 v17, s35
s_nop 0
v_cndmask_b32 v16, v16, v17, vcc
v_lshlrev_b32 v16, 3, v16
v_add_lshl_u32 v16, v16, v15, 7
s_add_u32 s22, s77, 786432
s_and_b32 s23, s6, 7
s_lshl_b32 s23, s23, 7
s_add_u32 s23, s23, 64
v_min_u32 v17, 61, v1
v_add_u32 v17, s23, v17
v_lshlrev_b32 v17, 7, v17
v_add_u32 v17, 131072, v17
v_cmp_lt_u32 vcc, 31, v1
s_nop 1
v_cndmask_b32 v16, v16, v17, vcc
s_mov_b32 s52, 0
L_poll2:
buffer_load_dwordx2 v[14:15], v16, s[8:11], s22 offen sc1
s_add_u32 s52, s52, 1
s_waitcnt vmcnt(0)
v_cmp_ne_u64 vcc, s[68:69], v[14:15]
s_cmp_ge_u32 s52, 0x100000
s_cbranch_scc1 L_got2
s_and_b64 exec, exec, vcc
s_cbranch_execnz L_poll2
L_got2:
s_mov_b64 exec, -1
buffer_load_dwordx4 a[0:3], v2, s[8:11], s26 offen offset:0 sc1
buffer_load_dwordx4 a[72:75], v2, s[8:11], s27 offen offset:0 sc1
buffer_load_dwordx4 a[144:147], v19, s[8:11], s28 offen offset:0 sc1
buffer_load_dwordx4 a[4:7], v2, s[8:11], s26 offen offset:1024 sc1
buffer_load_dwordx4 a[76:79], v2, s[8:11], s27 offen offset:1024 sc1
buffer_load_dwordx4 a[148:151], v19, s[8:11], s28 offen offset:1024 sc1
buffer_load_dwordx4 a[8:11], v2, s[8:11], s26 offen offset:2048 sc1
buffer_load_dwordx4 a[80:83], v2, s[8:11], s27 offen offset:2048 sc1
buffer_load_dwordx4 a[152:155], v19, s[8:11], s28 offen offset:2048 sc1
buffer_load_dwordx4 a[12:15], v2, s[8:11], s26 offen offset:3072 sc1
buffer_load_dwordx4 a[84:87], v2, s[8:11], s27 offen offset:3072 sc1
buffer_load_dwordx4 a[156:159], v19, s[8:11], s28 offen offset:3072 sc1
s_add_u32 s26, s26, 4096
s_add_u32 s27, s27, 4096
s_add_u32 s28, s28, 4096
buffer_load_dwordx4 a[16:19], v2, s[8:11], s26 offen offset:0 sc1
buffer_load_dwordx4 a[88:91], v2, s[8:11], s27 offen offset:0 sc1
buffer_load_dwordx4 a[160:163], v19, s[8:11], s28 offen offset:0 sc1
buffer_load_dwordx4 a[20:23], v2, s[8:11], s26 offen offset:1024 sc1
buffer_load_dwordx4 a[92:95], v2, s[8:11], s27 offen offset:1024 sc1
buffer_load_dwordx4 a[164:167], v19, s[8:11], s28 offen offset:1024 sc1
buffer_load_dwordx4 a[24:27], v2, s[8:11], s26 offen offset:2048 sc1
buffer_load_dwordx4 a[96:99], v2, s[8:11], s27 offen offset:2048 sc1
buffer_load_dwordx4 a[168:171], v19, s[8:11], s28 offen offset:2048 sc1
buffer_load_dwordx4 a[28:31], v2, s[8:11], s26 offen offset:3072 sc1
buffer_load_dwordx4 a[100:103], v2, s[8:11], s27 offen offset:3072 sc1
buffer_load_dwordx4 a[172:175], v19, s[8:11], s28 offen offset:3072 sc1
v_lshrrev_b32 v13, 4, v1
v_lshlrev_b32 v14, 2, v13
v_sub_u32 v14, v12, v14
v_subrev_u32 v15, 0, v14
v_cmp_gt_u32 s[52:53], 8, v15
v_cmp_gt_i32 s[44:45], -8, v15
v_subrev_u32 v15, 1, v14
v_cmp_gt_u32 s[54:55], 8, v15
v_cmp_gt_i32 s[46:47], -8, v15
v_subrev_u32 v15, 2, v14
v_cmp_gt_u32 s[56:57], 8, v15
v_cmp_gt_i32 s[48:49], -8, v15
v_subrev_u32 v15, 3, v14
v_cmp_gt_u32 s[58:59], 8, v15
v_cmp_gt_i32 s[50:51], -8, v15
s_and_b32 s31, s20, 7
s_or_b32 s31, s31, s4
s_cmp_eq_u32 s31, 0
s_cselect_b64 s[60:61], 0, s[44:45]
s_cselect_b64 s[62:63], 0, s[46:47]
s_cselect_b64 s[64:65], 0, s[48:49]
s_cselect_b64 s[66:67], 0, s[50:51]
s_barrier
ds_read_b128 a[216:219], v2 offset:0
ds_read_b128 a[220:223], v2 offset:8192
ds_read_b128 a[224:227], v2 offset:1024
ds_read_b128 a[228:231], v2 offset:9216
ds_read_b128 a[232:235], v2 offset:2048
ds_read_b128 a[236:239], v2 offset:10240
s_waitcnt vmcnt(18)
s_waitcnt lgkmcnt(4)
v_mfma_f32_16x16x32_bf16 v[32:35], a[216:219], a[0:3], 0
s_add_u32 s26, s26, 4096
s_add_u32 s27, s27, 4096
s_add_u32 s28, s28, 4096
buffer_load_dwordx4 a[32:35], v2, s[8:11], s26 offen offset:0 sc1
v_mfma_f32_16x16x32_bf16 v[32:35], a[220:223], a[4:7], v[32:35]
ds_read_b128 a[240:243], v2 offset:3072
v_lshlrev_b32 v24, 16, v208
v_mfma_f32_16x16x32_bf16 v[36:39], a[216:219], a[72:75], 0
v_and_b32 v25, 0xffff0000, v208
v_sub_f32 v24, v24, v20
v_mfma_f32_16x16x32_bf16 v[36:39], a[220:223], a[76:79], v[36:39]
ds_read_b128 a[244:247], v2 offset:11264
s_waitcnt lgkmcnt(4)
v_mfma_f32_16x16x32_bf16 v[40:43], a[224:227], a[0:3], 0
buffer_load_dwordx4 a[104:107], v2, s[8:11], s27 offen offset:0 sc1
v_mfma_f32_16x16x32_bf16 v[40:43], a[228:231], a[4:7], v[40:43]
ds_read_b128 a[216:219], v2 offset:4096
v_sub_f32 v25, v25, v20
v_mfma_f32_16x16x32_bf16 v[44:47], a[224:227], a[72:75], 0
v_cvt_pk_bf16_f32 v208, v24, v25
v_lshlrev_b32 v26, 16, v209
v_mfma_f32_16x16x32_bf16 v[44:47], a[228:231], a[76:79], v[44:47]
ds_read_b128 a[220:223], v2 offset:12288
s_waitcnt lgkmcnt(4)
v_mfma_f32_16x16x32_bf16 v[48:51], a[232:235], a[0:3], 0
buffer_load_dwordx4 a[176:179], v19, s[8:11], s28 offen offset:0 sc1
v_mfma_f32_16x16x32_bf16 v[48:51], a[236:239], a[4:7], v[48:51]
ds_read_b128 a[224:227], v2 offset:5120
v_and_b32 v27, 0xffff0000, v209
v_mfma_f32_16x16x32_bf16 v[52:55], a[232:235], a[72:75], 0
v_sub_f32 v26, v26, v20
v_sub_f32 v27, v27, v20
v_mfma_f32_16x16x32_bf16 v[52:55], a[236:239], a[76:79], v[52:55]
ds_read_b128 a[228:231], v2 offset:13312
s_waitcnt lgkmcnt(4)
v_mfma_f32_16x16x32_bf16 v[56:59], a[240:243], a[0:3], 0
buffer_load_dwordx4 a[36:39], v2, s[8:11], s26 offen offset:1024 sc1
v_mfma_f32_16x16x32_bf16 v[56:59], a[244:247], a[4:7], v[56:59]
ds_read_b128 a[232:235], v2 offset:6144
v_cvt_pk_bf16_f32 v209, v26, v27
v_mfma_f32_16x16x32_bf16 v[60:63], a[240:243], a[72:75], 0
v_lshlrev_b32 v28, 16, v210
v_and_b32 v29, 0xffff0000, v210
v_mfma_f32_16x16x32_bf16 v[60:63], a[244:247], a[76:79], v[60:63]
ds_read_b128 a[236:239], v2 offset:14336
s_waitcnt lgkmcnt(4)
v_mfma_f32_16x16x32_bf16 v[64:67], a[216:219], a[0:3], 0
buffer_load_dwordx4 a[108:111], v2, s[8:11], s27 offen offset:1024 sc1
v_mfma_f32_16x16x32_bf16 v[64:67], a[220:223], a[4:7], v[64:67]
ds_read_b128 a[240:243], v2 offset:7168
v_sub_f32 v28, v28, v20
v_mfma_f32_16x16x32_bf16 v[68:71], a[216:219], a[72:75], 0
v_sub_f32 v29, v29, v20
v_cvt_pk_bf16_f32 v210, v28, v29
v_mfma_f32_16x16x32_bf16 v[68:71], a[220:223], a[76:79], v[68:71]
ds_read_b128 a[244:247], v2 offset:15360
s_waitcnt lgkmcnt(4)
v_mfma_f32_16x16x32_bf16 v[72:75], a[0:3], a[224:227], 0
buffer_load_dwordx4 a[180:183], v19, s[8:11], s28 offen offset:1024 sc1
v_mfma_f32_16x16x32_bf16 v[72:75], a[4:7], a[228:231], v[72:75]
ds_read_b128 a[216:219], v6 offset:0
v_lshlrev_b32 v30, 16, v211
v_mfma_f32_16x16x32_bf16 v[76:79], a[72:75], a[224:227], 0
v_and_b32 v31, 0xffff0000, v211
v_sub_f32 v30, v30, v20
v_mfma_f32_16x16x32_bf16 v[76:79], a[76:79], a[228:231], v[76:79]
ds_read_b128 a[220:223], v6 offset:8192
s_waitcnt lgkmcnt(4)
v_mfma_f32_16x16x32_bf16 v[80:83], a[0:3], a[232:235], 0
buffer_load_dwordx4 a[40:43], v2, s[8:11], s26 offen offset:2048 sc1
v_mfma_f32_16x16x32_bf16 v[80:83], a[4:7], a[236:239], v[80:83]
ds_read_b128 a[224:227], v9 offset:0
v_sub_f32 v31, v31, v20
v_mfma_f32_16x16x32_bf16 v[84:87], a[72:75], a[232:235], 0
v_cvt_pk_bf16_f32 v211, v30, v31
v_lshlrev_b32 v24, 16, v212
v_mfma_f32_16x16x32_bf16 v[84:87], a[76:79], a[236:239], v[84:87]
ds_read_b128 a[228:231], v9 offset:8192
s_waitcnt lgkmcnt(4)
v_mfma_f32_16x16x32_bf16 v[88:91], a[0:3], a[240:243], 0
buffer_load_dwordx4 a[112:115], v2, s[8:11], s27 offen offset:2048 sc1
v_mfma_f32_16x16x32_bf16 v[88:91], a[4:7], a[244:247], v[88:91]
ds_read_b128 a[232:235], v2 offset:16384
v_and_b32 v25, 0xffff0000, v212
v_mfma_f32_16x16x32_bf16 v[92:95], a[72:75], a[240:243], 0
v_sub_f32 v24, v24, v21
v_sub_f32 v25, v25, v21
v_mfma_f32_16x16x32_bf16 v[92:95], a[76:79], a[244:247], v[92:95]
ds_read_b128 a[236:239], v2 offset:24576
s_waitcnt lgkmcnt(4)
v_mfma_f32_16x16x32_bf16 v[96:99], a[216:219], a[144:147], 0
ds_read_b128 a[240:243], v2 offset:17408
buffer_load_dwordx4 a[184:187], v19, s[8:11], s28 offen offset:2048 sc1
v_mfma_f32_16x16x32_bf16 v[96:99], a[220:223], a[148:151], v[96:99]
ds_read_b128 a[244:247], v2 offset:25600
s_waitcnt lgkmcnt(4)
v_mfma_f32_16x16x32_bf16 v[100:103], a[144:147], a[224:227], 0
ds_read_b128 a[216:219], v2 offset:18432
v_cvt_pk_bf16_f32 v212, v24, v25
v_mfma_f32_16x16x32_bf16 v[100:103], a[148:151], a[228:231], v[100:103]
ds_read_b128 a[220:223], v2 offset:26624
s_waitcnt vmcnt(21)
s_waitcnt lgkmcnt(4)
v_mfma_f32_16x16x32_bf16 v[32:35], a[232:235], a[8:11], v[32:35]
buffer_load_dwordx4 a[44:47], v2, s[8:11], s26 offen offset:3072 sc1
v_mfma_f32_16x16x32_bf16 v[32:35], a[236:239], a[12:15], v[32:35]
ds_read_b128 a[224:227], v2 offset:19456
v_lshlrev_b32 v26, 16, v213
v_mfma_f32_16x16x32_bf16 v[36:39], a[232:235], a[80:83], v[36:39]
v_and_b32 v27, 0xffff0000, v213
v_sub_f32 v26, v26, v21
v_mfma_f32_16x16x32_bf16 v[36:39], a[236:239], a[84:87], v[36:39]
ds_read_b128 a[228:231], v2 offset:27648
s_waitcnt lgkmcnt(4)
v_mfma_f32_16x16x32_bf16 v[40:43], a[240:243], a[8:11], v[40:43]
buffer_load_dwordx4 a[116:119], v2, s[8:11], s27 offen offset:3072 sc1
v_mfma_f32_16x16x32_bf16 v[40:43], a[244:247], a[12:15], v[40:43]
ds_read_b128 a[232:235], v2 offset:20480
v_sub_f32 v27, v27, v21
v_mfma_f32_16x16x32_bf16 v[44:47], a[240:243], a[80:83], v[44:47]
v_cvt_pk_bf16_f32 v213, v26, v27
v_lshlrev_b32 v28, 16, v214
v_mfma_f32_16x16x32_bf16 v[44:47], a[244:247], a[84:87], v[44:47]
ds_read_b128 a[236:239], v2 offset:28672
s_waitcnt lgkmcnt(4)
v_mfma_f32_16x16x32_bf16 v[48:51], a[216:219], a[8:11], v[48:51]
buffer_load_dwordx4 a[188:191], v19, s[8:11], s28 offen offset:3072 sc1
v_mfma_f32_16x16x32_bf16 v[48:51], a[220:223], a[12:15], v[48:51]
ds_read_b128 a[240:243], v2 offset:21504
v_and_b32 v29, 0xffff0000, v214
v_mfma_f32_16x16x32_bf16 v[52:55], a[216:219], a[80:83], v[52:55]
v_sub_f32 v28, v28, v21
v_sub_f32 v29, v29, v21
v_mfma_f32_16x16x32_bf16 v[52:55], a[220:223], a[84:87], v[52:55]
ds_read_b128 a[244:247], v2 offset:29696
s_waitcnt lgkmcnt(4)
v_mfma_f32_16x16x32_bf16 v[56:59], a[224:227], a[8:11], v[56:59]
s_add_u32 s26, s26, 4096
s_add_u32 s27, s27, 4096
s_add_u32 s28, s28, 4096
buffer_load_dwordx4 a[48:51], v2, s[8:11], s26 offen offset:0 sc1
v_mfma_f32_16x16x32_bf16 v[56:59], a[228:231], a[12:15], v[56:59]
ds_read_b128 a[216:219], v2 offset:22528
v_cvt_pk_bf16_f32 v214, v28, v29
v_mfma_f32_16x16x32_bf16 v[60:63], a[224:227], a[80:83], v[60:63]
v_lshlrev_b32 v30, 16, v215
v_and_b32 v31, 0xffff0000, v215
v_mfma_f32_16x16x32_bf16 v[60:63], a[228:231], a[84:87], v[60:63]
ds_read_b128 a[220:223], v2 offset:30720
s_waitcnt lgkmcnt(4)
v_mfma_f32_16x16x32_bf16 v[64:67], a[232:235], a[8:11], v[64:67]
buffer_load_dwordx4 a[120:123], v2, s[8:11], s27 offen offset:0 sc1
v_mfma_f32_16x16x32_bf16 v[64:67], a[236:239], a[12:15], v[64:67]
ds_read_b128 a[224:227], v2 offset:23552
v_sub_f32 v30, v30, v21
v_mfma_f32_16x16x32_bf16 v[68:71], a[232:235], a[80:83], v[68:71]
v_sub_f32 v31, v31, v21
v_cvt_pk_bf16_f32 v215, v30, v31
v_mfma_f32_16x16x32_bf16 v[68:71], a[236:239], a[84:87], v[68:71]
ds_read_b128 a[228:231], v2 offset:31744
s_waitcnt lgkmcnt(4)
v_mfma_f32_16x16x32_bf16 v[72:75], a[8:11], a[240:243], v[72:75]
buffer_load_dwordx4 a[192:195], v19, s[8:11], s28 offen offset:0 sc1
v_mfma_f32_16x16x32_bf16 v[72:75], a[12:15], a[244:247], v[72:75]
ds_read_b128 a[232:235], v6 offset:16384
v_lshlrev_b32 v24, 16, v216
v_mfma_f32_16x16x32_bf16 v[76:79], a[80:83], a[240:243], v[76:79]
v_and_b32 v25, 0xffff0000, v216
v_sub_f32 v24, v24, v22
v_mfma_f32_16x16x32_bf16 v[76:79], a[84:87], a[244:247], v[76:79]
ds_read_b128 a[236:239], v6 offset:24576
s_waitcnt lgkmcnt(4)
v_mfma_f32_16x16x32_bf16 v[80:83], a[8:11], a[216:219], v[80:83]
buffer_load_dwordx4 a[52:55], v2, s[8:11], s26 offen offset:1024 sc1
v_mfma_f32_16x16x32_bf16 v[80:83], a[12:15], a[220:223], v[80:83]
ds_read_b128 a[240:243], v9 offset:16384
v_sub_f32 v25, v25, v22
v_mfma_f32_16x16x32_bf16 v[84:87], a[80:83], a[216:219], v[84:87]
v_cvt_pk_bf16_f32 v216, v24, v25
v_lshlrev_b32 v26, 16, v217
v_mfma_f32_16x16x32_bf16 v[84:87], a[84:87], a[220:223], v[84:87]
ds_read_b128 a[244:247], v9 offset:24576
s_waitcnt lgkmcnt(4)
v_mfma_f32_16x16x32_bf16 v[88:91], a[8:11], a[224:227], v[88:91]
buffer_load_dwordx4 a[124:127], v2, s[8:11], s27 offen offset:1024 sc1
v_mfma_f32_16x16x32_bf16 v[88:91], a[12:15], a[228:231], v[88:91]
ds_read_b128 a[216:219], v2 offset:32768
v_and_b32 v27, 0xffff0000, v217
v_mfma_f32_16x16x32_bf16 v[92:95], a[80:83], a[224:227], v[92:95]
v_sub_f32 v26, v26, v22
v_sub_f32 v27, v27, v22
v_mfma_f32_16x16x32_bf16 v[92:95], a[84:87], a[228:231], v[92:95]
ds_read_b128 a[220:223], v2 offset:40960
s_waitcnt lgkmcnt(4)
v_mfma_f32_16x16x32_bf16 v[96:99], a[232:235], a[152:155], v[96:99]
ds_read_b128 a[224:227], v2 offset:33792
buffer_load_dwordx4 a[196:199], v19, s[8:11], s28 offen offset:1024 sc1
v_mfma_f32_16x16x32_bf16 v[96:99], a[236:239], a[156:159], v[96:99]
ds_read_b128 a[228:231], v2 offset:41984
s_waitcnt lgkmcnt(4)
v_mfma_f32_16x16x32_bf16 v[100:103], a[152:155], a[240:243], v[100:103]
ds_read_b128 a[232:235], v2 offset:34816
v_cvt_pk_bf16_f32 v217, v26, v27
v_mfma_f32_16x16x32_bf16 v[100:103], a[156:159], a[244:247], v[100:103]
ds_read_b128 a[236:239], v2 offset:43008
s_waitcnt vmcnt(24)
s_waitcnt lgkmcnt(4)
v_mfma_f32_16x16x32_bf16 v[32:35], a[216:219], a[16:19], v[32:35]
buffer_load_dwordx4 a[56:59], v2, s[8:11], s26 offen offset:2048 sc1
v_mfma_f32_16x16x32_bf16 v[32:35], a[220:223], a[20:23], v[32:35]
ds_read_b128 a[240:243], v2 offset:35840
v_lshlrev_b32 v28, 16, v218
v_mfma_f32_16x16x32_bf16 v[36:39], a[216:219], a[88:91], v[36:39]
v_and_b32 v29, 0xffff0000, v218
v_sub_f32 v28, v28, v22
v_mfma_f32_16x16x32_bf16 v[36:39], a[220:223], a[92:95], v[36:39]
ds_read_b128 a[244:247], v2 offset:44032
s_waitcnt lgkmcnt(4)
v_mfma_f32_16x16x32_bf16 v[40:43], a[224:227], a[16:19], v[40:43]
buffer_load_dwordx4 a[128:131], v2, s[8:11], s27 offen offset:2048 sc1
v_mfma_f32_16x16x32_bf16 v[40:43], a[228:231], a[20:23], v[40:43]
ds_read_b128 a[216:219], v2 offset:36864
v_sub_f32 v29, v29, v22
v_mfma_f32_16x16x32_bf16 v[44:47], a[224:227], a[88:91], v[44:47]
v_cvt_pk_bf16_f32 v218, v28, v29
v_lshlrev_b32 v30, 16, v219
v_mfma_f32_16x16x32_bf16 v[44:47], a[228:231], a[92:95], v[44:47]
ds_read_b128 a[220:223], v2 offset:45056
s_waitcnt lgkmcnt(4)
v_mfma_f32_16x16x32_bf16 v[48:51], a[232:235], a[16:19], v[48:51]
buffer_load_dwordx4 a[200:203], v19, s[8:11], s28 offen offset:2048 sc1
v_mfma_f32_16x16x32_bf16 v[48:51], a[236:239], a[20:23], v[48:51]
ds_read_b128 a[224:227], v2 offset:37888
v_and_b32 v31, 0xffff0000, v219
v_mfma_f32_16x16x32_bf16 v[52:55], a[232:235], a[88:91], v[52:55]
v_sub_f32 v30, v30, v22
v_sub_f32 v31, v31, v22
v_mfma_f32_16x16x32_bf16 v[52:55], a[236:239], a[92:95], v[52:55]
ds_read_b128 a[228:231], v2 offset:46080
s_waitcnt lgkmcnt(4)
v_mfma_f32_16x16x32_bf16 v[56:59], a[240:243], a[16:19], v[56:59]
buffer_load_dwordx4 a[60:63], v2, s[8:11], s26 offen offset:3072 sc1
v_mfma_f32_16x16x32_bf16 v[56:59], a[244:247], a[20:23], v[56:59]
ds_read_b128 a[232:235], v2 offset:38912
v_cvt_pk_bf16_f32 v219, v30, v31
v_mfma_f32_16x16x32_bf16 v[60:63], a[240:243], a[88:91], v[60:63]
v_lshlrev_b32 v24, 16, v220
v_and_b32 v25, 0xffff0000, v220
v_mfma_f32_16x16x32_bf16 v[60:63], a[244:247], a[92:95], v[60:63]
ds_read_b128 a[236:239], v2 offset:47104
s_waitcnt lgkmcnt(4)
v_mfma_f32_16x16x32_bf16 v[64:67], a[216:219], a[16:19], v[64:67]
buffer_load_dwordx4 a[132:135], v2, s[8:11], s27 offen offset:3072 sc1
v_mfma_f32_16x16x32_bf16 v[64:67], a[220:223], a[20:23], v[64:67]
ds_read_b128 a[240:243], v2 offset:39936
v_sub_f32 v24, v24, v23
v_mfma_f32_16x16x32_bf16 v[68:71], a[216:219], a[88:91], v[68:71]
v_sub_f32 v25, v25, v23
v_cvt_pk_bf16_f32 v220, v24, v25
v_mfma_f32_16x16x32_bf16 v[68:71], a[220:223], a[92:95], v[68:71]
ds_read_b128 a[244:247], v2 offset:48128
s_waitcnt lgkmcnt(4)
v_mfma_f32_16x16x32_bf16 v[72:75], a[16:19], a[224:227], v[72:75]
buffer_load_dwordx4 a[204:207], v19, s[8:11], s28 offen offset:3072 sc1
v_mfma_f32_16x16x32_bf16 v[72:75], a[20:23], a[228:231], v[72:75]
ds_read_b128 a[216:219], v6 offset:32768
v_lshlrev_b32 v26, 16, v221
v_mfma_f32_16x16x32_bf16 v[76:79], a[88:91], a[224:227], v[76:79]
v_and_b32 v27, 0xffff0000, v221
v_sub_f32 v26, v26, v23
v_mfma_f32_16x16x32_bf16 v[76:79], a[92:95], a[228:231], v[76:79]
ds_read_b128 a[220:223], v6 offset:40960
s_waitcnt lgkmcnt(4)
v_mfma_f32_16x16x32_bf16 v[80:83], a[16:19], a[232:235], v[80:83]
s_add_u32 s26, s26, 4096
s_add_u32 s27, s27, 4096
s_add_u32 s28, s28, 4096
buffer_load_dwordx4 a[64:67], v2, s[8:11], s26 offen offset:0 sc1
v_mfma_f32_16x16x32_bf16 v[80:83], a[20:23], a[236:239], v[80:83]
ds_read_b128 a[224:227], v9 offset:32768
v_sub_f32 v27, v27, v23
v_mfma_f32_16x16x32_bf16 v[84:87], a[88:91], a[232:235], v[84:87]
v_cvt_pk_bf16_f32 v221, v26, v27
v_lshlrev_b32 v28, 16, v222
v_mfma_f32_16x16x32_bf16 v[84:87], a[92:95], a[236:239], v[84:87]
ds_read_b128 a[228:231], v9 offset:40960
s_waitcnt lgkmcnt(4)
v_mfma_f32_16x16x32_bf16 v[88:91], a[16:19], a[240:243], v[88:91]
buffer_load_dwordx4 a[136:139], v2, s[8:11], s27 offen offset:0 sc1
v_mfma_f32_16x16x32_bf16 v[88:91], a[20:23], a[244:247], v[88:91]
ds_read_b128 a[232:235], v2 offset:49152
v_and_b32 v29, 0xffff0000, v222
v_mfma_f32_16x16x32_bf16 v[92:95], a[88:91], a[240:243], v[92:95]
v_sub_f32 v28, v28, v23
v_sub_f32 v29, v29, v23
v_mfma_f32_16x16x32_bf16 v[92:95], a[92:95], a[244:247], v[92:95]
ds_read_b128 a[236:239], v2 offset:57344
s_waitcnt lgkmcnt(4)
v_mfma_f32_16x16x32_bf16 v[96:99], a[216:219], a[160:163], v[96:99]
ds_read_b128 a[240:243], v2 offset:50176
buffer_load_dwordx4 a[208:211], v19, s[8:11], s28 offen offset:0 sc1
v_mfma_f32_16x16x32_bf16 v[96:99], a[220:223], a[164:167], v[96:99]
ds_read_b128 a[244:247], v2 offset:58368
s_waitcnt lgkmcnt(4)
v_mfma_f32_16x16x32_bf16 v[100:103], a[160:163], a[224:227], v[100:103]
ds_read_b128 a[216:219], v2 offset:51200
v_cvt_pk_bf16_f32 v222, v28, v29
v_mfma_f32_16x16x32_bf16 v[100:103], a[164:167], a[228:231], v[100:103]
ds_read_b128 a[220:223], v2 offset:59392
s_waitcnt vmcnt(27)
s_waitcnt lgkmcnt(4)
v_mfma_f32_16x16x32_bf16 v[32:35], a[232:235], a[24:27], v[32:35]
buffer_load_dwordx4 a[68:71], v2, s[8:11], s26 offen offset:1024 sc1
v_mfma_f32_16x16x32_bf16 v[32:35], a[236:239], a[28:31], v[32:35]
ds_read_b128 a[224:227], v2 offset:52224
v_lshlrev_b32 v30, 16, v223
v_mfma_f32_16x16x32_bf16 v[36:39], a[232:235], a[96:99], v[36:39]
v_and_b32 v31, 0xffff0000, v223
v_sub_f32 v30, v30, v23
v_mfma_f32_16x16x32_bf16 v[36:39], a[236:239], a[100:103], v[36:39]
ds_read_b128 a[228:231], v2 offset:60416
s_waitcnt lgkmcnt(4)
v_mfma_f32_16x16x32_bf16 v[40:43], a[240:243], a[24:27], v[40:43]
buffer_load_dwordx4 a[140:143], v2, s[8:11], s27 offen offset:1024 sc1
v_mfma_f32_16x16x32_bf16 v[40:43], a[244:247], a[28:31], v[40:43]
ds_read_b128 a[232:235], v2 offset:53248
v_sub_f32 v31, v31, v23
v_mfma_f32_16x16x32_bf16 v[44:47], a[240:243], a[96:99], v[44:47]
v_cvt_pk_bf16_f32 v223, v30, v31
v_lshlrev_b32 v24, 16, v224
v_mfma_f32_16x16x32_bf16 v[44:47], a[244:247], a[100:103], v[44:47]
ds_read_b128 a[236:239], v2 offset:61440
s_waitcnt lgkmcnt(4)
v_mfma_f32_16x16x32_bf16 v[48:51], a[216:219], a[24:27], v[48:51]
buffer_load_dwordx4 a[212:215], v19, s[8:11], s28 offen offset:1024 sc1
v_mfma_f32_16x16x32_bf16 v[48:51], a[220:223], a[28:31], v[48:51]
ds_read_b128 a[240:243], v2 offset:54272
v_and_b32 v25, 0xffff0000, v224
v_mfma_f32_16x16x32_bf16 v[52:55], a[216:219], a[96:99], v[52:55]
v_sub_f32 v24, v24, v20
v_sub_f32 v25, v25, v20
v_mfma_f32_16x16x32_bf16 v[52:55], a[220:223], a[100:103], v[52:55]
ds_read_b128 a[244:247], v2 offset:62464
s_waitcnt lgkmcnt(4)
v_mfma_f32_16x16x32_bf16 v[56:59], a[224:227], a[24:27], v[56:59]
buffer_store_dwordx4 v[176:179], v156, s[8:11], 0 offen sc1
v_cvt_pk_bf16_f32 v224, v24, v25
v_mfma_f32_16x16x32_bf16 v[56:59], a[228:231], a[28:31], v[56:59]
ds_read_b128 a[216:219], v2 offset:55296
v_lshlrev_b32 v26, 16, v225
v_mfma_f32_16x16x32_bf16 v[60:63], a[224:227], a[96:99], v[60:63]
v_and_b32 v27, 0xffff0000, v225
v_sub_f32 v26, v26, v20
v_mfma_f32_16x16x32_bf16 v[60:63], a[228:231], a[100:103], v[60:63]
ds_read_b128 a[220:223], v2 offset:63488
s_waitcnt lgkmcnt(4)
v_mfma_f32_16x16x32_bf16 v[64:67], a[232:235], a[24:27], v[64:67]
buffer_store_dwordx4 v[180:183], v157, s[8:11], 0 offen sc1
v_sub_f32 v27, v27, v20
v_mfma_f32_16x16x32_bf16 v[64:67], a[236:239], a[28:31], v[64:67]
ds_read_b128 a[224:227], v2 offset:56320
v_cvt_pk_bf16_f32 v225, v26, v27
v_mfma_f32_16x16x32_bf16 v[68:71], a[232:235], a[96:99], v[68:71]
v_lshlrev_b32 v28, 16, v226
v_and_b32 v29, 0xffff0000, v226
v_mfma_f32_16x16x32_bf16 v[68:71], a[236:239], a[100:103], v[68:71]
ds_read_b128 a[228:231], v2 offset:64512
s_waitcnt lgkmcnt(4)
v_mfma_f32_16x16x32_bf16 v[72:75], a[24:27], a[240:243], v[72:75]
buffer_store_dwordx4 v[184:187], v158, s[8:11], 0 offen sc1
v_sub_f32 v28, v28, v20
v_mfma_f32_16x16x32_bf16 v[72:75], a[28:31], a[244:247], v[72:75]
ds_read_b128 a[232:235], v6 offset:49152
v_sub_f32 v29, v29, v20
v_mfma_f32_16x16x32_bf16 v[76:79], a[96:99], a[240:243], v[76:79]
v_cvt_pk_bf16_f32 v226, v28, v29
v_lshlrev_b32 v30, 16, v227
v_mfma_f32_16x16x32_bf16 v[76:79], a[100:103], a[244:247], v[76:79]
ds_read_b128 a[236:239], v6 offset:57344
s_waitcnt lgkmcnt(4)
v_mfma_f32_16x16x32_bf16 v[80:83], a[24:27], a[216:219], v[80:83]
buffer_store_dwordx4 v[188:191], v159, s[8:11], 0 offen sc1
v_and_b32 v31, 0xffff0000, v227
v_mfma_f32_16x16x32_bf16 v[80:83], a[28:31], a[220:223], v[80:83]
ds_read_b128 a[240:243], v9 offset:49152
v_sub_f32 v30, v30, v20
v_mfma_f32_16x16x32_bf16 v[84:87], a[96:99], a[216:219], v[84:87]
v_sub_f32 v31, v31, v20
v_cvt_pk_bf16_f32 v227, v30, v31
v_mfma_f32_16x16x32_bf16 v[84:87], a[100:103], a[220:223], v[84:87]
ds_read_b128 a[244:247], v9 offset:57344
s_waitcnt lgkmcnt(4)
v_mfma_f32_16x16x32_bf16 v[88:91], a[24:27], a[224:227], v[88:91]
buffer_store_dwordx4 v[192:195], v160, s[8:11], 0 offen sc1
v_lshlrev_b32 v24, 16, v228
v_mfma_f32_16x16x32_bf16 v[88:91], a[28:31], a[228:231], v[88:91]
ds_read_b128 a[216:219], v4 offset:0
v_and_b32 v25, 0xffff0000, v228
v_mfma_f32_16x16x32_bf16 v[92:95], a[96:99], a[224:227], v[92:95]
v_sub_f32 v24, v24, v21
v_sub_f32 v25, v25, v21
v_mfma_f32_16x16x32_bf16 v[92:95], a[100:103], a[228:231], v[92:95]
ds_read_b128 a[220:223], v4 offset:8192
s_waitcnt lgkmcnt(4)
v_mfma_f32_16x16x32_bf16 v[96:99], a[232:235], a[168:171], v[96:99]
ds_read_b128 a[224:227], v4 offset:1024
buffer_store_dwordx4 v[196:199], v161, s[8:11], 0 offen sc1
v_cvt_pk_bf16_f32 v228, v24, v25
v_mfma_f32_16x16x32_bf16 v[96:99], a[236:239], a[172:175], v[96:99]
ds_read_b128 a[228:231], v4 offset:9216
s_waitcnt lgkmcnt(4)
v_mfma_f32_16x16x32_bf16 v[100:103], a[168:171], a[240:243], v[100:103]
ds_read_b128 a[232:235], v4 offset:2048
v_lshlrev_b32 v26, 16, v229
v_mfma_f32_16x16x32_bf16 v[100:103], a[172:175], a[244:247], v[100:103]
ds_read_b128 a[236:239], v4 offset:10240
s_waitcnt vmcnt(30)
s_waitcnt lgkmcnt(4)
v_mfma_f32_16x16x32_bf16 v[32:35], a[216:219], a[32:35], v[32:35]
buffer_store_dwordx4 v[200:203], v162, s[8:11], 0 offen sc1
v_and_b32 v27, 0xffff0000, v229
v_mfma_f32_16x16x32_bf16 v[32:35], a[220:223], a[36:39], v[32:35]
ds_read_b128 a[240:243], v4 offset:3072
v_sub_f32 v26, v26, v21
v_mfma_f32_16x16x32_bf16 v[36:39], a[216:219], a[104:107], v[36:39]
v_sub_f32 v27, v27, v21
v_cvt_pk_bf16_f32 v229, v26, v27
v_mfma_f32_16x16x32_bf16 v[36:39], a[220:223], a[108:111], v[36:39]
ds_read_b128 a[244:247], v4 offset:11264
s_waitcnt lgkmcnt(4)
v_mfma_f32_16x16x32_bf16 v[40:43], a[224:227], a[32:35], v[40:43]
buffer_store_dwordx4 v[204:207], v163, s[8:11], 0 offen sc1
v_lshlrev_b32 v28, 16, v230
v_mfma_f32_16x16x32_bf16 v[40:43], a[228:231], a[36:39], v[40:43]
ds_read_b128 a[216:219], v4 offset:4096
v_and_b32 v29, 0xffff0000, v230
v_mfma_f32_16x16x32_bf16 v[44:47], a[224:227], a[104:107], v[44:47]
v_sub_f32 v28, v28, v21
v_sub_f32 v29, v29, v21
v_mfma_f32_16x16x32_bf16 v[44:47], a[228:231], a[108:111], v[44:47]
ds_read_b128 a[220:223], v4 offset:12288
s_waitcnt lgkmcnt(4)
v_mfma_f32_16x16x32_bf16 v[48:51], a[232:235], a[32:35], v[48:51]
buffer_store_dwordx4 v[208:211], v164, s[8:11], 0 offen sc1
v_cvt_pk_bf16_f32 v230, v28, v29
v_mfma_f32_16x16x32_bf16 v[48:51], a[236:239], a[36:39], v[48:51]
ds_read_b128 a[224:227], v4 offset:5120
v_lshlrev_b32 v30, 16, v231
v_mfma_f32_16x16x32_bf16 v[52:55], a[232:235], a[104:107], v[52:55]
v_and_b32 v31, 0xffff0000, v231
v_sub_f32 v30, v30, v21
v_mfma_f32_16x16x32_bf16 v[52:55], a[236:239], a[108:111], v[52:55]
ds_read_b128 a[228:231], v4 offset:13312
s_waitcnt lgkmcnt(4)
v_mfma_f32_16x16x32_bf16 v[56:59], a[240:243], a[32:35], v[56:59]
buffer_store_dwordx4 v[212:215], v165, s[8:11], 0 offen sc1
v_sub_f32 v31, v31, v21
v_mfma_f32_16x16x32_bf16 v[56:59], a[244:247], a[36:39], v[56:59]
ds_read_b128 a[232:235], v4 offset:6144
v_cvt_pk_bf16_f32 v231, v30, v31
v_mfma_f32_16x16x32_bf16 v[60:63], a[240:243], a[104:107], v[60:63]
v_lshlrev_b32 v24, 16, v232
v_and_b32 v25, 0xffff0000, v232
v_mfma_f32_16x16x32_bf16 v[60:63], a[244:247], a[108:111], v[60:63]
ds_read_b128 a[236:239], v4 offset:14336
s_waitcnt lgkmcnt(4)
v_mfma_f32_16x16x32_bf16 v[64:67], a[216:219], a[32:35], v[64:67]
buffer_store_dwordx4 v[216:219], v166, s[8:11], 0 offen sc1
v_sub_f32 v24, v24, v22
v_mfma_f32_16x16x32_bf16 v[64:67], a[220:223], a[36:39], v[64:67]
ds_read_b128 a[240:243], v4 offset:7168
v_sub_f32 v25, v25, v22
v_mfma_f32_16x16x32_bf16 v[68:71], a[216:219], a[104:107], v[68:71]
v_cvt_pk_bf16_f32 v232, v24, v25
v_lshlrev_b32 v26, 16, v233
v_mfma_f32_16x16x32_bf16 v[68:71], a[220:223], a[108:111], v[68:71]
ds_read_b128 a[244:247], v4 offset:15360
s_waitcnt lgkmcnt(4)
v_mfma_f32_16x16x32_bf16 v[72:75], a[32:35], a[224:227], v[72:75]
buffer_store_dwordx4 v[220:223], v167, s[8:11], 0 offen sc1
v_and_b32 v27, 0xffff0000, v233
v_mfma_f32_16x16x32_bf16 v[72:75], a[36:39], a[228:231], v[72:75]
ds_read_b128 a[216:219], v7 offset:0
v_sub_f32 v26, v26, v22
v_mfma_f32_16x16x32_bf16 v[76:79], a[104:107], a[224:227], v[76:79]
v_sub_f32 v27, v27, v22
v_cvt_pk_bf16_f32 v233, v26, v27
v_mfma_f32_16x16x32_bf16 v[76:79], a[108:111], a[228:231], v[76:79]
ds_read_b128 a[220:223], v7 offset:8192
s_waitcnt lgkmcnt(4)
v_mfma_f32_16x16x32_bf16 v[80:83], a[32:35], a[232:235], v[80:83]
buffer_store_dwordx4 v[224:227], v168, s[8:11], 0 offen sc1
v_lshlrev_b32 v28, 16, v234
v_mfma_f32_16x16x32_bf16 v[80:83], a[36:39], a[236:239], v[80:83]
ds_read_b128 a[224:227], v10 offset:0
v_and_b32 v29, 0xffff0000, v234
v_mfma_f32_16x16x32_bf16 v[84:87], a[104:107], a[232:235], v[84:87]
v_sub_f32 v28, v28, v22
v_sub_f32 v29, v29, v22
v_mfma_f32_16x16x32_bf16 v[84:87], a[108:111], a[236:239], v[84:87]
ds_read_b128 a[228:231], v10 offset:8192
s_waitcnt lgkmcnt(4)
v_mfma_f32_16x16x32_bf16 v[88:91], a[32:35], a[240:243], v[88:91]
buffer_store_dwordx4 v[228:231], v169, s[8:11], 0 offen sc1
v_cvt_pk_bf16_f32 v234, v28, v29
v_mfma_f32_16x16x32_bf16 v[88:91], a[36:39], a[244:247], v[88:91]
ds_read_b128 a[232:235], v4 offset:16384
v_lshlrev_b32 v30, 16, v235
v_mfma_f32_16x16x32_bf16 v[92:95], a[104:107], a[240:243], v[92:95]
v_and_b32 v31, 0xffff0000, v235
v_sub_f32 v30, v30, v22
v_mfma_f32_16x16x32_bf16 v[92:95], a[108:111], a[244:247], v[92:95]
ds_read_b128 a[236:239], v4 offset:24576
s_waitcnt lgkmcnt(4)
v_mfma_f32_16x16x32_bf16 v[96:99], a[216:219], a[176:179], v[96:99]
ds_read_b128 a[240:243], v4 offset:17408
v_sub_f32 v31, v31, v22
v_mfma_f32_16x16x32_bf16 v[96:99], a[220:223], a[180:183], v[96:99]
ds_read_b128 a[244:247], v4 offset:25600
s_waitcnt lgkmcnt(4)
v_mfma_f32_16x16x32_bf16 v[100:103], a[176:179], a[224:227], v[100:103]
ds_read_b128 a[216:219], v4 offset:18432
v_cvt_pk_bf16_f32 v235, v30, v31
v_mfma_f32_16x16x32_bf16 v[100:103], a[180:183], a[228:231], v[100:103]
ds_read_b128 a[220:223], v4 offset:26624
s_waitcnt vmcnt(32)
s_waitcnt lgkmcnt(4)
v_mfma_f32_16x16x32_bf16 v[32:35], a[232:235], a[40:43], v[32:35]
buffer_store_dwordx4 v[232:235], v170, s[8:11], 0 offen sc1
v_lshlrev_b32 v24, 16, v236
v_mfma_f32_16x16x32_bf16 v[32:35], a[236:239], a[44:47], v[32:35]
ds_read_b128 a[224:227], v4 offset:19456
v_and_b32 v25, 0xffff0000, v236
v_mfma_f32_16x16x32_bf16 v[36:39], a[232:235], a[112:115], v[36:39]
v_sub_f32 v24, v24, v23
v_sub_f32 v25, v25, v23
v_mfma_f32_16x16x32_bf16 v[36:39], a[236:239], a[116:119], v[36:39]
ds_read_b128 a[228:231], v4 offset:27648
s_waitcnt lgkmcnt(4)
v_mfma_f32_16x16x32_bf16 v[40:43], a[240:243], a[40:43], v[40:43]
v_cvt_pk_bf16_f32 v236, v24, v25
v_lshlrev_b32 v26, 16, v237
v_mfma_f32_16x16x32_bf16 v[40:43], a[244:247], a[44:47], v[40:43]
ds_read_b128 a[232:235], v4 offset:20480
v_and_b32 v27, 0xffff0000, v237
v_mfma_f32_16x16x32_bf16 v[44:47], a[240:243], a[112:115], v[44:47]
v_sub_f32 v26, v26, v23
v_sub_f32 v27, v27, v23
v_mfma_f32_16x16x32_bf16 v[44:47], a[244:247], a[116:119], v[44:47]
ds_read_b128 a[236:239], v4 offset:28672
s_waitcnt lgkmcnt(4)
v_mfma_f32_16x16x32_bf16 v[48:51], a[216:219], a[40:43], v[48:51]
v_cvt_pk_bf16_f32 v237, v26, v27
v_lshlrev_b32 v28, 16, v238
v_mfma_f32_16x16x32_bf16 v[48:51], a[220:223], a[44:47], v[48:51]
ds_read_b128 a[240:243], v4 offset:21504
v_and_b32 v29, 0xffff0000, v238
v_mfma_f32_16x16x32_bf16 v[52:55], a[216:219], a[112:115], v[52:55]
v_sub_f32 v28, v28, v23
v_sub_f32 v29, v29, v23
v_mfma_f32_16x16x32_bf16 v[52:55], a[220:223], a[116:119], v[52:55]
ds_read_b128 a[244:247], v4 offset:29696
s_waitcnt lgkmcnt(4)
v_mfma_f32_16x16x32_bf16 v[56:59], a[224:227], a[40:43], v[56:59]
v_cvt_pk_bf16_f32 v238, v28, v29
v_lshlrev_b32 v30, 16, v239
v_mfma_f32_16x16x32_bf16 v[56:59], a[228:231], a[44:47], v[56:59]
ds_read_b128 a[216:219], v4 offset:22528
v_and_b32 v31, 0xffff0000, v239
v_mfma_f32_16x16x32_bf16 v[60:63], a[224:227], a[112:115], v[60:63]
v_sub_f32 v30, v30, v23
v_sub_f32 v31, v31, v23
v_mfma_f32_16x16x32_bf16 v[60:63], a[228:231], a[116:119], v[60:63]
ds_read_b128 a[220:223], v4 offset:30720
s_waitcnt lgkmcnt(4)
v_mfma_f32_16x16x32_bf16 v[64:67], a[232:235], a[40:43], v[64:67]
v_cvt_pk_bf16_f32 v239, v30, v31
v_lshlrev_b32 v24, 16, v240
v_mfma_f32_16x16x32_bf16 v[64:67], a[236:239], a[44:47], v[64:67]
ds_read_b128 a[224:227], v4 offset:23552
v_and_b32 v25, 0xffff0000, v240
v_mfma_f32_16x16x32_bf16 v[68:71], a[232:235], a[112:115], v[68:71]
v_sub_f32 v24, v24, v20
v_sub_f32 v25, v25, v20
v_mfma_f32_16x16x32_bf16 v[68:71], a[236:239], a[116:119], v[68:71]
ds_read_b128 a[228:231], v4 offset:31744
s_waitcnt lgkmcnt(4)
v_mfma_f32_16x16x32_bf16 v[72:75], a[40:43], a[240:243], v[72:75]
buffer_store_dwordx4 v[236:239], v171, s[8:11], 0 offen sc1
v_cvt_pk_bf16_f32 v240, v24, v25
v_mfma_f32_16x16x32_bf16 v[72:75], a[44:47], a[244:247], v[72:75]
ds_read_b128 a[232:235], v7 offset:16384
v_lshlrev_b32 v26, 16, v241
v_mfma_f32_16x16x32_bf16 v[76:79], a[112:115], a[240:243], v[76:79]
v_and_b32 v27, 0xffff0000, v241
v_sub_f32 v26, v26, v20
v_mfma_f32_16x16x32_bf16 v[76:79], a[116:119], a[244:247], v[76:79]
ds_read_b128 a[236:239], v7 offset:24576
s_waitcnt lgkmcnt(4)
v_mfma_f32_16x16x32_bf16 v[80:83], a[40:43], a[216:219], v[80:83]
v_sub_f32 v27, v27, v20
v_cvt_pk_bf16_f32 v241, v26, v27
v_mfma_f32_16x16x32_bf16 v[80:83], a[44:47], a[220:223], v[80:83]
ds_read_b128 a[240:243], v10 offset:16384
v_lshlrev_b32 v28, 16, v242
v_mfma_f32_16x16x32_bf16 v[84:87], a[112:115], a[216:219], v[84:87]
v_and_b32 v29, 0xffff0000, v242
v_sub_f32 v28, v28, v20
v_mfma_f32_16x16x32_bf16 v[84:87], a[116:119], a[220:223], v[84:87]
ds_read_b128 a[244:247], v10 offset:24576
s_waitcnt lgkmcnt(4)
v_mfma_f32_16x16x32_bf16 v[88:91], a[40:43], a[224:227], v[88:91]
v_sub_f32 v29, v29, v20
v_cvt_pk_bf16_f32 v242, v28, v29
v_mfma_f32_16x16x32_bf16 v[88:91], a[44:47], a[228:231], v[88:91]
ds_read_b128 a[216:219], v4 offset:32768
v_lshlrev_b32 v30, 16, v243
v_mfma_f32_16x16x32_bf16 v[92:95], a[112:115], a[224:227], v[92:95]
v_and_b32 v31, 0xffff0000, v243
v_sub_f32 v30, v30, v20
v_mfma_f32_16x16x32_bf16 v[92:95], a[116:119], a[228:231], v[92:95]
ds_read_b128 a[220:223], v4 offset:40960
s_waitcnt lgkmcnt(4)
v_mfma_f32_16x16x32_bf16 v[96:99], a[232:235], a[184:187], v[96:99]
ds_read_b128 a[224:227], v4 offset:33792
v_sub_f32 v31, v31, v20
v_mfma_f32_16x16x32_bf16 v[96:99], a[236:239], a[188:191], v[96:99]
ds_read_b128 a[228:231], v4 offset:41984
s_waitcnt lgkmcnt(4)
v_mfma_f32_16x16x32_bf16 v[100:103], a[184:187], a[240:243], v[100:103]
ds_read_b128 a[232:235], v4 offset:34816
v_cvt_pk_bf16_f32 v243, v30, v31
v_mfma_f32_16x16x32_bf16 v[100:103], a[188:191], a[244:247], v[100:103]
ds_read_b128 a[236:239], v4 offset:43008
s_waitcnt vmcnt(28)
s_waitcnt lgkmcnt(4)
v_mfma_f32_16x16x32_bf16 v[32:35], a[216:219], a[48:51], v[32:35]
buffer_store_dwordx4 v[240:243], v172, s[8:11], 0 offen sc1
v_lshlrev_b32 v24, 16, v244
v_mfma_f32_16x16x32_bf16 v[32:35], a[220:223], a[52:55], v[32:35]
ds_read_b128 a[240:243], v4 offset:35840
v_and_b32 v25, 0xffff0000, v244
v_mfma_f32_16x16x32_bf16 v[36:39], a[216:219], a[120:123], v[36:39]
v_sub_f32 v24, v24, v21
v_sub_f32 v25, v25, v21
v_mfma_f32_16x16x32_bf16 v[36:39], a[220:223], a[124:127], v[36:39]
ds_read_b128 a[244:247], v4 offset:44032
s_waitcnt lgkmcnt(4)
v_mfma_f32_16x16x32_bf16 v[40:43], a[224:227], a[48:51], v[40:43]
v_cvt_pk_bf16_f32 v244, v24, v25
v_lshlrev_b32 v26, 16, v245
v_mfma_f32_16x16x32_bf16 v[40:43], a[228:231], a[52:55], v[40:43]
ds_read_b128 a[216:219], v4 offset:36864
v_and_b32 v27, 0xffff0000, v245
v_mfma_f32_16x16x32_bf16 v[44:47], a[224:227], a[120:123], v[44:47]
v_sub_f32 v26, v26, v21
v_sub_f32 v27, v27, v21
v_mfma_f32_16x16x32_bf16 v[44:47], a[228:231], a[124:127], v[44:47]
ds_read_b128 a[220:223], v4 offset:45056
s_waitcnt lgkmcnt(4)
v_mfma_f32_16x16x32_bf16 v[48:51], a[232:235], a[48:51], v[48:51]
v_cvt_pk_bf16_f32 v245, v26, v27
v_lshlrev_b32 v28, 16, v246
v_mfma_f32_16x16x32_bf16 v[48:51], a[236:239], a[52:55], v[48:51]
ds_read_b128 a[224:227], v4 offset:37888
v_and_b32 v29, 0xffff0000, v246
v_mfma_f32_16x16x32_bf16 v[52:55], a[232:235], a[120:123], v[52:55]
v_sub_f32 v28, v28, v21
v_sub_f32 v29, v29, v21
v_mfma_f32_16x16x32_bf16 v[52:55], a[236:239], a[124:127], v[52:55]
ds_read_b128 a[228:231], v4 offset:46080
s_waitcnt lgkmcnt(4)
v_mfma_f32_16x16x32_bf16 v[56:59], a[240:243], a[48:51], v[56:59]
v_cvt_pk_bf16_f32 v246, v28, v29
v_lshlrev_b32 v30, 16, v247
v_mfma_f32_16x16x32_bf16 v[56:59], a[244:247], a[52:55], v[56:59]
ds_read_b128 a[232:235], v4 offset:38912
v_and_b32 v31, 0xffff0000, v247
v_mfma_f32_16x16x32_bf16 v[60:63], a[240:243], a[120:123], v[60:63]
v_sub_f32 v30, v30, v21
v_sub_f32 v31, v31, v21
v_mfma_f32_16x16x32_bf16 v[60:63], a[244:247], a[124:127], v[60:63]
ds_read_b128 a[236:239], v4 offset:47104
s_waitcnt lgkmcnt(4)
v_mfma_f32_16x16x32_bf16 v[64:67], a[216:219], a[48:51], v[64:67]
v_cvt_pk_bf16_f32 v247, v30, v31
v_lshlrev_b32 v24, 16, v248
v_mfma_f32_16x16x32_bf16 v[64:67], a[220:223], a[52:55], v[64:67]
ds_read_b128 a[240:243], v4 offset:39936
v_and_b32 v25, 0xffff0000, v248
v_mfma_f32_16x16x32_bf16 v[68:71], a[216:219], a[120:123], v[68:71]
v_sub_f32 v24, v24, v22
v_sub_f32 v25, v25, v22
v_mfma_f32_16x16x32_bf16 v[68:71], a[220:223], a[124:127], v[68:71]
ds_read_b128 a[244:247], v4 offset:48128
s_waitcnt lgkmcnt(4)
v_mfma_f32_16x16x32_bf16 v[72:75], a[48:51], a[224:227], v[72:75]
buffer_store_dwordx4 v[244:247], v173, s[8:11], 0 offen sc1
v_cvt_pk_bf16_f32 v248, v24, v25
v_mfma_f32_16x16x32_bf16 v[72:75], a[52:55], a[228:231], v[72:75]
ds_read_b128 a[216:219], v7 offset:32768
v_lshlrev_b32 v26, 16, v249
v_mfma_f32_16x16x32_bf16 v[76:79], a[120:123], a[224:227], v[76:79]
v_and_b32 v27, 0xffff0000, v249
v_sub_f32 v26, v26, v22
v_mfma_f32_16x16x32_bf16 v[76:79], a[124:127], a[228:231], v[76:79]
ds_read_b128 a[220:223], v7 offset:40960
s_waitcnt lgkmcnt(4)
v_mfma_f32_16x16x32_bf16 v[80:83], a[48:51], a[232:235], v[80:83]
v_sub_f32 v27, v27, v22
v_cvt_pk_bf16_f32 v249, v26, v27
v_mfma_f32_16x16x32_bf16 v[80:83], a[52:55], a[236:239], v[80:83]
ds_read_b128 a[224:227], v10 offset:32768
v_lshlrev_b32 v28, 16, v250
v_mfma_f32_16x16x32_bf16 v[84:87], a[120:123], a[232:235], v[84:87]
v_and_b32 v29, 0xffff0000, v250
v_sub_f32 v28, v28, v22
v_mfma_f32_16x16x32_bf16 v[84:87], a[124:127], a[236:239], v[84:87]
ds_read_b128 a[228:231], v10 offset:40960
s_waitcnt lgkmcnt(4)
v_mfma_f32_16x16x32_bf16 v[88:91], a[48:51], a[240:243], v[88:91]
v_sub_f32 v29, v29, v22
v_cvt_pk_bf16_f32 v250, v28, v29
v_mfma_f32_16x16x32_bf16 v[88:91], a[52:55], a[244:247], v[88:91]
ds_read_b128 a[232:235], v4 offset:49152
v_lshlrev_b32 v30, 16, v251
v_mfma_f32_16x16x32_bf16 v[92:95], a[120:123], a[240:243], v[92:95]
v_and_b32 v31, 0xffff0000, v251
v_sub_f32 v30, v30, v22
v_mfma_f32_16x16x32_bf16 v[92:95], a[124:127], a[244:247], v[92:95]
ds_read_b128 a[236:239], v4 offset:57344
s_waitcnt lgkmcnt(4)
v_mfma_f32_16x16x32_bf16 v[96:99], a[216:219], a[192:195], v[96:99]
ds_read_b128 a[240:243], v4 offset:50176
v_sub_f32 v31, v31, v22
v_mfma_f32_16x16x32_bf16 v[96:99], a[220:223], a[196:199], v[96:99]
ds_read_b128 a[244:247], v4 offset:58368
s_waitcnt lgkmcnt(4)
v_mfma_f32_16x16x32_bf16 v[100:103], a[192:195], a[224:227], v[100:103]
ds_read_b128 a[216:219], v4 offset:51200
v_cvt_pk_bf16_f32 v251, v30, v31
v_mfma_f32_16x16x32_bf16 v[100:103], a[196:199], a[228:231], v[100:103]
ds_read_b128 a[220:223], v4 offset:59392
s_waitcnt vmcnt(24)
s_waitcnt lgkmcnt(4)
v_mfma_f32_16x16x32_bf16 v[32:35], a[232:235], a[56:59], v[32:35]
buffer_store_dwordx4 v[248:251], v174, s[8:11], 0 offen sc1
v_lshlrev_b32 v24, 16, v252
v_mfma_f32_16x16x32_bf16 v[32:35], a[236:239], a[60:63], v[32:35]
ds_read_b128 a[224:227], v4 offset:52224
v_and_b32 v25, 0xffff0000, v252
v_mfma_f32_16x16x32_bf16 v[36:39], a[232:235], a[128:131], v[36:39]
v_sub_f32 v24, v24, v23
v_sub_f32 v25, v25, v23
v_mfma_f32_16x16x32_bf16 v[36:39], a[236:239], a[132:135], v[36:39]
ds_read_b128 a[228:231], v4 offset:60416
s_waitcnt lgkmcnt(4)
v_mfma_f32_16x16x32_bf16 v[40:43], a[240:243], a[56:59], v[40:43]
v_cvt_pk_bf16_f32 v252, v24, v25
v_lshlrev_b32 v26, 16, v253
v_mfma_f32_16x16x32_bf16 v[40:43], a[244:247], a[60:63], v[40:43]
ds_read_b128 a[232:235], v4 offset:53248
v_and_b32 v27, 0xffff0000, v253
v_mfma_f32_16x16x32_bf16 v[44:47], a[240:243], a[128:131], v[44:47]
v_sub_f32 v26, v26, v23
v_sub_f32 v27, v27, v23
v_mfma_f32_16x16x32_bf16 v[44:47], a[244:247], a[132:135], v[44:47]
ds_read_b128 a[236:239], v4 offset:61440
s_waitcnt lgkmcnt(4)
v_mfma_f32_16x16x32_bf16 v[48:51], a[216:219], a[56:59], v[48:51]
v_cvt_pk_bf16_f32 v253, v26, v27
v_lshlrev_b32 v28, 16, v254
v_mfma_f32_16x16x32_bf16 v[48:51], a[220:223], a[60:63], v[48:51]
ds_read_b128 a[240:243], v4 offset:54272
v_and_b32 v29, 0xffff0000, v254
v_mfma_f32_16x16x32_bf16 v[52:55], a[216:219], a[128:131], v[52:55]
v_sub_f32 v28, v28, v23
v_sub_f32 v29, v29, v23
v_mfma_f32_16x16x32_bf16 v[52:55], a[220:223], a[132:135], v[52:55]
ds_read_b128 a[244:247], v4 offset:62464
s_waitcnt lgkmcnt(4)
v_mfma_f32_16x16x32_bf16 v[56:59], a[224:227], a[56:59], v[56:59]
v_cvt_pk_bf16_f32 v254, v28, v29
v_lshlrev_b32 v30, 16, v255
v_mfma_f32_16x16x32_bf16 v[56:59], a[228:231], a[60:63], v[56:59]
ds_read_b128 a[216:219], v4 offset:55296
v_and_b32 v31, 0xffff0000, v255
v_mfma_f32_16x16x32_bf16 v[60:63], a[224:227], a[128:131], v[60:63]
v_sub_f32 v30, v30, v23
v_sub_f32 v31, v31, v23
v_mfma_f32_16x16x32_bf16 v[60:63], a[228:231], a[132:135], v[60:63]
ds_read_b128 a[220:223], v4 offset:63488
s_waitcnt lgkmcnt(4)
v_mfma_f32_16x16x32_bf16 v[64:67], a[232:235], a[56:59], v[64:67]
v_cvt_pk_bf16_f32 v255, v30, v31
v_mfma_f32_16x16x32_bf16 v[64:67], a[236:239], a[60:63], v[64:67]
ds_read_b128 a[224:227], v4 offset:56320
v_mfma_f32_16x16x32_bf16 v[68:71], a[232:235], a[128:131], v[68:71]
v_mfma_f32_16x16x32_bf16 v[68:71], a[236:239], a[132:135], v[68:71]
ds_read_b128 a[228:231], v4 offset:64512
s_waitcnt lgkmcnt(4)
v_mfma_f32_16x16x32_bf16 v[72:75], a[56:59], a[240:243], v[72:75]
buffer_store_dwordx4 v[252:255], v175, s[8:11], 0 offen sc1
v_mfma_f32_16x16x32_bf16 v[72:75], a[60:63], a[244:247], v[72:75]
ds_read_b128 a[232:235], v7 offset:49152
v_mfma_f32_16x16x32_bf16 v[76:79], a[128:131], a[240:243], v[76:79]
v_mfma_f32_16x16x32_bf16 v[76:79], a[132:135], a[244:247], v[76:79]
ds_read_b128 a[236:239], v7 offset:57344
s_waitcnt lgkmcnt(4)
v_mfma_f32_16x16x32_bf16 v[80:83], a[56:59], a[216:219], v[80:83]
v_mfma_f32_16x16x32_bf16 v[80:83], a[60:63], a[220:223], v[80:83]
ds_read_b128 a[240:243], v10 offset:49152
v_mfma_f32_16x16x32_bf16 v[84:87], a[128:131], a[216:219], v[84:87]
v_mfma_f32_16x16x32_bf16 v[84:87], a[132:135], a[220:223], v[84:87]
ds_read_b128 a[244:247], v10 offset:57344
s_waitcnt lgkmcnt(4)
v_mfma_f32_16x16x32_bf16 v[88:91], a[56:59], a[224:227], v[88:91]
v_mfma_f32_16x16x32_bf16 v[88:91], a[60:63], a[228:231], v[88:91]
ds_read_b128 a[216:219], v5 offset:0
v_mfma_f32_16x16x32_bf16 v[92:95], a[128:131], a[224:227], v[92:95]
v_mfma_f32_16x16x32_bf16 v[92:95], a[132:135], a[228:231], v[92:95]
ds_read_b128 a[220:223], v5 offset:8192
s_waitcnt lgkmcnt(4)
v_mfma_f32_16x16x32_bf16 v[96:99], a[232:235], a[200:203], v[96:99]
ds_read_b128 a[224:227], v5 offset:1024
v_mfma_f32_16x16x32_bf16 v[96:99], a[236:239], a[204:207], v[96:99]
ds_read_b128 a[228:231], v5 offset:9216
s_waitcnt lgkmcnt(4)
v_mfma_f32_16x16x32_bf16 v[100:103], a[200:203], a[240:243], v[100:103]
ds_read_b128 a[232:235], v5 offset:2048
v_mfma_f32_16x16x32_bf16 v[100:103], a[204:207], a[244:247], v[100:103]
ds_read_b128 a[236:239], v5 offset:10240
s_waitcnt vmcnt(20)
s_waitcnt lgkmcnt(4)
v_mfma_f32_16x16x32_bf16 v[32:35], a[216:219], a[64:67], v[32:35]
v_mfma_f32_16x16x32_bf16 v[32:35], a[220:223], a[68:71], v[32:35]
ds_read_b128 a[240:243], v5 offset:3072
v_mfma_f32_16x16x32_bf16 v[36:39], a[216:219], a[136:139], v[36:39]
v_mfma_f32_16x16x32_bf16 v[36:39], a[220:223], a[140:143], v[36:39]
ds_read_b128 a[244:247], v5 offset:11264
s_waitcnt lgkmcnt(4)
v_mfma_f32_16x16x32_bf16 v[40:43], a[224:227], a[64:67], v[40:43]
v_mfma_f32_16x16x32_bf16 v[40:43], a[228:231], a[68:71], v[40:43]
ds_read_b128 a[216:219], v5 offset:4096
v_mfma_f32_16x16x32_bf16 v[44:47], a[224:227], a[136:139], v[44:47]
v_mfma_f32_16x16x32_bf16 v[44:47], a[228:231], a[140:143], v[44:47]
ds_read_b128 a[220:223], v5 offset:12288
s_waitcnt lgkmcnt(4)
v_mfma_f32_16x16x32_bf16 v[48:51], a[232:235], a[64:67], v[48:51]
v_mfma_f32_16x16x32_bf16 v[48:51], a[236:239], a[68:71], v[48:51]
ds_read_b128 a[224:227], v5 offset:5120
v_mfma_f32_16x16x32_bf16 v[52:55], a[232:235], a[136:139], v[52:55]
v_mfma_f32_16x16x32_bf16 v[52:55], a[236:239], a[140:143], v[52:55]
ds_read_b128 a[228:231], v5 offset:13312
s_waitcnt lgkmcnt(4)
v_mfma_f32_16x16x32_bf16 v[56:59], a[240:243], a[64:67], v[56:59]
v_mfma_f32_16x16x32_bf16 v[56:59], a[244:247], a[68:71], v[56:59]
ds_read_b128 a[232:235], v5 offset:6144
v_mfma_f32_16x16x32_bf16 v[60:63], a[240:243], a[136:139], v[60:63]
v_mfma_f32_16x16x32_bf16 v[60:63], a[244:247], a[140:143], v[60:63]
ds_read_b128 a[236:239], v5 offset:14336
s_waitcnt lgkmcnt(4)
v_mfma_f32_16x16x32_bf16 v[64:67], a[216:219], a[64:67], v[64:67]
v_mfma_f32_16x16x32_bf16 v[64:67], a[220:223], a[68:71], v[64:67]
ds_read_b128 a[240:243], v5 offset:7168
v_mfma_f32_16x16x32_bf16 v[68:71], a[216:219], a[136:139], v[68:71]
v_mfma_f32_16x16x32_bf16 v[68:71], a[220:223], a[140:143], v[68:71]
ds_read_b128 a[244:247], v5 offset:15360
s_waitcnt lgkmcnt(4)
v_mfma_f32_16x16x32_bf16 v[72:75], a[64:67], a[224:227], v[72:75]
v_mfma_f32_16x16x32_bf16 v[72:75], a[68:71], a[228:231], v[72:75]
ds_read_b128 a[216:219], v8 offset:0
v_mfma_f32_16x16x32_bf16 v[76:79], a[136:139], a[224:227], v[76:79]
v_mfma_f32_16x16x32_bf16 v[76:79], a[140:143], a[228:231], v[76:79]
ds_read_b128 a[220:223], v8 offset:8192
s_waitcnt lgkmcnt(4)
v_mfma_f32_16x16x32_bf16 v[80:83], a[64:67], a[232:235], v[80:83]
v_mfma_f32_16x16x32_bf16 v[80:83], a[68:71], a[236:239], v[80:83]
ds_read_b128 a[224:227], v11 offset:0
v_mfma_f32_16x16x32_bf16 v[84:87], a[136:139], a[232:235], v[84:87]
v_mfma_f32_16x16x32_bf16 v[84:87], a[140:143], a[236:239], v[84:87]
ds_read_b128 a[228:231], v11 offset:8192
s_waitcnt lgkmcnt(4)
v_mfma_f32_16x16x32_bf16 v[88:91], a[64:67], a[240:243], v[88:91]
v_mfma_f32_16x16x32_bf16 v[88:91], a[68:71], a[244:247], v[88:91]
v_mfma_f32_16x16x32_bf16 v[92:95], a[136:139], a[240:243], v[92:95]
v_mfma_f32_16x16x32_bf16 v[92:95], a[140:143], a[244:247], v[92:95]
s_waitcnt lgkmcnt(2)
v_mfma_f32_16x16x32_bf16 v[96:99], a[216:219], a[208:211], v[96:99]
v_mfma_f32_16x16x32_bf16 v[96:99], a[220:223], a[212:215], v[96:99]
s_waitcnt lgkmcnt(0)
v_mfma_f32_16x16x32_bf16 v[100:103], a[208:211], a[224:227], v[100:103]
v_mfma_f32_16x16x32_bf16 v[100:103], a[212:215], a[228:231], v[100:103]
L_att:
v_cvt_pk_bf16_f32 v116, v52, v53
v_cvt_pk_bf16_f32 v117, v54, v55
v_cvt_pk_bf16_f32 v120, v60, v61
v_cvt_pk_bf16_f32 v121, v62, v63
v_cvt_pk_bf16_f32 v160, v68, v69
v_cvt_pk_bf16_f32 v161, v70, v71
v_cvt_pk_bf16_f32 v126, v76, v77
v_cvt_pk_bf16_f32 v127, v78, v79
v_cvt_pk_bf16_f32 v132, v84, v85
v_cvt_pk_bf16_f32 v133, v86, v87
v_cvt_pk_bf16_f32 v138, v92, v93
v_cvt_pk_bf16_f32 v139, v94, v95
v_cvt_pk_bf16_f32 v156, v96, v97
v_cvt_pk_bf16_f32 v157, v98, v99
v_cvt_pk_bf16_f32 v158, v100, v101
v_cvt_pk_bf16_f32 v159, v102, v103
v_lshlrev_b32 v14, 3, v1
s_mul_i32 s31, s4, 3072
s_add_u32 s32, s31, 147456
v_add_u32 v15, s32, v14
s_lshl_b32 s33, s29, 9
s_add_u32 s33, s33, 147456
v_add_u32 v16, s33, v14
s_cmp_eq_u32 s4, 3
s_cbranch_scc1 L_a1_noxch
ds_write_b64 v16, v[156:157]
ds_write_b64 v16, v[158:159] offset:1536
ds_write_b64 v15, v[116:117] offset:3072
ds_write_b64 v15, v[120:121] offset:3584
ds_write_b64 v15, v[160:161] offset:4096
ds_write_b64 v15, v[126:127] offset:4608
ds_write_b64 v15, v[132:133] offset:5120
ds_write_b64 v15, v[138:139] offset:5632
L_a1_noxch:
v_cvt_pk_bf16_f32 v110, v48, v49
v_cvt_pk_bf16_f32 v111, v50, v51
v_cvt_pk_bf16_f32 v114, v56, v57
v_cvt_pk_bf16_f32 v115, v58, v59
v_cvt_pk_bf16_f32 v124, v72, v73
v_cvt_pk_bf16_f32 v125, v74, v75
v_cvt_pk_bf16_f32 v130, v80, v81
v_cvt_pk_bf16_f32 v131, v82, v83
v_cvt_pk_bf16_f32 v136, v88, v89
v_cvt_pk_bf16_f32 v137, v90, v91
v_cvt_pk_bf16_f32 v140, v32, v33
v_cvt_pk_bf16_f32 v141, v34, v35
v_cvt_pk_bf16_f32 v146, v40, v41
v_cvt_pk_bf16_f32 v147, v42, v43
v_cvt_pk_bf16_f32 v142, v64, v65
v_cvt_pk_bf16_f32 v145, v66, v67
v_mov_b32 v143, 0
v_mov_b32 v144, 0
v_mov_b32 v112, 0
v_mov_b32 v113, 0
s_nop 0
v_permlane16_swap_b32 v142, v112
v_permlane16_swap_b32 v145, v113
v_cvt_pk_bf16_f32 v148, v36, v37
v_cvt_pk_bf16_f32 v149, v38, v39
v_cvt_pk_bf16_f32 v154, v44, v45
v_cvt_pk_bf16_f32 v155, v46, v47
v_cvt_pk_bf16_f32 v150, v68, v69
v_cvt_pk_bf16_f32 v153, v70, v71
v_mov_b32 v151, 0
v_mov_b32 v152, 0
v_mov_b32 v118, 0
v_mov_b32 v119, 0
s_nop 0
v_permlane16_swap_b32 v150, v118
v_permlane16_swap_b32 v153, v119
v_add_u32 v17, 16, v12
v_add_u32 v18, 32, v12
v_cmp_gt_u32 vcc, 16, v1
s_nop 1
v_cndmask_b32 v17, v18, v17, vcc
v_lshlrev_b32 v17, 3, v17
v_add_u32 v17, s32, v17
s_waitcnt lgkmcnt(0)
s_barrier
ds_read_b64 v[104:105], v15
ds_read_b64 v[108:109], v15 offset:512
ds_read_b64 v[106:107], v17 offset:1024
ds_read_b64 v[122:123], v15 offset:1536
ds_read_b64 v[128:129], v15 offset:2048
ds_read_b64 v[134:135], v15 offset:2560
v_mfma_f32_16x16x32_bf16 v[32:35], v[110:113], v[148:151], 0
v_mfma_f32_16x16x32_bf16 v[36:39], v[116:119], v[148:151], 0
v_mfma_f32_16x16x32_bf16 v[40:43], v[112:115], v[152:155], 0
v_mfma_f32_16x16x32_bf16 v[44:47], v[118:121], v[152:155], 0
s_waitcnt lgkmcnt(0)
v_mfma_f32_16x16x32_bf16 v[48:51], v[104:107], v[140:143], 0
v_mfma_f32_16x16x32_bf16 v[52:55], v[110:113], v[140:143], 0
v_mfma_f32_16x16x32_bf16 v[56:59], v[106:109], v[144:147], 0
v_mfma_f32_16x16x32_bf16 v[60:63], v[112:115], v[144:147], 0
v_mov_b32 v18, 0xff61b1e6
s_mov_b32 s34, 0x3eae1a93
v_cndmask_b32 v32, v18, v32, s[44:45]
v_cndmask_b32 v40, v18, v40, s[44:45]
s_nop 0
v_cndmask_b32 v48, v18, v48, s[60:61]
s_nop 0
v_cndmask_b32 v56, v18, v56, s[60:61]
v_cndmask_b32 v33, v18, v33, s[46:47]
v_cndmask_b32 v41, v18, v41, s[46:47]
v_cndmask_b32 v49, v18, v49, s[62:63]
v_cndmask_b32 v57, v18, v57, s[62:63]
v_cndmask_b32 v34, v18, v34, s[48:49]
v_cndmask_b32 v42, v18, v42, s[48:49]
v_cndmask_b32 v50, v18, v50, s[64:65]
v_cndmask_b32 v58, v18, v58, s[64:65]
v_cndmask_b32 v35, v18, v35, s[50:51]
v_cndmask_b32 v43, v18, v43, s[50:51]
v_cndmask_b32 v51, v18, v51, s[66:67]
v_cndmask_b32 v59, v18, v59, s[66:67]
v_cndmask_b32 v36, v18, v36, s[52:53]
v_cndmask_b32 v44, v18, v44, s[52:53]
v_cndmask_b32 v52, v18, v52, s[52:53]
v_cndmask_b32 v60, v18, v60, s[52:53]
v_cndmask_b32 v37, v18, v37, s[54:55]
v_cndmask_b32 v45, v18, v45, s[54:55]
v_cndmask_b32 v53, v18, v53, s[54:55]
v_cndmask_b32 v61, v18, v61, s[54:55]
v_cndmask_b32 v38, v18, v38, s[56:57]
v_cndmask_b32 v46, v18, v46, s[56:57]
v_cndmask_b32 v54, v18, v54, s[56:57]
v_cndmask_b32 v62, v18, v62, s[56:57]
v_cndmask_b32 v39, v18, v39, s[58:59]
v_cndmask_b32 v47, v18, v47, s[58:59]
v_cndmask_b32 v55, v18, v55, s[58:59]
v_cndmask_b32 v63, v18, v63, s[58:59]
v_max3_f32 v20, v32, v33, v34
v_max3_f32 v21, v40, v41, v42
v_max3_f32 v22, v48, v49, v50
v_max3_f32 v23, v56, v57, v58
v_max3_f32 v20, v20, v35, v36
v_max3_f32 v21, v21, v43, v44
v_max3_f32 v22, v22, v51, v52
v_max3_f32 v23, v23, v59, v60
v_max3_f32 v20, v20, v37, v38
v_max3_f32 v21, v21, v45, v46
v_max3_f32 v22, v22, v53, v54
v_max3_f32 v23, v23, v61, v62
v_max_f32 v20, v20, v39
v_max_f32 v21, v21, v47
v_max_f32 v22, v22, v55
v_max_f32 v23, v23, v63
v_mov_b32 v24, v20
v_mov_b32 v25, v21
v_mov_b32 v26, v22
v_mov_b32 v27, v23
v_permlane16_swap_b32 v20, v24
v_permlane16_swap_b32 v21, v25
v_permlane16_swap_b32 v22, v26
v_permlane16_swap_b32 v23, v27
v_max_f32 v20, v20, v24
v_max_f32 v21, v21, v25
v_max_f32 v22, v22, v26
v_max_f32 v23, v23, v27
v_mov_b32 v24, v20
v_mov_b32 v25, v21
v_mov_b32 v26, v22
v_mov_b32 v27, v23
v_permlane32_swap_b32 v20, v24
v_permlane32_swap_b32 v21, v25
v_permlane32_swap_b32 v22, v26
v_permlane32_swap_b32 v23, v27
v_max_f32 v20, v20, v24
v_max_f32 v21, v21, v25
v_max_f32 v22, v22, v26
v_max_f32 v23, v23, v27
v_mul_f32 v20, s34, v20
v_mul_f32 v21, s34, v21
v_mul_f32 v22, s34, v22
v_mul_f32 v23, s34, v23
v_fma_f32 v32, v32, s34, -v20
v_fma_f32 v40, v40, s34, -v21
v_fma_f32 v48, v48, s34, -v22
v_fma_f32 v56, v56, s34, -v23
v_exp_f32 v32, v32
v_exp_f32 v40, v40
v_exp_f32 v48, v48
v_exp_f32 v56, v56
v_fma_f32 v33, v33, s34, -v20
v_fma_f32 v41, v41, s34, -v21
v_fma_f32 v49, v49, s34, -v22
v_fma_f32 v57, v57, s34, -v23
v_exp_f32 v33, v33
v_exp_f32 v41, v41
v_exp_f32 v49, v49
v_exp_f32 v57, v57
v_fma_f32 v34, v34, s34, -v20
v_fma_f32 v42, v42, s34, -v21
v_fma_f32 v50, v50, s34, -v22
v_fma_f32 v58, v58, s34, -v23
v_exp_f32 v34, v34
v_exp_f32 v42, v42
v_exp_f32 v50, v50
v_exp_f32 v58, v58
v_fma_f32 v35, v35, s34, -v20
v_fma_f32 v43, v43, s34, -v21
v_fma_f32 v51, v51, s34, -v22
v_fma_f32 v59, v59, s34, -v23
v_exp_f32 v35, v35
v_exp_f32 v43, v43
v_exp_f32 v51, v51
v_exp_f32 v59, v59
v_fma_f32 v36, v36, s34, -v20
v_fma_f32 v44, v44, s34, -v21
v_fma_f32 v52, v52, s34, -v22
v_fma_f32 v60, v60, s34, -v23
v_exp_f32 v36, v36
v_exp_f32 v44, v44
v_exp_f32 v52, v52
v_exp_f32 v60, v60
v_fma_f32 v37, v37, s34, -v20
v_fma_f32 v45, v45, s34, -v21
v_fma_f32 v53, v53, s34, -v22
v_fma_f32 v61, v61, s34, -v23
v_exp_f32 v37, v37
v_exp_f32 v45, v45
v_exp_f32 v53, v53
v_exp_f32 v61, v61
v_fma_f32 v38, v38, s34, -v20
v_fma_f32 v46, v46, s34, -v21
v_fma_f32 v54, v54, s34, -v22
v_fma_f32 v62, v62, s34, -v23
v_exp_f32 v38, v38
v_exp_f32 v46, v46
v_exp_f32 v54, v54
v_exp_f32 v62, v62
v_fma_f32 v39, v39, s34, -v20
v_fma_f32 v47, v47, s34, -v21
v_fma_f32 v55, v55, s34, -v22
v_fma_f32 v63, v63, s34, -v23
v_exp_f32 v39, v39
v_exp_f32 v47, v47
v_exp_f32 v55, v55
v_exp_f32 v63, v63
v_add_f32 v28, v32, v33
v_add_f32 v29, v40, v41
v_add_f32 v30, v48, v49
v_add_f32 v31, v56, v57
v_add_f32 v28, v28, v34
v_add_f32 v29, v29, v42
v_add_f32 v30, v30, v50
v_add_f32 v31, v31, v58
v_add_f32 v28, v28, v35
v_add_f32 v29, v29, v43
v_add_f32 v30, v30, v51
v_add_f32 v31, v31, v59
v_add_f32 v28, v28, v36
v_add_f32 v29, v29, v44
v_add_f32 v30, v30, v52
v_add_f32 v31, v31, v60
v_add_f32 v28, v28, v37
v_add_f32 v29, v29, v45
v_add_f32 v30, v30, v53
v_add_f32 v31, v31, v61
v_add_f32 v28, v28, v38
v_add_f32 v29, v29, v46
v_add_f32 v30, v30, v54
v_add_f32 v31, v31, v62
v_add_f32 v28, v28, v39
v_add_f32 v29, v29, v47
v_add_f32 v30, v30, v55
v_add_f32 v31, v31, v63
v_mov_b32 v24, v28
v_mov_b32 v25, v29
v_mov_b32 v26, v30
v_mov_b32 v27, v31
v_permlane16_swap_b32 v28, v24
v_permlane16_swap_b32 v29, v25
v_permlane16_swap_b32 v30, v26
v_permlane16_swap_b32 v31, v27
v_add_f32 v28, v28, v24
v_add_f32 v29, v29, v25
v_add_f32 v30, v30, v26
v_add_f32 v31, v31, v27
v_mov_b32 v24, v28
v_mov_b32 v25, v29
v_mov_b32 v26, v30
v_mov_b32 v27, v31
v_permlane32_swap_b32 v28, v24
v_permlane32_swap_b32 v29, v25
v_permlane32_swap_b32 v30, v26
v_permlane32_swap_b32 v31, v27
v_add_f32 v28, v28, v24
v_add_f32 v29, v29, v25
v_add_f32 v30, v30, v26
v_add_f32 v31, v31, v27
v_rcp_f32 v28, v28
v_rcp_f32 v29, v29
v_rcp_f32 v30, v30
v_rcp_f32 v31, v31
v_mul_f32 v32, v32, v28
v_mul_f32 v40, v40, v29
v_mul_f32 v48, v48, v30
v_mul_f32 v56, v56, v31
v_mul_f32 v33, v33, v28
v_mul_f32 v41, v41, v29
v_mul_f32 v49, v49, v30
v_mul_f32 v57, v57, v31
v_mul_f32 v34, v34, v28
v_mul_f32 v42, v42, v29
v_mul_f32 v50, v50, v30
v_mul_f32 v58, v58, v31
v_mul_f32 v35, v35, v28
v_mul_f32 v43, v43, v29
v_mul_f32 v51, v51, v30
v_mul_f32 v59, v59, v31
v_mul_f32 v36, v36, v28
v_mul_f32 v44, v44, v29
v_mul_f32 v52, v52, v30
v_mul_f32 v60, v60, v31
v_mul_f32 v37, v37, v28
v_mul_f32 v45, v45, v29
v_mul_f32 v53, v53, v30
v_mul_f32 v61, v61, v31
v_mul_f32 v38, v38, v28
v_mul_f32 v46, v46, v29
v_mul_f32 v54, v54, v30
v_mul_f32 v62, v62, v31
v_mul_f32 v39, v39, v28
v_mul_f32 v47, v47, v29
v_mul_f32 v55, v55, v30
v_mul_f32 v63, v63, v31
v_cvt_pk_bf16_f32 v64, v32, v33
v_cvt_pk_bf16_f32 v65, v34, v35
v_cvt_pk_bf16_f32 v66, v36, v37
v_cvt_pk_bf16_f32 v67, v38, v39
v_cvt_pk_bf16_f32 v68, v40, v41
v_cvt_pk_bf16_f32 v69, v42, v43
v_cvt_pk_bf16_f32 v70, v44, v45
v_cvt_pk_bf16_f32 v71, v46, v47
v_cvt_pk_bf16_f32 v72, v48, v49
v_cvt_pk_bf16_f32 v73, v50, v51
v_cvt_pk_bf16_f32 v74, v52, v53
v_cvt_pk_bf16_f32 v75, v54, v55
v_cvt_pk_bf16_f32 v76, v56, v57
v_cvt_pk_bf16_f32 v77, v58, v59
v_cvt_pk_bf16_f32 v78, v60, v61
v_cvt_pk_bf16_f32 v79, v62, v63
v_mfma_f32_16x16x32_bf16 v[80:83], v[124:127], v[64:67], 0
v_mfma_f32_16x16x32_bf16 v[84:87], v[136:139], v[64:67], 0
v_mfma_f32_16x16x32_bf16 v[88:91], v[130:133], v[68:71], 0
v_mfma_f32_16x16x32_bf16 v[92:95], v[136:139], v[68:71], 0
v_mfma_f32_16x16x32_bf16 v[96:99], v[122:125], v[72:75], 0
v_mfma_f32_16x16x32_bf16 v[100:103], v[134:137], v[72:75], 0
v_mfma_f32_16x16x32_bf16 v[164:167], v[128:131], v[76:79], 0
v_mfma_f32_16x16x32_bf16 v[168:171], v[134:137], v[76:79], 0
v_lshlrev_b32 v14, 3, v12
v_mov_b32 v15, 2146435072
v_cmp_gt_u32 vcc, 16, v1
s_nop 1
v_cndmask_b32 v14, v15, v14, vcc
s_add_u32 s26, s24, s72
s_lshl_b32 s27, s21, 10
s_add_u32 s27, s27, s26
s_lshl_b32 s28, s21, 7
s_add_u32 s28, s28, 16384
s_add_u32 s28, s28, s26
s_add_u32 s30, s27, 18432
s_add_u32 s31, s28, 18432
v_cvt_pk_bf16_f32 v180, v80, v81
v_cvt_pk_bf16_f32 v181, v82, v83
v_cvt_pk_bf16_f32 v182, v88, v89
v_cvt_pk_bf16_f32 v183, v90, v91
v_cvt_pk_bf16_f32 v184, v84, v85
v_cvt_pk_bf16_f32 v185, v94, v95
buffer_store_dwordx4 v[180:183], v2, s[8:11], s30 offen sc1
buffer_store_dwordx2 v[184:185], v14, s[8:11], s31 offen sc1
v_cvt_pk_bf16_f32 v172, v96, v97
v_cvt_pk_bf16_f32 v173, v98, v99
v_cvt_pk_bf16_f32 v174, v164, v165
v_cvt_pk_bf16_f32 v175, v166, v167
v_cvt_pk_bf16_f32 v176, v100, v101
v_cvt_pk_bf16_f32 v177, v170, v171
buffer_store_dwordx4 v[172:175], v2, s[8:11], s27 offen sc1
buffer_store_dwordx2 v[176:177], v14, s[8:11], s28 offen sc1
s_lshl_b32 s26, s20, 2
s_add_u32 s26, s26, s4
s_lshl_b32 s26, s26, 4
s_add_u32 s26, s26, s21
s_lshl_b32 s26, s26, 7
s_add_u32 s26, s26, s77
s_add_u32 s26, s26, 393216
s_and_b32 s37, s6, 7
s_mul_i32 s37, s37, 92160
s_mul_i32 s38, s4, 23552
s_add_u32 s37, s37, s38
s_add_u32 s37, s37, 6557696
v_mov_b32 v13, 2146435072
v_cmp_eq_u32 vcc, 0, v1
v_mov_b32 v14, s68
v_mov_b32 v15, s69
v_cndmask_b32 v13, v13, 0, vcc
s_add_u32 m0, s38, 0
s_add_u32 s40, s37, 0
buffer_load_dwordx4 v2, s[8:11], s40 offen offset:0 sc1 lds
buffer_load_dwordx4 v2, s[8:11], s40 offen offset:1024 sc1 lds
buffer_load_dwordx4 v2, s[8:11], s40 offen offset:2048 sc1 lds
buffer_load_dwordx4 v2, s[8:11], s40 offen offset:3072 sc1 lds
s_add_u32 m0, s38, 4096
s_add_u32 s40, s37, 4096
buffer_load_dwordx4 v2, s[8:11], s40 offen offset:0 sc1 lds
buffer_load_dwordx4 v2, s[8:11], s40 offen offset:1024 sc1 lds
buffer_load_dwordx4 v2, s[8:11], s40 offen offset:2048 sc1 lds
buffer_load_dwordx4 v2, s[8:11], s40 offen offset:3072 sc1 lds
s_waitcnt vmcnt(8)
buffer_store_dwordx2 v[14:15], v13, s[8:11], s26 offen sc1
s_add_u32 m0, s38, 8192
s_add_u32 s40, s37, 8192
buffer_load_dwordx4 v2, s[8:11], s40 offen offset:0 sc1 lds
buffer_load_dwordx4 v2, s[8:11], s40 offen offset:1024 sc1 lds
buffer_load_dwordx4 v2, s[8:11], s40 offen offset:2048 sc1 lds
buffer_load_dwordx4 v2, s[8:11], s40 offen offset:3072 sc1 lds
s_add_u32 m0, s38, 12288
s_add_u32 s40, s37, 12288
buffer_load_dwordx4 v2, s[8:11], s40 offen offset:0 sc1 lds
buffer_load_dwordx4 v2, s[8:11], s40 offen offset:1024 sc1 lds
buffer_load_dwordx4 v2, s[8:11], s40 offen offset:2048 sc1 lds
buffer_load_dwordx4 v2, s[8:11], s40 offen offset:3072 sc1 lds
s_add_u32 m0, s38, 16384
s_add_u32 s40, s37, 16384
buffer_load_dwordx4 v2, s[8:11], s40 offen offset:0 sc1 lds
buffer_load_dwordx4 v2, s[8:11], s40 offen offset:1024 sc1 lds
buffer_load_dwordx4 v2, s[8:11], s40 offen offset:2048 sc1 lds
buffer_load_dwordx4 v2, s[8:11], s40 offen offset:3072 sc1 lds
s_add_u32 m0, s38, 20480
s_add_u32 s40, s37, 20480
buffer_load_dwordx4 v2, s[8:11], s40 offen offset:0 sc1 lds
buffer_load_dwordx4 v2, s[8:11], s40 offen offset:1024 sc1 lds
buffer_load_dwordx4 v2, s[8:11], s40 offen offset:2048 sc1 lds
s_lshr_b32 s20, s6, 3
s_lshl_b32 s21, s5, 2
s_add_u32 s20, s20, s21
s_lshl_b32 s20, s20, 2
s_add_u32 s20, s20, s4
s_and_b32 s21, s6, 7
s_mul_i32 s24, s20, 18432
s_add_u32 s25, s24, s72
s_mul_i32 s26, s21, 2304
s_add_u32 s26, s26, s24
s_add_u32 s27, s26, s71
v_and_b32 v6, 15, v1
v_lshrrev_b32 v7, 4, v1
v_lshlrev_b32 v8, 4, v6
v_lshl_add_u32 v8, v7, 3, v8
v_add_u32 v8, 2048, v8
v_mov_b32 v9, 2146435072
v_cmp_gt_u32 vcc, 32, v1
s_nop 1
v_cndmask_b32 v4, v9, v8, vcc
v_add_u32 v5, 0x10000, v2
s_lshr_b32 s22, s20, 1
s_lshl_b32 s22, s22, 11
s_add_u32 s22, s22, s77
s_add_u32 s22, s22, 393216
v_lshlrev_b32 v10, 7, v6
s_mul_i32 s30, s2, 7282
s_lshr_b32 s30, s30, 16
s_mul_i32 s31, s30, 9
s_sub_u32 s31, s2, s31
s_lshr_b32 s32, s30, 3
s_and_b32 s30, s30, 7
s_mul_i32 s32, s32, 9
s_add_u32 s31, s31, s32
s_lshl_b32 s30, s30, 5
s_add_u32 s30, s30, s31
s_lshl_b32 s39, s30, 7
s_add_u32 s39, s39, 1966080
s_or_b32 s30, s4, s7
s_cmp_lg_u32 s30, 0
s_cselect_b32 s39, 2146435072, s39
s_cmp_ge_u32 s2, 216
s_cselect_b32 s39, 2146435072, s39
v_lshlrev_b32 v11, 3, v6
v_lshl_add_u32 v11, v7, 8, v11
s_mov_b32 s52, 0
L_poll3:
buffer_load_dwordx2 v[14:15], v10, s[8:11], s22 offen sc1
s_add_u32 s52, s52, 1
s_waitcnt vmcnt(0)
v_cmp_ne_u64 vcc, s[68:69], v[14:15]
s_cmp_ge_u32 s52, 0x100000
s_cbranch_scc1 L_got3
s_and_b64 exec, exec, vcc
s_cbranch_execnz L_poll3
L_got3:
s_mov_b64 exec, -1
buffer_load_dwordx4 a[0:3], v2, s[8:11], s25 offen offset:0 sc1
buffer_load_dwordx4 a[4:7], v2, s[8:11], s25 offen offset:1024 sc1
buffer_load_dwordx4 a[8:11], v2, s[8:11], s25 offen offset:2048 sc1
buffer_load_dwordx4 a[12:15], v2, s[8:11], s25 offen offset:3072 sc1
s_add_u32 s25, s25, 4096
buffer_load_dwordx4 a[16:19], v2, s[8:11], s25 offen offset:0 sc1
buffer_load_dwordx4 a[20:23], v2, s[8:11], s25 offen offset:1024 sc1
buffer_load_dwordx4 a[24:27], v2, s[8:11], s25 offen offset:2048 sc1
buffer_load_dwordx4 a[28:31], v2, s[8:11], s25 offen offset:3072 sc1
s_add_u32 s25, s25, 4096
buffer_load_dwordx4 a[32:35], v2, s[8:11], s25 offen offset:0 sc1
buffer_load_dwordx4 a[36:39], v2, s[8:11], s25 offen offset:1024 sc1
buffer_load_dwordx4 a[40:43], v2, s[8:11], s25 offen offset:2048 sc1
buffer_load_dwordx4 a[44:47], v2, s[8:11], s25 offen offset:3072 sc1
s_barrier
ds_read_b128 a[216:219], v2 offset:0
ds_read_b128 a[220:223], v2 offset:5120
ds_read_b128 a[224:227], v2 offset:1024
ds_read_b128 a[228:231], v2 offset:6144
ds_read_b128 a[232:235], v2 offset:2048
ds_read_b128 a[236:239], v2 offset:7168
v_mov_b32 v13, 2146435072
v_cmp_eq_u32 vcc, 0, v1
v_mov_b32 v14, s68
v_mov_b32 v15, s69
v_cndmask_b32 v13, v13, 0, vcc
buffer_store_dwordx2 v[14:15], v13, s[8:11], s39 offen sc1
s_waitcnt vmcnt(11)
s_waitcnt lgkmcnt(4)
v_mfma_f32_16x16x32_bf16 v[32:35], a[216:219], a[0:3], 0
ds_read_b128 a[240:243], v2 offset:3072
v_mfma_f32_16x16x32_bf16 v[32:35], a[220:223], a[4:7], v[32:35]
ds_read_b128 a[244:247], v2 offset:8192
s_add_u32 s25, s25, 4096
buffer_load_dwordx4 a[48:51], v2, s[8:11], s25 offen offset:0 sc1
s_waitcnt lgkmcnt(4)
v_mfma_f32_16x16x32_bf16 v[36:39], a[224:227], a[0:3], 0
ds_read_b128 a[216:219], v2 offset:4096
v_mfma_f32_16x16x32_bf16 v[36:39], a[228:231], a[4:7], v[36:39]
ds_read_b128 a[220:223], v2 offset:9216
s_waitcnt lgkmcnt(4)
v_mfma_f32_16x16x32_bf16 v[40:43], a[232:235], a[0:3], 0
ds_read_b128 a[224:227], v2 offset:10240
v_mfma_f32_16x16x32_bf16 v[40:43], a[236:239], a[4:7], v[40:43]
ds_read_b128 a[228:231], v2 offset:15360
buffer_load_dwordx4 a[52:55], v2, s[8:11], s25 offen offset:1024 sc1
s_waitcnt lgkmcnt(4)
v_mfma_f32_16x16x32_bf16 v[44:47], a[240:243], a[0:3], 0
ds_read_b128 a[232:235], v2 offset:11264
v_mfma_f32_16x16x32_bf16 v[44:47], a[244:247], a[4:7], v[44:47]
ds_read_b128 a[236:239], v2 offset:16384
s_waitcnt lgkmcnt(4)
v_mfma_f32_16x16x32_bf16 v[48:51], a[216:219], a[0:3], 0
ds_read_b128 a[240:243], v2 offset:12288
v_mfma_f32_16x16x32_bf16 v[48:51], a[220:223], a[4:7], v[48:51]
ds_read_b128 a[244:247], v2 offset:17408
buffer_load_dwordx4 a[56:59], v2, s[8:11], s25 offen offset:2048 sc1
s_waitcnt vmcnt(12)
s_waitcnt lgkmcnt(4)
v_mfma_f32_16x16x32_bf16 v[32:35], a[224:227], a[8:11], v[32:35]
ds_read_b128 a[216:219], v2 offset:13312
v_mfma_f32_16x16x32_bf16 v[32:35], a[228:231], a[12:15], v[32:35]
ds_read_b128 a[220:223], v2 offset:18432
s_waitcnt lgkmcnt(4)
v_mfma_f32_16x16x32_bf16 v[36:39], a[232:235], a[8:11], v[36:39]
ds_read_b128 a[224:227], v2 offset:14336
v_mfma_f32_16x16x32_bf16 v[36:39], a[236:239], a[12:15], v[36:39]
ds_read_b128 a[228:231], v2 offset:19456
buffer_load_dwordx4 a[60:63], v2, s[8:11], s25 offen offset:3072 sc1
s_waitcnt lgkmcnt(4)
v_mfma_f32_16x16x32_bf16 v[40:43], a[240:243], a[8:11], v[40:43]
ds_read_b128 a[232:235], v2 offset:20480
v_mfma_f32_16x16x32_bf16 v[40:43], a[244:247], a[12:15], v[40:43]
ds_read_b128 a[236:239], v2 offset:25600
s_waitcnt lgkmcnt(4)
v_mfma_f32_16x16x32_bf16 v[44:47], a[216:219], a[8:11], v[44:47]
ds_read_b128 a[240:243], v2 offset:21504
v_mfma_f32_16x16x32_bf16 v[44:47], a[220:223], a[12:15], v[44:47]
ds_read_b128 a[244:247], v2 offset:26624
s_add_u32 s25, s25, 4096
buffer_load_dwordx2 a[64:65], v11, s[8:11], s25 offen offset:0 sc1
buffer_load_dwordx2 a[66:67], v11, s[8:11], s25 offen offset:128 sc1
s_waitcnt lgkmcnt(4)
v_mfma_f32_16x16x32_bf16 v[48:51], a[224:227], a[8:11], v[48:51]
ds_read_b128 a[216:219], v2 offset:22528
v_mfma_f32_16x16x32_bf16 v[48:51], a[228:231], a[12:15], v[48:51]
ds_read_b128 a[220:223], v2 offset:27648
s_waitcnt vmcnt(13)
s_waitcnt lgkmcnt(4)
v_mfma_f32_16x16x32_bf16 v[32:35], a[232:235], a[16:19], v[32:35]
ds_read_b128 a[224:227], v2 offset:23552
v_mfma_f32_16x16x32_bf16 v[32:35], a[236:239], a[20:23], v[32:35]
ds_read_b128 a[228:231], v2 offset:28672
buffer_load_dwordx2 a[68:69], v11, s[8:11], s25 offen offset:1024 sc1
buffer_load_dwordx2 a[70:71], v11, s[8:11], s25 offen offset:1152 sc1
s_waitcnt lgkmcnt(4)
v_mfma_f32_16x16x32_bf16 v[36:39], a[240:243], a[16:19], v[36:39]
ds_read_b128 a[232:235], v2 offset:24576
v_mfma_f32_16x16x32_bf16 v[36:39], a[244:247], a[20:23], v[36:39]
ds_read_b128 a[236:239], v2 offset:29696
s_waitcnt lgkmcnt(4)
v_mfma_f32_16x16x32_bf16 v[40:43], a[216:219], a[16:19], v[40:43]
ds_read_b128 a[240:243], v2 offset:30720
v_mfma_f32_16x16x32_bf16 v[40:43], a[220:223], a[20:23], v[40:43]
ds_read_b128 a[244:247], v2 offset:35840
buffer_load_dwordx4 v[56:59], v2, s[8:11], s27 offen sc1
s_waitcnt lgkmcnt(4)
v_mfma_f32_16x16x32_bf16 v[44:47], a[224:227], a[16:19], v[44:47]
ds_read_b128 a[216:219], v2 offset:31744
v_mfma_f32_16x16x32_bf16 v[44:47], a[228:231], a[20:23], v[44:47]
ds_read_b128 a[220:223], v2 offset:36864
s_waitcnt lgkmcnt(4)
v_mfma_f32_16x16x32_bf16 v[48:51], a[232:235], a[16:19], v[48:51]
ds_read_b128 a[224:227], v2 offset:32768
v_mfma_f32_16x16x32_bf16 v[48:51], a[236:239], a[20:23], v[48:51]
ds_read_b128 a[228:231], v2 offset:37888
buffer_load_dwordx4 v[60:63], v2, s[8:11], s27 offen offset:1024 sc1
s_waitcnt vmcnt(15)
s_waitcnt lgkmcnt(4)
v_mfma_f32_16x16x32_bf16 v[32:35], a[240:243], a[24:27], v[32:35]
ds_read_b128 a[232:235], v2 offset:33792
v_mfma_f32_16x16x32_bf16 v[32:35], a[244:247], a[28:31], v[32:35]
ds_read_b128 a[236:239], v2 offset:38912
s_waitcnt lgkmcnt(4)
v_mfma_f32_16x16x32_bf16 v[36:39], a[216:219], a[24:27], v[36:39]
ds_read_b128 a[240:243], v2 offset:34816
v_mfma_f32_16x16x32_bf16 v[36:39], a[220:223], a[28:31], v[36:39]
ds_read_b128 a[244:247], v2 offset:39936
buffer_load_dwordx2 v[64:65], v4, s[8:11], s27 offen sc1
s_waitcnt lgkmcnt(4)
v_mfma_f32_16x16x32_bf16 v[40:43], a[224:227], a[24:27], v[40:43]
ds_read_b128 a[216:219], v2 offset:40960
v_mfma_f32_16x16x32_bf16 v[40:43], a[228:231], a[28:31], v[40:43]
ds_read_b128 a[220:223], v2 offset:46080
s_waitcnt lgkmcnt(4)
v_mfma_f32_16x16x32_bf16 v[44:47], a[232:235], a[24:27], v[44:47]
ds_read_b128 a[224:227], v2 offset:41984
v_mfma_f32_16x16x32_bf16 v[44:47], a[236:239], a[28:31], v[44:47]
ds_read_b128 a[228:231], v2 offset:47104
s_waitcnt lgkmcnt(4)
v_mfma_f32_16x16x32_bf16 v[48:51], a[240:243], a[24:27], v[48:51]
ds_read_b128 a[232:235], v2 offset:43008
v_mfma_f32_16x16x32_bf16 v[48:51], a[244:247], a[28:31], v[48:51]
ds_read_b128 a[236:239], v2 offset:48128
s_waitcnt vmcnt(14)
s_waitcnt lgkmcnt(4)
v_mfma_f32_16x16x32_bf16 v[32:35], a[216:219], a[32:35], v[32:35]
ds_read_b128 a[240:243], v2 offset:44032
v_mfma_f32_16x16x32_bf16 v[32:35], a[220:223], a[36:39], v[32:35]
ds_read_b128 a[244:247], v2 offset:49152
s_waitcnt lgkmcnt(4)
v_mfma_f32_16x16x32_bf16 v[36:39], a[224:227], a[32:35], v[36:39]
ds_read_b128 a[216:219], v2 offset:45056
v_mfma_f32_16x16x32_bf16 v[36:39], a[228:231], a[36:39], v[36:39]
ds_read_b128 a[220:223], v2 offset:50176
s_waitcnt lgkmcnt(4)
v_mfma_f32_16x16x32_bf16 v[40:43], a[232:235], a[32:35], v[40:43]
ds_read_b128 a[224:227], v2 offset:51200
v_mfma_f32_16x16x32_bf16 v[40:43], a[236:239], a[36:39], v[40:43]
ds_read_b128 a[228:231], v2 offset:56320
s_waitcnt lgkmcnt(4)
v_mfma_f32_16x16x32_bf16 v[44:47], a[240:243], a[32:35], v[44:47]
ds_read_b128 a[232:235], v2 offset:52224
v_mfma_f32_16x16x32_bf16 v[44:47], a[244:247], a[36:39], v[44:47]
ds_read_b128 a[236:239], v2 offset:57344
s_waitcnt lgkmcnt(4)
v_mfma_f32_16x16x32_bf16 v[48:51], a[216:219], a[32:35], v[48:51]
ds_read_b128 a[240:243], v2 offset:53248
v_mfma_f32_16x16x32_bf16 v[48:51], a[220:223], a[36:39], v[48:51]
ds_read_b128 a[244:247], v2 offset:58368
s_waitcnt vmcnt(12)
s_waitcnt lgkmcnt(4)
v_mfma_f32_16x16x32_bf16 v[32:35], a[224:227], a[40:43], v[32:35]
ds_read_b128 a[216:219], v2 offset:54272
v_mfma_f32_16x16x32_bf16 v[32:35], a[228:231], a[44:47], v[32:35]
ds_read_b128 a[220:223], v2 offset:59392
s_waitcnt lgkmcnt(4)
v_mfma_f32_16x16x32_bf16 v[36:39], a[232:235], a[40:43], v[36:39]
ds_read_b128 a[224:227], v2 offset:55296
v_mfma_f32_16x16x32_bf16 v[36:39], a[236:239], a[44:47], v[36:39]
ds_read_b128 a[228:231], v2 offset:60416
s_waitcnt lgkmcnt(4)
v_mfma_f32_16x16x32_bf16 v[40:43], a[240:243], a[40:43], v[40:43]
ds_read_b128 a[232:235], v2 offset:61440
v_mfma_f32_16x16x32_bf16 v[40:43], a[244:247], a[44:47], v[40:43]
ds_read_b128 a[236:239], v5 offset:1024
s_waitcnt lgkmcnt(4)
v_mfma_f32_16x16x32_bf16 v[44:47], a[216:219], a[40:43], v[44:47]
ds_read_b128 a[240:243], v2 offset:62464
v_mfma_f32_16x16x32_bf16 v[44:47], a[220:223], a[44:47], v[44:47]
ds_read_b128 a[244:247], v5 offset:2048
s_waitcnt lgkmcnt(4)
v_mfma_f32_16x16x32_bf16 v[48:51], a[224:227], a[40:43], v[48:51]
ds_read_b128 a[216:219], v2 offset:63488
v_mfma_f32_16x16x32_bf16 v[48:51], a[228:231], a[44:47], v[48:51]
ds_read_b128 a[220:223], v5 offset:3072
s_waitcnt vmcnt(9)
s_waitcnt lgkmcnt(4)
v_mfma_f32_16x16x32_bf16 v[32:35], a[232:235], a[48:51], v[32:35]
ds_read_b128 a[224:227], v2 offset:64512
v_mfma_f32_16x16x32_bf16 v[32:35], a[236:239], a[52:55], v[32:35]
ds_read_b128 a[228:231], v5 offset:4096
s_waitcnt lgkmcnt(4)
v_mfma_f32_16x16x32_bf16 v[36:39], a[240:243], a[48:51], v[36:39]
ds_read_b128 a[232:235], v5 offset:0
v_mfma_f32_16x16x32_bf16 v[36:39], a[244:247], a[52:55], v[36:39]
ds_read_b128 a[236:239], v5 offset:5120
s_waitcnt lgkmcnt(4)
v_mfma_f32_16x16x32_bf16 v[40:43], a[216:219], a[48:51], v[40:43]
ds_read_b128 a[240:243], v5 offset:6144
v_mfma_f32_16x16x32_bf16 v[40:43], a[220:223], a[52:55], v[40:43]
ds_read_b128 a[244:247], v5 offset:11264
s_waitcnt lgkmcnt(4)
v_mfma_f32_16x16x32_bf16 v[44:47], a[224:227], a[48:51], v[44:47]
ds_read_b128 a[216:219], v5 offset:7168
v_mfma_f32_16x16x32_bf16 v[44:47], a[228:231], a[52:55], v[44:47]
ds_read_b128 a[220:223], v5 offset:12288
s_waitcnt lgkmcnt(4)
v_mfma_f32_16x16x32_bf16 v[48:51], a[232:235], a[48:51], v[48:51]
ds_read_b128 a[224:227], v5 offset:8192
v_mfma_f32_16x16x32_bf16 v[48:51], a[236:239], a[52:55], v[48:51]
ds_read_b128 a[228:231], v5 offset:13312
s_waitcnt vmcnt(7)
s_waitcnt lgkmcnt(4)
v_mfma_f32_16x16x32_bf16 v[32:35], a[240:243], a[56:59], v[32:35]
ds_read_b128 a[232:235], v5 offset:9216
v_mfma_f32_16x16x32_bf16 v[32:35], a[244:247], a[60:63], v[32:35]
ds_read_b128 a[236:239], v5 offset:14336
s_waitcnt lgkmcnt(4)
v_mfma_f32_16x16x32_bf16 v[36:39], a[216:219], a[56:59], v[36:39]
ds_read_b128 a[240:243], v5 offset:10240
v_mfma_f32_16x16x32_bf16 v[36:39], a[220:223], a[60:63], v[36:39]
ds_read_b128 a[244:247], v5 offset:15360
s_waitcnt lgkmcnt(4)
v_mfma_f32_16x16x32_bf16 v[40:43], a[224:227], a[56:59], v[40:43]
ds_read_b128 a[216:219], v5 offset:16384
v_mfma_f32_16x16x32_bf16 v[40:43], a[228:231], a[60:63], v[40:43]
ds_read_b128 a[220:223], v5 offset:21504
s_waitcnt lgkmcnt(4)
v_mfma_f32_16x16x32_bf16 v[44:47], a[232:235], a[56:59], v[44:47]
ds_read_b128 a[224:227], v5 offset:17408
v_mfma_f32_16x16x32_bf16 v[44:47], a[236:239], a[60:63], v[44:47]
ds_read_b128 a[228:231], v5 offset:22528
s_waitcnt lgkmcnt(4)
v_mfma_f32_16x16x32_bf16 v[48:51], a[240:243], a[56:59], v[48:51]
ds_read_b128 a[232:235], v5 offset:18432
v_mfma_f32_16x16x32_bf16 v[48:51], a[244:247], a[60:63], v[48:51]
ds_read_b128 a[236:239], v5 offset:23552
s_waitcnt vmcnt(3)
s_waitcnt lgkmcnt(4)
v_mfma_f32_16x16x32_bf16 v[32:35], a[216:219], a[64:67], v[32:35]
ds_read_b128 a[240:243], v5 offset:19456
v_mfma_f32_16x16x32_bf16 v[32:35], a[220:223], a[68:71], v[32:35]
ds_read_b128 a[244:247], v5 offset:24576
s_waitcnt lgkmcnt(4)
v_mfma_f32_16x16x32_bf16 v[36:39], a[224:227], a[64:67], v[36:39]
ds_read_b128 a[216:219], v5 offset:20480
v_mfma_f32_16x16x32_bf16 v[36:39], a[228:231], a[68:71], v[36:39]
ds_read_b128 a[220:223], v5 offset:25600
s_waitcnt lgkmcnt(4)
v_mfma_f32_16x16x32_bf16 v[40:43], a[232:235], a[64:67], v[40:43]
v_mfma_f32_16x16x32_bf16 v[40:43], a[236:239], a[68:71], v[40:43]
s_waitcnt lgkmcnt(2)
v_mfma_f32_16x16x32_bf16 v[44:47], a[240:243], a[64:67], v[44:47]
v_mfma_f32_16x16x32_bf16 v[44:47], a[244:247], a[68:71], v[44:47]
s_waitcnt lgkmcnt(0)
v_mfma_f32_16x16x32_bf16 v[48:51], a[216:219], a[64:67], v[48:51]
v_mfma_f32_16x16x32_bf16 v[48:51], a[220:223], a[68:71], v[48:51]
s_waitcnt vmcnt(0)
v_lshlrev_b32 v68, 16, v56
v_and_b32 v69, 0xffff0000, v56
v_add_f32 v32, v32, v68
v_add_f32 v33, v33, v69
v_lshlrev_b32 v70, 16, v57
v_and_b32 v71, 0xffff0000, v57
v_add_f32 v34, v34, v70
v_add_f32 v35, v35, v71
v_lshlrev_b32 v72, 16, v58
v_and_b32 v73, 0xffff0000, v58
v_add_f32 v36, v36, v72
v_add_f32 v37, v37, v73
v_lshlrev_b32 v74, 16, v59
v_and_b32 v75, 0xffff0000, v59
v_add_f32 v38, v38, v74
v_add_f32 v39, v39, v75
v_lshlrev_b32 v68, 16, v60
v_and_b32 v69, 0xffff0000, v60
v_add_f32 v40, v40, v68
v_add_f32 v41, v41, v69
v_lshlrev_b32 v70, 16, v61
v_and_b32 v71, 0xffff0000, v61
v_add_f32 v42, v42, v70
v_add_f32 v43, v43, v71
v_lshlrev_b32 v72, 16, v62
v_and_b32 v73, 0xffff0000, v62
v_add_f32 v44, v44, v72
v_add_f32 v45, v45, v73
v_lshlrev_b32 v74, 16, v63
v_and_b32 v75, 0xffff0000, v63
v_add_f32 v46, v46, v74
v_add_f32 v47, v47, v75
v_lshlrev_b32 v68, 16, v64
v_and_b32 v69, 0xffff0000, v64
v_add_f32 v48, v48, v68
v_add_f32 v49, v49, v69
v_lshlrev_b32 v70, 16, v65
v_and_b32 v71, 0xffff0000, v65
v_add_f32 v50, v50, v70
v_add_f32 v51, v51, v71
v_cvt_pk_bf16_f32 v80, v32, v33
v_cvt_pk_bf16_f32 v81, v34, v35
v_cvt_pk_bf16_f32 v82, v36, v37
v_cvt_pk_bf16_f32 v83, v38, v39
v_cvt_pk_bf16_f32 v84, v40, v41
v_cvt_pk_bf16_f32 v85, v42, v43
v_cvt_pk_bf16_f32 v86, v44, v45
v_cvt_pk_bf16_f32 v87, v46, v47
v_cvt_pk_bf16_f32 v88, v48, v49
v_cvt_pk_bf16_f32 v89, v50, v51
s_add_u32 s27, s26, s73
buffer_store_dwordx4 v[80:83], v2, s[8:11], s27 offen sc1
buffer_store_dwordx4 v[84:87], v2, s[8:11], s27 offen offset:1024 sc1
buffer_store_dwordx2 v[88:89], v4, s[8:11], s27 offen sc1
v_add_f32 v10, v32, v33
v_mul_f32 v11, v32, v32
v_mul_f32 v13, v33, v33
v_mov_b32 v12, 0
v_add_f32 v10, v10, v34
v_add_f32 v12, v12, v35
v_fmac_f32 v11, v34, v34
v_fmac_f32 v13, v35, v35
v_add_f32 v10, v10, v36
v_add_f32 v12, v12, v37
v_fmac_f32 v11, v36, v36
v_fmac_f32 v13, v37, v37
v_add_f32 v10, v10, v38
v_add_f32 v12, v12, v39
v_fmac_f32 v11, v38, v38
v_fmac_f32 v13, v39, v39
v_add_f32 v10, v10, v40
v_add_f32 v12, v12, v41
v_fmac_f32 v11, v40, v40
v_fmac_f32 v13, v41, v41
v_add_f32 v10, v10, v42
v_add_f32 v12, v12, v43
v_fmac_f32 v11, v42, v42
v_fmac_f32 v13, v43, v43
v_add_f32 v10, v10, v44
v_add_f32 v12, v12, v45
v_fmac_f32 v11, v44, v44
v_fmac_f32 v13, v45, v45
v_add_f32 v10, v10, v46
v_add_f32 v12, v12, v47
v_fmac_f32 v11, v46, v46
v_fmac_f32 v13, v47, v47
v_add_f32 v10, v10, v48
v_add_f32 v12, v12, v49
v_fmac_f32 v11, v48, v48
v_fmac_f32 v13, v49, v49
v_add_f32 v10, v10, v50
v_add_f32 v12, v12, v51
v_fmac_f32 v11, v50, v50
v_fmac_f32 v13, v51, v51
v_add_f32 v10, v10, v12
v_add_f32 v11, v11, v13
v_mov_b32 v12, v10
v_mov_b32 v13, v11
s_nop 0
v_permlane16_swap_b32 v10, v12
v_permlane16_swap_b32 v11, v13
v_add_f32 v10, v10, v12
v_add_f32 v11, v11, v13
v_mov_b32 v12, v10
v_mov_b32 v13, v11
s_nop 0
v_permlane32_swap_b32 v10, v12
v_permlane32_swap_b32 v11, v13
v_add_f32 v10, v10, v12
v_add_f32 v11, v11, v13
v_lshlrev_b32 v8, 3, v6
v_cmp_gt_u32 vcc, 16, v1
s_nop 1
v_cndmask_b32 v8, v9, v8, vcc
s_lshl_b32 s27, s20, 10
s_lshl_b32 s28, s21, 7
s_add_u32 s27, s27, s28
s_add_u32 s27, s27, s74
buffer_store_dwordx2 v[10:11], v8, s[8:11], s27 offen sc1
s_lshr_b32 s27, s20, 2
s_lshl_b32 s27, s27, 3
s_add_u32 s27, s27, s21
s_lshl_b32 s27, s27, 2
s_add_u32 s27, s27, s4
s_lshl_b32 s27, s27, 7
s_add_u32 s27, s27, s77
s_add_u32 s27, s27, 524288
v_mov_b32 v13, 2146435072
v_cmp_eq_u32 vcc, 0, v1
v_mov_b32 v14, s68
v_mov_b32 v15, s69
v_cndmask_b32 v13, v13, 0, vcc
s_waitcnt vmcnt(0)
buffer_store_dwordx2 v[14:15], v13, s[8:11], s27 offen sc1
s_barrier
s_lshr_b32 s40, s6, 2
s_lshl_b32 s41, s5, 2
s_and_b32 s42, s6, 3
s_add_u32 s41, s41, s42
s_lshr_b32 s42, s41, 2
s_and_b32 s43, s41, 3
s_mul_i32 s22, s4, 6144
s_mul_i32 s21, s41, 497664
s_add_u32 s21, s21, s22
s_add_u32 s21, s21, 7303168
v_add_u32 v3, s21, v2
s_cmp_eq_u32 s7, 0
s_cbranch_scc0 L_f_packed
s_lshl_b32 s47, s42, 12
s_add_u32 s47, s47, 1966080
v_min_u32 v16, 26, v1
v_lshlrev_b32 v16, 7, v16
s_mov_b32 s52, 0
L_poll4:
buffer_load_dwordx2 v[14:15], v16, s[8:11], s47 offen sc1
s_add_u32 s52, s52, 1
s_waitcnt vmcnt(0)
v_cmp_ne_u64 vcc, s[68:69], v[14:15]
s_cmp_ge_u32 s52, 0x100000
s_cbranch_scc1 L_got4
s_and_b64 exec, exec, vcc
s_cbranch_execnz L_poll4
L_got4:
s_mov_b64 exec, -1
L_f_packed:
s_add_u32 m0, s22, 0
s_nop 0
buffer_load_dwordx4 v3, s[8:11], 0 offen offset:0 sc1 lds
buffer_load_dwordx4 v3, s[8:11], 0 offen offset:1024 sc1 lds
buffer_load_dwordx4 v3, s[8:11], 0 offen offset:2048 sc1 lds
buffer_load_dwordx4 v3, s[8:11], 0 offen offset:3072 sc1 lds
s_add_u32 m0, s22, 4096
v_add_u32 v3, 4096, v3
buffer_load_dwordx4 v3, s[8:11], 0 offen offset:0 sc1 lds
buffer_load_dwordx4 v3, s[8:11], 0 offen offset:1024 sc1 lds
s_add_u32 m0, s22, 24576
v_add_u32 v3, 20480, v3
buffer_load_dwordx4 v3, s[8:11], 0 offen offset:0 sc1 lds
buffer_load_dwordx4 v3, s[8:11], 0 offen offset:1024 sc1 lds
buffer_load_dwordx4 v3, s[8:11], 0 offen offset:2048 sc1 lds
buffer_load_dwordx4 v3, s[8:11], 0 offen offset:3072 sc1 lds
s_add_u32 m0, s22, 28672
v_add_u32 v3, 4096, v3
buffer_load_dwordx4 v3, s[8:11], 0 offen offset:0 sc1 lds
buffer_load_dwordx4 v3, s[8:11], 0 offen offset:1024 sc1 lds
s_add_u32 m0, s22, 49152
v_add_u32 v3, 20480, v3
buffer_load_dwordx4 v3, s[8:11], 0 offen offset:0 sc1 lds
buffer_load_dwordx4 v3, s[8:11], 0 offen offset:1024 sc1 lds
buffer_load_dwordx4 v3, s[8:11], 0 offen offset:2048 sc1 lds
buffer_load_dwordx4 v3, s[8:11], 0 offen offset:3072 sc1 lds
s_add_u32 m0, s22, 53248
v_add_u32 v3, 4096, v3
buffer_load_dwordx4 v3, s[8:11], 0 offen offset:0 sc1 lds
buffer_load_dwordx4 v3, s[8:11], 0 offen offset:1024 sc1 lds
s_add_u32 m0, s22, 73728
v_add_u32 v3, 20480, v3
buffer_load_dwordx4 v3, s[8:11], 0 offen offset:0 sc1 lds
buffer_load_dwordx4 v3, s[8:11], 0 offen offset:1024 sc1 lds
buffer_load_dwordx4 v3, s[8:11], 0 offen offset:2048 sc1 lds
buffer_load_dwordx4 v3, s[8:11], 0 offen offset:3072 sc1 lds
s_add_u32 m0, s22, 77824
v_add_u32 v3, 4096, v3
buffer_load_dwordx4 v3, s[8:11], 0 offen offset:0 sc1 lds
buffer_load_dwordx4 v3, s[8:11], 0 offen offset:1024 sc1 lds
s_lshl_b32 s44, s40, 4
s_lshl_b32 s45, s4, 2
s_add_u32 s44, s44, s45
s_mul_i32 s46, s44, 18432
s_add_u32 s20, s46, s73
v_add_u32 v4, 18432, v2
v_add_u32 v5, 36864, v2
v_add_u32 v6, 55296, v2
v_lshlrev_b32 v244, 3, v1
v_add_u32 v245, 18432, v244
v_add_u32 v246, 36864, v244
v_add_u32 v247, 55296, v244
v_and_b32 v13, 15, v1
v_lshrrev_b32 v14, 4, v1
v_add_u32 v7, 0x10000, v2
v_add_u32 v8, 0x20000, v2
v_and_b32 v9, 1, v14
v_mul_u32_u24 v9, 18432, v9
v_lshrrev_b32 v15, 1, v14
v_lshlrev_b32 v15, 8, v15
v_lshl_add_u32 v15, v13, 4, v15
v_add_u32 v9, v9, v15
v_and_b32 v11, 3, v1
v_lshlrev_b32 v11, 7, v11
s_lshl_b32 s49, s43, 7
v_mov_b32 v10, 2146435072
v_mov_b32 v15, s49
v_cmp_eq_u32 vcc, 0, v1
s_nop 1
v_cndmask_b32 v10, v10, v15, vcc
s_lshl_b32 s49, s40, 3
s_add_u32 s49, s49, s42
s_lshl_b32 s50, s49, 2
s_add_u32 s50, s50, s4
s_lshl_b32 s50, s50, 9
s_add_u32 s34, s50, s77
s_add_u32 s34, s34, 0
s_lshl_b32 s49, s49, 4
s_add_u32 s49, s49, s45
s_mul_i32 s49, s49, 18432
s_add_u32 s49, s49, s75
s_add_u32 s50, s43, 0
s_and_b32 s50, s50, 3
s_mul_i32 s50, s50, 9
s_add_u32 s50, s50, 1
s_lshr_b32 s50, s50, 1
s_lshl_b32 s50, s50, 10
s_add_u32 s24, s49, s50
s_add_u32 s50, s43, 1
s_and_b32 s50, s50, 3
s_mul_i32 s50, s50, 9
s_add_u32 s50, s50, 1
s_lshr_b32 s50, s50, 1
s_lshl_b32 s50, s50, 10
s_add_u32 s25, s49, s50
s_add_u32 s50, s43, 2
s_and_b32 s50, s50, 3
s_mul_i32 s50, s50, 9
s_add_u32 s50, s50, 1
s_lshr_b32 s50, s50, 1
s_lshl_b32 s50, s50, 10
s_add_u32 s26, s49, s50
s_add_u32 s50, s43, 3
s_and_b32 s50, s50, 3
s_mul_i32 s50, s50, 9
s_add_u32 s50, s50, 1
s_lshr_b32 s50, s50, 1
s_lshl_b32 s50, s50, 10
s_add_u32 s27, s49, s50
s_add_u32 s28, s49, 4096
s_add_u32 s29, s49, 13312
s_cmp_ge_u32 s43, 2
s_cselect_b32 s50, s29, s28
s_and_b32 s51, s43, 1
s_lshl_b32 s51, s51, 9
s_add_u32 s30, s50, s51
s_mul_i32 s50, s42, 2359296
s_add_u32 s50, s50, s46
s_mul_i32 s51, s43, 4608
s_add_u32 s50, s50, s51
s_add_u32 s31, s50, s76
s_add_u32 s32, s31, 4096
s_add_u32 s33, s32, 36864
s_add_u32 s36, s31, 0
s_add_u32 s37, s31, 18432
s_add_u32 s38, s31, 36864
s_add_u32 s39, s31, 55296
v_lshlrev_b32 v252, 4, v13
v_lshl_add_u32 v252, v14, 9, v252
s_lshl_b32 s35, s40, 2
s_add_u32 s35, s35, s4
s_lshl_b32 s35, s35, 5
s_add_u32 s35, s35, s41
s_lshl_b32 s35, s35, 7
s_add_u32 s35, s35, s77
s_add_u32 s35, s35, 655360
v_lshlrev_b32 v17, 3, v13
v_lshl_add_u32 v17, v14, 8, v17
s_lshl_b32 s47, s44, 10
s_add_u32 s47, s47, s74
s_lshl_b32 s49, s44, 10
s_add_u32 s49, s49, s77
s_add_u32 s49, s49, 524288
v_and_b32 v16, 31, v1
v_lshlrev_b32 v16, 7, v16
s_mov_b32 s52, 0
L_poll5:
buffer_load_dwordx2 v[14:15], v16, s[8:11], s49 offen sc1
s_add_u32 s52, s52, 1
s_waitcnt vmcnt(0)
v_cmp_ne_u64 vcc, s[68:69], v[14:15]
s_cmp_ge_u32 s52, 0x100000
s_cbranch_scc1 L_got5
s_and_b64 exec, exec, vcc
s_cbranch_execnz L_poll5
L_got5:
s_mov_b64 exec, -1
s_add_u32 s48, s20, 0
buffer_load_dwordx4 a[0:3], v2, s[8:11], s48 offen offset:0 sc1
buffer_load_dwordx4 a[4:7], v4, s[8:11], s48 offen offset:0 sc1
buffer_load_dwordx4 a[8:11], v5, s[8:11], s48 offen offset:0 sc1
buffer_load_dwordx4 a[12:15], v6, s[8:11], s48 offen offset:0 sc1
buffer_load_dwordx4 a[16:19], v2, s[8:11], s48 offen offset:1024 sc1
buffer_load_dwordx4 a[20:23], v4, s[8:11], s48 offen offset:1024 sc1
buffer_load_dwordx4 a[24:27], v5, s[8:11], s48 offen offset:1024 sc1
buffer_load_dwordx4 a[28:31], v6, s[8:11], s48 offen offset:1024 sc1
buffer_load_dwordx2 v[144:145], v17, s[8:11], s47 offen offset:0 sc1
buffer_load_dwordx2 v[146:147], v17, s[8:11], s47 offen offset:128 sc1
buffer_load_dwordx2 v[148:149], v17, s[8:11], s47 offen offset:1024 sc1
buffer_load_dwordx2 v[150:151], v17, s[8:11], s47 offen offset:1152 sc1
buffer_load_dwordx2 v[152:153], v17, s[8:11], s47 offen offset:2048 sc1
buffer_load_dwordx2 v[154:155], v17, s[8:11], s47 offen offset:2176 sc1
buffer_load_dwordx2 v[156:157], v17, s[8:11], s47 offen offset:3072 sc1
buffer_load_dwordx2 v[158:159], v17, s[8:11], s47 offen offset:3200 sc1
buffer_load_dwordx4 a[32:35], v2, s[8:11], s48 offen offset:2048 sc1
buffer_load_dwordx4 a[36:39], v4, s[8:11], s48 offen offset:2048 sc1
buffer_load_dwordx4 a[40:43], v5, s[8:11], s48 offen offset:2048 sc1
buffer_load_dwordx4 a[44:47], v6, s[8:11], s48 offen offset:2048 sc1
buffer_load_dwordx4 a[48:51], v2, s[8:11], s48 offen offset:3072 sc1
buffer_load_dwordx4 a[52:55], v4, s[8:11], s48 offen offset:3072 sc1
buffer_load_dwordx4 a[56:59], v5, s[8:11], s48 offen offset:3072 sc1
buffer_load_dwordx4 a[60:63], v6, s[8:11], s48 offen offset:3072 sc1
s_add_u32 s48, s20, 4096
buffer_load_dwordx4 a[64:67], v2, s[8:11], s48 offen offset:0 sc1
buffer_load_dwordx4 a[68:71], v4, s[8:11], s48 offen offset:0 sc1
buffer_load_dwordx4 a[72:75], v5, s[8:11], s48 offen offset:0 sc1
buffer_load_dwordx4 a[76:79], v6, s[8:11], s48 offen offset:0 sc1
s_barrier
ds_read_b128 v[48:51], v2 offset:0
ds_read_b128 v[52:55], v2 offset:1024
ds_read_b128 v[56:59], v2 offset:2048
ds_read_b128 v[60:63], v2 offset:3072
ds_read_b128 v[64:67], v2 offset:4096
ds_read_b128 v[68:71], v2 offset:5120
s_waitcnt vmcnt(20)
s_waitcnt lgkmcnt(4)
v_mfma_f32_16x16x32_bf16 v[80:83], v[48:51], a[0:3], 0
buffer_load_dwordx4 a[80:83], v2, s[8:11], s48 offen offset:1024 sc1
v_mfma_f32_16x16x32_bf16 v[80:83], v[52:55], a[16:19], v[80:83]
v_mfma_f32_16x16x32_bf16 v[84:87], v[48:51], a[4:7], 0
ds_read_b128 v[72:75], v2 offset:6144
v_mfma_f32_16x16x32_bf16 v[84:87], v[52:55], a[20:23], v[84:87]
v_mfma_f32_16x16x32_bf16 v[88:91], v[48:51], a[8:11], 0
buffer_load_dwordx4 a[84:87], v4, s[8:11], s48 offen offset:1024 sc1
v_mfma_f32_16x16x32_bf16 v[88:91], v[52:55], a[24:27], v[88:91]
ds_read_b128 v[76:79], v2 offset:7168
v_mfma_f32_16x16x32_bf16 v[92:95], v[48:51], a[12:15], 0
v_mfma_f32_16x16x32_bf16 v[92:95], v[52:55], a[28:31], v[92:95]
s_waitcnt lgkmcnt(4)
v_mfma_f32_16x16x32_bf16 v[96:99], v[56:59], a[0:3], 0
buffer_load_dwordx4 a[88:91], v5, s[8:11], s48 offen offset:1024 sc1
v_mfma_f32_16x16x32_bf16 v[96:99], v[60:63], a[16:19], v[96:99]
v_mfma_f32_16x16x32_bf16 v[100:103], v[56:59], a[4:7], 0
ds_read_b128 v[48:51], v2 offset:8192
v_mfma_f32_16x16x32_bf16 v[100:103], v[60:63], a[20:23], v[100:103]
v_mfma_f32_16x16x32_bf16 v[104:107], v[56:59], a[8:11], 0
buffer_load_dwordx4 a[92:95], v6, s[8:11], s48 offen offset:1024 sc1
v_mfma_f32_16x16x32_bf16 v[104:107], v[60:63], a[24:27], v[104:107]
ds_read_b128 v[52:55], v2 offset:9216
v_mfma_f32_16x16x32_bf16 v[108:111], v[56:59], a[12:15], 0
v_mfma_f32_16x16x32_bf16 v[108:111], v[60:63], a[28:31], v[108:111]
s_waitcnt lgkmcnt(4)
v_mfma_f32_16x16x32_bf16 v[112:115], v[64:67], a[0:3], 0
buffer_load_dwordx4 a[96:99], v2, s[8:11], s48 offen offset:2048 sc1
v_mfma_f32_16x16x32_bf16 v[112:115], v[68:71], a[16:19], v[112:115]
v_mfma_f32_16x16x32_bf16 v[116:119], v[64:67], a[4:7], 0
ds_read_b128 v[56:59], v2 offset:10240
v_mfma_f32_16x16x32_bf16 v[116:119], v[68:71], a[20:23], v[116:119]
v_mfma_f32_16x16x32_bf16 v[120:123], v[64:67], a[8:11], 0
buffer_load_dwordx4 a[100:103], v4, s[8:11], s48 offen offset:2048 sc1
v_mfma_f32_16x16x32_bf16 v[120:123], v[68:71], a[24:27], v[120:123]
ds_read_b128 v[60:63], v2 offset:11264
v_mfma_f32_16x16x32_bf16 v[124:127], v[64:67], a[12:15], 0
v_mfma_f32_16x16x32_bf16 v[124:127], v[68:71], a[28:31], v[124:127]
s_waitcnt lgkmcnt(4)
v_mfma_f32_16x16x32_bf16 v[128:131], v[72:75], a[0:3], 0
buffer_load_dwordx4 a[104:107], v5, s[8:11], s48 offen offset:2048 sc1
v_mfma_f32_16x16x32_bf16 v[128:131], v[76:79], a[16:19], v[128:131]
v_mfma_f32_16x16x32_bf16 v[132:135], v[72:75], a[4:7], 0
ds_read_b128 v[64:67], v2 offset:12288
v_mfma_f32_16x16x32_bf16 v[132:135], v[76:79], a[20:23], v[132:135]
v_mfma_f32_16x16x32_bf16 v[136:139], v[72:75], a[8:11], 0
buffer_load_dwordx4 a[108:111], v6, s[8:11], s48 offen offset:2048 sc1
v_mfma_f32_16x16x32_bf16 v[136:139], v[76:79], a[24:27], v[136:139]
ds_read_b128 v[68:71], v2 offset:13312
v_mfma_f32_16x16x32_bf16 v[140:143], v[72:75], a[12:15], 0
v_mfma_f32_16x16x32_bf16 v[140:143], v[76:79], a[28:31], v[140:143]
s_waitcnt vmcnt(12)
s_waitcnt lgkmcnt(4)
v_mfma_f32_16x16x32_bf16 v[80:83], v[48:51], a[32:35], v[80:83]
buffer_load_dwordx4 a[112:115], v2, s[8:11], s48 offen offset:3072 sc1
v_mfma_f32_16x16x32_bf16 v[80:83], v[52:55], a[48:51], v[80:83]
v_mfma_f32_16x16x32_bf16 v[84:87], v[48:51], a[36:39], v[84:87]
ds_read_b128 v[72:75], v2 offset:14336
v_mfma_f32_16x16x32_bf16 v[84:87], v[52:55], a[52:55], v[84:87]
v_mfma_f32_16x16x32_bf16 v[88:91], v[48:51], a[40:43], v[88:91]
buffer_load_dwordx4 a[116:119], v4, s[8:11], s48 offen offset:3072 sc1
v_mfma_f32_16x16x32_bf16 v[88:91], v[52:55], a[56:59], v[88:91]
ds_read_b128 v[76:79], v2 offset:15360
v_mfma_f32_16x16x32_bf16 v[92:95], v[48:51], a[44:47], v[92:95]
v_mfma_f32_16x16x32_bf16 v[92:95], v[52:55], a[60:63], v[92:95]
s_waitcnt lgkmcnt(4)
v_mfma_f32_16x16x32_bf16 v[96:99], v[56:59], a[32:35], v[96:99]
buffer_load_dwordx4 a[120:123], v5, s[8:11], s48 offen offset:3072 sc1
v_mfma_f32_16x16x32_bf16 v[96:99], v[60:63], a[48:51], v[96:99]
v_mfma_f32_16x16x32_bf16 v[100:103], v[56:59], a[36:39], v[100:103]
ds_read_b128 v[48:51], v2 offset:16384
v_mfma_f32_16x16x32_bf16 v[100:103], v[60:63], a[52:55], v[100:103]
v_mfma_f32_16x16x32_bf16 v[104:107], v[56:59], a[40:43], v[104:107]
buffer_load_dwordx4 a[124:127], v6, s[8:11], s48 offen offset:3072 sc1
v_mfma_f32_16x16x32_bf16 v[104:107], v[60:63], a[56:59], v[104:107]
ds_read_b128 v[52:55], v2 offset:17408
s_add_u32 s48, s20, 8192
v_mfma_f32_16x16x32_bf16 v[108:111], v[56:59], a[44:47], v[108:111]
v_mfma_f32_16x16x32_bf16 v[108:111], v[60:63], a[60:63], v[108:111]
s_waitcnt lgkmcnt(4)
v_mfma_f32_16x16x32_bf16 v[112:115], v[64:67], a[32:35], v[112:115]
buffer_load_dwordx4 a[128:131], v2, s[8:11], s48 offen offset:0 sc1
v_mfma_f32_16x16x32_bf16 v[112:115], v[68:71], a[48:51], v[112:115]
v_mfma_f32_16x16x32_bf16 v[116:119], v[64:67], a[36:39], v[116:119]
ds_read_b128 v[56:59], v2 offset:18432
v_mfma_f32_16x16x32_bf16 v[116:119], v[68:71], a[52:55], v[116:119]
v_mfma_f32_16x16x32_bf16 v[120:123], v[64:67], a[40:43], v[120:123]
buffer_load_dwordx4 a[132:135], v4, s[8:11], s48 offen offset:0 sc1
v_mfma_f32_16x16x32_bf16 v[120:123], v[68:71], a[56:59], v[120:123]
ds_read_b128 v[60:63], v2 offset:19456
v_mfma_f32_16x16x32_bf16 v[124:127], v[64:67], a[44:47], v[124:127]
v_mfma_f32_16x16x32_bf16 v[124:127], v[68:71], a[60:63], v[124:127]
s_waitcnt lgkmcnt(4)
v_mfma_f32_16x16x32_bf16 v[128:131], v[72:75], a[32:35], v[128:131]
buffer_load_dwordx4 a[136:139], v5, s[8:11], s48 offen offset:0 sc1
v_mfma_f32_16x16x32_bf16 v[128:131], v[76:79], a[48:51], v[128:131]
v_mfma_f32_16x16x32_bf16 v[132:135], v[72:75], a[36:39], v[132:135]
ds_read_b128 v[64:67], v2 offset:20480
v_mfma_f32_16x16x32_bf16 v[132:135], v[76:79], a[52:55], v[132:135]
v_mfma_f32_16x16x32_bf16 v[136:139], v[72:75], a[40:43], v[136:139]
buffer_load_dwordx4 a[140:143], v6, s[8:11], s48 offen offset:0 sc1
v_mfma_f32_16x16x32_bf16 v[136:139], v[76:79], a[56:59], v[136:139]
ds_read_b128 v[68:71], v2 offset:21504
v_mfma_f32_16x16x32_bf16 v[140:143], v[72:75], a[44:47], v[140:143]
v_mfma_f32_16x16x32_bf16 v[140:143], v[76:79], a[60:63], v[140:143]
s_waitcnt vmcnt(12)
s_waitcnt lgkmcnt(4)
v_mfma_f32_16x16x32_bf16 v[80:83], v[48:51], a[64:67], v[80:83]
buffer_load_dwordx4 a[144:147], v2, s[8:11], s48 offen offset:1024 sc1
v_mfma_f32_16x16x32_bf16 v[80:83], v[52:55], a[80:83], v[80:83]
v_mfma_f32_16x16x32_bf16 v[84:87], v[48:51], a[68:71], v[84:87]
ds_read_b128 v[72:75], v2 offset:22528
v_mfma_f32_16x16x32_bf16 v[84:87], v[52:55], a[84:87], v[84:87]
v_add_f32 v144, v144, v146
v_add_f32 v145, v145, v147
v_mfma_f32_16x16x32_bf16 v[88:91], v[48:51], a[72:75], v[88:91]
buffer_load_dwordx4 a[148:151], v4, s[8:11], s48 offen offset:1024 sc1
v_mfma_f32_16x16x32_bf16 v[88:91], v[52:55], a[88:91], v[88:91]
ds_read_b128 v[76:79], v2 offset:23552
v_add_f32 v148, v148, v150
v_mfma_f32_16x16x32_bf16 v[92:95], v[48:51], a[76:79], v[92:95]
v_add_f32 v149, v149, v151
v_add_f32 v152, v152, v154
v_mfma_f32_16x16x32_bf16 v[92:95], v[52:55], a[92:95], v[92:95]
v_add_f32 v153, v153, v155
s_waitcnt lgkmcnt(4)
v_mfma_f32_16x16x32_bf16 v[96:99], v[56:59], a[64:67], v[96:99]
buffer_load_dwordx4 a[152:155], v5, s[8:11], s48 offen offset:1024 sc1
v_mfma_f32_16x16x32_bf16 v[96:99], v[60:63], a[80:83], v[96:99]
s_barrier
v_mfma_f32_16x16x32_bf16 v[100:103], v[56:59], a[68:71], v[100:103]
ds_read_b128 v[48:51], v2 offset:24576
v_add_f32 v156, v156, v158
v_mfma_f32_16x16x32_bf16 v[100:103], v[60:63], a[84:87], v[100:103]
v_add_f32 v157, v157, v159
v_mov_b32 v160, v144
v_mfma_f32_16x16x32_bf16 v[104:107], v[56:59], a[72:75], v[104:107]
buffer_load_dwordx4 a[156:159], v6, s[8:11], s48 offen offset:1024 sc1
v_mfma_f32_16x16x32_bf16 v[104:107], v[60:63], a[88:91], v[104:107]
ds_read_b128 v[52:55], v2 offset:25600
v_mov_b32 v161, v145
v_mfma_f32_16x16x32_bf16 v[108:111], v[56:59], a[76:79], v[108:111]
v_mov_b32 v162, v148
v_mov_b32 v163, v149
v_mfma_f32_16x16x32_bf16 v[108:111], v[60:63], a[92:95], v[108:111]
v_mov_b32 v164, v152
s_waitcnt lgkmcnt(4)
v_mfma_f32_16x16x32_bf16 v[112:115], v[64:67], a[64:67], v[112:115]
buffer_load_dwordx4 a[160:163], v2, s[8:11], s48 offen offset:2048 sc1
v_mfma_f32_16x16x32_bf16 v[112:115], v[68:71], a[80:83], v[112:115]
v_mov_b32 v165, v153
v_mov_b32 v166, v156
v_mfma_f32_16x16x32_bf16 v[116:119], v[64:67], a[68:71], v[116:119]
ds_read_b128 v[56:59], v2 offset:26624
v_mov_b32 v167, v157
v_mfma_f32_16x16x32_bf16 v[116:119], v[68:71], a[84:87], v[116:119]
v_permlane16_swap_b32 v144, v160
v_permlane16_swap_b32 v145, v161
v_mfma_f32_16x16x32_bf16 v[120:123], v[64:67], a[72:75], v[120:123]
buffer_load_dwordx4 a[164:167], v4, s[8:11], s48 offen offset:2048 sc1
v_mfma_f32_16x16x32_bf16 v[120:123], v[68:71], a[88:91], v[120:123]
ds_read_b128 v[60:63], v2 offset:27648
v_permlane16_swap_b32 v148, v162
v_mfma_f32_16x16x32_bf16 v[124:127], v[64:67], a[76:79], v[124:127]
v_permlane16_swap_b32 v149, v163
v_permlane16_swap_b32 v152, v164
v_mfma_f32_16x16x32_bf16 v[124:127], v[68:71], a[92:95], v[124:127]
v_permlane16_swap_b32 v153, v165
s_waitcnt lgkmcnt(4)
v_mfma_f32_16x16x32_bf16 v[128:131], v[72:75], a[64:67], v[128:131]
buffer_load_dwordx4 a[168:171], v5, s[8:11], s48 offen offset:2048 sc1
v_mfma_f32_16x16x32_bf16 v[128:131], v[76:79], a[80:83], v[128:131]
v_permlane16_swap_b32 v156, v166
v_permlane16_swap_b32 v157, v167
v_mfma_f32_16x16x32_bf16 v[132:135], v[72:75], a[68:71], v[132:135]
ds_read_b128 v[64:67], v2 offset:28672
v_add_f32 v144, v144, v160
v_mfma_f32_16x16x32_bf16 v[132:135], v[76:79], a[84:87], v[132:135]
v_add_f32 v145, v145, v161
v_add_f32 v148, v148, v162
v_mfma_f32_16x16x32_bf16 v[136:139], v[72:75], a[72:75], v[136:139]
buffer_load_dwordx4 a[172:175], v6, s[8:11], s48 offen offset:2048 sc1
v_mfma_f32_16x16x32_bf16 v[136:139], v[76:79], a[88:91], v[136:139]
ds_read_b128 v[68:71], v2 offset:29696
v_add_f32 v149, v149, v163
v_mfma_f32_16x16x32_bf16 v[140:143], v[72:75], a[76:79], v[140:143]
v_add_f32 v152, v152, v164
v_add_f32 v153, v153, v165
v_mfma_f32_16x16x32_bf16 v[140:143], v[76:79], a[92:95], v[140:143]
v_add_f32 v156, v156, v166
s_waitcnt vmcnt(12)
s_waitcnt lgkmcnt(4)
v_mfma_f32_16x16x32_bf16 v[80:83], v[48:51], a[96:99], v[80:83]
buffer_load_dwordx4 a[176:179], v2, s[8:11], s48 offen offset:3072 sc1
v_mfma_f32_16x16x32_bf16 v[80:83], v[52:55], a[112:115], v[80:83]
v_add_f32 v157, v157, v167
v_mov_b32 v160, v144
v_mfma_f32_16x16x32_bf16 v[84:87], v[48:51], a[100:103], v[84:87]
ds_read_b128 v[72:75], v2 offset:30720
v_mov_b32 v161, v145
v_mfma_f32_16x16x32_bf16 v[84:87], v[52:55], a[116:119], v[84:87]
v_mov_b32 v162, v148
v_mov_b32 v163, v149
v_mfma_f32_16x16x32_bf16 v[88:91], v[48:51], a[104:107], v[88:91]
buffer_load_dwordx4 a[180:183], v4, s[8:11], s48 offen offset:3072 sc1
v_mfma_f32_16x16x32_bf16 v[88:91], v[52:55], a[120:123], v[88:91]
ds_read_b128 v[76:79], v2 offset:31744
v_mov_b32 v164, v152
v_mfma_f32_16x16x32_bf16 v[92:95], v[48:51], a[108:111], v[92:95]
v_mov_b32 v165, v153
v_mov_b32 v166, v156
v_mfma_f32_16x16x32_bf16 v[92:95], v[52:55], a[124:127], v[92:95]
v_mov_b32 v167, v157
s_waitcnt lgkmcnt(4)
v_mfma_f32_16x16x32_bf16 v[96:99], v[56:59], a[96:99], v[96:99]
buffer_load_dwordx4 a[184:187], v5, s[8:11], s48 offen offset:3072 sc1
v_mfma_f32_16x16x32_bf16 v[96:99], v[60:63], a[112:115], v[96:99]
v_permlane32_swap_b32 v144, v160
v_permlane32_swap_b32 v145, v161
v_mfma_f32_16x16x32_bf16 v[100:103], v[56:59], a[100:103], v[100:103]
ds_read_b128 v[48:51], v2 offset:32768
v_permlane32_swap_b32 v148, v162
v_mfma_f32_16x16x32_bf16 v[100:103], v[60:63], a[116:119], v[100:103]
v_permlane32_swap_b32 v149, v163
v_permlane32_swap_b32 v152, v164
v_mfma_f32_16x16x32_bf16 v[104:107], v[56:59], a[104:107], v[104:107]
buffer_load_dwordx4 a[188:191], v6, s[8:11], s48 offen offset:3072 sc1
v_mfma_f32_16x16x32_bf16 v[104:107], v[60:63], a[120:123], v[104:107]
ds_read_b128 v[52:55], v2 offset:33792
s_add_u32 s48, s20, 12288
v_mfma_f32_16x16x32_bf16 v[108:111], v[56:59], a[108:111], v[108:111]
v_permlane32_swap_b32 v153, v165
v_permlane32_swap_b32 v156, v166
v_mfma_f32_16x16x32_bf16 v[108:111], v[60:63], a[124:127], v[108:111]
v_permlane32_swap_b32 v157, v167
s_waitcnt lgkmcnt(4)
v_mfma_f32_16x16x32_bf16 v[112:115], v[64:67], a[96:99], v[112:115]
buffer_load_dwordx4 a[192:195], v2, s[8:11], s48 offen offset:0 sc1
v_mfma_f32_16x16x32_bf16 v[112:115], v[68:71], a[112:115], v[112:115]
v_add_f32 v144, v144, v160
v_add_f32 v145, v145, v161
v_mfma_f32_16x16x32_bf16 v[116:119], v[64:67], a[100:103], v[116:119]
ds_read_b128 v[56:59], v2 offset:34816
v_add_f32 v148, v148, v162
v_mfma_f32_16x16x32_bf16 v[116:119], v[68:71], a[116:119], v[116:119]
v_add_f32 v149, v149, v163
v_add_f32 v152, v152, v164
v_mfma_f32_16x16x32_bf16 v[120:123], v[64:67], a[104:107], v[120:123]
buffer_load_dwordx4 a[196:199], v4, s[8:11], s48 offen offset:0 sc1
v_mfma_f32_16x16x32_bf16 v[120:123], v[68:71], a[120:123], v[120:123]
ds_read_b128 v[60:63], v2 offset:35840
v_add_f32 v153, v153, v165
v_mfma_f32_16x16x32_bf16 v[124:127], v[64:67], a[108:111], v[124:127]
v_add_f32 v156, v156, v166
v_add_f32 v157, v157, v167
v_mfma_f32_16x16x32_bf16 v[124:127], v[68:71], a[124:127], v[124:127]
v_mul_f32 v144, 0x3ae38e39, v144
s_waitcnt lgkmcnt(4)
v_mfma_f32_16x16x32_bf16 v[128:131], v[72:75], a[96:99], v[128:131]
buffer_load_dwordx4 a[200:203], v5, s[8:11], s48 offen offset:0 sc1
v_mfma_f32_16x16x32_bf16 v[128:131], v[76:79], a[112:115], v[128:131]
v_mul_f32 v148, 0x3ae38e39, v148
v_mul_f32 v152, 0x3ae38e39, v152
v_mfma_f32_16x16x32_bf16 v[132:135], v[72:75], a[100:103], v[132:135]
ds_read_b128 v[64:67], v2 offset:36864
v_mul_f32 v156, 0x3ae38e39, v156
v_mfma_f32_16x16x32_bf16 v[132:135], v[76:79], a[116:119], v[132:135]
v_mul_f32 v145, 0x3ae38e39, v145
v_mul_f32 v149, 0x3ae38e39, v149
v_mfma_f32_16x16x32_bf16 v[136:139], v[72:75], a[104:107], v[136:139]
buffer_load_dwordx4 a[204:207], v6, s[8:11], s48 offen offset:0 sc1
v_mfma_f32_16x16x32_bf16 v[136:139], v[76:79], a[120:123], v[136:139]
ds_read_b128 v[68:71], v2 offset:37888
v_mul_f32 v153, 0x3ae38e39, v153
v_mfma_f32_16x16x32_bf16 v[140:143], v[72:75], a[108:111], v[140:143]
v_mul_f32 v157, 0x3ae38e39, v157
v_fma_f32 v145, -v144, v144, v145
v_mfma_f32_16x16x32_bf16 v[140:143], v[76:79], a[124:127], v[140:143]
v_fma_f32 v149, -v148, v148, v149
s_waitcnt vmcnt(12)
s_waitcnt lgkmcnt(4)
v_mfma_f32_16x16x32_bf16 v[80:83], v[48:51], a[128:131], v[80:83]
buffer_load_dwordx4 a[208:211], v2, s[8:11], s48 offen offset:1024 sc1
v_mfma_f32_16x16x32_bf16 v[80:83], v[52:55], a[144:147], v[80:83]
v_fma_f32 v153, -v152, v152, v153
v_fma_f32 v157, -v156, v156, v157
v_mfma_f32_16x16x32_bf16 v[84:87], v[48:51], a[132:135], v[84:87]
ds_read_b128 v[72:75], v2 offset:38912
v_max_f32 v145, 0, v145
v_mfma_f32_16x16x32_bf16 v[84:87], v[52:55], a[148:151], v[84:87]
v_max_f32 v149, 0, v149
v_max_f32 v153, 0, v153
v_mfma_f32_16x16x32_bf16 v[88:91], v[48:51], a[136:139], v[88:91]
buffer_load_dwordx4 a[212:215], v4, s[8:11], s48 offen offset:1024 sc1
v_mfma_f32_16x16x32_bf16 v[88:91], v[52:55], a[152:155], v[88:91]
ds_read_b128 v[76:79], v2 offset:39936
v_max_f32 v157, 0, v157
v_mfma_f32_16x16x32_bf16 v[92:95], v[48:51], a[140:143], v[92:95]
v_add_f32 v234, 0x3727c5ac, v145
v_add_f32 v237, 0x3727c5ac, v149
v_mfma_f32_16x16x32_bf16 v[92:95], v[52:55], a[156:159], v[92:95]
v_add_f32 v240, 0x3727c5ac, v153
s_waitcnt lgkmcnt(4)
v_mfma_f32_16x16x32_bf16 v[96:99], v[56:59], a[128:131], v[96:99]
buffer_load_dwordx4 a[216:219], v5, s[8:11], s48 offen offset:1024 sc1
v_mfma_f32_16x16x32_bf16 v[96:99], v[60:63], a[144:147], v[96:99]
v_add_f32 v243, 0x3727c5ac, v157
v_mfma_f32_16x16x32_bf16 v[100:103], v[56:59], a[132:135], v[100:103]
ds_read_b128 v[48:51], v2 offset:40960
v_mfma_f32_16x16x32_bf16 v[100:103], v[60:63], a[148:151], v[100:103]
v_rsq_f32 v144, v234
v_mfma_f32_16x16x32_bf16 v[104:107], v[56:59], a[136:139], v[104:107]
buffer_load_dwordx4 a[220:223], v6, s[8:11], s48 offen offset:1024 sc1
v_mfma_f32_16x16x32_bf16 v[104:107], v[60:63], a[152:155], v[104:107]
ds_read_b128 v[52:55], v2 offset:41984
v_mul_f32 v232, 0xc0135761, v144
v_mfma_f32_16x16x32_bf16 v[108:111], v[56:59], a[140:143], v[108:111]
v_rsq_f32 v148, v237
v_mfma_f32_16x16x32_bf16 v[108:111], v[60:63], a[156:159], v[108:111]
v_mul_f32 v235, 0xc0135761, v148
s_waitcnt lgkmcnt(4)
v_mfma_f32_16x16x32_bf16 v[112:115], v[64:67], a[128:131], v[112:115]
buffer_load_dwordx4 a[224:227], v2, s[8:11], s48 offen offset:2048 sc1
v_mfma_f32_16x16x32_bf16 v[112:115], v[68:71], a[144:147], v[112:115]
v_rsq_f32 v152, v240
v_mfma_f32_16x16x32_bf16 v[116:119], v[64:67], a[132:135], v[116:119]
ds_read_b128 v[56:59], v2 offset:43008
v_mul_f32 v238, 0xc0135761, v152
v_mfma_f32_16x16x32_bf16 v[116:119], v[68:71], a[148:151], v[116:119]
v_rsq_f32 v156, v243
v_mfma_f32_16x16x32_bf16 v[120:123], v[64:67], a[136:139], v[120:123]
buffer_load_dwordx4 a[228:231], v4, s[8:11], s48 offen offset:2048 sc1
v_mfma_f32_16x16x32_bf16 v[120:123], v[68:71], a[152:155], v[120:123]
ds_read_b128 v[60:63], v2 offset:44032
v_mul_f32 v241, 0xc0135761, v156
v_mfma_f32_16x16x32_bf16 v[124:127], v[64:67], a[140:143], v[124:127]
v_mul_f32 v145, v144, v144
v_mul_f32 v149, v148, v148
v_mfma_f32_16x16x32_bf16 v[124:127], v[68:71], a[156:159], v[124:127]
v_mul_f32 v153, v152, v152
s_waitcnt lgkmcnt(4)
v_mfma_f32_16x16x32_bf16 v[128:131], v[72:75], a[128:131], v[128:131]
buffer_load_dwordx4 a[232:235], v5, s[8:11], s48 offen offset:2048 sc1
v_mfma_f32_16x16x32_bf16 v[128:131], v[76:79], a[144:147], v[128:131]
v_mul_f32 v157, v156, v156
v_mul_f32 v145, v145, v144
v_mfma_f32_16x16x32_bf16 v[132:135], v[72:75], a[132:135], v[132:135]
ds_read_b128 v[64:67], v2 offset:45056
v_mul_f32 v149, v149, v148
v_mfma_f32_16x16x32_bf16 v[132:135], v[76:79], a[148:151], v[132:135]
v_mul_f32 v153, v153, v152
v_mul_f32 v157, v157, v156
v_mfma_f32_16x16x32_bf16 v[136:139], v[72:75], a[136:139], v[136:139]
buffer_load_dwordx4 a[236:239], v6, s[8:11], s48 offen offset:2048 sc1
v_mfma_f32_16x16x32_bf16 v[136:139], v[76:79], a[152:155], v[136:139]
ds_read_b128 v[68:71], v2 offset:46080
v_mul_f32 v233, 0xbdd2d3e8, v145
v_mfma_f32_16x16x32_bf16 v[140:143], v[72:75], a[140:143], v[140:143]
v_mul_f32 v236, 0xbdd2d3e8, v149
v_mul_f32 v239, 0xbdd2d3e8, v153
v_mfma_f32_16x16x32_bf16 v[140:143], v[76:79], a[156:159], v[140:143]
v_mul_f32 v242, 0xbdd2d3e8, v157
s_waitcnt vmcnt(12)
s_waitcnt lgkmcnt(4)
v_mfma_f32_16x16x32_bf16 v[80:83], v[48:51], a[160:163], v[80:83]
buffer_load_dwordx4 a[240:243], v2, s[8:11], s48 offen offset:3072 sc1
v_mfma_f32_16x16x32_bf16 v[80:83], v[52:55], a[176:179], v[80:83]
v_mfma_f32_16x16x32_bf16 v[84:87], v[48:51], a[164:167], v[84:87]
ds_read_b128 v[72:75], v2 offset:47104
v_mfma_f32_16x16x32_bf16 v[84:87], v[52:55], a[180:183], v[84:87]
v_mfma_f32_16x16x32_bf16 v[88:91], v[48:51], a[168:171], v[88:91]
buffer_load_dwordx4 a[244:247], v4, s[8:11], s48 offen offset:3072 sc1
v_mfma_f32_16x16x32_bf16 v[88:91], v[52:55], a[184:187], v[88:91]
ds_read_b128 v[76:79], v2 offset:48128
v_mfma_f32_16x16x32_bf16 v[92:95], v[48:51], a[172:175], v[92:95]
v_mfma_f32_16x16x32_bf16 v[92:95], v[52:55], a[188:191], v[92:95]
s_waitcnt lgkmcnt(4)
v_mfma_f32_16x16x32_bf16 v[96:99], v[56:59], a[160:163], v[96:99]
buffer_load_dwordx4 a[248:251], v5, s[8:11], s48 offen offset:3072 sc1
v_mfma_f32_16x16x32_bf16 v[96:99], v[60:63], a[176:179], v[96:99]
s_barrier
v_mfma_f32_16x16x32_bf16 v[100:103], v[56:59], a[164:167], v[100:103]
ds_read_b128 v[48:51], v2 offset:49152
v_mfma_f32_16x16x32_bf16 v[100:103], v[60:63], a[180:183], v[100:103]
v_mfma_f32_16x16x32_bf16 v[104:107], v[56:59], a[168:171], v[104:107]
buffer_load_dwordx4 a[252:255], v6, s[8:11], s48 offen offset:3072 sc1
v_mfma_f32_16x16x32_bf16 v[104:107], v[60:63], a[184:187], v[104:107]
ds_read_b128 v[52:55], v2 offset:50176
s_add_u32 s48, s20, 16384
v_mfma_f32_16x16x32_bf16 v[108:111], v[56:59], a[172:175], v[108:111]
v_mfma_f32_16x16x32_bf16 v[108:111], v[60:63], a[188:191], v[108:111]
s_waitcnt lgkmcnt(4)
v_mfma_f32_16x16x32_bf16 v[112:115], v[64:67], a[160:163], v[112:115]
buffer_load_dwordx4 v[16:19], v2, s[8:11], s48 offen offset:0 sc1
v_mfma_f32_16x16x32_bf16 v[112:115], v[68:71], a[176:179], v[112:115]
v_mfma_f32_16x16x32_bf16 v[116:119], v[64:67], a[164:167], v[116:119]
ds_read_b128 v[56:59], v2 offset:51200
v_mfma_f32_16x16x32_bf16 v[116:119], v[68:71], a[180:183], v[116:119]
v_mfma_f32_16x16x32_bf16 v[120:123], v[64:67], a[168:171], v[120:123]
buffer_load_dwordx4 v[20:23], v4, s[8:11], s48 offen offset:0 sc1
v_mfma_f32_16x16x32_bf16 v[120:123], v[68:71], a[184:187], v[120:123]
ds_read_b128 v[60:63], v2 offset:52224
v_mfma_f32_16x16x32_bf16 v[124:127], v[64:67], a[172:175], v[124:127]
v_mfma_f32_16x16x32_bf16 v[124:127], v[68:71], a[188:191], v[124:127]
s_waitcnt lgkmcnt(4)
v_mfma_f32_16x16x32_bf16 v[128:131], v[72:75], a[160:163], v[128:131]
buffer_load_dwordx4 v[24:27], v5, s[8:11], s48 offen offset:0 sc1
v_mfma_f32_16x16x32_bf16 v[128:131], v[76:79], a[176:179], v[128:131]
v_mfma_f32_16x16x32_bf16 v[132:135], v[72:75], a[164:167], v[132:135]
ds_read_b128 v[64:67], v2 offset:53248
v_mfma_f32_16x16x32_bf16 v[132:135], v[76:79], a[180:183], v[132:135]
v_mfma_f32_16x16x32_bf16 v[136:139], v[72:75], a[168:171], v[136:139]
buffer_load_dwordx4 v[28:31], v6, s[8:11], s48 offen offset:0 sc1
v_mfma_f32_16x16x32_bf16 v[136:139], v[76:79], a[184:187], v[136:139]
ds_read_b128 v[68:71], v2 offset:54272
v_mfma_f32_16x16x32_bf16 v[140:143], v[72:75], a[172:175], v[140:143]
v_mfma_f32_16x16x32_bf16 v[140:143], v[76:79], a[188:191], v[140:143]
s_waitcnt vmcnt(12)
s_waitcnt lgkmcnt(4)
v_mfma_f32_16x16x32_bf16 v[80:83], v[48:51], a[192:195], v[80:83]
buffer_load_dwordx4 v[32:35], v2, s[8:11], s48 offen offset:1024 sc1
v_mfma_f32_16x16x32_bf16 v[80:83], v[52:55], a[208:211], v[80:83]
v_mfma_f32_16x16x32_bf16 v[84:87], v[48:51], a[196:199], v[84:87]
ds_read_b128 v[72:75], v2 offset:55296
v_mfma_f32_16x16x32_bf16 v[84:87], v[52:55], a[212:215], v[84:87]
v_mfma_f32_16x16x32_bf16 v[88:91], v[48:51], a[200:203], v[88:91]
buffer_load_dwordx4 v[36:39], v4, s[8:11], s48 offen offset:1024 sc1
v_mfma_f32_16x16x32_bf16 v[88:91], v[52:55], a[216:219], v[88:91]
ds_read_b128 v[76:79], v2 offset:56320
v_mfma_f32_16x16x32_bf16 v[92:95], v[48:51], a[204:207], v[92:95]
v_mfma_f32_16x16x32_bf16 v[92:95], v[52:55], a[220:223], v[92:95]
s_waitcnt lgkmcnt(4)
v_mfma_f32_16x16x32_bf16 v[96:99], v[56:59], a[192:195], v[96:99]
buffer_load_dwordx4 v[40:43], v5, s[8:11], s48 offen offset:1024 sc1
v_mfma_f32_16x16x32_bf16 v[96:99], v[60:63], a[208:211], v[96:99]
v_mfma_f32_16x16x32_bf16 v[100:103], v[56:59], a[196:199], v[100:103]
ds_read_b128 v[48:51], v2 offset:57344
v_mfma_f32_16x16x32_bf16 v[100:103], v[60:63], a[212:215], v[100:103]
v_mfma_f32_16x16x32_bf16 v[104:107], v[56:59], a[200:203], v[104:107]
buffer_load_dwordx4 v[44:47], v6, s[8:11], s48 offen offset:1024 sc1
v_mfma_f32_16x16x32_bf16 v[104:107], v[60:63], a[216:219], v[104:107]
ds_read_b128 v[52:55], v2 offset:58368
s_add_u32 m0, s22, 98304
v_mfma_f32_16x16x32_bf16 v[108:111], v[56:59], a[204:207], v[108:111]
v_add_u32 v3, 20480, v3
v_mfma_f32_16x16x32_bf16 v[108:111], v[60:63], a[220:223], v[108:111]
s_waitcnt lgkmcnt(4)
v_mfma_f32_16x16x32_bf16 v[112:115], v[64:67], a[192:195], v[112:115]
buffer_load_dwordx4 v3, s[8:11], 0 offen offset:0 sc1 lds
v_mfma_f32_16x16x32_bf16 v[112:115], v[68:71], a[208:211], v[112:115]
v_mfma_f32_16x16x32_bf16 v[116:119], v[64:67], a[196:199], v[116:119]
ds_read_b128 v[56:59], v2 offset:59392
v_mfma_f32_16x16x32_bf16 v[116:119], v[68:71], a[212:215], v[116:119]
v_mfma_f32_16x16x32_bf16 v[120:123], v[64:67], a[200:203], v[120:123]
buffer_load_dwordx4 v3, s[8:11], 0 offen offset:1024 sc1 lds
v_mfma_f32_16x16x32_bf16 v[120:123], v[68:71], a[216:219], v[120:123]
ds_read_b128 v[60:63], v2 offset:60416
v_mfma_f32_16x16x32_bf16 v[124:127], v[64:67], a[204:207], v[124:127]
v_mfma_f32_16x16x32_bf16 v[124:127], v[68:71], a[220:223], v[124:127]
s_waitcnt lgkmcnt(4)
v_mfma_f32_16x16x32_bf16 v[128:131], v[72:75], a[192:195], v[128:131]
buffer_load_dwordx4 v3, s[8:11], 0 offen offset:2048 sc1 lds
v_mfma_f32_16x16x32_bf16 v[128:131], v[76:79], a[208:211], v[128:131]
v_mfma_f32_16x16x32_bf16 v[132:135], v[72:75], a[196:199], v[132:135]
ds_read_b128 v[64:67], v2 offset:61440
v_mfma_f32_16x16x32_bf16 v[132:135], v[76:79], a[212:215], v[132:135]
v_mfma_f32_16x16x32_bf16 v[136:139], v[72:75], a[200:203], v[136:139]
buffer_load_dwordx4 v3, s[8:11], 0 offen offset:3072 sc1 lds
v_mfma_f32_16x16x32_bf16 v[136:139], v[76:79], a[216:219], v[136:139]
ds_read_b128 v[68:71], v2 offset:62464
s_add_u32 m0, s22, 102400
v_mfma_f32_16x16x32_bf16 v[140:143], v[72:75], a[204:207], v[140:143]
v_add_u32 v3, 4096, v3
v_mfma_f32_16x16x32_bf16 v[140:143], v[76:79], a[220:223], v[140:143]
s_waitcnt vmcnt(12)
s_waitcnt lgkmcnt(4)
v_mfma_f32_16x16x32_bf16 v[80:83], v[48:51], a[224:227], v[80:83]
buffer_load_dwordx4 v3, s[8:11], 0 offen offset:0 sc1 lds
v_mfma_f32_16x16x32_bf16 v[80:83], v[52:55], a[240:243], v[80:83]
v_mfma_f32_16x16x32_bf16 v[84:87], v[48:51], a[228:231], v[84:87]
ds_read_b128 v[72:75], v2 offset:63488
v_mfma_f32_16x16x32_bf16 v[84:87], v[52:55], a[244:247], v[84:87]
v_mfma_f32_16x16x32_bf16 v[88:91], v[48:51], a[232:235], v[88:91]
buffer_load_dwordx4 v3, s[8:11], 0 offen offset:1024 sc1 lds
v_mfma_f32_16x16x32_bf16 v[88:91], v[52:55], a[248:251], v[88:91]
ds_read_b128 v[76:79], v2 offset:64512
s_add_u32 m0, s22, 122880
v_mfma_f32_16x16x32_bf16 v[92:95], v[48:51], a[236:239], v[92:95]
v_add_u32 v3, 20480, v3
v_mfma_f32_16x16x32_bf16 v[92:95], v[52:55], a[252:255], v[92:95]
s_waitcnt lgkmcnt(4)
v_mfma_f32_16x16x32_bf16 v[96:99], v[56:59], a[224:227], v[96:99]
buffer_load_dwordx4 v3, s[8:11], 0 offen offset:0 sc1 lds
v_mfma_f32_16x16x32_bf16 v[96:99], v[60:63], a[240:243], v[96:99]
v_mfma_f32_16x16x32_bf16 v[100:103], v[56:59], a[228:231], v[100:103]
ds_read_b128 v[48:51], v7 offset:0
v_mfma_f32_16x16x32_bf16 v[100:103], v[60:63], a[244:247], v[100:103]
v_mfma_f32_16x16x32_bf16 v[104:107], v[56:59], a[232:235], v[104:107]
buffer_load_dwordx4 v3, s[8:11], 0 offen offset:1024 sc1 lds
v_mfma_f32_16x16x32_bf16 v[104:107], v[60:63], a[248:251], v[104:107]
ds_read_b128 v[52:55], v7 offset:1024
v_mfma_f32_16x16x32_bf16 v[108:111], v[56:59], a[236:239], v[108:111]
v_mfma_f32_16x16x32_bf16 v[108:111], v[60:63], a[252:255], v[108:111]
s_waitcnt lgkmcnt(4)
v_mfma_f32_16x16x32_bf16 v[112:115], v[64:67], a[224:227], v[112:115]
buffer_load_dwordx4 v3, s[8:11], 0 offen offset:2048 sc1 lds
v_mfma_f32_16x16x32_bf16 v[112:115], v[68:71], a[240:243], v[112:115]
v_mfma_f32_16x16x32_bf16 v[116:119], v[64:67], a[228:231], v[116:119]
ds_read_b128 v[56:59], v7 offset:2048
v_mfma_f32_16x16x32_bf16 v[116:119], v[68:71], a[244:247], v[116:119]
v_mfma_f32_16x16x32_bf16 v[120:123], v[64:67], a[232:235], v[120:123]
buffer_load_dwordx4 v3, s[8:11], 0 offen offset:3072 sc1 lds
v_mfma_f32_16x16x32_bf16 v[120:123], v[68:71], a[248:251], v[120:123]
ds_read_b128 v[60:63], v7 offset:3072
s_add_u32 m0, s22, 126976
v_mfma_f32_16x16x32_bf16 v[124:127], v[64:67], a[236:239], v[124:127]
v_add_u32 v3, 4096, v3
v_mfma_f32_16x16x32_bf16 v[124:127], v[68:71], a[252:255], v[124:127]
s_waitcnt lgkmcnt(4)
v_mfma_f32_16x16x32_bf16 v[128:131], v[72:75], a[224:227], v[128:131]
buffer_load_dwordx4 v3, s[8:11], 0 offen offset:0 sc1 lds
v_mfma_f32_16x16x32_bf16 v[128:131], v[76:79], a[240:243], v[128:131]
v_mfma_f32_16x16x32_bf16 v[132:135], v[72:75], a[228:231], v[132:135]
ds_read_b128 v[64:67], v7 offset:4096
v_mfma_f32_16x16x32_bf16 v[132:135], v[76:79], a[244:247], v[132:135]
v_mfma_f32_16x16x32_bf16 v[136:139], v[72:75], a[232:235], v[136:139]
buffer_load_dwordx4 v3, s[8:11], 0 offen offset:1024 sc1 lds
v_mfma_f32_16x16x32_bf16 v[136:139], v[76:79], a[248:251], v[136:139]
ds_read_b128 v[68:71], v7 offset:5120
s_add_u32 m0, s22, 0
v_mfma_f32_16x16x32_bf16 v[140:143], v[72:75], a[236:239], v[140:143]
v_add_u32 v3, 20480, v3
v_mfma_f32_16x16x32_bf16 v[140:143], v[76:79], a[252:255], v[140:143]
s_waitcnt vmcnt(12)
s_waitcnt lgkmcnt(4)
v_mfma_f32_16x16x32_bf16 v[80:83], v[48:51], v[16:19], v[80:83]
buffer_load_dwordx4 v3, s[8:11], 0 offen offset:0 sc1 lds
v_mfma_f32_16x16x32_bf16 v[80:83], v[52:55], v[32:35], v[80:83]
v_mfma_f32_16x16x32_bf16 v[84:87], v[48:51], v[20:23], v[84:87]
ds_read_b128 v[72:75], v7 offset:6144
v_mfma_f32_16x16x32_bf16 v[84:87], v[52:55], v[36:39], v[84:87]
v_mfma_f32_16x16x32_bf16 v[88:91], v[48:51], v[24:27], v[88:91]
buffer_load_dwordx4 v3, s[8:11], 0 offen offset:1024 sc1 lds
v_mfma_f32_16x16x32_bf16 v[88:91], v[52:55], v[40:43], v[88:91]
ds_read_b128 v[76:79], v7 offset:7168
v_mfma_f32_16x16x32_bf16 v[92:95], v[48:51], v[28:31], v[92:95]
v_mfma_f32_16x16x32_bf16 v[92:95], v[52:55], v[44:47], v[92:95]
s_waitcnt lgkmcnt(4)
v_mfma_f32_16x16x32_bf16 v[96:99], v[56:59], v[16:19], v[96:99]
buffer_load_dwordx4 v3, s[8:11], 0 offen offset:2048 sc1 lds
v_mfma_f32_16x16x32_bf16 v[96:99], v[60:63], v[32:35], v[96:99]
s_barrier
v_mfma_f32_16x16x32_bf16 v[100:103], v[56:59], v[20:23], v[100:103]
ds_read_b128 v[48:51], v7 offset:8192
v_mfma_f32_16x16x32_bf16 v[100:103], v[60:63], v[36:39], v[100:103]
v_mfma_f32_16x16x32_bf16 v[104:107], v[56:59], v[24:27], v[104:107]
buffer_load_dwordx4 v3, s[8:11], 0 offen offset:3072 sc1 lds
v_mfma_f32_16x16x32_bf16 v[104:107], v[60:63], v[40:43], v[104:107]
ds_read_b128 v[52:55], v7 offset:9216
s_add_u32 m0, s22, 4096
v_mfma_f32_16x16x32_bf16 v[108:111], v[56:59], v[28:31], v[108:111]
v_add_u32 v3, 4096, v3
v_mfma_f32_16x16x32_bf16 v[108:111], v[60:63], v[44:47], v[108:111]
s_waitcnt lgkmcnt(4)
v_mfma_f32_16x16x32_bf16 v[112:115], v[64:67], v[16:19], v[112:115]
buffer_load_dwordx4 v3, s[8:11], 0 offen offset:0 sc1 lds
v_mfma_f32_16x16x32_bf16 v[112:115], v[68:71], v[32:35], v[112:115]
v_mfma_f32_16x16x32_bf16 v[116:119], v[64:67], v[20:23], v[116:119]
ds_read_b128 v[56:59], v7 offset:10240
v_mfma_f32_16x16x32_bf16 v[116:119], v[68:71], v[36:39], v[116:119]
v_mfma_f32_16x16x32_bf16 v[120:123], v[64:67], v[24:27], v[120:123]
buffer_load_dwordx4 v3, s[8:11], 0 offen offset:1024 sc1 lds
v_mfma_f32_16x16x32_bf16 v[120:123], v[68:71], v[40:43], v[120:123]
ds_read_b128 v[60:63], v7 offset:11264
s_add_u32 m0, s22, 24576
v_mfma_f32_16x16x32_bf16 v[124:127], v[64:67], v[28:31], v[124:127]
v_add_u32 v3, 20480, v3
v_mfma_f32_16x16x32_bf16 v[124:127], v[68:71], v[44:47], v[124:127]
s_waitcnt lgkmcnt(4)
v_mfma_f32_16x16x32_bf16 v[128:131], v[72:75], v[16:19], v[128:131]
buffer_load_dwordx4 v3, s[8:11], 0 offen offset:0 sc1 lds
v_mfma_f32_16x16x32_bf16 v[128:131], v[76:79], v[32:35], v[128:131]
v_mfma_f32_16x16x32_bf16 v[132:135], v[72:75], v[20:23], v[132:135]
ds_read_b128 v[64:67], v7 offset:12288
v_mfma_f32_16x16x32_bf16 v[132:135], v[76:79], v[36:39], v[132:135]
v_mfma_f32_16x16x32_bf16 v[136:139], v[72:75], v[24:27], v[136:139]
buffer_load_dwordx4 v3, s[8:11], 0 offen offset:1024 sc1 lds
v_mfma_f32_16x16x32_bf16 v[136:139], v[76:79], v[40:43], v[136:139]
ds_read_b128 v[68:71], v7 offset:13312
v_mfma_f32_16x16x32_bf16 v[140:143], v[72:75], v[28:31], v[140:143]
v_mfma_f32_16x16x32_bf16 v[140:143], v[76:79], v[44:47], v[140:143]
s_waitcnt lgkmcnt(4)
v_mfma_f32_16x16x32_bf16 v[176:179], v[48:51], a[0:3], 0
buffer_load_dwordx4 v3, s[8:11], 0 offen offset:2048 sc1 lds
v_mfma_f32_16x16x32_bf16 v[176:179], v[52:55], a[16:19], v[176:179]
v_mfma_f32_16x16x32_bf16 v[180:183], v[48:51], a[4:7], 0
ds_read_b128 v[72:75], v7 offset:14336
v_mfma_f32_16x16x32_bf16 v[180:183], v[52:55], a[20:23], v[180:183]
v_mul_f32 v208, v80, v80
v_mul_f32 v210, v81, v81
v_mfma_f32_16x16x32_bf16 v[184:187], v[48:51], a[8:11], 0
buffer_load_dwordx4 v3, s[8:11], 0 offen offset:3072 sc1 lds
v_mfma_f32_16x16x32_bf16 v[184:187], v[52:55], a[24:27], v[184:187]
ds_read_b128 v[76:79], v7 offset:15360
s_add_u32 m0, s22, 28672
v_mfma_f32_16x16x32_bf16 v[188:191], v[48:51], a[12:15], 0
v_add_u32 v3, 4096, v3
v_fma_f32 v208, v208, v233, v232
v_mfma_f32_16x16x32_bf16 v[188:191], v[52:55], a[28:31], v[188:191]
v_fma_f32 v210, v210, v233, v232
s_waitcnt lgkmcnt(4)
v_mfma_f32_16x16x32_bf16 v[192:195], v[56:59], a[0:3], 0
buffer_load_dwordx4 v3, s[8:11], 0 offen offset:0 sc1 lds
v_mfma_f32_16x16x32_bf16 v[192:195], v[60:63], a[16:19], v[192:195]
v_mul_f32 v208, v208, v80
v_mul_f32 v210, v210, v81
v_mfma_f32_16x16x32_bf16 v[196:199], v[56:59], a[4:7], 0
ds_read_b128 v[48:51], v7 offset:16384
v_mul_f32 v209, v80, v96
v_mfma_f32_16x16x32_bf16 v[196:199], v[60:63], a[20:23], v[196:199]
v_exp_f32 v208, v208
v_mfma_f32_16x16x32_bf16 v[200:203], v[56:59], a[8:11], 0
buffer_load_dwordx4 v3, s[8:11], 0 offen offset:1024 sc1 lds
v_mfma_f32_16x16x32_bf16 v[200:203], v[60:63], a[24:27], v[200:203]
ds_read_b128 v[52:55], v7 offset:17408
v_mul_f32 v211, v81, v97
v_mfma_f32_16x16x32_bf16 v[204:207], v[56:59], a[12:15], 0
v_exp_f32 v210, v210
v_mfma_f32_16x16x32_bf16 v[204:207], v[60:63], a[28:31], v[204:207]
v_fma_f32 v208, v208, v234, v234
s_waitcnt lgkmcnt(4)
v_mfma_f32_16x16x32_bf16 v[176:179], v[64:67], a[32:35], v[176:179]
v_fma_f32 v210, v210, v234, v234
v_mul_f32 v212, v82, v82
v_mfma_f32_16x16x32_bf16 v[176:179], v[68:71], a[48:51], v[176:179]
v_rcp_f32 v208, v208
v_mfma_f32_16x16x32_bf16 v[180:183], v[64:67], a[36:39], v[180:183]
ds_read_b128 v[56:59], v7 offset:18432
v_mul_f32 v209, v209, v208
v_mfma_f32_16x16x32_bf16 v[180:183], v[68:71], a[52:55], v[180:183]
v_rcp_f32 v210, v210
v_mfma_f32_16x16x32_bf16 v[184:187], v[64:67], a[40:43], v[184:187]
v_mul_f32 v211, v211, v210
v_cvt_pk_bf16_f32 v224, v209, v211
v_mfma_f32_16x16x32_bf16 v[184:187], v[68:71], a[56:59], v[184:187]
ds_read_b128 v[60:63], v7 offset:19456
v_mul_f32 v214, v83, v83
v_mfma_f32_16x16x32_bf16 v[188:191], v[64:67], a[44:47], v[188:191]
v_fma_f32 v212, v212, v233, v232
v_fma_f32 v214, v214, v233, v232
v_mfma_f32_16x16x32_bf16 v[188:191], v[68:71], a[60:63], v[188:191]
v_mul_f32 v212, v212, v82
s_waitcnt lgkmcnt(4)
v_mfma_f32_16x16x32_bf16 v[192:195], v[72:75], a[32:35], v[192:195]
v_mul_f32 v214, v214, v83
v_mul_f32 v213, v82, v98
v_mfma_f32_16x16x32_bf16 v[192:195], v[76:79], a[48:51], v[192:195]
v_exp_f32 v212, v212
v_mfma_f32_16x16x32_bf16 v[196:199], v[72:75], a[36:39], v[196:199]
ds_read_b128 v[64:67], v7 offset:20480
v_mul_f32 v215, v83, v99
v_mfma_f32_16x16x32_bf16 v[196:199], v[76:79], a[52:55], v[196:199]
v_exp_f32 v214, v214
v_mfma_f32_16x16x32_bf16 v[200:203], v[72:75], a[40:43], v[200:203]
v_fma_f32 v212, v212, v234, v234
v_fma_f32 v214, v214, v234, v234
v_mfma_f32_16x16x32_bf16 v[200:203], v[76:79], a[56:59], v[200:203]
ds_read_b128 v[68:71], v7 offset:21504
v_mul_f32 v208, v84, v84
v_mfma_f32_16x16x32_bf16 v[204:207], v[72:75], a[44:47], v[204:207]
v_rcp_f32 v212, v212
v_mfma_f32_16x16x32_bf16 v[204:207], v[76:79], a[60:63], v[204:207]
v_mul_f32 v213, v213, v212
s_waitcnt lgkmcnt(4)
v_mfma_f32_16x16x32_bf16 v[176:179], v[48:51], a[64:67], v[176:179]
v_rcp_f32 v214, v214
v_mfma_f32_16x16x32_bf16 v[176:179], v[52:55], a[80:83], v[176:179]
v_mul_f32 v215, v215, v214
v_cvt_pk_bf16_f32 v225, v213, v215
v_mfma_f32_16x16x32_bf16 v[180:183], v[48:51], a[68:71], v[180:183]
ds_read_b128 v[72:75], v7 offset:22528
v_mul_f32 v210, v85, v85
v_mfma_f32_16x16x32_bf16 v[180:183], v[52:55], a[84:87], v[180:183]
buffer_store_dwordx2 v[224:225], v244, s[8:11], s30 offen sc1
v_mfma_f32_16x16x32_bf16 v[184:187], v[48:51], a[72:75], v[184:187]
v_fma_f32 v208, v208, v236, v235
v_fma_f32 v210, v210, v236, v235
v_mfma_f32_16x16x32_bf16 v[184:187], v[52:55], a[88:91], v[184:187]
ds_read_b128 v[76:79], v7 offset:23552
v_mul_f32 v208, v208, v84
v_mfma_f32_16x16x32_bf16 v[188:191], v[48:51], a[76:79], v[188:191]
v_mul_f32 v210, v210, v85
v_mul_f32 v209, v84, v100
v_mfma_f32_16x16x32_bf16 v[188:191], v[52:55], a[92:95], v[188:191]
v_mul_f32 v211, v85, v101
s_waitcnt lgkmcnt(4)
v_mfma_f32_16x16x32_bf16 v[192:195], v[56:59], a[64:67], v[192:195]
v_exp_f32 v208, v208
v_mfma_f32_16x16x32_bf16 v[192:195], v[60:63], a[80:83], v[192:195]
v_exp_f32 v210, v210
v_mfma_f32_16x16x32_bf16 v[196:199], v[56:59], a[68:71], v[196:199]
ds_read_b128 v[48:51], v7 offset:24576
v_fma_f32 v208, v208, v237, v237
v_mfma_f32_16x16x32_bf16 v[196:199], v[60:63], a[84:87], v[196:199]
v_fma_f32 v210, v210, v237, v237
v_mul_f32 v212, v86, v86
v_mfma_f32_16x16x32_bf16 v[200:203], v[56:59], a[72:75], v[200:203]
v_rcp_f32 v208, v208
v_mfma_f32_16x16x32_bf16 v[200:203], v[60:63], a[88:91], v[200:203]
ds_read_b128 v[52:55], v7 offset:25600
v_mul_f32 v209, v209, v208
v_mfma_f32_16x16x32_bf16 v[204:207], v[56:59], a[76:79], v[204:207]
v_rcp_f32 v210, v210
v_mfma_f32_16x16x32_bf16 v[204:207], v[60:63], a[92:95], v[204:207]
v_mul_f32 v211, v211, v210
s_waitcnt lgkmcnt(4)
v_mfma_f32_16x16x32_bf16 v[176:179], v[64:67], a[96:99], v[176:179]
v_cvt_pk_bf16_f32 v226, v209, v211
v_mul_f32 v214, v87, v87
v_mfma_f32_16x16x32_bf16 v[176:179], v[68:71], a[112:115], v[176:179]
v_fma_f32 v212, v212, v236, v235
v_fma_f32 v214, v214, v236, v235
v_mfma_f32_16x16x32_bf16 v[180:183], v[64:67], a[100:103], v[180:183]
ds_read_b128 v[56:59], v7 offset:26624
v_mul_f32 v212, v212, v86
v_mfma_f32_16x16x32_bf16 v[180:183], v[68:71], a[116:119], v[180:183]
v_mul_f32 v214, v214, v87
v_mul_f32 v213, v86, v102
v_mfma_f32_16x16x32_bf16 v[184:187], v[64:67], a[104:107], v[184:187]
v_exp_f32 v212, v212
v_mfma_f32_16x16x32_bf16 v[184:187], v[68:71], a[120:123], v[184:187]
ds_read_b128 v[60:63], v7 offset:27648
v_mul_f32 v215, v87, v103
v_mfma_f32_16x16x32_bf16 v[188:191], v[64:67], a[108:111], v[188:191]
v_exp_f32 v214, v214
v_mfma_f32_16x16x32_bf16 v[188:191], v[68:71], a[124:127], v[188:191]
v_fma_f32 v212, v212, v237, v237
s_waitcnt lgkmcnt(4)
v_mfma_f32_16x16x32_bf16 v[192:195], v[72:75], a[96:99], v[192:195]
v_fma_f32 v214, v214, v237, v237
v_mul_f32 v208, v88, v88
v_mfma_f32_16x16x32_bf16 v[192:195], v[76:79], a[112:115], v[192:195]
v_rcp_f32 v212, v212
v_mfma_f32_16x16x32_bf16 v[196:199], v[72:75], a[100:103], v[196:199]
ds_read_b128 v[64:67], v7 offset:28672
v_mul_f32 v213, v213, v212
v_mfma_f32_16x16x32_bf16 v[196:199], v[76:79], a[116:119], v[196:199]
v_rcp_f32 v214, v214
v_mfma_f32_16x16x32_bf16 v[200:203], v[72:75], a[104:107], v[200:203]
v_mul_f32 v215, v215, v214
v_cvt_pk_bf16_f32 v227, v213, v215
v_mfma_f32_16x16x32_bf16 v[200:203], v[76:79], a[120:123], v[200:203]
ds_read_b128 v[68:71], v7 offset:29696
v_mul_f32 v210, v89, v89
v_mfma_f32_16x16x32_bf16 v[204:207], v[72:75], a[108:111], v[204:207]
buffer_store_dwordx2 v[226:227], v245, s[8:11], s30 offen sc1
v_mfma_f32_16x16x32_bf16 v[204:207], v[76:79], a[124:127], v[204:207]
v_fma_f32 v208, v208, v239, v238
s_waitcnt lgkmcnt(4)
v_mfma_f32_16x16x32_bf16 v[176:179], v[48:51], a[128:131], v[176:179]
v_fma_f32 v210, v210, v239, v238
v_mul_f32 v208, v208, v88
v_mfma_f32_16x16x32_bf16 v[176:179], v[52:55], a[144:147], v[176:179]
v_mul_f32 v210, v210, v89
v_mul_f32 v209, v88, v104
v_mfma_f32_16x16x32_bf16 v[180:183], v[48:51], a[132:135], v[180:183]
ds_read_b128 v[72:75], v7 offset:30720
v_mul_f32 v211, v89, v105
v_mfma_f32_16x16x32_bf16 v[180:183], v[52:55], a[148:151], v[180:183]
v_exp_f32 v208, v208
v_mfma_f32_16x16x32_bf16 v[184:187], v[48:51], a[136:139], v[184:187]
v_exp_f32 v210, v210
v_mfma_f32_16x16x32_bf16 v[184:187], v[52:55], a[152:155], v[184:187]
ds_read_b128 v[76:79], v7 offset:31744
v_fma_f32 v208, v208, v240, v240
v_mfma_f32_16x16x32_bf16 v[188:191], v[48:51], a[140:143], v[188:191]
v_fma_f32 v210, v210, v240, v240
v_mul_f32 v212, v90, v90
v_mfma_f32_16x16x32_bf16 v[188:191], v[52:55], a[156:159], v[188:191]
v_mul_f32 v214, v91, v91
s_waitcnt lgkmcnt(4)
v_mfma_f32_16x16x32_bf16 v[192:195], v[56:59], a[128:131], v[192:195]
s_waitcnt vmcnt(20)
v_fma_f32 v212, v212, v239, v238
v_mfma_f32_16x16x32_bf16 v[192:195], v[60:63], a[144:147], v[192:195]
s_barrier
v_mfma_f32_16x16x32_bf16 v[196:199], v[56:59], a[132:135], v[196:199]
ds_read_b128 v[48:51], v7 offset:32768
s_add_u32 m0, s22, 49152
v_mfma_f32_16x16x32_bf16 v[196:199], v[60:63], a[148:151], v[196:199]
v_add_u32 v3, 20480, v3
buffer_load_dwordx4 v3, s[8:11], 0 offen offset:0 sc1 lds
v_mfma_f32_16x16x32_bf16 v[200:203], v[56:59], a[136:139], v[200:203]
v_rcp_f32 v208, v208
v_mfma_f32_16x16x32_bf16 v[200:203], v[60:63], a[152:155], v[200:203]
ds_read_b128 v[52:55], v7 offset:33792
v_mul_f32 v209, v209, v208
v_mfma_f32_16x16x32_bf16 v[204:207], v[56:59], a[140:143], v[204:207]
v_rcp_f32 v210, v210
v_mfma_f32_16x16x32_bf16 v[204:207], v[60:63], a[156:159], v[204:207]
v_mul_f32 v211, v211, v210
s_waitcnt lgkmcnt(4)
v_mfma_f32_16x16x32_bf16 v[176:179], v[64:67], a[160:163], v[176:179]
buffer_load_dwordx4 v3, s[8:11], 0 offen offset:1024 sc1 lds
v_mfma_f32_16x16x32_bf16 v[176:179], v[68:71], a[176:179], v[176:179]
v_cvt_pk_bf16_f32 v228, v209, v211
v_fma_f32 v214, v214, v239, v238
v_mfma_f32_16x16x32_bf16 v[180:183], v[64:67], a[164:167], v[180:183]
ds_read_b128 v[56:59], v7 offset:34816
v_mul_f32 v212, v212, v90
v_mfma_f32_16x16x32_bf16 v[180:183], v[68:71], a[180:183], v[180:183]
v_mul_f32 v214, v214, v91
v_mul_f32 v213, v90, v106
v_mfma_f32_16x16x32_bf16 v[184:187], v[64:67], a[168:171], v[184:187]
buffer_load_dwordx4 v3, s[8:11], 0 offen offset:2048 sc1 lds
v_mfma_f32_16x16x32_bf16 v[184:187], v[68:71], a[184:187], v[184:187]
ds_read_b128 v[60:63], v7 offset:35840
v_mul_f32 v215, v91, v107
v_mfma_f32_16x16x32_bf16 v[188:191], v[64:67], a[172:175], v[188:191]
v_exp_f32 v212, v212
v_mfma_f32_16x16x32_bf16 v[188:191], v[68:71], a[188:191], v[188:191]
v_fma_f32 v212, v212, v240, v240
s_waitcnt lgkmcnt(4)
v_mfma_f32_16x16x32_bf16 v[192:195], v[72:75], a[160:163], v[192:195]
buffer_load_dwordx4 v3, s[8:11], 0 offen offset:3072 sc1 lds
v_mfma_f32_16x16x32_bf16 v[192:195], v[76:79], a[176:179], v[192:195]
s_add_u32 m0, s22, 53248
v_add_u32 v3, 4096, v3
v_mfma_f32_16x16x32_bf16 v[196:199], v[72:75], a[164:167], v[196:199]
ds_read_b128 v[64:67], v7 offset:36864
v_mul_f32 v208, v92, v92
v_mfma_f32_16x16x32_bf16 v[196:199], v[76:79], a[180:183], v[196:199]
v_exp_f32 v214, v214
v_mfma_f32_16x16x32_bf16 v[200:203], v[72:75], a[168:171], v[200:203]
buffer_load_dwordx4 v3, s[8:11], 0 offen offset:0 sc1 lds
v_mfma_f32_16x16x32_bf16 v[200:203], v[76:79], a[184:187], v[200:203]
ds_read_b128 v[68:71], v7 offset:37888
v_fma_f32 v214, v214, v240, v240
v_mfma_f32_16x16x32_bf16 v[204:207], v[72:75], a[172:175], v[204:207]
v_rcp_f32 v212, v212
v_mfma_f32_16x16x32_bf16 v[204:207], v[76:79], a[188:191], v[204:207]
v_mul_f32 v213, v213, v212
s_waitcnt lgkmcnt(4)
v_mfma_f32_16x16x32_bf16 v[176:179], v[48:51], a[192:195], v[176:179]
buffer_load_dwordx4 v3, s[8:11], 0 offen offset:1024 sc1 lds
v_mfma_f32_16x16x32_bf16 v[176:179], v[52:55], a[208:211], v[176:179]
v_rcp_f32 v214, v214
v_mfma_f32_16x16x32_bf16 v[180:183], v[48:51], a[196:199], v[180:183]
ds_read_b128 v[72:75], v7 offset:38912
v_mul_f32 v215, v215, v214
v_mfma_f32_16x16x32_bf16 v[180:183], v[52:55], a[212:215], v[180:183]
v_cvt_pk_bf16_f32 v229, v213, v215
v_mul_f32 v210, v93, v93
v_mfma_f32_16x16x32_bf16 v[184:187], v[48:51], a[200:203], v[184:187]
buffer_store_dwordx2 v[228:229], v246, s[8:11], s30 offen sc1
v_mfma_f32_16x16x32_bf16 v[184:187], v[52:55], a[216:219], v[184:187]
ds_read_b128 v[76:79], v7 offset:39936
v_fma_f32 v208, v208, v242, v241
v_mfma_f32_16x16x32_bf16 v[188:191], v[48:51], a[204:207], v[188:191]
v_fma_f32 v210, v210, v242, v241
v_mul_f32 v208, v208, v92
v_mfma_f32_16x16x32_bf16 v[188:191], v[52:55], a[220:223], v[188:191]
v_mul_f32 v210, v210, v93
s_waitcnt lgkmcnt(4)
v_mfma_f32_16x16x32_bf16 v[192:195], v[56:59], a[192:195], v[192:195]
v_exp_f32 v208, v208
v_mfma_f32_16x16x32_bf16 v[192:195], v[60:63], a[208:211], v[192:195]
v_exp_f32 v210, v210
v_mfma_f32_16x16x32_bf16 v[196:199], v[56:59], a[196:199], v[196:199]
ds_read_b128 v[48:51], v7 offset:40960
v_mul_f32 v209, v92, v108
v_mfma_f32_16x16x32_bf16 v[196:199], v[60:63], a[212:215], v[196:199]
v_mul_f32 v211, v93, v109
v_fma_f32 v208, v208, v243, v243
v_mfma_f32_16x16x32_bf16 v[200:203], v[56:59], a[200:203], v[200:203]
v_fma_f32 v210, v210, v243, v243
v_mul_f32 v212, v94, v94
v_mfma_f32_16x16x32_bf16 v[200:203], v[60:63], a[216:219], v[200:203]
ds_read_b128 v[52:55], v7 offset:41984
v_mul_f32 v214, v95, v95
v_mfma_f32_16x16x32_bf16 v[204:207], v[56:59], a[204:207], v[204:207]
v_rcp_f32 v208, v208
v_mfma_f32_16x16x32_bf16 v[204:207], v[60:63], a[220:223], v[204:207]
v_mul_f32 v209, v209, v208
s_waitcnt lgkmcnt(4)
v_mfma_f32_16x16x32_bf16 v[176:179], v[64:67], a[224:227], v[176:179]
v_rcp_f32 v210, v210
v_mfma_f32_16x16x32_bf16 v[176:179], v[68:71], a[240:243], v[176:179]
v_mul_f32 v211, v211, v210
v_cvt_pk_bf16_f32 v230, v209, v211
v_mfma_f32_16x16x32_bf16 v[180:183], v[64:67], a[228:231], v[180:183]
ds_read_b128 v[56:59], v7 offset:43008
v_fma_f32 v212, v212, v242, v241
v_mfma_f32_16x16x32_bf16 v[180:183], v[68:71], a[244:247], v[180:183]
v_fma_f32 v214, v214, v242, v241
v_mul_f32 v212, v212, v94
v_mfma_f32_16x16x32_bf16 v[184:187], v[64:67], a[232:235], v[184:187]
v_mul_f32 v214, v214, v95
v_mul_f32 v213, v94, v110
v_mfma_f32_16x16x32_bf16 v[184:187], v[68:71], a[248:251], v[184:187]
ds_read_b128 v[60:63], v7 offset:44032
v_mul_f32 v215, v95, v111
v_mfma_f32_16x16x32_bf16 v[188:191], v[64:67], a[236:239], v[188:191]
v_exp_f32 v212, v212
v_mfma_f32_16x16x32_bf16 v[188:191], v[68:71], a[252:255], v[188:191]
v_fma_f32 v212, v212, v243, v243
s_waitcnt lgkmcnt(4)
v_mfma_f32_16x16x32_bf16 v[192:195], v[72:75], a[224:227], v[192:195]
v_exp_f32 v214, v214
v_mfma_f32_16x16x32_bf16 v[192:195], v[76:79], a[240:243], v[192:195]
v_fma_f32 v214, v214, v243, v243
v_mul_f32 v208, v112, v112
v_mfma_f32_16x16x32_bf16 v[196:199], v[72:75], a[228:231], v[196:199]
ds_read_b128 v[64:67], v7 offset:45056
v_mul_f32 v210, v113, v113
v_mfma_f32_16x16x32_bf16 v[196:199], v[76:79], a[244:247], v[196:199]
v_rcp_f32 v212, v212
v_mfma_f32_16x16x32_bf16 v[200:203], v[72:75], a[232:235], v[200:203]
v_rcp_f32 v214, v214
v_mfma_f32_16x16x32_bf16 v[200:203], v[76:79], a[248:251], v[200:203]
ds_read_b128 v[68:71], v7 offset:46080
v_mul_f32 v213, v213, v212
v_mfma_f32_16x16x32_bf16 v[204:207], v[72:75], a[236:239], v[204:207]
v_mul_f32 v215, v215, v214
v_cvt_pk_bf16_f32 v231, v213, v215
v_mfma_f32_16x16x32_bf16 v[204:207], v[76:79], a[252:255], v[204:207]
v_fma_f32 v208, v208, v233, v232
s_waitcnt lgkmcnt(4)
v_mfma_f32_16x16x32_bf16 v[176:179], v[48:51], v[16:19], v[176:179]
buffer_store_dwordx2 v[230:231], v247, s[8:11], s30 offen sc1
v_mfma_f32_16x16x32_bf16 v[176:179], v[52:55], v[32:35], v[176:179]
v_fma_f32 v210, v210, v233, v232
v_mul_f32 v208, v208, v112
v_mfma_f32_16x16x32_bf16 v[180:183], v[48:51], v[20:23], v[180:183]
ds_read_b128 v[72:75], v7 offset:47104
v_mul_f32 v210, v210, v113
v_mfma_f32_16x16x32_bf16 v[180:183], v[52:55], v[36:39], v[180:183]
v_exp_f32 v208, v208
v_mfma_f32_16x16x32_bf16 v[184:187], v[48:51], v[24:27], v[184:187]
v_exp_f32 v210, v210
v_mfma_f32_16x16x32_bf16 v[184:187], v[52:55], v[40:43], v[184:187]
ds_read_b128 v[76:79], v7 offset:48128
v_mul_f32 v209, v112, v128
v_mfma_f32_16x16x32_bf16 v[188:191], v[48:51], v[28:31], v[188:191]
v_mul_f32 v211, v113, v129
v_fma_f32 v208, v208, v234, v234
v_mfma_f32_16x16x32_bf16 v[188:191], v[52:55], v[44:47], v[188:191]
v_fma_f32 v210, v210, v234, v234
s_waitcnt lgkmcnt(4)
v_mfma_f32_16x16x32_bf16 v[192:195], v[56:59], v[16:19], v[192:195]
v_rcp_f32 v208, v208
v_mfma_f32_16x16x32_bf16 v[192:195], v[60:63], v[32:35], v[192:195]
v_rcp_f32 v210, v210
v_mfma_f32_16x16x32_bf16 v[196:199], v[56:59], v[20:23], v[196:199]
ds_read_b128 v[48:51], v7 offset:49152
v_mul_f32 v209, v209, v208
v_mfma_f32_16x16x32_bf16 v[196:199], v[60:63], v[36:39], v[196:199]
v_mul_f32 v211, v211, v210
v_cvt_pk_bf16_f32 v144, v209, v211
v_mfma_f32_16x16x32_bf16 v[200:203], v[56:59], v[24:27], v[200:203]
v_mul_f32 v212, v114, v114
v_mul_f32 v214, v115, v115
v_mfma_f32_16x16x32_bf16 v[200:203], v[60:63], v[40:43], v[200:203]
ds_read_b128 v[52:55], v7 offset:50176
v_fma_f32 v212, v212, v233, v232
v_mfma_f32_16x16x32_bf16 v[204:207], v[56:59], v[28:31], v[204:207]
v_fma_f32 v214, v214, v233, v232
v_mul_f32 v212, v212, v114
v_mfma_f32_16x16x32_bf16 v[204:207], v[60:63], v[44:47], v[204:207]
v_mul_f32 v214, v214, v115
s_waitcnt lgkmcnt(4)
v_mfma_f32_16x16x32_bf16 v[80:83], v[64:67], a[0:3], 0
v_exp_f32 v212, v212
v_mfma_f32_16x16x32_bf16 v[80:83], v[68:71], a[16:19], v[80:83]
v_exp_f32 v214, v214
v_mfma_f32_16x16x32_bf16 v[84:87], v[64:67], a[4:7], 0
ds_read_b128 v[56:59], v7 offset:51200
v_mul_f32 v213, v114, v130
v_mfma_f32_16x16x32_bf16 v[84:87], v[68:71], a[20:23], v[84:87]
v_mul_f32 v215, v115, v131
v_fma_f32 v212, v212, v234, v234
v_mfma_f32_16x16x32_bf16 v[88:91], v[64:67], a[8:11], 0
v_fma_f32 v214, v214, v234, v234
v_mul_f32 v208, v116, v116
v_mfma_f32_16x16x32_bf16 v[88:91], v[68:71], a[24:27], v[88:91]
ds_read_b128 v[60:63], v7 offset:52224
v_mul_f32 v210, v117, v117
v_mfma_f32_16x16x32_bf16 v[92:95], v[64:67], a[12:15], 0
v_rcp_f32 v212, v212
v_mfma_f32_16x16x32_bf16 v[92:95], v[68:71], a[28:31], v[92:95]
v_mul_f32 v213, v213, v212
s_waitcnt lgkmcnt(4)
v_mfma_f32_16x16x32_bf16 v[96:99], v[72:75], a[0:3], 0
v_rcp_f32 v214, v214
v_mfma_f32_16x16x32_bf16 v[96:99], v[76:79], a[16:19], v[96:99]
v_mul_f32 v215, v215, v214
v_cvt_pk_bf16_f32 v145, v213, v215
v_mfma_f32_16x16x32_bf16 v[100:103], v[72:75], a[4:7], 0
ds_read_b128 v[64:67], v7 offset:53248
v_fma_f32 v208, v208, v236, v235
v_mfma_f32_16x16x32_bf16 v[100:103], v[76:79], a[20:23], v[100:103]
v_fma_f32 v210, v210, v236, v235
v_mul_f32 v208, v208, v116
v_mfma_f32_16x16x32_bf16 v[104:107], v[72:75], a[8:11], 0
v_mul_f32 v210, v210, v117
v_mul_f32 v209, v116, v132
v_mfma_f32_16x16x32_bf16 v[104:107], v[76:79], a[24:27], v[104:107]
ds_read_b128 v[68:71], v7 offset:54272
v_mul_f32 v211, v117, v133
v_mfma_f32_16x16x32_bf16 v[108:111], v[72:75], a[12:15], 0
v_exp_f32 v208, v208
v_mfma_f32_16x16x32_bf16 v[108:111], v[76:79], a[28:31], v[108:111]
v_fma_f32 v208, v208, v237, v237
s_waitcnt lgkmcnt(4)
v_mfma_f32_16x16x32_bf16 v[80:83], v[48:51], a[32:35], v[80:83]
v_exp_f32 v210, v210
v_mfma_f32_16x16x32_bf16 v[80:83], v[52:55], a[48:51], v[80:83]
v_fma_f32 v210, v210, v237, v237
v_mul_f32 v212, v118, v118
v_mfma_f32_16x16x32_bf16 v[84:87], v[48:51], a[36:39], v[84:87]
ds_read_b128 v[72:75], v7 offset:55296
v_mul_f32 v214, v119, v119
v_mfma_f32_16x16x32_bf16 v[84:87], v[52:55], a[52:55], v[84:87]
v_rcp_f32 v208, v208
v_mfma_f32_16x16x32_bf16 v[88:91], v[48:51], a[40:43], v[88:91]
v_rcp_f32 v210, v210
v_mfma_f32_16x16x32_bf16 v[88:91], v[52:55], a[56:59], v[88:91]
ds_read_b128 v[76:79], v7 offset:56320
v_mul_f32 v209, v209, v208
v_mfma_f32_16x16x32_bf16 v[92:95], v[48:51], a[44:47], v[92:95]
v_mul_f32 v211, v211, v210
v_cvt_pk_bf16_f32 v148, v209, v211
v_mfma_f32_16x16x32_bf16 v[92:95], v[52:55], a[60:63], v[92:95]
v_fma_f32 v212, v212, v236, v235
s_waitcnt lgkmcnt(4)
v_mfma_f32_16x16x32_bf16 v[96:99], v[56:59], a[32:35], v[96:99]
s_waitcnt vmcnt(22)
v_fma_f32 v214, v214, v236, v235
v_mfma_f32_16x16x32_bf16 v[96:99], v[60:63], a[48:51], v[96:99]
s_barrier
v_mfma_f32_16x16x32_bf16 v[100:103], v[56:59], a[36:39], v[100:103]
ds_read_b128 v[48:51], v7 offset:57344
s_add_u32 m0, s22, 73728
v_mfma_f32_16x16x32_bf16 v[100:103], v[60:63], a[52:55], v[100:103]
v_add_u32 v3, 20480, v3
buffer_load_dwordx4 v3, s[8:11], 0 offen offset:0 sc1 lds
v_mfma_f32_16x16x32_bf16 v[104:107], v[56:59], a[40:43], v[104:107]
v_mul_f32 v212, v212, v118
v_mul_f32 v214, v214, v119
v_mfma_f32_16x16x32_bf16 v[104:107], v[60:63], a[56:59], v[104:107]
ds_read_b128 v[52:55], v7 offset:58368
v_mul_f32 v213, v118, v134
v_mfma_f32_16x16x32_bf16 v[108:111], v[56:59], a[44:47], v[108:111]
v_exp_f32 v212, v212
v_mfma_f32_16x16x32_bf16 v[108:111], v[60:63], a[60:63], v[108:111]
v_mul_f32 v215, v119, v135
s_waitcnt lgkmcnt(4)
v_mfma_f32_16x16x32_bf16 v[80:83], v[64:67], a[64:67], v[80:83]
buffer_load_dwordx4 v3, s[8:11], 0 offen offset:1024 sc1 lds
v_mfma_f32_16x16x32_bf16 v[80:83], v[68:71], a[80:83], v[80:83]
v_exp_f32 v214, v214
v_mfma_f32_16x16x32_bf16 v[84:87], v[64:67], a[68:71], v[84:87]
ds_read_b128 v[56:59], v7 offset:59392
v_fma_f32 v212, v212, v237, v237
v_mfma_f32_16x16x32_bf16 v[84:87], v[68:71], a[84:87], v[84:87]
v_fma_f32 v214, v214, v237, v237
v_mul_f32 v208, v120, v120
v_mfma_f32_16x16x32_bf16 v[88:91], v[64:67], a[72:75], v[88:91]
buffer_load_dwordx4 v3, s[8:11], 0 offen offset:2048 sc1 lds
v_mfma_f32_16x16x32_bf16 v[88:91], v[68:71], a[88:91], v[88:91]
ds_read_b128 v[60:63], v7 offset:60416
v_mul_f32 v210, v121, v121
v_mfma_f32_16x16x32_bf16 v[92:95], v[64:67], a[76:79], v[92:95]
v_rcp_f32 v212, v212
v_mfma_f32_16x16x32_bf16 v[92:95], v[68:71], a[92:95], v[92:95]
v_mul_f32 v213, v213, v212
s_waitcnt lgkmcnt(4)
v_mfma_f32_16x16x32_bf16 v[96:99], v[72:75], a[64:67], v[96:99]
buffer_load_dwordx4 v3, s[8:11], 0 offen offset:3072 sc1 lds
v_mfma_f32_16x16x32_bf16 v[96:99], v[76:79], a[80:83], v[96:99]
s_add_u32 m0, s22, 77824
v_add_u32 v3, 4096, v3
v_mfma_f32_16x16x32_bf16 v[100:103], v[72:75], a[68:71], v[100:103]
ds_read_b128 v[64:67], v7 offset:61440
v_fma_f32 v208, v208, v239, v238
v_mfma_f32_16x16x32_bf16 v[100:103], v[76:79], a[84:87], v[100:103]
v_rcp_f32 v214, v214
v_mfma_f32_16x16x32_bf16 v[104:107], v[72:75], a[72:75], v[104:107]
buffer_load_dwordx4 v3, s[8:11], 0 offen offset:0 sc1 lds
v_mfma_f32_16x16x32_bf16 v[104:107], v[76:79], a[88:91], v[104:107]
ds_read_b128 v[68:71], v7 offset:62464
v_mul_f32 v215, v215, v214
v_mfma_f32_16x16x32_bf16 v[108:111], v[72:75], a[76:79], v[108:111]
v_cvt_pk_bf16_f32 v149, v213, v215
v_fma_f32 v210, v210, v239, v238
v_mfma_f32_16x16x32_bf16 v[108:111], v[76:79], a[92:95], v[108:111]
v_mul_f32 v208, v208, v120
s_waitcnt lgkmcnt(4)
v_mfma_f32_16x16x32_bf16 v[80:83], v[48:51], a[96:99], v[80:83]
buffer_load_dwordx4 v3, s[8:11], 0 offen offset:1024 sc1 lds
v_mfma_f32_16x16x32_bf16 v[80:83], v[52:55], a[112:115], v[80:83]
v_mul_f32 v210, v210, v121
v_mul_f32 v209, v120, v136
v_mfma_f32_16x16x32_bf16 v[84:87], v[48:51], a[100:103], v[84:87]
ds_read_b128 v[72:75], v7 offset:63488
v_mul_f32 v211, v121, v137
v_mfma_f32_16x16x32_bf16 v[84:87], v[52:55], a[116:119], v[84:87]
v_exp_f32 v208, v208
v_mfma_f32_16x16x32_bf16 v[88:91], v[48:51], a[104:107], v[88:91]
v_exp_f32 v210, v210
v_mfma_f32_16x16x32_bf16 v[88:91], v[52:55], a[120:123], v[88:91]
ds_read_b128 v[76:79], v7 offset:64512
v_fma_f32 v208, v208, v240, v240
v_mfma_f32_16x16x32_bf16 v[92:95], v[48:51], a[108:111], v[92:95]
v_fma_f32 v210, v210, v240, v240
v_mul_f32 v212, v122, v122
v_mfma_f32_16x16x32_bf16 v[92:95], v[52:55], a[124:127], v[92:95]
v_mul_f32 v214, v123, v123
s_waitcnt lgkmcnt(4)
v_mfma_f32_16x16x32_bf16 v[96:99], v[56:59], a[96:99], v[96:99]
v_rcp_f32 v208, v208
v_mfma_f32_16x16x32_bf16 v[96:99], v[60:63], a[112:115], v[96:99]
v_rcp_f32 v210, v210
v_mfma_f32_16x16x32_bf16 v[100:103], v[56:59], a[100:103], v[100:103]
ds_read_b128 v[48:51], v8 offset:0
v_mul_f32 v209, v209, v208
v_mfma_f32_16x16x32_bf16 v[100:103], v[60:63], a[116:119], v[100:103]
v_mul_f32 v211, v211, v210
v_cvt_pk_bf16_f32 v152, v209, v211
v_mfma_f32_16x16x32_bf16 v[104:107], v[56:59], a[104:107], v[104:107]
v_fma_f32 v212, v212, v239, v238
v_fma_f32 v214, v214, v239, v238
v_mfma_f32_16x16x32_bf16 v[104:107], v[60:63], a[120:123], v[104:107]
ds_read_b128 v[52:55], v8 offset:1024
v_mul_f32 v212, v212, v122
v_mfma_f32_16x16x32_bf16 v[108:111], v[56:59], a[108:111], v[108:111]
v_mul_f32 v214, v214, v123
v_mul_f32 v213, v122, v138
v_mfma_f32_16x16x32_bf16 v[108:111], v[60:63], a[124:127], v[108:111]
v_mul_f32 v215, v123, v139
s_waitcnt lgkmcnt(4)
v_mfma_f32_16x16x32_bf16 v[80:83], v[64:67], a[128:131], v[80:83]
v_exp_f32 v212, v212
v_mfma_f32_16x16x32_bf16 v[80:83], v[68:71], a[144:147], v[80:83]
v_exp_f32 v214, v214
v_mfma_f32_16x16x32_bf16 v[84:87], v[64:67], a[132:135], v[84:87]
ds_read_b128 v[56:59], v8 offset:2048
v_fma_f32 v212, v212, v240, v240
v_mfma_f32_16x16x32_bf16 v[84:87], v[68:71], a[148:151], v[84:87]
v_fma_f32 v214, v214, v240, v240
v_mul_f32 v208, v124, v124
v_mfma_f32_16x16x32_bf16 v[88:91], v[64:67], a[136:139], v[88:91]
v_rcp_f32 v212, v212
v_mfma_f32_16x16x32_bf16 v[88:91], v[68:71], a[152:155], v[88:91]
ds_read_b128 v[60:63], v8 offset:3072
v_mul_f32 v213, v213, v212
v_mfma_f32_16x16x32_bf16 v[92:95], v[64:67], a[140:143], v[92:95]
v_rcp_f32 v214, v214
v_mfma_f32_16x16x32_bf16 v[92:95], v[68:71], a[156:159], v[92:95]
v_mul_f32 v215, v215, v214
s_waitcnt lgkmcnt(4)
v_mfma_f32_16x16x32_bf16 v[96:99], v[72:75], a[128:131], v[96:99]
v_cvt_pk_bf16_f32 v153, v213, v215
v_mul_f32 v210, v125, v125
v_mfma_f32_16x16x32_bf16 v[96:99], v[76:79], a[144:147], v[96:99]
v_fma_f32 v208, v208, v242, v241
v_fma_f32 v210, v210, v242, v241
v_mfma_f32_16x16x32_bf16 v[100:103], v[72:75], a[132:135], v[100:103]
ds_read_b128 v[64:67], v8 offset:4096
v_mul_f32 v208, v208, v124
v_mfma_f32_16x16x32_bf16 v[100:103], v[76:79], a[148:151], v[100:103]
v_mul_f32 v210, v210, v125
v_mul_f32 v209, v124, v140
v_mfma_f32_16x16x32_bf16 v[104:107], v[72:75], a[136:139], v[104:107]
v_exp_f32 v208, v208
v_mfma_f32_16x16x32_bf16 v[104:107], v[76:79], a[152:155], v[104:107]
ds_read_b128 v[68:71], v8 offset:5120
v_mul_f32 v211, v125, v141
v_mfma_f32_16x16x32_bf16 v[108:111], v[72:75], a[140:143], v[108:111]
v_exp_f32 v210, v210
v_mfma_f32_16x16x32_bf16 v[108:111], v[76:79], a[156:159], v[108:111]
v_fma_f32 v208, v208, v243, v243
s_waitcnt lgkmcnt(4)
v_mfma_f32_16x16x32_bf16 v[80:83], v[48:51], a[160:163], v[80:83]
v_fma_f32 v210, v210, v243, v243
v_mul_f32 v212, v126, v126
v_mfma_f32_16x16x32_bf16 v[80:83], v[52:55], a[176:179], v[80:83]
v_rcp_f32 v208, v208
v_mfma_f32_16x16x32_bf16 v[84:87], v[48:51], a[164:167], v[84:87]
ds_read_b128 v[72:75], v8 offset:6144
v_mul_f32 v209, v209, v208
v_mfma_f32_16x16x32_bf16 v[84:87], v[52:55], a[180:183], v[84:87]
v_rcp_f32 v210, v210
v_mfma_f32_16x16x32_bf16 v[88:91], v[48:51], a[168:171], v[88:91]
v_mul_f32 v211, v211, v210
v_cvt_pk_bf16_f32 v156, v209, v211
v_mfma_f32_16x16x32_bf16 v[88:91], v[52:55], a[184:187], v[88:91]
ds_read_b128 v[76:79], v8 offset:7168
v_mul_f32 v214, v127, v127
v_mfma_f32_16x16x32_bf16 v[92:95], v[48:51], a[172:175], v[92:95]
v_fma_f32 v212, v212, v242, v241
v_fma_f32 v214, v214, v242, v241
v_mfma_f32_16x16x32_bf16 v[92:95], v[52:55], a[188:191], v[92:95]
v_mul_f32 v212, v212, v126
s_waitcnt lgkmcnt(4)
v_mfma_f32_16x16x32_bf16 v[96:99], v[56:59], a[160:163], v[96:99]
v_mul_f32 v214, v214, v127
v_mul_f32 v213, v126, v142
v_mfma_f32_16x16x32_bf16 v[96:99], v[60:63], a[176:179], v[96:99]
v_exp_f32 v212, v212
v_mfma_f32_16x16x32_bf16 v[100:103], v[56:59], a[164:167], v[100:103]
ds_read_b128 v[48:51], v8 offset:8192
v_mul_f32 v215, v127, v143
v_mfma_f32_16x16x32_bf16 v[100:103], v[60:63], a[180:183], v[100:103]
v_exp_f32 v214, v214
v_mfma_f32_16x16x32_bf16 v[104:107], v[56:59], a[168:171], v[104:107]
v_fma_f32 v212, v212, v243, v243
v_fma_f32 v214, v214, v243, v243
v_mfma_f32_16x16x32_bf16 v[104:107], v[60:63], a[184:187], v[104:107]
ds_read_b128 v[52:55], v8 offset:9216
v_mul_f32 v216, v176, v176
v_mfma_f32_16x16x32_bf16 v[108:111], v[56:59], a[172:175], v[108:111]
v_rcp_f32 v212, v212
v_mfma_f32_16x16x32_bf16 v[108:111], v[60:63], a[188:191], v[108:111]
v_mul_f32 v213, v213, v212
s_waitcnt lgkmcnt(4)
v_mfma_f32_16x16x32_bf16 v[80:83], v[64:67], a[192:195], v[80:83]
v_rcp_f32 v214, v214
v_mfma_f32_16x16x32_bf16 v[80:83], v[68:71], a[208:211], v[80:83]
v_mul_f32 v215, v215, v214
v_cvt_pk_bf16_f32 v157, v213, v215
v_mfma_f32_16x16x32_bf16 v[84:87], v[64:67], a[196:199], v[84:87]
ds_read_b128 v[56:59], v8 offset:10240
v_mul_f32 v218, v177, v177
v_mfma_f32_16x16x32_bf16 v[84:87], v[68:71], a[212:215], v[84:87]
v_fma_f32 v216, v216, v233, v232
v_fma_f32 v218, v218, v233, v232
v_mfma_f32_16x16x32_bf16 v[88:91], v[64:67], a[200:203], v[88:91]
v_mul_f32 v216, v216, v176
v_mul_f32 v218, v218, v177
v_mfma_f32_16x16x32_bf16 v[88:91], v[68:71], a[216:219], v[88:91]
ds_read_b128 v[60:63], v8 offset:11264
v_mul_f32 v217, v176, v192
v_mfma_f32_16x16x32_bf16 v[92:95], v[64:67], a[204:207], v[92:95]
v_exp_f32 v216, v216
v_mfma_f32_16x16x32_bf16 v[92:95], v[68:71], a[220:223], v[92:95]
v_mul_f32 v219, v177, v193
s_waitcnt lgkmcnt(4)
v_mfma_f32_16x16x32_bf16 v[96:99], v[72:75], a[192:195], v[96:99]
v_exp_f32 v218, v218
v_mfma_f32_16x16x32_bf16 v[96:99], v[76:79], a[208:211], v[96:99]
v_fma_f32 v216, v216, v234, v234
v_fma_f32 v218, v218, v234, v234
v_mfma_f32_16x16x32_bf16 v[100:103], v[72:75], a[196:199], v[100:103]
ds_read_b128 v[64:67], v8 offset:12288
v_mul_f32 v220, v178, v178
v_mfma_f32_16x16x32_bf16 v[100:103], v[76:79], a[212:215], v[100:103]
v_rcp_f32 v216, v216
v_mfma_f32_16x16x32_bf16 v[104:107], v[72:75], a[200:203], v[104:107]
v_rcp_f32 v218, v218
v_mfma_f32_16x16x32_bf16 v[104:107], v[76:79], a[216:219], v[104:107]
ds_read_b128 v[68:71], v8 offset:13312
v_mul_f32 v217, v217, v216
v_mfma_f32_16x16x32_bf16 v[108:111], v[72:75], a[204:207], v[108:111]
v_mul_f32 v219, v219, v218
v_cvt_pk_bf16_f32 v146, v217, v219
v_mfma_f32_16x16x32_bf16 v[108:111], v[76:79], a[220:223], v[108:111]
v_mul_f32 v222, v179, v179
s_waitcnt lgkmcnt(4)
v_mfma_f32_16x16x32_bf16 v[80:83], v[48:51], a[224:227], v[80:83]
v_fma_f32 v220, v220, v233, v232
v_fma_f32 v222, v222, v233, v232
v_mfma_f32_16x16x32_bf16 v[80:83], v[52:55], a[240:243], v[80:83]
v_mul_f32 v220, v220, v178
v_mul_f32 v222, v222, v179
v_mfma_f32_16x16x32_bf16 v[84:87], v[48:51], a[228:231], v[84:87]
ds_read_b128 v[72:75], v8 offset:14336
v_mul_f32 v221, v178, v194
v_mfma_f32_16x16x32_bf16 v[84:87], v[52:55], a[244:247], v[84:87]
v_exp_f32 v220, v220
v_mfma_f32_16x16x32_bf16 v[88:91], v[48:51], a[232:235], v[88:91]
v_exp_f32 v222, v222
v_mfma_f32_16x16x32_bf16 v[88:91], v[52:55], a[248:251], v[88:91]
ds_read_b128 v[76:79], v8 offset:15360
v_mul_f32 v223, v179, v195
v_mfma_f32_16x16x32_bf16 v[92:95], v[48:51], a[236:239], v[92:95]
v_fma_f32 v220, v220, v234, v234
v_fma_f32 v222, v222, v234, v234
v_mfma_f32_16x16x32_bf16 v[92:95], v[52:55], a[252:255], v[92:95]
v_mul_f32 v216, v180, v180
s_waitcnt lgkmcnt(4)
v_mfma_f32_16x16x32_bf16 v[96:99], v[56:59], a[224:227], v[96:99]
s_waitcnt vmcnt(22)
v_mul_f32 v218, v181, v181
v_mfma_f32_16x16x32_bf16 v[96:99], v[60:63], a[240:243], v[96:99]
s_barrier
v_mfma_f32_16x16x32_bf16 v[100:103], v[56:59], a[228:231], v[100:103]
ds_read_b128 v[48:51], v2 offset:0
s_add_u32 m0, s22, 98304
v_mfma_f32_16x16x32_bf16 v[100:103], v[60:63], a[244:247], v[100:103]
v_add_u32 v3, 20480, v3
buffer_load_dwordx4 v3, s[8:11], 0 offen offset:0 sc1 lds
v_mfma_f32_16x16x32_bf16 v[104:107], v[56:59], a[232:235], v[104:107]
v_rcp_f32 v220, v220
v_mfma_f32_16x16x32_bf16 v[104:107], v[60:63], a[248:251], v[104:107]
ds_read_b128 v[52:55], v2 offset:1024
v_mul_f32 v221, v221, v220
v_mfma_f32_16x16x32_bf16 v[108:111], v[56:59], a[236:239], v[108:111]
v_rcp_f32 v222, v222
v_mfma_f32_16x16x32_bf16 v[108:111], v[60:63], a[252:255], v[108:111]
v_mul_f32 v223, v223, v222
s_waitcnt lgkmcnt(4)
v_mfma_f32_16x16x32_bf16 v[80:83], v[64:67], v[16:19], v[80:83]
buffer_load_dwordx4 v3, s[8:11], 0 offen offset:1024 sc1 lds
v_mfma_f32_16x16x32_bf16 v[80:83], v[68:71], v[32:35], v[80:83]
v_cvt_pk_bf16_f32 v147, v221, v223
v_fma_f32 v216, v216, v236, v235
v_mfma_f32_16x16x32_bf16 v[84:87], v[64:67], v[20:23], v[84:87]
ds_read_b128 v[56:59], v2 offset:2048
v_fma_f32 v218, v218, v236, v235
v_mfma_f32_16x16x32_bf16 v[84:87], v[68:71], v[36:39], v[84:87]
buffer_store_dwordx4 v[144:147], v2, s[8:11], s24 offen offset:0 sc1
v_mfma_f32_16x16x32_bf16 v[88:91], v[64:67], v[24:27], v[88:91]
v_mul_f32 v216, v216, v180
v_mul_f32 v218, v218, v181
v_mfma_f32_16x16x32_bf16 v[88:91], v[68:71], v[40:43], v[88:91]
ds_read_b128 v[60:63], v2 offset:3072
v_mul_f32 v217, v180, v196
v_mfma_f32_16x16x32_bf16 v[92:95], v[64:67], v[28:31], v[92:95]
v_exp_f32 v216, v216
v_mfma_f32_16x16x32_bf16 v[92:95], v[68:71], v[44:47], v[92:95]
v_mul_f32 v219, v181, v197
s_waitcnt lgkmcnt(4)
v_mfma_f32_16x16x32_bf16 v[96:99], v[72:75], v[16:19], v[96:99]
buffer_load_dwordx4 v3, s[8:11], 0 offen offset:2048 sc1 lds
v_mfma_f32_16x16x32_bf16 v[96:99], v[76:79], v[32:35], v[96:99]
v_exp_f32 v218, v218
v_mfma_f32_16x16x32_bf16 v[100:103], v[72:75], v[20:23], v[100:103]
ds_read_b128 v[64:67], v2 offset:4096
v_fma_f32 v216, v216, v237, v237
v_mfma_f32_16x16x32_bf16 v[100:103], v[76:79], v[36:39], v[100:103]
v_fma_f32 v218, v218, v237, v237
v_mul_f32 v220, v182, v182
v_mfma_f32_16x16x32_bf16 v[104:107], v[72:75], v[24:27], v[104:107]
buffer_load_dwordx4 v3, s[8:11], 0 offen offset:3072 sc1 lds
v_mfma_f32_16x16x32_bf16 v[104:107], v[76:79], v[40:43], v[104:107]
ds_read_b128 v[68:71], v2 offset:5120
s_add_u32 m0, s22, 102400
v_mfma_f32_16x16x32_bf16 v[108:111], v[72:75], v[28:31], v[108:111]
v_add_u32 v3, 4096, v3
v_mul_f32 v222, v183, v183
v_mfma_f32_16x16x32_bf16 v[108:111], v[76:79], v[44:47], v[108:111]
v_fma_f32 v220, v220, v236, v235
s_waitcnt lgkmcnt(4)
v_mfma_f32_16x16x32_bf16 v[112:115], v[48:51], a[0:3], 0
buffer_load_dwordx4 v3, s[8:11], 0 offen offset:0 sc1 lds
v_mfma_f32_16x16x32_bf16 v[112:115], v[52:55], a[16:19], v[112:115]
v_rcp_f32 v216, v216
v_mfma_f32_16x16x32_bf16 v[116:119], v[48:51], a[4:7], 0
ds_read_b128 v[72:75], v2 offset:6144
v_mul_f32 v217, v217, v216
v_mfma_f32_16x16x32_bf16 v[116:119], v[52:55], a[20:23], v[116:119]
v_mul_f32 v208, v80, v80
v_mul_f32 v210, v81, v81
v_mfma_f32_16x16x32_bf16 v[120:123], v[48:51], a[8:11], 0
buffer_load_dwordx4 v3, s[8:11], 0 offen offset:1024 sc1 lds
v_mfma_f32_16x16x32_bf16 v[120:123], v[52:55], a[24:27], v[120:123]
ds_read_b128 v[76:79], v2 offset:7168
v_fma_f32 v208, v208, v233, v232
v_mfma_f32_16x16x32_bf16 v[124:127], v[48:51], a[12:15], 0
v_fma_f32 v210, v210, v233, v232
v_mul_f32 v208, v208, v80
v_mfma_f32_16x16x32_bf16 v[124:127], v[52:55], a[28:31], v[124:127]
v_mul_f32 v210, v210, v81
s_waitcnt lgkmcnt(4)
v_mfma_f32_16x16x32_bf16 v[128:131], v[56:59], a[0:3], 0
v_exp_f32 v208, v208
v_mfma_f32_16x16x32_bf16 v[128:131], v[60:63], a[16:19], v[128:131]
v_exp_f32 v210, v210
v_mfma_f32_16x16x32_bf16 v[132:135], v[56:59], a[4:7], 0
ds_read_b128 v[48:51], v2 offset:8192
v_mul_f32 v209, v80, v96
v_mfma_f32_16x16x32_bf16 v[132:135], v[60:63], a[20:23], v[132:135]
v_mul_f32 v211, v81, v97
v_fma_f32 v208, v208, v234, v234
v_mfma_f32_16x16x32_bf16 v[136:139], v[56:59], a[8:11], 0
v_fma_f32 v210, v210, v234, v234
v_mul_f32 v212, v82, v82
v_mfma_f32_16x16x32_bf16 v[136:139], v[60:63], a[24:27], v[136:139]
ds_read_b128 v[52:55], v2 offset:9216
v_mul_f32 v214, v83, v83
v_mfma_f32_16x16x32_bf16 v[140:143], v[56:59], a[12:15], 0
v_rcp_f32 v208, v208
v_mfma_f32_16x16x32_bf16 v[140:143], v[60:63], a[28:31], v[140:143]
v_mul_f32 v209, v209, v208
s_waitcnt lgkmcnt(4)
v_mfma_f32_16x16x32_bf16 v[112:115], v[64:67], a[32:35], v[112:115]
v_rcp_f32 v210, v210
v_mfma_f32_16x16x32_bf16 v[112:115], v[68:71], a[48:51], v[112:115]
v_mul_f32 v211, v211, v210
v_cvt_pk_bf16_f32 v160, v209, v211
v_mfma_f32_16x16x32_bf16 v[116:119], v[64:67], a[36:39], v[116:119]
ds_read_b128 v[56:59], v2 offset:10240
v_fma_f32 v212, v212, v233, v232
v_mfma_f32_16x16x32_bf16 v[116:119], v[68:71], a[52:55], v[116:119]
v_fma_f32 v214, v214, v233, v232
v_mul_f32 v212, v212, v82
v_mfma_f32_16x16x32_bf16 v[120:123], v[64:67], a[40:43], v[120:123]
v_mul_f32 v214, v214, v83
v_mul_f32 v213, v82, v98
v_mfma_f32_16x16x32_bf16 v[120:123], v[68:71], a[56:59], v[120:123]
ds_read_b128 v[60:63], v2 offset:11264
v_mul_f32 v215, v83, v99
v_mfma_f32_16x16x32_bf16 v[124:127], v[64:67], a[44:47], v[124:127]
v_exp_f32 v212, v212
v_mfma_f32_16x16x32_bf16 v[124:127], v[68:71], a[60:63], v[124:127]
v_fma_f32 v212, v212, v234, v234
s_waitcnt lgkmcnt(4)
v_mfma_f32_16x16x32_bf16 v[128:131], v[72:75], a[32:35], v[128:131]
v_exp_f32 v214, v214
v_mfma_f32_16x16x32_bf16 v[128:131], v[76:79], a[48:51], v[128:131]
v_fma_f32 v214, v214, v234, v234
v_mul_f32 v208, v84, v84
v_mfma_f32_16x16x32_bf16 v[132:135], v[72:75], a[36:39], v[132:135]
ds_read_b128 v[64:67], v2 offset:12288
v_mul_f32 v210, v85, v85
v_mfma_f32_16x16x32_bf16 v[132:135], v[76:79], a[52:55], v[132:135]
v_rcp_f32 v212, v212
v_mfma_f32_16x16x32_bf16 v[136:139], v[72:75], a[40:43], v[136:139]
v_rcp_f32 v214, v214
v_mfma_f32_16x16x32_bf16 v[136:139], v[76:79], a[56:59], v[136:139]
ds_read_b128 v[68:71], v2 offset:13312
v_mul_f32 v213, v213, v212
v_mfma_f32_16x16x32_bf16 v[140:143], v[72:75], a[44:47], v[140:143]
v_mul_f32 v215, v215, v214
v_cvt_pk_bf16_f32 v161, v213, v215
v_mfma_f32_16x16x32_bf16 v[140:143], v[76:79], a[60:63], v[140:143]
v_fma_f32 v208, v208, v236, v235
s_waitcnt lgkmcnt(4)
v_mfma_f32_16x16x32_bf16 v[112:115], v[48:51], a[64:67], v[112:115]
v_fma_f32 v210, v210, v236, v235
v_mul_f32 v208, v208, v84
v_mfma_f32_16x16x32_bf16 v[112:115], v[52:55], a[80:83], v[112:115]
v_mul_f32 v210, v210, v85
v_mul_f32 v209, v84, v100
v_mfma_f32_16x16x32_bf16 v[116:119], v[48:51], a[68:71], v[116:119]
ds_read_b128 v[72:75], v2 offset:14336
v_mul_f32 v211, v85, v101
v_mfma_f32_16x16x32_bf16 v[116:119], v[52:55], a[84:87], v[116:119]
v_exp_f32 v208, v208
v_mfma_f32_16x16x32_bf16 v[120:123], v[48:51], a[72:75], v[120:123]
v_exp_f32 v210, v210
v_mfma_f32_16x16x32_bf16 v[120:123], v[52:55], a[88:91], v[120:123]
ds_read_b128 v[76:79], v2 offset:15360
v_fma_f32 v208, v208, v237, v237
v_mfma_f32_16x16x32_bf16 v[124:127], v[48:51], a[76:79], v[124:127]
v_fma_f32 v210, v210, v237, v237
v_mul_f32 v212, v86, v86
v_mfma_f32_16x16x32_bf16 v[124:127], v[52:55], a[92:95], v[124:127]
v_mul_f32 v214, v87, v87
s_waitcnt lgkmcnt(4)
v_mfma_f32_16x16x32_bf16 v[128:131], v[56:59], a[64:67], v[128:131]
v_rcp_f32 v208, v208
v_mfma_f32_16x16x32_bf16 v[128:131], v[60:63], a[80:83], v[128:131]
v_rcp_f32 v210, v210
v_mfma_f32_16x16x32_bf16 v[132:135], v[56:59], a[68:71], v[132:135]
ds_read_b128 v[48:51], v2 offset:16384
v_mul_f32 v209, v209, v208
v_mfma_f32_16x16x32_bf16 v[132:135], v[60:63], a[84:87], v[132:135]
v_mul_f32 v211, v211, v210
v_cvt_pk_bf16_f32 v164, v209, v211
v_mfma_f32_16x16x32_bf16 v[136:139], v[56:59], a[72:75], v[136:139]
v_fma_f32 v212, v212, v236, v235
v_fma_f32 v214, v214, v236, v235
v_mfma_f32_16x16x32_bf16 v[136:139], v[60:63], a[88:91], v[136:139]
ds_read_b128 v[52:55], v2 offset:17408
v_mul_f32 v212, v212, v86
v_mfma_f32_16x16x32_bf16 v[140:143], v[56:59], a[76:79], v[140:143]
v_mul_f32 v214, v214, v87
v_mul_f32 v213, v86, v102
v_mfma_f32_16x16x32_bf16 v[140:143], v[60:63], a[92:95], v[140:143]
v_mul_f32 v215, v87, v103
s_waitcnt lgkmcnt(4)
v_mfma_f32_16x16x32_bf16 v[112:115], v[64:67], a[96:99], v[112:115]
v_exp_f32 v212, v212
v_mfma_f32_16x16x32_bf16 v[112:115], v[68:71], a[112:115], v[112:115]
v_exp_f32 v214, v214
v_mfma_f32_16x16x32_bf16 v[116:119], v[64:67], a[100:103], v[116:119]
ds_read_b128 v[56:59], v2 offset:18432
v_fma_f32 v212, v212, v237, v237
v_mfma_f32_16x16x32_bf16 v[116:119], v[68:71], a[116:119], v[116:119]
v_fma_f32 v214, v214, v237, v237
v_mul_f32 v208, v88, v88
v_mfma_f32_16x16x32_bf16 v[120:123], v[64:67], a[104:107], v[120:123]
v_rcp_f32 v212, v212
v_mfma_f32_16x16x32_bf16 v[120:123], v[68:71], a[120:123], v[120:123]
ds_read_b128 v[60:63], v2 offset:19456
v_mul_f32 v213, v213, v212
v_mfma_f32_16x16x32_bf16 v[124:127], v[64:67], a[108:111], v[124:127]
v_rcp_f32 v214, v214
v_mfma_f32_16x16x32_bf16 v[124:127], v[68:71], a[124:127], v[124:127]
v_mul_f32 v215, v215, v214
s_waitcnt lgkmcnt(4)
v_mfma_f32_16x16x32_bf16 v[128:131], v[72:75], a[96:99], v[128:131]
v_cvt_pk_bf16_f32 v165, v213, v215
v_mul_f32 v210, v89, v89
v_mfma_f32_16x16x32_bf16 v[128:131], v[76:79], a[112:115], v[128:131]
v_fma_f32 v208, v208, v239, v238
v_fma_f32 v210, v210, v239, v238
v_mfma_f32_16x16x32_bf16 v[132:135], v[72:75], a[100:103], v[132:135]
ds_read_b128 v[64:67], v2 offset:20480
v_mul_f32 v208, v208, v88
v_mfma_f32_16x16x32_bf16 v[132:135], v[76:79], a[116:119], v[132:135]
v_mul_f32 v210, v210, v89
v_mul_f32 v209, v88, v104
v_mfma_f32_16x16x32_bf16 v[136:139], v[72:75], a[104:107], v[136:139]
v_exp_f32 v208, v208
v_mfma_f32_16x16x32_bf16 v[136:139], v[76:79], a[120:123], v[136:139]
ds_read_b128 v[68:71], v2 offset:21504
v_mul_f32 v211, v89, v105
v_mfma_f32_16x16x32_bf16 v[140:143], v[72:75], a[108:111], v[140:143]
v_exp_f32 v210, v210
v_mfma_f32_16x16x32_bf16 v[140:143], v[76:79], a[124:127], v[140:143]
v_fma_f32 v208, v208, v240, v240
s_waitcnt lgkmcnt(4)
v_mfma_f32_16x16x32_bf16 v[112:115], v[48:51], a[128:131], v[112:115]
v_fma_f32 v210, v210, v240, v240
v_mul_f32 v212, v90, v90
v_mfma_f32_16x16x32_bf16 v[112:115], v[52:55], a[144:147], v[112:115]
v_rcp_f32 v208, v208
v_mfma_f32_16x16x32_bf16 v[116:119], v[48:51], a[132:135], v[116:119]
ds_read_b128 v[72:75], v2 offset:22528
v_mul_f32 v209, v209, v208
v_mfma_f32_16x16x32_bf16 v[116:119], v[52:55], a[148:151], v[116:119]
v_rcp_f32 v210, v210
v_mfma_f32_16x16x32_bf16 v[120:123], v[48:51], a[136:139], v[120:123]
v_mul_f32 v211, v211, v210
v_cvt_pk_bf16_f32 v168, v209, v211
v_mfma_f32_16x16x32_bf16 v[120:123], v[52:55], a[152:155], v[120:123]
ds_read_b128 v[76:79], v2 offset:23552
v_mul_f32 v214, v91, v91
v_mfma_f32_16x16x32_bf16 v[124:127], v[48:51], a[140:143], v[124:127]
v_fma_f32 v212, v212, v239, v238
v_fma_f32 v214, v214, v239, v238
v_mfma_f32_16x16x32_bf16 v[124:127], v[52:55], a[156:159], v[124:127]
v_mul_f32 v212, v212, v90
s_waitcnt lgkmcnt(4)
v_mfma_f32_16x16x32_bf16 v[128:131], v[56:59], a[128:131], v[128:131]
s_waitcnt vmcnt(23)
v_mul_f32 v214, v214, v91
v_mfma_f32_16x16x32_bf16 v[128:131], v[60:63], a[144:147], v[128:131]
s_barrier
v_mfma_f32_16x16x32_bf16 v[132:135], v[56:59], a[132:135], v[132:135]
ds_read_b128 v[48:51], v2 offset:24576
s_add_u32 m0, s22, 122880
v_mfma_f32_16x16x32_bf16 v[132:135], v[60:63], a[148:151], v[132:135]
v_add_u32 v3, 20480, v3
buffer_load_dwordx4 v3, s[8:11], 0 offen offset:0 sc1 lds
v_mfma_f32_16x16x32_bf16 v[136:139], v[56:59], a[136:139], v[136:139]
v_exp_f32 v212, v212
v_mfma_f32_16x16x32_bf16 v[136:139], v[60:63], a[152:155], v[136:139]
ds_read_b128 v[52:55], v2 offset:25600
v_mul_f32 v213, v90, v106
v_mfma_f32_16x16x32_bf16 v[140:143], v[56:59], a[140:143], v[140:143]
v_exp_f32 v214, v214
v_mfma_f32_16x16x32_bf16 v[140:143], v[60:63], a[156:159], v[140:143]
v_mul_f32 v215, v91, v107
s_waitcnt lgkmcnt(4)
v_mfma_f32_16x16x32_bf16 v[112:115], v[64:67], a[160:163], v[112:115]
buffer_load_dwordx4 v3, s[8:11], 0 offen offset:1024 sc1 lds
v_mfma_f32_16x16x32_bf16 v[112:115], v[68:71], a[176:179], v[112:115]
v_fma_f32 v212, v212, v240, v240
v_fma_f32 v214, v214, v240, v240
v_mfma_f32_16x16x32_bf16 v[116:119], v[64:67], a[164:167], v[116:119]
ds_read_b128 v[56:59], v2 offset:26624
v_mul_f32 v208, v92, v92
v_mfma_f32_16x16x32_bf16 v[116:119], v[68:71], a[180:183], v[116:119]
v_rcp_f32 v212, v212
v_mfma_f32_16x16x32_bf16 v[120:123], v[64:67], a[168:171], v[120:123]
buffer_load_dwordx4 v3, s[8:11], 0 offen offset:2048 sc1 lds
v_mfma_f32_16x16x32_bf16 v[120:123], v[68:71], a[184:187], v[120:123]
ds_read_b128 v[60:63], v2 offset:27648
v_mul_f32 v213, v213, v212
v_mfma_f32_16x16x32_bf16 v[124:127], v[64:67], a[172:175], v[124:127]
v_rcp_f32 v214, v214
v_mfma_f32_16x16x32_bf16 v[124:127], v[68:71], a[188:191], v[124:127]
v_mul_f32 v215, v215, v214
s_waitcnt lgkmcnt(4)
v_mfma_f32_16x16x32_bf16 v[128:131], v[72:75], a[160:163], v[128:131]
buffer_load_dwordx4 v3, s[8:11], 0 offen offset:3072 sc1 lds
v_mfma_f32_16x16x32_bf16 v[128:131], v[76:79], a[176:179], v[128:131]
s_add_u32 m0, s22, 126976
v_add_u32 v3, 4096, v3
v_mfma_f32_16x16x32_bf16 v[132:135], v[72:75], a[164:167], v[132:135]
ds_read_b128 v[64:67], v2 offset:28672
v_cvt_pk_bf16_f32 v169, v213, v215
v_mfma_f32_16x16x32_bf16 v[132:135], v[76:79], a[180:183], v[132:135]
v_mul_f32 v210, v93, v93
v_fma_f32 v208, v208, v242, v241
v_mfma_f32_16x16x32_bf16 v[136:139], v[72:75], a[168:171], v[136:139]
buffer_load_dwordx4 v3, s[8:11], 0 offen offset:0 sc1 lds
v_mfma_f32_16x16x32_bf16 v[136:139], v[76:79], a[184:187], v[136:139]
ds_read_b128 v[68:71], v2 offset:29696
v_fma_f32 v210, v210, v242, v241
v_mfma_f32_16x16x32_bf16 v[140:143], v[72:75], a[172:175], v[140:143]
v_mul_f32 v208, v208, v92
v_mul_f32 v210, v210, v93
v_mfma_f32_16x16x32_bf16 v[140:143], v[76:79], a[188:191], v[140:143]
v_mul_f32 v209, v92, v108
s_waitcnt lgkmcnt(4)
v_mfma_f32_16x16x32_bf16 v[112:115], v[48:51], a[192:195], v[112:115]
buffer_load_dwordx4 v3, s[8:11], 0 offen offset:1024 sc1 lds
v_mfma_f32_16x16x32_bf16 v[112:115], v[52:55], a[208:211], v[112:115]
v_exp_f32 v208, v208
v_mfma_f32_16x16x32_bf16 v[116:119], v[48:51], a[196:199], v[116:119]
ds_read_b128 v[72:75], v2 offset:30720
v_mul_f32 v211, v93, v109
v_mfma_f32_16x16x32_bf16 v[116:119], v[52:55], a[212:215], v[116:119]
v_exp_f32 v210, v210
v_mfma_f32_16x16x32_bf16 v[120:123], v[48:51], a[200:203], v[120:123]
v_fma_f32 v208, v208, v243, v243
v_fma_f32 v210, v210, v243, v243
v_mfma_f32_16x16x32_bf16 v[120:123], v[52:55], a[216:219], v[120:123]
ds_read_b128 v[76:79], v2 offset:31744
v_mul_f32 v212, v94, v94
v_mfma_f32_16x16x32_bf16 v[124:127], v[48:51], a[204:207], v[124:127]
v_rcp_f32 v208, v208
v_mfma_f32_16x16x32_bf16 v[124:127], v[52:55], a[220:223], v[124:127]
v_mul_f32 v209, v209, v208
s_waitcnt lgkmcnt(4)
v_mfma_f32_16x16x32_bf16 v[128:131], v[56:59], a[192:195], v[128:131]
v_rcp_f32 v210, v210
v_mfma_f32_16x16x32_bf16 v[128:131], v[60:63], a[208:211], v[128:131]
v_mul_f32 v211, v211, v210
v_cvt_pk_bf16_f32 v172, v209, v211
v_mfma_f32_16x16x32_bf16 v[132:135], v[56:59], a[196:199], v[132:135]
ds_read_b128 v[48:51], v2 offset:32768
v_mul_f32 v214, v95, v95
v_mfma_f32_16x16x32_bf16 v[132:135], v[60:63], a[212:215], v[132:135]
v_fma_f32 v212, v212, v242, v241
v_fma_f32 v214, v214, v242, v241
v_mfma_f32_16x16x32_bf16 v[136:139], v[56:59], a[200:203], v[136:139]
v_mul_f32 v212, v212, v94
v_mul_f32 v214, v214, v95
v_mfma_f32_16x16x32_bf16 v[136:139], v[60:63], a[216:219], v[136:139]
ds_read_b128 v[52:55], v2 offset:33792
v_mul_f32 v213, v94, v110
v_mfma_f32_16x16x32_bf16 v[140:143], v[56:59], a[204:207], v[140:143]
v_exp_f32 v212, v212
v_mfma_f32_16x16x32_bf16 v[140:143], v[60:63], a[220:223], v[140:143]
v_mul_f32 v215, v95, v111
s_waitcnt lgkmcnt(4)
v_mfma_f32_16x16x32_bf16 v[112:115], v[64:67], a[224:227], v[112:115]
v_exp_f32 v214, v214
v_mfma_f32_16x16x32_bf16 v[112:115], v[68:71], a[240:243], v[112:115]
v_fma_f32 v212, v212, v243, v243
v_fma_f32 v214, v214, v243, v243
v_mfma_f32_16x16x32_bf16 v[116:119], v[64:67], a[228:231], v[116:119]
ds_read_b128 v[56:59], v2 offset:34816
v_fma_f32 v222, v222, v236, v235
v_mfma_f32_16x16x32_bf16 v[116:119], v[68:71], a[244:247], v[116:119]
v_rcp_f32 v212, v212
v_mfma_f32_16x16x32_bf16 v[120:123], v[64:67], a[232:235], v[120:123]
v_rcp_f32 v214, v214
v_mfma_f32_16x16x32_bf16 v[120:123], v[68:71], a[248:251], v[120:123]
ds_read_b128 v[60:63], v2 offset:35840
v_mul_f32 v213, v213, v212
v_mfma_f32_16x16x32_bf16 v[124:127], v[64:67], a[236:239], v[124:127]
v_mul_f32 v215, v215, v214
v_cvt_pk_bf16_f32 v173, v213, v215
v_mfma_f32_16x16x32_bf16 v[124:127], v[68:71], a[252:255], v[124:127]
v_mul_f32 v220, v220, v182
s_waitcnt lgkmcnt(4)
v_mfma_f32_16x16x32_bf16 v[128:131], v[72:75], a[224:227], v[128:131]
v_rcp_f32 v218, v218
v_mfma_f32_16x16x32_bf16 v[128:131], v[76:79], a[240:243], v[128:131]
v_mul_f32 v219, v219, v218
v_cvt_pk_bf16_f32 v150, v217, v219
v_mfma_f32_16x16x32_bf16 v[132:135], v[72:75], a[228:231], v[132:135]
ds_read_b128 v[64:67], v2 offset:36864
v_mul_f32 v222, v222, v183
v_mfma_f32_16x16x32_bf16 v[132:135], v[76:79], a[244:247], v[132:135]
v_exp_f32 v220, v220
v_mfma_f32_16x16x32_bf16 v[136:139], v[72:75], a[232:235], v[136:139]
v_exp_f32 v222, v222
v_mfma_f32_16x16x32_bf16 v[136:139], v[76:79], a[248:251], v[136:139]
ds_read_b128 v[68:71], v2 offset:37888
v_mul_f32 v221, v182, v198
v_mfma_f32_16x16x32_bf16 v[140:143], v[72:75], a[236:239], v[140:143]
v_mul_f32 v223, v183, v199
v_fma_f32 v220, v220, v237, v237
v_mfma_f32_16x16x32_bf16 v[140:143], v[76:79], a[252:255], v[140:143]
v_fma_f32 v222, v222, v237, v237
s_waitcnt lgkmcnt(4)
v_mfma_f32_16x16x32_bf16 v[112:115], v[48:51], v[16:19], v[112:115]
v_rcp_f32 v220, v220
v_mfma_f32_16x16x32_bf16 v[112:115], v[52:55], v[32:35], v[112:115]
v_rcp_f32 v222, v222
v_mfma_f32_16x16x32_bf16 v[116:119], v[48:51], v[20:23], v[116:119]
ds_read_b128 v[72:75], v2 offset:38912
v_mul_f32 v221, v221, v220
v_mfma_f32_16x16x32_bf16 v[116:119], v[52:55], v[36:39], v[116:119]
v_mul_f32 v223, v223, v222
v_cvt_pk_bf16_f32 v151, v221, v223
v_mfma_f32_16x16x32_bf16 v[120:123], v[48:51], v[24:27], v[120:123]
buffer_store_dwordx4 v[148:151], v4, s[8:11], s24 offen offset:0 sc1
v_mfma_f32_16x16x32_bf16 v[120:123], v[52:55], v[40:43], v[120:123]
ds_read_b128 v[76:79], v2 offset:39936
v_mul_f32 v216, v184, v184
v_mfma_f32_16x16x32_bf16 v[124:127], v[48:51], v[28:31], v[124:127]
v_mul_f32 v218, v185, v185
v_fma_f32 v216, v216, v239, v238
v_mfma_f32_16x16x32_bf16 v[124:127], v[52:55], v[44:47], v[124:127]
v_fma_f32 v218, v218, v239, v238
s_waitcnt lgkmcnt(4)
v_mfma_f32_16x16x32_bf16 v[128:131], v[56:59], v[16:19], v[128:131]
v_mul_f32 v216, v216, v184
v_mul_f32 v218, v218, v185
v_mfma_f32_16x16x32_bf16 v[128:131], v[60:63], v[32:35], v[128:131]
v_exp_f32 v216, v216
v_mfma_f32_16x16x32_bf16 v[132:135], v[56:59], v[20:23], v[132:135]
ds_read_b128 v[48:51], v2 offset:40960
v_mul_f32 v217, v184, v200
v_mfma_f32_16x16x32_bf16 v[132:135], v[60:63], v[36:39], v[132:135]
v_exp_f32 v218, v218
v_mfma_f32_16x16x32_bf16 v[136:139], v[56:59], v[24:27], v[136:139]
v_mul_f32 v219, v185, v201
v_fma_f32 v216, v216, v240, v240
v_mfma_f32_16x16x32_bf16 v[136:139], v[60:63], v[40:43], v[136:139]
ds_read_b128 v[52:55], v2 offset:41984
v_fma_f32 v218, v218, v240, v240
v_mfma_f32_16x16x32_bf16 v[140:143], v[56:59], v[28:31], v[140:143]
v_rcp_f32 v216, v216
v_mfma_f32_16x16x32_bf16 v[140:143], v[60:63], v[44:47], v[140:143]
v_mul_f32 v217, v217, v216
s_waitcnt lgkmcnt(4)
v_mfma_f32_16x16x32_bf16 v[80:83], v[64:67], a[0:3], 0
v_rcp_f32 v218, v218
v_mfma_f32_16x16x32_bf16 v[80:83], v[68:71], a[16:19], v[80:83]
v_mul_f32 v219, v219, v218
v_cvt_pk_bf16_f32 v154, v217, v219
v_mfma_f32_16x16x32_bf16 v[84:87], v[64:67], a[4:7], 0
ds_read_b128 v[56:59], v2 offset:43008
v_mul_f32 v220, v186, v186
v_mfma_f32_16x16x32_bf16 v[84:87], v[68:71], a[20:23], v[84:87]
v_mul_f32 v208, v112, v112
v_mul_f32 v210, v113, v113
v_mfma_f32_16x16x32_bf16 v[88:91], v[64:67], a[8:11], 0
v_fma_f32 v208, v208, v233, v232
v_fma_f32 v210, v210, v233, v232
v_mfma_f32_16x16x32_bf16 v[88:91], v[68:71], a[24:27], v[88:91]
ds_read_b128 v[60:63], v2 offset:44032
v_mul_f32 v208, v208, v112
v_mfma_f32_16x16x32_bf16 v[92:95], v[64:67], a[12:15], 0
v_mul_f32 v210, v210, v113
v_mul_f32 v209, v112, v128
v_mfma_f32_16x16x32_bf16 v[92:95], v[68:71], a[28:31], v[92:95]
v_mul_f32 v211, v113, v129
s_waitcnt lgkmcnt(4)
v_mfma_f32_16x16x32_bf16 v[96:99], v[72:75], a[0:3], 0
v_exp_f32 v208, v208
v_mfma_f32_16x16x32_bf16 v[96:99], v[76:79], a[16:19], v[96:99]
v_exp_f32 v210, v210
v_mfma_f32_16x16x32_bf16 v[100:103], v[72:75], a[4:7], 0
ds_read_b128 v[64:67], v2 offset:45056
v_fma_f32 v208, v208, v234, v234
v_mfma_f32_16x16x32_bf16 v[100:103], v[76:79], a[20:23], v[100:103]
v_fma_f32 v210, v210, v234, v234
v_mul_f32 v212, v114, v114
v_mfma_f32_16x16x32_bf16 v[104:107], v[72:75], a[8:11], 0
v_rcp_f32 v208, v208
v_mfma_f32_16x16x32_bf16 v[104:107], v[76:79], a[24:27], v[104:107]
ds_read_b128 v[68:71], v2 offset:46080
v_mul_f32 v209, v209, v208
v_mfma_f32_16x16x32_bf16 v[108:111], v[72:75], a[12:15], 0
v_rcp_f32 v210, v210
v_mfma_f32_16x16x32_bf16 v[108:111], v[76:79], a[28:31], v[108:111]
v_mul_f32 v211, v211, v210
s_waitcnt lgkmcnt(4)
v_mfma_f32_16x16x32_bf16 v[80:83], v[48:51], a[32:35], v[80:83]
v_cvt_pk_bf16_f32 v162, v209, v211
v_mul_f32 v214, v115, v115
v_mfma_f32_16x16x32_bf16 v[80:83], v[52:55], a[48:51], v[80:83]
v_fma_f32 v212, v212, v233, v232
v_fma_f32 v214, v214, v233, v232
v_mfma_f32_16x16x32_bf16 v[84:87], v[48:51], a[36:39], v[84:87]
ds_read_b128 v[72:75], v2 offset:47104
v_mul_f32 v212, v212, v114
v_mfma_f32_16x16x32_bf16 v[84:87], v[52:55], a[52:55], v[84:87]
v_mul_f32 v214, v214, v115
v_mul_f32 v213, v114, v130
v_mfma_f32_16x16x32_bf16 v[88:91], v[48:51], a[40:43], v[88:91]
v_exp_f32 v212, v212
v_mfma_f32_16x16x32_bf16 v[88:91], v[52:55], a[56:59], v[88:91]
ds_read_b128 v[76:79], v2 offset:48128
v_mul_f32 v215, v115, v131
v_mfma_f32_16x16x32_bf16 v[92:95], v[48:51], a[44:47], v[92:95]
v_exp_f32 v214, v214
v_mfma_f32_16x16x32_bf16 v[92:95], v[52:55], a[60:63], v[92:95]
v_fma_f32 v212, v212, v234, v234
s_waitcnt lgkmcnt(4)
v_mfma_f32_16x16x32_bf16 v[96:99], v[56:59], a[32:35], v[96:99]
s_waitcnt vmcnt(22)
v_fma_f32 v214, v214, v234, v234
v_mfma_f32_16x16x32_bf16 v[96:99], v[60:63], a[48:51], v[96:99]
s_barrier
v_mfma_f32_16x16x32_bf16 v[100:103], v[56:59], a[36:39], v[100:103]
ds_read_b128 v[48:51], v2 offset:49152
s_add_u32 m0, s22, 0
v_mfma_f32_16x16x32_bf16 v[100:103], v[60:63], a[52:55], v[100:103]
v_add_u32 v3, 20480, v3
buffer_load_dwordx4 v3, s[8:11], 0 offen offset:0 sc1 lds
v_mfma_f32_16x16x32_bf16 v[104:107], v[56:59], a[40:43], v[104:107]
v_rcp_f32 v212, v212
v_mfma_f32_16x16x32_bf16 v[104:107], v[60:63], a[56:59], v[104:107]
ds_read_b128 v[52:55], v2 offset:50176
v_mul_f32 v213, v213, v212
v_mfma_f32_16x16x32_bf16 v[108:111], v[56:59], a[44:47], v[108:111]
v_rcp_f32 v214, v214
v_mfma_f32_16x16x32_bf16 v[108:111], v[60:63], a[60:63], v[108:111]
v_mul_f32 v215, v215, v214
s_waitcnt lgkmcnt(4)
v_mfma_f32_16x16x32_bf16 v[80:83], v[64:67], a[64:67], v[80:83]
buffer_load_dwordx4 v3, s[8:11], 0 offen offset:1024 sc1 lds
v_mfma_f32_16x16x32_bf16 v[80:83], v[68:71], a[80:83], v[80:83]
v_cvt_pk_bf16_f32 v163, v213, v215
v_mul_f32 v208, v116, v116
v_mfma_f32_16x16x32_bf16 v[84:87], v[64:67], a[68:71], v[84:87]
ds_read_b128 v[56:59], v2 offset:51200
v_mul_f32 v210, v117, v117
v_mfma_f32_16x16x32_bf16 v[84:87], v[68:71], a[84:87], v[84:87]
buffer_store_dwordx4 v[160:163], v2, s[8:11], s24 offen offset:1024 sc1
v_mfma_f32_16x16x32_bf16 v[88:91], v[64:67], a[72:75], v[88:91]
v_fma_f32 v208, v208, v236, v235
v_fma_f32 v210, v210, v236, v235
v_mfma_f32_16x16x32_bf16 v[88:91], v[68:71], a[88:91], v[88:91]
ds_read_b128 v[60:63], v2 offset:52224
v_mul_f32 v208, v208, v116
v_mfma_f32_16x16x32_bf16 v[92:95], v[64:67], a[76:79], v[92:95]
v_mul_f32 v210, v210, v117
v_mul_f32 v209, v116, v132
v_mfma_f32_16x16x32_bf16 v[92:95], v[68:71], a[92:95], v[92:95]
v_mul_f32 v211, v117, v133
s_waitcnt lgkmcnt(4)
v_mfma_f32_16x16x32_bf16 v[96:99], v[72:75], a[64:67], v[96:99]
buffer_load_dwordx4 v3, s[8:11], 0 offen offset:2048 sc1 lds
v_mfma_f32_16x16x32_bf16 v[96:99], v[76:79], a[80:83], v[96:99]
v_exp_f32 v208, v208
v_mfma_f32_16x16x32_bf16 v[100:103], v[72:75], a[68:71], v[100:103]
ds_read_b128 v[64:67], v2 offset:53248
v_fma_f32 v208, v208, v237, v237
v_mfma_f32_16x16x32_bf16 v[100:103], v[76:79], a[84:87], v[100:103]
v_exp_f32 v210, v210
v_mfma_f32_16x16x32_bf16 v[104:107], v[72:75], a[72:75], v[104:107]
buffer_load_dwordx4 v3, s[8:11], 0 offen offset:3072 sc1 lds
v_mfma_f32_16x16x32_bf16 v[104:107], v[76:79], a[88:91], v[104:107]
ds_read_b128 v[68:71], v2 offset:54272
s_add_u32 m0, s22, 4096
v_mfma_f32_16x16x32_bf16 v[108:111], v[72:75], a[76:79], v[108:111]
v_add_u32 v3, 4096, v3
v_fma_f32 v210, v210, v237, v237
v_mfma_f32_16x16x32_bf16 v[108:111], v[76:79], a[92:95], v[108:111]
v_mul_f32 v212, v118, v118
s_waitcnt lgkmcnt(4)
v_mfma_f32_16x16x32_bf16 v[80:83], v[48:51], a[96:99], v[80:83]
buffer_load_dwordx4 v3, s[8:11], 0 offen offset:0 sc1 lds
v_mfma_f32_16x16x32_bf16 v[80:83], v[52:55], a[112:115], v[80:83]
v_rcp_f32 v208, v208
v_mfma_f32_16x16x32_bf16 v[84:87], v[48:51], a[100:103], v[84:87]
ds_read_b128 v[72:75], v2 offset:55296
v_mul_f32 v209, v209, v208
v_mfma_f32_16x16x32_bf16 v[84:87], v[52:55], a[116:119], v[84:87]
v_rcp_f32 v210, v210
v_mfma_f32_16x16x32_bf16 v[88:91], v[48:51], a[104:107], v[88:91]
buffer_load_dwordx4 v3, s[8:11], 0 offen offset:1024 sc1 lds
v_mfma_f32_16x16x32_bf16 v[88:91], v[52:55], a[120:123], v[88:91]
ds_read_b128 v[76:79], v2 offset:56320
v_mul_f32 v211, v211, v210
v_mfma_f32_16x16x32_bf16 v[92:95], v[48:51], a[108:111], v[92:95]
v_cvt_pk_bf16_f32 v166, v209, v211
v_mul_f32 v214, v119, v119
v_mfma_f32_16x16x32_bf16 v[92:95], v[52:55], a[124:127], v[92:95]
v_fma_f32 v212, v212, v236, v235
s_waitcnt lgkmcnt(4)
v_mfma_f32_16x16x32_bf16 v[96:99], v[56:59], a[96:99], v[96:99]
v_fma_f32 v214, v214, v236, v235
v_mul_f32 v212, v212, v118
v_mfma_f32_16x16x32_bf16 v[96:99], v[60:63], a[112:115], v[96:99]
v_mul_f32 v214, v214, v119
v_mul_f32 v213, v118, v134
v_mfma_f32_16x16x32_bf16 v[100:103], v[56:59], a[100:103], v[100:103]
ds_read_b128 v[48:51], v2 offset:57344
v_mul_f32 v215, v119, v135
v_mfma_f32_16x16x32_bf16 v[100:103], v[60:63], a[116:119], v[100:103]
v_exp_f32 v212, v212
v_mfma_f32_16x16x32_bf16 v[104:107], v[56:59], a[104:107], v[104:107]
v_exp_f32 v214, v214
v_mfma_f32_16x16x32_bf16 v[104:107], v[60:63], a[120:123], v[104:107]
ds_read_b128 v[52:55], v2 offset:58368
v_fma_f32 v212, v212, v237, v237
v_mfma_f32_16x16x32_bf16 v[108:111], v[56:59], a[108:111], v[108:111]
v_fma_f32 v214, v214, v237, v237
v_mul_f32 v208, v120, v120
v_mfma_f32_16x16x32_bf16 v[108:111], v[60:63], a[124:127], v[108:111]
v_mul_f32 v210, v121, v121
s_waitcnt lgkmcnt(4)
v_mfma_f32_16x16x32_bf16 v[80:83], v[64:67], a[128:131], v[80:83]
v_rcp_f32 v212, v212
v_mfma_f32_16x16x32_bf16 v[80:83], v[68:71], a[144:147], v[80:83]
v_rcp_f32 v214, v214
v_mfma_f32_16x16x32_bf16 v[84:87], v[64:67], a[132:135], v[84:87]
ds_read_b128 v[56:59], v2 offset:59392
v_mul_f32 v213, v213, v212
v_mfma_f32_16x16x32_bf16 v[84:87], v[68:71], a[148:151], v[84:87]
v_mul_f32 v215, v215, v214
v_cvt_pk_bf16_f32 v167, v213, v215
v_mfma_f32_16x16x32_bf16 v[88:91], v[64:67], a[136:139], v[88:91]
buffer_store_dwordx4 v[164:167], v4, s[8:11], s24 offen offset:1024 sc1
v_mfma_f32_16x16x32_bf16 v[88:91], v[68:71], a[152:155], v[88:91]
ds_read_b128 v[60:63], v2 offset:60416
v_fma_f32 v208, v208, v239, v238
v_mfma_f32_16x16x32_bf16 v[92:95], v[64:67], a[140:143], v[92:95]
v_fma_f32 v210, v210, v239, v238
v_mul_f32 v208, v208, v120
v_mfma_f32_16x16x32_bf16 v[92:95], v[68:71], a[156:159], v[92:95]
v_mul_f32 v210, v210, v121
s_waitcnt lgkmcnt(4)
v_mfma_f32_16x16x32_bf16 v[96:99], v[72:75], a[128:131], v[96:99]
v_exp_f32 v208, v208
v_mfma_f32_16x16x32_bf16 v[96:99], v[76:79], a[144:147], v[96:99]
v_exp_f32 v210, v210
v_mfma_f32_16x16x32_bf16 v[100:103], v[72:75], a[132:135], v[100:103]
ds_read_b128 v[64:67], v2 offset:61440
v_mul_f32 v209, v120, v136
v_mfma_f32_16x16x32_bf16 v[100:103], v[76:79], a[148:151], v[100:103]
v_mul_f32 v211, v121, v137
v_fma_f32 v208, v208, v240, v240
v_mfma_f32_16x16x32_bf16 v[104:107], v[72:75], a[136:139], v[104:107]
v_fma_f32 v210, v210, v240, v240
v_mul_f32 v212, v122, v122
v_mfma_f32_16x16x32_bf16 v[104:107], v[76:79], a[152:155], v[104:107]
ds_read_b128 v[68:71], v2 offset:62464
v_mul_f32 v214, v123, v123
v_mfma_f32_16x16x32_bf16 v[108:111], v[72:75], a[140:143], v[108:111]
v_rcp_f32 v208, v208
v_mfma_f32_16x16x32_bf16 v[108:111], v[76:79], a[156:159], v[108:111]
v_mul_f32 v209, v209, v208
s_waitcnt lgkmcnt(4)
v_mfma_f32_16x16x32_bf16 v[80:83], v[48:51], a[160:163], v[80:83]
v_rcp_f32 v210, v210
v_mfma_f32_16x16x32_bf16 v[80:83], v[52:55], a[176:179], v[80:83]
v_mul_f32 v211, v211, v210
v_cvt_pk_bf16_f32 v170, v209, v211
v_mfma_f32_16x16x32_bf16 v[84:87], v[48:51], a[164:167], v[84:87]
ds_read_b128 v[72:75], v2 offset:63488
v_fma_f32 v212, v212, v239, v238
v_mfma_f32_16x16x32_bf16 v[84:87], v[52:55], a[180:183], v[84:87]
v_fma_f32 v214, v214, v239, v238
v_mul_f32 v212, v212, v122
v_mfma_f32_16x16x32_bf16 v[88:91], v[48:51], a[168:171], v[88:91]
v_mul_f32 v214, v214, v123
v_mul_f32 v213, v122, v138
v_mfma_f32_16x16x32_bf16 v[88:91], v[52:55], a[184:187], v[88:91]
ds_read_b128 v[76:79], v2 offset:64512
v_mul_f32 v215, v123, v139
v_mfma_f32_16x16x32_bf16 v[92:95], v[48:51], a[172:175], v[92:95]
v_exp_f32 v212, v212
v_mfma_f32_16x16x32_bf16 v[92:95], v[52:55], a[188:191], v[92:95]
v_fma_f32 v212, v212, v240, v240
s_waitcnt lgkmcnt(4)
v_mfma_f32_16x16x32_bf16 v[96:99], v[56:59], a[160:163], v[96:99]
v_exp_f32 v214, v214
v_mfma_f32_16x16x32_bf16 v[96:99], v[60:63], a[176:179], v[96:99]
v_fma_f32 v214, v214, v240, v240
v_mul_f32 v208, v124, v124
v_mfma_f32_16x16x32_bf16 v[100:103], v[56:59], a[164:167], v[100:103]
ds_read_b128 v[48:51], v7 offset:0
v_mul_f32 v210, v125, v125
v_mfma_f32_16x16x32_bf16 v[100:103], v[60:63], a[180:183], v[100:103]
v_rcp_f32 v212, v212
v_mfma_f32_16x16x32_bf16 v[104:107], v[56:59], a[168:171], v[104:107]
v_rcp_f32 v214, v214
v_mfma_f32_16x16x32_bf16 v[104:107], v[60:63], a[184:187], v[104:107]
ds_read_b128 v[52:55], v7 offset:1024
v_mul_f32 v213, v213, v212
v_mfma_f32_16x16x32_bf16 v[108:111], v[56:59], a[172:175], v[108:111]
v_mul_f32 v215, v215, v214
v_cvt_pk_bf16_f32 v171, v213, v215
v_mfma_f32_16x16x32_bf16 v[108:111], v[60:63], a[188:191], v[108:111]
v_fma_f32 v208, v208, v242, v241
s_waitcnt lgkmcnt(4)
v_mfma_f32_16x16x32_bf16 v[80:83], v[64:67], a[192:195], v[80:83]
buffer_store_dwordx4 v[168:171], v5, s[8:11], s24 offen offset:1024 sc1
v_mfma_f32_16x16x32_bf16 v[80:83], v[68:71], a[208:211], v[80:83]
v_fma_f32 v210, v210, v242, v241
v_mul_f32 v208, v208, v124
v_mfma_f32_16x16x32_bf16 v[84:87], v[64:67], a[196:199], v[84:87]
ds_read_b128 v[56:59], v7 offset:2048
v_mul_f32 v210, v210, v125
v_mfma_f32_16x16x32_bf16 v[84:87], v[68:71], a[212:215], v[84:87]
v_exp_f32 v208, v208
v_mfma_f32_16x16x32_bf16 v[88:91], v[64:67], a[200:203], v[88:91]
v_exp_f32 v210, v210
v_mfma_f32_16x16x32_bf16 v[88:91], v[68:71], a[216:219], v[88:91]
ds_read_b128 v[60:63], v7 offset:3072
v_mul_f32 v209, v124, v140
v_mfma_f32_16x16x32_bf16 v[92:95], v[64:67], a[204:207], v[92:95]
v_mul_f32 v211, v125, v141
v_fma_f32 v208, v208, v243, v243
v_mfma_f32_16x16x32_bf16 v[92:95], v[68:71], a[220:223], v[92:95]
v_fma_f32 v210, v210, v243, v243
s_waitcnt lgkmcnt(4)
v_mfma_f32_16x16x32_bf16 v[96:99], v[72:75], a[192:195], v[96:99]
v_rcp_f32 v208, v208
v_mfma_f32_16x16x32_bf16 v[96:99], v[76:79], a[208:211], v[96:99]
v_rcp_f32 v210, v210
v_mfma_f32_16x16x32_bf16 v[100:103], v[72:75], a[196:199], v[100:103]
ds_read_b128 v[64:67], v7 offset:4096
v_mul_f32 v209, v209, v208
v_mfma_f32_16x16x32_bf16 v[100:103], v[76:79], a[212:215], v[100:103]
v_mul_f32 v211, v211, v210
v_cvt_pk_bf16_f32 v174, v209, v211
v_mfma_f32_16x16x32_bf16 v[104:107], v[72:75], a[200:203], v[104:107]
v_mul_f32 v212, v126, v126
v_mul_f32 v214, v127, v127
v_mfma_f32_16x16x32_bf16 v[104:107], v[76:79], a[216:219], v[104:107]
ds_read_b128 v[68:71], v7 offset:5120
v_fma_f32 v212, v212, v242, v241
v_mfma_f32_16x16x32_bf16 v[108:111], v[72:75], a[204:207], v[108:111]
v_fma_f32 v214, v214, v242, v241
v_mul_f32 v212, v212, v126
v_mfma_f32_16x16x32_bf16 v[108:111], v[76:79], a[220:223], v[108:111]
v_mul_f32 v214, v214, v127
s_waitcnt lgkmcnt(4)
v_mfma_f32_16x16x32_bf16 v[80:83], v[48:51], a[224:227], v[80:83]
v_exp_f32 v212, v212
v_mfma_f32_16x16x32_bf16 v[80:83], v[52:55], a[240:243], v[80:83]
v_exp_f32 v214, v214
v_mfma_f32_16x16x32_bf16 v[84:87], v[48:51], a[228:231], v[84:87]
ds_read_b128 v[72:75], v7 offset:6144
v_mul_f32 v213, v126, v142
v_mfma_f32_16x16x32_bf16 v[84:87], v[52:55], a[244:247], v[84:87]
v_mul_f32 v215, v127, v143
v_fma_f32 v212, v212, v243, v243
v_mfma_f32_16x16x32_bf16 v[88:91], v[48:51], a[232:235], v[88:91]
v_fma_f32 v214, v214, v243, v243
v_mul_f32 v222, v187, v187
v_mfma_f32_16x16x32_bf16 v[88:91], v[52:55], a[248:251], v[88:91]
ds_read_b128 v[76:79], v7 offset:7168
v_fma_f32 v220, v220, v239, v238
v_mfma_f32_16x16x32_bf16 v[92:95], v[48:51], a[236:239], v[92:95]
v_rcp_f32 v212, v212
v_mfma_f32_16x16x32_bf16 v[92:95], v[52:55], a[252:255], v[92:95]
v_mul_f32 v213, v213, v212
s_waitcnt lgkmcnt(4)
v_mfma_f32_16x16x32_bf16 v[96:99], v[56:59], a[224:227], v[96:99]
s_waitcnt vmcnt(23)
v_fma_f32 v222, v222, v239, v238
v_mfma_f32_16x16x32_bf16 v[96:99], v[60:63], a[240:243], v[96:99]
s_barrier
v_mfma_f32_16x16x32_bf16 v[100:103], v[56:59], a[228:231], v[100:103]
ds_read_b128 v[48:51], v7 offset:8192
s_add_u32 m0, s22, 24576
v_mfma_f32_16x16x32_bf16 v[100:103], v[60:63], a[244:247], v[100:103]
v_add_u32 v3, 20480, v3
buffer_load_dwordx4 v3, s[8:11], 0 offen offset:0 sc1 lds
v_mfma_f32_16x16x32_bf16 v[104:107], v[56:59], a[232:235], v[104:107]
v_rcp_f32 v214, v214
v_mfma_f32_16x16x32_bf16 v[104:107], v[60:63], a[248:251], v[104:107]
ds_read_b128 v[52:55], v7 offset:9216
v_mul_f32 v215, v215, v214
v_mfma_f32_16x16x32_bf16 v[108:111], v[56:59], a[236:239], v[108:111]
v_cvt_pk_bf16_f32 v175, v213, v215
v_mul_f32 v220, v220, v186
v_mfma_f32_16x16x32_bf16 v[108:111], v[60:63], a[252:255], v[108:111]
v_mul_f32 v222, v222, v187
s_waitcnt lgkmcnt(4)
v_mfma_f32_16x16x32_bf16 v[80:83], v[64:67], v[16:19], v[80:83]
buffer_load_dwordx4 v3, s[8:11], 0 offen offset:1024 sc1 lds
v_mfma_f32_16x16x32_bf16 v[80:83], v[68:71], v[32:35], v[80:83]
v_exp_f32 v220, v220
v_mfma_f32_16x16x32_bf16 v[84:87], v[64:67], v[20:23], v[84:87]
ds_read_b128 v[56:59], v7 offset:10240
v_mul_f32 v221, v186, v202
v_mfma_f32_16x16x32_bf16 v[84:87], v[68:71], v[36:39], v[84:87]
buffer_store_dwordx4 v[172:175], v6, s[8:11], s24 offen offset:1024 sc1
v_mfma_f32_16x16x32_bf16 v[88:91], v[64:67], v[24:27], v[88:91]
v_exp_f32 v222, v222
v_mfma_f32_16x16x32_bf16 v[88:91], v[68:71], v[40:43], v[88:91]
ds_read_b128 v[60:63], v7 offset:11264
v_mul_f32 v223, v187, v203
v_mfma_f32_16x16x32_bf16 v[92:95], v[64:67], v[28:31], v[92:95]
v_fma_f32 v220, v220, v240, v240
v_fma_f32 v222, v222, v240, v240
v_mfma_f32_16x16x32_bf16 v[92:95], v[68:71], v[44:47], v[92:95]
v_mul_f32 v216, v188, v188
s_waitcnt lgkmcnt(4)
v_mfma_f32_16x16x32_bf16 v[96:99], v[72:75], v[16:19], v[96:99]
buffer_load_dwordx4 v3, s[8:11], 0 offen offset:2048 sc1 lds
v_mfma_f32_16x16x32_bf16 v[96:99], v[76:79], v[32:35], v[96:99]
v_rcp_f32 v220, v220
v_mfma_f32_16x16x32_bf16 v[100:103], v[72:75], v[20:23], v[100:103]
ds_read_b128 v[64:67], v7 offset:12288
v_mul_f32 v221, v221, v220
v_mfma_f32_16x16x32_bf16 v[100:103], v[76:79], v[36:39], v[100:103]
v_rcp_f32 v222, v222
v_mfma_f32_16x16x32_bf16 v[104:107], v[72:75], v[24:27], v[104:107]
buffer_load_dwordx4 v3, s[8:11], 0 offen offset:3072 sc1 lds
v_mfma_f32_16x16x32_bf16 v[104:107], v[76:79], v[40:43], v[104:107]
ds_read_b128 v[68:71], v7 offset:13312
s_add_u32 m0, s22, 28672
v_mfma_f32_16x16x32_bf16 v[108:111], v[72:75], v[28:31], v[108:111]
v_add_u32 v3, 4096, v3
v_mul_f32 v223, v223, v222
v_mfma_f32_16x16x32_bf16 v[108:111], v[76:79], v[44:47], v[108:111]
v_cvt_pk_bf16_f32 v155, v221, v223
s_waitcnt lgkmcnt(4)
v_mfma_f32_16x16x32_bf16 v[112:115], v[48:51], a[0:3], 0
buffer_load_dwordx4 v3, s[8:11], 0 offen offset:0 sc1 lds
v_mfma_f32_16x16x32_bf16 v[112:115], v[52:55], a[16:19], v[112:115]
v_mul_f32 v218, v189, v189
v_fma_f32 v216, v216, v242, v241
v_mfma_f32_16x16x32_bf16 v[116:119], v[48:51], a[4:7], 0
ds_read_b128 v[72:75], v7 offset:14336
v_fma_f32 v218, v218, v242, v241
v_mfma_f32_16x16x32_bf16 v[116:119], v[52:55], a[20:23], v[116:119]
buffer_store_dwordx4 v[152:155], v5, s[8:11], s24 offen offset:0 sc1
v_mfma_f32_16x16x32_bf16 v[120:123], v[48:51], a[8:11], 0
v_mul_f32 v216, v216, v188
v_mul_f32 v218, v218, v189
v_mfma_f32_16x16x32_bf16 v[120:123], v[52:55], a[24:27], v[120:123]
ds_read_b128 v[76:79], v7 offset:15360
v_mul_f32 v217, v188, v204
v_mfma_f32_16x16x32_bf16 v[124:127], v[48:51], a[12:15], 0
v_exp_f32 v216, v216
v_mfma_f32_16x16x32_bf16 v[124:127], v[52:55], a[28:31], v[124:127]
v_mul_f32 v219, v189, v205
s_waitcnt lgkmcnt(4)
v_mfma_f32_16x16x32_bf16 v[128:131], v[56:59], a[0:3], 0
buffer_load_dwordx4 v3, s[8:11], 0 offen offset:1024 sc1 lds
v_mfma_f32_16x16x32_bf16 v[128:131], v[60:63], a[16:19], v[128:131]
v_exp_f32 v218, v218
v_mfma_f32_16x16x32_bf16 v[132:135], v[56:59], a[4:7], 0
ds_read_b128 v[48:51], v7 offset:16384
v_fma_f32 v216, v216, v243, v243
v_mfma_f32_16x16x32_bf16 v[132:135], v[60:63], a[20:23], v[132:135]
v_fma_f32 v218, v218, v243, v243
v_mul_f32 v220, v190, v190
v_mfma_f32_16x16x32_bf16 v[136:139], v[56:59], a[8:11], 0
v_rcp_f32 v216, v216
v_mfma_f32_16x16x32_bf16 v[136:139], v[60:63], a[24:27], v[136:139]
ds_read_b128 v[52:55], v7 offset:17408
v_mul_f32 v217, v217, v216
v_mfma_f32_16x16x32_bf16 v[140:143], v[56:59], a[12:15], 0
v_rcp_f32 v218, v218
v_mfma_f32_16x16x32_bf16 v[140:143], v[60:63], a[28:31], v[140:143]
v_mul_f32 v219, v219, v218
s_waitcnt lgkmcnt(4)
v_mfma_f32_16x16x32_bf16 v[112:115], v[64:67], a[32:35], v[112:115]
v_cvt_pk_bf16_f32 v158, v217, v219
v_mul_f32 v222, v191, v191
v_mfma_f32_16x16x32_bf16 v[112:115], v[68:71], a[48:51], v[112:115]
v_fma_f32 v220, v220, v242, v241
v_fma_f32 v222, v222, v242, v241
v_mfma_f32_16x16x32_bf16 v[116:119], v[64:67], a[36:39], v[116:119]
ds_read_b128 v[56:59], v7 offset:18432
v_mul_f32 v220, v220, v190
v_mfma_f32_16x16x32_bf16 v[116:119], v[68:71], a[52:55], v[116:119]
v_mul_f32 v222, v222, v191
v_mul_f32 v221, v190, v206
v_mfma_f32_16x16x32_bf16 v[120:123], v[64:67], a[40:43], v[120:123]
v_exp_f32 v220, v220
v_mfma_f32_16x16x32_bf16 v[120:123], v[68:71], a[56:59], v[120:123]
ds_read_b128 v[60:63], v7 offset:19456
v_mul_f32 v223, v191, v207
v_mfma_f32_16x16x32_bf16 v[124:127], v[64:67], a[44:47], v[124:127]
v_exp_f32 v222, v222
v_mfma_f32_16x16x32_bf16 v[124:127], v[68:71], a[60:63], v[124:127]
v_fma_f32 v220, v220, v243, v243
s_waitcnt lgkmcnt(4)
v_mfma_f32_16x16x32_bf16 v[128:131], v[72:75], a[32:35], v[128:131]
v_fma_f32 v222, v222, v243, v243
v_mfma_f32_16x16x32_bf16 v[128:131], v[76:79], a[48:51], v[128:131]
v_rcp_f32 v220, v220
v_mfma_f32_16x16x32_bf16 v[132:135], v[72:75], a[36:39], v[132:135]
ds_read_b128 v[64:67], v7 offset:20480
v_mul_f32 v221, v221, v220
v_mfma_f32_16x16x32_bf16 v[132:135], v[76:79], a[52:55], v[132:135]
v_rcp_f32 v222, v222
v_mfma_f32_16x16x32_bf16 v[136:139], v[72:75], a[40:43], v[136:139]
v_mul_f32 v223, v223, v222
v_cvt_pk_bf16_f32 v159, v221, v223
v_mfma_f32_16x16x32_bf16 v[136:139], v[76:79], a[56:59], v[136:139]
ds_read_b128 v[68:71], v7 offset:21504
v_mfma_f32_16x16x32_bf16 v[140:143], v[72:75], a[44:47], v[140:143]
buffer_store_dwordx4 v[156:159], v6, s[8:11], s24 offen offset:0 sc1
v_mfma_f32_16x16x32_bf16 v[140:143], v[76:79], a[60:63], v[140:143]
v_mul_f32 v208, v80, v80
s_waitcnt lgkmcnt(4)
v_mfma_f32_16x16x32_bf16 v[112:115], v[48:51], a[64:67], v[112:115]
v_mul_f32 v210, v81, v81
v_fma_f32 v208, v208, v233, v232
v_mfma_f32_16x16x32_bf16 v[112:115], v[52:55], a[80:83], v[112:115]
v_fma_f32 v210, v210, v233, v232
v_mul_f32 v208, v208, v80
v_mfma_f32_16x16x32_bf16 v[116:119], v[48:51], a[68:71], v[116:119]
ds_read_b128 v[72:75], v7 offset:22528
v_mul_f32 v210, v210, v81
v_mfma_f32_16x16x32_bf16 v[116:119], v[52:55], a[84:87], v[116:119]
v_exp_f32 v208, v208
v_mfma_f32_16x16x32_bf16 v[120:123], v[48:51], a[72:75], v[120:123]
v_exp_f32 v210, v210
v_mfma_f32_16x16x32_bf16 v[120:123], v[52:55], a[88:91], v[120:123]
ds_read_b128 v[76:79], v7 offset:23552
v_mul_f32 v209, v80, v96
v_mfma_f32_16x16x32_bf16 v[124:127], v[48:51], a[76:79], v[124:127]
v_mul_f32 v211, v81, v97
v_fma_f32 v208, v208, v234, v234
v_mfma_f32_16x16x32_bf16 v[124:127], v[52:55], a[92:95], v[124:127]
v_fma_f32 v210, v210, v234, v234
s_waitcnt lgkmcnt(4)
v_mfma_f32_16x16x32_bf16 v[128:131], v[56:59], a[64:67], v[128:131]
v_rcp_f32 v208, v208
v_mfma_f32_16x16x32_bf16 v[128:131], v[60:63], a[80:83], v[128:131]
v_rcp_f32 v210, v210
v_mfma_f32_16x16x32_bf16 v[132:135], v[56:59], a[68:71], v[132:135]
ds_read_b128 v[48:51], v7 offset:24576
v_mul_f32 v209, v209, v208
v_mfma_f32_16x16x32_bf16 v[132:135], v[60:63], a[84:87], v[132:135]
v_mul_f32 v211, v211, v210
v_cvt_pk_bf16_f32 v176, v209, v211
v_mfma_f32_16x16x32_bf16 v[136:139], v[56:59], a[72:75], v[136:139]
v_mul_f32 v212, v82, v82
v_mul_f32 v214, v83, v83
v_mfma_f32_16x16x32_bf16 v[136:139], v[60:63], a[88:91], v[136:139]
ds_read_b128 v[52:55], v7 offset:25600
v_fma_f32 v212, v212, v233, v232
v_mfma_f32_16x16x32_bf16 v[140:143], v[56:59], a[76:79], v[140:143]
v_fma_f32 v214, v214, v233, v232
v_mul_f32 v212, v212, v82
v_mfma_f32_16x16x32_bf16 v[140:143], v[60:63], a[92:95], v[140:143]
v_mul_f32 v214, v214, v83
s_waitcnt lgkmcnt(4)
v_mfma_f32_16x16x32_bf16 v[112:115], v[64:67], a[96:99], v[112:115]
v_exp_f32 v212, v212
v_mfma_f32_16x16x32_bf16 v[112:115], v[68:71], a[112:115], v[112:115]
v_exp_f32 v214, v214
v_mfma_f32_16x16x32_bf16 v[116:119], v[64:67], a[100:103], v[116:119]
ds_read_b128 v[56:59], v7 offset:26624
v_mul_f32 v213, v82, v98
v_mfma_f32_16x16x32_bf16 v[116:119], v[68:71], a[116:119], v[116:119]
v_mul_f32 v215, v83, v99
v_fma_f32 v212, v212, v234, v234
v_mfma_f32_16x16x32_bf16 v[120:123], v[64:67], a[104:107], v[120:123]
v_fma_f32 v214, v214, v234, v234
v_mul_f32 v208, v84, v84
v_mfma_f32_16x16x32_bf16 v[120:123], v[68:71], a[120:123], v[120:123]
ds_read_b128 v[60:63], v7 offset:27648
v_mul_f32 v210, v85, v85
v_mfma_f32_16x16x32_bf16 v[124:127], v[64:67], a[108:111], v[124:127]
v_rcp_f32 v212, v212
v_mfma_f32_16x16x32_bf16 v[124:127], v[68:71], a[124:127], v[124:127]
v_mul_f32 v213, v213, v212
s_waitcnt lgkmcnt(4)
v_mfma_f32_16x16x32_bf16 v[128:131], v[72:75], a[96:99], v[128:131]
v_rcp_f32 v214, v214
v_mfma_f32_16x16x32_bf16 v[128:131], v[76:79], a[112:115], v[128:131]
v_mul_f32 v215, v215, v214
v_cvt_pk_bf16_f32 v177, v213, v215
v_mfma_f32_16x16x32_bf16 v[132:135], v[72:75], a[100:103], v[132:135]
ds_read_b128 v[64:67], v7 offset:28672
v_fma_f32 v208, v208, v236, v235
v_mfma_f32_16x16x32_bf16 v[132:135], v[76:79], a[116:119], v[132:135]
v_fma_f32 v210, v210, v236, v235
v_mul_f32 v208, v208, v84
v_mfma_f32_16x16x32_bf16 v[136:139], v[72:75], a[104:107], v[136:139]
v_mul_f32 v210, v210, v85
v_mul_f32 v209, v84, v100
v_mfma_f32_16x16x32_bf16 v[136:139], v[76:79], a[120:123], v[136:139]
ds_read_b128 v[68:71], v7 offset:29696
v_mul_f32 v211, v85, v101
v_mfma_f32_16x16x32_bf16 v[140:143], v[72:75], a[108:111], v[140:143]
v_exp_f32 v208, v208
v_mfma_f32_16x16x32_bf16 v[140:143], v[76:79], a[124:127], v[140:143]
v_fma_f32 v208, v208, v237, v237
s_waitcnt lgkmcnt(4)
v_mfma_f32_16x16x32_bf16 v[112:115], v[48:51], a[128:131], v[112:115]
v_exp_f32 v210, v210
v_mfma_f32_16x16x32_bf16 v[112:115], v[52:55], a[144:147], v[112:115]
v_fma_f32 v210, v210, v237, v237
v_mul_f32 v212, v86, v86
v_mfma_f32_16x16x32_bf16 v[116:119], v[48:51], a[132:135], v[116:119]
ds_read_b128 v[72:75], v7 offset:30720
v_mul_f32 v214, v87, v87
v_mfma_f32_16x16x32_bf16 v[116:119], v[52:55], a[148:151], v[116:119]
v_rcp_f32 v208, v208
v_mfma_f32_16x16x32_bf16 v[120:123], v[48:51], a[136:139], v[120:123]
v_rcp_f32 v210, v210
v_mfma_f32_16x16x32_bf16 v[120:123], v[52:55], a[152:155], v[120:123]
ds_read_b128 v[76:79], v7 offset:31744
v_mul_f32 v209, v209, v208
v_mfma_f32_16x16x32_bf16 v[124:127], v[48:51], a[140:143], v[124:127]
v_mul_f32 v211, v211, v210
v_cvt_pk_bf16_f32 v180, v209, v211
v_mfma_f32_16x16x32_bf16 v[124:127], v[52:55], a[156:159], v[124:127]
v_fma_f32 v212, v212, v236, v235
s_waitcnt lgkmcnt(4)
v_mfma_f32_16x16x32_bf16 v[128:131], v[56:59], a[128:131], v[128:131]
s_waitcnt vmcnt(25)
v_fma_f32 v214, v214, v236, v235
v_mfma_f32_16x16x32_bf16 v[128:131], v[60:63], a[144:147], v[128:131]
s_barrier
v_mfma_f32_16x16x32_bf16 v[132:135], v[56:59], a[132:135], v[132:135]
ds_read_b128 v[48:51], v7 offset:32768
s_add_u32 m0, s22, 49152
v_mfma_f32_16x16x32_bf16 v[132:135], v[60:63], a[148:151], v[132:135]
v_add_u32 v3, 20480, v3
buffer_load_dwordx4 v3, s[8:11], 0 offen offset:0 sc1 lds
v_mfma_f32_16x16x32_bf16 v[136:139], v[56:59], a[136:139], v[136:139]
v_mul_f32 v212, v212, v86
v_mul_f32 v214, v214, v87
v_mfma_f32_16x16x32_bf16 v[136:139], v[60:63], a[152:155], v[136:139]
ds_read_b128 v[52:55], v7 offset:33792
v_mul_f32 v213, v86, v102
v_mfma_f32_16x16x32_bf16 v[140:143], v[56:59], a[140:143], v[140:143]
v_exp_f32 v212, v212
v_mfma_f32_16x16x32_bf16 v[140:143], v[60:63], a[156:159], v[140:143]
v_mul_f32 v215, v87, v103
s_waitcnt lgkmcnt(4)
v_mfma_f32_16x16x32_bf16 v[112:115], v[64:67], a[160:163], v[112:115]
buffer_load_dwordx4 v3, s[8:11], 0 offen offset:1024 sc1 lds
v_mfma_f32_16x16x32_bf16 v[112:115], v[68:71], a[176:179], v[112:115]
v_exp_f32 v214, v214
v_mfma_f32_16x16x32_bf16 v[116:119], v[64:67], a[164:167], v[116:119]
ds_read_b128 v[56:59], v7 offset:34816
v_fma_f32 v212, v212, v237, v237
v_mfma_f32_16x16x32_bf16 v[116:119], v[68:71], a[180:183], v[116:119]
v_fma_f32 v214, v214, v237, v237
v_mul_f32 v208, v88, v88
v_mfma_f32_16x16x32_bf16 v[120:123], v[64:67], a[168:171], v[120:123]
buffer_load_dwordx4 v3, s[8:11], 0 offen offset:2048 sc1 lds
v_mfma_f32_16x16x32_bf16 v[120:123], v[68:71], a[184:187], v[120:123]
ds_read_b128 v[60:63], v7 offset:35840
v_mul_f32 v210, v89, v89
v_mfma_f32_16x16x32_bf16 v[124:127], v[64:67], a[172:175], v[124:127]
v_rcp_f32 v212, v212
v_mfma_f32_16x16x32_bf16 v[124:127], v[68:71], a[188:191], v[124:127]
v_mul_f32 v213, v213, v212
s_waitcnt lgkmcnt(4)
v_mfma_f32_16x16x32_bf16 v[128:131], v[72:75], a[160:163], v[128:131]
buffer_load_dwordx4 v3, s[8:11], 0 offen offset:3072 sc1 lds
v_mfma_f32_16x16x32_bf16 v[128:131], v[76:79], a[176:179], v[128:131]
s_add_u32 m0, s22, 53248
v_add_u32 v3, 4096, v3
v_mfma_f32_16x16x32_bf16 v[132:135], v[72:75], a[164:167], v[132:135]
ds_read_b128 v[64:67], v7 offset:36864
v_fma_f32 v208, v208, v239, v238
v_mfma_f32_16x16x32_bf16 v[132:135], v[76:79], a[180:183], v[132:135]
v_rcp_f32 v214, v214
v_mfma_f32_16x16x32_bf16 v[136:139], v[72:75], a[168:171], v[136:139]
buffer_load_dwordx4 v3, s[8:11], 0 offen offset:0 sc1 lds
v_mfma_f32_16x16x32_bf16 v[136:139], v[76:79], a[184:187], v[136:139]
ds_read_b128 v[68:71], v7 offset:37888
v_mul_f32 v215, v215, v214
v_mfma_f32_16x16x32_bf16 v[140:143], v[72:75], a[172:175], v[140:143]
v_cvt_pk_bf16_f32 v181, v213, v215
v_fma_f32 v210, v210, v239, v238
v_mfma_f32_16x16x32_bf16 v[140:143], v[76:79], a[188:191], v[140:143]
v_mul_f32 v208, v208, v88
s_waitcnt lgkmcnt(4)
v_mfma_f32_16x16x32_bf16 v[112:115], v[48:51], a[192:195], v[112:115]
buffer_load_dwordx4 v3, s[8:11], 0 offen offset:1024 sc1 lds
v_mfma_f32_16x16x32_bf16 v[112:115], v[52:55], a[208:211], v[112:115]
v_mul_f32 v210, v210, v89
v_mul_f32 v209, v88, v104
v_mfma_f32_16x16x32_bf16 v[116:119], v[48:51], a[196:199], v[116:119]
ds_read_b128 v[72:75], v7 offset:38912
v_mul_f32 v211, v89, v105
v_mfma_f32_16x16x32_bf16 v[116:119], v[52:55], a[212:215], v[116:119]
v_exp_f32 v208, v208
v_mfma_f32_16x16x32_bf16 v[120:123], v[48:51], a[200:203], v[120:123]
v_exp_f32 v210, v210
v_mfma_f32_16x16x32_bf16 v[120:123], v[52:55], a[216:219], v[120:123]
ds_read_b128 v[76:79], v7 offset:39936
v_fma_f32 v208, v208, v240, v240
v_mfma_f32_16x16x32_bf16 v[124:127], v[48:51], a[204:207], v[124:127]
v_fma_f32 v210, v210, v240, v240
v_mul_f32 v212, v90, v90
v_mfma_f32_16x16x32_bf16 v[124:127], v[52:55], a[220:223], v[124:127]
v_mul_f32 v214, v91, v91
s_waitcnt lgkmcnt(4)
v_mfma_f32_16x16x32_bf16 v[128:131], v[56:59], a[192:195], v[128:131]
v_mov_b32 v12, s68
v_mov_b32 v13, s69
v_mfma_f32_16x16x32_bf16 v[128:131], v[60:63], a[208:211], v[128:131]
s_add_u32 s53, s34, 0
s_waitcnt vmcnt(6)
buffer_store_dwordx2 v[12:13], v10, s[8:11], s53 offen sc1
v_mfma_f32_16x16x32_bf16 v[132:135], v[56:59], a[196:199], v[132:135]
ds_read_b128 v[48:51], v7 offset:40960
v_fma_f32 v212, v212, v239, v238
v_mfma_f32_16x16x32_bf16 v[132:135], v[60:63], a[212:215], v[132:135]
v_rcp_f32 v208, v208
v_mfma_f32_16x16x32_bf16 v[136:139], v[56:59], a[200:203], v[136:139]
v_rcp_f32 v210, v210
v_mfma_f32_16x16x32_bf16 v[136:139], v[60:63], a[216:219], v[136:139]
ds_read_b128 v[52:55], v7 offset:41984
v_mul_f32 v209, v209, v208
v_mfma_f32_16x16x32_bf16 v[140:143], v[56:59], a[204:207], v[140:143]
v_mul_f32 v211, v211, v210
v_cvt_pk_bf16_f32 v184, v209, v211
v_mfma_f32_16x16x32_bf16 v[140:143], v[60:63], a[220:223], v[140:143]
v_fma_f32 v214, v214, v239, v238
s_waitcnt lgkmcnt(4)
v_mfma_f32_16x16x32_bf16 v[112:115], v[64:67], a[224:227], v[112:115]
v_mul_f32 v212, v212, v90
v_mul_f32 v214, v214, v91
v_mfma_f32_16x16x32_bf16 v[112:115], v[68:71], a[240:243], v[112:115]
v_exp_f32 v212, v212
v_mfma_f32_16x16x32_bf16 v[116:119], v[64:67], a[228:231], v[116:119]
ds_read_b128 v[56:59], v7 offset:43008
v_exp_f32 v214, v214
v_mfma_f32_16x16x32_bf16 v[116:119], v[68:71], a[244:247], v[116:119]
v_mul_f32 v213, v90, v106
v_mul_f32 v215, v91, v107
v_mfma_f32_16x16x32_bf16 v[120:123], v[64:67], a[232:235], v[120:123]
v_fma_f32 v212, v212, v240, v240
v_fma_f32 v214, v214, v240, v240
v_mfma_f32_16x16x32_bf16 v[120:123], v[68:71], a[248:251], v[120:123]
ds_read_b128 v[60:63], v7 offset:44032
v_rcp_f32 v212, v212
v_mfma_f32_16x16x32_bf16 v[124:127], v[64:67], a[236:239], v[124:127]
v_rcp_f32 v214, v214
v_mfma_f32_16x16x32_bf16 v[124:127], v[68:71], a[252:255], v[124:127]
v_mul_f32 v213, v213, v212
s_waitcnt lgkmcnt(4)
v_mfma_f32_16x16x32_bf16 v[128:131], v[72:75], a[224:227], v[128:131]
v_mul_f32 v215, v215, v214
v_cvt_pk_bf16_f32 v185, v213, v215
v_mfma_f32_16x16x32_bf16 v[128:131], v[76:79], a[240:243], v[128:131]
v_mul_f32 v208, v92, v92
v_mul_f32 v210, v93, v93
v_mfma_f32_16x16x32_bf16 v[132:135], v[72:75], a[228:231], v[132:135]
ds_read_b128 v[64:67], v7 offset:45056
v_fma_f32 v208, v208, v242, v241
v_mfma_f32_16x16x32_bf16 v[132:135], v[76:79], a[244:247], v[132:135]
v_fma_f32 v210, v210, v242, v241
v_mul_f32 v208, v208, v92
v_mfma_f32_16x16x32_bf16 v[136:139], v[72:75], a[232:235], v[136:139]
v_mul_f32 v210, v210, v93
v_exp_f32 v208, v208
v_mfma_f32_16x16x32_bf16 v[136:139], v[76:79], a[248:251], v[136:139]
ds_read_b128 v[68:71], v7 offset:46080
v_exp_f32 v210, v210
v_mfma_f32_16x16x32_bf16 v[140:143], v[72:75], a[236:239], v[140:143]
v_mul_f32 v209, v92, v108
v_mul_f32 v211, v93, v109
v_mfma_f32_16x16x32_bf16 v[140:143], v[76:79], a[252:255], v[140:143]
v_fma_f32 v208, v208, v243, v243
s_waitcnt lgkmcnt(4)
v_mfma_f32_16x16x32_bf16 v[112:115], v[48:51], v[16:19], v[112:115]
v_fma_f32 v210, v210, v243, v243
v_rcp_f32 v208, v208
v_mfma_f32_16x16x32_bf16 v[112:115], v[52:55], v[32:35], v[112:115]
v_rcp_f32 v210, v210
v_mfma_f32_16x16x32_bf16 v[116:119], v[48:51], v[20:23], v[116:119]
ds_read_b128 v[72:75], v7 offset:47104
v_mul_f32 v209, v209, v208
v_mfma_f32_16x16x32_bf16 v[116:119], v[52:55], v[36:39], v[116:119]
v_mul_f32 v211, v211, v210
v_cvt_pk_bf16_f32 v188, v209, v211
v_mfma_f32_16x16x32_bf16 v[120:123], v[48:51], v[24:27], v[120:123]
v_mul_f32 v212, v94, v94
v_mul_f32 v214, v95, v95
v_mfma_f32_16x16x32_bf16 v[120:123], v[52:55], v[40:43], v[120:123]
ds_read_b128 v[76:79], v7 offset:48128
v_fma_f32 v212, v212, v242, v241
v_mfma_f32_16x16x32_bf16 v[124:127], v[48:51], v[28:31], v[124:127]
v_fma_f32 v214, v214, v242, v241
v_mul_f32 v212, v212, v94
v_mfma_f32_16x16x32_bf16 v[124:127], v[52:55], v[44:47], v[124:127]
v_mul_f32 v214, v214, v95
s_waitcnt lgkmcnt(4)
v_mfma_f32_16x16x32_bf16 v[128:131], v[56:59], v[16:19], v[128:131]
v_exp_f32 v212, v212
v_mfma_f32_16x16x32_bf16 v[128:131], v[60:63], v[32:35], v[128:131]
v_exp_f32 v214, v214
v_mfma_f32_16x16x32_bf16 v[132:135], v[56:59], v[20:23], v[132:135]
ds_read_b128 v[48:51], v7 offset:49152
v_mul_f32 v213, v94, v110
v_mfma_f32_16x16x32_bf16 v[132:135], v[60:63], v[36:39], v[132:135]
v_mul_f32 v215, v95, v111
v_fma_f32 v212, v212, v243, v243
v_mfma_f32_16x16x32_bf16 v[136:139], v[56:59], v[24:27], v[136:139]
v_fma_f32 v214, v214, v243, v243
v_rcp_f32 v212, v212
v_mfma_f32_16x16x32_bf16 v[136:139], v[60:63], v[40:43], v[136:139]
ds_read_b128 v[52:55], v7 offset:50176
v_rcp_f32 v214, v214
v_mfma_f32_16x16x32_bf16 v[140:143], v[56:59], v[28:31], v[140:143]
v_mul_f32 v213, v213, v212
v_mul_f32 v215, v215, v214
v_mfma_f32_16x16x32_bf16 v[140:143], v[60:63], v[44:47], v[140:143]
v_cvt_pk_bf16_f32 v189, v213, v215
s_waitcnt lgkmcnt(4)
v_mfma_f32_16x16x32_bf16 v[80:83], v[64:67], a[0:3], 0
v_mfma_f32_16x16x32_bf16 v[80:83], v[68:71], a[16:19], v[80:83]
v_mfma_f32_16x16x32_bf16 v[84:87], v[64:67], a[4:7], 0
ds_read_b128 v[56:59], v7 offset:51200
v_mfma_f32_16x16x32_bf16 v[84:87], v[68:71], a[20:23], v[84:87]
v_mul_f32 v208, v112, v112
v_mul_f32 v210, v113, v113
v_mfma_f32_16x16x32_bf16 v[88:91], v[64:67], a[8:11], 0
v_fma_f32 v208, v208, v233, v232
v_fma_f32 v210, v210, v233, v232
v_mfma_f32_16x16x32_bf16 v[88:91], v[68:71], a[24:27], v[88:91]
ds_read_b128 v[60:63], v7 offset:52224
v_mul_f32 v208, v208, v112
v_mfma_f32_16x16x32_bf16 v[92:95], v[64:67], a[12:15], 0
v_mul_f32 v210, v210, v113
v_mul_f32 v209, v112, v128
v_mfma_f32_16x16x32_bf16 v[92:95], v[68:71], a[28:31], v[92:95]
v_mul_f32 v211, v113, v129
s_waitcnt lgkmcnt(4)
v_mfma_f32_16x16x32_bf16 v[96:99], v[72:75], a[0:3], 0
v_exp_f32 v208, v208
v_mfma_f32_16x16x32_bf16 v[96:99], v[76:79], a[16:19], v[96:99]
v_exp_f32 v210, v210
v_mfma_f32_16x16x32_bf16 v[100:103], v[72:75], a[4:7], 0
ds_read_b128 v[64:67], v7 offset:53248
v_fma_f32 v208, v208, v234, v234
v_mfma_f32_16x16x32_bf16 v[100:103], v[76:79], a[20:23], v[100:103]
v_fma_f32 v210, v210, v234, v234
v_mul_f32 v212, v114, v114
v_mfma_f32_16x16x32_bf16 v[104:107], v[72:75], a[8:11], 0
v_rcp_f32 v208, v208
v_mfma_f32_16x16x32_bf16 v[104:107], v[76:79], a[24:27], v[104:107]
ds_read_b128 v[68:71], v7 offset:54272
v_mul_f32 v209, v209, v208
v_mfma_f32_16x16x32_bf16 v[108:111], v[72:75], a[12:15], 0
v_rcp_f32 v210, v210
v_mfma_f32_16x16x32_bf16 v[108:111], v[76:79], a[28:31], v[108:111]
v_mul_f32 v211, v211, v210
s_waitcnt lgkmcnt(4)
v_mfma_f32_16x16x32_bf16 v[80:83], v[48:51], a[32:35], v[80:83]
v_cvt_pk_bf16_f32 v178, v209, v211
v_mul_f32 v214, v115, v115
v_mfma_f32_16x16x32_bf16 v[80:83], v[52:55], a[48:51], v[80:83]
v_fma_f32 v212, v212, v233, v232
v_fma_f32 v214, v214, v233, v232
v_mfma_f32_16x16x32_bf16 v[84:87], v[48:51], a[36:39], v[84:87]
ds_read_b128 v[72:75], v7 offset:55296
v_mul_f32 v212, v212, v114
v_mfma_f32_16x16x32_bf16 v[84:87], v[52:55], a[52:55], v[84:87]
v_mul_f32 v214, v214, v115
v_mul_f32 v213, v114, v130
v_mfma_f32_16x16x32_bf16 v[88:91], v[48:51], a[40:43], v[88:91]
v_exp_f32 v212, v212
v_mfma_f32_16x16x32_bf16 v[88:91], v[52:55], a[56:59], v[88:91]
ds_read_b128 v[76:79], v7 offset:56320
v_mul_f32 v215, v115, v131
v_mfma_f32_16x16x32_bf16 v[92:95], v[48:51], a[44:47], v[92:95]
v_exp_f32 v214, v214
v_mfma_f32_16x16x32_bf16 v[92:95], v[52:55], a[60:63], v[92:95]
v_fma_f32 v212, v212, v234, v234
s_waitcnt lgkmcnt(4)
v_mfma_f32_16x16x32_bf16 v[96:99], v[56:59], a[32:35], v[96:99]
s_waitcnt vmcnt(26)
v_fma_f32 v214, v214, v234, v234
v_mfma_f32_16x16x32_bf16 v[96:99], v[60:63], a[48:51], v[96:99]
s_barrier
v_mfma_f32_16x16x32_bf16 v[100:103], v[56:59], a[36:39], v[100:103]
ds_read_b128 v[48:51], v7 offset:57344
s_add_u32 m0, s22, 73728
v_mfma_f32_16x16x32_bf16 v[100:103], v[60:63], a[52:55], v[100:103]
v_add_u32 v3, 20480, v3
buffer_load_dwordx4 v3, s[8:11], 0 offen offset:0 sc1 lds
v_mfma_f32_16x16x32_bf16 v[104:107], v[56:59], a[40:43], v[104:107]
v_rcp_f32 v212, v212
v_mfma_f32_16x16x32_bf16 v[104:107], v[60:63], a[56:59], v[104:107]
ds_read_b128 v[52:55], v7 offset:58368
v_mul_f32 v213, v213, v212
v_mfma_f32_16x16x32_bf16 v[108:111], v[56:59], a[44:47], v[108:111]
v_rcp_f32 v214, v214
v_mfma_f32_16x16x32_bf16 v[108:111], v[60:63], a[60:63], v[108:111]
v_mul_f32 v215, v215, v214
s_waitcnt lgkmcnt(4)
v_mfma_f32_16x16x32_bf16 v[80:83], v[64:67], a[64:67], v[80:83]
buffer_load_dwordx4 v3, s[8:11], 0 offen offset:1024 sc1 lds
v_mfma_f32_16x16x32_bf16 v[80:83], v[68:71], a[80:83], v[80:83]
v_cvt_pk_bf16_f32 v179, v213, v215
v_mul_f32 v208, v116, v116
v_mfma_f32_16x16x32_bf16 v[84:87], v[64:67], a[68:71], v[84:87]
ds_read_b128 v[56:59], v7 offset:59392
v_mul_f32 v210, v117, v117
v_mfma_f32_16x16x32_bf16 v[84:87], v[68:71], a[84:87], v[84:87]
buffer_store_dwordx4 v[176:179], v2, s[8:11], s24 offen offset:2048 sc1
v_mfma_f32_16x16x32_bf16 v[88:91], v[64:67], a[72:75], v[88:91]
v_fma_f32 v208, v208, v236, v235
v_fma_f32 v210, v210, v236, v235
v_mfma_f32_16x16x32_bf16 v[88:91], v[68:71], a[88:91], v[88:91]
ds_read_b128 v[60:63], v7 offset:60416
v_mul_f32 v208, v208, v116
v_mfma_f32_16x16x32_bf16 v[92:95], v[64:67], a[76:79], v[92:95]
v_mul_f32 v210, v210, v117
v_mul_f32 v209, v116, v132
v_mfma_f32_16x16x32_bf16 v[92:95], v[68:71], a[92:95], v[92:95]
v_mul_f32 v211, v117, v133
s_waitcnt lgkmcnt(4)
v_mfma_f32_16x16x32_bf16 v[96:99], v[72:75], a[64:67], v[96:99]
buffer_load_dwordx4 v3, s[8:11], 0 offen offset:2048 sc1 lds
v_mfma_f32_16x16x32_bf16 v[96:99], v[76:79], a[80:83], v[96:99]
v_exp_f32 v208, v208
v_mfma_f32_16x16x32_bf16 v[100:103], v[72:75], a[68:71], v[100:103]
ds_read_b128 v[64:67], v7 offset:61440
v_fma_f32 v208, v208, v237, v237
v_mfma_f32_16x16x32_bf16 v[100:103], v[76:79], a[84:87], v[100:103]
v_exp_f32 v210, v210
v_mfma_f32_16x16x32_bf16 v[104:107], v[72:75], a[72:75], v[104:107]
buffer_load_dwordx4 v3, s[8:11], 0 offen offset:3072 sc1 lds
v_mfma_f32_16x16x32_bf16 v[104:107], v[76:79], a[88:91], v[104:107]
ds_read_b128 v[68:71], v7 offset:62464
s_add_u32 m0, s22, 77824
v_mfma_f32_16x16x32_bf16 v[108:111], v[72:75], a[76:79], v[108:111]
v_add_u32 v3, 4096, v3
v_fma_f32 v210, v210, v237, v237
v_mfma_f32_16x16x32_bf16 v[108:111], v[76:79], a[92:95], v[108:111]
v_mul_f32 v212, v118, v118
s_waitcnt lgkmcnt(4)
v_mfma_f32_16x16x32_bf16 v[80:83], v[48:51], a[96:99], v[80:83]
buffer_load_dwordx4 v3, s[8:11], 0 offen offset:0 sc1 lds
v_mfma_f32_16x16x32_bf16 v[80:83], v[52:55], a[112:115], v[80:83]
v_rcp_f32 v208, v208
v_mfma_f32_16x16x32_bf16 v[84:87], v[48:51], a[100:103], v[84:87]
ds_read_b128 v[72:75], v7 offset:63488
v_mul_f32 v209, v209, v208
v_mfma_f32_16x16x32_bf16 v[84:87], v[52:55], a[116:119], v[84:87]
v_rcp_f32 v210, v210
v_mfma_f32_16x16x32_bf16 v[88:91], v[48:51], a[104:107], v[88:91]
buffer_load_dwordx4 v3, s[8:11], 0 offen offset:1024 sc1 lds
v_mfma_f32_16x16x32_bf16 v[88:91], v[52:55], a[120:123], v[88:91]
ds_read_b128 v[76:79], v7 offset:64512
s_add_u32 s23, s34, 0
v_mfma_f32_16x16x32_bf16 v[92:95], v[48:51], a[108:111], v[92:95]
v_mul_f32 v211, v211, v210
v_cvt_pk_bf16_f32 v182, v209, v211
v_mfma_f32_16x16x32_bf16 v[92:95], v[52:55], a[124:127], v[92:95]
v_mul_f32 v214, v119, v119
s_waitcnt lgkmcnt(4)
v_mfma_f32_16x16x32_bf16 v[96:99], v[56:59], a[96:99], v[96:99]
buffer_load_dwordx2 v[14:15], v11, s[8:11], s23 offen sc1
v_mfma_f32_16x16x32_bf16 v[96:99], v[60:63], a[112:115], v[96:99]
v_fma_f32 v212, v212, v236, v235
v_fma_f32 v214, v214, v236, v235
v_mfma_f32_16x16x32_bf16 v[100:103], v[56:59], a[100:103], v[100:103]
ds_read_b128 v[48:51], v8 offset:0
v_mul_f32 v212, v212, v118
v_mfma_f32_16x16x32_bf16 v[100:103], v[60:63], a[116:119], v[100:103]
v_mul_f32 v214, v214, v119
v_mul_f32 v213, v118, v134
v_mfma_f32_16x16x32_bf16 v[104:107], v[56:59], a[104:107], v[104:107]
v_exp_f32 v212, v212
v_mfma_f32_16x16x32_bf16 v[104:107], v[60:63], a[120:123], v[104:107]
ds_read_b128 v[52:55], v8 offset:1024
v_mul_f32 v215, v119, v135
v_mfma_f32_16x16x32_bf16 v[108:111], v[56:59], a[108:111], v[108:111]
v_exp_f32 v214, v214
v_mfma_f32_16x16x32_bf16 v[108:111], v[60:63], a[124:127], v[108:111]
v_fma_f32 v212, v212, v237, v237
s_waitcnt lgkmcnt(4)
v_mfma_f32_16x16x32_bf16 v[80:83], v[64:67], a[128:131], v[80:83]
v_fma_f32 v214, v214, v237, v237
v_mul_f32 v208, v120, v120
v_mfma_f32_16x16x32_bf16 v[80:83], v[68:71], a[144:147], v[80:83]
v_rcp_f32 v212, v212
v_mfma_f32_16x16x32_bf16 v[84:87], v[64:67], a[132:135], v[84:87]
ds_read_b128 v[56:59], v8 offset:2048
v_mul_f32 v213, v213, v212
v_mfma_f32_16x16x32_bf16 v[84:87], v[68:71], a[148:151], v[84:87]
v_rcp_f32 v214, v214
v_mfma_f32_16x16x32_bf16 v[88:91], v[64:67], a[136:139], v[88:91]
v_mul_f32 v215, v215, v214
v_cvt_pk_bf16_f32 v183, v213, v215
v_mfma_f32_16x16x32_bf16 v[88:91], v[68:71], a[152:155], v[88:91]
ds_read_b128 v[60:63], v8 offset:3072
v_mul_f32 v210, v121, v121
v_mfma_f32_16x16x32_bf16 v[92:95], v[64:67], a[140:143], v[92:95]
buffer_store_dwordx4 v[180:183], v4, s[8:11], s24 offen offset:2048 sc1
v_mfma_f32_16x16x32_bf16 v[92:95], v[68:71], a[156:159], v[92:95]
v_fma_f32 v208, v208, v239, v238
s_waitcnt lgkmcnt(4)
v_mfma_f32_16x16x32_bf16 v[96:99], v[72:75], a[128:131], v[96:99]
v_fma_f32 v210, v210, v239, v238
v_mul_f32 v208, v208, v120
v_mfma_f32_16x16x32_bf16 v[96:99], v[76:79], a[144:147], v[96:99]
v_mul_f32 v210, v210, v121
v_mul_f32 v209, v120, v136
v_mfma_f32_16x16x32_bf16 v[100:103], v[72:75], a[132:135], v[100:103]
ds_read_b128 v[64:67], v8 offset:4096
v_mul_f32 v211, v121, v137
v_mfma_f32_16x16x32_bf16 v[100:103], v[76:79], a[148:151], v[100:103]
v_exp_f32 v208, v208
v_mfma_f32_16x16x32_bf16 v[104:107], v[72:75], a[136:139], v[104:107]
v_exp_f32 v210, v210
v_mfma_f32_16x16x32_bf16 v[104:107], v[76:79], a[152:155], v[104:107]
ds_read_b128 v[68:71], v8 offset:5120
v_fma_f32 v208, v208, v240, v240
v_mfma_f32_16x16x32_bf16 v[108:111], v[72:75], a[140:143], v[108:111]
v_fma_f32 v210, v210, v240, v240
v_mul_f32 v212, v122, v122
v_mfma_f32_16x16x32_bf16 v[108:111], v[76:79], a[156:159], v[108:111]
v_mul_f32 v214, v123, v123
s_waitcnt lgkmcnt(4)
v_mfma_f32_16x16x32_bf16 v[80:83], v[48:51], a[160:163], v[80:83]
v_rcp_f32 v208, v208
v_mfma_f32_16x16x32_bf16 v[80:83], v[52:55], a[176:179], v[80:83]
v_rcp_f32 v210, v210
v_mfma_f32_16x16x32_bf16 v[84:87], v[48:51], a[164:167], v[84:87]
ds_read_b128 v[72:75], v8 offset:6144
v_mul_f32 v209, v209, v208
v_mfma_f32_16x16x32_bf16 v[84:87], v[52:55], a[180:183], v[84:87]
v_mul_f32 v211, v211, v210
v_cvt_pk_bf16_f32 v186, v209, v211
v_mfma_f32_16x16x32_bf16 v[88:91], v[48:51], a[168:171], v[88:91]
v_fma_f32 v212, v212, v239, v238
v_fma_f32 v214, v214, v239, v238
v_mfma_f32_16x16x32_bf16 v[88:91], v[52:55], a[184:187], v[88:91]
ds_read_b128 v[76:79], v8 offset:7168
v_mul_f32 v212, v212, v122
v_mfma_f32_16x16x32_bf16 v[92:95], v[48:51], a[172:175], v[92:95]
v_mul_f32 v214, v214, v123
v_mul_f32 v213, v122, v138
v_mfma_f32_16x16x32_bf16 v[92:95], v[52:55], a[188:191], v[92:95]
v_mul_f32 v215, v123, v139
s_waitcnt lgkmcnt(4)
v_mfma_f32_16x16x32_bf16 v[96:99], v[56:59], a[160:163], v[96:99]
v_exp_f32 v212, v212
v_mfma_f32_16x16x32_bf16 v[96:99], v[60:63], a[176:179], v[96:99]
v_exp_f32 v214, v214
v_mfma_f32_16x16x32_bf16 v[100:103], v[56:59], a[164:167], v[100:103]
ds_read_b128 v[48:51], v8 offset:8192
v_fma_f32 v212, v212, v240, v240
v_mfma_f32_16x16x32_bf16 v[100:103], v[60:63], a[180:183], v[100:103]
v_fma_f32 v214, v214, v240, v240
v_mul_f32 v208, v124, v124
v_mfma_f32_16x16x32_bf16 v[104:107], v[56:59], a[168:171], v[104:107]
v_rcp_f32 v212, v212
v_mfma_f32_16x16x32_bf16 v[104:107], v[60:63], a[184:187], v[104:107]
ds_read_b128 v[52:55], v8 offset:9216
v_mfma_f32_16x16x32_bf16 v[108:111], v[56:59], a[172:175], v[108:111]
v_rcp_f32 v214, v214
v_mfma_f32_16x16x32_bf16 v[108:111], v[60:63], a[188:191], v[108:111]
s_waitcnt lgkmcnt(4)
v_mfma_f32_16x16x32_bf16 v[80:83], v[64:67], a[192:195], v[80:83]
v_mul_f32 v213, v213, v212
v_mul_f32 v215, v215, v214
v_mfma_f32_16x16x32_bf16 v[80:83], v[68:71], a[208:211], v[80:83]
v_cvt_pk_bf16_f32 v187, v213, v215
v_mul_f32 v210, v125, v125
v_mfma_f32_16x16x32_bf16 v[84:87], v[64:67], a[196:199], v[84:87]
ds_read_b128 v[56:59], v8 offset:10240
v_mfma_f32_16x16x32_bf16 v[84:87], v[68:71], a[212:215], v[84:87]
buffer_store_dwordx4 v[184:187], v5, s[8:11], s24 offen offset:2048 sc1
v_mfma_f32_16x16x32_bf16 v[88:91], v[64:67], a[200:203], v[88:91]
v_mfma_f32_16x16x32_bf16 v[88:91], v[68:71], a[216:219], v[88:91]
ds_read_b128 v[60:63], v8 offset:11264
v_fma_f32 v208, v208, v242, v241
v_mfma_f32_16x16x32_bf16 v[92:95], v[64:67], a[204:207], v[92:95]
v_fma_f32 v210, v210, v242, v241
v_mul_f32 v208, v208, v124
v_mfma_f32_16x16x32_bf16 v[92:95], v[68:71], a[220:223], v[92:95]
v_mul_f32 v210, v210, v125
s_waitcnt lgkmcnt(4)
v_mfma_f32_16x16x32_bf16 v[96:99], v[72:75], a[192:195], v[96:99]
v_exp_f32 v208, v208
v_mfma_f32_16x16x32_bf16 v[96:99], v[76:79], a[208:211], v[96:99]
v_mfma_f32_16x16x32_bf16 v[100:103], v[72:75], a[196:199], v[100:103]
ds_read_b128 v[64:67], v8 offset:12288
v_mul_f32 v209, v124, v140
v_mfma_f32_16x16x32_bf16 v[100:103], v[76:79], a[212:215], v[100:103]
v_exp_f32 v210, v210
v_mfma_f32_16x16x32_bf16 v[104:107], v[72:75], a[200:203], v[104:107]
v_mfma_f32_16x16x32_bf16 v[104:107], v[76:79], a[216:219], v[104:107]
ds_read_b128 v[68:71], v8 offset:13312
v_mul_f32 v211, v125, v141
v_mfma_f32_16x16x32_bf16 v[108:111], v[72:75], a[204:207], v[108:111]
v_fma_f32 v208, v208, v243, v243
v_fma_f32 v210, v210, v243, v243
v_mfma_f32_16x16x32_bf16 v[108:111], v[76:79], a[220:223], v[108:111]
v_mul_f32 v212, v126, v126
s_waitcnt lgkmcnt(4)
v_mfma_f32_16x16x32_bf16 v[80:83], v[48:51], a[224:227], v[80:83]
v_rcp_f32 v208, v208
v_mfma_f32_16x16x32_bf16 v[80:83], v[52:55], a[240:243], v[80:83]
v_mfma_f32_16x16x32_bf16 v[84:87], v[48:51], a[228:231], v[84:87]
ds_read_b128 v[72:75], v8 offset:14336
v_mul_f32 v209, v209, v208
v_mfma_f32_16x16x32_bf16 v[84:87], v[52:55], a[244:247], v[84:87]
v_rcp_f32 v210, v210
v_mfma_f32_16x16x32_bf16 v[88:91], v[48:51], a[232:235], v[88:91]
v_mul_f32 v211, v211, v210
v_cvt_pk_bf16_f32 v190, v209, v211
v_mfma_f32_16x16x32_bf16 v[88:91], v[52:55], a[248:251], v[88:91]
ds_read_b128 v[76:79], v8 offset:15360
v_mfma_f32_16x16x32_bf16 v[92:95], v[48:51], a[236:239], v[92:95]
v_mul_f32 v214, v127, v127
v_fma_f32 v212, v212, v242, v241
v_mfma_f32_16x16x32_bf16 v[92:95], v[52:55], a[252:255], v[92:95]
s_waitcnt lgkmcnt(4)
v_mfma_f32_16x16x32_bf16 v[96:99], v[56:59], a[224:227], v[96:99]
s_waitcnt vmcnt(28)
v_fma_f32 v214, v214, v242, v241
v_mfma_f32_16x16x32_bf16 v[96:99], v[60:63], a[240:243], v[96:99]
s_barrier
v_mfma_f32_16x16x32_bf16 v[100:103], v[56:59], a[228:231], v[100:103]
ds_read_b128 v[48:51], v2 offset:0
s_add_u32 m0, s22, 98304
v_mfma_f32_16x16x32_bf16 v[100:103], v[60:63], a[244:247], v[100:103]
v_add_u32 v3, 20480, v3
buffer_load_dwordx4 v3, s[8:11], 0 offen offset:0 sc1 lds
v_mfma_f32_16x16x32_bf16 v[104:107], v[56:59], a[232:235], v[104:107]
v_mul_f32 v212, v212, v126
v_mul_f32 v214, v214, v127
v_mfma_f32_16x16x32_bf16 v[104:107], v[60:63], a[248:251], v[104:107]
ds_read_b128 v[52:55], v2 offset:1024
v_mul_f32 v213, v126, v142
v_mfma_f32_16x16x32_bf16 v[108:111], v[56:59], a[236:239], v[108:111]
v_exp_f32 v212, v212
v_mfma_f32_16x16x32_bf16 v[108:111], v[60:63], a[252:255], v[108:111]
v_mul_f32 v215, v127, v143
s_waitcnt lgkmcnt(4)
v_mfma_f32_16x16x32_bf16 v[80:83], v[64:67], v[16:19], v[80:83]
buffer_load_dwordx4 v3, s[8:11], 0 offen offset:1024 sc1 lds
v_mfma_f32_16x16x32_bf16 v[80:83], v[68:71], v[32:35], v[80:83]
v_exp_f32 v214, v214
v_mfma_f32_16x16x32_bf16 v[84:87], v[64:67], v[20:23], v[84:87]
ds_read_b128 v[56:59], v2 offset:2048
v_fma_f32 v212, v212, v243, v243
v_mfma_f32_16x16x32_bf16 v[84:87], v[68:71], v[36:39], v[84:87]
v_fma_f32 v214, v214, v243, v243
v_mfma_f32_16x16x32_bf16 v[88:91], v[64:67], v[24:27], v[88:91]
buffer_load_dwordx4 v3, s[8:11], 0 offen offset:2048 sc1 lds
v_mfma_f32_16x16x32_bf16 v[88:91], v[68:71], v[40:43], v[88:91]
ds_read_b128 v[60:63], v2 offset:3072
v_mfma_f32_16x16x32_bf16 v[92:95], v[64:67], v[28:31], v[92:95]
v_rcp_f32 v212, v212
v_mfma_f32_16x16x32_bf16 v[92:95], v[68:71], v[44:47], v[92:95]
v_mul_f32 v213, v213, v212
s_waitcnt lgkmcnt(4)
v_mfma_f32_16x16x32_bf16 v[96:99], v[72:75], v[16:19], v[96:99]
buffer_load_dwordx4 v3, s[8:11], 0 offen offset:3072 sc1 lds
v_mfma_f32_16x16x32_bf16 v[96:99], v[76:79], v[32:35], v[96:99]
s_add_u32 m0, s22, 102400
v_add_u32 v3, 4096, v3
v_mfma_f32_16x16x32_bf16 v[100:103], v[72:75], v[20:23], v[100:103]
ds_read_b128 v[64:67], v2 offset:4096
v_mfma_f32_16x16x32_bf16 v[100:103], v[76:79], v[36:39], v[100:103]
v_rcp_f32 v214, v214
v_mfma_f32_16x16x32_bf16 v[104:107], v[72:75], v[24:27], v[104:107]
buffer_load_dwordx4 v3, s[8:11], 0 offen offset:0 sc1 lds
v_mul_f32 v215, v215, v214
v_mfma_f32_16x16x32_bf16 v[104:107], v[76:79], v[40:43], v[104:107]
ds_read_b128 v[68:71], v2 offset:5120
v_cvt_pk_bf16_f32 v191, v213, v215
v_mfma_f32_16x16x32_bf16 v[108:111], v[72:75], v[28:31], v[108:111]
buffer_store_dwordx4 v[188:191], v6, s[8:11], s24 offen offset:2048 sc1
v_mfma_f32_16x16x32_bf16 v[108:111], v[76:79], v[44:47], v[108:111]
s_waitcnt lgkmcnt(4)
v_mfma_f32_16x16x32_bf16 v[112:115], v[48:51], a[0:3], 0
v_mfma_f32_16x16x32_bf16 v[112:115], v[52:55], a[16:19], v[112:115]
v_mfma_f32_16x16x32_bf16 v[116:119], v[48:51], a[4:7], 0
ds_read_b128 v[72:75], v2 offset:6144
v_mfma_f32_16x16x32_bf16 v[116:119], v[52:55], a[20:23], v[116:119]
buffer_load_dwordx4 v3, s[8:11], 0 offen offset:1024 sc1 lds
v_mfma_f32_16x16x32_bf16 v[120:123], v[48:51], a[8:11], 0
s_waitcnt vmcnt(9)
v_cmp_eq_u64 vcc, s[68:69], v[14:15]
s_nop 0
s_cmp_eq_u64 vcc, exec
s_cbranch_scc0 L_f_slow1
L_f_back1:
v_mul_f32 v208, v80, v80
v_mfma_f32_16x16x32_bf16 v[120:123], v[52:55], a[24:27], v[120:123]
ds_read_b128 v[76:79], v2 offset:7168
v_mul_f32 v210, v81, v81
v_mfma_f32_16x16x32_bf16 v[124:127], v[48:51], a[12:15], 0
v_fma_f32 v208, v208, v233, v232
v_fma_f32 v210, v210, v233, v232
v_mfma_f32_16x16x32_bf16 v[124:127], v[52:55], a[28:31], v[124:127]
v_mul_f32 v208, v208, v80
s_waitcnt lgkmcnt(4)
v_mfma_f32_16x16x32_bf16 v[128:131], v[56:59], a[0:3], 0
v_mul_f32 v210, v210, v81
v_mul_f32 v209, v80, v96
v_mfma_f32_16x16x32_bf16 v[128:131], v[60:63], a[16:19], v[128:131]
v_exp_f32 v208, v208
v_mfma_f32_16x16x32_bf16 v[132:135], v[56:59], a[4:7], 0
ds_read_b128 v[48:51], v2 offset:8192
v_mul_f32 v211, v81, v97
v_mfma_f32_16x16x32_bf16 v[132:135], v[60:63], a[20:23], v[132:135]
v_exp_f32 v210, v210
v_mfma_f32_16x16x32_bf16 v[136:139], v[56:59], a[8:11], 0
v_fma_f32 v208, v208, v234, v234
v_fma_f32 v210, v210, v234, v234
v_mfma_f32_16x16x32_bf16 v[136:139], v[60:63], a[24:27], v[136:139]
ds_read_b128 v[52:55], v2 offset:9216
v_mul_f32 v212, v82, v82
v_mfma_f32_16x16x32_bf16 v[140:143], v[56:59], a[12:15], 0
v_rcp_f32 v208, v208
v_mfma_f32_16x16x32_bf16 v[140:143], v[60:63], a[28:31], v[140:143]
v_mul_f32 v209, v209, v208
s_waitcnt lgkmcnt(4)
v_mfma_f32_16x16x32_bf16 v[112:115], v[64:67], a[32:35], v[112:115]
v_rcp_f32 v210, v210
v_mfma_f32_16x16x32_bf16 v[112:115], v[68:71], a[48:51], v[112:115]
v_mul_f32 v211, v211, v210
v_cvt_pk_bf16_f32 v192, v209, v211
v_mfma_f32_16x16x32_bf16 v[116:119], v[64:67], a[36:39], v[116:119]
ds_read_b128 v[56:59], v2 offset:10240
v_mul_f32 v214, v83, v83
v_mfma_f32_16x16x32_bf16 v[116:119], v[68:71], a[52:55], v[116:119]
v_fma_f32 v212, v212, v233, v232
v_fma_f32 v214, v214, v233, v232
v_mfma_f32_16x16x32_bf16 v[120:123], v[64:67], a[40:43], v[120:123]
v_mul_f32 v212, v212, v82
v_mul_f32 v214, v214, v83
v_mfma_f32_16x16x32_bf16 v[120:123], v[68:71], a[56:59], v[120:123]
ds_read_b128 v[60:63], v2 offset:11264
v_mul_f32 v213, v82, v98
v_mfma_f32_16x16x32_bf16 v[124:127], v[64:67], a[44:47], v[124:127]
v_exp_f32 v212, v212
v_mfma_f32_16x16x32_bf16 v[124:127], v[68:71], a[60:63], v[124:127]
v_mul_f32 v215, v83, v99
s_waitcnt lgkmcnt(4)
v_mfma_f32_16x16x32_bf16 v[128:131], v[72:75], a[32:35], v[128:131]
buffer_load_dwordx4 a[0:3], v2, s[8:11], s25 offen offset:0 sc1
v_mfma_f32_16x16x32_bf16 v[128:131], v[76:79], a[48:51], v[128:131]
v_exp_f32 v214, v214
v_mfma_f32_16x16x32_bf16 v[132:135], v[72:75], a[36:39], v[132:135]
ds_read_b128 v[64:67], v2 offset:12288
v_fma_f32 v212, v212, v234, v234
v_mfma_f32_16x16x32_bf16 v[132:135], v[76:79], a[52:55], v[132:135]
v_fma_f32 v214, v214, v234, v234
v_mul_f32 v208, v84, v84
v_mfma_f32_16x16x32_bf16 v[136:139], v[72:75], a[40:43], v[136:139]
buffer_load_dwordx4 a[4:7], v4, s[8:11], s25 offen offset:0 sc1
v_mfma_f32_16x16x32_bf16 v[136:139], v[76:79], a[56:59], v[136:139]
ds_read_b128 v[68:71], v2 offset:13312
v_mul_f32 v210, v85, v85
v_mfma_f32_16x16x32_bf16 v[140:143], v[72:75], a[44:47], v[140:143]
v_rcp_f32 v212, v212
v_mfma_f32_16x16x32_bf16 v[140:143], v[76:79], a[60:63], v[140:143]
v_mul_f32 v213, v213, v212
s_waitcnt lgkmcnt(4)
v_mfma_f32_16x16x32_bf16 v[112:115], v[48:51], a[64:67], v[112:115]
buffer_load_dwordx4 a[8:11], v5, s[8:11], s25 offen offset:0 sc1
v_mfma_f32_16x16x32_bf16 v[112:115], v[52:55], a[80:83], v[112:115]
v_rcp_f32 v214, v214
v_mfma_f32_16x16x32_bf16 v[116:119], v[48:51], a[68:71], v[116:119]
ds_read_b128 v[72:75], v2 offset:14336
v_mul_f32 v215, v215, v214
v_mfma_f32_16x16x32_bf16 v[116:119], v[52:55], a[84:87], v[116:119]
v_cvt_pk_bf16_f32 v193, v213, v215
v_fma_f32 v208, v208, v236, v235
v_mfma_f32_16x16x32_bf16 v[120:123], v[48:51], a[72:75], v[120:123]
buffer_load_dwordx4 a[12:15], v6, s[8:11], s25 offen offset:0 sc1
v_mfma_f32_16x16x32_bf16 v[120:123], v[52:55], a[88:91], v[120:123]
ds_read_b128 v[76:79], v2 offset:15360
v_fma_f32 v210, v210, v236, v235
v_mfma_f32_16x16x32_bf16 v[124:127], v[48:51], a[76:79], v[124:127]
v_mul_f32 v208, v208, v84
v_mul_f32 v210, v210, v85
v_mfma_f32_16x16x32_bf16 v[124:127], v[52:55], a[92:95], v[124:127]
v_mul_f32 v209, v84, v100
s_waitcnt lgkmcnt(4)
v_mfma_f32_16x16x32_bf16 v[128:131], v[56:59], a[64:67], v[128:131]
v_exp_f32 v208, v208
v_mfma_f32_16x16x32_bf16 v[128:131], v[60:63], a[80:83], v[128:131]
v_exp_f32 v210, v210
v_mfma_f32_16x16x32_bf16 v[132:135], v[56:59], a[68:71], v[132:135]
ds_read_b128 v[48:51], v2 offset:16384
v_mul_f32 v211, v85, v101
v_mfma_f32_16x16x32_bf16 v[132:135], v[60:63], a[84:87], v[132:135]
v_fma_f32 v208, v208, v237, v237
v_fma_f32 v210, v210, v237, v237
v_mfma_f32_16x16x32_bf16 v[136:139], v[56:59], a[72:75], v[136:139]
v_rcp_f32 v208, v208
v_mfma_f32_16x16x32_bf16 v[136:139], v[60:63], a[88:91], v[136:139]
ds_read_b128 v[52:55], v2 offset:17408
v_mul_f32 v209, v209, v208
v_mfma_f32_16x16x32_bf16 v[140:143], v[56:59], a[76:79], v[140:143]
v_rcp_f32 v210, v210
v_mfma_f32_16x16x32_bf16 v[140:143], v[60:63], a[92:95], v[140:143]
v_mul_f32 v211, v211, v210
s_waitcnt lgkmcnt(4)
v_mfma_f32_16x16x32_bf16 v[112:115], v[64:67], a[96:99], v[112:115]
v_mov_b32 v12, s68
v_mov_b32 v13, s69
v_mfma_f32_16x16x32_bf16 v[112:115], v[68:71], a[112:115], v[112:115]
s_add_u32 s53, s34, 131072
s_waitcnt vmcnt(5)
buffer_store_dwordx2 v[12:13], v10, s[8:11], s53 offen sc1
v_mfma_f32_16x16x32_bf16 v[116:119], v[64:67], a[100:103], v[116:119]
ds_read_b128 v[56:59], v2 offset:18432
v_cvt_pk_bf16_f32 v196, v209, v211
v_mfma_f32_16x16x32_bf16 v[116:119], v[68:71], a[116:119], v[116:119]
v_mul_f32 v212, v86, v86
v_mul_f32 v214, v87, v87
v_mfma_f32_16x16x32_bf16 v[120:123], v[64:67], a[104:107], v[120:123]
v_fma_f32 v212, v212, v236, v235
v_fma_f32 v214, v214, v236, v235
v_mfma_f32_16x16x32_bf16 v[120:123], v[68:71], a[120:123], v[120:123]
ds_read_b128 v[60:63], v2 offset:19456
v_mul_f32 v212, v212, v86
v_mfma_f32_16x16x32_bf16 v[124:127], v[64:67], a[108:111], v[124:127]
buffer_load_dwordx4 a[16:19], v2, s[8:11], s26 offen offset:0 sc1
v_mfma_f32_16x16x32_bf16 v[124:127], v[68:71], a[124:127], v[124:127]
v_mul_f32 v214, v214, v87
s_waitcnt lgkmcnt(4)
v_mfma_f32_16x16x32_bf16 v[128:131], v[72:75], a[96:99], v[128:131]
v_exp_f32 v212, v212
v_mfma_f32_16x16x32_bf16 v[128:131], v[76:79], a[112:115], v[128:131]
v_exp_f32 v214, v214
v_mfma_f32_16x16x32_bf16 v[132:135], v[72:75], a[100:103], v[132:135]
ds_read_b128 v[64:67], v2 offset:20480
v_mul_f32 v213, v86, v102
v_mfma_f32_16x16x32_bf16 v[132:135], v[76:79], a[116:119], v[132:135]
buffer_load_dwordx4 a[20:23], v4, s[8:11], s26 offen offset:0 sc1
v_mfma_f32_16x16x32_bf16 v[136:139], v[72:75], a[104:107], v[136:139]
v_mul_f32 v215, v87, v103
v_fma_f32 v212, v212, v237, v237
v_mfma_f32_16x16x32_bf16 v[136:139], v[76:79], a[120:123], v[136:139]
ds_read_b128 v[68:71], v2 offset:21504
v_fma_f32 v214, v214, v237, v237
v_mfma_f32_16x16x32_bf16 v[140:143], v[72:75], a[108:111], v[140:143]
v_rcp_f32 v212, v212
v_mfma_f32_16x16x32_bf16 v[140:143], v[76:79], a[124:127], v[140:143]
v_mul_f32 v213, v213, v212
s_waitcnt lgkmcnt(4)
v_mfma_f32_16x16x32_bf16 v[112:115], v[48:51], a[128:131], v[112:115]
buffer_load_dwordx4 a[24:27], v5, s[8:11], s26 offen offset:0 sc1
v_mfma_f32_16x16x32_bf16 v[112:115], v[52:55], a[144:147], v[112:115]
v_rcp_f32 v214, v214
v_mfma_f32_16x16x32_bf16 v[116:119], v[48:51], a[132:135], v[116:119]
ds_read_b128 v[72:75], v2 offset:22528
v_mul_f32 v215, v215, v214
v_mfma_f32_16x16x32_bf16 v[116:119], v[52:55], a[148:151], v[116:119]
v_cvt_pk_bf16_f32 v197, v213, v215
v_mul_f32 v208, v88, v88
v_mfma_f32_16x16x32_bf16 v[120:123], v[48:51], a[136:139], v[120:123]
buffer_load_dwordx4 a[28:31], v6, s[8:11], s26 offen offset:0 sc1
v_mfma_f32_16x16x32_bf16 v[120:123], v[52:55], a[152:155], v[120:123]
ds_read_b128 v[76:79], v2 offset:23552
v_mul_f32 v210, v89, v89
v_mfma_f32_16x16x32_bf16 v[124:127], v[48:51], a[140:143], v[124:127]
v_fma_f32 v208, v208, v239, v238
v_fma_f32 v210, v210, v239, v238
v_mfma_f32_16x16x32_bf16 v[124:127], v[52:55], a[156:159], v[124:127]
v_mul_f32 v208, v208, v88
s_waitcnt lgkmcnt(4)
v_mfma_f32_16x16x32_bf16 v[128:131], v[56:59], a[128:131], v[128:131]
s_waitcnt vmcnt(34)
v_mul_f32 v210, v210, v89
v_mfma_f32_16x16x32_bf16 v[128:131], v[60:63], a[144:147], v[128:131]
s_barrier
v_mfma_f32_16x16x32_bf16 v[132:135], v[56:59], a[132:135], v[132:135]
ds_read_b128 v[48:51], v2 offset:24576
v_mul_f32 v209, v88, v104
v_mfma_f32_16x16x32_bf16 v[132:135], v[60:63], a[148:151], v[132:135]
buffer_load_dwordx4 a[32:35], v2, s[8:11], s27 offen offset:0 sc1
v_mfma_f32_16x16x32_bf16 v[136:139], v[56:59], a[136:139], v[136:139]
v_exp_f32 v208, v208
v_mfma_f32_16x16x32_bf16 v[136:139], v[60:63], a[152:155], v[136:139]
ds_read_b128 v[52:55], v2 offset:25600
v_mul_f32 v211, v89, v105
v_mfma_f32_16x16x32_bf16 v[140:143], v[56:59], a[140:143], v[140:143]
v_exp_f32 v210, v210
v_mfma_f32_16x16x32_bf16 v[140:143], v[60:63], a[156:159], v[140:143]
v_fma_f32 v208, v208, v240, v240
s_waitcnt lgkmcnt(4)
v_mfma_f32_16x16x32_bf16 v[112:115], v[64:67], a[160:163], v[112:115]
buffer_load_dwordx4 a[36:39], v4, s[8:11], s27 offen offset:0 sc1
v_mfma_f32_16x16x32_bf16 v[112:115], v[68:71], a[176:179], v[112:115]
v_fma_f32 v210, v210, v240, v240
v_mul_f32 v212, v90, v90
v_mfma_f32_16x16x32_bf16 v[116:119], v[64:67], a[164:167], v[116:119]
ds_read_b128 v[56:59], v2 offset:26624
v_mul_f32 v214, v91, v91
v_mfma_f32_16x16x32_bf16 v[116:119], v[68:71], a[180:183], v[116:119]
v_rcp_f32 v208, v208
v_mfma_f32_16x16x32_bf16 v[120:123], v[64:67], a[168:171], v[120:123]
buffer_load_dwordx4 a[40:43], v5, s[8:11], s27 offen offset:0 sc1
v_mfma_f32_16x16x32_bf16 v[120:123], v[68:71], a[184:187], v[120:123]
ds_read_b128 v[60:63], v2 offset:27648
v_mul_f32 v209, v209, v208
v_mfma_f32_16x16x32_bf16 v[124:127], v[64:67], a[172:175], v[124:127]
v_rcp_f32 v210, v210
v_mfma_f32_16x16x32_bf16 v[124:127], v[68:71], a[188:191], v[124:127]
v_mul_f32 v211, v211, v210
s_waitcnt lgkmcnt(4)
v_mfma_f32_16x16x32_bf16 v[128:131], v[72:75], a[160:163], v[128:131]
buffer_load_dwordx4 a[44:47], v6, s[8:11], s27 offen offset:0 sc1
v_mfma_f32_16x16x32_bf16 v[128:131], v[76:79], a[176:179], v[128:131]
s_add_u32 m0, s22, 122880
v_add_u32 v3, 20480, v3
v_mfma_f32_16x16x32_bf16 v[132:135], v[72:75], a[164:167], v[132:135]
ds_read_b128 v[64:67], v2 offset:28672
v_cvt_pk_bf16_f32 v200, v209, v211
v_mfma_f32_16x16x32_bf16 v[132:135], v[76:79], a[180:183], v[132:135]
v_fma_f32 v212, v212, v239, v238
v_fma_f32 v214, v214, v239, v238
v_mfma_f32_16x16x32_bf16 v[136:139], v[72:75], a[168:171], v[136:139]
buffer_load_dwordx4 v3, s[8:11], 0 offen offset:0 sc1 lds
v_mfma_f32_16x16x32_bf16 v[136:139], v[76:79], a[184:187], v[136:139]
ds_read_b128 v[68:71], v2 offset:29696
v_mul_f32 v212, v212, v90
v_mfma_f32_16x16x32_bf16 v[140:143], v[72:75], a[172:175], v[140:143]
v_mul_f32 v214, v214, v91
v_mul_f32 v213, v90, v106
v_mfma_f32_16x16x32_bf16 v[140:143], v[76:79], a[188:191], v[140:143]
v_mul_f32 v215, v91, v107
s_waitcnt lgkmcnt(4)
v_mfma_f32_16x16x32_bf16 v[112:115], v[48:51], a[192:195], v[112:115]
buffer_load_dwordx4 v3, s[8:11], 0 offen offset:1024 sc1 lds
v_mfma_f32_16x16x32_bf16 v[112:115], v[52:55], a[208:211], v[112:115]
v_exp_f32 v212, v212
v_mfma_f32_16x16x32_bf16 v[116:119], v[48:51], a[196:199], v[116:119]
ds_read_b128 v[72:75], v2 offset:30720
v_fma_f32 v212, v212, v240, v240
v_mfma_f32_16x16x32_bf16 v[116:119], v[52:55], a[212:215], v[116:119]
v_exp_f32 v214, v214
v_mfma_f32_16x16x32_bf16 v[120:123], v[48:51], a[200:203], v[120:123]
buffer_load_dwordx4 v3, s[8:11], 0 offen offset:2048 sc1 lds
v_mfma_f32_16x16x32_bf16 v[120:123], v[52:55], a[216:219], v[120:123]
ds_read_b128 v[76:79], v2 offset:31744
v_fma_f32 v214, v214, v240, v240
v_mfma_f32_16x16x32_bf16 v[124:127], v[48:51], a[204:207], v[124:127]
v_rcp_f32 v212, v212
v_mfma_f32_16x16x32_bf16 v[124:127], v[52:55], a[220:223], v[124:127]
v_mul_f32 v213, v213, v212
s_waitcnt lgkmcnt(4)
v_mfma_f32_16x16x32_bf16 v[128:131], v[56:59], a[192:195], v[128:131]
buffer_load_dwordx4 v3, s[8:11], 0 offen offset:3072 sc1 lds
v_mfma_f32_16x16x32_bf16 v[128:131], v[60:63], a[208:211], v[128:131]
s_add_u32 m0, s22, 126976
v_add_u32 v3, 4096, v3
v_mfma_f32_16x16x32_bf16 v[132:135], v[56:59], a[196:199], v[132:135]
ds_read_b128 v[48:51], v2 offset:32768
v_mul_f32 v208, v92, v92
v_mfma_f32_16x16x32_bf16 v[132:135], v[60:63], a[212:215], v[132:135]
v_rcp_f32 v214, v214
v_mfma_f32_16x16x32_bf16 v[136:139], v[56:59], a[200:203], v[136:139]
buffer_load_dwordx4 v3, s[8:11], 0 offen offset:0 sc1 lds
v_mfma_f32_16x16x32_bf16 v[136:139], v[60:63], a[216:219], v[136:139]
ds_read_b128 v[52:55], v2 offset:33792
v_mul_f32 v215, v215, v214
v_mfma_f32_16x16x32_bf16 v[140:143], v[56:59], a[204:207], v[140:143]
v_cvt_pk_bf16_f32 v201, v213, v215
v_mul_f32 v210, v93, v93
v_mfma_f32_16x16x32_bf16 v[140:143], v[60:63], a[220:223], v[140:143]
v_fma_f32 v208, v208, v242, v241
s_waitcnt lgkmcnt(4)
v_mfma_f32_16x16x32_bf16 v[112:115], v[64:67], a[224:227], v[112:115]
buffer_load_dwordx4 v3, s[8:11], 0 offen offset:1024 sc1 lds
v_mfma_f32_16x16x32_bf16 v[112:115], v[68:71], a[240:243], v[112:115]
v_fma_f32 v210, v210, v242, v241
v_mul_f32 v208, v208, v92
v_mfma_f32_16x16x32_bf16 v[116:119], v[64:67], a[228:231], v[116:119]
ds_read_b128 v[56:59], v2 offset:34816
v_mul_f32 v210, v210, v93
v_mfma_f32_16x16x32_bf16 v[116:119], v[68:71], a[244:247], v[116:119]
v_exp_f32 v208, v208
v_mfma_f32_16x16x32_bf16 v[120:123], v[64:67], a[232:235], v[120:123]
buffer_load_dwordx4 a[48:51], v2, s[8:11], s25 offen offset:1024 sc1
v_mfma_f32_16x16x32_bf16 v[120:123], v[68:71], a[248:251], v[120:123]
ds_read_b128 v[60:63], v2 offset:35840
v_mul_f32 v209, v92, v108
v_mfma_f32_16x16x32_bf16 v[124:127], v[64:67], a[236:239], v[124:127]
v_exp_f32 v210, v210
v_mfma_f32_16x16x32_bf16 v[124:127], v[68:71], a[252:255], v[124:127]
v_mul_f32 v211, v93, v109
s_waitcnt lgkmcnt(4)
v_mfma_f32_16x16x32_bf16 v[128:131], v[72:75], a[224:227], v[128:131]
buffer_load_dwordx4 a[52:55], v4, s[8:11], s25 offen offset:1024 sc1
v_mfma_f32_16x16x32_bf16 v[128:131], v[76:79], a[240:243], v[128:131]
v_fma_f32 v208, v208, v243, v243
v_fma_f32 v210, v210, v243, v243
v_mfma_f32_16x16x32_bf16 v[132:135], v[72:75], a[228:231], v[132:135]
ds_read_b128 v[64:67], v2 offset:36864
v_mul_f32 v212, v94, v94
v_mfma_f32_16x16x32_bf16 v[132:135], v[76:79], a[244:247], v[132:135]
v_rcp_f32 v208, v208
v_mfma_f32_16x16x32_bf16 v[136:139], v[72:75], a[232:235], v[136:139]
buffer_load_dwordx4 a[56:59], v5, s[8:11], s25 offen offset:1024 sc1
v_mfma_f32_16x16x32_bf16 v[136:139], v[76:79], a[248:251], v[136:139]
ds_read_b128 v[68:71], v2 offset:37888
v_mul_f32 v209, v209, v208
v_mfma_f32_16x16x32_bf16 v[140:143], v[72:75], a[236:239], v[140:143]
v_rcp_f32 v210, v210
v_mfma_f32_16x16x32_bf16 v[140:143], v[76:79], a[252:255], v[140:143]
v_mul_f32 v211, v211, v210
s_waitcnt lgkmcnt(4)
v_mfma_f32_16x16x32_bf16 v[112:115], v[48:51], v[16:19], v[112:115]
buffer_load_dwordx4 a[60:63], v6, s[8:11], s25 offen offset:1024 sc1
v_mfma_f32_16x16x32_bf16 v[112:115], v[52:55], v[32:35], v[112:115]
v_cvt_pk_bf16_f32 v204, v209, v211
v_mul_f32 v214, v95, v95
v_mfma_f32_16x16x32_bf16 v[116:119], v[48:51], v[20:23], v[116:119]
ds_read_b128 v[72:75], v2 offset:38912
v_fma_f32 v212, v212, v242, v241
v_mfma_f32_16x16x32_bf16 v[116:119], v[52:55], v[36:39], v[116:119]
v_fma_f32 v214, v214, v242, v241
v_mul_f32 v212, v212, v94
v_mfma_f32_16x16x32_bf16 v[120:123], v[48:51], v[24:27], v[120:123]
buffer_load_dwordx4 a[64:67], v2, s[8:11], s26 offen offset:1024 sc1
v_mfma_f32_16x16x32_bf16 v[120:123], v[52:55], v[40:43], v[120:123]
ds_read_b128 v[76:79], v2 offset:39936
v_mul_f32 v214, v214, v95
v_mfma_f32_16x16x32_bf16 v[124:127], v[48:51], v[28:31], v[124:127]
v_exp_f32 v212, v212
v_mfma_f32_16x16x32_bf16 v[124:127], v[52:55], v[44:47], v[124:127]
v_mul_f32 v213, v94, v110
s_waitcnt lgkmcnt(4)
v_mfma_f32_16x16x32_bf16 v[128:131], v[56:59], v[16:19], v[128:131]
buffer_load_dwordx4 a[68:71], v4, s[8:11], s26 offen offset:1024 sc1
v_mfma_f32_16x16x32_bf16 v[128:131], v[60:63], v[32:35], v[128:131]
v_exp_f32 v214, v214
v_mfma_f32_16x16x32_bf16 v[132:135], v[56:59], v[20:23], v[132:135]
ds_read_b128 v[48:51], v2 offset:40960
v_mul_f32 v215, v95, v111
v_mfma_f32_16x16x32_bf16 v[132:135], v[60:63], v[36:39], v[132:135]
v_fma_f32 v212, v212, v243, v243
v_fma_f32 v214, v214, v243, v243
v_mfma_f32_16x16x32_bf16 v[136:139], v[56:59], v[24:27], v[136:139]
buffer_load_dwordx4 a[72:75], v5, s[8:11], s26 offen offset:1024 sc1
v_mfma_f32_16x16x32_bf16 v[136:139], v[60:63], v[40:43], v[136:139]
ds_read_b128 v[52:55], v2 offset:41984
v_mfma_f32_16x16x32_bf16 v[140:143], v[56:59], v[28:31], v[140:143]
v_rcp_f32 v212, v212
v_mfma_f32_16x16x32_bf16 v[140:143], v[60:63], v[44:47], v[140:143]
v_mul_f32 v213, v213, v212
s_waitcnt lgkmcnt(4)
v_mfma_f32_16x16x32_bf16 a[112:115], v[64:67], v[144:147], 0
buffer_load_dwordx4 a[76:79], v6, s[8:11], s26 offen offset:1024 sc1
v_mfma_f32_16x16x32_bf16 a[112:115], v[68:71], v[160:163], a[112:115]
v_rcp_f32 v214, v214
v_mfma_f32_16x16x32_bf16 a[116:119], v[64:67], v[148:151], 0
ds_read_b128 v[56:59], v2 offset:43008
v_mul_f32 v215, v215, v214
v_mfma_f32_16x16x32_bf16 a[116:119], v[68:71], v[164:167], a[116:119]
v_cvt_pk_bf16_f32 v205, v213, v215
v_mfma_f32_16x16x32_bf16 a[120:123], v[64:67], v[152:155], 0
buffer_load_dwordx4 a[80:83], v2, s[8:11], s27 offen offset:1024 sc1
v_mfma_f32_16x16x32_bf16 a[120:123], v[68:71], v[168:171], a[120:123]
ds_read_b128 v[60:63], v2 offset:44032
v_mul_f32 v208, v112, v112
v_mfma_f32_16x16x32_bf16 a[124:127], v[64:67], v[156:159], 0
v_mul_f32 v210, v113, v113
v_fma_f32 v208, v208, v233, v232
v_mfma_f32_16x16x32_bf16 a[124:127], v[68:71], v[172:175], a[124:127]
v_fma_f32 v210, v210, v233, v232
s_waitcnt lgkmcnt(4)
v_mfma_f32_16x16x32_bf16 a[128:131], v[72:75], v[144:147], 0
buffer_load_dwordx4 a[84:87], v4, s[8:11], s27 offen offset:1024 sc1
v_mfma_f32_16x16x32_bf16 a[128:131], v[76:79], v[160:163], a[128:131]
v_mul_f32 v208, v208, v112
v_mul_f32 v210, v210, v113
v_mfma_f32_16x16x32_bf16 a[132:135], v[72:75], v[148:151], 0
ds_read_b128 v[64:67], v2 offset:45056
v_mul_f32 v209, v112, v128
v_mfma_f32_16x16x32_bf16 a[132:135], v[76:79], v[164:167], a[132:135]
v_exp_f32 v208, v208
v_mfma_f32_16x16x32_bf16 a[136:139], v[72:75], v[152:155], 0
buffer_load_dwordx4 a[88:91], v5, s[8:11], s27 offen offset:1024 sc1
v_mfma_f32_16x16x32_bf16 a[136:139], v[76:79], v[168:171], a[136:139]
ds_read_b128 v[68:71], v2 offset:46080
v_mul_f32 v211, v113, v129
v_mfma_f32_16x16x32_bf16 a[140:143], v[72:75], v[156:159], 0
v_exp_f32 v210, v210
v_mfma_f32_16x16x32_bf16 a[140:143], v[76:79], v[172:175], a[140:143]
v_fma_f32 v208, v208, v234, v234
s_waitcnt lgkmcnt(4)
v_mfma_f32_16x16x32_bf16 a[144:147], v[48:51], v[144:147], 0
buffer_load_dwordx4 a[92:95], v6, s[8:11], s27 offen offset:1024 sc1
v_mfma_f32_16x16x32_bf16 a[144:147], v[52:55], v[160:163], a[144:147]
v_fma_f32 v210, v210, v234, v234
v_mul_f32 v212, v114, v114
v_mfma_f32_16x16x32_bf16 a[148:151], v[48:51], v[148:151], 0
ds_read_b128 v[72:75], v2 offset:47104
v_mul_f32 v214, v115, v115
v_mfma_f32_16x16x32_bf16 a[148:151], v[52:55], v[164:167], a[148:151]
v_rcp_f32 v208, v208
v_mfma_f32_16x16x32_bf16 a[152:155], v[48:51], v[152:155], 0
v_rcp_f32 v210, v210
v_mfma_f32_16x16x32_bf16 a[152:155], v[52:55], v[168:171], a[152:155]
ds_read_b128 v[76:79], v2 offset:48128
v_mul_f32 v209, v209, v208
v_mfma_f32_16x16x32_bf16 a[156:159], v[48:51], v[156:159], 0
v_mul_f32 v211, v211, v210
v_cvt_pk_bf16_f32 v194, v209, v211
v_mfma_f32_16x16x32_bf16 a[156:159], v[52:55], v[172:175], a[156:159]
v_fma_f32 v212, v212, v233, v232
s_waitcnt lgkmcnt(4)
v_mfma_f32_16x16x32_bf16 a[160:163], v[56:59], v[144:147], 0
s_waitcnt vmcnt(49)
buffer_load_dwordx2 a[96:97], v244, s[8:11], s28 offen offset:0 sc1
v_mfma_f32_16x16x32_bf16 a[160:163], v[60:63], v[160:163], a[160:163]
s_barrier
v_mfma_f32_16x16x32_bf16 a[164:167], v[56:59], v[148:151], 0
ds_read_b128 v[48:51], v2 offset:49152
v_fma_f32 v214, v214, v233, v232
v_mfma_f32_16x16x32_bf16 a[164:167], v[60:63], v[164:167], a[164:167]
v_mul_f32 v212, v212, v114
v_mul_f32 v214, v214, v115
v_mfma_f32_16x16x32_bf16 a[168:171], v[56:59], v[152:155], 0
buffer_load_dwordx2 a[98:99], v244, s[8:11], s28 offen offset:512 sc1
v_mfma_f32_16x16x32_bf16 a[168:171], v[60:63], v[168:171], a[168:171]
ds_read_b128 v[52:55], v2 offset:50176
v_mul_f32 v213, v114, v130
v_mfma_f32_16x16x32_bf16 a[172:175], v[56:59], v[156:159], 0
v_exp_f32 v212, v212
v_mfma_f32_16x16x32_bf16 a[172:175], v[60:63], v[172:175], a[172:175]
v_mul_f32 v215, v115, v131
s_waitcnt lgkmcnt(4)
v_mfma_f32_16x16x32_bf16 a[176:179], v[64:67], v[144:147], 0
buffer_load_dwordx2 a[100:101], v245, s[8:11], s28 offen offset:0 sc1
v_mfma_f32_16x16x32_bf16 a[176:179], v[68:71], v[160:163], a[176:179]
v_exp_f32 v214, v214
v_mfma_f32_16x16x32_bf16 a[180:183], v[64:67], v[148:151], 0
ds_read_b128 v[56:59], v2 offset:51200
v_fma_f32 v212, v212, v234, v234
v_mfma_f32_16x16x32_bf16 a[180:183], v[68:71], v[164:167], a[180:183]
v_fma_f32 v214, v214, v234, v234
v_mul_f32 v208, v116, v116
v_mfma_f32_16x16x32_bf16 a[184:187], v[64:67], v[152:155], 0
buffer_load_dwordx2 a[102:103], v245, s[8:11], s28 offen offset:512 sc1
v_mfma_f32_16x16x32_bf16 a[184:187], v[68:71], v[168:171], a[184:187]
ds_read_b128 v[60:63], v2 offset:52224
v_mul_f32 v210, v117, v117
v_mfma_f32_16x16x32_bf16 a[188:191], v[64:67], v[156:159], 0
v_rcp_f32 v212, v212
v_mfma_f32_16x16x32_bf16 a[188:191], v[68:71], v[172:175], a[188:191]
v_mul_f32 v213, v213, v212
s_waitcnt lgkmcnt(4)
v_mfma_f32_16x16x32_bf16 a[192:195], v[72:75], v[144:147], 0
buffer_load_dwordx2 a[104:105], v246, s[8:11], s28 offen offset:0 sc1
v_mfma_f32_16x16x32_bf16 a[192:195], v[76:79], v[160:163], a[192:195]
v_rcp_f32 v214, v214
v_mfma_f32_16x16x32_bf16 a[196:199], v[72:75], v[148:151], 0
ds_read_b128 v[64:67], v2 offset:53248
v_mul_f32 v215, v215, v214
v_mfma_f32_16x16x32_bf16 a[196:199], v[76:79], v[164:167], a[196:199]
v_cvt_pk_bf16_f32 v195, v213, v215
v_fma_f32 v208, v208, v236, v235
v_mfma_f32_16x16x32_bf16 a[200:203], v[72:75], v[152:155], 0
buffer_load_dwordx2 a[106:107], v246, s[8:11], s28 offen offset:512 sc1
v_mfma_f32_16x16x32_bf16 a[200:203], v[76:79], v[168:171], a[200:203]
ds_read_b128 v[68:71], v2 offset:54272
v_fma_f32 v210, v210, v236, v235
v_mfma_f32_16x16x32_bf16 a[204:207], v[72:75], v[156:159], 0
buffer_store_dwordx4 v[192:195], v2, s[8:11], s24 offen offset:3072 sc1
v_mfma_f32_16x16x32_bf16 a[204:207], v[76:79], v[172:175], a[204:207]
v_mul_f32 v208, v208, v116
s_waitcnt lgkmcnt(4)
v_mfma_f32_16x16x32_bf16 a[208:211], v[48:51], v[144:147], 0
v_mul_f32 v210, v210, v117
v_mul_f32 v209, v116, v132
v_mfma_f32_16x16x32_bf16 a[208:211], v[52:55], v[160:163], a[208:211]
v_exp_f32 v208, v208
v_mfma_f32_16x16x32_bf16 a[212:215], v[48:51], v[148:151], 0
ds_read_b128 v[72:75], v2 offset:55296
v_mul_f32 v211, v117, v133
v_mfma_f32_16x16x32_bf16 a[212:215], v[52:55], v[164:167], a[212:215]
buffer_load_dwordx2 a[108:109], v247, s[8:11], s28 offen offset:0 sc1
v_mfma_f32_16x16x32_bf16 a[216:219], v[48:51], v[152:155], 0
v_exp_f32 v210, v210
v_mfma_f32_16x16x32_bf16 a[216:219], v[52:55], v[168:171], a[216:219]
ds_read_b128 v[76:79], v2 offset:56320
v_fma_f32 v208, v208, v237, v237
v_mfma_f32_16x16x32_bf16 a[220:223], v[48:51], v[156:159], 0
v_fma_f32 v210, v210, v237, v237
v_mul_f32 v212, v118, v118
v_mfma_f32_16x16x32_bf16 a[220:223], v[52:55], v[172:175], a[220:223]
v_mul_f32 v214, v119, v119
s_waitcnt lgkmcnt(4)
v_mfma_f32_16x16x32_bf16 a[224:227], v[56:59], v[144:147], 0
buffer_load_dwordx2 a[110:111], v247, s[8:11], s28 offen offset:512 sc1
v_mfma_f32_16x16x32_bf16 a[224:227], v[60:63], v[160:163], a[224:227]
s_add_u32 m0, s22, 0
v_add_u32 v3, 20480, v3
v_mfma_f32_16x16x32_bf16 a[228:231], v[56:59], v[148:151], 0
ds_read_b128 v[48:51], v2 offset:57344
v_fma_f32 v212, v212, v236, v235
v_mfma_f32_16x16x32_bf16 a[228:231], v[60:63], v[164:167], a[228:231]
v_rcp_f32 v208, v208
v_mfma_f32_16x16x32_bf16 a[232:235], v[56:59], v[152:155], 0
buffer_load_dwordx4 v3, s[8:11], 0 offen offset:0 sc1 lds
v_mfma_f32_16x16x32_bf16 a[232:235], v[60:63], v[168:171], a[232:235]
ds_read_b128 v[52:55], v2 offset:58368
v_mul_f32 v209, v209, v208
v_mfma_f32_16x16x32_bf16 a[236:239], v[56:59], v[156:159], 0
v_rcp_f32 v210, v210
v_mfma_f32_16x16x32_bf16 a[236:239], v[60:63], v[172:175], a[236:239]
v_mul_f32 v211, v211, v210
s_waitcnt lgkmcnt(4)
v_mfma_f32_16x16x32_bf16 a[240:243], v[64:67], v[144:147], 0
buffer_load_dwordx4 v3, s[8:11], 0 offen offset:1024 sc1 lds
v_mfma_f32_16x16x32_bf16 a[240:243], v[68:71], v[160:163], a[240:243]
v_cvt_pk_bf16_f32 v198, v209, v211
v_fma_f32 v214, v214, v236, v235
v_mfma_f32_16x16x32_bf16 a[244:247], v[64:67], v[148:151], 0
ds_read_b128 v[56:59], v2 offset:59392
v_mul_f32 v212, v212, v118
v_mfma_f32_16x16x32_bf16 a[244:247], v[68:71], v[164:167], a[244:247]
v_mul_f32 v214, v214, v119
v_mul_f32 v213, v118, v134
v_mfma_f32_16x16x32_bf16 a[248:251], v[64:67], v[152:155], 0
buffer_load_dwordx4 v3, s[8:11], 0 offen offset:2048 sc1 lds
v_mfma_f32_16x16x32_bf16 a[248:251], v[68:71], v[168:171], a[248:251]
ds_read_b128 v[60:63], v2 offset:60416
v_mul_f32 v215, v119, v135
v_mfma_f32_16x16x32_bf16 a[252:255], v[64:67], v[156:159], 0
v_exp_f32 v212, v212
v_mfma_f32_16x16x32_bf16 a[252:255], v[68:71], v[172:175], a[252:255]
v_fma_f32 v212, v212, v237, v237
s_waitcnt vmcnt(39)
s_waitcnt lgkmcnt(4)
v_mfma_f32_16x16x32_bf16 a[112:115], v[72:75], v[176:179], a[112:115]
buffer_load_dwordx4 v3, s[8:11], 0 offen offset:3072 sc1 lds
v_mfma_f32_16x16x32_bf16 a[112:115], v[76:79], a[0:3], a[112:115]
s_add_u32 m0, s22, 4096
v_add_u32 v3, 4096, v3
v_mfma_f32_16x16x32_bf16 a[116:119], v[72:75], v[180:183], a[116:119]
ds_read_b128 v[64:67], v2 offset:61440
v_mul_f32 v208, v120, v120
v_mfma_f32_16x16x32_bf16 a[116:119], v[76:79], a[4:7], a[116:119]
v_exp_f32 v214, v214
v_mfma_f32_16x16x32_bf16 a[120:123], v[72:75], v[184:187], a[120:123]
buffer_load_dwordx4 v3, s[8:11], 0 offen offset:0 sc1 lds
v_mfma_f32_16x16x32_bf16 a[120:123], v[76:79], a[8:11], a[120:123]
ds_read_b128 v[68:71], v2 offset:62464
v_fma_f32 v214, v214, v237, v237
v_mfma_f32_16x16x32_bf16 a[124:127], v[72:75], v[188:191], a[124:127]
v_rcp_f32 v212, v212
v_mfma_f32_16x16x32_bf16 a[124:127], v[76:79], a[12:15], a[124:127]
v_mul_f32 v213, v213, v212
s_waitcnt lgkmcnt(4)
v_mfma_f32_16x16x32_bf16 a[128:131], v[48:51], v[176:179], a[128:131]
buffer_load_dwordx4 v3, s[8:11], 0 offen offset:1024 sc1 lds
v_mfma_f32_16x16x32_bf16 a[128:131], v[52:55], a[0:3], a[128:131]
s_add_u32 s23, s34, 131072
v_mul_f32 v210, v121, v121
v_mfma_f32_16x16x32_bf16 a[132:135], v[48:51], v[180:183], a[132:135]
ds_read_b128 v[72:75], v2 offset:63488
v_fma_f32 v208, v208, v239, v238
v_mfma_f32_16x16x32_bf16 a[132:135], v[52:55], a[4:7], a[132:135]
v_rcp_f32 v214, v214
v_mfma_f32_16x16x32_bf16 a[136:139], v[48:51], v[184:187], a[136:139]
buffer_load_dwordx2 v[14:15], v11, s[8:11], s23 offen sc1
v_mfma_f32_16x16x32_bf16 a[136:139], v[52:55], a[8:11], a[136:139]
ds_read_b128 v[76:79], v2 offset:64512
v_mul_f32 v215, v215, v214
v_mfma_f32_16x16x32_bf16 a[140:143], v[48:51], v[188:191], a[140:143]
v_cvt_pk_bf16_f32 v199, v213, v215
v_fma_f32 v210, v210, v239, v238
v_mfma_f32_16x16x32_bf16 a[140:143], v[52:55], a[12:15], a[140:143]
v_mul_f32 v208, v208, v120
s_waitcnt lgkmcnt(4)
v_mfma_f32_16x16x32_bf16 a[144:147], v[56:59], v[176:179], a[144:147]
buffer_load_dwordx2 v[16:17], v244, s[8:11], s29 offen offset:0 sc1
v_mfma_f32_16x16x32_bf16 a[144:147], v[60:63], a[0:3], a[144:147]
v_mul_f32 v210, v210, v121
v_mul_f32 v209, v120, v136
v_mfma_f32_16x16x32_bf16 a[148:151], v[56:59], v[180:183], a[148:151]
ds_read_b128 v[48:51], v7 offset:0
v_mul_f32 v211, v121, v137
v_mfma_f32_16x16x32_bf16 a[148:151], v[60:63], a[4:7], a[148:151]
buffer_store_dwordx4 v[196:199], v4, s[8:11], s24 offen offset:3072 sc1
v_mfma_f32_16x16x32_bf16 a[152:155], v[56:59], v[184:187], a[152:155]
v_exp_f32 v208, v208
v_mfma_f32_16x16x32_bf16 a[152:155], v[60:63], a[8:11], a[152:155]
ds_read_b128 v[52:55], v7 offset:1024
v_fma_f32 v208, v208, v240, v240
v_mfma_f32_16x16x32_bf16 a[156:159], v[56:59], v[188:191], a[156:159]
v_exp_f32 v210, v210
v_mfma_f32_16x16x32_bf16 a[156:159], v[60:63], a[12:15], a[156:159]
v_fma_f32 v210, v210, v240, v240
s_waitcnt lgkmcnt(4)
v_mfma_f32_16x16x32_bf16 a[160:163], v[64:67], v[176:179], a[160:163]
buffer_load_dwordx2 v[18:19], v244, s[8:11], s29 offen offset:512 sc1
v_mfma_f32_16x16x32_bf16 a[160:163], v[68:71], a[0:3], a[160:163]
v_rcp_f32 v208, v208
v_mfma_f32_16x16x32_bf16 a[164:167], v[64:67], v[180:183], a[164:167]
ds_read_b128 v[56:59], v7 offset:2048
v_mul_f32 v209, v209, v208
v_mfma_f32_16x16x32_bf16 a[164:167], v[68:71], a[4:7], a[164:167]
v_rcp_f32 v210, v210
v_mfma_f32_16x16x32_bf16 a[168:171], v[64:67], v[184:187], a[168:171]
buffer_load_dwordx2 v[20:21], v245, s[8:11], s29 offen offset:0 sc1
v_mfma_f32_16x16x32_bf16 a[168:171], v[68:71], a[8:11], a[168:171]
ds_read_b128 v[60:63], v7 offset:3072
v_mul_f32 v211, v211, v210
v_mfma_f32_16x16x32_bf16 a[172:175], v[64:67], v[188:191], a[172:175]
v_cvt_pk_bf16_f32 v202, v209, v211
v_mul_f32 v212, v122, v122
v_mfma_f32_16x16x32_bf16 a[172:175], v[68:71], a[12:15], a[172:175]
v_mul_f32 v214, v123, v123
s_waitcnt lgkmcnt(4)
v_mfma_f32_16x16x32_bf16 a[176:179], v[72:75], v[176:179], a[176:179]
buffer_load_dwordx2 v[22:23], v245, s[8:11], s29 offen offset:512 sc1
v_mfma_f32_16x16x32_bf16 a[176:179], v[76:79], a[0:3], a[176:179]
v_fma_f32 v212, v212, v239, v238
v_fma_f32 v214, v214, v239, v238
v_mfma_f32_16x16x32_bf16 a[180:183], v[72:75], v[180:183], a[180:183]
ds_read_b128 v[64:67], v7 offset:4096
v_mul_f32 v212, v212, v122
v_mfma_f32_16x16x32_bf16 a[180:183], v[76:79], a[4:7], a[180:183]
v_mul_f32 v214, v214, v123
v_mul_f32 v213, v122, v138
v_mfma_f32_16x16x32_bf16 a[184:187], v[72:75], v[184:187], a[184:187]
buffer_load_dwordx2 v[24:25], v246, s[8:11], s29 offen offset:0 sc1
v_mfma_f32_16x16x32_bf16 a[184:187], v[76:79], a[8:11], a[184:187]
ds_read_b128 v[68:71], v7 offset:5120
v_mul_f32 v215, v123, v139
v_mfma_f32_16x16x32_bf16 a[188:191], v[72:75], v[188:191], a[188:191]
v_exp_f32 v212, v212
v_mfma_f32_16x16x32_bf16 a[188:191], v[76:79], a[12:15], a[188:191]
v_fma_f32 v212, v212, v240, v240
s_waitcnt lgkmcnt(4)
v_mfma_f32_16x16x32_bf16 a[192:195], v[48:51], v[176:179], a[192:195]
buffer_load_dwordx2 v[26:27], v246, s[8:11], s29 offen offset:512 sc1
v_mfma_f32_16x16x32_bf16 a[192:195], v[52:55], a[0:3], a[192:195]
v_exp_f32 v214, v214
v_mfma_f32_16x16x32_bf16 a[196:199], v[48:51], v[180:183], a[196:199]
ds_read_b128 v[72:75], v7 offset:6144
v_fma_f32 v214, v214, v240, v240
v_mfma_f32_16x16x32_bf16 a[196:199], v[52:55], a[4:7], a[196:199]
v_rcp_f32 v212, v212
v_mfma_f32_16x16x32_bf16 a[200:203], v[48:51], v[184:187], a[200:203]
buffer_load_dwordx2 v[28:29], v247, s[8:11], s29 offen offset:0 sc1
v_mfma_f32_16x16x32_bf16 a[200:203], v[52:55], a[8:11], a[200:203]
ds_read_b128 v[76:79], v7 offset:7168
v_mul_f32 v213, v213, v212
v_mfma_f32_16x16x32_bf16 a[204:207], v[48:51], v[188:191], a[204:207]
v_rcp_f32 v214, v214
v_mfma_f32_16x16x32_bf16 a[204:207], v[52:55], a[12:15], a[204:207]
v_mul_f32 v215, v215, v214
s_waitcnt lgkmcnt(4)
v_mfma_f32_16x16x32_bf16 a[208:211], v[56:59], v[176:179], a[208:211]
s_waitcnt vmcnt(63)
v_cvt_pk_bf16_f32 v203, v213, v215
v_mfma_f32_16x16x32_bf16 a[208:211], v[60:63], a[0:3], a[208:211]
s_barrier
v_mfma_f32_16x16x32_bf16 a[212:215], v[56:59], v[180:183], a[212:215]
ds_read_b128 v[48:51], v7 offset:8192
v_mul_f32 v208, v124, v124
v_mfma_f32_16x16x32_bf16 a[212:215], v[60:63], a[4:7], a[212:215]
buffer_load_dwordx2 v[30:31], v247, s[8:11], s29 offen offset:512 sc1
v_mfma_f32_16x16x32_bf16 a[216:219], v[56:59], v[184:187], a[216:219]
s_add_u32 m0, s22, 24576
v_add_u32 v3, 20480, v3
v_mfma_f32_16x16x32_bf16 a[216:219], v[60:63], a[8:11], a[216:219]
ds_read_b128 v[52:55], v7 offset:9216
v_mul_f32 v210, v125, v125
v_mfma_f32_16x16x32_bf16 a[220:223], v[56:59], v[188:191], a[220:223]
buffer_store_dwordx4 v[200:203], v5, s[8:11], s24 offen offset:3072 sc1
v_mfma_f32_16x16x32_bf16 a[220:223], v[60:63], a[12:15], a[220:223]
v_fma_f32 v208, v208, v242, v241
s_waitcnt lgkmcnt(4)
v_mfma_f32_16x16x32_bf16 a[224:227], v[64:67], v[176:179], a[224:227]
v_fma_f32 v210, v210, v242, v241
v_mul_f32 v208, v208, v124
v_mfma_f32_16x16x32_bf16 a[224:227], v[68:71], a[0:3], a[224:227]
v_mul_f32 v210, v210, v125
v_mul_f32 v209, v124, v140
v_mfma_f32_16x16x32_bf16 a[228:231], v[64:67], v[180:183], a[228:231]
ds_read_b128 v[56:59], v7 offset:10240
v_mul_f32 v211, v125, v141
v_mfma_f32_16x16x32_bf16 a[228:231], v[68:71], a[4:7], a[228:231]
buffer_load_dwordx4 v3, s[8:11], 0 offen offset:0 sc1 lds
v_mfma_f32_16x16x32_bf16 a[232:235], v[64:67], v[184:187], a[232:235]
v_exp_f32 v208, v208
v_mfma_f32_16x16x32_bf16 a[232:235], v[68:71], a[8:11], a[232:235]
ds_read_b128 v[60:63], v7 offset:11264
v_exp_f32 v210, v210
v_mfma_f32_16x16x32_bf16 a[236:239], v[64:67], v[188:191], a[236:239]
v_fma_f32 v208, v208, v243, v243
v_fma_f32 v210, v210, v243, v243
v_mfma_f32_16x16x32_bf16 a[236:239], v[68:71], a[12:15], a[236:239]
v_rcp_f32 v208, v208
s_waitcnt lgkmcnt(4)
v_mfma_f32_16x16x32_bf16 a[240:243], v[72:75], v[176:179], a[240:243]
buffer_load_dwordx4 v3, s[8:11], 0 offen offset:1024 sc1 lds
v_rcp_f32 v210, v210
v_mfma_f32_16x16x32_bf16 a[240:243], v[76:79], a[0:3], a[240:243]
v_mul_f32 v209, v209, v208
v_mul_f32 v211, v211, v210
v_mfma_f32_16x16x32_bf16 a[244:247], v[72:75], v[180:183], a[244:247]
ds_read_b128 v[64:67], v7 offset:12288
v_cvt_pk_bf16_f32 v206, v209, v211
v_mfma_f32_16x16x32_bf16 a[244:247], v[76:79], a[4:7], a[244:247]
v_mul_f32 v212, v126, v126
v_mul_f32 v214, v127, v127
v_mfma_f32_16x16x32_bf16 a[248:251], v[72:75], v[184:187], a[248:251]
buffer_load_dwordx4 v3, s[8:11], 0 offen offset:2048 sc1 lds
v_fma_f32 v212, v212, v242, v241
v_mfma_f32_16x16x32_bf16 a[248:251], v[76:79], a[8:11], a[248:251]
ds_read_b128 v[68:71], v7 offset:13312
v_fma_f32 v214, v214, v242, v241
v_mfma_f32_16x16x32_bf16 a[252:255], v[72:75], v[188:191], a[252:255]
v_mul_f32 v212, v212, v126
v_mul_f32 v214, v214, v127
v_mfma_f32_16x16x32_bf16 a[252:255], v[76:79], a[12:15], a[252:255]
v_exp_f32 v212, v212
s_waitcnt vmcnt(47)
s_waitcnt lgkmcnt(4)
v_mfma_f32_16x16x32_bf16 a[112:115], v[48:51], a[16:19], a[112:115]
buffer_load_dwordx4 v3, s[8:11], 0 offen offset:3072 sc1 lds
v_exp_f32 v214, v214
v_mfma_f32_16x16x32_bf16 a[112:115], v[52:55], a[32:35], a[112:115]
s_add_u32 m0, s22, 28672
v_add_u32 v3, 4096, v3
v_mul_f32 v213, v126, v142
v_mfma_f32_16x16x32_bf16 a[116:119], v[48:51], a[20:23], a[116:119]
ds_read_b128 v[72:75], v7 offset:14336
v_mul_f32 v215, v127, v143
v_mfma_f32_16x16x32_bf16 a[116:119], v[52:55], a[36:39], a[116:119]
v_fma_f32 v212, v212, v243, v243
v_fma_f32 v214, v214, v243, v243
v_mfma_f32_16x16x32_bf16 a[120:123], v[48:51], a[24:27], a[120:123]
buffer_load_dwordx4 v3, s[8:11], 0 offen offset:0 sc1 lds
v_rcp_f32 v212, v212
v_mfma_f32_16x16x32_bf16 a[120:123], v[52:55], a[40:43], a[120:123]
ds_read_b128 v[76:79], v7 offset:15360
v_rcp_f32 v214, v214
v_mfma_f32_16x16x32_bf16 a[124:127], v[48:51], a[28:31], a[124:127]
v_mul_f32 v213, v213, v212
v_mul_f32 v215, v215, v214
v_mfma_f32_16x16x32_bf16 a[124:127], v[52:55], a[44:47], a[124:127]
v_cvt_pk_bf16_f32 v207, v213, v215
buffer_store_dwordx4 v[204:207], v6, s[8:11], s24 offen offset:3072 sc1
s_waitcnt lgkmcnt(4)
v_mfma_f32_16x16x32_bf16 a[128:131], v[56:59], a[16:19], a[128:131]
buffer_load_dwordx4 v3, s[8:11], 0 offen offset:1024 sc1 lds
v_mfma_f32_16x16x32_bf16 a[128:131], v[60:63], a[32:35], a[128:131]
s_waitcnt vmcnt(17)
v_cmp_eq_u64 vcc, s[68:69], v[14:15]
s_nop 0
s_cmp_eq_u64 vcc, exec
s_cbranch_scc0 L_f_slow2
L_f_back2:
v_mfma_f32_16x16x32_bf16 a[132:135], v[56:59], a[20:23], a[132:135]
ds_read_b128 v[48:51], v7 offset:16384
v_mfma_f32_16x16x32_bf16 a[132:135], v[60:63], a[36:39], a[132:135]
v_mfma_f32_16x16x32_bf16 a[136:139], v[56:59], a[24:27], a[136:139]
buffer_load_dwordx4 v[32:35], v2, s[8:11], s25 offen offset:2048 sc1
v_mfma_f32_16x16x32_bf16 a[136:139], v[60:63], a[40:43], a[136:139]
ds_read_b128 v[52:55], v7 offset:17408
v_mfma_f32_16x16x32_bf16 a[140:143], v[56:59], a[28:31], a[140:143]
v_mfma_f32_16x16x32_bf16 a[140:143], v[60:63], a[44:47], a[140:143]
s_waitcnt lgkmcnt(4)
v_mfma_f32_16x16x32_bf16 a[144:147], v[64:67], a[16:19], a[144:147]
buffer_load_dwordx4 v[36:39], v4, s[8:11], s25 offen offset:2048 sc1
v_mfma_f32_16x16x32_bf16 a[144:147], v[68:71], a[32:35], a[144:147]
v_mfma_f32_16x16x32_bf16 a[148:151], v[64:67], a[20:23], a[148:151]
ds_read_b128 v[56:59], v7 offset:18432
v_mfma_f32_16x16x32_bf16 a[148:151], v[68:71], a[36:39], a[148:151]
v_mfma_f32_16x16x32_bf16 a[152:155], v[64:67], a[24:27], a[152:155]
buffer_load_dwordx4 v[40:43], v5, s[8:11], s25 offen offset:2048 sc1
v_mfma_f32_16x16x32_bf16 a[152:155], v[68:71], a[40:43], a[152:155]
ds_read_b128 v[60:63], v7 offset:19456
v_mfma_f32_16x16x32_bf16 a[156:159], v[64:67], a[28:31], a[156:159]
v_mfma_f32_16x16x32_bf16 a[156:159], v[68:71], a[44:47], a[156:159]
s_waitcnt lgkmcnt(4)
v_mfma_f32_16x16x32_bf16 a[160:163], v[72:75], a[16:19], a[160:163]
buffer_load_dwordx4 v[44:47], v6, s[8:11], s25 offen offset:2048 sc1
v_mfma_f32_16x16x32_bf16 a[160:163], v[76:79], a[32:35], a[160:163]
v_mfma_f32_16x16x32_bf16 a[164:167], v[72:75], a[20:23], a[164:167]
ds_read_b128 v[64:67], v7 offset:20480
v_mfma_f32_16x16x32_bf16 a[164:167], v[76:79], a[36:39], a[164:167]
v_mfma_f32_16x16x32_bf16 a[168:171], v[72:75], a[24:27], a[168:171]
buffer_load_dwordx4 v[80:83], v2, s[8:11], s26 offen offset:2048 sc1
v_mfma_f32_16x16x32_bf16 a[168:171], v[76:79], a[40:43], a[168:171]
ds_read_b128 v[68:71], v7 offset:21504
v_mfma_f32_16x16x32_bf16 a[172:175], v[72:75], a[28:31], a[172:175]
v_mfma_f32_16x16x32_bf16 a[172:175], v[76:79], a[44:47], a[172:175]
s_waitcnt lgkmcnt(4)
v_mfma_f32_16x16x32_bf16 a[176:179], v[48:51], a[16:19], a[176:179]
buffer_load_dwordx4 v[84:87], v4, s[8:11], s26 offen offset:2048 sc1
v_mfma_f32_16x16x32_bf16 a[176:179], v[52:55], a[32:35], a[176:179]
v_mfma_f32_16x16x32_bf16 a[180:183], v[48:51], a[20:23], a[180:183]
ds_read_b128 v[72:75], v7 offset:22528
v_mfma_f32_16x16x32_bf16 a[180:183], v[52:55], a[36:39], a[180:183]
v_mfma_f32_16x16x32_bf16 a[184:187], v[48:51], a[24:27], a[184:187]
buffer_load_dwordx4 v[88:91], v5, s[8:11], s26 offen offset:2048 sc1
v_mfma_f32_16x16x32_bf16 a[184:187], v[52:55], a[40:43], a[184:187]
ds_read_b128 v[76:79], v7 offset:23552
v_mfma_f32_16x16x32_bf16 a[188:191], v[48:51], a[28:31], a[188:191]
v_mfma_f32_16x16x32_bf16 a[188:191], v[52:55], a[44:47], a[188:191]
s_waitcnt lgkmcnt(4)
v_mfma_f32_16x16x32_bf16 a[192:195], v[56:59], a[16:19], a[192:195]
buffer_load_dwordx4 v[92:95], v6, s[8:11], s26 offen offset:2048 sc1
v_mfma_f32_16x16x32_bf16 a[192:195], v[60:63], a[32:35], a[192:195]
v_mfma_f32_16x16x32_bf16 a[196:199], v[56:59], a[20:23], a[196:199]
ds_read_b128 v[48:51], v7 offset:24576
v_mfma_f32_16x16x32_bf16 a[196:199], v[60:63], a[36:39], a[196:199]
v_mfma_f32_16x16x32_bf16 a[200:203], v[56:59], a[24:27], a[200:203]
buffer_load_dwordx4 v[96:99], v2, s[8:11], s27 offen offset:2048 sc1
v_mfma_f32_16x16x32_bf16 a[200:203], v[60:63], a[40:43], a[200:203]
ds_read_b128 v[52:55], v7 offset:25600
v_mfma_f32_16x16x32_bf16 a[204:207], v[56:59], a[28:31], a[204:207]
v_mfma_f32_16x16x32_bf16 a[204:207], v[60:63], a[44:47], a[204:207]
s_waitcnt lgkmcnt(4)
v_mfma_f32_16x16x32_bf16 a[208:211], v[64:67], a[16:19], a[208:211]
buffer_load_dwordx4 v[100:103], v4, s[8:11], s27 offen offset:2048 sc1
v_mfma_f32_16x16x32_bf16 a[208:211], v[68:71], a[32:35], a[208:211]
v_mfma_f32_16x16x32_bf16 a[212:215], v[64:67], a[20:23], a[212:215]
ds_read_b128 v[56:59], v7 offset:26624
v_mfma_f32_16x16x32_bf16 a[212:215], v[68:71], a[36:39], a[212:215]
v_mfma_f32_16x16x32_bf16 a[216:219], v[64:67], a[24:27], a[216:219]
buffer_load_dwordx4 v[104:107], v5, s[8:11], s27 offen offset:2048 sc1
v_mfma_f32_16x16x32_bf16 a[216:219], v[68:71], a[40:43], a[216:219]
ds_read_b128 v[60:63], v7 offset:27648
v_mfma_f32_16x16x32_bf16 a[220:223], v[64:67], a[28:31], a[220:223]
v_mfma_f32_16x16x32_bf16 a[220:223], v[68:71], a[44:47], a[220:223]
s_waitcnt lgkmcnt(4)
v_mfma_f32_16x16x32_bf16 a[224:227], v[72:75], a[16:19], a[224:227]
buffer_load_dwordx4 v[108:111], v6, s[8:11], s27 offen offset:2048 sc1
v_mfma_f32_16x16x32_bf16 a[224:227], v[76:79], a[32:35], a[224:227]
v_mov_b32 v12, s68
v_mov_b32 v13, s69
v_mfma_f32_16x16x32_bf16 a[228:231], v[72:75], a[20:23], a[228:231]
ds_read_b128 v[64:67], v7 offset:28672
s_add_u32 s53, s34, 262144
v_mfma_f32_16x16x32_bf16 a[228:231], v[76:79], a[36:39], a[228:231]
s_waitcnt vmcnt(13)
v_mfma_f32_16x16x32_bf16 a[232:235], v[72:75], a[24:27], a[232:235]
buffer_store_dwordx2 v[12:13], v10, s[8:11], s53 offen sc1
v_mfma_f32_16x16x32_bf16 a[232:235], v[76:79], a[40:43], a[232:235]
ds_read_b128 v[68:71], v7 offset:29696
v_mfma_f32_16x16x32_bf16 a[236:239], v[72:75], a[28:31], a[236:239]
v_mfma_f32_16x16x32_bf16 a[236:239], v[76:79], a[44:47], a[236:239]
s_waitcnt lgkmcnt(4)
v_mfma_f32_16x16x32_bf16 a[240:243], v[48:51], a[16:19], a[240:243]
s_mul_i32 s48, s7, 2146435072
s_lshl_b32 s49, s6, 2
v_mfma_f32_16x16x32_bf16 a[240:243], v[52:55], a[32:35], a[240:243]
s_add_u32 s49, s49, s4
s_mul_i32 s50, s49, 6144
v_mfma_f32_16x16x32_bf16 a[244:247], v[48:51], a[20:23], a[244:247]
ds_read_b128 v[72:75], v7 offset:30720
s_add_u32 s50, s50, s48
v_mfma_f32_16x16x32_bf16 a[244:247], v[52:55], a[36:39], a[244:247]
s_add_u32 s50, s50, 6557696
s_mul_i32 s49, s49, 5120
v_mfma_f32_16x16x32_bf16 a[248:251], v[48:51], a[24:27], a[248:251]
s_add_u32 s48, s48, s49
s_and_b32 s49, s5, 3
v_mfma_f32_16x16x32_bf16 a[248:251], v[52:55], a[40:43], a[248:251]
ds_read_b128 v[76:79], v7 offset:31744
s_mul_i32 s49, s49, 589824
v_mfma_f32_16x16x32_bf16 a[252:255], v[48:51], a[28:31], a[252:255]
s_add_u32 s48, s48, s49
s_add_u32 s48, s48, 4198400
buffer_load_dwordx4 v[248:251], v2, s[8:11], s48 offen offset:0
v_mfma_f32_16x16x32_bf16 a[252:255], v[52:55], a[44:47], a[252:255]
s_waitcnt vmcnt(51)
s_waitcnt lgkmcnt(4)
v_mfma_f32_16x16x32_bf16 a[112:115], v[56:59], a[48:51], a[112:115]
s_waitcnt vmcnt(63)
v_mfma_f32_16x16x32_bf16 a[112:115], v[60:63], a[64:67], a[112:115]
s_barrier
v_mfma_f32_16x16x32_bf16 a[116:119], v[56:59], a[52:55], a[116:119]
ds_read_b128 v[48:51], v7 offset:32768
v_mfma_f32_16x16x32_bf16 a[116:119], v[60:63], a[68:71], a[116:119]
buffer_load_dwordx4 v[248:251], v2, s[8:11], s48 offen offset:1024
v_mfma_f32_16x16x32_bf16 a[120:123], v[56:59], a[56:59], a[120:123]
v_mfma_f32_16x16x32_bf16 a[120:123], v[60:63], a[72:75], a[120:123]
ds_read_b128 v[52:55], v7 offset:33792
v_mfma_f32_16x16x32_bf16 a[124:127], v[56:59], a[60:63], a[124:127]
v_mfma_f32_16x16x32_bf16 a[124:127], v[60:63], a[76:79], a[124:127]
s_waitcnt lgkmcnt(4)
v_mfma_f32_16x16x32_bf16 a[128:131], v[64:67], a[48:51], a[128:131]
buffer_load_dwordx4 v[248:251], v2, s[8:11], s48 offen offset:2048
v_mfma_f32_16x16x32_bf16 a[128:131], v[68:71], a[64:67], a[128:131]
v_mfma_f32_16x16x32_bf16 a[132:135], v[64:67], a[52:55], a[132:135]
ds_read_b128 v[56:59], v7 offset:34816
v_mfma_f32_16x16x32_bf16 a[132:135], v[68:71], a[68:71], a[132:135]
v_mfma_f32_16x16x32_bf16 a[136:139], v[64:67], a[56:59], a[136:139]
buffer_load_dwordx4 v[248:251], v2, s[8:11], s48 offen offset:3072
v_mfma_f32_16x16x32_bf16 a[136:139], v[68:71], a[72:75], a[136:139]
ds_read_b128 v[60:63], v7 offset:35840
s_add_u32 s48, s48, 4096
v_mfma_f32_16x16x32_bf16 a[140:143], v[64:67], a[60:63], a[140:143]
v_mfma_f32_16x16x32_bf16 a[140:143], v[68:71], a[76:79], a[140:143]
s_waitcnt lgkmcnt(4)
v_mfma_f32_16x16x32_bf16 a[144:147], v[72:75], a[48:51], a[144:147]
buffer_load_dwordx4 v[248:251], v2, s[8:11], s48 offen offset:0
v_mfma_f32_16x16x32_bf16 a[144:147], v[76:79], a[64:67], a[144:147]
v_mfma_f32_16x16x32_bf16 a[148:151], v[72:75], a[52:55], a[148:151]
ds_read_b128 v[64:67], v7 offset:36864
v_mfma_f32_16x16x32_bf16 a[148:151], v[76:79], a[68:71], a[148:151]
v_mfma_f32_16x16x32_bf16 a[152:155], v[72:75], a[56:59], a[152:155]
buffer_load_dwordx4 v[248:251], v2, s[8:11], s50 offen offset:0
v_mfma_f32_16x16x32_bf16 a[152:155], v[76:79], a[72:75], a[152:155]
ds_read_b128 v[68:71], v7 offset:37888
v_mfma_f32_16x16x32_bf16 a[156:159], v[72:75], a[60:63], a[156:159]
v_mfma_f32_16x16x32_bf16 a[156:159], v[76:79], a[76:79], a[156:159]
s_waitcnt lgkmcnt(4)
v_mfma_f32_16x16x32_bf16 a[160:163], v[48:51], a[48:51], a[160:163]
buffer_load_dwordx4 v[248:251], v2, s[8:11], s50 offen offset:1024
v_mfma_f32_16x16x32_bf16 a[160:163], v[52:55], a[64:67], a[160:163]
v_mfma_f32_16x16x32_bf16 a[164:167], v[48:51], a[52:55], a[164:167]
ds_read_b128 v[72:75], v7 offset:38912
v_mfma_f32_16x16x32_bf16 a[164:167], v[52:55], a[68:71], a[164:167]
v_mfma_f32_16x16x32_bf16 a[168:171], v[48:51], a[56:59], a[168:171]
buffer_load_dwordx4 v[248:251], v2, s[8:11], s50 offen offset:2048
v_mfma_f32_16x16x32_bf16 a[168:171], v[52:55], a[72:75], a[168:171]
ds_read_b128 v[76:79], v7 offset:39936
v_mfma_f32_16x16x32_bf16 a[172:175], v[48:51], a[60:63], a[172:175]
v_mfma_f32_16x16x32_bf16 a[172:175], v[52:55], a[76:79], a[172:175]
s_waitcnt lgkmcnt(4)
v_mfma_f32_16x16x32_bf16 a[176:179], v[56:59], a[48:51], a[176:179]
buffer_load_dwordx4 v[248:251], v2, s[8:11], s50 offen offset:3072
v_mfma_f32_16x16x32_bf16 a[176:179], v[60:63], a[64:67], a[176:179]
s_add_u32 s50, s50, 4096
v_mfma_f32_16x16x32_bf16 a[180:183], v[56:59], a[52:55], a[180:183]
ds_read_b128 v[48:51], v7 offset:40960
v_mfma_f32_16x16x32_bf16 a[180:183], v[60:63], a[68:71], a[180:183]
v_mfma_f32_16x16x32_bf16 a[184:187], v[56:59], a[56:59], a[184:187]
buffer_load_dwordx4 v[248:251], v2, s[8:11], s50 offen offset:0
v_mfma_f32_16x16x32_bf16 a[184:187], v[60:63], a[72:75], a[184:187]
ds_read_b128 v[52:55], v7 offset:41984
v_mfma_f32_16x16x32_bf16 a[188:191], v[56:59], a[60:63], a[188:191]
v_mfma_f32_16x16x32_bf16 a[188:191], v[60:63], a[76:79], a[188:191]
s_waitcnt lgkmcnt(4)
v_mfma_f32_16x16x32_bf16 a[192:195], v[64:67], a[48:51], a[192:195]
buffer_load_dwordx4 v[248:251], v2, s[8:11], s50 offen offset:1024
v_mfma_f32_16x16x32_bf16 a[192:195], v[68:71], a[64:67], a[192:195]
s_add_u32 m0, s22, 49152
v_add_u32 v3, 20480, v3
v_mfma_f32_16x16x32_bf16 a[196:199], v[64:67], a[52:55], a[196:199]
ds_read_b128 v[56:59], v7 offset:43008
v_mfma_f32_16x16x32_bf16 a[196:199], v[68:71], a[68:71], a[196:199]
v_mfma_f32_16x16x32_bf16 a[200:203], v[64:67], a[56:59], a[200:203]
buffer_load_dwordx4 v3, s[8:11], 0 offen offset:0 sc1 lds
v_mfma_f32_16x16x32_bf16 a[200:203], v[68:71], a[72:75], a[200:203]
ds_read_b128 v[60:63], v7 offset:44032
v_mfma_f32_16x16x32_bf16 a[204:207], v[64:67], a[60:63], a[204:207]
v_mfma_f32_16x16x32_bf16 a[204:207], v[68:71], a[76:79], a[204:207]
s_waitcnt lgkmcnt(4)
v_mfma_f32_16x16x32_bf16 a[208:211], v[72:75], a[48:51], a[208:211]
buffer_load_dwordx4 v3, s[8:11], 0 offen offset:1024 sc1 lds
v_mfma_f32_16x16x32_bf16 a[208:211], v[76:79], a[64:67], a[208:211]
v_mfma_f32_16x16x32_bf16 a[212:215], v[72:75], a[52:55], a[212:215]
ds_read_b128 v[64:67], v7 offset:45056
v_mfma_f32_16x16x32_bf16 a[212:215], v[76:79], a[68:71], a[212:215]
v_mfma_f32_16x16x32_bf16 a[216:219], v[72:75], a[56:59], a[216:219]
buffer_load_dwordx4 v3, s[8:11], 0 offen offset:2048 sc1 lds
v_mfma_f32_16x16x32_bf16 a[216:219], v[76:79], a[72:75], a[216:219]
ds_read_b128 v[68:71], v7 offset:46080
v_mfma_f32_16x16x32_bf16 a[220:223], v[72:75], a[60:63], a[220:223]
v_mfma_f32_16x16x32_bf16 a[220:223], v[76:79], a[76:79], a[220:223]
s_waitcnt lgkmcnt(4)
v_mfma_f32_16x16x32_bf16 a[224:227], v[48:51], a[48:51], a[224:227]
buffer_load_dwordx4 v3, s[8:11], 0 offen offset:3072 sc1 lds
v_mfma_f32_16x16x32_bf16 a[224:227], v[52:55], a[64:67], a[224:227]
s_add_u32 m0, s22, 53248
v_add_u32 v3, 4096, v3
v_mfma_f32_16x16x32_bf16 a[228:231], v[48:51], a[52:55], a[228:231]
ds_read_b128 v[72:75], v7 offset:47104
v_mfma_f32_16x16x32_bf16 a[228:231], v[52:55], a[68:71], a[228:231]
v_mfma_f32_16x16x32_bf16 a[232:235], v[48:51], a[56:59], a[232:235]
buffer_load_dwordx4 v3, s[8:11], 0 offen offset:0 sc1 lds
v_mfma_f32_16x16x32_bf16 a[232:235], v[52:55], a[72:75], a[232:235]
ds_read_b128 v[76:79], v7 offset:48128
v_mfma_f32_16x16x32_bf16 a[236:239], v[48:51], a[60:63], a[236:239]
v_mfma_f32_16x16x32_bf16 a[236:239], v[52:55], a[76:79], a[236:239]
s_waitcnt lgkmcnt(4)
v_mfma_f32_16x16x32_bf16 a[240:243], v[56:59], a[48:51], a[240:243]
buffer_load_dwordx4 v3, s[8:11], 0 offen offset:1024 sc1 lds
v_mfma_f32_16x16x32_bf16 a[240:243], v[60:63], a[64:67], a[240:243]
s_add_u32 s23, s34, 262144
v_mfma_f32_16x16x32_bf16 a[244:247], v[56:59], a[52:55], a[244:247]
ds_read_b128 v[48:51], v7 offset:49152
v_mfma_f32_16x16x32_bf16 a[244:247], v[60:63], a[68:71], a[244:247]
v_mfma_f32_16x16x32_bf16 a[248:251], v[56:59], a[56:59], a[248:251]
buffer_load_dwordx2 v[14:15], v11, s[8:11], s23 offen sc1
v_mfma_f32_16x16x32_bf16 a[248:251], v[60:63], a[72:75], a[248:251]
ds_read_b128 v[52:55], v7 offset:50176
v_mfma_f32_16x16x32_bf16 a[252:255], v[56:59], a[60:63], a[252:255]
v_mfma_f32_16x16x32_bf16 a[252:255], v[60:63], a[76:79], a[252:255]
s_waitcnt vmcnt(55)
s_waitcnt lgkmcnt(4)
v_mfma_f32_16x16x32_bf16 a[112:115], v[64:67], a[80:83], a[112:115]
v_mfma_f32_16x16x32_bf16 a[112:115], v[68:71], a[96:99], a[112:115]
v_mfma_f32_16x16x32_bf16 a[116:119], v[64:67], a[84:87], a[116:119]
ds_read_b128 v[56:59], v7 offset:51200
v_mfma_f32_16x16x32_bf16 a[116:119], v[68:71], a[100:103], a[116:119]
v_mfma_f32_16x16x32_bf16 a[120:123], v[64:67], a[88:91], a[120:123]
v_mfma_f32_16x16x32_bf16 a[120:123], v[68:71], a[104:107], a[120:123]
ds_read_b128 v[60:63], v7 offset:52224
v_mfma_f32_16x16x32_bf16 a[124:127], v[64:67], a[92:95], a[124:127]
v_mfma_f32_16x16x32_bf16 a[124:127], v[68:71], a[108:111], a[124:127]
s_waitcnt lgkmcnt(4)
v_mfma_f32_16x16x32_bf16 a[128:131], v[72:75], a[80:83], a[128:131]
v_mfma_f32_16x16x32_bf16 a[128:131], v[76:79], a[96:99], a[128:131]
v_mfma_f32_16x16x32_bf16 a[132:135], v[72:75], a[84:87], a[132:135]
ds_read_b128 v[64:67], v7 offset:53248
v_mfma_f32_16x16x32_bf16 a[132:135], v[76:79], a[100:103], a[132:135]
v_mfma_f32_16x16x32_bf16 a[136:139], v[72:75], a[88:91], a[136:139]
v_mfma_f32_16x16x32_bf16 a[136:139], v[76:79], a[104:107], a[136:139]
ds_read_b128 v[68:71], v7 offset:54272
v_mfma_f32_16x16x32_bf16 a[140:143], v[72:75], a[92:95], a[140:143]
v_mfma_f32_16x16x32_bf16 a[140:143], v[76:79], a[108:111], a[140:143]
s_waitcnt lgkmcnt(4)
v_mfma_f32_16x16x32_bf16 a[144:147], v[48:51], a[80:83], a[144:147]
v_mfma_f32_16x16x32_bf16 a[144:147], v[52:55], a[96:99], a[144:147]
v_mfma_f32_16x16x32_bf16 a[148:151], v[48:51], a[84:87], a[148:151]
ds_read_b128 v[72:75], v7 offset:55296
v_mfma_f32_16x16x32_bf16 a[148:151], v[52:55], a[100:103], a[148:151]
v_mfma_f32_16x16x32_bf16 a[152:155], v[48:51], a[88:91], a[152:155]
v_mfma_f32_16x16x32_bf16 a[152:155], v[52:55], a[104:107], a[152:155]
ds_read_b128 v[76:79], v7 offset:56320
v_mfma_f32_16x16x32_bf16 a[156:159], v[48:51], a[92:95], a[156:159]
v_mfma_f32_16x16x32_bf16 a[156:159], v[52:55], a[108:111], a[156:159]
s_waitcnt lgkmcnt(4)
v_mfma_f32_16x16x32_bf16 a[160:163], v[56:59], a[80:83], a[160:163]
s_waitcnt vmcnt(63)
v_mfma_f32_16x16x32_bf16 a[160:163], v[60:63], a[96:99], a[160:163]
s_barrier
v_mfma_f32_16x16x32_bf16 a[164:167], v[56:59], a[84:87], a[164:167]
ds_read_b128 v[48:51], v7 offset:57344
v_mfma_f32_16x16x32_bf16 a[164:167], v[60:63], a[100:103], a[164:167]
v_mfma_f32_16x16x32_bf16 a[168:171], v[56:59], a[88:91], a[168:171]
v_mfma_f32_16x16x32_bf16 a[168:171], v[60:63], a[104:107], a[168:171]
ds_read_b128 v[52:55], v7 offset:58368
v_mfma_f32_16x16x32_bf16 a[172:175], v[56:59], a[92:95], a[172:175]
v_mfma_f32_16x16x32_bf16 a[172:175], v[60:63], a[108:111], a[172:175]
s_waitcnt lgkmcnt(4)
v_mfma_f32_16x16x32_bf16 a[176:179], v[64:67], a[80:83], a[176:179]
v_mfma_f32_16x16x32_bf16 a[176:179], v[68:71], a[96:99], a[176:179]
v_mfma_f32_16x16x32_bf16 a[180:183], v[64:67], a[84:87], a[180:183]
ds_read_b128 v[56:59], v7 offset:59392
v_mfma_f32_16x16x32_bf16 a[180:183], v[68:71], a[100:103], a[180:183]
v_mfma_f32_16x16x32_bf16 a[184:187], v[64:67], a[88:91], a[184:187]
v_mfma_f32_16x16x32_bf16 a[184:187], v[68:71], a[104:107], a[184:187]
ds_read_b128 v[60:63], v7 offset:60416
v_mfma_f32_16x16x32_bf16 a[188:191], v[64:67], a[92:95], a[188:191]
v_mfma_f32_16x16x32_bf16 a[188:191], v[68:71], a[108:111], a[188:191]
s_waitcnt lgkmcnt(4)
v_mfma_f32_16x16x32_bf16 a[192:195], v[72:75], a[80:83], a[192:195]
v_mfma_f32_16x16x32_bf16 a[192:195], v[76:79], a[96:99], a[192:195]
v_mfma_f32_16x16x32_bf16 a[196:199], v[72:75], a[84:87], a[196:199]
ds_read_b128 v[64:67], v7 offset:61440
v_mfma_f32_16x16x32_bf16 a[196:199], v[76:79], a[100:103], a[196:199]
v_mfma_f32_16x16x32_bf16 a[200:203], v[72:75], a[88:91], a[200:203]
v_mfma_f32_16x16x32_bf16 a[200:203], v[76:79], a[104:107], a[200:203]
ds_read_b128 v[68:71], v7 offset:62464
v_mfma_f32_16x16x32_bf16 a[204:207], v[72:75], a[92:95], a[204:207]
v_mfma_f32_16x16x32_bf16 a[204:207], v[76:79], a[108:111], a[204:207]
s_waitcnt lgkmcnt(4)
v_mfma_f32_16x16x32_bf16 a[208:211], v[48:51], a[80:83], a[208:211]
v_mfma_f32_16x16x32_bf16 a[208:211], v[52:55], a[96:99], a[208:211]
v_mfma_f32_16x16x32_bf16 a[212:215], v[48:51], a[84:87], a[212:215]
ds_read_b128 v[72:75], v7 offset:63488
v_mfma_f32_16x16x32_bf16 a[212:215], v[52:55], a[100:103], a[212:215]
v_mfma_f32_16x16x32_bf16 a[216:219], v[48:51], a[88:91], a[216:219]
v_mfma_f32_16x16x32_bf16 a[216:219], v[52:55], a[104:107], a[216:219]
ds_read_b128 v[76:79], v7 offset:64512
v_mfma_f32_16x16x32_bf16 a[220:223], v[48:51], a[92:95], a[220:223]
v_mfma_f32_16x16x32_bf16 a[220:223], v[52:55], a[108:111], a[220:223]
s_waitcnt lgkmcnt(4)
v_mfma_f32_16x16x32_bf16 a[224:227], v[56:59], a[80:83], a[224:227]
v_mfma_f32_16x16x32_bf16 a[224:227], v[60:63], a[96:99], a[224:227]
v_mfma_f32_16x16x32_bf16 a[228:231], v[56:59], a[84:87], a[228:231]
ds_read_b128 v[48:51], v8 offset:0
v_mfma_f32_16x16x32_bf16 a[228:231], v[60:63], a[100:103], a[228:231]
v_mfma_f32_16x16x32_bf16 a[232:235], v[56:59], a[88:91], a[232:235]
v_mfma_f32_16x16x32_bf16 a[232:235], v[60:63], a[104:107], a[232:235]
ds_read_b128 v[52:55], v8 offset:1024
v_mfma_f32_16x16x32_bf16 a[236:239], v[56:59], a[92:95], a[236:239]
v_mfma_f32_16x16x32_bf16 a[236:239], v[60:63], a[108:111], a[236:239]
s_waitcnt lgkmcnt(4)
v_mfma_f32_16x16x32_bf16 a[240:243], v[64:67], a[80:83], a[240:243]
s_waitcnt vmcnt(0)
v_cmp_eq_u64 vcc, s[68:69], v[14:15]
s_nop 0
s_cmp_eq_u64 vcc, exec
s_cbranch_scc0 L_f_slow3
L_f_back3:
buffer_load_dwordx4 v[112:115], v2, s[8:11], s25 offen offset:3072 sc1
v_mfma_f32_16x16x32_bf16 a[240:243], v[68:71], a[96:99], a[240:243]
v_mfma_f32_16x16x32_bf16 a[244:247], v[64:67], a[84:87], a[244:247]
ds_read_b128 v[56:59], v8 offset:2048
v_mfma_f32_16x16x32_bf16 a[244:247], v[68:71], a[100:103], a[244:247]
v_mfma_f32_16x16x32_bf16 a[248:251], v[64:67], a[88:91], a[248:251]
buffer_load_dwordx4 v[116:119], v4, s[8:11], s25 offen offset:3072 sc1
v_mfma_f32_16x16x32_bf16 a[248:251], v[68:71], a[104:107], a[248:251]
ds_read_b128 v[60:63], v8 offset:3072
v_mfma_f32_16x16x32_bf16 a[252:255], v[64:67], a[92:95], a[252:255]
v_mfma_f32_16x16x32_bf16 a[252:255], v[68:71], a[108:111], a[252:255]
s_waitcnt vmcnt(41)
s_waitcnt lgkmcnt(4)
v_mfma_f32_16x16x32_bf16 a[112:115], v[72:75], v[16:19], a[112:115]
buffer_load_dwordx4 v[120:123], v5, s[8:11], s25 offen offset:3072 sc1
v_mfma_f32_16x16x32_bf16 a[112:115], v[76:79], v[192:195], a[112:115]
v_mfma_f32_16x16x32_bf16 a[116:119], v[72:75], v[20:23], a[116:119]
ds_read_b128 v[64:67], v8 offset:4096
v_mfma_f32_16x16x32_bf16 a[116:119], v[76:79], v[196:199], a[116:119]
v_mfma_f32_16x16x32_bf16 a[120:123], v[72:75], v[24:27], a[120:123]
buffer_load_dwordx4 v[124:127], v6, s[8:11], s25 offen offset:3072 sc1
v_mfma_f32_16x16x32_bf16 a[120:123], v[76:79], v[200:203], a[120:123]
ds_read_b128 v[68:71], v8 offset:5120
v_mfma_f32_16x16x32_bf16 a[124:127], v[72:75], v[28:31], a[124:127]
v_mfma_f32_16x16x32_bf16 a[124:127], v[76:79], v[204:207], a[124:127]
s_waitcnt lgkmcnt(4)
v_mfma_f32_16x16x32_bf16 a[128:131], v[48:51], v[16:19], a[128:131]
buffer_load_dwordx4 v[128:131], v2, s[8:11], s26 offen offset:3072 sc1
v_mfma_f32_16x16x32_bf16 a[128:131], v[52:55], v[192:195], a[128:131]
v_mfma_f32_16x16x32_bf16 a[132:135], v[48:51], v[20:23], a[132:135]
ds_read_b128 v[72:75], v8 offset:6144
v_mfma_f32_16x16x32_bf16 a[132:135], v[52:55], v[196:199], a[132:135]
v_mfma_f32_16x16x32_bf16 a[136:139], v[48:51], v[24:27], a[136:139]
buffer_load_dwordx4 v[132:135], v4, s[8:11], s26 offen offset:3072 sc1
v_mfma_f32_16x16x32_bf16 a[136:139], v[52:55], v[200:203], a[136:139]
ds_read_b128 v[76:79], v8 offset:7168
v_mfma_f32_16x16x32_bf16 a[140:143], v[48:51], v[28:31], a[140:143]
v_mfma_f32_16x16x32_bf16 a[140:143], v[52:55], v[204:207], a[140:143]
s_waitcnt lgkmcnt(4)
v_mfma_f32_16x16x32_bf16 a[144:147], v[56:59], v[16:19], a[144:147]
buffer_load_dwordx4 v[136:139], v5, s[8:11], s26 offen offset:3072 sc1
v_mfma_f32_16x16x32_bf16 a[144:147], v[60:63], v[192:195], a[144:147]
v_mfma_f32_16x16x32_bf16 a[148:151], v[56:59], v[20:23], a[148:151]
ds_read_b128 v[48:51], v8 offset:8192
v_mfma_f32_16x16x32_bf16 a[148:151], v[60:63], v[196:199], a[148:151]
v_mfma_f32_16x16x32_bf16 a[152:155], v[56:59], v[24:27], a[152:155]
buffer_load_dwordx4 v[140:143], v6, s[8:11], s26 offen offset:3072 sc1
v_mfma_f32_16x16x32_bf16 a[152:155], v[60:63], v[200:203], a[152:155]
ds_read_b128 v[52:55], v8 offset:9216
v_mfma_f32_16x16x32_bf16 a[156:159], v[56:59], v[28:31], a[156:159]
v_mfma_f32_16x16x32_bf16 a[156:159], v[60:63], v[204:207], a[156:159]
s_waitcnt lgkmcnt(4)
v_mfma_f32_16x16x32_bf16 a[160:163], v[64:67], v[16:19], a[160:163]
buffer_load_dwordx4 v[144:147], v2, s[8:11], s27 offen offset:3072 sc1
v_mfma_f32_16x16x32_bf16 a[160:163], v[68:71], v[192:195], a[160:163]
v_mfma_f32_16x16x32_bf16 a[164:167], v[64:67], v[20:23], a[164:167]
ds_read_b128 v[56:59], v8 offset:10240
v_mfma_f32_16x16x32_bf16 a[164:167], v[68:71], v[196:199], a[164:167]
v_mfma_f32_16x16x32_bf16 a[168:171], v[64:67], v[24:27], a[168:171]
buffer_load_dwordx4 v[148:151], v4, s[8:11], s27 offen offset:3072 sc1
v_mfma_f32_16x16x32_bf16 a[168:171], v[68:71], v[200:203], a[168:171]
ds_read_b128 v[60:63], v8 offset:11264
v_mfma_f32_16x16x32_bf16 a[172:175], v[64:67], v[28:31], a[172:175]
v_mfma_f32_16x16x32_bf16 a[172:175], v[68:71], v[204:207], a[172:175]
s_waitcnt lgkmcnt(4)
v_mfma_f32_16x16x32_bf16 a[176:179], v[72:75], v[16:19], a[176:179]
buffer_load_dwordx4 v[152:155], v5, s[8:11], s27 offen offset:3072 sc1
v_mfma_f32_16x16x32_bf16 a[176:179], v[76:79], v[192:195], a[176:179]
v_mfma_f32_16x16x32_bf16 a[180:183], v[72:75], v[20:23], a[180:183]
ds_read_b128 v[64:67], v8 offset:12288
v_mfma_f32_16x16x32_bf16 a[180:183], v[76:79], v[196:199], a[180:183]
v_mfma_f32_16x16x32_bf16 a[184:187], v[72:75], v[24:27], a[184:187]
buffer_load_dwordx4 v[156:159], v6, s[8:11], s27 offen offset:3072 sc1
v_mfma_f32_16x16x32_bf16 a[184:187], v[76:79], v[200:203], a[184:187]
ds_read_b128 v[68:71], v8 offset:13312
v_mfma_f32_16x16x32_bf16 a[188:191], v[72:75], v[28:31], a[188:191]
v_mfma_f32_16x16x32_bf16 a[188:191], v[76:79], v[204:207], a[188:191]
s_waitcnt lgkmcnt(4)
v_mfma_f32_16x16x32_bf16 a[192:195], v[48:51], v[16:19], a[192:195]
v_mfma_f32_16x16x32_bf16 a[192:195], v[52:55], v[192:195], a[192:195]
v_mfma_f32_16x16x32_bf16 a[196:199], v[48:51], v[20:23], a[196:199]
ds_read_b128 v[72:75], v8 offset:14336
v_mfma_f32_16x16x32_bf16 a[196:199], v[52:55], v[196:199], a[196:199]
v_mfma_f32_16x16x32_bf16 a[200:203], v[48:51], v[24:27], a[200:203]
v_mfma_f32_16x16x32_bf16 a[200:203], v[52:55], v[200:203], a[200:203]
ds_read_b128 v[76:79], v8 offset:15360
v_mfma_f32_16x16x32_bf16 a[204:207], v[48:51], v[28:31], a[204:207]
v_mfma_f32_16x16x32_bf16 a[204:207], v[52:55], v[204:207], a[204:207]
s_waitcnt lgkmcnt(4)
v_mfma_f32_16x16x32_bf16 a[208:211], v[56:59], v[16:19], a[208:211]
s_waitcnt vmcnt(61)
v_mfma_f32_16x16x32_bf16 a[208:211], v[60:63], v[192:195], a[208:211]
s_barrier
v_mfma_f32_16x16x32_bf16 a[212:215], v[56:59], v[20:23], a[212:215]
ds_read_b128 v[48:51], v2 offset:0
v_mfma_f32_16x16x32_bf16 a[212:215], v[60:63], v[196:199], a[212:215]
v_mfma_f32_16x16x32_bf16 a[216:219], v[56:59], v[24:27], a[216:219]
v_mfma_f32_16x16x32_bf16 a[216:219], v[60:63], v[200:203], a[216:219]
ds_read_b128 v[52:55], v2 offset:1024
v_mfma_f32_16x16x32_bf16 a[220:223], v[56:59], v[28:31], a[220:223]
v_mfma_f32_16x16x32_bf16 a[220:223], v[60:63], v[204:207], a[220:223]
s_waitcnt lgkmcnt(4)
v_mfma_f32_16x16x32_bf16 a[224:227], v[64:67], v[16:19], a[224:227]
v_mfma_f32_16x16x32_bf16 a[224:227], v[68:71], v[192:195], a[224:227]
v_mfma_f32_16x16x32_bf16 a[228:231], v[64:67], v[20:23], a[228:231]
ds_read_b128 v[56:59], v2 offset:2048
v_mfma_f32_16x16x32_bf16 a[228:231], v[68:71], v[196:199], a[228:231]
v_mfma_f32_16x16x32_bf16 a[232:235], v[64:67], v[24:27], a[232:235]
v_mfma_f32_16x16x32_bf16 a[232:235], v[68:71], v[200:203], a[232:235]
ds_read_b128 v[60:63], v2 offset:3072
v_mfma_f32_16x16x32_bf16 a[236:239], v[64:67], v[28:31], a[236:239]
v_mfma_f32_16x16x32_bf16 a[236:239], v[68:71], v[204:207], a[236:239]
s_waitcnt vmcnt(35)
s_waitcnt lgkmcnt(4)
v_mfma_f32_16x16x32_bf16 a[112:115], v[72:75], v[32:35], a[112:115]
v_mfma_f32_16x16x32_bf16 a[112:115], v[76:79], v[80:83], a[112:115]
v_mfma_f32_16x16x32_bf16 a[116:119], v[72:75], v[36:39], a[116:119]
ds_read_b128 v[64:67], v2 offset:4096
v_mfma_f32_16x16x32_bf16 a[116:119], v[76:79], v[84:87], a[116:119]
v_mfma_f32_16x16x32_bf16 a[120:123], v[72:75], v[40:43], a[120:123]
v_mfma_f32_16x16x32_bf16 a[120:123], v[76:79], v[88:91], a[120:123]
ds_read_b128 v[68:71], v2 offset:5120
v_mfma_f32_16x16x32_bf16 a[124:127], v[72:75], v[44:47], a[124:127]
v_mfma_f32_16x16x32_bf16 a[124:127], v[76:79], v[92:95], a[124:127]
s_waitcnt lgkmcnt(4)
v_mfma_f32_16x16x32_bf16 a[128:131], v[48:51], v[32:35], a[128:131]
v_mfma_f32_16x16x32_bf16 a[128:131], v[52:55], v[80:83], a[128:131]
v_mfma_f32_16x16x32_bf16 a[132:135], v[48:51], v[36:39], a[132:135]
ds_read_b128 v[72:75], v2 offset:6144
v_mfma_f32_16x16x32_bf16 a[132:135], v[52:55], v[84:87], a[132:135]
v_mfma_f32_16x16x32_bf16 a[136:139], v[48:51], v[40:43], a[136:139]
v_mfma_f32_16x16x32_bf16 a[136:139], v[52:55], v[88:91], a[136:139]
ds_read_b128 v[76:79], v2 offset:7168
v_mfma_f32_16x16x32_bf16 a[140:143], v[48:51], v[44:47], a[140:143]
v_mfma_f32_16x16x32_bf16 a[140:143], v[52:55], v[92:95], a[140:143]
s_waitcnt lgkmcnt(4)
v_mfma_f32_16x16x32_bf16 a[144:147], v[56:59], v[32:35], a[144:147]
v_mfma_f32_16x16x32_bf16 a[144:147], v[60:63], v[80:83], a[144:147]
v_mfma_f32_16x16x32_bf16 a[148:151], v[56:59], v[36:39], a[148:151]
ds_read_b128 v[48:51], v2 offset:8192
v_mfma_f32_16x16x32_bf16 a[148:151], v[60:63], v[84:87], a[148:151]
v_mfma_f32_16x16x32_bf16 a[152:155], v[56:59], v[40:43], a[152:155]
v_mfma_f32_16x16x32_bf16 a[152:155], v[60:63], v[88:91], a[152:155]
ds_read_b128 v[52:55], v2 offset:9216
v_mfma_f32_16x16x32_bf16 a[156:159], v[56:59], v[44:47], a[156:159]
v_mfma_f32_16x16x32_bf16 a[156:159], v[60:63], v[92:95], a[156:159]
s_waitcnt lgkmcnt(4)
v_mfma_f32_16x16x32_bf16 a[160:163], v[64:67], v[32:35], a[160:163]
v_mfma_f32_16x16x32_bf16 a[160:163], v[68:71], v[80:83], a[160:163]
v_mfma_f32_16x16x32_bf16 a[164:167], v[64:67], v[36:39], a[164:167]
ds_read_b128 v[56:59], v2 offset:10240
v_mfma_f32_16x16x32_bf16 a[164:167], v[68:71], v[84:87], a[164:167]
v_mfma_f32_16x16x32_bf16 a[168:171], v[64:67], v[40:43], a[168:171]
v_mfma_f32_16x16x32_bf16 a[168:171], v[68:71], v[88:91], a[168:171]
ds_read_b128 v[60:63], v2 offset:11264
v_mfma_f32_16x16x32_bf16 a[172:175], v[64:67], v[44:47], a[172:175]
v_mfma_f32_16x16x32_bf16 a[172:175], v[68:71], v[92:95], a[172:175]
s_waitcnt lgkmcnt(4)
v_mfma_f32_16x16x32_bf16 a[176:179], v[72:75], v[32:35], a[176:179]
v_mfma_f32_16x16x32_bf16 a[176:179], v[76:79], v[80:83], a[176:179]
v_mfma_f32_16x16x32_bf16 a[180:183], v[72:75], v[36:39], a[180:183]
ds_read_b128 v[64:67], v2 offset:12288
v_mfma_f32_16x16x32_bf16 a[180:183], v[76:79], v[84:87], a[180:183]
v_mfma_f32_16x16x32_bf16 a[184:187], v[72:75], v[40:43], a[184:187]
v_mfma_f32_16x16x32_bf16 a[184:187], v[76:79], v[88:91], a[184:187]
ds_read_b128 v[68:71], v2 offset:13312
v_mfma_f32_16x16x32_bf16 a[188:191], v[72:75], v[44:47], a[188:191]
v_mfma_f32_16x16x32_bf16 a[188:191], v[76:79], v[92:95], a[188:191]
s_waitcnt lgkmcnt(4)
v_mfma_f32_16x16x32_bf16 a[192:195], v[48:51], v[32:35], a[192:195]
v_mfma_f32_16x16x32_bf16 a[192:195], v[52:55], v[80:83], a[192:195]
v_mfma_f32_16x16x32_bf16 a[196:199], v[48:51], v[36:39], a[196:199]
ds_read_b128 v[72:75], v2 offset:14336
v_mfma_f32_16x16x32_bf16 a[196:199], v[52:55], v[84:87], a[196:199]
v_mfma_f32_16x16x32_bf16 a[200:203], v[48:51], v[40:43], a[200:203]
v_mfma_f32_16x16x32_bf16 a[200:203], v[52:55], v[88:91], a[200:203]
ds_read_b128 v[76:79], v2 offset:15360
v_mfma_f32_16x16x32_bf16 a[204:207], v[48:51], v[44:47], a[204:207]
v_mfma_f32_16x16x32_bf16 a[204:207], v[52:55], v[92:95], a[204:207]
s_waitcnt lgkmcnt(4)
v_mfma_f32_16x16x32_bf16 a[208:211], v[56:59], v[32:35], a[208:211]
v_mfma_f32_16x16x32_bf16 a[208:211], v[60:63], v[80:83], a[208:211]
v_mfma_f32_16x16x32_bf16 a[212:215], v[56:59], v[36:39], a[212:215]
ds_read_b128 v[48:51], v2 offset:16384
v_mfma_f32_16x16x32_bf16 a[212:215], v[60:63], v[84:87], a[212:215]
v_mfma_f32_16x16x32_bf16 a[216:219], v[56:59], v[40:43], a[216:219]
v_mfma_f32_16x16x32_bf16 a[216:219], v[60:63], v[88:91], a[216:219]
ds_read_b128 v[52:55], v2 offset:17408
v_mfma_f32_16x16x32_bf16 a[220:223], v[56:59], v[44:47], a[220:223]
v_mfma_f32_16x16x32_bf16 a[220:223], v[60:63], v[92:95], a[220:223]
s_waitcnt lgkmcnt(4)
v_mfma_f32_16x16x32_bf16 a[224:227], v[64:67], v[32:35], a[224:227]
v_mfma_f32_16x16x32_bf16 a[224:227], v[68:71], v[80:83], a[224:227]
v_mfma_f32_16x16x32_bf16 a[228:231], v[64:67], v[36:39], a[228:231]
ds_read_b128 v[56:59], v2 offset:18432
v_mfma_f32_16x16x32_bf16 a[228:231], v[68:71], v[84:87], a[228:231]
v_mfma_f32_16x16x32_bf16 a[232:235], v[64:67], v[40:43], a[232:235]
v_mfma_f32_16x16x32_bf16 a[232:235], v[68:71], v[88:91], a[232:235]
ds_read_b128 v[60:63], v2 offset:19456
v_mfma_f32_16x16x32_bf16 a[236:239], v[64:67], v[44:47], a[236:239]
v_mfma_f32_16x16x32_bf16 a[236:239], v[68:71], v[92:95], a[236:239]
s_waitcnt vmcnt(8)
s_waitcnt lgkmcnt(4)
v_mfma_f32_16x16x32_bf16 a[112:115], v[72:75], v[96:99], a[112:115]
v_mfma_f32_16x16x32_bf16 a[112:115], v[76:79], v[112:115], a[112:115]
v_mfma_f32_16x16x32_bf16 a[116:119], v[72:75], v[100:103], a[116:119]
ds_read_b128 v[64:67], v2 offset:20480
v_mfma_f32_16x16x32_bf16 a[116:119], v[76:79], v[116:119], a[116:119]
v_mfma_f32_16x16x32_bf16 a[120:123], v[72:75], v[104:107], a[120:123]
v_mfma_f32_16x16x32_bf16 a[120:123], v[76:79], v[120:123], a[120:123]
ds_read_b128 v[68:71], v2 offset:21504
v_mfma_f32_16x16x32_bf16 a[124:127], v[72:75], v[108:111], a[124:127]
v_mfma_f32_16x16x32_bf16 a[124:127], v[76:79], v[124:127], a[124:127]
s_waitcnt vmcnt(0)
s_waitcnt lgkmcnt(4)
v_mfma_f32_16x16x32_bf16 a[112:115], v[48:51], v[128:131], a[112:115]
v_mfma_f32_16x16x32_bf16 a[112:115], v[52:55], v[144:147], a[112:115]
v_mfma_f32_16x16x32_bf16 a[116:119], v[48:51], v[132:135], a[116:119]
ds_read_b128 v[72:75], v2 offset:22528
v_mfma_f32_16x16x32_bf16 a[116:119], v[52:55], v[148:151], a[116:119]
v_mfma_f32_16x16x32_bf16 a[120:123], v[48:51], v[136:139], a[120:123]
v_mfma_f32_16x16x32_bf16 a[120:123], v[52:55], v[152:155], a[120:123]
ds_read_b128 v[76:79], v2 offset:23552
v_mfma_f32_16x16x32_bf16 a[124:127], v[48:51], v[140:143], a[124:127]
v_mfma_f32_16x16x32_bf16 a[124:127], v[52:55], v[156:159], a[124:127]
s_waitcnt lgkmcnt(4)
v_mfma_f32_16x16x32_bf16 a[128:131], v[56:59], v[96:99], a[128:131]
s_waitcnt vmcnt(43)
v_mfma_f32_16x16x32_bf16 a[128:131], v[60:63], v[112:115], a[128:131]
s_barrier
v_mfma_f32_16x16x32_bf16 a[132:135], v[56:59], v[100:103], a[132:135]
ds_read_b128 v[48:51], v2 offset:24576
v_mfma_f32_16x16x32_bf16 a[132:135], v[60:63], v[116:119], a[132:135]
v_mfma_f32_16x16x32_bf16 a[136:139], v[56:59], v[104:107], a[136:139]
v_mfma_f32_16x16x32_bf16 a[136:139], v[60:63], v[120:123], a[136:139]
ds_read_b128 v[52:55], v2 offset:25600
v_mfma_f32_16x16x32_bf16 a[140:143], v[56:59], v[108:111], a[140:143]
v_mfma_f32_16x16x32_bf16 a[140:143], v[60:63], v[124:127], a[140:143]
s_waitcnt lgkmcnt(4)
v_mfma_f32_16x16x32_bf16 a[128:131], v[64:67], v[128:131], a[128:131]
v_mfma_f32_16x16x32_bf16 a[128:131], v[68:71], v[144:147], a[128:131]
v_mfma_f32_16x16x32_bf16 a[132:135], v[64:67], v[132:135], a[132:135]
ds_read_b128 v[56:59], v2 offset:26624
v_mfma_f32_16x16x32_bf16 a[132:135], v[68:71], v[148:151], a[132:135]
v_mfma_f32_16x16x32_bf16 a[136:139], v[64:67], v[136:139], a[136:139]
v_mfma_f32_16x16x32_bf16 a[136:139], v[68:71], v[152:155], a[136:139]
ds_read_b128 v[60:63], v2 offset:27648
v_mfma_f32_16x16x32_bf16 a[140:143], v[64:67], v[140:143], a[140:143]
v_mfma_f32_16x16x32_bf16 a[140:143], v[68:71], v[156:159], a[140:143]
s_waitcnt lgkmcnt(4)
v_mfma_f32_16x16x32_bf16 a[144:147], v[72:75], v[96:99], a[144:147]
v_mfma_f32_16x16x32_bf16 a[144:147], v[76:79], v[112:115], a[144:147]
v_mfma_f32_16x16x32_bf16 a[148:151], v[72:75], v[100:103], a[148:151]
ds_read_b128 v[64:67], v2 offset:28672
v_mfma_f32_16x16x32_bf16 a[148:151], v[76:79], v[116:119], a[148:151]
v_mfma_f32_16x16x32_bf16 a[152:155], v[72:75], v[104:107], a[152:155]
v_mfma_f32_16x16x32_bf16 a[152:155], v[76:79], v[120:123], a[152:155]
ds_read_b128 v[68:71], v2 offset:29696
v_mfma_f32_16x16x32_bf16 a[156:159], v[72:75], v[108:111], a[156:159]
v_mfma_f32_16x16x32_bf16 a[156:159], v[76:79], v[124:127], a[156:159]
s_waitcnt lgkmcnt(4)
v_mfma_f32_16x16x32_bf16 a[144:147], v[48:51], v[128:131], a[144:147]
v_mfma_f32_16x16x32_bf16 a[144:147], v[52:55], v[144:147], a[144:147]
v_mfma_f32_16x16x32_bf16 a[148:151], v[48:51], v[132:135], a[148:151]
ds_read_b128 v[72:75], v2 offset:30720
v_mfma_f32_16x16x32_bf16 a[148:151], v[52:55], v[148:151], a[148:151]
v_mfma_f32_16x16x32_bf16 a[152:155], v[48:51], v[136:139], a[152:155]
v_mfma_f32_16x16x32_bf16 a[152:155], v[52:55], v[152:155], a[152:155]
ds_read_b128 v[76:79], v2 offset:31744
v_mfma_f32_16x16x32_bf16 a[156:159], v[48:51], v[140:143], a[156:159]
v_mfma_f32_16x16x32_bf16 a[156:159], v[52:55], v[156:159], a[156:159]
s_waitcnt lgkmcnt(4)
v_mfma_f32_16x16x32_bf16 a[160:163], v[56:59], v[96:99], a[160:163]
v_mfma_f32_16x16x32_bf16 a[160:163], v[60:63], v[112:115], a[160:163]
v_mfma_f32_16x16x32_bf16 a[164:167], v[56:59], v[100:103], a[164:167]
ds_read_b128 v[48:51], v2 offset:32768
v_mfma_f32_16x16x32_bf16 a[164:167], v[60:63], v[116:119], a[164:167]
v_mfma_f32_16x16x32_bf16 a[168:171], v[56:59], v[104:107], a[168:171]
v_mfma_f32_16x16x32_bf16 a[168:171], v[60:63], v[120:123], a[168:171]
ds_read_b128 v[52:55], v2 offset:33792
v_mfma_f32_16x16x32_bf16 a[172:175], v[56:59], v[108:111], a[172:175]
v_mfma_f32_16x16x32_bf16 a[172:175], v[60:63], v[124:127], a[172:175]
s_waitcnt lgkmcnt(4)
v_mfma_f32_16x16x32_bf16 a[160:163], v[64:67], v[128:131], a[160:163]
v_mfma_f32_16x16x32_bf16 a[160:163], v[68:71], v[144:147], a[160:163]
v_mfma_f32_16x16x32_bf16 a[164:167], v[64:67], v[132:135], a[164:167]
ds_read_b128 v[56:59], v2 offset:34816
v_mfma_f32_16x16x32_bf16 a[164:167], v[68:71], v[148:151], a[164:167]
v_mfma_f32_16x16x32_bf16 a[168:171], v[64:67], v[136:139], a[168:171]
v_mfma_f32_16x16x32_bf16 a[168:171], v[68:71], v[152:155], a[168:171]
ds_read_b128 v[60:63], v2 offset:35840
v_mfma_f32_16x16x32_bf16 a[172:175], v[64:67], v[140:143], a[172:175]
v_mfma_f32_16x16x32_bf16 a[172:175], v[68:71], v[156:159], a[172:175]
s_waitcnt lgkmcnt(4)
v_mfma_f32_16x16x32_bf16 a[176:179], v[72:75], v[96:99], a[176:179]
v_mfma_f32_16x16x32_bf16 a[176:179], v[76:79], v[112:115], a[176:179]
v_mfma_f32_16x16x32_bf16 a[180:183], v[72:75], v[100:103], a[180:183]
ds_read_b128 v[64:67], v2 offset:36864
v_mfma_f32_16x16x32_bf16 a[180:183], v[76:79], v[116:119], a[180:183]
v_accvgpr_read_b32 v208, a112
v_accvgpr_read_b32 v209, a128
v_mfma_f32_16x16x32_bf16 a[184:187], v[72:75], v[104:107], a[184:187]
v_accvgpr_read_b32 v210, a144
v_accvgpr_read_b32 v211, a160
v_mfma_f32_16x16x32_bf16 a[184:187], v[76:79], v[120:123], a[184:187]
ds_read_b128 v[68:71], v2 offset:37888
v_accvgpr_read_b32 v212, a113
v_mfma_f32_16x16x32_bf16 a[188:191], v[72:75], v[108:111], a[188:191]
v_accvgpr_read_b32 v213, a129
v_accvgpr_read_b32 v214, a145
v_mfma_f32_16x16x32_bf16 a[188:191], v[76:79], v[124:127], a[188:191]
v_accvgpr_read_b32 v215, a161
s_waitcnt lgkmcnt(4)
v_mfma_f32_16x16x32_bf16 a[176:179], v[48:51], v[128:131], a[176:179]
v_cvt_pk_bf16_f32 v224, v208, v209
v_cvt_pk_bf16_f32 v225, v210, v211
v_mfma_f32_16x16x32_bf16 a[176:179], v[52:55], v[144:147], a[176:179]
v_cvt_pk_bf16_f32 v226, v212, v213
v_cvt_pk_bf16_f32 v227, v214, v215
v_mfma_f32_16x16x32_bf16 a[180:183], v[48:51], v[132:135], a[180:183]
ds_read_b128 v[72:75], v2 offset:38912
buffer_store_dwordx4 v[224:227], v252, s[8:11], s36 offen offset:0 sc1
v_mfma_f32_16x16x32_bf16 a[180:183], v[52:55], v[148:151], a[180:183]
v_accvgpr_read_b32 v216, a114
v_accvgpr_read_b32 v217, a130
v_mfma_f32_16x16x32_bf16 a[184:187], v[48:51], v[136:139], a[184:187]
v_accvgpr_read_b32 v218, a146
v_accvgpr_read_b32 v219, a162
v_mfma_f32_16x16x32_bf16 a[184:187], v[52:55], v[152:155], a[184:187]
ds_read_b128 v[76:79], v2 offset:39936
v_accvgpr_read_b32 v220, a115
v_mfma_f32_16x16x32_bf16 a[188:191], v[48:51], v[140:143], a[188:191]
v_accvgpr_read_b32 v221, a131
v_accvgpr_read_b32 v222, a147
v_mfma_f32_16x16x32_bf16 a[188:191], v[52:55], v[156:159], a[188:191]
v_accvgpr_read_b32 v223, a163
s_waitcnt lgkmcnt(4)
v_mfma_f32_16x16x32_bf16 a[192:195], v[56:59], v[96:99], a[192:195]
v_cvt_pk_bf16_f32 v228, v216, v217
v_cvt_pk_bf16_f32 v229, v218, v219
v_mfma_f32_16x16x32_bf16 a[192:195], v[60:63], v[112:115], a[192:195]
v_cvt_pk_bf16_f32 v230, v220, v221
v_cvt_pk_bf16_f32 v231, v222, v223
v_mfma_f32_16x16x32_bf16 a[196:199], v[56:59], v[100:103], a[196:199]
ds_read_b128 v[48:51], v2 offset:40960
buffer_store_dwordx4 v[228:231], v252, s[8:11], s36 offen offset:256 sc1
v_mfma_f32_16x16x32_bf16 a[196:199], v[60:63], v[116:119], a[196:199]
v_accvgpr_read_b32 v208, a116
v_accvgpr_read_b32 v209, a132
v_mfma_f32_16x16x32_bf16 a[200:203], v[56:59], v[104:107], a[200:203]
v_accvgpr_read_b32 v210, a148
v_accvgpr_read_b32 v211, a164
v_mfma_f32_16x16x32_bf16 a[200:203], v[60:63], v[120:123], a[200:203]
ds_read_b128 v[52:55], v2 offset:41984
v_accvgpr_read_b32 v212, a117
v_mfma_f32_16x16x32_bf16 a[204:207], v[56:59], v[108:111], a[204:207]
v_accvgpr_read_b32 v213, a133
v_accvgpr_read_b32 v214, a149
v_mfma_f32_16x16x32_bf16 a[204:207], v[60:63], v[124:127], a[204:207]
v_accvgpr_read_b32 v215, a165
s_waitcnt lgkmcnt(4)
v_mfma_f32_16x16x32_bf16 a[192:195], v[64:67], v[128:131], a[192:195]
v_cvt_pk_bf16_f32 v224, v208, v209
v_cvt_pk_bf16_f32 v225, v210, v211
v_mfma_f32_16x16x32_bf16 a[192:195], v[68:71], v[144:147], a[192:195]
v_cvt_pk_bf16_f32 v226, v212, v213
v_cvt_pk_bf16_f32 v227, v214, v215
v_mfma_f32_16x16x32_bf16 a[196:199], v[64:67], v[132:135], a[196:199]
ds_read_b128 v[56:59], v2 offset:43008
buffer_store_dwordx4 v[224:227], v252, s[8:11], s37 offen offset:0 sc1
v_mfma_f32_16x16x32_bf16 a[196:199], v[68:71], v[148:151], a[196:199]
v_accvgpr_read_b32 v216, a118
v_accvgpr_read_b32 v217, a134
v_mfma_f32_16x16x32_bf16 a[200:203], v[64:67], v[136:139], a[200:203]
v_accvgpr_read_b32 v218, a150
v_accvgpr_read_b32 v219, a166
v_mfma_f32_16x16x32_bf16 a[200:203], v[68:71], v[152:155], a[200:203]
ds_read_b128 v[60:63], v2 offset:44032
v_accvgpr_read_b32 v220, a119
v_mfma_f32_16x16x32_bf16 a[204:207], v[64:67], v[140:143], a[204:207]
v_accvgpr_read_b32 v221, a135
v_accvgpr_read_b32 v222, a151
v_mfma_f32_16x16x32_bf16 a[204:207], v[68:71], v[156:159], a[204:207]
v_accvgpr_read_b32 v223, a167
s_waitcnt lgkmcnt(4)
v_mfma_f32_16x16x32_bf16 a[208:211], v[72:75], v[96:99], a[208:211]
v_cvt_pk_bf16_f32 v228, v216, v217
v_cvt_pk_bf16_f32 v229, v218, v219
v_mfma_f32_16x16x32_bf16 a[208:211], v[76:79], v[112:115], a[208:211]
v_cvt_pk_bf16_f32 v230, v220, v221
v_cvt_pk_bf16_f32 v231, v222, v223
v_mfma_f32_16x16x32_bf16 a[212:215], v[72:75], v[100:103], a[212:215]
ds_read_b128 v[64:67], v2 offset:45056
buffer_store_dwordx4 v[228:231], v252, s[8:11], s37 offen offset:256 sc1
v_mfma_f32_16x16x32_bf16 a[212:215], v[76:79], v[116:119], a[212:215]
v_accvgpr_read_b32 v208, a120
v_accvgpr_read_b32 v209, a136
v_mfma_f32_16x16x32_bf16 a[216:219], v[72:75], v[104:107], a[216:219]
v_accvgpr_read_b32 v210, a152
v_accvgpr_read_b32 v211, a168
v_mfma_f32_16x16x32_bf16 a[216:219], v[76:79], v[120:123], a[216:219]
ds_read_b128 v[68:71], v2 offset:46080
v_accvgpr_read_b32 v212, a121
v_mfma_f32_16x16x32_bf16 a[220:223], v[72:75], v[108:111], a[220:223]
v_accvgpr_read_b32 v213, a137
v_accvgpr_read_b32 v214, a153
v_mfma_f32_16x16x32_bf16 a[220:223], v[76:79], v[124:127], a[220:223]
v_accvgpr_read_b32 v215, a169
s_waitcnt lgkmcnt(4)
v_mfma_f32_16x16x32_bf16 a[208:211], v[48:51], v[128:131], a[208:211]
v_cvt_pk_bf16_f32 v224, v208, v209
v_cvt_pk_bf16_f32 v225, v210, v211
v_mfma_f32_16x16x32_bf16 a[208:211], v[52:55], v[144:147], a[208:211]
v_cvt_pk_bf16_f32 v226, v212, v213
v_cvt_pk_bf16_f32 v227, v214, v215
v_mfma_f32_16x16x32_bf16 a[212:215], v[48:51], v[132:135], a[212:215]
ds_read_b128 v[72:75], v2 offset:47104
buffer_store_dwordx4 v[224:227], v252, s[8:11], s38 offen offset:0 sc1
v_mfma_f32_16x16x32_bf16 a[212:215], v[52:55], v[148:151], a[212:215]
v_accvgpr_read_b32 v216, a122
v_accvgpr_read_b32 v217, a138
v_mfma_f32_16x16x32_bf16 a[216:219], v[48:51], v[136:139], a[216:219]
v_accvgpr_read_b32 v218, a154
v_accvgpr_read_b32 v219, a170
v_mfma_f32_16x16x32_bf16 a[216:219], v[52:55], v[152:155], a[216:219]
ds_read_b128 v[76:79], v2 offset:48128
v_accvgpr_read_b32 v220, a123
v_mfma_f32_16x16x32_bf16 a[220:223], v[48:51], v[140:143], a[220:223]
v_accvgpr_read_b32 v221, a139
v_accvgpr_read_b32 v222, a155
v_mfma_f32_16x16x32_bf16 a[220:223], v[52:55], v[156:159], a[220:223]
v_accvgpr_read_b32 v223, a171
s_waitcnt lgkmcnt(4)
v_mfma_f32_16x16x32_bf16 a[224:227], v[56:59], v[96:99], a[224:227]
s_waitcnt vmcnt(18)
v_cvt_pk_bf16_f32 v228, v216, v217
v_mfma_f32_16x16x32_bf16 a[224:227], v[60:63], v[112:115], a[224:227]
s_barrier
v_mfma_f32_16x16x32_bf16 a[228:231], v[56:59], v[100:103], a[228:231]
ds_read_b128 v[48:51], v2 offset:49152
v_cvt_pk_bf16_f32 v229, v218, v219
v_mfma_f32_16x16x32_bf16 a[228:231], v[60:63], v[116:119], a[228:231]
v_cvt_pk_bf16_f32 v230, v220, v221
v_cvt_pk_bf16_f32 v231, v222, v223
v_mfma_f32_16x16x32_bf16 a[232:235], v[56:59], v[104:107], a[232:235]
buffer_store_dwordx4 v[228:231], v252, s[8:11], s38 offen offset:256 sc1
v_mfma_f32_16x16x32_bf16 a[232:235], v[60:63], v[120:123], a[232:235]
ds_read_b128 v[52:55], v2 offset:50176
v_accvgpr_read_b32 v208, a124
v_mfma_f32_16x16x32_bf16 a[236:239], v[56:59], v[108:111], a[236:239]
v_accvgpr_read_b32 v209, a140
v_accvgpr_read_b32 v210, a156
v_mfma_f32_16x16x32_bf16 a[236:239], v[60:63], v[124:127], a[236:239]
v_accvgpr_read_b32 v211, a172
s_waitcnt lgkmcnt(4)
v_mfma_f32_16x16x32_bf16 a[224:227], v[64:67], v[128:131], a[224:227]
v_accvgpr_read_b32 v212, a125
v_accvgpr_read_b32 v213, a141
v_mfma_f32_16x16x32_bf16 a[224:227], v[68:71], v[144:147], a[224:227]
v_accvgpr_read_b32 v214, a157
v_accvgpr_read_b32 v215, a173
v_mfma_f32_16x16x32_bf16 a[228:231], v[64:67], v[132:135], a[228:231]
ds_read_b128 v[56:59], v2 offset:51200
v_cvt_pk_bf16_f32 v224, v208, v209
v_mfma_f32_16x16x32_bf16 a[228:231], v[68:71], v[148:151], a[228:231]
v_cvt_pk_bf16_f32 v225, v210, v211
v_cvt_pk_bf16_f32 v226, v212, v213
v_mfma_f32_16x16x32_bf16 a[232:235], v[64:67], v[136:139], a[232:235]
v_cvt_pk_bf16_f32 v227, v214, v215
buffer_store_dwordx4 v[224:227], v252, s[8:11], s39 offen offset:0 sc1
v_mfma_f32_16x16x32_bf16 a[232:235], v[68:71], v[152:155], a[232:235]
ds_read_b128 v[60:63], v2 offset:52224
v_accvgpr_read_b32 v216, a126
v_mfma_f32_16x16x32_bf16 a[236:239], v[64:67], v[140:143], a[236:239]
v_accvgpr_read_b32 v217, a142
v_accvgpr_read_b32 v218, a158
v_mfma_f32_16x16x32_bf16 a[236:239], v[68:71], v[156:159], a[236:239]
v_accvgpr_read_b32 v219, a174
v_accvgpr_read_b32 v220, a127
v_accvgpr_read_b32 v221, a143
v_accvgpr_read_b32 v222, a159
v_accvgpr_read_b32 v223, a175
v_cvt_pk_bf16_f32 v228, v216, v217
v_cvt_pk_bf16_f32 v229, v218, v219
v_cvt_pk_bf16_f32 v230, v220, v221
v_cvt_pk_bf16_f32 v231, v222, v223
buffer_store_dwordx4 v[228:231], v252, s[8:11], s39 offen offset:256 sc1
s_waitcnt lgkmcnt(4)
v_mfma_f32_16x16x32_bf16 a[240:243], v[72:75], v[16:19], a[240:243]
v_mfma_f32_16x16x32_bf16 a[240:243], v[76:79], v[192:195], a[240:243]
v_mfma_f32_16x16x32_bf16 a[244:247], v[72:75], v[20:23], a[244:247]
ds_read_b128 v[64:67], v2 offset:53248
v_mfma_f32_16x16x32_bf16 a[244:247], v[76:79], v[196:199], a[244:247]
v_accvgpr_read_b32 v208, a176
v_accvgpr_read_b32 v209, a192
v_mfma_f32_16x16x32_bf16 a[248:251], v[72:75], v[24:27], a[248:251]
v_accvgpr_read_b32 v210, a208
v_accvgpr_read_b32 v211, a224
v_mfma_f32_16x16x32_bf16 a[248:251], v[76:79], v[200:203], a[248:251]
ds_read_b128 v[68:71], v2 offset:54272
v_accvgpr_read_b32 v212, a177
v_mfma_f32_16x16x32_bf16 a[252:255], v[72:75], v[28:31], a[252:255]
v_accvgpr_read_b32 v213, a193
v_accvgpr_read_b32 v214, a209
v_mfma_f32_16x16x32_bf16 a[252:255], v[76:79], v[204:207], a[252:255]
v_accvgpr_read_b32 v215, a225
s_waitcnt lgkmcnt(4)
v_mfma_f32_16x16x32_bf16 a[240:243], v[48:51], v[32:35], a[240:243]
v_cvt_pk_bf16_f32 v224, v208, v209
v_cvt_pk_bf16_f32 v225, v210, v211
v_mfma_f32_16x16x32_bf16 a[240:243], v[52:55], v[80:83], a[240:243]
v_cvt_pk_bf16_f32 v226, v212, v213
v_cvt_pk_bf16_f32 v227, v214, v215
v_mfma_f32_16x16x32_bf16 a[244:247], v[48:51], v[36:39], a[244:247]
buffer_store_dwordx4 v[224:227], v252, s[8:11], s36 offen offset:2048 sc1
v_mfma_f32_16x16x32_bf16 a[244:247], v[52:55], v[84:87], a[244:247]
v_accvgpr_read_b32 v216, a178
v_accvgpr_read_b32 v217, a194
v_mfma_f32_16x16x32_bf16 a[248:251], v[48:51], v[40:43], a[248:251]
v_accvgpr_read_b32 v218, a210
v_accvgpr_read_b32 v219, a226
v_mfma_f32_16x16x32_bf16 a[248:251], v[52:55], v[88:91], a[248:251]
v_accvgpr_read_b32 v220, a179
v_accvgpr_read_b32 v221, a195
v_mfma_f32_16x16x32_bf16 a[252:255], v[48:51], v[44:47], a[252:255]
v_accvgpr_read_b32 v222, a211
v_accvgpr_read_b32 v223, a227
v_mfma_f32_16x16x32_bf16 a[252:255], v[52:55], v[92:95], a[252:255]
v_cvt_pk_bf16_f32 v228, v216, v217
s_waitcnt lgkmcnt(2)
v_mfma_f32_16x16x32_bf16 a[240:243], v[56:59], v[96:99], a[240:243]
v_cvt_pk_bf16_f32 v229, v218, v219
v_cvt_pk_bf16_f32 v230, v220, v221
v_mfma_f32_16x16x32_bf16 a[240:243], v[60:63], v[112:115], a[240:243]
v_cvt_pk_bf16_f32 v231, v222, v223
buffer_store_dwordx4 v[228:231], v252, s[8:11], s36 offen offset:2304 sc1
v_mfma_f32_16x16x32_bf16 a[244:247], v[56:59], v[100:103], a[244:247]
v_accvgpr_read_b32 v208, a180
v_accvgpr_read_b32 v209, a196
v_mfma_f32_16x16x32_bf16 a[244:247], v[60:63], v[116:119], a[244:247]
v_accvgpr_read_b32 v210, a212
v_accvgpr_read_b32 v211, a228
v_mfma_f32_16x16x32_bf16 a[248:251], v[56:59], v[104:107], a[248:251]
v_accvgpr_read_b32 v212, a181
v_accvgpr_read_b32 v213, a197
v_mfma_f32_16x16x32_bf16 a[248:251], v[60:63], v[120:123], a[248:251]
v_accvgpr_read_b32 v214, a213
v_accvgpr_read_b32 v215, a229
v_mfma_f32_16x16x32_bf16 a[252:255], v[56:59], v[108:111], a[252:255]
v_cvt_pk_bf16_f32 v224, v208, v209
v_cvt_pk_bf16_f32 v225, v210, v211
v_mfma_f32_16x16x32_bf16 a[252:255], v[60:63], v[124:127], a[252:255]
v_cvt_pk_bf16_f32 v226, v212, v213
s_waitcnt lgkmcnt(0)
v_mfma_f32_16x16x32_bf16 a[240:243], v[64:67], v[128:131], a[240:243]
v_cvt_pk_bf16_f32 v227, v214, v215
buffer_store_dwordx4 v[224:227], v252, s[8:11], s37 offen offset:2048 sc1
v_mfma_f32_16x16x32_bf16 a[240:243], v[68:71], v[144:147], a[240:243]
v_accvgpr_read_b32 v216, a182
v_accvgpr_read_b32 v217, a198
v_mfma_f32_16x16x32_bf16 a[244:247], v[64:67], v[132:135], a[244:247]
v_accvgpr_read_b32 v218, a214
v_accvgpr_read_b32 v219, a230
v_mfma_f32_16x16x32_bf16 a[244:247], v[68:71], v[148:151], a[244:247]
v_accvgpr_read_b32 v220, a183
v_accvgpr_read_b32 v221, a199
v_mfma_f32_16x16x32_bf16 a[248:251], v[64:67], v[136:139], a[248:251]
v_accvgpr_read_b32 v222, a215
v_accvgpr_read_b32 v223, a231
v_mfma_f32_16x16x32_bf16 a[248:251], v[68:71], v[152:155], a[248:251]
v_cvt_pk_bf16_f32 v228, v216, v217
v_cvt_pk_bf16_f32 v229, v218, v219
v_mfma_f32_16x16x32_bf16 a[252:255], v[64:67], v[140:143], a[252:255]
v_cvt_pk_bf16_f32 v230, v220, v221
v_cvt_pk_bf16_f32 v231, v222, v223
v_mfma_f32_16x16x32_bf16 a[252:255], v[68:71], v[156:159], a[252:255]
buffer_store_dwordx4 v[228:231], v252, s[8:11], s37 offen offset:2304 sc1
s_barrier
v_accvgpr_read_b32 v208, a184
v_accvgpr_read_b32 v209, a200
v_accvgpr_read_b32 v210, a216
v_accvgpr_read_b32 v211, a232
v_accvgpr_read_b32 v212, a185
v_accvgpr_read_b32 v213, a201
v_accvgpr_read_b32 v214, a217
v_accvgpr_read_b32 v215, a233
v_cvt_pk_bf16_f32 v224, v208, v209
v_cvt_pk_bf16_f32 v225, v210, v211
v_cvt_pk_bf16_f32 v226, v212, v213
v_cvt_pk_bf16_f32 v227, v214, v215
buffer_store_dwordx4 v[224:227], v252, s[8:11], s38 offen offset:2048 sc1
v_accvgpr_read_b32 v216, a186
v_accvgpr_read_b32 v217, a202
v_accvgpr_read_b32 v218, a218
v_accvgpr_read_b32 v219, a234
v_accvgpr_read_b32 v220, a187
v_accvgpr_read_b32 v221, a203
v_accvgpr_read_b32 v222, a219
v_accvgpr_read_b32 v223, a235
v_cvt_pk_bf16_f32 v228, v216, v217
v_cvt_pk_bf16_f32 v229, v218, v219
v_cvt_pk_bf16_f32 v230, v220, v221
v_cvt_pk_bf16_f32 v231, v222, v223
buffer_store_dwordx4 v[228:231], v252, s[8:11], s38 offen offset:2304 sc1
v_accvgpr_read_b32 v208, a188
v_accvgpr_read_b32 v209, a204
v_accvgpr_read_b32 v210, a220
v_accvgpr_read_b32 v211, a236
v_accvgpr_read_b32 v212, a189
v_accvgpr_read_b32 v213, a205
v_accvgpr_read_b32 v214, a221
v_accvgpr_read_b32 v215, a237
v_cvt_pk_bf16_f32 v224, v208, v209
v_cvt_pk_bf16_f32 v225, v210, v211
v_cvt_pk_bf16_f32 v226, v212, v213
v_cvt_pk_bf16_f32 v227, v214, v215
buffer_store_dwordx4 v[224:227], v252, s[8:11], s39 offen offset:2048 sc1
v_accvgpr_read_b32 v216, a190
v_accvgpr_read_b32 v217, a206
v_accvgpr_read_b32 v218, a222
v_accvgpr_read_b32 v219, a238
v_accvgpr_read_b32 v220, a191
v_accvgpr_read_b32 v221, a207
v_accvgpr_read_b32 v222, a223
v_accvgpr_read_b32 v223, a239
v_cvt_pk_bf16_f32 v228, v216, v217
v_cvt_pk_bf16_f32 v229, v218, v219
v_cvt_pk_bf16_f32 v230, v220, v221
v_cvt_pk_bf16_f32 v231, v222, v223
buffer_store_dwordx4 v[228:231], v252, s[8:11], s39 offen offset:2304 sc1
v_accvgpr_read_b32 v208, a240
v_accvgpr_read_b32 v209, a241
v_accvgpr_read_b32 v210, a242
v_accvgpr_read_b32 v211, a243
v_accvgpr_read_b32 v212, a244
v_accvgpr_read_b32 v213, a245
v_accvgpr_read_b32 v214, a246
v_accvgpr_read_b32 v215, a247
v_cvt_pk_bf16_f32 v224, v208, v209
v_cvt_pk_bf16_f32 v225, v210, v211
v_cvt_pk_bf16_f32 v226, v212, v213
v_cvt_pk_bf16_f32 v227, v214, v215
s_nop 0
v_permlane16_swap_b32 v224, v226
v_permlane16_swap_b32 v225, v227
buffer_store_dwordx4 v[224:227], v9, s[8:11], s32 offen sc1
v_accvgpr_read_b32 v216, a248
v_accvgpr_read_b32 v217, a249
v_accvgpr_read_b32 v218, a250
v_accvgpr_read_b32 v219, a251
v_accvgpr_read_b32 v220, a252
v_accvgpr_read_b32 v221, a253
v_accvgpr_read_b32 v222, a254
v_accvgpr_read_b32 v223, a255
v_cvt_pk_bf16_f32 v228, v216, v217
v_cvt_pk_bf16_f32 v229, v218, v219
v_cvt_pk_bf16_f32 v230, v220, v221
v_cvt_pk_bf16_f32 v231, v222, v223
s_nop 0
v_permlane16_swap_b32 v228, v230
v_permlane16_swap_b32 v229, v231
buffer_store_dwordx4 v[228:231], v9, s[8:11], s33 offen sc1
v_mov_b32 v13, 2146435072
v_cmp_eq_u32 vcc, 0, v1
v_mov_b32 v14, s68
v_mov_b32 v15, s69
v_cndmask_b32 v13, v13, 0, vcc
s_waitcnt vmcnt(0)
buffer_store_dwordx2 v[14:15], v13, s[8:11], s35 offen sc1
s_cmp_eq_u32 s7, 1
s_cbranch_scc1 L_last
s_lshr_b32 s20, s5, 2
s_lshl_b32 s20, s20, 3
s_lshr_b32 s21, s6, 2
s_add_u32 s20, s20, s21
s_and_b32 s21, s5, 3
s_lshl_b32 s21, s21, 2
s_and_b32 s22, s6, 3
s_add_u32 s21, s21, s22
s_mul_i32 s22, s21, 147456
s_add_u32 s22, s22, 4198400
s_mul_i32 s23, s4, 36864
s_add_u32 s22, s22, s23
s_add_u32 m0, s23, 0
s_add_u32 s40, s22, 0
buffer_load_dwordx4 v2, s[8:11], s40 offen offset:0 sc1 lds
buffer_load_dwordx4 v2, s[8:11], s40 offen offset:1024 sc1 lds
buffer_load_dwordx4 v2, s[8:11], s40 offen offset:2048 sc1 lds
buffer_load_dwordx4 v2, s[8:11], s40 offen offset:3072 sc1 lds
s_add_u32 m0, s23, 4096
s_add_u32 s40, s22, 4096
buffer_load_dwordx4 v2, s[8:11], s40 offen offset:0 sc1 lds
buffer_load_dwordx4 v2, s[8:11], s40 offen offset:1024 sc1 lds
buffer_load_dwordx4 v2, s[8:11], s40 offen offset:2048 sc1 lds
buffer_load_dwordx4 v2, s[8:11], s40 offen offset:3072 sc1 lds
s_add_u32 m0, s23, 8192
s_add_u32 s40, s22, 8192
buffer_load_dwordx4 v2, s[8:11], s40 offen offset:0 sc1 lds
buffer_load_dwordx4 v2, s[8:11], s40 offen offset:1024 sc1 lds
buffer_load_dwordx4 v2, s[8:11], s40 offen offset:2048 sc1 lds
buffer_load_dwordx4 v2, s[8:11], s40 offen offset:3072 sc1 lds
s_add_u32 m0, s23, 12288
s_add_u32 s40, s22, 12288
buffer_load_dwordx4 v2, s[8:11], s40 offen offset:0 sc1 lds
buffer_load_dwordx4 v2, s[8:11], s40 offen offset:1024 sc1 lds
buffer_load_dwordx4 v2, s[8:11], s40 offen offset:2048 sc1 lds
buffer_load_dwordx4 v2, s[8:11], s40 offen offset:3072 sc1 lds
s_add_u32 m0, s23, 16384
s_add_u32 s40, s22, 16384
buffer_load_dwordx4 v2, s[8:11], s40 offen offset:0 sc1 lds
buffer_load_dwordx4 v2, s[8:11], s40 offen offset:1024 sc1 lds
buffer_load_dwordx4 v2, s[8:11], s40 offen offset:2048 sc1 lds
buffer_load_dwordx4 v2, s[8:11], s40 offen offset:3072 sc1 lds
s_add_u32 m0, s23, 20480
s_add_u32 s40, s22, 20480
buffer_load_dwordx4 v2, s[8:11], s40 offen offset:0 sc1 lds
buffer_load_dwordx4 v2, s[8:11], s40 offen offset:1024 sc1 lds
buffer_load_dwordx4 v2, s[8:11], s40 offen offset:2048 sc1 lds
buffer_load_dwordx4 v2, s[8:11], s40 offen offset:3072 sc1 lds
s_add_u32 m0, s23, 24576
s_add_u32 s40, s22, 24576
buffer_load_dwordx4 v2, s[8:11], s40 offen offset:0 sc1 lds
buffer_load_dwordx4 v2, s[8:11], s40 offen offset:1024 sc1 lds
buffer_load_dwordx4 v2, s[8:11], s40 offen offset:2048 sc1 lds
buffer_load_dwordx4 v2, s[8:11], s40 offen offset:3072 sc1 lds
s_add_u32 m0, s23, 28672
s_add_u32 s40, s22, 28672
buffer_load_dwordx4 v2, s[8:11], s40 offen offset:0 sc1 lds
buffer_load_dwordx4 v2, s[8:11], s40 offen offset:1024 sc1 lds
buffer_load_dwordx4 v2, s[8:11], s40 offen offset:2048 sc1 lds
buffer_load_dwordx4 v2, s[8:11], s40 offen offset:3072 sc1 lds
s_add_u32 m0, s23, 32768
s_add_u32 s40, s22, 32768
buffer_load_dwordx4 v2, s[8:11], s40 offen offset:0 sc1 lds
buffer_load_dwordx4 v2, s[8:11], s40 offen offset:1024 sc1 lds
buffer_load_dwordx4 v2, s[8:11], s40 offen offset:2048 sc1 lds
buffer_load_dwordx4 v2, s[8:11], s40 offen offset:3072 sc1 lds
s_cmp_eq_u32 s4, 3
s_cbranch_scc1 L_r_side
v_and_b32 v6, 7, v1
v_lshrrev_b32 v7, 3, v1
s_mul_i32 s22, s4, 24
v_add_u32 v7, s22, v7
s_and_b32 s23, s6, 1
s_lshl_b32 s23, s23, 3
v_add_u32 v8, s23, v6
v_lshlrev_b32 v8, 4, v8
v_lshl_add_u32 v4, v7, 8, v8
s_lshl_b32 s24, s5, 4
s_lshr_b32 s25, s6, 1
s_add_u32 s24, s24, s25
s_mul_i32 s20, s24, 18432
s_add_u32 s24, s20, 37416960
s_add_u32 s25, s24, 4096
buffer_load_dwordx4 v[16:19], v4, s[8:11], s24 offen offset:0 sc1
buffer_load_dwordx4 v[20:23], v4, s[8:11], s24 offen offset:2048 sc1
buffer_load_dwordx4 v[24:27], v4, s[8:11], s25 offen offset:0 sc1
s_lshl_b32 s24, s5, 2
s_lshr_b32 s25, s6, 3
s_add_u32 s24, s24, s25
s_lshl_b32 s24, s24, 12
s_add_u32 s24, s24, 655360
v_and_b32 v6, 31, v1
v_lshlrev_b32 v6, 7, v6
s_mov_b32 s52, 0
L_poll6:
buffer_load_dwordx2 v[14:15], v6, s[8:11], s24 offen sc1
s_add_u32 s52, s52, 1
s_waitcnt vmcnt(0)
v_cmp_ne_u64 vcc, s[68:69], v[14:15]
s_cmp_ge_u32 s52, 0x100000
s_cbranch_scc1 L_got6
s_and_b64 exec, exec, vcc
s_cbranch_execnz L_poll6
L_got6:
s_mov_b64 exec, -1
s_add_u32 s24, s20, 80146432
s_add_u32 s25, s24, 4096
buffer_load_dwordx4 v[28:31], v4, s[8:11], s24 offen offset:0 sc1
buffer_load_dwordx4 v[32:35], v4, s[8:11], s24 offen offset:2048 sc1
buffer_load_dwordx4 v[36:39], v4, s[8:11], s25 offen offset:0 sc1
s_add_u32 s24, s20, 82505728
s_add_u32 s25, s24, 4096
buffer_load_dwordx4 v[40:43], v4, s[8:11], s24 offen offset:0 sc1
buffer_load_dwordx4 v[44:47], v4, s[8:11], s24 offen offset:2048 sc1
buffer_load_dwordx4 v[48:51], v4, s[8:11], s25 offen offset:0 sc1
s_add_u32 s24, s20, 84865024
s_add_u32 s25, s24, 4096
buffer_load_dwordx4 v[52:55], v4, s[8:11], s24 offen offset:0 sc1
buffer_load_dwordx4 v[56:59], v4, s[8:11], s24 offen offset:2048 sc1
buffer_load_dwordx4 v[60:63], v4, s[8:11], s25 offen offset:0 sc1
s_add_u32 s24, s20, 87224320
s_add_u32 s25, s24, 4096
buffer_load_dwordx4 v[64:67], v4, s[8:11], s24 offen offset:0 sc1
buffer_load_dwordx4 v[68:71], v4, s[8:11], s24 offen offset:2048 sc1
buffer_load_dwordx4 v[72:75], v4, s[8:11], s25 offen offset:0 sc1
s_add_u32 s24, s20, 89583616
s_add_u32 s25, s24, 4096
buffer_load_dwordx4 v[76:79], v4, s[8:11], s24 offen offset:0 sc1
buffer_load_dwordx4 v[80:83], v4, s[8:11], s24 offen offset:2048 sc1
buffer_load_dwordx4 v[84:87], v4, s[8:11], s25 offen offset:0 sc1
s_add_u32 s24, s20, 91942912
s_add_u32 s25, s24, 4096
buffer_load_dwordx4 v[88:91], v4, s[8:11], s24 offen offset:0 sc1
buffer_load_dwordx4 v[92:95], v4, s[8:11], s24 offen offset:2048 sc1
buffer_load_dwordx4 v[96:99], v4, s[8:11], s25 offen offset:0 sc1
s_add_u32 s24, s20, 94302208
s_add_u32 s25, s24, 4096
buffer_load_dwordx4 v[100:103], v4, s[8:11], s24 offen offset:0 sc1
buffer_load_dwordx4 v[104:107], v4, s[8:11], s24 offen offset:2048 sc1
buffer_load_dwordx4 v[108:111], v4, s[8:11], s25 offen offset:0 sc1
s_add_u32 s24, s20, 96661504
s_add_u32 s25, s24, 4096
buffer_load_dwordx4 v[112:115], v4, s[8:11], s24 offen offset:0 sc1
buffer_load_dwordx4 v[116:119], v4, s[8:11], s24 offen offset:2048 sc1
buffer_load_dwordx4 v[120:123], v4, s[8:11], s25 offen offset:0 sc1
s_waitcnt vmcnt(26)
v_lshlrev_b32 v128, 16, v16
v_and_b32 v129, 0xffff0000, v16
v_lshlrev_b32 v130, 16, v17
v_and_b32 v131, 0xffff0000, v17
v_lshlrev_b32 v132, 16, v18
v_and_b32 v133, 0xffff0000, v18
v_lshlrev_b32 v134, 16, v19
v_and_b32 v135, 0xffff0000, v19
s_waitcnt vmcnt(25)
v_lshlrev_b32 v136, 16, v20
v_and_b32 v137, 0xffff0000, v20
v_lshlrev_b32 v138, 16, v21
v_and_b32 v139, 0xffff0000, v21
v_lshlrev_b32 v140, 16, v22
v_and_b32 v141, 0xffff0000, v22
v_lshlrev_b32 v142, 16, v23
v_and_b32 v143, 0xffff0000, v23
s_waitcnt vmcnt(24)
v_lshlrev_b32 v144, 16, v24
v_and_b32 v145, 0xffff0000, v24
v_lshlrev_b32 v146, 16, v25
v_and_b32 v147, 0xffff0000, v25
v_lshlrev_b32 v148, 16, v26
v_and_b32 v149, 0xffff0000, v26
v_lshlrev_b32 v150, 16, v27
v_and_b32 v151, 0xffff0000, v27
s_waitcnt vmcnt(23)
v_lshlrev_b32 v6, 16, v28
v_and_b32 v7, 0xffff0000, v28
v_add_f32 v128, v128, v6
v_add_f32 v129, v129, v7
v_lshlrev_b32 v8, 16, v29
v_and_b32 v9, 0xffff0000, v29
v_add_f32 v130, v130, v8
v_add_f32 v131, v131, v9
v_lshlrev_b32 v6, 16, v30
v_and_b32 v7, 0xffff0000, v30
v_add_f32 v132, v132, v6
v_add_f32 v133, v133, v7
v_lshlrev_b32 v8, 16, v31
v_and_b32 v9, 0xffff0000, v31
v_add_f32 v134, v134, v8
v_add_f32 v135, v135, v9
s_waitcnt vmcnt(22)
v_lshlrev_b32 v6, 16, v32
v_and_b32 v7, 0xffff0000, v32
v_add_f32 v136, v136, v6
v_add_f32 v137, v137, v7
v_lshlrev_b32 v8, 16, v33
v_and_b32 v9, 0xffff0000, v33
v_add_f32 v138, v138, v8
v_add_f32 v139, v139, v9
v_lshlrev_b32 v6, 16, v34
v_and_b32 v7, 0xffff0000, v34
v_add_f32 v140, v140, v6
v_add_f32 v141, v141, v7
v_lshlrev_b32 v8, 16, v35
v_and_b32 v9, 0xffff0000, v35
v_add_f32 v142, v142, v8
v_add_f32 v143, v143, v9
s_waitcnt vmcnt(21)
v_lshlrev_b32 v6, 16, v36
v_and_b32 v7, 0xffff0000, v36
v_add_f32 v144, v144, v6
v_add_f32 v145, v145, v7
v_lshlrev_b32 v8, 16, v37
v_and_b32 v9, 0xffff0000, v37
v_add_f32 v146, v146, v8
v_add_f32 v147, v147, v9
v_lshlrev_b32 v6, 16, v38
v_and_b32 v7, 0xffff0000, v38
v_add_f32 v148, v148, v6
v_add_f32 v149, v149, v7
v_lshlrev_b32 v8, 16, v39
v_and_b32 v9, 0xffff0000, v39
v_add_f32 v150, v150, v8
v_add_f32 v151, v151, v9
s_waitcnt vmcnt(20)
v_lshlrev_b32 v6, 16, v40
v_and_b32 v7, 0xffff0000, v40
v_add_f32 v128, v128, v6
v_add_f32 v129, v129, v7
v_lshlrev_b32 v8, 16, v41
v_and_b32 v9, 0xffff0000, v41
v_add_f32 v130, v130, v8
v_add_f32 v131, v131, v9
v_lshlrev_b32 v6, 16, v42
v_and_b32 v7, 0xffff0000, v42
v_add_f32 v132, v132, v6
v_add_f32 v133, v133, v7
v_lshlrev_b32 v8, 16, v43
v_and_b32 v9, 0xffff0000, v43
v_add_f32 v134, v134, v8
v_add_f32 v135, v135, v9
s_waitcnt vmcnt(19)
v_lshlrev_b32 v6, 16, v44
v_and_b32 v7, 0xffff0000, v44
v_add_f32 v136, v136, v6
v_add_f32 v137, v137, v7
v_lshlrev_b32 v8, 16, v45
v_and_b32 v9, 0xffff0000, v45
v_add_f32 v138, v138, v8
v_add_f32 v139, v139, v9
v_lshlrev_b32 v6, 16, v46
v_and_b32 v7, 0xffff0000, v46
v_add_f32 v140, v140, v6
v_add_f32 v141, v141, v7
v_lshlrev_b32 v8, 16, v47
v_and_b32 v9, 0xffff0000, v47
v_add_f32 v142, v142, v8
v_add_f32 v143, v143, v9
s_waitcnt vmcnt(18)
v_lshlrev_b32 v6, 16, v48
v_and_b32 v7, 0xffff0000, v48
v_add_f32 v144, v144, v6
v_add_f32 v145, v145, v7
v_lshlrev_b32 v8, 16, v49
v_and_b32 v9, 0xffff0000, v49
v_add_f32 v146, v146, v8
v_add_f32 v147, v147, v9
v_lshlrev_b32 v6, 16, v50
v_and_b32 v7, 0xffff0000, v50
v_add_f32 v148, v148, v6
v_add_f32 v149, v149, v7
v_lshlrev_b32 v8, 16, v51
v_and_b32 v9, 0xffff0000, v51
v_add_f32 v150, v150, v8
v_add_f32 v151, v151, v9
s_waitcnt vmcnt(17)
v_lshlrev_b32 v6, 16, v52
v_and_b32 v7, 0xffff0000, v52
v_add_f32 v128, v128, v6
v_add_f32 v129, v129, v7
v_lshlrev_b32 v8, 16, v53
v_and_b32 v9, 0xffff0000, v53
v_add_f32 v130, v130, v8
v_add_f32 v131, v131, v9
v_lshlrev_b32 v6, 16, v54
v_and_b32 v7, 0xffff0000, v54
v_add_f32 v132, v132, v6
v_add_f32 v133, v133, v7
v_lshlrev_b32 v8, 16, v55
v_and_b32 v9, 0xffff0000, v55
v_add_f32 v134, v134, v8
v_add_f32 v135, v135, v9
s_waitcnt vmcnt(16)
v_lshlrev_b32 v6, 16, v56
v_and_b32 v7, 0xffff0000, v56
v_add_f32 v136, v136, v6
v_add_f32 v137, v137, v7
v_lshlrev_b32 v8, 16, v57
v_and_b32 v9, 0xffff0000, v57
v_add_f32 v138, v138, v8
v_add_f32 v139, v139, v9
v_lshlrev_b32 v6, 16, v58
v_and_b32 v7, 0xffff0000, v58
v_add_f32 v140, v140, v6
v_add_f32 v141, v141, v7
v_lshlrev_b32 v8, 16, v59
v_and_b32 v9, 0xffff0000, v59
v_add_f32 v142, v142, v8
v_add_f32 v143, v143, v9
s_waitcnt vmcnt(15)
v_lshlrev_b32 v6, 16, v60
v_and_b32 v7, 0xffff0000, v60
v_add_f32 v144, v144, v6
v_add_f32 v145, v145, v7
v_lshlrev_b32 v8, 16, v61
v_and_b32 v9, 0xffff0000, v61
v_add_f32 v146, v146, v8
v_add_f32 v147, v147, v9
v_lshlrev_b32 v6, 16, v62
v_and_b32 v7, 0xffff0000, v62
v_add_f32 v148, v148, v6
v_add_f32 v149, v149, v7
v_lshlrev_b32 v8, 16, v63
v_and_b32 v9, 0xffff0000, v63
v_add_f32 v150, v150, v8
v_add_f32 v151, v151, v9
s_waitcnt vmcnt(14)
v_lshlrev_b32 v6, 16, v64
v_and_b32 v7, 0xffff0000, v64
v_add_f32 v128, v128, v6
v_add_f32 v129, v129, v7
v_lshlrev_b32 v8, 16, v65
v_and_b32 v9, 0xffff0000, v65
v_add_f32 v130, v130, v8
v_add_f32 v131, v131, v9
v_lshlrev_b32 v6, 16, v66
v_and_b32 v7, 0xffff0000, v66
v_add_f32 v132, v132, v6
v_add_f32 v133, v133, v7
v_lshlrev_b32 v8, 16, v67
v_and_b32 v9, 0xffff0000, v67
v_add_f32 v134, v134, v8
v_add_f32 v135, v135, v9
s_waitcnt vmcnt(13)
v_lshlrev_b32 v6, 16, v68
v_and_b32 v7, 0xffff0000, v68
v_add_f32 v136, v136, v6
v_add_f32 v137, v137, v7
v_lshlrev_b32 v8, 16, v69
v_and_b32 v9, 0xffff0000, v69
v_add_f32 v138, v138, v8
v_add_f32 v139, v139, v9
v_lshlrev_b32 v6, 16, v70
v_and_b32 v7, 0xffff0000, v70
v_add_f32 v140, v140, v6
v_add_f32 v141, v141, v7
v_lshlrev_b32 v8, 16, v71
v_and_b32 v9, 0xffff0000, v71
v_add_f32 v142, v142, v8
v_add_f32 v143, v143, v9
s_waitcnt vmcnt(12)
v_lshlrev_b32 v6, 16, v72
v_and_b32 v7, 0xffff0000, v72
v_add_f32 v144, v144, v6
v_add_f32 v145, v145, v7
v_lshlrev_b32 v8, 16, v73
v_and_b32 v9, 0xffff0000, v73
v_add_f32 v146, v146, v8
v_add_f32 v147, v147, v9
v_lshlrev_b32 v6, 16, v74
v_and_b32 v7, 0xffff0000, v74
v_add_f32 v148, v148, v6
v_add_f32 v149, v149, v7
v_lshlrev_b32 v8, 16, v75
v_and_b32 v9, 0xffff0000, v75
v_add_f32 v150, v150, v8
v_add_f32 v151, v151, v9
s_waitcnt vmcnt(11)
v_lshlrev_b32 v6, 16, v76
v_and_b32 v7, 0xffff0000, v76
v_add_f32 v128, v128, v6
v_add_f32 v129, v129, v7
v_lshlrev_b32 v8, 16, v77
v_and_b32 v9, 0xffff0000, v77
v_add_f32 v130, v130, v8
v_add_f32 v131, v131, v9
v_lshlrev_b32 v6, 16, v78
v_and_b32 v7, 0xffff0000, v78
v_add_f32 v132, v132, v6
v_add_f32 v133, v133, v7
v_lshlrev_b32 v8, 16, v79
v_and_b32 v9, 0xffff0000, v79
v_add_f32 v134, v134, v8
v_add_f32 v135, v135, v9
s_waitcnt vmcnt(10)
v_lshlrev_b32 v6, 16, v80
v_and_b32 v7, 0xffff0000, v80
v_add_f32 v136, v136, v6
v_add_f32 v137, v137, v7
v_lshlrev_b32 v8, 16, v81
v_and_b32 v9, 0xffff0000, v81
v_add_f32 v138, v138, v8
v_add_f32 v139, v139, v9
v_lshlrev_b32 v6, 16, v82
v_and_b32 v7, 0xffff0000, v82
v_add_f32 v140, v140, v6
v_add_f32 v141, v141, v7
v_lshlrev_b32 v8, 16, v83
v_and_b32 v9, 0xffff0000, v83
v_add_f32 v142, v142, v8
v_add_f32 v143, v143, v9
s_waitcnt vmcnt(9)
v_lshlrev_b32 v6, 16, v84
v_and_b32 v7, 0xffff0000, v84
v_add_f32 v144, v144, v6
v_add_f32 v145, v145, v7
v_lshlrev_b32 v8, 16, v85
v_and_b32 v9, 0xffff0000, v85
v_add_f32 v146, v146, v8
v_add_f32 v147, v147, v9
v_lshlrev_b32 v6, 16, v86
v_and_b32 v7, 0xffff0000, v86
v_add_f32 v148, v148, v6
v_add_f32 v149, v149, v7
v_lshlrev_b32 v8, 16, v87
v_and_b32 v9, 0xffff0000, v87
v_add_f32 v150, v150, v8
v_add_f32 v151, v151, v9
s_waitcnt vmcnt(8)
v_lshlrev_b32 v6, 16, v88
v_and_b32 v7, 0xffff0000, v88
v_add_f32 v128, v128, v6
v_add_f32 v129, v129, v7
v_lshlrev_b32 v8, 16, v89
v_and_b32 v9, 0xffff0000, v89
v_add_f32 v130, v130, v8
v_add_f32 v131, v131, v9
v_lshlrev_b32 v6, 16, v90
v_and_b32 v7, 0xffff0000, v90
v_add_f32 v132, v132, v6
v_add_f32 v133, v133, v7
v_lshlrev_b32 v8, 16, v91
v_and_b32 v9, 0xffff0000, v91
v_add_f32 v134, v134, v8
v_add_f32 v135, v135, v9
s_waitcnt vmcnt(7)
v_lshlrev_b32 v6, 16, v92
v_and_b32 v7, 0xffff0000, v92
v_add_f32 v136, v136, v6
v_add_f32 v137, v137, v7
v_lshlrev_b32 v8, 16, v93
v_and_b32 v9, 0xffff0000, v93
v_add_f32 v138, v138, v8
v_add_f32 v139, v139, v9
v_lshlrev_b32 v6, 16, v94
v_and_b32 v7, 0xffff0000, v94
v_add_f32 v140, v140, v6
v_add_f32 v141, v141, v7
v_lshlrev_b32 v8, 16, v95
v_and_b32 v9, 0xffff0000, v95
v_add_f32 v142, v142, v8
v_add_f32 v143, v143, v9
s_waitcnt vmcnt(6)
v_lshlrev_b32 v6, 16, v96
v_and_b32 v7, 0xffff0000, v96
v_add_f32 v144, v144, v6
v_add_f32 v145, v145, v7
v_lshlrev_b32 v8, 16, v97
v_and_b32 v9, 0xffff0000, v97
v_add_f32 v146, v146, v8
v_add_f32 v147, v147, v9
v_lshlrev_b32 v6, 16, v98
v_and_b32 v7, 0xffff0000, v98
v_add_f32 v148, v148, v6
v_add_f32 v149, v149, v7
v_lshlrev_b32 v8, 16, v99
v_and_b32 v9, 0xffff0000, v99
v_add_f32 v150, v150, v8
v_add_f32 v151, v151, v9
s_waitcnt vmcnt(5)
v_lshlrev_b32 v6, 16, v100
v_and_b32 v7, 0xffff0000, v100
v_add_f32 v128, v128, v6
v_add_f32 v129, v129, v7
v_lshlrev_b32 v8, 16, v101
v_and_b32 v9, 0xffff0000, v101
v_add_f32 v130, v130, v8
v_add_f32 v131, v131, v9
v_lshlrev_b32 v6, 16, v102
v_and_b32 v7, 0xffff0000, v102
v_add_f32 v132, v132, v6
v_add_f32 v133, v133, v7
v_lshlrev_b32 v8, 16, v103
v_and_b32 v9, 0xffff0000, v103
v_add_f32 v134, v134, v8
v_add_f32 v135, v135, v9
s_waitcnt vmcnt(4)
v_lshlrev_b32 v6, 16, v104
v_and_b32 v7, 0xffff0000, v104
v_add_f32 v136, v136, v6
v_add_f32 v137, v137, v7
v_lshlrev_b32 v8, 16, v105
v_and_b32 v9, 0xffff0000, v105
v_add_f32 v138, v138, v8
v_add_f32 v139, v139, v9
v_lshlrev_b32 v6, 16, v106
v_and_b32 v7, 0xffff0000, v106
v_add_f32 v140, v140, v6
v_add_f32 v141, v141, v7
v_lshlrev_b32 v8, 16, v107
v_and_b32 v9, 0xffff0000, v107
v_add_f32 v142, v142, v8
v_add_f32 v143, v143, v9
s_waitcnt vmcnt(3)
v_lshlrev_b32 v6, 16, v108
v_and_b32 v7, 0xffff0000, v108
v_add_f32 v144, v144, v6
v_add_f32 v145, v145, v7
v_lshlrev_b32 v8, 16, v109
v_and_b32 v9, 0xffff0000, v109
v_add_f32 v146, v146, v8
v_add_f32 v147, v147, v9
v_lshlrev_b32 v6, 16, v110
v_and_b32 v7, 0xffff0000, v110
v_add_f32 v148, v148, v6
v_add_f32 v149, v149, v7
v_lshlrev_b32 v8, 16, v111
v_and_b32 v9, 0xffff0000, v111
v_add_f32 v150, v150, v8
v_add_f32 v151, v151, v9
s_waitcnt vmcnt(2)
v_lshlrev_b32 v6, 16, v112
v_and_b32 v7, 0xffff0000, v112
v_add_f32 v128, v128, v6
v_add_f32 v129, v129, v7
v_lshlrev_b32 v8, 16, v113
v_and_b32 v9, 0xffff0000, v113
v_add_f32 v130, v130, v8
v_add_f32 v131, v131, v9
v_lshlrev_b32 v6, 16, v114
v_and_b32 v7, 0xffff0000, v114
v_add_f32 v132, v132, v6
v_add_f32 v133, v133, v7
v_lshlrev_b32 v8, 16, v115
v_and_b32 v9, 0xffff0000, v115
v_add_f32 v134, v134, v8
v_add_f32 v135, v135, v9
s_waitcnt vmcnt(1)
v_lshlrev_b32 v6, 16, v116
v_and_b32 v7, 0xffff0000, v116
v_add_f32 v136, v136, v6
v_add_f32 v137, v137, v7
v_lshlrev_b32 v8, 16, v117
v_and_b32 v9, 0xffff0000, v117
v_add_f32 v138, v138, v8
v_add_f32 v139, v139, v9
v_lshlrev_b32 v6, 16, v118
v_and_b32 v7, 0xffff0000, v118
v_add_f32 v140, v140, v6
v_add_f32 v141, v141, v7
v_lshlrev_b32 v8, 16, v119
v_and_b32 v9, 0xffff0000, v119
v_add_f32 v142, v142, v8
v_add_f32 v143, v143, v9
s_waitcnt vmcnt(0)
v_lshlrev_b32 v6, 16, v120
v_and_b32 v7, 0xffff0000, v120
v_add_f32 v144, v144, v6
v_add_f32 v145, v145, v7
v_lshlrev_b32 v8, 16, v121
v_and_b32 v9, 0xffff0000, v121
v_add_f32 v146, v146, v8
v_add_f32 v147, v147, v9
v_lshlrev_b32 v6, 16, v122
v_and_b32 v7, 0xffff0000, v122
v_add_f32 v148, v148, v6
v_add_f32 v149, v149, v7
v_lshlrev_b32 v8, 16, v123
v_and_b32 v9, 0xffff0000, v123
v_add_f32 v150, v150, v8
v_add_f32 v151, v151, v9
v_cvt_pk_bf16_f32 v152, v128, v129
v_cvt_pk_bf16_f32 v153, v130, v131
v_cvt_pk_bf16_f32 v154, v132, v133
v_cvt_pk_bf16_f32 v155, v134, v135
v_cvt_pk_bf16_f32 v156, v136, v137
v_cvt_pk_bf16_f32 v157, v138, v139
v_cvt_pk_bf16_f32 v158, v140, v141
v_cvt_pk_bf16_f32 v159, v142, v143
v_cvt_pk_bf16_f32 v160, v144, v145
v_cvt_pk_bf16_f32 v161, v146, v147
v_cvt_pk_bf16_f32 v162, v148, v149
v_cvt_pk_bf16_f32 v163, v150, v151
s_add_u32 s24, s20, 30339072
s_add_u32 s25, s24, 4096
buffer_store_dwordx4 v[152:155], v4, s[8:11], s24 offen offset:0 sc1
buffer_store_dwordx4 v[156:159], v4, s[8:11], s24 offen offset:2048 sc1
buffer_store_dwordx4 v[160:163], v4, s[8:11], s25 offen offset:0 sc1
v_add_f32 v6, v128, v129
v_mul_f32 v7, v128, v128
v_mul_f32 v9, v129, v129
v_mov_b32 v8, 0
v_add_f32 v6, v6, v130
v_add_f32 v8, v8, v131
v_fmac_f32 v7, v130, v130
v_fmac_f32 v9, v131, v131
v_add_f32 v6, v6, v132
v_add_f32 v8, v8, v133
v_fmac_f32 v7, v132, v132
v_fmac_f32 v9, v133, v133
v_add_f32 v6, v6, v134
v_add_f32 v8, v8, v135
v_fmac_f32 v7, v134, v134
v_fmac_f32 v9, v135, v135
v_add_f32 v6, v6, v136
v_add_f32 v8, v8, v137
v_fmac_f32 v7, v136, v136
v_fmac_f32 v9, v137, v137
v_add_f32 v6, v6, v138
v_add_f32 v8, v8, v139
v_fmac_f32 v7, v138, v138
v_fmac_f32 v9, v139, v139
v_add_f32 v6, v6, v140
v_add_f32 v8, v8, v141
v_fmac_f32 v7, v140, v140
v_fmac_f32 v9, v141, v141
v_add_f32 v6, v6, v142
v_add_f32 v8, v8, v143
v_fmac_f32 v7, v142, v142
v_fmac_f32 v9, v143, v143
v_add_f32 v6, v6, v144
v_add_f32 v8, v8, v145
v_fmac_f32 v7, v144, v144
v_fmac_f32 v9, v145, v145
v_add_f32 v6, v6, v146
v_add_f32 v8, v8, v147
v_fmac_f32 v7, v146, v146
v_fmac_f32 v9, v147, v147
v_add_f32 v6, v6, v148
v_add_f32 v8, v8, v149
v_fmac_f32 v7, v148, v148
v_fmac_f32 v9, v149, v149
v_add_f32 v6, v6, v150
v_add_f32 v8, v8, v151
v_fmac_f32 v7, v150, v150
v_fmac_f32 v9, v151, v151
v_add_f32 v6, v6, v8
v_add_f32 v7, v7, v9
s_nop 0
v_add_f32_dpp v6, v6, v6 row_ror:8 row_mask:0xf bank_mask:0xf
v_add_f32_dpp v7, v7, v7 row_ror:8 row_mask:0xf bank_mask:0xf
v_mov_b32 v8, v6
v_mov_b32 v9, v7
s_nop 0
v_permlane16_swap_b32 v6, v8
v_permlane16_swap_b32 v7, v9
v_add_f32 v6, v6, v8
v_add_f32 v7, v7, v9
v_mov_b32 v8, v6
v_mov_b32 v9, v7
s_nop 0
v_permlane32_swap_b32 v6, v8
v_permlane32_swap_b32 v7, v9
v_add_f32 v6, v6, v8
v_add_f32 v7, v7, v9
v_and_b32 v10, 7, v1
v_lshlrev_b32 v10, 3, v10
v_add_u32 v10, 147456, v10
s_lshl_b32 s24, s4, 6
v_add_u32 v11, s24, v10
ds_write_b64 v11, v[6:7]
s_waitcnt lgkmcnt(0)
s_barrier
ds_read_b64 v[6:7], v10
ds_read_b64 v[8:9], v10 offset:64
ds_read_b64 v[12:13], v10 offset:128
s_waitcnt lgkmcnt(0)
v_add_f32 v6, v6, v8
v_add_f32 v7, v7, v9
v_add_f32 v6, v6, v12
v_add_f32 v7, v7, v13
v_mul_f32 v6, 0x3ae38e39, v6
v_mul_f32 v7, 0x3ae38e39, v7
v_fma_f32 v7, -v6, v6, v7
v_max_f32 v7, 0, v7
v_add_f32 v7, 0x3727c5ac, v7
v_rsq_f32 v7, v7
s_nop 0
v_mul_f32 v6, v6, v7
v_fma_f32 v128, v128, v7, -v6
v_fma_f32 v129, v129, v7, -v6
v_fma_f32 v130, v130, v7, -v6
v_fma_f32 v131, v131, v7, -v6
v_fma_f32 v132, v132, v7, -v6
v_fma_f32 v133, v133, v7, -v6
v_fma_f32 v134, v134, v7, -v6
v_fma_f32 v135, v135, v7, -v6
v_fma_f32 v136, v136, v7, -v6
v_fma_f32 v137, v137, v7, -v6
v_fma_f32 v138, v138, v7, -v6
v_fma_f32 v139, v139, v7, -v6
v_fma_f32 v140, v140, v7, -v6
v_fma_f32 v141, v141, v7, -v6
v_fma_f32 v142, v142, v7, -v6
v_fma_f32 v143, v143, v7, -v6
v_fma_f32 v144, v144, v7, -v6
v_fma_f32 v145, v145, v7, -v6
v_fma_f32 v146, v146, v7, -v6
v_fma_f32 v147, v147, v7, -v6
v_fma_f32 v148, v148, v7, -v6
v_fma_f32 v149, v149, v7, -v6
v_fma_f32 v150, v150, v7, -v6
v_fma_f32 v151, v151, v7, -v6
v_cvt_pk_bf16_f32 v168, v128, v129
v_cvt_pk_bf16_f32 v169, v130, v131
v_cvt_pk_bf16_f32 v170, v132, v133
v_cvt_pk_bf16_f32 v171, v134, v135
v_cvt_pk_bf16_f32 v172, v136, v137
v_cvt_pk_bf16_f32 v173, v138, v139
v_cvt_pk_bf16_f32 v174, v140, v141
v_cvt_pk_bf16_f32 v175, v142, v143
v_cvt_pk_bf16_f32 v176, v144, v145
v_cvt_pk_bf16_f32 v177, v146, v147
v_cvt_pk_bf16_f32 v178, v148, v149
v_cvt_pk_bf16_f32 v179, v150, v151
s_add_u32 s24, s20, 25620480
s_add_u32 s25, s24, 4096
buffer_store_dwordx4 v[168:171], v4, s[8:11], s24 offen offset:0 sc1
buffer_store_dwordx4 v[172:175], v4, s[8:11], s24 offen offset:2048 sc1
buffer_store_dwordx4 v[176:179], v4, s[8:11], s25 offen offset:0 sc1
s_lshl_b32 s24, s5, 4
s_lshr_b32 s25, s6, 1
s_add_u32 s24, s24, s25
s_lshl_b32 s24, s24, 3
s_and_b32 s25, s6, 1
s_mul_i32 s25, s25, 3
s_add_u32 s24, s24, s25
s_add_u32 s24, s24, s4
s_lshl_b32 s24, s24, 7
s_add_u32 s24, s24, 1835008
v_mov_b32 v13, 2146435072
v_cmp_eq_u32 vcc, 0, v1
v_mov_b32 v14, s68
v_mov_b32 v15, s69
v_cndmask_b32 v13, v13, 0, vcc
s_waitcnt vmcnt(0)
buffer_store_dwordx2 v[14:15], v13, s[8:11], s24 offen sc1
s_branch L_r_done
L_r_side:
s_barrier
s_waitcnt vmcnt(0)
L_r_done:
s_barrier
s_mov_b32 s70, 25620480
s_mov_b32 s71, 30339072
s_mov_b32 s72, 35057664
s_mov_b32 s73, 39776256
s_mov_b32 s74, 42266624
s_mov_b32 s75, 61272064
s_mov_b32 s76, 99020800
s_mov_b32 s77, 1048576
s_mov_b32 s7, 1
s_lshr_b32 s20, s5, 2
s_lshl_b32 s20, s20, 3
s_lshr_b32 s21, s6, 2
s_add_u32 s20, s20, s21
s_and_b32 s21, s5, 3
s_lshl_b32 s21, s21, 2
s_and_b32 s22, s6, 3
s_add_u32 s21, s21, s22
s_lshl_b32 s24, s20, 3
s_sub_u32 s25, s24, 1
s_max_i32 s35, s25, 0
s_mul_i32 s25, s35, 18432
s_lshl_b32 s26, s4, 1
s_add_u32 s36, s24, s26
s_mul_i32 s24, s36, 18432
s_add_u32 s26, s24, s70
s_add_u32 s27, s26, 18432
s_add_u32 s28, s25, s70
v_add_u32 v4, 0x10000, v2
v_add_u32 v5, 0x20000, v2
s_cmp_eq_u32 s4, 3
s_cselect_b32 s29, 0, s4
s_cselect_b32 s31, 16, 9
s_lshl_b32 s30, s29, 10
v_and_b32 v12, 15, v1
v_mov_b32 v13, 2146435072
v_cmp_le_u32 vcc, s31, v12
s_nop 1
v_cndmask_b32 v19, v13, v2, vcc
s_add_u32 s31, s30, 2048
v_add_u32 v6, s31, v2
v_add_u32 v7, s31, v4
v_add_u32 v8, s31, v5
s_add_u32 s31, s30, 5120
v_add_u32 v9, s31, v2
v_add_u32 v10, s31, v4
v_add_u32 v11, s31, v5
v_mul_u32_u24 v14, 43, v1
v_lshrrev_b32 v14, 8, v14
v_mul_u32_u24 v15, 6, v14
v_sub_u32 v15, v1, v15
v_cmp_eq_u32 vcc, 1, v14
v_mov_b32 v16, s36
s_nop 0
v_addc_co_u32 v16, vcc, 0, v16, vcc
v_cmp_eq_u32 vcc, 2, v14
v_mov_b32 v17, s35
s_nop 0
v_cndmask_b32 v16, v16, v17, vcc
v_lshlrev_b32 v16, 3, v16
v_add_lshl_u32 v16, v16, v15, 7
s_add_u32 s22, s77, 786432
s_mov_b32 s52, 0
L_poll7:
buffer_load_dwordx2 v[14:15], v16, s[8:11], s22 offen sc1
s_add_u32 s52, s52, 1
s_waitcnt vmcnt(0)
v_cmp_ne_u64 vcc, s[68:69], v[14:15]
s_cmp_ge_u32 s52, 0x100000
s_cbranch_scc1 L_got7
s_and_b64 exec, exec, vcc
s_cbranch_execnz L_poll7
L_got7:
s_mov_b64 exec, -1
buffer_load_dwordx4 a[0:3], v2, s[8:11], s26 offen offset:0 sc1
buffer_load_dwordx4 a[72:75], v2, s[8:11], s27 offen offset:0 sc1
buffer_load_dwordx4 a[144:147], v19, s[8:11], s28 offen offset:0 sc1
buffer_load_dwordx4 a[4:7], v2, s[8:11], s26 offen offset:1024 sc1
buffer_load_dwordx4 a[76:79], v2, s[8:11], s27 offen offset:1024 sc1
buffer_load_dwordx4 a[148:151], v19, s[8:11], s28 offen offset:1024 sc1
buffer_load_dwordx4 a[8:11], v2, s[8:11], s26 offen offset:2048 sc1
buffer_load_dwordx4 a[80:83], v2, s[8:11], s27 offen offset:2048 sc1
buffer_load_dwordx4 a[152:155], v19, s[8:11], s28 offen offset:2048 sc1
buffer_load_dwordx4 a[12:15], v2, s[8:11], s26 offen offset:3072 sc1
buffer_load_dwordx4 a[84:87], v2, s[8:11], s27 offen offset:3072 sc1
buffer_load_dwordx4 a[156:159], v19, s[8:11], s28 offen offset:3072 sc1
s_add_u32 s26, s26, 4096
s_add_u32 s27, s27, 4096
s_add_u32 s28, s28, 4096
buffer_load_dwordx4 a[16:19], v2, s[8:11], s26 offen offset:0 sc1
buffer_load_dwordx4 a[88:91], v2, s[8:11], s27 offen offset:0 sc1
buffer_load_dwordx4 a[160:163], v19, s[8:11], s28 offen offset:0 sc1
buffer_load_dwordx4 a[20:23], v2, s[8:11], s26 offen offset:1024 sc1
buffer_load_dwordx4 a[92:95], v2, s[8:11], s27 offen offset:1024 sc1
buffer_load_dwordx4 a[164:167], v19, s[8:11], s28 offen offset:1024 sc1
buffer_load_dwordx4 a[24:27], v2, s[8:11], s26 offen offset:2048 sc1
buffer_load_dwordx4 a[96:99], v2, s[8:11], s27 offen offset:2048 sc1
buffer_load_dwordx4 a[168:171], v19, s[8:11], s28 offen offset:2048 sc1
buffer_load_dwordx4 a[28:31], v2, s[8:11], s26 offen offset:3072 sc1
buffer_load_dwordx4 a[100:103], v2, s[8:11], s27 offen offset:3072 sc1
buffer_load_dwordx4 a[172:175], v19, s[8:11], s28 offen offset:3072 sc1
v_lshrrev_b32 v13, 4, v1
v_lshlrev_b32 v14, 2, v13
v_sub_u32 v14, v12, v14
v_subrev_u32 v15, 0, v14
v_cmp_gt_u32 s[52:53], 8, v15
v_cmp_gt_i32 s[44:45], -8, v15
v_subrev_u32 v15, 1, v14
v_cmp_gt_u32 s[54:55], 8, v15
v_cmp_gt_i32 s[46:47], -8, v15
v_subrev_u32 v15, 2, v14
v_cmp_gt_u32 s[56:57], 8, v15
v_cmp_gt_i32 s[48:49], -8, v15
v_subrev_u32 v15, 3, v14
v_cmp_gt_u32 s[58:59], 8, v15
v_cmp_gt_i32 s[50:51], -8, v15
s_and_b32 s31, s20, 7
s_or_b32 s31, s31, s4
s_cmp_eq_u32 s31, 0
s_cselect_b64 s[60:61], 0, s[44:45]
s_cselect_b64 s[62:63], 0, s[46:47]
s_cselect_b64 s[64:65], 0, s[48:49]
s_cselect_b64 s[66:67], 0, s[50:51]
ds_read_b128 a[216:219], v2 offset:0
ds_read_b128 a[220:223], v2 offset:8192
ds_read_b128 a[224:227], v2 offset:1024
ds_read_b128 a[228:231], v2 offset:9216
ds_read_b128 a[232:235], v2 offset:2048
ds_read_b128 a[236:239], v2 offset:10240
s_waitcnt vmcnt(18)
s_waitcnt lgkmcnt(4)
v_mfma_f32_16x16x32_bf16 v[32:35], a[216:219], a[0:3], 0
s_add_u32 s26, s26, 4096
s_add_u32 s27, s27, 4096
s_add_u32 s28, s28, 4096
buffer_load_dwordx4 a[32:35], v2, s[8:11], s26 offen offset:0 sc1
v_mfma_f32_16x16x32_bf16 v[32:35], a[220:223], a[4:7], v[32:35]
ds_read_b128 a[240:243], v2 offset:3072
v_mfma_f32_16x16x32_bf16 v[36:39], a[216:219], a[72:75], 0
v_mfma_f32_16x16x32_bf16 v[36:39], a[220:223], a[76:79], v[36:39]
ds_read_b128 a[244:247], v2 offset:11264
s_waitcnt lgkmcnt(4)
v_mfma_f32_16x16x32_bf16 v[40:43], a[224:227], a[0:3], 0
buffer_load_dwordx4 a[104:107], v2, s[8:11], s27 offen offset:0 sc1
v_mfma_f32_16x16x32_bf16 v[40:43], a[228:231], a[4:7], v[40:43]
ds_read_b128 a[216:219], v2 offset:4096
v_mfma_f32_16x16x32_bf16 v[44:47], a[224:227], a[72:75], 0
v_mfma_f32_16x16x32_bf16 v[44:47], a[228:231], a[76:79], v[44:47]
ds_read_b128 a[220:223], v2 offset:12288
s_waitcnt lgkmcnt(4)
v_mfma_f32_16x16x32_bf16 v[48:51], a[232:235], a[0:3], 0
buffer_load_dwordx4 a[176:179], v19, s[8:11], s28 offen offset:0 sc1
v_mfma_f32_16x16x32_bf16 v[48:51], a[236:239], a[4:7], v[48:51]
ds_read_b128 a[224:227], v2 offset:5120
v_mfma_f32_16x16x32_bf16 v[52:55], a[232:235], a[72:75], 0
v_mfma_f32_16x16x32_bf16 v[52:55], a[236:239], a[76:79], v[52:55]
ds_read_b128 a[228:231], v2 offset:13312
s_waitcnt lgkmcnt(4)
v_mfma_f32_16x16x32_bf16 v[56:59], a[240:243], a[0:3], 0
buffer_load_dwordx4 a[36:39], v2, s[8:11], s26 offen offset:1024 sc1
v_mfma_f32_16x16x32_bf16 v[56:59], a[244:247], a[4:7], v[56:59]
ds_read_b128 a[232:235], v2 offset:6144
v_mfma_f32_16x16x32_bf16 v[60:63], a[240:243], a[72:75], 0
v_mfma_f32_16x16x32_bf16 v[60:63], a[244:247], a[76:79], v[60:63]
ds_read_b128 a[236:239], v2 offset:14336
s_waitcnt lgkmcnt(4)
v_mfma_f32_16x16x32_bf16 v[64:67], a[216:219], a[0:3], 0
buffer_load_dwordx4 a[108:111], v2, s[8:11], s27 offen offset:1024 sc1
v_mfma_f32_16x16x32_bf16 v[64:67], a[220:223], a[4:7], v[64:67]
ds_read_b128 a[240:243], v2 offset:7168
v_mfma_f32_16x16x32_bf16 v[68:71], a[216:219], a[72:75], 0
v_mfma_f32_16x16x32_bf16 v[68:71], a[220:223], a[76:79], v[68:71]
ds_read_b128 a[244:247], v2 offset:15360
s_waitcnt lgkmcnt(4)
v_mfma_f32_16x16x32_bf16 v[72:75], a[0:3], a[224:227], 0
buffer_load_dwordx4 a[180:183], v19, s[8:11], s28 offen offset:1024 sc1
v_mfma_f32_16x16x32_bf16 v[72:75], a[4:7], a[228:231], v[72:75]
ds_read_b128 a[216:219], v6 offset:0
v_mfma_f32_16x16x32_bf16 v[76:79], a[72:75], a[224:227], 0
v_mfma_f32_16x16x32_bf16 v[76:79], a[76:79], a[228:231], v[76:79]
ds_read_b128 a[220:223], v6 offset:8192
s_waitcnt lgkmcnt(4)
v_mfma_f32_16x16x32_bf16 v[80:83], a[0:3], a[232:235], 0
buffer_load_dwordx4 a[40:43], v2, s[8:11], s26 offen offset:2048 sc1
v_mfma_f32_16x16x32_bf16 v[80:83], a[4:7], a[236:239], v[80:83]
ds_read_b128 a[224:227], v9 offset:0
v_mfma_f32_16x16x32_bf16 v[84:87], a[72:75], a[232:235], 0
v_mfma_f32_16x16x32_bf16 v[84:87], a[76:79], a[236:239], v[84:87]
ds_read_b128 a[228:231], v9 offset:8192
s_waitcnt lgkmcnt(4)
v_mfma_f32_16x16x32_bf16 v[88:91], a[0:3], a[240:243], 0
buffer_load_dwordx4 a[112:115], v2, s[8:11], s27 offen offset:2048 sc1
v_mfma_f32_16x16x32_bf16 v[88:91], a[4:7], a[244:247], v[88:91]
ds_read_b128 a[232:235], v2 offset:16384
v_mfma_f32_16x16x32_bf16 v[92:95], a[72:75], a[240:243], 0
v_mfma_f32_16x16x32_bf16 v[92:95], a[76:79], a[244:247], v[92:95]
ds_read_b128 a[236:239], v2 offset:24576
s_waitcnt lgkmcnt(4)
v_mfma_f32_16x16x32_bf16 v[96:99], a[216:219], a[144:147], 0
ds_read_b128 a[240:243], v2 offset:17408
buffer_load_dwordx4 a[184:187], v19, s[8:11], s28 offen offset:2048 sc1
v_mfma_f32_16x16x32_bf16 v[96:99], a[220:223], a[148:151], v[96:99]
ds_read_b128 a[244:247], v2 offset:25600
s_waitcnt lgkmcnt(4)
v_mfma_f32_16x16x32_bf16 v[100:103], a[144:147], a[224:227], 0
ds_read_b128 a[216:219], v2 offset:18432
v_mfma_f32_16x16x32_bf16 v[100:103], a[148:151], a[228:231], v[100:103]
ds_read_b128 a[220:223], v2 offset:26624
s_waitcnt vmcnt(21)
s_waitcnt lgkmcnt(4)
v_mfma_f32_16x16x32_bf16 v[32:35], a[232:235], a[8:11], v[32:35]
buffer_load_dwordx4 a[44:47], v2, s[8:11], s26 offen offset:3072 sc1
v_mfma_f32_16x16x32_bf16 v[32:35], a[236:239], a[12:15], v[32:35]
ds_read_b128 a[224:227], v2 offset:19456
v_mfma_f32_16x16x32_bf16 v[36:39], a[232:235], a[80:83], v[36:39]
v_mfma_f32_16x16x32_bf16 v[36:39], a[236:239], a[84:87], v[36:39]
ds_read_b128 a[228:231], v2 offset:27648
s_waitcnt lgkmcnt(4)
v_mfma_f32_16x16x32_bf16 v[40:43], a[240:243], a[8:11], v[40:43]
buffer_load_dwordx4 a[116:119], v2, s[8:11], s27 offen offset:3072 sc1
v_mfma_f32_16x16x32_bf16 v[40:43], a[244:247], a[12:15], v[40:43]
ds_read_b128 a[232:235], v2 offset:20480
v_mfma_f32_16x16x32_bf16 v[44:47], a[240:243], a[80:83], v[44:47]
v_mfma_f32_16x16x32_bf16 v[44:47], a[244:247], a[84:87], v[44:47]
ds_read_b128 a[236:239], v2 offset:28672
s_waitcnt lgkmcnt(4)
v_mfma_f32_16x16x32_bf16 v[48:51], a[216:219], a[8:11], v[48:51]
buffer_load_dwordx4 a[188:191], v19, s[8:11], s28 offen offset:3072 sc1
v_mfma_f32_16x16x32_bf16 v[48:51], a[220:223], a[12:15], v[48:51]
ds_read_b128 a[240:243], v2 offset:21504
v_mfma_f32_16x16x32_bf16 v[52:55], a[216:219], a[80:83], v[52:55]
v_mfma_f32_16x16x32_bf16 v[52:55], a[220:223], a[84:87], v[52:55]
ds_read_b128 a[244:247], v2 offset:29696
s_waitcnt lgkmcnt(4)
v_mfma_f32_16x16x32_bf16 v[56:59], a[224:227], a[8:11], v[56:59]
s_add_u32 s26, s26, 4096
s_add_u32 s27, s27, 4096
s_add_u32 s28, s28, 4096
buffer_load_dwordx4 a[48:51], v2, s[8:11], s26 offen offset:0 sc1
v_mfma_f32_16x16x32_bf16 v[56:59], a[228:231], a[12:15], v[56:59]
ds_read_b128 a[216:219], v2 offset:22528
v_mfma_f32_16x16x32_bf16 v[60:63], a[224:227], a[80:83], v[60:63]
v_mfma_f32_16x16x32_bf16 v[60:63], a[228:231], a[84:87], v[60:63]
ds_read_b128 a[220:223], v2 offset:30720
s_waitcnt lgkmcnt(4)
v_mfma_f32_16x16x32_bf16 v[64:67], a[232:235], a[8:11], v[64:67]
buffer_load_dwordx4 a[120:123], v2, s[8:11], s27 offen offset:0 sc1
v_mfma_f32_16x16x32_bf16 v[64:67], a[236:239], a[12:15], v[64:67]
ds_read_b128 a[224:227], v2 offset:23552
v_mfma_f32_16x16x32_bf16 v[68:71], a[232:235], a[80:83], v[68:71]
v_mfma_f32_16x16x32_bf16 v[68:71], a[236:239], a[84:87], v[68:71]
ds_read_b128 a[228:231], v2 offset:31744
s_waitcnt lgkmcnt(4)
v_mfma_f32_16x16x32_bf16 v[72:75], a[8:11], a[240:243], v[72:75]
buffer_load_dwordx4 a[192:195], v19, s[8:11], s28 offen offset:0 sc1
v_mfma_f32_16x16x32_bf16 v[72:75], a[12:15], a[244:247], v[72:75]
ds_read_b128 a[232:235], v6 offset:16384
v_mfma_f32_16x16x32_bf16 v[76:79], a[80:83], a[240:243], v[76:79]
v_mfma_f32_16x16x32_bf16 v[76:79], a[84:87], a[244:247], v[76:79]
ds_read_b128 a[236:239], v6 offset:24576
s_waitcnt lgkmcnt(4)
v_mfma_f32_16x16x32_bf16 v[80:83], a[8:11], a[216:219], v[80:83]
buffer_load_dwordx4 a[52:55], v2, s[8:11], s26 offen offset:1024 sc1
v_mfma_f32_16x16x32_bf16 v[80:83], a[12:15], a[220:223], v[80:83]
ds_read_b128 a[240:243], v9 offset:16384
v_mfma_f32_16x16x32_bf16 v[84:87], a[80:83], a[216:219], v[84:87]
v_mfma_f32_16x16x32_bf16 v[84:87], a[84:87], a[220:223], v[84:87]
ds_read_b128 a[244:247], v9 offset:24576
s_waitcnt lgkmcnt(4)
v_mfma_f32_16x16x32_bf16 v[88:91], a[8:11], a[224:227], v[88:91]
buffer_load_dwordx4 a[124:127], v2, s[8:11], s27 offen offset:1024 sc1
v_mfma_f32_16x16x32_bf16 v[88:91], a[12:15], a[228:231], v[88:91]
ds_read_b128 a[216:219], v2 offset:32768
v_mfma_f32_16x16x32_bf16 v[92:95], a[80:83], a[224:227], v[92:95]
v_mfma_f32_16x16x32_bf16 v[92:95], a[84:87], a[228:231], v[92:95]
ds_read_b128 a[220:223], v2 offset:40960
s_waitcnt lgkmcnt(4)
v_mfma_f32_16x16x32_bf16 v[96:99], a[232:235], a[152:155], v[96:99]
ds_read_b128 a[224:227], v2 offset:33792
buffer_load_dwordx4 a[196:199], v19, s[8:11], s28 offen offset:1024 sc1
v_mfma_f32_16x16x32_bf16 v[96:99], a[236:239], a[156:159], v[96:99]
ds_read_b128 a[228:231], v2 offset:41984
s_waitcnt lgkmcnt(4)
v_mfma_f32_16x16x32_bf16 v[100:103], a[152:155], a[240:243], v[100:103]
ds_read_b128 a[232:235], v2 offset:34816
v_mfma_f32_16x16x32_bf16 v[100:103], a[156:159], a[244:247], v[100:103]
ds_read_b128 a[236:239], v2 offset:43008
s_waitcnt vmcnt(24)
s_waitcnt lgkmcnt(4)
v_mfma_f32_16x16x32_bf16 v[32:35], a[216:219], a[16:19], v[32:35]
buffer_load_dwordx4 a[56:59], v2, s[8:11], s26 offen offset:2048 sc1
v_mfma_f32_16x16x32_bf16 v[32:35], a[220:223], a[20:23], v[32:35]
ds_read_b128 a[240:243], v2 offset:35840
v_mfma_f32_16x16x32_bf16 v[36:39], a[216:219], a[88:91], v[36:39]
v_mfma_f32_16x16x32_bf16 v[36:39], a[220:223], a[92:95], v[36:39]
ds_read_b128 a[244:247], v2 offset:44032
s_waitcnt lgkmcnt(4)
v_mfma_f32_16x16x32_bf16 v[40:43], a[224:227], a[16:19], v[40:43]
buffer_load_dwordx4 a[128:131], v2, s[8:11], s27 offen offset:2048 sc1
v_mfma_f32_16x16x32_bf16 v[40:43], a[228:231], a[20:23], v[40:43]
ds_read_b128 a[216:219], v2 offset:36864
v_mfma_f32_16x16x32_bf16 v[44:47], a[224:227], a[88:91], v[44:47]
v_mfma_f32_16x16x32_bf16 v[44:47], a[228:231], a[92:95], v[44:47]
ds_read_b128 a[220:223], v2 offset:45056
s_waitcnt lgkmcnt(4)
v_mfma_f32_16x16x32_bf16 v[48:51], a[232:235], a[16:19], v[48:51]
buffer_load_dwordx4 a[200:203], v19, s[8:11], s28 offen offset:2048 sc1
v_mfma_f32_16x16x32_bf16 v[48:51], a[236:239], a[20:23], v[48:51]
ds_read_b128 a[224:227], v2 offset:37888
v_mfma_f32_16x16x32_bf16 v[52:55], a[232:235], a[88:91], v[52:55]
v_mfma_f32_16x16x32_bf16 v[52:55], a[236:239], a[92:95], v[52:55]
ds_read_b128 a[228:231], v2 offset:46080
s_waitcnt lgkmcnt(4)
v_mfma_f32_16x16x32_bf16 v[56:59], a[240:243], a[16:19], v[56:59]
buffer_load_dwordx4 a[60:63], v2, s[8:11], s26 offen offset:3072 sc1
v_mfma_f32_16x16x32_bf16 v[56:59], a[244:247], a[20:23], v[56:59]
ds_read_b128 a[232:235], v2 offset:38912
v_mfma_f32_16x16x32_bf16 v[60:63], a[240:243], a[88:91], v[60:63]
v_mfma_f32_16x16x32_bf16 v[60:63], a[244:247], a[92:95], v[60:63]
ds_read_b128 a[236:239], v2 offset:47104
s_waitcnt lgkmcnt(4)
v_mfma_f32_16x16x32_bf16 v[64:67], a[216:219], a[16:19], v[64:67]
buffer_load_dwordx4 a[132:135], v2, s[8:11], s27 offen offset:3072 sc1
v_mfma_f32_16x16x32_bf16 v[64:67], a[220:223], a[20:23], v[64:67]
ds_read_b128 a[240:243], v2 offset:39936
v_mfma_f32_16x16x32_bf16 v[68:71], a[216:219], a[88:91], v[68:71]
v_mfma_f32_16x16x32_bf16 v[68:71], a[220:223], a[92:95], v[68:71]
ds_read_b128 a[244:247], v2 offset:48128
s_waitcnt lgkmcnt(4)
v_mfma_f32_16x16x32_bf16 v[72:75], a[16:19], a[224:227], v[72:75]
buffer_load_dwordx4 a[204:207], v19, s[8:11], s28 offen offset:3072 sc1
v_mfma_f32_16x16x32_bf16 v[72:75], a[20:23], a[228:231], v[72:75]
ds_read_b128 a[216:219], v6 offset:32768
v_mfma_f32_16x16x32_bf16 v[76:79], a[88:91], a[224:227], v[76:79]
v_mfma_f32_16x16x32_bf16 v[76:79], a[92:95], a[228:231], v[76:79]
ds_read_b128 a[220:223], v6 offset:40960
s_waitcnt lgkmcnt(4)
v_mfma_f32_16x16x32_bf16 v[80:83], a[16:19], a[232:235], v[80:83]
s_add_u32 s26, s26, 4096
s_add_u32 s27, s27, 4096
s_add_u32 s28, s28, 4096
buffer_load_dwordx4 a[64:67], v2, s[8:11], s26 offen offset:0 sc1
v_mfma_f32_16x16x32_bf16 v[80:83], a[20:23], a[236:239], v[80:83]
ds_read_b128 a[224:227], v9 offset:32768
v_mfma_f32_16x16x32_bf16 v[84:87], a[88:91], a[232:235], v[84:87]
v_mfma_f32_16x16x32_bf16 v[84:87], a[92:95], a[236:239], v[84:87]
ds_read_b128 a[228:231], v9 offset:40960
s_waitcnt lgkmcnt(4)
v_mfma_f32_16x16x32_bf16 v[88:91], a[16:19], a[240:243], v[88:91]
buffer_load_dwordx4 a[136:139], v2, s[8:11], s27 offen offset:0 sc1
v_mfma_f32_16x16x32_bf16 v[88:91], a[20:23], a[244:247], v[88:91]
ds_read_b128 a[232:235], v2 offset:49152
v_mfma_f32_16x16x32_bf16 v[92:95], a[88:91], a[240:243], v[92:95]
v_mfma_f32_16x16x32_bf16 v[92:95], a[92:95], a[244:247], v[92:95]
ds_read_b128 a[236:239], v2 offset:57344
s_waitcnt lgkmcnt(4)
v_mfma_f32_16x16x32_bf16 v[96:99], a[216:219], a[160:163], v[96:99]
ds_read_b128 a[240:243], v2 offset:50176
buffer_load_dwordx4 a[208:211], v19, s[8:11], s28 offen offset:0 sc1
v_mfma_f32_16x16x32_bf16 v[96:99], a[220:223], a[164:167], v[96:99]
ds_read_b128 a[244:247], v2 offset:58368
s_waitcnt lgkmcnt(4)
v_mfma_f32_16x16x32_bf16 v[100:103], a[160:163], a[224:227], v[100:103]
ds_read_b128 a[216:219], v2 offset:51200
v_mfma_f32_16x16x32_bf16 v[100:103], a[164:167], a[228:231], v[100:103]
ds_read_b128 a[220:223], v2 offset:59392
s_waitcnt vmcnt(27)
s_waitcnt lgkmcnt(4)
v_mfma_f32_16x16x32_bf16 v[32:35], a[232:235], a[24:27], v[32:35]
buffer_load_dwordx4 a[68:71], v2, s[8:11], s26 offen offset:1024 sc1
v_mfma_f32_16x16x32_bf16 v[32:35], a[236:239], a[28:31], v[32:35]
ds_read_b128 a[224:227], v2 offset:52224
v_mfma_f32_16x16x32_bf16 v[36:39], a[232:235], a[96:99], v[36:39]
v_mfma_f32_16x16x32_bf16 v[36:39], a[236:239], a[100:103], v[36:39]
ds_read_b128 a[228:231], v2 offset:60416
s_waitcnt lgkmcnt(4)
v_mfma_f32_16x16x32_bf16 v[40:43], a[240:243], a[24:27], v[40:43]
buffer_load_dwordx4 a[140:143], v2, s[8:11], s27 offen offset:1024 sc1
v_mfma_f32_16x16x32_bf16 v[40:43], a[244:247], a[28:31], v[40:43]
ds_read_b128 a[232:235], v2 offset:53248
v_mfma_f32_16x16x32_bf16 v[44:47], a[240:243], a[96:99], v[44:47]
v_mfma_f32_16x16x32_bf16 v[44:47], a[244:247], a[100:103], v[44:47]
ds_read_b128 a[236:239], v2 offset:61440
s_waitcnt lgkmcnt(4)
v_mfma_f32_16x16x32_bf16 v[48:51], a[216:219], a[24:27], v[48:51]
buffer_load_dwordx4 a[212:215], v19, s[8:11], s28 offen offset:1024 sc1
v_mfma_f32_16x16x32_bf16 v[48:51], a[220:223], a[28:31], v[48:51]
ds_read_b128 a[240:243], v2 offset:54272
v_mfma_f32_16x16x32_bf16 v[52:55], a[216:219], a[96:99], v[52:55]
v_mfma_f32_16x16x32_bf16 v[52:55], a[220:223], a[100:103], v[52:55]
ds_read_b128 a[244:247], v2 offset:62464
s_waitcnt lgkmcnt(4)
v_mfma_f32_16x16x32_bf16 v[56:59], a[224:227], a[24:27], v[56:59]
v_mfma_f32_16x16x32_bf16 v[56:59], a[228:231], a[28:31], v[56:59]
ds_read_b128 a[216:219], v2 offset:55296
v_mfma_f32_16x16x32_bf16 v[60:63], a[224:227], a[96:99], v[60:63]
v_mfma_f32_16x16x32_bf16 v[60:63], a[228:231], a[100:103], v[60:63]
ds_read_b128 a[220:223], v2 offset:63488
s_waitcnt lgkmcnt(4)
v_mfma_f32_16x16x32_bf16 v[64:67], a[232:235], a[24:27], v[64:67]
v_mfma_f32_16x16x32_bf16 v[64:67], a[236:239], a[28:31], v[64:67]
ds_read_b128 a[224:227], v2 offset:56320
v_mfma_f32_16x16x32_bf16 v[68:71], a[232:235], a[96:99], v[68:71]
v_mfma_f32_16x16x32_bf16 v[68:71], a[236:239], a[100:103], v[68:71]
ds_read_b128 a[228:231], v2 offset:64512
s_waitcnt lgkmcnt(4)
v_mfma_f32_16x16x32_bf16 v[72:75], a[24:27], a[240:243], v[72:75]
v_mfma_f32_16x16x32_bf16 v[72:75], a[28:31], a[244:247], v[72:75]
ds_read_b128 a[232:235], v6 offset:49152
v_mfma_f32_16x16x32_bf16 v[76:79], a[96:99], a[240:243], v[76:79]
v_mfma_f32_16x16x32_bf16 v[76:79], a[100:103], a[244:247], v[76:79]
ds_read_b128 a[236:239], v6 offset:57344
s_waitcnt lgkmcnt(4)
v_mfma_f32_16x16x32_bf16 v[80:83], a[24:27], a[216:219], v[80:83]
v_mfma_f32_16x16x32_bf16 v[80:83], a[28:31], a[220:223], v[80:83]
ds_read_b128 a[240:243], v9 offset:49152
v_mfma_f32_16x16x32_bf16 v[84:87], a[96:99], a[216:219], v[84:87]
v_mfma_f32_16x16x32_bf16 v[84:87], a[100:103], a[220:223], v[84:87]
ds_read_b128 a[244:247], v9 offset:57344
s_waitcnt lgkmcnt(4)
v_mfma_f32_16x16x32_bf16 v[88:91], a[24:27], a[224:227], v[88:91]
v_mfma_f32_16x16x32_bf16 v[88:91], a[28:31], a[228:231], v[88:91]
ds_read_b128 a[216:219], v4 offset:0
v_mfma_f32_16x16x32_bf16 v[92:95], a[96:99], a[224:227], v[92:95]
v_mfma_f32_16x16x32_bf16 v[92:95], a[100:103], a[228:231], v[92:95]
ds_read_b128 a[220:223], v4 offset:8192
s_waitcnt lgkmcnt(4)
v_mfma_f32_16x16x32_bf16 v[96:99], a[232:235], a[168:171], v[96:99]
ds_read_b128 a[224:227], v4 offset:1024
v_mfma_f32_16x16x32_bf16 v[96:99], a[236:239], a[172:175], v[96:99]
ds_read_b128 a[228:231], v4 offset:9216
s_waitcnt lgkmcnt(4)
v_mfma_f32_16x16x32_bf16 v[100:103], a[168:171], a[240:243], v[100:103]
ds_read_b128 a[232:235], v4 offset:2048
v_mfma_f32_16x16x32_bf16 v[100:103], a[172:175], a[244:247], v[100:103]
ds_read_b128 a[236:239], v4 offset:10240
s_waitcnt vmcnt(24)
s_waitcnt lgkmcnt(4)
v_mfma_f32_16x16x32_bf16 v[32:35], a[216:219], a[32:35], v[32:35]
v_mfma_f32_16x16x32_bf16 v[32:35], a[220:223], a[36:39], v[32:35]
ds_read_b128 a[240:243], v4 offset:3072
v_mfma_f32_16x16x32_bf16 v[36:39], a[216:219], a[104:107], v[36:39]
v_mfma_f32_16x16x32_bf16 v[36:39], a[220:223], a[108:111], v[36:39]
ds_read_b128 a[244:247], v4 offset:11264
s_waitcnt lgkmcnt(4)
v_mfma_f32_16x16x32_bf16 v[40:43], a[224:227], a[32:35], v[40:43]
v_mfma_f32_16x16x32_bf16 v[40:43], a[228:231], a[36:39], v[40:43]
ds_read_b128 a[216:219], v4 offset:4096
v_mfma_f32_16x16x32_bf16 v[44:47], a[224:227], a[104:107], v[44:47]
v_mfma_f32_16x16x32_bf16 v[44:47], a[228:231], a[108:111], v[44:47]
ds_read_b128 a[220:223], v4 offset:12288
s_waitcnt lgkmcnt(4)
v_mfma_f32_16x16x32_bf16 v[48:51], a[232:235], a[32:35], v[48:51]
v_mfma_f32_16x16x32_bf16 v[48:51], a[236:239], a[36:39], v[48:51]
ds_read_b128 a[224:227], v4 offset:5120
v_mfma_f32_16x16x32_bf16 v[52:55], a[232:235], a[104:107], v[52:55]
v_mfma_f32_16x16x32_bf16 v[52:55], a[236:239], a[108:111], v[52:55]
ds_read_b128 a[228:231], v4 offset:13312
s_waitcnt lgkmcnt(4)
v_mfma_f32_16x16x32_bf16 v[56:59], a[240:243], a[32:35], v[56:59]
v_mfma_f32_16x16x32_bf16 v[56:59], a[244:247], a[36:39], v[56:59]
ds_read_b128 a[232:235], v4 offset:6144
v_mfma_f32_16x16x32_bf16 v[60:63], a[240:243], a[104:107], v[60:63]
v_mfma_f32_16x16x32_bf16 v[60:63], a[244:247], a[108:111], v[60:63]
ds_read_b128 a[236:239], v4 offset:14336
s_waitcnt lgkmcnt(4)
v_mfma_f32_16x16x32_bf16 v[64:67], a[216:219], a[32:35], v[64:67]
v_mfma_f32_16x16x32_bf16 v[64:67], a[220:223], a[36:39], v[64:67]
ds_read_b128 a[240:243], v4 offset:7168
v_mfma_f32_16x16x32_bf16 v[68:71], a[216:219], a[104:107], v[68:71]
v_mfma_f32_16x16x32_bf16 v[68:71], a[220:223], a[108:111], v[68:71]
ds_read_b128 a[244:247], v4 offset:15360
s_waitcnt lgkmcnt(4)
v_mfma_f32_16x16x32_bf16 v[72:75], a[32:35], a[224:227], v[72:75]
v_mfma_f32_16x16x32_bf16 v[72:75], a[36:39], a[228:231], v[72:75]
ds_read_b128 a[216:219], v7 offset:0
v_mfma_f32_16x16x32_bf16 v[76:79], a[104:107], a[224:227], v[76:79]
v_mfma_f32_16x16x32_bf16 v[76:79], a[108:111], a[228:231], v[76:79]
ds_read_b128 a[220:223], v7 offset:8192
s_waitcnt lgkmcnt(4)
v_mfma_f32_16x16x32_bf16 v[80:83], a[32:35], a[232:235], v[80:83]
v_mfma_f32_16x16x32_bf16 v[80:83], a[36:39], a[236:239], v[80:83]
ds_read_b128 a[224:227], v10 offset:0
v_mfma_f32_16x16x32_bf16 v[84:87], a[104:107], a[232:235], v[84:87]
v_mfma_f32_16x16x32_bf16 v[84:87], a[108:111], a[236:239], v[84:87]
ds_read_b128 a[228:231], v10 offset:8192
s_waitcnt lgkmcnt(4)
v_mfma_f32_16x16x32_bf16 v[88:91], a[32:35], a[240:243], v[88:91]
v_mfma_f32_16x16x32_bf16 v[88:91], a[36:39], a[244:247], v[88:91]
ds_read_b128 a[232:235], v4 offset:16384
v_mfma_f32_16x16x32_bf16 v[92:95], a[104:107], a[240:243], v[92:95]
v_mfma_f32_16x16x32_bf16 v[92:95], a[108:111], a[244:247], v[92:95]
ds_read_b128 a[236:239], v4 offset:24576
s_waitcnt lgkmcnt(4)
v_mfma_f32_16x16x32_bf16 v[96:99], a[216:219], a[176:179], v[96:99]
ds_read_b128 a[240:243], v4 offset:17408
v_mfma_f32_16x16x32_bf16 v[96:99], a[220:223], a[180:183], v[96:99]
ds_read_b128 a[244:247], v4 offset:25600
s_waitcnt lgkmcnt(4)
v_mfma_f32_16x16x32_bf16 v[100:103], a[176:179], a[224:227], v[100:103]
ds_read_b128 a[216:219], v4 offset:18432
v_mfma_f32_16x16x32_bf16 v[100:103], a[180:183], a[228:231], v[100:103]
ds_read_b128 a[220:223], v4 offset:26624
s_waitcnt vmcnt(18)
s_waitcnt lgkmcnt(4)
v_mfma_f32_16x16x32_bf16 v[32:35], a[232:235], a[40:43], v[32:35]
v_mfma_f32_16x16x32_bf16 v[32:35], a[236:239], a[44:47], v[32:35]
ds_read_b128 a[224:227], v4 offset:19456
v_mfma_f32_16x16x32_bf16 v[36:39], a[232:235], a[112:115], v[36:39]
v_mfma_f32_16x16x32_bf16 v[36:39], a[236:239], a[116:119], v[36:39]
ds_read_b128 a[228:231], v4 offset:27648
s_waitcnt lgkmcnt(4)
v_mfma_f32_16x16x32_bf16 v[40:43], a[240:243], a[40:43], v[40:43]
v_mfma_f32_16x16x32_bf16 v[40:43], a[244:247], a[44:47], v[40:43]
ds_read_b128 a[232:235], v4 offset:20480
v_mfma_f32_16x16x32_bf16 v[44:47], a[240:243], a[112:115], v[44:47]
v_mfma_f32_16x16x32_bf16 v[44:47], a[244:247], a[116:119], v[44:47]
ds_read_b128 a[236:239], v4 offset:28672
s_waitcnt lgkmcnt(4)
v_mfma_f32_16x16x32_bf16 v[48:51], a[216:219], a[40:43], v[48:51]
v_mfma_f32_16x16x32_bf16 v[48:51], a[220:223], a[44:47], v[48:51]
ds_read_b128 a[240:243], v4 offset:21504
v_mfma_f32_16x16x32_bf16 v[52:55], a[216:219], a[112:115], v[52:55]
v_mfma_f32_16x16x32_bf16 v[52:55], a[220:223], a[116:119], v[52:55]
ds_read_b128 a[244:247], v4 offset:29696
s_waitcnt lgkmcnt(4)
v_mfma_f32_16x16x32_bf16 v[56:59], a[224:227], a[40:43], v[56:59]
v_mfma_f32_16x16x32_bf16 v[56:59], a[228:231], a[44:47], v[56:59]
ds_read_b128 a[216:219], v4 offset:22528
v_mfma_f32_16x16x32_bf16 v[60:63], a[224:227], a[112:115], v[60:63]
v_mfma_f32_16x16x32_bf16 v[60:63], a[228:231], a[116:119], v[60:63]
ds_read_b128 a[220:223], v4 offset:30720
s_waitcnt lgkmcnt(4)
v_mfma_f32_16x16x32_bf16 v[64:67], a[232:235], a[40:43], v[64:67]
v_mfma_f32_16x16x32_bf16 v[64:67], a[236:239], a[44:47], v[64:67]
ds_read_b128 a[224:227], v4 offset:23552
v_mfma_f32_16x16x32_bf16 v[68:71], a[232:235], a[112:115], v[68:71]
v_mfma_f32_16x16x32_bf16 v[68:71], a[236:239], a[116:119], v[68:71]
ds_read_b128 a[228:231], v4 offset:31744
s_waitcnt lgkmcnt(4)
v_mfma_f32_16x16x32_bf16 v[72:75], a[40:43], a[240:243], v[72:75]
v_mfma_f32_16x16x32_bf16 v[72:75], a[44:47], a[244:247], v[72:75]
ds_read_b128 a[232:235], v7 offset:16384
v_mfma_f32_16x16x32_bf16 v[76:79], a[112:115], a[240:243], v[76:79]
v_mfma_f32_16x16x32_bf16 v[76:79], a[116:119], a[244:247], v[76:79]
ds_read_b128 a[236:239], v7 offset:24576
s_waitcnt lgkmcnt(4)
v_mfma_f32_16x16x32_bf16 v[80:83], a[40:43], a[216:219], v[80:83]
v_mfma_f32_16x16x32_bf16 v[80:83], a[44:47], a[220:223], v[80:83]
ds_read_b128 a[240:243], v10 offset:16384
v_mfma_f32_16x16x32_bf16 v[84:87], a[112:115], a[216:219], v[84:87]
v_mfma_f32_16x16x32_bf16 v[84:87], a[116:119], a[220:223], v[84:87]
ds_read_b128 a[244:247], v10 offset:24576
s_waitcnt lgkmcnt(4)
v_mfma_f32_16x16x32_bf16 v[88:91], a[40:43], a[224:227], v[88:91]
v_mfma_f32_16x16x32_bf16 v[88:91], a[44:47], a[228:231], v[88:91]
ds_read_b128 a[216:219], v4 offset:32768
v_mfma_f32_16x16x32_bf16 v[92:95], a[112:115], a[224:227], v[92:95]
v_mfma_f32_16x16x32_bf16 v[92:95], a[116:119], a[228:231], v[92:95]
ds_read_b128 a[220:223], v4 offset:40960
s_waitcnt lgkmcnt(4)
v_mfma_f32_16x16x32_bf16 v[96:99], a[232:235], a[184:187], v[96:99]
ds_read_b128 a[224:227], v4 offset:33792
v_mfma_f32_16x16x32_bf16 v[96:99], a[236:239], a[188:191], v[96:99]
ds_read_b128 a[228:231], v4 offset:41984
s_waitcnt lgkmcnt(4)
v_mfma_f32_16x16x32_bf16 v[100:103], a[184:187], a[240:243], v[100:103]
ds_read_b128 a[232:235], v4 offset:34816
v_mfma_f32_16x16x32_bf16 v[100:103], a[188:191], a[244:247], v[100:103]
ds_read_b128 a[236:239], v4 offset:43008
s_waitcnt vmcnt(12)
s_waitcnt lgkmcnt(4)
v_mfma_f32_16x16x32_bf16 v[32:35], a[216:219], a[48:51], v[32:35]
v_mfma_f32_16x16x32_bf16 v[32:35], a[220:223], a[52:55], v[32:35]
ds_read_b128 a[240:243], v4 offset:35840
v_mfma_f32_16x16x32_bf16 v[36:39], a[216:219], a[120:123], v[36:39]
v_mfma_f32_16x16x32_bf16 v[36:39], a[220:223], a[124:127], v[36:39]
ds_read_b128 a[244:247], v4 offset:44032
s_waitcnt lgkmcnt(4)
v_mfma_f32_16x16x32_bf16 v[40:43], a[224:227], a[48:51], v[40:43]
v_mfma_f32_16x16x32_bf16 v[40:43], a[228:231], a[52:55], v[40:43]
ds_read_b128 a[216:219], v4 offset:36864
v_mfma_f32_16x16x32_bf16 v[44:47], a[224:227], a[120:123], v[44:47]
v_mfma_f32_16x16x32_bf16 v[44:47], a[228:231], a[124:127], v[44:47]
ds_read_b128 a[220:223], v4 offset:45056
s_waitcnt lgkmcnt(4)
v_mfma_f32_16x16x32_bf16 v[48:51], a[232:235], a[48:51], v[48:51]
v_mfma_f32_16x16x32_bf16 v[48:51], a[236:239], a[52:55], v[48:51]
ds_read_b128 a[224:227], v4 offset:37888
v_mfma_f32_16x16x32_bf16 v[52:55], a[232:235], a[120:123], v[52:55]
v_mfma_f32_16x16x32_bf16 v[52:55], a[236:239], a[124:127], v[52:55]
ds_read_b128 a[228:231], v4 offset:46080
s_waitcnt lgkmcnt(4)
v_mfma_f32_16x16x32_bf16 v[56:59], a[240:243], a[48:51], v[56:59]
v_mfma_f32_16x16x32_bf16 v[56:59], a[244:247], a[52:55], v[56:59]
ds_read_b128 a[232:235], v4 offset:38912
v_mfma_f32_16x16x32_bf16 v[60:63], a[240:243], a[120:123], v[60:63]
v_mfma_f32_16x16x32_bf16 v[60:63], a[244:247], a[124:127], v[60:63]
ds_read_b128 a[236:239], v4 offset:47104
s_waitcnt lgkmcnt(4)
v_mfma_f32_16x16x32_bf16 v[64:67], a[216:219], a[48:51], v[64:67]
v_mfma_f32_16x16x32_bf16 v[64:67], a[220:223], a[52:55], v[64:67]
ds_read_b128 a[240:243], v4 offset:39936
v_mfma_f32_16x16x32_bf16 v[68:71], a[216:219], a[120:123], v[68:71]
v_mfma_f32_16x16x32_bf16 v[68:71], a[220:223], a[124:127], v[68:71]
ds_read_b128 a[244:247], v4 offset:48128
s_waitcnt lgkmcnt(4)
v_mfma_f32_16x16x32_bf16 v[72:75], a[48:51], a[224:227], v[72:75]
v_mfma_f32_16x16x32_bf16 v[72:75], a[52:55], a[228:231], v[72:75]
ds_read_b128 a[216:219], v7 offset:32768
v_mfma_f32_16x16x32_bf16 v[76:79], a[120:123], a[224:227], v[76:79]
v_mfma_f32_16x16x32_bf16 v[76:79], a[124:127], a[228:231], v[76:79]
ds_read_b128 a[220:223], v7 offset:40960
s_waitcnt lgkmcnt(4)
v_mfma_f32_16x16x32_bf16 v[80:83], a[48:51], a[232:235], v[80:83]
v_mfma_f32_16x16x32_bf16 v[80:83], a[52:55], a[236:239], v[80:83]
ds_read_b128 a[224:227], v10 offset:32768
v_mfma_f32_16x16x32_bf16 v[84:87], a[120:123], a[232:235], v[84:87]
v_mfma_f32_16x16x32_bf16 v[84:87], a[124:127], a[236:239], v[84:87]
ds_read_b128 a[228:231], v10 offset:40960
s_waitcnt lgkmcnt(4)
v_mfma_f32_16x16x32_bf16 v[88:91], a[48:51], a[240:243], v[88:91]
v_mfma_f32_16x16x32_bf16 v[88:91], a[52:55], a[244:247], v[88:91]
ds_read_b128 a[232:235], v4 offset:49152
v_mfma_f32_16x16x32_bf16 v[92:95], a[120:123], a[240:243], v[92:95]
v_mfma_f32_16x16x32_bf16 v[92:95], a[124:127], a[244:247], v[92:95]
ds_read_b128 a[236:239], v4 offset:57344
s_waitcnt lgkmcnt(4)
v_mfma_f32_16x16x32_bf16 v[96:99], a[216:219], a[192:195], v[96:99]
ds_read_b128 a[240:243], v4 offset:50176
v_mfma_f32_16x16x32_bf16 v[96:99], a[220:223], a[196:199], v[96:99]
ds_read_b128 a[244:247], v4 offset:58368
s_waitcnt lgkmcnt(4)
v_mfma_f32_16x16x32_bf16 v[100:103], a[192:195], a[224:227], v[100:103]
ds_read_b128 a[216:219], v4 offset:51200
v_mfma_f32_16x16x32_bf16 v[100:103], a[196:199], a[228:231], v[100:103]
ds_read_b128 a[220:223], v4 offset:59392
s_waitcnt vmcnt(6)
s_waitcnt lgkmcnt(4)
v_mfma_f32_16x16x32_bf16 v[32:35], a[232:235], a[56:59], v[32:35]
v_mfma_f32_16x16x32_bf16 v[32:35], a[236:239], a[60:63], v[32:35]
ds_read_b128 a[224:227], v4 offset:52224
v_mfma_f32_16x16x32_bf16 v[36:39], a[232:235], a[128:131], v[36:39]
v_mfma_f32_16x16x32_bf16 v[36:39], a[236:239], a[132:135], v[36:39]
ds_read_b128 a[228:231], v4 offset:60416
s_waitcnt lgkmcnt(4)
v_mfma_f32_16x16x32_bf16 v[40:43], a[240:243], a[56:59], v[40:43]
v_mfma_f32_16x16x32_bf16 v[40:43], a[244:247], a[60:63], v[40:43]
ds_read_b128 a[232:235], v4 offset:53248
v_mfma_f32_16x16x32_bf16 v[44:47], a[240:243], a[128:131], v[44:47]
v_mfma_f32_16x16x32_bf16 v[44:47], a[244:247], a[132:135], v[44:47]
ds_read_b128 a[236:239], v4 offset:61440
s_waitcnt lgkmcnt(4)
v_mfma_f32_16x16x32_bf16 v[48:51], a[216:219], a[56:59], v[48:51]
v_mfma_f32_16x16x32_bf16 v[48:51], a[220:223], a[60:63], v[48:51]
ds_read_b128 a[240:243], v4 offset:54272
v_mfma_f32_16x16x32_bf16 v[52:55], a[216:219], a[128:131], v[52:55]
v_mfma_f32_16x16x32_bf16 v[52:55], a[220:223], a[132:135], v[52:55]
ds_read_b128 a[244:247], v4 offset:62464
s_waitcnt lgkmcnt(4)
v_mfma_f32_16x16x32_bf16 v[56:59], a[224:227], a[56:59], v[56:59]
v_mfma_f32_16x16x32_bf16 v[56:59], a[228:231], a[60:63], v[56:59]
ds_read_b128 a[216:219], v4 offset:55296
v_mfma_f32_16x16x32_bf16 v[60:63], a[224:227], a[128:131], v[60:63]
v_mfma_f32_16x16x32_bf16 v[60:63], a[228:231], a[132:135], v[60:63]
ds_read_b128 a[220:223], v4 offset:63488
s_waitcnt lgkmcnt(4)
v_mfma_f32_16x16x32_bf16 v[64:67], a[232:235], a[56:59], v[64:67]
v_mfma_f32_16x16x32_bf16 v[64:67], a[236:239], a[60:63], v[64:67]
ds_read_b128 a[224:227], v4 offset:56320
v_mfma_f32_16x16x32_bf16 v[68:71], a[232:235], a[128:131], v[68:71]
v_mfma_f32_16x16x32_bf16 v[68:71], a[236:239], a[132:135], v[68:71]
ds_read_b128 a[228:231], v4 offset:64512
s_waitcnt lgkmcnt(4)
v_mfma_f32_16x16x32_bf16 v[72:75], a[56:59], a[240:243], v[72:75]
v_mfma_f32_16x16x32_bf16 v[72:75], a[60:63], a[244:247], v[72:75]
ds_read_b128 a[232:235], v7 offset:49152
v_mfma_f32_16x16x32_bf16 v[76:79], a[128:131], a[240:243], v[76:79]
v_mfma_f32_16x16x32_bf16 v[76:79], a[132:135], a[244:247], v[76:79]
ds_read_b128 a[236:239], v7 offset:57344
s_waitcnt lgkmcnt(4)
v_mfma_f32_16x16x32_bf16 v[80:83], a[56:59], a[216:219], v[80:83]
v_mfma_f32_16x16x32_bf16 v[80:83], a[60:63], a[220:223], v[80:83]
ds_read_b128 a[240:243], v10 offset:49152
v_mfma_f32_16x16x32_bf16 v[84:87], a[128:131], a[216:219], v[84:87]
v_mfma_f32_16x16x32_bf16 v[84:87], a[132:135], a[220:223], v[84:87]
ds_read_b128 a[244:247], v10 offset:57344
s_waitcnt lgkmcnt(4)
v_mfma_f32_16x16x32_bf16 v[88:91], a[56:59], a[224:227], v[88:91]
v_mfma_f32_16x16x32_bf16 v[88:91], a[60:63], a[228:231], v[88:91]
ds_read_b128 a[216:219], v5 offset:0
v_mfma_f32_16x16x32_bf16 v[92:95], a[128:131], a[224:227], v[92:95]
v_mfma_f32_16x16x32_bf16 v[92:95], a[132:135], a[228:231], v[92:95]
ds_read_b128 a[220:223], v5 offset:8192
s_waitcnt lgkmcnt(4)
v_mfma_f32_16x16x32_bf16 v[96:99], a[232:235], a[200:203], v[96:99]
ds_read_b128 a[224:227], v5 offset:1024
v_mfma_f32_16x16x32_bf16 v[96:99], a[236:239], a[204:207], v[96:99]
ds_read_b128 a[228:231], v5 offset:9216
s_waitcnt lgkmcnt(4)
v_mfma_f32_16x16x32_bf16 v[100:103], a[200:203], a[240:243], v[100:103]
ds_read_b128 a[232:235], v5 offset:2048
v_mfma_f32_16x16x32_bf16 v[100:103], a[204:207], a[244:247], v[100:103]
ds_read_b128 a[236:239], v5 offset:10240
s_waitcnt vmcnt(0)
s_waitcnt lgkmcnt(4)
v_mfma_f32_16x16x32_bf16 v[32:35], a[216:219], a[64:67], v[32:35]
v_mfma_f32_16x16x32_bf16 v[32:35], a[220:223], a[68:71], v[32:35]
ds_read_b128 a[240:243], v5 offset:3072
v_mfma_f32_16x16x32_bf16 v[36:39], a[216:219], a[136:139], v[36:39]
v_mfma_f32_16x16x32_bf16 v[36:39], a[220:223], a[140:143], v[36:39]
ds_read_b128 a[244:247], v5 offset:11264
s_waitcnt lgkmcnt(4)
v_mfma_f32_16x16x32_bf16 v[40:43], a[224:227], a[64:67], v[40:43]
v_mfma_f32_16x16x32_bf16 v[40:43], a[228:231], a[68:71], v[40:43]
ds_read_b128 a[216:219], v5 offset:4096
v_mfma_f32_16x16x32_bf16 v[44:47], a[224:227], a[136:139], v[44:47]
v_mfma_f32_16x16x32_bf16 v[44:47], a[228:231], a[140:143], v[44:47]
ds_read_b128 a[220:223], v5 offset:12288
s_waitcnt lgkmcnt(4)
v_mfma_f32_16x16x32_bf16 v[48:51], a[232:235], a[64:67], v[48:51]
v_mfma_f32_16x16x32_bf16 v[48:51], a[236:239], a[68:71], v[48:51]
ds_read_b128 a[224:227], v5 offset:5120
v_mfma_f32_16x16x32_bf16 v[52:55], a[232:235], a[136:139], v[52:55]
v_mfma_f32_16x16x32_bf16 v[52:55], a[236:239], a[140:143], v[52:55]
ds_read_b128 a[228:231], v5 offset:13312
s_waitcnt lgkmcnt(4)
v_mfma_f32_16x16x32_bf16 v[56:59], a[240:243], a[64:67], v[56:59]
v_mfma_f32_16x16x32_bf16 v[56:59], a[244:247], a[68:71], v[56:59]
ds_read_b128 a[232:235], v5 offset:6144
v_mfma_f32_16x16x32_bf16 v[60:63], a[240:243], a[136:139], v[60:63]
v_mfma_f32_16x16x32_bf16 v[60:63], a[244:247], a[140:143], v[60:63]
ds_read_b128 a[236:239], v5 offset:14336
s_waitcnt lgkmcnt(4)
v_mfma_f32_16x16x32_bf16 v[64:67], a[216:219], a[64:67], v[64:67]
v_mfma_f32_16x16x32_bf16 v[64:67], a[220:223], a[68:71], v[64:67]
ds_read_b128 a[240:243], v5 offset:7168
v_mfma_f32_16x16x32_bf16 v[68:71], a[216:219], a[136:139], v[68:71]
v_mfma_f32_16x16x32_bf16 v[68:71], a[220:223], a[140:143], v[68:71]
ds_read_b128 a[244:247], v5 offset:15360
s_waitcnt lgkmcnt(4)
v_mfma_f32_16x16x32_bf16 v[72:75], a[64:67], a[224:227], v[72:75]
v_mfma_f32_16x16x32_bf16 v[72:75], a[68:71], a[228:231], v[72:75]
ds_read_b128 a[216:219], v8 offset:0
v_mfma_f32_16x16x32_bf16 v[76:79], a[136:139], a[224:227], v[76:79]
v_mfma_f32_16x16x32_bf16 v[76:79], a[140:143], a[228:231], v[76:79]
ds_read_b128 a[220:223], v8 offset:8192
s_waitcnt lgkmcnt(4)
v_mfma_f32_16x16x32_bf16 v[80:83], a[64:67], a[232:235], v[80:83]
v_mfma_f32_16x16x32_bf16 v[80:83], a[68:71], a[236:239], v[80:83]
ds_read_b128 a[224:227], v11 offset:0
v_mfma_f32_16x16x32_bf16 v[84:87], a[136:139], a[232:235], v[84:87]
v_mfma_f32_16x16x32_bf16 v[84:87], a[140:143], a[236:239], v[84:87]
ds_read_b128 a[228:231], v11 offset:8192
s_waitcnt lgkmcnt(4)
v_mfma_f32_16x16x32_bf16 v[88:91], a[64:67], a[240:243], v[88:91]
v_mfma_f32_16x16x32_bf16 v[88:91], a[68:71], a[244:247], v[88:91]
v_mfma_f32_16x16x32_bf16 v[92:95], a[136:139], a[240:243], v[92:95]
v_mfma_f32_16x16x32_bf16 v[92:95], a[140:143], a[244:247], v[92:95]
s_waitcnt lgkmcnt(2)
v_mfma_f32_16x16x32_bf16 v[96:99], a[216:219], a[208:211], v[96:99]
v_mfma_f32_16x16x32_bf16 v[96:99], a[220:223], a[212:215], v[96:99]
s_waitcnt lgkmcnt(0)
v_mfma_f32_16x16x32_bf16 v[100:103], a[208:211], a[224:227], v[100:103]
v_mfma_f32_16x16x32_bf16 v[100:103], a[212:215], a[228:231], v[100:103]
s_branch L_att
L_last:
s_cmp_eq_u32 s4, 3
s_cbranch_scc1 L_epoch
v_and_b32 v6, 7, v1
v_lshrrev_b32 v7, 3, v1
s_mul_i32 s22, s4, 24
v_add_u32 v7, s22, v7
s_and_b32 s23, s6, 1
s_lshl_b32 s23, s23, 3
v_add_u32 v8, s23, v6
v_lshlrev_b32 v8, 4, v8
v_lshl_add_u32 v4, v7, 8, v8
s_lshl_b32 s24, s5, 4
s_lshr_b32 s25, s6, 1
s_add_u32 s24, s24, s25
s_mul_i32 s20, s24, 18432
s_lshl_b32 s24, s5, 8
s_lshl_b32 s25, s6, 3
s_add_u32 s24, s24, s25
s_and_b32 s25, s24, 1023
s_lshl_b32 s25, s25, 1
s_lshr_b32 s24, s24, 10
s_add_u32 s24, s24, s25
s_mul_i32 s21, s24, 1152
v_mul_u32_u24 v8, 2304, v6
v_lshl_add_u32 v5, v7, 4, v8
s_load_dwordx2 s[12:13], s[0:1], 56
s_waitcnt lgkmcnt(0)
s_mov_b32 s16, s12
s_and_b32 s17, s13, 0xffff
s_mov_b32 s18, 2359296
s_mov_b32 s19, 0x20000
s_add_u32 s24, s20, 39776256
s_add_u32 s25, s24, 4096
buffer_load_dwordx4 v[16:19], v4, s[8:11], s24 offen offset:0 sc1
buffer_load_dwordx4 v[20:23], v4, s[8:11], s24 offen offset:2048 sc1
buffer_load_dwordx4 v[24:27], v4, s[8:11], s25 offen offset:0 sc1
s_lshl_b32 s24, s5, 2
s_lshr_b32 s25, s6, 3
s_add_u32 s24, s24, s25
s_lshl_b32 s24, s24, 12
s_add_u32 s24, s24, 1703936
v_and_b32 v6, 31, v1
v_lshlrev_b32 v6, 7, v6
s_mov_b32 s52, 0
L_poll8:
buffer_load_dwordx2 v[14:15], v6, s[8:11], s24 offen sc1
s_add_u32 s52, s52, 1
s_waitcnt vmcnt(0)
v_cmp_ne_u64 vcc, s[68:69], v[14:15]
s_cmp_ge_u32 s52, 0x100000
s_cbranch_scc1 L_got8
s_and_b64 exec, exec, vcc
s_cbranch_execnz L_poll8
L_got8:
s_mov_b64 exec, -1
s_add_u32 s24, s20, 99020800
s_add_u32 s25, s24, 4096
buffer_load_dwordx4 v[28:31], v4, s[8:11], s24 offen offset:0 sc1
buffer_load_dwordx4 v[32:35], v4, s[8:11], s24 offen offset:2048 sc1
buffer_load_dwordx4 v[36:39], v4, s[8:11], s25 offen offset:0 sc1
s_add_u32 s24, s20, 101380096
s_add_u32 s25, s24, 4096
buffer_load_dwordx4 v[40:43], v4, s[8:11], s24 offen offset:0 sc1
buffer_load_dwordx4 v[44:47], v4, s[8:11], s24 offen offset:2048 sc1
buffer_load_dwordx4 v[48:51], v4, s[8:11], s25 offen offset:0 sc1
s_add_u32 s24, s20, 103739392
s_add_u32 s25, s24, 4096
buffer_load_dwordx4 v[52:55], v4, s[8:11], s24 offen offset:0 sc1
buffer_load_dwordx4 v[56:59], v4, s[8:11], s24 offen offset:2048 sc1
buffer_load_dwordx4 v[60:63], v4, s[8:11], s25 offen offset:0 sc1
s_add_u32 s24, s20, 106098688
s_add_u32 s25, s24, 4096
buffer_load_dwordx4 v[64:67], v4, s[8:11], s24 offen offset:0 sc1
buffer_load_dwordx4 v[68:71], v4, s[8:11], s24 offen offset:2048 sc1
buffer_load_dwordx4 v[72:75], v4, s[8:11], s25 offen offset:0 sc1
s_add_u32 s24, s20, 108457984
s_add_u32 s25, s24, 4096
buffer_load_dwordx4 v[76:79], v4, s[8:11], s24 offen offset:0 sc1
buffer_load_dwordx4 v[80:83], v4, s[8:11], s24 offen offset:2048 sc1
buffer_load_dwordx4 v[84:87], v4, s[8:11], s25 offen offset:0 sc1
s_add_u32 s24, s20, 110817280
s_add_u32 s25, s24, 4096
buffer_load_dwordx4 v[88:91], v4, s[8:11], s24 offen offset:0 sc1
buffer_load_dwordx4 v[92:95], v4, s[8:11], s24 offen offset:2048 sc1
buffer_load_dwordx4 v[96:99], v4, s[8:11], s25 offen offset:0 sc1
s_add_u32 s24, s20, 113176576
s_add_u32 s25, s24, 4096
buffer_load_dwordx4 v[100:103], v4, s[8:11], s24 offen offset:0 sc1
buffer_load_dwordx4 v[104:107], v4, s[8:11], s24 offen offset:2048 sc1
buffer_load_dwordx4 v[108:111], v4, s[8:11], s25 offen offset:0 sc1
s_add_u32 s24, s20, 115535872
s_add_u32 s25, s24, 4096
buffer_load_dwordx4 v[112:115], v4, s[8:11], s24 offen offset:0 sc1
buffer_load_dwordx4 v[116:119], v4, s[8:11], s24 offen offset:2048 sc1
buffer_load_dwordx4 v[120:123], v4, s[8:11], s25 offen offset:0 sc1
s_waitcnt vmcnt(26)
v_lshlrev_b32 v128, 16, v16
v_and_b32 v129, 0xffff0000, v16
v_lshlrev_b32 v130, 16, v17
v_and_b32 v131, 0xffff0000, v17
v_lshlrev_b32 v132, 16, v18
v_and_b32 v133, 0xffff0000, v18
v_lshlrev_b32 v134, 16, v19
v_and_b32 v135, 0xffff0000, v19
s_waitcnt vmcnt(25)
v_lshlrev_b32 v136, 16, v20
v_and_b32 v137, 0xffff0000, v20
v_lshlrev_b32 v138, 16, v21
v_and_b32 v139, 0xffff0000, v21
v_lshlrev_b32 v140, 16, v22
v_and_b32 v141, 0xffff0000, v22
v_lshlrev_b32 v142, 16, v23
v_and_b32 v143, 0xffff0000, v23
s_waitcnt vmcnt(24)
v_lshlrev_b32 v144, 16, v24
v_and_b32 v145, 0xffff0000, v24
v_lshlrev_b32 v146, 16, v25
v_and_b32 v147, 0xffff0000, v25
v_lshlrev_b32 v148, 16, v26
v_and_b32 v149, 0xffff0000, v26
v_lshlrev_b32 v150, 16, v27
v_and_b32 v151, 0xffff0000, v27
s_waitcnt vmcnt(23)
v_lshlrev_b32 v6, 16, v28
v_and_b32 v7, 0xffff0000, v28
v_add_f32 v128, v128, v6
v_add_f32 v129, v129, v7
v_lshlrev_b32 v8, 16, v29
v_and_b32 v9, 0xffff0000, v29
v_add_f32 v130, v130, v8
v_add_f32 v131, v131, v9
v_lshlrev_b32 v6, 16, v30
v_and_b32 v7, 0xffff0000, v30
v_add_f32 v132, v132, v6
v_add_f32 v133, v133, v7
v_lshlrev_b32 v8, 16, v31
v_and_b32 v9, 0xffff0000, v31
v_add_f32 v134, v134, v8
v_add_f32 v135, v135, v9
s_waitcnt vmcnt(22)
v_lshlrev_b32 v6, 16, v32
v_and_b32 v7, 0xffff0000, v32
v_add_f32 v136, v136, v6
v_add_f32 v137, v137, v7
v_lshlrev_b32 v8, 16, v33
v_and_b32 v9, 0xffff0000, v33
v_add_f32 v138, v138, v8
v_add_f32 v139, v139, v9
v_lshlrev_b32 v6, 16, v34
v_and_b32 v7, 0xffff0000, v34
v_add_f32 v140, v140, v6
v_add_f32 v141, v141, v7
v_lshlrev_b32 v8, 16, v35
v_and_b32 v9, 0xffff0000, v35
v_add_f32 v142, v142, v8
v_add_f32 v143, v143, v9
s_waitcnt vmcnt(21)
v_lshlrev_b32 v6, 16, v36
v_and_b32 v7, 0xffff0000, v36
v_add_f32 v144, v144, v6
v_add_f32 v145, v145, v7
v_lshlrev_b32 v8, 16, v37
v_and_b32 v9, 0xffff0000, v37
v_add_f32 v146, v146, v8
v_add_f32 v147, v147, v9
v_lshlrev_b32 v6, 16, v38
v_and_b32 v7, 0xffff0000, v38
v_add_f32 v148, v148, v6
v_add_f32 v149, v149, v7
v_lshlrev_b32 v8, 16, v39
v_and_b32 v9, 0xffff0000, v39
v_add_f32 v150, v150, v8
v_add_f32 v151, v151, v9
s_waitcnt vmcnt(20)
v_lshlrev_b32 v6, 16, v40
v_and_b32 v7, 0xffff0000, v40
v_add_f32 v128, v128, v6
v_add_f32 v129, v129, v7
v_lshlrev_b32 v8, 16, v41
v_and_b32 v9, 0xffff0000, v41
v_add_f32 v130, v130, v8
v_add_f32 v131, v131, v9
v_lshlrev_b32 v6, 16, v42
v_and_b32 v7, 0xffff0000, v42
v_add_f32 v132, v132, v6
v_add_f32 v133, v133, v7
v_lshlrev_b32 v8, 16, v43
v_and_b32 v9, 0xffff0000, v43
v_add_f32 v134, v134, v8
v_add_f32 v135, v135, v9
s_waitcnt vmcnt(19)
v_lshlrev_b32 v6, 16, v44
v_and_b32 v7, 0xffff0000, v44
v_add_f32 v136, v136, v6
v_add_f32 v137, v137, v7
v_lshlrev_b32 v8, 16, v45
v_and_b32 v9, 0xffff0000, v45
v_add_f32 v138, v138, v8
v_add_f32 v139, v139, v9
v_lshlrev_b32 v6, 16, v46
v_and_b32 v7, 0xffff0000, v46
v_add_f32 v140, v140, v6
v_add_f32 v141, v141, v7
v_lshlrev_b32 v8, 16, v47
v_and_b32 v9, 0xffff0000, v47
v_add_f32 v142, v142, v8
v_add_f32 v143, v143, v9
s_waitcnt vmcnt(18)
v_lshlrev_b32 v6, 16, v48
v_and_b32 v7, 0xffff0000, v48
v_add_f32 v144, v144, v6
v_add_f32 v145, v145, v7
v_lshlrev_b32 v8, 16, v49
v_and_b32 v9, 0xffff0000, v49
v_add_f32 v146, v146, v8
v_add_f32 v147, v147, v9
v_lshlrev_b32 v6, 16, v50
v_and_b32 v7, 0xffff0000, v50
v_add_f32 v148, v148, v6
v_add_f32 v149, v149, v7
v_lshlrev_b32 v8, 16, v51
v_and_b32 v9, 0xffff0000, v51
v_add_f32 v150, v150, v8
v_add_f32 v151, v151, v9
s_waitcnt vmcnt(17)
v_lshlrev_b32 v6, 16, v52
v_and_b32 v7, 0xffff0000, v52
v_add_f32 v128, v128, v6
v_add_f32 v129, v129, v7
v_lshlrev_b32 v8, 16, v53
v_and_b32 v9, 0xffff0000, v53
v_add_f32 v130, v130, v8
v_add_f32 v131, v131, v9
v_lshlrev_b32 v6, 16, v54
v_and_b32 v7, 0xffff0000, v54
v_add_f32 v132, v132, v6
v_add_f32 v133, v133, v7
v_lshlrev_b32 v8, 16, v55
v_and_b32 v9, 0xffff0000, v55
v_add_f32 v134, v134, v8
v_add_f32 v135, v135, v9
s_waitcnt vmcnt(16)
v_lshlrev_b32 v6, 16, v56
v_and_b32 v7, 0xffff0000, v56
v_add_f32 v136, v136, v6
v_add_f32 v137, v137, v7
v_lshlrev_b32 v8, 16, v57
v_and_b32 v9, 0xffff0000, v57
v_add_f32 v138, v138, v8
v_add_f32 v139, v139, v9
v_lshlrev_b32 v6, 16, v58
v_and_b32 v7, 0xffff0000, v58
v_add_f32 v140, v140, v6
v_add_f32 v141, v141, v7
v_lshlrev_b32 v8, 16, v59
v_and_b32 v9, 0xffff0000, v59
v_add_f32 v142, v142, v8
v_add_f32 v143, v143, v9
s_waitcnt vmcnt(15)
v_lshlrev_b32 v6, 16, v60
v_and_b32 v7, 0xffff0000, v60
v_add_f32 v144, v144, v6
v_add_f32 v145, v145, v7
v_lshlrev_b32 v8, 16, v61
v_and_b32 v9, 0xffff0000, v61
v_add_f32 v146, v146, v8
v_add_f32 v147, v147, v9
v_lshlrev_b32 v6, 16, v62
v_and_b32 v7, 0xffff0000, v62
v_add_f32 v148, v148, v6
v_add_f32 v149, v149, v7
v_lshlrev_b32 v8, 16, v63
v_and_b32 v9, 0xffff0000, v63
v_add_f32 v150, v150, v8
v_add_f32 v151, v151, v9
s_waitcnt vmcnt(14)
v_lshlrev_b32 v6, 16, v64
v_and_b32 v7, 0xffff0000, v64
v_add_f32 v128, v128, v6
v_add_f32 v129, v129, v7
v_lshlrev_b32 v8, 16, v65
v_and_b32 v9, 0xffff0000, v65
v_add_f32 v130, v130, v8
v_add_f32 v131, v131, v9
v_lshlrev_b32 v6, 16, v66
v_and_b32 v7, 0xffff0000, v66
v_add_f32 v132, v132, v6
v_add_f32 v133, v133, v7
v_lshlrev_b32 v8, 16, v67
v_and_b32 v9, 0xffff0000, v67
v_add_f32 v134, v134, v8
v_add_f32 v135, v135, v9
s_waitcnt vmcnt(13)
v_lshlrev_b32 v6, 16, v68
v_and_b32 v7, 0xffff0000, v68
v_add_f32 v136, v136, v6
v_add_f32 v137, v137, v7
v_lshlrev_b32 v8, 16, v69
v_and_b32 v9, 0xffff0000, v69
v_add_f32 v138, v138, v8
v_add_f32 v139, v139, v9
v_lshlrev_b32 v6, 16, v70
v_and_b32 v7, 0xffff0000, v70
v_add_f32 v140, v140, v6
v_add_f32 v141, v141, v7
v_lshlrev_b32 v8, 16, v71
v_and_b32 v9, 0xffff0000, v71
v_add_f32 v142, v142, v8
v_add_f32 v143, v143, v9
s_waitcnt vmcnt(12)
v_lshlrev_b32 v6, 16, v72
v_and_b32 v7, 0xffff0000, v72
v_add_f32 v144, v144, v6
v_add_f32 v145, v145, v7
v_lshlrev_b32 v8, 16, v73
v_and_b32 v9, 0xffff0000, v73
v_add_f32 v146, v146, v8
v_add_f32 v147, v147, v9
v_lshlrev_b32 v6, 16, v74
v_and_b32 v7, 0xffff0000, v74
v_add_f32 v148, v148, v6
v_add_f32 v149, v149, v7
v_lshlrev_b32 v8, 16, v75
v_and_b32 v9, 0xffff0000, v75
v_add_f32 v150, v150, v8
v_add_f32 v151, v151, v9
s_waitcnt vmcnt(11)
v_lshlrev_b32 v6, 16, v76
v_and_b32 v7, 0xffff0000, v76
v_add_f32 v128, v128, v6
v_add_f32 v129, v129, v7
v_lshlrev_b32 v8, 16, v77
v_and_b32 v9, 0xffff0000, v77
v_add_f32 v130, v130, v8
v_add_f32 v131, v131, v9
v_lshlrev_b32 v6, 16, v78
v_and_b32 v7, 0xffff0000, v78
v_add_f32 v132, v132, v6
v_add_f32 v133, v133, v7
v_lshlrev_b32 v8, 16, v79
v_and_b32 v9, 0xffff0000, v79
v_add_f32 v134, v134, v8
v_add_f32 v135, v135, v9
s_waitcnt vmcnt(10)
v_lshlrev_b32 v6, 16, v80
v_and_b32 v7, 0xffff0000, v80
v_add_f32 v136, v136, v6
v_add_f32 v137, v137, v7
v_lshlrev_b32 v8, 16, v81
v_and_b32 v9, 0xffff0000, v81
v_add_f32 v138, v138, v8
v_add_f32 v139, v139, v9
v_lshlrev_b32 v6, 16, v82
v_and_b32 v7, 0xffff0000, v82
v_add_f32 v140, v140, v6
v_add_f32 v141, v141, v7
v_lshlrev_b32 v8, 16, v83
v_and_b32 v9, 0xffff0000, v83
v_add_f32 v142, v142, v8
v_add_f32 v143, v143, v9
s_waitcnt vmcnt(9)
v_lshlrev_b32 v6, 16, v84
v_and_b32 v7, 0xffff0000, v84
v_add_f32 v144, v144, v6
v_add_f32 v145, v145, v7
v_lshlrev_b32 v8, 16, v85
v_and_b32 v9, 0xffff0000, v85
v_add_f32 v146, v146, v8
v_add_f32 v147, v147, v9
v_lshlrev_b32 v6, 16, v86
v_and_b32 v7, 0xffff0000, v86
v_add_f32 v148, v148, v6
v_add_f32 v149, v149, v7
v_lshlrev_b32 v8, 16, v87
v_and_b32 v9, 0xffff0000, v87
v_add_f32 v150, v150, v8
v_add_f32 v151, v151, v9
s_waitcnt vmcnt(8)
v_lshlrev_b32 v6, 16, v88
v_and_b32 v7, 0xffff0000, v88
v_add_f32 v128, v128, v6
v_add_f32 v129, v129, v7
v_lshlrev_b32 v8, 16, v89
v_and_b32 v9, 0xffff0000, v89
v_add_f32 v130, v130, v8
v_add_f32 v131, v131, v9
v_lshlrev_b32 v6, 16, v90
v_and_b32 v7, 0xffff0000, v90
v_add_f32 v132, v132, v6
v_add_f32 v133, v133, v7
v_lshlrev_b32 v8, 16, v91
v_and_b32 v9, 0xffff0000, v91
v_add_f32 v134, v134, v8
v_add_f32 v135, v135, v9
s_waitcnt vmcnt(7)
v_lshlrev_b32 v6, 16, v92
v_and_b32 v7, 0xffff0000, v92
v_add_f32 v136, v136, v6
v_add_f32 v137, v137, v7
v_lshlrev_b32 v8, 16, v93
v_and_b32 v9, 0xffff0000, v93
v_add_f32 v138, v138, v8
v_add_f32 v139, v139, v9
v_lshlrev_b32 v6, 16, v94
v_and_b32 v7, 0xffff0000, v94
v_add_f32 v140, v140, v6
v_add_f32 v141, v141, v7
v_lshlrev_b32 v8, 16, v95
v_and_b32 v9, 0xffff0000, v95
v_add_f32 v142, v142, v8
v_add_f32 v143, v143, v9
s_waitcnt vmcnt(6)
v_lshlrev_b32 v6, 16, v96
v_and_b32 v7, 0xffff0000, v96
v_add_f32 v144, v144, v6
v_add_f32 v145, v145, v7
v_lshlrev_b32 v8, 16, v97
v_and_b32 v9, 0xffff0000, v97
v_add_f32 v146, v146, v8
v_add_f32 v147, v147, v9
v_lshlrev_b32 v6, 16, v98
v_and_b32 v7, 0xffff0000, v98
v_add_f32 v148, v148, v6
v_add_f32 v149, v149, v7
v_lshlrev_b32 v8, 16, v99
v_and_b32 v9, 0xffff0000, v99
v_add_f32 v150, v150, v8
v_add_f32 v151, v151, v9
s_waitcnt vmcnt(5)
v_lshlrev_b32 v6, 16, v100
v_and_b32 v7, 0xffff0000, v100
v_add_f32 v128, v128, v6
v_add_f32 v129, v129, v7
v_lshlrev_b32 v8, 16, v101
v_and_b32 v9, 0xffff0000, v101
v_add_f32 v130, v130, v8
v_add_f32 v131, v131, v9
v_lshlrev_b32 v6, 16, v102
v_and_b32 v7, 0xffff0000, v102
v_add_f32 v132, v132, v6
v_add_f32 v133, v133, v7
v_lshlrev_b32 v8, 16, v103
v_and_b32 v9, 0xffff0000, v103
v_add_f32 v134, v134, v8
v_add_f32 v135, v135, v9
s_waitcnt vmcnt(4)
v_lshlrev_b32 v6, 16, v104
v_and_b32 v7, 0xffff0000, v104
v_add_f32 v136, v136, v6
v_add_f32 v137, v137, v7
v_lshlrev_b32 v8, 16, v105
v_and_b32 v9, 0xffff0000, v105
v_add_f32 v138, v138, v8
v_add_f32 v139, v139, v9
v_lshlrev_b32 v6, 16, v106
v_and_b32 v7, 0xffff0000, v106
v_add_f32 v140, v140, v6
v_add_f32 v141, v141, v7
v_lshlrev_b32 v8, 16, v107
v_and_b32 v9, 0xffff0000, v107
v_add_f32 v142, v142, v8
v_add_f32 v143, v143, v9
s_waitcnt vmcnt(3)
v_lshlrev_b32 v6, 16, v108
v_and_b32 v7, 0xffff0000, v108
v_add_f32 v144, v144, v6
v_add_f32 v145, v145, v7
v_lshlrev_b32 v8, 16, v109
v_and_b32 v9, 0xffff0000, v109
v_add_f32 v146, v146, v8
v_add_f32 v147, v147, v9
v_lshlrev_b32 v6, 16, v110
v_and_b32 v7, 0xffff0000, v110
v_add_f32 v148, v148, v6
v_add_f32 v149, v149, v7
v_lshlrev_b32 v8, 16, v111
v_and_b32 v9, 0xffff0000, v111
v_add_f32 v150, v150, v8
v_add_f32 v151, v151, v9
s_waitcnt vmcnt(2)
v_lshlrev_b32 v6, 16, v112
v_and_b32 v7, 0xffff0000, v112
v_add_f32 v128, v128, v6
v_add_f32 v129, v129, v7
v_lshlrev_b32 v8, 16, v113
v_and_b32 v9, 0xffff0000, v113
v_add_f32 v130, v130, v8
v_add_f32 v131, v131, v9
v_lshlrev_b32 v6, 16, v114
v_and_b32 v7, 0xffff0000, v114
v_add_f32 v132, v132, v6
v_add_f32 v133, v133, v7
v_lshlrev_b32 v8, 16, v115
v_and_b32 v9, 0xffff0000, v115
v_add_f32 v134, v134, v8
v_add_f32 v135, v135, v9
s_waitcnt vmcnt(1)
v_lshlrev_b32 v6, 16, v116
v_and_b32 v7, 0xffff0000, v116
v_add_f32 v136, v136, v6
v_add_f32 v137, v137, v7
v_lshlrev_b32 v8, 16, v117
v_and_b32 v9, 0xffff0000, v117
v_add_f32 v138, v138, v8
v_add_f32 v139, v139, v9
v_lshlrev_b32 v6, 16, v118
v_and_b32 v7, 0xffff0000, v118
v_add_f32 v140, v140, v6
v_add_f32 v141, v141, v7
v_lshlrev_b32 v8, 16, v119
v_and_b32 v9, 0xffff0000, v119
v_add_f32 v142, v142, v8
v_add_f32 v143, v143, v9
s_waitcnt vmcnt(0)
v_lshlrev_b32 v6, 16, v120
v_and_b32 v7, 0xffff0000, v120
v_add_f32 v144, v144, v6
v_add_f32 v145, v145, v7
v_lshlrev_b32 v8, 16, v121
v_and_b32 v9, 0xffff0000, v121
v_add_f32 v146, v146, v8
v_add_f32 v147, v147, v9
v_lshlrev_b32 v6, 16, v122
v_and_b32 v7, 0xffff0000, v122
v_add_f32 v148, v148, v6
v_add_f32 v149, v149, v7
v_lshlrev_b32 v8, 16, v123
v_and_b32 v9, 0xffff0000, v123
v_add_f32 v150, v150, v8
v_add_f32 v151, v151, v9
v_cvt_pk_bf16_f32 v152, v128, v129
v_cvt_pk_bf16_f32 v153, v130, v131
v_cvt_pk_bf16_f32 v154, v132, v133
v_cvt_pk_bf16_f32 v155, v134, v135
v_cvt_pk_bf16_f32 v156, v136, v137
v_cvt_pk_bf16_f32 v157, v138, v139
v_cvt_pk_bf16_f32 v158, v140, v141
v_cvt_pk_bf16_f32 v159, v142, v143
v_cvt_pk_bf16_f32 v160, v144, v145
v_cvt_pk_bf16_f32 v161, v146, v147
v_cvt_pk_bf16_f32 v162, v148, v149
v_cvt_pk_bf16_f32 v163, v150, v151
buffer_store_dwordx4 v[152:155], v5, s[16:19], s21 offen offset:0
buffer_store_dwordx4 v[156:159], v5, s[16:19], s21 offen offset:128
buffer_store_dwordx4 v[160:163], v5, s[16:19], s21 offen offset:256
L_end:
s_endpgm
L_f_slow1:
s_mov_b32 s52, 0
L_f_spin1:
buffer_load_dwordx2 v[14:15], v11, s[8:11], s23 offen sc1
s_add_u32 s52, s52, 1
s_waitcnt vmcnt(0)
v_cmp_eq_u64 vcc, s[68:69], v[14:15]
s_cmp_gt_u32 s52, 0x100000
s_cbranch_scc1 L_f_back1
s_cmp_eq_u64 vcc, exec
s_cbranch_scc0 L_f_spin1
s_branch L_f_back1
L_f_slow2:
s_mov_b32 s52, 0
L_f_spin2:
buffer_load_dwordx2 v[14:15], v11, s[8:11], s23 offen sc1
s_add_u32 s52, s52, 1
s_waitcnt vmcnt(0)
v_cmp_eq_u64 vcc, s[68:69], v[14:15]
s_cmp_gt_u32 s52, 0x100000
s_cbranch_scc1 L_f_back2
s_cmp_eq_u64 vcc, exec
s_cbranch_scc0 L_f_spin2
s_branch L_f_back2
L_f_slow3:
s_mov_b32 s52, 0
L_f_spin3:
buffer_load_dwordx2 v[14:15], v11, s[8:11], s23 offen sc1
s_add_u32 s52, s52, 1
s_waitcnt vmcnt(0)
v_cmp_eq_u64 vcc, s[68:69], v[14:15]
s_cmp_gt_u32 s52, 0x100000
s_cbranch_scc1 L_f_back3
s_cmp_eq_u64 vcc, exec
s_cbranch_scc0 L_f_spin3
s_branch L_f_back3
L_epoch:
s_cmp_lg_u32 s2, 0
s_cbranch_scc1 L_end
s_load_dwordx2 s[12:13], s[0:1], 64
s_waitcnt lgkmcnt(0)
s_mov_b32 s44, s12
s_and_b32 s45, s13, 0xffff
s_mov_b32 s46, 256
s_mov_b32 s47, 0x20000
v_mov_b32 v3, 0
s_mov_b32 s52, 0
L_ep:
buffer_load_dword v4, v3, s[44:47], 0 offen sc1
s_add_u32 s52, s52, 1
s_waitcnt vmcnt(0)
v_readfirstlane_b32 s40, v4
s_cmp_ge_u32 s52, 0x100000
s_cbranch_scc1 L_end
s_cmp_lt_u32 s40, 256
s_cbranch_scc1 L_ep
s_mov_b32 s40, 4194304
v_mov_b32 v13, 2146435072
v_cmp_eq_u32 vcc, 0, v1
v_mov_b32 v14, s68
v_mov_b32 v15, s69
v_cndmask_b32 v13, v13, 0, vcc
buffer_store_dwordx2 v[14:15], v13, s[8:11], s40 offen sc1
s_branch L_end
L_code_end:
s_endpgm
.section .rodata,"a"
.p2align 6
.amdhsa_kernel interleave_layers__sliding_local_dilated__glu_gated_geglu__prompt_kernel
  .amdhsa_next_free_vgpr 512
  .amdhsa_next_free_sgpr 102
  .amdhsa_accum_offset 256
  .amdhsa_group_segment_fixed_size 0
  .amdhsa_kernarg_size 80
  .amdhsa_user_sgpr_count 2
  .amdhsa_user_sgpr_kernarg_segment_ptr 1
  .amdhsa_system_sgpr_workgroup_id_x 1
.end_amdhsa_kernel
```

```asm
; @launch grid=(256,1,1) block=(256,1,1) lds=159744
.amdgcn_target "amdgcn-amd-amdhsa--gfx950"
.text
.p2align 8
.globl interleave_layers__sliding_local_dilated__glu_gated_geglu__prompt_kernel
.type interleave_layers__sliding_local_dilated__glu_gated_geglu__prompt_kernel,@function
interleave_layers__sliding_local_dilated__glu_gated_geglu__prompt_kernel:
s_cmp_ge_u32 s2, 256
s_cbranch_scc1 L_end
s_getpc_b64 s[40:41]
L_warm_pc:
s_lshr_b32 s42, s2, 3
s_lshl_b32 s42, s42, 11
v_lshlrev_b32 v10, 3, v0
v_add_u32 v10, s42, v10
v_min_u32 v10, L_code_end - L_warm_pc - 8, v10
v_mov_b32 v11, s41
v_add_co_u32 v10, vcc, s40, v10
s_nop 1
v_addc_co_u32 v11, vcc, 0, v11, vcc
global_load_dwordx2 a[0:1], v[10:11], off
v_add_co_u32 v10, vcc, 0x10000, v10
s_nop 1
v_addc_co_u32 v11, vcc, 0, v11, vcc
s_add_u32 s42, s42, 67584
s_cmp_le_u32 s42, L_code_end - L_warm_pc - 8
s_cbranch_scc0 L_warm_done
global_load_dwordx2 a[2:3], v[10:11], off
L_warm_done:
s_load_dwordx4 s[56:59], s[0:1], 0
s_load_dwordx2 s[60:61], s[0:1], 16
s_load_dwordx4 s[64:67], s[0:1], 32
s_load_dwordx2 s[62:63], s[0:1], 48
s_load_dwordx2 s[26:27], s[0:1], 64
s_load_dwordx2 s[12:13], s[0:1], 72
v_and_b32 v1, 63, v0
v_lshrrev_b32 v3, 6, v0
v_lshlrev_b32 v2, 4, v1
v_readfirstlane_b32 s4, v3
s_and_b32 s5, s2, 7
s_lshr_b32 s6, s2, 3
s_waitcnt lgkmcnt(0)
s_mov_b32 s8, s12
s_and_b32 s9, s13, 0xffff
s_mov_b32 s10, 268435456
s_mov_b32 s11, 0x20000
s_mov_b32 s16, s56
s_and_b32 s17, s57, 0xffff
s_mov_b32 s18, 2359296
s_mov_b32 s19, 0x20000
v_mov_b32 v3, 4194304
buffer_load_dwordx2 v[14:15], v3, s[8:11], 0 offen sc1
v_and_b32 v6, 7, v1
v_lshrrev_b32 v7, 3, v1
s_mul_i32 s22, s4, 24
v_add_u32 v7, s22, v7
s_and_b32 s23, s6, 1
s_lshl_b32 s23, s23, 3
v_add_u32 v8, s23, v6
v_lshlrev_b32 v8, 4, v8
v_lshl_add_u32 v4, v7, 8, v8
s_lshl_b32 s24, s5, 4
s_lshr_b32 s25, s6, 1
s_add_u32 s24, s24, s25
s_mul_i32 s20, s24, 18432
s_lshl_b32 s24, s5, 8
s_lshl_b32 s25, s6, 3
s_add_u32 s24, s24, s25
s_and_b32 s25, s24, 1023
s_lshl_b32 s25, s25, 1
s_lshr_b32 s24, s24, 10
s_add_u32 s24, s24, s25
s_mul_i32 s21, s24, 1152
v_mul_u32_u24 v8, 2304, v6
v_lshl_add_u32 v5, v7, 4, v8
s_cmp_eq_u32 s4, 3
s_cselect_b64 vcc, -1, 0
v_mov_b32 v8, 2146435072
v_cndmask_b32 v4, v4, v8, vcc
v_cndmask_b32 v5, v5, v8, vcc
buffer_load_dwordx4 v[16:19], v5, s[16:19], s21 offen offset:0 nt
buffer_load_dwordx4 v[20:23], v5, s[16:19], s21 offen offset:128 nt
buffer_load_dwordx4 v[24:27], v5, s[16:19], s21 offen offset:256 nt
s_lshl_b32 s40, s6, 2
s_add_u32 s40, s40, s4
v_and_b32 v6, 15, v1
v_lshrrev_b32 v7, 4, v1
v_lshrrev_b32 v8, 2, v6
v_mov_b32 v12, 2146435072
s_lshl_b32 s39, s5, 7
s_add_u32 s39, s39, s40
s_lshl_b32 s39, s39, 7
s_add_u32 s39, s39, 917504
s_cmp_ge_u32 s40, 96
s_cbranch_scc1 L_g_o
s_mov_b32 s44, s58
s_and_b32 s45, s59, 0xffff
s_mov_b32 s46, 1990656
s_mov_b32 s47, 0x20000
s_cmp_ge_u32 s40, 48
s_cselect_b32 s41, 1, 0
s_mul_i32 s42, s41, 48
s_sub_u32 s40, s40, s42
s_mul_i32 s40, s40, 3
s_lshl_b32 s42, s5, 1
s_add_u32 s41, s41, s42
s_mul_i32 s38, s41, 147456
s_lshl_b32 s42, s40, 10
s_add_u32 s38, s38, s42
s_add_u32 s38, s38, 4198400
s_mul_i32 s41, s41, 36
v_and_b32 v9, 1, v6
v_bfe_u32 v10, v6, 1, 1
v_mul_u32_u24 v10, 18, v10
v_add_u32 v9, v9, v10
v_mul_u32_u24 v10, 576, v8
v_add_u32 v9, v9, v10
v_mul_u32_u24 v10, 27648, v7
s_add_u32 s42, s40, 0
s_and_b32 s43, s42, 7
s_lshr_b32 s42, s42, 3
s_mul_i32 s42, s42, 110592
s_mov_b32 s35, 0
s_cmp_eq_u32 s43, 1
s_cselect_b32 s35, 18, s35
s_cmp_eq_u32 s43, 2
s_cselect_b32 s35, 576, s35
s_cmp_eq_u32 s43, 3
s_cselect_b32 s35, 594, s35
s_cmp_eq_u32 s43, 4
s_cselect_b32 s35, 16, s35
s_cmp_eq_u32 s43, 5
s_cselect_b32 s35, 1152, s35
s_cmp_eq_u32 s43, 6
s_cselect_b32 s35, 1170, s35
s_cmp_eq_u32 s43, 7
s_cselect_b32 s35, 1168, s35
s_add_u32 s35, s35, s41
s_mov_b32 s36, 16
s_cmp_eq_u32 s43, 4
s_cselect_b32 s36, 8, s36
s_cmp_eq_u32 s43, 7
s_cselect_b32 s36, 4, s36
s_cmp_lg_u32 s36, 16
s_cselect_b64 vcc, -1, 0
v_cndmask_b32 v11, v6, v9, vcc
v_add_u32 v11, s35, v11
v_lshl_add_u32 v11, v11, 1, v10
v_cmp_gt_u32 vcc, s36, v6
s_nop 1
v_cndmask_b32 v11, v12, v11, vcc
buffer_load_ushort v52, v11, s[44:47], s42 offen nt
s_add_u32 s42, s42, 3456
buffer_load_ushort v53, v11, s[44:47], s42 offen nt
s_add_u32 s42, s42, 3456
buffer_load_ushort v54, v11, s[44:47], s42 offen nt
s_add_u32 s42, s42, 3456
buffer_load_ushort v55, v11, s[44:47], s42 offen nt
s_add_u32 s42, s42, 3456
buffer_load_ushort v56, v11, s[44:47], s42 offen nt
s_add_u32 s42, s42, 3456
buffer_load_ushort v57, v11, s[44:47], s42 offen nt
s_add_u32 s42, s42, 3456
buffer_load_ushort v58, v11, s[44:47], s42 offen nt
s_add_u32 s42, s42, 3456
buffer_load_ushort v59, v11, s[44:47], s42 offen nt
s_add_u32 s42, s40, 1
s_and_b32 s43, s42, 7
s_lshr_b32 s42, s42, 3
s_mul_i32 s42, s42, 110592
s_mov_b32 s35, 0
s_cmp_eq_u32 s43, 1
s_cselect_b32 s35, 18, s35
s_cmp_eq_u32 s43, 2
s_cselect_b32 s35, 576, s35
s_cmp_eq_u32 s43, 3
s_cselect_b32 s35, 594, s35
s_cmp_eq_u32 s43, 4
s_cselect_b32 s35, 16, s35
s_cmp_eq_u32 s43, 5
s_cselect_b32 s35, 1152, s35
s_cmp_eq_u32 s43, 6
s_cselect_b32 s35, 1170, s35
s_cmp_eq_u32 s43, 7
s_cselect_b32 s35, 1168, s35
s_add_u32 s35, s35, s41
s_mov_b32 s36, 16
s_cmp_eq_u32 s43, 4
s_cselect_b32 s36, 8, s36
s_cmp_eq_u32 s43, 7
s_cselect_b32 s36, 4, s36
s_cmp_lg_u32 s36, 16
s_cselect_b64 vcc, -1, 0
v_cndmask_b32 v11, v6, v9, vcc
v_add_u32 v11, s35, v11
v_lshl_add_u32 v11, v11, 1, v10
v_cmp_gt_u32 vcc, s36, v6
s_nop 1
v_cndmask_b32 v11, v12, v11, vcc
buffer_load_ushort v60, v11, s[44:47], s42 offen nt
s_add_u32 s42, s42, 3456
buffer_load_ushort v61, v11, s[44:47], s42 offen nt
s_add_u32 s42, s42, 3456
buffer_load_ushort v62, v11, s[44:47], s42 offen nt
s_add_u32 s42, s42, 3456
buffer_load_ushort v63, v11, s[44:47], s42 offen nt
s_add_u32 s42, s42, 3456
buffer_load_ushort v64, v11, s[44:47], s42 offen nt
s_add_u32 s42, s42, 3456
buffer_load_ushort v65, v11, s[44:47], s42 offen nt
s_add_u32 s42, s42, 3456
buffer_load_ushort v66, v11, s[44:47], s42 offen nt
s_add_u32 s42, s42, 3456
buffer_load_ushort v67, v11, s[44:47], s42 offen nt
s_add_u32 s42, s40, 2
s_and_b32 s43, s42, 7
s_lshr_b32 s42, s42, 3
s_mul_i32 s42, s42, 110592
s_mov_b32 s35, 0
s_cmp_eq_u32 s43, 1
s_cselect_b32 s35, 18, s35
s_cmp_eq_u32 s43, 2
s_cselect_b32 s35, 576, s35
s_cmp_eq_u32 s43, 3
s_cselect_b32 s35, 594, s35
s_cmp_eq_u32 s43, 4
s_cselect_b32 s35, 16, s35
s_cmp_eq_u32 s43, 5
s_cselect_b32 s35, 1152, s35
s_cmp_eq_u32 s43, 6
s_cselect_b32 s35, 1170, s35
s_cmp_eq_u32 s43, 7
s_cselect_b32 s35, 1168, s35
s_add_u32 s35, s35, s41
s_mov_b32 s36, 16
s_cmp_eq_u32 s43, 4
s_cselect_b32 s36, 8, s36
s_cmp_eq_u32 s43, 7
s_cselect_b32 s36, 4, s36
s_cmp_lg_u32 s36, 16
s_cselect_b64 vcc, -1, 0
v_cndmask_b32 v11, v6, v9, vcc
v_add_u32 v11, s35, v11
v_lshl_add_u32 v11, v11, 1, v10
v_cmp_gt_u32 vcc, s36, v6
s_nop 1
v_cndmask_b32 v11, v12, v11, vcc
buffer_load_ushort v68, v11, s[44:47], s42 offen nt
s_add_u32 s42, s42, 3456
buffer_load_ushort v69, v11, s[44:47], s42 offen nt
s_add_u32 s42, s42, 3456
buffer_load_ushort v70, v11, s[44:47], s42 offen nt
s_add_u32 s42, s42, 3456
buffer_load_ushort v71, v11, s[44:47], s42 offen nt
s_add_u32 s42, s42, 3456
buffer_load_ushort v72, v11, s[44:47], s42 offen nt
s_add_u32 s42, s42, 3456
buffer_load_ushort v73, v11, s[44:47], s42 offen nt
s_add_u32 s42, s42, 3456
buffer_load_ushort v74, v11, s[44:47], s42 offen nt
s_add_u32 s42, s42, 3456
buffer_load_ushort v75, v11, s[44:47], s42 offen nt
s_branch L_g_done
L_g_o:
s_mov_b32 s44, s60
s_and_b32 s45, s61, 0xffff
s_mov_b32 s46, 663552
s_mov_b32 s47, 0x20000
s_sub_u32 s40, s40, 96
s_mul_i32 s40, s40, 3
s_mul_i32 s38, s5, 92160
s_lshl_b32 s42, s40, 10
s_add_u32 s38, s38, s42
s_add_u32 s38, s38, 6557696
s_cmp_ge_u32 s40, 90
s_cselect_b32 s38, 2146435072, s38
s_mul_i32 s41, s5, 72
v_and_b32 v9, 3, v6
v_lshl_add_u32 v9, v8, 3, v9
s_add_u32 s42, s40, 0
s_mul_i32 s43, s42, 13108
s_lshr_b32 s43, s43, 16
s_mul_i32 s35, s43, 5
s_sub_u32 s42, s42, s35
s_lshr_b32 s35, s42, 1
s_lshl_b32 s35, s35, 5
s_and_b32 s36, s42, 1
s_lshl_b32 s36, s36, 2
s_add_u32 s35, s35, s36
s_add_u32 s35, s35, s41
s_cmp_eq_u32 s42, 4
s_cselect_b64 vcc, -1, 0
s_cselect_b32 s36, 8, 16
v_cndmask_b32 v11, v9, v6, vcc
v_add_u32 v11, s35, v11
s_mul_i32 s35, s43, 41472
s_sub_u32 s37, s43, 16
s_mul_i32 s37, s37, 331776
s_cmp_lt_u32 s43, 16
s_cselect_b32 s35, s35, s37
s_cselect_b32 s37, 4, 72
s_cselect_b32 s34, 0, 1
s_mul_i32 s37, s37, 1152
v_mul_lo_u32 v10, s37, v7
v_lshl_add_u32 v11, v11, 1, v10
v_cmp_gt_u32 vcc, s36, v6
s_nop 1
v_cndmask_b32 v11, v12, v11, vcc
s_mul_i32 s42, s34, 18432
s_add_u32 s42, s42, 0
s_add_u32 s42, s42, s35
buffer_load_ushort v52, v11, s[44:47], s42 offen nt
s_mul_i32 s42, s34, 18432
s_add_u32 s42, s42, 1152
s_add_u32 s42, s42, s35
buffer_load_ushort v53, v11, s[44:47], s42 offen nt
s_mul_i32 s42, s34, 36864
s_add_u32 s42, s42, 2304
s_add_u32 s42, s42, s35
buffer_load_ushort v54, v11, s[44:47], s42 offen nt
s_mul_i32 s42, s34, 36864
s_add_u32 s42, s42, 3456
s_add_u32 s42, s42, s35
buffer_load_ushort v55, v11, s[44:47], s42 offen nt
s_mul_i32 s42, s34, 39168
s_add_u32 s42, s42, 20736
s_add_u32 s42, s42, s35
buffer_load_ushort v56, v11, s[44:47], s42 offen nt
s_mul_i32 s42, s34, 39168
s_add_u32 s42, s42, 21888
s_add_u32 s42, s42, s35
buffer_load_ushort v57, v11, s[44:47], s42 offen nt
s_mul_i32 s42, s34, 57600
s_add_u32 s42, s42, 23040
s_add_u32 s42, s42, s35
buffer_load_ushort v58, v11, s[44:47], s42 offen nt
s_mul_i32 s42, s34, 57600
s_add_u32 s42, s42, 24192
s_add_u32 s42, s42, s35
buffer_load_ushort v59, v11, s[44:47], s42 offen nt
s_add_u32 s42, s40, 1
s_mul_i32 s43, s42, 13108
s_lshr_b32 s43, s43, 16
s_mul_i32 s35, s43, 5
s_sub_u32 s42, s42, s35
s_lshr_b32 s35, s42, 1
s_lshl_b32 s35, s35, 5
s_and_b32 s36, s42, 1
s_lshl_b32 s36, s36, 2
s_add_u32 s35, s35, s36
s_add_u32 s35, s35, s41
s_cmp_eq_u32 s42, 4
s_cselect_b64 vcc, -1, 0
s_cselect_b32 s36, 8, 16
v_cndmask_b32 v11, v9, v6, vcc
v_add_u32 v11, s35, v11
s_mul_i32 s35, s43, 41472
s_sub_u32 s37, s43, 16
s_mul_i32 s37, s37, 331776
s_cmp_lt_u32 s43, 16
s_cselect_b32 s35, s35, s37
s_cselect_b32 s37, 4, 72
s_cselect_b32 s34, 0, 1
s_mul_i32 s37, s37, 1152
v_mul_lo_u32 v10, s37, v7
v_lshl_add_u32 v11, v11, 1, v10
v_cmp_gt_u32 vcc, s36, v6
s_nop 1
v_cndmask_b32 v11, v12, v11, vcc
s_mul_i32 s42, s34, 18432
s_add_u32 s42, s42, 0
s_add_u32 s42, s42, s35
buffer_load_ushort v60, v11, s[44:47], s42 offen nt
s_mul_i32 s42, s34, 18432
s_add_u32 s42, s42, 1152
s_add_u32 s42, s42, s35
buffer_load_ushort v61, v11, s[44:47], s42 offen nt
s_mul_i32 s42, s34, 36864
s_add_u32 s42, s42, 2304
s_add_u32 s42, s42, s35
buffer_load_ushort v62, v11, s[44:47], s42 offen nt
s_mul_i32 s42, s34, 36864
s_add_u32 s42, s42, 3456
s_add_u32 s42, s42, s35
buffer_load_ushort v63, v11, s[44:47], s42 offen nt
s_mul_i32 s42, s34, 39168
s_add_u32 s42, s42, 20736
s_add_u32 s42, s42, s35
buffer_load_ushort v64, v11, s[44:47], s42 offen nt
s_mul_i32 s42, s34, 39168
s_add_u32 s42, s42, 21888
s_add_u32 s42, s42, s35
buffer_load_ushort v65, v11, s[44:47], s42 offen nt
s_mul_i32 s42, s34, 57600
s_add_u32 s42, s42, 23040
s_add_u32 s42, s42, s35
buffer_load_ushort v66, v11, s[44:47], s42 offen nt
s_mul_i32 s42, s34, 57600
s_add_u32 s42, s42, 24192
s_add_u32 s42, s42, s35
buffer_load_ushort v67, v11, s[44:47], s42 offen nt
s_add_u32 s42, s40, 2
s_mul_i32 s43, s42, 13108
s_lshr_b32 s43, s43, 16
s_mul_i32 s35, s43, 5
s_sub_u32 s42, s42, s35
s_lshr_b32 s35, s42, 1
s_lshl_b32 s35, s35, 5
s_and_b32 s36, s42, 1
s_lshl_b32 s36, s36, 2
s_add_u32 s35, s35, s36
s_add_u32 s35, s35, s41
s_cmp_eq_u32 s42, 4
s_cselect_b64 vcc, -1, 0
s_cselect_b32 s36, 8, 16
v_cndmask_b32 v11, v9, v6, vcc
v_add_u32 v11, s35, v11
s_mul_i32 s35, s43, 41472
s_sub_u32 s37, s43, 16
s_mul_i32 s37, s37, 331776
s_cmp_lt_u32 s43, 16
s_cselect_b32 s35, s35, s37
s_cselect_b32 s37, 4, 72
s_cselect_b32 s34, 0, 1
s_mul_i32 s37, s37, 1152
v_mul_lo_u32 v10, s37, v7
v_lshl_add_u32 v11, v11, 1, v10
v_cmp_gt_u32 vcc, s36, v6
s_nop 1
v_cndmask_b32 v11, v12, v11, vcc
s_mul_i32 s42, s34, 18432
s_add_u32 s42, s42, 0
s_add_u32 s42, s42, s35
buffer_load_ushort v68, v11, s[44:47], s42 offen nt
s_mul_i32 s42, s34, 18432
s_add_u32 s42, s42, 1152
s_add_u32 s42, s42, s35
buffer_load_ushort v69, v11, s[44:47], s42 offen nt
s_mul_i32 s42, s34, 36864
s_add_u32 s42, s42, 2304
s_add_u32 s42, s42, s35
buffer_load_ushort v70, v11, s[44:47], s42 offen nt
s_mul_i32 s42, s34, 36864
s_add_u32 s42, s42, 3456
s_add_u32 s42, s42, s35
buffer_load_ushort v71, v11, s[44:47], s42 offen nt
s_mul_i32 s42, s34, 39168
s_add_u32 s42, s42, 20736
s_add_u32 s42, s42, s35
buffer_load_ushort v72, v11, s[44:47], s42 offen nt
s_mul_i32 s42, s34, 39168
s_add_u32 s42, s42, 21888
s_add_u32 s42, s42, s35
buffer_load_ushort v73, v11, s[44:47], s42 offen nt
s_mul_i32 s42, s34, 57600
s_add_u32 s42, s42, 23040
s_add_u32 s42, s42, s35
buffer_load_ushort v74, v11, s[44:47], s42 offen nt
s_mul_i32 s42, s34, 57600
s_add_u32 s42, s42, 24192
s_add_u32 s42, s42, s35
buffer_load_ushort v75, v11, s[44:47], s42 offen nt
L_g_done:
s_cmp_ge_u32 s2, 144
s_cbranch_scc1 L_l1_d
s_mul_i32 s40, s2, 911
s_lshr_b32 s40, s40, 16
s_mul_i32 s41, s40, 72
s_sub_u32 s41, s2, s41
s_cmp_eq_u32 s40, 0
s_cselect_b64 s[12:13], s[64:65], s[66:67]
s_mov_b32 s48, s12
s_and_b32 s49, s13, 0xffff
s_mov_b32 s50, 5308416
s_mov_b32 s51, 0x20000
s_lshl_b32 s42, s41, 7
v_lshlrev_b32 v9, 3, v6
v_mul_u32_u24 v10, 73728, v7
v_add3_u32 v254, v9, v10, s42
s_bitcmp1_b32 s4, 0
s_cselect_b64 vcc, -1, 0
v_cndmask_b32 v255, v254, v12, vcc
s_mul_i32 s43, s4, 9
s_add_u32 s43, s43, 1
s_lshr_b32 s43, s43, 1
s_mul_i32 s53, s43, 294912
buffer_load_dwordx2 v[76:77], v254, s[48:51], s53 offen nt
s_add_u32 s53, s53, 9216
buffer_load_dwordx2 v[78:79], v254, s[48:51], s53 offen nt
s_add_u32 s53, s53, 9216
buffer_load_dwordx2 v[80:81], v254, s[48:51], s53 offen nt
s_add_u32 s53, s53, 9216
buffer_load_dwordx2 v[82:83], v254, s[48:51], s53 offen nt
s_add_u32 s53, s53, 9216
buffer_load_dwordx2 v[84:85], v254, s[48:51], s53 offen nt
s_add_u32 s53, s53, 9216
buffer_load_dwordx2 v[86:87], v254, s[48:51], s53 offen nt
s_add_u32 s53, s53, 9216
buffer_load_dwordx2 v[88:89], v254, s[48:51], s53 offen nt
s_add_u32 s53, s53, 9216
buffer_load_dwordx2 v[90:91], v254, s[48:51], s53 offen nt
s_add_u32 s53, s53, 230400
buffer_load_dwordx2 v[92:93], v254, s[48:51], s53 offen nt
s_add_u32 s53, s53, 9216
buffer_load_dwordx2 v[94:95], v254, s[48:51], s53 offen nt
s_add_u32 s53, s53, 9216
buffer_load_dwordx2 v[96:97], v254, s[48:51], s53 offen nt
s_add_u32 s53, s53, 9216
buffer_load_dwordx2 v[98:99], v254, s[48:51], s53 offen nt
s_add_u32 s53, s53, 9216
buffer_load_dwordx2 v[100:101], v254, s[48:51], s53 offen nt
s_add_u32 s53, s53, 9216
buffer_load_dwordx2 v[102:103], v254, s[48:51], s53 offen nt
s_add_u32 s53, s53, 9216
buffer_load_dwordx2 v[104:105], v254, s[48:51], s53 offen nt
s_add_u32 s53, s53, 9216
s_mul_i32 s42, s41, 7282
s_lshr_b32 s42, s42, 16
s_mul_i32 s35, s42, 9
s_sub_u32 s41, s41, s35
s_lshl_b32 s41, s41, 2
s_lshl_b32 s42, s42, 2
s_lshl_b32 s40, s40, 11
s_add_u32 s40, s40, 7303168
s_mov_b32 s35, 497664
v_and_b32 v6, 3, v1
v_add_u32 v6, s41, v6
v_mul_u32_u24 v7, 57, v6
v_lshrrev_b32 v7, 9, v7
v_mul_u32_u24 v8, 9, v7
v_sub_u32 v6, v6, v8
v_add_u32 v8, 1, v6
v_cmp_eq_u32 vcc, 9, v8
s_nop 1
v_cndmask_b32 v8, v8, 0, vcc
v_and_b32 v9, 1, v7
v_cmp_eq_u32 vcc, 0, v9
s_nop 1
v_cndmask_b32 v6, v6, v8, vcc
v_add_u32 v7, s42, v7
v_mul_lo_u32 v7, v7, s35
v_add_u32 v7, s40, v7
v_lshrrev_b32 v8, 2, v1
v_add_u32 v8, s43, v8
v_and_b32 v9, 1, v8
v_lshl_add_u32 v7, v9, 10, v7
v_lshrrev_b32 v9, 1, v8
v_lshlrev_b32 v9, 12, v9
v_add_u32 v7, v7, v9
v_lshl_add_u32 v9, v6, 12, v9
v_mul_u32_u24 v10, 36864, v6
v_cmp_gt_u32 vcc, 2, v6
s_nop 1
v_cndmask_b32 v9, v10, v9, vcc
v_add_u32 v7, v7, v9
v_cmp_gt_u32 vcc, 18, v8
s_nop 1
v_cndmask_b32 v7, v12, v7, vcc
s_bitcmp1_b32 s4, 0
s_cselect_b32 s41, 16, 20
v_cmp_gt_u32 vcc, s41, v1
s_nop 1
v_cndmask_b32 v7, v12, v7, vcc
s_nop 0
v_readlane_b32 s40, v7, 0
v_readlane_b32 s41, v7, 1
v_readlane_b32 s42, v7, 2
v_readlane_b32 s43, v7, 3
v_add_u32 v156, s40, v2
v_add_u32 v157, s41, v2
v_add_u32 v158, s42, v2
v_add_u32 v159, s43, v2
v_readlane_b32 s40, v7, 4
v_readlane_b32 s41, v7, 5
v_readlane_b32 s42, v7, 6
v_readlane_b32 s43, v7, 7
v_add_u32 v160, s40, v2
v_add_u32 v161, s41, v2
v_add_u32 v162, s42, v2
v_add_u32 v163, s43, v2
v_readlane_b32 s40, v7, 8
v_readlane_b32 s41, v7, 9
v_readlane_b32 s42, v7, 10
v_readlane_b32 s43, v7, 11
v_add_u32 v164, s40, v2
v_add_u32 v165, s41, v2
v_add_u32 v166, s42, v2
v_add_u32 v167, s43, v2
v_readlane_b32 s40, v7, 12
v_readlane_b32 s41, v7, 13
v_readlane_b32 s42, v7, 14
v_readlane_b32 s43, v7, 15
v_add_u32 v168, s40, v2
v_add_u32 v169, s41, v2
v_add_u32 v170, s42, v2
v_add_u32 v171, s43, v2
v_readlane_b32 s40, v7, 16
v_readlane_b32 s41, v7, 17
v_readlane_b32 s42, v7, 18
v_readlane_b32 s43, v7, 19
v_add_u32 v172, s40, v2
v_add_u32 v173, s41, v2
v_add_u32 v174, s42, v2
v_add_u32 v175, s43, v2
s_waitcnt vmcnt(39)
s_branch L_l1_e
L_l1_d:
s_cmp_ge_u32 s2, 216
s_cbranch_scc1 L_l1_n
s_mov_b32 s48, s62
s_and_b32 s49, s63, 0xffff
s_mov_b32 s50, 5308416
s_mov_b32 s51, 0x20000
s_sub_u32 s40, s2, 144
s_mul_i32 s53, s40, 73728
s_lshl_b32 s41, s4, 8
s_lshl_b32 s42, s4, 5
v_mul_u32_u24 v10, 18432, v7
v_lshl_add_u32 v9, v6, 3, v10
v_add_u32 v254, s41, v9
v_lshl_add_u32 v9, v6, 1, v10
v_add_u32 v255, s42, v9
s_add_u32 s43, s53, 0
buffer_load_dwordx2 v[76:77], v254, s[48:51], s43 offen offset:0 nt
buffer_load_dwordx2 v[92:93], v254, s[48:51], s43 offen offset:128 nt
buffer_load_ushort v108, v255, s[48:51], s43 offen offset:1024 nt
s_add_u32 s43, s53, 4608
buffer_load_dwordx2 v[78:79], v254, s[48:51], s43 offen offset:0 nt
buffer_load_dwordx2 v[94:95], v254, s[48:51], s43 offen offset:128 nt
buffer_load_ushort v109, v255, s[48:51], s43 offen offset:1024 nt
s_add_u32 s43, s53, 9216
buffer_load_dwordx2 v[80:81], v254, s[48:51], s43 offen offset:0 nt
buffer_load_dwordx2 v[96:97], v254, s[48:51], s43 offen offset:128 nt
buffer_load_ushort v110, v255, s[48:51], s43 offen offset:1024 nt
s_add_u32 s43, s53, 13824
buffer_load_dwordx2 v[82:83], v254, s[48:51], s43 offen offset:0 nt
buffer_load_dwordx2 v[98:99], v254, s[48:51], s43 offen offset:128 nt
buffer_load_ushort v111, v255, s[48:51], s43 offen offset:1024 nt
s_add_u32 s43, s53, 1152
buffer_load_dwordx2 v[84:85], v254, s[48:51], s43 offen offset:0 nt
buffer_load_dwordx2 v[100:101], v254, s[48:51], s43 offen offset:128 nt
buffer_load_ushort v112, v255, s[48:51], s43 offen offset:1024 nt
s_mul_i32 s41, s40, 7282
s_lshr_b32 s41, s41, 16
s_mul_i32 s42, s41, 9
s_sub_u32 s40, s40, s42
s_lshl_b32 s40, s40, 1
s_lshl_b32 s41, s41, 2
s_add_u32 s41, s41, s4
s_mul_i32 s41, s41, 497664
s_add_u32 s41, s41, 7634944
v_cmp_lt_u32 vcc, 8, v1
s_nop 1
v_cndmask_b32 v6, 0, 1, vcc
v_mul_u32_u24 v7, 9, v6
v_sub_u32 v7, v1, v7
v_add_u32 v6, s40, v6
v_mov_b32 v8, 0
v_cmp_lt_u32 vcc, 4, v6
s_nop 1
v_addc_co_u32 v8, vcc, 0, v8, vcc
v_cmp_lt_u32 vcc, 8, v6
s_nop 1
v_addc_co_u32 v8, vcc, 0, v8, vcc
v_cmp_lt_u32 vcc, 13, v6
s_nop 1
v_addc_co_u32 v8, vcc, 0, v8, vcc
v_mul_u32_u24 v9, 9, v8
v_add_u32 v9, 1, v9
v_lshrrev_b32 v9, 1, v9
v_sub_u32 v9, v6, v9
v_subrev_u32 v8, s4, v8
v_and_b32 v8, 3, v8
v_mul_u32_u24 v10, 3, v9
v_add3_u32 v10, v10, v8, 2
v_add_u32 v11, 3, v10
v_cmp_lt_u32 vcc, 1, v9
s_nop 1
v_cndmask_b32 v10, v10, v11, vcc
v_cmp_eq_u32 vcc, 3, v9
s_nop 1
v_cndmask_b32 v9, v9, 11, vcc
v_cmp_eq_u32 vcc, 0, v8
s_nop 1
v_cndmask_b32 v10, v10, v9, vcc
v_cmp_eq_u32 vcc, 4, v6
s_nop 1
v_cndmask_b32 v10, v10, 9, vcc
v_cmp_eq_u32 vcc, 13, v6
s_nop 1
v_cndmask_b32 v10, v10, 10, vcc
v_and_b32 v6, 30, v10
v_and_b32 v8, 1, v10
v_lshl_add_u32 v8, v7, 1, v8
v_mad_u32_u24 v9, v6, 9, v8
v_lshl_add_u32 v11, v6, 3, v8
v_add_u32 v11, 10, v11
v_lshl_add_u32 v6, v7, 2, v10
v_add_u32 v6, 108, v6
v_cmp_gt_u32 vcc, 14, v10
s_nop 1
v_cndmask_b32 v11, v6, v11, vcc
v_add_u32 v6, 144, v10
v_cmp_eq_u32 vcc, 8, v7
s_nop 1
v_cndmask_b32 v11, v11, v6, vcc
v_cmp_gt_u32 vcc, 10, v10
s_nop 1
v_cndmask_b32 v9, v11, v9, vcc
v_lshlrev_b32 v9, 10, v9
v_add_u32 v9, s41, v9
v_cmp_gt_u32 vcc, 18, v1
s_nop 1
v_cndmask_b32 v9, v12, v9, vcc
s_nop 0
v_readlane_b32 s40, v9, 0
v_readlane_b32 s41, v9, 1
v_readlane_b32 s42, v9, 2
v_readlane_b32 s43, v9, 3
v_add_u32 v156, s40, v2
v_add_u32 v157, s41, v2
v_add_u32 v158, s42, v2
v_add_u32 v159, s43, v2
v_readlane_b32 s40, v9, 4
v_readlane_b32 s41, v9, 5
v_readlane_b32 s42, v9, 6
v_readlane_b32 s43, v9, 7
v_add_u32 v160, s40, v2
v_add_u32 v161, s41, v2
v_add_u32 v162, s42, v2
v_add_u32 v163, s43, v2
v_readlane_b32 s40, v9, 8
v_readlane_b32 s41, v9, 9
v_readlane_b32 s42, v9, 10
v_readlane_b32 s43, v9, 11
v_add_u32 v164, s40, v2
v_add_u32 v165, s41, v2
v_add_u32 v166, s42, v2
v_add_u32 v167, s43, v2
v_readlane_b32 s40, v9, 12
v_readlane_b32 s41, v9, 13
v_readlane_b32 s42, v9, 14
v_readlane_b32 s43, v9, 15
v_add_u32 v168, s40, v2
v_add_u32 v169, s41, v2
v_add_u32 v170, s42, v2
v_add_u32 v171, s43, v2
v_readlane_b32 s40, v9, 16
v_readlane_b32 s41, v9, 17
v_readlane_b32 s42, v9, 18
v_readlane_b32 s43, v9, 19
v_add_u32 v172, s40, v2
v_add_u32 v173, s41, v2
v_add_u32 v174, s42, v2
v_add_u32 v175, s43, v2
s_waitcnt vmcnt(39)
s_branch L_l1_e
L_l1_n:
v_mov_b32 v156, v12
v_mov_b32 v157, v12
v_mov_b32 v158, v12
v_mov_b32 v159, v12
v_mov_b32 v160, v12
v_mov_b32 v161, v12
v_mov_b32 v162, v12
v_mov_b32 v163, v12
v_mov_b32 v164, v12
v_mov_b32 v165, v12
v_mov_b32 v166, v12
v_mov_b32 v167, v12
v_mov_b32 v168, v12
v_mov_b32 v169, v12
v_mov_b32 v170, v12
v_mov_b32 v171, v12
v_mov_b32 v172, v12
v_mov_b32 v173, v12
v_mov_b32 v174, v12
v_mov_b32 v175, v12
s_waitcnt vmcnt(24)
L_l1_e:
v_readfirstlane_b32 s40, v14
v_readfirstlane_b32 s41, v15
s_add_u32 s68, s40, 1
s_addc_u32 s69, s41, 0
v_lshlrev_b32 v28, 16, v16
v_and_b32 v29, 0xffff0000, v16
v_lshlrev_b32 v30, 16, v17
v_and_b32 v31, 0xffff0000, v17
v_lshlrev_b32 v32, 16, v18
v_and_b32 v33, 0xffff0000, v18
v_lshlrev_b32 v34, 16, v19
v_and_b32 v35, 0xffff0000, v19
v_lshlrev_b32 v36, 16, v20
v_and_b32 v37, 0xffff0000, v20
v_lshlrev_b32 v38, 16, v21
v_and_b32 v39, 0xffff0000, v21
v_lshlrev_b32 v40, 16, v22
v_and_b32 v41, 0xffff0000, v22
v_lshlrev_b32 v42, 16, v23
v_and_b32 v43, 0xffff0000, v23
v_lshlrev_b32 v44, 16, v24
v_and_b32 v45, 0xffff0000, v24
v_lshlrev_b32 v46, 16, v25
v_and_b32 v47, 0xffff0000, v25
v_lshlrev_b32 v48, 16, v26
v_and_b32 v49, 0xffff0000, v26
v_lshlrev_b32 v50, 16, v27
v_and_b32 v51, 0xffff0000, v27
s_add_u32 s24, s20, 27979776
s_add_u32 s25, s24, 4096
buffer_store_dwordx4 v[16:19], v4, s[8:11], s24 offen offset:0 sc1
buffer_store_dwordx4 v[20:23], v4, s[8:11], s24 offen offset:2048 sc1
buffer_store_dwordx4 v[24:27], v4, s[8:11], s25 offen offset:0 sc1
v_add_f32 v6, v28, v29
v_mul_f32 v7, v28, v28
v_mul_f32 v9, v29, v29
v_mov_b32 v8, 0
v_add_f32 v6, v6, v30
v_add_f32 v8, v8, v31
v_fmac_f32 v7, v30, v30
v_fmac_f32 v9, v31, v31
v_add_f32 v6, v6, v32
v_add_f32 v8, v8, v33
v_fmac_f32 v7, v32, v32
v_fmac_f32 v9, v33, v33
v_add_f32 v6, v6, v34
v_add_f32 v8, v8, v35
v_fmac_f32 v7, v34, v34
v_fmac_f32 v9, v35, v35
v_add_f32 v6, v6, v36
v_add_f32 v8, v8, v37
v_fmac_f32 v7, v36, v36
v_fmac_f32 v9, v37, v37
v_add_f32 v6, v6, v38
v_add_f32 v8, v8, v39
v_fmac_f32 v7, v38, v38
v_fmac_f32 v9, v39, v39
v_add_f32 v6, v6, v40
v_add_f32 v8, v8, v41
v_fmac_f32 v7, v40, v40
v_fmac_f32 v9, v41, v41
v_add_f32 v6, v6, v42
v_add_f32 v8, v8, v43
v_fmac_f32 v7, v42, v42
v_fmac_f32 v9, v43, v43
v_add_f32 v6, v6, v44
v_add_f32 v8, v8, v45
v_fmac_f32 v7, v44, v44
v_fmac_f32 v9, v45, v45
v_add_f32 v6, v6, v46
v_add_f32 v8, v8, v47
v_fmac_f32 v7, v46, v46
v_fmac_f32 v9, v47, v47
v_add_f32 v6, v6, v48
v_add_f32 v8, v8, v49
v_fmac_f32 v7, v48, v48
v_fmac_f32 v9, v49, v49
v_add_f32 v6, v6, v50
v_add_f32 v8, v8, v51
v_fmac_f32 v7, v50, v50
v_fmac_f32 v9, v51, v51
v_add_f32 v6, v6, v8
v_add_f32 v7, v7, v9
s_nop 0
v_add_f32_dpp v6, v6, v6 row_ror:8 row_mask:0xf bank_mask:0xf
v_add_f32_dpp v7, v7, v7 row_ror:8 row_mask:0xf bank_mask:0xf
v_mov_b32 v8, v6
v_mov_b32 v9, v7
s_nop 0
v_permlane16_swap_b32 v6, v8
v_permlane16_swap_b32 v7, v9
v_add_f32 v6, v6, v8
v_add_f32 v7, v7, v9
v_mov_b32 v8, v6
v_mov_b32 v9, v7
s_nop 0
v_permlane32_swap_b32 v6, v8
v_permlane32_swap_b32 v7, v9
v_add_f32 v6, v6, v8
v_add_f32 v7, v7, v9
v_and_b32 v10, 7, v1
v_lshlrev_b32 v10, 3, v10
v_add_u32 v10, 147456, v10
s_lshl_b32 s24, s4, 6
v_add_u32 v11, s24, v10
ds_write_b64 v11, v[6:7]
s_waitcnt lgkmcnt(0)
s_barrier
ds_read_b64 v[6:7], v10
ds_read_b64 v[8:9], v10 offset:64
ds_read_b64 v[12:13], v10 offset:128
s_waitcnt lgkmcnt(0)
v_add_f32 v6, v6, v8
v_add_f32 v7, v7, v9
v_add_f32 v6, v6, v12
v_add_f32 v7, v7, v13
v_mul_f32 v6, 0x3ae38e39, v6
v_mul_f32 v7, 0x3ae38e39, v7
v_fma_f32 v7, -v6, v6, v7
v_max_f32 v7, 0, v7
v_add_f32 v7, 0x3727c5ac, v7
v_rsq_f32 v7, v7
s_nop 0
v_mul_f32 v6, v6, v7
v_fma_f32 v28, v28, v7, -v6
v_fma_f32 v29, v29, v7, -v6
v_fma_f32 v30, v30, v7, -v6
v_fma_f32 v31, v31, v7, -v6
v_fma_f32 v32, v32, v7, -v6
v_fma_f32 v33, v33, v7, -v6
v_fma_f32 v34, v34, v7, -v6
v_fma_f32 v35, v35, v7, -v6
v_fma_f32 v36, v36, v7, -v6
v_fma_f32 v37, v37, v7, -v6
v_fma_f32 v38, v38, v7, -v6
v_fma_f32 v39, v39, v7, -v6
v_fma_f32 v40, v40, v7, -v6
v_fma_f32 v41, v41, v7, -v6
v_fma_f32 v42, v42, v7, -v6
v_fma_f32 v43, v43, v7, -v6
v_fma_f32 v44, v44, v7, -v6
v_fma_f32 v45, v45, v7, -v6
v_fma_f32 v46, v46, v7, -v6
v_fma_f32 v47, v47, v7, -v6
v_fma_f32 v48, v48, v7, -v6
v_fma_f32 v49, v49, v7, -v6
v_fma_f32 v50, v50, v7, -v6
v_fma_f32 v51, v51, v7, -v6
v_cvt_pk_bf16_f32 v16, v28, v29
v_cvt_pk_bf16_f32 v17, v30, v31
v_cvt_pk_bf16_f32 v18, v32, v33
v_cvt_pk_bf16_f32 v19, v34, v35
v_cvt_pk_bf16_f32 v20, v36, v37
v_cvt_pk_bf16_f32 v21, v38, v39
v_cvt_pk_bf16_f32 v22, v40, v41
v_cvt_pk_bf16_f32 v23, v42, v43
v_cvt_pk_bf16_f32 v24, v44, v45
v_cvt_pk_bf16_f32 v25, v46, v47
v_cvt_pk_bf16_f32 v26, v48, v49
v_cvt_pk_bf16_f32 v27, v50, v51
s_add_u32 s24, s20, 23261184
s_add_u32 s25, s24, 4096
buffer_store_dwordx4 v[16:19], v4, s[8:11], s24 offen offset:0 sc1
buffer_store_dwordx4 v[20:23], v4, s[8:11], s24 offen offset:2048 sc1
buffer_store_dwordx4 v[24:27], v4, s[8:11], s25 offen offset:0 sc1
s_lshl_b32 s24, s5, 4
s_lshr_b32 s25, s6, 1
s_add_u32 s24, s24, s25
s_lshl_b32 s24, s24, 3
s_and_b32 s25, s6, 1
s_mul_i32 s25, s25, 3
s_add_u32 s24, s24, s25
s_add_u32 s24, s24, s4
s_lshl_b32 s24, s24, 7
s_add_u32 s24, s24, 786432
s_cmp_eq_u32 s4, 3
s_cselect_b32 s24, 2146435072, s24
s_waitcnt vmcnt(6)
v_lshl_or_b32 v52, v53, 16, v52
v_lshl_or_b32 v53, v55, 16, v54
v_lshl_or_b32 v54, v57, 16, v56
v_lshl_or_b32 v55, v59, 16, v58
buffer_store_dwordx4 v[52:55], v2, s[8:11], s38 offen offset:0 sc1
v_lshl_or_b32 v60, v61, 16, v60
v_lshl_or_b32 v61, v63, 16, v62
v_lshl_or_b32 v62, v65, 16, v64
v_lshl_or_b32 v63, v67, 16, v66
buffer_store_dwordx4 v[60:63], v2, s[8:11], s38 offen offset:1024 sc1
v_lshl_or_b32 v68, v69, 16, v68
v_lshl_or_b32 v69, v71, 16, v70
v_lshl_or_b32 v70, v73, 16, v72
v_lshl_or_b32 v71, v75, 16, v74
buffer_store_dwordx4 v[68:71], v2, s[8:11], s38 offen offset:2048 sc1
v_mov_b32 v13, 2146435072
v_cmp_eq_u32 vcc, 0, v1
v_mov_b32 v14, s68
v_mov_b32 v15, s69
v_cndmask_b32 v13, v13, 0, vcc
s_waitcnt vmcnt(0)
buffer_store_dwordx2 v[14:15], v13, s[8:11], s24 offen sc1
buffer_store_dwordx2 v[14:15], v13, s[8:11], s39 offen sc1
s_mov_b32 s44, s26
s_and_b32 s45, s27, 0xffff
s_mov_b32 s46, 256
s_mov_b32 s47, 0x20000
s_cmp_eq_u32 s4, 0
s_cselect_b32 s40, 0, 4096
v_mov_b32 v3, 1
buffer_atomic_add v3, v13, s[44:47], s40 offen sc1
s_cmp_ge_u32 s2, 144
s_cbranch_scc1 L_l2_d
buffer_load_dwordx2 v[106:107], v254, s[48:51], s53 offen nt
s_add_u32 s53, s53, 230400
buffer_load_dwordx2 v[108:109], v254, s[48:51], s53 offen nt
s_add_u32 s53, s53, 9216
buffer_load_dwordx2 v[110:111], v254, s[48:51], s53 offen nt
s_add_u32 s53, s53, 9216
buffer_load_dwordx2 v[112:113], v254, s[48:51], s53 offen nt
s_add_u32 s53, s53, 9216
buffer_load_dwordx2 v[114:115], v254, s[48:51], s53 offen nt
s_add_u32 s53, s53, 9216
buffer_load_dwordx2 v[116:117], v254, s[48:51], s53 offen nt
s_add_u32 s53, s53, 9216
buffer_load_dwordx2 v[118:119], v254, s[48:51], s53 offen nt
s_add_u32 s53, s53, 9216
buffer_load_dwordx2 v[120:121], v254, s[48:51], s53 offen nt
s_add_u32 s53, s53, 9216
buffer_load_dwordx2 v[122:123], v254, s[48:51], s53 offen nt
s_add_u32 s53, s53, 230400
buffer_load_dwordx2 v[124:125], v254, s[48:51], s53 offen nt
s_add_u32 s53, s53, 9216
buffer_load_dwordx2 v[126:127], v254, s[48:51], s53 offen nt
s_add_u32 s53, s53, 9216
buffer_load_dwordx2 v[128:129], v254, s[48:51], s53 offen nt
s_add_u32 s53, s53, 9216
buffer_load_dwordx2 v[130:131], v254, s[48:51], s53 offen nt
s_add_u32 s53, s53, 9216
buffer_load_dwordx2 v[132:133], v254, s[48:51], s53 offen nt
s_add_u32 s53, s53, 9216
buffer_load_dwordx2 v[134:135], v254, s[48:51], s53 offen nt
s_add_u32 s53, s53, 9216
buffer_load_dwordx2 v[136:137], v254, s[48:51], s53 offen nt
s_add_u32 s53, s53, 9216
buffer_load_dwordx2 v[138:139], v254, s[48:51], s53 offen nt
s_add_u32 s53, s53, 230400
buffer_load_dwordx2 v[140:141], v255, s[48:51], s53 offen nt
s_add_u32 s53, s53, 9216
buffer_load_dwordx2 v[142:143], v255, s[48:51], s53 offen nt
s_add_u32 s53, s53, 9216
buffer_load_dwordx2 v[144:145], v255, s[48:51], s53 offen nt
s_add_u32 s53, s53, 9216
buffer_load_dwordx2 v[146:147], v255, s[48:51], s53 offen nt
s_add_u32 s53, s53, 9216
buffer_load_dwordx2 v[148:149], v255, s[48:51], s53 offen nt
s_add_u32 s53, s53, 9216
buffer_load_dwordx2 v[150:151], v255, s[48:51], s53 offen nt
s_add_u32 s53, s53, 9216
buffer_load_dwordx2 v[152:153], v255, s[48:51], s53 offen nt
s_add_u32 s53, s53, 9216
buffer_load_dwordx2 v[154:155], v255, s[48:51], s53 offen nt
s_add_u32 s53, s53, 230400
s_branch L_l2_e
L_l2_d:
s_cmp_ge_u32 s2, 216
s_cbranch_scc1 L_l2_n
s_add_u32 s43, s53, 5760
buffer_load_dwordx2 v[86:87], v254, s[48:51], s43 offen offset:0 nt
buffer_load_dwordx2 v[102:103], v254, s[48:51], s43 offen offset:128 nt
buffer_load_ushort v113, v255, s[48:51], s43 offen offset:1024 nt
s_add_u32 s43, s53, 10368
buffer_load_dwordx2 v[88:89], v254, s[48:51], s43 offen offset:0 nt
buffer_load_dwordx2 v[104:105], v254, s[48:51], s43 offen offset:128 nt
buffer_load_ushort v114, v255, s[48:51], s43 offen offset:1024 nt
s_add_u32 s43, s53, 14976
buffer_load_dwordx2 v[90:91], v254, s[48:51], s43 offen offset:0 nt
buffer_load_dwordx2 v[106:107], v254, s[48:51], s43 offen offset:128 nt
buffer_load_ushort v115, v255, s[48:51], s43 offen offset:1024 nt
s_add_u32 s43, s53, 2304
buffer_load_dwordx2 v[116:117], v254, s[48:51], s43 offen offset:0 nt
buffer_load_dwordx2 v[132:133], v254, s[48:51], s43 offen offset:128 nt
buffer_load_ushort v148, v255, s[48:51], s43 offen offset:1024 nt
s_add_u32 s43, s53, 6912
buffer_load_dwordx2 v[118:119], v254, s[48:51], s43 offen offset:0 nt
buffer_load_dwordx2 v[134:135], v254, s[48:51], s43 offen offset:128 nt
buffer_load_ushort v149, v255, s[48:51], s43 offen offset:1024 nt
s_add_u32 s43, s53, 11520
buffer_load_dwordx2 v[120:121], v254, s[48:51], s43 offen offset:0 nt
buffer_load_dwordx2 v[136:137], v254, s[48:51], s43 offen offset:128 nt
buffer_load_ushort v150, v255, s[48:51], s43 offen offset:1024 nt
s_add_u32 s43, s53, 16128
buffer_load_dwordx2 v[122:123], v254, s[48:51], s43 offen offset:0 nt
buffer_load_dwordx2 v[138:139], v254, s[48:51], s43 offen offset:128 nt
buffer_load_ushort v151, v255, s[48:51], s43 offen offset:1024 nt
s_add_u32 s43, s53, 3456
buffer_load_dwordx2 v[124:125], v254, s[48:51], s43 offen offset:0 nt
buffer_load_dwordx2 v[140:141], v254, s[48:51], s43 offen offset:128 nt
buffer_load_ushort v152, v255, s[48:51], s43 offen offset:1024 nt
s_add_u32 s43, s53, 8064
buffer_load_dwordx2 v[126:127], v254, s[48:51], s43 offen offset:0 nt
buffer_load_dwordx2 v[142:143], v254, s[48:51], s43 offen offset:128 nt
buffer_load_ushort v153, v255, s[48:51], s43 offen offset:1024 nt
s_add_u32 s43, s53, 12672
buffer_load_dwordx2 v[128:129], v254, s[48:51], s43 offen offset:0 nt
buffer_load_dwordx2 v[144:145], v254, s[48:51], s43 offen offset:128 nt
buffer_load_ushort v154, v255, s[48:51], s43 offen offset:1024 nt
s_add_u32 s43, s53, 17280
buffer_load_dwordx2 v[130:131], v254, s[48:51], s43 offen offset:0 nt
buffer_load_dwordx2 v[146:147], v254, s[48:51], s43 offen offset:128 nt
buffer_load_ushort v155, v255, s[48:51], s43 offen offset:1024 nt
L_l2_n:
L_l2_e:
s_mov_b32 s70, 23261184
s_mov_b32 s71, 27979776
s_mov_b32 s72, 32698368
s_mov_b32 s73, 37416960
s_mov_b32 s74, 42135552
s_mov_b32 s75, 42397696
s_mov_b32 s76, 80146432
s_mov_b32 s77, 0
s_mov_b32 s7, 0
s_lshr_b32 s20, s5, 2
s_lshl_b32 s20, s20, 3
s_lshr_b32 s21, s6, 2
s_add_u32 s20, s20, s21
s_and_b32 s21, s5, 3
s_lshl_b32 s21, s21, 2
s_and_b32 s22, s6, 3
s_add_u32 s21, s21, s22
s_lshl_b32 s24, s20, 3
s_sub_u32 s25, s24, 1
s_max_i32 s35, s25, 0
s_mul_i32 s25, s35, 18432
s_lshl_b32 s26, s4, 1
s_add_u32 s36, s24, s26
s_mul_i32 s24, s36, 18432
s_add_u32 s26, s24, s70
s_add_u32 s27, s26, 18432
s_add_u32 s28, s25, s70
v_add_u32 v4, 0x10000, v2
v_add_u32 v5, 0x20000, v2
s_cmp_eq_u32 s4, 3
s_cselect_b32 s29, 0, s4
s_cselect_b32 s31, 16, 9
s_lshl_b32 s30, s29, 10
v_and_b32 v12, 15, v1
v_mov_b32 v13, 2146435072
v_cmp_le_u32 vcc, s31, v12
s_nop 1
v_cndmask_b32 v3, v13, v2, vcc
s_add_u32 s31, s30, 2048
v_add_u32 v6, s31, v2
v_add_u32 v7, s31, v4
v_add_u32 v8, s31, v5
s_add_u32 s31, s30, 5120
v_add_u32 v9, s31, v2
v_add_u32 v10, s31, v4
v_add_u32 v11, s31, v5
v_mul_u32_u24 v14, 43, v1
v_lshrrev_b32 v14, 8, v14
v_mul_u32_u24 v15, 6, v14
v_sub_u32 v15, v1, v15
v_cmp_eq_u32 vcc, 1, v14
v_mov_b32 v16, s36
s_nop 0
v_addc_co_u32 v16, vcc, 0, v16, vcc
v_cmp_eq_u32 vcc, 2, v14
v_mov_b32 v17, s35
s_nop 0
v_cndmask_b32 v16, v16, v17, vcc
v_lshlrev_b32 v16, 3, v16
v_add_lshl_u32 v16, v16, v15, 7
s_add_u32 s22, s77, 786432
s_and_b32 s23, s6, 7
s_lshl_b32 s23, s23, 7
s_add_u32 s23, s23, 64
v_min_u32 v17, 61, v1
v_add_u32 v17, s23, v17
v_lshlrev_b32 v17, 7, v17
v_add_u32 v17, 131072, v17
v_cmp_lt_u32 vcc, 31, v1
s_nop 1
v_cndmask_b32 v16, v16, v17, vcc
s_lshr_b32 s23, s21, 1
s_lshl_b32 s23, s23, 7
s_and_b32 s31, s21, 1
s_mul_i32 s31, s31, 48
s_add_u32 s23, s23, s31
v_min_u32 v17, 47, v1
v_add_u32 v17, s23, v17
v_lshlrev_b32 v17, 7, v17
v_add_u32 v17, 131072, v17
s_mov_b32 s52, 0
L_poll1:
buffer_load_dwordx2 v[14:15], v16, s[8:11], s22 offen sc1
buffer_load_dwordx2 v[18:19], v17, s[8:11], s22 offen sc1
s_add_u32 s52, s52, 1
s_waitcnt vmcnt(0)
v_cmp_ne_u64 vcc, s[68:69], v[14:15]
v_cmp_ne_u64 s[40:41], s[68:69], v[18:19]
s_cmp_ge_u32 s52, 0x100000
s_cbranch_scc1 L_got1
s_or_b64 vcc, vcc, s[40:41]
s_and_b64 exec, exec, vcc
s_cbranch_execnz L_poll1
L_got1:
s_mov_b64 exec, -1
s_lshr_b32 s20, s5, 2
s_lshl_b32 s20, s20, 3
s_lshr_b32 s21, s6, 2
s_add_u32 s20, s20, s21
s_and_b32 s21, s5, 3
s_lshl_b32 s21, s21, 2
s_and_b32 s22, s6, 3
s_add_u32 s21, s21, s22
s_mul_i32 s22, s21, 147456
s_add_u32 s22, s22, 4198400
s_mul_i32 s23, s4, 36864
s_add_u32 s22, s22, s23
s_mov_b32 s34, 0x05040100
s_mov_b32 s33, s35
s_mov_b32 s35, 0x07060302
s_mov_b32 s38, 0x00003f80
s_mov_b32 s39, 0x3f800000
v_mov_b32 v20, 0
v_mov_b32 v21, 0
v_mov_b32 v22, 0
v_mov_b32 v23, 0
s_cmp_ge_u32 s2, 144
s_cbranch_scc1 L_tr_d
v_mov_b32 v68, 0x3f803f80
v_mov_b32 v69, 0x3f803f80
s_add_u32 m0, s23, 0
s_add_u32 s40, s22, 0
buffer_load_dwordx4 v2, s[8:11], s40 offen offset:0 sc1 lds
v_mov_b32 v70, 0x3f803f80
v_mov_b32 v71, 0x3f803f80
v_perm_b32 v176, v78, v76, s34
v_perm_b32 v177, v82, v80, s34
v_perm_b32 v178, v86, v84, s34
v_perm_b32 v179, v90, v88, s34
buffer_load_dwordx4 v2, s[8:11], s40 offen offset:1024 sc1 lds
v_perm_b32 v180, v78, v76, s35
v_perm_b32 v181, v82, v80, s35
v_perm_b32 v182, v86, v84, s35
v_perm_b32 v183, v90, v88, s35
v_perm_b32 v184, v79, v77, s34
v_perm_b32 v185, v83, v81, s34
buffer_load_dwordx4 v2, s[8:11], s40 offen offset:2048 sc1 lds
v_perm_b32 v186, v87, v85, s34
v_perm_b32 v187, v91, v89, s34
v_perm_b32 v188, v79, v77, s35
v_perm_b32 v189, v83, v81, s35
v_perm_b32 v190, v87, v85, s35
v_perm_b32 v191, v91, v89, s35
buffer_load_dwordx4 v2, s[8:11], s40 offen offset:3072 sc1 lds
v_perm_b32 v192, v94, v92, s34
v_perm_b32 v193, v98, v96, s34
v_perm_b32 v194, v102, v100, s34
v_perm_b32 v195, v106, v104, s34
v_perm_b32 v196, v94, v92, s35
v_perm_b32 v197, v98, v96, s35
s_add_u32 m0, s23, 4096
s_add_u32 s40, s22, 4096
buffer_load_dwordx4 v2, s[8:11], s40 offen offset:0 sc1 lds
v_perm_b32 v198, v102, v100, s35
v_perm_b32 v199, v106, v104, s35
v_perm_b32 v200, v95, v93, s34
v_perm_b32 v201, v99, v97, s34
v_perm_b32 v202, v103, v101, s34
v_perm_b32 v203, v107, v105, s34
buffer_load_dwordx4 v2, s[8:11], s40 offen offset:1024 sc1 lds
v_perm_b32 v204, v95, v93, s35
v_perm_b32 v205, v99, v97, s35
v_perm_b32 v206, v103, v101, s35
v_perm_b32 v207, v107, v105, s35
v_perm_b32 v208, v110, v108, s34
v_perm_b32 v209, v114, v112, s34
buffer_load_dwordx4 v2, s[8:11], s40 offen offset:2048 sc1 lds
v_perm_b32 v210, v118, v116, s34
v_perm_b32 v211, v122, v120, s34
v_perm_b32 v212, v110, v108, s35
v_perm_b32 v213, v114, v112, s35
v_perm_b32 v214, v118, v116, s35
v_perm_b32 v215, v122, v120, s35
buffer_load_dwordx4 v2, s[8:11], s40 offen offset:3072 sc1 lds
v_perm_b32 v216, v111, v109, s34
v_perm_b32 v217, v115, v113, s34
v_perm_b32 v218, v119, v117, s34
v_perm_b32 v219, v123, v121, s34
v_perm_b32 v220, v111, v109, s35
v_perm_b32 v221, v115, v113, s35
s_add_u32 m0, s23, 8192
s_add_u32 s40, s22, 8192
buffer_load_dwordx4 v2, s[8:11], s40 offen offset:0 sc1 lds
v_perm_b32 v222, v119, v117, s35
v_perm_b32 v223, v123, v121, s35
v_perm_b32 v224, v126, v124, s34
v_perm_b32 v225, v130, v128, s34
v_perm_b32 v226, v134, v132, s34
v_perm_b32 v227, v138, v136, s34
buffer_load_dwordx4 v2, s[8:11], s40 offen offset:1024 sc1 lds
v_perm_b32 v228, v126, v124, s35
v_perm_b32 v229, v130, v128, s35
v_perm_b32 v230, v134, v132, s35
v_perm_b32 v231, v138, v136, s35
v_perm_b32 v232, v127, v125, s34
v_perm_b32 v233, v131, v129, s34
buffer_load_dwordx4 v2, s[8:11], s40 offen offset:2048 sc1 lds
v_perm_b32 v234, v135, v133, s34
v_perm_b32 v235, v139, v137, s34
v_perm_b32 v236, v127, v125, s35
v_perm_b32 v237, v131, v129, s35
v_perm_b32 v238, v135, v133, s35
v_perm_b32 v239, v139, v137, s35
buffer_load_dwordx4 v2, s[8:11], s40 offen offset:3072 sc1 lds
v_perm_b32 v240, v142, v140, s34
v_perm_b32 v241, v146, v144, s34
v_perm_b32 v242, v150, v148, s34
v_perm_b32 v243, v154, v152, s34
v_perm_b32 v244, v142, v140, s35
v_perm_b32 v245, v146, v144, s35
s_add_u32 m0, s23, 12288
s_add_u32 s40, s22, 12288
buffer_load_dwordx4 v2, s[8:11], s40 offen offset:0 sc1 lds
v_perm_b32 v246, v150, v148, s35
v_perm_b32 v247, v154, v152, s35
v_perm_b32 v248, v143, v141, s34
v_perm_b32 v249, v147, v145, s34
v_perm_b32 v250, v151, v149, s34
v_perm_b32 v251, v155, v153, s34
buffer_load_dwordx4 v2, s[8:11], s40 offen offset:1024 sc1 lds
v_perm_b32 v252, v143, v141, s35
v_perm_b32 v253, v147, v145, s35
v_perm_b32 v254, v151, v149, s35
v_perm_b32 v255, v155, v153, s35
v_mfma_f32_16x16x32_bf16 v[52:55], v[68:71], v[176:179], 0
v_mfma_f32_16x16x32_bf16 v[56:59], v[68:71], v[180:183], 0
buffer_load_dwordx4 v2, s[8:11], s40 offen offset:2048 sc1 lds
v_mfma_f32_16x16x32_bf16 v[60:63], v[68:71], v[184:187], 0
v_mfma_f32_16x16x32_bf16 v[64:67], v[68:71], v[188:191], 0
v_mfma_f32_16x16x32_bf16 v[52:55], v[68:71], v[192:195], v[52:55]
v_mfma_f32_16x16x32_bf16 v[56:59], v[68:71], v[196:199], v[56:59]
v_mfma_f32_16x16x32_bf16 v[60:63], v[68:71], v[200:203], v[60:63]
v_mfma_f32_16x16x32_bf16 v[64:67], v[68:71], v[204:207], v[64:67]
buffer_load_dwordx4 v2, s[8:11], s40 offen offset:3072 sc1 lds
v_mfma_f32_16x16x32_bf16 v[52:55], v[68:71], v[208:211], v[52:55]
v_mfma_f32_16x16x32_bf16 v[56:59], v[68:71], v[212:215], v[56:59]
v_mfma_f32_16x16x32_bf16 v[60:63], v[68:71], v[216:219], v[60:63]
v_mfma_f32_16x16x32_bf16 v[64:67], v[68:71], v[220:223], v[64:67]
v_mfma_f32_16x16x32_bf16 v[52:55], v[68:71], v[224:227], v[52:55]
v_mfma_f32_16x16x32_bf16 v[56:59], v[68:71], v[228:231], v[56:59]
s_add_u32 m0, s23, 16384
s_add_u32 s40, s22, 16384
buffer_load_dwordx4 v2, s[8:11], s40 offen offset:0 sc1 lds
v_mfma_f32_16x16x32_bf16 v[60:63], v[68:71], v[232:235], v[60:63]
v_mfma_f32_16x16x32_bf16 v[64:67], v[68:71], v[236:239], v[64:67]
v_mfma_f32_16x16x32_bf16 v[52:55], v[68:71], v[240:243], v[52:55]
v_mfma_f32_16x16x32_bf16 v[56:59], v[68:71], v[244:247], v[56:59]
v_mfma_f32_16x16x32_bf16 v[60:63], v[68:71], v[248:251], v[60:63]
v_mfma_f32_16x16x32_bf16 v[64:67], v[68:71], v[252:255], v[64:67]
buffer_load_dwordx4 v2, s[8:11], s40 offen offset:1024 sc1 lds
v_and_b32 v72, 15, v1
v_lshlrev_b32 v72, 4, v72
v_add_u32 v72, 148480, v72
s_lshl_b32 s44, s4, 2
v_add_u32 v73, s44, v72
ds_write_b32 v73, v52 offset:0
buffer_load_dwordx4 v2, s[8:11], s40 offen offset:2048 sc1 lds
ds_write_b32 v73, v56 offset:256
ds_write_b32 v73, v60 offset:512
ds_write_b32 v73, v64 offset:768
s_waitcnt lgkmcnt(0)
s_barrier
ds_read_b128 v[52:55], v72 offset:0
buffer_load_dwordx4 v2, s[8:11], s40 offen offset:3072 sc1 lds
ds_read_b128 v[56:59], v72 offset:256
ds_read_b128 v[60:63], v72 offset:512
ds_read_b128 v[64:67], v72 offset:768
s_waitcnt lgkmcnt(0)
v_add_f32 v52, v52, v53
v_add_f32 v54, v54, v55
s_add_u32 m0, s23, 20480
s_add_u32 s40, s22, 20480
buffer_load_dwordx4 v2, s[8:11], s40 offen offset:0 sc1 lds
v_add_f32 v56, v56, v57
v_add_f32 v58, v58, v59
v_add_f32 v60, v60, v61
v_add_f32 v62, v62, v63
v_add_f32 v64, v64, v65
v_add_f32 v66, v66, v67
buffer_load_dwordx4 v2, s[8:11], s40 offen offset:1024 sc1 lds
v_add_f32 v52, v52, v54
v_add_f32 v56, v56, v58
v_add_f32 v60, v60, v62
v_add_f32 v64, v64, v66
v_mul_f32 v20, 0xbae38e39, v52
v_mul_f32 v21, 0xbae38e39, v56
buffer_load_dwordx4 v2, s[8:11], s40 offen offset:2048 sc1 lds
v_mul_f32 v22, 0xbae38e39, v60
v_mul_f32 v23, 0xbae38e39, v64
v_dot2_f32_bf16 v24, v176, s38, v20
v_dot2_f32_bf16 v25, v176, s39, v20
v_dot2_f32_bf16 v26, v177, s38, v20
v_dot2_f32_bf16 v27, v177, s39, v20
buffer_load_dwordx4 v2, s[8:11], s40 offen offset:3072 sc1 lds
v_dot2_f32_bf16 v28, v178, s38, v20
v_dot2_f32_bf16 v29, v178, s39, v20
v_dot2_f32_bf16 v30, v179, s38, v20
v_dot2_f32_bf16 v31, v179, s39, v20
v_cvt_pk_bf16_f32 v176, v24, v25
v_cvt_pk_bf16_f32 v177, v26, v27
s_add_u32 m0, s23, 24576
s_add_u32 s40, s22, 24576
buffer_load_dwordx4 v2, s[8:11], s40 offen offset:0 sc1 lds
v_cvt_pk_bf16_f32 v178, v28, v29
v_cvt_pk_bf16_f32 v179, v30, v31
v_dot2_f32_bf16 v24, v180, s38, v21
v_dot2_f32_bf16 v25, v180, s39, v21
v_dot2_f32_bf16 v26, v181, s38, v21
v_dot2_f32_bf16 v27, v181, s39, v21
buffer_load_dwordx4 v2, s[8:11], s40 offen offset:1024 sc1 lds
v_dot2_f32_bf16 v28, v182, s38, v21
v_dot2_f32_bf16 v29, v182, s39, v21
v_dot2_f32_bf16 v30, v183, s38, v21
v_dot2_f32_bf16 v31, v183, s39, v21
v_cvt_pk_bf16_f32 v180, v24, v25
v_cvt_pk_bf16_f32 v181, v26, v27
buffer_load_dwordx4 v2, s[8:11], s40 offen offset:2048 sc1 lds
v_cvt_pk_bf16_f32 v182, v28, v29
v_cvt_pk_bf16_f32 v183, v30, v31
v_dot2_f32_bf16 v24, v184, s38, v22
v_dot2_f32_bf16 v25, v184, s39, v22
v_dot2_f32_bf16 v26, v185, s38, v22
v_dot2_f32_bf16 v27, v185, s39, v22
buffer_load_dwordx4 v2, s[8:11], s40 offen offset:3072 sc1 lds
v_dot2_f32_bf16 v28, v186, s38, v22
v_dot2_f32_bf16 v29, v186, s39, v22
v_dot2_f32_bf16 v30, v187, s38, v22
v_dot2_f32_bf16 v31, v187, s39, v22
v_cvt_pk_bf16_f32 v184, v24, v25
v_cvt_pk_bf16_f32 v185, v26, v27
s_add_u32 m0, s23, 28672
s_add_u32 s40, s22, 28672
buffer_load_dwordx4 v2, s[8:11], s40 offen offset:0 sc1 lds
v_cvt_pk_bf16_f32 v186, v28, v29
v_cvt_pk_bf16_f32 v187, v30, v31
v_dot2_f32_bf16 v24, v188, s38, v23
v_dot2_f32_bf16 v25, v188, s39, v23
v_dot2_f32_bf16 v26, v189, s38, v23
v_dot2_f32_bf16 v27, v189, s39, v23
buffer_load_dwordx4 v2, s[8:11], s40 offen offset:1024 sc1 lds
v_dot2_f32_bf16 v28, v190, s38, v23
v_dot2_f32_bf16 v29, v190, s39, v23
v_dot2_f32_bf16 v30, v191, s38, v23
v_dot2_f32_bf16 v31, v191, s39, v23
v_cvt_pk_bf16_f32 v188, v24, v25
v_cvt_pk_bf16_f32 v189, v26, v27
buffer_load_dwordx4 v2, s[8:11], s40 offen offset:2048 sc1 lds
v_cvt_pk_bf16_f32 v190, v28, v29
v_cvt_pk_bf16_f32 v191, v30, v31
v_dot2_f32_bf16 v24, v192, s38, v20
v_dot2_f32_bf16 v25, v192, s39, v20
v_dot2_f32_bf16 v26, v193, s38, v20
v_dot2_f32_bf16 v27, v193, s39, v20
buffer_load_dwordx4 v2, s[8:11], s40 offen offset:3072 sc1 lds
v_dot2_f32_bf16 v28, v194, s38, v20
v_dot2_f32_bf16 v29, v194, s39, v20
v_dot2_f32_bf16 v30, v195, s38, v20
v_dot2_f32_bf16 v31, v195, s39, v20
v_cvt_pk_bf16_f32 v192, v24, v25
v_cvt_pk_bf16_f32 v193, v26, v27
s_add_u32 m0, s23, 32768
s_add_u32 s40, s22, 32768
buffer_load_dwordx4 v2, s[8:11], s40 offen offset:0 sc1 lds
v_cvt_pk_bf16_f32 v194, v28, v29
v_cvt_pk_bf16_f32 v195, v30, v31
v_dot2_f32_bf16 v24, v196, s38, v21
v_dot2_f32_bf16 v25, v196, s39, v21
v_dot2_f32_bf16 v26, v197, s38, v21
v_dot2_f32_bf16 v27, v197, s39, v21
buffer_load_dwordx4 v2, s[8:11], s40 offen offset:1024 sc1 lds
v_dot2_f32_bf16 v28, v198, s38, v21
v_dot2_f32_bf16 v29, v198, s39, v21
v_dot2_f32_bf16 v30, v199, s38, v21
v_dot2_f32_bf16 v31, v199, s39, v21
v_cvt_pk_bf16_f32 v196, v24, v25
v_cvt_pk_bf16_f32 v197, v26, v27
buffer_load_dwordx4 v2, s[8:11], s40 offen offset:2048 sc1 lds
v_cvt_pk_bf16_f32 v198, v28, v29
v_cvt_pk_bf16_f32 v199, v30, v31
v_dot2_f32_bf16 v24, v200, s38, v22
v_dot2_f32_bf16 v25, v200, s39, v22
v_dot2_f32_bf16 v26, v201, s38, v22
v_dot2_f32_bf16 v27, v201, s39, v22
buffer_load_dwordx4 v2, s[8:11], s40 offen offset:3072 sc1 lds
v_dot2_f32_bf16 v28, v202, s38, v22
v_dot2_f32_bf16 v29, v202, s39, v22
v_dot2_f32_bf16 v30, v203, s38, v22
v_dot2_f32_bf16 v31, v203, s39, v22
v_cvt_pk_bf16_f32 v200, v24, v25
v_cvt_pk_bf16_f32 v201, v26, v27
v_cvt_pk_bf16_f32 v202, v28, v29
v_cvt_pk_bf16_f32 v203, v30, v31
v_dot2_f32_bf16 v24, v204, s38, v23
v_dot2_f32_bf16 v25, v204, s39, v23
v_dot2_f32_bf16 v26, v205, s38, v23
v_dot2_f32_bf16 v27, v205, s39, v23
v_dot2_f32_bf16 v28, v206, s38, v23
v_dot2_f32_bf16 v29, v206, s39, v23
v_dot2_f32_bf16 v30, v207, s38, v23
v_dot2_f32_bf16 v31, v207, s39, v23
v_cvt_pk_bf16_f32 v204, v24, v25
v_cvt_pk_bf16_f32 v205, v26, v27
v_cvt_pk_bf16_f32 v206, v28, v29
v_cvt_pk_bf16_f32 v207, v30, v31
s_branch L_tr_e
L_tr_d:
s_cmp_ge_u32 s2, 216
s_cbranch_scc1 L_tr_n
v_perm_b32 v176, v78, v76, s34
v_perm_b32 v177, v82, v80, s34
s_add_u32 m0, s23, 0
s_add_u32 s40, s22, 0
buffer_load_dwordx4 v2, s[8:11], s40 offen offset:0 sc1 lds
v_perm_b32 v178, v86, v84, s34
v_perm_b32 v179, v90, v88, s34
buffer_load_dwordx4 v2, s[8:11], s40 offen offset:1024 sc1 lds
v_perm_b32 v180, v78, v76, s35
v_perm_b32 v181, v82, v80, s35
buffer_load_dwordx4 v2, s[8:11], s40 offen offset:2048 sc1 lds
v_perm_b32 v182, v86, v84, s35
v_perm_b32 v183, v90, v88, s35
buffer_load_dwordx4 v2, s[8:11], s40 offen offset:3072 sc1 lds
v_perm_b32 v184, v79, v77, s34
v_perm_b32 v185, v83, v81, s34
s_add_u32 m0, s23, 4096
s_add_u32 s40, s22, 4096
buffer_load_dwordx4 v2, s[8:11], s40 offen offset:0 sc1 lds
v_perm_b32 v186, v87, v85, s34
v_perm_b32 v187, v91, v89, s34
buffer_load_dwordx4 v2, s[8:11], s40 offen offset:1024 sc1 lds
v_perm_b32 v188, v79, v77, s35
v_perm_b32 v189, v83, v81, s35
buffer_load_dwordx4 v2, s[8:11], s40 offen offset:2048 sc1 lds
v_perm_b32 v190, v87, v85, s35
v_perm_b32 v191, v91, v89, s35
buffer_load_dwordx4 v2, s[8:11], s40 offen offset:3072 sc1 lds
v_perm_b32 v192, v94, v92, s34
v_perm_b32 v193, v98, v96, s34
s_add_u32 m0, s23, 8192
s_add_u32 s40, s22, 8192
buffer_load_dwordx4 v2, s[8:11], s40 offen offset:0 sc1 lds
v_perm_b32 v194, v102, v100, s34
v_perm_b32 v195, v106, v104, s34
buffer_load_dwordx4 v2, s[8:11], s40 offen offset:1024 sc1 lds
v_perm_b32 v196, v94, v92, s35
v_perm_b32 v197, v98, v96, s35
buffer_load_dwordx4 v2, s[8:11], s40 offen offset:2048 sc1 lds
v_perm_b32 v198, v102, v100, s35
v_perm_b32 v199, v106, v104, s35
buffer_load_dwordx4 v2, s[8:11], s40 offen offset:3072 sc1 lds
v_perm_b32 v200, v95, v93, s34
v_perm_b32 v201, v99, v97, s34
s_add_u32 m0, s23, 12288
s_add_u32 s40, s22, 12288
buffer_load_dwordx4 v2, s[8:11], s40 offen offset:0 sc1 lds
v_perm_b32 v202, v103, v101, s34
v_perm_b32 v203, v107, v105, s34
buffer_load_dwordx4 v2, s[8:11], s40 offen offset:1024 sc1 lds
v_perm_b32 v204, v95, v93, s35
v_perm_b32 v205, v99, v97, s35
buffer_load_dwordx4 v2, s[8:11], s40 offen offset:2048 sc1 lds
v_perm_b32 v206, v103, v101, s35
v_perm_b32 v207, v107, v105, s35
buffer_load_dwordx4 v2, s[8:11], s40 offen offset:3072 sc1 lds
v_lshl_or_b32 v208, v109, 16, v108
v_lshl_or_b32 v209, v111, 16, v110
s_add_u32 m0, s23, 16384
s_add_u32 s40, s22, 16384
buffer_load_dwordx4 v2, s[8:11], s40 offen offset:0 sc1 lds
v_lshl_or_b32 v210, v113, 16, v112
v_lshl_or_b32 v211, v115, 16, v114
buffer_load_dwordx4 v2, s[8:11], s40 offen offset:1024 sc1 lds
v_perm_b32 v212, v118, v116, s34
v_perm_b32 v213, v122, v120, s34
buffer_load_dwordx4 v2, s[8:11], s40 offen offset:2048 sc1 lds
v_perm_b32 v214, v126, v124, s34
v_perm_b32 v215, v130, v128, s34
buffer_load_dwordx4 v2, s[8:11], s40 offen offset:3072 sc1 lds
v_perm_b32 v216, v118, v116, s35
v_perm_b32 v217, v122, v120, s35
s_add_u32 m0, s23, 20480
s_add_u32 s40, s22, 20480
buffer_load_dwordx4 v2, s[8:11], s40 offen offset:0 sc1 lds
v_perm_b32 v218, v126, v124, s35
v_perm_b32 v219, v130, v128, s35
buffer_load_dwordx4 v2, s[8:11], s40 offen offset:1024 sc1 lds
v_perm_b32 v220, v119, v117, s34
v_perm_b32 v221, v123, v121, s34
buffer_load_dwordx4 v2, s[8:11], s40 offen offset:2048 sc1 lds
v_perm_b32 v222, v127, v125, s34
v_perm_b32 v223, v131, v129, s34
buffer_load_dwordx4 v2, s[8:11], s40 offen offset:3072 sc1 lds
v_perm_b32 v224, v119, v117, s35
v_perm_b32 v225, v123, v121, s35
s_add_u32 m0, s23, 24576
s_add_u32 s40, s22, 24576
buffer_load_dwordx4 v2, s[8:11], s40 offen offset:0 sc1 lds
v_perm_b32 v226, v127, v125, s35
v_perm_b32 v227, v131, v129, s35
buffer_load_dwordx4 v2, s[8:11], s40 offen offset:1024 sc1 lds
v_perm_b32 v228, v134, v132, s34
v_perm_b32 v229, v138, v136, s34
buffer_load_dwordx4 v2, s[8:11], s40 offen offset:2048 sc1 lds
v_perm_b32 v230, v142, v140, s34
v_perm_b32 v231, v146, v144, s34
buffer_load_dwordx4 v2, s[8:11], s40 offen offset:3072 sc1 lds
v_perm_b32 v232, v134, v132, s35
v_perm_b32 v233, v138, v136, s35
s_add_u32 m0, s23, 28672
s_add_u32 s40, s22, 28672
buffer_load_dwordx4 v2, s[8:11], s40 offen offset:0 sc1 lds
v_perm_b32 v234, v142, v140, s35
v_perm_b32 v235, v146, v144, s35
buffer_load_dwordx4 v2, s[8:11], s40 offen offset:1024 sc1 lds
v_perm_b32 v236, v135, v133, s34
v_perm_b32 v237, v139, v137, s34
buffer_load_dwordx4 v2, s[8:11], s40 offen offset:2048 sc1 lds
v_perm_b32 v238, v143, v141, s34
v_perm_b32 v239, v147, v145, s34
buffer_load_dwordx4 v2, s[8:11], s40 offen offset:3072 sc1 lds
v_perm_b32 v240, v135, v133, s35
v_perm_b32 v241, v139, v137, s35
s_add_u32 m0, s23, 32768
s_add_u32 s40, s22, 32768
buffer_load_dwordx4 v2, s[8:11], s40 offen offset:0 sc1 lds
v_perm_b32 v242, v143, v141, s35
v_perm_b32 v243, v147, v145, s35
buffer_load_dwordx4 v2, s[8:11], s40 offen offset:1024 sc1 lds
v_lshl_or_b32 v244, v149, 16, v148
v_lshl_or_b32 v245, v151, 16, v150
buffer_load_dwordx4 v2, s[8:11], s40 offen offset:2048 sc1 lds
v_lshl_or_b32 v246, v153, 16, v152
v_lshl_or_b32 v247, v155, 16, v154
buffer_load_dwordx4 v2, s[8:11], s40 offen offset:3072 sc1 lds
s_branch L_tr_e
L_tr_n:
s_add_u32 m0, s23, 0
s_add_u32 s40, s22, 0
buffer_load_dwordx4 v2, s[8:11], s40 offen offset:0 sc1 lds
buffer_load_dwordx4 v2, s[8:11], s40 offen offset:1024 sc1 lds
buffer_load_dwordx4 v2, s[8:11], s40 offen offset:2048 sc1 lds
buffer_load_dwordx4 v2, s[8:11], s40 offen offset:3072 sc1 lds
s_add_u32 m0, s23, 4096
s_add_u32 s40, s22, 4096
buffer_load_dwordx4 v2, s[8:11], s40 offen offset:0 sc1 lds
buffer_load_dwordx4 v2, s[8:11], s40 offen offset:1024 sc1 lds
buffer_load_dwordx4 v2, s[8:11], s40 offen offset:2048 sc1 lds
buffer_load_dwordx4 v2, s[8:11], s40 offen offset:3072 sc1 lds
s_add_u32 m0, s23, 8192
s_add_u32 s40, s22, 8192
buffer_load_dwordx4 v2, s[8:11], s40 offen offset:0 sc1 lds
buffer_load_dwordx4 v2, s[8:11], s40 offen offset:1024 sc1 lds
buffer_load_dwordx4 v2, s[8:11], s40 offen offset:2048 sc1 lds
buffer_load_dwordx4 v2, s[8:11], s40 offen offset:3072 sc1 lds
s_add_u32 m0, s23, 12288
s_add_u32 s40, s22, 12288
buffer_load_dwordx4 v2, s[8:11], s40 offen offset:0 sc1 lds
buffer_load_dwordx4 v2, s[8:11], s40 offen offset:1024 sc1 lds
buffer_load_dwordx4 v2, s[8:11], s40 offen offset:2048 sc1 lds
buffer_load_dwordx4 v2, s[8:11], s40 offen offset:3072 sc1 lds
s_add_u32 m0, s23, 16384
s_add_u32 s40, s22, 16384
buffer_load_dwordx4 v2, s[8:11], s40 offen offset:0 sc1 lds
buffer_load_dwordx4 v2, s[8:11], s40 offen offset:1024 sc1 lds
buffer_load_dwordx4 v2, s[8:11], s40 offen offset:2048 sc1 lds
buffer_load_dwordx4 v2, s[8:11], s40 offen offset:3072 sc1 lds
s_add_u32 m0, s23, 20480
s_add_u32 s40, s22, 20480
buffer_load_dwordx4 v2, s[8:11], s40 offen offset:0 sc1 lds
buffer_load_dwordx4 v2, s[8:11], s40 offen offset:1024 sc1 lds
buffer_load_dwordx4 v2, s[8:11], s40 offen offset:2048 sc1 lds
buffer_load_dwordx4 v2, s[8:11], s40 offen offset:3072 sc1 lds
s_add_u32 m0, s23, 24576
s_add_u32 s40, s22, 24576
buffer_load_dwordx4 v2, s[8:11], s40 offen offset:0 sc1 lds
buffer_load_dwordx4 v2, s[8:11], s40 offen offset:1024 sc1 lds
buffer_load_dwordx4 v2, s[8:11], s40 offen offset:2048 sc1 lds
buffer_load_dwordx4 v2, s[8:11], s40 offen offset:3072 sc1 lds
s_add_u32 m0, s23, 28672
s_add_u32 s40, s22, 28672
buffer_load_dwordx4 v2, s[8:11], s40 offen offset:0 sc1 lds
buffer_load_dwordx4 v2, s[8:11], s40 offen offset:1024 sc1 lds
buffer_load_dwordx4 v2, s[8:11], s40 offen offset:2048 sc1 lds
buffer_load_dwordx4 v2, s[8:11], s40 offen offset:3072 sc1 lds
s_add_u32 m0, s23, 32768
s_add_u32 s40, s22, 32768
buffer_load_dwordx4 v2, s[8:11], s40 offen offset:0 sc1 lds
buffer_load_dwordx4 v2, s[8:11], s40 offen offset:1024 sc1 lds
buffer_load_dwordx4 v2, s[8:11], s40 offen offset:2048 sc1 lds
buffer_load_dwordx4 v2, s[8:11], s40 offen offset:3072 sc1 lds
L_tr_e:
s_mov_b32 s35, s33
buffer_load_dwordx4 a[0:3], v2, s[8:11], s26 offen offset:0 sc1
buffer_load_dwordx4 a[72:75], v2, s[8:11], s27 offen offset:0 sc1
buffer_load_dwordx4 a[144:147], v3, s[8:11], s28 offen offset:0 sc1
buffer_load_dwordx4 a[4:7], v2, s[8:11], s26 offen offset:1024 sc1
buffer_load_dwordx4 a[76:79], v2, s[8:11], s27 offen offset:1024 sc1
buffer_load_dwordx4 a[148:151], v3, s[8:11], s28 offen offset:1024 sc1
buffer_load_dwordx4 a[8:11], v2, s[8:11], s26 offen offset:2048 sc1
buffer_load_dwordx4 a[80:83], v2, s[8:11], s27 offen offset:2048 sc1
buffer_load_dwordx4 a[152:155], v3, s[8:11], s28 offen offset:2048 sc1
buffer_load_dwordx4 a[12:15], v2, s[8:11], s26 offen offset:3072 sc1
buffer_load_dwordx4 a[84:87], v2, s[8:11], s27 offen offset:3072 sc1
buffer_load_dwordx4 a[156:159], v3, s[8:11], s28 offen offset:3072 sc1
s_add_u32 s26, s26, 4096
s_add_u32 s27, s27, 4096
s_add_u32 s28, s28, 4096
buffer_load_dwordx4 a[16:19], v2, s[8:11], s26 offen offset:0 sc1
buffer_load_dwordx4 a[88:91], v2, s[8:11], s27 offen offset:0 sc1
buffer_load_dwordx4 a[160:163], v3, s[8:11], s28 offen offset:0 sc1
buffer_load_dwordx4 a[20:23], v2, s[8:11], s26 offen offset:1024 sc1
buffer_load_dwordx4 a[92:95], v2, s[8:11], s27 offen offset:1024 sc1
buffer_load_dwordx4 a[164:167], v3, s[8:11], s28 offen offset:1024 sc1
buffer_load_dwordx4 a[24:27], v2, s[8:11], s26 offen offset:2048 sc1
buffer_load_dwordx4 a[96:99], v2, s[8:11], s27 offen offset:2048 sc1
buffer_load_dwordx4 a[168:171], v3, s[8:11], s28 offen offset:2048 sc1
buffer_load_dwordx4 a[28:31], v2, s[8:11], s26 offen offset:3072 sc1
buffer_load_dwordx4 a[100:103], v2, s[8:11], s27 offen offset:3072 sc1
buffer_load_dwordx4 a[172:175], v3, s[8:11], s28 offen offset:3072 sc1
v_lshrrev_b32 v13, 4, v1
v_lshlrev_b32 v14, 2, v13
v_sub_u32 v14, v12, v14
v_subrev_u32 v15, 0, v14
v_cmp_gt_u32 s[52:53], 8, v15
v_cmp_gt_i32 s[44:45], -8, v15
v_subrev_u32 v15, 1, v14
v_cmp_gt_u32 s[54:55], 8, v15
v_cmp_gt_i32 s[46:47], -8, v15
v_subrev_u32 v15, 2, v14
v_cmp_gt_u32 s[56:57], 8, v15
v_cmp_gt_i32 s[48:49], -8, v15
v_subrev_u32 v15, 3, v14
v_cmp_gt_u32 s[58:59], 8, v15
v_cmp_gt_i32 s[50:51], -8, v15
s_and_b32 s31, s20, 7
s_or_b32 s31, s31, s4
s_cmp_eq_u32 s31, 0
s_cselect_b64 s[60:61], 0, s[44:45]
s_cselect_b64 s[62:63], 0, s[46:47]
s_cselect_b64 s[64:65], 0, s[48:49]
s_cselect_b64 s[66:67], 0, s[50:51]
s_waitcnt vmcnt(24)
s_barrier
ds_read_b128 a[216:219], v2 offset:0
ds_read_b128 a[220:223], v2 offset:8192
ds_read_b128 a[224:227], v2 offset:1024
ds_read_b128 a[228:231], v2 offset:9216
ds_read_b128 a[232:235], v2 offset:2048
ds_read_b128 a[236:239], v2 offset:10240
s_waitcnt vmcnt(18)
s_waitcnt lgkmcnt(4)
v_mfma_f32_16x16x32_bf16 v[32:35], a[216:219], a[0:3], 0
s_add_u32 s26, s26, 4096
s_add_u32 s27, s27, 4096
s_add_u32 s28, s28, 4096
buffer_load_dwordx4 a[32:35], v2, s[8:11], s26 offen offset:0 sc1
v_mfma_f32_16x16x32_bf16 v[32:35], a[220:223], a[4:7], v[32:35]
ds_read_b128 a[240:243], v2 offset:3072
v_dot2_f32_bf16 v24, v208, s38, v20
v_mfma_f32_16x16x32_bf16 v[36:39], a[216:219], a[72:75], 0
v_dot2_f32_bf16 v25, v208, s39, v20
v_dot2_f32_bf16 v26, v209, s38, v20
v_mfma_f32_16x16x32_bf16 v[36:39], a[220:223], a[76:79], v[36:39]
ds_read_b128 a[244:247], v2 offset:11264
s_waitcnt lgkmcnt(4)
v_mfma_f32_16x16x32_bf16 v[40:43], a[224:227], a[0:3], 0
buffer_load_dwordx4 a[104:107], v2, s[8:11], s27 offen offset:0 sc1
v_mfma_f32_16x16x32_bf16 v[40:43], a[228:231], a[4:7], v[40:43]
ds_read_b128 a[216:219], v2 offset:4096
v_dot2_f32_bf16 v27, v209, s39, v20
v_mfma_f32_16x16x32_bf16 v[44:47], a[224:227], a[72:75], 0
v_dot2_f32_bf16 v28, v210, s38, v20
v_dot2_f32_bf16 v29, v210, s39, v20
v_mfma_f32_16x16x32_bf16 v[44:47], a[228:231], a[76:79], v[44:47]
ds_read_b128 a[220:223], v2 offset:12288
s_waitcnt lgkmcnt(4)
v_mfma_f32_16x16x32_bf16 v[48:51], a[232:235], a[0:3], 0
buffer_load_dwordx4 a[176:179], v3, s[8:11], s28 offen offset:0 sc1
v_mfma_f32_16x16x32_bf16 v[48:51], a[236:239], a[4:7], v[48:51]
ds_read_b128 a[224:227], v2 offset:5120
v_dot2_f32_bf16 v30, v211, s38, v20
v_mfma_f32_16x16x32_bf16 v[52:55], a[232:235], a[72:75], 0
v_dot2_f32_bf16 v31, v211, s39, v20
v_cvt_pk_bf16_f32 v208, v24, v25
v_mfma_f32_16x16x32_bf16 v[52:55], a[236:239], a[76:79], v[52:55]
ds_read_b128 a[228:231], v2 offset:13312
s_waitcnt lgkmcnt(4)
v_mfma_f32_16x16x32_bf16 v[56:59], a[240:243], a[0:3], 0
buffer_load_dwordx4 a[36:39], v2, s[8:11], s26 offen offset:1024 sc1
v_mfma_f32_16x16x32_bf16 v[56:59], a[244:247], a[4:7], v[56:59]
ds_read_b128 a[232:235], v2 offset:6144
v_cvt_pk_bf16_f32 v209, v26, v27
v_mfma_f32_16x16x32_bf16 v[60:63], a[240:243], a[72:75], 0
v_cvt_pk_bf16_f32 v210, v28, v29
v_cvt_pk_bf16_f32 v211, v30, v31
v_mfma_f32_16x16x32_bf16 v[60:63], a[244:247], a[76:79], v[60:63]
ds_read_b128 a[236:239], v2 offset:14336
s_waitcnt lgkmcnt(4)
v_mfma_f32_16x16x32_bf16 v[64:67], a[216:219], a[0:3], 0
buffer_load_dwordx4 a[108:111], v2, s[8:11], s27 offen offset:1024 sc1
v_mfma_f32_16x16x32_bf16 v[64:67], a[220:223], a[4:7], v[64:67]
ds_read_b128 a[240:243], v2 offset:7168
v_dot2_f32_bf16 v24, v212, s38, v21
v_mfma_f32_16x16x32_bf16 v[68:71], a[216:219], a[72:75], 0
v_dot2_f32_bf16 v25, v212, s39, v21
v_dot2_f32_bf16 v26, v213, s38, v21
v_mfma_f32_16x16x32_bf16 v[68:71], a[220:223], a[76:79], v[68:71]
ds_read_b128 a[244:247], v2 offset:15360
s_waitcnt lgkmcnt(4)
v_mfma_f32_16x16x32_bf16 v[72:75], a[0:3], a[224:227], 0
buffer_load_dwordx4 a[180:183], v3, s[8:11], s28 offen offset:1024 sc1
v_mfma_f32_16x16x32_bf16 v[72:75], a[4:7], a[228:231], v[72:75]
ds_read_b128 a[216:219], v6 offset:0
v_dot2_f32_bf16 v27, v213, s39, v21
v_mfma_f32_16x16x32_bf16 v[76:79], a[72:75], a[224:227], 0
v_dot2_f32_bf16 v28, v214, s38, v21
v_dot2_f32_bf16 v29, v214, s39, v21
v_mfma_f32_16x16x32_bf16 v[76:79], a[76:79], a[228:231], v[76:79]
ds_read_b128 a[220:223], v6 offset:8192
s_waitcnt lgkmcnt(4)
v_mfma_f32_16x16x32_bf16 v[80:83], a[0:3], a[232:235], 0
buffer_load_dwordx4 a[40:43], v2, s[8:11], s26 offen offset:2048 sc1
v_mfma_f32_16x16x32_bf16 v[80:83], a[4:7], a[236:239], v[80:83]
ds_read_b128 a[224:227], v9 offset:0
v_dot2_f32_bf16 v30, v215, s38, v21
v_mfma_f32_16x16x32_bf16 v[84:87], a[72:75], a[232:235], 0
v_dot2_f32_bf16 v31, v215, s39, v21
v_cvt_pk_bf16_f32 v212, v24, v25
v_mfma_f32_16x16x32_bf16 v[84:87], a[76:79], a[236:239], v[84:87]
ds_read_b128 a[228:231], v9 offset:8192
s_waitcnt lgkmcnt(4)
v_mfma_f32_16x16x32_bf16 v[88:91], a[0:3], a[240:243], 0
buffer_load_dwordx4 a[112:115], v2, s[8:11], s27 offen offset:2048 sc1
v_mfma_f32_16x16x32_bf16 v[88:91], a[4:7], a[244:247], v[88:91]
ds_read_b128 a[232:235], v2 offset:16384
v_cvt_pk_bf16_f32 v213, v26, v27
v_mfma_f32_16x16x32_bf16 v[92:95], a[72:75], a[240:243], 0
v_cvt_pk_bf16_f32 v214, v28, v29
v_cvt_pk_bf16_f32 v215, v30, v31
v_mfma_f32_16x16x32_bf16 v[92:95], a[76:79], a[244:247], v[92:95]
ds_read_b128 a[236:239], v2 offset:24576
s_waitcnt lgkmcnt(4)
v_mfma_f32_16x16x32_bf16 v[96:99], a[216:219], a[144:147], 0
ds_read_b128 a[240:243], v2 offset:17408
buffer_load_dwordx4 a[184:187], v3, s[8:11], s28 offen offset:2048 sc1
v_mfma_f32_16x16x32_bf16 v[96:99], a[220:223], a[148:151], v[96:99]
ds_read_b128 a[244:247], v2 offset:25600
s_waitcnt lgkmcnt(4)
v_mfma_f32_16x16x32_bf16 v[100:103], a[144:147], a[224:227], 0
ds_read_b128 a[216:219], v2 offset:18432
v_dot2_f32_bf16 v24, v216, s38, v22
v_mfma_f32_16x16x32_bf16 v[100:103], a[148:151], a[228:231], v[100:103]
ds_read_b128 a[220:223], v2 offset:26624
s_waitcnt vmcnt(21)
s_waitcnt lgkmcnt(4)
v_mfma_f32_16x16x32_bf16 v[32:35], a[232:235], a[8:11], v[32:35]
buffer_load_dwordx4 a[44:47], v2, s[8:11], s26 offen offset:3072 sc1
v_mfma_f32_16x16x32_bf16 v[32:35], a[236:239], a[12:15], v[32:35]
ds_read_b128 a[224:227], v2 offset:19456
v_dot2_f32_bf16 v25, v216, s39, v22
v_mfma_f32_16x16x32_bf16 v[36:39], a[232:235], a[80:83], v[36:39]
v_dot2_f32_bf16 v26, v217, s38, v22
v_dot2_f32_bf16 v27, v217, s39, v22
v_mfma_f32_16x16x32_bf16 v[36:39], a[236:239], a[84:87], v[36:39]
ds_read_b128 a[228:231], v2 offset:27648
s_waitcnt lgkmcnt(4)
v_mfma_f32_16x16x32_bf16 v[40:43], a[240:243], a[8:11], v[40:43]
buffer_load_dwordx4 a[116:119], v2, s[8:11], s27 offen offset:3072 sc1
v_mfma_f32_16x16x32_bf16 v[40:43], a[244:247], a[12:15], v[40:43]
ds_read_b128 a[232:235], v2 offset:20480
v_dot2_f32_bf16 v28, v218, s38, v22
v_mfma_f32_16x16x32_bf16 v[44:47], a[240:243], a[80:83], v[44:47]
v_dot2_f32_bf16 v29, v218, s39, v22
v_dot2_f32_bf16 v30, v219, s38, v22
v_mfma_f32_16x16x32_bf16 v[44:47], a[244:247], a[84:87], v[44:47]
ds_read_b128 a[236:239], v2 offset:28672
s_waitcnt lgkmcnt(4)
v_mfma_f32_16x16x32_bf16 v[48:51], a[216:219], a[8:11], v[48:51]
buffer_load_dwordx4 a[188:191], v3, s[8:11], s28 offen offset:3072 sc1
v_mfma_f32_16x16x32_bf16 v[48:51], a[220:223], a[12:15], v[48:51]
ds_read_b128 a[240:243], v2 offset:21504
v_dot2_f32_bf16 v31, v219, s39, v22
v_mfma_f32_16x16x32_bf16 v[52:55], a[216:219], a[80:83], v[52:55]
v_cvt_pk_bf16_f32 v216, v24, v25
v_cvt_pk_bf16_f32 v217, v26, v27
v_mfma_f32_16x16x32_bf16 v[52:55], a[220:223], a[84:87], v[52:55]
ds_read_b128 a[244:247], v2 offset:29696
s_waitcnt lgkmcnt(4)
v_mfma_f32_16x16x32_bf16 v[56:59], a[224:227], a[8:11], v[56:59]
s_add_u32 s26, s26, 4096
s_add_u32 s27, s27, 4096
s_add_u32 s28, s28, 4096
buffer_load_dwordx4 a[48:51], v2, s[8:11], s26 offen offset:0 sc1
v_mfma_f32_16x16x32_bf16 v[56:59], a[228:231], a[12:15], v[56:59]
ds_read_b128 a[216:219], v2 offset:22528
v_cvt_pk_bf16_f32 v218, v28, v29
v_mfma_f32_16x16x32_bf16 v[60:63], a[224:227], a[80:83], v[60:63]
v_cvt_pk_bf16_f32 v219, v30, v31
v_dot2_f32_bf16 v24, v220, s38, v23
v_mfma_f32_16x16x32_bf16 v[60:63], a[228:231], a[84:87], v[60:63]
ds_read_b128 a[220:223], v2 offset:30720
s_waitcnt lgkmcnt(4)
v_mfma_f32_16x16x32_bf16 v[64:67], a[232:235], a[8:11], v[64:67]
buffer_load_dwordx4 a[120:123], v2, s[8:11], s27 offen offset:0 sc1
v_mfma_f32_16x16x32_bf16 v[64:67], a[236:239], a[12:15], v[64:67]
ds_read_b128 a[224:227], v2 offset:23552
v_dot2_f32_bf16 v25, v220, s39, v23
v_mfma_f32_16x16x32_bf16 v[68:71], a[232:235], a[80:83], v[68:71]
v_dot2_f32_bf16 v26, v221, s38, v23
v_dot2_f32_bf16 v27, v221, s39, v23
v_mfma_f32_16x16x32_bf16 v[68:71], a[236:239], a[84:87], v[68:71]
ds_read_b128 a[228:231], v2 offset:31744
s_waitcnt lgkmcnt(4)
v_mfma_f32_16x16x32_bf16 v[72:75], a[8:11], a[240:243], v[72:75]
buffer_load_dwordx4 a[192:195], v3, s[8:11], s28 offen offset:0 sc1
v_mfma_f32_16x16x32_bf16 v[72:75], a[12:15], a[244:247], v[72:75]
ds_read_b128 a[232:235], v6 offset:16384
v_dot2_f32_bf16 v28, v222, s38, v23
v_mfma_f32_16x16x32_bf16 v[76:79], a[80:83], a[240:243], v[76:79]
v_dot2_f32_bf16 v29, v222, s39, v23
v_dot2_f32_bf16 v30, v223, s38, v23
v_mfma_f32_16x16x32_bf16 v[76:79], a[84:87], a[244:247], v[76:79]
ds_read_b128 a[236:239], v6 offset:24576
s_waitcnt lgkmcnt(4)
v_mfma_f32_16x16x32_bf16 v[80:83], a[8:11], a[216:219], v[80:83]
buffer_load_dwordx4 a[52:55], v2, s[8:11], s26 offen offset:1024 sc1
v_mfma_f32_16x16x32_bf16 v[80:83], a[12:15], a[220:223], v[80:83]
ds_read_b128 a[240:243], v9 offset:16384
v_dot2_f32_bf16 v31, v223, s39, v23
v_mfma_f32_16x16x32_bf16 v[84:87], a[80:83], a[216:219], v[84:87]
v_cvt_pk_bf16_f32 v220, v24, v25
v_cvt_pk_bf16_f32 v221, v26, v27
v_mfma_f32_16x16x32_bf16 v[84:87], a[84:87], a[220:223], v[84:87]
ds_read_b128 a[244:247], v9 offset:24576
s_waitcnt lgkmcnt(4)
v_mfma_f32_16x16x32_bf16 v[88:91], a[8:11], a[224:227], v[88:91]
buffer_load_dwordx4 a[124:127], v2, s[8:11], s27 offen offset:1024 sc1
v_mfma_f32_16x16x32_bf16 v[88:91], a[12:15], a[228:231], v[88:91]
ds_read_b128 a[216:219], v2 offset:32768
v_cvt_pk_bf16_f32 v222, v28, v29
v_mfma_f32_16x16x32_bf16 v[92:95], a[80:83], a[224:227], v[92:95]
v_cvt_pk_bf16_f32 v223, v30, v31
v_dot2_f32_bf16 v24, v224, s38, v20
v_mfma_f32_16x16x32_bf16 v[92:95], a[84:87], a[228:231], v[92:95]
ds_read_b128 a[220:223], v2 offset:40960
s_waitcnt lgkmcnt(4)
v_mfma_f32_16x16x32_bf16 v[96:99], a[232:235], a[152:155], v[96:99]
ds_read_b128 a[224:227], v2 offset:33792
buffer_load_dwordx4 a[196:199], v3, s[8:11], s28 offen offset:1024 sc1
v_mfma_f32_16x16x32_bf16 v[96:99], a[236:239], a[156:159], v[96:99]
ds_read_b128 a[228:231], v2 offset:41984
s_waitcnt lgkmcnt(4)
v_mfma_f32_16x16x32_bf16 v[100:103], a[152:155], a[240:243], v[100:103]
ds_read_b128 a[232:235], v2 offset:34816
v_dot2_f32_bf16 v25, v224, s39, v20
v_mfma_f32_16x16x32_bf16 v[100:103], a[156:159], a[244:247], v[100:103]
ds_read_b128 a[236:239], v2 offset:43008
s_waitcnt vmcnt(24)
s_waitcnt lgkmcnt(4)
v_mfma_f32_16x16x32_bf16 v[32:35], a[216:219], a[16:19], v[32:35]
buffer_load_dwordx4 a[56:59], v2, s[8:11], s26 offen offset:2048 sc1
v_mfma_f32_16x16x32_bf16 v[32:35], a[220:223], a[20:23], v[32:35]
ds_read_b128 a[240:243], v2 offset:35840
v_dot2_f32_bf16 v26, v225, s38, v20
v_mfma_f32_16x16x32_bf16 v[36:39], a[216:219], a[88:91], v[36:39]
v_dot2_f32_bf16 v27, v225, s39, v20
v_dot2_f32_bf16 v28, v226, s38, v20
v_mfma_f32_16x16x32_bf16 v[36:39], a[220:223], a[92:95], v[36:39]
ds_read_b128 a[244:247], v2 offset:44032
s_waitcnt lgkmcnt(4)
v_mfma_f32_16x16x32_bf16 v[40:43], a[224:227], a[16:19], v[40:43]
buffer_load_dwordx4 a[128:131], v2, s[8:11], s27 offen offset:2048 sc1
v_mfma_f32_16x16x32_bf16 v[40:43], a[228:231], a[20:23], v[40:43]
ds_read_b128 a[216:219], v2 offset:36864
v_dot2_f32_bf16 v29, v226, s39, v20
v_mfma_f32_16x16x32_bf16 v[44:47], a[224:227], a[88:91], v[44:47]
v_dot2_f32_bf16 v30, v227, s38, v20
v_dot2_f32_bf16 v31, v227, s39, v20
v_mfma_f32_16x16x32_bf16 v[44:47], a[228:231], a[92:95], v[44:47]
ds_read_b128 a[220:223], v2 offset:45056
s_waitcnt lgkmcnt(4)
v_mfma_f32_16x16x32_bf16 v[48:51], a[232:235], a[16:19], v[48:51]
buffer_load_dwordx4 a[200:203], v3, s[8:11], s28 offen offset:2048 sc1
v_mfma_f32_16x16x32_bf16 v[48:51], a[236:239], a[20:23], v[48:51]
ds_read_b128 a[224:227], v2 offset:37888
v_cvt_pk_bf16_f32 v224, v24, v25
v_mfma_f32_16x16x32_bf16 v[52:55], a[232:235], a[88:91], v[52:55]
v_cvt_pk_bf16_f32 v225, v26, v27
v_cvt_pk_bf16_f32 v226, v28, v29
v_mfma_f32_16x16x32_bf16 v[52:55], a[236:239], a[92:95], v[52:55]
ds_read_b128 a[228:231], v2 offset:46080
s_waitcnt lgkmcnt(4)
v_mfma_f32_16x16x32_bf16 v[56:59], a[240:243], a[16:19], v[56:59]
buffer_load_dwordx4 a[60:63], v2, s[8:11], s26 offen offset:3072 sc1
v_mfma_f32_16x16x32_bf16 v[56:59], a[244:247], a[20:23], v[56:59]
ds_read_b128 a[232:235], v2 offset:38912
v_cvt_pk_bf16_f32 v227, v30, v31
v_mfma_f32_16x16x32_bf16 v[60:63], a[240:243], a[88:91], v[60:63]
v_dot2_f32_bf16 v24, v228, s38, v21
v_dot2_f32_bf16 v25, v228, s39, v21
v_mfma_f32_16x16x32_bf16 v[60:63], a[244:247], a[92:95], v[60:63]
ds_read_b128 a[236:239], v2 offset:47104
s_waitcnt lgkmcnt(4)
v_mfma_f32_16x16x32_bf16 v[64:67], a[216:219], a[16:19], v[64:67]
buffer_load_dwordx4 a[132:135], v2, s[8:11], s27 offen offset:3072 sc1
v_mfma_f32_16x16x32_bf16 v[64:67], a[220:223], a[20:23], v[64:67]
ds_read_b128 a[240:243], v2 offset:39936
v_dot2_f32_bf16 v26, v229, s38, v21
v_mfma_f32_16x16x32_bf16 v[68:71], a[216:219], a[88:91], v[68:71]
v_dot2_f32_bf16 v27, v229, s39, v21
v_dot2_f32_bf16 v28, v230, s38, v21
v_mfma_f32_16x16x32_bf16 v[68:71], a[220:223], a[92:95], v[68:71]
ds_read_b128 a[244:247], v2 offset:48128
s_waitcnt lgkmcnt(4)
v_mfma_f32_16x16x32_bf16 v[72:75], a[16:19], a[224:227], v[72:75]
buffer_load_dwordx4 a[204:207], v3, s[8:11], s28 offen offset:3072 sc1
v_mfma_f32_16x16x32_bf16 v[72:75], a[20:23], a[228:231], v[72:75]
ds_read_b128 a[216:219], v6 offset:32768
v_dot2_f32_bf16 v29, v230, s39, v21
v_mfma_f32_16x16x32_bf16 v[76:79], a[88:91], a[224:227], v[76:79]
v_dot2_f32_bf16 v30, v231, s38, v21
v_dot2_f32_bf16 v31, v231, s39, v21
v_mfma_f32_16x16x32_bf16 v[76:79], a[92:95], a[228:231], v[76:79]
ds_read_b128 a[220:223], v6 offset:40960
s_waitcnt lgkmcnt(4)
v_mfma_f32_16x16x32_bf16 v[80:83], a[16:19], a[232:235], v[80:83]
s_add_u32 s26, s26, 4096
s_add_u32 s27, s27, 4096
s_add_u32 s28, s28, 4096
buffer_load_dwordx4 a[64:67], v2, s[8:11], s26 offen offset:0 sc1
v_mfma_f32_16x16x32_bf16 v[80:83], a[20:23], a[236:239], v[80:83]
ds_read_b128 a[224:227], v9 offset:32768
v_cvt_pk_bf16_f32 v228, v24, v25
v_mfma_f32_16x16x32_bf16 v[84:87], a[88:91], a[232:235], v[84:87]
v_cvt_pk_bf16_f32 v229, v26, v27
v_cvt_pk_bf16_f32 v230, v28, v29
v_mfma_f32_16x16x32_bf16 v[84:87], a[92:95], a[236:239], v[84:87]
ds_read_b128 a[228:231], v9 offset:40960
s_waitcnt lgkmcnt(4)
v_mfma_f32_16x16x32_bf16 v[88:91], a[16:19], a[240:243], v[88:91]
buffer_load_dwordx4 a[136:139], v2, s[8:11], s27 offen offset:0 sc1
v_mfma_f32_16x16x32_bf16 v[88:91], a[20:23], a[244:247], v[88:91]
ds_read_b128 a[232:235], v2 offset:49152
v_cvt_pk_bf16_f32 v231, v30, v31
v_mfma_f32_16x16x32_bf16 v[92:95], a[88:91], a[240:243], v[92:95]
v_dot2_f32_bf16 v24, v232, s38, v22
v_dot2_f32_bf16 v25, v232, s39, v22
v_mfma_f32_16x16x32_bf16 v[92:95], a[92:95], a[244:247], v[92:95]
ds_read_b128 a[236:239], v2 offset:57344
s_waitcnt lgkmcnt(4)
v_mfma_f32_16x16x32_bf16 v[96:99], a[216:219], a[160:163], v[96:99]
ds_read_b128 a[240:243], v2 offset:50176
buffer_load_dwordx4 a[208:211], v3, s[8:11], s28 offen offset:0 sc1
v_mfma_f32_16x16x32_bf16 v[96:99], a[220:223], a[164:167], v[96:99]
ds_read_b128 a[244:247], v2 offset:58368
s_waitcnt lgkmcnt(4)
v_mfma_f32_16x16x32_bf16 v[100:103], a[160:163], a[224:227], v[100:103]
ds_read_b128 a[216:219], v2 offset:51200
v_dot2_f32_bf16 v26, v233, s38, v22
v_mfma_f32_16x16x32_bf16 v[100:103], a[164:167], a[228:231], v[100:103]
ds_read_b128 a[220:223], v2 offset:59392
s_waitcnt vmcnt(27)
s_waitcnt lgkmcnt(4)
v_mfma_f32_16x16x32_bf16 v[32:35], a[232:235], a[24:27], v[32:35]
buffer_load_dwordx4 a[68:71], v2, s[8:11], s26 offen offset:1024 sc1
v_mfma_f32_16x16x32_bf16 v[32:35], a[236:239], a[28:31], v[32:35]
ds_read_b128 a[224:227], v2 offset:52224
v_dot2_f32_bf16 v27, v233, s39, v22
v_mfma_f32_16x16x32_bf16 v[36:39], a[232:235], a[96:99], v[36:39]
v_dot2_f32_bf16 v28, v234, s38, v22
v_dot2_f32_bf16 v29, v234, s39, v22
v_mfma_f32_16x16x32_bf16 v[36:39], a[236:239], a[100:103], v[36:39]
ds_read_b128 a[228:231], v2 offset:60416
s_waitcnt lgkmcnt(4)
v_mfma_f32_16x16x32_bf16 v[40:43], a[240:243], a[24:27], v[40:43]
buffer_load_dwordx4 a[140:143], v2, s[8:11], s27 offen offset:1024 sc1
v_mfma_f32_16x16x32_bf16 v[40:43], a[244:247], a[28:31], v[40:43]
ds_read_b128 a[232:235], v2 offset:53248
v_dot2_f32_bf16 v30, v235, s38, v22
v_mfma_f32_16x16x32_bf16 v[44:47], a[240:243], a[96:99], v[44:47]
v_dot2_f32_bf16 v31, v235, s39, v22
v_cvt_pk_bf16_f32 v232, v24, v25
v_mfma_f32_16x16x32_bf16 v[44:47], a[244:247], a[100:103], v[44:47]
ds_read_b128 a[236:239], v2 offset:61440
s_waitcnt lgkmcnt(4)
v_mfma_f32_16x16x32_bf16 v[48:51], a[216:219], a[24:27], v[48:51]
buffer_load_dwordx4 a[212:215], v3, s[8:11], s28 offen offset:1024 sc1
v_mfma_f32_16x16x32_bf16 v[48:51], a[220:223], a[28:31], v[48:51]
ds_read_b128 a[240:243], v2 offset:54272
v_cvt_pk_bf16_f32 v233, v26, v27
v_mfma_f32_16x16x32_bf16 v[52:55], a[216:219], a[96:99], v[52:55]
v_cvt_pk_bf16_f32 v234, v28, v29
v_cvt_pk_bf16_f32 v235, v30, v31
v_mfma_f32_16x16x32_bf16 v[52:55], a[220:223], a[100:103], v[52:55]
ds_read_b128 a[244:247], v2 offset:62464
s_waitcnt lgkmcnt(4)
v_mfma_f32_16x16x32_bf16 v[56:59], a[224:227], a[24:27], v[56:59]
buffer_store_dwordx4 v[176:179], v156, s[8:11], 0 offen sc1
v_dot2_f32_bf16 v24, v236, s38, v23
v_mfma_f32_16x16x32_bf16 v[56:59], a[228:231], a[28:31], v[56:59]
ds_read_b128 a[216:219], v2 offset:55296
v_dot2_f32_bf16 v25, v236, s39, v23
v_mfma_f32_16x16x32_bf16 v[60:63], a[224:227], a[96:99], v[60:63]
v_dot2_f32_bf16 v26, v237, s38, v23
v_dot2_f32_bf16 v27, v237, s39, v23
v_mfma_f32_16x16x32_bf16 v[60:63], a[228:231], a[100:103], v[60:63]
ds_read_b128 a[220:223], v2 offset:63488
s_waitcnt lgkmcnt(4)
v_mfma_f32_16x16x32_bf16 v[64:67], a[232:235], a[24:27], v[64:67]
buffer_store_dwordx4 v[180:183], v157, s[8:11], 0 offen sc1
v_dot2_f32_bf16 v28, v238, s38, v23
v_mfma_f32_16x16x32_bf16 v[64:67], a[236:239], a[28:31], v[64:67]
ds_read_b128 a[224:227], v2 offset:56320
v_dot2_f32_bf16 v29, v238, s39, v23
v_mfma_f32_16x16x32_bf16 v[68:71], a[232:235], a[96:99], v[68:71]
v_dot2_f32_bf16 v30, v239, s38, v23
v_dot2_f32_bf16 v31, v239, s39, v23
v_mfma_f32_16x16x32_bf16 v[68:71], a[236:239], a[100:103], v[68:71]
ds_read_b128 a[228:231], v2 offset:64512
s_waitcnt lgkmcnt(4)
v_mfma_f32_16x16x32_bf16 v[72:75], a[24:27], a[240:243], v[72:75]
buffer_store_dwordx4 v[184:187], v158, s[8:11], 0 offen sc1
v_cvt_pk_bf16_f32 v236, v24, v25
v_mfma_f32_16x16x32_bf16 v[72:75], a[28:31], a[244:247], v[72:75]
ds_read_b128 a[232:235], v6 offset:49152
v_cvt_pk_bf16_f32 v237, v26, v27
v_mfma_f32_16x16x32_bf16 v[76:79], a[96:99], a[240:243], v[76:79]
v_cvt_pk_bf16_f32 v238, v28, v29
v_cvt_pk_bf16_f32 v239, v30, v31
v_mfma_f32_16x16x32_bf16 v[76:79], a[100:103], a[244:247], v[76:79]
ds_read_b128 a[236:239], v6 offset:57344
s_waitcnt lgkmcnt(4)
v_mfma_f32_16x16x32_bf16 v[80:83], a[24:27], a[216:219], v[80:83]
buffer_store_dwordx4 v[188:191], v159, s[8:11], 0 offen sc1
v_dot2_f32_bf16 v24, v240, s38, v20
v_mfma_f32_16x16x32_bf16 v[80:83], a[28:31], a[220:223], v[80:83]
ds_read_b128 a[240:243], v9 offset:49152
v_dot2_f32_bf16 v25, v240, s39, v20
v_mfma_f32_16x16x32_bf16 v[84:87], a[96:99], a[216:219], v[84:87]
v_dot2_f32_bf16 v26, v241, s38, v20
v_dot2_f32_bf16 v27, v241, s39, v20
v_mfma_f32_16x16x32_bf16 v[84:87], a[100:103], a[220:223], v[84:87]
ds_read_b128 a[244:247], v9 offset:57344
s_waitcnt lgkmcnt(4)
v_mfma_f32_16x16x32_bf16 v[88:91], a[24:27], a[224:227], v[88:91]
buffer_store_dwordx4 v[192:195], v160, s[8:11], 0 offen sc1
v_dot2_f32_bf16 v28, v242, s38, v20
v_mfma_f32_16x16x32_bf16 v[88:91], a[28:31], a[228:231], v[88:91]
ds_read_b128 a[216:219], v4 offset:0
v_dot2_f32_bf16 v29, v242, s39, v20
v_mfma_f32_16x16x32_bf16 v[92:95], a[96:99], a[224:227], v[92:95]
v_dot2_f32_bf16 v30, v243, s38, v20
v_dot2_f32_bf16 v31, v243, s39, v20
v_mfma_f32_16x16x32_bf16 v[92:95], a[100:103], a[228:231], v[92:95]
ds_read_b128 a[220:223], v4 offset:8192
s_waitcnt lgkmcnt(4)
v_mfma_f32_16x16x32_bf16 v[96:99], a[232:235], a[168:171], v[96:99]
ds_read_b128 a[224:227], v4 offset:1024
buffer_store_dwordx4 v[196:199], v161, s[8:11], 0 offen sc1
v_cvt_pk_bf16_f32 v240, v24, v25
v_mfma_f32_16x16x32_bf16 v[96:99], a[236:239], a[172:175], v[96:99]
ds_read_b128 a[228:231], v4 offset:9216
s_waitcnt lgkmcnt(4)
v_mfma_f32_16x16x32_bf16 v[100:103], a[168:171], a[240:243], v[100:103]
ds_read_b128 a[232:235], v4 offset:2048
v_cvt_pk_bf16_f32 v241, v26, v27
v_mfma_f32_16x16x32_bf16 v[100:103], a[172:175], a[244:247], v[100:103]
ds_read_b128 a[236:239], v4 offset:10240
s_waitcnt vmcnt(30)
s_waitcnt lgkmcnt(4)
v_mfma_f32_16x16x32_bf16 v[32:35], a[216:219], a[32:35], v[32:35]
buffer_store_dwordx4 v[200:203], v162, s[8:11], 0 offen sc1
v_cvt_pk_bf16_f32 v242, v28, v29
v_mfma_f32_16x16x32_bf16 v[32:35], a[220:223], a[36:39], v[32:35]
ds_read_b128 a[240:243], v4 offset:3072
v_cvt_pk_bf16_f32 v243, v30, v31
v_mfma_f32_16x16x32_bf16 v[36:39], a[216:219], a[104:107], v[36:39]
v_dot2_f32_bf16 v24, v244, s38, v21
v_dot2_f32_bf16 v25, v244, s39, v21
v_mfma_f32_16x16x32_bf16 v[36:39], a[220:223], a[108:111], v[36:39]
ds_read_b128 a[244:247], v4 offset:11264
s_waitcnt lgkmcnt(4)
v_mfma_f32_16x16x32_bf16 v[40:43], a[224:227], a[32:35], v[40:43]
buffer_store_dwordx4 v[204:207], v163, s[8:11], 0 offen sc1
v_dot2_f32_bf16 v26, v245, s38, v21
v_mfma_f32_16x16x32_bf16 v[40:43], a[228:231], a[36:39], v[40:43]
ds_read_b128 a[216:219], v4 offset:4096
v_dot2_f32_bf16 v27, v245, s39, v21
v_mfma_f32_16x16x32_bf16 v[44:47], a[224:227], a[104:107], v[44:47]
v_dot2_f32_bf16 v28, v246, s38, v21
v_dot2_f32_bf16 v29, v246, s39, v21
v_mfma_f32_16x16x32_bf16 v[44:47], a[228:231], a[108:111], v[44:47]
ds_read_b128 a[220:223], v4 offset:12288
s_waitcnt lgkmcnt(4)
v_mfma_f32_16x16x32_bf16 v[48:51], a[232:235], a[32:35], v[48:51]
buffer_store_dwordx4 v[208:211], v164, s[8:11], 0 offen sc1
v_dot2_f32_bf16 v30, v247, s38, v21
v_mfma_f32_16x16x32_bf16 v[48:51], a[236:239], a[36:39], v[48:51]
ds_read_b128 a[224:227], v4 offset:5120
v_dot2_f32_bf16 v31, v247, s39, v21
v_mfma_f32_16x16x32_bf16 v[52:55], a[232:235], a[104:107], v[52:55]
v_cvt_pk_bf16_f32 v244, v24, v25
v_cvt_pk_bf16_f32 v245, v26, v27
v_mfma_f32_16x16x32_bf16 v[52:55], a[236:239], a[108:111], v[52:55]
ds_read_b128 a[228:231], v4 offset:13312
s_waitcnt lgkmcnt(4)
v_mfma_f32_16x16x32_bf16 v[56:59], a[240:243], a[32:35], v[56:59]
buffer_store_dwordx4 v[212:215], v165, s[8:11], 0 offen sc1
v_cvt_pk_bf16_f32 v246, v28, v29
v_mfma_f32_16x16x32_bf16 v[56:59], a[244:247], a[36:39], v[56:59]
ds_read_b128 a[232:235], v4 offset:6144
v_cvt_pk_bf16_f32 v247, v30, v31
v_mfma_f32_16x16x32_bf16 v[60:63], a[240:243], a[104:107], v[60:63]
v_dot2_f32_bf16 v24, v248, s38, v22
v_dot2_f32_bf16 v25, v248, s39, v22
v_mfma_f32_16x16x32_bf16 v[60:63], a[244:247], a[108:111], v[60:63]
ds_read_b128 a[236:239], v4 offset:14336
s_waitcnt lgkmcnt(4)
v_mfma_f32_16x16x32_bf16 v[64:67], a[216:219], a[32:35], v[64:67]
buffer_store_dwordx4 v[216:219], v166, s[8:11], 0 offen sc1
v_dot2_f32_bf16 v26, v249, s38, v22
v_mfma_f32_16x16x32_bf16 v[64:67], a[220:223], a[36:39], v[64:67]
ds_read_b128 a[240:243], v4 offset:7168
v_dot2_f32_bf16 v27, v249, s39, v22
v_mfma_f32_16x16x32_bf16 v[68:71], a[216:219], a[104:107], v[68:71]
v_dot2_f32_bf16 v28, v250, s38, v22
v_dot2_f32_bf16 v29, v250, s39, v22
v_mfma_f32_16x16x32_bf16 v[68:71], a[220:223], a[108:111], v[68:71]
ds_read_b128 a[244:247], v4 offset:15360
s_waitcnt lgkmcnt(4)
v_mfma_f32_16x16x32_bf16 v[72:75], a[32:35], a[224:227], v[72:75]
buffer_store_dwordx4 v[220:223], v167, s[8:11], 0 offen sc1
v_dot2_f32_bf16 v30, v251, s38, v22
v_mfma_f32_16x16x32_bf16 v[72:75], a[36:39], a[228:231], v[72:75]
ds_read_b128 a[216:219], v7 offset:0
v_dot2_f32_bf16 v31, v251, s39, v22
v_mfma_f32_16x16x32_bf16 v[76:79], a[104:107], a[224:227], v[76:79]
v_cvt_pk_bf16_f32 v248, v24, v25
v_cvt_pk_bf16_f32 v249, v26, v27
v_mfma_f32_16x16x32_bf16 v[76:79], a[108:111], a[228:231], v[76:79]
ds_read_b128 a[220:223], v7 offset:8192
s_waitcnt lgkmcnt(4)
v_mfma_f32_16x16x32_bf16 v[80:83], a[32:35], a[232:235], v[80:83]
buffer_store_dwordx4 v[224:227], v168, s[8:11], 0 offen sc1
v_cvt_pk_bf16_f32 v250, v28, v29
v_mfma_f32_16x16x32_bf16 v[80:83], a[36:39], a[236:239], v[80:83]
ds_read_b128 a[224:227], v10 offset:0
v_cvt_pk_bf16_f32 v251, v30, v31
v_mfma_f32_16x16x32_bf16 v[84:87], a[104:107], a[232:235], v[84:87]
v_dot2_f32_bf16 v24, v252, s38, v23
v_dot2_f32_bf16 v25, v252, s39, v23
v_mfma_f32_16x16x32_bf16 v[84:87], a[108:111], a[236:239], v[84:87]
ds_read_b128 a[228:231], v10 offset:8192
s_waitcnt lgkmcnt(4)
v_mfma_f32_16x16x32_bf16 v[88:91], a[32:35], a[240:243], v[88:91]
buffer_store_dwordx4 v[228:231], v169, s[8:11], 0 offen sc1
v_dot2_f32_bf16 v26, v253, s38, v23
v_mfma_f32_16x16x32_bf16 v[88:91], a[36:39], a[244:247], v[88:91]
ds_read_b128 a[232:235], v4 offset:16384
v_dot2_f32_bf16 v27, v253, s39, v23
v_mfma_f32_16x16x32_bf16 v[92:95], a[104:107], a[240:243], v[92:95]
v_dot2_f32_bf16 v28, v254, s38, v23
v_dot2_f32_bf16 v29, v254, s39, v23
v_mfma_f32_16x16x32_bf16 v[92:95], a[108:111], a[244:247], v[92:95]
ds_read_b128 a[236:239], v4 offset:24576
s_waitcnt lgkmcnt(4)
v_mfma_f32_16x16x32_bf16 v[96:99], a[216:219], a[176:179], v[96:99]
ds_read_b128 a[240:243], v4 offset:17408
buffer_store_dwordx4 v[232:235], v170, s[8:11], 0 offen sc1
v_dot2_f32_bf16 v30, v255, s38, v23
v_mfma_f32_16x16x32_bf16 v[96:99], a[220:223], a[180:183], v[96:99]
ds_read_b128 a[244:247], v4 offset:25600
s_waitcnt lgkmcnt(4)
v_mfma_f32_16x16x32_bf16 v[100:103], a[176:179], a[224:227], v[100:103]
ds_read_b128 a[216:219], v4 offset:18432
v_dot2_f32_bf16 v31, v255, s39, v23
v_mfma_f32_16x16x32_bf16 v[100:103], a[180:183], a[228:231], v[100:103]
ds_read_b128 a[220:223], v4 offset:26624
s_waitcnt vmcnt(33)
s_waitcnt lgkmcnt(4)
v_mfma_f32_16x16x32_bf16 v[32:35], a[232:235], a[40:43], v[32:35]
buffer_store_dwordx4 v[236:239], v171, s[8:11], 0 offen sc1
v_cvt_pk_bf16_f32 v252, v24, v25
v_mfma_f32_16x16x32_bf16 v[32:35], a[236:239], a[44:47], v[32:35]
ds_read_b128 a[224:227], v4 offset:19456
v_cvt_pk_bf16_f32 v253, v26, v27
v_mfma_f32_16x16x32_bf16 v[36:39], a[232:235], a[112:115], v[36:39]
v_cvt_pk_bf16_f32 v254, v28, v29
v_cvt_pk_bf16_f32 v255, v30, v31
v_mfma_f32_16x16x32_bf16 v[36:39], a[236:239], a[116:119], v[36:39]
ds_read_b128 a[228:231], v4 offset:27648
s_waitcnt lgkmcnt(4)
v_mfma_f32_16x16x32_bf16 v[40:43], a[240:243], a[40:43], v[40:43]
buffer_store_dwordx4 v[240:243], v172, s[8:11], 0 offen sc1
v_mfma_f32_16x16x32_bf16 v[40:43], a[244:247], a[44:47], v[40:43]
ds_read_b128 a[232:235], v4 offset:20480
v_mfma_f32_16x16x32_bf16 v[44:47], a[240:243], a[112:115], v[44:47]
v_mfma_f32_16x16x32_bf16 v[44:47], a[244:247], a[116:119], v[44:47]
ds_read_b128 a[236:239], v4 offset:28672
s_waitcnt lgkmcnt(4)
v_mfma_f32_16x16x32_bf16 v[48:51], a[216:219], a[40:43], v[48:51]
buffer_store_dwordx4 v[244:247], v173, s[8:11], 0 offen sc1
v_mfma_f32_16x16x32_bf16 v[48:51], a[220:223], a[44:47], v[48:51]
ds_read_b128 a[240:243], v4 offset:21504
v_mfma_f32_16x16x32_bf16 v[52:55], a[216:219], a[112:115], v[52:55]
v_mfma_f32_16x16x32_bf16 v[52:55], a[220:223], a[116:119], v[52:55]
ds_read_b128 a[244:247], v4 offset:29696
s_waitcnt lgkmcnt(4)
v_mfma_f32_16x16x32_bf16 v[56:59], a[224:227], a[40:43], v[56:59]
buffer_store_dwordx4 v[248:251], v174, s[8:11], 0 offen sc1
v_mfma_f32_16x16x32_bf16 v[56:59], a[228:231], a[44:47], v[56:59]
ds_read_b128 a[216:219], v4 offset:22528
v_mfma_f32_16x16x32_bf16 v[60:63], a[224:227], a[112:115], v[60:63]
v_mfma_f32_16x16x32_bf16 v[60:63], a[228:231], a[116:119], v[60:63]
ds_read_b128 a[220:223], v4 offset:30720
s_waitcnt lgkmcnt(4)
v_mfma_f32_16x16x32_bf16 v[64:67], a[232:235], a[40:43], v[64:67]
buffer_store_dwordx4 v[252:255], v175, s[8:11], 0 offen sc1
v_mfma_f32_16x16x32_bf16 v[64:67], a[236:239], a[44:47], v[64:67]
ds_read_b128 a[224:227], v4 offset:23552
v_mfma_f32_16x16x32_bf16 v[68:71], a[232:235], a[112:115], v[68:71]
v_mfma_f32_16x16x32_bf16 v[68:71], a[236:239], a[116:119], v[68:71]
ds_read_b128 a[228:231], v4 offset:31744
s_waitcnt lgkmcnt(4)
v_mfma_f32_16x16x32_bf16 v[72:75], a[40:43], a[240:243], v[72:75]
v_mfma_f32_16x16x32_bf16 v[72:75], a[44:47], a[244:247], v[72:75]
ds_read_b128 a[232:235], v7 offset:16384
v_mfma_f32_16x16x32_bf16 v[76:79], a[112:115], a[240:243], v[76:79]
v_mfma_f32_16x16x32_bf16 v[76:79], a[116:119], a[244:247], v[76:79]
ds_read_b128 a[236:239], v7 offset:24576
s_waitcnt lgkmcnt(4)
v_mfma_f32_16x16x32_bf16 v[80:83], a[40:43], a[216:219], v[80:83]
v_mfma_f32_16x16x32_bf16 v[80:83], a[44:47], a[220:223], v[80:83]
ds_read_b128 a[240:243], v10 offset:16384
v_mfma_f32_16x16x32_bf16 v[84:87], a[112:115], a[216:219], v[84:87]
v_mfma_f32_16x16x32_bf16 v[84:87], a[116:119], a[220:223], v[84:87]
ds_read_b128 a[244:247], v10 offset:24576
s_waitcnt lgkmcnt(4)
v_mfma_f32_16x16x32_bf16 v[88:91], a[40:43], a[224:227], v[88:91]
v_mfma_f32_16x16x32_bf16 v[88:91], a[44:47], a[228:231], v[88:91]
ds_read_b128 a[216:219], v4 offset:32768
v_mfma_f32_16x16x32_bf16 v[92:95], a[112:115], a[224:227], v[92:95]
v_mfma_f32_16x16x32_bf16 v[92:95], a[116:119], a[228:231], v[92:95]
ds_read_b128 a[220:223], v4 offset:40960
s_waitcnt lgkmcnt(4)
v_mfma_f32_16x16x32_bf16 v[96:99], a[232:235], a[184:187], v[96:99]
ds_read_b128 a[224:227], v4 offset:33792
v_mfma_f32_16x16x32_bf16 v[96:99], a[236:239], a[188:191], v[96:99]
ds_read_b128 a[228:231], v4 offset:41984
s_waitcnt lgkmcnt(4)
v_mfma_f32_16x16x32_bf16 v[100:103], a[184:187], a[240:243], v[100:103]
ds_read_b128 a[232:235], v4 offset:34816
v_mfma_f32_16x16x32_bf16 v[100:103], a[188:191], a[244:247], v[100:103]
ds_read_b128 a[236:239], v4 offset:43008
s_waitcnt vmcnt(32)
s_waitcnt lgkmcnt(4)
v_mfma_f32_16x16x32_bf16 v[32:35], a[216:219], a[48:51], v[32:35]
v_mfma_f32_16x16x32_bf16 v[32:35], a[220:223], a[52:55], v[32:35]
ds_read_b128 a[240:243], v4 offset:35840
v_mfma_f32_16x16x32_bf16 v[36:39], a[216:219], a[120:123], v[36:39]
v_mfma_f32_16x16x32_bf16 v[36:39], a[220:223], a[124:127], v[36:39]
ds_read_b128 a[244:247], v4 offset:44032
s_waitcnt lgkmcnt(4)
v_mfma_f32_16x16x32_bf16 v[40:43], a[224:227], a[48:51], v[40:43]
v_mfma_f32_16x16x32_bf16 v[40:43], a[228:231], a[52:55], v[40:43]
ds_read_b128 a[216:219], v4 offset:36864
v_mfma_f32_16x16x32_bf16 v[44:47], a[224:227], a[120:123], v[44:47]
v_mfma_f32_16x16x32_bf16 v[44:47], a[228:231], a[124:127], v[44:47]
ds_read_b128 a[220:223], v4 offset:45056
s_waitcnt lgkmcnt(4)
v_mfma_f32_16x16x32_bf16 v[48:51], a[232:235], a[48:51], v[48:51]
v_mfma_f32_16x16x32_bf16 v[48:51], a[236:239], a[52:55], v[48:51]
ds_read_b128 a[224:227], v4 offset:37888
v_mfma_f32_16x16x32_bf16 v[52:55], a[232:235], a[120:123], v[52:55]
v_mfma_f32_16x16x32_bf16 v[52:55], a[236:239], a[124:127], v[52:55]
ds_read_b128 a[228:231], v4 offset:46080
s_waitcnt lgkmcnt(4)
v_mfma_f32_16x16x32_bf16 v[56:59], a[240:243], a[48:51], v[56:59]
v_mfma_f32_16x16x32_bf16 v[56:59], a[244:247], a[52:55], v[56:59]
ds_read_b128 a[232:235], v4 offset:38912
v_mfma_f32_16x16x32_bf16 v[60:63], a[240:243], a[120:123], v[60:63]
v_mfma_f32_16x16x32_bf16 v[60:63], a[244:247], a[124:127], v[60:63]
ds_read_b128 a[236:239], v4 offset:47104
s_waitcnt lgkmcnt(4)
v_mfma_f32_16x16x32_bf16 v[64:67], a[216:219], a[48:51], v[64:67]
v_mfma_f32_16x16x32_bf16 v[64:67], a[220:223], a[52:55], v[64:67]
ds_read_b128 a[240:243], v4 offset:39936
v_mfma_f32_16x16x32_bf16 v[68:71], a[216:219], a[120:123], v[68:71]
v_mfma_f32_16x16x32_bf16 v[68:71], a[220:223], a[124:127], v[68:71]
ds_read_b128 a[244:247], v4 offset:48128
s_waitcnt lgkmcnt(4)
v_mfma_f32_16x16x32_bf16 v[72:75], a[48:51], a[224:227], v[72:75]
v_mfma_f32_16x16x32_bf16 v[72:75], a[52:55], a[228:231], v[72:75]
ds_read_b128 a[216:219], v7 offset:32768
v_mfma_f32_16x16x32_bf16 v[76:79], a[120:123], a[224:227], v[76:79]
v_mfma_f32_16x16x32_bf16 v[76:79], a[124:127], a[228:231], v[76:79]
ds_read_b128 a[220:223], v7 offset:40960
s_waitcnt lgkmcnt(4)
v_mfma_f32_16x16x32_bf16 v[80:83], a[48:51], a[232:235], v[80:83]
v_mfma_f32_16x16x32_bf16 v[80:83], a[52:55], a[236:239], v[80:83]
ds_read_b128 a[224:227], v10 offset:32768
v_mfma_f32_16x16x32_bf16 v[84:87], a[120:123], a[232:235], v[84:87]
v_mfma_f32_16x16x32_bf16 v[84:87], a[124:127], a[236:239], v[84:87]
ds_read_b128 a[228:231], v10 offset:40960
s_waitcnt lgkmcnt(4)
v_mfma_f32_16x16x32_bf16 v[88:91], a[48:51], a[240:243], v[88:91]
v_mfma_f32_16x16x32_bf16 v[88:91], a[52:55], a[244:247], v[88:91]
ds_read_b128 a[232:235], v4 offset:49152
v_mfma_f32_16x16x32_bf16 v[92:95], a[120:123], a[240:243], v[92:95]
v_mfma_f32_16x16x32_bf16 v[92:95], a[124:127], a[244:247], v[92:95]
ds_read_b128 a[236:239], v4 offset:57344
s_waitcnt lgkmcnt(4)
v_mfma_f32_16x16x32_bf16 v[96:99], a[216:219], a[192:195], v[96:99]
ds_read_b128 a[240:243], v4 offset:50176
v_mfma_f32_16x16x32_bf16 v[96:99], a[220:223], a[196:199], v[96:99]
ds_read_b128 a[244:247], v4 offset:58368
s_waitcnt lgkmcnt(4)
v_mfma_f32_16x16x32_bf16 v[100:103], a[192:195], a[224:227], v[100:103]
ds_read_b128 a[216:219], v4 offset:51200
v_mfma_f32_16x16x32_bf16 v[100:103], a[196:199], a[228:231], v[100:103]
ds_read_b128 a[220:223], v4 offset:59392
s_waitcnt vmcnt(26)
s_waitcnt lgkmcnt(4)
v_mfma_f32_16x16x32_bf16 v[32:35], a[232:235], a[56:59], v[32:35]
v_mfma_f32_16x16x32_bf16 v[32:35], a[236:239], a[60:63], v[32:35]
ds_read_b128 a[224:227], v4 offset:52224
v_mfma_f32_16x16x32_bf16 v[36:39], a[232:235], a[128:131], v[36:39]
v_mfma_f32_16x16x32_bf16 v[36:39], a[236:239], a[132:135], v[36:39]
ds_read_b128 a[228:231], v4 offset:60416
s_waitcnt lgkmcnt(4)
v_mfma_f32_16x16x32_bf16 v[40:43], a[240:243], a[56:59], v[40:43]
v_mfma_f32_16x16x32_bf16 v[40:43], a[244:247], a[60:63], v[40:43]
ds_read_b128 a[232:235], v4 offset:53248
v_mfma_f32_16x16x32_bf16 v[44:47], a[240:243], a[128:131], v[44:47]
v_mfma_f32_16x16x32_bf16 v[44:47], a[244:247], a[132:135], v[44:47]
ds_read_b128 a[236:239], v4 offset:61440
s_waitcnt lgkmcnt(4)
v_mfma_f32_16x16x32_bf16 v[48:51], a[216:219], a[56:59], v[48:51]
v_mfma_f32_16x16x32_bf16 v[48:51], a[220:223], a[60:63], v[48:51]
ds_read_b128 a[240:243], v4 offset:54272
v_mfma_f32_16x16x32_bf16 v[52:55], a[216:219], a[128:131], v[52:55]
v_mfma_f32_16x16x32_bf16 v[52:55], a[220:223], a[132:135], v[52:55]
ds_read_b128 a[244:247], v4 offset:62464
s_waitcnt lgkmcnt(4)
v_mfma_f32_16x16x32_bf16 v[56:59], a[224:227], a[56:59], v[56:59]
v_mfma_f32_16x16x32_bf16 v[56:59], a[228:231], a[60:63], v[56:59]
ds_read_b128 a[216:219], v4 offset:55296
v_mfma_f32_16x16x32_bf16 v[60:63], a[224:227], a[128:131], v[60:63]
v_mfma_f32_16x16x32_bf16 v[60:63], a[228:231], a[132:135], v[60:63]
ds_read_b128 a[220:223], v4 offset:63488
s_waitcnt lgkmcnt(4)
v_mfma_f32_16x16x32_bf16 v[64:67], a[232:235], a[56:59], v[64:67]
v_mfma_f32_16x16x32_bf16 v[64:67], a[236:239], a[60:63], v[64:67]
ds_read_b128 a[224:227], v4 offset:56320
v_mfma_f32_16x16x32_bf16 v[68:71], a[232:235], a[128:131], v[68:71]
v_mfma_f32_16x16x32_bf16 v[68:71], a[236:239], a[132:135], v[68:71]
ds_read_b128 a[228:231], v4 offset:64512
s_waitcnt lgkmcnt(4)
v_mfma_f32_16x16x32_bf16 v[72:75], a[56:59], a[240:243], v[72:75]
v_mfma_f32_16x16x32_bf16 v[72:75], a[60:63], a[244:247], v[72:75]
ds_read_b128 a[232:235], v7 offset:49152
v_mfma_f32_16x16x32_bf16 v[76:79], a[128:131], a[240:243], v[76:79]
v_mfma_f32_16x16x32_bf16 v[76:79], a[132:135], a[244:247], v[76:79]
ds_read_b128 a[236:239], v7 offset:57344
s_waitcnt lgkmcnt(4)
v_mfma_f32_16x16x32_bf16 v[80:83], a[56:59], a[216:219], v[80:83]
v_mfma_f32_16x16x32_bf16 v[80:83], a[60:63], a[220:223], v[80:83]
ds_read_b128 a[240:243], v10 offset:49152
v_mfma_f32_16x16x32_bf16 v[84:87], a[128:131], a[216:219], v[84:87]
v_mfma_f32_16x16x32_bf16 v[84:87], a[132:135], a[220:223], v[84:87]
ds_read_b128 a[244:247], v10 offset:57344
s_waitcnt lgkmcnt(4)
v_mfma_f32_16x16x32_bf16 v[88:91], a[56:59], a[224:227], v[88:91]
v_mfma_f32_16x16x32_bf16 v[88:91], a[60:63], a[228:231], v[88:91]
ds_read_b128 a[216:219], v5 offset:0
v_mfma_f32_16x16x32_bf16 v[92:95], a[128:131], a[224:227], v[92:95]
v_mfma_f32_16x16x32_bf16 v[92:95], a[132:135], a[228:231], v[92:95]
ds_read_b128 a[220:223], v5 offset:8192
s_waitcnt lgkmcnt(4)
v_mfma_f32_16x16x32_bf16 v[96:99], a[232:235], a[200:203], v[96:99]
ds_read_b128 a[224:227], v5 offset:1024
v_mfma_f32_16x16x32_bf16 v[96:99], a[236:239], a[204:207], v[96:99]
ds_read_b128 a[228:231], v5 offset:9216
s_waitcnt lgkmcnt(4)
v_mfma_f32_16x16x32_bf16 v[100:103], a[200:203], a[240:243], v[100:103]
ds_read_b128 a[232:235], v5 offset:2048
v_mfma_f32_16x16x32_bf16 v[100:103], a[204:207], a[244:247], v[100:103]
ds_read_b128 a[236:239], v5 offset:10240
s_waitcnt vmcnt(20)
s_waitcnt lgkmcnt(4)
v_mfma_f32_16x16x32_bf16 v[32:35], a[216:219], a[64:67], v[32:35]
v_mfma_f32_16x16x32_bf16 v[32:35], a[220:223], a[68:71], v[32:35]
ds_read_b128 a[240:243], v5 offset:3072
v_mfma_f32_16x16x32_bf16 v[36:39], a[216:219], a[136:139], v[36:39]
v_mfma_f32_16x16x32_bf16 v[36:39], a[220:223], a[140:143], v[36:39]
ds_read_b128 a[244:247], v5 offset:11264
s_waitcnt lgkmcnt(4)
v_mfma_f32_16x16x32_bf16 v[40:43], a[224:227], a[64:67], v[40:43]
v_mfma_f32_16x16x32_bf16 v[40:43], a[228:231], a[68:71], v[40:43]
ds_read_b128 a[216:219], v5 offset:4096
v_mfma_f32_16x16x32_bf16 v[44:47], a[224:227], a[136:139], v[44:47]
v_mfma_f32_16x16x32_bf16 v[44:47], a[228:231], a[140:143], v[44:47]
ds_read_b128 a[220:223], v5 offset:12288
s_waitcnt lgkmcnt(4)
v_mfma_f32_16x16x32_bf16 v[48:51], a[232:235], a[64:67], v[48:51]
v_mfma_f32_16x16x32_bf16 v[48:51], a[236:239], a[68:71], v[48:51]
ds_read_b128 a[224:227], v5 offset:5120
v_mfma_f32_16x16x32_bf16 v[52:55], a[232:235], a[136:139], v[52:55]
v_mfma_f32_16x16x32_bf16 v[52:55], a[236:239], a[140:143], v[52:55]
ds_read_b128 a[228:231], v5 offset:13312
s_waitcnt lgkmcnt(4)
v_mfma_f32_16x16x32_bf16 v[56:59], a[240:243], a[64:67], v[56:59]
v_mfma_f32_16x16x32_bf16 v[56:59], a[244:247], a[68:71], v[56:59]
ds_read_b128 a[232:235], v5 offset:6144
v_mfma_f32_16x16x32_bf16 v[60:63], a[240:243], a[136:139], v[60:63]
v_mfma_f32_16x16x32_bf16 v[60:63], a[244:247], a[140:143], v[60:63]
ds_read_b128 a[236:239], v5 offset:14336
s_waitcnt lgkmcnt(4)
v_mfma_f32_16x16x32_bf16 v[64:67], a[216:219], a[64:67], v[64:67]
v_mfma_f32_16x16x32_bf16 v[64:67], a[220:223], a[68:71], v[64:67]
ds_read_b128 a[240:243], v5 offset:7168
v_mfma_f32_16x16x32_bf16 v[68:71], a[216:219], a[136:139], v[68:71]
v_mfma_f32_16x16x32_bf16 v[68:71], a[220:223], a[140:143], v[68:71]
ds_read_b128 a[244:247], v5 offset:15360
s_waitcnt lgkmcnt(4)
v_mfma_f32_16x16x32_bf16 v[72:75], a[64:67], a[224:227], v[72:75]
v_mfma_f32_16x16x32_bf16 v[72:75], a[68:71], a[228:231], v[72:75]
ds_read_b128 a[216:219], v8 offset:0
v_mfma_f32_16x16x32_bf16 v[76:79], a[136:139], a[224:227], v[76:79]
v_mfma_f32_16x16x32_bf16 v[76:79], a[140:143], a[228:231], v[76:79]
ds_read_b128 a[220:223], v8 offset:8192
s_waitcnt lgkmcnt(4)
v_mfma_f32_16x16x32_bf16 v[80:83], a[64:67], a[232:235], v[80:83]
v_mfma_f32_16x16x32_bf16 v[80:83], a[68:71], a[236:239], v[80:83]
ds_read_b128 a[224:227], v11 offset:0
v_mfma_f32_16x16x32_bf16 v[84:87], a[136:139], a[232:235], v[84:87]
v_mfma_f32_16x16x32_bf16 v[84:87], a[140:143], a[236:239], v[84:87]
ds_read_b128 a[228:231], v11 offset:8192
s_waitcnt lgkmcnt(4)
v_mfma_f32_16x16x32_bf16 v[88:91], a[64:67], a[240:243], v[88:91]
v_mfma_f32_16x16x32_bf16 v[88:91], a[68:71], a[244:247], v[88:91]
v_mfma_f32_16x16x32_bf16 v[92:95], a[136:139], a[240:243], v[92:95]
v_mfma_f32_16x16x32_bf16 v[92:95], a[140:143], a[244:247], v[92:95]
s_waitcnt lgkmcnt(2)
v_mfma_f32_16x16x32_bf16 v[96:99], a[216:219], a[208:211], v[96:99]
v_mfma_f32_16x16x32_bf16 v[96:99], a[220:223], a[212:215], v[96:99]
s_waitcnt lgkmcnt(0)
v_mfma_f32_16x16x32_bf16 v[100:103], a[208:211], a[224:227], v[100:103]
v_mfma_f32_16x16x32_bf16 v[100:103], a[212:215], a[228:231], v[100:103]
L_att:
v_cvt_pk_bf16_f32 v116, v52, v53
v_cvt_pk_bf16_f32 v117, v54, v55
v_cvt_pk_bf16_f32 v120, v60, v61
v_cvt_pk_bf16_f32 v121, v62, v63
v_cvt_pk_bf16_f32 v160, v68, v69
v_cvt_pk_bf16_f32 v161, v70, v71
v_cvt_pk_bf16_f32 v126, v76, v77
v_cvt_pk_bf16_f32 v127, v78, v79
v_cvt_pk_bf16_f32 v132, v84, v85
v_cvt_pk_bf16_f32 v133, v86, v87
v_cvt_pk_bf16_f32 v138, v92, v93
v_cvt_pk_bf16_f32 v139, v94, v95
v_cvt_pk_bf16_f32 v156, v96, v97
v_cvt_pk_bf16_f32 v157, v98, v99
v_cvt_pk_bf16_f32 v158, v100, v101
v_cvt_pk_bf16_f32 v159, v102, v103
v_lshlrev_b32 v14, 3, v1
s_mul_i32 s31, s4, 3072
s_add_u32 s32, s31, 147456
v_add_u32 v15, s32, v14
s_lshl_b32 s33, s29, 9
s_add_u32 s33, s33, 147456
v_add_u32 v16, s33, v14
s_cmp_eq_u32 s4, 3
s_cbranch_scc1 L_a1_noxch
ds_write_b64 v16, v[156:157]
ds_write_b64 v16, v[158:159] offset:1536
ds_write_b64 v15, v[116:117] offset:3072
ds_write_b64 v15, v[120:121] offset:3584
ds_write_b64 v15, v[160:161] offset:4096
ds_write_b64 v15, v[126:127] offset:4608
ds_write_b64 v15, v[132:133] offset:5120
ds_write_b64 v15, v[138:139] offset:5632
L_a1_noxch:
v_cvt_pk_bf16_f32 v110, v48, v49
v_cvt_pk_bf16_f32 v111, v50, v51
v_cvt_pk_bf16_f32 v114, v56, v57
v_cvt_pk_bf16_f32 v115, v58, v59
v_cvt_pk_bf16_f32 v124, v72, v73
v_cvt_pk_bf16_f32 v125, v74, v75
v_cvt_pk_bf16_f32 v130, v80, v81
v_cvt_pk_bf16_f32 v131, v82, v83
v_cvt_pk_bf16_f32 v136, v88, v89
v_cvt_pk_bf16_f32 v137, v90, v91
v_cvt_pk_bf16_f32 v140, v32, v33
v_cvt_pk_bf16_f32 v141, v34, v35
v_cvt_pk_bf16_f32 v146, v40, v41
v_cvt_pk_bf16_f32 v147, v42, v43
v_cvt_pk_bf16_f32 v142, v64, v65
v_cvt_pk_bf16_f32 v145, v66, v67
v_mov_b32 v143, 0
v_mov_b32 v144, 0
v_mov_b32 v112, 0
v_mov_b32 v113, 0
s_nop 0
v_permlane16_swap_b32 v142, v112
v_permlane16_swap_b32 v145, v113
v_cvt_pk_bf16_f32 v148, v36, v37
v_cvt_pk_bf16_f32 v149, v38, v39
v_cvt_pk_bf16_f32 v154, v44, v45
v_cvt_pk_bf16_f32 v155, v46, v47
v_cvt_pk_bf16_f32 v150, v68, v69
v_cvt_pk_bf16_f32 v153, v70, v71
v_mov_b32 v151, 0
v_mov_b32 v152, 0
v_mov_b32 v118, 0
v_mov_b32 v119, 0
s_nop 0
v_permlane16_swap_b32 v150, v118
v_permlane16_swap_b32 v153, v119
v_add_u32 v17, 16, v12
v_add_u32 v18, 32, v12
v_cmp_gt_u32 vcc, 16, v1
s_nop 1
v_cndmask_b32 v17, v18, v17, vcc
v_lshlrev_b32 v17, 3, v17
v_add_u32 v17, s32, v17
s_waitcnt lgkmcnt(0)
s_barrier
ds_read_b64 v[104:105], v15
ds_read_b64 v[108:109], v15 offset:512
ds_read_b64 v[106:107], v17 offset:1024
ds_read_b64 v[122:123], v15 offset:1536
ds_read_b64 v[128:129], v15 offset:2048
ds_read_b64 v[134:135], v15 offset:2560
v_mfma_f32_16x16x32_bf16 v[32:35], v[110:113], v[148:151], 0
v_mfma_f32_16x16x32_bf16 v[36:39], v[116:119], v[148:151], 0
v_mfma_f32_16x16x32_bf16 v[40:43], v[112:115], v[152:155], 0
v_mfma_f32_16x16x32_bf16 v[44:47], v[118:121], v[152:155], 0
s_waitcnt lgkmcnt(0)
v_mfma_f32_16x16x32_bf16 v[48:51], v[104:107], v[140:143], 0
v_mfma_f32_16x16x32_bf16 v[52:55], v[110:113], v[140:143], 0
v_mfma_f32_16x16x32_bf16 v[56:59], v[106:109], v[144:147], 0
v_mfma_f32_16x16x32_bf16 v[60:63], v[112:115], v[144:147], 0
v_mov_b32 v18, 0xff61b1e6
s_mov_b32 s34, 0x3eae1a93
v_cndmask_b32 v32, v18, v32, s[44:45]
v_cndmask_b32 v40, v18, v40, s[44:45]
s_nop 0
v_cndmask_b32 v48, v18, v48, s[60:61]
s_nop 0
v_cndmask_b32 v56, v18, v56, s[60:61]
v_cndmask_b32 v33, v18, v33, s[46:47]
v_cndmask_b32 v41, v18, v41, s[46:47]
v_cndmask_b32 v49, v18, v49, s[62:63]
v_cndmask_b32 v57, v18, v57, s[62:63]
v_cndmask_b32 v34, v18, v34, s[48:49]
v_cndmask_b32 v42, v18, v42, s[48:49]
v_cndmask_b32 v50, v18, v50, s[64:65]
v_cndmask_b32 v58, v18, v58, s[64:65]
v_cndmask_b32 v35, v18, v35, s[50:51]
v_cndmask_b32 v43, v18, v43, s[50:51]
v_cndmask_b32 v51, v18, v51, s[66:67]
v_cndmask_b32 v59, v18, v59, s[66:67]
v_cndmask_b32 v36, v18, v36, s[52:53]
v_cndmask_b32 v44, v18, v44, s[52:53]
v_cndmask_b32 v52, v18, v52, s[52:53]
v_cndmask_b32 v60, v18, v60, s[52:53]
v_cndmask_b32 v37, v18, v37, s[54:55]
v_cndmask_b32 v45, v18, v45, s[54:55]
v_cndmask_b32 v53, v18, v53, s[54:55]
v_cndmask_b32 v61, v18, v61, s[54:55]
v_cndmask_b32 v38, v18, v38, s[56:57]
v_cndmask_b32 v46, v18, v46, s[56:57]
v_cndmask_b32 v54, v18, v54, s[56:57]
v_cndmask_b32 v62, v18, v62, s[56:57]
v_cndmask_b32 v39, v18, v39, s[58:59]
v_cndmask_b32 v47, v18, v47, s[58:59]
v_cndmask_b32 v55, v18, v55, s[58:59]
v_cndmask_b32 v63, v18, v63, s[58:59]
v_max3_f32 v20, v32, v33, v34
v_max3_f32 v21, v40, v41, v42
v_max3_f32 v22, v48, v49, v50
v_max3_f32 v23, v56, v57, v58
v_max3_f32 v20, v20, v35, v36
v_max3_f32 v21, v21, v43, v44
v_max3_f32 v22, v22, v51, v52
v_max3_f32 v23, v23, v59, v60
v_max3_f32 v20, v20, v37, v38
v_max3_f32 v21, v21, v45, v46
v_max3_f32 v22, v22, v53, v54
v_max3_f32 v23, v23, v61, v62
v_max_f32 v20, v20, v39
v_max_f32 v21, v21, v47
v_max_f32 v22, v22, v55
v_max_f32 v23, v23, v63
v_mov_b32 v24, v20
v_mov_b32 v25, v21
v_mov_b32 v26, v22
v_mov_b32 v27, v23
v_permlane16_swap_b32 v20, v24
v_permlane16_swap_b32 v21, v25
v_permlane16_swap_b32 v22, v26
v_permlane16_swap_b32 v23, v27
v_max_f32 v20, v20, v24
v_max_f32 v21, v21, v25
v_max_f32 v22, v22, v26
v_max_f32 v23, v23, v27
v_mov_b32 v24, v20
v_mov_b32 v25, v21
v_mov_b32 v26, v22
v_mov_b32 v27, v23
v_permlane32_swap_b32 v20, v24
v_permlane32_swap_b32 v21, v25
v_permlane32_swap_b32 v22, v26
v_permlane32_swap_b32 v23, v27
v_max_f32 v20, v20, v24
v_max_f32 v21, v21, v25
v_max_f32 v22, v22, v26
v_max_f32 v23, v23, v27
v_mul_f32 v20, s34, v20
v_mul_f32 v21, s34, v21
v_mul_f32 v22, s34, v22
v_mul_f32 v23, s34, v23
v_fma_f32 v32, v32, s34, -v20
v_fma_f32 v40, v40, s34, -v21
v_fma_f32 v48, v48, s34, -v22
v_fma_f32 v56, v56, s34, -v23
v_exp_f32 v32, v32
v_exp_f32 v40, v40
v_exp_f32 v48, v48
v_exp_f32 v56, v56
v_fma_f32 v33, v33, s34, -v20
v_fma_f32 v41, v41, s34, -v21
v_fma_f32 v49, v49, s34, -v22
v_fma_f32 v57, v57, s34, -v23
v_exp_f32 v33, v33
v_exp_f32 v41, v41
v_exp_f32 v49, v49
v_exp_f32 v57, v57
v_fma_f32 v34, v34, s34, -v20
v_fma_f32 v42, v42, s34, -v21
v_fma_f32 v50, v50, s34, -v22
v_fma_f32 v58, v58, s34, -v23
v_exp_f32 v34, v34
v_exp_f32 v42, v42
v_exp_f32 v50, v50
v_exp_f32 v58, v58
v_fma_f32 v35, v35, s34, -v20
v_fma_f32 v43, v43, s34, -v21
v_fma_f32 v51, v51, s34, -v22
v_fma_f32 v59, v59, s34, -v23
v_exp_f32 v35, v35
v_exp_f32 v43, v43
v_exp_f32 v51, v51
v_exp_f32 v59, v59
v_fma_f32 v36, v36, s34, -v20
v_fma_f32 v44, v44, s34, -v21
v_fma_f32 v52, v52, s34, -v22
v_fma_f32 v60, v60, s34, -v23
v_exp_f32 v36, v36
v_exp_f32 v44, v44
v_exp_f32 v52, v52
v_exp_f32 v60, v60
v_fma_f32 v37, v37, s34, -v20
v_fma_f32 v45, v45, s34, -v21
v_fma_f32 v53, v53, s34, -v22
v_fma_f32 v61, v61, s34, -v23
v_exp_f32 v37, v37
v_exp_f32 v45, v45
v_exp_f32 v53, v53
v_exp_f32 v61, v61
v_fma_f32 v38, v38, s34, -v20
v_fma_f32 v46, v46, s34, -v21
v_fma_f32 v54, v54, s34, -v22
v_fma_f32 v62, v62, s34, -v23
v_exp_f32 v38, v38
v_exp_f32 v46, v46
v_exp_f32 v54, v54
v_exp_f32 v62, v62
v_fma_f32 v39, v39, s34, -v20
v_fma_f32 v47, v47, s34, -v21
v_fma_f32 v55, v55, s34, -v22
v_fma_f32 v63, v63, s34, -v23
v_exp_f32 v39, v39
v_exp_f32 v47, v47
v_exp_f32 v55, v55
v_exp_f32 v63, v63
v_add_f32 v28, v32, v33
v_add_f32 v29, v40, v41
v_add_f32 v30, v48, v49
v_add_f32 v31, v56, v57
v_add_f32 v28, v28, v34
v_add_f32 v29, v29, v42
v_add_f32 v30, v30, v50
v_add_f32 v31, v31, v58
v_add_f32 v28, v28, v35
v_add_f32 v29, v29, v43
v_add_f32 v30, v30, v51
v_add_f32 v31, v31, v59
v_add_f32 v28, v28, v36
v_add_f32 v29, v29, v44
v_add_f32 v30, v30, v52
v_add_f32 v31, v31, v60
v_add_f32 v28, v28, v37
v_add_f32 v29, v29, v45
v_add_f32 v30, v30, v53
v_add_f32 v31, v31, v61
v_add_f32 v28, v28, v38
v_add_f32 v29, v29, v46
v_add_f32 v30, v30, v54
v_add_f32 v31, v31, v62
v_add_f32 v28, v28, v39
v_add_f32 v29, v29, v47
v_add_f32 v30, v30, v55
v_add_f32 v31, v31, v63
v_mov_b32 v24, v28
v_mov_b32 v25, v29
v_mov_b32 v26, v30
v_mov_b32 v27, v31
v_permlane16_swap_b32 v28, v24
v_permlane16_swap_b32 v29, v25
v_permlane16_swap_b32 v30, v26
v_permlane16_swap_b32 v31, v27
v_add_f32 v28, v28, v24
v_add_f32 v29, v29, v25
v_add_f32 v30, v30, v26
v_add_f32 v31, v31, v27
v_mov_b32 v24, v28
v_mov_b32 v25, v29
v_mov_b32 v26, v30
v_mov_b32 v27, v31
v_permlane32_swap_b32 v28, v24
v_permlane32_swap_b32 v29, v25
v_permlane32_swap_b32 v30, v26
v_permlane32_swap_b32 v31, v27
v_add_f32 v28, v28, v24
v_add_f32 v29, v29, v25
v_add_f32 v30, v30, v26
v_add_f32 v31, v31, v27
v_rcp_f32 v28, v28
v_rcp_f32 v29, v29
v_rcp_f32 v30, v30
v_rcp_f32 v31, v31
v_mul_f32 v32, v32, v28
v_mul_f32 v40, v40, v29
v_mul_f32 v48, v48, v30
v_mul_f32 v56, v56, v31
v_mul_f32 v33, v33, v28
v_mul_f32 v41, v41, v29
v_mul_f32 v49, v49, v30
v_mul_f32 v57, v57, v31
v_mul_f32 v34, v34, v28
v_mul_f32 v42, v42, v29
v_mul_f32 v50, v50, v30
v_mul_f32 v58, v58, v31
v_mul_f32 v35, v35, v28
v_mul_f32 v43, v43, v29
v_mul_f32 v51, v51, v30
v_mul_f32 v59, v59, v31
v_mul_f32 v36, v36, v28
v_mul_f32 v44, v44, v29
v_mul_f32 v52, v52, v30
v_mul_f32 v60, v60, v31
v_mul_f32 v37, v37, v28
v_mul_f32 v45, v45, v29
v_mul_f32 v53, v53, v30
v_mul_f32 v61, v61, v31
v_mul_f32 v38, v38, v28
v_mul_f32 v46, v46, v29
v_mul_f32 v54, v54, v30
v_mul_f32 v62, v62, v31
v_mul_f32 v39, v39, v28
v_mul_f32 v47, v47, v29
v_mul_f32 v55, v55, v30
v_mul_f32 v63, v63, v31
v_cvt_pk_bf16_f32 v64, v32, v33
v_cvt_pk_bf16_f32 v65, v34, v35
v_cvt_pk_bf16_f32 v66, v36, v37
v_cvt_pk_bf16_f32 v67, v38, v39
v_cvt_pk_bf16_f32 v68, v40, v41
v_cvt_pk_bf16_f32 v69, v42, v43
v_cvt_pk_bf16_f32 v70, v44, v45
v_cvt_pk_bf16_f32 v71, v46, v47
v_cvt_pk_bf16_f32 v72, v48, v49
v_cvt_pk_bf16_f32 v73, v50, v51
v_cvt_pk_bf16_f32 v74, v52, v53
v_cvt_pk_bf16_f32 v75, v54, v55
v_cvt_pk_bf16_f32 v76, v56, v57
v_cvt_pk_bf16_f32 v77, v58, v59
v_cvt_pk_bf16_f32 v78, v60, v61
v_cvt_pk_bf16_f32 v79, v62, v63
v_mfma_f32_16x16x32_bf16 v[80:83], v[124:127], v[64:67], 0
v_mfma_f32_16x16x32_bf16 v[84:87], v[136:139], v[64:67], 0
v_mfma_f32_16x16x32_bf16 v[88:91], v[130:133], v[68:71], 0
v_mfma_f32_16x16x32_bf16 v[92:95], v[136:139], v[68:71], 0
v_mfma_f32_16x16x32_bf16 v[96:99], v[122:125], v[72:75], 0
v_mfma_f32_16x16x32_bf16 v[100:103], v[134:137], v[72:75], 0
v_mfma_f32_16x16x32_bf16 v[164:167], v[128:131], v[76:79], 0
v_mfma_f32_16x16x32_bf16 v[168:171], v[134:137], v[76:79], 0
v_lshlrev_b32 v14, 3, v12
v_mov_b32 v15, 2146435072
v_cmp_gt_u32 vcc, 16, v1
s_nop 1
v_cndmask_b32 v14, v15, v14, vcc
s_add_u32 s26, s24, s72
s_lshl_b32 s27, s21, 10
s_add_u32 s27, s27, s26
s_lshl_b32 s28, s21, 7
s_add_u32 s28, s28, 16384
s_add_u32 s28, s28, s26
s_add_u32 s30, s27, 18432
s_add_u32 s31, s28, 18432
v_cvt_pk_bf16_f32 v180, v80, v81
v_cvt_pk_bf16_f32 v181, v82, v83
v_cvt_pk_bf16_f32 v182, v88, v89
v_cvt_pk_bf16_f32 v183, v90, v91
v_cvt_pk_bf16_f32 v184, v84, v85
v_cvt_pk_bf16_f32 v185, v94, v95
buffer_store_dwordx4 v[180:183], v2, s[8:11], s30 offen sc1
buffer_store_dwordx2 v[184:185], v14, s[8:11], s31 offen sc1
v_cvt_pk_bf16_f32 v172, v96, v97
v_cvt_pk_bf16_f32 v173, v98, v99
v_cvt_pk_bf16_f32 v174, v164, v165
v_cvt_pk_bf16_f32 v175, v166, v167
v_cvt_pk_bf16_f32 v176, v100, v101
v_cvt_pk_bf16_f32 v177, v170, v171
buffer_store_dwordx4 v[172:175], v2, s[8:11], s27 offen sc1
buffer_store_dwordx2 v[176:177], v14, s[8:11], s28 offen sc1
s_lshl_b32 s26, s20, 2
s_add_u32 s26, s26, s4
s_lshl_b32 s26, s26, 4
s_add_u32 s26, s26, s21
s_lshl_b32 s26, s26, 7
s_add_u32 s26, s26, s77
s_add_u32 s26, s26, 393216
s_and_b32 s37, s6, 7
s_mul_i32 s37, s37, 92160
s_mul_i32 s38, s4, 23552
s_add_u32 s37, s37, s38
s_add_u32 s37, s37, 6557696
v_mov_b32 v13, 2146435072
v_cmp_eq_u32 vcc, 0, v1
v_mov_b32 v14, s68
v_mov_b32 v15, s69
v_cndmask_b32 v13, v13, 0, vcc
s_add_u32 m0, s38, 0
s_add_u32 s40, s37, 0
buffer_load_dwordx4 v2, s[8:11], s40 offen offset:0 sc1 lds
buffer_load_dwordx4 v2, s[8:11], s40 offen offset:1024 sc1 lds
buffer_load_dwordx4 v2, s[8:11], s40 offen offset:2048 sc1 lds
buffer_load_dwordx4 v2, s[8:11], s40 offen offset:3072 sc1 lds
s_add_u32 m0, s38, 4096
s_add_u32 s40, s37, 4096
buffer_load_dwordx4 v2, s[8:11], s40 offen offset:0 sc1 lds
buffer_load_dwordx4 v2, s[8:11], s40 offen offset:1024 sc1 lds
buffer_load_dwordx4 v2, s[8:11], s40 offen offset:2048 sc1 lds
buffer_load_dwordx4 v2, s[8:11], s40 offen offset:3072 sc1 lds
s_waitcnt vmcnt(8)
buffer_store_dwordx2 v[14:15], v13, s[8:11], s26 offen sc1
s_add_u32 m0, s38, 8192
s_add_u32 s40, s37, 8192
buffer_load_dwordx4 v2, s[8:11], s40 offen offset:0 sc1 lds
buffer_load_dwordx4 v2, s[8:11], s40 offen offset:1024 sc1 lds
buffer_load_dwordx4 v2, s[8:11], s40 offen offset:2048 sc1 lds
buffer_load_dwordx4 v2, s[8:11], s40 offen offset:3072 sc1 lds
s_add_u32 m0, s38, 12288
s_add_u32 s40, s37, 12288
buffer_load_dwordx4 v2, s[8:11], s40 offen offset:0 sc1 lds
buffer_load_dwordx4 v2, s[8:11], s40 offen offset:1024 sc1 lds
buffer_load_dwordx4 v2, s[8:11], s40 offen offset:2048 sc1 lds
buffer_load_dwordx4 v2, s[8:11], s40 offen offset:3072 sc1 lds
s_add_u32 m0, s38, 16384
s_add_u32 s40, s37, 16384
buffer_load_dwordx4 v2, s[8:11], s40 offen offset:0 sc1 lds
buffer_load_dwordx4 v2, s[8:11], s40 offen offset:1024 sc1 lds
buffer_load_dwordx4 v2, s[8:11], s40 offen offset:2048 sc1 lds
buffer_load_dwordx4 v2, s[8:11], s40 offen offset:3072 sc1 lds
s_add_u32 m0, s38, 20480
s_add_u32 s40, s37, 20480
buffer_load_dwordx4 v2, s[8:11], s40 offen offset:0 sc1 lds
buffer_load_dwordx4 v2, s[8:11], s40 offen offset:1024 sc1 lds
buffer_load_dwordx4 v2, s[8:11], s40 offen offset:2048 sc1 lds
s_lshr_b32 s20, s6, 3
s_lshl_b32 s21, s5, 2
s_add_u32 s20, s20, s21
s_lshl_b32 s20, s20, 2
s_add_u32 s20, s20, s4
s_and_b32 s21, s6, 7
s_mul_i32 s24, s20, 18432
s_add_u32 s25, s24, s72
s_mul_i32 s26, s21, 2304
s_add_u32 s26, s26, s24
s_add_u32 s27, s26, s71
v_and_b32 v6, 15, v1
v_lshrrev_b32 v7, 4, v1
v_lshlrev_b32 v8, 4, v6
v_lshl_add_u32 v8, v7, 3, v8
v_add_u32 v8, 2048, v8
v_mov_b32 v9, 2146435072
v_cmp_gt_u32 vcc, 32, v1
s_nop 1
v_cndmask_b32 v4, v9, v8, vcc
v_add_u32 v5, 0x10000, v2
s_lshr_b32 s22, s20, 1
s_lshl_b32 s22, s22, 11
s_add_u32 s22, s22, s77
s_add_u32 s22, s22, 393216
v_lshlrev_b32 v10, 7, v6
s_mul_i32 s30, s2, 7282
s_lshr_b32 s30, s30, 16
s_mul_i32 s31, s30, 9
s_sub_u32 s31, s2, s31
s_lshr_b32 s32, s30, 3
s_and_b32 s30, s30, 7
s_mul_i32 s32, s32, 9
s_add_u32 s31, s31, s32
s_lshl_b32 s30, s30, 5
s_add_u32 s30, s30, s31
s_lshl_b32 s39, s30, 7
s_add_u32 s39, s39, 1966080
s_or_b32 s30, s4, s7
s_cmp_lg_u32 s30, 0
s_cselect_b32 s39, 2146435072, s39
s_cmp_ge_u32 s2, 216
s_cselect_b32 s39, 2146435072, s39
v_lshlrev_b32 v11, 3, v6
v_lshl_add_u32 v11, v7, 8, v11
s_mov_b32 s52, 0
L_poll2:
buffer_load_dwordx2 v[14:15], v10, s[8:11], s22 offen sc1
s_add_u32 s52, s52, 1
s_waitcnt vmcnt(0)
v_cmp_ne_u64 vcc, s[68:69], v[14:15]
s_cmp_ge_u32 s52, 0x100000
s_cbranch_scc1 L_got2
s_and_b64 exec, exec, vcc
s_cbranch_execnz L_poll2
L_got2:
s_mov_b64 exec, -1
buffer_load_dwordx4 a[0:3], v2, s[8:11], s25 offen offset:0 sc1
buffer_load_dwordx4 a[4:7], v2, s[8:11], s25 offen offset:1024 sc1
buffer_load_dwordx4 a[8:11], v2, s[8:11], s25 offen offset:2048 sc1
buffer_load_dwordx4 a[12:15], v2, s[8:11], s25 offen offset:3072 sc1
s_add_u32 s25, s25, 4096
buffer_load_dwordx4 a[16:19], v2, s[8:11], s25 offen offset:0 sc1
buffer_load_dwordx4 a[20:23], v2, s[8:11], s25 offen offset:1024 sc1
buffer_load_dwordx4 a[24:27], v2, s[8:11], s25 offen offset:2048 sc1
buffer_load_dwordx4 a[28:31], v2, s[8:11], s25 offen offset:3072 sc1
s_add_u32 s25, s25, 4096
buffer_load_dwordx4 a[32:35], v2, s[8:11], s25 offen offset:0 sc1
buffer_load_dwordx4 a[36:39], v2, s[8:11], s25 offen offset:1024 sc1
buffer_load_dwordx4 a[40:43], v2, s[8:11], s25 offen offset:2048 sc1
buffer_load_dwordx4 a[44:47], v2, s[8:11], s25 offen offset:3072 sc1
s_barrier
ds_read_b128 a[216:219], v2 offset:0
ds_read_b128 a[220:223], v2 offset:5120
ds_read_b128 a[224:227], v2 offset:1024
ds_read_b128 a[228:231], v2 offset:6144
ds_read_b128 a[232:235], v2 offset:2048
ds_read_b128 a[236:239], v2 offset:7168
v_mov_b32 v13, 2146435072
v_cmp_eq_u32 vcc, 0, v1
v_mov_b32 v14, s68
v_mov_b32 v15, s69
v_cndmask_b32 v13, v13, 0, vcc
buffer_store_dwordx2 v[14:15], v13, s[8:11], s39 offen sc1
s_waitcnt vmcnt(11)
s_waitcnt lgkmcnt(4)
v_mfma_f32_16x16x32_bf16 v[32:35], a[216:219], a[0:3], 0
ds_read_b128 a[240:243], v2 offset:3072
v_mfma_f32_16x16x32_bf16 v[32:35], a[220:223], a[4:7], v[32:35]
ds_read_b128 a[244:247], v2 offset:8192
s_add_u32 s25, s25, 4096
buffer_load_dwordx4 a[48:51], v2, s[8:11], s25 offen offset:0 sc1
s_waitcnt lgkmcnt(4)
v_mfma_f32_16x16x32_bf16 v[36:39], a[224:227], a[0:3], 0
ds_read_b128 a[216:219], v2 offset:4096
v_mfma_f32_16x16x32_bf16 v[36:39], a[228:231], a[4:7], v[36:39]
ds_read_b128 a[220:223], v2 offset:9216
s_waitcnt lgkmcnt(4)
v_mfma_f32_16x16x32_bf16 v[40:43], a[232:235], a[0:3], 0
ds_read_b128 a[224:227], v2 offset:10240
v_mfma_f32_16x16x32_bf16 v[40:43], a[236:239], a[4:7], v[40:43]
ds_read_b128 a[228:231], v2 offset:15360
buffer_load_dwordx4 a[52:55], v2, s[8:11], s25 offen offset:1024 sc1
s_waitcnt lgkmcnt(4)
v_mfma_f32_16x16x32_bf16 v[44:47], a[240:243], a[0:3], 0
ds_read_b128 a[232:235], v2 offset:11264
v_mfma_f32_16x16x32_bf16 v[44:47], a[244:247], a[4:7], v[44:47]
ds_read_b128 a[236:239], v2 offset:16384
s_waitcnt lgkmcnt(4)
v_mfma_f32_16x16x32_bf16 v[48:51], a[216:219], a[0:3], 0
ds_read_b128 a[240:243], v2 offset:12288
v_mfma_f32_16x16x32_bf16 v[48:51], a[220:223], a[4:7], v[48:51]
ds_read_b128 a[244:247], v2 offset:17408
buffer_load_dwordx4 a[56:59], v2, s[8:11], s25 offen offset:2048 sc1
s_waitcnt vmcnt(12)
s_waitcnt lgkmcnt(4)
v_mfma_f32_16x16x32_bf16 v[32:35], a[224:227], a[8:11], v[32:35]
ds_read_b128 a[216:219], v2 offset:13312
v_mfma_f32_16x16x32_bf16 v[32:35], a[228:231], a[12:15], v[32:35]
ds_read_b128 a[220:223], v2 offset:18432
s_waitcnt lgkmcnt(4)
v_mfma_f32_16x16x32_bf16 v[36:39], a[232:235], a[8:11], v[36:39]
ds_read_b128 a[224:227], v2 offset:14336
v_mfma_f32_16x16x32_bf16 v[36:39], a[236:239], a[12:15], v[36:39]
ds_read_b128 a[228:231], v2 offset:19456
buffer_load_dwordx4 a[60:63], v2, s[8:11], s25 offen offset:3072 sc1
s_waitcnt lgkmcnt(4)
v_mfma_f32_16x16x32_bf16 v[40:43], a[240:243], a[8:11], v[40:43]
ds_read_b128 a[232:235], v2 offset:20480
v_mfma_f32_16x16x32_bf16 v[40:43], a[244:247], a[12:15], v[40:43]
ds_read_b128 a[236:239], v2 offset:25600
s_waitcnt lgkmcnt(4)
v_mfma_f32_16x16x32_bf16 v[44:47], a[216:219], a[8:11], v[44:47]
ds_read_b128 a[240:243], v2 offset:21504
v_mfma_f32_16x16x32_bf16 v[44:47], a[220:223], a[12:15], v[44:47]
ds_read_b128 a[244:247], v2 offset:26624
s_add_u32 s25, s25, 4096
buffer_load_dwordx2 a[64:65], v11, s[8:11], s25 offen offset:0 sc1
buffer_load_dwordx2 a[66:67], v11, s[8:11], s25 offen offset:128 sc1
s_waitcnt lgkmcnt(4)
v_mfma_f32_16x16x32_bf16 v[48:51], a[224:227], a[8:11], v[48:51]
ds_read_b128 a[216:219], v2 offset:22528
v_mfma_f32_16x16x32_bf16 v[48:51], a[228:231], a[12:15], v[48:51]
ds_read_b128 a[220:223], v2 offset:27648
s_waitcnt vmcnt(13)
s_waitcnt lgkmcnt(4)
v_mfma_f32_16x16x32_bf16 v[32:35], a[232:235], a[16:19], v[32:35]
ds_read_b128 a[224:227], v2 offset:23552
v_mfma_f32_16x16x32_bf16 v[32:35], a[236:239], a[20:23], v[32:35]
ds_read_b128 a[228:231], v2 offset:28672
buffer_load_dwordx2 a[68:69], v11, s[8:11], s25 offen offset:1024 sc1
buffer_load_dwordx2 a[70:71], v11, s[8:11], s25 offen offset:1152 sc1
s_waitcnt lgkmcnt(4)
v_mfma_f32_16x16x32_bf16 v[36:39], a[240:243], a[16:19], v[36:39]
ds_read_b128 a[232:235], v2 offset:24576
v_mfma_f32_16x16x32_bf16 v[36:39], a[244:247], a[20:23], v[36:39]
ds_read_b128 a[236:239], v2 offset:29696
s_waitcnt lgkmcnt(4)
v_mfma_f32_16x16x32_bf16 v[40:43], a[216:219], a[16:19], v[40:43]
ds_read_b128 a[240:243], v2 offset:30720
v_mfma_f32_16x16x32_bf16 v[40:43], a[220:223], a[20:23], v[40:43]
ds_read_b128 a[244:247], v2 offset:35840
buffer_load_dwordx4 v[56:59], v2, s[8:11], s27 offen sc1
s_waitcnt lgkmcnt(4)
v_mfma_f32_16x16x32_bf16 v[44:47], a[224:227], a[16:19], v[44:47]
ds_read_b128 a[216:219], v2 offset:31744
v_mfma_f32_16x16x32_bf16 v[44:47], a[228:231], a[20:23], v[44:47]
ds_read_b128 a[220:223], v2 offset:36864
s_waitcnt lgkmcnt(4)
v_mfma_f32_16x16x32_bf16 v[48:51], a[232:235], a[16:19], v[48:51]
ds_read_b128 a[224:227], v2 offset:32768
v_mfma_f32_16x16x32_bf16 v[48:51], a[236:239], a[20:23], v[48:51]
ds_read_b128 a[228:231], v2 offset:37888
buffer_load_dwordx4 v[60:63], v2, s[8:11], s27 offen offset:1024 sc1
s_waitcnt vmcnt(15)
s_waitcnt lgkmcnt(4)
v_mfma_f32_16x16x32_bf16 v[32:35], a[240:243], a[24:27], v[32:35]
ds_read_b128 a[232:235], v2 offset:33792
v_mfma_f32_16x16x32_bf16 v[32:35], a[244:247], a[28:31], v[32:35]
ds_read_b128 a[236:239], v2 offset:38912
s_waitcnt lgkmcnt(4)
v_mfma_f32_16x16x32_bf16 v[36:39], a[216:219], a[24:27], v[36:39]
ds_read_b128 a[240:243], v2 offset:34816
v_mfma_f32_16x16x32_bf16 v[36:39], a[220:223], a[28:31], v[36:39]
ds_read_b128 a[244:247], v2 offset:39936
buffer_load_dwordx2 v[64:65], v4, s[8:11], s27 offen sc1
s_waitcnt lgkmcnt(4)
v_mfma_f32_16x16x32_bf16 v[40:43], a[224:227], a[24:27], v[40:43]
ds_read_b128 a[216:219], v2 offset:40960
v_mfma_f32_16x16x32_bf16 v[40:43], a[228:231], a[28:31], v[40:43]
ds_read_b128 a[220:223], v2 offset:46080
s_waitcnt lgkmcnt(4)
v_mfma_f32_16x16x32_bf16 v[44:47], a[232:235], a[24:27], v[44:47]
ds_read_b128 a[224:227], v2 offset:41984
v_mfma_f32_16x16x32_bf16 v[44:47], a[236:239], a[28:31], v[44:47]
ds_read_b128 a[228:231], v2 offset:47104
s_waitcnt lgkmcnt(4)
v_mfma_f32_16x16x32_bf16 v[48:51], a[240:243], a[24:27], v[48:51]
ds_read_b128 a[232:235], v2 offset:43008
v_mfma_f32_16x16x32_bf16 v[48:51], a[244:247], a[28:31], v[48:51]
ds_read_b128 a[236:239], v2 offset:48128
s_waitcnt vmcnt(14)
s_waitcnt lgkmcnt(4)
v_mfma_f32_16x16x32_bf16 v[32:35], a[216:219], a[32:35], v[32:35]
ds_read_b128 a[240:243], v2 offset:44032
v_mfma_f32_16x16x32_bf16 v[32:35], a[220:223], a[36:39], v[32:35]
ds_read_b128 a[244:247], v2 offset:49152
s_waitcnt lgkmcnt(4)
v_mfma_f32_16x16x32_bf16 v[36:39], a[224:227], a[32:35], v[36:39]
ds_read_b128 a[216:219], v2 offset:45056
v_mfma_f32_16x16x32_bf16 v[36:39], a[228:231], a[36:39], v[36:39]
ds_read_b128 a[220:223], v2 offset:50176
s_waitcnt lgkmcnt(4)
v_mfma_f32_16x16x32_bf16 v[40:43], a[232:235], a[32:35], v[40:43]
ds_read_b128 a[224:227], v2 offset:51200
v_mfma_f32_16x16x32_bf16 v[40:43], a[236:239], a[36:39], v[40:43]
ds_read_b128 a[228:231], v2 offset:56320
s_waitcnt lgkmcnt(4)
v_mfma_f32_16x16x32_bf16 v[44:47], a[240:243], a[32:35], v[44:47]
ds_read_b128 a[232:235], v2 offset:52224
v_mfma_f32_16x16x32_bf16 v[44:47], a[244:247], a[36:39], v[44:47]
ds_read_b128 a[236:239], v2 offset:57344
s_waitcnt lgkmcnt(4)
v_mfma_f32_16x16x32_bf16 v[48:51], a[216:219], a[32:35], v[48:51]
ds_read_b128 a[240:243], v2 offset:53248
v_mfma_f32_16x16x32_bf16 v[48:51], a[220:223], a[36:39], v[48:51]
ds_read_b128 a[244:247], v2 offset:58368
s_waitcnt vmcnt(12)
s_waitcnt lgkmcnt(4)
v_mfma_f32_16x16x32_bf16 v[32:35], a[224:227], a[40:43], v[32:35]
ds_read_b128 a[216:219], v2 offset:54272
v_mfma_f32_16x16x32_bf16 v[32:35], a[228:231], a[44:47], v[32:35]
ds_read_b128 a[220:223], v2 offset:59392
s_waitcnt lgkmcnt(4)
v_mfma_f32_16x16x32_bf16 v[36:39], a[232:235], a[40:43], v[36:39]
ds_read_b128 a[224:227], v2 offset:55296
v_mfma_f32_16x16x32_bf16 v[36:39], a[236:239], a[44:47], v[36:39]
ds_read_b128 a[228:231], v2 offset:60416
s_waitcnt lgkmcnt(4)
v_mfma_f32_16x16x32_bf16 v[40:43], a[240:243], a[40:43], v[40:43]
ds_read_b128 a[232:235], v2 offset:61440
v_mfma_f32_16x16x32_bf16 v[40:43], a[244:247], a[44:47], v[40:43]
ds_read_b128 a[236:239], v5 offset:1024
s_waitcnt lgkmcnt(4)
v_mfma_f32_16x16x32_bf16 v[44:47], a[216:219], a[40:43], v[44:47]
ds_read_b128 a[240:243], v2 offset:62464
v_mfma_f32_16x16x32_bf16 v[44:47], a[220:223], a[44:47], v[44:47]
ds_read_b128 a[244:247], v5 offset:2048
s_waitcnt lgkmcnt(4)
v_mfma_f32_16x16x32_bf16 v[48:51], a[224:227], a[40:43], v[48:51]
ds_read_b128 a[216:219], v2 offset:63488
v_mfma_f32_16x16x32_bf16 v[48:51], a[228:231], a[44:47], v[48:51]
ds_read_b128 a[220:223], v5 offset:3072
s_waitcnt vmcnt(9)
s_waitcnt lgkmcnt(4)
v_mfma_f32_16x16x32_bf16 v[32:35], a[232:235], a[48:51], v[32:35]
ds_read_b128 a[224:227], v2 offset:64512
v_mfma_f32_16x16x32_bf16 v[32:35], a[236:239], a[52:55], v[32:35]
ds_read_b128 a[228:231], v5 offset:4096
s_waitcnt lgkmcnt(4)
v_mfma_f32_16x16x32_bf16 v[36:39], a[240:243], a[48:51], v[36:39]
ds_read_b128 a[232:235], v5 offset:0
v_mfma_f32_16x16x32_bf16 v[36:39], a[244:247], a[52:55], v[36:39]
ds_read_b128 a[236:239], v5 offset:5120
s_waitcnt lgkmcnt(4)
v_mfma_f32_16x16x32_bf16 v[40:43], a[216:219], a[48:51], v[40:43]
ds_read_b128 a[240:243], v5 offset:6144
v_mfma_f32_16x16x32_bf16 v[40:43], a[220:223], a[52:55], v[40:43]
ds_read_b128 a[244:247], v5 offset:11264
s_waitcnt lgkmcnt(4)
v_mfma_f32_16x16x32_bf16 v[44:47], a[224:227], a[48:51], v[44:47]
ds_read_b128 a[216:219], v5 offset:7168
v_mfma_f32_16x16x32_bf16 v[44:47], a[228:231], a[52:55], v[44:47]
ds_read_b128 a[220:223], v5 offset:12288
s_waitcnt lgkmcnt(4)
v_mfma_f32_16x16x32_bf16 v[48:51], a[232:235], a[48:51], v[48:51]
ds_read_b128 a[224:227], v5 offset:8192
v_mfma_f32_16x16x32_bf16 v[48:51], a[236:239], a[52:55], v[48:51]
ds_read_b128 a[228:231], v5 offset:13312
s_waitcnt vmcnt(7)
s_waitcnt lgkmcnt(4)
v_mfma_f32_16x16x32_bf16 v[32:35], a[240:243], a[56:59], v[32:35]
ds_read_b128 a[232:235], v5 offset:9216
v_mfma_f32_16x16x32_bf16 v[32:35], a[244:247], a[60:63], v[32:35]
ds_read_b128 a[236:239], v5 offset:14336
s_waitcnt lgkmcnt(4)
v_mfma_f32_16x16x32_bf16 v[36:39], a[216:219], a[56:59], v[36:39]
ds_read_b128 a[240:243], v5 offset:10240
v_mfma_f32_16x16x32_bf16 v[36:39], a[220:223], a[60:63], v[36:39]
ds_read_b128 a[244:247], v5 offset:15360
s_waitcnt lgkmcnt(4)
v_mfma_f32_16x16x32_bf16 v[40:43], a[224:227], a[56:59], v[40:43]
ds_read_b128 a[216:219], v5 offset:16384
v_mfma_f32_16x16x32_bf16 v[40:43], a[228:231], a[60:63], v[40:43]
ds_read_b128 a[220:223], v5 offset:21504
s_waitcnt lgkmcnt(4)
v_mfma_f32_16x16x32_bf16 v[44:47], a[232:235], a[56:59], v[44:47]
ds_read_b128 a[224:227], v5 offset:17408
v_mfma_f32_16x16x32_bf16 v[44:47], a[236:239], a[60:63], v[44:47]
ds_read_b128 a[228:231], v5 offset:22528
s_waitcnt lgkmcnt(4)
v_mfma_f32_16x16x32_bf16 v[48:51], a[240:243], a[56:59], v[48:51]
ds_read_b128 a[232:235], v5 offset:18432
v_mfma_f32_16x16x32_bf16 v[48:51], a[244:247], a[60:63], v[48:51]
ds_read_b128 a[236:239], v5 offset:23552
s_waitcnt vmcnt(3)
s_waitcnt lgkmcnt(4)
v_mfma_f32_16x16x32_bf16 v[32:35], a[216:219], a[64:67], v[32:35]
ds_read_b128 a[240:243], v5 offset:19456
v_mfma_f32_16x16x32_bf16 v[32:35], a[220:223], a[68:71], v[32:35]
ds_read_b128 a[244:247], v5 offset:24576
s_waitcnt lgkmcnt(4)
v_mfma_f32_16x16x32_bf16 v[36:39], a[224:227], a[64:67], v[36:39]
ds_read_b128 a[216:219], v5 offset:20480
v_mfma_f32_16x16x32_bf16 v[36:39], a[228:231], a[68:71], v[36:39]
ds_read_b128 a[220:223], v5 offset:25600
s_waitcnt lgkmcnt(4)
v_mfma_f32_16x16x32_bf16 v[40:43], a[232:235], a[64:67], v[40:43]
v_mfma_f32_16x16x32_bf16 v[40:43], a[236:239], a[68:71], v[40:43]
s_waitcnt lgkmcnt(2)
v_mfma_f32_16x16x32_bf16 v[44:47], a[240:243], a[64:67], v[44:47]
v_mfma_f32_16x16x32_bf16 v[44:47], a[244:247], a[68:71], v[44:47]
s_waitcnt lgkmcnt(0)
v_mfma_f32_16x16x32_bf16 v[48:51], a[216:219], a[64:67], v[48:51]
v_mfma_f32_16x16x32_bf16 v[48:51], a[220:223], a[68:71], v[48:51]
s_waitcnt vmcnt(0)
v_lshlrev_b32 v68, 16, v56
v_and_b32 v69, 0xffff0000, v56
v_add_f32 v32, v32, v68
v_add_f32 v33, v33, v69
v_lshlrev_b32 v70, 16, v57
v_and_b32 v71, 0xffff0000, v57
v_add_f32 v34, v34, v70
v_add_f32 v35, v35, v71
v_lshlrev_b32 v72, 16, v58
v_and_b32 v73, 0xffff0000, v58
v_add_f32 v36, v36, v72
v_add_f32 v37, v37, v73
v_lshlrev_b32 v74, 16, v59
v_and_b32 v75, 0xffff0000, v59
v_add_f32 v38, v38, v74
v_add_f32 v39, v39, v75
v_lshlrev_b32 v68, 16, v60
v_and_b32 v69, 0xffff0000, v60
v_add_f32 v40, v40, v68
v_add_f32 v41, v41, v69
v_lshlrev_b32 v70, 16, v61
v_and_b32 v71, 0xffff0000, v61
v_add_f32 v42, v42, v70
v_add_f32 v43, v43, v71
v_lshlrev_b32 v72, 16, v62
v_and_b32 v73, 0xffff0000, v62
v_add_f32 v44, v44, v72
v_add_f32 v45, v45, v73
v_lshlrev_b32 v74, 16, v63
v_and_b32 v75, 0xffff0000, v63
v_add_f32 v46, v46, v74
v_add_f32 v47, v47, v75
v_lshlrev_b32 v68, 16, v64
v_and_b32 v69, 0xffff0000, v64
v_add_f32 v48, v48, v68
v_add_f32 v49, v49, v69
v_lshlrev_b32 v70, 16, v65
v_and_b32 v71, 0xffff0000, v65
v_add_f32 v50, v50, v70
v_add_f32 v51, v51, v71
v_cvt_pk_bf16_f32 v80, v32, v33
v_cvt_pk_bf16_f32 v81, v34, v35
v_cvt_pk_bf16_f32 v82, v36, v37
v_cvt_pk_bf16_f32 v83, v38, v39
v_cvt_pk_bf16_f32 v84, v40, v41
v_cvt_pk_bf16_f32 v85, v42, v43
v_cvt_pk_bf16_f32 v86, v44, v45
v_cvt_pk_bf16_f32 v87, v46, v47
v_cvt_pk_bf16_f32 v88, v48, v49
v_cvt_pk_bf16_f32 v89, v50, v51
s_add_u32 s27, s26, s73
buffer_store_dwordx4 v[80:83], v2, s[8:11], s27 offen sc1
buffer_store_dwordx4 v[84:87], v2, s[8:11], s27 offen offset:1024 sc1
buffer_store_dwordx2 v[88:89], v4, s[8:11], s27 offen sc1
v_add_f32 v10, v32, v33
v_mul_f32 v11, v32, v32
v_mul_f32 v13, v33, v33
v_mov_b32 v12, 0
v_add_f32 v10, v10, v34
v_add_f32 v12, v12, v35
v_fmac_f32 v11, v34, v34
v_fmac_f32 v13, v35, v35
v_add_f32 v10, v10, v36
v_add_f32 v12, v12, v37
v_fmac_f32 v11, v36, v36
v_fmac_f32 v13, v37, v37
v_add_f32 v10, v10, v38
v_add_f32 v12, v12, v39
v_fmac_f32 v11, v38, v38
v_fmac_f32 v13, v39, v39
v_add_f32 v10, v10, v40
v_add_f32 v12, v12, v41
v_fmac_f32 v11, v40, v40
v_fmac_f32 v13, v41, v41
v_add_f32 v10, v10, v42
v_add_f32 v12, v12, v43
v_fmac_f32 v11, v42, v42
v_fmac_f32 v13, v43, v43
v_add_f32 v10, v10, v44
v_add_f32 v12, v12, v45
v_fmac_f32 v11, v44, v44
v_fmac_f32 v13, v45, v45
v_add_f32 v10, v10, v46
v_add_f32 v12, v12, v47
v_fmac_f32 v11, v46, v46
v_fmac_f32 v13, v47, v47
v_add_f32 v10, v10, v48
v_add_f32 v12, v12, v49
v_fmac_f32 v11, v48, v48
v_fmac_f32 v13, v49, v49
v_add_f32 v10, v10, v50
v_add_f32 v12, v12, v51
v_fmac_f32 v11, v50, v50
v_fmac_f32 v13, v51, v51
v_add_f32 v10, v10, v12
v_add_f32 v11, v11, v13
v_mov_b32 v12, v10
v_mov_b32 v13, v11
s_nop 0
v_permlane16_swap_b32 v10, v12
v_permlane16_swap_b32 v11, v13
v_add_f32 v10, v10, v12
v_add_f32 v11, v11, v13
v_mov_b32 v12, v10
v_mov_b32 v13, v11
s_nop 0
v_permlane32_swap_b32 v10, v12
v_permlane32_swap_b32 v11, v13
v_add_f32 v10, v10, v12
v_add_f32 v11, v11, v13
v_lshlrev_b32 v8, 3, v6
v_cmp_gt_u32 vcc, 16, v1
s_nop 1
v_cndmask_b32 v8, v9, v8, vcc
s_lshl_b32 s27, s20, 10
s_lshl_b32 s28, s21, 7
s_add_u32 s27, s27, s28
s_add_u32 s27, s27, s74
buffer_store_dwordx2 v[10:11], v8, s[8:11], s27 offen sc1
s_lshr_b32 s27, s20, 2
s_lshl_b32 s27, s27, 3
s_add_u32 s27, s27, s21
s_lshl_b32 s27, s27, 2
s_add_u32 s27, s27, s4
s_lshl_b32 s27, s27, 7
s_add_u32 s27, s27, s77
s_add_u32 s27, s27, 524288
v_mov_b32 v13, 2146435072
v_cmp_eq_u32 vcc, 0, v1
v_mov_b32 v14, s68
v_mov_b32 v15, s69
v_cndmask_b32 v13, v13, 0, vcc
s_waitcnt vmcnt(0)
buffer_store_dwordx2 v[14:15], v13, s[8:11], s27 offen sc1
s_barrier
s_lshr_b32 s40, s6, 2
s_lshl_b32 s41, s5, 2
s_and_b32 s42, s6, 3
s_add_u32 s41, s41, s42
s_lshr_b32 s42, s41, 2
s_and_b32 s43, s41, 3
s_mul_i32 s22, s4, 6144
s_mul_i32 s21, s41, 497664
s_add_u32 s21, s21, s22
s_add_u32 s21, s21, 7303168
v_add_u32 v3, s21, v2
s_cmp_eq_u32 s7, 0
s_cbranch_scc0 L_f_packed
s_lshl_b32 s47, s42, 12
s_add_u32 s47, s47, 1966080
v_min_u32 v16, 26, v1
v_lshlrev_b32 v16, 7, v16
s_mov_b32 s52, 0
L_poll3:
buffer_load_dwordx2 v[14:15], v16, s[8:11], s47 offen sc1
s_add_u32 s52, s52, 1
s_waitcnt vmcnt(0)
v_cmp_ne_u64 vcc, s[68:69], v[14:15]
s_cmp_ge_u32 s52, 0x100000
s_cbranch_scc1 L_got3
s_and_b64 exec, exec, vcc
s_cbranch_execnz L_poll3
L_got3:
s_mov_b64 exec, -1
L_f_packed:
s_add_u32 m0, s22, 0
s_nop 0
buffer_load_dwordx4 v3, s[8:11], 0 offen offset:0 sc1 lds
buffer_load_dwordx4 v3, s[8:11], 0 offen offset:1024 sc1 lds
buffer_load_dwordx4 v3, s[8:11], 0 offen offset:2048 sc1 lds
buffer_load_dwordx4 v3, s[8:11], 0 offen offset:3072 sc1 lds
s_add_u32 m0, s22, 4096
v_add_u32 v3, 4096, v3
buffer_load_dwordx4 v3, s[8:11], 0 offen offset:0 sc1 lds
buffer_load_dwordx4 v3, s[8:11], 0 offen offset:1024 sc1 lds
s_add_u32 m0, s22, 24576
v_add_u32 v3, 20480, v3
buffer_load_dwordx4 v3, s[8:11], 0 offen offset:0 sc1 lds
buffer_load_dwordx4 v3, s[8:11], 0 offen offset:1024 sc1 lds
buffer_load_dwordx4 v3, s[8:11], 0 offen offset:2048 sc1 lds
buffer_load_dwordx4 v3, s[8:11], 0 offen offset:3072 sc1 lds
s_add_u32 m0, s22, 28672
v_add_u32 v3, 4096, v3
buffer_load_dwordx4 v3, s[8:11], 0 offen offset:0 sc1 lds
buffer_load_dwordx4 v3, s[8:11], 0 offen offset:1024 sc1 lds
s_add_u32 m0, s22, 49152
v_add_u32 v3, 20480, v3
buffer_load_dwordx4 v3, s[8:11], 0 offen offset:0 sc1 lds
buffer_load_dwordx4 v3, s[8:11], 0 offen offset:1024 sc1 lds
buffer_load_dwordx4 v3, s[8:11], 0 offen offset:2048 sc1 lds
buffer_load_dwordx4 v3, s[8:11], 0 offen offset:3072 sc1 lds
s_add_u32 m0, s22, 53248
v_add_u32 v3, 4096, v3
buffer_load_dwordx4 v3, s[8:11], 0 offen offset:0 sc1 lds
buffer_load_dwordx4 v3, s[8:11], 0 offen offset:1024 sc1 lds
s_add_u32 m0, s22, 73728
v_add_u32 v3, 20480, v3
buffer_load_dwordx4 v3, s[8:11], 0 offen offset:0 sc1 lds
buffer_load_dwordx4 v3, s[8:11], 0 offen offset:1024 sc1 lds
buffer_load_dwordx4 v3, s[8:11], 0 offen offset:2048 sc1 lds
buffer_load_dwordx4 v3, s[8:11], 0 offen offset:3072 sc1 lds
s_add_u32 m0, s22, 77824
v_add_u32 v3, 4096, v3
buffer_load_dwordx4 v3, s[8:11], 0 offen offset:0 sc1 lds
buffer_load_dwordx4 v3, s[8:11], 0 offen offset:1024 sc1 lds
s_lshl_b32 s44, s40, 4
s_lshl_b32 s45, s4, 2
s_add_u32 s44, s44, s45
s_mul_i32 s46, s44, 18432
s_add_u32 s20, s46, s73
v_add_u32 v4, 18432, v2
v_add_u32 v5, 36864, v2
v_add_u32 v6, 55296, v2
v_lshlrev_b32 v244, 3, v1
v_add_u32 v245, 18432, v244
v_add_u32 v246, 36864, v244
v_add_u32 v247, 55296, v244
v_and_b32 v13, 15, v1
v_lshrrev_b32 v14, 4, v1
v_add_u32 v7, 0x10000, v2
v_add_u32 v8, 0x20000, v2
v_and_b32 v9, 1, v14
v_mul_u32_u24 v9, 18432, v9
v_lshrrev_b32 v15, 1, v14
v_lshlrev_b32 v15, 8, v15
v_lshl_add_u32 v15, v13, 4, v15
v_add_u32 v9, v9, v15
v_and_b32 v11, 3, v1
v_lshlrev_b32 v11, 7, v11
s_lshl_b32 s49, s43, 7
v_mov_b32 v10, 2146435072
v_mov_b32 v15, s49
v_cmp_eq_u32 vcc, 0, v1
s_nop 1
v_cndmask_b32 v10, v10, v15, vcc
s_lshl_b32 s49, s40, 3
s_add_u32 s49, s49, s42
s_lshl_b32 s50, s49, 2
s_add_u32 s50, s50, s4
s_lshl_b32 s50, s50, 9
s_add_u32 s34, s50, s77
s_add_u32 s34, s34, 0
s_lshl_b32 s49, s49, 4
s_add_u32 s49, s49, s45
s_mul_i32 s49, s49, 18432
s_add_u32 s49, s49, s75
s_add_u32 s50, s43, 0
s_and_b32 s50, s50, 3
s_mul_i32 s50, s50, 9
s_add_u32 s50, s50, 1
s_lshr_b32 s50, s50, 1
s_lshl_b32 s50, s50, 10
s_add_u32 s24, s49, s50
s_add_u32 s50, s43, 1
s_and_b32 s50, s50, 3
s_mul_i32 s50, s50, 9
s_add_u32 s50, s50, 1
s_lshr_b32 s50, s50, 1
s_lshl_b32 s50, s50, 10
s_add_u32 s25, s49, s50
s_add_u32 s50, s43, 2
s_and_b32 s50, s50, 3
s_mul_i32 s50, s50, 9
s_add_u32 s50, s50, 1
s_lshr_b32 s50, s50, 1
s_lshl_b32 s50, s50, 10
s_add_u32 s26, s49, s50
s_add_u32 s50, s43, 3
s_and_b32 s50, s50, 3
s_mul_i32 s50, s50, 9
s_add_u32 s50, s50, 1
s_lshr_b32 s50, s50, 1
s_lshl_b32 s50, s50, 10
s_add_u32 s27, s49, s50
s_add_u32 s28, s49, 4096
s_add_u32 s29, s49, 13312
s_cmp_ge_u32 s43, 2
s_cselect_b32 s50, s29, s28
s_and_b32 s51, s43, 1
s_lshl_b32 s51, s51, 9
s_add_u32 s30, s50, s51
s_mul_i32 s50, s42, 2359296
s_add_u32 s50, s50, s46
s_add_u32 s50, s50, s76
s_lshl_b32 s51, s43, 12
s_add_u32 s31, s50, s51
s_lshl_b32 s51, s43, 9
s_add_u32 s50, s50, s51
s_add_u32 s32, s50, 16384
s_add_u32 s33, s32, 36864
s_add_u32 s36, s31, 0
s_add_u32 s37, s31, 18432
s_add_u32 s38, s31, 36864
s_add_u32 s39, s31, 55296
v_lshlrev_b32 v252, 4, v13
v_lshl_add_u32 v252, v14, 9, v252
s_lshl_b32 s35, s40, 2
s_add_u32 s35, s35, s4
s_lshl_b32 s35, s35, 5
s_add_u32 s35, s35, s41
s_lshl_b32 s35, s35, 7
s_add_u32 s35, s35, s77
s_add_u32 s35, s35, 655360
v_lshlrev_b32 v17, 3, v13
v_lshl_add_u32 v17, v14, 8, v17
s_lshl_b32 s47, s44, 10
s_add_u32 s47, s47, s74
s_lshl_b32 s49, s44, 10
s_add_u32 s49, s49, s77
s_add_u32 s49, s49, 524288
v_and_b32 v16, 31, v1
v_lshlrev_b32 v16, 7, v16
s_mov_b32 s52, 0
L_poll4:
buffer_load_dwordx2 v[14:15], v16, s[8:11], s49 offen sc1
s_add_u32 s52, s52, 1
s_waitcnt vmcnt(0)
v_cmp_ne_u64 vcc, s[68:69], v[14:15]
s_cmp_ge_u32 s52, 0x100000
s_cbranch_scc1 L_got4
s_and_b64 exec, exec, vcc
s_cbranch_execnz L_poll4
L_got4:
s_mov_b64 exec, -1
s_add_u32 s48, s20, 0
buffer_load_dwordx4 a[0:3], v2, s[8:11], s48 offen offset:0 sc1
buffer_load_dwordx4 a[4:7], v4, s[8:11], s48 offen offset:0 sc1
buffer_load_dwordx4 a[8:11], v5, s[8:11], s48 offen offset:0 sc1
buffer_load_dwordx4 a[12:15], v6, s[8:11], s48 offen offset:0 sc1
buffer_load_dwordx4 a[16:19], v2, s[8:11], s48 offen offset:1024 sc1
buffer_load_dwordx4 a[20:23], v4, s[8:11], s48 offen offset:1024 sc1
buffer_load_dwordx4 a[24:27], v5, s[8:11], s48 offen offset:1024 sc1
buffer_load_dwordx4 a[28:31], v6, s[8:11], s48 offen offset:1024 sc1
buffer_load_dwordx2 v[144:145], v17, s[8:11], s47 offen offset:0 sc1
buffer_load_dwordx2 v[146:147], v17, s[8:11], s47 offen offset:128 sc1
buffer_load_dwordx2 v[148:149], v17, s[8:11], s47 offen offset:1024 sc1
buffer_load_dwordx2 v[150:151], v17, s[8:11], s47 offen offset:1152 sc1
buffer_load_dwordx2 v[152:153], v17, s[8:11], s47 offen offset:2048 sc1
buffer_load_dwordx2 v[154:155], v17, s[8:11], s47 offen offset:2176 sc1
buffer_load_dwordx2 v[156:157], v17, s[8:11], s47 offen offset:3072 sc1
buffer_load_dwordx2 v[158:159], v17, s[8:11], s47 offen offset:3200 sc1
buffer_load_dwordx4 a[32:35], v2, s[8:11], s48 offen offset:2048 sc1
buffer_load_dwordx4 a[36:39], v4, s[8:11], s48 offen offset:2048 sc1
buffer_load_dwordx4 a[40:43], v5, s[8:11], s48 offen offset:2048 sc1
buffer_load_dwordx4 a[44:47], v6, s[8:11], s48 offen offset:2048 sc1
buffer_load_dwordx4 a[48:51], v2, s[8:11], s48 offen offset:3072 sc1
buffer_load_dwordx4 a[52:55], v4, s[8:11], s48 offen offset:3072 sc1
buffer_load_dwordx4 a[56:59], v5, s[8:11], s48 offen offset:3072 sc1
buffer_load_dwordx4 a[60:63], v6, s[8:11], s48 offen offset:3072 sc1
s_add_u32 s48, s20, 4096
buffer_load_dwordx4 a[64:67], v2, s[8:11], s48 offen offset:0 sc1
buffer_load_dwordx4 a[68:71], v4, s[8:11], s48 offen offset:0 sc1
buffer_load_dwordx4 a[72:75], v5, s[8:11], s48 offen offset:0 sc1
buffer_load_dwordx4 a[76:79], v6, s[8:11], s48 offen offset:0 sc1
s_barrier
ds_read_b128 v[48:51], v2 offset:0
ds_read_b128 v[52:55], v2 offset:1024
ds_read_b128 v[56:59], v2 offset:2048
ds_read_b128 v[60:63], v2 offset:3072
ds_read_b128 v[64:67], v2 offset:4096
ds_read_b128 v[68:71], v2 offset:5120
s_waitcnt vmcnt(20)
s_waitcnt lgkmcnt(4)
v_mfma_f32_16x16x32_bf16 v[80:83], v[48:51], a[0:3], 0
buffer_load_dwordx4 a[80:83], v2, s[8:11], s48 offen offset:1024 sc1
v_mfma_f32_16x16x32_bf16 v[80:83], v[52:55], a[16:19], v[80:83]
v_mfma_f32_16x16x32_bf16 v[84:87], v[48:51], a[4:7], 0
ds_read_b128 v[72:75], v2 offset:6144
v_mfma_f32_16x16x32_bf16 v[84:87], v[52:55], a[20:23], v[84:87]
v_mfma_f32_16x16x32_bf16 v[88:91], v[48:51], a[8:11], 0
buffer_load_dwordx4 a[84:87], v4, s[8:11], s48 offen offset:1024 sc1
v_mfma_f32_16x16x32_bf16 v[88:91], v[52:55], a[24:27], v[88:91]
ds_read_b128 v[76:79], v2 offset:7168
v_mfma_f32_16x16x32_bf16 v[92:95], v[48:51], a[12:15], 0
v_mfma_f32_16x16x32_bf16 v[92:95], v[52:55], a[28:31], v[92:95]
s_waitcnt lgkmcnt(4)
v_mfma_f32_16x16x32_bf16 v[96:99], v[56:59], a[0:3], 0
buffer_load_dwordx4 a[88:91], v5, s[8:11], s48 offen offset:1024 sc1
v_mfma_f32_16x16x32_bf16 v[96:99], v[60:63], a[16:19], v[96:99]
v_mfma_f32_16x16x32_bf16 v[100:103], v[56:59], a[4:7], 0
ds_read_b128 v[48:51], v2 offset:8192
v_mfma_f32_16x16x32_bf16 v[100:103], v[60:63], a[20:23], v[100:103]
v_mfma_f32_16x16x32_bf16 v[104:107], v[56:59], a[8:11], 0
buffer_load_dwordx4 a[92:95], v6, s[8:11], s48 offen offset:1024 sc1
v_mfma_f32_16x16x32_bf16 v[104:107], v[60:63], a[24:27], v[104:107]
ds_read_b128 v[52:55], v2 offset:9216
v_mfma_f32_16x16x32_bf16 v[108:111], v[56:59], a[12:15], 0
v_mfma_f32_16x16x32_bf16 v[108:111], v[60:63], a[28:31], v[108:111]
s_waitcnt lgkmcnt(4)
v_mfma_f32_16x16x32_bf16 v[112:115], v[64:67], a[0:3], 0
buffer_load_dwordx4 a[96:99], v2, s[8:11], s48 offen offset:2048 sc1
v_mfma_f32_16x16x32_bf16 v[112:115], v[68:71], a[16:19], v[112:115]
v_mfma_f32_16x16x32_bf16 v[116:119], v[64:67], a[4:7], 0
ds_read_b128 v[56:59], v2 offset:10240
v_mfma_f32_16x16x32_bf16 v[116:119], v[68:71], a[20:23], v[116:119]
v_mfma_f32_16x16x32_bf16 v[120:123], v[64:67], a[8:11], 0
buffer_load_dwordx4 a[100:103], v4, s[8:11], s48 offen offset:2048 sc1
v_mfma_f32_16x16x32_bf16 v[120:123], v[68:71], a[24:27], v[120:123]
ds_read_b128 v[60:63], v2 offset:11264
v_mfma_f32_16x16x32_bf16 v[124:127], v[64:67], a[12:15], 0
v_mfma_f32_16x16x32_bf16 v[124:127], v[68:71], a[28:31], v[124:127]
s_waitcnt lgkmcnt(4)
v_mfma_f32_16x16x32_bf16 v[128:131], v[72:75], a[0:3], 0
buffer_load_dwordx4 a[104:107], v5, s[8:11], s48 offen offset:2048 sc1
v_mfma_f32_16x16x32_bf16 v[128:131], v[76:79], a[16:19], v[128:131]
v_mfma_f32_16x16x32_bf16 v[132:135], v[72:75], a[4:7], 0
ds_read_b128 v[64:67], v2 offset:12288
v_mfma_f32_16x16x32_bf16 v[132:135], v[76:79], a[20:23], v[132:135]
v_mfma_f32_16x16x32_bf16 v[136:139], v[72:75], a[8:11], 0
buffer_load_dwordx4 a[108:111], v6, s[8:11], s48 offen offset:2048 sc1
v_mfma_f32_16x16x32_bf16 v[136:139], v[76:79], a[24:27], v[136:139]
ds_read_b128 v[68:71], v2 offset:13312
v_mfma_f32_16x16x32_bf16 v[140:143], v[72:75], a[12:15], 0
v_mfma_f32_16x16x32_bf16 v[140:143], v[76:79], a[28:31], v[140:143]
s_waitcnt vmcnt(12)
s_waitcnt lgkmcnt(4)
v_mfma_f32_16x16x32_bf16 v[80:83], v[48:51], a[32:35], v[80:83]
buffer_load_dwordx4 a[112:115], v2, s[8:11], s48 offen offset:3072 sc1
v_mfma_f32_16x16x32_bf16 v[80:83], v[52:55], a[48:51], v[80:83]
v_mfma_f32_16x16x32_bf16 v[84:87], v[48:51], a[36:39], v[84:87]
ds_read_b128 v[72:75], v2 offset:14336
v_mfma_f32_16x16x32_bf16 v[84:87], v[52:55], a[52:55], v[84:87]
v_mfma_f32_16x16x32_bf16 v[88:91], v[48:51], a[40:43], v[88:91]
buffer_load_dwordx4 a[116:119], v4, s[8:11], s48 offen offset:3072 sc1
v_mfma_f32_16x16x32_bf16 v[88:91], v[52:55], a[56:59], v[88:91]
ds_read_b128 v[76:79], v2 offset:15360
v_mfma_f32_16x16x32_bf16 v[92:95], v[48:51], a[44:47], v[92:95]
v_mfma_f32_16x16x32_bf16 v[92:95], v[52:55], a[60:63], v[92:95]
s_waitcnt lgkmcnt(4)
v_mfma_f32_16x16x32_bf16 v[96:99], v[56:59], a[32:35], v[96:99]
buffer_load_dwordx4 a[120:123], v5, s[8:11], s48 offen offset:3072 sc1
v_mfma_f32_16x16x32_bf16 v[96:99], v[60:63], a[48:51], v[96:99]
v_mfma_f32_16x16x32_bf16 v[100:103], v[56:59], a[36:39], v[100:103]
ds_read_b128 v[48:51], v2 offset:16384
v_mfma_f32_16x16x32_bf16 v[100:103], v[60:63], a[52:55], v[100:103]
v_mfma_f32_16x16x32_bf16 v[104:107], v[56:59], a[40:43], v[104:107]
buffer_load_dwordx4 a[124:127], v6, s[8:11], s48 offen offset:3072 sc1
v_mfma_f32_16x16x32_bf16 v[104:107], v[60:63], a[56:59], v[104:107]
ds_read_b128 v[52:55], v2 offset:17408
s_add_u32 s48, s20, 8192
v_mfma_f32_16x16x32_bf16 v[108:111], v[56:59], a[44:47], v[108:111]
v_mfma_f32_16x16x32_bf16 v[108:111], v[60:63], a[60:63], v[108:111]
s_waitcnt lgkmcnt(4)
v_mfma_f32_16x16x32_bf16 v[112:115], v[64:67], a[32:35], v[112:115]
buffer_load_dwordx4 a[128:131], v2, s[8:11], s48 offen offset:0 sc1
v_mfma_f32_16x16x32_bf16 v[112:115], v[68:71], a[48:51], v[112:115]
v_mfma_f32_16x16x32_bf16 v[116:119], v[64:67], a[36:39], v[116:119]
ds_read_b128 v[56:59], v2 offset:18432
v_mfma_f32_16x16x32_bf16 v[116:119], v[68:71], a[52:55], v[116:119]
v_mfma_f32_16x16x32_bf16 v[120:123], v[64:67], a[40:43], v[120:123]
buffer_load_dwordx4 a[132:135], v4, s[8:11], s48 offen offset:0 sc1
v_mfma_f32_16x16x32_bf16 v[120:123], v[68:71], a[56:59], v[120:123]
ds_read_b128 v[60:63], v2 offset:19456
v_mfma_f32_16x16x32_bf16 v[124:127], v[64:67], a[44:47], v[124:127]
v_mfma_f32_16x16x32_bf16 v[124:127], v[68:71], a[60:63], v[124:127]
s_waitcnt lgkmcnt(4)
v_mfma_f32_16x16x32_bf16 v[128:131], v[72:75], a[32:35], v[128:131]
buffer_load_dwordx4 a[136:139], v5, s[8:11], s48 offen offset:0 sc1
v_mfma_f32_16x16x32_bf16 v[128:131], v[76:79], a[48:51], v[128:131]
v_mfma_f32_16x16x32_bf16 v[132:135], v[72:75], a[36:39], v[132:135]
ds_read_b128 v[64:67], v2 offset:20480
v_mfma_f32_16x16x32_bf16 v[132:135], v[76:79], a[52:55], v[132:135]
v_mfma_f32_16x16x32_bf16 v[136:139], v[72:75], a[40:43], v[136:139]
buffer_load_dwordx4 a[140:143], v6, s[8:11], s48 offen offset:0 sc1
v_mfma_f32_16x16x32_bf16 v[136:139], v[76:79], a[56:59], v[136:139]
ds_read_b128 v[68:71], v2 offset:21504
v_mfma_f32_16x16x32_bf16 v[140:143], v[72:75], a[44:47], v[140:143]
v_mfma_f32_16x16x32_bf16 v[140:143], v[76:79], a[60:63], v[140:143]
s_waitcnt vmcnt(12)
s_waitcnt lgkmcnt(4)
v_mfma_f32_16x16x32_bf16 v[80:83], v[48:51], a[64:67], v[80:83]
buffer_load_dwordx4 a[144:147], v2, s[8:11], s48 offen offset:1024 sc1
v_mfma_f32_16x16x32_bf16 v[80:83], v[52:55], a[80:83], v[80:83]
v_mfma_f32_16x16x32_bf16 v[84:87], v[48:51], a[68:71], v[84:87]
ds_read_b128 v[72:75], v2 offset:22528
v_mfma_f32_16x16x32_bf16 v[84:87], v[52:55], a[84:87], v[84:87]
v_add_f32 v144, v144, v146
v_add_f32 v145, v145, v147
v_mfma_f32_16x16x32_bf16 v[88:91], v[48:51], a[72:75], v[88:91]
buffer_load_dwordx4 a[148:151], v4, s[8:11], s48 offen offset:1024 sc1
v_mfma_f32_16x16x32_bf16 v[88:91], v[52:55], a[88:91], v[88:91]
ds_read_b128 v[76:79], v2 offset:23552
v_add_f32 v148, v148, v150
v_mfma_f32_16x16x32_bf16 v[92:95], v[48:51], a[76:79], v[92:95]
v_add_f32 v149, v149, v151
v_add_f32 v152, v152, v154
v_mfma_f32_16x16x32_bf16 v[92:95], v[52:55], a[92:95], v[92:95]
v_add_f32 v153, v153, v155
s_waitcnt lgkmcnt(4)
v_mfma_f32_16x16x32_bf16 v[96:99], v[56:59], a[64:67], v[96:99]
buffer_load_dwordx4 a[152:155], v5, s[8:11], s48 offen offset:1024 sc1
v_mfma_f32_16x16x32_bf16 v[96:99], v[60:63], a[80:83], v[96:99]
s_barrier
v_mfma_f32_16x16x32_bf16 v[100:103], v[56:59], a[68:71], v[100:103]
ds_read_b128 v[48:51], v2 offset:24576
v_add_f32 v156, v156, v158
v_mfma_f32_16x16x32_bf16 v[100:103], v[60:63], a[84:87], v[100:103]
v_add_f32 v157, v157, v159
v_mov_b32 v160, v144
v_mfma_f32_16x16x32_bf16 v[104:107], v[56:59], a[72:75], v[104:107]
buffer_load_dwordx4 a[156:159], v6, s[8:11], s48 offen offset:1024 sc1
v_mfma_f32_16x16x32_bf16 v[104:107], v[60:63], a[88:91], v[104:107]
ds_read_b128 v[52:55], v2 offset:25600
v_mov_b32 v161, v145
v_mfma_f32_16x16x32_bf16 v[108:111], v[56:59], a[76:79], v[108:111]
v_mov_b32 v162, v148
v_mov_b32 v163, v149
v_mfma_f32_16x16x32_bf16 v[108:111], v[60:63], a[92:95], v[108:111]
v_mov_b32 v164, v152
s_waitcnt lgkmcnt(4)
v_mfma_f32_16x16x32_bf16 v[112:115], v[64:67], a[64:67], v[112:115]
buffer_load_dwordx4 a[160:163], v2, s[8:11], s48 offen offset:2048 sc1
v_mfma_f32_16x16x32_bf16 v[112:115], v[68:71], a[80:83], v[112:115]
v_mov_b32 v165, v153
v_mov_b32 v166, v156
v_mfma_f32_16x16x32_bf16 v[116:119], v[64:67], a[68:71], v[116:119]
ds_read_b128 v[56:59], v2 offset:26624
v_mov_b32 v167, v157
v_mfma_f32_16x16x32_bf16 v[116:119], v[68:71], a[84:87], v[116:119]
v_permlane16_swap_b32 v144, v160
v_permlane16_swap_b32 v145, v161
v_mfma_f32_16x16x32_bf16 v[120:123], v[64:67], a[72:75], v[120:123]
buffer_load_dwordx4 a[164:167], v4, s[8:11], s48 offen offset:2048 sc1
v_mfma_f32_16x16x32_bf16 v[120:123], v[68:71], a[88:91], v[120:123]
ds_read_b128 v[60:63], v2 offset:27648
v_permlane16_swap_b32 v148, v162
v_mfma_f32_16x16x32_bf16 v[124:127], v[64:67], a[76:79], v[124:127]
v_permlane16_swap_b32 v149, v163
v_permlane16_swap_b32 v152, v164
v_mfma_f32_16x16x32_bf16 v[124:127], v[68:71], a[92:95], v[124:127]
v_permlane16_swap_b32 v153, v165
s_waitcnt lgkmcnt(4)
v_mfma_f32_16x16x32_bf16 v[128:131], v[72:75], a[64:67], v[128:131]
buffer_load_dwordx4 a[168:171], v5, s[8:11], s48 offen offset:2048 sc1
v_mfma_f32_16x16x32_bf16 v[128:131], v[76:79], a[80:83], v[128:131]
v_permlane16_swap_b32 v156, v166
v_permlane16_swap_b32 v157, v167
v_mfma_f32_16x16x32_bf16 v[132:135], v[72:75], a[68:71], v[132:135]
ds_read_b128 v[64:67], v2 offset:28672
v_add_f32 v144, v144, v160
v_mfma_f32_16x16x32_bf16 v[132:135], v[76:79], a[84:87], v[132:135]
v_add_f32 v145, v145, v161
v_add_f32 v148, v148, v162
v_mfma_f32_16x16x32_bf16 v[136:139], v[72:75], a[72:75], v[136:139]
buffer_load_dwordx4 a[172:175], v6, s[8:11], s48 offen offset:2048 sc1
v_mfma_f32_16x16x32_bf16 v[136:139], v[76:79], a[88:91], v[136:139]
ds_read_b128 v[68:71], v2 offset:29696
v_add_f32 v149, v149, v163
v_mfma_f32_16x16x32_bf16 v[140:143], v[72:75], a[76:79], v[140:143]
v_add_f32 v152, v152, v164
v_add_f32 v153, v153, v165
v_mfma_f32_16x16x32_bf16 v[140:143], v[76:79], a[92:95], v[140:143]
v_add_f32 v156, v156, v166
s_waitcnt vmcnt(12)
s_waitcnt lgkmcnt(4)
v_mfma_f32_16x16x32_bf16 v[80:83], v[48:51], a[96:99], v[80:83]
buffer_load_dwordx4 a[176:179], v2, s[8:11], s48 offen offset:3072 sc1
v_mfma_f32_16x16x32_bf16 v[80:83], v[52:55], a[112:115], v[80:83]
v_add_f32 v157, v157, v167
v_mov_b32 v160, v144
v_mfma_f32_16x16x32_bf16 v[84:87], v[48:51], a[100:103], v[84:87]
ds_read_b128 v[72:75], v2 offset:30720
v_mov_b32 v161, v145
v_mfma_f32_16x16x32_bf16 v[84:87], v[52:55], a[116:119], v[84:87]
v_mov_b32 v162, v148
v_mov_b32 v163, v149
v_mfma_f32_16x16x32_bf16 v[88:91], v[48:51], a[104:107], v[88:91]
buffer_load_dwordx4 a[180:183], v4, s[8:11], s48 offen offset:3072 sc1
v_mfma_f32_16x16x32_bf16 v[88:91], v[52:55], a[120:123], v[88:91]
ds_read_b128 v[76:79], v2 offset:31744
v_mov_b32 v164, v152
v_mfma_f32_16x16x32_bf16 v[92:95], v[48:51], a[108:111], v[92:95]
v_mov_b32 v165, v153
v_mov_b32 v166, v156
v_mfma_f32_16x16x32_bf16 v[92:95], v[52:55], a[124:127], v[92:95]
v_mov_b32 v167, v157
s_waitcnt lgkmcnt(4)
v_mfma_f32_16x16x32_bf16 v[96:99], v[56:59], a[96:99], v[96:99]
buffer_load_dwordx4 a[184:187], v5, s[8:11], s48 offen offset:3072 sc1
v_mfma_f32_16x16x32_bf16 v[96:99], v[60:63], a[112:115], v[96:99]
v_permlane32_swap_b32 v144, v160
v_permlane32_swap_b32 v145, v161
v_mfma_f32_16x16x32_bf16 v[100:103], v[56:59], a[100:103], v[100:103]
ds_read_b128 v[48:51], v2 offset:32768
v_permlane32_swap_b32 v148, v162
v_mfma_f32_16x16x32_bf16 v[100:103], v[60:63], a[116:119], v[100:103]
v_permlane32_swap_b32 v149, v163
v_permlane32_swap_b32 v152, v164
v_mfma_f32_16x16x32_bf16 v[104:107], v[56:59], a[104:107], v[104:107]
buffer_load_dwordx4 a[188:191], v6, s[8:11], s48 offen offset:3072 sc1
v_mfma_f32_16x16x32_bf16 v[104:107], v[60:63], a[120:123], v[104:107]
ds_read_b128 v[52:55], v2 offset:33792
s_add_u32 s48, s20, 12288
v_mfma_f32_16x16x32_bf16 v[108:111], v[56:59], a[108:111], v[108:111]
v_permlane32_swap_b32 v153, v165
v_permlane32_swap_b32 v156, v166
v_mfma_f32_16x16x32_bf16 v[108:111], v[60:63], a[124:127], v[108:111]
v_permlane32_swap_b32 v157, v167
s_waitcnt lgkmcnt(4)
v_mfma_f32_16x16x32_bf16 v[112:115], v[64:67], a[96:99], v[112:115]
buffer_load_dwordx4 a[192:195], v2, s[8:11], s48 offen offset:0 sc1
v_mfma_f32_16x16x32_bf16 v[112:115], v[68:71], a[112:115], v[112:115]
v_add_f32 v144, v144, v160
v_add_f32 v145, v145, v161
v_mfma_f32_16x16x32_bf16 v[116:119], v[64:67], a[100:103], v[116:119]
ds_read_b128 v[56:59], v2 offset:34816
v_add_f32 v148, v148, v162
v_mfma_f32_16x16x32_bf16 v[116:119], v[68:71], a[116:119], v[116:119]
v_add_f32 v149, v149, v163
v_add_f32 v152, v152, v164
v_mfma_f32_16x16x32_bf16 v[120:123], v[64:67], a[104:107], v[120:123]
buffer_load_dwordx4 a[196:199], v4, s[8:11], s48 offen offset:0 sc1
v_mfma_f32_16x16x32_bf16 v[120:123], v[68:71], a[120:123], v[120:123]
ds_read_b128 v[60:63], v2 offset:35840
v_add_f32 v153, v153, v165
v_mfma_f32_16x16x32_bf16 v[124:127], v[64:67], a[108:111], v[124:127]
v_add_f32 v156, v156, v166
v_add_f32 v157, v157, v167
v_mfma_f32_16x16x32_bf16 v[124:127], v[68:71], a[124:127], v[124:127]
v_mul_f32 v144, 0x3ae38e39, v144
s_waitcnt lgkmcnt(4)
v_mfma_f32_16x16x32_bf16 v[128:131], v[72:75], a[96:99], v[128:131]
buffer_load_dwordx4 a[200:203], v5, s[8:11], s48 offen offset:0 sc1
v_mfma_f32_16x16x32_bf16 v[128:131], v[76:79], a[112:115], v[128:131]
v_mul_f32 v148, 0x3ae38e39, v148
v_mul_f32 v152, 0x3ae38e39, v152
v_mfma_f32_16x16x32_bf16 v[132:135], v[72:75], a[100:103], v[132:135]
ds_read_b128 v[64:67], v2 offset:36864
v_mul_f32 v156, 0x3ae38e39, v156
v_mfma_f32_16x16x32_bf16 v[132:135], v[76:79], a[116:119], v[132:135]
v_mul_f32 v145, 0x3ae38e39, v145
v_mul_f32 v149, 0x3ae38e39, v149
v_mfma_f32_16x16x32_bf16 v[136:139], v[72:75], a[104:107], v[136:139]
buffer_load_dwordx4 a[204:207], v6, s[8:11], s48 offen offset:0 sc1
v_mfma_f32_16x16x32_bf16 v[136:139], v[76:79], a[120:123], v[136:139]
ds_read_b128 v[68:71], v2 offset:37888
v_mul_f32 v153, 0x3ae38e39, v153
v_mfma_f32_16x16x32_bf16 v[140:143], v[72:75], a[108:111], v[140:143]
v_mul_f32 v157, 0x3ae38e39, v157
v_fma_f32 v145, -v144, v144, v145
v_mfma_f32_16x16x32_bf16 v[140:143], v[76:79], a[124:127], v[140:143]
v_fma_f32 v149, -v148, v148, v149
s_waitcnt vmcnt(12)
s_waitcnt lgkmcnt(4)
v_mfma_f32_16x16x32_bf16 v[80:83], v[48:51], a[128:131], v[80:83]
buffer_load_dwordx4 a[208:211], v2, s[8:11], s48 offen offset:1024 sc1
v_mfma_f32_16x16x32_bf16 v[80:83], v[52:55], a[144:147], v[80:83]
v_fma_f32 v153, -v152, v152, v153
v_fma_f32 v157, -v156, v156, v157
v_mfma_f32_16x16x32_bf16 v[84:87], v[48:51], a[132:135], v[84:87]
ds_read_b128 v[72:75], v2 offset:38912
v_max_f32 v145, 0, v145
v_mfma_f32_16x16x32_bf16 v[84:87], v[52:55], a[148:151], v[84:87]
v_max_f32 v149, 0, v149
v_max_f32 v153, 0, v153
v_mfma_f32_16x16x32_bf16 v[88:91], v[48:51], a[136:139], v[88:91]
buffer_load_dwordx4 a[212:215], v4, s[8:11], s48 offen offset:1024 sc1
v_mfma_f32_16x16x32_bf16 v[88:91], v[52:55], a[152:155], v[88:91]
ds_read_b128 v[76:79], v2 offset:39936
v_max_f32 v157, 0, v157
v_mfma_f32_16x16x32_bf16 v[92:95], v[48:51], a[140:143], v[92:95]
v_add_f32 v234, 0x3727c5ac, v145
v_add_f32 v237, 0x3727c5ac, v149
v_mfma_f32_16x16x32_bf16 v[92:95], v[52:55], a[156:159], v[92:95]
v_add_f32 v240, 0x3727c5ac, v153
s_waitcnt lgkmcnt(4)
v_mfma_f32_16x16x32_bf16 v[96:99], v[56:59], a[128:131], v[96:99]
buffer_load_dwordx4 a[216:219], v5, s[8:11], s48 offen offset:1024 sc1
v_mfma_f32_16x16x32_bf16 v[96:99], v[60:63], a[144:147], v[96:99]
v_add_f32 v243, 0x3727c5ac, v157
v_mfma_f32_16x16x32_bf16 v[100:103], v[56:59], a[132:135], v[100:103]
ds_read_b128 v[48:51], v2 offset:40960
v_mfma_f32_16x16x32_bf16 v[100:103], v[60:63], a[148:151], v[100:103]
v_rsq_f32 v144, v234
v_mfma_f32_16x16x32_bf16 v[104:107], v[56:59], a[136:139], v[104:107]
buffer_load_dwordx4 a[220:223], v6, s[8:11], s48 offen offset:1024 sc1
v_mfma_f32_16x16x32_bf16 v[104:107], v[60:63], a[152:155], v[104:107]
ds_read_b128 v[52:55], v2 offset:41984
v_mul_f32 v232, 0xc0135761, v144
v_mfma_f32_16x16x32_bf16 v[108:111], v[56:59], a[140:143], v[108:111]
v_rsq_f32 v148, v237
v_mfma_f32_16x16x32_bf16 v[108:111], v[60:63], a[156:159], v[108:111]
v_mul_f32 v235, 0xc0135761, v148
s_waitcnt lgkmcnt(4)
v_mfma_f32_16x16x32_bf16 v[112:115], v[64:67], a[128:131], v[112:115]
buffer_load_dwordx4 a[224:227], v2, s[8:11], s48 offen offset:2048 sc1
v_mfma_f32_16x16x32_bf16 v[112:115], v[68:71], a[144:147], v[112:115]
v_rsq_f32 v152, v240
v_mfma_f32_16x16x32_bf16 v[116:119], v[64:67], a[132:135], v[116:119]
ds_read_b128 v[56:59], v2 offset:43008
v_mul_f32 v238, 0xc0135761, v152
v_mfma_f32_16x16x32_bf16 v[116:119], v[68:71], a[148:151], v[116:119]
v_rsq_f32 v156, v243
v_mfma_f32_16x16x32_bf16 v[120:123], v[64:67], a[136:139], v[120:123]
buffer_load_dwordx4 a[228:231], v4, s[8:11], s48 offen offset:2048 sc1
v_mfma_f32_16x16x32_bf16 v[120:123], v[68:71], a[152:155], v[120:123]
ds_read_b128 v[60:63], v2 offset:44032
v_mul_f32 v241, 0xc0135761, v156
v_mfma_f32_16x16x32_bf16 v[124:127], v[64:67], a[140:143], v[124:127]
v_mul_f32 v145, v144, v144
v_mul_f32 v149, v148, v148
v_mfma_f32_16x16x32_bf16 v[124:127], v[68:71], a[156:159], v[124:127]
v_mul_f32 v153, v152, v152
s_waitcnt lgkmcnt(4)
v_mfma_f32_16x16x32_bf16 v[128:131], v[72:75], a[128:131], v[128:131]
buffer_load_dwordx4 a[232:235], v5, s[8:11], s48 offen offset:2048 sc1
v_mfma_f32_16x16x32_bf16 v[128:131], v[76:79], a[144:147], v[128:131]
v_mul_f32 v157, v156, v156
v_mul_f32 v145, v145, v144
v_mfma_f32_16x16x32_bf16 v[132:135], v[72:75], a[132:135], v[132:135]
ds_read_b128 v[64:67], v2 offset:45056
v_mul_f32 v149, v149, v148
v_mfma_f32_16x16x32_bf16 v[132:135], v[76:79], a[148:151], v[132:135]
v_mul_f32 v153, v153, v152
v_mul_f32 v157, v157, v156
v_mfma_f32_16x16x32_bf16 v[136:139], v[72:75], a[136:139], v[136:139]
buffer_load_dwordx4 a[236:239], v6, s[8:11], s48 offen offset:2048 sc1
v_mfma_f32_16x16x32_bf16 v[136:139], v[76:79], a[152:155], v[136:139]
ds_read_b128 v[68:71], v2 offset:46080
v_mul_f32 v233, 0xbdd2d3e8, v145
v_mfma_f32_16x16x32_bf16 v[140:143], v[72:75], a[140:143], v[140:143]
v_mul_f32 v236, 0xbdd2d3e8, v149
v_mul_f32 v239, 0xbdd2d3e8, v153
v_mfma_f32_16x16x32_bf16 v[140:143], v[76:79], a[156:159], v[140:143]
v_mul_f32 v242, 0xbdd2d3e8, v157
s_waitcnt vmcnt(12)
s_waitcnt lgkmcnt(4)
v_mfma_f32_16x16x32_bf16 v[80:83], v[48:51], a[160:163], v[80:83]
buffer_load_dwordx4 a[240:243], v2, s[8:11], s48 offen offset:3072 sc1
v_mfma_f32_16x16x32_bf16 v[80:83], v[52:55], a[176:179], v[80:83]
v_mfma_f32_16x16x32_bf16 v[84:87], v[48:51], a[164:167], v[84:87]
ds_read_b128 v[72:75], v2 offset:47104
v_mfma_f32_16x16x32_bf16 v[84:87], v[52:55], a[180:183], v[84:87]
v_mfma_f32_16x16x32_bf16 v[88:91], v[48:51], a[168:171], v[88:91]
buffer_load_dwordx4 a[244:247], v4, s[8:11], s48 offen offset:3072 sc1
v_mfma_f32_16x16x32_bf16 v[88:91], v[52:55], a[184:187], v[88:91]
ds_read_b128 v[76:79], v2 offset:48128
v_mfma_f32_16x16x32_bf16 v[92:95], v[48:51], a[172:175], v[92:95]
v_mfma_f32_16x16x32_bf16 v[92:95], v[52:55], a[188:191], v[92:95]
s_waitcnt lgkmcnt(4)
v_mfma_f32_16x16x32_bf16 v[96:99], v[56:59], a[160:163], v[96:99]
buffer_load_dwordx4 a[248:251], v5, s[8:11], s48 offen offset:3072 sc1
v_mfma_f32_16x16x32_bf16 v[96:99], v[60:63], a[176:179], v[96:99]
s_barrier
v_mfma_f32_16x16x32_bf16 v[100:103], v[56:59], a[164:167], v[100:103]
ds_read_b128 v[48:51], v2 offset:49152
v_mfma_f32_16x16x32_bf16 v[100:103], v[60:63], a[180:183], v[100:103]
v_mfma_f32_16x16x32_bf16 v[104:107], v[56:59], a[168:171], v[104:107]
buffer_load_dwordx4 a[252:255], v6, s[8:11], s48 offen offset:3072 sc1
v_mfma_f32_16x16x32_bf16 v[104:107], v[60:63], a[184:187], v[104:107]
ds_read_b128 v[52:55], v2 offset:50176
s_add_u32 s48, s20, 16384
v_mfma_f32_16x16x32_bf16 v[108:111], v[56:59], a[172:175], v[108:111]
v_mfma_f32_16x16x32_bf16 v[108:111], v[60:63], a[188:191], v[108:111]
s_waitcnt lgkmcnt(4)
v_mfma_f32_16x16x32_bf16 v[112:115], v[64:67], a[160:163], v[112:115]
buffer_load_dwordx4 v[16:19], v2, s[8:11], s48 offen offset:0 sc1
v_mfma_f32_16x16x32_bf16 v[112:115], v[68:71], a[176:179], v[112:115]
v_mfma_f32_16x16x32_bf16 v[116:119], v[64:67], a[164:167], v[116:119]
ds_read_b128 v[56:59], v2 offset:51200
v_mfma_f32_16x16x32_bf16 v[116:119], v[68:71], a[180:183], v[116:119]
v_mfma_f32_16x16x32_bf16 v[120:123], v[64:67], a[168:171], v[120:123]
buffer_load_dwordx4 v[20:23], v4, s[8:11], s48 offen offset:0 sc1
v_mfma_f32_16x16x32_bf16 v[120:123], v[68:71], a[184:187], v[120:123]
ds_read_b128 v[60:63], v2 offset:52224
v_mfma_f32_16x16x32_bf16 v[124:127], v[64:67], a[172:175], v[124:127]
v_mfma_f32_16x16x32_bf16 v[124:127], v[68:71], a[188:191], v[124:127]
s_waitcnt lgkmcnt(4)
v_mfma_f32_16x16x32_bf16 v[128:131], v[72:75], a[160:163], v[128:131]
buffer_load_dwordx4 v[24:27], v5, s[8:11], s48 offen offset:0 sc1
v_mfma_f32_16x16x32_bf16 v[128:131], v[76:79], a[176:179], v[128:131]
v_mfma_f32_16x16x32_bf16 v[132:135], v[72:75], a[164:167], v[132:135]
ds_read_b128 v[64:67], v2 offset:53248
v_mfma_f32_16x16x32_bf16 v[132:135], v[76:79], a[180:183], v[132:135]
v_mfma_f32_16x16x32_bf16 v[136:139], v[72:75], a[168:171], v[136:139]
buffer_load_dwordx4 v[28:31], v6, s[8:11], s48 offen offset:0 sc1
v_mfma_f32_16x16x32_bf16 v[136:139], v[76:79], a[184:187], v[136:139]
ds_read_b128 v[68:71], v2 offset:54272
v_mfma_f32_16x16x32_bf16 v[140:143], v[72:75], a[172:175], v[140:143]
v_mfma_f32_16x16x32_bf16 v[140:143], v[76:79], a[188:191], v[140:143]
s_waitcnt vmcnt(12)
s_waitcnt lgkmcnt(4)
v_mfma_f32_16x16x32_bf16 v[80:83], v[48:51], a[192:195], v[80:83]
buffer_load_dwordx4 v[32:35], v2, s[8:11], s48 offen offset:1024 sc1
v_mfma_f32_16x16x32_bf16 v[80:83], v[52:55], a[208:211], v[80:83]
v_mfma_f32_16x16x32_bf16 v[84:87], v[48:51], a[196:199], v[84:87]
ds_read_b128 v[72:75], v2 offset:55296
v_mfma_f32_16x16x32_bf16 v[84:87], v[52:55], a[212:215], v[84:87]
v_mfma_f32_16x16x32_bf16 v[88:91], v[48:51], a[200:203], v[88:91]
buffer_load_dwordx4 v[36:39], v4, s[8:11], s48 offen offset:1024 sc1
v_mfma_f32_16x16x32_bf16 v[88:91], v[52:55], a[216:219], v[88:91]
ds_read_b128 v[76:79], v2 offset:56320
v_mfma_f32_16x16x32_bf16 v[92:95], v[48:51], a[204:207], v[92:95]
v_mfma_f32_16x16x32_bf16 v[92:95], v[52:55], a[220:223], v[92:95]
s_waitcnt lgkmcnt(4)
v_mfma_f32_16x16x32_bf16 v[96:99], v[56:59], a[192:195], v[96:99]
buffer_load_dwordx4 v[40:43], v5, s[8:11], s48 offen offset:1024 sc1
v_mfma_f32_16x16x32_bf16 v[96:99], v[60:63], a[208:211], v[96:99]
v_mfma_f32_16x16x32_bf16 v[100:103], v[56:59], a[196:199], v[100:103]
ds_read_b128 v[48:51], v2 offset:57344
v_mfma_f32_16x16x32_bf16 v[100:103], v[60:63], a[212:215], v[100:103]
v_mfma_f32_16x16x32_bf16 v[104:107], v[56:59], a[200:203], v[104:107]
buffer_load_dwordx4 v[44:47], v6, s[8:11], s48 offen offset:1024 sc1
v_mfma_f32_16x16x32_bf16 v[104:107], v[60:63], a[216:219], v[104:107]
ds_read_b128 v[52:55], v2 offset:58368
s_add_u32 m0, s22, 98304
v_mfma_f32_16x16x32_bf16 v[108:111], v[56:59], a[204:207], v[108:111]
v_add_u32 v3, 20480, v3
v_mfma_f32_16x16x32_bf16 v[108:111], v[60:63], a[220:223], v[108:111]
s_waitcnt lgkmcnt(4)
v_mfma_f32_16x16x32_bf16 v[112:115], v[64:67], a[192:195], v[112:115]
buffer_load_dwordx4 v3, s[8:11], 0 offen offset:0 sc1 lds
v_mfma_f32_16x16x32_bf16 v[112:115], v[68:71], a[208:211], v[112:115]
v_mfma_f32_16x16x32_bf16 v[116:119], v[64:67], a[196:199], v[116:119]
ds_read_b128 v[56:59], v2 offset:59392
v_mfma_f32_16x16x32_bf16 v[116:119], v[68:71], a[212:215], v[116:119]
v_mfma_f32_16x16x32_bf16 v[120:123], v[64:67], a[200:203], v[120:123]
buffer_load_dwordx4 v3, s[8:11], 0 offen offset:1024 sc1 lds
v_mfma_f32_16x16x32_bf16 v[120:123], v[68:71], a[216:219], v[120:123]
ds_read_b128 v[60:63], v2 offset:60416
v_mfma_f32_16x16x32_bf16 v[124:127], v[64:67], a[204:207], v[124:127]
v_mfma_f32_16x16x32_bf16 v[124:127], v[68:71], a[220:223], v[124:127]
s_waitcnt lgkmcnt(4)
v_mfma_f32_16x16x32_bf16 v[128:131], v[72:75], a[192:195], v[128:131]
buffer_load_dwordx4 v3, s[8:11], 0 offen offset:2048 sc1 lds
v_mfma_f32_16x16x32_bf16 v[128:131], v[76:79], a[208:211], v[128:131]
v_mfma_f32_16x16x32_bf16 v[132:135], v[72:75], a[196:199], v[132:135]
ds_read_b128 v[64:67], v2 offset:61440
v_mfma_f32_16x16x32_bf16 v[132:135], v[76:79], a[212:215], v[132:135]
v_mfma_f32_16x16x32_bf16 v[136:139], v[72:75], a[200:203], v[136:139]
buffer_load_dwordx4 v3, s[8:11], 0 offen offset:3072 sc1 lds
v_mfma_f32_16x16x32_bf16 v[136:139], v[76:79], a[216:219], v[136:139]
ds_read_b128 v[68:71], v2 offset:62464
s_add_u32 m0, s22, 102400
v_mfma_f32_16x16x32_bf16 v[140:143], v[72:75], a[204:207], v[140:143]
v_add_u32 v3, 4096, v3
v_mfma_f32_16x16x32_bf16 v[140:143], v[76:79], a[220:223], v[140:143]
s_waitcnt vmcnt(12)
s_waitcnt lgkmcnt(4)
v_mfma_f32_16x16x32_bf16 v[80:83], v[48:51], a[224:227], v[80:83]
buffer_load_dwordx4 v3, s[8:11], 0 offen offset:0 sc1 lds
v_mfma_f32_16x16x32_bf16 v[80:83], v[52:55], a[240:243], v[80:83]
v_mfma_f32_16x16x32_bf16 v[84:87], v[48:51], a[228:231], v[84:87]
ds_read_b128 v[72:75], v2 offset:63488
v_mfma_f32_16x16x32_bf16 v[84:87], v[52:55], a[244:247], v[84:87]
v_mfma_f32_16x16x32_bf16 v[88:91], v[48:51], a[232:235], v[88:91]
buffer_load_dwordx4 v3, s[8:11], 0 offen offset:1024 sc1 lds
v_mfma_f32_16x16x32_bf16 v[88:91], v[52:55], a[248:251], v[88:91]
ds_read_b128 v[76:79], v2 offset:64512
s_add_u32 m0, s22, 122880
v_mfma_f32_16x16x32_bf16 v[92:95], v[48:51], a[236:239], v[92:95]
v_add_u32 v3, 20480, v3
v_mfma_f32_16x16x32_bf16 v[92:95], v[52:55], a[252:255], v[92:95]
s_waitcnt lgkmcnt(4)
v_mfma_f32_16x16x32_bf16 v[96:99], v[56:59], a[224:227], v[96:99]
buffer_load_dwordx4 v3, s[8:11], 0 offen offset:0 sc1 lds
v_mfma_f32_16x16x32_bf16 v[96:99], v[60:63], a[240:243], v[96:99]
v_mfma_f32_16x16x32_bf16 v[100:103], v[56:59], a[228:231], v[100:103]
ds_read_b128 v[48:51], v7 offset:0
v_mfma_f32_16x16x32_bf16 v[100:103], v[60:63], a[244:247], v[100:103]
v_mfma_f32_16x16x32_bf16 v[104:107], v[56:59], a[232:235], v[104:107]
buffer_load_dwordx4 v3, s[8:11], 0 offen offset:1024 sc1 lds
v_mfma_f32_16x16x32_bf16 v[104:107], v[60:63], a[248:251], v[104:107]
ds_read_b128 v[52:55], v7 offset:1024
v_mfma_f32_16x16x32_bf16 v[108:111], v[56:59], a[236:239], v[108:111]
v_mfma_f32_16x16x32_bf16 v[108:111], v[60:63], a[252:255], v[108:111]
s_waitcnt lgkmcnt(4)
v_mfma_f32_16x16x32_bf16 v[112:115], v[64:67], a[224:227], v[112:115]
buffer_load_dwordx4 v3, s[8:11], 0 offen offset:2048 sc1 lds
v_mfma_f32_16x16x32_bf16 v[112:115], v[68:71], a[240:243], v[112:115]
v_mfma_f32_16x16x32_bf16 v[116:119], v[64:67], a[228:231], v[116:119]
ds_read_b128 v[56:59], v7 offset:2048
v_mfma_f32_16x16x32_bf16 v[116:119], v[68:71], a[244:247], v[116:119]
v_mfma_f32_16x16x32_bf16 v[120:123], v[64:67], a[232:235], v[120:123]
buffer_load_dwordx4 v3, s[8:11], 0 offen offset:3072 sc1 lds
v_mfma_f32_16x16x32_bf16 v[120:123], v[68:71], a[248:251], v[120:123]
ds_read_b128 v[60:63], v7 offset:3072
s_add_u32 m0, s22, 126976
v_mfma_f32_16x16x32_bf16 v[124:127], v[64:67], a[236:239], v[124:127]
v_add_u32 v3, 4096, v3
v_mfma_f32_16x16x32_bf16 v[124:127], v[68:71], a[252:255], v[124:127]
s_waitcnt lgkmcnt(4)
v_mfma_f32_16x16x32_bf16 v[128:131], v[72:75], a[224:227], v[128:131]
buffer_load_dwordx4 v3, s[8:11], 0 offen offset:0 sc1 lds
v_mfma_f32_16x16x32_bf16 v[128:131], v[76:79], a[240:243], v[128:131]
v_mfma_f32_16x16x32_bf16 v[132:135], v[72:75], a[228:231], v[132:135]
ds_read_b128 v[64:67], v7 offset:4096
v_mfma_f32_16x16x32_bf16 v[132:135], v[76:79], a[244:247], v[132:135]
v_mfma_f32_16x16x32_bf16 v[136:139], v[72:75], a[232:235], v[136:139]
buffer_load_dwordx4 v3, s[8:11], 0 offen offset:1024 sc1 lds
v_mfma_f32_16x16x32_bf16 v[136:139], v[76:79], a[248:251], v[136:139]
ds_read_b128 v[68:71], v7 offset:5120
s_add_u32 m0, s22, 0
v_mfma_f32_16x16x32_bf16 v[140:143], v[72:75], a[236:239], v[140:143]
v_add_u32 v3, 20480, v3
v_mfma_f32_16x16x32_bf16 v[140:143], v[76:79], a[252:255], v[140:143]
s_waitcnt vmcnt(12)
s_waitcnt lgkmcnt(4)
v_mfma_f32_16x16x32_bf16 v[80:83], v[48:51], v[16:19], v[80:83]
buffer_load_dwordx4 v3, s[8:11], 0 offen offset:0 sc1 lds
v_mfma_f32_16x16x32_bf16 v[80:83], v[52:55], v[32:35], v[80:83]
v_mfma_f32_16x16x32_bf16 v[84:87], v[48:51], v[20:23], v[84:87]
ds_read_b128 v[72:75], v7 offset:6144
v_mfma_f32_16x16x32_bf16 v[84:87], v[52:55], v[36:39], v[84:87]
v_mfma_f32_16x16x32_bf16 v[88:91], v[48:51], v[24:27], v[88:91]
buffer_load_dwordx4 v3, s[8:11], 0 offen offset:1024 sc1 lds
v_mfma_f32_16x16x32_bf16 v[88:91], v[52:55], v[40:43], v[88:91]
ds_read_b128 v[76:79], v7 offset:7168
v_mfma_f32_16x16x32_bf16 v[92:95], v[48:51], v[28:31], v[92:95]
v_mfma_f32_16x16x32_bf16 v[92:95], v[52:55], v[44:47], v[92:95]
s_waitcnt lgkmcnt(4)
v_mfma_f32_16x16x32_bf16 v[96:99], v[56:59], v[16:19], v[96:99]
buffer_load_dwordx4 v3, s[8:11], 0 offen offset:2048 sc1 lds
v_mfma_f32_16x16x32_bf16 v[96:99], v[60:63], v[32:35], v[96:99]
s_barrier
v_mfma_f32_16x16x32_bf16 v[100:103], v[56:59], v[20:23], v[100:103]
ds_read_b128 v[48:51], v7 offset:8192
v_mfma_f32_16x16x32_bf16 v[100:103], v[60:63], v[36:39], v[100:103]
v_mfma_f32_16x16x32_bf16 v[104:107], v[56:59], v[24:27], v[104:107]
buffer_load_dwordx4 v3, s[8:11], 0 offen offset:3072 sc1 lds
v_mfma_f32_16x16x32_bf16 v[104:107], v[60:63], v[40:43], v[104:107]
ds_read_b128 v[52:55], v7 offset:9216
s_add_u32 m0, s22, 4096
v_mfma_f32_16x16x32_bf16 v[108:111], v[56:59], v[28:31], v[108:111]
v_add_u32 v3, 4096, v3
v_mfma_f32_16x16x32_bf16 v[108:111], v[60:63], v[44:47], v[108:111]
s_waitcnt lgkmcnt(4)
v_mfma_f32_16x16x32_bf16 v[112:115], v[64:67], v[16:19], v[112:115]
buffer_load_dwordx4 v3, s[8:11], 0 offen offset:0 sc1 lds
v_mfma_f32_16x16x32_bf16 v[112:115], v[68:71], v[32:35], v[112:115]
v_mfma_f32_16x16x32_bf16 v[116:119], v[64:67], v[20:23], v[116:119]
ds_read_b128 v[56:59], v7 offset:10240
v_mfma_f32_16x16x32_bf16 v[116:119], v[68:71], v[36:39], v[116:119]
v_mfma_f32_16x16x32_bf16 v[120:123], v[64:67], v[24:27], v[120:123]
buffer_load_dwordx4 v3, s[8:11], 0 offen offset:1024 sc1 lds
v_mfma_f32_16x16x32_bf16 v[120:123], v[68:71], v[40:43], v[120:123]
ds_read_b128 v[60:63], v7 offset:11264
s_add_u32 m0, s22, 24576
v_mfma_f32_16x16x32_bf16 v[124:127], v[64:67], v[28:31], v[124:127]
v_add_u32 v3, 20480, v3
v_mfma_f32_16x16x32_bf16 v[124:127], v[68:71], v[44:47], v[124:127]
s_waitcnt lgkmcnt(4)
v_mfma_f32_16x16x32_bf16 v[128:131], v[72:75], v[16:19], v[128:131]
buffer_load_dwordx4 v3, s[8:11], 0 offen offset:0 sc1 lds
v_mfma_f32_16x16x32_bf16 v[128:131], v[76:79], v[32:35], v[128:131]
v_mfma_f32_16x16x32_bf16 v[132:135], v[72:75], v[20:23], v[132:135]
ds_read_b128 v[64:67], v7 offset:12288
v_mfma_f32_16x16x32_bf16 v[132:135], v[76:79], v[36:39], v[132:135]
v_mfma_f32_16x16x32_bf16 v[136:139], v[72:75], v[24:27], v[136:139]
buffer_load_dwordx4 v3, s[8:11], 0 offen offset:1024 sc1 lds
v_mfma_f32_16x16x32_bf16 v[136:139], v[76:79], v[40:43], v[136:139]
ds_read_b128 v[68:71], v7 offset:13312
v_mfma_f32_16x16x32_bf16 v[140:143], v[72:75], v[28:31], v[140:143]
v_mfma_f32_16x16x32_bf16 v[140:143], v[76:79], v[44:47], v[140:143]
s_waitcnt lgkmcnt(4)
v_mfma_f32_16x16x32_bf16 v[176:179], v[48:51], a[0:3], 0
buffer_load_dwordx4 v3, s[8:11], 0 offen offset:2048 sc1 lds
v_mfma_f32_16x16x32_bf16 v[176:179], v[52:55], a[16:19], v[176:179]
v_mfma_f32_16x16x32_bf16 v[180:183], v[48:51], a[4:7], 0
ds_read_b128 v[72:75], v7 offset:14336
v_mfma_f32_16x16x32_bf16 v[180:183], v[52:55], a[20:23], v[180:183]
v_mul_f32 v208, v80, v80
v_mul_f32 v210, v81, v81
v_mfma_f32_16x16x32_bf16 v[184:187], v[48:51], a[8:11], 0
buffer_load_dwordx4 v3, s[8:11], 0 offen offset:3072 sc1 lds
v_mfma_f32_16x16x32_bf16 v[184:187], v[52:55], a[24:27], v[184:187]
ds_read_b128 v[76:79], v7 offset:15360
s_add_u32 m0, s22, 28672
v_mfma_f32_16x16x32_bf16 v[188:191], v[48:51], a[12:15], 0
v_add_u32 v3, 4096, v3
v_fma_f32 v208, v208, v233, v232
v_mfma_f32_16x16x32_bf16 v[188:191], v[52:55], a[28:31], v[188:191]
v_fma_f32 v210, v210, v233, v232
s_waitcnt lgkmcnt(4)
v_mfma_f32_16x16x32_bf16 v[192:195], v[56:59], a[0:3], 0
buffer_load_dwordx4 v3, s[8:11], 0 offen offset:0 sc1 lds
v_mfma_f32_16x16x32_bf16 v[192:195], v[60:63], a[16:19], v[192:195]
v_mul_f32 v208, v208, v80
v_mul_f32 v210, v210, v81
v_mfma_f32_16x16x32_bf16 v[196:199], v[56:59], a[4:7], 0
ds_read_b128 v[48:51], v7 offset:16384
v_mul_f32 v209, v80, v96
v_mfma_f32_16x16x32_bf16 v[196:199], v[60:63], a[20:23], v[196:199]
v_exp_f32 v208, v208
v_mfma_f32_16x16x32_bf16 v[200:203], v[56:59], a[8:11], 0
buffer_load_dwordx4 v3, s[8:11], 0 offen offset:1024 sc1 lds
v_mfma_f32_16x16x32_bf16 v[200:203], v[60:63], a[24:27], v[200:203]
ds_read_b128 v[52:55], v7 offset:17408
v_mul_f32 v211, v81, v97
v_mfma_f32_16x16x32_bf16 v[204:207], v[56:59], a[12:15], 0
v_exp_f32 v210, v210
v_mfma_f32_16x16x32_bf16 v[204:207], v[60:63], a[28:31], v[204:207]
v_fma_f32 v208, v208, v234, v234
s_waitcnt lgkmcnt(4)
v_mfma_f32_16x16x32_bf16 v[176:179], v[64:67], a[32:35], v[176:179]
v_fma_f32 v210, v210, v234, v234
v_mul_f32 v212, v82, v82
v_mfma_f32_16x16x32_bf16 v[176:179], v[68:71], a[48:51], v[176:179]
v_rcp_f32 v208, v208
v_mfma_f32_16x16x32_bf16 v[180:183], v[64:67], a[36:39], v[180:183]
ds_read_b128 v[56:59], v7 offset:18432
v_mul_f32 v209, v209, v208
v_mfma_f32_16x16x32_bf16 v[180:183], v[68:71], a[52:55], v[180:183]
v_rcp_f32 v210, v210
v_mfma_f32_16x16x32_bf16 v[184:187], v[64:67], a[40:43], v[184:187]
v_mul_f32 v211, v211, v210
v_cvt_pk_bf16_f32 v224, v209, v211
v_mfma_f32_16x16x32_bf16 v[184:187], v[68:71], a[56:59], v[184:187]
ds_read_b128 v[60:63], v7 offset:19456
v_mul_f32 v214, v83, v83
v_mfma_f32_16x16x32_bf16 v[188:191], v[64:67], a[44:47], v[188:191]
v_fma_f32 v212, v212, v233, v232
v_fma_f32 v214, v214, v233, v232
v_mfma_f32_16x16x32_bf16 v[188:191], v[68:71], a[60:63], v[188:191]
v_mul_f32 v212, v212, v82
s_waitcnt lgkmcnt(4)
v_mfma_f32_16x16x32_bf16 v[192:195], v[72:75], a[32:35], v[192:195]
v_mul_f32 v214, v214, v83
v_mul_f32 v213, v82, v98
v_mfma_f32_16x16x32_bf16 v[192:195], v[76:79], a[48:51], v[192:195]
v_exp_f32 v212, v212
v_mfma_f32_16x16x32_bf16 v[196:199], v[72:75], a[36:39], v[196:199]
ds_read_b128 v[64:67], v7 offset:20480
v_mul_f32 v215, v83, v99
v_mfma_f32_16x16x32_bf16 v[196:199], v[76:79], a[52:55], v[196:199]
v_exp_f32 v214, v214
v_mfma_f32_16x16x32_bf16 v[200:203], v[72:75], a[40:43], v[200:203]
v_fma_f32 v212, v212, v234, v234
v_fma_f32 v214, v214, v234, v234
v_mfma_f32_16x16x32_bf16 v[200:203], v[76:79], a[56:59], v[200:203]
ds_read_b128 v[68:71], v7 offset:21504
v_mul_f32 v208, v84, v84
v_mfma_f32_16x16x32_bf16 v[204:207], v[72:75], a[44:47], v[204:207]
v_rcp_f32 v212, v212
v_mfma_f32_16x16x32_bf16 v[204:207], v[76:79], a[60:63], v[204:207]
v_mul_f32 v213, v213, v212
s_waitcnt lgkmcnt(4)
v_mfma_f32_16x16x32_bf16 v[176:179], v[48:51], a[64:67], v[176:179]
v_rcp_f32 v214, v214
v_mfma_f32_16x16x32_bf16 v[176:179], v[52:55], a[80:83], v[176:179]
v_mul_f32 v215, v215, v214
v_cvt_pk_bf16_f32 v225, v213, v215
v_mfma_f32_16x16x32_bf16 v[180:183], v[48:51], a[68:71], v[180:183]
ds_read_b128 v[72:75], v7 offset:22528
v_mul_f32 v210, v85, v85
v_mfma_f32_16x16x32_bf16 v[180:183], v[52:55], a[84:87], v[180:183]
buffer_store_dwordx2 v[224:225], v244, s[8:11], s30 offen sc1
v_mfma_f32_16x16x32_bf16 v[184:187], v[48:51], a[72:75], v[184:187]
v_fma_f32 v208, v208, v236, v235
v_fma_f32 v210, v210, v236, v235
v_mfma_f32_16x16x32_bf16 v[184:187], v[52:55], a[88:91], v[184:187]
ds_read_b128 v[76:79], v7 offset:23552
v_mul_f32 v208, v208, v84
v_mfma_f32_16x16x32_bf16 v[188:191], v[48:51], a[76:79], v[188:191]
v_mul_f32 v210, v210, v85
v_mul_f32 v209, v84, v100
v_mfma_f32_16x16x32_bf16 v[188:191], v[52:55], a[92:95], v[188:191]
v_mul_f32 v211, v85, v101
s_waitcnt lgkmcnt(4)
v_mfma_f32_16x16x32_bf16 v[192:195], v[56:59], a[64:67], v[192:195]
v_exp_f32 v208, v208
v_mfma_f32_16x16x32_bf16 v[192:195], v[60:63], a[80:83], v[192:195]
v_exp_f32 v210, v210
v_mfma_f32_16x16x32_bf16 v[196:199], v[56:59], a[68:71], v[196:199]
ds_read_b128 v[48:51], v7 offset:24576
v_fma_f32 v208, v208, v237, v237
v_mfma_f32_16x16x32_bf16 v[196:199], v[60:63], a[84:87], v[196:199]
v_fma_f32 v210, v210, v237, v237
v_mul_f32 v212, v86, v86
v_mfma_f32_16x16x32_bf16 v[200:203], v[56:59], a[72:75], v[200:203]
v_rcp_f32 v208, v208
v_mfma_f32_16x16x32_bf16 v[200:203], v[60:63], a[88:91], v[200:203]
ds_read_b128 v[52:55], v7 offset:25600
v_mul_f32 v209, v209, v208
v_mfma_f32_16x16x32_bf16 v[204:207], v[56:59], a[76:79], v[204:207]
v_rcp_f32 v210, v210
v_mfma_f32_16x16x32_bf16 v[204:207], v[60:63], a[92:95], v[204:207]
v_mul_f32 v211, v211, v210
s_waitcnt lgkmcnt(4)
v_mfma_f32_16x16x32_bf16 v[176:179], v[64:67], a[96:99], v[176:179]
v_cvt_pk_bf16_f32 v226, v209, v211
v_mul_f32 v214, v87, v87
v_mfma_f32_16x16x32_bf16 v[176:179], v[68:71], a[112:115], v[176:179]
v_fma_f32 v212, v212, v236, v235
v_fma_f32 v214, v214, v236, v235
v_mfma_f32_16x16x32_bf16 v[180:183], v[64:67], a[100:103], v[180:183]
ds_read_b128 v[56:59], v7 offset:26624
v_mul_f32 v212, v212, v86
v_mfma_f32_16x16x32_bf16 v[180:183], v[68:71], a[116:119], v[180:183]
v_mul_f32 v214, v214, v87
v_mul_f32 v213, v86, v102
v_mfma_f32_16x16x32_bf16 v[184:187], v[64:67], a[104:107], v[184:187]
v_exp_f32 v212, v212
v_mfma_f32_16x16x32_bf16 v[184:187], v[68:71], a[120:123], v[184:187]
ds_read_b128 v[60:63], v7 offset:27648
v_mul_f32 v215, v87, v103
v_mfma_f32_16x16x32_bf16 v[188:191], v[64:67], a[108:111], v[188:191]
v_exp_f32 v214, v214
v_mfma_f32_16x16x32_bf16 v[188:191], v[68:71], a[124:127], v[188:191]
v_fma_f32 v212, v212, v237, v237
s_waitcnt lgkmcnt(4)
v_mfma_f32_16x16x32_bf16 v[192:195], v[72:75], a[96:99], v[192:195]
v_fma_f32 v214, v214, v237, v237
v_mul_f32 v208, v88, v88
v_mfma_f32_16x16x32_bf16 v[192:195], v[76:79], a[112:115], v[192:195]
v_rcp_f32 v212, v212
v_mfma_f32_16x16x32_bf16 v[196:199], v[72:75], a[100:103], v[196:199]
ds_read_b128 v[64:67], v7 offset:28672
v_mul_f32 v213, v213, v212
v_mfma_f32_16x16x32_bf16 v[196:199], v[76:79], a[116:119], v[196:199]
v_rcp_f32 v214, v214
v_mfma_f32_16x16x32_bf16 v[200:203], v[72:75], a[104:107], v[200:203]
v_mul_f32 v215, v215, v214
v_cvt_pk_bf16_f32 v227, v213, v215
v_mfma_f32_16x16x32_bf16 v[200:203], v[76:79], a[120:123], v[200:203]
ds_read_b128 v[68:71], v7 offset:29696
v_mul_f32 v210, v89, v89
v_mfma_f32_16x16x32_bf16 v[204:207], v[72:75], a[108:111], v[204:207]
buffer_store_dwordx2 v[226:227], v245, s[8:11], s30 offen sc1
v_mfma_f32_16x16x32_bf16 v[204:207], v[76:79], a[124:127], v[204:207]
v_fma_f32 v208, v208, v239, v238
s_waitcnt lgkmcnt(4)
v_mfma_f32_16x16x32_bf16 v[176:179], v[48:51], a[128:131], v[176:179]
v_fma_f32 v210, v210, v239, v238
v_mul_f32 v208, v208, v88
v_mfma_f32_16x16x32_bf16 v[176:179], v[52:55], a[144:147], v[176:179]
v_mul_f32 v210, v210, v89
v_mul_f32 v209, v88, v104
v_mfma_f32_16x16x32_bf16 v[180:183], v[48:51], a[132:135], v[180:183]
ds_read_b128 v[72:75], v7 offset:30720
v_mul_f32 v211, v89, v105
v_mfma_f32_16x16x32_bf16 v[180:183], v[52:55], a[148:151], v[180:183]
v_exp_f32 v208, v208
v_mfma_f32_16x16x32_bf16 v[184:187], v[48:51], a[136:139], v[184:187]
v_exp_f32 v210, v210
v_mfma_f32_16x16x32_bf16 v[184:187], v[52:55], a[152:155], v[184:187]
ds_read_b128 v[76:79], v7 offset:31744
v_fma_f32 v208, v208, v240, v240
v_mfma_f32_16x16x32_bf16 v[188:191], v[48:51], a[140:143], v[188:191]
v_fma_f32 v210, v210, v240, v240
v_mul_f32 v212, v90, v90
v_mfma_f32_16x16x32_bf16 v[188:191], v[52:55], a[156:159], v[188:191]
v_mul_f32 v214, v91, v91
s_waitcnt lgkmcnt(4)
v_mfma_f32_16x16x32_bf16 v[192:195], v[56:59], a[128:131], v[192:195]
s_waitcnt vmcnt(20)
v_fma_f32 v212, v212, v239, v238
v_mfma_f32_16x16x32_bf16 v[192:195], v[60:63], a[144:147], v[192:195]
s_barrier
v_mfma_f32_16x16x32_bf16 v[196:199], v[56:59], a[132:135], v[196:199]
ds_read_b128 v[48:51], v7 offset:32768
s_add_u32 m0, s22, 49152
v_mfma_f32_16x16x32_bf16 v[196:199], v[60:63], a[148:151], v[196:199]
v_add_u32 v3, 20480, v3
buffer_load_dwordx4 v3, s[8:11], 0 offen offset:0 sc1 lds
v_mfma_f32_16x16x32_bf16 v[200:203], v[56:59], a[136:139], v[200:203]
v_rcp_f32 v208, v208
v_mfma_f32_16x16x32_bf16 v[200:203], v[60:63], a[152:155], v[200:203]
ds_read_b128 v[52:55], v7 offset:33792
v_mul_f32 v209, v209, v208
v_mfma_f32_16x16x32_bf16 v[204:207], v[56:59], a[140:143], v[204:207]
v_rcp_f32 v210, v210
v_mfma_f32_16x16x32_bf16 v[204:207], v[60:63], a[156:159], v[204:207]
v_mul_f32 v211, v211, v210
s_waitcnt lgkmcnt(4)
v_mfma_f32_16x16x32_bf16 v[176:179], v[64:67], a[160:163], v[176:179]
buffer_load_dwordx4 v3, s[8:11], 0 offen offset:1024 sc1 lds
v_mfma_f32_16x16x32_bf16 v[176:179], v[68:71], a[176:179], v[176:179]
v_cvt_pk_bf16_f32 v228, v209, v211
v_fma_f32 v214, v214, v239, v238
v_mfma_f32_16x16x32_bf16 v[180:183], v[64:67], a[164:167], v[180:183]
ds_read_b128 v[56:59], v7 offset:34816
v_mul_f32 v212, v212, v90
v_mfma_f32_16x16x32_bf16 v[180:183], v[68:71], a[180:183], v[180:183]
v_mul_f32 v214, v214, v91
v_mul_f32 v213, v90, v106
v_mfma_f32_16x16x32_bf16 v[184:187], v[64:67], a[168:171], v[184:187]
buffer_load_dwordx4 v3, s[8:11], 0 offen offset:2048 sc1 lds
v_mfma_f32_16x16x32_bf16 v[184:187], v[68:71], a[184:187], v[184:187]
ds_read_b128 v[60:63], v7 offset:35840
v_mul_f32 v215, v91, v107
v_mfma_f32_16x16x32_bf16 v[188:191], v[64:67], a[172:175], v[188:191]
v_exp_f32 v212, v212
v_mfma_f32_16x16x32_bf16 v[188:191], v[68:71], a[188:191], v[188:191]
v_fma_f32 v212, v212, v240, v240
s_waitcnt lgkmcnt(4)
v_mfma_f32_16x16x32_bf16 v[192:195], v[72:75], a[160:163], v[192:195]
buffer_load_dwordx4 v3, s[8:11], 0 offen offset:3072 sc1 lds
v_mfma_f32_16x16x32_bf16 v[192:195], v[76:79], a[176:179], v[192:195]
s_add_u32 m0, s22, 53248
v_add_u32 v3, 4096, v3
v_mfma_f32_16x16x32_bf16 v[196:199], v[72:75], a[164:167], v[196:199]
ds_read_b128 v[64:67], v7 offset:36864
v_mul_f32 v208, v92, v92
v_mfma_f32_16x16x32_bf16 v[196:199], v[76:79], a[180:183], v[196:199]
v_exp_f32 v214, v214
v_mfma_f32_16x16x32_bf16 v[200:203], v[72:75], a[168:171], v[200:203]
buffer_load_dwordx4 v3, s[8:11], 0 offen offset:0 sc1 lds
v_mfma_f32_16x16x32_bf16 v[200:203], v[76:79], a[184:187], v[200:203]
ds_read_b128 v[68:71], v7 offset:37888
v_fma_f32 v214, v214, v240, v240
v_mfma_f32_16x16x32_bf16 v[204:207], v[72:75], a[172:175], v[204:207]
v_rcp_f32 v212, v212
v_mfma_f32_16x16x32_bf16 v[204:207], v[76:79], a[188:191], v[204:207]
v_mul_f32 v213, v213, v212
s_waitcnt lgkmcnt(4)
v_mfma_f32_16x16x32_bf16 v[176:179], v[48:51], a[192:195], v[176:179]
buffer_load_dwordx4 v3, s[8:11], 0 offen offset:1024 sc1 lds
v_mfma_f32_16x16x32_bf16 v[176:179], v[52:55], a[208:211], v[176:179]
v_rcp_f32 v214, v214
v_mfma_f32_16x16x32_bf16 v[180:183], v[48:51], a[196:199], v[180:183]
ds_read_b128 v[72:75], v7 offset:38912
v_mul_f32 v215, v215, v214
v_mfma_f32_16x16x32_bf16 v[180:183], v[52:55], a[212:215], v[180:183]
v_cvt_pk_bf16_f32 v229, v213, v215
v_mul_f32 v210, v93, v93
v_mfma_f32_16x16x32_bf16 v[184:187], v[48:51], a[200:203], v[184:187]
buffer_store_dwordx2 v[228:229], v246, s[8:11], s30 offen sc1
v_mfma_f32_16x16x32_bf16 v[184:187], v[52:55], a[216:219], v[184:187]
ds_read_b128 v[76:79], v7 offset:39936
v_fma_f32 v208, v208, v242, v241
v_mfma_f32_16x16x32_bf16 v[188:191], v[48:51], a[204:207], v[188:191]
v_fma_f32 v210, v210, v242, v241
v_mul_f32 v208, v208, v92
v_mfma_f32_16x16x32_bf16 v[188:191], v[52:55], a[220:223], v[188:191]
v_mul_f32 v210, v210, v93
s_waitcnt lgkmcnt(4)
v_mfma_f32_16x16x32_bf16 v[192:195], v[56:59], a[192:195], v[192:195]
v_exp_f32 v208, v208
v_mfma_f32_16x16x32_bf16 v[192:195], v[60:63], a[208:211], v[192:195]
v_exp_f32 v210, v210
v_mfma_f32_16x16x32_bf16 v[196:199], v[56:59], a[196:199], v[196:199]
ds_read_b128 v[48:51], v7 offset:40960
v_mul_f32 v209, v92, v108
v_mfma_f32_16x16x32_bf16 v[196:199], v[60:63], a[212:215], v[196:199]
v_mul_f32 v211, v93, v109
v_fma_f32 v208, v208, v243, v243
v_mfma_f32_16x16x32_bf16 v[200:203], v[56:59], a[200:203], v[200:203]
v_fma_f32 v210, v210, v243, v243
v_mul_f32 v212, v94, v94
v_mfma_f32_16x16x32_bf16 v[200:203], v[60:63], a[216:219], v[200:203]
ds_read_b128 v[52:55], v7 offset:41984
v_mul_f32 v214, v95, v95
v_mfma_f32_16x16x32_bf16 v[204:207], v[56:59], a[204:207], v[204:207]
v_rcp_f32 v208, v208
v_mfma_f32_16x16x32_bf16 v[204:207], v[60:63], a[220:223], v[204:207]
v_mul_f32 v209, v209, v208
s_waitcnt lgkmcnt(4)
v_mfma_f32_16x16x32_bf16 v[176:179], v[64:67], a[224:227], v[176:179]
v_rcp_f32 v210, v210
v_mfma_f32_16x16x32_bf16 v[176:179], v[68:71], a[240:243], v[176:179]
v_mul_f32 v211, v211, v210
v_cvt_pk_bf16_f32 v230, v209, v211
v_mfma_f32_16x16x32_bf16 v[180:183], v[64:67], a[228:231], v[180:183]
ds_read_b128 v[56:59], v7 offset:43008
v_fma_f32 v212, v212, v242, v241
v_mfma_f32_16x16x32_bf16 v[180:183], v[68:71], a[244:247], v[180:183]
v_fma_f32 v214, v214, v242, v241
v_mul_f32 v212, v212, v94
v_mfma_f32_16x16x32_bf16 v[184:187], v[64:67], a[232:235], v[184:187]
v_mul_f32 v214, v214, v95
v_mul_f32 v213, v94, v110
v_mfma_f32_16x16x32_bf16 v[184:187], v[68:71], a[248:251], v[184:187]
ds_read_b128 v[60:63], v7 offset:44032
v_mul_f32 v215, v95, v111
v_mfma_f32_16x16x32_bf16 v[188:191], v[64:67], a[236:239], v[188:191]
v_exp_f32 v212, v212
v_mfma_f32_16x16x32_bf16 v[188:191], v[68:71], a[252:255], v[188:191]
v_fma_f32 v212, v212, v243, v243
s_waitcnt lgkmcnt(4)
v_mfma_f32_16x16x32_bf16 v[192:195], v[72:75], a[224:227], v[192:195]
v_exp_f32 v214, v214
v_mfma_f32_16x16x32_bf16 v[192:195], v[76:79], a[240:243], v[192:195]
v_fma_f32 v214, v214, v243, v243
v_mul_f32 v208, v112, v112
v_mfma_f32_16x16x32_bf16 v[196:199], v[72:75], a[228:231], v[196:199]
ds_read_b128 v[64:67], v7 offset:45056
v_mul_f32 v210, v113, v113
v_mfma_f32_16x16x32_bf16 v[196:199], v[76:79], a[244:247], v[196:199]
v_rcp_f32 v212, v212
v_mfma_f32_16x16x32_bf16 v[200:203], v[72:75], a[232:235], v[200:203]
v_rcp_f32 v214, v214
v_mfma_f32_16x16x32_bf16 v[200:203], v[76:79], a[248:251], v[200:203]
ds_read_b128 v[68:71], v7 offset:46080
v_mul_f32 v213, v213, v212
v_mfma_f32_16x16x32_bf16 v[204:207], v[72:75], a[236:239], v[204:207]
v_mul_f32 v215, v215, v214
v_cvt_pk_bf16_f32 v231, v213, v215
v_mfma_f32_16x16x32_bf16 v[204:207], v[76:79], a[252:255], v[204:207]
v_fma_f32 v208, v208, v233, v232
s_waitcnt lgkmcnt(4)
v_mfma_f32_16x16x32_bf16 v[176:179], v[48:51], v[16:19], v[176:179]
buffer_store_dwordx2 v[230:231], v247, s[8:11], s30 offen sc1
v_mfma_f32_16x16x32_bf16 v[176:179], v[52:55], v[32:35], v[176:179]
v_fma_f32 v210, v210, v233, v232
v_mul_f32 v208, v208, v112
v_mfma_f32_16x16x32_bf16 v[180:183], v[48:51], v[20:23], v[180:183]
ds_read_b128 v[72:75], v7 offset:47104
v_mul_f32 v210, v210, v113
v_mfma_f32_16x16x32_bf16 v[180:183], v[52:55], v[36:39], v[180:183]
v_exp_f32 v208, v208
v_mfma_f32_16x16x32_bf16 v[184:187], v[48:51], v[24:27], v[184:187]
v_exp_f32 v210, v210
v_mfma_f32_16x16x32_bf16 v[184:187], v[52:55], v[40:43], v[184:187]
ds_read_b128 v[76:79], v7 offset:48128
v_mul_f32 v209, v112, v128
v_mfma_f32_16x16x32_bf16 v[188:191], v[48:51], v[28:31], v[188:191]
v_mul_f32 v211, v113, v129
v_fma_f32 v208, v208, v234, v234
v_mfma_f32_16x16x32_bf16 v[188:191], v[52:55], v[44:47], v[188:191]
v_fma_f32 v210, v210, v234, v234
s_waitcnt lgkmcnt(4)
v_mfma_f32_16x16x32_bf16 v[192:195], v[56:59], v[16:19], v[192:195]
v_rcp_f32 v208, v208
v_mfma_f32_16x16x32_bf16 v[192:195], v[60:63], v[32:35], v[192:195]
v_rcp_f32 v210, v210
v_mfma_f32_16x16x32_bf16 v[196:199], v[56:59], v[20:23], v[196:199]
ds_read_b128 v[48:51], v7 offset:49152
v_mul_f32 v209, v209, v208
v_mfma_f32_16x16x32_bf16 v[196:199], v[60:63], v[36:39], v[196:199]
v_mul_f32 v211, v211, v210
v_cvt_pk_bf16_f32 v144, v209, v211
v_mfma_f32_16x16x32_bf16 v[200:203], v[56:59], v[24:27], v[200:203]
v_mul_f32 v212, v114, v114
v_mul_f32 v214, v115, v115
v_mfma_f32_16x16x32_bf16 v[200:203], v[60:63], v[40:43], v[200:203]
ds_read_b128 v[52:55], v7 offset:50176
v_fma_f32 v212, v212, v233, v232
v_mfma_f32_16x16x32_bf16 v[204:207], v[56:59], v[28:31], v[204:207]
v_fma_f32 v214, v214, v233, v232
v_mul_f32 v212, v212, v114
v_mfma_f32_16x16x32_bf16 v[204:207], v[60:63], v[44:47], v[204:207]
v_mul_f32 v214, v214, v115
s_waitcnt lgkmcnt(4)
v_mfma_f32_16x16x32_bf16 v[80:83], v[64:67], a[0:3], 0
v_exp_f32 v212, v212
v_mfma_f32_16x16x32_bf16 v[80:83], v[68:71], a[16:19], v[80:83]
v_exp_f32 v214, v214
v_mfma_f32_16x16x32_bf16 v[84:87], v[64:67], a[4:7], 0
ds_read_b128 v[56:59], v7 offset:51200
v_mul_f32 v213, v114, v130
v_mfma_f32_16x16x32_bf16 v[84:87], v[68:71], a[20:23], v[84:87]
v_mul_f32 v215, v115, v131
v_fma_f32 v212, v212, v234, v234
v_mfma_f32_16x16x32_bf16 v[88:91], v[64:67], a[8:11], 0
v_fma_f32 v214, v214, v234, v234
v_mul_f32 v208, v116, v116
v_mfma_f32_16x16x32_bf16 v[88:91], v[68:71], a[24:27], v[88:91]
ds_read_b128 v[60:63], v7 offset:52224
v_mul_f32 v210, v117, v117
v_mfma_f32_16x16x32_bf16 v[92:95], v[64:67], a[12:15], 0
v_rcp_f32 v212, v212
v_mfma_f32_16x16x32_bf16 v[92:95], v[68:71], a[28:31], v[92:95]
v_mul_f32 v213, v213, v212
s_waitcnt lgkmcnt(4)
v_mfma_f32_16x16x32_bf16 v[96:99], v[72:75], a[0:3], 0
v_rcp_f32 v214, v214
v_mfma_f32_16x16x32_bf16 v[96:99], v[76:79], a[16:19], v[96:99]
v_mul_f32 v215, v215, v214
v_cvt_pk_bf16_f32 v145, v213, v215
v_mfma_f32_16x16x32_bf16 v[100:103], v[72:75], a[4:7], 0
ds_read_b128 v[64:67], v7 offset:53248
v_fma_f32 v208, v208, v236, v235
v_mfma_f32_16x16x32_bf16 v[100:103], v[76:79], a[20:23], v[100:103]
v_fma_f32 v210, v210, v236, v235
v_mul_f32 v208, v208, v116
v_mfma_f32_16x16x32_bf16 v[104:107], v[72:75], a[8:11], 0
v_mul_f32 v210, v210, v117
v_mul_f32 v209, v116, v132
v_mfma_f32_16x16x32_bf16 v[104:107], v[76:79], a[24:27], v[104:107]
ds_read_b128 v[68:71], v7 offset:54272
v_mul_f32 v211, v117, v133
v_mfma_f32_16x16x32_bf16 v[108:111], v[72:75], a[12:15], 0
v_exp_f32 v208, v208
v_mfma_f32_16x16x32_bf16 v[108:111], v[76:79], a[28:31], v[108:111]
v_fma_f32 v208, v208, v237, v237
s_waitcnt lgkmcnt(4)
v_mfma_f32_16x16x32_bf16 v[80:83], v[48:51], a[32:35], v[80:83]
v_exp_f32 v210, v210
v_mfma_f32_16x16x32_bf16 v[80:83], v[52:55], a[48:51], v[80:83]
v_fma_f32 v210, v210, v237, v237
v_mul_f32 v212, v118, v118
v_mfma_f32_16x16x32_bf16 v[84:87], v[48:51], a[36:39], v[84:87]
ds_read_b128 v[72:75], v7 offset:55296
v_mul_f32 v214, v119, v119
v_mfma_f32_16x16x32_bf16 v[84:87], v[52:55], a[52:55], v[84:87]
v_rcp_f32 v208, v208
v_mfma_f32_16x16x32_bf16 v[88:91], v[48:51], a[40:43], v[88:91]
v_rcp_f32 v210, v210
v_mfma_f32_16x16x32_bf16 v[88:91], v[52:55], a[56:59], v[88:91]
ds_read_b128 v[76:79], v7 offset:56320
v_mul_f32 v209, v209, v208
v_mfma_f32_16x16x32_bf16 v[92:95], v[48:51], a[44:47], v[92:95]
v_mul_f32 v211, v211, v210
v_cvt_pk_bf16_f32 v148, v209, v211
v_mfma_f32_16x16x32_bf16 v[92:95], v[52:55], a[60:63], v[92:95]
v_fma_f32 v212, v212, v236, v235
s_waitcnt lgkmcnt(4)
v_mfma_f32_16x16x32_bf16 v[96:99], v[56:59], a[32:35], v[96:99]
s_waitcnt vmcnt(22)
v_fma_f32 v214, v214, v236, v235
v_mfma_f32_16x16x32_bf16 v[96:99], v[60:63], a[48:51], v[96:99]
s_barrier
v_mfma_f32_16x16x32_bf16 v[100:103], v[56:59], a[36:39], v[100:103]
ds_read_b128 v[48:51], v7 offset:57344
s_add_u32 m0, s22, 73728
v_mfma_f32_16x16x32_bf16 v[100:103], v[60:63], a[52:55], v[100:103]
v_add_u32 v3, 20480, v3
buffer_load_dwordx4 v3, s[8:11], 0 offen offset:0 sc1 lds
v_mfma_f32_16x16x32_bf16 v[104:107], v[56:59], a[40:43], v[104:107]
v_mul_f32 v212, v212, v118
v_mul_f32 v214, v214, v119
v_mfma_f32_16x16x32_bf16 v[104:107], v[60:63], a[56:59], v[104:107]
ds_read_b128 v[52:55], v7 offset:58368
v_mul_f32 v213, v118, v134
v_mfma_f32_16x16x32_bf16 v[108:111], v[56:59], a[44:47], v[108:111]
v_exp_f32 v212, v212
v_mfma_f32_16x16x32_bf16 v[108:111], v[60:63], a[60:63], v[108:111]
v_mul_f32 v215, v119, v135
s_waitcnt lgkmcnt(4)
v_mfma_f32_16x16x32_bf16 v[80:83], v[64:67], a[64:67], v[80:83]
buffer_load_dwordx4 v3, s[8:11], 0 offen offset:1024 sc1 lds
v_mfma_f32_16x16x32_bf16 v[80:83], v[68:71], a[80:83], v[80:83]
v_exp_f32 v214, v214
v_mfma_f32_16x16x32_bf16 v[84:87], v[64:67], a[68:71], v[84:87]
ds_read_b128 v[56:59], v7 offset:59392
v_fma_f32 v212, v212, v237, v237
v_mfma_f32_16x16x32_bf16 v[84:87], v[68:71], a[84:87], v[84:87]
v_fma_f32 v214, v214, v237, v237
v_mul_f32 v208, v120, v120
v_mfma_f32_16x16x32_bf16 v[88:91], v[64:67], a[72:75], v[88:91]
buffer_load_dwordx4 v3, s[8:11], 0 offen offset:2048 sc1 lds
v_mfma_f32_16x16x32_bf16 v[88:91], v[68:71], a[88:91], v[88:91]
ds_read_b128 v[60:63], v7 offset:60416
v_mul_f32 v210, v121, v121
v_mfma_f32_16x16x32_bf16 v[92:95], v[64:67], a[76:79], v[92:95]
v_rcp_f32 v212, v212
v_mfma_f32_16x16x32_bf16 v[92:95], v[68:71], a[92:95], v[92:95]
v_mul_f32 v213, v213, v212
s_waitcnt lgkmcnt(4)
v_mfma_f32_16x16x32_bf16 v[96:99], v[72:75], a[64:67], v[96:99]
buffer_load_dwordx4 v3, s[8:11], 0 offen offset:3072 sc1 lds
v_mfma_f32_16x16x32_bf16 v[96:99], v[76:79], a[80:83], v[96:99]
s_add_u32 m0, s22, 77824
v_add_u32 v3, 4096, v3
v_mfma_f32_16x16x32_bf16 v[100:103], v[72:75], a[68:71], v[100:103]
ds_read_b128 v[64:67], v7 offset:61440
v_fma_f32 v208, v208, v239, v238
v_mfma_f32_16x16x32_bf16 v[100:103], v[76:79], a[84:87], v[100:103]
v_rcp_f32 v214, v214
v_mfma_f32_16x16x32_bf16 v[104:107], v[72:75], a[72:75], v[104:107]
buffer_load_dwordx4 v3, s[8:11], 0 offen offset:0 sc1 lds
v_mfma_f32_16x16x32_bf16 v[104:107], v[76:79], a[88:91], v[104:107]
ds_read_b128 v[68:71], v7 offset:62464
v_mul_f32 v215, v215, v214
v_mfma_f32_16x16x32_bf16 v[108:111], v[72:75], a[76:79], v[108:111]
v_cvt_pk_bf16_f32 v149, v213, v215
v_fma_f32 v210, v210, v239, v238
v_mfma_f32_16x16x32_bf16 v[108:111], v[76:79], a[92:95], v[108:111]
v_mul_f32 v208, v208, v120
s_waitcnt lgkmcnt(4)
v_mfma_f32_16x16x32_bf16 v[80:83], v[48:51], a[96:99], v[80:83]
buffer_load_dwordx4 v3, s[8:11], 0 offen offset:1024 sc1 lds
v_mfma_f32_16x16x32_bf16 v[80:83], v[52:55], a[112:115], v[80:83]
v_mul_f32 v210, v210, v121
v_mul_f32 v209, v120, v136
v_mfma_f32_16x16x32_bf16 v[84:87], v[48:51], a[100:103], v[84:87]
ds_read_b128 v[72:75], v7 offset:63488
v_mul_f32 v211, v121, v137
v_mfma_f32_16x16x32_bf16 v[84:87], v[52:55], a[116:119], v[84:87]
v_exp_f32 v208, v208
v_mfma_f32_16x16x32_bf16 v[88:91], v[48:51], a[104:107], v[88:91]
v_exp_f32 v210, v210
v_mfma_f32_16x16x32_bf16 v[88:91], v[52:55], a[120:123], v[88:91]
ds_read_b128 v[76:79], v7 offset:64512
v_fma_f32 v208, v208, v240, v240
v_mfma_f32_16x16x32_bf16 v[92:95], v[48:51], a[108:111], v[92:95]
v_fma_f32 v210, v210, v240, v240
v_mul_f32 v212, v122, v122
v_mfma_f32_16x16x32_bf16 v[92:95], v[52:55], a[124:127], v[92:95]
v_mul_f32 v214, v123, v123
s_waitcnt lgkmcnt(4)
v_mfma_f32_16x16x32_bf16 v[96:99], v[56:59], a[96:99], v[96:99]
v_rcp_f32 v208, v208
v_mfma_f32_16x16x32_bf16 v[96:99], v[60:63], a[112:115], v[96:99]
v_rcp_f32 v210, v210
v_mfma_f32_16x16x32_bf16 v[100:103], v[56:59], a[100:103], v[100:103]
ds_read_b128 v[48:51], v8 offset:0
v_mul_f32 v209, v209, v208
v_mfma_f32_16x16x32_bf16 v[100:103], v[60:63], a[116:119], v[100:103]
v_mul_f32 v211, v211, v210
v_cvt_pk_bf16_f32 v152, v209, v211
v_mfma_f32_16x16x32_bf16 v[104:107], v[56:59], a[104:107], v[104:107]
v_fma_f32 v212, v212, v239, v238
v_fma_f32 v214, v214, v239, v238
v_mfma_f32_16x16x32_bf16 v[104:107], v[60:63], a[120:123], v[104:107]
ds_read_b128 v[52:55], v8 offset:1024
v_mul_f32 v212, v212, v122
v_mfma_f32_16x16x32_bf16 v[108:111], v[56:59], a[108:111], v[108:111]
v_mul_f32 v214, v214, v123
v_mul_f32 v213, v122, v138
v_mfma_f32_16x16x32_bf16 v[108:111], v[60:63], a[124:127], v[108:111]
v_mul_f32 v215, v123, v139
s_waitcnt lgkmcnt(4)
v_mfma_f32_16x16x32_bf16 v[80:83], v[64:67], a[128:131], v[80:83]
v_exp_f32 v212, v212
v_mfma_f32_16x16x32_bf16 v[80:83], v[68:71], a[144:147], v[80:83]
v_exp_f32 v214, v214
v_mfma_f32_16x16x32_bf16 v[84:87], v[64:67], a[132:135], v[84:87]
ds_read_b128 v[56:59], v8 offset:2048
v_fma_f32 v212, v212, v240, v240
v_mfma_f32_16x16x32_bf16 v[84:87], v[68:71], a[148:151], v[84:87]
v_fma_f32 v214, v214, v240, v240
v_mul_f32 v208, v124, v124
v_mfma_f32_16x16x32_bf16 v[88:91], v[64:67], a[136:139], v[88:91]
v_rcp_f32 v212, v212
v_mfma_f32_16x16x32_bf16 v[88:91], v[68:71], a[152:155], v[88:91]
ds_read_b128 v[60:63], v8 offset:3072
v_mul_f32 v213, v213, v212
v_mfma_f32_16x16x32_bf16 v[92:95], v[64:67], a[140:143], v[92:95]
v_rcp_f32 v214, v214
v_mfma_f32_16x16x32_bf16 v[92:95], v[68:71], a[156:159], v[92:95]
v_mul_f32 v215, v215, v214
s_waitcnt lgkmcnt(4)
v_mfma_f32_16x16x32_bf16 v[96:99], v[72:75], a[128:131], v[96:99]
v_cvt_pk_bf16_f32 v153, v213, v215
v_mul_f32 v210, v125, v125
v_mfma_f32_16x16x32_bf16 v[96:99], v[76:79], a[144:147], v[96:99]
v_fma_f32 v208, v208, v242, v241
v_fma_f32 v210, v210, v242, v241
v_mfma_f32_16x16x32_bf16 v[100:103], v[72:75], a[132:135], v[100:103]
ds_read_b128 v[64:67], v8 offset:4096
v_mul_f32 v208, v208, v124
v_mfma_f32_16x16x32_bf16 v[100:103], v[76:79], a[148:151], v[100:103]
v_mul_f32 v210, v210, v125
v_mul_f32 v209, v124, v140
v_mfma_f32_16x16x32_bf16 v[104:107], v[72:75], a[136:139], v[104:107]
v_exp_f32 v208, v208
v_mfma_f32_16x16x32_bf16 v[104:107], v[76:79], a[152:155], v[104:107]
ds_read_b128 v[68:71], v8 offset:5120
v_mul_f32 v211, v125, v141
v_mfma_f32_16x16x32_bf16 v[108:111], v[72:75], a[140:143], v[108:111]
v_exp_f32 v210, v210
v_mfma_f32_16x16x32_bf16 v[108:111], v[76:79], a[156:159], v[108:111]
v_fma_f32 v208, v208, v243, v243
s_waitcnt lgkmcnt(4)
v_mfma_f32_16x16x32_bf16 v[80:83], v[48:51], a[160:163], v[80:83]
v_fma_f32 v210, v210, v243, v243
v_mul_f32 v212, v126, v126
v_mfma_f32_16x16x32_bf16 v[80:83], v[52:55], a[176:179], v[80:83]
v_rcp_f32 v208, v208
v_mfma_f32_16x16x32_bf16 v[84:87], v[48:51], a[164:167], v[84:87]
ds_read_b128 v[72:75], v8 offset:6144
v_mul_f32 v209, v209, v208
v_mfma_f32_16x16x32_bf16 v[84:87], v[52:55], a[180:183], v[84:87]
v_rcp_f32 v210, v210
v_mfma_f32_16x16x32_bf16 v[88:91], v[48:51], a[168:171], v[88:91]
v_mul_f32 v211, v211, v210
v_cvt_pk_bf16_f32 v156, v209, v211
v_mfma_f32_16x16x32_bf16 v[88:91], v[52:55], a[184:187], v[88:91]
ds_read_b128 v[76:79], v8 offset:7168
v_mul_f32 v214, v127, v127
v_mfma_f32_16x16x32_bf16 v[92:95], v[48:51], a[172:175], v[92:95]
v_fma_f32 v212, v212, v242, v241
v_fma_f32 v214, v214, v242, v241
v_mfma_f32_16x16x32_bf16 v[92:95], v[52:55], a[188:191], v[92:95]
v_mul_f32 v212, v212, v126
s_waitcnt lgkmcnt(4)
v_mfma_f32_16x16x32_bf16 v[96:99], v[56:59], a[160:163], v[96:99]
v_mul_f32 v214, v214, v127
v_mul_f32 v213, v126, v142
v_mfma_f32_16x16x32_bf16 v[96:99], v[60:63], a[176:179], v[96:99]
v_exp_f32 v212, v212
v_mfma_f32_16x16x32_bf16 v[100:103], v[56:59], a[164:167], v[100:103]
ds_read_b128 v[48:51], v8 offset:8192
v_mul_f32 v215, v127, v143
v_mfma_f32_16x16x32_bf16 v[100:103], v[60:63], a[180:183], v[100:103]
v_exp_f32 v214, v214
v_mfma_f32_16x16x32_bf16 v[104:107], v[56:59], a[168:171], v[104:107]
v_fma_f32 v212, v212, v243, v243
v_fma_f32 v214, v214, v243, v243
v_mfma_f32_16x16x32_bf16 v[104:107], v[60:63], a[184:187], v[104:107]
ds_read_b128 v[52:55], v8 offset:9216
v_mul_f32 v216, v176, v176
v_mfma_f32_16x16x32_bf16 v[108:111], v[56:59], a[172:175], v[108:111]
v_rcp_f32 v212, v212
v_mfma_f32_16x16x32_bf16 v[108:111], v[60:63], a[188:191], v[108:111]
v_mul_f32 v213, v213, v212
s_waitcnt lgkmcnt(4)
v_mfma_f32_16x16x32_bf16 v[80:83], v[64:67], a[192:195], v[80:83]
v_rcp_f32 v214, v214
v_mfma_f32_16x16x32_bf16 v[80:83], v[68:71], a[208:211], v[80:83]
v_mul_f32 v215, v215, v214
v_cvt_pk_bf16_f32 v157, v213, v215
v_mfma_f32_16x16x32_bf16 v[84:87], v[64:67], a[196:199], v[84:87]
ds_read_b128 v[56:59], v8 offset:10240
v_mul_f32 v218, v177, v177
v_mfma_f32_16x16x32_bf16 v[84:87], v[68:71], a[212:215], v[84:87]
v_fma_f32 v216, v216, v233, v232
v_fma_f32 v218, v218, v233, v232
v_mfma_f32_16x16x32_bf16 v[88:91], v[64:67], a[200:203], v[88:91]
v_mul_f32 v216, v216, v176
v_mul_f32 v218, v218, v177
v_mfma_f32_16x16x32_bf16 v[88:91], v[68:71], a[216:219], v[88:91]
ds_read_b128 v[60:63], v8 offset:11264
v_mul_f32 v217, v176, v192
v_mfma_f32_16x16x32_bf16 v[92:95], v[64:67], a[204:207], v[92:95]
v_exp_f32 v216, v216
v_mfma_f32_16x16x32_bf16 v[92:95], v[68:71], a[220:223], v[92:95]
v_mul_f32 v219, v177, v193
s_waitcnt lgkmcnt(4)
v_mfma_f32_16x16x32_bf16 v[96:99], v[72:75], a[192:195], v[96:99]
v_exp_f32 v218, v218
v_mfma_f32_16x16x32_bf16 v[96:99], v[76:79], a[208:211], v[96:99]
v_fma_f32 v216, v216, v234, v234
v_fma_f32 v218, v218, v234, v234
v_mfma_f32_16x16x32_bf16 v[100:103], v[72:75], a[196:199], v[100:103]
ds_read_b128 v[64:67], v8 offset:12288
v_mul_f32 v220, v178, v178
v_mfma_f32_16x16x32_bf16 v[100:103], v[76:79], a[212:215], v[100:103]
v_rcp_f32 v216, v216
v_mfma_f32_16x16x32_bf16 v[104:107], v[72:75], a[200:203], v[104:107]
v_rcp_f32 v218, v218
v_mfma_f32_16x16x32_bf16 v[104:107], v[76:79], a[216:219], v[104:107]
ds_read_b128 v[68:71], v8 offset:13312
v_mul_f32 v217, v217, v216
v_mfma_f32_16x16x32_bf16 v[108:111], v[72:75], a[204:207], v[108:111]
v_mul_f32 v219, v219, v218
v_cvt_pk_bf16_f32 v146, v217, v219
v_mfma_f32_16x16x32_bf16 v[108:111], v[76:79], a[220:223], v[108:111]
v_mul_f32 v222, v179, v179
s_waitcnt lgkmcnt(4)
v_mfma_f32_16x16x32_bf16 v[80:83], v[48:51], a[224:227], v[80:83]
v_fma_f32 v220, v220, v233, v232
v_fma_f32 v222, v222, v233, v232
v_mfma_f32_16x16x32_bf16 v[80:83], v[52:55], a[240:243], v[80:83]
v_mul_f32 v220, v220, v178
v_mul_f32 v222, v222, v179
v_mfma_f32_16x16x32_bf16 v[84:87], v[48:51], a[228:231], v[84:87]
ds_read_b128 v[72:75], v8 offset:14336
v_mul_f32 v221, v178, v194
v_mfma_f32_16x16x32_bf16 v[84:87], v[52:55], a[244:247], v[84:87]
v_exp_f32 v220, v220
v_mfma_f32_16x16x32_bf16 v[88:91], v[48:51], a[232:235], v[88:91]
v_exp_f32 v222, v222
v_mfma_f32_16x16x32_bf16 v[88:91], v[52:55], a[248:251], v[88:91]
ds_read_b128 v[76:79], v8 offset:15360
v_mul_f32 v223, v179, v195
v_mfma_f32_16x16x32_bf16 v[92:95], v[48:51], a[236:239], v[92:95]
v_fma_f32 v220, v220, v234, v234
v_fma_f32 v222, v222, v234, v234
v_mfma_f32_16x16x32_bf16 v[92:95], v[52:55], a[252:255], v[92:95]
v_mul_f32 v216, v180, v180
s_waitcnt lgkmcnt(4)
v_mfma_f32_16x16x32_bf16 v[96:99], v[56:59], a[224:227], v[96:99]
s_waitcnt vmcnt(22)
v_mul_f32 v218, v181, v181
v_mfma_f32_16x16x32_bf16 v[96:99], v[60:63], a[240:243], v[96:99]
s_barrier
v_mfma_f32_16x16x32_bf16 v[100:103], v[56:59], a[228:231], v[100:103]
ds_read_b128 v[48:51], v2 offset:0
s_add_u32 m0, s22, 98304
v_mfma_f32_16x16x32_bf16 v[100:103], v[60:63], a[244:247], v[100:103]
v_add_u32 v3, 20480, v3
buffer_load_dwordx4 v3, s[8:11], 0 offen offset:0 sc1 lds
v_mfma_f32_16x16x32_bf16 v[104:107], v[56:59], a[232:235], v[104:107]
v_rcp_f32 v220, v220
v_mfma_f32_16x16x32_bf16 v[104:107], v[60:63], a[248:251], v[104:107]
ds_read_b128 v[52:55], v2 offset:1024
v_mul_f32 v221, v221, v220
v_mfma_f32_16x16x32_bf16 v[108:111], v[56:59], a[236:239], v[108:111]
v_rcp_f32 v222, v222
v_mfma_f32_16x16x32_bf16 v[108:111], v[60:63], a[252:255], v[108:111]
v_mul_f32 v223, v223, v222
s_waitcnt lgkmcnt(4)
v_mfma_f32_16x16x32_bf16 v[80:83], v[64:67], v[16:19], v[80:83]
buffer_load_dwordx4 v3, s[8:11], 0 offen offset:1024 sc1 lds
v_mfma_f32_16x16x32_bf16 v[80:83], v[68:71], v[32:35], v[80:83]
v_cvt_pk_bf16_f32 v147, v221, v223
v_fma_f32 v216, v216, v236, v235
v_mfma_f32_16x16x32_bf16 v[84:87], v[64:67], v[20:23], v[84:87]
ds_read_b128 v[56:59], v2 offset:2048
v_fma_f32 v218, v218, v236, v235
v_mfma_f32_16x16x32_bf16 v[84:87], v[68:71], v[36:39], v[84:87]
buffer_store_dwordx4 v[144:147], v2, s[8:11], s24 offen offset:0 sc1
v_mfma_f32_16x16x32_bf16 v[88:91], v[64:67], v[24:27], v[88:91]
v_mul_f32 v216, v216, v180
v_mul_f32 v218, v218, v181
v_mfma_f32_16x16x32_bf16 v[88:91], v[68:71], v[40:43], v[88:91]
ds_read_b128 v[60:63], v2 offset:3072
v_mul_f32 v217, v180, v196
v_mfma_f32_16x16x32_bf16 v[92:95], v[64:67], v[28:31], v[92:95]
v_exp_f32 v216, v216
v_mfma_f32_16x16x32_bf16 v[92:95], v[68:71], v[44:47], v[92:95]
v_mul_f32 v219, v181, v197
s_waitcnt lgkmcnt(4)
v_mfma_f32_16x16x32_bf16 v[96:99], v[72:75], v[16:19], v[96:99]
buffer_load_dwordx4 v3, s[8:11], 0 offen offset:2048 sc1 lds
v_mfma_f32_16x16x32_bf16 v[96:99], v[76:79], v[32:35], v[96:99]
v_exp_f32 v218, v218
v_mfma_f32_16x16x32_bf16 v[100:103], v[72:75], v[20:23], v[100:103]
ds_read_b128 v[64:67], v2 offset:4096
v_fma_f32 v216, v216, v237, v237
v_mfma_f32_16x16x32_bf16 v[100:103], v[76:79], v[36:39], v[100:103]
v_fma_f32 v218, v218, v237, v237
v_mul_f32 v220, v182, v182
v_mfma_f32_16x16x32_bf16 v[104:107], v[72:75], v[24:27], v[104:107]
buffer_load_dwordx4 v3, s[8:11], 0 offen offset:3072 sc1 lds
v_mfma_f32_16x16x32_bf16 v[104:107], v[76:79], v[40:43], v[104:107]
ds_read_b128 v[68:71], v2 offset:5120
s_add_u32 m0, s22, 102400
v_mfma_f32_16x16x32_bf16 v[108:111], v[72:75], v[28:31], v[108:111]
v_add_u32 v3, 4096, v3
v_mul_f32 v222, v183, v183
v_mfma_f32_16x16x32_bf16 v[108:111], v[76:79], v[44:47], v[108:111]
v_fma_f32 v220, v220, v236, v235
s_waitcnt lgkmcnt(4)
v_mfma_f32_16x16x32_bf16 v[112:115], v[48:51], a[0:3], 0
buffer_load_dwordx4 v3, s[8:11], 0 offen offset:0 sc1 lds
v_mfma_f32_16x16x32_bf16 v[112:115], v[52:55], a[16:19], v[112:115]
v_rcp_f32 v216, v216
v_mfma_f32_16x16x32_bf16 v[116:119], v[48:51], a[4:7], 0
ds_read_b128 v[72:75], v2 offset:6144
v_mul_f32 v217, v217, v216
v_mfma_f32_16x16x32_bf16 v[116:119], v[52:55], a[20:23], v[116:119]
v_mul_f32 v208, v80, v80
v_mul_f32 v210, v81, v81
v_mfma_f32_16x16x32_bf16 v[120:123], v[48:51], a[8:11], 0
buffer_load_dwordx4 v3, s[8:11], 0 offen offset:1024 sc1 lds
v_mfma_f32_16x16x32_bf16 v[120:123], v[52:55], a[24:27], v[120:123]
ds_read_b128 v[76:79], v2 offset:7168
v_fma_f32 v208, v208, v233, v232
v_mfma_f32_16x16x32_bf16 v[124:127], v[48:51], a[12:15], 0
v_fma_f32 v210, v210, v233, v232
v_mul_f32 v208, v208, v80
v_mfma_f32_16x16x32_bf16 v[124:127], v[52:55], a[28:31], v[124:127]
v_mul_f32 v210, v210, v81
s_waitcnt lgkmcnt(4)
v_mfma_f32_16x16x32_bf16 v[128:131], v[56:59], a[0:3], 0
v_exp_f32 v208, v208
v_mfma_f32_16x16x32_bf16 v[128:131], v[60:63], a[16:19], v[128:131]
v_exp_f32 v210, v210
v_mfma_f32_16x16x32_bf16 v[132:135], v[56:59], a[4:7], 0
ds_read_b128 v[48:51], v2 offset:8192
v_mul_f32 v209, v80, v96
v_mfma_f32_16x16x32_bf16 v[132:135], v[60:63], a[20:23], v[132:135]
v_mul_f32 v211, v81, v97
v_fma_f32 v208, v208, v234, v234
v_mfma_f32_16x16x32_bf16 v[136:139], v[56:59], a[8:11], 0
v_fma_f32 v210, v210, v234, v234
v_mul_f32 v212, v82, v82
v_mfma_f32_16x16x32_bf16 v[136:139], v[60:63], a[24:27], v[136:139]
ds_read_b128 v[52:55], v2 offset:9216
v_mul_f32 v214, v83, v83
v_mfma_f32_16x16x32_bf16 v[140:143], v[56:59], a[12:15], 0
v_rcp_f32 v208, v208
v_mfma_f32_16x16x32_bf16 v[140:143], v[60:63], a[28:31], v[140:143]
v_mul_f32 v209, v209, v208
s_waitcnt lgkmcnt(4)
v_mfma_f32_16x16x32_bf16 v[112:115], v[64:67], a[32:35], v[112:115]
v_rcp_f32 v210, v210
v_mfma_f32_16x16x32_bf16 v[112:115], v[68:71], a[48:51], v[112:115]
v_mul_f32 v211, v211, v210
v_cvt_pk_bf16_f32 v160, v209, v211
v_mfma_f32_16x16x32_bf16 v[116:119], v[64:67], a[36:39], v[116:119]
ds_read_b128 v[56:59], v2 offset:10240
v_fma_f32 v212, v212, v233, v232
v_mfma_f32_16x16x32_bf16 v[116:119], v[68:71], a[52:55], v[116:119]
v_fma_f32 v214, v214, v233, v232
v_mul_f32 v212, v212, v82
v_mfma_f32_16x16x32_bf16 v[120:123], v[64:67], a[40:43], v[120:123]
v_mul_f32 v214, v214, v83
v_mul_f32 v213, v82, v98
v_mfma_f32_16x16x32_bf16 v[120:123], v[68:71], a[56:59], v[120:123]
ds_read_b128 v[60:63], v2 offset:11264
v_mul_f32 v215, v83, v99
v_mfma_f32_16x16x32_bf16 v[124:127], v[64:67], a[44:47], v[124:127]
v_exp_f32 v212, v212
v_mfma_f32_16x16x32_bf16 v[124:127], v[68:71], a[60:63], v[124:127]
v_fma_f32 v212, v212, v234, v234
s_waitcnt lgkmcnt(4)
v_mfma_f32_16x16x32_bf16 v[128:131], v[72:75], a[32:35], v[128:131]
v_exp_f32 v214, v214
v_mfma_f32_16x16x32_bf16 v[128:131], v[76:79], a[48:51], v[128:131]
v_fma_f32 v214, v214, v234, v234
v_mul_f32 v208, v84, v84
v_mfma_f32_16x16x32_bf16 v[132:135], v[72:75], a[36:39], v[132:135]
ds_read_b128 v[64:67], v2 offset:12288
v_mul_f32 v210, v85, v85
v_mfma_f32_16x16x32_bf16 v[132:135], v[76:79], a[52:55], v[132:135]
v_rcp_f32 v212, v212
v_mfma_f32_16x16x32_bf16 v[136:139], v[72:75], a[40:43], v[136:139]
v_rcp_f32 v214, v214
v_mfma_f32_16x16x32_bf16 v[136:139], v[76:79], a[56:59], v[136:139]
ds_read_b128 v[68:71], v2 offset:13312
v_mul_f32 v213, v213, v212
v_mfma_f32_16x16x32_bf16 v[140:143], v[72:75], a[44:47], v[140:143]
v_mul_f32 v215, v215, v214
v_cvt_pk_bf16_f32 v161, v213, v215
v_mfma_f32_16x16x32_bf16 v[140:143], v[76:79], a[60:63], v[140:143]
v_fma_f32 v208, v208, v236, v235
s_waitcnt lgkmcnt(4)
v_mfma_f32_16x16x32_bf16 v[112:115], v[48:51], a[64:67], v[112:115]
v_fma_f32 v210, v210, v236, v235
v_mul_f32 v208, v208, v84
v_mfma_f32_16x16x32_bf16 v[112:115], v[52:55], a[80:83], v[112:115]
v_mul_f32 v210, v210, v85
v_mul_f32 v209, v84, v100
v_mfma_f32_16x16x32_bf16 v[116:119], v[48:51], a[68:71], v[116:119]
ds_read_b128 v[72:75], v2 offset:14336
v_mul_f32 v211, v85, v101
v_mfma_f32_16x16x32_bf16 v[116:119], v[52:55], a[84:87], v[116:119]
v_exp_f32 v208, v208
v_mfma_f32_16x16x32_bf16 v[120:123], v[48:51], a[72:75], v[120:123]
v_exp_f32 v210, v210
v_mfma_f32_16x16x32_bf16 v[120:123], v[52:55], a[88:91], v[120:123]
ds_read_b128 v[76:79], v2 offset:15360
v_fma_f32 v208, v208, v237, v237
v_mfma_f32_16x16x32_bf16 v[124:127], v[48:51], a[76:79], v[124:127]
v_fma_f32 v210, v210, v237, v237
v_mul_f32 v212, v86, v86
v_mfma_f32_16x16x32_bf16 v[124:127], v[52:55], a[92:95], v[124:127]
v_mul_f32 v214, v87, v87
s_waitcnt lgkmcnt(4)
v_mfma_f32_16x16x32_bf16 v[128:131], v[56:59], a[64:67], v[128:131]
v_rcp_f32 v208, v208
v_mfma_f32_16x16x32_bf16 v[128:131], v[60:63], a[80:83], v[128:131]
v_rcp_f32 v210, v210
v_mfma_f32_16x16x32_bf16 v[132:135], v[56:59], a[68:71], v[132:135]
ds_read_b128 v[48:51], v2 offset:16384
v_mul_f32 v209, v209, v208
v_mfma_f32_16x16x32_bf16 v[132:135], v[60:63], a[84:87], v[132:135]
v_mul_f32 v211, v211, v210
v_cvt_pk_bf16_f32 v164, v209, v211
v_mfma_f32_16x16x32_bf16 v[136:139], v[56:59], a[72:75], v[136:139]
v_fma_f32 v212, v212, v236, v235
v_fma_f32 v214, v214, v236, v235
v_mfma_f32_16x16x32_bf16 v[136:139], v[60:63], a[88:91], v[136:139]
ds_read_b128 v[52:55], v2 offset:17408
v_mul_f32 v212, v212, v86
v_mfma_f32_16x16x32_bf16 v[140:143], v[56:59], a[76:79], v[140:143]
v_mul_f32 v214, v214, v87
v_mul_f32 v213, v86, v102
v_mfma_f32_16x16x32_bf16 v[140:143], v[60:63], a[92:95], v[140:143]
v_mul_f32 v215, v87, v103
s_waitcnt lgkmcnt(4)
v_mfma_f32_16x16x32_bf16 v[112:115], v[64:67], a[96:99], v[112:115]
v_exp_f32 v212, v212
v_mfma_f32_16x16x32_bf16 v[112:115], v[68:71], a[112:115], v[112:115]
v_exp_f32 v214, v214
v_mfma_f32_16x16x32_bf16 v[116:119], v[64:67], a[100:103], v[116:119]
ds_read_b128 v[56:59], v2 offset:18432
v_fma_f32 v212, v212, v237, v237
v_mfma_f32_16x16x32_bf16 v[116:119], v[68:71], a[116:119], v[116:119]
v_fma_f32 v214, v214, v237, v237
v_mul_f32 v208, v88, v88
v_mfma_f32_16x16x32_bf16 v[120:123], v[64:67], a[104:107], v[120:123]
v_rcp_f32 v212, v212
v_mfma_f32_16x16x32_bf16 v[120:123], v[68:71], a[120:123], v[120:123]
ds_read_b128 v[60:63], v2 offset:19456
v_mul_f32 v213, v213, v212
v_mfma_f32_16x16x32_bf16 v[124:127], v[64:67], a[108:111], v[124:127]
v_rcp_f32 v214, v214
v_mfma_f32_16x16x32_bf16 v[124:127], v[68:71], a[124:127], v[124:127]
v_mul_f32 v215, v215, v214
s_waitcnt lgkmcnt(4)
v_mfma_f32_16x16x32_bf16 v[128:131], v[72:75], a[96:99], v[128:131]
v_cvt_pk_bf16_f32 v165, v213, v215
v_mul_f32 v210, v89, v89
v_mfma_f32_16x16x32_bf16 v[128:131], v[76:79], a[112:115], v[128:131]
v_fma_f32 v208, v208, v239, v238
v_fma_f32 v210, v210, v239, v238
v_mfma_f32_16x16x32_bf16 v[132:135], v[72:75], a[100:103], v[132:135]
ds_read_b128 v[64:67], v2 offset:20480
v_mul_f32 v208, v208, v88
v_mfma_f32_16x16x32_bf16 v[132:135], v[76:79], a[116:119], v[132:135]
v_mul_f32 v210, v210, v89
v_mul_f32 v209, v88, v104
v_mfma_f32_16x16x32_bf16 v[136:139], v[72:75], a[104:107], v[136:139]
v_exp_f32 v208, v208
v_mfma_f32_16x16x32_bf16 v[136:139], v[76:79], a[120:123], v[136:139]
ds_read_b128 v[68:71], v2 offset:21504
v_mul_f32 v211, v89, v105
v_mfma_f32_16x16x32_bf16 v[140:143], v[72:75], a[108:111], v[140:143]
v_exp_f32 v210, v210
v_mfma_f32_16x16x32_bf16 v[140:143], v[76:79], a[124:127], v[140:143]
v_fma_f32 v208, v208, v240, v240
s_waitcnt lgkmcnt(4)
v_mfma_f32_16x16x32_bf16 v[112:115], v[48:51], a[128:131], v[112:115]
v_fma_f32 v210, v210, v240, v240
v_mul_f32 v212, v90, v90
v_mfma_f32_16x16x32_bf16 v[112:115], v[52:55], a[144:147], v[112:115]
v_rcp_f32 v208, v208
v_mfma_f32_16x16x32_bf16 v[116:119], v[48:51], a[132:135], v[116:119]
ds_read_b128 v[72:75], v2 offset:22528
v_mul_f32 v209, v209, v208
v_mfma_f32_16x16x32_bf16 v[116:119], v[52:55], a[148:151], v[116:119]
v_rcp_f32 v210, v210
v_mfma_f32_16x16x32_bf16 v[120:123], v[48:51], a[136:139], v[120:123]
v_mul_f32 v211, v211, v210
v_cvt_pk_bf16_f32 v168, v209, v211
v_mfma_f32_16x16x32_bf16 v[120:123], v[52:55], a[152:155], v[120:123]
ds_read_b128 v[76:79], v2 offset:23552
v_mul_f32 v214, v91, v91
v_mfma_f32_16x16x32_bf16 v[124:127], v[48:51], a[140:143], v[124:127]
v_fma_f32 v212, v212, v239, v238
v_fma_f32 v214, v214, v239, v238
v_mfma_f32_16x16x32_bf16 v[124:127], v[52:55], a[156:159], v[124:127]
v_mul_f32 v212, v212, v90
s_waitcnt lgkmcnt(4)
v_mfma_f32_16x16x32_bf16 v[128:131], v[56:59], a[128:131], v[128:131]
s_waitcnt vmcnt(23)
v_mul_f32 v214, v214, v91
v_mfma_f32_16x16x32_bf16 v[128:131], v[60:63], a[144:147], v[128:131]
s_barrier
v_mfma_f32_16x16x32_bf16 v[132:135], v[56:59], a[132:135], v[132:135]
ds_read_b128 v[48:51], v2 offset:24576
s_add_u32 m0, s22, 122880
v_mfma_f32_16x16x32_bf16 v[132:135], v[60:63], a[148:151], v[132:135]
v_add_u32 v3, 20480, v3
buffer_load_dwordx4 v3, s[8:11], 0 offen offset:0 sc1 lds
v_mfma_f32_16x16x32_bf16 v[136:139], v[56:59], a[136:139], v[136:139]
v_exp_f32 v212, v212
v_mfma_f32_16x16x32_bf16 v[136:139], v[60:63], a[152:155], v[136:139]
ds_read_b128 v[52:55], v2 offset:25600
v_mul_f32 v213, v90, v106
v_mfma_f32_16x16x32_bf16 v[140:143], v[56:59], a[140:143], v[140:143]
v_exp_f32 v214, v214
v_mfma_f32_16x16x32_bf16 v[140:143], v[60:63], a[156:159], v[140:143]
v_mul_f32 v215, v91, v107
s_waitcnt lgkmcnt(4)
v_mfma_f32_16x16x32_bf16 v[112:115], v[64:67], a[160:163], v[112:115]
buffer_load_dwordx4 v3, s[8:11], 0 offen offset:1024 sc1 lds
v_mfma_f32_16x16x32_bf16 v[112:115], v[68:71], a[176:179], v[112:115]
v_fma_f32 v212, v212, v240, v240
v_fma_f32 v214, v214, v240, v240
v_mfma_f32_16x16x32_bf16 v[116:119], v[64:67], a[164:167], v[116:119]
ds_read_b128 v[56:59], v2 offset:26624
v_mul_f32 v208, v92, v92
v_mfma_f32_16x16x32_bf16 v[116:119], v[68:71], a[180:183], v[116:119]
v_rcp_f32 v212, v212
v_mfma_f32_16x16x32_bf16 v[120:123], v[64:67], a[168:171], v[120:123]
buffer_load_dwordx4 v3, s[8:11], 0 offen offset:2048 sc1 lds
v_mfma_f32_16x16x32_bf16 v[120:123], v[68:71], a[184:187], v[120:123]
ds_read_b128 v[60:63], v2 offset:27648
v_mul_f32 v213, v213, v212
v_mfma_f32_16x16x32_bf16 v[124:127], v[64:67], a[172:175], v[124:127]
v_rcp_f32 v214, v214
v_mfma_f32_16x16x32_bf16 v[124:127], v[68:71], a[188:191], v[124:127]
v_mul_f32 v215, v215, v214
s_waitcnt lgkmcnt(4)
v_mfma_f32_16x16x32_bf16 v[128:131], v[72:75], a[160:163], v[128:131]
buffer_load_dwordx4 v3, s[8:11], 0 offen offset:3072 sc1 lds
v_mfma_f32_16x16x32_bf16 v[128:131], v[76:79], a[176:179], v[128:131]
s_add_u32 m0, s22, 126976
v_add_u32 v3, 4096, v3
v_mfma_f32_16x16x32_bf16 v[132:135], v[72:75], a[164:167], v[132:135]
ds_read_b128 v[64:67], v2 offset:28672
v_cvt_pk_bf16_f32 v169, v213, v215
v_mfma_f32_16x16x32_bf16 v[132:135], v[76:79], a[180:183], v[132:135]
v_mul_f32 v210, v93, v93
v_fma_f32 v208, v208, v242, v241
v_mfma_f32_16x16x32_bf16 v[136:139], v[72:75], a[168:171], v[136:139]
buffer_load_dwordx4 v3, s[8:11], 0 offen offset:0 sc1 lds
v_mfma_f32_16x16x32_bf16 v[136:139], v[76:79], a[184:187], v[136:139]
ds_read_b128 v[68:71], v2 offset:29696
v_fma_f32 v210, v210, v242, v241
v_mfma_f32_16x16x32_bf16 v[140:143], v[72:75], a[172:175], v[140:143]
v_mul_f32 v208, v208, v92
v_mul_f32 v210, v210, v93
v_mfma_f32_16x16x32_bf16 v[140:143], v[76:79], a[188:191], v[140:143]
v_mul_f32 v209, v92, v108
s_waitcnt lgkmcnt(4)
v_mfma_f32_16x16x32_bf16 v[112:115], v[48:51], a[192:195], v[112:115]
buffer_load_dwordx4 v3, s[8:11], 0 offen offset:1024 sc1 lds
v_mfma_f32_16x16x32_bf16 v[112:115], v[52:55], a[208:211], v[112:115]
v_exp_f32 v208, v208
v_mfma_f32_16x16x32_bf16 v[116:119], v[48:51], a[196:199], v[116:119]
ds_read_b128 v[72:75], v2 offset:30720
v_mul_f32 v211, v93, v109
v_mfma_f32_16x16x32_bf16 v[116:119], v[52:55], a[212:215], v[116:119]
v_exp_f32 v210, v210
v_mfma_f32_16x16x32_bf16 v[120:123], v[48:51], a[200:203], v[120:123]
v_fma_f32 v208, v208, v243, v243
v_fma_f32 v210, v210, v243, v243
v_mfma_f32_16x16x32_bf16 v[120:123], v[52:55], a[216:219], v[120:123]
ds_read_b128 v[76:79], v2 offset:31744
v_mul_f32 v212, v94, v94
v_mfma_f32_16x16x32_bf16 v[124:127], v[48:51], a[204:207], v[124:127]
v_rcp_f32 v208, v208
v_mfma_f32_16x16x32_bf16 v[124:127], v[52:55], a[220:223], v[124:127]
v_mul_f32 v209, v209, v208
s_waitcnt lgkmcnt(4)
v_mfma_f32_16x16x32_bf16 v[128:131], v[56:59], a[192:195], v[128:131]
v_rcp_f32 v210, v210
v_mfma_f32_16x16x32_bf16 v[128:131], v[60:63], a[208:211], v[128:131]
v_mul_f32 v211, v211, v210
v_cvt_pk_bf16_f32 v172, v209, v211
v_mfma_f32_16x16x32_bf16 v[132:135], v[56:59], a[196:199], v[132:135]
ds_read_b128 v[48:51], v2 offset:32768
v_mul_f32 v214, v95, v95
v_mfma_f32_16x16x32_bf16 v[132:135], v[60:63], a[212:215], v[132:135]
v_fma_f32 v212, v212, v242, v241
v_fma_f32 v214, v214, v242, v241
v_mfma_f32_16x16x32_bf16 v[136:139], v[56:59], a[200:203], v[136:139]
v_mul_f32 v212, v212, v94
v_mul_f32 v214, v214, v95
v_mfma_f32_16x16x32_bf16 v[136:139], v[60:63], a[216:219], v[136:139]
ds_read_b128 v[52:55], v2 offset:33792
v_mul_f32 v213, v94, v110
v_mfma_f32_16x16x32_bf16 v[140:143], v[56:59], a[204:207], v[140:143]
v_exp_f32 v212, v212
v_mfma_f32_16x16x32_bf16 v[140:143], v[60:63], a[220:223], v[140:143]
v_mul_f32 v215, v95, v111
s_waitcnt lgkmcnt(4)
v_mfma_f32_16x16x32_bf16 v[112:115], v[64:67], a[224:227], v[112:115]
v_exp_f32 v214, v214
v_mfma_f32_16x16x32_bf16 v[112:115], v[68:71], a[240:243], v[112:115]
v_fma_f32 v212, v212, v243, v243
v_fma_f32 v214, v214, v243, v243
v_mfma_f32_16x16x32_bf16 v[116:119], v[64:67], a[228:231], v[116:119]
ds_read_b128 v[56:59], v2 offset:34816
v_fma_f32 v222, v222, v236, v235
v_mfma_f32_16x16x32_bf16 v[116:119], v[68:71], a[244:247], v[116:119]
v_rcp_f32 v212, v212
v_mfma_f32_16x16x32_bf16 v[120:123], v[64:67], a[232:235], v[120:123]
v_rcp_f32 v214, v214
v_mfma_f32_16x16x32_bf16 v[120:123], v[68:71], a[248:251], v[120:123]
ds_read_b128 v[60:63], v2 offset:35840
v_mul_f32 v213, v213, v212
v_mfma_f32_16x16x32_bf16 v[124:127], v[64:67], a[236:239], v[124:127]
v_mul_f32 v215, v215, v214
v_cvt_pk_bf16_f32 v173, v213, v215
v_mfma_f32_16x16x32_bf16 v[124:127], v[68:71], a[252:255], v[124:127]
v_mul_f32 v220, v220, v182
s_waitcnt lgkmcnt(4)
v_mfma_f32_16x16x32_bf16 v[128:131], v[72:75], a[224:227], v[128:131]
v_rcp_f32 v218, v218
v_mfma_f32_16x16x32_bf16 v[128:131], v[76:79], a[240:243], v[128:131]
v_mul_f32 v219, v219, v218
v_cvt_pk_bf16_f32 v150, v217, v219
v_mfma_f32_16x16x32_bf16 v[132:135], v[72:75], a[228:231], v[132:135]
ds_read_b128 v[64:67], v2 offset:36864
v_mul_f32 v222, v222, v183
v_mfma_f32_16x16x32_bf16 v[132:135], v[76:79], a[244:247], v[132:135]
v_exp_f32 v220, v220
v_mfma_f32_16x16x32_bf16 v[136:139], v[72:75], a[232:235], v[136:139]
v_exp_f32 v222, v222
v_mfma_f32_16x16x32_bf16 v[136:139], v[76:79], a[248:251], v[136:139]
ds_read_b128 v[68:71], v2 offset:37888
v_mul_f32 v221, v182, v198
v_mfma_f32_16x16x32_bf16 v[140:143], v[72:75], a[236:239], v[140:143]
v_mul_f32 v223, v183, v199
v_fma_f32 v220, v220, v237, v237
v_mfma_f32_16x16x32_bf16 v[140:143], v[76:79], a[252:255], v[140:143]
v_fma_f32 v222, v222, v237, v237
s_waitcnt lgkmcnt(4)
v_mfma_f32_16x16x32_bf16 v[112:115], v[48:51], v[16:19], v[112:115]
v_rcp_f32 v220, v220
v_mfma_f32_16x16x32_bf16 v[112:115], v[52:55], v[32:35], v[112:115]
v_rcp_f32 v222, v222
v_mfma_f32_16x16x32_bf16 v[116:119], v[48:51], v[20:23], v[116:119]
ds_read_b128 v[72:75], v2 offset:38912
v_mul_f32 v221, v221, v220
v_mfma_f32_16x16x32_bf16 v[116:119], v[52:55], v[36:39], v[116:119]
v_mul_f32 v223, v223, v222
v_cvt_pk_bf16_f32 v151, v221, v223
v_mfma_f32_16x16x32_bf16 v[120:123], v[48:51], v[24:27], v[120:123]
buffer_store_dwordx4 v[148:151], v4, s[8:11], s24 offen offset:0 sc1
v_mfma_f32_16x16x32_bf16 v[120:123], v[52:55], v[40:43], v[120:123]
ds_read_b128 v[76:79], v2 offset:39936
v_mul_f32 v216, v184, v184
v_mfma_f32_16x16x32_bf16 v[124:127], v[48:51], v[28:31], v[124:127]
v_mul_f32 v218, v185, v185
v_fma_f32 v216, v216, v239, v238
v_mfma_f32_16x16x32_bf16 v[124:127], v[52:55], v[44:47], v[124:127]
v_fma_f32 v218, v218, v239, v238
s_waitcnt lgkmcnt(4)
v_mfma_f32_16x16x32_bf16 v[128:131], v[56:59], v[16:19], v[128:131]
v_mul_f32 v216, v216, v184
v_mul_f32 v218, v218, v185
v_mfma_f32_16x16x32_bf16 v[128:131], v[60:63], v[32:35], v[128:131]
v_exp_f32 v216, v216
v_mfma_f32_16x16x32_bf16 v[132:135], v[56:59], v[20:23], v[132:135]
ds_read_b128 v[48:51], v2 offset:40960
v_mul_f32 v217, v184, v200
v_mfma_f32_16x16x32_bf16 v[132:135], v[60:63], v[36:39], v[132:135]
v_exp_f32 v218, v218
v_mfma_f32_16x16x32_bf16 v[136:139], v[56:59], v[24:27], v[136:139]
v_mul_f32 v219, v185, v201
v_fma_f32 v216, v216, v240, v240
v_mfma_f32_16x16x32_bf16 v[136:139], v[60:63], v[40:43], v[136:139]
ds_read_b128 v[52:55], v2 offset:41984
v_fma_f32 v218, v218, v240, v240
v_mfma_f32_16x16x32_bf16 v[140:143], v[56:59], v[28:31], v[140:143]
v_rcp_f32 v216, v216
v_mfma_f32_16x16x32_bf16 v[140:143], v[60:63], v[44:47], v[140:143]
v_mul_f32 v217, v217, v216
s_waitcnt lgkmcnt(4)
v_mfma_f32_16x16x32_bf16 v[80:83], v[64:67], a[0:3], 0
v_rcp_f32 v218, v218
v_mfma_f32_16x16x32_bf16 v[80:83], v[68:71], a[16:19], v[80:83]
v_mul_f32 v219, v219, v218
v_cvt_pk_bf16_f32 v154, v217, v219
v_mfma_f32_16x16x32_bf16 v[84:87], v[64:67], a[4:7], 0
ds_read_b128 v[56:59], v2 offset:43008
v_mul_f32 v220, v186, v186
v_mfma_f32_16x16x32_bf16 v[84:87], v[68:71], a[20:23], v[84:87]
v_mul_f32 v208, v112, v112
v_mul_f32 v210, v113, v113
v_mfma_f32_16x16x32_bf16 v[88:91], v[64:67], a[8:11], 0
v_fma_f32 v208, v208, v233, v232
v_fma_f32 v210, v210, v233, v232
v_mfma_f32_16x16x32_bf16 v[88:91], v[68:71], a[24:27], v[88:91]
ds_read_b128 v[60:63], v2 offset:44032
v_mul_f32 v208, v208, v112
v_mfma_f32_16x16x32_bf16 v[92:95], v[64:67], a[12:15], 0
v_mul_f32 v210, v210, v113
v_mul_f32 v209, v112, v128
v_mfma_f32_16x16x32_bf16 v[92:95], v[68:71], a[28:31], v[92:95]
v_mul_f32 v211, v113, v129
s_waitcnt lgkmcnt(4)
v_mfma_f32_16x16x32_bf16 v[96:99], v[72:75], a[0:3], 0
v_exp_f32 v208, v208
v_mfma_f32_16x16x32_bf16 v[96:99], v[76:79], a[16:19], v[96:99]
v_exp_f32 v210, v210
v_mfma_f32_16x16x32_bf16 v[100:103], v[72:75], a[4:7], 0
ds_read_b128 v[64:67], v2 offset:45056
v_fma_f32 v208, v208, v234, v234
v_mfma_f32_16x16x32_bf16 v[100:103], v[76:79], a[20:23], v[100:103]
v_fma_f32 v210, v210, v234, v234
v_mul_f32 v212, v114, v114
v_mfma_f32_16x16x32_bf16 v[104:107], v[72:75], a[8:11], 0
v_rcp_f32 v208, v208
v_mfma_f32_16x16x32_bf16 v[104:107], v[76:79], a[24:27], v[104:107]
ds_read_b128 v[68:71], v2 offset:46080
v_mul_f32 v209, v209, v208
v_mfma_f32_16x16x32_bf16 v[108:111], v[72:75], a[12:15], 0
v_rcp_f32 v210, v210
v_mfma_f32_16x16x32_bf16 v[108:111], v[76:79], a[28:31], v[108:111]
v_mul_f32 v211, v211, v210
s_waitcnt lgkmcnt(4)
v_mfma_f32_16x16x32_bf16 v[80:83], v[48:51], a[32:35], v[80:83]
v_cvt_pk_bf16_f32 v162, v209, v211
v_mul_f32 v214, v115, v115
v_mfma_f32_16x16x32_bf16 v[80:83], v[52:55], a[48:51], v[80:83]
v_fma_f32 v212, v212, v233, v232
v_fma_f32 v214, v214, v233, v232
v_mfma_f32_16x16x32_bf16 v[84:87], v[48:51], a[36:39], v[84:87]
ds_read_b128 v[72:75], v2 offset:47104
v_mul_f32 v212, v212, v114
v_mfma_f32_16x16x32_bf16 v[84:87], v[52:55], a[52:55], v[84:87]
v_mul_f32 v214, v214, v115
v_mul_f32 v213, v114, v130
v_mfma_f32_16x16x32_bf16 v[88:91], v[48:51], a[40:43], v[88:91]
v_exp_f32 v212, v212
v_mfma_f32_16x16x32_bf16 v[88:91], v[52:55], a[56:59], v[88:91]
ds_read_b128 v[76:79], v2 offset:48128
v_mul_f32 v215, v115, v131
v_mfma_f32_16x16x32_bf16 v[92:95], v[48:51], a[44:47], v[92:95]
v_exp_f32 v214, v214
v_mfma_f32_16x16x32_bf16 v[92:95], v[52:55], a[60:63], v[92:95]
v_fma_f32 v212, v212, v234, v234
s_waitcnt lgkmcnt(4)
v_mfma_f32_16x16x32_bf16 v[96:99], v[56:59], a[32:35], v[96:99]
s_waitcnt vmcnt(22)
v_fma_f32 v214, v214, v234, v234
v_mfma_f32_16x16x32_bf16 v[96:99], v[60:63], a[48:51], v[96:99]
s_barrier
v_mfma_f32_16x16x32_bf16 v[100:103], v[56:59], a[36:39], v[100:103]
ds_read_b128 v[48:51], v2 offset:49152
s_add_u32 m0, s22, 0
v_mfma_f32_16x16x32_bf16 v[100:103], v[60:63], a[52:55], v[100:103]
v_add_u32 v3, 20480, v3
buffer_load_dwordx4 v3, s[8:11], 0 offen offset:0 sc1 lds
v_mfma_f32_16x16x32_bf16 v[104:107], v[56:59], a[40:43], v[104:107]
v_rcp_f32 v212, v212
v_mfma_f32_16x16x32_bf16 v[104:107], v[60:63], a[56:59], v[104:107]
ds_read_b128 v[52:55], v2 offset:50176
v_mul_f32 v213, v213, v212
v_mfma_f32_16x16x32_bf16 v[108:111], v[56:59], a[44:47], v[108:111]
v_rcp_f32 v214, v214
v_mfma_f32_16x16x32_bf16 v[108:111], v[60:63], a[60:63], v[108:111]
v_mul_f32 v215, v215, v214
s_waitcnt lgkmcnt(4)
v_mfma_f32_16x16x32_bf16 v[80:83], v[64:67], a[64:67], v[80:83]
buffer_load_dwordx4 v3, s[8:11], 0 offen offset:1024 sc1 lds
v_mfma_f32_16x16x32_bf16 v[80:83], v[68:71], a[80:83], v[80:83]
v_cvt_pk_bf16_f32 v163, v213, v215
v_mul_f32 v208, v116, v116
v_mfma_f32_16x16x32_bf16 v[84:87], v[64:67], a[68:71], v[84:87]
ds_read_b128 v[56:59], v2 offset:51200
v_mul_f32 v210, v117, v117
v_mfma_f32_16x16x32_bf16 v[84:87], v[68:71], a[84:87], v[84:87]
buffer_store_dwordx4 v[160:163], v2, s[8:11], s24 offen offset:1024 sc1
v_mfma_f32_16x16x32_bf16 v[88:91], v[64:67], a[72:75], v[88:91]
v_fma_f32 v208, v208, v236, v235
v_fma_f32 v210, v210, v236, v235
v_mfma_f32_16x16x32_bf16 v[88:91], v[68:71], a[88:91], v[88:91]
ds_read_b128 v[60:63], v2 offset:52224
v_mul_f32 v208, v208, v116
v_mfma_f32_16x16x32_bf16 v[92:95], v[64:67], a[76:79], v[92:95]
v_mul_f32 v210, v210, v117
v_mul_f32 v209, v116, v132
v_mfma_f32_16x16x32_bf16 v[92:95], v[68:71], a[92:95], v[92:95]
v_mul_f32 v211, v117, v133
s_waitcnt lgkmcnt(4)
v_mfma_f32_16x16x32_bf16 v[96:99], v[72:75], a[64:67], v[96:99]
buffer_load_dwordx4 v3, s[8:11], 0 offen offset:2048 sc1 lds
v_mfma_f32_16x16x32_bf16 v[96:99], v[76:79], a[80:83], v[96:99]
v_exp_f32 v208, v208
v_mfma_f32_16x16x32_bf16 v[100:103], v[72:75], a[68:71], v[100:103]
ds_read_b128 v[64:67], v2 offset:53248
v_fma_f32 v208, v208, v237, v237
v_mfma_f32_16x16x32_bf16 v[100:103], v[76:79], a[84:87], v[100:103]
v_exp_f32 v210, v210
v_mfma_f32_16x16x32_bf16 v[104:107], v[72:75], a[72:75], v[104:107]
buffer_load_dwordx4 v3, s[8:11], 0 offen offset:3072 sc1 lds
v_mfma_f32_16x16x32_bf16 v[104:107], v[76:79], a[88:91], v[104:107]
ds_read_b128 v[68:71], v2 offset:54272
s_add_u32 m0, s22, 4096
v_mfma_f32_16x16x32_bf16 v[108:111], v[72:75], a[76:79], v[108:111]
v_add_u32 v3, 4096, v3
v_fma_f32 v210, v210, v237, v237
v_mfma_f32_16x16x32_bf16 v[108:111], v[76:79], a[92:95], v[108:111]
v_mul_f32 v212, v118, v118
s_waitcnt lgkmcnt(4)
v_mfma_f32_16x16x32_bf16 v[80:83], v[48:51], a[96:99], v[80:83]
buffer_load_dwordx4 v3, s[8:11], 0 offen offset:0 sc1 lds
v_mfma_f32_16x16x32_bf16 v[80:83], v[52:55], a[112:115], v[80:83]
v_rcp_f32 v208, v208
v_mfma_f32_16x16x32_bf16 v[84:87], v[48:51], a[100:103], v[84:87]
ds_read_b128 v[72:75], v2 offset:55296
v_mul_f32 v209, v209, v208
v_mfma_f32_16x16x32_bf16 v[84:87], v[52:55], a[116:119], v[84:87]
v_rcp_f32 v210, v210
v_mfma_f32_16x16x32_bf16 v[88:91], v[48:51], a[104:107], v[88:91]
buffer_load_dwordx4 v3, s[8:11], 0 offen offset:1024 sc1 lds
v_mfma_f32_16x16x32_bf16 v[88:91], v[52:55], a[120:123], v[88:91]
ds_read_b128 v[76:79], v2 offset:56320
v_mul_f32 v211, v211, v210
v_mfma_f32_16x16x32_bf16 v[92:95], v[48:51], a[108:111], v[92:95]
v_cvt_pk_bf16_f32 v166, v209, v211
v_mul_f32 v214, v119, v119
v_mfma_f32_16x16x32_bf16 v[92:95], v[52:55], a[124:127], v[92:95]
v_fma_f32 v212, v212, v236, v235
s_waitcnt lgkmcnt(4)
v_mfma_f32_16x16x32_bf16 v[96:99], v[56:59], a[96:99], v[96:99]
v_fma_f32 v214, v214, v236, v235
v_mul_f32 v212, v212, v118
v_mfma_f32_16x16x32_bf16 v[96:99], v[60:63], a[112:115], v[96:99]
v_mul_f32 v214, v214, v119
v_mul_f32 v213, v118, v134
v_mfma_f32_16x16x32_bf16 v[100:103], v[56:59], a[100:103], v[100:103]
ds_read_b128 v[48:51], v2 offset:57344
v_mul_f32 v215, v119, v135
v_mfma_f32_16x16x32_bf16 v[100:103], v[60:63], a[116:119], v[100:103]
v_exp_f32 v212, v212
v_mfma_f32_16x16x32_bf16 v[104:107], v[56:59], a[104:107], v[104:107]
v_exp_f32 v214, v214
v_mfma_f32_16x16x32_bf16 v[104:107], v[60:63], a[120:123], v[104:107]
ds_read_b128 v[52:55], v2 offset:58368
v_fma_f32 v212, v212, v237, v237
v_mfma_f32_16x16x32_bf16 v[108:111], v[56:59], a[108:111], v[108:111]
v_fma_f32 v214, v214, v237, v237
v_mul_f32 v208, v120, v120
v_mfma_f32_16x16x32_bf16 v[108:111], v[60:63], a[124:127], v[108:111]
v_mul_f32 v210, v121, v121
s_waitcnt lgkmcnt(4)
v_mfma_f32_16x16x32_bf16 v[80:83], v[64:67], a[128:131], v[80:83]
v_rcp_f32 v212, v212
v_mfma_f32_16x16x32_bf16 v[80:83], v[68:71], a[144:147], v[80:83]
v_rcp_f32 v214, v214
v_mfma_f32_16x16x32_bf16 v[84:87], v[64:67], a[132:135], v[84:87]
ds_read_b128 v[56:59], v2 offset:59392
v_mul_f32 v213, v213, v212
v_mfma_f32_16x16x32_bf16 v[84:87], v[68:71], a[148:151], v[84:87]
v_mul_f32 v215, v215, v214
v_cvt_pk_bf16_f32 v167, v213, v215
v_mfma_f32_16x16x32_bf16 v[88:91], v[64:67], a[136:139], v[88:91]
buffer_store_dwordx4 v[164:167], v4, s[8:11], s24 offen offset:1024 sc1
v_mfma_f32_16x16x32_bf16 v[88:91], v[68:71], a[152:155], v[88:91]
ds_read_b128 v[60:63], v2 offset:60416
v_fma_f32 v208, v208, v239, v238
v_mfma_f32_16x16x32_bf16 v[92:95], v[64:67], a[140:143], v[92:95]
v_fma_f32 v210, v210, v239, v238
v_mul_f32 v208, v208, v120
v_mfma_f32_16x16x32_bf16 v[92:95], v[68:71], a[156:159], v[92:95]
v_mul_f32 v210, v210, v121
s_waitcnt lgkmcnt(4)
v_mfma_f32_16x16x32_bf16 v[96:99], v[72:75], a[128:131], v[96:99]
v_exp_f32 v208, v208
v_mfma_f32_16x16x32_bf16 v[96:99], v[76:79], a[144:147], v[96:99]
v_exp_f32 v210, v210
v_mfma_f32_16x16x32_bf16 v[100:103], v[72:75], a[132:135], v[100:103]
ds_read_b128 v[64:67], v2 offset:61440
v_mul_f32 v209, v120, v136
v_mfma_f32_16x16x32_bf16 v[100:103], v[76:79], a[148:151], v[100:103]
v_mul_f32 v211, v121, v137
v_fma_f32 v208, v208, v240, v240
v_mfma_f32_16x16x32_bf16 v[104:107], v[72:75], a[136:139], v[104:107]
v_fma_f32 v210, v210, v240, v240
v_mul_f32 v212, v122, v122
v_mfma_f32_16x16x32_bf16 v[104:107], v[76:79], a[152:155], v[104:107]
ds_read_b128 v[68:71], v2 offset:62464
v_mul_f32 v214, v123, v123
v_mfma_f32_16x16x32_bf16 v[108:111], v[72:75], a[140:143], v[108:111]
v_rcp_f32 v208, v208
v_mfma_f32_16x16x32_bf16 v[108:111], v[76:79], a[156:159], v[108:111]
v_mul_f32 v209, v209, v208
s_waitcnt lgkmcnt(4)
v_mfma_f32_16x16x32_bf16 v[80:83], v[48:51], a[160:163], v[80:83]
v_rcp_f32 v210, v210
v_mfma_f32_16x16x32_bf16 v[80:83], v[52:55], a[176:179], v[80:83]
v_mul_f32 v211, v211, v210
v_cvt_pk_bf16_f32 v170, v209, v211
v_mfma_f32_16x16x32_bf16 v[84:87], v[48:51], a[164:167], v[84:87]
ds_read_b128 v[72:75], v2 offset:63488
v_fma_f32 v212, v212, v239, v238
v_mfma_f32_16x16x32_bf16 v[84:87], v[52:55], a[180:183], v[84:87]
v_fma_f32 v214, v214, v239, v238
v_mul_f32 v212, v212, v122
v_mfma_f32_16x16x32_bf16 v[88:91], v[48:51], a[168:171], v[88:91]
v_mul_f32 v214, v214, v123
v_mul_f32 v213, v122, v138
v_mfma_f32_16x16x32_bf16 v[88:91], v[52:55], a[184:187], v[88:91]
ds_read_b128 v[76:79], v2 offset:64512
v_mul_f32 v215, v123, v139
v_mfma_f32_16x16x32_bf16 v[92:95], v[48:51], a[172:175], v[92:95]
v_exp_f32 v212, v212
v_mfma_f32_16x16x32_bf16 v[92:95], v[52:55], a[188:191], v[92:95]
v_fma_f32 v212, v212, v240, v240
s_waitcnt lgkmcnt(4)
v_mfma_f32_16x16x32_bf16 v[96:99], v[56:59], a[160:163], v[96:99]
v_exp_f32 v214, v214
v_mfma_f32_16x16x32_bf16 v[96:99], v[60:63], a[176:179], v[96:99]
v_fma_f32 v214, v214, v240, v240
v_mul_f32 v208, v124, v124
v_mfma_f32_16x16x32_bf16 v[100:103], v[56:59], a[164:167], v[100:103]
ds_read_b128 v[48:51], v7 offset:0
v_mul_f32 v210, v125, v125
v_mfma_f32_16x16x32_bf16 v[100:103], v[60:63], a[180:183], v[100:103]
v_rcp_f32 v212, v212
v_mfma_f32_16x16x32_bf16 v[104:107], v[56:59], a[168:171], v[104:107]
v_rcp_f32 v214, v214
v_mfma_f32_16x16x32_bf16 v[104:107], v[60:63], a[184:187], v[104:107]
ds_read_b128 v[52:55], v7 offset:1024
v_mul_f32 v213, v213, v212
v_mfma_f32_16x16x32_bf16 v[108:111], v[56:59], a[172:175], v[108:111]
v_mul_f32 v215, v215, v214
v_cvt_pk_bf16_f32 v171, v213, v215
v_mfma_f32_16x16x32_bf16 v[108:111], v[60:63], a[188:191], v[108:111]
v_fma_f32 v208, v208, v242, v241
s_waitcnt lgkmcnt(4)
v_mfma_f32_16x16x32_bf16 v[80:83], v[64:67], a[192:195], v[80:83]
buffer_store_dwordx4 v[168:171], v5, s[8:11], s24 offen offset:1024 sc1
v_mfma_f32_16x16x32_bf16 v[80:83], v[68:71], a[208:211], v[80:83]
v_fma_f32 v210, v210, v242, v241
v_mul_f32 v208, v208, v124
v_mfma_f32_16x16x32_bf16 v[84:87], v[64:67], a[196:199], v[84:87]
ds_read_b128 v[56:59], v7 offset:2048
v_mul_f32 v210, v210, v125
v_mfma_f32_16x16x32_bf16 v[84:87], v[68:71], a[212:215], v[84:87]
v_exp_f32 v208, v208
v_mfma_f32_16x16x32_bf16 v[88:91], v[64:67], a[200:203], v[88:91]
v_exp_f32 v210, v210
v_mfma_f32_16x16x32_bf16 v[88:91], v[68:71], a[216:219], v[88:91]
ds_read_b128 v[60:63], v7 offset:3072
v_mul_f32 v209, v124, v140
v_mfma_f32_16x16x32_bf16 v[92:95], v[64:67], a[204:207], v[92:95]
v_mul_f32 v211, v125, v141
v_fma_f32 v208, v208, v243, v243
v_mfma_f32_16x16x32_bf16 v[92:95], v[68:71], a[220:223], v[92:95]
v_fma_f32 v210, v210, v243, v243
s_waitcnt lgkmcnt(4)
v_mfma_f32_16x16x32_bf16 v[96:99], v[72:75], a[192:195], v[96:99]
v_rcp_f32 v208, v208
v_mfma_f32_16x16x32_bf16 v[96:99], v[76:79], a[208:211], v[96:99]
v_rcp_f32 v210, v210
v_mfma_f32_16x16x32_bf16 v[100:103], v[72:75], a[196:199], v[100:103]
ds_read_b128 v[64:67], v7 offset:4096
v_mul_f32 v209, v209, v208
v_mfma_f32_16x16x32_bf16 v[100:103], v[76:79], a[212:215], v[100:103]
v_mul_f32 v211, v211, v210
v_cvt_pk_bf16_f32 v174, v209, v211
v_mfma_f32_16x16x32_bf16 v[104:107], v[72:75], a[200:203], v[104:107]
v_mul_f32 v212, v126, v126
v_mul_f32 v214, v127, v127
v_mfma_f32_16x16x32_bf16 v[104:107], v[76:79], a[216:219], v[104:107]
ds_read_b128 v[68:71], v7 offset:5120
v_fma_f32 v212, v212, v242, v241
v_mfma_f32_16x16x32_bf16 v[108:111], v[72:75], a[204:207], v[108:111]
v_fma_f32 v214, v214, v242, v241
v_mul_f32 v212, v212, v126
v_mfma_f32_16x16x32_bf16 v[108:111], v[76:79], a[220:223], v[108:111]
v_mul_f32 v214, v214, v127
s_waitcnt lgkmcnt(4)
v_mfma_f32_16x16x32_bf16 v[80:83], v[48:51], a[224:227], v[80:83]
v_exp_f32 v212, v212
v_mfma_f32_16x16x32_bf16 v[80:83], v[52:55], a[240:243], v[80:83]
v_exp_f32 v214, v214
v_mfma_f32_16x16x32_bf16 v[84:87], v[48:51], a[228:231], v[84:87]
ds_read_b128 v[72:75], v7 offset:6144
v_mul_f32 v213, v126, v142
v_mfma_f32_16x16x32_bf16 v[84:87], v[52:55], a[244:247], v[84:87]
v_mul_f32 v215, v127, v143
v_fma_f32 v212, v212, v243, v243
v_mfma_f32_16x16x32_bf16 v[88:91], v[48:51], a[232:235], v[88:91]
v_fma_f32 v214, v214, v243, v243
v_mul_f32 v222, v187, v187
v_mfma_f32_16x16x32_bf16 v[88:91], v[52:55], a[248:251], v[88:91]
ds_read_b128 v[76:79], v7 offset:7168
v_fma_f32 v220, v220, v239, v238
v_mfma_f32_16x16x32_bf16 v[92:95], v[48:51], a[236:239], v[92:95]
v_rcp_f32 v212, v212
v_mfma_f32_16x16x32_bf16 v[92:95], v[52:55], a[252:255], v[92:95]
v_mul_f32 v213, v213, v212
s_waitcnt lgkmcnt(4)
v_mfma_f32_16x16x32_bf16 v[96:99], v[56:59], a[224:227], v[96:99]
s_waitcnt vmcnt(23)
v_fma_f32 v222, v222, v239, v238
v_mfma_f32_16x16x32_bf16 v[96:99], v[60:63], a[240:243], v[96:99]
s_barrier
v_mfma_f32_16x16x32_bf16 v[100:103], v[56:59], a[228:231], v[100:103]
ds_read_b128 v[48:51], v7 offset:8192
s_add_u32 m0, s22, 24576
v_mfma_f32_16x16x32_bf16 v[100:103], v[60:63], a[244:247], v[100:103]
v_add_u32 v3, 20480, v3
buffer_load_dwordx4 v3, s[8:11], 0 offen offset:0 sc1 lds
v_mfma_f32_16x16x32_bf16 v[104:107], v[56:59], a[232:235], v[104:107]
v_rcp_f32 v214, v214
v_mfma_f32_16x16x32_bf16 v[104:107], v[60:63], a[248:251], v[104:107]
ds_read_b128 v[52:55], v7 offset:9216
v_mul_f32 v215, v215, v214
v_mfma_f32_16x16x32_bf16 v[108:111], v[56:59], a[236:239], v[108:111]
v_cvt_pk_bf16_f32 v175, v213, v215
v_mul_f32 v220, v220, v186
v_mfma_f32_16x16x32_bf16 v[108:111], v[60:63], a[252:255], v[108:111]
v_mul_f32 v222, v222, v187
s_waitcnt lgkmcnt(4)
v_mfma_f32_16x16x32_bf16 v[80:83], v[64:67], v[16:19], v[80:83]
buffer_load_dwordx4 v3, s[8:11], 0 offen offset:1024 sc1 lds
v_mfma_f32_16x16x32_bf16 v[80:83], v[68:71], v[32:35], v[80:83]
v_exp_f32 v220, v220
v_mfma_f32_16x16x32_bf16 v[84:87], v[64:67], v[20:23], v[84:87]
ds_read_b128 v[56:59], v7 offset:10240
v_mul_f32 v221, v186, v202
v_mfma_f32_16x16x32_bf16 v[84:87], v[68:71], v[36:39], v[84:87]
buffer_store_dwordx4 v[172:175], v6, s[8:11], s24 offen offset:1024 sc1
v_mfma_f32_16x16x32_bf16 v[88:91], v[64:67], v[24:27], v[88:91]
v_exp_f32 v222, v222
v_mfma_f32_16x16x32_bf16 v[88:91], v[68:71], v[40:43], v[88:91]
ds_read_b128 v[60:63], v7 offset:11264
v_mul_f32 v223, v187, v203
v_mfma_f32_16x16x32_bf16 v[92:95], v[64:67], v[28:31], v[92:95]
v_fma_f32 v220, v220, v240, v240
v_fma_f32 v222, v222, v240, v240
v_mfma_f32_16x16x32_bf16 v[92:95], v[68:71], v[44:47], v[92:95]
v_mul_f32 v216, v188, v188
s_waitcnt lgkmcnt(4)
v_mfma_f32_16x16x32_bf16 v[96:99], v[72:75], v[16:19], v[96:99]
buffer_load_dwordx4 v3, s[8:11], 0 offen offset:2048 sc1 lds
v_mfma_f32_16x16x32_bf16 v[96:99], v[76:79], v[32:35], v[96:99]
v_rcp_f32 v220, v220
v_mfma_f32_16x16x32_bf16 v[100:103], v[72:75], v[20:23], v[100:103]
ds_read_b128 v[64:67], v7 offset:12288
v_mul_f32 v221, v221, v220
v_mfma_f32_16x16x32_bf16 v[100:103], v[76:79], v[36:39], v[100:103]
v_rcp_f32 v222, v222
v_mfma_f32_16x16x32_bf16 v[104:107], v[72:75], v[24:27], v[104:107]
buffer_load_dwordx4 v3, s[8:11], 0 offen offset:3072 sc1 lds
v_mfma_f32_16x16x32_bf16 v[104:107], v[76:79], v[40:43], v[104:107]
ds_read_b128 v[68:71], v7 offset:13312
s_add_u32 m0, s22, 28672
v_mfma_f32_16x16x32_bf16 v[108:111], v[72:75], v[28:31], v[108:111]
v_add_u32 v3, 4096, v3
v_mul_f32 v223, v223, v222
v_mfma_f32_16x16x32_bf16 v[108:111], v[76:79], v[44:47], v[108:111]
v_cvt_pk_bf16_f32 v155, v221, v223
s_waitcnt lgkmcnt(4)
v_mfma_f32_16x16x32_bf16 v[112:115], v[48:51], a[0:3], 0
buffer_load_dwordx4 v3, s[8:11], 0 offen offset:0 sc1 lds
v_mfma_f32_16x16x32_bf16 v[112:115], v[52:55], a[16:19], v[112:115]
v_mul_f32 v218, v189, v189
v_fma_f32 v216, v216, v242, v241
v_mfma_f32_16x16x32_bf16 v[116:119], v[48:51], a[4:7], 0
ds_read_b128 v[72:75], v7 offset:14336
v_fma_f32 v218, v218, v242, v241
v_mfma_f32_16x16x32_bf16 v[116:119], v[52:55], a[20:23], v[116:119]
buffer_store_dwordx4 v[152:155], v5, s[8:11], s24 offen offset:0 sc1
v_mfma_f32_16x16x32_bf16 v[120:123], v[48:51], a[8:11], 0
v_mul_f32 v216, v216, v188
v_mul_f32 v218, v218, v189
v_mfma_f32_16x16x32_bf16 v[120:123], v[52:55], a[24:27], v[120:123]
ds_read_b128 v[76:79], v7 offset:15360
v_mul_f32 v217, v188, v204
v_mfma_f32_16x16x32_bf16 v[124:127], v[48:51], a[12:15], 0
v_exp_f32 v216, v216
v_mfma_f32_16x16x32_bf16 v[124:127], v[52:55], a[28:31], v[124:127]
v_mul_f32 v219, v189, v205
s_waitcnt lgkmcnt(4)
v_mfma_f32_16x16x32_bf16 v[128:131], v[56:59], a[0:3], 0
buffer_load_dwordx4 v3, s[8:11], 0 offen offset:1024 sc1 lds
v_mfma_f32_16x16x32_bf16 v[128:131], v[60:63], a[16:19], v[128:131]
v_exp_f32 v218, v218
v_mfma_f32_16x16x32_bf16 v[132:135], v[56:59], a[4:7], 0
ds_read_b128 v[48:51], v7 offset:16384
v_fma_f32 v216, v216, v243, v243
v_mfma_f32_16x16x32_bf16 v[132:135], v[60:63], a[20:23], v[132:135]
v_fma_f32 v218, v218, v243, v243
v_mul_f32 v220, v190, v190
v_mfma_f32_16x16x32_bf16 v[136:139], v[56:59], a[8:11], 0
v_rcp_f32 v216, v216
v_mfma_f32_16x16x32_bf16 v[136:139], v[60:63], a[24:27], v[136:139]
ds_read_b128 v[52:55], v7 offset:17408
v_mul_f32 v217, v217, v216
v_mfma_f32_16x16x32_bf16 v[140:143], v[56:59], a[12:15], 0
v_rcp_f32 v218, v218
v_mfma_f32_16x16x32_bf16 v[140:143], v[60:63], a[28:31], v[140:143]
v_mul_f32 v219, v219, v218
s_waitcnt lgkmcnt(4)
v_mfma_f32_16x16x32_bf16 v[112:115], v[64:67], a[32:35], v[112:115]
v_cvt_pk_bf16_f32 v158, v217, v219
v_mul_f32 v222, v191, v191
v_mfma_f32_16x16x32_bf16 v[112:115], v[68:71], a[48:51], v[112:115]
v_fma_f32 v220, v220, v242, v241
v_fma_f32 v222, v222, v242, v241
v_mfma_f32_16x16x32_bf16 v[116:119], v[64:67], a[36:39], v[116:119]
ds_read_b128 v[56:59], v7 offset:18432
v_mul_f32 v220, v220, v190
v_mfma_f32_16x16x32_bf16 v[116:119], v[68:71], a[52:55], v[116:119]
v_mul_f32 v222, v222, v191
v_mul_f32 v221, v190, v206
v_mfma_f32_16x16x32_bf16 v[120:123], v[64:67], a[40:43], v[120:123]
v_exp_f32 v220, v220
v_mfma_f32_16x16x32_bf16 v[120:123], v[68:71], a[56:59], v[120:123]
ds_read_b128 v[60:63], v7 offset:19456
v_mul_f32 v223, v191, v207
v_mfma_f32_16x16x32_bf16 v[124:127], v[64:67], a[44:47], v[124:127]
v_exp_f32 v222, v222
v_mfma_f32_16x16x32_bf16 v[124:127], v[68:71], a[60:63], v[124:127]
v_fma_f32 v220, v220, v243, v243
s_waitcnt lgkmcnt(4)
v_mfma_f32_16x16x32_bf16 v[128:131], v[72:75], a[32:35], v[128:131]
v_fma_f32 v222, v222, v243, v243
v_mfma_f32_16x16x32_bf16 v[128:131], v[76:79], a[48:51], v[128:131]
v_rcp_f32 v220, v220
v_mfma_f32_16x16x32_bf16 v[132:135], v[72:75], a[36:39], v[132:135]
ds_read_b128 v[64:67], v7 offset:20480
v_mul_f32 v221, v221, v220
v_mfma_f32_16x16x32_bf16 v[132:135], v[76:79], a[52:55], v[132:135]
v_rcp_f32 v222, v222
v_mfma_f32_16x16x32_bf16 v[136:139], v[72:75], a[40:43], v[136:139]
v_mul_f32 v223, v223, v222
v_cvt_pk_bf16_f32 v159, v221, v223
v_mfma_f32_16x16x32_bf16 v[136:139], v[76:79], a[56:59], v[136:139]
ds_read_b128 v[68:71], v7 offset:21504
v_mfma_f32_16x16x32_bf16 v[140:143], v[72:75], a[44:47], v[140:143]
buffer_store_dwordx4 v[156:159], v6, s[8:11], s24 offen offset:0 sc1
v_mfma_f32_16x16x32_bf16 v[140:143], v[76:79], a[60:63], v[140:143]
v_mul_f32 v208, v80, v80
s_waitcnt lgkmcnt(4)
v_mfma_f32_16x16x32_bf16 v[112:115], v[48:51], a[64:67], v[112:115]
v_mul_f32 v210, v81, v81
v_fma_f32 v208, v208, v233, v232
v_mfma_f32_16x16x32_bf16 v[112:115], v[52:55], a[80:83], v[112:115]
v_fma_f32 v210, v210, v233, v232
v_mul_f32 v208, v208, v80
v_mfma_f32_16x16x32_bf16 v[116:119], v[48:51], a[68:71], v[116:119]
ds_read_b128 v[72:75], v7 offset:22528
v_mul_f32 v210, v210, v81
v_mfma_f32_16x16x32_bf16 v[116:119], v[52:55], a[84:87], v[116:119]
v_exp_f32 v208, v208
v_mfma_f32_16x16x32_bf16 v[120:123], v[48:51], a[72:75], v[120:123]
v_exp_f32 v210, v210
v_mfma_f32_16x16x32_bf16 v[120:123], v[52:55], a[88:91], v[120:123]
ds_read_b128 v[76:79], v7 offset:23552
v_mul_f32 v209, v80, v96
v_mfma_f32_16x16x32_bf16 v[124:127], v[48:51], a[76:79], v[124:127]
v_mul_f32 v211, v81, v97
v_fma_f32 v208, v208, v234, v234
v_mfma_f32_16x16x32_bf16 v[124:127], v[52:55], a[92:95], v[124:127]
v_fma_f32 v210, v210, v234, v234
s_waitcnt lgkmcnt(4)
v_mfma_f32_16x16x32_bf16 v[128:131], v[56:59], a[64:67], v[128:131]
v_rcp_f32 v208, v208
v_mfma_f32_16x16x32_bf16 v[128:131], v[60:63], a[80:83], v[128:131]
v_rcp_f32 v210, v210
v_mfma_f32_16x16x32_bf16 v[132:135], v[56:59], a[68:71], v[132:135]
ds_read_b128 v[48:51], v7 offset:24576
v_mul_f32 v209, v209, v208
v_mfma_f32_16x16x32_bf16 v[132:135], v[60:63], a[84:87], v[132:135]
v_mul_f32 v211, v211, v210
v_cvt_pk_bf16_f32 v176, v209, v211
v_mfma_f32_16x16x32_bf16 v[136:139], v[56:59], a[72:75], v[136:139]
v_mul_f32 v212, v82, v82
v_mul_f32 v214, v83, v83
v_mfma_f32_16x16x32_bf16 v[136:139], v[60:63], a[88:91], v[136:139]
ds_read_b128 v[52:55], v7 offset:25600
v_fma_f32 v212, v212, v233, v232
v_mfma_f32_16x16x32_bf16 v[140:143], v[56:59], a[76:79], v[140:143]
v_fma_f32 v214, v214, v233, v232
v_mul_f32 v212, v212, v82
v_mfma_f32_16x16x32_bf16 v[140:143], v[60:63], a[92:95], v[140:143]
v_mul_f32 v214, v214, v83
s_waitcnt lgkmcnt(4)
v_mfma_f32_16x16x32_bf16 v[112:115], v[64:67], a[96:99], v[112:115]
v_exp_f32 v212, v212
v_mfma_f32_16x16x32_bf16 v[112:115], v[68:71], a[112:115], v[112:115]
v_exp_f32 v214, v214
v_mfma_f32_16x16x32_bf16 v[116:119], v[64:67], a[100:103], v[116:119]
ds_read_b128 v[56:59], v7 offset:26624
v_mul_f32 v213, v82, v98
v_mfma_f32_16x16x32_bf16 v[116:119], v[68:71], a[116:119], v[116:119]
v_mul_f32 v215, v83, v99
v_fma_f32 v212, v212, v234, v234
v_mfma_f32_16x16x32_bf16 v[120:123], v[64:67], a[104:107], v[120:123]
v_fma_f32 v214, v214, v234, v234
v_mul_f32 v208, v84, v84
v_mfma_f32_16x16x32_bf16 v[120:123], v[68:71], a[120:123], v[120:123]
ds_read_b128 v[60:63], v7 offset:27648
v_mul_f32 v210, v85, v85
v_mfma_f32_16x16x32_bf16 v[124:127], v[64:67], a[108:111], v[124:127]
v_rcp_f32 v212, v212
v_mfma_f32_16x16x32_bf16 v[124:127], v[68:71], a[124:127], v[124:127]
v_mul_f32 v213, v213, v212
s_waitcnt lgkmcnt(4)
v_mfma_f32_16x16x32_bf16 v[128:131], v[72:75], a[96:99], v[128:131]
v_rcp_f32 v214, v214
v_mfma_f32_16x16x32_bf16 v[128:131], v[76:79], a[112:115], v[128:131]
v_mul_f32 v215, v215, v214
v_cvt_pk_bf16_f32 v177, v213, v215
v_mfma_f32_16x16x32_bf16 v[132:135], v[72:75], a[100:103], v[132:135]
ds_read_b128 v[64:67], v7 offset:28672
v_fma_f32 v208, v208, v236, v235
v_mfma_f32_16x16x32_bf16 v[132:135], v[76:79], a[116:119], v[132:135]
v_fma_f32 v210, v210, v236, v235
v_mul_f32 v208, v208, v84
v_mfma_f32_16x16x32_bf16 v[136:139], v[72:75], a[104:107], v[136:139]
v_mul_f32 v210, v210, v85
v_mul_f32 v209, v84, v100
v_mfma_f32_16x16x32_bf16 v[136:139], v[76:79], a[120:123], v[136:139]
ds_read_b128 v[68:71], v7 offset:29696
v_mul_f32 v211, v85, v101
v_mfma_f32_16x16x32_bf16 v[140:143], v[72:75], a[108:111], v[140:143]
v_exp_f32 v208, v208
v_mfma_f32_16x16x32_bf16 v[140:143], v[76:79], a[124:127], v[140:143]
v_fma_f32 v208, v208, v237, v237
s_waitcnt lgkmcnt(4)
v_mfma_f32_16x16x32_bf16 v[112:115], v[48:51], a[128:131], v[112:115]
v_exp_f32 v210, v210
v_mfma_f32_16x16x32_bf16 v[112:115], v[52:55], a[144:147], v[112:115]
v_fma_f32 v210, v210, v237, v237
v_mul_f32 v212, v86, v86
v_mfma_f32_16x16x32_bf16 v[116:119], v[48:51], a[132:135], v[116:119]
ds_read_b128 v[72:75], v7 offset:30720
v_mul_f32 v214, v87, v87
v_mfma_f32_16x16x32_bf16 v[116:119], v[52:55], a[148:151], v[116:119]
v_rcp_f32 v208, v208
v_mfma_f32_16x16x32_bf16 v[120:123], v[48:51], a[136:139], v[120:123]
v_rcp_f32 v210, v210
v_mfma_f32_16x16x32_bf16 v[120:123], v[52:55], a[152:155], v[120:123]
ds_read_b128 v[76:79], v7 offset:31744
v_mul_f32 v209, v209, v208
v_mfma_f32_16x16x32_bf16 v[124:127], v[48:51], a[140:143], v[124:127]
v_mul_f32 v211, v211, v210
v_cvt_pk_bf16_f32 v180, v209, v211
v_mfma_f32_16x16x32_bf16 v[124:127], v[52:55], a[156:159], v[124:127]
v_fma_f32 v212, v212, v236, v235
s_waitcnt lgkmcnt(4)
v_mfma_f32_16x16x32_bf16 v[128:131], v[56:59], a[128:131], v[128:131]
s_waitcnt vmcnt(25)
v_fma_f32 v214, v214, v236, v235
v_mfma_f32_16x16x32_bf16 v[128:131], v[60:63], a[144:147], v[128:131]
s_barrier
v_mfma_f32_16x16x32_bf16 v[132:135], v[56:59], a[132:135], v[132:135]
ds_read_b128 v[48:51], v7 offset:32768
s_add_u32 m0, s22, 49152
v_mfma_f32_16x16x32_bf16 v[132:135], v[60:63], a[148:151], v[132:135]
v_add_u32 v3, 20480, v3
buffer_load_dwordx4 v3, s[8:11], 0 offen offset:0 sc1 lds
v_mfma_f32_16x16x32_bf16 v[136:139], v[56:59], a[136:139], v[136:139]
v_mul_f32 v212, v212, v86
v_mul_f32 v214, v214, v87
v_mfma_f32_16x16x32_bf16 v[136:139], v[60:63], a[152:155], v[136:139]
ds_read_b128 v[52:55], v7 offset:33792
v_mul_f32 v213, v86, v102
v_mfma_f32_16x16x32_bf16 v[140:143], v[56:59], a[140:143], v[140:143]
v_exp_f32 v212, v212
v_mfma_f32_16x16x32_bf16 v[140:143], v[60:63], a[156:159], v[140:143]
v_mul_f32 v215, v87, v103
s_waitcnt lgkmcnt(4)
v_mfma_f32_16x16x32_bf16 v[112:115], v[64:67], a[160:163], v[112:115]
buffer_load_dwordx4 v3, s[8:11], 0 offen offset:1024 sc1 lds
v_mfma_f32_16x16x32_bf16 v[112:115], v[68:71], a[176:179], v[112:115]
v_exp_f32 v214, v214
v_mfma_f32_16x16x32_bf16 v[116:119], v[64:67], a[164:167], v[116:119]
ds_read_b128 v[56:59], v7 offset:34816
v_fma_f32 v212, v212, v237, v237
v_mfma_f32_16x16x32_bf16 v[116:119], v[68:71], a[180:183], v[116:119]
v_fma_f32 v214, v214, v237, v237
v_mul_f32 v208, v88, v88
v_mfma_f32_16x16x32_bf16 v[120:123], v[64:67], a[168:171], v[120:123]
buffer_load_dwordx4 v3, s[8:11], 0 offen offset:2048 sc1 lds
v_mfma_f32_16x16x32_bf16 v[120:123], v[68:71], a[184:187], v[120:123]
ds_read_b128 v[60:63], v7 offset:35840
v_mul_f32 v210, v89, v89
v_mfma_f32_16x16x32_bf16 v[124:127], v[64:67], a[172:175], v[124:127]
v_rcp_f32 v212, v212
v_mfma_f32_16x16x32_bf16 v[124:127], v[68:71], a[188:191], v[124:127]
v_mul_f32 v213, v213, v212
s_waitcnt lgkmcnt(4)
v_mfma_f32_16x16x32_bf16 v[128:131], v[72:75], a[160:163], v[128:131]
buffer_load_dwordx4 v3, s[8:11], 0 offen offset:3072 sc1 lds
v_mfma_f32_16x16x32_bf16 v[128:131], v[76:79], a[176:179], v[128:131]
s_add_u32 m0, s22, 53248
v_add_u32 v3, 4096, v3
v_mfma_f32_16x16x32_bf16 v[132:135], v[72:75], a[164:167], v[132:135]
ds_read_b128 v[64:67], v7 offset:36864
v_fma_f32 v208, v208, v239, v238
v_mfma_f32_16x16x32_bf16 v[132:135], v[76:79], a[180:183], v[132:135]
v_rcp_f32 v214, v214
v_mfma_f32_16x16x32_bf16 v[136:139], v[72:75], a[168:171], v[136:139]
buffer_load_dwordx4 v3, s[8:11], 0 offen offset:0 sc1 lds
v_mfma_f32_16x16x32_bf16 v[136:139], v[76:79], a[184:187], v[136:139]
ds_read_b128 v[68:71], v7 offset:37888
v_mul_f32 v215, v215, v214
v_mfma_f32_16x16x32_bf16 v[140:143], v[72:75], a[172:175], v[140:143]
v_cvt_pk_bf16_f32 v181, v213, v215
v_fma_f32 v210, v210, v239, v238
v_mfma_f32_16x16x32_bf16 v[140:143], v[76:79], a[188:191], v[140:143]
v_mul_f32 v208, v208, v88
s_waitcnt lgkmcnt(4)
v_mfma_f32_16x16x32_bf16 v[112:115], v[48:51], a[192:195], v[112:115]
buffer_load_dwordx4 v3, s[8:11], 0 offen offset:1024 sc1 lds
v_mfma_f32_16x16x32_bf16 v[112:115], v[52:55], a[208:211], v[112:115]
v_mul_f32 v210, v210, v89
v_mul_f32 v209, v88, v104
v_mfma_f32_16x16x32_bf16 v[116:119], v[48:51], a[196:199], v[116:119]
ds_read_b128 v[72:75], v7 offset:38912
v_mul_f32 v211, v89, v105
v_mfma_f32_16x16x32_bf16 v[116:119], v[52:55], a[212:215], v[116:119]
v_exp_f32 v208, v208
v_mfma_f32_16x16x32_bf16 v[120:123], v[48:51], a[200:203], v[120:123]
v_exp_f32 v210, v210
v_mfma_f32_16x16x32_bf16 v[120:123], v[52:55], a[216:219], v[120:123]
ds_read_b128 v[76:79], v7 offset:39936
v_fma_f32 v208, v208, v240, v240
v_mfma_f32_16x16x32_bf16 v[124:127], v[48:51], a[204:207], v[124:127]
v_fma_f32 v210, v210, v240, v240
v_mul_f32 v212, v90, v90
v_mfma_f32_16x16x32_bf16 v[124:127], v[52:55], a[220:223], v[124:127]
v_mul_f32 v214, v91, v91
s_waitcnt lgkmcnt(4)
v_mfma_f32_16x16x32_bf16 v[128:131], v[56:59], a[192:195], v[128:131]
v_mov_b32 v12, s68
v_mov_b32 v13, s69
v_mfma_f32_16x16x32_bf16 v[128:131], v[60:63], a[208:211], v[128:131]
s_add_u32 s53, s34, 0
s_waitcnt vmcnt(6)
buffer_store_dwordx2 v[12:13], v10, s[8:11], s53 offen sc1
v_mfma_f32_16x16x32_bf16 v[132:135], v[56:59], a[196:199], v[132:135]
ds_read_b128 v[48:51], v7 offset:40960
v_fma_f32 v212, v212, v239, v238
v_mfma_f32_16x16x32_bf16 v[132:135], v[60:63], a[212:215], v[132:135]
v_rcp_f32 v208, v208
v_mfma_f32_16x16x32_bf16 v[136:139], v[56:59], a[200:203], v[136:139]
v_rcp_f32 v210, v210
v_mfma_f32_16x16x32_bf16 v[136:139], v[60:63], a[216:219], v[136:139]
ds_read_b128 v[52:55], v7 offset:41984
v_mul_f32 v209, v209, v208
v_mfma_f32_16x16x32_bf16 v[140:143], v[56:59], a[204:207], v[140:143]
v_mul_f32 v211, v211, v210
v_cvt_pk_bf16_f32 v184, v209, v211
v_mfma_f32_16x16x32_bf16 v[140:143], v[60:63], a[220:223], v[140:143]
v_fma_f32 v214, v214, v239, v238
s_waitcnt lgkmcnt(4)
v_mfma_f32_16x16x32_bf16 v[112:115], v[64:67], a[224:227], v[112:115]
v_mul_f32 v212, v212, v90
v_mul_f32 v214, v214, v91
v_mfma_f32_16x16x32_bf16 v[112:115], v[68:71], a[240:243], v[112:115]
v_exp_f32 v212, v212
v_mfma_f32_16x16x32_bf16 v[116:119], v[64:67], a[228:231], v[116:119]
ds_read_b128 v[56:59], v7 offset:43008
v_exp_f32 v214, v214
v_mfma_f32_16x16x32_bf16 v[116:119], v[68:71], a[244:247], v[116:119]
v_mul_f32 v213, v90, v106
v_mul_f32 v215, v91, v107
v_mfma_f32_16x16x32_bf16 v[120:123], v[64:67], a[232:235], v[120:123]
v_fma_f32 v212, v212, v240, v240
v_fma_f32 v214, v214, v240, v240
v_mfma_f32_16x16x32_bf16 v[120:123], v[68:71], a[248:251], v[120:123]
ds_read_b128 v[60:63], v7 offset:44032
v_rcp_f32 v212, v212
v_mfma_f32_16x16x32_bf16 v[124:127], v[64:67], a[236:239], v[124:127]
v_rcp_f32 v214, v214
v_mfma_f32_16x16x32_bf16 v[124:127], v[68:71], a[252:255], v[124:127]
v_mul_f32 v213, v213, v212
s_waitcnt lgkmcnt(4)
v_mfma_f32_16x16x32_bf16 v[128:131], v[72:75], a[224:227], v[128:131]
v_mul_f32 v215, v215, v214
v_cvt_pk_bf16_f32 v185, v213, v215
v_mfma_f32_16x16x32_bf16 v[128:131], v[76:79], a[240:243], v[128:131]
v_mul_f32 v208, v92, v92
v_mul_f32 v210, v93, v93
v_mfma_f32_16x16x32_bf16 v[132:135], v[72:75], a[228:231], v[132:135]
ds_read_b128 v[64:67], v7 offset:45056
v_fma_f32 v208, v208, v242, v241
v_mfma_f32_16x16x32_bf16 v[132:135], v[76:79], a[244:247], v[132:135]
v_fma_f32 v210, v210, v242, v241
v_mul_f32 v208, v208, v92
v_mfma_f32_16x16x32_bf16 v[136:139], v[72:75], a[232:235], v[136:139]
v_mul_f32 v210, v210, v93
v_exp_f32 v208, v208
v_mfma_f32_16x16x32_bf16 v[136:139], v[76:79], a[248:251], v[136:139]
ds_read_b128 v[68:71], v7 offset:46080
v_exp_f32 v210, v210
v_mfma_f32_16x16x32_bf16 v[140:143], v[72:75], a[236:239], v[140:143]
v_mul_f32 v209, v92, v108
v_mul_f32 v211, v93, v109
v_mfma_f32_16x16x32_bf16 v[140:143], v[76:79], a[252:255], v[140:143]
v_fma_f32 v208, v208, v243, v243
s_waitcnt lgkmcnt(4)
v_mfma_f32_16x16x32_bf16 v[112:115], v[48:51], v[16:19], v[112:115]
v_fma_f32 v210, v210, v243, v243
v_rcp_f32 v208, v208
v_mfma_f32_16x16x32_bf16 v[112:115], v[52:55], v[32:35], v[112:115]
v_rcp_f32 v210, v210
v_mfma_f32_16x16x32_bf16 v[116:119], v[48:51], v[20:23], v[116:119]
ds_read_b128 v[72:75], v7 offset:47104
v_mul_f32 v209, v209, v208
v_mfma_f32_16x16x32_bf16 v[116:119], v[52:55], v[36:39], v[116:119]
v_mul_f32 v211, v211, v210
v_cvt_pk_bf16_f32 v188, v209, v211
v_mfma_f32_16x16x32_bf16 v[120:123], v[48:51], v[24:27], v[120:123]
v_mul_f32 v212, v94, v94
v_mul_f32 v214, v95, v95
v_mfma_f32_16x16x32_bf16 v[120:123], v[52:55], v[40:43], v[120:123]
ds_read_b128 v[76:79], v7 offset:48128
v_fma_f32 v212, v212, v242, v241
v_mfma_f32_16x16x32_bf16 v[124:127], v[48:51], v[28:31], v[124:127]
v_fma_f32 v214, v214, v242, v241
v_mul_f32 v212, v212, v94
v_mfma_f32_16x16x32_bf16 v[124:127], v[52:55], v[44:47], v[124:127]
v_mul_f32 v214, v214, v95
s_waitcnt lgkmcnt(4)
v_mfma_f32_16x16x32_bf16 v[128:131], v[56:59], v[16:19], v[128:131]
v_exp_f32 v212, v212
v_mfma_f32_16x16x32_bf16 v[128:131], v[60:63], v[32:35], v[128:131]
v_exp_f32 v214, v214
v_mfma_f32_16x16x32_bf16 v[132:135], v[56:59], v[20:23], v[132:135]
ds_read_b128 v[48:51], v7 offset:49152
v_mul_f32 v213, v94, v110
v_mfma_f32_16x16x32_bf16 v[132:135], v[60:63], v[36:39], v[132:135]
v_mul_f32 v215, v95, v111
v_fma_f32 v212, v212, v243, v243
v_mfma_f32_16x16x32_bf16 v[136:139], v[56:59], v[24:27], v[136:139]
v_fma_f32 v214, v214, v243, v243
v_rcp_f32 v212, v212
v_mfma_f32_16x16x32_bf16 v[136:139], v[60:63], v[40:43], v[136:139]
ds_read_b128 v[52:55], v7 offset:50176
v_rcp_f32 v214, v214
v_mfma_f32_16x16x32_bf16 v[140:143], v[56:59], v[28:31], v[140:143]
v_mul_f32 v213, v213, v212
v_mul_f32 v215, v215, v214
v_mfma_f32_16x16x32_bf16 v[140:143], v[60:63], v[44:47], v[140:143]
v_cvt_pk_bf16_f32 v189, v213, v215
s_waitcnt lgkmcnt(4)
v_mfma_f32_16x16x32_bf16 v[80:83], v[64:67], a[0:3], 0
v_mfma_f32_16x16x32_bf16 v[80:83], v[68:71], a[16:19], v[80:83]
v_mfma_f32_16x16x32_bf16 v[84:87], v[64:67], a[4:7], 0
ds_read_b128 v[56:59], v7 offset:51200
v_mfma_f32_16x16x32_bf16 v[84:87], v[68:71], a[20:23], v[84:87]
v_mul_f32 v208, v112, v112
v_mul_f32 v210, v113, v113
v_mfma_f32_16x16x32_bf16 v[88:91], v[64:67], a[8:11], 0
v_fma_f32 v208, v208, v233, v232
v_fma_f32 v210, v210, v233, v232
v_mfma_f32_16x16x32_bf16 v[88:91], v[68:71], a[24:27], v[88:91]
ds_read_b128 v[60:63], v7 offset:52224
v_mul_f32 v208, v208, v112
v_mfma_f32_16x16x32_bf16 v[92:95], v[64:67], a[12:15], 0
v_mul_f32 v210, v210, v113
v_mul_f32 v209, v112, v128
v_mfma_f32_16x16x32_bf16 v[92:95], v[68:71], a[28:31], v[92:95]
v_mul_f32 v211, v113, v129
s_waitcnt lgkmcnt(4)
v_mfma_f32_16x16x32_bf16 v[96:99], v[72:75], a[0:3], 0
v_exp_f32 v208, v208
v_mfma_f32_16x16x32_bf16 v[96:99], v[76:79], a[16:19], v[96:99]
v_exp_f32 v210, v210
v_mfma_f32_16x16x32_bf16 v[100:103], v[72:75], a[4:7], 0
ds_read_b128 v[64:67], v7 offset:53248
v_fma_f32 v208, v208, v234, v234
v_mfma_f32_16x16x32_bf16 v[100:103], v[76:79], a[20:23], v[100:103]
v_fma_f32 v210, v210, v234, v234
v_mul_f32 v212, v114, v114
v_mfma_f32_16x16x32_bf16 v[104:107], v[72:75], a[8:11], 0
v_rcp_f32 v208, v208
v_mfma_f32_16x16x32_bf16 v[104:107], v[76:79], a[24:27], v[104:107]
ds_read_b128 v[68:71], v7 offset:54272
v_mul_f32 v209, v209, v208
v_mfma_f32_16x16x32_bf16 v[108:111], v[72:75], a[12:15], 0
v_rcp_f32 v210, v210
v_mfma_f32_16x16x32_bf16 v[108:111], v[76:79], a[28:31], v[108:111]
v_mul_f32 v211, v211, v210
s_waitcnt lgkmcnt(4)
v_mfma_f32_16x16x32_bf16 v[80:83], v[48:51], a[32:35], v[80:83]
v_cvt_pk_bf16_f32 v178, v209, v211
v_mul_f32 v214, v115, v115
v_mfma_f32_16x16x32_bf16 v[80:83], v[52:55], a[48:51], v[80:83]
v_fma_f32 v212, v212, v233, v232
v_fma_f32 v214, v214, v233, v232
v_mfma_f32_16x16x32_bf16 v[84:87], v[48:51], a[36:39], v[84:87]
ds_read_b128 v[72:75], v7 offset:55296
v_mul_f32 v212, v212, v114
v_mfma_f32_16x16x32_bf16 v[84:87], v[52:55], a[52:55], v[84:87]
v_mul_f32 v214, v214, v115
v_mul_f32 v213, v114, v130
v_mfma_f32_16x16x32_bf16 v[88:91], v[48:51], a[40:43], v[88:91]
v_exp_f32 v212, v212
v_mfma_f32_16x16x32_bf16 v[88:91], v[52:55], a[56:59], v[88:91]
ds_read_b128 v[76:79], v7 offset:56320
v_mul_f32 v215, v115, v131
v_mfma_f32_16x16x32_bf16 v[92:95], v[48:51], a[44:47], v[92:95]
v_exp_f32 v214, v214
v_mfma_f32_16x16x32_bf16 v[92:95], v[52:55], a[60:63], v[92:95]
v_fma_f32 v212, v212, v234, v234
s_waitcnt lgkmcnt(4)
v_mfma_f32_16x16x32_bf16 v[96:99], v[56:59], a[32:35], v[96:99]
s_waitcnt vmcnt(26)
v_fma_f32 v214, v214, v234, v234
v_mfma_f32_16x16x32_bf16 v[96:99], v[60:63], a[48:51], v[96:99]
s_barrier
v_mfma_f32_16x16x32_bf16 v[100:103], v[56:59], a[36:39], v[100:103]
ds_read_b128 v[48:51], v7 offset:57344
s_add_u32 m0, s22, 73728
v_mfma_f32_16x16x32_bf16 v[100:103], v[60:63], a[52:55], v[100:103]
v_add_u32 v3, 20480, v3
buffer_load_dwordx4 v3, s[8:11], 0 offen offset:0 sc1 lds
v_mfma_f32_16x16x32_bf16 v[104:107], v[56:59], a[40:43], v[104:107]
v_rcp_f32 v212, v212
v_mfma_f32_16x16x32_bf16 v[104:107], v[60:63], a[56:59], v[104:107]
ds_read_b128 v[52:55], v7 offset:58368
v_mul_f32 v213, v213, v212
v_mfma_f32_16x16x32_bf16 v[108:111], v[56:59], a[44:47], v[108:111]
v_rcp_f32 v214, v214
v_mfma_f32_16x16x32_bf16 v[108:111], v[60:63], a[60:63], v[108:111]
v_mul_f32 v215, v215, v214
s_waitcnt lgkmcnt(4)
v_mfma_f32_16x16x32_bf16 v[80:83], v[64:67], a[64:67], v[80:83]
buffer_load_dwordx4 v3, s[8:11], 0 offen offset:1024 sc1 lds
v_mfma_f32_16x16x32_bf16 v[80:83], v[68:71], a[80:83], v[80:83]
v_cvt_pk_bf16_f32 v179, v213, v215
v_mul_f32 v208, v116, v116
v_mfma_f32_16x16x32_bf16 v[84:87], v[64:67], a[68:71], v[84:87]
ds_read_b128 v[56:59], v7 offset:59392
v_mul_f32 v210, v117, v117
v_mfma_f32_16x16x32_bf16 v[84:87], v[68:71], a[84:87], v[84:87]
buffer_store_dwordx4 v[176:179], v2, s[8:11], s24 offen offset:2048 sc1
v_mfma_f32_16x16x32_bf16 v[88:91], v[64:67], a[72:75], v[88:91]
v_fma_f32 v208, v208, v236, v235
v_fma_f32 v210, v210, v236, v235
v_mfma_f32_16x16x32_bf16 v[88:91], v[68:71], a[88:91], v[88:91]
ds_read_b128 v[60:63], v7 offset:60416
v_mul_f32 v208, v208, v116
v_mfma_f32_16x16x32_bf16 v[92:95], v[64:67], a[76:79], v[92:95]
v_mul_f32 v210, v210, v117
v_mul_f32 v209, v116, v132
v_mfma_f32_16x16x32_bf16 v[92:95], v[68:71], a[92:95], v[92:95]
v_mul_f32 v211, v117, v133
s_waitcnt lgkmcnt(4)
v_mfma_f32_16x16x32_bf16 v[96:99], v[72:75], a[64:67], v[96:99]
buffer_load_dwordx4 v3, s[8:11], 0 offen offset:2048 sc1 lds
v_mfma_f32_16x16x32_bf16 v[96:99], v[76:79], a[80:83], v[96:99]
v_exp_f32 v208, v208
v_mfma_f32_16x16x32_bf16 v[100:103], v[72:75], a[68:71], v[100:103]
ds_read_b128 v[64:67], v7 offset:61440
v_fma_f32 v208, v208, v237, v237
v_mfma_f32_16x16x32_bf16 v[100:103], v[76:79], a[84:87], v[100:103]
v_exp_f32 v210, v210
v_mfma_f32_16x16x32_bf16 v[104:107], v[72:75], a[72:75], v[104:107]
buffer_load_dwordx4 v3, s[8:11], 0 offen offset:3072 sc1 lds
v_mfma_f32_16x16x32_bf16 v[104:107], v[76:79], a[88:91], v[104:107]
ds_read_b128 v[68:71], v7 offset:62464
s_add_u32 m0, s22, 77824
v_mfma_f32_16x16x32_bf16 v[108:111], v[72:75], a[76:79], v[108:111]
v_add_u32 v3, 4096, v3
v_fma_f32 v210, v210, v237, v237
v_mfma_f32_16x16x32_bf16 v[108:111], v[76:79], a[92:95], v[108:111]
v_mul_f32 v212, v118, v118
s_waitcnt lgkmcnt(4)
v_mfma_f32_16x16x32_bf16 v[80:83], v[48:51], a[96:99], v[80:83]
buffer_load_dwordx4 v3, s[8:11], 0 offen offset:0 sc1 lds
v_mfma_f32_16x16x32_bf16 v[80:83], v[52:55], a[112:115], v[80:83]
v_rcp_f32 v208, v208
v_mfma_f32_16x16x32_bf16 v[84:87], v[48:51], a[100:103], v[84:87]
ds_read_b128 v[72:75], v7 offset:63488
v_mul_f32 v209, v209, v208
v_mfma_f32_16x16x32_bf16 v[84:87], v[52:55], a[116:119], v[84:87]
v_rcp_f32 v210, v210
v_mfma_f32_16x16x32_bf16 v[88:91], v[48:51], a[104:107], v[88:91]
buffer_load_dwordx4 v3, s[8:11], 0 offen offset:1024 sc1 lds
v_mfma_f32_16x16x32_bf16 v[88:91], v[52:55], a[120:123], v[88:91]
ds_read_b128 v[76:79], v7 offset:64512
s_add_u32 s23, s34, 0
v_mfma_f32_16x16x32_bf16 v[92:95], v[48:51], a[108:111], v[92:95]
v_mul_f32 v211, v211, v210
v_cvt_pk_bf16_f32 v182, v209, v211
v_mfma_f32_16x16x32_bf16 v[92:95], v[52:55], a[124:127], v[92:95]
v_mul_f32 v214, v119, v119
s_waitcnt lgkmcnt(4)
v_mfma_f32_16x16x32_bf16 v[96:99], v[56:59], a[96:99], v[96:99]
buffer_load_dwordx2 v[14:15], v11, s[8:11], s23 offen sc1
v_mfma_f32_16x16x32_bf16 v[96:99], v[60:63], a[112:115], v[96:99]
v_fma_f32 v212, v212, v236, v235
v_fma_f32 v214, v214, v236, v235
v_mfma_f32_16x16x32_bf16 v[100:103], v[56:59], a[100:103], v[100:103]
ds_read_b128 v[48:51], v8 offset:0
v_mul_f32 v212, v212, v118
v_mfma_f32_16x16x32_bf16 v[100:103], v[60:63], a[116:119], v[100:103]
v_mul_f32 v214, v214, v119
v_mul_f32 v213, v118, v134
v_mfma_f32_16x16x32_bf16 v[104:107], v[56:59], a[104:107], v[104:107]
v_exp_f32 v212, v212
v_mfma_f32_16x16x32_bf16 v[104:107], v[60:63], a[120:123], v[104:107]
ds_read_b128 v[52:55], v8 offset:1024
v_mul_f32 v215, v119, v135
v_mfma_f32_16x16x32_bf16 v[108:111], v[56:59], a[108:111], v[108:111]
v_exp_f32 v214, v214
v_mfma_f32_16x16x32_bf16 v[108:111], v[60:63], a[124:127], v[108:111]
v_fma_f32 v212, v212, v237, v237
s_waitcnt lgkmcnt(4)
v_mfma_f32_16x16x32_bf16 v[80:83], v[64:67], a[128:131], v[80:83]
v_fma_f32 v214, v214, v237, v237
v_mul_f32 v208, v120, v120
v_mfma_f32_16x16x32_bf16 v[80:83], v[68:71], a[144:147], v[80:83]
v_rcp_f32 v212, v212
v_mfma_f32_16x16x32_bf16 v[84:87], v[64:67], a[132:135], v[84:87]
ds_read_b128 v[56:59], v8 offset:2048
v_mul_f32 v213, v213, v212
v_mfma_f32_16x16x32_bf16 v[84:87], v[68:71], a[148:151], v[84:87]
v_rcp_f32 v214, v214
v_mfma_f32_16x16x32_bf16 v[88:91], v[64:67], a[136:139], v[88:91]
v_mul_f32 v215, v215, v214
v_cvt_pk_bf16_f32 v183, v213, v215
v_mfma_f32_16x16x32_bf16 v[88:91], v[68:71], a[152:155], v[88:91]
ds_read_b128 v[60:63], v8 offset:3072
v_mul_f32 v210, v121, v121
v_mfma_f32_16x16x32_bf16 v[92:95], v[64:67], a[140:143], v[92:95]
buffer_store_dwordx4 v[180:183], v4, s[8:11], s24 offen offset:2048 sc1
v_mfma_f32_16x16x32_bf16 v[92:95], v[68:71], a[156:159], v[92:95]
v_fma_f32 v208, v208, v239, v238
s_waitcnt lgkmcnt(4)
v_mfma_f32_16x16x32_bf16 v[96:99], v[72:75], a[128:131], v[96:99]
v_fma_f32 v210, v210, v239, v238
v_mul_f32 v208, v208, v120
v_mfma_f32_16x16x32_bf16 v[96:99], v[76:79], a[144:147], v[96:99]
v_mul_f32 v210, v210, v121
v_mul_f32 v209, v120, v136
v_mfma_f32_16x16x32_bf16 v[100:103], v[72:75], a[132:135], v[100:103]
ds_read_b128 v[64:67], v8 offset:4096
v_mul_f32 v211, v121, v137
v_mfma_f32_16x16x32_bf16 v[100:103], v[76:79], a[148:151], v[100:103]
v_exp_f32 v208, v208
v_mfma_f32_16x16x32_bf16 v[104:107], v[72:75], a[136:139], v[104:107]
v_exp_f32 v210, v210
v_mfma_f32_16x16x32_bf16 v[104:107], v[76:79], a[152:155], v[104:107]
ds_read_b128 v[68:71], v8 offset:5120
v_fma_f32 v208, v208, v240, v240
v_mfma_f32_16x16x32_bf16 v[108:111], v[72:75], a[140:143], v[108:111]
v_fma_f32 v210, v210, v240, v240
v_mul_f32 v212, v122, v122
v_mfma_f32_16x16x32_bf16 v[108:111], v[76:79], a[156:159], v[108:111]
v_mul_f32 v214, v123, v123
s_waitcnt lgkmcnt(4)
v_mfma_f32_16x16x32_bf16 v[80:83], v[48:51], a[160:163], v[80:83]
v_rcp_f32 v208, v208
v_mfma_f32_16x16x32_bf16 v[80:83], v[52:55], a[176:179], v[80:83]
v_rcp_f32 v210, v210
v_mfma_f32_16x16x32_bf16 v[84:87], v[48:51], a[164:167], v[84:87]
ds_read_b128 v[72:75], v8 offset:6144
v_mul_f32 v209, v209, v208
v_mfma_f32_16x16x32_bf16 v[84:87], v[52:55], a[180:183], v[84:87]
v_mul_f32 v211, v211, v210
v_cvt_pk_bf16_f32 v186, v209, v211
v_mfma_f32_16x16x32_bf16 v[88:91], v[48:51], a[168:171], v[88:91]
v_fma_f32 v212, v212, v239, v238
v_fma_f32 v214, v214, v239, v238
v_mfma_f32_16x16x32_bf16 v[88:91], v[52:55], a[184:187], v[88:91]
ds_read_b128 v[76:79], v8 offset:7168
v_mul_f32 v212, v212, v122
v_mfma_f32_16x16x32_bf16 v[92:95], v[48:51], a[172:175], v[92:95]
v_mul_f32 v214, v214, v123
v_mul_f32 v213, v122, v138
v_mfma_f32_16x16x32_bf16 v[92:95], v[52:55], a[188:191], v[92:95]
v_mul_f32 v215, v123, v139
s_waitcnt lgkmcnt(4)
v_mfma_f32_16x16x32_bf16 v[96:99], v[56:59], a[160:163], v[96:99]
v_exp_f32 v212, v212
v_mfma_f32_16x16x32_bf16 v[96:99], v[60:63], a[176:179], v[96:99]
v_exp_f32 v214, v214
v_mfma_f32_16x16x32_bf16 v[100:103], v[56:59], a[164:167], v[100:103]
ds_read_b128 v[48:51], v8 offset:8192
v_fma_f32 v212, v212, v240, v240
v_mfma_f32_16x16x32_bf16 v[100:103], v[60:63], a[180:183], v[100:103]
v_fma_f32 v214, v214, v240, v240
v_mul_f32 v208, v124, v124
v_mfma_f32_16x16x32_bf16 v[104:107], v[56:59], a[168:171], v[104:107]
v_rcp_f32 v212, v212
v_mfma_f32_16x16x32_bf16 v[104:107], v[60:63], a[184:187], v[104:107]
ds_read_b128 v[52:55], v8 offset:9216
v_mfma_f32_16x16x32_bf16 v[108:111], v[56:59], a[172:175], v[108:111]
v_rcp_f32 v214, v214
v_mfma_f32_16x16x32_bf16 v[108:111], v[60:63], a[188:191], v[108:111]
s_waitcnt lgkmcnt(4)
v_mfma_f32_16x16x32_bf16 v[80:83], v[64:67], a[192:195], v[80:83]
v_mul_f32 v213, v213, v212
v_mul_f32 v215, v215, v214
v_mfma_f32_16x16x32_bf16 v[80:83], v[68:71], a[208:211], v[80:83]
v_cvt_pk_bf16_f32 v187, v213, v215
v_mul_f32 v210, v125, v125
v_mfma_f32_16x16x32_bf16 v[84:87], v[64:67], a[196:199], v[84:87]
ds_read_b128 v[56:59], v8 offset:10240
v_mfma_f32_16x16x32_bf16 v[84:87], v[68:71], a[212:215], v[84:87]
buffer_store_dwordx4 v[184:187], v5, s[8:11], s24 offen offset:2048 sc1
v_mfma_f32_16x16x32_bf16 v[88:91], v[64:67], a[200:203], v[88:91]
v_mfma_f32_16x16x32_bf16 v[88:91], v[68:71], a[216:219], v[88:91]
ds_read_b128 v[60:63], v8 offset:11264
v_fma_f32 v208, v208, v242, v241
v_mfma_f32_16x16x32_bf16 v[92:95], v[64:67], a[204:207], v[92:95]
v_fma_f32 v210, v210, v242, v241
v_mul_f32 v208, v208, v124
v_mfma_f32_16x16x32_bf16 v[92:95], v[68:71], a[220:223], v[92:95]
v_mul_f32 v210, v210, v125
s_waitcnt lgkmcnt(4)
v_mfma_f32_16x16x32_bf16 v[96:99], v[72:75], a[192:195], v[96:99]
v_exp_f32 v208, v208
v_mfma_f32_16x16x32_bf16 v[96:99], v[76:79], a[208:211], v[96:99]
v_mfma_f32_16x16x32_bf16 v[100:103], v[72:75], a[196:199], v[100:103]
ds_read_b128 v[64:67], v8 offset:12288
v_mul_f32 v209, v124, v140
v_mfma_f32_16x16x32_bf16 v[100:103], v[76:79], a[212:215], v[100:103]
v_exp_f32 v210, v210
v_mfma_f32_16x16x32_bf16 v[104:107], v[72:75], a[200:203], v[104:107]
v_mfma_f32_16x16x32_bf16 v[104:107], v[76:79], a[216:219], v[104:107]
ds_read_b128 v[68:71], v8 offset:13312
v_mul_f32 v211, v125, v141
v_mfma_f32_16x16x32_bf16 v[108:111], v[72:75], a[204:207], v[108:111]
v_fma_f32 v208, v208, v243, v243
v_fma_f32 v210, v210, v243, v243
v_mfma_f32_16x16x32_bf16 v[108:111], v[76:79], a[220:223], v[108:111]
v_mul_f32 v212, v126, v126
s_waitcnt lgkmcnt(4)
v_mfma_f32_16x16x32_bf16 v[80:83], v[48:51], a[224:227], v[80:83]
v_rcp_f32 v208, v208
v_mfma_f32_16x16x32_bf16 v[80:83], v[52:55], a[240:243], v[80:83]
v_mfma_f32_16x16x32_bf16 v[84:87], v[48:51], a[228:231], v[84:87]
ds_read_b128 v[72:75], v8 offset:14336
v_mul_f32 v209, v209, v208
v_mfma_f32_16x16x32_bf16 v[84:87], v[52:55], a[244:247], v[84:87]
v_rcp_f32 v210, v210
v_mfma_f32_16x16x32_bf16 v[88:91], v[48:51], a[232:235], v[88:91]
v_mul_f32 v211, v211, v210
v_cvt_pk_bf16_f32 v190, v209, v211
v_mfma_f32_16x16x32_bf16 v[88:91], v[52:55], a[248:251], v[88:91]
ds_read_b128 v[76:79], v8 offset:15360
v_mfma_f32_16x16x32_bf16 v[92:95], v[48:51], a[236:239], v[92:95]
v_mul_f32 v214, v127, v127
v_fma_f32 v212, v212, v242, v241
v_mfma_f32_16x16x32_bf16 v[92:95], v[52:55], a[252:255], v[92:95]
s_waitcnt lgkmcnt(4)
v_mfma_f32_16x16x32_bf16 v[96:99], v[56:59], a[224:227], v[96:99]
s_waitcnt vmcnt(28)
v_fma_f32 v214, v214, v242, v241
v_mfma_f32_16x16x32_bf16 v[96:99], v[60:63], a[240:243], v[96:99]
s_barrier
v_mfma_f32_16x16x32_bf16 v[100:103], v[56:59], a[228:231], v[100:103]
ds_read_b128 v[48:51], v2 offset:0
s_add_u32 m0, s22, 98304
v_mfma_f32_16x16x32_bf16 v[100:103], v[60:63], a[244:247], v[100:103]
v_add_u32 v3, 20480, v3
buffer_load_dwordx4 v3, s[8:11], 0 offen offset:0 sc1 lds
v_mfma_f32_16x16x32_bf16 v[104:107], v[56:59], a[232:235], v[104:107]
v_mul_f32 v212, v212, v126
v_mul_f32 v214, v214, v127
v_mfma_f32_16x16x32_bf16 v[104:107], v[60:63], a[248:251], v[104:107]
ds_read_b128 v[52:55], v2 offset:1024
v_mul_f32 v213, v126, v142
v_mfma_f32_16x16x32_bf16 v[108:111], v[56:59], a[236:239], v[108:111]
v_exp_f32 v212, v212
v_mfma_f32_16x16x32_bf16 v[108:111], v[60:63], a[252:255], v[108:111]
v_mul_f32 v215, v127, v143
s_waitcnt lgkmcnt(4)
v_mfma_f32_16x16x32_bf16 v[80:83], v[64:67], v[16:19], v[80:83]
buffer_load_dwordx4 v3, s[8:11], 0 offen offset:1024 sc1 lds
v_mfma_f32_16x16x32_bf16 v[80:83], v[68:71], v[32:35], v[80:83]
v_exp_f32 v214, v214
v_mfma_f32_16x16x32_bf16 v[84:87], v[64:67], v[20:23], v[84:87]
ds_read_b128 v[56:59], v2 offset:2048
v_fma_f32 v212, v212, v243, v243
v_mfma_f32_16x16x32_bf16 v[84:87], v[68:71], v[36:39], v[84:87]
v_fma_f32 v214, v214, v243, v243
v_mfma_f32_16x16x32_bf16 v[88:91], v[64:67], v[24:27], v[88:91]
buffer_load_dwordx4 v3, s[8:11], 0 offen offset:2048 sc1 lds
v_mfma_f32_16x16x32_bf16 v[88:91], v[68:71], v[40:43], v[88:91]
ds_read_b128 v[60:63], v2 offset:3072
v_mfma_f32_16x16x32_bf16 v[92:95], v[64:67], v[28:31], v[92:95]
v_rcp_f32 v212, v212
v_mfma_f32_16x16x32_bf16 v[92:95], v[68:71], v[44:47], v[92:95]
v_mul_f32 v213, v213, v212
s_waitcnt lgkmcnt(4)
v_mfma_f32_16x16x32_bf16 v[96:99], v[72:75], v[16:19], v[96:99]
buffer_load_dwordx4 v3, s[8:11], 0 offen offset:3072 sc1 lds
v_mfma_f32_16x16x32_bf16 v[96:99], v[76:79], v[32:35], v[96:99]
s_add_u32 m0, s22, 102400
v_add_u32 v3, 4096, v3
v_mfma_f32_16x16x32_bf16 v[100:103], v[72:75], v[20:23], v[100:103]
ds_read_b128 v[64:67], v2 offset:4096
v_mfma_f32_16x16x32_bf16 v[100:103], v[76:79], v[36:39], v[100:103]
v_rcp_f32 v214, v214
v_mfma_f32_16x16x32_bf16 v[104:107], v[72:75], v[24:27], v[104:107]
buffer_load_dwordx4 v3, s[8:11], 0 offen offset:0 sc1 lds
v_mul_f32 v215, v215, v214
v_mfma_f32_16x16x32_bf16 v[104:107], v[76:79], v[40:43], v[104:107]
ds_read_b128 v[68:71], v2 offset:5120
v_cvt_pk_bf16_f32 v191, v213, v215
v_mfma_f32_16x16x32_bf16 v[108:111], v[72:75], v[28:31], v[108:111]
buffer_store_dwordx4 v[188:191], v6, s[8:11], s24 offen offset:2048 sc1
v_mfma_f32_16x16x32_bf16 v[108:111], v[76:79], v[44:47], v[108:111]
s_waitcnt lgkmcnt(4)
v_mfma_f32_16x16x32_bf16 v[112:115], v[48:51], a[0:3], 0
v_mfma_f32_16x16x32_bf16 v[112:115], v[52:55], a[16:19], v[112:115]
v_mfma_f32_16x16x32_bf16 v[116:119], v[48:51], a[4:7], 0
ds_read_b128 v[72:75], v2 offset:6144
v_mfma_f32_16x16x32_bf16 v[116:119], v[52:55], a[20:23], v[116:119]
buffer_load_dwordx4 v3, s[8:11], 0 offen offset:1024 sc1 lds
v_mfma_f32_16x16x32_bf16 v[120:123], v[48:51], a[8:11], 0
s_waitcnt vmcnt(9)
v_cmp_eq_u64 vcc, s[68:69], v[14:15]
s_nop 0
s_cmp_eq_u64 vcc, exec
s_cbranch_scc0 L_f_slow1
L_f_back1:
v_mul_f32 v208, v80, v80
v_mfma_f32_16x16x32_bf16 v[120:123], v[52:55], a[24:27], v[120:123]
ds_read_b128 v[76:79], v2 offset:7168
v_mul_f32 v210, v81, v81
v_mfma_f32_16x16x32_bf16 v[124:127], v[48:51], a[12:15], 0
v_fma_f32 v208, v208, v233, v232
v_fma_f32 v210, v210, v233, v232
v_mfma_f32_16x16x32_bf16 v[124:127], v[52:55], a[28:31], v[124:127]
v_mul_f32 v208, v208, v80
s_waitcnt lgkmcnt(4)
v_mfma_f32_16x16x32_bf16 v[128:131], v[56:59], a[0:3], 0
v_mul_f32 v210, v210, v81
v_mul_f32 v209, v80, v96
v_mfma_f32_16x16x32_bf16 v[128:131], v[60:63], a[16:19], v[128:131]
v_exp_f32 v208, v208
v_mfma_f32_16x16x32_bf16 v[132:135], v[56:59], a[4:7], 0
ds_read_b128 v[48:51], v2 offset:8192
v_mul_f32 v211, v81, v97
v_mfma_f32_16x16x32_bf16 v[132:135], v[60:63], a[20:23], v[132:135]
v_exp_f32 v210, v210
v_mfma_f32_16x16x32_bf16 v[136:139], v[56:59], a[8:11], 0
v_fma_f32 v208, v208, v234, v234
v_fma_f32 v210, v210, v234, v234
v_mfma_f32_16x16x32_bf16 v[136:139], v[60:63], a[24:27], v[136:139]
ds_read_b128 v[52:55], v2 offset:9216
v_mul_f32 v212, v82, v82
v_mfma_f32_16x16x32_bf16 v[140:143], v[56:59], a[12:15], 0
v_rcp_f32 v208, v208
v_mfma_f32_16x16x32_bf16 v[140:143], v[60:63], a[28:31], v[140:143]
v_mul_f32 v209, v209, v208
s_waitcnt lgkmcnt(4)
v_mfma_f32_16x16x32_bf16 v[112:115], v[64:67], a[32:35], v[112:115]
v_rcp_f32 v210, v210
v_mfma_f32_16x16x32_bf16 v[112:115], v[68:71], a[48:51], v[112:115]
v_mul_f32 v211, v211, v210
v_cvt_pk_bf16_f32 v192, v209, v211
v_mfma_f32_16x16x32_bf16 v[116:119], v[64:67], a[36:39], v[116:119]
ds_read_b128 v[56:59], v2 offset:10240
v_mul_f32 v214, v83, v83
v_mfma_f32_16x16x32_bf16 v[116:119], v[68:71], a[52:55], v[116:119]
v_fma_f32 v212, v212, v233, v232
v_fma_f32 v214, v214, v233, v232
v_mfma_f32_16x16x32_bf16 v[120:123], v[64:67], a[40:43], v[120:123]
v_mul_f32 v212, v212, v82
v_mul_f32 v214, v214, v83
v_mfma_f32_16x16x32_bf16 v[120:123], v[68:71], a[56:59], v[120:123]
ds_read_b128 v[60:63], v2 offset:11264
v_mul_f32 v213, v82, v98
v_mfma_f32_16x16x32_bf16 v[124:127], v[64:67], a[44:47], v[124:127]
v_exp_f32 v212, v212
v_mfma_f32_16x16x32_bf16 v[124:127], v[68:71], a[60:63], v[124:127]
v_mul_f32 v215, v83, v99
s_waitcnt lgkmcnt(4)
v_mfma_f32_16x16x32_bf16 v[128:131], v[72:75], a[32:35], v[128:131]
buffer_load_dwordx4 a[0:3], v2, s[8:11], s25 offen offset:0 sc1
v_mfma_f32_16x16x32_bf16 v[128:131], v[76:79], a[48:51], v[128:131]
v_exp_f32 v214, v214
v_mfma_f32_16x16x32_bf16 v[132:135], v[72:75], a[36:39], v[132:135]
ds_read_b128 v[64:67], v2 offset:12288
v_fma_f32 v212, v212, v234, v234
v_mfma_f32_16x16x32_bf16 v[132:135], v[76:79], a[52:55], v[132:135]
v_fma_f32 v214, v214, v234, v234
v_mul_f32 v208, v84, v84
v_mfma_f32_16x16x32_bf16 v[136:139], v[72:75], a[40:43], v[136:139]
buffer_load_dwordx4 a[4:7], v4, s[8:11], s25 offen offset:0 sc1
v_mfma_f32_16x16x32_bf16 v[136:139], v[76:79], a[56:59], v[136:139]
ds_read_b128 v[68:71], v2 offset:13312
v_mul_f32 v210, v85, v85
v_mfma_f32_16x16x32_bf16 v[140:143], v[72:75], a[44:47], v[140:143]
v_rcp_f32 v212, v212
v_mfma_f32_16x16x32_bf16 v[140:143], v[76:79], a[60:63], v[140:143]
v_mul_f32 v213, v213, v212
s_waitcnt lgkmcnt(4)
v_mfma_f32_16x16x32_bf16 v[112:115], v[48:51], a[64:67], v[112:115]
buffer_load_dwordx4 a[8:11], v5, s[8:11], s25 offen offset:0 sc1
v_mfma_f32_16x16x32_bf16 v[112:115], v[52:55], a[80:83], v[112:115]
v_rcp_f32 v214, v214
v_mfma_f32_16x16x32_bf16 v[116:119], v[48:51], a[68:71], v[116:119]
ds_read_b128 v[72:75], v2 offset:14336
v_mul_f32 v215, v215, v214
v_mfma_f32_16x16x32_bf16 v[116:119], v[52:55], a[84:87], v[116:119]
v_cvt_pk_bf16_f32 v193, v213, v215
v_fma_f32 v208, v208, v236, v235
v_mfma_f32_16x16x32_bf16 v[120:123], v[48:51], a[72:75], v[120:123]
buffer_load_dwordx4 a[12:15], v6, s[8:11], s25 offen offset:0 sc1
v_mfma_f32_16x16x32_bf16 v[120:123], v[52:55], a[88:91], v[120:123]
ds_read_b128 v[76:79], v2 offset:15360
v_fma_f32 v210, v210, v236, v235
v_mfma_f32_16x16x32_bf16 v[124:127], v[48:51], a[76:79], v[124:127]
v_mul_f32 v208, v208, v84
v_mul_f32 v210, v210, v85
v_mfma_f32_16x16x32_bf16 v[124:127], v[52:55], a[92:95], v[124:127]
v_mul_f32 v209, v84, v100
s_waitcnt lgkmcnt(4)
v_mfma_f32_16x16x32_bf16 v[128:131], v[56:59], a[64:67], v[128:131]
v_exp_f32 v208, v208
v_mfma_f32_16x16x32_bf16 v[128:131], v[60:63], a[80:83], v[128:131]
v_exp_f32 v210, v210
v_mfma_f32_16x16x32_bf16 v[132:135], v[56:59], a[68:71], v[132:135]
ds_read_b128 v[48:51], v2 offset:16384
v_mul_f32 v211, v85, v101
v_mfma_f32_16x16x32_bf16 v[132:135], v[60:63], a[84:87], v[132:135]
v_fma_f32 v208, v208, v237, v237
v_fma_f32 v210, v210, v237, v237
v_mfma_f32_16x16x32_bf16 v[136:139], v[56:59], a[72:75], v[136:139]
v_rcp_f32 v208, v208
v_mfma_f32_16x16x32_bf16 v[136:139], v[60:63], a[88:91], v[136:139]
ds_read_b128 v[52:55], v2 offset:17408
v_mul_f32 v209, v209, v208
v_mfma_f32_16x16x32_bf16 v[140:143], v[56:59], a[76:79], v[140:143]
v_rcp_f32 v210, v210
v_mfma_f32_16x16x32_bf16 v[140:143], v[60:63], a[92:95], v[140:143]
v_mul_f32 v211, v211, v210
s_waitcnt lgkmcnt(4)
v_mfma_f32_16x16x32_bf16 v[112:115], v[64:67], a[96:99], v[112:115]
v_mov_b32 v12, s68
v_mov_b32 v13, s69
v_mfma_f32_16x16x32_bf16 v[112:115], v[68:71], a[112:115], v[112:115]
s_add_u32 s53, s34, 131072
s_waitcnt vmcnt(5)
buffer_store_dwordx2 v[12:13], v10, s[8:11], s53 offen sc1
v_mfma_f32_16x16x32_bf16 v[116:119], v[64:67], a[100:103], v[116:119]
ds_read_b128 v[56:59], v2 offset:18432
v_cvt_pk_bf16_f32 v196, v209, v211
v_mfma_f32_16x16x32_bf16 v[116:119], v[68:71], a[116:119], v[116:119]
v_mul_f32 v212, v86, v86
v_mul_f32 v214, v87, v87
v_mfma_f32_16x16x32_bf16 v[120:123], v[64:67], a[104:107], v[120:123]
v_fma_f32 v212, v212, v236, v235
v_fma_f32 v214, v214, v236, v235
v_mfma_f32_16x16x32_bf16 v[120:123], v[68:71], a[120:123], v[120:123]
ds_read_b128 v[60:63], v2 offset:19456
v_mul_f32 v212, v212, v86
v_mfma_f32_16x16x32_bf16 v[124:127], v[64:67], a[108:111], v[124:127]
buffer_load_dwordx4 a[16:19], v2, s[8:11], s26 offen offset:0 sc1
v_mfma_f32_16x16x32_bf16 v[124:127], v[68:71], a[124:127], v[124:127]
v_mul_f32 v214, v214, v87
s_waitcnt lgkmcnt(4)
v_mfma_f32_16x16x32_bf16 v[128:131], v[72:75], a[96:99], v[128:131]
v_exp_f32 v212, v212
v_mfma_f32_16x16x32_bf16 v[128:131], v[76:79], a[112:115], v[128:131]
v_exp_f32 v214, v214
v_mfma_f32_16x16x32_bf16 v[132:135], v[72:75], a[100:103], v[132:135]
ds_read_b128 v[64:67], v2 offset:20480
v_mul_f32 v213, v86, v102
v_mfma_f32_16x16x32_bf16 v[132:135], v[76:79], a[116:119], v[132:135]
buffer_load_dwordx4 a[20:23], v4, s[8:11], s26 offen offset:0 sc1
v_mfma_f32_16x16x32_bf16 v[136:139], v[72:75], a[104:107], v[136:139]
v_mul_f32 v215, v87, v103
v_fma_f32 v212, v212, v237, v237
v_mfma_f32_16x16x32_bf16 v[136:139], v[76:79], a[120:123], v[136:139]
ds_read_b128 v[68:71], v2 offset:21504
v_fma_f32 v214, v214, v237, v237
v_mfma_f32_16x16x32_bf16 v[140:143], v[72:75], a[108:111], v[140:143]
v_rcp_f32 v212, v212
v_mfma_f32_16x16x32_bf16 v[140:143], v[76:79], a[124:127], v[140:143]
v_mul_f32 v213, v213, v212
s_waitcnt lgkmcnt(4)
v_mfma_f32_16x16x32_bf16 v[112:115], v[48:51], a[128:131], v[112:115]
buffer_load_dwordx4 a[24:27], v5, s[8:11], s26 offen offset:0 sc1
v_mfma_f32_16x16x32_bf16 v[112:115], v[52:55], a[144:147], v[112:115]
v_rcp_f32 v214, v214
v_mfma_f32_16x16x32_bf16 v[116:119], v[48:51], a[132:135], v[116:119]
ds_read_b128 v[72:75], v2 offset:22528
v_mul_f32 v215, v215, v214
v_mfma_f32_16x16x32_bf16 v[116:119], v[52:55], a[148:151], v[116:119]
v_cvt_pk_bf16_f32 v197, v213, v215
v_mul_f32 v208, v88, v88
v_mfma_f32_16x16x32_bf16 v[120:123], v[48:51], a[136:139], v[120:123]
buffer_load_dwordx4 a[28:31], v6, s[8:11], s26 offen offset:0 sc1
v_mfma_f32_16x16x32_bf16 v[120:123], v[52:55], a[152:155], v[120:123]
ds_read_b128 v[76:79], v2 offset:23552
v_mul_f32 v210, v89, v89
v_mfma_f32_16x16x32_bf16 v[124:127], v[48:51], a[140:143], v[124:127]
v_fma_f32 v208, v208, v239, v238
v_fma_f32 v210, v210, v239, v238
v_mfma_f32_16x16x32_bf16 v[124:127], v[52:55], a[156:159], v[124:127]
v_mul_f32 v208, v208, v88
s_waitcnt lgkmcnt(4)
v_mfma_f32_16x16x32_bf16 v[128:131], v[56:59], a[128:131], v[128:131]
s_waitcnt vmcnt(34)
v_mul_f32 v210, v210, v89
v_mfma_f32_16x16x32_bf16 v[128:131], v[60:63], a[144:147], v[128:131]
s_barrier
v_mfma_f32_16x16x32_bf16 v[132:135], v[56:59], a[132:135], v[132:135]
ds_read_b128 v[48:51], v2 offset:24576
v_mul_f32 v209, v88, v104
v_mfma_f32_16x16x32_bf16 v[132:135], v[60:63], a[148:151], v[132:135]
buffer_load_dwordx4 a[32:35], v2, s[8:11], s27 offen offset:0 sc1
v_mfma_f32_16x16x32_bf16 v[136:139], v[56:59], a[136:139], v[136:139]
v_exp_f32 v208, v208
v_mfma_f32_16x16x32_bf16 v[136:139], v[60:63], a[152:155], v[136:139]
ds_read_b128 v[52:55], v2 offset:25600
v_mul_f32 v211, v89, v105
v_mfma_f32_16x16x32_bf16 v[140:143], v[56:59], a[140:143], v[140:143]
v_exp_f32 v210, v210
v_mfma_f32_16x16x32_bf16 v[140:143], v[60:63], a[156:159], v[140:143]
v_fma_f32 v208, v208, v240, v240
s_waitcnt lgkmcnt(4)
v_mfma_f32_16x16x32_bf16 v[112:115], v[64:67], a[160:163], v[112:115]
buffer_load_dwordx4 a[36:39], v4, s[8:11], s27 offen offset:0 sc1
v_mfma_f32_16x16x32_bf16 v[112:115], v[68:71], a[176:179], v[112:115]
v_fma_f32 v210, v210, v240, v240
v_mul_f32 v212, v90, v90
v_mfma_f32_16x16x32_bf16 v[116:119], v[64:67], a[164:167], v[116:119]
ds_read_b128 v[56:59], v2 offset:26624
v_mul_f32 v214, v91, v91
v_mfma_f32_16x16x32_bf16 v[116:119], v[68:71], a[180:183], v[116:119]
v_rcp_f32 v208, v208
v_mfma_f32_16x16x32_bf16 v[120:123], v[64:67], a[168:171], v[120:123]
buffer_load_dwordx4 a[40:43], v5, s[8:11], s27 offen offset:0 sc1
v_mfma_f32_16x16x32_bf16 v[120:123], v[68:71], a[184:187], v[120:123]
ds_read_b128 v[60:63], v2 offset:27648
v_mul_f32 v209, v209, v208
v_mfma_f32_16x16x32_bf16 v[124:127], v[64:67], a[172:175], v[124:127]
v_rcp_f32 v210, v210
v_mfma_f32_16x16x32_bf16 v[124:127], v[68:71], a[188:191], v[124:127]
v_mul_f32 v211, v211, v210
s_waitcnt lgkmcnt(4)
v_mfma_f32_16x16x32_bf16 v[128:131], v[72:75], a[160:163], v[128:131]
buffer_load_dwordx4 a[44:47], v6, s[8:11], s27 offen offset:0 sc1
v_mfma_f32_16x16x32_bf16 v[128:131], v[76:79], a[176:179], v[128:131]
s_add_u32 m0, s22, 122880
v_add_u32 v3, 20480, v3
v_mfma_f32_16x16x32_bf16 v[132:135], v[72:75], a[164:167], v[132:135]
ds_read_b128 v[64:67], v2 offset:28672
v_cvt_pk_bf16_f32 v200, v209, v211
v_mfma_f32_16x16x32_bf16 v[132:135], v[76:79], a[180:183], v[132:135]
v_fma_f32 v212, v212, v239, v238
v_fma_f32 v214, v214, v239, v238
v_mfma_f32_16x16x32_bf16 v[136:139], v[72:75], a[168:171], v[136:139]
buffer_load_dwordx4 v3, s[8:11], 0 offen offset:0 sc1 lds
v_mfma_f32_16x16x32_bf16 v[136:139], v[76:79], a[184:187], v[136:139]
ds_read_b128 v[68:71], v2 offset:29696
v_mul_f32 v212, v212, v90
v_mfma_f32_16x16x32_bf16 v[140:143], v[72:75], a[172:175], v[140:143]
v_mul_f32 v214, v214, v91
v_mul_f32 v213, v90, v106
v_mfma_f32_16x16x32_bf16 v[140:143], v[76:79], a[188:191], v[140:143]
v_mul_f32 v215, v91, v107
s_waitcnt lgkmcnt(4)
v_mfma_f32_16x16x32_bf16 v[112:115], v[48:51], a[192:195], v[112:115]
buffer_load_dwordx4 v3, s[8:11], 0 offen offset:1024 sc1 lds
v_mfma_f32_16x16x32_bf16 v[112:115], v[52:55], a[208:211], v[112:115]
v_exp_f32 v212, v212
v_mfma_f32_16x16x32_bf16 v[116:119], v[48:51], a[196:199], v[116:119]
ds_read_b128 v[72:75], v2 offset:30720
v_fma_f32 v212, v212, v240, v240
v_mfma_f32_16x16x32_bf16 v[116:119], v[52:55], a[212:215], v[116:119]
v_exp_f32 v214, v214
v_mfma_f32_16x16x32_bf16 v[120:123], v[48:51], a[200:203], v[120:123]
buffer_load_dwordx4 v3, s[8:11], 0 offen offset:2048 sc1 lds
v_mfma_f32_16x16x32_bf16 v[120:123], v[52:55], a[216:219], v[120:123]
ds_read_b128 v[76:79], v2 offset:31744
v_fma_f32 v214, v214, v240, v240
v_mfma_f32_16x16x32_bf16 v[124:127], v[48:51], a[204:207], v[124:127]
v_rcp_f32 v212, v212
v_mfma_f32_16x16x32_bf16 v[124:127], v[52:55], a[220:223], v[124:127]
v_mul_f32 v213, v213, v212
s_waitcnt lgkmcnt(4)
v_mfma_f32_16x16x32_bf16 v[128:131], v[56:59], a[192:195], v[128:131]
buffer_load_dwordx4 v3, s[8:11], 0 offen offset:3072 sc1 lds
v_mfma_f32_16x16x32_bf16 v[128:131], v[60:63], a[208:211], v[128:131]
s_add_u32 m0, s22, 126976
v_add_u32 v3, 4096, v3
v_mfma_f32_16x16x32_bf16 v[132:135], v[56:59], a[196:199], v[132:135]
ds_read_b128 v[48:51], v2 offset:32768
v_mul_f32 v208, v92, v92
v_mfma_f32_16x16x32_bf16 v[132:135], v[60:63], a[212:215], v[132:135]
v_rcp_f32 v214, v214
v_mfma_f32_16x16x32_bf16 v[136:139], v[56:59], a[200:203], v[136:139]
buffer_load_dwordx4 v3, s[8:11], 0 offen offset:0 sc1 lds
v_mfma_f32_16x16x32_bf16 v[136:139], v[60:63], a[216:219], v[136:139]
ds_read_b128 v[52:55], v2 offset:33792
v_mul_f32 v215, v215, v214
v_mfma_f32_16x16x32_bf16 v[140:143], v[56:59], a[204:207], v[140:143]
v_cvt_pk_bf16_f32 v201, v213, v215
v_mul_f32 v210, v93, v93
v_mfma_f32_16x16x32_bf16 v[140:143], v[60:63], a[220:223], v[140:143]
v_fma_f32 v208, v208, v242, v241
s_waitcnt lgkmcnt(4)
v_mfma_f32_16x16x32_bf16 v[112:115], v[64:67], a[224:227], v[112:115]
buffer_load_dwordx4 v3, s[8:11], 0 offen offset:1024 sc1 lds
v_mfma_f32_16x16x32_bf16 v[112:115], v[68:71], a[240:243], v[112:115]
v_fma_f32 v210, v210, v242, v241
v_mul_f32 v208, v208, v92
v_mfma_f32_16x16x32_bf16 v[116:119], v[64:67], a[228:231], v[116:119]
ds_read_b128 v[56:59], v2 offset:34816
v_mul_f32 v210, v210, v93
v_mfma_f32_16x16x32_bf16 v[116:119], v[68:71], a[244:247], v[116:119]
v_exp_f32 v208, v208
v_mfma_f32_16x16x32_bf16 v[120:123], v[64:67], a[232:235], v[120:123]
buffer_load_dwordx4 a[48:51], v2, s[8:11], s25 offen offset:1024 sc1
v_mfma_f32_16x16x32_bf16 v[120:123], v[68:71], a[248:251], v[120:123]
ds_read_b128 v[60:63], v2 offset:35840
v_mul_f32 v209, v92, v108
v_mfma_f32_16x16x32_bf16 v[124:127], v[64:67], a[236:239], v[124:127]
v_exp_f32 v210, v210
v_mfma_f32_16x16x32_bf16 v[124:127], v[68:71], a[252:255], v[124:127]
v_mul_f32 v211, v93, v109
s_waitcnt lgkmcnt(4)
v_mfma_f32_16x16x32_bf16 v[128:131], v[72:75], a[224:227], v[128:131]
buffer_load_dwordx4 a[52:55], v4, s[8:11], s25 offen offset:1024 sc1
v_mfma_f32_16x16x32_bf16 v[128:131], v[76:79], a[240:243], v[128:131]
v_fma_f32 v208, v208, v243, v243
v_fma_f32 v210, v210, v243, v243
v_mfma_f32_16x16x32_bf16 v[132:135], v[72:75], a[228:231], v[132:135]
ds_read_b128 v[64:67], v2 offset:36864
v_mul_f32 v212, v94, v94
v_mfma_f32_16x16x32_bf16 v[132:135], v[76:79], a[244:247], v[132:135]
v_rcp_f32 v208, v208
v_mfma_f32_16x16x32_bf16 v[136:139], v[72:75], a[232:235], v[136:139]
buffer_load_dwordx4 a[56:59], v5, s[8:11], s25 offen offset:1024 sc1
v_mfma_f32_16x16x32_bf16 v[136:139], v[76:79], a[248:251], v[136:139]
ds_read_b128 v[68:71], v2 offset:37888
v_mul_f32 v209, v209, v208
v_mfma_f32_16x16x32_bf16 v[140:143], v[72:75], a[236:239], v[140:143]
v_rcp_f32 v210, v210
v_mfma_f32_16x16x32_bf16 v[140:143], v[76:79], a[252:255], v[140:143]
v_mul_f32 v211, v211, v210
s_waitcnt lgkmcnt(4)
v_mfma_f32_16x16x32_bf16 v[112:115], v[48:51], v[16:19], v[112:115]
buffer_load_dwordx4 a[60:63], v6, s[8:11], s25 offen offset:1024 sc1
v_mfma_f32_16x16x32_bf16 v[112:115], v[52:55], v[32:35], v[112:115]
v_cvt_pk_bf16_f32 v204, v209, v211
v_mul_f32 v214, v95, v95
v_mfma_f32_16x16x32_bf16 v[116:119], v[48:51], v[20:23], v[116:119]
ds_read_b128 v[72:75], v2 offset:38912
v_fma_f32 v212, v212, v242, v241
v_mfma_f32_16x16x32_bf16 v[116:119], v[52:55], v[36:39], v[116:119]
v_fma_f32 v214, v214, v242, v241
v_mul_f32 v212, v212, v94
v_mfma_f32_16x16x32_bf16 v[120:123], v[48:51], v[24:27], v[120:123]
buffer_load_dwordx4 a[64:67], v2, s[8:11], s26 offen offset:1024 sc1
v_mfma_f32_16x16x32_bf16 v[120:123], v[52:55], v[40:43], v[120:123]
ds_read_b128 v[76:79], v2 offset:39936
v_mul_f32 v214, v214, v95
v_mfma_f32_16x16x32_bf16 v[124:127], v[48:51], v[28:31], v[124:127]
v_exp_f32 v212, v212
v_mfma_f32_16x16x32_bf16 v[124:127], v[52:55], v[44:47], v[124:127]
v_mul_f32 v213, v94, v110
s_waitcnt lgkmcnt(4)
v_mfma_f32_16x16x32_bf16 v[128:131], v[56:59], v[16:19], v[128:131]
buffer_load_dwordx4 a[68:71], v4, s[8:11], s26 offen offset:1024 sc1
v_mfma_f32_16x16x32_bf16 v[128:131], v[60:63], v[32:35], v[128:131]
v_exp_f32 v214, v214
v_mfma_f32_16x16x32_bf16 v[132:135], v[56:59], v[20:23], v[132:135]
ds_read_b128 v[48:51], v2 offset:40960
v_mul_f32 v215, v95, v111
v_mfma_f32_16x16x32_bf16 v[132:135], v[60:63], v[36:39], v[132:135]
v_fma_f32 v212, v212, v243, v243
v_fma_f32 v214, v214, v243, v243
v_mfma_f32_16x16x32_bf16 v[136:139], v[56:59], v[24:27], v[136:139]
buffer_load_dwordx4 a[72:75], v5, s[8:11], s26 offen offset:1024 sc1
v_mfma_f32_16x16x32_bf16 v[136:139], v[60:63], v[40:43], v[136:139]
ds_read_b128 v[52:55], v2 offset:41984
v_mfma_f32_16x16x32_bf16 v[140:143], v[56:59], v[28:31], v[140:143]
v_rcp_f32 v212, v212
v_mfma_f32_16x16x32_bf16 v[140:143], v[60:63], v[44:47], v[140:143]
v_mul_f32 v213, v213, v212
s_waitcnt lgkmcnt(4)
v_mfma_f32_16x16x32_bf16 a[112:115], v[64:67], v[144:147], 0
buffer_load_dwordx4 a[76:79], v6, s[8:11], s26 offen offset:1024 sc1
v_mfma_f32_16x16x32_bf16 a[112:115], v[68:71], v[160:163], a[112:115]
v_rcp_f32 v214, v214
v_mfma_f32_16x16x32_bf16 a[116:119], v[64:67], v[148:151], 0
ds_read_b128 v[56:59], v2 offset:43008
v_mul_f32 v215, v215, v214
v_mfma_f32_16x16x32_bf16 a[116:119], v[68:71], v[164:167], a[116:119]
v_cvt_pk_bf16_f32 v205, v213, v215
v_mfma_f32_16x16x32_bf16 a[120:123], v[64:67], v[152:155], 0
buffer_load_dwordx4 a[80:83], v2, s[8:11], s27 offen offset:1024 sc1
v_mfma_f32_16x16x32_bf16 a[120:123], v[68:71], v[168:171], a[120:123]
ds_read_b128 v[60:63], v2 offset:44032
v_mul_f32 v208, v112, v112
v_mfma_f32_16x16x32_bf16 a[124:127], v[64:67], v[156:159], 0
v_mul_f32 v210, v113, v113
v_fma_f32 v208, v208, v233, v232
v_mfma_f32_16x16x32_bf16 a[124:127], v[68:71], v[172:175], a[124:127]
v_fma_f32 v210, v210, v233, v232
s_waitcnt lgkmcnt(4)
v_mfma_f32_16x16x32_bf16 a[128:131], v[72:75], v[144:147], 0
buffer_load_dwordx4 a[84:87], v4, s[8:11], s27 offen offset:1024 sc1
v_mfma_f32_16x16x32_bf16 a[128:131], v[76:79], v[160:163], a[128:131]
v_mul_f32 v208, v208, v112
v_mul_f32 v210, v210, v113
v_mfma_f32_16x16x32_bf16 a[132:135], v[72:75], v[148:151], 0
ds_read_b128 v[64:67], v2 offset:45056
v_mul_f32 v209, v112, v128
v_mfma_f32_16x16x32_bf16 a[132:135], v[76:79], v[164:167], a[132:135]
v_exp_f32 v208, v208
v_mfma_f32_16x16x32_bf16 a[136:139], v[72:75], v[152:155], 0
buffer_load_dwordx4 a[88:91], v5, s[8:11], s27 offen offset:1024 sc1
v_mfma_f32_16x16x32_bf16 a[136:139], v[76:79], v[168:171], a[136:139]
ds_read_b128 v[68:71], v2 offset:46080
v_mul_f32 v211, v113, v129
v_mfma_f32_16x16x32_bf16 a[140:143], v[72:75], v[156:159], 0
v_exp_f32 v210, v210
v_mfma_f32_16x16x32_bf16 a[140:143], v[76:79], v[172:175], a[140:143]
v_fma_f32 v208, v208, v234, v234
s_waitcnt lgkmcnt(4)
v_mfma_f32_16x16x32_bf16 a[144:147], v[48:51], v[144:147], 0
buffer_load_dwordx4 a[92:95], v6, s[8:11], s27 offen offset:1024 sc1
v_mfma_f32_16x16x32_bf16 a[144:147], v[52:55], v[160:163], a[144:147]
v_fma_f32 v210, v210, v234, v234
v_mul_f32 v212, v114, v114
v_mfma_f32_16x16x32_bf16 a[148:151], v[48:51], v[148:151], 0
ds_read_b128 v[72:75], v2 offset:47104
v_mul_f32 v214, v115, v115
v_mfma_f32_16x16x32_bf16 a[148:151], v[52:55], v[164:167], a[148:151]
v_rcp_f32 v208, v208
v_mfma_f32_16x16x32_bf16 a[152:155], v[48:51], v[152:155], 0
v_rcp_f32 v210, v210
v_mfma_f32_16x16x32_bf16 a[152:155], v[52:55], v[168:171], a[152:155]
ds_read_b128 v[76:79], v2 offset:48128
v_mul_f32 v209, v209, v208
v_mfma_f32_16x16x32_bf16 a[156:159], v[48:51], v[156:159], 0
v_mul_f32 v211, v211, v210
v_cvt_pk_bf16_f32 v194, v209, v211
v_mfma_f32_16x16x32_bf16 a[156:159], v[52:55], v[172:175], a[156:159]
v_fma_f32 v212, v212, v233, v232
s_waitcnt lgkmcnt(4)
v_mfma_f32_16x16x32_bf16 a[160:163], v[56:59], v[144:147], 0
s_waitcnt vmcnt(49)
buffer_load_dwordx2 a[96:97], v244, s[8:11], s28 offen offset:0 sc1
v_mfma_f32_16x16x32_bf16 a[160:163], v[60:63], v[160:163], a[160:163]
s_barrier
v_mfma_f32_16x16x32_bf16 a[164:167], v[56:59], v[148:151], 0
ds_read_b128 v[48:51], v2 offset:49152
v_fma_f32 v214, v214, v233, v232
v_mfma_f32_16x16x32_bf16 a[164:167], v[60:63], v[164:167], a[164:167]
v_mul_f32 v212, v212, v114
v_mul_f32 v214, v214, v115
v_mfma_f32_16x16x32_bf16 a[168:171], v[56:59], v[152:155], 0
buffer_load_dwordx2 a[98:99], v244, s[8:11], s28 offen offset:512 sc1
v_mfma_f32_16x16x32_bf16 a[168:171], v[60:63], v[168:171], a[168:171]
ds_read_b128 v[52:55], v2 offset:50176
v_mul_f32 v213, v114, v130
v_mfma_f32_16x16x32_bf16 a[172:175], v[56:59], v[156:159], 0
v_exp_f32 v212, v212
v_mfma_f32_16x16x32_bf16 a[172:175], v[60:63], v[172:175], a[172:175]
v_mul_f32 v215, v115, v131
s_waitcnt lgkmcnt(4)
v_mfma_f32_16x16x32_bf16 a[176:179], v[64:67], v[144:147], 0
buffer_load_dwordx2 a[100:101], v245, s[8:11], s28 offen offset:0 sc1
v_mfma_f32_16x16x32_bf16 a[176:179], v[68:71], v[160:163], a[176:179]
v_exp_f32 v214, v214
v_mfma_f32_16x16x32_bf16 a[180:183], v[64:67], v[148:151], 0
ds_read_b128 v[56:59], v2 offset:51200
v_fma_f32 v212, v212, v234, v234
v_mfma_f32_16x16x32_bf16 a[180:183], v[68:71], v[164:167], a[180:183]
v_fma_f32 v214, v214, v234, v234
v_mul_f32 v208, v116, v116
v_mfma_f32_16x16x32_bf16 a[184:187], v[64:67], v[152:155], 0
buffer_load_dwordx2 a[102:103], v245, s[8:11], s28 offen offset:512 sc1
v_mfma_f32_16x16x32_bf16 a[184:187], v[68:71], v[168:171], a[184:187]
ds_read_b128 v[60:63], v2 offset:52224
v_mul_f32 v210, v117, v117
v_mfma_f32_16x16x32_bf16 a[188:191], v[64:67], v[156:159], 0
v_rcp_f32 v212, v212
v_mfma_f32_16x16x32_bf16 a[188:191], v[68:71], v[172:175], a[188:191]
v_mul_f32 v213, v213, v212
s_waitcnt lgkmcnt(4)
v_mfma_f32_16x16x32_bf16 a[192:195], v[72:75], v[144:147], 0
buffer_load_dwordx2 a[104:105], v246, s[8:11], s28 offen offset:0 sc1
v_mfma_f32_16x16x32_bf16 a[192:195], v[76:79], v[160:163], a[192:195]
v_rcp_f32 v214, v214
v_mfma_f32_16x16x32_bf16 a[196:199], v[72:75], v[148:151], 0
ds_read_b128 v[64:67], v2 offset:53248
v_mul_f32 v215, v215, v214
v_mfma_f32_16x16x32_bf16 a[196:199], v[76:79], v[164:167], a[196:199]
v_cvt_pk_bf16_f32 v195, v213, v215
v_fma_f32 v208, v208, v236, v235
v_mfma_f32_16x16x32_bf16 a[200:203], v[72:75], v[152:155], 0
buffer_load_dwordx2 a[106:107], v246, s[8:11], s28 offen offset:512 sc1
v_mfma_f32_16x16x32_bf16 a[200:203], v[76:79], v[168:171], a[200:203]
ds_read_b128 v[68:71], v2 offset:54272
v_fma_f32 v210, v210, v236, v235
v_mfma_f32_16x16x32_bf16 a[204:207], v[72:75], v[156:159], 0
buffer_store_dwordx4 v[192:195], v2, s[8:11], s24 offen offset:3072 sc1
v_mfma_f32_16x16x32_bf16 a[204:207], v[76:79], v[172:175], a[204:207]
v_mul_f32 v208, v208, v116
s_waitcnt lgkmcnt(4)
v_mfma_f32_16x16x32_bf16 a[208:211], v[48:51], v[144:147], 0
v_mul_f32 v210, v210, v117
v_mul_f32 v209, v116, v132
v_mfma_f32_16x16x32_bf16 a[208:211], v[52:55], v[160:163], a[208:211]
v_exp_f32 v208, v208
v_mfma_f32_16x16x32_bf16 a[212:215], v[48:51], v[148:151], 0
ds_read_b128 v[72:75], v2 offset:55296
v_mul_f32 v211, v117, v133
v_mfma_f32_16x16x32_bf16 a[212:215], v[52:55], v[164:167], a[212:215]
buffer_load_dwordx2 a[108:109], v247, s[8:11], s28 offen offset:0 sc1
v_mfma_f32_16x16x32_bf16 a[216:219], v[48:51], v[152:155], 0
v_exp_f32 v210, v210
v_mfma_f32_16x16x32_bf16 a[216:219], v[52:55], v[168:171], a[216:219]
ds_read_b128 v[76:79], v2 offset:56320
v_fma_f32 v208, v208, v237, v237
v_mfma_f32_16x16x32_bf16 a[220:223], v[48:51], v[156:159], 0
v_fma_f32 v210, v210, v237, v237
v_mul_f32 v212, v118, v118
v_mfma_f32_16x16x32_bf16 a[220:223], v[52:55], v[172:175], a[220:223]
v_mul_f32 v214, v119, v119
s_waitcnt lgkmcnt(4)
v_mfma_f32_16x16x32_bf16 a[224:227], v[56:59], v[144:147], 0
buffer_load_dwordx2 a[110:111], v247, s[8:11], s28 offen offset:512 sc1
v_mfma_f32_16x16x32_bf16 a[224:227], v[60:63], v[160:163], a[224:227]
s_add_u32 m0, s22, 0
v_add_u32 v3, 20480, v3
v_mfma_f32_16x16x32_bf16 a[228:231], v[56:59], v[148:151], 0
ds_read_b128 v[48:51], v2 offset:57344
v_fma_f32 v212, v212, v236, v235
v_mfma_f32_16x16x32_bf16 a[228:231], v[60:63], v[164:167], a[228:231]
v_rcp_f32 v208, v208
v_mfma_f32_16x16x32_bf16 a[232:235], v[56:59], v[152:155], 0
buffer_load_dwordx4 v3, s[8:11], 0 offen offset:0 sc1 lds
v_mfma_f32_16x16x32_bf16 a[232:235], v[60:63], v[168:171], a[232:235]
ds_read_b128 v[52:55], v2 offset:58368
v_mul_f32 v209, v209, v208
v_mfma_f32_16x16x32_bf16 a[236:239], v[56:59], v[156:159], 0
v_rcp_f32 v210, v210
v_mfma_f32_16x16x32_bf16 a[236:239], v[60:63], v[172:175], a[236:239]
v_mul_f32 v211, v211, v210
s_waitcnt lgkmcnt(4)
v_mfma_f32_16x16x32_bf16 a[240:243], v[64:67], v[144:147], 0
buffer_load_dwordx4 v3, s[8:11], 0 offen offset:1024 sc1 lds
v_mfma_f32_16x16x32_bf16 a[240:243], v[68:71], v[160:163], a[240:243]
v_cvt_pk_bf16_f32 v198, v209, v211
v_fma_f32 v214, v214, v236, v235
v_mfma_f32_16x16x32_bf16 a[244:247], v[64:67], v[148:151], 0
ds_read_b128 v[56:59], v2 offset:59392
v_mul_f32 v212, v212, v118
v_mfma_f32_16x16x32_bf16 a[244:247], v[68:71], v[164:167], a[244:247]
v_mul_f32 v214, v214, v119
v_mul_f32 v213, v118, v134
v_mfma_f32_16x16x32_bf16 a[248:251], v[64:67], v[152:155], 0
buffer_load_dwordx4 v3, s[8:11], 0 offen offset:2048 sc1 lds
v_mfma_f32_16x16x32_bf16 a[248:251], v[68:71], v[168:171], a[248:251]
ds_read_b128 v[60:63], v2 offset:60416
v_mul_f32 v215, v119, v135
v_mfma_f32_16x16x32_bf16 a[252:255], v[64:67], v[156:159], 0
v_exp_f32 v212, v212
v_mfma_f32_16x16x32_bf16 a[252:255], v[68:71], v[172:175], a[252:255]
v_fma_f32 v212, v212, v237, v237
s_waitcnt vmcnt(39)
s_waitcnt lgkmcnt(4)
v_mfma_f32_16x16x32_bf16 a[112:115], v[72:75], v[176:179], a[112:115]
buffer_load_dwordx4 v3, s[8:11], 0 offen offset:3072 sc1 lds
v_mfma_f32_16x16x32_bf16 a[112:115], v[76:79], a[0:3], a[112:115]
s_add_u32 m0, s22, 4096
v_add_u32 v3, 4096, v3
v_mfma_f32_16x16x32_bf16 a[116:119], v[72:75], v[180:183], a[116:119]
ds_read_b128 v[64:67], v2 offset:61440
v_mul_f32 v208, v120, v120
v_mfma_f32_16x16x32_bf16 a[116:119], v[76:79], a[4:7], a[116:119]
v_exp_f32 v214, v214
v_mfma_f32_16x16x32_bf16 a[120:123], v[72:75], v[184:187], a[120:123]
buffer_load_dwordx4 v3, s[8:11], 0 offen offset:0 sc1 lds
v_mfma_f32_16x16x32_bf16 a[120:123], v[76:79], a[8:11], a[120:123]
ds_read_b128 v[68:71], v2 offset:62464
v_fma_f32 v214, v214, v237, v237
v_mfma_f32_16x16x32_bf16 a[124:127], v[72:75], v[188:191], a[124:127]
v_rcp_f32 v212, v212
v_mfma_f32_16x16x32_bf16 a[124:127], v[76:79], a[12:15], a[124:127]
v_mul_f32 v213, v213, v212
s_waitcnt lgkmcnt(4)
v_mfma_f32_16x16x32_bf16 a[128:131], v[48:51], v[176:179], a[128:131]
buffer_load_dwordx4 v3, s[8:11], 0 offen offset:1024 sc1 lds
v_mfma_f32_16x16x32_bf16 a[128:131], v[52:55], a[0:3], a[128:131]
s_add_u32 s23, s34, 131072
v_mul_f32 v210, v121, v121
v_mfma_f32_16x16x32_bf16 a[132:135], v[48:51], v[180:183], a[132:135]
ds_read_b128 v[72:75], v2 offset:63488
v_fma_f32 v208, v208, v239, v238
v_mfma_f32_16x16x32_bf16 a[132:135], v[52:55], a[4:7], a[132:135]
v_rcp_f32 v214, v214
v_mfma_f32_16x16x32_bf16 a[136:139], v[48:51], v[184:187], a[136:139]
buffer_load_dwordx2 v[14:15], v11, s[8:11], s23 offen sc1
v_mfma_f32_16x16x32_bf16 a[136:139], v[52:55], a[8:11], a[136:139]
ds_read_b128 v[76:79], v2 offset:64512
v_mul_f32 v215, v215, v214
v_mfma_f32_16x16x32_bf16 a[140:143], v[48:51], v[188:191], a[140:143]
v_cvt_pk_bf16_f32 v199, v213, v215
v_fma_f32 v210, v210, v239, v238
v_mfma_f32_16x16x32_bf16 a[140:143], v[52:55], a[12:15], a[140:143]
v_mul_f32 v208, v208, v120
s_waitcnt lgkmcnt(4)
v_mfma_f32_16x16x32_bf16 a[144:147], v[56:59], v[176:179], a[144:147]
buffer_load_dwordx2 v[16:17], v244, s[8:11], s29 offen offset:0 sc1
v_mfma_f32_16x16x32_bf16 a[144:147], v[60:63], a[0:3], a[144:147]
v_mul_f32 v210, v210, v121
v_mul_f32 v209, v120, v136
v_mfma_f32_16x16x32_bf16 a[148:151], v[56:59], v[180:183], a[148:151]
ds_read_b128 v[48:51], v7 offset:0
v_mul_f32 v211, v121, v137
v_mfma_f32_16x16x32_bf16 a[148:151], v[60:63], a[4:7], a[148:151]
buffer_store_dwordx4 v[196:199], v4, s[8:11], s24 offen offset:3072 sc1
v_mfma_f32_16x16x32_bf16 a[152:155], v[56:59], v[184:187], a[152:155]
v_exp_f32 v208, v208
v_mfma_f32_16x16x32_bf16 a[152:155], v[60:63], a[8:11], a[152:155]
ds_read_b128 v[52:55], v7 offset:1024
v_fma_f32 v208, v208, v240, v240
v_mfma_f32_16x16x32_bf16 a[156:159], v[56:59], v[188:191], a[156:159]
v_exp_f32 v210, v210
v_mfma_f32_16x16x32_bf16 a[156:159], v[60:63], a[12:15], a[156:159]
v_fma_f32 v210, v210, v240, v240
s_waitcnt lgkmcnt(4)
v_mfma_f32_16x16x32_bf16 a[160:163], v[64:67], v[176:179], a[160:163]
buffer_load_dwordx2 v[18:19], v244, s[8:11], s29 offen offset:512 sc1
v_mfma_f32_16x16x32_bf16 a[160:163], v[68:71], a[0:3], a[160:163]
v_rcp_f32 v208, v208
v_mfma_f32_16x16x32_bf16 a[164:167], v[64:67], v[180:183], a[164:167]
ds_read_b128 v[56:59], v7 offset:2048
v_mul_f32 v209, v209, v208
v_mfma_f32_16x16x32_bf16 a[164:167], v[68:71], a[4:7], a[164:167]
v_rcp_f32 v210, v210
v_mfma_f32_16x16x32_bf16 a[168:171], v[64:67], v[184:187], a[168:171]
buffer_load_dwordx2 v[20:21], v245, s[8:11], s29 offen offset:0 sc1
v_mfma_f32_16x16x32_bf16 a[168:171], v[68:71], a[8:11], a[168:171]
ds_read_b128 v[60:63], v7 offset:3072
v_mul_f32 v211, v211, v210
v_mfma_f32_16x16x32_bf16 a[172:175], v[64:67], v[188:191], a[172:175]
v_cvt_pk_bf16_f32 v202, v209, v211
v_mul_f32 v212, v122, v122
v_mfma_f32_16x16x32_bf16 a[172:175], v[68:71], a[12:15], a[172:175]
v_mul_f32 v214, v123, v123
s_waitcnt lgkmcnt(4)
v_mfma_f32_16x16x32_bf16 a[176:179], v[72:75], v[176:179], a[176:179]
buffer_load_dwordx2 v[22:23], v245, s[8:11], s29 offen offset:512 sc1
v_mfma_f32_16x16x32_bf16 a[176:179], v[76:79], a[0:3], a[176:179]
v_fma_f32 v212, v212, v239, v238
v_fma_f32 v214, v214, v239, v238
v_mfma_f32_16x16x32_bf16 a[180:183], v[72:75], v[180:183], a[180:183]
ds_read_b128 v[64:67], v7 offset:4096
v_mul_f32 v212, v212, v122
v_mfma_f32_16x16x32_bf16 a[180:183], v[76:79], a[4:7], a[180:183]
v_mul_f32 v214, v214, v123
v_mul_f32 v213, v122, v138
v_mfma_f32_16x16x32_bf16 a[184:187], v[72:75], v[184:187], a[184:187]
buffer_load_dwordx2 v[24:25], v246, s[8:11], s29 offen offset:0 sc1
v_mfma_f32_16x16x32_bf16 a[184:187], v[76:79], a[8:11], a[184:187]
ds_read_b128 v[68:71], v7 offset:5120
v_mul_f32 v215, v123, v139
v_mfma_f32_16x16x32_bf16 a[188:191], v[72:75], v[188:191], a[188:191]
v_exp_f32 v212, v212
v_mfma_f32_16x16x32_bf16 a[188:191], v[76:79], a[12:15], a[188:191]
v_fma_f32 v212, v212, v240, v240
s_waitcnt lgkmcnt(4)
v_mfma_f32_16x16x32_bf16 a[192:195], v[48:51], v[176:179], a[192:195]
buffer_load_dwordx2 v[26:27], v246, s[8:11], s29 offen offset:512 sc1
v_mfma_f32_16x16x32_bf16 a[192:195], v[52:55], a[0:3], a[192:195]
v_exp_f32 v214, v214
v_mfma_f32_16x16x32_bf16 a[196:199], v[48:51], v[180:183], a[196:199]
ds_read_b128 v[72:75], v7 offset:6144
v_fma_f32 v214, v214, v240, v240
v_mfma_f32_16x16x32_bf16 a[196:199], v[52:55], a[4:7], a[196:199]
v_rcp_f32 v212, v212
v_mfma_f32_16x16x32_bf16 a[200:203], v[48:51], v[184:187], a[200:203]
buffer_load_dwordx2 v[28:29], v247, s[8:11], s29 offen offset:0 sc1
v_mfma_f32_16x16x32_bf16 a[200:203], v[52:55], a[8:11], a[200:203]
ds_read_b128 v[76:79], v7 offset:7168
v_mul_f32 v213, v213, v212
v_mfma_f32_16x16x32_bf16 a[204:207], v[48:51], v[188:191], a[204:207]
v_rcp_f32 v214, v214
v_mfma_f32_16x16x32_bf16 a[204:207], v[52:55], a[12:15], a[204:207]
v_mul_f32 v215, v215, v214
s_waitcnt lgkmcnt(4)
v_mfma_f32_16x16x32_bf16 a[208:211], v[56:59], v[176:179], a[208:211]
s_waitcnt vmcnt(63)
v_cvt_pk_bf16_f32 v203, v213, v215
v_mfma_f32_16x16x32_bf16 a[208:211], v[60:63], a[0:3], a[208:211]
s_barrier
v_mfma_f32_16x16x32_bf16 a[212:215], v[56:59], v[180:183], a[212:215]
ds_read_b128 v[48:51], v7 offset:8192
v_mul_f32 v208, v124, v124
v_mfma_f32_16x16x32_bf16 a[212:215], v[60:63], a[4:7], a[212:215]
buffer_load_dwordx2 v[30:31], v247, s[8:11], s29 offen offset:512 sc1
v_mfma_f32_16x16x32_bf16 a[216:219], v[56:59], v[184:187], a[216:219]
s_add_u32 m0, s22, 24576
v_add_u32 v3, 20480, v3
v_mfma_f32_16x16x32_bf16 a[216:219], v[60:63], a[8:11], a[216:219]
ds_read_b128 v[52:55], v7 offset:9216
v_mul_f32 v210, v125, v125
v_mfma_f32_16x16x32_bf16 a[220:223], v[56:59], v[188:191], a[220:223]
buffer_store_dwordx4 v[200:203], v5, s[8:11], s24 offen offset:3072 sc1
v_mfma_f32_16x16x32_bf16 a[220:223], v[60:63], a[12:15], a[220:223]
v_fma_f32 v208, v208, v242, v241
s_waitcnt lgkmcnt(4)
v_mfma_f32_16x16x32_bf16 a[224:227], v[64:67], v[176:179], a[224:227]
v_fma_f32 v210, v210, v242, v241
v_mul_f32 v208, v208, v124
v_mfma_f32_16x16x32_bf16 a[224:227], v[68:71], a[0:3], a[224:227]
v_mul_f32 v210, v210, v125
v_mul_f32 v209, v124, v140
v_mfma_f32_16x16x32_bf16 a[228:231], v[64:67], v[180:183], a[228:231]
ds_read_b128 v[56:59], v7 offset:10240
v_mul_f32 v211, v125, v141
v_mfma_f32_16x16x32_bf16 a[228:231], v[68:71], a[4:7], a[228:231]
buffer_load_dwordx4 v3, s[8:11], 0 offen offset:0 sc1 lds
v_mfma_f32_16x16x32_bf16 a[232:235], v[64:67], v[184:187], a[232:235]
v_exp_f32 v208, v208
v_mfma_f32_16x16x32_bf16 a[232:235], v[68:71], a[8:11], a[232:235]
ds_read_b128 v[60:63], v7 offset:11264
v_exp_f32 v210, v210
v_mfma_f32_16x16x32_bf16 a[236:239], v[64:67], v[188:191], a[236:239]
v_fma_f32 v208, v208, v243, v243
v_fma_f32 v210, v210, v243, v243
v_mfma_f32_16x16x32_bf16 a[236:239], v[68:71], a[12:15], a[236:239]
v_rcp_f32 v208, v208
s_waitcnt lgkmcnt(4)
v_mfma_f32_16x16x32_bf16 a[240:243], v[72:75], v[176:179], a[240:243]
buffer_load_dwordx4 v3, s[8:11], 0 offen offset:1024 sc1 lds
v_rcp_f32 v210, v210
v_mfma_f32_16x16x32_bf16 a[240:243], v[76:79], a[0:3], a[240:243]
v_mul_f32 v209, v209, v208
v_mul_f32 v211, v211, v210
v_mfma_f32_16x16x32_bf16 a[244:247], v[72:75], v[180:183], a[244:247]
ds_read_b128 v[64:67], v7 offset:12288
v_cvt_pk_bf16_f32 v206, v209, v211
v_mfma_f32_16x16x32_bf16 a[244:247], v[76:79], a[4:7], a[244:247]
v_mul_f32 v212, v126, v126
v_mul_f32 v214, v127, v127
v_mfma_f32_16x16x32_bf16 a[248:251], v[72:75], v[184:187], a[248:251]
buffer_load_dwordx4 v3, s[8:11], 0 offen offset:2048 sc1 lds
v_fma_f32 v212, v212, v242, v241
v_mfma_f32_16x16x32_bf16 a[248:251], v[76:79], a[8:11], a[248:251]
ds_read_b128 v[68:71], v7 offset:13312
v_fma_f32 v214, v214, v242, v241
v_mfma_f32_16x16x32_bf16 a[252:255], v[72:75], v[188:191], a[252:255]
v_mul_f32 v212, v212, v126
v_mul_f32 v214, v214, v127
v_mfma_f32_16x16x32_bf16 a[252:255], v[76:79], a[12:15], a[252:255]
v_exp_f32 v212, v212
s_waitcnt vmcnt(47)
s_waitcnt lgkmcnt(4)
v_mfma_f32_16x16x32_bf16 a[112:115], v[48:51], a[16:19], a[112:115]
buffer_load_dwordx4 v3, s[8:11], 0 offen offset:3072 sc1 lds
v_exp_f32 v214, v214
v_mfma_f32_16x16x32_bf16 a[112:115], v[52:55], a[32:35], a[112:115]
s_add_u32 m0, s22, 28672
v_add_u32 v3, 4096, v3
v_mul_f32 v213, v126, v142
v_mfma_f32_16x16x32_bf16 a[116:119], v[48:51], a[20:23], a[116:119]
ds_read_b128 v[72:75], v7 offset:14336
v_mul_f32 v215, v127, v143
v_mfma_f32_16x16x32_bf16 a[116:119], v[52:55], a[36:39], a[116:119]
v_fma_f32 v212, v212, v243, v243
v_fma_f32 v214, v214, v243, v243
v_mfma_f32_16x16x32_bf16 a[120:123], v[48:51], a[24:27], a[120:123]
buffer_load_dwordx4 v3, s[8:11], 0 offen offset:0 sc1 lds
v_rcp_f32 v212, v212
v_mfma_f32_16x16x32_bf16 a[120:123], v[52:55], a[40:43], a[120:123]
ds_read_b128 v[76:79], v7 offset:15360
v_rcp_f32 v214, v214
v_mfma_f32_16x16x32_bf16 a[124:127], v[48:51], a[28:31], a[124:127]
v_mul_f32 v213, v213, v212
v_mul_f32 v215, v215, v214
v_mfma_f32_16x16x32_bf16 a[124:127], v[52:55], a[44:47], a[124:127]
v_cvt_pk_bf16_f32 v207, v213, v215
buffer_store_dwordx4 v[204:207], v6, s[8:11], s24 offen offset:3072 sc1
s_waitcnt lgkmcnt(4)
v_mfma_f32_16x16x32_bf16 a[128:131], v[56:59], a[16:19], a[128:131]
buffer_load_dwordx4 v3, s[8:11], 0 offen offset:1024 sc1 lds
v_mfma_f32_16x16x32_bf16 a[128:131], v[60:63], a[32:35], a[128:131]
s_waitcnt vmcnt(17)
v_cmp_eq_u64 vcc, s[68:69], v[14:15]
s_nop 0
s_cmp_eq_u64 vcc, exec
s_cbranch_scc0 L_f_slow2
L_f_back2:
v_mfma_f32_16x16x32_bf16 a[132:135], v[56:59], a[20:23], a[132:135]
ds_read_b128 v[48:51], v7 offset:16384
v_mfma_f32_16x16x32_bf16 a[132:135], v[60:63], a[36:39], a[132:135]
v_mfma_f32_16x16x32_bf16 a[136:139], v[56:59], a[24:27], a[136:139]
buffer_load_dwordx4 v[32:35], v2, s[8:11], s25 offen offset:2048 sc1
v_mfma_f32_16x16x32_bf16 a[136:139], v[60:63], a[40:43], a[136:139]
ds_read_b128 v[52:55], v7 offset:17408
v_mfma_f32_16x16x32_bf16 a[140:143], v[56:59], a[28:31], a[140:143]
v_mfma_f32_16x16x32_bf16 a[140:143], v[60:63], a[44:47], a[140:143]
s_waitcnt lgkmcnt(4)
v_mfma_f32_16x16x32_bf16 a[144:147], v[64:67], a[16:19], a[144:147]
buffer_load_dwordx4 v[36:39], v4, s[8:11], s25 offen offset:2048 sc1
v_mfma_f32_16x16x32_bf16 a[144:147], v[68:71], a[32:35], a[144:147]
v_mfma_f32_16x16x32_bf16 a[148:151], v[64:67], a[20:23], a[148:151]
ds_read_b128 v[56:59], v7 offset:18432
v_mfma_f32_16x16x32_bf16 a[148:151], v[68:71], a[36:39], a[148:151]
v_mfma_f32_16x16x32_bf16 a[152:155], v[64:67], a[24:27], a[152:155]
buffer_load_dwordx4 v[40:43], v5, s[8:11], s25 offen offset:2048 sc1
v_mfma_f32_16x16x32_bf16 a[152:155], v[68:71], a[40:43], a[152:155]
ds_read_b128 v[60:63], v7 offset:19456
v_mfma_f32_16x16x32_bf16 a[156:159], v[64:67], a[28:31], a[156:159]
v_mfma_f32_16x16x32_bf16 a[156:159], v[68:71], a[44:47], a[156:159]
s_waitcnt lgkmcnt(4)
v_mfma_f32_16x16x32_bf16 a[160:163], v[72:75], a[16:19], a[160:163]
buffer_load_dwordx4 v[44:47], v6, s[8:11], s25 offen offset:2048 sc1
v_mfma_f32_16x16x32_bf16 a[160:163], v[76:79], a[32:35], a[160:163]
v_mfma_f32_16x16x32_bf16 a[164:167], v[72:75], a[20:23], a[164:167]
ds_read_b128 v[64:67], v7 offset:20480
v_mfma_f32_16x16x32_bf16 a[164:167], v[76:79], a[36:39], a[164:167]
v_mfma_f32_16x16x32_bf16 a[168:171], v[72:75], a[24:27], a[168:171]
buffer_load_dwordx4 v[80:83], v2, s[8:11], s26 offen offset:2048 sc1
v_mfma_f32_16x16x32_bf16 a[168:171], v[76:79], a[40:43], a[168:171]
ds_read_b128 v[68:71], v7 offset:21504
v_mfma_f32_16x16x32_bf16 a[172:175], v[72:75], a[28:31], a[172:175]
v_mfma_f32_16x16x32_bf16 a[172:175], v[76:79], a[44:47], a[172:175]
s_waitcnt lgkmcnt(4)
v_mfma_f32_16x16x32_bf16 a[176:179], v[48:51], a[16:19], a[176:179]
buffer_load_dwordx4 v[84:87], v4, s[8:11], s26 offen offset:2048 sc1
v_mfma_f32_16x16x32_bf16 a[176:179], v[52:55], a[32:35], a[176:179]
v_mfma_f32_16x16x32_bf16 a[180:183], v[48:51], a[20:23], a[180:183]
ds_read_b128 v[72:75], v7 offset:22528
v_mfma_f32_16x16x32_bf16 a[180:183], v[52:55], a[36:39], a[180:183]
v_mfma_f32_16x16x32_bf16 a[184:187], v[48:51], a[24:27], a[184:187]
buffer_load_dwordx4 v[88:91], v5, s[8:11], s26 offen offset:2048 sc1
v_mfma_f32_16x16x32_bf16 a[184:187], v[52:55], a[40:43], a[184:187]
ds_read_b128 v[76:79], v7 offset:23552
v_mfma_f32_16x16x32_bf16 a[188:191], v[48:51], a[28:31], a[188:191]
v_mfma_f32_16x16x32_bf16 a[188:191], v[52:55], a[44:47], a[188:191]
s_waitcnt lgkmcnt(4)
v_mfma_f32_16x16x32_bf16 a[192:195], v[56:59], a[16:19], a[192:195]
buffer_load_dwordx4 v[92:95], v6, s[8:11], s26 offen offset:2048 sc1
v_mfma_f32_16x16x32_bf16 a[192:195], v[60:63], a[32:35], a[192:195]
v_mfma_f32_16x16x32_bf16 a[196:199], v[56:59], a[20:23], a[196:199]
ds_read_b128 v[48:51], v7 offset:24576
v_mfma_f32_16x16x32_bf16 a[196:199], v[60:63], a[36:39], a[196:199]
v_mfma_f32_16x16x32_bf16 a[200:203], v[56:59], a[24:27], a[200:203]
buffer_load_dwordx4 v[96:99], v2, s[8:11], s27 offen offset:2048 sc1
v_mfma_f32_16x16x32_bf16 a[200:203], v[60:63], a[40:43], a[200:203]
ds_read_b128 v[52:55], v7 offset:25600
v_mfma_f32_16x16x32_bf16 a[204:207], v[56:59], a[28:31], a[204:207]
v_mfma_f32_16x16x32_bf16 a[204:207], v[60:63], a[44:47], a[204:207]
s_waitcnt lgkmcnt(4)
v_mfma_f32_16x16x32_bf16 a[208:211], v[64:67], a[16:19], a[208:211]
buffer_load_dwordx4 v[100:103], v4, s[8:11], s27 offen offset:2048 sc1
v_mfma_f32_16x16x32_bf16 a[208:211], v[68:71], a[32:35], a[208:211]
v_mfma_f32_16x16x32_bf16 a[212:215], v[64:67], a[20:23], a[212:215]
ds_read_b128 v[56:59], v7 offset:26624
v_mfma_f32_16x16x32_bf16 a[212:215], v[68:71], a[36:39], a[212:215]
v_mfma_f32_16x16x32_bf16 a[216:219], v[64:67], a[24:27], a[216:219]
buffer_load_dwordx4 v[104:107], v5, s[8:11], s27 offen offset:2048 sc1
v_mfma_f32_16x16x32_bf16 a[216:219], v[68:71], a[40:43], a[216:219]
ds_read_b128 v[60:63], v7 offset:27648
v_mfma_f32_16x16x32_bf16 a[220:223], v[64:67], a[28:31], a[220:223]
v_mfma_f32_16x16x32_bf16 a[220:223], v[68:71], a[44:47], a[220:223]
s_waitcnt lgkmcnt(4)
v_mfma_f32_16x16x32_bf16 a[224:227], v[72:75], a[16:19], a[224:227]
buffer_load_dwordx4 v[108:111], v6, s[8:11], s27 offen offset:2048 sc1
v_mfma_f32_16x16x32_bf16 a[224:227], v[76:79], a[32:35], a[224:227]
v_mov_b32 v12, s68
v_mov_b32 v13, s69
v_mfma_f32_16x16x32_bf16 a[228:231], v[72:75], a[20:23], a[228:231]
ds_read_b128 v[64:67], v7 offset:28672
s_add_u32 s53, s34, 262144
v_mfma_f32_16x16x32_bf16 a[228:231], v[76:79], a[36:39], a[228:231]
s_waitcnt vmcnt(13)
v_mfma_f32_16x16x32_bf16 a[232:235], v[72:75], a[24:27], a[232:235]
buffer_store_dwordx2 v[12:13], v10, s[8:11], s53 offen sc1
v_mfma_f32_16x16x32_bf16 a[232:235], v[76:79], a[40:43], a[232:235]
ds_read_b128 v[68:71], v7 offset:29696
v_mfma_f32_16x16x32_bf16 a[236:239], v[72:75], a[28:31], a[236:239]
v_mfma_f32_16x16x32_bf16 a[236:239], v[76:79], a[44:47], a[236:239]
s_waitcnt lgkmcnt(4)
v_mfma_f32_16x16x32_bf16 a[240:243], v[48:51], a[16:19], a[240:243]
s_mul_i32 s48, s7, 2146435072
s_lshl_b32 s49, s6, 2
v_mfma_f32_16x16x32_bf16 a[240:243], v[52:55], a[32:35], a[240:243]
s_add_u32 s49, s49, s4
s_mul_i32 s50, s49, 6144
v_mfma_f32_16x16x32_bf16 a[244:247], v[48:51], a[20:23], a[244:247]
ds_read_b128 v[72:75], v7 offset:30720
s_add_u32 s50, s50, s48
v_mfma_f32_16x16x32_bf16 a[244:247], v[52:55], a[36:39], a[244:247]
s_add_u32 s50, s50, 6557696
s_mul_i32 s49, s49, 5120
v_mfma_f32_16x16x32_bf16 a[248:251], v[48:51], a[24:27], a[248:251]
s_add_u32 s48, s48, s49
s_and_b32 s49, s5, 3
v_mfma_f32_16x16x32_bf16 a[248:251], v[52:55], a[40:43], a[248:251]
ds_read_b128 v[76:79], v7 offset:31744
s_mul_i32 s49, s49, 589824
v_mfma_f32_16x16x32_bf16 a[252:255], v[48:51], a[28:31], a[252:255]
s_add_u32 s48, s48, s49
s_add_u32 s48, s48, 4198400
buffer_load_dwordx4 v[248:251], v2, s[8:11], s48 offen offset:0
v_mfma_f32_16x16x32_bf16 a[252:255], v[52:55], a[44:47], a[252:255]
s_waitcnt vmcnt(51)
s_waitcnt lgkmcnt(4)
v_mfma_f32_16x16x32_bf16 a[112:115], v[56:59], a[48:51], a[112:115]
s_waitcnt vmcnt(63)
v_mfma_f32_16x16x32_bf16 a[112:115], v[60:63], a[64:67], a[112:115]
s_barrier
v_mfma_f32_16x16x32_bf16 a[116:119], v[56:59], a[52:55], a[116:119]
ds_read_b128 v[48:51], v7 offset:32768
v_mfma_f32_16x16x32_bf16 a[116:119], v[60:63], a[68:71], a[116:119]
buffer_load_dwordx4 v[248:251], v2, s[8:11], s48 offen offset:1024
v_mfma_f32_16x16x32_bf16 a[120:123], v[56:59], a[56:59], a[120:123]
v_mfma_f32_16x16x32_bf16 a[120:123], v[60:63], a[72:75], a[120:123]
ds_read_b128 v[52:55], v7 offset:33792
v_mfma_f32_16x16x32_bf16 a[124:127], v[56:59], a[60:63], a[124:127]
v_mfma_f32_16x16x32_bf16 a[124:127], v[60:63], a[76:79], a[124:127]
s_waitcnt lgkmcnt(4)
v_mfma_f32_16x16x32_bf16 a[128:131], v[64:67], a[48:51], a[128:131]
buffer_load_dwordx4 v[248:251], v2, s[8:11], s48 offen offset:2048
v_mfma_f32_16x16x32_bf16 a[128:131], v[68:71], a[64:67], a[128:131]
v_mfma_f32_16x16x32_bf16 a[132:135], v[64:67], a[52:55], a[132:135]
ds_read_b128 v[56:59], v7 offset:34816
v_mfma_f32_16x16x32_bf16 a[132:135], v[68:71], a[68:71], a[132:135]
v_mfma_f32_16x16x32_bf16 a[136:139], v[64:67], a[56:59], a[136:139]
buffer_load_dwordx4 v[248:251], v2, s[8:11], s48 offen offset:3072
v_mfma_f32_16x16x32_bf16 a[136:139], v[68:71], a[72:75], a[136:139]
ds_read_b128 v[60:63], v7 offset:35840
s_add_u32 s48, s48, 4096
v_mfma_f32_16x16x32_bf16 a[140:143], v[64:67], a[60:63], a[140:143]
v_mfma_f32_16x16x32_bf16 a[140:143], v[68:71], a[76:79], a[140:143]
s_waitcnt lgkmcnt(4)
v_mfma_f32_16x16x32_bf16 a[144:147], v[72:75], a[48:51], a[144:147]
buffer_load_dwordx4 v[248:251], v2, s[8:11], s48 offen offset:0
v_mfma_f32_16x16x32_bf16 a[144:147], v[76:79], a[64:67], a[144:147]
v_mfma_f32_16x16x32_bf16 a[148:151], v[72:75], a[52:55], a[148:151]
ds_read_b128 v[64:67], v7 offset:36864
v_mfma_f32_16x16x32_bf16 a[148:151], v[76:79], a[68:71], a[148:151]
v_mfma_f32_16x16x32_bf16 a[152:155], v[72:75], a[56:59], a[152:155]
buffer_load_dwordx4 v[248:251], v2, s[8:11], s50 offen offset:0
v_mfma_f32_16x16x32_bf16 a[152:155], v[76:79], a[72:75], a[152:155]
ds_read_b128 v[68:71], v7 offset:37888
v_mfma_f32_16x16x32_bf16 a[156:159], v[72:75], a[60:63], a[156:159]
v_mfma_f32_16x16x32_bf16 a[156:159], v[76:79], a[76:79], a[156:159]
s_waitcnt lgkmcnt(4)
v_mfma_f32_16x16x32_bf16 a[160:163], v[48:51], a[48:51], a[160:163]
buffer_load_dwordx4 v[248:251], v2, s[8:11], s50 offen offset:1024
v_mfma_f32_16x16x32_bf16 a[160:163], v[52:55], a[64:67], a[160:163]
v_mfma_f32_16x16x32_bf16 a[164:167], v[48:51], a[52:55], a[164:167]
ds_read_b128 v[72:75], v7 offset:38912
v_mfma_f32_16x16x32_bf16 a[164:167], v[52:55], a[68:71], a[164:167]
v_mfma_f32_16x16x32_bf16 a[168:171], v[48:51], a[56:59], a[168:171]
buffer_load_dwordx4 v[248:251], v2, s[8:11], s50 offen offset:2048
v_mfma_f32_16x16x32_bf16 a[168:171], v[52:55], a[72:75], a[168:171]
ds_read_b128 v[76:79], v7 offset:39936
v_mfma_f32_16x16x32_bf16 a[172:175], v[48:51], a[60:63], a[172:175]
v_mfma_f32_16x16x32_bf16 a[172:175], v[52:55], a[76:79], a[172:175]
s_waitcnt lgkmcnt(4)
v_mfma_f32_16x16x32_bf16 a[176:179], v[56:59], a[48:51], a[176:179]
buffer_load_dwordx4 v[248:251], v2, s[8:11], s50 offen offset:3072
v_mfma_f32_16x16x32_bf16 a[176:179], v[60:63], a[64:67], a[176:179]
s_add_u32 s50, s50, 4096
v_mfma_f32_16x16x32_bf16 a[180:183], v[56:59], a[52:55], a[180:183]
ds_read_b128 v[48:51], v7 offset:40960
v_mfma_f32_16x16x32_bf16 a[180:183], v[60:63], a[68:71], a[180:183]
v_mfma_f32_16x16x32_bf16 a[184:187], v[56:59], a[56:59], a[184:187]
buffer_load_dwordx4 v[248:251], v2, s[8:11], s50 offen offset:0
v_mfma_f32_16x16x32_bf16 a[184:187], v[60:63], a[72:75], a[184:187]
ds_read_b128 v[52:55], v7 offset:41984
v_mfma_f32_16x16x32_bf16 a[188:191], v[56:59], a[60:63], a[188:191]
v_mfma_f32_16x16x32_bf16 a[188:191], v[60:63], a[76:79], a[188:191]
s_waitcnt lgkmcnt(4)
v_mfma_f32_16x16x32_bf16 a[192:195], v[64:67], a[48:51], a[192:195]
buffer_load_dwordx4 v[248:251], v2, s[8:11], s50 offen offset:1024
v_mfma_f32_16x16x32_bf16 a[192:195], v[68:71], a[64:67], a[192:195]
s_add_u32 m0, s22, 49152
v_add_u32 v3, 20480, v3
v_mfma_f32_16x16x32_bf16 a[196:199], v[64:67], a[52:55], a[196:199]
ds_read_b128 v[56:59], v7 offset:43008
v_mfma_f32_16x16x32_bf16 a[196:199], v[68:71], a[68:71], a[196:199]
v_mfma_f32_16x16x32_bf16 a[200:203], v[64:67], a[56:59], a[200:203]
buffer_load_dwordx4 v3, s[8:11], 0 offen offset:0 sc1 lds
v_mfma_f32_16x16x32_bf16 a[200:203], v[68:71], a[72:75], a[200:203]
ds_read_b128 v[60:63], v7 offset:44032
v_mfma_f32_16x16x32_bf16 a[204:207], v[64:67], a[60:63], a[204:207]
v_mfma_f32_16x16x32_bf16 a[204:207], v[68:71], a[76:79], a[204:207]
s_waitcnt lgkmcnt(4)
v_mfma_f32_16x16x32_bf16 a[208:211], v[72:75], a[48:51], a[208:211]
buffer_load_dwordx4 v3, s[8:11], 0 offen offset:1024 sc1 lds
v_mfma_f32_16x16x32_bf16 a[208:211], v[76:79], a[64:67], a[208:211]
v_mfma_f32_16x16x32_bf16 a[212:215], v[72:75], a[52:55], a[212:215]
ds_read_b128 v[64:67], v7 offset:45056
v_mfma_f32_16x16x32_bf16 a[212:215], v[76:79], a[68:71], a[212:215]
v_mfma_f32_16x16x32_bf16 a[216:219], v[72:75], a[56:59], a[216:219]
buffer_load_dwordx4 v3, s[8:11], 0 offen offset:2048 sc1 lds
v_mfma_f32_16x16x32_bf16 a[216:219], v[76:79], a[72:75], a[216:219]
ds_read_b128 v[68:71], v7 offset:46080
v_mfma_f32_16x16x32_bf16 a[220:223], v[72:75], a[60:63], a[220:223]
v_mfma_f32_16x16x32_bf16 a[220:223], v[76:79], a[76:79], a[220:223]
s_waitcnt lgkmcnt(4)
v_mfma_f32_16x16x32_bf16 a[224:227], v[48:51], a[48:51], a[224:227]
buffer_load_dwordx4 v3, s[8:11], 0 offen offset:3072 sc1 lds
v_mfma_f32_16x16x32_bf16 a[224:227], v[52:55], a[64:67], a[224:227]
s_add_u32 m0, s22, 53248
v_add_u32 v3, 4096, v3
v_mfma_f32_16x16x32_bf16 a[228:231], v[48:51], a[52:55], a[228:231]
ds_read_b128 v[72:75], v7 offset:47104
v_mfma_f32_16x16x32_bf16 a[228:231], v[52:55], a[68:71], a[228:231]
v_mfma_f32_16x16x32_bf16 a[232:235], v[48:51], a[56:59], a[232:235]
buffer_load_dwordx4 v3, s[8:11], 0 offen offset:0 sc1 lds
v_mfma_f32_16x16x32_bf16 a[232:235], v[52:55], a[72:75], a[232:235]
ds_read_b128 v[76:79], v7 offset:48128
v_mfma_f32_16x16x32_bf16 a[236:239], v[48:51], a[60:63], a[236:239]
v_mfma_f32_16x16x32_bf16 a[236:239], v[52:55], a[76:79], a[236:239]
s_waitcnt lgkmcnt(4)
v_mfma_f32_16x16x32_bf16 a[240:243], v[56:59], a[48:51], a[240:243]
buffer_load_dwordx4 v3, s[8:11], 0 offen offset:1024 sc1 lds
v_mfma_f32_16x16x32_bf16 a[240:243], v[60:63], a[64:67], a[240:243]
s_add_u32 s23, s34, 262144
v_mfma_f32_16x16x32_bf16 a[244:247], v[56:59], a[52:55], a[244:247]
ds_read_b128 v[48:51], v7 offset:49152
v_mfma_f32_16x16x32_bf16 a[244:247], v[60:63], a[68:71], a[244:247]
v_mfma_f32_16x16x32_bf16 a[248:251], v[56:59], a[56:59], a[248:251]
buffer_load_dwordx2 v[14:15], v11, s[8:11], s23 offen sc1
v_mfma_f32_16x16x32_bf16 a[248:251], v[60:63], a[72:75], a[248:251]
ds_read_b128 v[52:55], v7 offset:50176
v_mfma_f32_16x16x32_bf16 a[252:255], v[56:59], a[60:63], a[252:255]
v_mfma_f32_16x16x32_bf16 a[252:255], v[60:63], a[76:79], a[252:255]
s_waitcnt vmcnt(55)
s_waitcnt lgkmcnt(4)
v_mfma_f32_16x16x32_bf16 a[112:115], v[64:67], a[80:83], a[112:115]
v_mfma_f32_16x16x32_bf16 a[112:115], v[68:71], a[96:99], a[112:115]
v_mfma_f32_16x16x32_bf16 a[116:119], v[64:67], a[84:87], a[116:119]
ds_read_b128 v[56:59], v7 offset:51200
v_mfma_f32_16x16x32_bf16 a[116:119], v[68:71], a[100:103], a[116:119]
v_mfma_f32_16x16x32_bf16 a[120:123], v[64:67], a[88:91], a[120:123]
v_mfma_f32_16x16x32_bf16 a[120:123], v[68:71], a[104:107], a[120:123]
ds_read_b128 v[60:63], v7 offset:52224
v_mfma_f32_16x16x32_bf16 a[124:127], v[64:67], a[92:95], a[124:127]
v_mfma_f32_16x16x32_bf16 a[124:127], v[68:71], a[108:111], a[124:127]
s_waitcnt lgkmcnt(4)
v_mfma_f32_16x16x32_bf16 a[128:131], v[72:75], a[80:83], a[128:131]
v_mfma_f32_16x16x32_bf16 a[128:131], v[76:79], a[96:99], a[128:131]
v_mfma_f32_16x16x32_bf16 a[132:135], v[72:75], a[84:87], a[132:135]
ds_read_b128 v[64:67], v7 offset:53248
v_mfma_f32_16x16x32_bf16 a[132:135], v[76:79], a[100:103], a[132:135]
v_mfma_f32_16x16x32_bf16 a[136:139], v[72:75], a[88:91], a[136:139]
v_mfma_f32_16x16x32_bf16 a[136:139], v[76:79], a[104:107], a[136:139]
ds_read_b128 v[68:71], v7 offset:54272
v_mfma_f32_16x16x32_bf16 a[140:143], v[72:75], a[92:95], a[140:143]
v_mfma_f32_16x16x32_bf16 a[140:143], v[76:79], a[108:111], a[140:143]
s_waitcnt lgkmcnt(4)
v_mfma_f32_16x16x32_bf16 a[144:147], v[48:51], a[80:83], a[144:147]
v_mfma_f32_16x16x32_bf16 a[144:147], v[52:55], a[96:99], a[144:147]
v_mfma_f32_16x16x32_bf16 a[148:151], v[48:51], a[84:87], a[148:151]
ds_read_b128 v[72:75], v7 offset:55296
v_mfma_f32_16x16x32_bf16 a[148:151], v[52:55], a[100:103], a[148:151]
v_mfma_f32_16x16x32_bf16 a[152:155], v[48:51], a[88:91], a[152:155]
v_mfma_f32_16x16x32_bf16 a[152:155], v[52:55], a[104:107], a[152:155]
ds_read_b128 v[76:79], v7 offset:56320
v_mfma_f32_16x16x32_bf16 a[156:159], v[48:51], a[92:95], a[156:159]
v_mfma_f32_16x16x32_bf16 a[156:159], v[52:55], a[108:111], a[156:159]
s_waitcnt lgkmcnt(4)
v_mfma_f32_16x16x32_bf16 a[160:163], v[56:59], a[80:83], a[160:163]
s_waitcnt vmcnt(63)
v_mfma_f32_16x16x32_bf16 a[160:163], v[60:63], a[96:99], a[160:163]
s_barrier
v_mfma_f32_16x16x32_bf16 a[164:167], v[56:59], a[84:87], a[164:167]
ds_read_b128 v[48:51], v7 offset:57344
v_mfma_f32_16x16x32_bf16 a[164:167], v[60:63], a[100:103], a[164:167]
v_mfma_f32_16x16x32_bf16 a[168:171], v[56:59], a[88:91], a[168:171]
v_mfma_f32_16x16x32_bf16 a[168:171], v[60:63], a[104:107], a[168:171]
ds_read_b128 v[52:55], v7 offset:58368
v_mfma_f32_16x16x32_bf16 a[172:175], v[56:59], a[92:95], a[172:175]
v_mfma_f32_16x16x32_bf16 a[172:175], v[60:63], a[108:111], a[172:175]
s_waitcnt lgkmcnt(4)
v_mfma_f32_16x16x32_bf16 a[176:179], v[64:67], a[80:83], a[176:179]
v_mfma_f32_16x16x32_bf16 a[176:179], v[68:71], a[96:99], a[176:179]
v_mfma_f32_16x16x32_bf16 a[180:183], v[64:67], a[84:87], a[180:183]
ds_read_b128 v[56:59], v7 offset:59392
v_mfma_f32_16x16x32_bf16 a[180:183], v[68:71], a[100:103], a[180:183]
v_mfma_f32_16x16x32_bf16 a[184:187], v[64:67], a[88:91], a[184:187]
v_mfma_f32_16x16x32_bf16 a[184:187], v[68:71], a[104:107], a[184:187]
ds_read_b128 v[60:63], v7 offset:60416
v_mfma_f32_16x16x32_bf16 a[188:191], v[64:67], a[92:95], a[188:191]
v_mfma_f32_16x16x32_bf16 a[188:191], v[68:71], a[108:111], a[188:191]
s_waitcnt lgkmcnt(4)
v_mfma_f32_16x16x32_bf16 a[192:195], v[72:75], a[80:83], a[192:195]
v_mfma_f32_16x16x32_bf16 a[192:195], v[76:79], a[96:99], a[192:195]
v_mfma_f32_16x16x32_bf16 a[196:199], v[72:75], a[84:87], a[196:199]
ds_read_b128 v[64:67], v7 offset:61440
v_mfma_f32_16x16x32_bf16 a[196:199], v[76:79], a[100:103], a[196:199]
v_mfma_f32_16x16x32_bf16 a[200:203], v[72:75], a[88:91], a[200:203]
v_mfma_f32_16x16x32_bf16 a[200:203], v[76:79], a[104:107], a[200:203]
ds_read_b128 v[68:71], v7 offset:62464
v_mfma_f32_16x16x32_bf16 a[204:207], v[72:75], a[92:95], a[204:207]
v_mfma_f32_16x16x32_bf16 a[204:207], v[76:79], a[108:111], a[204:207]
s_waitcnt lgkmcnt(4)
v_mfma_f32_16x16x32_bf16 a[208:211], v[48:51], a[80:83], a[208:211]
v_mfma_f32_16x16x32_bf16 a[208:211], v[52:55], a[96:99], a[208:211]
v_mfma_f32_16x16x32_bf16 a[212:215], v[48:51], a[84:87], a[212:215]
ds_read_b128 v[72:75], v7 offset:63488
v_mfma_f32_16x16x32_bf16 a[212:215], v[52:55], a[100:103], a[212:215]
v_mfma_f32_16x16x32_bf16 a[216:219], v[48:51], a[88:91], a[216:219]
v_mfma_f32_16x16x32_bf16 a[216:219], v[52:55], a[104:107], a[216:219]
ds_read_b128 v[76:79], v7 offset:64512
v_mfma_f32_16x16x32_bf16 a[220:223], v[48:51], a[92:95], a[220:223]
v_mfma_f32_16x16x32_bf16 a[220:223], v[52:55], a[108:111], a[220:223]
s_waitcnt lgkmcnt(4)
v_mfma_f32_16x16x32_bf16 a[224:227], v[56:59], a[80:83], a[224:227]
v_mfma_f32_16x16x32_bf16 a[224:227], v[60:63], a[96:99], a[224:227]
v_mfma_f32_16x16x32_bf16 a[228:231], v[56:59], a[84:87], a[228:231]
ds_read_b128 v[48:51], v8 offset:0
v_mfma_f32_16x16x32_bf16 a[228:231], v[60:63], a[100:103], a[228:231]
v_mfma_f32_16x16x32_bf16 a[232:235], v[56:59], a[88:91], a[232:235]
v_mfma_f32_16x16x32_bf16 a[232:235], v[60:63], a[104:107], a[232:235]
ds_read_b128 v[52:55], v8 offset:1024
v_mfma_f32_16x16x32_bf16 a[236:239], v[56:59], a[92:95], a[236:239]
v_mfma_f32_16x16x32_bf16 a[236:239], v[60:63], a[108:111], a[236:239]
s_waitcnt lgkmcnt(4)
v_mfma_f32_16x16x32_bf16 a[240:243], v[64:67], a[80:83], a[240:243]
s_waitcnt vmcnt(0)
v_cmp_eq_u64 vcc, s[68:69], v[14:15]
s_nop 0
s_cmp_eq_u64 vcc, exec
s_cbranch_scc0 L_f_slow3
L_f_back3:
buffer_load_dwordx4 v[112:115], v2, s[8:11], s25 offen offset:3072 sc1
v_mfma_f32_16x16x32_bf16 a[240:243], v[68:71], a[96:99], a[240:243]
v_mfma_f32_16x16x32_bf16 a[244:247], v[64:67], a[84:87], a[244:247]
ds_read_b128 v[56:59], v8 offset:2048
v_mfma_f32_16x16x32_bf16 a[244:247], v[68:71], a[100:103], a[244:247]
v_mfma_f32_16x16x32_bf16 a[248:251], v[64:67], a[88:91], a[248:251]
buffer_load_dwordx4 v[116:119], v4, s[8:11], s25 offen offset:3072 sc1
v_mfma_f32_16x16x32_bf16 a[248:251], v[68:71], a[104:107], a[248:251]
ds_read_b128 v[60:63], v8 offset:3072
v_mfma_f32_16x16x32_bf16 a[252:255], v[64:67], a[92:95], a[252:255]
v_mfma_f32_16x16x32_bf16 a[252:255], v[68:71], a[108:111], a[252:255]
s_waitcnt vmcnt(41)
s_waitcnt lgkmcnt(4)
v_mfma_f32_16x16x32_bf16 a[112:115], v[72:75], v[16:19], a[112:115]
buffer_load_dwordx4 v[120:123], v5, s[8:11], s25 offen offset:3072 sc1
v_mfma_f32_16x16x32_bf16 a[112:115], v[76:79], v[192:195], a[112:115]
v_mfma_f32_16x16x32_bf16 a[116:119], v[72:75], v[20:23], a[116:119]
ds_read_b128 v[64:67], v8 offset:4096
v_mfma_f32_16x16x32_bf16 a[116:119], v[76:79], v[196:199], a[116:119]
v_mfma_f32_16x16x32_bf16 a[120:123], v[72:75], v[24:27], a[120:123]
buffer_load_dwordx4 v[124:127], v6, s[8:11], s25 offen offset:3072 sc1
v_mfma_f32_16x16x32_bf16 a[120:123], v[76:79], v[200:203], a[120:123]
ds_read_b128 v[68:71], v8 offset:5120
v_mfma_f32_16x16x32_bf16 a[124:127], v[72:75], v[28:31], a[124:127]
v_mfma_f32_16x16x32_bf16 a[124:127], v[76:79], v[204:207], a[124:127]
s_waitcnt lgkmcnt(4)
v_mfma_f32_16x16x32_bf16 a[128:131], v[48:51], v[16:19], a[128:131]
buffer_load_dwordx4 v[128:131], v2, s[8:11], s26 offen offset:3072 sc1
v_mfma_f32_16x16x32_bf16 a[128:131], v[52:55], v[192:195], a[128:131]
v_mfma_f32_16x16x32_bf16 a[132:135], v[48:51], v[20:23], a[132:135]
ds_read_b128 v[72:75], v8 offset:6144
v_mfma_f32_16x16x32_bf16 a[132:135], v[52:55], v[196:199], a[132:135]
v_mfma_f32_16x16x32_bf16 a[136:139], v[48:51], v[24:27], a[136:139]
buffer_load_dwordx4 v[132:135], v4, s[8:11], s26 offen offset:3072 sc1
v_mfma_f32_16x16x32_bf16 a[136:139], v[52:55], v[200:203], a[136:139]
ds_read_b128 v[76:79], v8 offset:7168
v_mfma_f32_16x16x32_bf16 a[140:143], v[48:51], v[28:31], a[140:143]
v_mfma_f32_16x16x32_bf16 a[140:143], v[52:55], v[204:207], a[140:143]
s_waitcnt lgkmcnt(4)
v_mfma_f32_16x16x32_bf16 a[144:147], v[56:59], v[16:19], a[144:147]
buffer_load_dwordx4 v[136:139], v5, s[8:11], s26 offen offset:3072 sc1
v_mfma_f32_16x16x32_bf16 a[144:147], v[60:63], v[192:195], a[144:147]
v_mfma_f32_16x16x32_bf16 a[148:151], v[56:59], v[20:23], a[148:151]
ds_read_b128 v[48:51], v8 offset:8192
v_mfma_f32_16x16x32_bf16 a[148:151], v[60:63], v[196:199], a[148:151]
v_mfma_f32_16x16x32_bf16 a[152:155], v[56:59], v[24:27], a[152:155]
buffer_load_dwordx4 v[140:143], v6, s[8:11], s26 offen offset:3072 sc1
v_mfma_f32_16x16x32_bf16 a[152:155], v[60:63], v[200:203], a[152:155]
ds_read_b128 v[52:55], v8 offset:9216
v_mfma_f32_16x16x32_bf16 a[156:159], v[56:59], v[28:31], a[156:159]
v_mfma_f32_16x16x32_bf16 a[156:159], v[60:63], v[204:207], a[156:159]
s_waitcnt lgkmcnt(4)
v_mfma_f32_16x16x32_bf16 a[160:163], v[64:67], v[16:19], a[160:163]
buffer_load_dwordx4 v[144:147], v2, s[8:11], s27 offen offset:3072 sc1
v_mfma_f32_16x16x32_bf16 a[160:163], v[68:71], v[192:195], a[160:163]
v_mfma_f32_16x16x32_bf16 a[164:167], v[64:67], v[20:23], a[164:167]
ds_read_b128 v[56:59], v8 offset:10240
v_mfma_f32_16x16x32_bf16 a[164:167], v[68:71], v[196:199], a[164:167]
v_mfma_f32_16x16x32_bf16 a[168:171], v[64:67], v[24:27], a[168:171]
buffer_load_dwordx4 v[148:151], v4, s[8:11], s27 offen offset:3072 sc1
v_mfma_f32_16x16x32_bf16 a[168:171], v[68:71], v[200:203], a[168:171]
ds_read_b128 v[60:63], v8 offset:11264
v_mfma_f32_16x16x32_bf16 a[172:175], v[64:67], v[28:31], a[172:175]
v_mfma_f32_16x16x32_bf16 a[172:175], v[68:71], v[204:207], a[172:175]
s_waitcnt lgkmcnt(4)
v_mfma_f32_16x16x32_bf16 a[176:179], v[72:75], v[16:19], a[176:179]
buffer_load_dwordx4 v[152:155], v5, s[8:11], s27 offen offset:3072 sc1
v_mfma_f32_16x16x32_bf16 a[176:179], v[76:79], v[192:195], a[176:179]
v_mfma_f32_16x16x32_bf16 a[180:183], v[72:75], v[20:23], a[180:183]
ds_read_b128 v[64:67], v8 offset:12288
v_mfma_f32_16x16x32_bf16 a[180:183], v[76:79], v[196:199], a[180:183]
v_mfma_f32_16x16x32_bf16 a[184:187], v[72:75], v[24:27], a[184:187]
buffer_load_dwordx4 v[156:159], v6, s[8:11], s27 offen offset:3072 sc1
v_mfma_f32_16x16x32_bf16 a[184:187], v[76:79], v[200:203], a[184:187]
ds_read_b128 v[68:71], v8 offset:13312
v_mfma_f32_16x16x32_bf16 a[188:191], v[72:75], v[28:31], a[188:191]
v_mfma_f32_16x16x32_bf16 a[188:191], v[76:79], v[204:207], a[188:191]
s_waitcnt lgkmcnt(4)
v_mfma_f32_16x16x32_bf16 a[192:195], v[48:51], v[16:19], a[192:195]
v_mfma_f32_16x16x32_bf16 a[192:195], v[52:55], v[192:195], a[192:195]
v_mfma_f32_16x16x32_bf16 a[196:199], v[48:51], v[20:23], a[196:199]
ds_read_b128 v[72:75], v8 offset:14336
v_mfma_f32_16x16x32_bf16 a[196:199], v[52:55], v[196:199], a[196:199]
v_mfma_f32_16x16x32_bf16 a[200:203], v[48:51], v[24:27], a[200:203]
v_mfma_f32_16x16x32_bf16 a[200:203], v[52:55], v[200:203], a[200:203]
ds_read_b128 v[76:79], v8 offset:15360
v_mfma_f32_16x16x32_bf16 a[204:207], v[48:51], v[28:31], a[204:207]
v_mfma_f32_16x16x32_bf16 a[204:207], v[52:55], v[204:207], a[204:207]
s_waitcnt lgkmcnt(4)
v_mfma_f32_16x16x32_bf16 a[208:211], v[56:59], v[16:19], a[208:211]
s_waitcnt vmcnt(61)
v_mfma_f32_16x16x32_bf16 a[208:211], v[60:63], v[192:195], a[208:211]
s_barrier
v_mfma_f32_16x16x32_bf16 a[212:215], v[56:59], v[20:23], a[212:215]
ds_read_b128 v[48:51], v2 offset:0
v_mfma_f32_16x16x32_bf16 a[212:215], v[60:63], v[196:199], a[212:215]
v_mfma_f32_16x16x32_bf16 a[216:219], v[56:59], v[24:27], a[216:219]
v_mfma_f32_16x16x32_bf16 a[216:219], v[60:63], v[200:203], a[216:219]
ds_read_b128 v[52:55], v2 offset:1024
v_mfma_f32_16x16x32_bf16 a[220:223], v[56:59], v[28:31], a[220:223]
v_mfma_f32_16x16x32_bf16 a[220:223], v[60:63], v[204:207], a[220:223]
s_waitcnt lgkmcnt(4)
v_mfma_f32_16x16x32_bf16 a[224:227], v[64:67], v[16:19], a[224:227]
v_mfma_f32_16x16x32_bf16 a[224:227], v[68:71], v[192:195], a[224:227]
v_mfma_f32_16x16x32_bf16 a[228:231], v[64:67], v[20:23], a[228:231]
ds_read_b128 v[56:59], v2 offset:2048
v_mfma_f32_16x16x32_bf16 a[228:231], v[68:71], v[196:199], a[228:231]
v_mfma_f32_16x16x32_bf16 a[232:235], v[64:67], v[24:27], a[232:235]
v_mfma_f32_16x16x32_bf16 a[232:235], v[68:71], v[200:203], a[232:235]
ds_read_b128 v[60:63], v2 offset:3072
v_mfma_f32_16x16x32_bf16 a[236:239], v[64:67], v[28:31], a[236:239]
v_mfma_f32_16x16x32_bf16 a[236:239], v[68:71], v[204:207], a[236:239]
s_waitcnt vmcnt(35)
s_waitcnt lgkmcnt(4)
v_mfma_f32_16x16x32_bf16 a[112:115], v[72:75], v[32:35], a[112:115]
v_mfma_f32_16x16x32_bf16 a[112:115], v[76:79], v[80:83], a[112:115]
v_mfma_f32_16x16x32_bf16 a[116:119], v[72:75], v[36:39], a[116:119]
ds_read_b128 v[64:67], v2 offset:4096
v_mfma_f32_16x16x32_bf16 a[116:119], v[76:79], v[84:87], a[116:119]
v_mfma_f32_16x16x32_bf16 a[120:123], v[72:75], v[40:43], a[120:123]
v_mfma_f32_16x16x32_bf16 a[120:123], v[76:79], v[88:91], a[120:123]
ds_read_b128 v[68:71], v2 offset:5120
v_mfma_f32_16x16x32_bf16 a[124:127], v[72:75], v[44:47], a[124:127]
v_mfma_f32_16x16x32_bf16 a[124:127], v[76:79], v[92:95], a[124:127]
s_waitcnt lgkmcnt(4)
v_mfma_f32_16x16x32_bf16 a[128:131], v[48:51], v[32:35], a[128:131]
v_mfma_f32_16x16x32_bf16 a[128:131], v[52:55], v[80:83], a[128:131]
v_mfma_f32_16x16x32_bf16 a[132:135], v[48:51], v[36:39], a[132:135]
ds_read_b128 v[72:75], v2 offset:6144
v_mfma_f32_16x16x32_bf16 a[132:135], v[52:55], v[84:87], a[132:135]
v_mfma_f32_16x16x32_bf16 a[136:139], v[48:51], v[40:43], a[136:139]
v_mfma_f32_16x16x32_bf16 a[136:139], v[52:55], v[88:91], a[136:139]
ds_read_b128 v[76:79], v2 offset:7168
v_mfma_f32_16x16x32_bf16 a[140:143], v[48:51], v[44:47], a[140:143]
v_mfma_f32_16x16x32_bf16 a[140:143], v[52:55], v[92:95], a[140:143]
s_waitcnt lgkmcnt(4)
v_mfma_f32_16x16x32_bf16 a[144:147], v[56:59], v[32:35], a[144:147]
v_mfma_f32_16x16x32_bf16 a[144:147], v[60:63], v[80:83], a[144:147]
v_mfma_f32_16x16x32_bf16 a[148:151], v[56:59], v[36:39], a[148:151]
ds_read_b128 v[48:51], v2 offset:8192
v_mfma_f32_16x16x32_bf16 a[148:151], v[60:63], v[84:87], a[148:151]
v_mfma_f32_16x16x32_bf16 a[152:155], v[56:59], v[40:43], a[152:155]
v_mfma_f32_16x16x32_bf16 a[152:155], v[60:63], v[88:91], a[152:155]
ds_read_b128 v[52:55], v2 offset:9216
v_mfma_f32_16x16x32_bf16 a[156:159], v[56:59], v[44:47], a[156:159]
v_mfma_f32_16x16x32_bf16 a[156:159], v[60:63], v[92:95], a[156:159]
s_waitcnt lgkmcnt(4)
v_mfma_f32_16x16x32_bf16 a[160:163], v[64:67], v[32:35], a[160:163]
v_mfma_f32_16x16x32_bf16 a[160:163], v[68:71], v[80:83], a[160:163]
v_mfma_f32_16x16x32_bf16 a[164:167], v[64:67], v[36:39], a[164:167]
ds_read_b128 v[56:59], v2 offset:10240
v_mfma_f32_16x16x32_bf16 a[164:167], v[68:71], v[84:87], a[164:167]
v_mfma_f32_16x16x32_bf16 a[168:171], v[64:67], v[40:43], a[168:171]
v_mfma_f32_16x16x32_bf16 a[168:171], v[68:71], v[88:91], a[168:171]
ds_read_b128 v[60:63], v2 offset:11264
v_mfma_f32_16x16x32_bf16 a[172:175], v[64:67], v[44:47], a[172:175]
v_mfma_f32_16x16x32_bf16 a[172:175], v[68:71], v[92:95], a[172:175]
s_waitcnt lgkmcnt(4)
v_mfma_f32_16x16x32_bf16 a[176:179], v[72:75], v[32:35], a[176:179]
v_mfma_f32_16x16x32_bf16 a[176:179], v[76:79], v[80:83], a[176:179]
v_mfma_f32_16x16x32_bf16 a[180:183], v[72:75], v[36:39], a[180:183]
ds_read_b128 v[64:67], v2 offset:12288
v_mfma_f32_16x16x32_bf16 a[180:183], v[76:79], v[84:87], a[180:183]
v_mfma_f32_16x16x32_bf16 a[184:187], v[72:75], v[40:43], a[184:187]
v_mfma_f32_16x16x32_bf16 a[184:187], v[76:79], v[88:91], a[184:187]
ds_read_b128 v[68:71], v2 offset:13312
v_mfma_f32_16x16x32_bf16 a[188:191], v[72:75], v[44:47], a[188:191]
v_mfma_f32_16x16x32_bf16 a[188:191], v[76:79], v[92:95], a[188:191]
s_waitcnt lgkmcnt(4)
v_mfma_f32_16x16x32_bf16 a[192:195], v[48:51], v[32:35], a[192:195]
v_mfma_f32_16x16x32_bf16 a[192:195], v[52:55], v[80:83], a[192:195]
v_mfma_f32_16x16x32_bf16 a[196:199], v[48:51], v[36:39], a[196:199]
ds_read_b128 v[72:75], v2 offset:14336
v_mfma_f32_16x16x32_bf16 a[196:199], v[52:55], v[84:87], a[196:199]
v_mfma_f32_16x16x32_bf16 a[200:203], v[48:51], v[40:43], a[200:203]
v_mfma_f32_16x16x32_bf16 a[200:203], v[52:55], v[88:91], a[200:203]
ds_read_b128 v[76:79], v2 offset:15360
v_mfma_f32_16x16x32_bf16 a[204:207], v[48:51], v[44:47], a[204:207]
v_mfma_f32_16x16x32_bf16 a[204:207], v[52:55], v[92:95], a[204:207]
s_waitcnt lgkmcnt(4)
v_mfma_f32_16x16x32_bf16 a[208:211], v[56:59], v[32:35], a[208:211]
v_mfma_f32_16x16x32_bf16 a[208:211], v[60:63], v[80:83], a[208:211]
v_mfma_f32_16x16x32_bf16 a[212:215], v[56:59], v[36:39], a[212:215]
ds_read_b128 v[48:51], v2 offset:16384
v_mfma_f32_16x16x32_bf16 a[212:215], v[60:63], v[84:87], a[212:215]
v_mfma_f32_16x16x32_bf16 a[216:219], v[56:59], v[40:43], a[216:219]
v_mfma_f32_16x16x32_bf16 a[216:219], v[60:63], v[88:91], a[216:219]
ds_read_b128 v[52:55], v2 offset:17408
v_mfma_f32_16x16x32_bf16 a[220:223], v[56:59], v[44:47], a[220:223]
v_mfma_f32_16x16x32_bf16 a[220:223], v[60:63], v[92:95], a[220:223]
s_waitcnt lgkmcnt(4)
v_mfma_f32_16x16x32_bf16 a[224:227], v[64:67], v[32:35], a[224:227]
v_mfma_f32_16x16x32_bf16 a[224:227], v[68:71], v[80:83], a[224:227]
v_mfma_f32_16x16x32_bf16 a[228:231], v[64:67], v[36:39], a[228:231]
ds_read_b128 v[56:59], v2 offset:18432
v_mfma_f32_16x16x32_bf16 a[228:231], v[68:71], v[84:87], a[228:231]
v_mfma_f32_16x16x32_bf16 a[232:235], v[64:67], v[40:43], a[232:235]
v_mfma_f32_16x16x32_bf16 a[232:235], v[68:71], v[88:91], a[232:235]
ds_read_b128 v[60:63], v2 offset:19456
v_mfma_f32_16x16x32_bf16 a[236:239], v[64:67], v[44:47], a[236:239]
v_mfma_f32_16x16x32_bf16 a[236:239], v[68:71], v[92:95], a[236:239]
s_waitcnt vmcnt(8)
s_waitcnt lgkmcnt(4)
v_mfma_f32_16x16x32_bf16 a[112:115], v[72:75], v[96:99], a[112:115]
v_mfma_f32_16x16x32_bf16 a[112:115], v[76:79], v[112:115], a[112:115]
v_mfma_f32_16x16x32_bf16 a[116:119], v[72:75], v[100:103], a[116:119]
ds_read_b128 v[64:67], v2 offset:20480
v_mfma_f32_16x16x32_bf16 a[116:119], v[76:79], v[116:119], a[116:119]
v_mfma_f32_16x16x32_bf16 a[120:123], v[72:75], v[104:107], a[120:123]
v_mfma_f32_16x16x32_bf16 a[120:123], v[76:79], v[120:123], a[120:123]
ds_read_b128 v[68:71], v2 offset:21504
v_mfma_f32_16x16x32_bf16 a[124:127], v[72:75], v[108:111], a[124:127]
v_mfma_f32_16x16x32_bf16 a[124:127], v[76:79], v[124:127], a[124:127]
s_waitcnt vmcnt(0)
s_waitcnt lgkmcnt(4)
v_mfma_f32_16x16x32_bf16 a[112:115], v[48:51], v[128:131], a[112:115]
v_mfma_f32_16x16x32_bf16 a[112:115], v[52:55], v[144:147], a[112:115]
v_mfma_f32_16x16x32_bf16 a[116:119], v[48:51], v[132:135], a[116:119]
ds_read_b128 v[72:75], v2 offset:22528
v_mfma_f32_16x16x32_bf16 a[116:119], v[52:55], v[148:151], a[116:119]
v_mfma_f32_16x16x32_bf16 a[120:123], v[48:51], v[136:139], a[120:123]
v_mfma_f32_16x16x32_bf16 a[120:123], v[52:55], v[152:155], a[120:123]
ds_read_b128 v[76:79], v2 offset:23552
v_mfma_f32_16x16x32_bf16 a[124:127], v[48:51], v[140:143], a[124:127]
v_mfma_f32_16x16x32_bf16 a[124:127], v[52:55], v[156:159], a[124:127]
s_waitcnt lgkmcnt(4)
v_mfma_f32_16x16x32_bf16 a[128:131], v[56:59], v[96:99], a[128:131]
s_waitcnt vmcnt(43)
v_mfma_f32_16x16x32_bf16 a[128:131], v[60:63], v[112:115], a[128:131]
s_barrier
v_mfma_f32_16x16x32_bf16 a[132:135], v[56:59], v[100:103], a[132:135]
ds_read_b128 v[48:51], v2 offset:24576
v_mfma_f32_16x16x32_bf16 a[132:135], v[60:63], v[116:119], a[132:135]
v_mfma_f32_16x16x32_bf16 a[136:139], v[56:59], v[104:107], a[136:139]
v_mfma_f32_16x16x32_bf16 a[136:139], v[60:63], v[120:123], a[136:139]
ds_read_b128 v[52:55], v2 offset:25600
v_mfma_f32_16x16x32_bf16 a[140:143], v[56:59], v[108:111], a[140:143]
v_mfma_f32_16x16x32_bf16 a[140:143], v[60:63], v[124:127], a[140:143]
s_waitcnt lgkmcnt(4)
v_mfma_f32_16x16x32_bf16 a[128:131], v[64:67], v[128:131], a[128:131]
v_mfma_f32_16x16x32_bf16 a[128:131], v[68:71], v[144:147], a[128:131]
v_mfma_f32_16x16x32_bf16 a[132:135], v[64:67], v[132:135], a[132:135]
ds_read_b128 v[56:59], v2 offset:26624
v_mfma_f32_16x16x32_bf16 a[132:135], v[68:71], v[148:151], a[132:135]
v_mfma_f32_16x16x32_bf16 a[136:139], v[64:67], v[136:139], a[136:139]
v_mfma_f32_16x16x32_bf16 a[136:139], v[68:71], v[152:155], a[136:139]
ds_read_b128 v[60:63], v2 offset:27648
v_mfma_f32_16x16x32_bf16 a[140:143], v[64:67], v[140:143], a[140:143]
v_mfma_f32_16x16x32_bf16 a[140:143], v[68:71], v[156:159], a[140:143]
s_waitcnt lgkmcnt(4)
v_mfma_f32_16x16x32_bf16 a[144:147], v[72:75], v[96:99], a[144:147]
v_mfma_f32_16x16x32_bf16 a[144:147], v[76:79], v[112:115], a[144:147]
v_mfma_f32_16x16x32_bf16 a[148:151], v[72:75], v[100:103], a[148:151]
ds_read_b128 v[64:67], v2 offset:28672
v_mfma_f32_16x16x32_bf16 a[148:151], v[76:79], v[116:119], a[148:151]
v_mfma_f32_16x16x32_bf16 a[152:155], v[72:75], v[104:107], a[152:155]
v_mfma_f32_16x16x32_bf16 a[152:155], v[76:79], v[120:123], a[152:155]
ds_read_b128 v[68:71], v2 offset:29696
v_mfma_f32_16x16x32_bf16 a[156:159], v[72:75], v[108:111], a[156:159]
v_mfma_f32_16x16x32_bf16 a[156:159], v[76:79], v[124:127], a[156:159]
s_waitcnt lgkmcnt(4)
v_mfma_f32_16x16x32_bf16 a[144:147], v[48:51], v[128:131], a[144:147]
v_mfma_f32_16x16x32_bf16 a[144:147], v[52:55], v[144:147], a[144:147]
v_mfma_f32_16x16x32_bf16 a[148:151], v[48:51], v[132:135], a[148:151]
ds_read_b128 v[72:75], v2 offset:30720
v_mfma_f32_16x16x32_bf16 a[148:151], v[52:55], v[148:151], a[148:151]
v_mfma_f32_16x16x32_bf16 a[152:155], v[48:51], v[136:139], a[152:155]
v_mfma_f32_16x16x32_bf16 a[152:155], v[52:55], v[152:155], a[152:155]
ds_read_b128 v[76:79], v2 offset:31744
v_mfma_f32_16x16x32_bf16 a[156:159], v[48:51], v[140:143], a[156:159]
v_mfma_f32_16x16x32_bf16 a[156:159], v[52:55], v[156:159], a[156:159]
s_waitcnt lgkmcnt(4)
v_mfma_f32_16x16x32_bf16 a[160:163], v[56:59], v[96:99], a[160:163]
v_mfma_f32_16x16x32_bf16 a[160:163], v[60:63], v[112:115], a[160:163]
v_mfma_f32_16x16x32_bf16 a[164:167], v[56:59], v[100:103], a[164:167]
ds_read_b128 v[48:51], v2 offset:32768
v_mfma_f32_16x16x32_bf16 a[164:167], v[60:63], v[116:119], a[164:167]
v_mfma_f32_16x16x32_bf16 a[168:171], v[56:59], v[104:107], a[168:171]
v_mfma_f32_16x16x32_bf16 a[168:171], v[60:63], v[120:123], a[168:171]
ds_read_b128 v[52:55], v2 offset:33792
v_mfma_f32_16x16x32_bf16 a[172:175], v[56:59], v[108:111], a[172:175]
v_mfma_f32_16x16x32_bf16 a[172:175], v[60:63], v[124:127], a[172:175]
s_waitcnt lgkmcnt(4)
v_mfma_f32_16x16x32_bf16 a[160:163], v[64:67], v[128:131], a[160:163]
v_mfma_f32_16x16x32_bf16 a[160:163], v[68:71], v[144:147], a[160:163]
v_mfma_f32_16x16x32_bf16 a[164:167], v[64:67], v[132:135], a[164:167]
ds_read_b128 v[56:59], v2 offset:34816
v_mfma_f32_16x16x32_bf16 a[164:167], v[68:71], v[148:151], a[164:167]
v_mfma_f32_16x16x32_bf16 a[168:171], v[64:67], v[136:139], a[168:171]
v_mfma_f32_16x16x32_bf16 a[168:171], v[68:71], v[152:155], a[168:171]
ds_read_b128 v[60:63], v2 offset:35840
v_mfma_f32_16x16x32_bf16 a[172:175], v[64:67], v[140:143], a[172:175]
v_mfma_f32_16x16x32_bf16 a[172:175], v[68:71], v[156:159], a[172:175]
s_waitcnt lgkmcnt(4)
v_mfma_f32_16x16x32_bf16 a[176:179], v[72:75], v[96:99], a[176:179]
v_mfma_f32_16x16x32_bf16 a[176:179], v[76:79], v[112:115], a[176:179]
v_mfma_f32_16x16x32_bf16 a[180:183], v[72:75], v[100:103], a[180:183]
ds_read_b128 v[64:67], v2 offset:36864
v_mfma_f32_16x16x32_bf16 a[180:183], v[76:79], v[116:119], a[180:183]
v_accvgpr_read_b32 v208, a112
v_accvgpr_read_b32 v209, a128
v_mfma_f32_16x16x32_bf16 a[184:187], v[72:75], v[104:107], a[184:187]
v_accvgpr_read_b32 v210, a144
v_accvgpr_read_b32 v211, a160
v_mfma_f32_16x16x32_bf16 a[184:187], v[76:79], v[120:123], a[184:187]
ds_read_b128 v[68:71], v2 offset:37888
v_accvgpr_read_b32 v212, a113
v_mfma_f32_16x16x32_bf16 a[188:191], v[72:75], v[108:111], a[188:191]
v_accvgpr_read_b32 v213, a129
v_accvgpr_read_b32 v214, a145
v_mfma_f32_16x16x32_bf16 a[188:191], v[76:79], v[124:127], a[188:191]
v_accvgpr_read_b32 v215, a161
s_waitcnt lgkmcnt(4)
v_mfma_f32_16x16x32_bf16 a[176:179], v[48:51], v[128:131], a[176:179]
v_cvt_pk_bf16_f32 v224, v208, v209
v_cvt_pk_bf16_f32 v225, v210, v211
v_mfma_f32_16x16x32_bf16 a[176:179], v[52:55], v[144:147], a[176:179]
v_cvt_pk_bf16_f32 v226, v212, v213
v_cvt_pk_bf16_f32 v227, v214, v215
v_mfma_f32_16x16x32_bf16 a[180:183], v[48:51], v[132:135], a[180:183]
ds_read_b128 v[72:75], v2 offset:38912
buffer_store_dwordx4 v[224:227], v252, s[8:11], s36 offen offset:0 sc1
v_mfma_f32_16x16x32_bf16 a[180:183], v[52:55], v[148:151], a[180:183]
v_accvgpr_read_b32 v216, a114
v_accvgpr_read_b32 v217, a130
v_mfma_f32_16x16x32_bf16 a[184:187], v[48:51], v[136:139], a[184:187]
v_accvgpr_read_b32 v218, a146
v_accvgpr_read_b32 v219, a162
v_mfma_f32_16x16x32_bf16 a[184:187], v[52:55], v[152:155], a[184:187]
ds_read_b128 v[76:79], v2 offset:39936
v_accvgpr_read_b32 v220, a115
v_mfma_f32_16x16x32_bf16 a[188:191], v[48:51], v[140:143], a[188:191]
v_accvgpr_read_b32 v221, a131
v_accvgpr_read_b32 v222, a147
v_mfma_f32_16x16x32_bf16 a[188:191], v[52:55], v[156:159], a[188:191]
v_accvgpr_read_b32 v223, a163
s_waitcnt lgkmcnt(4)
v_mfma_f32_16x16x32_bf16 a[192:195], v[56:59], v[96:99], a[192:195]
v_cvt_pk_bf16_f32 v228, v216, v217
v_cvt_pk_bf16_f32 v229, v218, v219
v_mfma_f32_16x16x32_bf16 a[192:195], v[60:63], v[112:115], a[192:195]
v_cvt_pk_bf16_f32 v230, v220, v221
v_cvt_pk_bf16_f32 v231, v222, v223
v_mfma_f32_16x16x32_bf16 a[196:199], v[56:59], v[100:103], a[196:199]
ds_read_b128 v[48:51], v2 offset:40960
buffer_store_dwordx4 v[228:231], v252, s[8:11], s36 offen offset:256 sc1
v_mfma_f32_16x16x32_bf16 a[196:199], v[60:63], v[116:119], a[196:199]
v_accvgpr_read_b32 v208, a116
v_accvgpr_read_b32 v209, a132
v_mfma_f32_16x16x32_bf16 a[200:203], v[56:59], v[104:107], a[200:203]
v_accvgpr_read_b32 v210, a148
v_accvgpr_read_b32 v211, a164
v_mfma_f32_16x16x32_bf16 a[200:203], v[60:63], v[120:123], a[200:203]
ds_read_b128 v[52:55], v2 offset:41984
v_accvgpr_read_b32 v212, a117
v_mfma_f32_16x16x32_bf16 a[204:207], v[56:59], v[108:111], a[204:207]
v_accvgpr_read_b32 v213, a133
v_accvgpr_read_b32 v214, a149
v_mfma_f32_16x16x32_bf16 a[204:207], v[60:63], v[124:127], a[204:207]
v_accvgpr_read_b32 v215, a165
s_waitcnt lgkmcnt(4)
v_mfma_f32_16x16x32_bf16 a[192:195], v[64:67], v[128:131], a[192:195]
v_cvt_pk_bf16_f32 v224, v208, v209
v_cvt_pk_bf16_f32 v225, v210, v211
v_mfma_f32_16x16x32_bf16 a[192:195], v[68:71], v[144:147], a[192:195]
v_cvt_pk_bf16_f32 v226, v212, v213
v_cvt_pk_bf16_f32 v227, v214, v215
v_mfma_f32_16x16x32_bf16 a[196:199], v[64:67], v[132:135], a[196:199]
ds_read_b128 v[56:59], v2 offset:43008
buffer_store_dwordx4 v[224:227], v252, s[8:11], s37 offen offset:0 sc1
v_mfma_f32_16x16x32_bf16 a[196:199], v[68:71], v[148:151], a[196:199]
v_accvgpr_read_b32 v216, a118
v_accvgpr_read_b32 v217, a134
v_mfma_f32_16x16x32_bf16 a[200:203], v[64:67], v[136:139], a[200:203]
v_accvgpr_read_b32 v218, a150
v_accvgpr_read_b32 v219, a166
v_mfma_f32_16x16x32_bf16 a[200:203], v[68:71], v[152:155], a[200:203]
ds_read_b128 v[60:63], v2 offset:44032
v_accvgpr_read_b32 v220, a119
v_mfma_f32_16x16x32_bf16 a[204:207], v[64:67], v[140:143], a[204:207]
v_accvgpr_read_b32 v221, a135
v_accvgpr_read_b32 v222, a151
v_mfma_f32_16x16x32_bf16 a[204:207], v[68:71], v[156:159], a[204:207]
v_accvgpr_read_b32 v223, a167
s_waitcnt lgkmcnt(4)
v_mfma_f32_16x16x32_bf16 a[208:211], v[72:75], v[96:99], a[208:211]
v_cvt_pk_bf16_f32 v228, v216, v217
v_cvt_pk_bf16_f32 v229, v218, v219
v_mfma_f32_16x16x32_bf16 a[208:211], v[76:79], v[112:115], a[208:211]
v_cvt_pk_bf16_f32 v230, v220, v221
v_cvt_pk_bf16_f32 v231, v222, v223
v_mfma_f32_16x16x32_bf16 a[212:215], v[72:75], v[100:103], a[212:215]
ds_read_b128 v[64:67], v2 offset:45056
buffer_store_dwordx4 v[228:231], v252, s[8:11], s37 offen offset:256 sc1
v_mfma_f32_16x16x32_bf16 a[212:215], v[76:79], v[116:119], a[212:215]
v_accvgpr_read_b32 v208, a120
v_accvgpr_read_b32 v209, a136
v_mfma_f32_16x16x32_bf16 a[216:219], v[72:75], v[104:107], a[216:219]
v_accvgpr_read_b32 v210, a152
v_accvgpr_read_b32 v211, a168
v_mfma_f32_16x16x32_bf16 a[216:219], v[76:79], v[120:123], a[216:219]
ds_read_b128 v[68:71], v2 offset:46080
v_accvgpr_read_b32 v212, a121
v_mfma_f32_16x16x32_bf16 a[220:223], v[72:75], v[108:111], a[220:223]
v_accvgpr_read_b32 v213, a137
v_accvgpr_read_b32 v214, a153
v_mfma_f32_16x16x32_bf16 a[220:223], v[76:79], v[124:127], a[220:223]
v_accvgpr_read_b32 v215, a169
s_waitcnt lgkmcnt(4)
v_mfma_f32_16x16x32_bf16 a[208:211], v[48:51], v[128:131], a[208:211]
v_cvt_pk_bf16_f32 v224, v208, v209
v_cvt_pk_bf16_f32 v225, v210, v211
v_mfma_f32_16x16x32_bf16 a[208:211], v[52:55], v[144:147], a[208:211]
v_cvt_pk_bf16_f32 v226, v212, v213
v_cvt_pk_bf16_f32 v227, v214, v215
v_mfma_f32_16x16x32_bf16 a[212:215], v[48:51], v[132:135], a[212:215]
ds_read_b128 v[72:75], v2 offset:47104
buffer_store_dwordx4 v[224:227], v252, s[8:11], s38 offen offset:0 sc1
v_mfma_f32_16x16x32_bf16 a[212:215], v[52:55], v[148:151], a[212:215]
v_accvgpr_read_b32 v216, a122
v_accvgpr_read_b32 v217, a138
v_mfma_f32_16x16x32_bf16 a[216:219], v[48:51], v[136:139], a[216:219]
v_accvgpr_read_b32 v218, a154
v_accvgpr_read_b32 v219, a170
v_mfma_f32_16x16x32_bf16 a[216:219], v[52:55], v[152:155], a[216:219]
ds_read_b128 v[76:79], v2 offset:48128
v_accvgpr_read_b32 v220, a123
v_mfma_f32_16x16x32_bf16 a[220:223], v[48:51], v[140:143], a[220:223]
v_accvgpr_read_b32 v221, a139
v_accvgpr_read_b32 v222, a155
v_mfma_f32_16x16x32_bf16 a[220:223], v[52:55], v[156:159], a[220:223]
v_accvgpr_read_b32 v223, a171
s_waitcnt lgkmcnt(4)
v_mfma_f32_16x16x32_bf16 a[224:227], v[56:59], v[96:99], a[224:227]
s_waitcnt vmcnt(18)
v_cvt_pk_bf16_f32 v228, v216, v217
v_mfma_f32_16x16x32_bf16 a[224:227], v[60:63], v[112:115], a[224:227]
s_barrier
v_mfma_f32_16x16x32_bf16 a[228:231], v[56:59], v[100:103], a[228:231]
ds_read_b128 v[48:51], v2 offset:49152
v_cvt_pk_bf16_f32 v229, v218, v219
v_mfma_f32_16x16x32_bf16 a[228:231], v[60:63], v[116:119], a[228:231]
v_cvt_pk_bf16_f32 v230, v220, v221
v_cvt_pk_bf16_f32 v231, v222, v223
v_mfma_f32_16x16x32_bf16 a[232:235], v[56:59], v[104:107], a[232:235]
buffer_store_dwordx4 v[228:231], v252, s[8:11], s38 offen offset:256 sc1
v_mfma_f32_16x16x32_bf16 a[232:235], v[60:63], v[120:123], a[232:235]
ds_read_b128 v[52:55], v2 offset:50176
v_accvgpr_read_b32 v208, a124
v_mfma_f32_16x16x32_bf16 a[236:239], v[56:59], v[108:111], a[236:239]
v_accvgpr_read_b32 v209, a140
v_accvgpr_read_b32 v210, a156
v_mfma_f32_16x16x32_bf16 a[236:239], v[60:63], v[124:127], a[236:239]
v_accvgpr_read_b32 v211, a172
s_waitcnt lgkmcnt(4)
v_mfma_f32_16x16x32_bf16 a[224:227], v[64:67], v[128:131], a[224:227]
v_accvgpr_read_b32 v212, a125
v_accvgpr_read_b32 v213, a141
v_mfma_f32_16x16x32_bf16 a[224:227], v[68:71], v[144:147], a[224:227]
v_accvgpr_read_b32 v214, a157
v_accvgpr_read_b32 v215, a173
v_mfma_f32_16x16x32_bf16 a[228:231], v[64:67], v[132:135], a[228:231]
ds_read_b128 v[56:59], v2 offset:51200
v_cvt_pk_bf16_f32 v224, v208, v209
v_mfma_f32_16x16x32_bf16 a[228:231], v[68:71], v[148:151], a[228:231]
v_cvt_pk_bf16_f32 v225, v210, v211
v_cvt_pk_bf16_f32 v226, v212, v213
v_mfma_f32_16x16x32_bf16 a[232:235], v[64:67], v[136:139], a[232:235]
v_cvt_pk_bf16_f32 v227, v214, v215
buffer_store_dwordx4 v[224:227], v252, s[8:11], s39 offen offset:0 sc1
v_mfma_f32_16x16x32_bf16 a[232:235], v[68:71], v[152:155], a[232:235]
ds_read_b128 v[60:63], v2 offset:52224
v_accvgpr_read_b32 v216, a126
v_mfma_f32_16x16x32_bf16 a[236:239], v[64:67], v[140:143], a[236:239]
v_accvgpr_read_b32 v217, a142
v_accvgpr_read_b32 v218, a158
v_mfma_f32_16x16x32_bf16 a[236:239], v[68:71], v[156:159], a[236:239]
v_accvgpr_read_b32 v219, a174
v_accvgpr_read_b32 v220, a127
v_accvgpr_read_b32 v221, a143
v_accvgpr_read_b32 v222, a159
v_accvgpr_read_b32 v223, a175
v_cvt_pk_bf16_f32 v228, v216, v217
v_cvt_pk_bf16_f32 v229, v218, v219
v_cvt_pk_bf16_f32 v230, v220, v221
v_cvt_pk_bf16_f32 v231, v222, v223
buffer_store_dwordx4 v[228:231], v252, s[8:11], s39 offen offset:256 sc1
s_waitcnt lgkmcnt(4)
v_mfma_f32_16x16x32_bf16 a[240:243], v[72:75], v[16:19], a[240:243]
v_mfma_f32_16x16x32_bf16 a[240:243], v[76:79], v[192:195], a[240:243]
v_mfma_f32_16x16x32_bf16 a[244:247], v[72:75], v[20:23], a[244:247]
ds_read_b128 v[64:67], v2 offset:53248
v_mfma_f32_16x16x32_bf16 a[244:247], v[76:79], v[196:199], a[244:247]
v_accvgpr_read_b32 v208, a176
v_accvgpr_read_b32 v209, a192
v_mfma_f32_16x16x32_bf16 a[248:251], v[72:75], v[24:27], a[248:251]
v_accvgpr_read_b32 v210, a208
v_accvgpr_read_b32 v211, a224
v_mfma_f32_16x16x32_bf16 a[248:251], v[76:79], v[200:203], a[248:251]
ds_read_b128 v[68:71], v2 offset:54272
v_accvgpr_read_b32 v212, a177
v_mfma_f32_16x16x32_bf16 a[252:255], v[72:75], v[28:31], a[252:255]
v_accvgpr_read_b32 v213, a193
v_accvgpr_read_b32 v214, a209
v_mfma_f32_16x16x32_bf16 a[252:255], v[76:79], v[204:207], a[252:255]
v_accvgpr_read_b32 v215, a225
s_waitcnt lgkmcnt(4)
v_mfma_f32_16x16x32_bf16 a[240:243], v[48:51], v[32:35], a[240:243]
v_cvt_pk_bf16_f32 v224, v208, v209
v_cvt_pk_bf16_f32 v225, v210, v211
v_mfma_f32_16x16x32_bf16 a[240:243], v[52:55], v[80:83], a[240:243]
v_cvt_pk_bf16_f32 v226, v212, v213
v_cvt_pk_bf16_f32 v227, v214, v215
v_mfma_f32_16x16x32_bf16 a[244:247], v[48:51], v[36:39], a[244:247]
buffer_store_dwordx4 v[224:227], v252, s[8:11], s36 offen offset:2048 sc1
v_mfma_f32_16x16x32_bf16 a[244:247], v[52:55], v[84:87], a[244:247]
v_accvgpr_read_b32 v216, a178
v_accvgpr_read_b32 v217, a194
v_mfma_f32_16x16x32_bf16 a[248:251], v[48:51], v[40:43], a[248:251]
v_accvgpr_read_b32 v218, a210
v_accvgpr_read_b32 v219, a226
v_mfma_f32_16x16x32_bf16 a[248:251], v[52:55], v[88:91], a[248:251]
v_accvgpr_read_b32 v220, a179
v_accvgpr_read_b32 v221, a195
v_mfma_f32_16x16x32_bf16 a[252:255], v[48:51], v[44:47], a[252:255]
v_accvgpr_read_b32 v222, a211
v_accvgpr_read_b32 v223, a227
v_mfma_f32_16x16x32_bf16 a[252:255], v[52:55], v[92:95], a[252:255]
v_cvt_pk_bf16_f32 v228, v216, v217
s_waitcnt lgkmcnt(2)
v_mfma_f32_16x16x32_bf16 a[240:243], v[56:59], v[96:99], a[240:243]
v_cvt_pk_bf16_f32 v229, v218, v219
v_cvt_pk_bf16_f32 v230, v220, v221
v_mfma_f32_16x16x32_bf16 a[240:243], v[60:63], v[112:115], a[240:243]
v_cvt_pk_bf16_f32 v231, v222, v223
buffer_store_dwordx4 v[228:231], v252, s[8:11], s36 offen offset:2304 sc1
v_mfma_f32_16x16x32_bf16 a[244:247], v[56:59], v[100:103], a[244:247]
v_accvgpr_read_b32 v208, a180
v_accvgpr_read_b32 v209, a196
v_mfma_f32_16x16x32_bf16 a[244:247], v[60:63], v[116:119], a[244:247]
v_accvgpr_read_b32 v210, a212
v_accvgpr_read_b32 v211, a228
v_mfma_f32_16x16x32_bf16 a[248:251], v[56:59], v[104:107], a[248:251]
v_accvgpr_read_b32 v212, a181
v_accvgpr_read_b32 v213, a197
v_mfma_f32_16x16x32_bf16 a[248:251], v[60:63], v[120:123], a[248:251]
v_accvgpr_read_b32 v214, a213
v_accvgpr_read_b32 v215, a229
v_mfma_f32_16x16x32_bf16 a[252:255], v[56:59], v[108:111], a[252:255]
v_cvt_pk_bf16_f32 v224, v208, v209
v_cvt_pk_bf16_f32 v225, v210, v211
v_mfma_f32_16x16x32_bf16 a[252:255], v[60:63], v[124:127], a[252:255]
v_cvt_pk_bf16_f32 v226, v212, v213
s_waitcnt lgkmcnt(0)
v_mfma_f32_16x16x32_bf16 a[240:243], v[64:67], v[128:131], a[240:243]
v_cvt_pk_bf16_f32 v227, v214, v215
buffer_store_dwordx4 v[224:227], v252, s[8:11], s37 offen offset:2048 sc1
v_mfma_f32_16x16x32_bf16 a[240:243], v[68:71], v[144:147], a[240:243]
v_accvgpr_read_b32 v216, a182
v_accvgpr_read_b32 v217, a198
v_mfma_f32_16x16x32_bf16 a[244:247], v[64:67], v[132:135], a[244:247]
v_accvgpr_read_b32 v218, a214
v_accvgpr_read_b32 v219, a230
v_mfma_f32_16x16x32_bf16 a[244:247], v[68:71], v[148:151], a[244:247]
v_accvgpr_read_b32 v220, a183
v_accvgpr_read_b32 v221, a199
v_mfma_f32_16x16x32_bf16 a[248:251], v[64:67], v[136:139], a[248:251]
v_accvgpr_read_b32 v222, a215
v_accvgpr_read_b32 v223, a231
v_mfma_f32_16x16x32_bf16 a[248:251], v[68:71], v[152:155], a[248:251]
v_cvt_pk_bf16_f32 v228, v216, v217
v_cvt_pk_bf16_f32 v229, v218, v219
v_mfma_f32_16x16x32_bf16 a[252:255], v[64:67], v[140:143], a[252:255]
v_cvt_pk_bf16_f32 v230, v220, v221
v_cvt_pk_bf16_f32 v231, v222, v223
v_mfma_f32_16x16x32_bf16 a[252:255], v[68:71], v[156:159], a[252:255]
buffer_store_dwordx4 v[228:231], v252, s[8:11], s37 offen offset:2304 sc1
s_barrier
v_accvgpr_read_b32 v208, a184
v_accvgpr_read_b32 v209, a200
v_accvgpr_read_b32 v210, a216
v_accvgpr_read_b32 v211, a232
v_accvgpr_read_b32 v212, a185
v_accvgpr_read_b32 v213, a201
v_accvgpr_read_b32 v214, a217
v_accvgpr_read_b32 v215, a233
v_cvt_pk_bf16_f32 v224, v208, v209
v_cvt_pk_bf16_f32 v225, v210, v211
v_cvt_pk_bf16_f32 v226, v212, v213
v_cvt_pk_bf16_f32 v227, v214, v215
buffer_store_dwordx4 v[224:227], v252, s[8:11], s38 offen offset:2048 sc1
v_accvgpr_read_b32 v216, a186
v_accvgpr_read_b32 v217, a202
v_accvgpr_read_b32 v218, a218
v_accvgpr_read_b32 v219, a234
v_accvgpr_read_b32 v220, a187
v_accvgpr_read_b32 v221, a203
v_accvgpr_read_b32 v222, a219
v_accvgpr_read_b32 v223, a235
v_cvt_pk_bf16_f32 v228, v216, v217
v_cvt_pk_bf16_f32 v229, v218, v219
v_cvt_pk_bf16_f32 v230, v220, v221
v_cvt_pk_bf16_f32 v231, v222, v223
buffer_store_dwordx4 v[228:231], v252, s[8:11], s38 offen offset:2304 sc1
v_accvgpr_read_b32 v208, a188
v_accvgpr_read_b32 v209, a204
v_accvgpr_read_b32 v210, a220
v_accvgpr_read_b32 v211, a236
v_accvgpr_read_b32 v212, a189
v_accvgpr_read_b32 v213, a205
v_accvgpr_read_b32 v214, a221
v_accvgpr_read_b32 v215, a237
v_cvt_pk_bf16_f32 v224, v208, v209
v_cvt_pk_bf16_f32 v225, v210, v211
v_cvt_pk_bf16_f32 v226, v212, v213
v_cvt_pk_bf16_f32 v227, v214, v215
buffer_store_dwordx4 v[224:227], v252, s[8:11], s39 offen offset:2048 sc1
v_accvgpr_read_b32 v216, a190
v_accvgpr_read_b32 v217, a206
v_accvgpr_read_b32 v218, a222
v_accvgpr_read_b32 v219, a238
v_accvgpr_read_b32 v220, a191
v_accvgpr_read_b32 v221, a207
v_accvgpr_read_b32 v222, a223
v_accvgpr_read_b32 v223, a239
v_cvt_pk_bf16_f32 v228, v216, v217
v_cvt_pk_bf16_f32 v229, v218, v219
v_cvt_pk_bf16_f32 v230, v220, v221
v_cvt_pk_bf16_f32 v231, v222, v223
buffer_store_dwordx4 v[228:231], v252, s[8:11], s39 offen offset:2304 sc1
v_accvgpr_read_b32 v208, a240
v_accvgpr_read_b32 v209, a241
v_accvgpr_read_b32 v210, a242
v_accvgpr_read_b32 v211, a243
v_accvgpr_read_b32 v212, a244
v_accvgpr_read_b32 v213, a245
v_accvgpr_read_b32 v214, a246
v_accvgpr_read_b32 v215, a247
v_cvt_pk_bf16_f32 v224, v208, v209
v_cvt_pk_bf16_f32 v225, v210, v211
v_cvt_pk_bf16_f32 v226, v212, v213
v_cvt_pk_bf16_f32 v227, v214, v215
s_nop 0
v_permlane16_swap_b32 v224, v226
v_permlane16_swap_b32 v225, v227
buffer_store_dwordx4 v[224:227], v9, s[8:11], s32 offen sc1
v_accvgpr_read_b32 v216, a248
v_accvgpr_read_b32 v217, a249
v_accvgpr_read_b32 v218, a250
v_accvgpr_read_b32 v219, a251
v_accvgpr_read_b32 v220, a252
v_accvgpr_read_b32 v221, a253
v_accvgpr_read_b32 v222, a254
v_accvgpr_read_b32 v223, a255
v_cvt_pk_bf16_f32 v228, v216, v217
v_cvt_pk_bf16_f32 v229, v218, v219
v_cvt_pk_bf16_f32 v230, v220, v221
v_cvt_pk_bf16_f32 v231, v222, v223
s_nop 0
v_permlane16_swap_b32 v228, v230
v_permlane16_swap_b32 v229, v231
buffer_store_dwordx4 v[228:231], v9, s[8:11], s33 offen sc1
v_mov_b32 v13, 2146435072
v_cmp_eq_u32 vcc, 0, v1
v_mov_b32 v14, s68
v_mov_b32 v15, s69
v_cndmask_b32 v13, v13, 0, vcc
s_waitcnt vmcnt(0)
buffer_store_dwordx2 v[14:15], v13, s[8:11], s35 offen sc1
s_cmp_eq_u32 s7, 1
s_cbranch_scc1 L_last
s_lshr_b32 s20, s5, 2
s_lshl_b32 s20, s20, 3
s_lshr_b32 s21, s6, 2
s_add_u32 s20, s20, s21
s_and_b32 s21, s5, 3
s_lshl_b32 s21, s21, 2
s_and_b32 s22, s6, 3
s_add_u32 s21, s21, s22
s_mul_i32 s22, s21, 147456
s_add_u32 s22, s22, 4198400
s_mul_i32 s23, s4, 36864
s_add_u32 s22, s22, s23
s_add_u32 m0, s23, 0
s_add_u32 s40, s22, 0
buffer_load_dwordx4 v2, s[8:11], s40 offen offset:0 sc1 lds
buffer_load_dwordx4 v2, s[8:11], s40 offen offset:1024 sc1 lds
buffer_load_dwordx4 v2, s[8:11], s40 offen offset:2048 sc1 lds
buffer_load_dwordx4 v2, s[8:11], s40 offen offset:3072 sc1 lds
s_add_u32 m0, s23, 4096
s_add_u32 s40, s22, 4096
buffer_load_dwordx4 v2, s[8:11], s40 offen offset:0 sc1 lds
buffer_load_dwordx4 v2, s[8:11], s40 offen offset:1024 sc1 lds
buffer_load_dwordx4 v2, s[8:11], s40 offen offset:2048 sc1 lds
buffer_load_dwordx4 v2, s[8:11], s40 offen offset:3072 sc1 lds
s_add_u32 m0, s23, 8192
s_add_u32 s40, s22, 8192
buffer_load_dwordx4 v2, s[8:11], s40 offen offset:0 sc1 lds
buffer_load_dwordx4 v2, s[8:11], s40 offen offset:1024 sc1 lds
buffer_load_dwordx4 v2, s[8:11], s40 offen offset:2048 sc1 lds
buffer_load_dwordx4 v2, s[8:11], s40 offen offset:3072 sc1 lds
s_add_u32 m0, s23, 12288
s_add_u32 s40, s22, 12288
buffer_load_dwordx4 v2, s[8:11], s40 offen offset:0 sc1 lds
buffer_load_dwordx4 v2, s[8:11], s40 offen offset:1024 sc1 lds
buffer_load_dwordx4 v2, s[8:11], s40 offen offset:2048 sc1 lds
buffer_load_dwordx4 v2, s[8:11], s40 offen offset:3072 sc1 lds
s_add_u32 m0, s23, 16384
s_add_u32 s40, s22, 16384
buffer_load_dwordx4 v2, s[8:11], s40 offen offset:0 sc1 lds
buffer_load_dwordx4 v2, s[8:11], s40 offen offset:1024 sc1 lds
buffer_load_dwordx4 v2, s[8:11], s40 offen offset:2048 sc1 lds
buffer_load_dwordx4 v2, s[8:11], s40 offen offset:3072 sc1 lds
s_add_u32 m0, s23, 20480
s_add_u32 s40, s22, 20480
buffer_load_dwordx4 v2, s[8:11], s40 offen offset:0 sc1 lds
buffer_load_dwordx4 v2, s[8:11], s40 offen offset:1024 sc1 lds
buffer_load_dwordx4 v2, s[8:11], s40 offen offset:2048 sc1 lds
buffer_load_dwordx4 v2, s[8:11], s40 offen offset:3072 sc1 lds
s_add_u32 m0, s23, 24576
s_add_u32 s40, s22, 24576
buffer_load_dwordx4 v2, s[8:11], s40 offen offset:0 sc1 lds
buffer_load_dwordx4 v2, s[8:11], s40 offen offset:1024 sc1 lds
buffer_load_dwordx4 v2, s[8:11], s40 offen offset:2048 sc1 lds
buffer_load_dwordx4 v2, s[8:11], s40 offen offset:3072 sc1 lds
s_add_u32 m0, s23, 28672
s_add_u32 s40, s22, 28672
buffer_load_dwordx4 v2, s[8:11], s40 offen offset:0 sc1 lds
buffer_load_dwordx4 v2, s[8:11], s40 offen offset:1024 sc1 lds
buffer_load_dwordx4 v2, s[8:11], s40 offen offset:2048 sc1 lds
buffer_load_dwordx4 v2, s[8:11], s40 offen offset:3072 sc1 lds
s_add_u32 m0, s23, 32768
s_add_u32 s40, s22, 32768
buffer_load_dwordx4 v2, s[8:11], s40 offen offset:0 sc1 lds
buffer_load_dwordx4 v2, s[8:11], s40 offen offset:1024 sc1 lds
buffer_load_dwordx4 v2, s[8:11], s40 offen offset:2048 sc1 lds
buffer_load_dwordx4 v2, s[8:11], s40 offen offset:3072 sc1 lds
s_cmp_eq_u32 s4, 3
s_cbranch_scc1 L_r_side
v_and_b32 v6, 7, v1
v_lshrrev_b32 v7, 3, v1
s_mul_i32 s22, s4, 24
v_add_u32 v7, s22, v7
s_and_b32 s23, s6, 1
s_lshl_b32 s23, s23, 3
v_add_u32 v8, s23, v6
v_lshlrev_b32 v8, 4, v8
v_lshl_add_u32 v4, v7, 8, v8
s_lshl_b32 s24, s5, 4
s_lshr_b32 s25, s6, 1
s_add_u32 s24, s24, s25
s_mul_i32 s20, s24, 18432
s_add_u32 s24, s20, 37416960
s_add_u32 s25, s24, 4096
buffer_load_dwordx4 v[16:19], v4, s[8:11], s24 offen offset:0 sc1
buffer_load_dwordx4 v[20:23], v4, s[8:11], s24 offen offset:2048 sc1
buffer_load_dwordx4 v[24:27], v4, s[8:11], s25 offen offset:0 sc1
s_lshl_b32 s24, s5, 2
s_lshr_b32 s25, s6, 3
s_add_u32 s24, s24, s25
s_lshl_b32 s24, s24, 12
s_add_u32 s24, s24, 655360
v_and_b32 v6, 31, v1
v_lshlrev_b32 v6, 7, v6
s_mov_b32 s52, 0
L_poll5:
buffer_load_dwordx2 v[14:15], v6, s[8:11], s24 offen sc1
s_add_u32 s52, s52, 1
s_waitcnt vmcnt(0)
v_cmp_ne_u64 vcc, s[68:69], v[14:15]
s_cmp_ge_u32 s52, 0x100000
s_cbranch_scc1 L_got5
s_and_b64 exec, exec, vcc
s_cbranch_execnz L_poll5
L_got5:
s_mov_b64 exec, -1
s_add_u32 s24, s20, 80146432
s_add_u32 s25, s24, 4096
buffer_load_dwordx4 v[28:31], v4, s[8:11], s24 offen offset:0 sc1
buffer_load_dwordx4 v[32:35], v4, s[8:11], s24 offen offset:2048 sc1
buffer_load_dwordx4 v[36:39], v4, s[8:11], s25 offen offset:0 sc1
s_add_u32 s24, s20, 82505728
s_add_u32 s25, s24, 4096
buffer_load_dwordx4 v[40:43], v4, s[8:11], s24 offen offset:0 sc1
buffer_load_dwordx4 v[44:47], v4, s[8:11], s24 offen offset:2048 sc1
buffer_load_dwordx4 v[48:51], v4, s[8:11], s25 offen offset:0 sc1
s_add_u32 s24, s20, 84865024
s_add_u32 s25, s24, 4096
buffer_load_dwordx4 v[52:55], v4, s[8:11], s24 offen offset:0 sc1
buffer_load_dwordx4 v[56:59], v4, s[8:11], s24 offen offset:2048 sc1
buffer_load_dwordx4 v[60:63], v4, s[8:11], s25 offen offset:0 sc1
s_add_u32 s24, s20, 87224320
s_add_u32 s25, s24, 4096
buffer_load_dwordx4 v[64:67], v4, s[8:11], s24 offen offset:0 sc1
buffer_load_dwordx4 v[68:71], v4, s[8:11], s24 offen offset:2048 sc1
buffer_load_dwordx4 v[72:75], v4, s[8:11], s25 offen offset:0 sc1
s_add_u32 s24, s20, 89583616
s_add_u32 s25, s24, 4096
buffer_load_dwordx4 v[76:79], v4, s[8:11], s24 offen offset:0 sc1
buffer_load_dwordx4 v[80:83], v4, s[8:11], s24 offen offset:2048 sc1
buffer_load_dwordx4 v[84:87], v4, s[8:11], s25 offen offset:0 sc1
s_add_u32 s24, s20, 91942912
s_add_u32 s25, s24, 4096
buffer_load_dwordx4 v[88:91], v4, s[8:11], s24 offen offset:0 sc1
buffer_load_dwordx4 v[92:95], v4, s[8:11], s24 offen offset:2048 sc1
buffer_load_dwordx4 v[96:99], v4, s[8:11], s25 offen offset:0 sc1
s_add_u32 s24, s20, 94302208
s_add_u32 s25, s24, 4096
buffer_load_dwordx4 v[100:103], v4, s[8:11], s24 offen offset:0 sc1
buffer_load_dwordx4 v[104:107], v4, s[8:11], s24 offen offset:2048 sc1
buffer_load_dwordx4 v[108:111], v4, s[8:11], s25 offen offset:0 sc1
s_add_u32 s24, s20, 96661504
s_add_u32 s25, s24, 4096
buffer_load_dwordx4 v[112:115], v4, s[8:11], s24 offen offset:0 sc1
buffer_load_dwordx4 v[116:119], v4, s[8:11], s24 offen offset:2048 sc1
buffer_load_dwordx4 v[120:123], v4, s[8:11], s25 offen offset:0 sc1
s_waitcnt vmcnt(26)
v_lshlrev_b32 v128, 16, v16
v_and_b32 v129, 0xffff0000, v16
v_lshlrev_b32 v130, 16, v17
v_and_b32 v131, 0xffff0000, v17
v_lshlrev_b32 v132, 16, v18
v_and_b32 v133, 0xffff0000, v18
v_lshlrev_b32 v134, 16, v19
v_and_b32 v135, 0xffff0000, v19
s_waitcnt vmcnt(25)
v_lshlrev_b32 v136, 16, v20
v_and_b32 v137, 0xffff0000, v20
v_lshlrev_b32 v138, 16, v21
v_and_b32 v139, 0xffff0000, v21
v_lshlrev_b32 v140, 16, v22
v_and_b32 v141, 0xffff0000, v22
v_lshlrev_b32 v142, 16, v23
v_and_b32 v143, 0xffff0000, v23
s_waitcnt vmcnt(24)
v_lshlrev_b32 v144, 16, v24
v_and_b32 v145, 0xffff0000, v24
v_lshlrev_b32 v146, 16, v25
v_and_b32 v147, 0xffff0000, v25
v_lshlrev_b32 v148, 16, v26
v_and_b32 v149, 0xffff0000, v26
v_lshlrev_b32 v150, 16, v27
v_and_b32 v151, 0xffff0000, v27
s_waitcnt vmcnt(23)
v_lshlrev_b32 v6, 16, v28
v_and_b32 v7, 0xffff0000, v28
v_add_f32 v128, v128, v6
v_add_f32 v129, v129, v7
v_lshlrev_b32 v8, 16, v29
v_and_b32 v9, 0xffff0000, v29
v_add_f32 v130, v130, v8
v_add_f32 v131, v131, v9
v_lshlrev_b32 v6, 16, v30
v_and_b32 v7, 0xffff0000, v30
v_add_f32 v132, v132, v6
v_add_f32 v133, v133, v7
v_lshlrev_b32 v8, 16, v31
v_and_b32 v9, 0xffff0000, v31
v_add_f32 v134, v134, v8
v_add_f32 v135, v135, v9
s_waitcnt vmcnt(22)
v_lshlrev_b32 v6, 16, v32
v_and_b32 v7, 0xffff0000, v32
v_add_f32 v136, v136, v6
v_add_f32 v137, v137, v7
v_lshlrev_b32 v8, 16, v33
v_and_b32 v9, 0xffff0000, v33
v_add_f32 v138, v138, v8
v_add_f32 v139, v139, v9
v_lshlrev_b32 v6, 16, v34
v_and_b32 v7, 0xffff0000, v34
v_add_f32 v140, v140, v6
v_add_f32 v141, v141, v7
v_lshlrev_b32 v8, 16, v35
v_and_b32 v9, 0xffff0000, v35
v_add_f32 v142, v142, v8
v_add_f32 v143, v143, v9
s_waitcnt vmcnt(21)
v_lshlrev_b32 v6, 16, v36
v_and_b32 v7, 0xffff0000, v36
v_add_f32 v144, v144, v6
v_add_f32 v145, v145, v7
v_lshlrev_b32 v8, 16, v37
v_and_b32 v9, 0xffff0000, v37
v_add_f32 v146, v146, v8
v_add_f32 v147, v147, v9
v_lshlrev_b32 v6, 16, v38
v_and_b32 v7, 0xffff0000, v38
v_add_f32 v148, v148, v6
v_add_f32 v149, v149, v7
v_lshlrev_b32 v8, 16, v39
v_and_b32 v9, 0xffff0000, v39
v_add_f32 v150, v150, v8
v_add_f32 v151, v151, v9
s_waitcnt vmcnt(20)
v_lshlrev_b32 v6, 16, v40
v_and_b32 v7, 0xffff0000, v40
v_add_f32 v128, v128, v6
v_add_f32 v129, v129, v7
v_lshlrev_b32 v8, 16, v41
v_and_b32 v9, 0xffff0000, v41
v_add_f32 v130, v130, v8
v_add_f32 v131, v131, v9
v_lshlrev_b32 v6, 16, v42
v_and_b32 v7, 0xffff0000, v42
v_add_f32 v132, v132, v6
v_add_f32 v133, v133, v7
v_lshlrev_b32 v8, 16, v43
v_and_b32 v9, 0xffff0000, v43
v_add_f32 v134, v134, v8
v_add_f32 v135, v135, v9
s_waitcnt vmcnt(19)
v_lshlrev_b32 v6, 16, v44
v_and_b32 v7, 0xffff0000, v44
v_add_f32 v136, v136, v6
v_add_f32 v137, v137, v7
v_lshlrev_b32 v8, 16, v45
v_and_b32 v9, 0xffff0000, v45
v_add_f32 v138, v138, v8
v_add_f32 v139, v139, v9
v_lshlrev_b32 v6, 16, v46
v_and_b32 v7, 0xffff0000, v46
v_add_f32 v140, v140, v6
v_add_f32 v141, v141, v7
v_lshlrev_b32 v8, 16, v47
v_and_b32 v9, 0xffff0000, v47
v_add_f32 v142, v142, v8
v_add_f32 v143, v143, v9
s_waitcnt vmcnt(18)
v_lshlrev_b32 v6, 16, v48
v_and_b32 v7, 0xffff0000, v48
v_add_f32 v144, v144, v6
v_add_f32 v145, v145, v7
v_lshlrev_b32 v8, 16, v49
v_and_b32 v9, 0xffff0000, v49
v_add_f32 v146, v146, v8
v_add_f32 v147, v147, v9
v_lshlrev_b32 v6, 16, v50
v_and_b32 v7, 0xffff0000, v50
v_add_f32 v148, v148, v6
v_add_f32 v149, v149, v7
v_lshlrev_b32 v8, 16, v51
v_and_b32 v9, 0xffff0000, v51
v_add_f32 v150, v150, v8
v_add_f32 v151, v151, v9
s_waitcnt vmcnt(17)
v_lshlrev_b32 v6, 16, v52
v_and_b32 v7, 0xffff0000, v52
v_add_f32 v128, v128, v6
v_add_f32 v129, v129, v7
v_lshlrev_b32 v8, 16, v53
v_and_b32 v9, 0xffff0000, v53
v_add_f32 v130, v130, v8
v_add_f32 v131, v131, v9
v_lshlrev_b32 v6, 16, v54
v_and_b32 v7, 0xffff0000, v54
v_add_f32 v132, v132, v6
v_add_f32 v133, v133, v7
v_lshlrev_b32 v8, 16, v55
v_and_b32 v9, 0xffff0000, v55
v_add_f32 v134, v134, v8
v_add_f32 v135, v135, v9
s_waitcnt vmcnt(16)
v_lshlrev_b32 v6, 16, v56
v_and_b32 v7, 0xffff0000, v56
v_add_f32 v136, v136, v6
v_add_f32 v137, v137, v7
v_lshlrev_b32 v8, 16, v57
v_and_b32 v9, 0xffff0000, v57
v_add_f32 v138, v138, v8
v_add_f32 v139, v139, v9
v_lshlrev_b32 v6, 16, v58
v_and_b32 v7, 0xffff0000, v58
v_add_f32 v140, v140, v6
v_add_f32 v141, v141, v7
v_lshlrev_b32 v8, 16, v59
v_and_b32 v9, 0xffff0000, v59
v_add_f32 v142, v142, v8
v_add_f32 v143, v143, v9
s_waitcnt vmcnt(15)
v_lshlrev_b32 v6, 16, v60
v_and_b32 v7, 0xffff0000, v60
v_add_f32 v144, v144, v6
v_add_f32 v145, v145, v7
v_lshlrev_b32 v8, 16, v61
v_and_b32 v9, 0xffff0000, v61
v_add_f32 v146, v146, v8
v_add_f32 v147, v147, v9
v_lshlrev_b32 v6, 16, v62
v_and_b32 v7, 0xffff0000, v62
v_add_f32 v148, v148, v6
v_add_f32 v149, v149, v7
v_lshlrev_b32 v8, 16, v63
v_and_b32 v9, 0xffff0000, v63
v_add_f32 v150, v150, v8
v_add_f32 v151, v151, v9
s_waitcnt vmcnt(14)
v_lshlrev_b32 v6, 16, v64
v_and_b32 v7, 0xffff0000, v64
v_add_f32 v128, v128, v6
v_add_f32 v129, v129, v7
v_lshlrev_b32 v8, 16, v65
v_and_b32 v9, 0xffff0000, v65
v_add_f32 v130, v130, v8
v_add_f32 v131, v131, v9
v_lshlrev_b32 v6, 16, v66
v_and_b32 v7, 0xffff0000, v66
v_add_f32 v132, v132, v6
v_add_f32 v133, v133, v7
v_lshlrev_b32 v8, 16, v67
v_and_b32 v9, 0xffff0000, v67
v_add_f32 v134, v134, v8
v_add_f32 v135, v135, v9
s_waitcnt vmcnt(13)
v_lshlrev_b32 v6, 16, v68
v_and_b32 v7, 0xffff0000, v68
v_add_f32 v136, v136, v6
v_add_f32 v137, v137, v7
v_lshlrev_b32 v8, 16, v69
v_and_b32 v9, 0xffff0000, v69
v_add_f32 v138, v138, v8
v_add_f32 v139, v139, v9
v_lshlrev_b32 v6, 16, v70
v_and_b32 v7, 0xffff0000, v70
v_add_f32 v140, v140, v6
v_add_f32 v141, v141, v7
v_lshlrev_b32 v8, 16, v71
v_and_b32 v9, 0xffff0000, v71
v_add_f32 v142, v142, v8
v_add_f32 v143, v143, v9
s_waitcnt vmcnt(12)
v_lshlrev_b32 v6, 16, v72
v_and_b32 v7, 0xffff0000, v72
v_add_f32 v144, v144, v6
v_add_f32 v145, v145, v7
v_lshlrev_b32 v8, 16, v73
v_and_b32 v9, 0xffff0000, v73
v_add_f32 v146, v146, v8
v_add_f32 v147, v147, v9
v_lshlrev_b32 v6, 16, v74
v_and_b32 v7, 0xffff0000, v74
v_add_f32 v148, v148, v6
v_add_f32 v149, v149, v7
v_lshlrev_b32 v8, 16, v75
v_and_b32 v9, 0xffff0000, v75
v_add_f32 v150, v150, v8
v_add_f32 v151, v151, v9
s_waitcnt vmcnt(11)
v_lshlrev_b32 v6, 16, v76
v_and_b32 v7, 0xffff0000, v76
v_add_f32 v128, v128, v6
v_add_f32 v129, v129, v7
v_lshlrev_b32 v8, 16, v77
v_and_b32 v9, 0xffff0000, v77
v_add_f32 v130, v130, v8
v_add_f32 v131, v131, v9
v_lshlrev_b32 v6, 16, v78
v_and_b32 v7, 0xffff0000, v78
v_add_f32 v132, v132, v6
v_add_f32 v133, v133, v7
v_lshlrev_b32 v8, 16, v79
v_and_b32 v9, 0xffff0000, v79
v_add_f32 v134, v134, v8
v_add_f32 v135, v135, v9
s_waitcnt vmcnt(10)
v_lshlrev_b32 v6, 16, v80
v_and_b32 v7, 0xffff0000, v80
v_add_f32 v136, v136, v6
v_add_f32 v137, v137, v7
v_lshlrev_b32 v8, 16, v81
v_and_b32 v9, 0xffff0000, v81
v_add_f32 v138, v138, v8
v_add_f32 v139, v139, v9
v_lshlrev_b32 v6, 16, v82
v_and_b32 v7, 0xffff0000, v82
v_add_f32 v140, v140, v6
v_add_f32 v141, v141, v7
v_lshlrev_b32 v8, 16, v83
v_and_b32 v9, 0xffff0000, v83
v_add_f32 v142, v142, v8
v_add_f32 v143, v143, v9
s_waitcnt vmcnt(9)
v_lshlrev_b32 v6, 16, v84
v_and_b32 v7, 0xffff0000, v84
v_add_f32 v144, v144, v6
v_add_f32 v145, v145, v7
v_lshlrev_b32 v8, 16, v85
v_and_b32 v9, 0xffff0000, v85
v_add_f32 v146, v146, v8
v_add_f32 v147, v147, v9
v_lshlrev_b32 v6, 16, v86
v_and_b32 v7, 0xffff0000, v86
v_add_f32 v148, v148, v6
v_add_f32 v149, v149, v7
v_lshlrev_b32 v8, 16, v87
v_and_b32 v9, 0xffff0000, v87
v_add_f32 v150, v150, v8
v_add_f32 v151, v151, v9
s_waitcnt vmcnt(8)
v_lshlrev_b32 v6, 16, v88
v_and_b32 v7, 0xffff0000, v88
v_add_f32 v128, v128, v6
v_add_f32 v129, v129, v7
v_lshlrev_b32 v8, 16, v89
v_and_b32 v9, 0xffff0000, v89
v_add_f32 v130, v130, v8
v_add_f32 v131, v131, v9
v_lshlrev_b32 v6, 16, v90
v_and_b32 v7, 0xffff0000, v90
v_add_f32 v132, v132, v6
v_add_f32 v133, v133, v7
v_lshlrev_b32 v8, 16, v91
v_and_b32 v9, 0xffff0000, v91
v_add_f32 v134, v134, v8
v_add_f32 v135, v135, v9
s_waitcnt vmcnt(7)
v_lshlrev_b32 v6, 16, v92
v_and_b32 v7, 0xffff0000, v92
v_add_f32 v136, v136, v6
v_add_f32 v137, v137, v7
v_lshlrev_b32 v8, 16, v93
v_and_b32 v9, 0xffff0000, v93
v_add_f32 v138, v138, v8
v_add_f32 v139, v139, v9
v_lshlrev_b32 v6, 16, v94
v_and_b32 v7, 0xffff0000, v94
v_add_f32 v140, v140, v6
v_add_f32 v141, v141, v7
v_lshlrev_b32 v8, 16, v95
v_and_b32 v9, 0xffff0000, v95
v_add_f32 v142, v142, v8
v_add_f32 v143, v143, v9
s_waitcnt vmcnt(6)
v_lshlrev_b32 v6, 16, v96
v_and_b32 v7, 0xffff0000, v96
v_add_f32 v144, v144, v6
v_add_f32 v145, v145, v7
v_lshlrev_b32 v8, 16, v97
v_and_b32 v9, 0xffff0000, v97
v_add_f32 v146, v146, v8
v_add_f32 v147, v147, v9
v_lshlrev_b32 v6, 16, v98
v_and_b32 v7, 0xffff0000, v98
v_add_f32 v148, v148, v6
v_add_f32 v149, v149, v7
v_lshlrev_b32 v8, 16, v99
v_and_b32 v9, 0xffff0000, v99
v_add_f32 v150, v150, v8
v_add_f32 v151, v151, v9
s_waitcnt vmcnt(5)
v_lshlrev_b32 v6, 16, v100
v_and_b32 v7, 0xffff0000, v100
v_add_f32 v128, v128, v6
v_add_f32 v129, v129, v7
v_lshlrev_b32 v8, 16, v101
v_and_b32 v9, 0xffff0000, v101
v_add_f32 v130, v130, v8
v_add_f32 v131, v131, v9
v_lshlrev_b32 v6, 16, v102
v_and_b32 v7, 0xffff0000, v102
v_add_f32 v132, v132, v6
v_add_f32 v133, v133, v7
v_lshlrev_b32 v8, 16, v103
v_and_b32 v9, 0xffff0000, v103
v_add_f32 v134, v134, v8
v_add_f32 v135, v135, v9
s_waitcnt vmcnt(4)
v_lshlrev_b32 v6, 16, v104
v_and_b32 v7, 0xffff0000, v104
v_add_f32 v136, v136, v6
v_add_f32 v137, v137, v7
v_lshlrev_b32 v8, 16, v105
v_and_b32 v9, 0xffff0000, v105
v_add_f32 v138, v138, v8
v_add_f32 v139, v139, v9
v_lshlrev_b32 v6, 16, v106
v_and_b32 v7, 0xffff0000, v106
v_add_f32 v140, v140, v6
v_add_f32 v141, v141, v7
v_lshlrev_b32 v8, 16, v107
v_and_b32 v9, 0xffff0000, v107
v_add_f32 v142, v142, v8
v_add_f32 v143, v143, v9
s_waitcnt vmcnt(3)
v_lshlrev_b32 v6, 16, v108
v_and_b32 v7, 0xffff0000, v108
v_add_f32 v144, v144, v6
v_add_f32 v145, v145, v7
v_lshlrev_b32 v8, 16, v109
v_and_b32 v9, 0xffff0000, v109
v_add_f32 v146, v146, v8
v_add_f32 v147, v147, v9
v_lshlrev_b32 v6, 16, v110
v_and_b32 v7, 0xffff0000, v110
v_add_f32 v148, v148, v6
v_add_f32 v149, v149, v7
v_lshlrev_b32 v8, 16, v111
v_and_b32 v9, 0xffff0000, v111
v_add_f32 v150, v150, v8
v_add_f32 v151, v151, v9
s_waitcnt vmcnt(2)
v_lshlrev_b32 v6, 16, v112
v_and_b32 v7, 0xffff0000, v112
v_add_f32 v128, v128, v6
v_add_f32 v129, v129, v7
v_lshlrev_b32 v8, 16, v113
v_and_b32 v9, 0xffff0000, v113
v_add_f32 v130, v130, v8
v_add_f32 v131, v131, v9
v_lshlrev_b32 v6, 16, v114
v_and_b32 v7, 0xffff0000, v114
v_add_f32 v132, v132, v6
v_add_f32 v133, v133, v7
v_lshlrev_b32 v8, 16, v115
v_and_b32 v9, 0xffff0000, v115
v_add_f32 v134, v134, v8
v_add_f32 v135, v135, v9
s_waitcnt vmcnt(1)
v_lshlrev_b32 v6, 16, v116
v_and_b32 v7, 0xffff0000, v116
v_add_f32 v136, v136, v6
v_add_f32 v137, v137, v7
v_lshlrev_b32 v8, 16, v117
v_and_b32 v9, 0xffff0000, v117
v_add_f32 v138, v138, v8
v_add_f32 v139, v139, v9
v_lshlrev_b32 v6, 16, v118
v_and_b32 v7, 0xffff0000, v118
v_add_f32 v140, v140, v6
v_add_f32 v141, v141, v7
v_lshlrev_b32 v8, 16, v119
v_and_b32 v9, 0xffff0000, v119
v_add_f32 v142, v142, v8
v_add_f32 v143, v143, v9
s_waitcnt vmcnt(0)
v_lshlrev_b32 v6, 16, v120
v_and_b32 v7, 0xffff0000, v120
v_add_f32 v144, v144, v6
v_add_f32 v145, v145, v7
v_lshlrev_b32 v8, 16, v121
v_and_b32 v9, 0xffff0000, v121
v_add_f32 v146, v146, v8
v_add_f32 v147, v147, v9
v_lshlrev_b32 v6, 16, v122
v_and_b32 v7, 0xffff0000, v122
v_add_f32 v148, v148, v6
v_add_f32 v149, v149, v7
v_lshlrev_b32 v8, 16, v123
v_and_b32 v9, 0xffff0000, v123
v_add_f32 v150, v150, v8
v_add_f32 v151, v151, v9
v_cvt_pk_bf16_f32 v152, v128, v129
v_cvt_pk_bf16_f32 v153, v130, v131
v_cvt_pk_bf16_f32 v154, v132, v133
v_cvt_pk_bf16_f32 v155, v134, v135
v_cvt_pk_bf16_f32 v156, v136, v137
v_cvt_pk_bf16_f32 v157, v138, v139
v_cvt_pk_bf16_f32 v158, v140, v141
v_cvt_pk_bf16_f32 v159, v142, v143
v_cvt_pk_bf16_f32 v160, v144, v145
v_cvt_pk_bf16_f32 v161, v146, v147
v_cvt_pk_bf16_f32 v162, v148, v149
v_cvt_pk_bf16_f32 v163, v150, v151
s_add_u32 s24, s20, 30339072
s_add_u32 s25, s24, 4096
buffer_store_dwordx4 v[152:155], v4, s[8:11], s24 offen offset:0 sc1
buffer_store_dwordx4 v[156:159], v4, s[8:11], s24 offen offset:2048 sc1
buffer_store_dwordx4 v[160:163], v4, s[8:11], s25 offen offset:0 sc1
v_add_f32 v6, v128, v129
v_mul_f32 v7, v128, v128
v_mul_f32 v9, v129, v129
v_mov_b32 v8, 0
v_add_f32 v6, v6, v130
v_add_f32 v8, v8, v131
v_fmac_f32 v7, v130, v130
v_fmac_f32 v9, v131, v131
v_add_f32 v6, v6, v132
v_add_f32 v8, v8, v133
v_fmac_f32 v7, v132, v132
v_fmac_f32 v9, v133, v133
v_add_f32 v6, v6, v134
v_add_f32 v8, v8, v135
v_fmac_f32 v7, v134, v134
v_fmac_f32 v9, v135, v135
v_add_f32 v6, v6, v136
v_add_f32 v8, v8, v137
v_fmac_f32 v7, v136, v136
v_fmac_f32 v9, v137, v137
v_add_f32 v6, v6, v138
v_add_f32 v8, v8, v139
v_fmac_f32 v7, v138, v138
v_fmac_f32 v9, v139, v139
v_add_f32 v6, v6, v140
v_add_f32 v8, v8, v141
v_fmac_f32 v7, v140, v140
v_fmac_f32 v9, v141, v141
v_add_f32 v6, v6, v142
v_add_f32 v8, v8, v143
v_fmac_f32 v7, v142, v142
v_fmac_f32 v9, v143, v143
v_add_f32 v6, v6, v144
v_add_f32 v8, v8, v145
v_fmac_f32 v7, v144, v144
v_fmac_f32 v9, v145, v145
v_add_f32 v6, v6, v146
v_add_f32 v8, v8, v147
v_fmac_f32 v7, v146, v146
v_fmac_f32 v9, v147, v147
v_add_f32 v6, v6, v148
v_add_f32 v8, v8, v149
v_fmac_f32 v7, v148, v148
v_fmac_f32 v9, v149, v149
v_add_f32 v6, v6, v150
v_add_f32 v8, v8, v151
v_fmac_f32 v7, v150, v150
v_fmac_f32 v9, v151, v151
v_add_f32 v6, v6, v8
v_add_f32 v7, v7, v9
s_nop 0
v_add_f32_dpp v6, v6, v6 row_ror:8 row_mask:0xf bank_mask:0xf
v_add_f32_dpp v7, v7, v7 row_ror:8 row_mask:0xf bank_mask:0xf
v_mov_b32 v8, v6
v_mov_b32 v9, v7
s_nop 0
v_permlane16_swap_b32 v6, v8
v_permlane16_swap_b32 v7, v9
v_add_f32 v6, v6, v8
v_add_f32 v7, v7, v9
v_mov_b32 v8, v6
v_mov_b32 v9, v7
s_nop 0
v_permlane32_swap_b32 v6, v8
v_permlane32_swap_b32 v7, v9
v_add_f32 v6, v6, v8
v_add_f32 v7, v7, v9
v_and_b32 v10, 7, v1
v_lshlrev_b32 v10, 3, v10
v_add_u32 v10, 147456, v10
s_lshl_b32 s24, s4, 6
v_add_u32 v11, s24, v10
ds_write_b64 v11, v[6:7]
s_waitcnt lgkmcnt(0)
s_barrier
ds_read_b64 v[6:7], v10
ds_read_b64 v[8:9], v10 offset:64
ds_read_b64 v[12:13], v10 offset:128
s_waitcnt lgkmcnt(0)
v_add_f32 v6, v6, v8
v_add_f32 v7, v7, v9
v_add_f32 v6, v6, v12
v_add_f32 v7, v7, v13
v_mul_f32 v6, 0x3ae38e39, v6
v_mul_f32 v7, 0x3ae38e39, v7
v_fma_f32 v7, -v6, v6, v7
v_max_f32 v7, 0, v7
v_add_f32 v7, 0x3727c5ac, v7
v_rsq_f32 v7, v7
s_nop 0
v_mul_f32 v6, v6, v7
v_fma_f32 v128, v128, v7, -v6
v_fma_f32 v129, v129, v7, -v6
v_fma_f32 v130, v130, v7, -v6
v_fma_f32 v131, v131, v7, -v6
v_fma_f32 v132, v132, v7, -v6
v_fma_f32 v133, v133, v7, -v6
v_fma_f32 v134, v134, v7, -v6
v_fma_f32 v135, v135, v7, -v6
v_fma_f32 v136, v136, v7, -v6
v_fma_f32 v137, v137, v7, -v6
v_fma_f32 v138, v138, v7, -v6
v_fma_f32 v139, v139, v7, -v6
v_fma_f32 v140, v140, v7, -v6
v_fma_f32 v141, v141, v7, -v6
v_fma_f32 v142, v142, v7, -v6
v_fma_f32 v143, v143, v7, -v6
v_fma_f32 v144, v144, v7, -v6
v_fma_f32 v145, v145, v7, -v6
v_fma_f32 v146, v146, v7, -v6
v_fma_f32 v147, v147, v7, -v6
v_fma_f32 v148, v148, v7, -v6
v_fma_f32 v149, v149, v7, -v6
v_fma_f32 v150, v150, v7, -v6
v_fma_f32 v151, v151, v7, -v6
v_cvt_pk_bf16_f32 v168, v128, v129
v_cvt_pk_bf16_f32 v169, v130, v131
v_cvt_pk_bf16_f32 v170, v132, v133
v_cvt_pk_bf16_f32 v171, v134, v135
v_cvt_pk_bf16_f32 v172, v136, v137
v_cvt_pk_bf16_f32 v173, v138, v139
v_cvt_pk_bf16_f32 v174, v140, v141
v_cvt_pk_bf16_f32 v175, v142, v143
v_cvt_pk_bf16_f32 v176, v144, v145
v_cvt_pk_bf16_f32 v177, v146, v147
v_cvt_pk_bf16_f32 v178, v148, v149
v_cvt_pk_bf16_f32 v179, v150, v151
s_add_u32 s24, s20, 25620480
s_add_u32 s25, s24, 4096
buffer_store_dwordx4 v[168:171], v4, s[8:11], s24 offen offset:0 sc1
buffer_store_dwordx4 v[172:175], v4, s[8:11], s24 offen offset:2048 sc1
buffer_store_dwordx4 v[176:179], v4, s[8:11], s25 offen offset:0 sc1
s_lshl_b32 s24, s5, 4
s_lshr_b32 s25, s6, 1
s_add_u32 s24, s24, s25
s_lshl_b32 s24, s24, 3
s_and_b32 s25, s6, 1
s_mul_i32 s25, s25, 3
s_add_u32 s24, s24, s25
s_add_u32 s24, s24, s4
s_lshl_b32 s24, s24, 7
s_add_u32 s24, s24, 1835008
v_mov_b32 v13, 2146435072
v_cmp_eq_u32 vcc, 0, v1
v_mov_b32 v14, s68
v_mov_b32 v15, s69
v_cndmask_b32 v13, v13, 0, vcc
s_waitcnt vmcnt(0)
buffer_store_dwordx2 v[14:15], v13, s[8:11], s24 offen sc1
s_branch L_r_done
L_r_side:
s_barrier
s_waitcnt vmcnt(0)
L_r_done:
s_barrier
s_mov_b32 s70, 25620480
s_mov_b32 s71, 30339072
s_mov_b32 s72, 35057664
s_mov_b32 s73, 39776256
s_mov_b32 s74, 42266624
s_mov_b32 s75, 61272064
s_mov_b32 s76, 99020800
s_mov_b32 s77, 1048576
s_mov_b32 s7, 1
s_lshr_b32 s20, s5, 2
s_lshl_b32 s20, s20, 3
s_lshr_b32 s21, s6, 2
s_add_u32 s20, s20, s21
s_and_b32 s21, s5, 3
s_lshl_b32 s21, s21, 2
s_and_b32 s22, s6, 3
s_add_u32 s21, s21, s22
s_lshl_b32 s24, s20, 3
s_sub_u32 s25, s24, 1
s_max_i32 s35, s25, 0
s_mul_i32 s25, s35, 18432
s_lshl_b32 s26, s4, 1
s_add_u32 s36, s24, s26
s_mul_i32 s24, s36, 18432
s_add_u32 s26, s24, s70
s_add_u32 s27, s26, 18432
s_add_u32 s28, s25, s70
v_add_u32 v4, 0x10000, v2
v_add_u32 v5, 0x20000, v2
s_cmp_eq_u32 s4, 3
s_cselect_b32 s29, 0, s4
s_cselect_b32 s31, 16, 9
s_lshl_b32 s30, s29, 10
v_and_b32 v12, 15, v1
v_mov_b32 v13, 2146435072
v_cmp_le_u32 vcc, s31, v12
s_nop 1
v_cndmask_b32 v3, v13, v2, vcc
s_add_u32 s31, s30, 2048
v_add_u32 v6, s31, v2
v_add_u32 v7, s31, v4
v_add_u32 v8, s31, v5
s_add_u32 s31, s30, 5120
v_add_u32 v9, s31, v2
v_add_u32 v10, s31, v4
v_add_u32 v11, s31, v5
v_mul_u32_u24 v14, 43, v1
v_lshrrev_b32 v14, 8, v14
v_mul_u32_u24 v15, 6, v14
v_sub_u32 v15, v1, v15
v_cmp_eq_u32 vcc, 1, v14
v_mov_b32 v16, s36
s_nop 0
v_addc_co_u32 v16, vcc, 0, v16, vcc
v_cmp_eq_u32 vcc, 2, v14
v_mov_b32 v17, s35
s_nop 0
v_cndmask_b32 v16, v16, v17, vcc
v_lshlrev_b32 v16, 3, v16
v_add_lshl_u32 v16, v16, v15, 7
s_add_u32 s22, s77, 786432
s_mov_b32 s52, 0
L_poll6:
buffer_load_dwordx2 v[14:15], v16, s[8:11], s22 offen sc1
s_add_u32 s52, s52, 1
s_waitcnt vmcnt(0)
v_cmp_ne_u64 vcc, s[68:69], v[14:15]
s_cmp_ge_u32 s52, 0x100000
s_cbranch_scc1 L_got6
s_and_b64 exec, exec, vcc
s_cbranch_execnz L_poll6
L_got6:
s_mov_b64 exec, -1
buffer_load_dwordx4 a[0:3], v2, s[8:11], s26 offen offset:0 sc1
buffer_load_dwordx4 a[72:75], v2, s[8:11], s27 offen offset:0 sc1
buffer_load_dwordx4 a[144:147], v3, s[8:11], s28 offen offset:0 sc1
buffer_load_dwordx4 a[4:7], v2, s[8:11], s26 offen offset:1024 sc1
buffer_load_dwordx4 a[76:79], v2, s[8:11], s27 offen offset:1024 sc1
buffer_load_dwordx4 a[148:151], v3, s[8:11], s28 offen offset:1024 sc1
buffer_load_dwordx4 a[8:11], v2, s[8:11], s26 offen offset:2048 sc1
buffer_load_dwordx4 a[80:83], v2, s[8:11], s27 offen offset:2048 sc1
buffer_load_dwordx4 a[152:155], v3, s[8:11], s28 offen offset:2048 sc1
buffer_load_dwordx4 a[12:15], v2, s[8:11], s26 offen offset:3072 sc1
buffer_load_dwordx4 a[84:87], v2, s[8:11], s27 offen offset:3072 sc1
buffer_load_dwordx4 a[156:159], v3, s[8:11], s28 offen offset:3072 sc1
s_add_u32 s26, s26, 4096
s_add_u32 s27, s27, 4096
s_add_u32 s28, s28, 4096
buffer_load_dwordx4 a[16:19], v2, s[8:11], s26 offen offset:0 sc1
buffer_load_dwordx4 a[88:91], v2, s[8:11], s27 offen offset:0 sc1
buffer_load_dwordx4 a[160:163], v3, s[8:11], s28 offen offset:0 sc1
buffer_load_dwordx4 a[20:23], v2, s[8:11], s26 offen offset:1024 sc1
buffer_load_dwordx4 a[92:95], v2, s[8:11], s27 offen offset:1024 sc1
buffer_load_dwordx4 a[164:167], v3, s[8:11], s28 offen offset:1024 sc1
buffer_load_dwordx4 a[24:27], v2, s[8:11], s26 offen offset:2048 sc1
buffer_load_dwordx4 a[96:99], v2, s[8:11], s27 offen offset:2048 sc1
buffer_load_dwordx4 a[168:171], v3, s[8:11], s28 offen offset:2048 sc1
buffer_load_dwordx4 a[28:31], v2, s[8:11], s26 offen offset:3072 sc1
buffer_load_dwordx4 a[100:103], v2, s[8:11], s27 offen offset:3072 sc1
buffer_load_dwordx4 a[172:175], v3, s[8:11], s28 offen offset:3072 sc1
v_lshrrev_b32 v13, 4, v1
v_lshlrev_b32 v14, 2, v13
v_sub_u32 v14, v12, v14
v_subrev_u32 v15, 0, v14
v_cmp_gt_u32 s[52:53], 8, v15
v_cmp_gt_i32 s[44:45], -8, v15
v_subrev_u32 v15, 1, v14
v_cmp_gt_u32 s[54:55], 8, v15
v_cmp_gt_i32 s[46:47], -8, v15
v_subrev_u32 v15, 2, v14
v_cmp_gt_u32 s[56:57], 8, v15
v_cmp_gt_i32 s[48:49], -8, v15
v_subrev_u32 v15, 3, v14
v_cmp_gt_u32 s[58:59], 8, v15
v_cmp_gt_i32 s[50:51], -8, v15
s_and_b32 s31, s20, 7
s_or_b32 s31, s31, s4
s_cmp_eq_u32 s31, 0
s_cselect_b64 s[60:61], 0, s[44:45]
s_cselect_b64 s[62:63], 0, s[46:47]
s_cselect_b64 s[64:65], 0, s[48:49]
s_cselect_b64 s[66:67], 0, s[50:51]
ds_read_b128 a[216:219], v2 offset:0
ds_read_b128 a[220:223], v2 offset:8192
ds_read_b128 a[224:227], v2 offset:1024
ds_read_b128 a[228:231], v2 offset:9216
ds_read_b128 a[232:235], v2 offset:2048
ds_read_b128 a[236:239], v2 offset:10240
s_waitcnt vmcnt(18)
s_waitcnt lgkmcnt(4)
v_mfma_f32_16x16x32_bf16 v[32:35], a[216:219], a[0:3], 0
s_add_u32 s26, s26, 4096
s_add_u32 s27, s27, 4096
s_add_u32 s28, s28, 4096
buffer_load_dwordx4 a[32:35], v2, s[8:11], s26 offen offset:0 sc1
v_mfma_f32_16x16x32_bf16 v[32:35], a[220:223], a[4:7], v[32:35]
ds_read_b128 a[240:243], v2 offset:3072
v_mfma_f32_16x16x32_bf16 v[36:39], a[216:219], a[72:75], 0
v_mfma_f32_16x16x32_bf16 v[36:39], a[220:223], a[76:79], v[36:39]
ds_read_b128 a[244:247], v2 offset:11264
s_waitcnt lgkmcnt(4)
v_mfma_f32_16x16x32_bf16 v[40:43], a[224:227], a[0:3], 0
buffer_load_dwordx4 a[104:107], v2, s[8:11], s27 offen offset:0 sc1
v_mfma_f32_16x16x32_bf16 v[40:43], a[228:231], a[4:7], v[40:43]
ds_read_b128 a[216:219], v2 offset:4096
v_mfma_f32_16x16x32_bf16 v[44:47], a[224:227], a[72:75], 0
v_mfma_f32_16x16x32_bf16 v[44:47], a[228:231], a[76:79], v[44:47]
ds_read_b128 a[220:223], v2 offset:12288
s_waitcnt lgkmcnt(4)
v_mfma_f32_16x16x32_bf16 v[48:51], a[232:235], a[0:3], 0
buffer_load_dwordx4 a[176:179], v3, s[8:11], s28 offen offset:0 sc1
v_mfma_f32_16x16x32_bf16 v[48:51], a[236:239], a[4:7], v[48:51]
ds_read_b128 a[224:227], v2 offset:5120
v_mfma_f32_16x16x32_bf16 v[52:55], a[232:235], a[72:75], 0
v_mfma_f32_16x16x32_bf16 v[52:55], a[236:239], a[76:79], v[52:55]
ds_read_b128 a[228:231], v2 offset:13312
s_waitcnt lgkmcnt(4)
v_mfma_f32_16x16x32_bf16 v[56:59], a[240:243], a[0:3], 0
buffer_load_dwordx4 a[36:39], v2, s[8:11], s26 offen offset:1024 sc1
v_mfma_f32_16x16x32_bf16 v[56:59], a[244:247], a[4:7], v[56:59]
ds_read_b128 a[232:235], v2 offset:6144
v_mfma_f32_16x16x32_bf16 v[60:63], a[240:243], a[72:75], 0
v_mfma_f32_16x16x32_bf16 v[60:63], a[244:247], a[76:79], v[60:63]
ds_read_b128 a[236:239], v2 offset:14336
s_waitcnt lgkmcnt(4)
v_mfma_f32_16x16x32_bf16 v[64:67], a[216:219], a[0:3], 0
buffer_load_dwordx4 a[108:111], v2, s[8:11], s27 offen offset:1024 sc1
v_mfma_f32_16x16x32_bf16 v[64:67], a[220:223], a[4:7], v[64:67]
ds_read_b128 a[240:243], v2 offset:7168
v_mfma_f32_16x16x32_bf16 v[68:71], a[216:219], a[72:75], 0
v_mfma_f32_16x16x32_bf16 v[68:71], a[220:223], a[76:79], v[68:71]
ds_read_b128 a[244:247], v2 offset:15360
s_waitcnt lgkmcnt(4)
v_mfma_f32_16x16x32_bf16 v[72:75], a[0:3], a[224:227], 0
buffer_load_dwordx4 a[180:183], v3, s[8:11], s28 offen offset:1024 sc1
v_mfma_f32_16x16x32_bf16 v[72:75], a[4:7], a[228:231], v[72:75]
ds_read_b128 a[216:219], v6 offset:0
v_mfma_f32_16x16x32_bf16 v[76:79], a[72:75], a[224:227], 0
v_mfma_f32_16x16x32_bf16 v[76:79], a[76:79], a[228:231], v[76:79]
ds_read_b128 a[220:223], v6 offset:8192
s_waitcnt lgkmcnt(4)
v_mfma_f32_16x16x32_bf16 v[80:83], a[0:3], a[232:235], 0
buffer_load_dwordx4 a[40:43], v2, s[8:11], s26 offen offset:2048 sc1
v_mfma_f32_16x16x32_bf16 v[80:83], a[4:7], a[236:239], v[80:83]
ds_read_b128 a[224:227], v9 offset:0
v_mfma_f32_16x16x32_bf16 v[84:87], a[72:75], a[232:235], 0
v_mfma_f32_16x16x32_bf16 v[84:87], a[76:79], a[236:239], v[84:87]
ds_read_b128 a[228:231], v9 offset:8192
s_waitcnt lgkmcnt(4)
v_mfma_f32_16x16x32_bf16 v[88:91], a[0:3], a[240:243], 0
buffer_load_dwordx4 a[112:115], v2, s[8:11], s27 offen offset:2048 sc1
v_mfma_f32_16x16x32_bf16 v[88:91], a[4:7], a[244:247], v[88:91]
ds_read_b128 a[232:235], v2 offset:16384
v_mfma_f32_16x16x32_bf16 v[92:95], a[72:75], a[240:243], 0
v_mfma_f32_16x16x32_bf16 v[92:95], a[76:79], a[244:247], v[92:95]
ds_read_b128 a[236:239], v2 offset:24576
s_waitcnt lgkmcnt(4)
v_mfma_f32_16x16x32_bf16 v[96:99], a[216:219], a[144:147], 0
ds_read_b128 a[240:243], v2 offset:17408
buffer_load_dwordx4 a[184:187], v3, s[8:11], s28 offen offset:2048 sc1
v_mfma_f32_16x16x32_bf16 v[96:99], a[220:223], a[148:151], v[96:99]
ds_read_b128 a[244:247], v2 offset:25600
s_waitcnt lgkmcnt(4)
v_mfma_f32_16x16x32_bf16 v[100:103], a[144:147], a[224:227], 0
ds_read_b128 a[216:219], v2 offset:18432
v_mfma_f32_16x16x32_bf16 v[100:103], a[148:151], a[228:231], v[100:103]
ds_read_b128 a[220:223], v2 offset:26624
s_waitcnt vmcnt(21)
s_waitcnt lgkmcnt(4)
v_mfma_f32_16x16x32_bf16 v[32:35], a[232:235], a[8:11], v[32:35]
buffer_load_dwordx4 a[44:47], v2, s[8:11], s26 offen offset:3072 sc1
v_mfma_f32_16x16x32_bf16 v[32:35], a[236:239], a[12:15], v[32:35]
ds_read_b128 a[224:227], v2 offset:19456
v_mfma_f32_16x16x32_bf16 v[36:39], a[232:235], a[80:83], v[36:39]
v_mfma_f32_16x16x32_bf16 v[36:39], a[236:239], a[84:87], v[36:39]
ds_read_b128 a[228:231], v2 offset:27648
s_waitcnt lgkmcnt(4)
v_mfma_f32_16x16x32_bf16 v[40:43], a[240:243], a[8:11], v[40:43]
buffer_load_dwordx4 a[116:119], v2, s[8:11], s27 offen offset:3072 sc1
v_mfma_f32_16x16x32_bf16 v[40:43], a[244:247], a[12:15], v[40:43]
ds_read_b128 a[232:235], v2 offset:20480
v_mfma_f32_16x16x32_bf16 v[44:47], a[240:243], a[80:83], v[44:47]
v_mfma_f32_16x16x32_bf16 v[44:47], a[244:247], a[84:87], v[44:47]
ds_read_b128 a[236:239], v2 offset:28672
s_waitcnt lgkmcnt(4)
v_mfma_f32_16x16x32_bf16 v[48:51], a[216:219], a[8:11], v[48:51]
buffer_load_dwordx4 a[188:191], v3, s[8:11], s28 offen offset:3072 sc1
v_mfma_f32_16x16x32_bf16 v[48:51], a[220:223], a[12:15], v[48:51]
ds_read_b128 a[240:243], v2 offset:21504
v_mfma_f32_16x16x32_bf16 v[52:55], a[216:219], a[80:83], v[52:55]
v_mfma_f32_16x16x32_bf16 v[52:55], a[220:223], a[84:87], v[52:55]
ds_read_b128 a[244:247], v2 offset:29696
s_waitcnt lgkmcnt(4)
v_mfma_f32_16x16x32_bf16 v[56:59], a[224:227], a[8:11], v[56:59]
s_add_u32 s26, s26, 4096
s_add_u32 s27, s27, 4096
s_add_u32 s28, s28, 4096
buffer_load_dwordx4 a[48:51], v2, s[8:11], s26 offen offset:0 sc1
v_mfma_f32_16x16x32_bf16 v[56:59], a[228:231], a[12:15], v[56:59]
ds_read_b128 a[216:219], v2 offset:22528
v_mfma_f32_16x16x32_bf16 v[60:63], a[224:227], a[80:83], v[60:63]
v_mfma_f32_16x16x32_bf16 v[60:63], a[228:231], a[84:87], v[60:63]
ds_read_b128 a[220:223], v2 offset:30720
s_waitcnt lgkmcnt(4)
v_mfma_f32_16x16x32_bf16 v[64:67], a[232:235], a[8:11], v[64:67]
buffer_load_dwordx4 a[120:123], v2, s[8:11], s27 offen offset:0 sc1
v_mfma_f32_16x16x32_bf16 v[64:67], a[236:239], a[12:15], v[64:67]
ds_read_b128 a[224:227], v2 offset:23552
v_mfma_f32_16x16x32_bf16 v[68:71], a[232:235], a[80:83], v[68:71]
v_mfma_f32_16x16x32_bf16 v[68:71], a[236:239], a[84:87], v[68:71]
ds_read_b128 a[228:231], v2 offset:31744
s_waitcnt lgkmcnt(4)
v_mfma_f32_16x16x32_bf16 v[72:75], a[8:11], a[240:243], v[72:75]
buffer_load_dwordx4 a[192:195], v3, s[8:11], s28 offen offset:0 sc1
v_mfma_f32_16x16x32_bf16 v[72:75], a[12:15], a[244:247], v[72:75]
ds_read_b128 a[232:235], v6 offset:16384
v_mfma_f32_16x16x32_bf16 v[76:79], a[80:83], a[240:243], v[76:79]
v_mfma_f32_16x16x32_bf16 v[76:79], a[84:87], a[244:247], v[76:79]
ds_read_b128 a[236:239], v6 offset:24576
s_waitcnt lgkmcnt(4)
v_mfma_f32_16x16x32_bf16 v[80:83], a[8:11], a[216:219], v[80:83]
buffer_load_dwordx4 a[52:55], v2, s[8:11], s26 offen offset:1024 sc1
v_mfma_f32_16x16x32_bf16 v[80:83], a[12:15], a[220:223], v[80:83]
ds_read_b128 a[240:243], v9 offset:16384
v_mfma_f32_16x16x32_bf16 v[84:87], a[80:83], a[216:219], v[84:87]
v_mfma_f32_16x16x32_bf16 v[84:87], a[84:87], a[220:223], v[84:87]
ds_read_b128 a[244:247], v9 offset:24576
s_waitcnt lgkmcnt(4)
v_mfma_f32_16x16x32_bf16 v[88:91], a[8:11], a[224:227], v[88:91]
buffer_load_dwordx4 a[124:127], v2, s[8:11], s27 offen offset:1024 sc1
v_mfma_f32_16x16x32_bf16 v[88:91], a[12:15], a[228:231], v[88:91]
ds_read_b128 a[216:219], v2 offset:32768
v_mfma_f32_16x16x32_bf16 v[92:95], a[80:83], a[224:227], v[92:95]
v_mfma_f32_16x16x32_bf16 v[92:95], a[84:87], a[228:231], v[92:95]
ds_read_b128 a[220:223], v2 offset:40960
s_waitcnt lgkmcnt(4)
v_mfma_f32_16x16x32_bf16 v[96:99], a[232:235], a[152:155], v[96:99]
ds_read_b128 a[224:227], v2 offset:33792
buffer_load_dwordx4 a[196:199], v3, s[8:11], s28 offen offset:1024 sc1
v_mfma_f32_16x16x32_bf16 v[96:99], a[236:239], a[156:159], v[96:99]
ds_read_b128 a[228:231], v2 offset:41984
s_waitcnt lgkmcnt(4)
v_mfma_f32_16x16x32_bf16 v[100:103], a[152:155], a[240:243], v[100:103]
ds_read_b128 a[232:235], v2 offset:34816
v_mfma_f32_16x16x32_bf16 v[100:103], a[156:159], a[244:247], v[100:103]
ds_read_b128 a[236:239], v2 offset:43008
s_waitcnt vmcnt(24)
s_waitcnt lgkmcnt(4)
v_mfma_f32_16x16x32_bf16 v[32:35], a[216:219], a[16:19], v[32:35]
buffer_load_dwordx4 a[56:59], v2, s[8:11], s26 offen offset:2048 sc1
v_mfma_f32_16x16x32_bf16 v[32:35], a[220:223], a[20:23], v[32:35]
ds_read_b128 a[240:243], v2 offset:35840
v_mfma_f32_16x16x32_bf16 v[36:39], a[216:219], a[88:91], v[36:39]
v_mfma_f32_16x16x32_bf16 v[36:39], a[220:223], a[92:95], v[36:39]
ds_read_b128 a[244:247], v2 offset:44032
s_waitcnt lgkmcnt(4)
v_mfma_f32_16x16x32_bf16 v[40:43], a[224:227], a[16:19], v[40:43]
buffer_load_dwordx4 a[128:131], v2, s[8:11], s27 offen offset:2048 sc1
v_mfma_f32_16x16x32_bf16 v[40:43], a[228:231], a[20:23], v[40:43]
ds_read_b128 a[216:219], v2 offset:36864
v_mfma_f32_16x16x32_bf16 v[44:47], a[224:227], a[88:91], v[44:47]
v_mfma_f32_16x16x32_bf16 v[44:47], a[228:231], a[92:95], v[44:47]
ds_read_b128 a[220:223], v2 offset:45056
s_waitcnt lgkmcnt(4)
v_mfma_f32_16x16x32_bf16 v[48:51], a[232:235], a[16:19], v[48:51]
buffer_load_dwordx4 a[200:203], v3, s[8:11], s28 offen offset:2048 sc1
v_mfma_f32_16x16x32_bf16 v[48:51], a[236:239], a[20:23], v[48:51]
ds_read_b128 a[224:227], v2 offset:37888
v_mfma_f32_16x16x32_bf16 v[52:55], a[232:235], a[88:91], v[52:55]
v_mfma_f32_16x16x32_bf16 v[52:55], a[236:239], a[92:95], v[52:55]
ds_read_b128 a[228:231], v2 offset:46080
s_waitcnt lgkmcnt(4)
v_mfma_f32_16x16x32_bf16 v[56:59], a[240:243], a[16:19], v[56:59]
buffer_load_dwordx4 a[60:63], v2, s[8:11], s26 offen offset:3072 sc1
v_mfma_f32_16x16x32_bf16 v[56:59], a[244:247], a[20:23], v[56:59]
ds_read_b128 a[232:235], v2 offset:38912
v_mfma_f32_16x16x32_bf16 v[60:63], a[240:243], a[88:91], v[60:63]
v_mfma_f32_16x16x32_bf16 v[60:63], a[244:247], a[92:95], v[60:63]
ds_read_b128 a[236:239], v2 offset:47104
s_waitcnt lgkmcnt(4)
v_mfma_f32_16x16x32_bf16 v[64:67], a[216:219], a[16:19], v[64:67]
buffer_load_dwordx4 a[132:135], v2, s[8:11], s27 offen offset:3072 sc1
v_mfma_f32_16x16x32_bf16 v[64:67], a[220:223], a[20:23], v[64:67]
ds_read_b128 a[240:243], v2 offset:39936
v_mfma_f32_16x16x32_bf16 v[68:71], a[216:219], a[88:91], v[68:71]
v_mfma_f32_16x16x32_bf16 v[68:71], a[220:223], a[92:95], v[68:71]
ds_read_b128 a[244:247], v2 offset:48128
s_waitcnt lgkmcnt(4)
v_mfma_f32_16x16x32_bf16 v[72:75], a[16:19], a[224:227], v[72:75]
buffer_load_dwordx4 a[204:207], v3, s[8:11], s28 offen offset:3072 sc1
v_mfma_f32_16x16x32_bf16 v[72:75], a[20:23], a[228:231], v[72:75]
ds_read_b128 a[216:219], v6 offset:32768
v_mfma_f32_16x16x32_bf16 v[76:79], a[88:91], a[224:227], v[76:79]
v_mfma_f32_16x16x32_bf16 v[76:79], a[92:95], a[228:231], v[76:79]
ds_read_b128 a[220:223], v6 offset:40960
s_waitcnt lgkmcnt(4)
v_mfma_f32_16x16x32_bf16 v[80:83], a[16:19], a[232:235], v[80:83]
s_add_u32 s26, s26, 4096
s_add_u32 s27, s27, 4096
s_add_u32 s28, s28, 4096
buffer_load_dwordx4 a[64:67], v2, s[8:11], s26 offen offset:0 sc1
v_mfma_f32_16x16x32_bf16 v[80:83], a[20:23], a[236:239], v[80:83]
ds_read_b128 a[224:227], v9 offset:32768
v_mfma_f32_16x16x32_bf16 v[84:87], a[88:91], a[232:235], v[84:87]
v_mfma_f32_16x16x32_bf16 v[84:87], a[92:95], a[236:239], v[84:87]
ds_read_b128 a[228:231], v9 offset:40960
s_waitcnt lgkmcnt(4)
v_mfma_f32_16x16x32_bf16 v[88:91], a[16:19], a[240:243], v[88:91]
buffer_load_dwordx4 a[136:139], v2, s[8:11], s27 offen offset:0 sc1
v_mfma_f32_16x16x32_bf16 v[88:91], a[20:23], a[244:247], v[88:91]
ds_read_b128 a[232:235], v2 offset:49152
v_mfma_f32_16x16x32_bf16 v[92:95], a[88:91], a[240:243], v[92:95]
v_mfma_f32_16x16x32_bf16 v[92:95], a[92:95], a[244:247], v[92:95]
ds_read_b128 a[236:239], v2 offset:57344
s_waitcnt lgkmcnt(4)
v_mfma_f32_16x16x32_bf16 v[96:99], a[216:219], a[160:163], v[96:99]
ds_read_b128 a[240:243], v2 offset:50176
buffer_load_dwordx4 a[208:211], v3, s[8:11], s28 offen offset:0 sc1
v_mfma_f32_16x16x32_bf16 v[96:99], a[220:223], a[164:167], v[96:99]
ds_read_b128 a[244:247], v2 offset:58368
s_waitcnt lgkmcnt(4)
v_mfma_f32_16x16x32_bf16 v[100:103], a[160:163], a[224:227], v[100:103]
ds_read_b128 a[216:219], v2 offset:51200
v_mfma_f32_16x16x32_bf16 v[100:103], a[164:167], a[228:231], v[100:103]
ds_read_b128 a[220:223], v2 offset:59392
s_waitcnt vmcnt(27)
s_waitcnt lgkmcnt(4)
v_mfma_f32_16x16x32_bf16 v[32:35], a[232:235], a[24:27], v[32:35]
buffer_load_dwordx4 a[68:71], v2, s[8:11], s26 offen offset:1024 sc1
v_mfma_f32_16x16x32_bf16 v[32:35], a[236:239], a[28:31], v[32:35]
ds_read_b128 a[224:227], v2 offset:52224
v_mfma_f32_16x16x32_bf16 v[36:39], a[232:235], a[96:99], v[36:39]
v_mfma_f32_16x16x32_bf16 v[36:39], a[236:239], a[100:103], v[36:39]
ds_read_b128 a[228:231], v2 offset:60416
s_waitcnt lgkmcnt(4)
v_mfma_f32_16x16x32_bf16 v[40:43], a[240:243], a[24:27], v[40:43]
buffer_load_dwordx4 a[140:143], v2, s[8:11], s27 offen offset:1024 sc1
v_mfma_f32_16x16x32_bf16 v[40:43], a[244:247], a[28:31], v[40:43]
ds_read_b128 a[232:235], v2 offset:53248
v_mfma_f32_16x16x32_bf16 v[44:47], a[240:243], a[96:99], v[44:47]
v_mfma_f32_16x16x32_bf16 v[44:47], a[244:247], a[100:103], v[44:47]
ds_read_b128 a[236:239], v2 offset:61440
s_waitcnt lgkmcnt(4)
v_mfma_f32_16x16x32_bf16 v[48:51], a[216:219], a[24:27], v[48:51]
buffer_load_dwordx4 a[212:215], v3, s[8:11], s28 offen offset:1024 sc1
v_mfma_f32_16x16x32_bf16 v[48:51], a[220:223], a[28:31], v[48:51]
ds_read_b128 a[240:243], v2 offset:54272
v_mfma_f32_16x16x32_bf16 v[52:55], a[216:219], a[96:99], v[52:55]
v_mfma_f32_16x16x32_bf16 v[52:55], a[220:223], a[100:103], v[52:55]
ds_read_b128 a[244:247], v2 offset:62464
s_waitcnt lgkmcnt(4)
v_mfma_f32_16x16x32_bf16 v[56:59], a[224:227], a[24:27], v[56:59]
v_mfma_f32_16x16x32_bf16 v[56:59], a[228:231], a[28:31], v[56:59]
ds_read_b128 a[216:219], v2 offset:55296
v_mfma_f32_16x16x32_bf16 v[60:63], a[224:227], a[96:99], v[60:63]
v_mfma_f32_16x16x32_bf16 v[60:63], a[228:231], a[100:103], v[60:63]
ds_read_b128 a[220:223], v2 offset:63488
s_waitcnt lgkmcnt(4)
v_mfma_f32_16x16x32_bf16 v[64:67], a[232:235], a[24:27], v[64:67]
v_mfma_f32_16x16x32_bf16 v[64:67], a[236:239], a[28:31], v[64:67]
ds_read_b128 a[224:227], v2 offset:56320
v_mfma_f32_16x16x32_bf16 v[68:71], a[232:235], a[96:99], v[68:71]
v_mfma_f32_16x16x32_bf16 v[68:71], a[236:239], a[100:103], v[68:71]
ds_read_b128 a[228:231], v2 offset:64512
s_waitcnt lgkmcnt(4)
v_mfma_f32_16x16x32_bf16 v[72:75], a[24:27], a[240:243], v[72:75]
v_mfma_f32_16x16x32_bf16 v[72:75], a[28:31], a[244:247], v[72:75]
ds_read_b128 a[232:235], v6 offset:49152
v_mfma_f32_16x16x32_bf16 v[76:79], a[96:99], a[240:243], v[76:79]
v_mfma_f32_16x16x32_bf16 v[76:79], a[100:103], a[244:247], v[76:79]
ds_read_b128 a[236:239], v6 offset:57344
s_waitcnt lgkmcnt(4)
v_mfma_f32_16x16x32_bf16 v[80:83], a[24:27], a[216:219], v[80:83]
v_mfma_f32_16x16x32_bf16 v[80:83], a[28:31], a[220:223], v[80:83]
ds_read_b128 a[240:243], v9 offset:49152
v_mfma_f32_16x16x32_bf16 v[84:87], a[96:99], a[216:219], v[84:87]
v_mfma_f32_16x16x32_bf16 v[84:87], a[100:103], a[220:223], v[84:87]
ds_read_b128 a[244:247], v9 offset:57344
s_waitcnt lgkmcnt(4)
v_mfma_f32_16x16x32_bf16 v[88:91], a[24:27], a[224:227], v[88:91]
v_mfma_f32_16x16x32_bf16 v[88:91], a[28:31], a[228:231], v[88:91]
ds_read_b128 a[216:219], v4 offset:0
v_mfma_f32_16x16x32_bf16 v[92:95], a[96:99], a[224:227], v[92:95]
v_mfma_f32_16x16x32_bf16 v[92:95], a[100:103], a[228:231], v[92:95]
ds_read_b128 a[220:223], v4 offset:8192
s_waitcnt lgkmcnt(4)
v_mfma_f32_16x16x32_bf16 v[96:99], a[232:235], a[168:171], v[96:99]
ds_read_b128 a[224:227], v4 offset:1024
v_mfma_f32_16x16x32_bf16 v[96:99], a[236:239], a[172:175], v[96:99]
ds_read_b128 a[228:231], v4 offset:9216
s_waitcnt lgkmcnt(4)
v_mfma_f32_16x16x32_bf16 v[100:103], a[168:171], a[240:243], v[100:103]
ds_read_b128 a[232:235], v4 offset:2048
v_mfma_f32_16x16x32_bf16 v[100:103], a[172:175], a[244:247], v[100:103]
ds_read_b128 a[236:239], v4 offset:10240
s_waitcnt vmcnt(24)
s_waitcnt lgkmcnt(4)
v_mfma_f32_16x16x32_bf16 v[32:35], a[216:219], a[32:35], v[32:35]
v_mfma_f32_16x16x32_bf16 v[32:35], a[220:223], a[36:39], v[32:35]
ds_read_b128 a[240:243], v4 offset:3072
v_mfma_f32_16x16x32_bf16 v[36:39], a[216:219], a[104:107], v[36:39]
v_mfma_f32_16x16x32_bf16 v[36:39], a[220:223], a[108:111], v[36:39]
ds_read_b128 a[244:247], v4 offset:11264
s_waitcnt lgkmcnt(4)
v_mfma_f32_16x16x32_bf16 v[40:43], a[224:227], a[32:35], v[40:43]
v_mfma_f32_16x16x32_bf16 v[40:43], a[228:231], a[36:39], v[40:43]
ds_read_b128 a[216:219], v4 offset:4096
v_mfma_f32_16x16x32_bf16 v[44:47], a[224:227], a[104:107], v[44:47]
v_mfma_f32_16x16x32_bf16 v[44:47], a[228:231], a[108:111], v[44:47]
ds_read_b128 a[220:223], v4 offset:12288
s_waitcnt lgkmcnt(4)
v_mfma_f32_16x16x32_bf16 v[48:51], a[232:235], a[32:35], v[48:51]
v_mfma_f32_16x16x32_bf16 v[48:51], a[236:239], a[36:39], v[48:51]
ds_read_b128 a[224:227], v4 offset:5120
v_mfma_f32_16x16x32_bf16 v[52:55], a[232:235], a[104:107], v[52:55]
v_mfma_f32_16x16x32_bf16 v[52:55], a[236:239], a[108:111], v[52:55]
ds_read_b128 a[228:231], v4 offset:13312
s_waitcnt lgkmcnt(4)
v_mfma_f32_16x16x32_bf16 v[56:59], a[240:243], a[32:35], v[56:59]
v_mfma_f32_16x16x32_bf16 v[56:59], a[244:247], a[36:39], v[56:59]
ds_read_b128 a[232:235], v4 offset:6144
v_mfma_f32_16x16x32_bf16 v[60:63], a[240:243], a[104:107], v[60:63]
v_mfma_f32_16x16x32_bf16 v[60:63], a[244:247], a[108:111], v[60:63]
ds_read_b128 a[236:239], v4 offset:14336
s_waitcnt lgkmcnt(4)
v_mfma_f32_16x16x32_bf16 v[64:67], a[216:219], a[32:35], v[64:67]
v_mfma_f32_16x16x32_bf16 v[64:67], a[220:223], a[36:39], v[64:67]
ds_read_b128 a[240:243], v4 offset:7168
v_mfma_f32_16x16x32_bf16 v[68:71], a[216:219], a[104:107], v[68:71]
v_mfma_f32_16x16x32_bf16 v[68:71], a[220:223], a[108:111], v[68:71]
ds_read_b128 a[244:247], v4 offset:15360
s_waitcnt lgkmcnt(4)
v_mfma_f32_16x16x32_bf16 v[72:75], a[32:35], a[224:227], v[72:75]
v_mfma_f32_16x16x32_bf16 v[72:75], a[36:39], a[228:231], v[72:75]
ds_read_b128 a[216:219], v7 offset:0
v_mfma_f32_16x16x32_bf16 v[76:79], a[104:107], a[224:227], v[76:79]
v_mfma_f32_16x16x32_bf16 v[76:79], a[108:111], a[228:231], v[76:79]
ds_read_b128 a[220:223], v7 offset:8192
s_waitcnt lgkmcnt(4)
v_mfma_f32_16x16x32_bf16 v[80:83], a[32:35], a[232:235], v[80:83]
v_mfma_f32_16x16x32_bf16 v[80:83], a[36:39], a[236:239], v[80:83]
ds_read_b128 a[224:227], v10 offset:0
v_mfma_f32_16x16x32_bf16 v[84:87], a[104:107], a[232:235], v[84:87]
v_mfma_f32_16x16x32_bf16 v[84:87], a[108:111], a[236:239], v[84:87]
ds_read_b128 a[228:231], v10 offset:8192
s_waitcnt lgkmcnt(4)
v_mfma_f32_16x16x32_bf16 v[88:91], a[32:35], a[240:243], v[88:91]
v_mfma_f32_16x16x32_bf16 v[88:91], a[36:39], a[244:247], v[88:91]
ds_read_b128 a[232:235], v4 offset:16384
v_mfma_f32_16x16x32_bf16 v[92:95], a[104:107], a[240:243], v[92:95]
v_mfma_f32_16x16x32_bf16 v[92:95], a[108:111], a[244:247], v[92:95]
ds_read_b128 a[236:239], v4 offset:24576
s_waitcnt lgkmcnt(4)
v_mfma_f32_16x16x32_bf16 v[96:99], a[216:219], a[176:179], v[96:99]
ds_read_b128 a[240:243], v4 offset:17408
v_mfma_f32_16x16x32_bf16 v[96:99], a[220:223], a[180:183], v[96:99]
ds_read_b128 a[244:247], v4 offset:25600
s_waitcnt lgkmcnt(4)
v_mfma_f32_16x16x32_bf16 v[100:103], a[176:179], a[224:227], v[100:103]
ds_read_b128 a[216:219], v4 offset:18432
v_mfma_f32_16x16x32_bf16 v[100:103], a[180:183], a[228:231], v[100:103]
ds_read_b128 a[220:223], v4 offset:26624
s_waitcnt vmcnt(18)
s_waitcnt lgkmcnt(4)
v_mfma_f32_16x16x32_bf16 v[32:35], a[232:235], a[40:43], v[32:35]
v_mfma_f32_16x16x32_bf16 v[32:35], a[236:239], a[44:47], v[32:35]
ds_read_b128 a[224:227], v4 offset:19456
v_mfma_f32_16x16x32_bf16 v[36:39], a[232:235], a[112:115], v[36:39]
v_mfma_f32_16x16x32_bf16 v[36:39], a[236:239], a[116:119], v[36:39]
ds_read_b128 a[228:231], v4 offset:27648
s_waitcnt lgkmcnt(4)
v_mfma_f32_16x16x32_bf16 v[40:43], a[240:243], a[40:43], v[40:43]
v_mfma_f32_16x16x32_bf16 v[40:43], a[244:247], a[44:47], v[40:43]
ds_read_b128 a[232:235], v4 offset:20480
v_mfma_f32_16x16x32_bf16 v[44:47], a[240:243], a[112:115], v[44:47]
v_mfma_f32_16x16x32_bf16 v[44:47], a[244:247], a[116:119], v[44:47]
ds_read_b128 a[236:239], v4 offset:28672
s_waitcnt lgkmcnt(4)
v_mfma_f32_16x16x32_bf16 v[48:51], a[216:219], a[40:43], v[48:51]
v_mfma_f32_16x16x32_bf16 v[48:51], a[220:223], a[44:47], v[48:51]
ds_read_b128 a[240:243], v4 offset:21504
v_mfma_f32_16x16x32_bf16 v[52:55], a[216:219], a[112:115], v[52:55]
v_mfma_f32_16x16x32_bf16 v[52:55], a[220:223], a[116:119], v[52:55]
ds_read_b128 a[244:247], v4 offset:29696
s_waitcnt lgkmcnt(4)
v_mfma_f32_16x16x32_bf16 v[56:59], a[224:227], a[40:43], v[56:59]
v_mfma_f32_16x16x32_bf16 v[56:59], a[228:231], a[44:47], v[56:59]
ds_read_b128 a[216:219], v4 offset:22528
v_mfma_f32_16x16x32_bf16 v[60:63], a[224:227], a[112:115], v[60:63]
v_mfma_f32_16x16x32_bf16 v[60:63], a[228:231], a[116:119], v[60:63]
ds_read_b128 a[220:223], v4 offset:30720
s_waitcnt lgkmcnt(4)
v_mfma_f32_16x16x32_bf16 v[64:67], a[232:235], a[40:43], v[64:67]
v_mfma_f32_16x16x32_bf16 v[64:67], a[236:239], a[44:47], v[64:67]
ds_read_b128 a[224:227], v4 offset:23552
v_mfma_f32_16x16x32_bf16 v[68:71], a[232:235], a[112:115], v[68:71]
v_mfma_f32_16x16x32_bf16 v[68:71], a[236:239], a[116:119], v[68:71]
ds_read_b128 a[228:231], v4 offset:31744
s_waitcnt lgkmcnt(4)
v_mfma_f32_16x16x32_bf16 v[72:75], a[40:43], a[240:243], v[72:75]
v_mfma_f32_16x16x32_bf16 v[72:75], a[44:47], a[244:247], v[72:75]
ds_read_b128 a[232:235], v7 offset:16384
v_mfma_f32_16x16x32_bf16 v[76:79], a[112:115], a[240:243], v[76:79]
v_mfma_f32_16x16x32_bf16 v[76:79], a[116:119], a[244:247], v[76:79]
ds_read_b128 a[236:239], v7 offset:24576
s_waitcnt lgkmcnt(4)
v_mfma_f32_16x16x32_bf16 v[80:83], a[40:43], a[216:219], v[80:83]
v_mfma_f32_16x16x32_bf16 v[80:83], a[44:47], a[220:223], v[80:83]
ds_read_b128 a[240:243], v10 offset:16384
v_mfma_f32_16x16x32_bf16 v[84:87], a[112:115], a[216:219], v[84:87]
v_mfma_f32_16x16x32_bf16 v[84:87], a[116:119], a[220:223], v[84:87]
ds_read_b128 a[244:247], v10 offset:24576
s_waitcnt lgkmcnt(4)
v_mfma_f32_16x16x32_bf16 v[88:91], a[40:43], a[224:227], v[88:91]
v_mfma_f32_16x16x32_bf16 v[88:91], a[44:47], a[228:231], v[88:91]
ds_read_b128 a[216:219], v4 offset:32768
v_mfma_f32_16x16x32_bf16 v[92:95], a[112:115], a[224:227], v[92:95]
v_mfma_f32_16x16x32_bf16 v[92:95], a[116:119], a[228:231], v[92:95]
ds_read_b128 a[220:223], v4 offset:40960
s_waitcnt lgkmcnt(4)
v_mfma_f32_16x16x32_bf16 v[96:99], a[232:235], a[184:187], v[96:99]
ds_read_b128 a[224:227], v4 offset:33792
v_mfma_f32_16x16x32_bf16 v[96:99], a[236:239], a[188:191], v[96:99]
ds_read_b128 a[228:231], v4 offset:41984
s_waitcnt lgkmcnt(4)
v_mfma_f32_16x16x32_bf16 v[100:103], a[184:187], a[240:243], v[100:103]
ds_read_b128 a[232:235], v4 offset:34816
v_mfma_f32_16x16x32_bf16 v[100:103], a[188:191], a[244:247], v[100:103]
ds_read_b128 a[236:239], v4 offset:43008
s_waitcnt vmcnt(12)
s_waitcnt lgkmcnt(4)
v_mfma_f32_16x16x32_bf16 v[32:35], a[216:219], a[48:51], v[32:35]
v_mfma_f32_16x16x32_bf16 v[32:35], a[220:223], a[52:55], v[32:35]
ds_read_b128 a[240:243], v4 offset:35840
v_mfma_f32_16x16x32_bf16 v[36:39], a[216:219], a[120:123], v[36:39]
v_mfma_f32_16x16x32_bf16 v[36:39], a[220:223], a[124:127], v[36:39]
ds_read_b128 a[244:247], v4 offset:44032
s_waitcnt lgkmcnt(4)
v_mfma_f32_16x16x32_bf16 v[40:43], a[224:227], a[48:51], v[40:43]
v_mfma_f32_16x16x32_bf16 v[40:43], a[228:231], a[52:55], v[40:43]
ds_read_b128 a[216:219], v4 offset:36864
v_mfma_f32_16x16x32_bf16 v[44:47], a[224:227], a[120:123], v[44:47]
v_mfma_f32_16x16x32_bf16 v[44:47], a[228:231], a[124:127], v[44:47]
ds_read_b128 a[220:223], v4 offset:45056
s_waitcnt lgkmcnt(4)
v_mfma_f32_16x16x32_bf16 v[48:51], a[232:235], a[48:51], v[48:51]
v_mfma_f32_16x16x32_bf16 v[48:51], a[236:239], a[52:55], v[48:51]
ds_read_b128 a[224:227], v4 offset:37888
v_mfma_f32_16x16x32_bf16 v[52:55], a[232:235], a[120:123], v[52:55]
v_mfma_f32_16x16x32_bf16 v[52:55], a[236:239], a[124:127], v[52:55]
ds_read_b128 a[228:231], v4 offset:46080
s_waitcnt lgkmcnt(4)
v_mfma_f32_16x16x32_bf16 v[56:59], a[240:243], a[48:51], v[56:59]
v_mfma_f32_16x16x32_bf16 v[56:59], a[244:247], a[52:55], v[56:59]
ds_read_b128 a[232:235], v4 offset:38912
v_mfma_f32_16x16x32_bf16 v[60:63], a[240:243], a[120:123], v[60:63]
v_mfma_f32_16x16x32_bf16 v[60:63], a[244:247], a[124:127], v[60:63]
ds_read_b128 a[236:239], v4 offset:47104
s_waitcnt lgkmcnt(4)
v_mfma_f32_16x16x32_bf16 v[64:67], a[216:219], a[48:51], v[64:67]
v_mfma_f32_16x16x32_bf16 v[64:67], a[220:223], a[52:55], v[64:67]
ds_read_b128 a[240:243], v4 offset:39936
v_mfma_f32_16x16x32_bf16 v[68:71], a[216:219], a[120:123], v[68:71]
v_mfma_f32_16x16x32_bf16 v[68:71], a[220:223], a[124:127], v[68:71]
ds_read_b128 a[244:247], v4 offset:48128
s_waitcnt lgkmcnt(4)
v_mfma_f32_16x16x32_bf16 v[72:75], a[48:51], a[224:227], v[72:75]
v_mfma_f32_16x16x32_bf16 v[72:75], a[52:55], a[228:231], v[72:75]
ds_read_b128 a[216:219], v7 offset:32768
v_mfma_f32_16x16x32_bf16 v[76:79], a[120:123], a[224:227], v[76:79]
v_mfma_f32_16x16x32_bf16 v[76:79], a[124:127], a[228:231], v[76:79]
ds_read_b128 a[220:223], v7 offset:40960
s_waitcnt lgkmcnt(4)
v_mfma_f32_16x16x32_bf16 v[80:83], a[48:51], a[232:235], v[80:83]
v_mfma_f32_16x16x32_bf16 v[80:83], a[52:55], a[236:239], v[80:83]
ds_read_b128 a[224:227], v10 offset:32768
v_mfma_f32_16x16x32_bf16 v[84:87], a[120:123], a[232:235], v[84:87]
v_mfma_f32_16x16x32_bf16 v[84:87], a[124:127], a[236:239], v[84:87]
ds_read_b128 a[228:231], v10 offset:40960
s_waitcnt lgkmcnt(4)
v_mfma_f32_16x16x32_bf16 v[88:91], a[48:51], a[240:243], v[88:91]
v_mfma_f32_16x16x32_bf16 v[88:91], a[52:55], a[244:247], v[88:91]
ds_read_b128 a[232:235], v4 offset:49152
v_mfma_f32_16x16x32_bf16 v[92:95], a[120:123], a[240:243], v[92:95]
v_mfma_f32_16x16x32_bf16 v[92:95], a[124:127], a[244:247], v[92:95]
ds_read_b128 a[236:239], v4 offset:57344
s_waitcnt lgkmcnt(4)
v_mfma_f32_16x16x32_bf16 v[96:99], a[216:219], a[192:195], v[96:99]
ds_read_b128 a[240:243], v4 offset:50176
v_mfma_f32_16x16x32_bf16 v[96:99], a[220:223], a[196:199], v[96:99]
ds_read_b128 a[244:247], v4 offset:58368
s_waitcnt lgkmcnt(4)
v_mfma_f32_16x16x32_bf16 v[100:103], a[192:195], a[224:227], v[100:103]
ds_read_b128 a[216:219], v4 offset:51200
v_mfma_f32_16x16x32_bf16 v[100:103], a[196:199], a[228:231], v[100:103]
ds_read_b128 a[220:223], v4 offset:59392
s_waitcnt vmcnt(6)
s_waitcnt lgkmcnt(4)
v_mfma_f32_16x16x32_bf16 v[32:35], a[232:235], a[56:59], v[32:35]
v_mfma_f32_16x16x32_bf16 v[32:35], a[236:239], a[60:63], v[32:35]
ds_read_b128 a[224:227], v4 offset:52224
v_mfma_f32_16x16x32_bf16 v[36:39], a[232:235], a[128:131], v[36:39]
v_mfma_f32_16x16x32_bf16 v[36:39], a[236:239], a[132:135], v[36:39]
ds_read_b128 a[228:231], v4 offset:60416
s_waitcnt lgkmcnt(4)
v_mfma_f32_16x16x32_bf16 v[40:43], a[240:243], a[56:59], v[40:43]
v_mfma_f32_16x16x32_bf16 v[40:43], a[244:247], a[60:63], v[40:43]
ds_read_b128 a[232:235], v4 offset:53248
v_mfma_f32_16x16x32_bf16 v[44:47], a[240:243], a[128:131], v[44:47]
v_mfma_f32_16x16x32_bf16 v[44:47], a[244:247], a[132:135], v[44:47]
ds_read_b128 a[236:239], v4 offset:61440
s_waitcnt lgkmcnt(4)
v_mfma_f32_16x16x32_bf16 v[48:51], a[216:219], a[56:59], v[48:51]
v_mfma_f32_16x16x32_bf16 v[48:51], a[220:223], a[60:63], v[48:51]
ds_read_b128 a[240:243], v4 offset:54272
v_mfma_f32_16x16x32_bf16 v[52:55], a[216:219], a[128:131], v[52:55]
v_mfma_f32_16x16x32_bf16 v[52:55], a[220:223], a[132:135], v[52:55]
ds_read_b128 a[244:247], v4 offset:62464
s_waitcnt lgkmcnt(4)
v_mfma_f32_16x16x32_bf16 v[56:59], a[224:227], a[56:59], v[56:59]
v_mfma_f32_16x16x32_bf16 v[56:59], a[228:231], a[60:63], v[56:59]
ds_read_b128 a[216:219], v4 offset:55296
v_mfma_f32_16x16x32_bf16 v[60:63], a[224:227], a[128:131], v[60:63]
v_mfma_f32_16x16x32_bf16 v[60:63], a[228:231], a[132:135], v[60:63]
ds_read_b128 a[220:223], v4 offset:63488
s_waitcnt lgkmcnt(4)
v_mfma_f32_16x16x32_bf16 v[64:67], a[232:235], a[56:59], v[64:67]
v_mfma_f32_16x16x32_bf16 v[64:67], a[236:239], a[60:63], v[64:67]
ds_read_b128 a[224:227], v4 offset:56320
v_mfma_f32_16x16x32_bf16 v[68:71], a[232:235], a[128:131], v[68:71]
v_mfma_f32_16x16x32_bf16 v[68:71], a[236:239], a[132:135], v[68:71]
ds_read_b128 a[228:231], v4 offset:64512
s_waitcnt lgkmcnt(4)
v_mfma_f32_16x16x32_bf16 v[72:75], a[56:59], a[240:243], v[72:75]
v_mfma_f32_16x16x32_bf16 v[72:75], a[60:63], a[244:247], v[72:75]
ds_read_b128 a[232:235], v7 offset:49152
v_mfma_f32_16x16x32_bf16 v[76:79], a[128:131], a[240:243], v[76:79]
v_mfma_f32_16x16x32_bf16 v[76:79], a[132:135], a[244:247], v[76:79]
ds_read_b128 a[236:239], v7 offset:57344
s_waitcnt lgkmcnt(4)
v_mfma_f32_16x16x32_bf16 v[80:83], a[56:59], a[216:219], v[80:83]
v_mfma_f32_16x16x32_bf16 v[80:83], a[60:63], a[220:223], v[80:83]
ds_read_b128 a[240:243], v10 offset:49152
v_mfma_f32_16x16x32_bf16 v[84:87], a[128:131], a[216:219], v[84:87]
v_mfma_f32_16x16x32_bf16 v[84:87], a[132:135], a[220:223], v[84:87]
ds_read_b128 a[244:247], v10 offset:57344
s_waitcnt lgkmcnt(4)
v_mfma_f32_16x16x32_bf16 v[88:91], a[56:59], a[224:227], v[88:91]
v_mfma_f32_16x16x32_bf16 v[88:91], a[60:63], a[228:231], v[88:91]
ds_read_b128 a[216:219], v5 offset:0
v_mfma_f32_16x16x32_bf16 v[92:95], a[128:131], a[224:227], v[92:95]
v_mfma_f32_16x16x32_bf16 v[92:95], a[132:135], a[228:231], v[92:95]
ds_read_b128 a[220:223], v5 offset:8192
s_waitcnt lgkmcnt(4)
v_mfma_f32_16x16x32_bf16 v[96:99], a[232:235], a[200:203], v[96:99]
ds_read_b128 a[224:227], v5 offset:1024
v_mfma_f32_16x16x32_bf16 v[96:99], a[236:239], a[204:207], v[96:99]
ds_read_b128 a[228:231], v5 offset:9216
s_waitcnt lgkmcnt(4)
v_mfma_f32_16x16x32_bf16 v[100:103], a[200:203], a[240:243], v[100:103]
ds_read_b128 a[232:235], v5 offset:2048
v_mfma_f32_16x16x32_bf16 v[100:103], a[204:207], a[244:247], v[100:103]
ds_read_b128 a[236:239], v5 offset:10240
s_waitcnt vmcnt(0)
s_waitcnt lgkmcnt(4)
v_mfma_f32_16x16x32_bf16 v[32:35], a[216:219], a[64:67], v[32:35]
v_mfma_f32_16x16x32_bf16 v[32:35], a[220:223], a[68:71], v[32:35]
ds_read_b128 a[240:243], v5 offset:3072
v_mfma_f32_16x16x32_bf16 v[36:39], a[216:219], a[136:139], v[36:39]
v_mfma_f32_16x16x32_bf16 v[36:39], a[220:223], a[140:143], v[36:39]
ds_read_b128 a[244:247], v5 offset:11264
s_waitcnt lgkmcnt(4)
v_mfma_f32_16x16x32_bf16 v[40:43], a[224:227], a[64:67], v[40:43]
v_mfma_f32_16x16x32_bf16 v[40:43], a[228:231], a[68:71], v[40:43]
ds_read_b128 a[216:219], v5 offset:4096
v_mfma_f32_16x16x32_bf16 v[44:47], a[224:227], a[136:139], v[44:47]
v_mfma_f32_16x16x32_bf16 v[44:47], a[228:231], a[140:143], v[44:47]
ds_read_b128 a[220:223], v5 offset:12288
s_waitcnt lgkmcnt(4)
v_mfma_f32_16x16x32_bf16 v[48:51], a[232:235], a[64:67], v[48:51]
v_mfma_f32_16x16x32_bf16 v[48:51], a[236:239], a[68:71], v[48:51]
ds_read_b128 a[224:227], v5 offset:5120
v_mfma_f32_16x16x32_bf16 v[52:55], a[232:235], a[136:139], v[52:55]
v_mfma_f32_16x16x32_bf16 v[52:55], a[236:239], a[140:143], v[52:55]
ds_read_b128 a[228:231], v5 offset:13312
s_waitcnt lgkmcnt(4)
v_mfma_f32_16x16x32_bf16 v[56:59], a[240:243], a[64:67], v[56:59]
v_mfma_f32_16x16x32_bf16 v[56:59], a[244:247], a[68:71], v[56:59]
ds_read_b128 a[232:235], v5 offset:6144
v_mfma_f32_16x16x32_bf16 v[60:63], a[240:243], a[136:139], v[60:63]
v_mfma_f32_16x16x32_bf16 v[60:63], a[244:247], a[140:143], v[60:63]
ds_read_b128 a[236:239], v5 offset:14336
s_waitcnt lgkmcnt(4)
v_mfma_f32_16x16x32_bf16 v[64:67], a[216:219], a[64:67], v[64:67]
v_mfma_f32_16x16x32_bf16 v[64:67], a[220:223], a[68:71], v[64:67]
ds_read_b128 a[240:243], v5 offset:7168
v_mfma_f32_16x16x32_bf16 v[68:71], a[216:219], a[136:139], v[68:71]
v_mfma_f32_16x16x32_bf16 v[68:71], a[220:223], a[140:143], v[68:71]
ds_read_b128 a[244:247], v5 offset:15360
s_waitcnt lgkmcnt(4)
v_mfma_f32_16x16x32_bf16 v[72:75], a[64:67], a[224:227], v[72:75]
v_mfma_f32_16x16x32_bf16 v[72:75], a[68:71], a[228:231], v[72:75]
ds_read_b128 a[216:219], v8 offset:0
v_mfma_f32_16x16x32_bf16 v[76:79], a[136:139], a[224:227], v[76:79]
v_mfma_f32_16x16x32_bf16 v[76:79], a[140:143], a[228:231], v[76:79]
ds_read_b128 a[220:223], v8 offset:8192
s_waitcnt lgkmcnt(4)
v_mfma_f32_16x16x32_bf16 v[80:83], a[64:67], a[232:235], v[80:83]
v_mfma_f32_16x16x32_bf16 v[80:83], a[68:71], a[236:239], v[80:83]
ds_read_b128 a[224:227], v11 offset:0
v_mfma_f32_16x16x32_bf16 v[84:87], a[136:139], a[232:235], v[84:87]
v_mfma_f32_16x16x32_bf16 v[84:87], a[140:143], a[236:239], v[84:87]
ds_read_b128 a[228:231], v11 offset:8192
s_waitcnt lgkmcnt(4)
v_mfma_f32_16x16x32_bf16 v[88:91], a[64:67], a[240:243], v[88:91]
v_mfma_f32_16x16x32_bf16 v[88:91], a[68:71], a[244:247], v[88:91]
v_mfma_f32_16x16x32_bf16 v[92:95], a[136:139], a[240:243], v[92:95]
v_mfma_f32_16x16x32_bf16 v[92:95], a[140:143], a[244:247], v[92:95]
s_waitcnt lgkmcnt(2)
v_mfma_f32_16x16x32_bf16 v[96:99], a[216:219], a[208:211], v[96:99]
v_mfma_f32_16x16x32_bf16 v[96:99], a[220:223], a[212:215], v[96:99]
s_waitcnt lgkmcnt(0)
v_mfma_f32_16x16x32_bf16 v[100:103], a[208:211], a[224:227], v[100:103]
v_mfma_f32_16x16x32_bf16 v[100:103], a[212:215], a[228:231], v[100:103]
s_branch L_att
L_last:
s_cmp_eq_u32 s4, 3
s_cbranch_scc1 L_epoch
v_and_b32 v6, 7, v1
v_lshrrev_b32 v7, 3, v1
s_mul_i32 s22, s4, 24
v_add_u32 v7, s22, v7
s_and_b32 s23, s6, 1
s_lshl_b32 s23, s23, 3
v_add_u32 v8, s23, v6
v_lshlrev_b32 v8, 4, v8
v_lshl_add_u32 v4, v7, 8, v8
s_lshl_b32 s24, s5, 4
s_lshr_b32 s25, s6, 1
s_add_u32 s24, s24, s25
s_mul_i32 s20, s24, 18432
s_lshl_b32 s24, s5, 8
s_lshl_b32 s25, s6, 3
s_add_u32 s24, s24, s25
s_and_b32 s25, s24, 1023
s_lshl_b32 s25, s25, 1
s_lshr_b32 s24, s24, 10
s_add_u32 s24, s24, s25
s_mul_i32 s21, s24, 1152
v_mul_u32_u24 v8, 2304, v6
v_lshl_add_u32 v5, v7, 4, v8
s_load_dwordx2 s[12:13], s[0:1], 56
s_waitcnt lgkmcnt(0)
s_mov_b32 s16, s12
s_and_b32 s17, s13, 0xffff
s_mov_b32 s18, 2359296
s_mov_b32 s19, 0x20000
s_add_u32 s24, s20, 39776256
s_add_u32 s25, s24, 4096
buffer_load_dwordx4 v[16:19], v4, s[8:11], s24 offen offset:0 sc1
buffer_load_dwordx4 v[20:23], v4, s[8:11], s24 offen offset:2048 sc1
buffer_load_dwordx4 v[24:27], v4, s[8:11], s25 offen offset:0 sc1
s_lshl_b32 s24, s5, 2
s_lshr_b32 s25, s6, 3
s_add_u32 s24, s24, s25
s_lshl_b32 s24, s24, 12
s_add_u32 s24, s24, 1703936
v_and_b32 v6, 31, v1
v_lshlrev_b32 v6, 7, v6
s_mov_b32 s52, 0
L_poll7:
buffer_load_dwordx2 v[14:15], v6, s[8:11], s24 offen sc1
s_add_u32 s52, s52, 1
s_waitcnt vmcnt(0)
v_cmp_ne_u64 vcc, s[68:69], v[14:15]
s_cmp_ge_u32 s52, 0x100000
s_cbranch_scc1 L_got7
s_and_b64 exec, exec, vcc
s_cbranch_execnz L_poll7
L_got7:
s_mov_b64 exec, -1
s_add_u32 s24, s20, 99020800
s_add_u32 s25, s24, 4096
buffer_load_dwordx4 v[28:31], v4, s[8:11], s24 offen offset:0 sc1
buffer_load_dwordx4 v[32:35], v4, s[8:11], s24 offen offset:2048 sc1
buffer_load_dwordx4 v[36:39], v4, s[8:11], s25 offen offset:0 sc1
s_add_u32 s24, s20, 101380096
s_add_u32 s25, s24, 4096
buffer_load_dwordx4 v[40:43], v4, s[8:11], s24 offen offset:0 sc1
buffer_load_dwordx4 v[44:47], v4, s[8:11], s24 offen offset:2048 sc1
buffer_load_dwordx4 v[48:51], v4, s[8:11], s25 offen offset:0 sc1
s_add_u32 s24, s20, 103739392
s_add_u32 s25, s24, 4096
buffer_load_dwordx4 v[52:55], v4, s[8:11], s24 offen offset:0 sc1
buffer_load_dwordx4 v[56:59], v4, s[8:11], s24 offen offset:2048 sc1
buffer_load_dwordx4 v[60:63], v4, s[8:11], s25 offen offset:0 sc1
s_add_u32 s24, s20, 106098688
s_add_u32 s25, s24, 4096
buffer_load_dwordx4 v[64:67], v4, s[8:11], s24 offen offset:0 sc1
buffer_load_dwordx4 v[68:71], v4, s[8:11], s24 offen offset:2048 sc1
buffer_load_dwordx4 v[72:75], v4, s[8:11], s25 offen offset:0 sc1
s_add_u32 s24, s20, 108457984
s_add_u32 s25, s24, 4096
buffer_load_dwordx4 v[76:79], v4, s[8:11], s24 offen offset:0 sc1
buffer_load_dwordx4 v[80:83], v4, s[8:11], s24 offen offset:2048 sc1
buffer_load_dwordx4 v[84:87], v4, s[8:11], s25 offen offset:0 sc1
s_add_u32 s24, s20, 110817280
s_add_u32 s25, s24, 4096
buffer_load_dwordx4 v[88:91], v4, s[8:11], s24 offen offset:0 sc1
buffer_load_dwordx4 v[92:95], v4, s[8:11], s24 offen offset:2048 sc1
buffer_load_dwordx4 v[96:99], v4, s[8:11], s25 offen offset:0 sc1
s_add_u32 s24, s20, 113176576
s_add_u32 s25, s24, 4096
buffer_load_dwordx4 v[100:103], v4, s[8:11], s24 offen offset:0 sc1
buffer_load_dwordx4 v[104:107], v4, s[8:11], s24 offen offset:2048 sc1
buffer_load_dwordx4 v[108:111], v4, s[8:11], s25 offen offset:0 sc1
s_add_u32 s24, s20, 115535872
s_add_u32 s25, s24, 4096
buffer_load_dwordx4 v[112:115], v4, s[8:11], s24 offen offset:0 sc1
buffer_load_dwordx4 v[116:119], v4, s[8:11], s24 offen offset:2048 sc1
buffer_load_dwordx4 v[120:123], v4, s[8:11], s25 offen offset:0 sc1
s_waitcnt vmcnt(26)
v_lshlrev_b32 v128, 16, v16
v_and_b32 v129, 0xffff0000, v16
v_lshlrev_b32 v130, 16, v17
v_and_b32 v131, 0xffff0000, v17
v_lshlrev_b32 v132, 16, v18
v_and_b32 v133, 0xffff0000, v18
v_lshlrev_b32 v134, 16, v19
v_and_b32 v135, 0xffff0000, v19
s_waitcnt vmcnt(25)
v_lshlrev_b32 v136, 16, v20
v_and_b32 v137, 0xffff0000, v20
v_lshlrev_b32 v138, 16, v21
v_and_b32 v139, 0xffff0000, v21
v_lshlrev_b32 v140, 16, v22
v_and_b32 v141, 0xffff0000, v22
v_lshlrev_b32 v142, 16, v23
v_and_b32 v143, 0xffff0000, v23
s_waitcnt vmcnt(24)
v_lshlrev_b32 v144, 16, v24
v_and_b32 v145, 0xffff0000, v24
v_lshlrev_b32 v146, 16, v25
v_and_b32 v147, 0xffff0000, v25
v_lshlrev_b32 v148, 16, v26
v_and_b32 v149, 0xffff0000, v26
v_lshlrev_b32 v150, 16, v27
v_and_b32 v151, 0xffff0000, v27
s_waitcnt vmcnt(23)
v_lshlrev_b32 v6, 16, v28
v_and_b32 v7, 0xffff0000, v28
v_add_f32 v128, v128, v6
v_add_f32 v129, v129, v7
v_lshlrev_b32 v8, 16, v29
v_and_b32 v9, 0xffff0000, v29
v_add_f32 v130, v130, v8
v_add_f32 v131, v131, v9
v_lshlrev_b32 v6, 16, v30
v_and_b32 v7, 0xffff0000, v30
v_add_f32 v132, v132, v6
v_add_f32 v133, v133, v7
v_lshlrev_b32 v8, 16, v31
v_and_b32 v9, 0xffff0000, v31
v_add_f32 v134, v134, v8
v_add_f32 v135, v135, v9
s_waitcnt vmcnt(22)
v_lshlrev_b32 v6, 16, v32
v_and_b32 v7, 0xffff0000, v32
v_add_f32 v136, v136, v6
v_add_f32 v137, v137, v7
v_lshlrev_b32 v8, 16, v33
v_and_b32 v9, 0xffff0000, v33
v_add_f32 v138, v138, v8
v_add_f32 v139, v139, v9
v_lshlrev_b32 v6, 16, v34
v_and_b32 v7, 0xffff0000, v34
v_add_f32 v140, v140, v6
v_add_f32 v141, v141, v7
v_lshlrev_b32 v8, 16, v35
v_and_b32 v9, 0xffff0000, v35
v_add_f32 v142, v142, v8
v_add_f32 v143, v143, v9
s_waitcnt vmcnt(21)
v_lshlrev_b32 v6, 16, v36
v_and_b32 v7, 0xffff0000, v36
v_add_f32 v144, v144, v6
v_add_f32 v145, v145, v7
v_lshlrev_b32 v8, 16, v37
v_and_b32 v9, 0xffff0000, v37
v_add_f32 v146, v146, v8
v_add_f32 v147, v147, v9
v_lshlrev_b32 v6, 16, v38
v_and_b32 v7, 0xffff0000, v38
v_add_f32 v148, v148, v6
v_add_f32 v149, v149, v7
v_lshlrev_b32 v8, 16, v39
v_and_b32 v9, 0xffff0000, v39
v_add_f32 v150, v150, v8
v_add_f32 v151, v151, v9
s_waitcnt vmcnt(20)
v_lshlrev_b32 v6, 16, v40
v_and_b32 v7, 0xffff0000, v40
v_add_f32 v128, v128, v6
v_add_f32 v129, v129, v7
v_lshlrev_b32 v8, 16, v41
v_and_b32 v9, 0xffff0000, v41
v_add_f32 v130, v130, v8
v_add_f32 v131, v131, v9
v_lshlrev_b32 v6, 16, v42
v_and_b32 v7, 0xffff0000, v42
v_add_f32 v132, v132, v6
v_add_f32 v133, v133, v7
v_lshlrev_b32 v8, 16, v43
v_and_b32 v9, 0xffff0000, v43
v_add_f32 v134, v134, v8
v_add_f32 v135, v135, v9
s_waitcnt vmcnt(19)
v_lshlrev_b32 v6, 16, v44
v_and_b32 v7, 0xffff0000, v44
v_add_f32 v136, v136, v6
v_add_f32 v137, v137, v7
v_lshlrev_b32 v8, 16, v45
v_and_b32 v9, 0xffff0000, v45
v_add_f32 v138, v138, v8
v_add_f32 v139, v139, v9
v_lshlrev_b32 v6, 16, v46
v_and_b32 v7, 0xffff0000, v46
v_add_f32 v140, v140, v6
v_add_f32 v141, v141, v7
v_lshlrev_b32 v8, 16, v47
v_and_b32 v9, 0xffff0000, v47
v_add_f32 v142, v142, v8
v_add_f32 v143, v143, v9
s_waitcnt vmcnt(18)
v_lshlrev_b32 v6, 16, v48
v_and_b32 v7, 0xffff0000, v48
v_add_f32 v144, v144, v6
v_add_f32 v145, v145, v7
v_lshlrev_b32 v8, 16, v49
v_and_b32 v9, 0xffff0000, v49
v_add_f32 v146, v146, v8
v_add_f32 v147, v147, v9
v_lshlrev_b32 v6, 16, v50
v_and_b32 v7, 0xffff0000, v50
v_add_f32 v148, v148, v6
v_add_f32 v149, v149, v7
v_lshlrev_b32 v8, 16, v51
v_and_b32 v9, 0xffff0000, v51
v_add_f32 v150, v150, v8
v_add_f32 v151, v151, v9
s_waitcnt vmcnt(17)
v_lshlrev_b32 v6, 16, v52
v_and_b32 v7, 0xffff0000, v52
v_add_f32 v128, v128, v6
v_add_f32 v129, v129, v7
v_lshlrev_b32 v8, 16, v53
v_and_b32 v9, 0xffff0000, v53
v_add_f32 v130, v130, v8
v_add_f32 v131, v131, v9
v_lshlrev_b32 v6, 16, v54
v_and_b32 v7, 0xffff0000, v54
v_add_f32 v132, v132, v6
v_add_f32 v133, v133, v7
v_lshlrev_b32 v8, 16, v55
v_and_b32 v9, 0xffff0000, v55
v_add_f32 v134, v134, v8
v_add_f32 v135, v135, v9
s_waitcnt vmcnt(16)
v_lshlrev_b32 v6, 16, v56
v_and_b32 v7, 0xffff0000, v56
v_add_f32 v136, v136, v6
v_add_f32 v137, v137, v7
v_lshlrev_b32 v8, 16, v57
v_and_b32 v9, 0xffff0000, v57
v_add_f32 v138, v138, v8
v_add_f32 v139, v139, v9
v_lshlrev_b32 v6, 16, v58
v_and_b32 v7, 0xffff0000, v58
v_add_f32 v140, v140, v6
v_add_f32 v141, v141, v7
v_lshlrev_b32 v8, 16, v59
v_and_b32 v9, 0xffff0000, v59
v_add_f32 v142, v142, v8
v_add_f32 v143, v143, v9
s_waitcnt vmcnt(15)
v_lshlrev_b32 v6, 16, v60
v_and_b32 v7, 0xffff0000, v60
v_add_f32 v144, v144, v6
v_add_f32 v145, v145, v7
v_lshlrev_b32 v8, 16, v61
v_and_b32 v9, 0xffff0000, v61
v_add_f32 v146, v146, v8
v_add_f32 v147, v147, v9
v_lshlrev_b32 v6, 16, v62
v_and_b32 v7, 0xffff0000, v62
v_add_f32 v148, v148, v6
v_add_f32 v149, v149, v7
v_lshlrev_b32 v8, 16, v63
v_and_b32 v9, 0xffff0000, v63
v_add_f32 v150, v150, v8
v_add_f32 v151, v151, v9
s_waitcnt vmcnt(14)
v_lshlrev_b32 v6, 16, v64
v_and_b32 v7, 0xffff0000, v64
v_add_f32 v128, v128, v6
v_add_f32 v129, v129, v7
v_lshlrev_b32 v8, 16, v65
v_and_b32 v9, 0xffff0000, v65
v_add_f32 v130, v130, v8
v_add_f32 v131, v131, v9
v_lshlrev_b32 v6, 16, v66
v_and_b32 v7, 0xffff0000, v66
v_add_f32 v132, v132, v6
v_add_f32 v133, v133, v7
v_lshlrev_b32 v8, 16, v67
v_and_b32 v9, 0xffff0000, v67
v_add_f32 v134, v134, v8
v_add_f32 v135, v135, v9
s_waitcnt vmcnt(13)
v_lshlrev_b32 v6, 16, v68
v_and_b32 v7, 0xffff0000, v68
v_add_f32 v136, v136, v6
v_add_f32 v137, v137, v7
v_lshlrev_b32 v8, 16, v69
v_and_b32 v9, 0xffff0000, v69
v_add_f32 v138, v138, v8
v_add_f32 v139, v139, v9
v_lshlrev_b32 v6, 16, v70
v_and_b32 v7, 0xffff0000, v70
v_add_f32 v140, v140, v6
v_add_f32 v141, v141, v7
v_lshlrev_b32 v8, 16, v71
v_and_b32 v9, 0xffff0000, v71
v_add_f32 v142, v142, v8
v_add_f32 v143, v143, v9
s_waitcnt vmcnt(12)
v_lshlrev_b32 v6, 16, v72
v_and_b32 v7, 0xffff0000, v72
v_add_f32 v144, v144, v6
v_add_f32 v145, v145, v7
v_lshlrev_b32 v8, 16, v73
v_and_b32 v9, 0xffff0000, v73
v_add_f32 v146, v146, v8
v_add_f32 v147, v147, v9
v_lshlrev_b32 v6, 16, v74
v_and_b32 v7, 0xffff0000, v74
v_add_f32 v148, v148, v6
v_add_f32 v149, v149, v7
v_lshlrev_b32 v8, 16, v75
v_and_b32 v9, 0xffff0000, v75
v_add_f32 v150, v150, v8
v_add_f32 v151, v151, v9
s_waitcnt vmcnt(11)
v_lshlrev_b32 v6, 16, v76
v_and_b32 v7, 0xffff0000, v76
v_add_f32 v128, v128, v6
v_add_f32 v129, v129, v7
v_lshlrev_b32 v8, 16, v77
v_and_b32 v9, 0xffff0000, v77
v_add_f32 v130, v130, v8
v_add_f32 v131, v131, v9
v_lshlrev_b32 v6, 16, v78
v_and_b32 v7, 0xffff0000, v78
v_add_f32 v132, v132, v6
v_add_f32 v133, v133, v7
v_lshlrev_b32 v8, 16, v79
v_and_b32 v9, 0xffff0000, v79
v_add_f32 v134, v134, v8
v_add_f32 v135, v135, v9
s_waitcnt vmcnt(10)
v_lshlrev_b32 v6, 16, v80
v_and_b32 v7, 0xffff0000, v80
v_add_f32 v136, v136, v6
v_add_f32 v137, v137, v7
v_lshlrev_b32 v8, 16, v81
v_and_b32 v9, 0xffff0000, v81
v_add_f32 v138, v138, v8
v_add_f32 v139, v139, v9
v_lshlrev_b32 v6, 16, v82
v_and_b32 v7, 0xffff0000, v82
v_add_f32 v140, v140, v6
v_add_f32 v141, v141, v7
v_lshlrev_b32 v8, 16, v83
v_and_b32 v9, 0xffff0000, v83
v_add_f32 v142, v142, v8
v_add_f32 v143, v143, v9
s_waitcnt vmcnt(9)
v_lshlrev_b32 v6, 16, v84
v_and_b32 v7, 0xffff0000, v84
v_add_f32 v144, v144, v6
v_add_f32 v145, v145, v7
v_lshlrev_b32 v8, 16, v85
v_and_b32 v9, 0xffff0000, v85
v_add_f32 v146, v146, v8
v_add_f32 v147, v147, v9
v_lshlrev_b32 v6, 16, v86
v_and_b32 v7, 0xffff0000, v86
v_add_f32 v148, v148, v6
v_add_f32 v149, v149, v7
v_lshlrev_b32 v8, 16, v87
v_and_b32 v9, 0xffff0000, v87
v_add_f32 v150, v150, v8
v_add_f32 v151, v151, v9
s_waitcnt vmcnt(8)
v_lshlrev_b32 v6, 16, v88
v_and_b32 v7, 0xffff0000, v88
v_add_f32 v128, v128, v6
v_add_f32 v129, v129, v7
v_lshlrev_b32 v8, 16, v89
v_and_b32 v9, 0xffff0000, v89
v_add_f32 v130, v130, v8
v_add_f32 v131, v131, v9
v_lshlrev_b32 v6, 16, v90
v_and_b32 v7, 0xffff0000, v90
v_add_f32 v132, v132, v6
v_add_f32 v133, v133, v7
v_lshlrev_b32 v8, 16, v91
v_and_b32 v9, 0xffff0000, v91
v_add_f32 v134, v134, v8
v_add_f32 v135, v135, v9
s_waitcnt vmcnt(7)
v_lshlrev_b32 v6, 16, v92
v_and_b32 v7, 0xffff0000, v92
v_add_f32 v136, v136, v6
v_add_f32 v137, v137, v7
v_lshlrev_b32 v8, 16, v93
v_and_b32 v9, 0xffff0000, v93
v_add_f32 v138, v138, v8
v_add_f32 v139, v139, v9
v_lshlrev_b32 v6, 16, v94
v_and_b32 v7, 0xffff0000, v94
v_add_f32 v140, v140, v6
v_add_f32 v141, v141, v7
v_lshlrev_b32 v8, 16, v95
v_and_b32 v9, 0xffff0000, v95
v_add_f32 v142, v142, v8
v_add_f32 v143, v143, v9
s_waitcnt vmcnt(6)
v_lshlrev_b32 v6, 16, v96
v_and_b32 v7, 0xffff0000, v96
v_add_f32 v144, v144, v6
v_add_f32 v145, v145, v7
v_lshlrev_b32 v8, 16, v97
v_and_b32 v9, 0xffff0000, v97
v_add_f32 v146, v146, v8
v_add_f32 v147, v147, v9
v_lshlrev_b32 v6, 16, v98
v_and_b32 v7, 0xffff0000, v98
v_add_f32 v148, v148, v6
v_add_f32 v149, v149, v7
v_lshlrev_b32 v8, 16, v99
v_and_b32 v9, 0xffff0000, v99
v_add_f32 v150, v150, v8
v_add_f32 v151, v151, v9
s_waitcnt vmcnt(5)
v_lshlrev_b32 v6, 16, v100
v_and_b32 v7, 0xffff0000, v100
v_add_f32 v128, v128, v6
v_add_f32 v129, v129, v7
v_lshlrev_b32 v8, 16, v101
v_and_b32 v9, 0xffff0000, v101
v_add_f32 v130, v130, v8
v_add_f32 v131, v131, v9
v_lshlrev_b32 v6, 16, v102
v_and_b32 v7, 0xffff0000, v102
v_add_f32 v132, v132, v6
v_add_f32 v133, v133, v7
v_lshlrev_b32 v8, 16, v103
v_and_b32 v9, 0xffff0000, v103
v_add_f32 v134, v134, v8
v_add_f32 v135, v135, v9
s_waitcnt vmcnt(4)
v_lshlrev_b32 v6, 16, v104
v_and_b32 v7, 0xffff0000, v104
v_add_f32 v136, v136, v6
v_add_f32 v137, v137, v7
v_lshlrev_b32 v8, 16, v105
v_and_b32 v9, 0xffff0000, v105
v_add_f32 v138, v138, v8
v_add_f32 v139, v139, v9
v_lshlrev_b32 v6, 16, v106
v_and_b32 v7, 0xffff0000, v106
v_add_f32 v140, v140, v6
v_add_f32 v141, v141, v7
v_lshlrev_b32 v8, 16, v107
v_and_b32 v9, 0xffff0000, v107
v_add_f32 v142, v142, v8
v_add_f32 v143, v143, v9
s_waitcnt vmcnt(3)
v_lshlrev_b32 v6, 16, v108
v_and_b32 v7, 0xffff0000, v108
v_add_f32 v144, v144, v6
v_add_f32 v145, v145, v7
v_lshlrev_b32 v8, 16, v109
v_and_b32 v9, 0xffff0000, v109
v_add_f32 v146, v146, v8
v_add_f32 v147, v147, v9
v_lshlrev_b32 v6, 16, v110
v_and_b32 v7, 0xffff0000, v110
v_add_f32 v148, v148, v6
v_add_f32 v149, v149, v7
v_lshlrev_b32 v8, 16, v111
v_and_b32 v9, 0xffff0000, v111
v_add_f32 v150, v150, v8
v_add_f32 v151, v151, v9
s_waitcnt vmcnt(2)
v_lshlrev_b32 v6, 16, v112
v_and_b32 v7, 0xffff0000, v112
v_add_f32 v128, v128, v6
v_add_f32 v129, v129, v7
v_lshlrev_b32 v8, 16, v113
v_and_b32 v9, 0xffff0000, v113
v_add_f32 v130, v130, v8
v_add_f32 v131, v131, v9
v_lshlrev_b32 v6, 16, v114
v_and_b32 v7, 0xffff0000, v114
v_add_f32 v132, v132, v6
v_add_f32 v133, v133, v7
v_lshlrev_b32 v8, 16, v115
v_and_b32 v9, 0xffff0000, v115
v_add_f32 v134, v134, v8
v_add_f32 v135, v135, v9
s_waitcnt vmcnt(1)
v_lshlrev_b32 v6, 16, v116
v_and_b32 v7, 0xffff0000, v116
v_add_f32 v136, v136, v6
v_add_f32 v137, v137, v7
v_lshlrev_b32 v8, 16, v117
v_and_b32 v9, 0xffff0000, v117
v_add_f32 v138, v138, v8
v_add_f32 v139, v139, v9
v_lshlrev_b32 v6, 16, v118
v_and_b32 v7, 0xffff0000, v118
v_add_f32 v140, v140, v6
v_add_f32 v141, v141, v7
v_lshlrev_b32 v8, 16, v119
v_and_b32 v9, 0xffff0000, v119
v_add_f32 v142, v142, v8
v_add_f32 v143, v143, v9
s_waitcnt vmcnt(0)
v_lshlrev_b32 v6, 16, v120
v_and_b32 v7, 0xffff0000, v120
v_add_f32 v144, v144, v6
v_add_f32 v145, v145, v7
v_lshlrev_b32 v8, 16, v121
v_and_b32 v9, 0xffff0000, v121
v_add_f32 v146, v146, v8
v_add_f32 v147, v147, v9
v_lshlrev_b32 v6, 16, v122
v_and_b32 v7, 0xffff0000, v122
v_add_f32 v148, v148, v6
v_add_f32 v149, v149, v7
v_lshlrev_b32 v8, 16, v123
v_and_b32 v9, 0xffff0000, v123
v_add_f32 v150, v150, v8
v_add_f32 v151, v151, v9
v_cvt_pk_bf16_f32 v152, v128, v129
v_cvt_pk_bf16_f32 v153, v130, v131
v_cvt_pk_bf16_f32 v154, v132, v133
v_cvt_pk_bf16_f32 v155, v134, v135
v_cvt_pk_bf16_f32 v156, v136, v137
v_cvt_pk_bf16_f32 v157, v138, v139
v_cvt_pk_bf16_f32 v158, v140, v141
v_cvt_pk_bf16_f32 v159, v142, v143
v_cvt_pk_bf16_f32 v160, v144, v145
v_cvt_pk_bf16_f32 v161, v146, v147
v_cvt_pk_bf16_f32 v162, v148, v149
v_cvt_pk_bf16_f32 v163, v150, v151
buffer_store_dwordx4 v[152:155], v5, s[16:19], s21 offen offset:0
buffer_store_dwordx4 v[156:159], v5, s[16:19], s21 offen offset:128
buffer_store_dwordx4 v[160:163], v5, s[16:19], s21 offen offset:256
L_end:
s_endpgm
L_f_slow1:
s_mov_b32 s52, 0
L_f_spin1:
buffer_load_dwordx2 v[14:15], v11, s[8:11], s23 offen sc1
s_add_u32 s52, s52, 1
s_waitcnt vmcnt(0)
v_cmp_eq_u64 vcc, s[68:69], v[14:15]
s_cmp_gt_u32 s52, 0x100000
s_cbranch_scc1 L_f_back1
s_cmp_eq_u64 vcc, exec
s_cbranch_scc0 L_f_spin1
s_branch L_f_back1
L_f_slow2:
s_mov_b32 s52, 0
L_f_spin2:
buffer_load_dwordx2 v[14:15], v11, s[8:11], s23 offen sc1
s_add_u32 s52, s52, 1
s_waitcnt vmcnt(0)
v_cmp_eq_u64 vcc, s[68:69], v[14:15]
s_cmp_gt_u32 s52, 0x100000
s_cbranch_scc1 L_f_back2
s_cmp_eq_u64 vcc, exec
s_cbranch_scc0 L_f_spin2
s_branch L_f_back2
L_f_slow3:
s_mov_b32 s52, 0
L_f_spin3:
buffer_load_dwordx2 v[14:15], v11, s[8:11], s23 offen sc1
s_add_u32 s52, s52, 1
s_waitcnt vmcnt(0)
v_cmp_eq_u64 vcc, s[68:69], v[14:15]
s_cmp_gt_u32 s52, 0x100000
s_cbranch_scc1 L_f_back3
s_cmp_eq_u64 vcc, exec
s_cbranch_scc0 L_f_spin3
s_branch L_f_back3
L_epoch:
s_cmp_lg_u32 s2, 0
s_cbranch_scc1 L_end
s_load_dwordx2 s[12:13], s[0:1], 64
s_waitcnt lgkmcnt(0)
s_mov_b32 s44, s12
s_and_b32 s45, s13, 0xffff
s_mov_b32 s46, 256
s_mov_b32 s47, 0x20000
v_mov_b32 v3, 0
s_mov_b32 s52, 0
L_ep:
buffer_load_dword v4, v3, s[44:47], 0 offen sc1
s_add_u32 s52, s52, 1
s_waitcnt vmcnt(0)
v_readfirstlane_b32 s40, v4
s_cmp_ge_u32 s52, 0x100000
s_cbranch_scc1 L_end
s_cmp_lt_u32 s40, 256
s_cbranch_scc1 L_ep
s_mov_b32 s40, 4194304
v_mov_b32 v13, 2146435072
v_cmp_eq_u32 vcc, 0, v1
v_mov_b32 v14, s68
v_mov_b32 v15, s69
v_cndmask_b32 v13, v13, 0, vcc
buffer_store_dwordx2 v[14:15], v13, s[8:11], s40 offen sc1
s_branch L_end
L_code_end:
s_endpgm
.section .rodata,"a"
.p2align 6
.amdhsa_kernel interleave_layers__sliding_local_dilated__glu_gated_geglu__prompt_kernel
  .amdhsa_next_free_vgpr 512
  .amdhsa_next_free_sgpr 102
  .amdhsa_accum_offset 256
  .amdhsa_group_segment_fixed_size 0
  .amdhsa_kernarg_size 80
  .amdhsa_user_sgpr_count 2
  .amdhsa_user_sgpr_kernarg_segment_ptr 1
  .amdhsa_system_sgpr_workgroup_id_x 1
.end_amdhsa_kernel
```

```asm
; @launch grid=(256,1,1) block=(256,1,1) lds=159744
.amdgcn_target "amdgcn-amd-amdhsa--gfx950"
.text
.p2align 8
.globl interleave_layers__sliding_local_dilated__glu_gated_geglu__prompt_kernel
.type interleave_layers__sliding_local_dilated__glu_gated_geglu__prompt_kernel,@function
interleave_layers__sliding_local_dilated__glu_gated_geglu__prompt_kernel:
s_cmp_ge_u32 s2, 256
s_cbranch_scc1 L_end
s_getpc_b64 s[40:41]
L_warm_pc:
s_lshr_b32 s42, s2, 3
s_lshl_b32 s42, s42, 11
v_lshlrev_b32 v10, 3, v0
v_add_u32 v10, s42, v10
v_min_u32 v10, L_code_end - L_warm_pc - 8, v10
v_mov_b32 v11, s41
v_add_co_u32 v10, vcc, s40, v10
s_nop 1
v_addc_co_u32 v11, vcc, 0, v11, vcc
global_load_dwordx2 a[0:1], v[10:11], off
v_add_co_u32 v10, vcc, 0x10000, v10
s_nop 1
v_addc_co_u32 v11, vcc, 0, v11, vcc
s_add_u32 s42, s42, 67584
s_cmp_le_u32 s42, L_code_end - L_warm_pc - 8
s_cbranch_scc0 L_warm_done
global_load_dwordx2 a[2:3], v[10:11], off
L_warm_done:
s_load_dwordx4 s[56:59], s[0:1], 0
s_load_dwordx2 s[60:61], s[0:1], 16
s_load_dwordx4 s[64:67], s[0:1], 32
s_load_dwordx2 s[62:63], s[0:1], 48
s_load_dwordx2 s[26:27], s[0:1], 64
s_load_dwordx2 s[12:13], s[0:1], 72
v_and_b32 v1, 63, v0
v_lshrrev_b32 v3, 6, v0
v_lshlrev_b32 v2, 4, v1
v_readfirstlane_b32 s4, v3
s_and_b32 s5, s2, 7
s_lshr_b32 s6, s2, 3
s_waitcnt lgkmcnt(0)
s_mov_b32 s8, s12
s_and_b32 s9, s13, 0xffff
s_mov_b32 s10, 268435456
s_mov_b32 s11, 0x20000
s_mov_b32 s16, s56
s_and_b32 s17, s57, 0xffff
s_mov_b32 s18, 2359296
s_mov_b32 s19, 0x20000
v_mov_b32 v3, 4194304
buffer_load_dwordx2 v[14:15], v3, s[8:11], 0 offen sc1
v_and_b32 v6, 7, v1
v_lshrrev_b32 v7, 3, v1
s_mul_i32 s22, s4, 24
v_add_u32 v7, s22, v7
s_and_b32 s23, s6, 1
s_lshl_b32 s23, s23, 3
v_add_u32 v8, s23, v6
v_lshlrev_b32 v8, 4, v8
v_lshl_add_u32 v4, v7, 8, v8
s_lshl_b32 s24, s5, 4
s_lshr_b32 s25, s6, 1
s_add_u32 s24, s24, s25
s_mul_i32 s20, s24, 18432
s_lshl_b32 s24, s5, 8
s_lshl_b32 s25, s6, 3
s_add_u32 s24, s24, s25
s_and_b32 s25, s24, 1023
s_lshl_b32 s25, s25, 1
s_lshr_b32 s24, s24, 10
s_add_u32 s24, s24, s25
s_mul_i32 s21, s24, 1152
v_mul_u32_u24 v8, 2304, v6
v_lshl_add_u32 v5, v7, 4, v8
s_cmp_eq_u32 s4, 3
s_cselect_b64 vcc, -1, 0
v_mov_b32 v8, 2146435072
v_cndmask_b32 v4, v4, v8, vcc
v_cndmask_b32 v5, v5, v8, vcc
buffer_load_dwordx4 v[16:19], v5, s[16:19], s21 offen offset:0 nt
buffer_load_dwordx4 v[20:23], v5, s[16:19], s21 offen offset:128 nt
buffer_load_dwordx4 v[24:27], v5, s[16:19], s21 offen offset:256 nt
s_lshl_b32 s40, s6, 2
s_add_u32 s40, s40, s4
v_and_b32 v6, 15, v1
v_lshrrev_b32 v7, 4, v1
v_lshrrev_b32 v8, 2, v6
v_mov_b32 v12, 2146435072
s_lshl_b32 s39, s5, 7
s_add_u32 s39, s39, s40
s_lshl_b32 s39, s39, 7
s_add_u32 s39, s39, 917504
s_cmp_ge_u32 s40, 96
s_cbranch_scc1 L_g_o
s_mov_b32 s44, s58
s_and_b32 s45, s59, 0xffff
s_mov_b32 s46, 1990656
s_mov_b32 s47, 0x20000
s_cmp_ge_u32 s40, 48
s_cselect_b32 s41, 1, 0
s_mul_i32 s42, s41, 48
s_sub_u32 s40, s40, s42
s_mul_i32 s40, s40, 3
s_lshl_b32 s42, s5, 1
s_add_u32 s41, s41, s42
s_mul_i32 s38, s41, 147456
s_lshl_b32 s42, s40, 10
s_add_u32 s38, s38, s42
s_add_u32 s38, s38, 4198400
s_mul_i32 s41, s41, 36
v_and_b32 v9, 1, v6
v_bfe_u32 v10, v6, 1, 1
v_mul_u32_u24 v10, 18, v10
v_add_u32 v9, v9, v10
v_mul_u32_u24 v10, 576, v8
v_add_u32 v9, v9, v10
v_mul_u32_u24 v10, 27648, v7
s_add_u32 s42, s40, 0
s_and_b32 s43, s42, 7
s_lshr_b32 s42, s42, 3
s_mul_i32 s42, s42, 110592
s_mov_b32 s35, 0
s_cmp_eq_u32 s43, 1
s_cselect_b32 s35, 18, s35
s_cmp_eq_u32 s43, 2
s_cselect_b32 s35, 576, s35
s_cmp_eq_u32 s43, 3
s_cselect_b32 s35, 594, s35
s_cmp_eq_u32 s43, 4
s_cselect_b32 s35, 16, s35
s_cmp_eq_u32 s43, 5
s_cselect_b32 s35, 1152, s35
s_cmp_eq_u32 s43, 6
s_cselect_b32 s35, 1170, s35
s_cmp_eq_u32 s43, 7
s_cselect_b32 s35, 1168, s35
s_add_u32 s35, s35, s41
s_mov_b32 s36, 16
s_cmp_eq_u32 s43, 4
s_cselect_b32 s36, 8, s36
s_cmp_eq_u32 s43, 7
s_cselect_b32 s36, 4, s36
s_cmp_lg_u32 s36, 16
s_cselect_b64 vcc, -1, 0
v_cndmask_b32 v11, v6, v9, vcc
v_add_u32 v11, s35, v11
v_lshl_add_u32 v11, v11, 1, v10
v_cmp_gt_u32 vcc, s36, v6
s_nop 1
v_cndmask_b32 v11, v12, v11, vcc
buffer_load_ushort v52, v11, s[44:47], s42 offen
s_add_u32 s42, s42, 3456
buffer_load_ushort v53, v11, s[44:47], s42 offen
s_add_u32 s42, s42, 3456
buffer_load_ushort v54, v11, s[44:47], s42 offen
s_add_u32 s42, s42, 3456
buffer_load_ushort v55, v11, s[44:47], s42 offen
s_add_u32 s42, s42, 3456
buffer_load_ushort v56, v11, s[44:47], s42 offen
s_add_u32 s42, s42, 3456
buffer_load_ushort v57, v11, s[44:47], s42 offen
s_add_u32 s42, s42, 3456
buffer_load_ushort v58, v11, s[44:47], s42 offen
s_add_u32 s42, s42, 3456
buffer_load_ushort v59, v11, s[44:47], s42 offen
s_add_u32 s42, s40, 1
s_and_b32 s43, s42, 7
s_lshr_b32 s42, s42, 3
s_mul_i32 s42, s42, 110592
s_mov_b32 s35, 0
s_cmp_eq_u32 s43, 1
s_cselect_b32 s35, 18, s35
s_cmp_eq_u32 s43, 2
s_cselect_b32 s35, 576, s35
s_cmp_eq_u32 s43, 3
s_cselect_b32 s35, 594, s35
s_cmp_eq_u32 s43, 4
s_cselect_b32 s35, 16, s35
s_cmp_eq_u32 s43, 5
s_cselect_b32 s35, 1152, s35
s_cmp_eq_u32 s43, 6
s_cselect_b32 s35, 1170, s35
s_cmp_eq_u32 s43, 7
s_cselect_b32 s35, 1168, s35
s_add_u32 s35, s35, s41
s_mov_b32 s36, 16
s_cmp_eq_u32 s43, 4
s_cselect_b32 s36, 8, s36
s_cmp_eq_u32 s43, 7
s_cselect_b32 s36, 4, s36
s_cmp_lg_u32 s36, 16
s_cselect_b64 vcc, -1, 0
v_cndmask_b32 v11, v6, v9, vcc
v_add_u32 v11, s35, v11
v_lshl_add_u32 v11, v11, 1, v10
v_cmp_gt_u32 vcc, s36, v6
s_nop 1
v_cndmask_b32 v11, v12, v11, vcc
buffer_load_ushort v60, v11, s[44:47], s42 offen
s_add_u32 s42, s42, 3456
buffer_load_ushort v61, v11, s[44:47], s42 offen
s_add_u32 s42, s42, 3456
buffer_load_ushort v62, v11, s[44:47], s42 offen
s_add_u32 s42, s42, 3456
buffer_load_ushort v63, v11, s[44:47], s42 offen
s_add_u32 s42, s42, 3456
buffer_load_ushort v64, v11, s[44:47], s42 offen
s_add_u32 s42, s42, 3456
buffer_load_ushort v65, v11, s[44:47], s42 offen
s_add_u32 s42, s42, 3456
buffer_load_ushort v66, v11, s[44:47], s42 offen
s_add_u32 s42, s42, 3456
buffer_load_ushort v67, v11, s[44:47], s42 offen
s_add_u32 s42, s40, 2
s_and_b32 s43, s42, 7
s_lshr_b32 s42, s42, 3
s_mul_i32 s42, s42, 110592
s_mov_b32 s35, 0
s_cmp_eq_u32 s43, 1
s_cselect_b32 s35, 18, s35
s_cmp_eq_u32 s43, 2
s_cselect_b32 s35, 576, s35
s_cmp_eq_u32 s43, 3
s_cselect_b32 s35, 594, s35
s_cmp_eq_u32 s43, 4
s_cselect_b32 s35, 16, s35
s_cmp_eq_u32 s43, 5
s_cselect_b32 s35, 1152, s35
s_cmp_eq_u32 s43, 6
s_cselect_b32 s35, 1170, s35
s_cmp_eq_u32 s43, 7
s_cselect_b32 s35, 1168, s35
s_add_u32 s35, s35, s41
s_mov_b32 s36, 16
s_cmp_eq_u32 s43, 4
s_cselect_b32 s36, 8, s36
s_cmp_eq_u32 s43, 7
s_cselect_b32 s36, 4, s36
s_cmp_lg_u32 s36, 16
s_cselect_b64 vcc, -1, 0
v_cndmask_b32 v11, v6, v9, vcc
v_add_u32 v11, s35, v11
v_lshl_add_u32 v11, v11, 1, v10
v_cmp_gt_u32 vcc, s36, v6
s_nop 1
v_cndmask_b32 v11, v12, v11, vcc
buffer_load_ushort v68, v11, s[44:47], s42 offen
s_add_u32 s42, s42, 3456
buffer_load_ushort v69, v11, s[44:47], s42 offen
s_add_u32 s42, s42, 3456
buffer_load_ushort v70, v11, s[44:47], s42 offen
s_add_u32 s42, s42, 3456
buffer_load_ushort v71, v11, s[44:47], s42 offen
s_add_u32 s42, s42, 3456
buffer_load_ushort v72, v11, s[44:47], s42 offen
s_add_u32 s42, s42, 3456
buffer_load_ushort v73, v11, s[44:47], s42 offen
s_add_u32 s42, s42, 3456
buffer_load_ushort v74, v11, s[44:47], s42 offen
s_add_u32 s42, s42, 3456
buffer_load_ushort v75, v11, s[44:47], s42 offen
s_branch L_g_done
L_g_o:
s_mov_b32 s44, s60
s_and_b32 s45, s61, 0xffff
s_mov_b32 s46, 663552
s_mov_b32 s47, 0x20000
s_sub_u32 s40, s40, 96
s_mul_i32 s40, s40, 3
s_mul_i32 s38, s5, 92160
s_lshl_b32 s42, s40, 10
s_add_u32 s38, s38, s42
s_add_u32 s38, s38, 6557696
s_cmp_ge_u32 s40, 90
s_cselect_b32 s38, 2146435072, s38
s_mul_i32 s41, s5, 72
v_and_b32 v9, 3, v6
v_lshl_add_u32 v9, v8, 3, v9
s_add_u32 s42, s40, 0
s_mul_i32 s43, s42, 13108
s_lshr_b32 s43, s43, 16
s_mul_i32 s35, s43, 5
s_sub_u32 s42, s42, s35
s_lshr_b32 s35, s42, 1
s_lshl_b32 s35, s35, 5
s_and_b32 s36, s42, 1
s_lshl_b32 s36, s36, 2
s_add_u32 s35, s35, s36
s_add_u32 s35, s35, s41
s_cmp_eq_u32 s42, 4
s_cselect_b64 vcc, -1, 0
s_cselect_b32 s36, 8, 16
v_cndmask_b32 v11, v9, v6, vcc
v_add_u32 v11, s35, v11
s_mul_i32 s35, s43, 41472
s_sub_u32 s37, s43, 16
s_mul_i32 s37, s37, 331776
s_cmp_lt_u32 s43, 16
s_cselect_b32 s35, s35, s37
s_cselect_b32 s37, 4, 72
s_cselect_b32 s34, 0, 1
s_mul_i32 s37, s37, 1152
v_mul_lo_u32 v10, s37, v7
v_lshl_add_u32 v11, v11, 1, v10
v_cmp_gt_u32 vcc, s36, v6
s_nop 1
v_cndmask_b32 v11, v12, v11, vcc
s_mul_i32 s42, s34, 18432
s_add_u32 s42, s42, 0
s_add_u32 s42, s42, s35
buffer_load_ushort v52, v11, s[44:47], s42 offen
s_mul_i32 s42, s34, 18432
s_add_u32 s42, s42, 1152
s_add_u32 s42, s42, s35
buffer_load_ushort v53, v11, s[44:47], s42 offen
s_mul_i32 s42, s34, 36864
s_add_u32 s42, s42, 2304
s_add_u32 s42, s42, s35
buffer_load_ushort v54, v11, s[44:47], s42 offen
s_mul_i32 s42, s34, 36864
s_add_u32 s42, s42, 3456
s_add_u32 s42, s42, s35
buffer_load_ushort v55, v11, s[44:47], s42 offen
s_mul_i32 s42, s34, 39168
s_add_u32 s42, s42, 20736
s_add_u32 s42, s42, s35
buffer_load_ushort v56, v11, s[44:47], s42 offen
s_mul_i32 s42, s34, 39168
s_add_u32 s42, s42, 21888
s_add_u32 s42, s42, s35
buffer_load_ushort v57, v11, s[44:47], s42 offen
s_mul_i32 s42, s34, 57600
s_add_u32 s42, s42, 23040
s_add_u32 s42, s42, s35
buffer_load_ushort v58, v11, s[44:47], s42 offen
s_mul_i32 s42, s34, 57600
s_add_u32 s42, s42, 24192
s_add_u32 s42, s42, s35
buffer_load_ushort v59, v11, s[44:47], s42 offen
s_add_u32 s42, s40, 1
s_mul_i32 s43, s42, 13108
s_lshr_b32 s43, s43, 16
s_mul_i32 s35, s43, 5
s_sub_u32 s42, s42, s35
s_lshr_b32 s35, s42, 1
s_lshl_b32 s35, s35, 5
s_and_b32 s36, s42, 1
s_lshl_b32 s36, s36, 2
s_add_u32 s35, s35, s36
s_add_u32 s35, s35, s41
s_cmp_eq_u32 s42, 4
s_cselect_b64 vcc, -1, 0
s_cselect_b32 s36, 8, 16
v_cndmask_b32 v11, v9, v6, vcc
v_add_u32 v11, s35, v11
s_mul_i32 s35, s43, 41472
s_sub_u32 s37, s43, 16
s_mul_i32 s37, s37, 331776
s_cmp_lt_u32 s43, 16
s_cselect_b32 s35, s35, s37
s_cselect_b32 s37, 4, 72
s_cselect_b32 s34, 0, 1
s_mul_i32 s37, s37, 1152
v_mul_lo_u32 v10, s37, v7
v_lshl_add_u32 v11, v11, 1, v10
v_cmp_gt_u32 vcc, s36, v6
s_nop 1
v_cndmask_b32 v11, v12, v11, vcc
s_mul_i32 s42, s34, 18432
s_add_u32 s42, s42, 0
s_add_u32 s42, s42, s35
buffer_load_ushort v60, v11, s[44:47], s42 offen
s_mul_i32 s42, s34, 18432
s_add_u32 s42, s42, 1152
s_add_u32 s42, s42, s35
buffer_load_ushort v61, v11, s[44:47], s42 offen
s_mul_i32 s42, s34, 36864
s_add_u32 s42, s42, 2304
s_add_u32 s42, s42, s35
buffer_load_ushort v62, v11, s[44:47], s42 offen
s_mul_i32 s42, s34, 36864
s_add_u32 s42, s42, 3456
s_add_u32 s42, s42, s35
buffer_load_ushort v63, v11, s[44:47], s42 offen
s_mul_i32 s42, s34, 39168
s_add_u32 s42, s42, 20736
s_add_u32 s42, s42, s35
buffer_load_ushort v64, v11, s[44:47], s42 offen
s_mul_i32 s42, s34, 39168
s_add_u32 s42, s42, 21888
s_add_u32 s42, s42, s35
buffer_load_ushort v65, v11, s[44:47], s42 offen
s_mul_i32 s42, s34, 57600
s_add_u32 s42, s42, 23040
s_add_u32 s42, s42, s35
buffer_load_ushort v66, v11, s[44:47], s42 offen
s_mul_i32 s42, s34, 57600
s_add_u32 s42, s42, 24192
s_add_u32 s42, s42, s35
buffer_load_ushort v67, v11, s[44:47], s42 offen
s_add_u32 s42, s40, 2
s_mul_i32 s43, s42, 13108
s_lshr_b32 s43, s43, 16
s_mul_i32 s35, s43, 5
s_sub_u32 s42, s42, s35
s_lshr_b32 s35, s42, 1
s_lshl_b32 s35, s35, 5
s_and_b32 s36, s42, 1
s_lshl_b32 s36, s36, 2
s_add_u32 s35, s35, s36
s_add_u32 s35, s35, s41
s_cmp_eq_u32 s42, 4
s_cselect_b64 vcc, -1, 0
s_cselect_b32 s36, 8, 16
v_cndmask_b32 v11, v9, v6, vcc
v_add_u32 v11, s35, v11
s_mul_i32 s35, s43, 41472
s_sub_u32 s37, s43, 16
s_mul_i32 s37, s37, 331776
s_cmp_lt_u32 s43, 16
s_cselect_b32 s35, s35, s37
s_cselect_b32 s37, 4, 72
s_cselect_b32 s34, 0, 1
s_mul_i32 s37, s37, 1152
v_mul_lo_u32 v10, s37, v7
v_lshl_add_u32 v11, v11, 1, v10
v_cmp_gt_u32 vcc, s36, v6
s_nop 1
v_cndmask_b32 v11, v12, v11, vcc
s_mul_i32 s42, s34, 18432
s_add_u32 s42, s42, 0
s_add_u32 s42, s42, s35
buffer_load_ushort v68, v11, s[44:47], s42 offen
s_mul_i32 s42, s34, 18432
s_add_u32 s42, s42, 1152
s_add_u32 s42, s42, s35
buffer_load_ushort v69, v11, s[44:47], s42 offen
s_mul_i32 s42, s34, 36864
s_add_u32 s42, s42, 2304
s_add_u32 s42, s42, s35
buffer_load_ushort v70, v11, s[44:47], s42 offen
s_mul_i32 s42, s34, 36864
s_add_u32 s42, s42, 3456
s_add_u32 s42, s42, s35
buffer_load_ushort v71, v11, s[44:47], s42 offen
s_mul_i32 s42, s34, 39168
s_add_u32 s42, s42, 20736
s_add_u32 s42, s42, s35
buffer_load_ushort v72, v11, s[44:47], s42 offen
s_mul_i32 s42, s34, 39168
s_add_u32 s42, s42, 21888
s_add_u32 s42, s42, s35
buffer_load_ushort v73, v11, s[44:47], s42 offen
s_mul_i32 s42, s34, 57600
s_add_u32 s42, s42, 23040
s_add_u32 s42, s42, s35
buffer_load_ushort v74, v11, s[44:47], s42 offen
s_mul_i32 s42, s34, 57600
s_add_u32 s42, s42, 24192
s_add_u32 s42, s42, s35
buffer_load_ushort v75, v11, s[44:47], s42 offen
L_g_done:
s_cmp_ge_u32 s2, 144
s_cbranch_scc1 L_l1_d
s_mul_i32 s40, s2, 911
s_lshr_b32 s40, s40, 16
s_mul_i32 s41, s40, 72
s_sub_u32 s41, s2, s41
s_cmp_eq_u32 s40, 0
s_cselect_b64 s[12:13], s[64:65], s[66:67]
s_mov_b32 s48, s12
s_and_b32 s49, s13, 0xffff
s_mov_b32 s50, 5308416
s_mov_b32 s51, 0x20000
s_lshl_b32 s42, s41, 7
v_lshlrev_b32 v9, 3, v6
v_mul_u32_u24 v10, 73728, v7
v_add3_u32 v254, v9, v10, s42
s_bitcmp1_b32 s4, 0
s_cselect_b64 vcc, -1, 0
v_cndmask_b32 v255, v254, v12, vcc
s_mul_i32 s43, s4, 9
s_add_u32 s43, s43, 1
s_lshr_b32 s43, s43, 1
s_mul_i32 s53, s43, 294912
buffer_load_dwordx2 v[76:77], v254, s[48:51], s53 offen nt
s_add_u32 s53, s53, 9216
buffer_load_dwordx2 v[78:79], v254, s[48:51], s53 offen nt
s_add_u32 s53, s53, 9216
buffer_load_dwordx2 v[80:81], v254, s[48:51], s53 offen nt
s_add_u32 s53, s53, 9216
buffer_load_dwordx2 v[82:83], v254, s[48:51], s53 offen nt
s_add_u32 s53, s53, 9216
buffer_load_dwordx2 v[84:85], v254, s[48:51], s53 offen nt
s_add_u32 s53, s53, 9216
buffer_load_dwordx2 v[86:87], v254, s[48:51], s53 offen nt
s_add_u32 s53, s53, 9216
buffer_load_dwordx2 v[88:89], v254, s[48:51], s53 offen nt
s_add_u32 s53, s53, 9216
buffer_load_dwordx2 v[90:91], v254, s[48:51], s53 offen nt
s_add_u32 s53, s53, 230400
buffer_load_dwordx2 v[92:93], v254, s[48:51], s53 offen nt
s_add_u32 s53, s53, 9216
s_mul_i32 s42, s41, 7282
s_lshr_b32 s42, s42, 16
s_mul_i32 s35, s42, 9
s_sub_u32 s41, s41, s35
s_lshl_b32 s41, s41, 2
s_lshl_b32 s42, s42, 2
s_lshl_b32 s40, s40, 11
s_add_u32 s40, s40, 7303168
s_mov_b32 s35, 497664
v_and_b32 v6, 3, v1
v_add_u32 v6, s41, v6
v_mul_u32_u24 v7, 57, v6
v_lshrrev_b32 v7, 9, v7
v_mul_u32_u24 v8, 9, v7
v_sub_u32 v6, v6, v8
v_add_u32 v8, 1, v6
v_cmp_eq_u32 vcc, 9, v8
s_nop 1
v_cndmask_b32 v8, v8, 0, vcc
v_and_b32 v9, 1, v7
v_cmp_eq_u32 vcc, 0, v9
s_nop 1
v_cndmask_b32 v6, v6, v8, vcc
v_add_u32 v7, s42, v7
v_mul_lo_u32 v7, v7, s35
v_add_u32 v7, s40, v7
v_lshrrev_b32 v8, 2, v1
v_add_u32 v8, s43, v8
v_and_b32 v9, 1, v8
v_lshl_add_u32 v7, v9, 10, v7
v_lshrrev_b32 v9, 1, v8
v_lshlrev_b32 v9, 12, v9
v_add_u32 v7, v7, v9
v_lshl_add_u32 v9, v6, 12, v9
v_mul_u32_u24 v10, 36864, v6
v_cmp_gt_u32 vcc, 2, v6
s_nop 1
v_cndmask_b32 v9, v10, v9, vcc
v_add_u32 v7, v7, v9
v_cmp_gt_u32 vcc, 18, v8
s_nop 1
v_cndmask_b32 v7, v12, v7, vcc
s_bitcmp1_b32 s4, 0
s_cselect_b32 s41, 16, 20
v_cmp_gt_u32 vcc, s41, v1
s_nop 1
v_cndmask_b32 v7, v12, v7, vcc
s_nop 0
v_readlane_b32 s40, v7, 0
v_readlane_b32 s41, v7, 1
v_readlane_b32 s42, v7, 2
v_readlane_b32 s43, v7, 3
v_add_u32 v156, s40, v2
v_add_u32 v157, s41, v2
v_add_u32 v158, s42, v2
v_add_u32 v159, s43, v2
v_readlane_b32 s40, v7, 4
v_readlane_b32 s41, v7, 5
v_readlane_b32 s42, v7, 6
v_readlane_b32 s43, v7, 7
v_add_u32 v160, s40, v2
v_add_u32 v161, s41, v2
v_add_u32 v162, s42, v2
v_add_u32 v163, s43, v2
v_readlane_b32 s40, v7, 8
v_readlane_b32 s41, v7, 9
v_readlane_b32 s42, v7, 10
v_readlane_b32 s43, v7, 11
v_add_u32 v164, s40, v2
v_add_u32 v165, s41, v2
v_add_u32 v166, s42, v2
v_add_u32 v167, s43, v2
v_readlane_b32 s40, v7, 12
v_readlane_b32 s41, v7, 13
v_readlane_b32 s42, v7, 14
v_readlane_b32 s43, v7, 15
v_add_u32 v168, s40, v2
v_add_u32 v169, s41, v2
v_add_u32 v170, s42, v2
v_add_u32 v171, s43, v2
v_readlane_b32 s40, v7, 16
v_readlane_b32 s41, v7, 17
v_readlane_b32 s42, v7, 18
v_readlane_b32 s43, v7, 19
v_add_u32 v172, s40, v2
v_add_u32 v173, s41, v2
v_add_u32 v174, s42, v2
v_add_u32 v175, s43, v2
s_waitcnt vmcnt(33)
s_branch L_l1_e
L_l1_d:
s_cmp_ge_u32 s2, 216
s_cbranch_scc1 L_l1_n
s_mov_b32 s48, s62
s_and_b32 s49, s63, 0xffff
s_mov_b32 s50, 5308416
s_mov_b32 s51, 0x20000
s_sub_u32 s40, s2, 144
s_mul_i32 s53, s40, 73728
s_lshl_b32 s41, s4, 8
s_lshl_b32 s42, s4, 5
v_mul_u32_u24 v10, 18432, v7
v_lshl_add_u32 v9, v6, 3, v10
v_add_u32 v254, s41, v9
v_lshl_add_u32 v9, v6, 1, v10
v_add_u32 v255, s42, v9
s_add_u32 s43, s53, 0
buffer_load_dwordx2 v[76:77], v254, s[48:51], s43 offen offset:0 nt
buffer_load_dwordx2 v[92:93], v254, s[48:51], s43 offen offset:128 nt
buffer_load_ushort v108, v255, s[48:51], s43 offen offset:1024 nt
s_add_u32 s43, s53, 4608
buffer_load_dwordx2 v[78:79], v254, s[48:51], s43 offen offset:0 nt
buffer_load_dwordx2 v[94:95], v254, s[48:51], s43 offen offset:128 nt
buffer_load_ushort v109, v255, s[48:51], s43 offen offset:1024 nt
s_add_u32 s43, s53, 9216
buffer_load_dwordx2 v[80:81], v254, s[48:51], s43 offen offset:0 nt
buffer_load_dwordx2 v[96:97], v254, s[48:51], s43 offen offset:128 nt
buffer_load_ushort v110, v255, s[48:51], s43 offen offset:1024 nt
s_mul_i32 s41, s40, 7282
s_lshr_b32 s41, s41, 16
s_mul_i32 s42, s41, 9
s_sub_u32 s40, s40, s42
s_lshl_b32 s40, s40, 1
s_lshl_b32 s41, s41, 2
s_add_u32 s41, s41, s4
s_mul_i32 s41, s41, 497664
s_add_u32 s41, s41, 7634944
v_cmp_lt_u32 vcc, 8, v1
s_nop 1
v_cndmask_b32 v6, 0, 1, vcc
v_mul_u32_u24 v7, 9, v6
v_sub_u32 v7, v1, v7
v_add_u32 v6, s40, v6
v_mov_b32 v8, 0
v_cmp_lt_u32 vcc, 4, v6
s_nop 1
v_addc_co_u32 v8, vcc, 0, v8, vcc
v_cmp_lt_u32 vcc, 8, v6
s_nop 1
v_addc_co_u32 v8, vcc, 0, v8, vcc
v_cmp_lt_u32 vcc, 13, v6
s_nop 1
v_addc_co_u32 v8, vcc, 0, v8, vcc
v_mul_u32_u24 v9, 9, v8
v_add_u32 v9, 1, v9
v_lshrrev_b32 v9, 1, v9
v_sub_u32 v9, v6, v9
v_subrev_u32 v8, s4, v8
v_and_b32 v8, 3, v8
v_mul_u32_u24 v10, 3, v9
v_add3_u32 v10, v10, v8, 2
v_add_u32 v11, 3, v10
v_cmp_lt_u32 vcc, 1, v9
s_nop 1
v_cndmask_b32 v10, v10, v11, vcc
v_cmp_eq_u32 vcc, 3, v9
s_nop 1
v_cndmask_b32 v9, v9, 11, vcc
v_cmp_eq_u32 vcc, 0, v8
s_nop 1
v_cndmask_b32 v10, v10, v9, vcc
v_cmp_eq_u32 vcc, 4, v6
s_nop 1
v_cndmask_b32 v10, v10, 9, vcc
v_cmp_eq_u32 vcc, 13, v6
s_nop 1
v_cndmask_b32 v10, v10, 10, vcc
v_and_b32 v6, 30, v10
v_and_b32 v8, 1, v10
v_lshl_add_u32 v8, v7, 1, v8
v_mad_u32_u24 v9, v6, 9, v8
v_lshl_add_u32 v11, v6, 3, v8
v_add_u32 v11, 10, v11
v_lshl_add_u32 v6, v7, 2, v10
v_add_u32 v6, 108, v6
v_cmp_gt_u32 vcc, 14, v10
s_nop 1
v_cndmask_b32 v11, v6, v11, vcc
v_add_u32 v6, 144, v10
v_cmp_eq_u32 vcc, 8, v7
s_nop 1
v_cndmask_b32 v11, v11, v6, vcc
v_cmp_gt_u32 vcc, 10, v10
s_nop 1
v_cndmask_b32 v9, v11, v9, vcc
v_lshlrev_b32 v9, 10, v9
v_add_u32 v9, s41, v9
v_cmp_gt_u32 vcc, 18, v1
s_nop 1
v_cndmask_b32 v9, v12, v9, vcc
s_nop 0
v_readlane_b32 s40, v9, 0
v_readlane_b32 s41, v9, 1
v_readlane_b32 s42, v9, 2
v_readlane_b32 s43, v9, 3
v_add_u32 v156, s40, v2
v_add_u32 v157, s41, v2
v_add_u32 v158, s42, v2
v_add_u32 v159, s43, v2
v_readlane_b32 s40, v9, 4
v_readlane_b32 s41, v9, 5
v_readlane_b32 s42, v9, 6
v_readlane_b32 s43, v9, 7
v_add_u32 v160, s40, v2
v_add_u32 v161, s41, v2
v_add_u32 v162, s42, v2
v_add_u32 v163, s43, v2
v_readlane_b32 s40, v9, 8
v_readlane_b32 s41, v9, 9
v_readlane_b32 s42, v9, 10
v_readlane_b32 s43, v9, 11
v_add_u32 v164, s40, v2
v_add_u32 v165, s41, v2
v_add_u32 v166, s42, v2
v_add_u32 v167, s43, v2
v_readlane_b32 s40, v9, 12
v_readlane_b32 s41, v9, 13
v_readlane_b32 s42, v9, 14
v_readlane_b32 s43, v9, 15
v_add_u32 v168, s40, v2
v_add_u32 v169, s41, v2
v_add_u32 v170, s42, v2
v_add_u32 v171, s43, v2
v_readlane_b32 s40, v9, 16
v_readlane_b32 s41, v9, 17
v_readlane_b32 s42, v9, 18
v_readlane_b32 s43, v9, 19
v_add_u32 v172, s40, v2
v_add_u32 v173, s41, v2
v_add_u32 v174, s42, v2
v_add_u32 v175, s43, v2
s_waitcnt vmcnt(33)
s_branch L_l1_e
L_l1_n:
v_mov_b32 v156, v12
v_mov_b32 v157, v12
v_mov_b32 v158, v12
v_mov_b32 v159, v12
v_mov_b32 v160, v12
v_mov_b32 v161, v12
v_mov_b32 v162, v12
v_mov_b32 v163, v12
v_mov_b32 v164, v12
v_mov_b32 v165, v12
v_mov_b32 v166, v12
v_mov_b32 v167, v12
v_mov_b32 v168, v12
v_mov_b32 v169, v12
v_mov_b32 v170, v12
v_mov_b32 v171, v12
v_mov_b32 v172, v12
v_mov_b32 v173, v12
v_mov_b32 v174, v12
v_mov_b32 v175, v12
s_waitcnt vmcnt(24)
L_l1_e:
v_readfirstlane_b32 s40, v14
v_readfirstlane_b32 s41, v15
s_add_u32 s68, s40, 1
s_addc_u32 s69, s41, 0
v_lshlrev_b32 v28, 16, v16
v_and_b32 v29, 0xffff0000, v16
v_lshlrev_b32 v30, 16, v17
v_and_b32 v31, 0xffff0000, v17
v_lshlrev_b32 v32, 16, v18
v_and_b32 v33, 0xffff0000, v18
v_lshlrev_b32 v34, 16, v19
v_and_b32 v35, 0xffff0000, v19
v_lshlrev_b32 v36, 16, v20
v_and_b32 v37, 0xffff0000, v20
v_lshlrev_b32 v38, 16, v21
v_and_b32 v39, 0xffff0000, v21
v_lshlrev_b32 v40, 16, v22
v_and_b32 v41, 0xffff0000, v22
v_lshlrev_b32 v42, 16, v23
v_and_b32 v43, 0xffff0000, v23
v_lshlrev_b32 v44, 16, v24
v_and_b32 v45, 0xffff0000, v24
v_lshlrev_b32 v46, 16, v25
v_and_b32 v47, 0xffff0000, v25
v_lshlrev_b32 v48, 16, v26
v_and_b32 v49, 0xffff0000, v26
v_lshlrev_b32 v50, 16, v27
v_and_b32 v51, 0xffff0000, v27
s_add_u32 s24, s20, 27979776
s_add_u32 s25, s24, 4096
buffer_store_dwordx4 v[16:19], v4, s[8:11], s24 offen offset:0 sc1
buffer_store_dwordx4 v[20:23], v4, s[8:11], s24 offen offset:2048 sc1
buffer_store_dwordx4 v[24:27], v4, s[8:11], s25 offen offset:0 sc1
v_add_f32 v6, v28, v29
v_mul_f32 v7, v28, v28
v_mul_f32 v9, v29, v29
v_mov_b32 v8, 0
v_add_f32 v6, v6, v30
v_add_f32 v8, v8, v31
v_fmac_f32 v7, v30, v30
v_fmac_f32 v9, v31, v31
v_add_f32 v6, v6, v32
v_add_f32 v8, v8, v33
v_fmac_f32 v7, v32, v32
v_fmac_f32 v9, v33, v33
v_add_f32 v6, v6, v34
v_add_f32 v8, v8, v35
v_fmac_f32 v7, v34, v34
v_fmac_f32 v9, v35, v35
v_add_f32 v6, v6, v36
v_add_f32 v8, v8, v37
v_fmac_f32 v7, v36, v36
v_fmac_f32 v9, v37, v37
v_add_f32 v6, v6, v38
v_add_f32 v8, v8, v39
v_fmac_f32 v7, v38, v38
v_fmac_f32 v9, v39, v39
v_add_f32 v6, v6, v40
v_add_f32 v8, v8, v41
v_fmac_f32 v7, v40, v40
v_fmac_f32 v9, v41, v41
v_add_f32 v6, v6, v42
v_add_f32 v8, v8, v43
v_fmac_f32 v7, v42, v42
v_fmac_f32 v9, v43, v43
v_add_f32 v6, v6, v44
v_add_f32 v8, v8, v45
v_fmac_f32 v7, v44, v44
v_fmac_f32 v9, v45, v45
v_add_f32 v6, v6, v46
v_add_f32 v8, v8, v47
v_fmac_f32 v7, v46, v46
v_fmac_f32 v9, v47, v47
v_add_f32 v6, v6, v48
v_add_f32 v8, v8, v49
v_fmac_f32 v7, v48, v48
v_fmac_f32 v9, v49, v49
v_add_f32 v6, v6, v50
v_add_f32 v8, v8, v51
v_fmac_f32 v7, v50, v50
v_fmac_f32 v9, v51, v51
v_add_f32 v6, v6, v8
v_add_f32 v7, v7, v9
s_nop 0
v_add_f32_dpp v6, v6, v6 row_ror:8 row_mask:0xf bank_mask:0xf
v_add_f32_dpp v7, v7, v7 row_ror:8 row_mask:0xf bank_mask:0xf
v_mov_b32 v8, v6
v_mov_b32 v9, v7
s_nop 0
v_permlane16_swap_b32 v6, v8
v_permlane16_swap_b32 v7, v9
v_add_f32 v6, v6, v8
v_add_f32 v7, v7, v9
v_mov_b32 v8, v6
v_mov_b32 v9, v7
s_nop 0
v_permlane32_swap_b32 v6, v8
v_permlane32_swap_b32 v7, v9
v_add_f32 v6, v6, v8
v_add_f32 v7, v7, v9
v_and_b32 v10, 7, v1
v_lshlrev_b32 v10, 3, v10
v_add_u32 v10, 147456, v10
s_lshl_b32 s24, s4, 6
v_add_u32 v11, s24, v10
ds_write_b64 v11, v[6:7]
s_waitcnt lgkmcnt(0)
s_barrier
ds_read_b64 v[6:7], v10
ds_read_b64 v[8:9], v10 offset:64
ds_read_b64 v[12:13], v10 offset:128
s_waitcnt lgkmcnt(0)
v_add_f32 v6, v6, v8
v_add_f32 v7, v7, v9
v_add_f32 v6, v6, v12
v_add_f32 v7, v7, v13
v_mul_f32 v6, 0x3ae38e39, v6
v_mul_f32 v7, 0x3ae38e39, v7
v_fma_f32 v7, -v6, v6, v7
v_max_f32 v7, 0, v7
v_add_f32 v7, 0x3727c5ac, v7
v_rsq_f32 v7, v7
s_nop 0
v_mul_f32 v6, v6, v7
v_fma_f32 v28, v28, v7, -v6
v_fma_f32 v29, v29, v7, -v6
v_fma_f32 v30, v30, v7, -v6
v_fma_f32 v31, v31, v7, -v6
v_fma_f32 v32, v32, v7, -v6
v_fma_f32 v33, v33, v7, -v6
v_fma_f32 v34, v34, v7, -v6
v_fma_f32 v35, v35, v7, -v6
v_fma_f32 v36, v36, v7, -v6
v_fma_f32 v37, v37, v7, -v6
v_fma_f32 v38, v38, v7, -v6
v_fma_f32 v39, v39, v7, -v6
v_fma_f32 v40, v40, v7, -v6
v_fma_f32 v41, v41, v7, -v6
v_fma_f32 v42, v42, v7, -v6
v_fma_f32 v43, v43, v7, -v6
v_fma_f32 v44, v44, v7, -v6
v_fma_f32 v45, v45, v7, -v6
v_fma_f32 v46, v46, v7, -v6
v_fma_f32 v47, v47, v7, -v6
v_fma_f32 v48, v48, v7, -v6
v_fma_f32 v49, v49, v7, -v6
v_fma_f32 v50, v50, v7, -v6
v_fma_f32 v51, v51, v7, -v6
v_cvt_pk_bf16_f32 v16, v28, v29
v_cvt_pk_bf16_f32 v17, v30, v31
v_cvt_pk_bf16_f32 v18, v32, v33
v_cvt_pk_bf16_f32 v19, v34, v35
v_cvt_pk_bf16_f32 v20, v36, v37
v_cvt_pk_bf16_f32 v21, v38, v39
v_cvt_pk_bf16_f32 v22, v40, v41
v_cvt_pk_bf16_f32 v23, v42, v43
v_cvt_pk_bf16_f32 v24, v44, v45
v_cvt_pk_bf16_f32 v25, v46, v47
v_cvt_pk_bf16_f32 v26, v48, v49
v_cvt_pk_bf16_f32 v27, v50, v51
s_add_u32 s24, s20, 23261184
s_add_u32 s25, s24, 4096
buffer_store_dwordx4 v[16:19], v4, s[8:11], s24 offen offset:0 sc1
buffer_store_dwordx4 v[20:23], v4, s[8:11], s24 offen offset:2048 sc1
buffer_store_dwordx4 v[24:27], v4, s[8:11], s25 offen offset:0 sc1
s_lshl_b32 s24, s5, 4
s_lshr_b32 s25, s6, 1
s_add_u32 s24, s24, s25
s_lshl_b32 s24, s24, 3
s_and_b32 s25, s6, 1
s_mul_i32 s25, s25, 3
s_add_u32 s24, s24, s25
s_add_u32 s24, s24, s4
s_lshl_b32 s24, s24, 7
s_add_u32 s24, s24, 786432
s_cmp_eq_u32 s4, 3
s_cselect_b32 s24, 2146435072, s24
s_waitcnt vmcnt(6)
v_lshl_or_b32 v52, v53, 16, v52
v_lshl_or_b32 v53, v55, 16, v54
v_lshl_or_b32 v54, v57, 16, v56
v_lshl_or_b32 v55, v59, 16, v58
buffer_store_dwordx4 v[52:55], v2, s[8:11], s38 offen offset:0 sc1
v_lshl_or_b32 v60, v61, 16, v60
v_lshl_or_b32 v61, v63, 16, v62
v_lshl_or_b32 v62, v65, 16, v64
v_lshl_or_b32 v63, v67, 16, v66
buffer_store_dwordx4 v[60:63], v2, s[8:11], s38 offen offset:1024 sc1
v_lshl_or_b32 v68, v69, 16, v68
v_lshl_or_b32 v69, v71, 16, v70
v_lshl_or_b32 v70, v73, 16, v72
v_lshl_or_b32 v71, v75, 16, v74
buffer_store_dwordx4 v[68:71], v2, s[8:11], s38 offen offset:2048 sc1
v_mov_b32 v13, 2146435072
v_cmp_eq_u32 vcc, 0, v1
v_mov_b32 v14, s68
v_mov_b32 v15, s69
v_cndmask_b32 v13, v13, 0, vcc
s_waitcnt vmcnt(0)
buffer_store_dwordx2 v[14:15], v13, s[8:11], s24 offen sc1
buffer_store_dwordx2 v[14:15], v13, s[8:11], s39 offen sc1
s_mov_b32 s44, s26
s_and_b32 s45, s27, 0xffff
s_mov_b32 s46, 256
s_mov_b32 s47, 0x20000
s_cmp_eq_u32 s4, 0
s_cselect_b32 s40, 0, 4096
v_mov_b32 v3, 1
buffer_atomic_add v3, v13, s[44:47], s40 offen sc1
s_cmp_ge_u32 s2, 144
s_cbranch_scc1 L_l2_d
buffer_load_dwordx2 v[94:95], v254, s[48:51], s53 offen nt
s_add_u32 s53, s53, 9216
buffer_load_dwordx2 v[96:97], v254, s[48:51], s53 offen nt
s_add_u32 s53, s53, 9216
buffer_load_dwordx2 v[98:99], v254, s[48:51], s53 offen nt
s_add_u32 s53, s53, 9216
buffer_load_dwordx2 v[100:101], v254, s[48:51], s53 offen nt
s_add_u32 s53, s53, 9216
buffer_load_dwordx2 v[102:103], v254, s[48:51], s53 offen nt
s_add_u32 s53, s53, 9216
buffer_load_dwordx2 v[104:105], v254, s[48:51], s53 offen nt
s_add_u32 s53, s53, 9216
buffer_load_dwordx2 v[106:107], v254, s[48:51], s53 offen nt
s_add_u32 s53, s53, 230400
buffer_load_dwordx2 v[108:109], v254, s[48:51], s53 offen nt
s_add_u32 s53, s53, 9216
buffer_load_dwordx2 v[110:111], v254, s[48:51], s53 offen nt
s_add_u32 s53, s53, 9216
buffer_load_dwordx2 v[112:113], v254, s[48:51], s53 offen nt
s_add_u32 s53, s53, 9216
buffer_load_dwordx2 v[114:115], v254, s[48:51], s53 offen nt
s_add_u32 s53, s53, 9216
buffer_load_dwordx2 v[116:117], v254, s[48:51], s53 offen nt
s_add_u32 s53, s53, 9216
buffer_load_dwordx2 v[118:119], v254, s[48:51], s53 offen nt
s_add_u32 s53, s53, 9216
buffer_load_dwordx2 v[120:121], v254, s[48:51], s53 offen nt
s_add_u32 s53, s53, 9216
buffer_load_dwordx2 v[122:123], v254, s[48:51], s53 offen nt
s_add_u32 s53, s53, 230400
buffer_load_dwordx2 v[124:125], v254, s[48:51], s53 offen nt
s_add_u32 s53, s53, 9216
buffer_load_dwordx2 v[126:127], v254, s[48:51], s53 offen nt
s_add_u32 s53, s53, 9216
buffer_load_dwordx2 v[128:129], v254, s[48:51], s53 offen nt
s_add_u32 s53, s53, 9216
buffer_load_dwordx2 v[130:131], v254, s[48:51], s53 offen nt
s_add_u32 s53, s53, 9216
buffer_load_dwordx2 v[132:133], v254, s[48:51], s53 offen nt
s_add_u32 s53, s53, 9216
buffer_load_dwordx2 v[134:135], v254, s[48:51], s53 offen nt
s_add_u32 s53, s53, 9216
buffer_load_dwordx2 v[136:137], v254, s[48:51], s53 offen nt
s_add_u32 s53, s53, 9216
buffer_load_dwordx2 v[138:139], v254, s[48:51], s53 offen nt
s_add_u32 s53, s53, 230400
buffer_load_dwordx2 v[140:141], v255, s[48:51], s53 offen nt
s_add_u32 s53, s53, 9216
buffer_load_dwordx2 v[142:143], v255, s[48:51], s53 offen nt
s_add_u32 s53, s53, 9216
buffer_load_dwordx2 v[144:145], v255, s[48:51], s53 offen nt
s_add_u32 s53, s53, 9216
buffer_load_dwordx2 v[146:147], v255, s[48:51], s53 offen nt
s_add_u32 s53, s53, 9216
buffer_load_dwordx2 v[148:149], v255, s[48:51], s53 offen nt
s_add_u32 s53, s53, 9216
buffer_load_dwordx2 v[150:151], v255, s[48:51], s53 offen nt
s_add_u32 s53, s53, 9216
buffer_load_dwordx2 v[152:153], v255, s[48:51], s53 offen nt
s_add_u32 s53, s53, 9216
buffer_load_dwordx2 v[154:155], v255, s[48:51], s53 offen nt
s_add_u32 s53, s53, 230400
s_branch L_l2_e
L_l2_d:
s_cmp_ge_u32 s2, 216
s_cbranch_scc1 L_l2_n
s_add_u32 s43, s53, 13824
buffer_load_dwordx2 v[82:83], v254, s[48:51], s43 offen offset:0 nt
buffer_load_dwordx2 v[98:99], v254, s[48:51], s43 offen offset:128 nt
buffer_load_ushort v111, v255, s[48:51], s43 offen offset:1024 nt
s_add_u32 s43, s53, 1152
buffer_load_dwordx2 v[84:85], v254, s[48:51], s43 offen offset:0 nt
buffer_load_dwordx2 v[100:101], v254, s[48:51], s43 offen offset:128 nt
buffer_load_ushort v112, v255, s[48:51], s43 offen offset:1024 nt
s_add_u32 s43, s53, 5760
buffer_load_dwordx2 v[86:87], v254, s[48:51], s43 offen offset:0 nt
buffer_load_dwordx2 v[102:103], v254, s[48:51], s43 offen offset:128 nt
buffer_load_ushort v113, v255, s[48:51], s43 offen offset:1024 nt
s_add_u32 s43, s53, 10368
buffer_load_dwordx2 v[88:89], v254, s[48:51], s43 offen offset:0 nt
buffer_load_dwordx2 v[104:105], v254, s[48:51], s43 offen offset:128 nt
buffer_load_ushort v114, v255, s[48:51], s43 offen offset:1024 nt
s_add_u32 s43, s53, 14976
buffer_load_dwordx2 v[90:91], v254, s[48:51], s43 offen offset:0 nt
buffer_load_dwordx2 v[106:107], v254, s[48:51], s43 offen offset:128 nt
buffer_load_ushort v115, v255, s[48:51], s43 offen offset:1024 nt
s_add_u32 s43, s53, 2304
buffer_load_dwordx2 v[116:117], v254, s[48:51], s43 offen offset:0 nt
buffer_load_dwordx2 v[132:133], v254, s[48:51], s43 offen offset:128 nt
buffer_load_ushort v148, v255, s[48:51], s43 offen offset:1024 nt
s_add_u32 s43, s53, 6912
buffer_load_dwordx2 v[118:119], v254, s[48:51], s43 offen offset:0 nt
buffer_load_dwordx2 v[134:135], v254, s[48:51], s43 offen offset:128 nt
buffer_load_ushort v149, v255, s[48:51], s43 offen offset:1024 nt
s_add_u32 s43, s53, 11520
buffer_load_dwordx2 v[120:121], v254, s[48:51], s43 offen offset:0 nt
buffer_load_dwordx2 v[136:137], v254, s[48:51], s43 offen offset:128 nt
buffer_load_ushort v150, v255, s[48:51], s43 offen offset:1024 nt
s_add_u32 s43, s53, 16128
buffer_load_dwordx2 v[122:123], v254, s[48:51], s43 offen offset:0 nt
buffer_load_dwordx2 v[138:139], v254, s[48:51], s43 offen offset:128 nt
buffer_load_ushort v151, v255, s[48:51], s43 offen offset:1024 nt
s_add_u32 s43, s53, 3456
buffer_load_dwordx2 v[124:125], v254, s[48:51], s43 offen offset:0 nt
buffer_load_dwordx2 v[140:141], v254, s[48:51], s43 offen offset:128 nt
buffer_load_ushort v152, v255, s[48:51], s43 offen offset:1024 nt
s_add_u32 s43, s53, 8064
buffer_load_dwordx2 v[126:127], v254, s[48:51], s43 offen offset:0 nt
buffer_load_dwordx2 v[142:143], v254, s[48:51], s43 offen offset:128 nt
buffer_load_ushort v153, v255, s[48:51], s43 offen offset:1024 nt
s_add_u32 s43, s53, 12672
buffer_load_dwordx2 v[128:129], v254, s[48:51], s43 offen offset:0 nt
buffer_load_dwordx2 v[144:145], v254, s[48:51], s43 offen offset:128 nt
buffer_load_ushort v154, v255, s[48:51], s43 offen offset:1024 nt
s_add_u32 s43, s53, 17280
buffer_load_dwordx2 v[130:131], v254, s[48:51], s43 offen offset:0 nt
buffer_load_dwordx2 v[146:147], v254, s[48:51], s43 offen offset:128 nt
buffer_load_ushort v155, v255, s[48:51], s43 offen offset:1024 nt
L_l2_n:
L_l2_e:
s_mov_b32 s70, 23261184
s_mov_b32 s71, 27979776
s_mov_b32 s72, 32698368
s_mov_b32 s73, 37416960
s_mov_b32 s74, 42135552
s_mov_b32 s75, 42397696
s_mov_b32 s76, 80146432
s_mov_b32 s77, 0
s_mov_b32 s7, 0
s_lshr_b32 s20, s5, 2
s_lshl_b32 s20, s20, 3
s_lshr_b32 s21, s6, 2
s_add_u32 s20, s20, s21
s_and_b32 s21, s5, 3
s_lshl_b32 s21, s21, 2
s_and_b32 s22, s6, 3
s_add_u32 s21, s21, s22
s_lshl_b32 s24, s20, 3
s_sub_u32 s25, s24, 1
s_max_i32 s35, s25, 0
s_mul_i32 s25, s35, 18432
s_lshl_b32 s26, s4, 1
s_add_u32 s36, s24, s26
s_mul_i32 s24, s36, 18432
s_add_u32 s26, s24, s70
s_add_u32 s27, s26, 18432
s_add_u32 s28, s25, s70
v_add_u32 v4, 0x10000, v2
v_add_u32 v5, 0x20000, v2
s_cmp_eq_u32 s4, 3
s_cselect_b32 s29, 0, s4
s_cselect_b32 s31, 16, 9
s_lshl_b32 s30, s29, 10
v_and_b32 v12, 15, v1
v_mov_b32 v13, 2146435072
v_cmp_le_u32 vcc, s31, v12
s_nop 1
v_cndmask_b32 v3, v13, v2, vcc
s_add_u32 s31, s30, 2048
v_add_u32 v6, s31, v2
v_add_u32 v7, s31, v4
v_add_u32 v8, s31, v5
s_add_u32 s31, s30, 5120
v_add_u32 v9, s31, v2
v_add_u32 v10, s31, v4
v_add_u32 v11, s31, v5
v_mul_u32_u24 v14, 43, v1
v_lshrrev_b32 v14, 8, v14
v_mul_u32_u24 v15, 6, v14
v_sub_u32 v15, v1, v15
v_cmp_eq_u32 vcc, 1, v14
v_mov_b32 v16, s36
s_nop 0
v_addc_co_u32 v16, vcc, 0, v16, vcc
v_cmp_eq_u32 vcc, 2, v14
v_mov_b32 v17, s35
s_nop 0
v_cndmask_b32 v16, v16, v17, vcc
v_lshlrev_b32 v16, 3, v16
v_add_lshl_u32 v16, v16, v15, 7
s_add_u32 s22, s77, 786432
s_and_b32 s23, s6, 7
s_lshl_b32 s23, s23, 7
s_add_u32 s23, s23, 64
v_min_u32 v17, 61, v1
v_add_u32 v17, s23, v17
v_lshlrev_b32 v17, 7, v17
v_add_u32 v17, 131072, v17
v_cmp_lt_u32 vcc, 31, v1
s_nop 1
v_cndmask_b32 v16, v16, v17, vcc
s_lshr_b32 s23, s21, 1
s_lshl_b32 s23, s23, 7
s_and_b32 s31, s21, 1
s_mul_i32 s31, s31, 48
s_add_u32 s23, s23, s31
v_min_u32 v17, 47, v1
v_add_u32 v17, s23, v17
v_lshlrev_b32 v17, 7, v17
v_add_u32 v17, 131072, v17
s_mov_b32 s52, 0
L_poll1:
buffer_load_dwordx2 v[14:15], v16, s[8:11], s22 offen sc1
buffer_load_dwordx2 v[18:19], v17, s[8:11], s22 offen sc1
s_add_u32 s52, s52, 1
s_waitcnt vmcnt(0)
v_cmp_ne_u64 vcc, s[68:69], v[14:15]
v_cmp_ne_u64 s[40:41], s[68:69], v[18:19]
s_cmp_ge_u32 s52, 0x100000
s_cbranch_scc1 L_got1
s_or_b64 vcc, vcc, s[40:41]
s_and_b64 exec, exec, vcc
s_cbranch_execnz L_poll1
L_got1:
s_mov_b64 exec, -1
s_lshr_b32 s20, s5, 2
s_lshl_b32 s20, s20, 3
s_lshr_b32 s21, s6, 2
s_add_u32 s20, s20, s21
s_and_b32 s21, s5, 3
s_lshl_b32 s21, s21, 2
s_and_b32 s22, s6, 3
s_add_u32 s21, s21, s22
s_mul_i32 s22, s21, 147456
s_add_u32 s22, s22, 4198400
s_mul_i32 s23, s4, 36864
s_add_u32 s22, s22, s23
s_mov_b32 s34, 0x05040100
s_mov_b32 s33, s35
s_mov_b32 s35, 0x07060302
s_mov_b32 s38, 0x00003f80
s_mov_b32 s39, 0x3f800000
v_mov_b32 v20, 0
v_mov_b32 v21, 0
v_mov_b32 v22, 0
v_mov_b32 v23, 0
s_cmp_ge_u32 s2, 144
s_cbranch_scc1 L_tr_d
v_mov_b32 v68, 0x3f803f80
v_mov_b32 v69, 0x3f803f80
s_add_u32 m0, s23, 0
s_add_u32 s40, s22, 0
buffer_load_dwordx4 v2, s[8:11], s40 offen offset:0 sc1 lds
v_mov_b32 v70, 0x3f803f80
v_mov_b32 v71, 0x3f803f80
v_perm_b32 v176, v78, v76, s34
v_perm_b32 v177, v82, v80, s34
v_perm_b32 v178, v86, v84, s34
v_perm_b32 v179, v90, v88, s34
buffer_load_dwordx4 v2, s[8:11], s40 offen offset:1024 sc1 lds
v_perm_b32 v180, v78, v76, s35
v_perm_b32 v181, v82, v80, s35
v_perm_b32 v182, v86, v84, s35
v_perm_b32 v183, v90, v88, s35
v_perm_b32 v184, v79, v77, s34
v_perm_b32 v185, v83, v81, s34
buffer_load_dwordx4 v2, s[8:11], s40 offen offset:2048 sc1 lds
v_perm_b32 v186, v87, v85, s34
v_perm_b32 v187, v91, v89, s34
v_perm_b32 v188, v79, v77, s35
v_perm_b32 v189, v83, v81, s35
v_perm_b32 v190, v87, v85, s35
v_perm_b32 v191, v91, v89, s35
buffer_load_dwordx4 v2, s[8:11], s40 offen offset:3072 sc1 lds
v_perm_b32 v192, v94, v92, s34
v_perm_b32 v193, v98, v96, s34
v_perm_b32 v194, v102, v100, s34
v_perm_b32 v195, v106, v104, s34
v_perm_b32 v196, v94, v92, s35
v_perm_b32 v197, v98, v96, s35
s_add_u32 m0, s23, 4096
s_add_u32 s40, s22, 4096
buffer_load_dwordx4 v2, s[8:11], s40 offen offset:0 sc1 lds
v_perm_b32 v198, v102, v100, s35
v_perm_b32 v199, v106, v104, s35
v_perm_b32 v200, v95, v93, s34
v_perm_b32 v201, v99, v97, s34
v_perm_b32 v202, v103, v101, s34
v_perm_b32 v203, v107, v105, s34
buffer_load_dwordx4 v2, s[8:11], s40 offen offset:1024 sc1 lds
v_perm_b32 v204, v95, v93, s35
v_perm_b32 v205, v99, v97, s35
v_perm_b32 v206, v103, v101, s35
v_perm_b32 v207, v107, v105, s35
v_perm_b32 v208, v110, v108, s34
v_perm_b32 v209, v114, v112, s34
buffer_load_dwordx4 v2, s[8:11], s40 offen offset:2048 sc1 lds
v_perm_b32 v210, v118, v116, s34
v_perm_b32 v211, v122, v120, s34
v_perm_b32 v212, v110, v108, s35
v_perm_b32 v213, v114, v112, s35
v_perm_b32 v214, v118, v116, s35
v_perm_b32 v215, v122, v120, s35
buffer_load_dwordx4 v2, s[8:11], s40 offen offset:3072 sc1 lds
v_perm_b32 v216, v111, v109, s34
v_perm_b32 v217, v115, v113, s34
v_perm_b32 v218, v119, v117, s34
v_perm_b32 v219, v123, v121, s34
v_perm_b32 v220, v111, v109, s35
v_perm_b32 v221, v115, v113, s35
s_add_u32 m0, s23, 8192
s_add_u32 s40, s22, 8192
buffer_load_dwordx4 v2, s[8:11], s40 offen offset:0 sc1 lds
v_perm_b32 v222, v119, v117, s35
v_perm_b32 v223, v123, v121, s35
v_perm_b32 v224, v126, v124, s34
v_perm_b32 v225, v130, v128, s34
v_perm_b32 v226, v134, v132, s34
v_perm_b32 v227, v138, v136, s34
buffer_load_dwordx4 v2, s[8:11], s40 offen offset:1024 sc1 lds
v_perm_b32 v228, v126, v124, s35
v_perm_b32 v229, v130, v128, s35
v_perm_b32 v230, v134, v132, s35
v_perm_b32 v231, v138, v136, s35
v_perm_b32 v232, v127, v125, s34
v_perm_b32 v233, v131, v129, s34
buffer_load_dwordx4 v2, s[8:11], s40 offen offset:2048 sc1 lds
v_perm_b32 v234, v135, v133, s34
v_perm_b32 v235, v139, v137, s34
v_perm_b32 v236, v127, v125, s35
v_perm_b32 v237, v131, v129, s35
v_perm_b32 v238, v135, v133, s35
v_perm_b32 v239, v139, v137, s35
buffer_load_dwordx4 v2, s[8:11], s40 offen offset:3072 sc1 lds
v_perm_b32 v240, v142, v140, s34
v_perm_b32 v241, v146, v144, s34
v_perm_b32 v242, v150, v148, s34
v_perm_b32 v243, v154, v152, s34
v_perm_b32 v244, v142, v140, s35
v_perm_b32 v245, v146, v144, s35
s_add_u32 m0, s23, 12288
s_add_u32 s40, s22, 12288
buffer_load_dwordx4 v2, s[8:11], s40 offen offset:0 sc1 lds
v_perm_b32 v246, v150, v148, s35
v_perm_b32 v247, v154, v152, s35
v_perm_b32 v248, v143, v141, s34
v_perm_b32 v249, v147, v145, s34
v_perm_b32 v250, v151, v149, s34
v_perm_b32 v251, v155, v153, s34
buffer_load_dwordx4 v2, s[8:11], s40 offen offset:1024 sc1 lds
v_perm_b32 v252, v143, v141, s35
v_perm_b32 v253, v147, v145, s35
v_perm_b32 v254, v151, v149, s35
v_perm_b32 v255, v155, v153, s35
v_mfma_f32_16x16x32_bf16 v[52:55], v[68:71], v[176:179], 0
v_mfma_f32_16x16x32_bf16 v[56:59], v[68:71], v[180:183], 0
buffer_load_dwordx4 v2, s[8:11], s40 offen offset:2048 sc1 lds
v_mfma_f32_16x16x32_bf16 v[60:63], v[68:71], v[184:187], 0
v_mfma_f32_16x16x32_bf16 v[64:67], v[68:71], v[188:191], 0
v_mfma_f32_16x16x32_bf16 v[52:55], v[68:71], v[192:195], v[52:55]
v_mfma_f32_16x16x32_bf16 v[56:59], v[68:71], v[196:199], v[56:59]
v_mfma_f32_16x16x32_bf16 v[60:63], v[68:71], v[200:203], v[60:63]
v_mfma_f32_16x16x32_bf16 v[64:67], v[68:71], v[204:207], v[64:67]
buffer_load_dwordx4 v2, s[8:11], s40 offen offset:3072 sc1 lds
v_mfma_f32_16x16x32_bf16 v[52:55], v[68:71], v[208:211], v[52:55]
v_mfma_f32_16x16x32_bf16 v[56:59], v[68:71], v[212:215], v[56:59]
v_mfma_f32_16x16x32_bf16 v[60:63], v[68:71], v[216:219], v[60:63]
v_mfma_f32_16x16x32_bf16 v[64:67], v[68:71], v[220:223], v[64:67]
v_mfma_f32_16x16x32_bf16 v[52:55], v[68:71], v[224:227], v[52:55]
v_mfma_f32_16x16x32_bf16 v[56:59], v[68:71], v[228:231], v[56:59]
s_add_u32 m0, s23, 16384
s_add_u32 s40, s22, 16384
buffer_load_dwordx4 v2, s[8:11], s40 offen offset:0 sc1 lds
v_mfma_f32_16x16x32_bf16 v[60:63], v[68:71], v[232:235], v[60:63]
v_mfma_f32_16x16x32_bf16 v[64:67], v[68:71], v[236:239], v[64:67]
v_mfma_f32_16x16x32_bf16 v[52:55], v[68:71], v[240:243], v[52:55]
v_mfma_f32_16x16x32_bf16 v[56:59], v[68:71], v[244:247], v[56:59]
v_mfma_f32_16x16x32_bf16 v[60:63], v[68:71], v[248:251], v[60:63]
v_mfma_f32_16x16x32_bf16 v[64:67], v[68:71], v[252:255], v[64:67]
buffer_load_dwordx4 v2, s[8:11], s40 offen offset:1024 sc1 lds
v_and_b32 v72, 15, v1
v_lshlrev_b32 v72, 4, v72
v_add_u32 v72, 148480, v72
s_lshl_b32 s44, s4, 2
v_add_u32 v73, s44, v72
ds_write_b32 v73, v52 offset:0
buffer_load_dwordx4 v2, s[8:11], s40 offen offset:2048 sc1 lds
ds_write_b32 v73, v56 offset:256
ds_write_b32 v73, v60 offset:512
ds_write_b32 v73, v64 offset:768
s_waitcnt lgkmcnt(0)
s_barrier
ds_read_b128 v[52:55], v72 offset:0
buffer_load_dwordx4 v2, s[8:11], s40 offen offset:3072 sc1 lds
ds_read_b128 v[56:59], v72 offset:256
ds_read_b128 v[60:63], v72 offset:512
ds_read_b128 v[64:67], v72 offset:768
s_waitcnt lgkmcnt(0)
v_add_f32 v52, v52, v53
v_add_f32 v54, v54, v55
s_add_u32 m0, s23, 20480
s_add_u32 s40, s22, 20480
buffer_load_dwordx4 v2, s[8:11], s40 offen offset:0 sc1 lds
v_add_f32 v56, v56, v57
v_add_f32 v58, v58, v59
v_add_f32 v60, v60, v61
v_add_f32 v62, v62, v63
v_add_f32 v64, v64, v65
v_add_f32 v66, v66, v67
buffer_load_dwordx4 v2, s[8:11], s40 offen offset:1024 sc1 lds
v_add_f32 v52, v52, v54
v_add_f32 v56, v56, v58
v_add_f32 v60, v60, v62
v_add_f32 v64, v64, v66
v_mul_f32 v20, 0xbae38e39, v52
v_mul_f32 v21, 0xbae38e39, v56
buffer_load_dwordx4 v2, s[8:11], s40 offen offset:2048 sc1 lds
v_mul_f32 v22, 0xbae38e39, v60
v_mul_f32 v23, 0xbae38e39, v64
v_dot2_f32_bf16 v24, v176, s38, v20
v_dot2_f32_bf16 v25, v176, s39, v20
v_dot2_f32_bf16 v26, v177, s38, v20
v_dot2_f32_bf16 v27, v177, s39, v20
buffer_load_dwordx4 v2, s[8:11], s40 offen offset:3072 sc1 lds
v_dot2_f32_bf16 v28, v178, s38, v20
v_dot2_f32_bf16 v29, v178, s39, v20
v_dot2_f32_bf16 v30, v179, s38, v20
v_dot2_f32_bf16 v31, v179, s39, v20
v_cvt_pk_bf16_f32 v176, v24, v25
v_cvt_pk_bf16_f32 v177, v26, v27
s_add_u32 m0, s23, 24576
s_add_u32 s40, s22, 24576
buffer_load_dwordx4 v2, s[8:11], s40 offen offset:0 sc1 lds
v_cvt_pk_bf16_f32 v178, v28, v29
v_cvt_pk_bf16_f32 v179, v30, v31
v_dot2_f32_bf16 v24, v180, s38, v21
v_dot2_f32_bf16 v25, v180, s39, v21
v_dot2_f32_bf16 v26, v181, s38, v21
v_dot2_f32_bf16 v27, v181, s39, v21
buffer_load_dwordx4 v2, s[8:11], s40 offen offset:1024 sc1 lds
v_dot2_f32_bf16 v28, v182, s38, v21
v_dot2_f32_bf16 v29, v182, s39, v21
v_dot2_f32_bf16 v30, v183, s38, v21
v_dot2_f32_bf16 v31, v183, s39, v21
v_cvt_pk_bf16_f32 v180, v24, v25
v_cvt_pk_bf16_f32 v181, v26, v27
buffer_load_dwordx4 v2, s[8:11], s40 offen offset:2048 sc1 lds
v_cvt_pk_bf16_f32 v182, v28, v29
v_cvt_pk_bf16_f32 v183, v30, v31
v_dot2_f32_bf16 v24, v184, s38, v22
v_dot2_f32_bf16 v25, v184, s39, v22
v_dot2_f32_bf16 v26, v185, s38, v22
v_dot2_f32_bf16 v27, v185, s39, v22
buffer_load_dwordx4 v2, s[8:11], s40 offen offset:3072 sc1 lds
v_dot2_f32_bf16 v28, v186, s38, v22
v_dot2_f32_bf16 v29, v186, s39, v22
v_dot2_f32_bf16 v30, v187, s38, v22
v_dot2_f32_bf16 v31, v187, s39, v22
v_cvt_pk_bf16_f32 v184, v24, v25
v_cvt_pk_bf16_f32 v185, v26, v27
s_add_u32 m0, s23, 28672
s_add_u32 s40, s22, 28672
buffer_load_dwordx4 v2, s[8:11], s40 offen offset:0 sc1 lds
v_cvt_pk_bf16_f32 v186, v28, v29
v_cvt_pk_bf16_f32 v187, v30, v31
v_dot2_f32_bf16 v24, v188, s38, v23
v_dot2_f32_bf16 v25, v188, s39, v23
v_dot2_f32_bf16 v26, v189, s38, v23
v_dot2_f32_bf16 v27, v189, s39, v23
buffer_load_dwordx4 v2, s[8:11], s40 offen offset:1024 sc1 lds
v_dot2_f32_bf16 v28, v190, s38, v23
v_dot2_f32_bf16 v29, v190, s39, v23
v_dot2_f32_bf16 v30, v191, s38, v23
v_dot2_f32_bf16 v31, v191, s39, v23
v_cvt_pk_bf16_f32 v188, v24, v25
v_cvt_pk_bf16_f32 v189, v26, v27
buffer_load_dwordx4 v2, s[8:11], s40 offen offset:2048 sc1 lds
v_cvt_pk_bf16_f32 v190, v28, v29
v_cvt_pk_bf16_f32 v191, v30, v31
v_dot2_f32_bf16 v24, v192, s38, v20
v_dot2_f32_bf16 v25, v192, s39, v20
v_dot2_f32_bf16 v26, v193, s38, v20
v_dot2_f32_bf16 v27, v193, s39, v20
buffer_load_dwordx4 v2, s[8:11], s40 offen offset:3072 sc1 lds
v_dot2_f32_bf16 v28, v194, s38, v20
v_dot2_f32_bf16 v29, v194, s39, v20
v_dot2_f32_bf16 v30, v195, s38, v20
v_dot2_f32_bf16 v31, v195, s39, v20
v_cvt_pk_bf16_f32 v192, v24, v25
v_cvt_pk_bf16_f32 v193, v26, v27
s_add_u32 m0, s23, 32768
s_add_u32 s40, s22, 32768
buffer_load_dwordx4 v2, s[8:11], s40 offen offset:0 sc1 lds
v_cvt_pk_bf16_f32 v194, v28, v29
v_cvt_pk_bf16_f32 v195, v30, v31
v_dot2_f32_bf16 v24, v196, s38, v21
v_dot2_f32_bf16 v25, v196, s39, v21
v_dot2_f32_bf16 v26, v197, s38, v21
v_dot2_f32_bf16 v27, v197, s39, v21
buffer_load_dwordx4 v2, s[8:11], s40 offen offset:1024 sc1 lds
v_dot2_f32_bf16 v28, v198, s38, v21
v_dot2_f32_bf16 v29, v198, s39, v21
v_dot2_f32_bf16 v30, v199, s38, v21
v_dot2_f32_bf16 v31, v199, s39, v21
v_cvt_pk_bf16_f32 v196, v24, v25
v_cvt_pk_bf16_f32 v197, v26, v27
buffer_load_dwordx4 v2, s[8:11], s40 offen offset:2048 sc1 lds
v_cvt_pk_bf16_f32 v198, v28, v29
v_cvt_pk_bf16_f32 v199, v30, v31
v_dot2_f32_bf16 v24, v200, s38, v22
v_dot2_f32_bf16 v25, v200, s39, v22
v_dot2_f32_bf16 v26, v201, s38, v22
v_dot2_f32_bf16 v27, v201, s39, v22
buffer_load_dwordx4 v2, s[8:11], s40 offen offset:3072 sc1 lds
v_dot2_f32_bf16 v28, v202, s38, v22
v_dot2_f32_bf16 v29, v202, s39, v22
v_dot2_f32_bf16 v30, v203, s38, v22
v_dot2_f32_bf16 v31, v203, s39, v22
v_cvt_pk_bf16_f32 v200, v24, v25
v_cvt_pk_bf16_f32 v201, v26, v27
v_cvt_pk_bf16_f32 v202, v28, v29
v_cvt_pk_bf16_f32 v203, v30, v31
v_dot2_f32_bf16 v24, v204, s38, v23
v_dot2_f32_bf16 v25, v204, s39, v23
v_dot2_f32_bf16 v26, v205, s38, v23
v_dot2_f32_bf16 v27, v205, s39, v23
v_dot2_f32_bf16 v28, v206, s38, v23
v_dot2_f32_bf16 v29, v206, s39, v23
v_dot2_f32_bf16 v30, v207, s38, v23
v_dot2_f32_bf16 v31, v207, s39, v23
v_cvt_pk_bf16_f32 v204, v24, v25
v_cvt_pk_bf16_f32 v205, v26, v27
v_cvt_pk_bf16_f32 v206, v28, v29
v_cvt_pk_bf16_f32 v207, v30, v31
s_branch L_tr_e
L_tr_d:
s_cmp_ge_u32 s2, 216
s_cbranch_scc1 L_tr_n
v_perm_b32 v176, v78, v76, s34
v_perm_b32 v177, v82, v80, s34
s_add_u32 m0, s23, 0
s_add_u32 s40, s22, 0
buffer_load_dwordx4 v2, s[8:11], s40 offen offset:0 sc1 lds
v_perm_b32 v178, v86, v84, s34
v_perm_b32 v179, v90, v88, s34
buffer_load_dwordx4 v2, s[8:11], s40 offen offset:1024 sc1 lds
v_perm_b32 v180, v78, v76, s35
v_perm_b32 v181, v82, v80, s35
buffer_load_dwordx4 v2, s[8:11], s40 offen offset:2048 sc1 lds
v_perm_b32 v182, v86, v84, s35
v_perm_b32 v183, v90, v88, s35
buffer_load_dwordx4 v2, s[8:11], s40 offen offset:3072 sc1 lds
v_perm_b32 v184, v79, v77, s34
v_perm_b32 v185, v83, v81, s34
s_add_u32 m0, s23, 4096
s_add_u32 s40, s22, 4096
buffer_load_dwordx4 v2, s[8:11], s40 offen offset:0 sc1 lds
v_perm_b32 v186, v87, v85, s34
v_perm_b32 v187, v91, v89, s34
buffer_load_dwordx4 v2, s[8:11], s40 offen offset:1024 sc1 lds
v_perm_b32 v188, v79, v77, s35
v_perm_b32 v189, v83, v81, s35
buffer_load_dwordx4 v2, s[8:11], s40 offen offset:2048 sc1 lds
v_perm_b32 v190, v87, v85, s35
v_perm_b32 v191, v91, v89, s35
buffer_load_dwordx4 v2, s[8:11], s40 offen offset:3072 sc1 lds
v_perm_b32 v192, v94, v92, s34
v_perm_b32 v193, v98, v96, s34
s_add_u32 m0, s23, 8192
s_add_u32 s40, s22, 8192
buffer_load_dwordx4 v2, s[8:11], s40 offen offset:0 sc1 lds
v_perm_b32 v194, v102, v100, s34
v_perm_b32 v195, v106, v104, s34
buffer_load_dwordx4 v2, s[8:11], s40 offen offset:1024 sc1 lds
v_perm_b32 v196, v94, v92, s35
v_perm_b32 v197, v98, v96, s35
buffer_load_dwordx4 v2, s[8:11], s40 offen offset:2048 sc1 lds
v_perm_b32 v198, v102, v100, s35
v_perm_b32 v199, v106, v104, s35
buffer_load_dwordx4 v2, s[8:11], s40 offen offset:3072 sc1 lds
v_perm_b32 v200, v95, v93, s34
v_perm_b32 v201, v99, v97, s34
s_add_u32 m0, s23, 12288
s_add_u32 s40, s22, 12288
buffer_load_dwordx4 v2, s[8:11], s40 offen offset:0 sc1 lds
v_perm_b32 v202, v103, v101, s34
v_perm_b32 v203, v107, v105, s34
buffer_load_dwordx4 v2, s[8:11], s40 offen offset:1024 sc1 lds
v_perm_b32 v204, v95, v93, s35
v_perm_b32 v205, v99, v97, s35
buffer_load_dwordx4 v2, s[8:11], s40 offen offset:2048 sc1 lds
v_perm_b32 v206, v103, v101, s35
v_perm_b32 v207, v107, v105, s35
buffer_load_dwordx4 v2, s[8:11], s40 offen offset:3072 sc1 lds
v_lshl_or_b32 v208, v109, 16, v108
v_lshl_or_b32 v209, v111, 16, v110
s_add_u32 m0, s23, 16384
s_add_u32 s40, s22, 16384
buffer_load_dwordx4 v2, s[8:11], s40 offen offset:0 sc1 lds
v_lshl_or_b32 v210, v113, 16, v112
v_lshl_or_b32 v211, v115, 16, v114
buffer_load_dwordx4 v2, s[8:11], s40 offen offset:1024 sc1 lds
v_perm_b32 v212, v118, v116, s34
v_perm_b32 v213, v122, v120, s34
buffer_load_dwordx4 v2, s[8:11], s40 offen offset:2048 sc1 lds
v_perm_b32 v214, v126, v124, s34
v_perm_b32 v215, v130, v128, s34
buffer_load_dwordx4 v2, s[8:11], s40 offen offset:3072 sc1 lds
v_perm_b32 v216, v118, v116, s35
v_perm_b32 v217, v122, v120, s35
s_add_u32 m0, s23, 20480
s_add_u32 s40, s22, 20480
buffer_load_dwordx4 v2, s[8:11], s40 offen offset:0 sc1 lds
v_perm_b32 v218, v126, v124, s35
v_perm_b32 v219, v130, v128, s35
buffer_load_dwordx4 v2, s[8:11], s40 offen offset:1024 sc1 lds
v_perm_b32 v220, v119, v117, s34
v_perm_b32 v221, v123, v121, s34
buffer_load_dwordx4 v2, s[8:11], s40 offen offset:2048 sc1 lds
v_perm_b32 v222, v127, v125, s34
v_perm_b32 v223, v131, v129, s34
buffer_load_dwordx4 v2, s[8:11], s40 offen offset:3072 sc1 lds
v_perm_b32 v224, v119, v117, s35
v_perm_b32 v225, v123, v121, s35
s_add_u32 m0, s23, 24576
s_add_u32 s40, s22, 24576
buffer_load_dwordx4 v2, s[8:11], s40 offen offset:0 sc1 lds
v_perm_b32 v226, v127, v125, s35
v_perm_b32 v227, v131, v129, s35
buffer_load_dwordx4 v2, s[8:11], s40 offen offset:1024 sc1 lds
v_perm_b32 v228, v134, v132, s34
v_perm_b32 v229, v138, v136, s34
buffer_load_dwordx4 v2, s[8:11], s40 offen offset:2048 sc1 lds
v_perm_b32 v230, v142, v140, s34
v_perm_b32 v231, v146, v144, s34
buffer_load_dwordx4 v2, s[8:11], s40 offen offset:3072 sc1 lds
v_perm_b32 v232, v134, v132, s35
v_perm_b32 v233, v138, v136, s35
s_add_u32 m0, s23, 28672
s_add_u32 s40, s22, 28672
buffer_load_dwordx4 v2, s[8:11], s40 offen offset:0 sc1 lds
v_perm_b32 v234, v142, v140, s35
v_perm_b32 v235, v146, v144, s35
buffer_load_dwordx4 v2, s[8:11], s40 offen offset:1024 sc1 lds
v_perm_b32 v236, v135, v133, s34
v_perm_b32 v237, v139, v137, s34
buffer_load_dwordx4 v2, s[8:11], s40 offen offset:2048 sc1 lds
v_perm_b32 v238, v143, v141, s34
v_perm_b32 v239, v147, v145, s34
buffer_load_dwordx4 v2, s[8:11], s40 offen offset:3072 sc1 lds
v_perm_b32 v240, v135, v133, s35
v_perm_b32 v241, v139, v137, s35
s_add_u32 m0, s23, 32768
s_add_u32 s40, s22, 32768
buffer_load_dwordx4 v2, s[8:11], s40 offen offset:0 sc1 lds
v_perm_b32 v242, v143, v141, s35
v_perm_b32 v243, v147, v145, s35
buffer_load_dwordx4 v2, s[8:11], s40 offen offset:1024 sc1 lds
v_lshl_or_b32 v244, v149, 16, v148
v_lshl_or_b32 v245, v151, 16, v150
buffer_load_dwordx4 v2, s[8:11], s40 offen offset:2048 sc1 lds
v_lshl_or_b32 v246, v153, 16, v152
v_lshl_or_b32 v247, v155, 16, v154
buffer_load_dwordx4 v2, s[8:11], s40 offen offset:3072 sc1 lds
s_branch L_tr_e
L_tr_n:
s_add_u32 m0, s23, 0
s_add_u32 s40, s22, 0
buffer_load_dwordx4 v2, s[8:11], s40 offen offset:0 sc1 lds
buffer_load_dwordx4 v2, s[8:11], s40 offen offset:1024 sc1 lds
buffer_load_dwordx4 v2, s[8:11], s40 offen offset:2048 sc1 lds
buffer_load_dwordx4 v2, s[8:11], s40 offen offset:3072 sc1 lds
s_add_u32 m0, s23, 4096
s_add_u32 s40, s22, 4096
buffer_load_dwordx4 v2, s[8:11], s40 offen offset:0 sc1 lds
buffer_load_dwordx4 v2, s[8:11], s40 offen offset:1024 sc1 lds
buffer_load_dwordx4 v2, s[8:11], s40 offen offset:2048 sc1 lds
buffer_load_dwordx4 v2, s[8:11], s40 offen offset:3072 sc1 lds
s_add_u32 m0, s23, 8192
s_add_u32 s40, s22, 8192
buffer_load_dwordx4 v2, s[8:11], s40 offen offset:0 sc1 lds
buffer_load_dwordx4 v2, s[8:11], s40 offen offset:1024 sc1 lds
buffer_load_dwordx4 v2, s[8:11], s40 offen offset:2048 sc1 lds
buffer_load_dwordx4 v2, s[8:11], s40 offen offset:3072 sc1 lds
s_add_u32 m0, s23, 12288
s_add_u32 s40, s22, 12288
buffer_load_dwordx4 v2, s[8:11], s40 offen offset:0 sc1 lds
buffer_load_dwordx4 v2, s[8:11], s40 offen offset:1024 sc1 lds
buffer_load_dwordx4 v2, s[8:11], s40 offen offset:2048 sc1 lds
buffer_load_dwordx4 v2, s[8:11], s40 offen offset:3072 sc1 lds
s_add_u32 m0, s23, 16384
s_add_u32 s40, s22, 16384
buffer_load_dwordx4 v2, s[8:11], s40 offen offset:0 sc1 lds
buffer_load_dwordx4 v2, s[8:11], s40 offen offset:1024 sc1 lds
buffer_load_dwordx4 v2, s[8:11], s40 offen offset:2048 sc1 lds
buffer_load_dwordx4 v2, s[8:11], s40 offen offset:3072 sc1 lds
s_add_u32 m0, s23, 20480
s_add_u32 s40, s22, 20480
buffer_load_dwordx4 v2, s[8:11], s40 offen offset:0 sc1 lds
buffer_load_dwordx4 v2, s[8:11], s40 offen offset:1024 sc1 lds
buffer_load_dwordx4 v2, s[8:11], s40 offen offset:2048 sc1 lds
buffer_load_dwordx4 v2, s[8:11], s40 offen offset:3072 sc1 lds
s_add_u32 m0, s23, 24576
s_add_u32 s40, s22, 24576
buffer_load_dwordx4 v2, s[8:11], s40 offen offset:0 sc1 lds
buffer_load_dwordx4 v2, s[8:11], s40 offen offset:1024 sc1 lds
buffer_load_dwordx4 v2, s[8:11], s40 offen offset:2048 sc1 lds
buffer_load_dwordx4 v2, s[8:11], s40 offen offset:3072 sc1 lds
s_add_u32 m0, s23, 28672
s_add_u32 s40, s22, 28672
buffer_load_dwordx4 v2, s[8:11], s40 offen offset:0 sc1 lds
buffer_load_dwordx4 v2, s[8:11], s40 offen offset:1024 sc1 lds
buffer_load_dwordx4 v2, s[8:11], s40 offen offset:2048 sc1 lds
buffer_load_dwordx4 v2, s[8:11], s40 offen offset:3072 sc1 lds
s_add_u32 m0, s23, 32768
s_add_u32 s40, s22, 32768
buffer_load_dwordx4 v2, s[8:11], s40 offen offset:0 sc1 lds
buffer_load_dwordx4 v2, s[8:11], s40 offen offset:1024 sc1 lds
buffer_load_dwordx4 v2, s[8:11], s40 offen offset:2048 sc1 lds
buffer_load_dwordx4 v2, s[8:11], s40 offen offset:3072 sc1 lds
L_tr_e:
s_mov_b32 s35, s33
buffer_load_dwordx4 a[0:3], v2, s[8:11], s26 offen offset:0 sc1
buffer_load_dwordx4 a[72:75], v2, s[8:11], s27 offen offset:0 sc1
buffer_load_dwordx4 a[144:147], v3, s[8:11], s28 offen offset:0 sc1
buffer_load_dwordx4 a[4:7], v2, s[8:11], s26 offen offset:1024 sc1
buffer_load_dwordx4 a[76:79], v2, s[8:11], s27 offen offset:1024 sc1
buffer_load_dwordx4 a[148:151], v3, s[8:11], s28 offen offset:1024 sc1
buffer_load_dwordx4 a[8:11], v2, s[8:11], s26 offen offset:2048 sc1
buffer_load_dwordx4 a[80:83], v2, s[8:11], s27 offen offset:2048 sc1
buffer_load_dwordx4 a[152:155], v3, s[8:11], s28 offen offset:2048 sc1
buffer_load_dwordx4 a[12:15], v2, s[8:11], s26 offen offset:3072 sc1
buffer_load_dwordx4 a[84:87], v2, s[8:11], s27 offen offset:3072 sc1
buffer_load_dwordx4 a[156:159], v3, s[8:11], s28 offen offset:3072 sc1
s_add_u32 s26, s26, 4096
s_add_u32 s27, s27, 4096
s_add_u32 s28, s28, 4096
buffer_load_dwordx4 a[16:19], v2, s[8:11], s26 offen offset:0 sc1
buffer_load_dwordx4 a[88:91], v2, s[8:11], s27 offen offset:0 sc1
buffer_load_dwordx4 a[160:163], v3, s[8:11], s28 offen offset:0 sc1
buffer_load_dwordx4 a[20:23], v2, s[8:11], s26 offen offset:1024 sc1
buffer_load_dwordx4 a[92:95], v2, s[8:11], s27 offen offset:1024 sc1
buffer_load_dwordx4 a[164:167], v3, s[8:11], s28 offen offset:1024 sc1
buffer_load_dwordx4 a[24:27], v2, s[8:11], s26 offen offset:2048 sc1
buffer_load_dwordx4 a[96:99], v2, s[8:11], s27 offen offset:2048 sc1
buffer_load_dwordx4 a[168:171], v3, s[8:11], s28 offen offset:2048 sc1
buffer_load_dwordx4 a[28:31], v2, s[8:11], s26 offen offset:3072 sc1
buffer_load_dwordx4 a[100:103], v2, s[8:11], s27 offen offset:3072 sc1
buffer_load_dwordx4 a[172:175], v3, s[8:11], s28 offen offset:3072 sc1
v_lshrrev_b32 v13, 4, v1
v_lshlrev_b32 v14, 2, v13
v_sub_u32 v14, v12, v14
v_subrev_u32 v15, 0, v14
v_cmp_gt_u32 s[52:53], 8, v15
v_cmp_gt_i32 s[44:45], -8, v15
v_subrev_u32 v15, 1, v14
v_cmp_gt_u32 s[54:55], 8, v15
v_cmp_gt_i32 s[46:47], -8, v15
v_subrev_u32 v15, 2, v14
v_cmp_gt_u32 s[56:57], 8, v15
v_cmp_gt_i32 s[48:49], -8, v15
v_subrev_u32 v15, 3, v14
v_cmp_gt_u32 s[58:59], 8, v15
v_cmp_gt_i32 s[50:51], -8, v15
s_and_b32 s31, s20, 7
s_or_b32 s31, s31, s4
s_cmp_eq_u32 s31, 0
s_cselect_b64 s[60:61], 0, s[44:45]
s_cselect_b64 s[62:63], 0, s[46:47]
s_cselect_b64 s[64:65], 0, s[48:49]
s_cselect_b64 s[66:67], 0, s[50:51]
s_waitcnt vmcnt(24)
s_barrier
ds_read_b128 a[216:219], v2 offset:0
ds_read_b128 a[220:223], v2 offset:8192
ds_read_b128 a[224:227], v2 offset:1024
ds_read_b128 a[228:231], v2 offset:9216
ds_read_b128 a[232:235], v2 offset:2048
ds_read_b128 a[236:239], v2 offset:10240
s_waitcnt vmcnt(18)
s_waitcnt lgkmcnt(4)
v_mfma_f32_16x16x32_bf16 v[32:35], a[216:219], a[0:3], 0
s_add_u32 s26, s26, 4096
s_add_u32 s27, s27, 4096
s_add_u32 s28, s28, 4096
buffer_load_dwordx4 a[32:35], v2, s[8:11], s26 offen offset:0 sc1
v_mfma_f32_16x16x32_bf16 v[32:35], a[220:223], a[4:7], v[32:35]
ds_read_b128 a[240:243], v2 offset:3072
v_dot2_f32_bf16 v24, v208, s38, v20
v_mfma_f32_16x16x32_bf16 v[36:39], a[216:219], a[72:75], 0
v_dot2_f32_bf16 v25, v208, s39, v20
v_dot2_f32_bf16 v26, v209, s38, v20
v_mfma_f32_16x16x32_bf16 v[36:39], a[220:223], a[76:79], v[36:39]
ds_read_b128 a[244:247], v2 offset:11264
s_waitcnt lgkmcnt(4)
v_mfma_f32_16x16x32_bf16 v[40:43], a[224:227], a[0:3], 0
buffer_load_dwordx4 a[104:107], v2, s[8:11], s27 offen offset:0 sc1
v_mfma_f32_16x16x32_bf16 v[40:43], a[228:231], a[4:7], v[40:43]
ds_read_b128 a[216:219], v2 offset:4096
v_dot2_f32_bf16 v27, v209, s39, v20
v_mfma_f32_16x16x32_bf16 v[44:47], a[224:227], a[72:75], 0
v_dot2_f32_bf16 v28, v210, s38, v20
v_dot2_f32_bf16 v29, v210, s39, v20
v_mfma_f32_16x16x32_bf16 v[44:47], a[228:231], a[76:79], v[44:47]
ds_read_b128 a[220:223], v2 offset:12288
s_waitcnt lgkmcnt(4)
v_mfma_f32_16x16x32_bf16 v[48:51], a[232:235], a[0:3], 0
buffer_load_dwordx4 a[176:179], v3, s[8:11], s28 offen offset:0 sc1
v_mfma_f32_16x16x32_bf16 v[48:51], a[236:239], a[4:7], v[48:51]
ds_read_b128 a[224:227], v2 offset:5120
v_dot2_f32_bf16 v30, v211, s38, v20
v_mfma_f32_16x16x32_bf16 v[52:55], a[232:235], a[72:75], 0
v_dot2_f32_bf16 v31, v211, s39, v20
v_cvt_pk_bf16_f32 v208, v24, v25
v_mfma_f32_16x16x32_bf16 v[52:55], a[236:239], a[76:79], v[52:55]
ds_read_b128 a[228:231], v2 offset:13312
s_waitcnt lgkmcnt(4)
v_mfma_f32_16x16x32_bf16 v[56:59], a[240:243], a[0:3], 0
buffer_load_dwordx4 a[36:39], v2, s[8:11], s26 offen offset:1024 sc1
v_mfma_f32_16x16x32_bf16 v[56:59], a[244:247], a[4:7], v[56:59]
ds_read_b128 a[232:235], v2 offset:6144
v_cvt_pk_bf16_f32 v209, v26, v27
v_mfma_f32_16x16x32_bf16 v[60:63], a[240:243], a[72:75], 0
v_cvt_pk_bf16_f32 v210, v28, v29
v_cvt_pk_bf16_f32 v211, v30, v31
v_mfma_f32_16x16x32_bf16 v[60:63], a[244:247], a[76:79], v[60:63]
ds_read_b128 a[236:239], v2 offset:14336
s_waitcnt lgkmcnt(4)
v_mfma_f32_16x16x32_bf16 v[64:67], a[216:219], a[0:3], 0
buffer_load_dwordx4 a[108:111], v2, s[8:11], s27 offen offset:1024 sc1
v_mfma_f32_16x16x32_bf16 v[64:67], a[220:223], a[4:7], v[64:67]
ds_read_b128 a[240:243], v2 offset:7168
v_dot2_f32_bf16 v24, v212, s38, v21
v_mfma_f32_16x16x32_bf16 v[68:71], a[216:219], a[72:75], 0
v_dot2_f32_bf16 v25, v212, s39, v21
v_dot2_f32_bf16 v26, v213, s38, v21
v_mfma_f32_16x16x32_bf16 v[68:71], a[220:223], a[76:79], v[68:71]
ds_read_b128 a[244:247], v2 offset:15360
s_waitcnt lgkmcnt(4)
v_mfma_f32_16x16x32_bf16 v[72:75], a[0:3], a[224:227], 0
buffer_load_dwordx4 a[180:183], v3, s[8:11], s28 offen offset:1024 sc1
v_mfma_f32_16x16x32_bf16 v[72:75], a[4:7], a[228:231], v[72:75]
ds_read_b128 a[216:219], v6 offset:0
v_dot2_f32_bf16 v27, v213, s39, v21
v_mfma_f32_16x16x32_bf16 v[76:79], a[72:75], a[224:227], 0
v_dot2_f32_bf16 v28, v214, s38, v21
v_dot2_f32_bf16 v29, v214, s39, v21
v_mfma_f32_16x16x32_bf16 v[76:79], a[76:79], a[228:231], v[76:79]
ds_read_b128 a[220:223], v6 offset:8192
s_waitcnt lgkmcnt(4)
v_mfma_f32_16x16x32_bf16 v[80:83], a[0:3], a[232:235], 0
buffer_load_dwordx4 a[40:43], v2, s[8:11], s26 offen offset:2048 sc1
v_mfma_f32_16x16x32_bf16 v[80:83], a[4:7], a[236:239], v[80:83]
ds_read_b128 a[224:227], v9 offset:0
v_dot2_f32_bf16 v30, v215, s38, v21
v_mfma_f32_16x16x32_bf16 v[84:87], a[72:75], a[232:235], 0
v_dot2_f32_bf16 v31, v215, s39, v21
v_cvt_pk_bf16_f32 v212, v24, v25
v_mfma_f32_16x16x32_bf16 v[84:87], a[76:79], a[236:239], v[84:87]
ds_read_b128 a[228:231], v9 offset:8192
s_waitcnt lgkmcnt(4)
v_mfma_f32_16x16x32_bf16 v[88:91], a[0:3], a[240:243], 0
buffer_load_dwordx4 a[112:115], v2, s[8:11], s27 offen offset:2048 sc1
v_mfma_f32_16x16x32_bf16 v[88:91], a[4:7], a[244:247], v[88:91]
ds_read_b128 a[232:235], v2 offset:16384
v_cvt_pk_bf16_f32 v213, v26, v27
v_mfma_f32_16x16x32_bf16 v[92:95], a[72:75], a[240:243], 0
v_cvt_pk_bf16_f32 v214, v28, v29
v_cvt_pk_bf16_f32 v215, v30, v31
v_mfma_f32_16x16x32_bf16 v[92:95], a[76:79], a[244:247], v[92:95]
ds_read_b128 a[236:239], v2 offset:24576
s_waitcnt lgkmcnt(4)
v_mfma_f32_16x16x32_bf16 v[96:99], a[216:219], a[144:147], 0
ds_read_b128 a[240:243], v2 offset:17408
buffer_load_dwordx4 a[184:187], v3, s[8:11], s28 offen offset:2048 sc1
v_mfma_f32_16x16x32_bf16 v[96:99], a[220:223], a[148:151], v[96:99]
ds_read_b128 a[244:247], v2 offset:25600
s_waitcnt lgkmcnt(4)
v_mfma_f32_16x16x32_bf16 v[100:103], a[144:147], a[224:227], 0
ds_read_b128 a[216:219], v2 offset:18432
v_dot2_f32_bf16 v24, v216, s38, v22
v_mfma_f32_16x16x32_bf16 v[100:103], a[148:151], a[228:231], v[100:103]
ds_read_b128 a[220:223], v2 offset:26624
s_waitcnt vmcnt(21)
s_waitcnt lgkmcnt(4)
v_mfma_f32_16x16x32_bf16 v[32:35], a[232:235], a[8:11], v[32:35]
buffer_load_dwordx4 a[44:47], v2, s[8:11], s26 offen offset:3072 sc1
v_mfma_f32_16x16x32_bf16 v[32:35], a[236:239], a[12:15], v[32:35]
ds_read_b128 a[224:227], v2 offset:19456
v_dot2_f32_bf16 v25, v216, s39, v22
v_mfma_f32_16x16x32_bf16 v[36:39], a[232:235], a[80:83], v[36:39]
v_dot2_f32_bf16 v26, v217, s38, v22
v_dot2_f32_bf16 v27, v217, s39, v22
v_mfma_f32_16x16x32_bf16 v[36:39], a[236:239], a[84:87], v[36:39]
ds_read_b128 a[228:231], v2 offset:27648
s_waitcnt lgkmcnt(4)
v_mfma_f32_16x16x32_bf16 v[40:43], a[240:243], a[8:11], v[40:43]
buffer_load_dwordx4 a[116:119], v2, s[8:11], s27 offen offset:3072 sc1
v_mfma_f32_16x16x32_bf16 v[40:43], a[244:247], a[12:15], v[40:43]
ds_read_b128 a[232:235], v2 offset:20480
v_dot2_f32_bf16 v28, v218, s38, v22
v_mfma_f32_16x16x32_bf16 v[44:47], a[240:243], a[80:83], v[44:47]
v_dot2_f32_bf16 v29, v218, s39, v22
v_dot2_f32_bf16 v30, v219, s38, v22
v_mfma_f32_16x16x32_bf16 v[44:47], a[244:247], a[84:87], v[44:47]
ds_read_b128 a[236:239], v2 offset:28672
s_waitcnt lgkmcnt(4)
v_mfma_f32_16x16x32_bf16 v[48:51], a[216:219], a[8:11], v[48:51]
buffer_load_dwordx4 a[188:191], v3, s[8:11], s28 offen offset:3072 sc1
v_mfma_f32_16x16x32_bf16 v[48:51], a[220:223], a[12:15], v[48:51]
ds_read_b128 a[240:243], v2 offset:21504
v_dot2_f32_bf16 v31, v219, s39, v22
v_mfma_f32_16x16x32_bf16 v[52:55], a[216:219], a[80:83], v[52:55]
v_cvt_pk_bf16_f32 v216, v24, v25
v_cvt_pk_bf16_f32 v217, v26, v27
v_mfma_f32_16x16x32_bf16 v[52:55], a[220:223], a[84:87], v[52:55]
ds_read_b128 a[244:247], v2 offset:29696
s_waitcnt lgkmcnt(4)
v_mfma_f32_16x16x32_bf16 v[56:59], a[224:227], a[8:11], v[56:59]
s_add_u32 s26, s26, 4096
s_add_u32 s27, s27, 4096
s_add_u32 s28, s28, 4096
buffer_load_dwordx4 a[48:51], v2, s[8:11], s26 offen offset:0 sc1
v_mfma_f32_16x16x32_bf16 v[56:59], a[228:231], a[12:15], v[56:59]
ds_read_b128 a[216:219], v2 offset:22528
v_cvt_pk_bf16_f32 v218, v28, v29
v_mfma_f32_16x16x32_bf16 v[60:63], a[224:227], a[80:83], v[60:63]
v_cvt_pk_bf16_f32 v219, v30, v31
v_dot2_f32_bf16 v24, v220, s38, v23
v_mfma_f32_16x16x32_bf16 v[60:63], a[228:231], a[84:87], v[60:63]
ds_read_b128 a[220:223], v2 offset:30720
s_waitcnt lgkmcnt(4)
v_mfma_f32_16x16x32_bf16 v[64:67], a[232:235], a[8:11], v[64:67]
buffer_load_dwordx4 a[120:123], v2, s[8:11], s27 offen offset:0 sc1
v_mfma_f32_16x16x32_bf16 v[64:67], a[236:239], a[12:15], v[64:67]
ds_read_b128 a[224:227], v2 offset:23552
v_dot2_f32_bf16 v25, v220, s39, v23
v_mfma_f32_16x16x32_bf16 v[68:71], a[232:235], a[80:83], v[68:71]
v_dot2_f32_bf16 v26, v221, s38, v23
v_dot2_f32_bf16 v27, v221, s39, v23
v_mfma_f32_16x16x32_bf16 v[68:71], a[236:239], a[84:87], v[68:71]
ds_read_b128 a[228:231], v2 offset:31744
s_waitcnt lgkmcnt(4)
v_mfma_f32_16x16x32_bf16 v[72:75], a[8:11], a[240:243], v[72:75]
buffer_load_dwordx4 a[192:195], v3, s[8:11], s28 offen offset:0 sc1
v_mfma_f32_16x16x32_bf16 v[72:75], a[12:15], a[244:247], v[72:75]
ds_read_b128 a[232:235], v6 offset:16384
v_dot2_f32_bf16 v28, v222, s38, v23
v_mfma_f32_16x16x32_bf16 v[76:79], a[80:83], a[240:243], v[76:79]
v_dot2_f32_bf16 v29, v222, s39, v23
v_dot2_f32_bf16 v30, v223, s38, v23
v_mfma_f32_16x16x32_bf16 v[76:79], a[84:87], a[244:247], v[76:79]
ds_read_b128 a[236:239], v6 offset:24576
s_waitcnt lgkmcnt(4)
v_mfma_f32_16x16x32_bf16 v[80:83], a[8:11], a[216:219], v[80:83]
buffer_load_dwordx4 a[52:55], v2, s[8:11], s26 offen offset:1024 sc1
v_mfma_f32_16x16x32_bf16 v[80:83], a[12:15], a[220:223], v[80:83]
ds_read_b128 a[240:243], v9 offset:16384
v_dot2_f32_bf16 v31, v223, s39, v23
v_mfma_f32_16x16x32_bf16 v[84:87], a[80:83], a[216:219], v[84:87]
v_cvt_pk_bf16_f32 v220, v24, v25
v_cvt_pk_bf16_f32 v221, v26, v27
v_mfma_f32_16x16x32_bf16 v[84:87], a[84:87], a[220:223], v[84:87]
ds_read_b128 a[244:247], v9 offset:24576
s_waitcnt lgkmcnt(4)
v_mfma_f32_16x16x32_bf16 v[88:91], a[8:11], a[224:227], v[88:91]
buffer_load_dwordx4 a[124:127], v2, s[8:11], s27 offen offset:1024 sc1
v_mfma_f32_16x16x32_bf16 v[88:91], a[12:15], a[228:231], v[88:91]
ds_read_b128 a[216:219], v2 offset:32768
v_cvt_pk_bf16_f32 v222, v28, v29
v_mfma_f32_16x16x32_bf16 v[92:95], a[80:83], a[224:227], v[92:95]
v_cvt_pk_bf16_f32 v223, v30, v31
v_dot2_f32_bf16 v24, v224, s38, v20
v_mfma_f32_16x16x32_bf16 v[92:95], a[84:87], a[228:231], v[92:95]
ds_read_b128 a[220:223], v2 offset:40960
s_waitcnt lgkmcnt(4)
v_mfma_f32_16x16x32_bf16 v[96:99], a[232:235], a[152:155], v[96:99]
ds_read_b128 a[224:227], v2 offset:33792
buffer_load_dwordx4 a[196:199], v3, s[8:11], s28 offen offset:1024 sc1
v_mfma_f32_16x16x32_bf16 v[96:99], a[236:239], a[156:159], v[96:99]
ds_read_b128 a[228:231], v2 offset:41984
s_waitcnt lgkmcnt(4)
v_mfma_f32_16x16x32_bf16 v[100:103], a[152:155], a[240:243], v[100:103]
ds_read_b128 a[232:235], v2 offset:34816
v_dot2_f32_bf16 v25, v224, s39, v20
v_mfma_f32_16x16x32_bf16 v[100:103], a[156:159], a[244:247], v[100:103]
ds_read_b128 a[236:239], v2 offset:43008
s_waitcnt vmcnt(24)
s_waitcnt lgkmcnt(4)
v_mfma_f32_16x16x32_bf16 v[32:35], a[216:219], a[16:19], v[32:35]
buffer_load_dwordx4 a[56:59], v2, s[8:11], s26 offen offset:2048 sc1
v_mfma_f32_16x16x32_bf16 v[32:35], a[220:223], a[20:23], v[32:35]
ds_read_b128 a[240:243], v2 offset:35840
v_dot2_f32_bf16 v26, v225, s38, v20
v_mfma_f32_16x16x32_bf16 v[36:39], a[216:219], a[88:91], v[36:39]
v_dot2_f32_bf16 v27, v225, s39, v20
v_dot2_f32_bf16 v28, v226, s38, v20
v_mfma_f32_16x16x32_bf16 v[36:39], a[220:223], a[92:95], v[36:39]
ds_read_b128 a[244:247], v2 offset:44032
s_waitcnt lgkmcnt(4)
v_mfma_f32_16x16x32_bf16 v[40:43], a[224:227], a[16:19], v[40:43]
buffer_load_dwordx4 a[128:131], v2, s[8:11], s27 offen offset:2048 sc1
v_mfma_f32_16x16x32_bf16 v[40:43], a[228:231], a[20:23], v[40:43]
ds_read_b128 a[216:219], v2 offset:36864
v_dot2_f32_bf16 v29, v226, s39, v20
v_mfma_f32_16x16x32_bf16 v[44:47], a[224:227], a[88:91], v[44:47]
v_dot2_f32_bf16 v30, v227, s38, v20
v_dot2_f32_bf16 v31, v227, s39, v20
v_mfma_f32_16x16x32_bf16 v[44:47], a[228:231], a[92:95], v[44:47]
ds_read_b128 a[220:223], v2 offset:45056
s_waitcnt lgkmcnt(4)
v_mfma_f32_16x16x32_bf16 v[48:51], a[232:235], a[16:19], v[48:51]
buffer_load_dwordx4 a[200:203], v3, s[8:11], s28 offen offset:2048 sc1
v_mfma_f32_16x16x32_bf16 v[48:51], a[236:239], a[20:23], v[48:51]
ds_read_b128 a[224:227], v2 offset:37888
v_cvt_pk_bf16_f32 v224, v24, v25
v_mfma_f32_16x16x32_bf16 v[52:55], a[232:235], a[88:91], v[52:55]
v_cvt_pk_bf16_f32 v225, v26, v27
v_cvt_pk_bf16_f32 v226, v28, v29
v_mfma_f32_16x16x32_bf16 v[52:55], a[236:239], a[92:95], v[52:55]
ds_read_b128 a[228:231], v2 offset:46080
s_waitcnt lgkmcnt(4)
v_mfma_f32_16x16x32_bf16 v[56:59], a[240:243], a[16:19], v[56:59]
buffer_load_dwordx4 a[60:63], v2, s[8:11], s26 offen offset:3072 sc1
v_mfma_f32_16x16x32_bf16 v[56:59], a[244:247], a[20:23], v[56:59]
ds_read_b128 a[232:235], v2 offset:38912
v_cvt_pk_bf16_f32 v227, v30, v31
v_mfma_f32_16x16x32_bf16 v[60:63], a[240:243], a[88:91], v[60:63]
v_dot2_f32_bf16 v24, v228, s38, v21
v_dot2_f32_bf16 v25, v228, s39, v21
v_mfma_f32_16x16x32_bf16 v[60:63], a[244:247], a[92:95], v[60:63]
ds_read_b128 a[236:239], v2 offset:47104
s_waitcnt lgkmcnt(4)
v_mfma_f32_16x16x32_bf16 v[64:67], a[216:219], a[16:19], v[64:67]
buffer_load_dwordx4 a[132:135], v2, s[8:11], s27 offen offset:3072 sc1
v_mfma_f32_16x16x32_bf16 v[64:67], a[220:223], a[20:23], v[64:67]
ds_read_b128 a[240:243], v2 offset:39936
v_dot2_f32_bf16 v26, v229, s38, v21
v_mfma_f32_16x16x32_bf16 v[68:71], a[216:219], a[88:91], v[68:71]
v_dot2_f32_bf16 v27, v229, s39, v21
v_dot2_f32_bf16 v28, v230, s38, v21
v_mfma_f32_16x16x32_bf16 v[68:71], a[220:223], a[92:95], v[68:71]
ds_read_b128 a[244:247], v2 offset:48128
s_waitcnt lgkmcnt(4)
v_mfma_f32_16x16x32_bf16 v[72:75], a[16:19], a[224:227], v[72:75]
buffer_load_dwordx4 a[204:207], v3, s[8:11], s28 offen offset:3072 sc1
v_mfma_f32_16x16x32_bf16 v[72:75], a[20:23], a[228:231], v[72:75]
ds_read_b128 a[216:219], v6 offset:32768
v_dot2_f32_bf16 v29, v230, s39, v21
v_mfma_f32_16x16x32_bf16 v[76:79], a[88:91], a[224:227], v[76:79]
v_dot2_f32_bf16 v30, v231, s38, v21
v_dot2_f32_bf16 v31, v231, s39, v21
v_mfma_f32_16x16x32_bf16 v[76:79], a[92:95], a[228:231], v[76:79]
ds_read_b128 a[220:223], v6 offset:40960
s_waitcnt lgkmcnt(4)
v_mfma_f32_16x16x32_bf16 v[80:83], a[16:19], a[232:235], v[80:83]
s_add_u32 s26, s26, 4096
s_add_u32 s27, s27, 4096
s_add_u32 s28, s28, 4096
buffer_load_dwordx4 a[64:67], v2, s[8:11], s26 offen offset:0 sc1
v_mfma_f32_16x16x32_bf16 v[80:83], a[20:23], a[236:239], v[80:83]
ds_read_b128 a[224:227], v9 offset:32768
v_cvt_pk_bf16_f32 v228, v24, v25
v_mfma_f32_16x16x32_bf16 v[84:87], a[88:91], a[232:235], v[84:87]
v_cvt_pk_bf16_f32 v229, v26, v27
v_cvt_pk_bf16_f32 v230, v28, v29
v_mfma_f32_16x16x32_bf16 v[84:87], a[92:95], a[236:239], v[84:87]
ds_read_b128 a[228:231], v9 offset:40960
s_waitcnt lgkmcnt(4)
v_mfma_f32_16x16x32_bf16 v[88:91], a[16:19], a[240:243], v[88:91]
buffer_load_dwordx4 a[136:139], v2, s[8:11], s27 offen offset:0 sc1
v_mfma_f32_16x16x32_bf16 v[88:91], a[20:23], a[244:247], v[88:91]
ds_read_b128 a[232:235], v2 offset:49152
v_cvt_pk_bf16_f32 v231, v30, v31
v_mfma_f32_16x16x32_bf16 v[92:95], a[88:91], a[240:243], v[92:95]
v_dot2_f32_bf16 v24, v232, s38, v22
v_dot2_f32_bf16 v25, v232, s39, v22
v_mfma_f32_16x16x32_bf16 v[92:95], a[92:95], a[244:247], v[92:95]
ds_read_b128 a[236:239], v2 offset:57344
s_waitcnt lgkmcnt(4)
v_mfma_f32_16x16x32_bf16 v[96:99], a[216:219], a[160:163], v[96:99]
ds_read_b128 a[240:243], v2 offset:50176
buffer_load_dwordx4 a[208:211], v3, s[8:11], s28 offen offset:0 sc1
v_mfma_f32_16x16x32_bf16 v[96:99], a[220:223], a[164:167], v[96:99]
ds_read_b128 a[244:247], v2 offset:58368
s_waitcnt lgkmcnt(4)
v_mfma_f32_16x16x32_bf16 v[100:103], a[160:163], a[224:227], v[100:103]
ds_read_b128 a[216:219], v2 offset:51200
v_dot2_f32_bf16 v26, v233, s38, v22
v_mfma_f32_16x16x32_bf16 v[100:103], a[164:167], a[228:231], v[100:103]
ds_read_b128 a[220:223], v2 offset:59392
s_waitcnt vmcnt(27)
s_waitcnt lgkmcnt(4)
v_mfma_f32_16x16x32_bf16 v[32:35], a[232:235], a[24:27], v[32:35]
buffer_load_dwordx4 a[68:71], v2, s[8:11], s26 offen offset:1024 sc1
v_mfma_f32_16x16x32_bf16 v[32:35], a[236:239], a[28:31], v[32:35]
ds_read_b128 a[224:227], v2 offset:52224
v_dot2_f32_bf16 v27, v233, s39, v22
v_mfma_f32_16x16x32_bf16 v[36:39], a[232:235], a[96:99], v[36:39]
v_dot2_f32_bf16 v28, v234, s38, v22
v_dot2_f32_bf16 v29, v234, s39, v22
v_mfma_f32_16x16x32_bf16 v[36:39], a[236:239], a[100:103], v[36:39]
ds_read_b128 a[228:231], v2 offset:60416
s_waitcnt lgkmcnt(4)
v_mfma_f32_16x16x32_bf16 v[40:43], a[240:243], a[24:27], v[40:43]
buffer_load_dwordx4 a[140:143], v2, s[8:11], s27 offen offset:1024 sc1
v_mfma_f32_16x16x32_bf16 v[40:43], a[244:247], a[28:31], v[40:43]
ds_read_b128 a[232:235], v2 offset:53248
v_dot2_f32_bf16 v30, v235, s38, v22
v_mfma_f32_16x16x32_bf16 v[44:47], a[240:243], a[96:99], v[44:47]
v_dot2_f32_bf16 v31, v235, s39, v22
v_cvt_pk_bf16_f32 v232, v24, v25
v_mfma_f32_16x16x32_bf16 v[44:47], a[244:247], a[100:103], v[44:47]
ds_read_b128 a[236:239], v2 offset:61440
s_waitcnt lgkmcnt(4)
v_mfma_f32_16x16x32_bf16 v[48:51], a[216:219], a[24:27], v[48:51]
buffer_load_dwordx4 a[212:215], v3, s[8:11], s28 offen offset:1024 sc1
v_mfma_f32_16x16x32_bf16 v[48:51], a[220:223], a[28:31], v[48:51]
ds_read_b128 a[240:243], v2 offset:54272
v_cvt_pk_bf16_f32 v233, v26, v27
v_mfma_f32_16x16x32_bf16 v[52:55], a[216:219], a[96:99], v[52:55]
v_cvt_pk_bf16_f32 v234, v28, v29
v_cvt_pk_bf16_f32 v235, v30, v31
v_mfma_f32_16x16x32_bf16 v[52:55], a[220:223], a[100:103], v[52:55]
ds_read_b128 a[244:247], v2 offset:62464
s_waitcnt lgkmcnt(4)
v_mfma_f32_16x16x32_bf16 v[56:59], a[224:227], a[24:27], v[56:59]
buffer_store_dwordx4 v[176:179], v156, s[8:11], 0 offen sc1
v_dot2_f32_bf16 v24, v236, s38, v23
v_mfma_f32_16x16x32_bf16 v[56:59], a[228:231], a[28:31], v[56:59]
ds_read_b128 a[216:219], v2 offset:55296
v_dot2_f32_bf16 v25, v236, s39, v23
v_mfma_f32_16x16x32_bf16 v[60:63], a[224:227], a[96:99], v[60:63]
v_dot2_f32_bf16 v26, v237, s38, v23
v_dot2_f32_bf16 v27, v237, s39, v23
v_mfma_f32_16x16x32_bf16 v[60:63], a[228:231], a[100:103], v[60:63]
ds_read_b128 a[220:223], v2 offset:63488
s_waitcnt lgkmcnt(4)
v_mfma_f32_16x16x32_bf16 v[64:67], a[232:235], a[24:27], v[64:67]
buffer_store_dwordx4 v[180:183], v157, s[8:11], 0 offen sc1
v_dot2_f32_bf16 v28, v238, s38, v23
v_mfma_f32_16x16x32_bf16 v[64:67], a[236:239], a[28:31], v[64:67]
ds_read_b128 a[224:227], v2 offset:56320
v_dot2_f32_bf16 v29, v238, s39, v23
v_mfma_f32_16x16x32_bf16 v[68:71], a[232:235], a[96:99], v[68:71]
v_dot2_f32_bf16 v30, v239, s38, v23
v_dot2_f32_bf16 v31, v239, s39, v23
v_mfma_f32_16x16x32_bf16 v[68:71], a[236:239], a[100:103], v[68:71]
ds_read_b128 a[228:231], v2 offset:64512
s_waitcnt lgkmcnt(4)
v_mfma_f32_16x16x32_bf16 v[72:75], a[24:27], a[240:243], v[72:75]
buffer_store_dwordx4 v[184:187], v158, s[8:11], 0 offen sc1
v_cvt_pk_bf16_f32 v236, v24, v25
v_mfma_f32_16x16x32_bf16 v[72:75], a[28:31], a[244:247], v[72:75]
ds_read_b128 a[232:235], v6 offset:49152
v_cvt_pk_bf16_f32 v237, v26, v27
v_mfma_f32_16x16x32_bf16 v[76:79], a[96:99], a[240:243], v[76:79]
v_cvt_pk_bf16_f32 v238, v28, v29
v_cvt_pk_bf16_f32 v239, v30, v31
v_mfma_f32_16x16x32_bf16 v[76:79], a[100:103], a[244:247], v[76:79]
ds_read_b128 a[236:239], v6 offset:57344
s_waitcnt lgkmcnt(4)
v_mfma_f32_16x16x32_bf16 v[80:83], a[24:27], a[216:219], v[80:83]
buffer_store_dwordx4 v[188:191], v159, s[8:11], 0 offen sc1
v_dot2_f32_bf16 v24, v240, s38, v20
v_mfma_f32_16x16x32_bf16 v[80:83], a[28:31], a[220:223], v[80:83]
ds_read_b128 a[240:243], v9 offset:49152
v_dot2_f32_bf16 v25, v240, s39, v20
v_mfma_f32_16x16x32_bf16 v[84:87], a[96:99], a[216:219], v[84:87]
v_dot2_f32_bf16 v26, v241, s38, v20
v_dot2_f32_bf16 v27, v241, s39, v20
v_mfma_f32_16x16x32_bf16 v[84:87], a[100:103], a[220:223], v[84:87]
ds_read_b128 a[244:247], v9 offset:57344
s_waitcnt lgkmcnt(4)
v_mfma_f32_16x16x32_bf16 v[88:91], a[24:27], a[224:227], v[88:91]
buffer_store_dwordx4 v[192:195], v160, s[8:11], 0 offen sc1
v_dot2_f32_bf16 v28, v242, s38, v20
v_mfma_f32_16x16x32_bf16 v[88:91], a[28:31], a[228:231], v[88:91]
ds_read_b128 a[216:219], v4 offset:0
v_dot2_f32_bf16 v29, v242, s39, v20
v_mfma_f32_16x16x32_bf16 v[92:95], a[96:99], a[224:227], v[92:95]
v_dot2_f32_bf16 v30, v243, s38, v20
v_dot2_f32_bf16 v31, v243, s39, v20
v_mfma_f32_16x16x32_bf16 v[92:95], a[100:103], a[228:231], v[92:95]
ds_read_b128 a[220:223], v4 offset:8192
s_waitcnt lgkmcnt(4)
v_mfma_f32_16x16x32_bf16 v[96:99], a[232:235], a[168:171], v[96:99]
ds_read_b128 a[224:227], v4 offset:1024
buffer_store_dwordx4 v[196:199], v161, s[8:11], 0 offen sc1
v_cvt_pk_bf16_f32 v240, v24, v25
v_mfma_f32_16x16x32_bf16 v[96:99], a[236:239], a[172:175], v[96:99]
ds_read_b128 a[228:231], v4 offset:9216
s_waitcnt lgkmcnt(4)
v_mfma_f32_16x16x32_bf16 v[100:103], a[168:171], a[240:243], v[100:103]
ds_read_b128 a[232:235], v4 offset:2048
v_cvt_pk_bf16_f32 v241, v26, v27
v_mfma_f32_16x16x32_bf16 v[100:103], a[172:175], a[244:247], v[100:103]
ds_read_b128 a[236:239], v4 offset:10240
s_waitcnt vmcnt(30)
s_waitcnt lgkmcnt(4)
v_mfma_f32_16x16x32_bf16 v[32:35], a[216:219], a[32:35], v[32:35]
buffer_store_dwordx4 v[200:203], v162, s[8:11], 0 offen sc1
v_cvt_pk_bf16_f32 v242, v28, v29
v_mfma_f32_16x16x32_bf16 v[32:35], a[220:223], a[36:39], v[32:35]
ds_read_b128 a[240:243], v4 offset:3072
v_cvt_pk_bf16_f32 v243, v30, v31
v_mfma_f32_16x16x32_bf16 v[36:39], a[216:219], a[104:107], v[36:39]
v_dot2_f32_bf16 v24, v244, s38, v21
v_dot2_f32_bf16 v25, v244, s39, v21
v_mfma_f32_16x16x32_bf16 v[36:39], a[220:223], a[108:111], v[36:39]
ds_read_b128 a[244:247], v4 offset:11264
s_waitcnt lgkmcnt(4)
v_mfma_f32_16x16x32_bf16 v[40:43], a[224:227], a[32:35], v[40:43]
buffer_store_dwordx4 v[204:207], v163, s[8:11], 0 offen sc1
v_dot2_f32_bf16 v26, v245, s38, v21
v_mfma_f32_16x16x32_bf16 v[40:43], a[228:231], a[36:39], v[40:43]
ds_read_b128 a[216:219], v4 offset:4096
v_dot2_f32_bf16 v27, v245, s39, v21
v_mfma_f32_16x16x32_bf16 v[44:47], a[224:227], a[104:107], v[44:47]
v_dot2_f32_bf16 v28, v246, s38, v21
v_dot2_f32_bf16 v29, v246, s39, v21
v_mfma_f32_16x16x32_bf16 v[44:47], a[228:231], a[108:111], v[44:47]
ds_read_b128 a[220:223], v4 offset:12288
s_waitcnt lgkmcnt(4)
v_mfma_f32_16x16x32_bf16 v[48:51], a[232:235], a[32:35], v[48:51]
buffer_store_dwordx4 v[208:211], v164, s[8:11], 0 offen sc1
v_dot2_f32_bf16 v30, v247, s38, v21
v_mfma_f32_16x16x32_bf16 v[48:51], a[236:239], a[36:39], v[48:51]
ds_read_b128 a[224:227], v4 offset:5120
v_dot2_f32_bf16 v31, v247, s39, v21
v_mfma_f32_16x16x32_bf16 v[52:55], a[232:235], a[104:107], v[52:55]
v_cvt_pk_bf16_f32 v244, v24, v25
v_cvt_pk_bf16_f32 v245, v26, v27
v_mfma_f32_16x16x32_bf16 v[52:55], a[236:239], a[108:111], v[52:55]
ds_read_b128 a[228:231], v4 offset:13312
s_waitcnt lgkmcnt(4)
v_mfma_f32_16x16x32_bf16 v[56:59], a[240:243], a[32:35], v[56:59]
buffer_store_dwordx4 v[212:215], v165, s[8:11], 0 offen sc1
v_cvt_pk_bf16_f32 v246, v28, v29
v_mfma_f32_16x16x32_bf16 v[56:59], a[244:247], a[36:39], v[56:59]
ds_read_b128 a[232:235], v4 offset:6144
v_cvt_pk_bf16_f32 v247, v30, v31
v_mfma_f32_16x16x32_bf16 v[60:63], a[240:243], a[104:107], v[60:63]
v_dot2_f32_bf16 v24, v248, s38, v22
v_dot2_f32_bf16 v25, v248, s39, v22
v_mfma_f32_16x16x32_bf16 v[60:63], a[244:247], a[108:111], v[60:63]
ds_read_b128 a[236:239], v4 offset:14336
s_waitcnt lgkmcnt(4)
v_mfma_f32_16x16x32_bf16 v[64:67], a[216:219], a[32:35], v[64:67]
buffer_store_dwordx4 v[216:219], v166, s[8:11], 0 offen sc1
v_dot2_f32_bf16 v26, v249, s38, v22
v_mfma_f32_16x16x32_bf16 v[64:67], a[220:223], a[36:39], v[64:67]
ds_read_b128 a[240:243], v4 offset:7168
v_dot2_f32_bf16 v27, v249, s39, v22
v_mfma_f32_16x16x32_bf16 v[68:71], a[216:219], a[104:107], v[68:71]
v_dot2_f32_bf16 v28, v250, s38, v22
v_dot2_f32_bf16 v29, v250, s39, v22
v_mfma_f32_16x16x32_bf16 v[68:71], a[220:223], a[108:111], v[68:71]
ds_read_b128 a[244:247], v4 offset:15360
s_waitcnt lgkmcnt(4)
v_mfma_f32_16x16x32_bf16 v[72:75], a[32:35], a[224:227], v[72:75]
buffer_store_dwordx4 v[220:223], v167, s[8:11], 0 offen sc1
v_dot2_f32_bf16 v30, v251, s38, v22
v_mfma_f32_16x16x32_bf16 v[72:75], a[36:39], a[228:231], v[72:75]
ds_read_b128 a[216:219], v7 offset:0
v_dot2_f32_bf16 v31, v251, s39, v22
v_mfma_f32_16x16x32_bf16 v[76:79], a[104:107], a[224:227], v[76:79]
v_cvt_pk_bf16_f32 v248, v24, v25
v_cvt_pk_bf16_f32 v249, v26, v27
v_mfma_f32_16x16x32_bf16 v[76:79], a[108:111], a[228:231], v[76:79]
ds_read_b128 a[220:223], v7 offset:8192
s_waitcnt lgkmcnt(4)
v_mfma_f32_16x16x32_bf16 v[80:83], a[32:35], a[232:235], v[80:83]
buffer_store_dwordx4 v[224:227], v168, s[8:11], 0 offen sc1
v_cvt_pk_bf16_f32 v250, v28, v29
v_mfma_f32_16x16x32_bf16 v[80:83], a[36:39], a[236:239], v[80:83]
ds_read_b128 a[224:227], v10 offset:0
v_cvt_pk_bf16_f32 v251, v30, v31
v_mfma_f32_16x16x32_bf16 v[84:87], a[104:107], a[232:235], v[84:87]
v_dot2_f32_bf16 v24, v252, s38, v23
v_dot2_f32_bf16 v25, v252, s39, v23
v_mfma_f32_16x16x32_bf16 v[84:87], a[108:111], a[236:239], v[84:87]
ds_read_b128 a[228:231], v10 offset:8192
s_waitcnt lgkmcnt(4)
v_mfma_f32_16x16x32_bf16 v[88:91], a[32:35], a[240:243], v[88:91]
buffer_store_dwordx4 v[228:231], v169, s[8:11], 0 offen sc1
v_dot2_f32_bf16 v26, v253, s38, v23
v_mfma_f32_16x16x32_bf16 v[88:91], a[36:39], a[244:247], v[88:91]
ds_read_b128 a[232:235], v4 offset:16384
v_dot2_f32_bf16 v27, v253, s39, v23
v_mfma_f32_16x16x32_bf16 v[92:95], a[104:107], a[240:243], v[92:95]
v_dot2_f32_bf16 v28, v254, s38, v23
v_dot2_f32_bf16 v29, v254, s39, v23
v_mfma_f32_16x16x32_bf16 v[92:95], a[108:111], a[244:247], v[92:95]
ds_read_b128 a[236:239], v4 offset:24576
s_waitcnt lgkmcnt(4)
v_mfma_f32_16x16x32_bf16 v[96:99], a[216:219], a[176:179], v[96:99]
ds_read_b128 a[240:243], v4 offset:17408
buffer_store_dwordx4 v[232:235], v170, s[8:11], 0 offen sc1
v_dot2_f32_bf16 v30, v255, s38, v23
v_mfma_f32_16x16x32_bf16 v[96:99], a[220:223], a[180:183], v[96:99]
ds_read_b128 a[244:247], v4 offset:25600
s_waitcnt lgkmcnt(4)
v_mfma_f32_16x16x32_bf16 v[100:103], a[176:179], a[224:227], v[100:103]
ds_read_b128 a[216:219], v4 offset:18432
v_dot2_f32_bf16 v31, v255, s39, v23
v_mfma_f32_16x16x32_bf16 v[100:103], a[180:183], a[228:231], v[100:103]
ds_read_b128 a[220:223], v4 offset:26624
s_waitcnt vmcnt(33)
s_waitcnt lgkmcnt(4)
v_mfma_f32_16x16x32_bf16 v[32:35], a[232:235], a[40:43], v[32:35]
buffer_store_dwordx4 v[236:239], v171, s[8:11], 0 offen sc1
v_cvt_pk_bf16_f32 v252, v24, v25
v_mfma_f32_16x16x32_bf16 v[32:35], a[236:239], a[44:47], v[32:35]
ds_read_b128 a[224:227], v4 offset:19456
v_cvt_pk_bf16_f32 v253, v26, v27
v_mfma_f32_16x16x32_bf16 v[36:39], a[232:235], a[112:115], v[36:39]
v_cvt_pk_bf16_f32 v254, v28, v29
v_cvt_pk_bf16_f32 v255, v30, v31
v_mfma_f32_16x16x32_bf16 v[36:39], a[236:239], a[116:119], v[36:39]
ds_read_b128 a[228:231], v4 offset:27648
s_waitcnt lgkmcnt(4)
v_mfma_f32_16x16x32_bf16 v[40:43], a[240:243], a[40:43], v[40:43]
buffer_store_dwordx4 v[240:243], v172, s[8:11], 0 offen sc1
v_mfma_f32_16x16x32_bf16 v[40:43], a[244:247], a[44:47], v[40:43]
ds_read_b128 a[232:235], v4 offset:20480
v_mfma_f32_16x16x32_bf16 v[44:47], a[240:243], a[112:115], v[44:47]
v_mfma_f32_16x16x32_bf16 v[44:47], a[244:247], a[116:119], v[44:47]
ds_read_b128 a[236:239], v4 offset:28672
s_waitcnt lgkmcnt(4)
v_mfma_f32_16x16x32_bf16 v[48:51], a[216:219], a[40:43], v[48:51]
buffer_store_dwordx4 v[244:247], v173, s[8:11], 0 offen sc1
v_mfma_f32_16x16x32_bf16 v[48:51], a[220:223], a[44:47], v[48:51]
ds_read_b128 a[240:243], v4 offset:21504
v_mfma_f32_16x16x32_bf16 v[52:55], a[216:219], a[112:115], v[52:55]
v_mfma_f32_16x16x32_bf16 v[52:55], a[220:223], a[116:119], v[52:55]
ds_read_b128 a[244:247], v4 offset:29696
s_waitcnt lgkmcnt(4)
v_mfma_f32_16x16x32_bf16 v[56:59], a[224:227], a[40:43], v[56:59]
buffer_store_dwordx4 v[248:251], v174, s[8:11], 0 offen sc1
v_mfma_f32_16x16x32_bf16 v[56:59], a[228:231], a[44:47], v[56:59]
ds_read_b128 a[216:219], v4 offset:22528
v_mfma_f32_16x16x32_bf16 v[60:63], a[224:227], a[112:115], v[60:63]
v_mfma_f32_16x16x32_bf16 v[60:63], a[228:231], a[116:119], v[60:63]
ds_read_b128 a[220:223], v4 offset:30720
s_waitcnt lgkmcnt(4)
v_mfma_f32_16x16x32_bf16 v[64:67], a[232:235], a[40:43], v[64:67]
buffer_store_dwordx4 v[252:255], v175, s[8:11], 0 offen sc1
v_mfma_f32_16x16x32_bf16 v[64:67], a[236:239], a[44:47], v[64:67]
ds_read_b128 a[224:227], v4 offset:23552
v_mfma_f32_16x16x32_bf16 v[68:71], a[232:235], a[112:115], v[68:71]
v_mfma_f32_16x16x32_bf16 v[68:71], a[236:239], a[116:119], v[68:71]
ds_read_b128 a[228:231], v4 offset:31744
s_waitcnt lgkmcnt(4)
v_mfma_f32_16x16x32_bf16 v[72:75], a[40:43], a[240:243], v[72:75]
v_mfma_f32_16x16x32_bf16 v[72:75], a[44:47], a[244:247], v[72:75]
ds_read_b128 a[232:235], v7 offset:16384
v_mfma_f32_16x16x32_bf16 v[76:79], a[112:115], a[240:243], v[76:79]
v_mfma_f32_16x16x32_bf16 v[76:79], a[116:119], a[244:247], v[76:79]
ds_read_b128 a[236:239], v7 offset:24576
s_waitcnt lgkmcnt(4)
v_mfma_f32_16x16x32_bf16 v[80:83], a[40:43], a[216:219], v[80:83]
v_mfma_f32_16x16x32_bf16 v[80:83], a[44:47], a[220:223], v[80:83]
ds_read_b128 a[240:243], v10 offset:16384
v_mfma_f32_16x16x32_bf16 v[84:87], a[112:115], a[216:219], v[84:87]
v_mfma_f32_16x16x32_bf16 v[84:87], a[116:119], a[220:223], v[84:87]
ds_read_b128 a[244:247], v10 offset:24576
s_waitcnt lgkmcnt(4)
v_mfma_f32_16x16x32_bf16 v[88:91], a[40:43], a[224:227], v[88:91]
v_mfma_f32_16x16x32_bf16 v[88:91], a[44:47], a[228:231], v[88:91]
ds_read_b128 a[216:219], v4 offset:32768
v_mfma_f32_16x16x32_bf16 v[92:95], a[112:115], a[224:227], v[92:95]
v_mfma_f32_16x16x32_bf16 v[92:95], a[116:119], a[228:231], v[92:95]
ds_read_b128 a[220:223], v4 offset:40960
s_waitcnt lgkmcnt(4)
v_mfma_f32_16x16x32_bf16 v[96:99], a[232:235], a[184:187], v[96:99]
ds_read_b128 a[224:227], v4 offset:33792
v_mfma_f32_16x16x32_bf16 v[96:99], a[236:239], a[188:191], v[96:99]
ds_read_b128 a[228:231], v4 offset:41984
s_waitcnt lgkmcnt(4)
v_mfma_f32_16x16x32_bf16 v[100:103], a[184:187], a[240:243], v[100:103]
ds_read_b128 a[232:235], v4 offset:34816
v_mfma_f32_16x16x32_bf16 v[100:103], a[188:191], a[244:247], v[100:103]
ds_read_b128 a[236:239], v4 offset:43008
s_waitcnt vmcnt(32)
s_waitcnt lgkmcnt(4)
v_mfma_f32_16x16x32_bf16 v[32:35], a[216:219], a[48:51], v[32:35]
v_mfma_f32_16x16x32_bf16 v[32:35], a[220:223], a[52:55], v[32:35]
ds_read_b128 a[240:243], v4 offset:35840
v_mfma_f32_16x16x32_bf16 v[36:39], a[216:219], a[120:123], v[36:39]
v_mfma_f32_16x16x32_bf16 v[36:39], a[220:223], a[124:127], v[36:39]
ds_read_b128 a[244:247], v4 offset:44032
s_waitcnt lgkmcnt(4)
v_mfma_f32_16x16x32_bf16 v[40:43], a[224:227], a[48:51], v[40:43]
v_mfma_f32_16x16x32_bf16 v[40:43], a[228:231], a[52:55], v[40:43]
ds_read_b128 a[216:219], v4 offset:36864
v_mfma_f32_16x16x32_bf16 v[44:47], a[224:227], a[120:123], v[44:47]
v_mfma_f32_16x16x32_bf16 v[44:47], a[228:231], a[124:127], v[44:47]
ds_read_b128 a[220:223], v4 offset:45056
s_waitcnt lgkmcnt(4)
v_mfma_f32_16x16x32_bf16 v[48:51], a[232:235], a[48:51], v[48:51]
v_mfma_f32_16x16x32_bf16 v[48:51], a[236:239], a[52:55], v[48:51]
ds_read_b128 a[224:227], v4 offset:37888
v_mfma_f32_16x16x32_bf16 v[52:55], a[232:235], a[120:123], v[52:55]
v_mfma_f32_16x16x32_bf16 v[52:55], a[236:239], a[124:127], v[52:55]
ds_read_b128 a[228:231], v4 offset:46080
s_waitcnt lgkmcnt(4)
v_mfma_f32_16x16x32_bf16 v[56:59], a[240:243], a[48:51], v[56:59]
v_mfma_f32_16x16x32_bf16 v[56:59], a[244:247], a[52:55], v[56:59]
ds_read_b128 a[232:235], v4 offset:38912
v_mfma_f32_16x16x32_bf16 v[60:63], a[240:243], a[120:123], v[60:63]
v_mfma_f32_16x16x32_bf16 v[60:63], a[244:247], a[124:127], v[60:63]
ds_read_b128 a[236:239], v4 offset:47104
s_waitcnt lgkmcnt(4)
v_mfma_f32_16x16x32_bf16 v[64:67], a[216:219], a[48:51], v[64:67]
v_mfma_f32_16x16x32_bf16 v[64:67], a[220:223], a[52:55], v[64:67]
ds_read_b128 a[240:243], v4 offset:39936
v_mfma_f32_16x16x32_bf16 v[68:71], a[216:219], a[120:123], v[68:71]
v_mfma_f32_16x16x32_bf16 v[68:71], a[220:223], a[124:127], v[68:71]
ds_read_b128 a[244:247], v4 offset:48128
s_waitcnt lgkmcnt(4)
v_mfma_f32_16x16x32_bf16 v[72:75], a[48:51], a[224:227], v[72:75]
v_mfma_f32_16x16x32_bf16 v[72:75], a[52:55], a[228:231], v[72:75]
ds_read_b128 a[216:219], v7 offset:32768
v_mfma_f32_16x16x32_bf16 v[76:79], a[120:123], a[224:227], v[76:79]
v_mfma_f32_16x16x32_bf16 v[76:79], a[124:127], a[228:231], v[76:79]
ds_read_b128 a[220:223], v7 offset:40960
s_waitcnt lgkmcnt(4)
v_mfma_f32_16x16x32_bf16 v[80:83], a[48:51], a[232:235], v[80:83]
v_mfma_f32_16x16x32_bf16 v[80:83], a[52:55], a[236:239], v[80:83]
ds_read_b128 a[224:227], v10 offset:32768
v_mfma_f32_16x16x32_bf16 v[84:87], a[120:123], a[232:235], v[84:87]
v_mfma_f32_16x16x32_bf16 v[84:87], a[124:127], a[236:239], v[84:87]
ds_read_b128 a[228:231], v10 offset:40960
s_waitcnt lgkmcnt(4)
v_mfma_f32_16x16x32_bf16 v[88:91], a[48:51], a[240:243], v[88:91]
v_mfma_f32_16x16x32_bf16 v[88:91], a[52:55], a[244:247], v[88:91]
ds_read_b128 a[232:235], v4 offset:49152
v_mfma_f32_16x16x32_bf16 v[92:95], a[120:123], a[240:243], v[92:95]
v_mfma_f32_16x16x32_bf16 v[92:95], a[124:127], a[244:247], v[92:95]
ds_read_b128 a[236:239], v4 offset:57344
s_waitcnt lgkmcnt(4)
v_mfma_f32_16x16x32_bf16 v[96:99], a[216:219], a[192:195], v[96:99]
ds_read_b128 a[240:243], v4 offset:50176
v_mfma_f32_16x16x32_bf16 v[96:99], a[220:223], a[196:199], v[96:99]
ds_read_b128 a[244:247], v4 offset:58368
s_waitcnt lgkmcnt(4)
v_mfma_f32_16x16x32_bf16 v[100:103], a[192:195], a[224:227], v[100:103]
ds_read_b128 a[216:219], v4 offset:51200
v_mfma_f32_16x16x32_bf16 v[100:103], a[196:199], a[228:231], v[100:103]
ds_read_b128 a[220:223], v4 offset:59392
s_waitcnt vmcnt(26)
s_waitcnt lgkmcnt(4)
v_mfma_f32_16x16x32_bf16 v[32:35], a[232:235], a[56:59], v[32:35]
v_mfma_f32_16x16x32_bf16 v[32:35], a[236:239], a[60:63], v[32:35]
ds_read_b128 a[224:227], v4 offset:52224
v_mfma_f32_16x16x32_bf16 v[36:39], a[232:235], a[128:131], v[36:39]
v_mfma_f32_16x16x32_bf16 v[36:39], a[236:239], a[132:135], v[36:39]
ds_read_b128 a[228:231], v4 offset:60416
s_waitcnt lgkmcnt(4)
v_mfma_f32_16x16x32_bf16 v[40:43], a[240:243], a[56:59], v[40:43]
v_mfma_f32_16x16x32_bf16 v[40:43], a[244:247], a[60:63], v[40:43]
ds_read_b128 a[232:235], v4 offset:53248
v_mfma_f32_16x16x32_bf16 v[44:47], a[240:243], a[128:131], v[44:47]
v_mfma_f32_16x16x32_bf16 v[44:47], a[244:247], a[132:135], v[44:47]
ds_read_b128 a[236:239], v4 offset:61440
s_waitcnt lgkmcnt(4)
v_mfma_f32_16x16x32_bf16 v[48:51], a[216:219], a[56:59], v[48:51]
v_mfma_f32_16x16x32_bf16 v[48:51], a[220:223], a[60:63], v[48:51]
ds_read_b128 a[240:243], v4 offset:54272
v_mfma_f32_16x16x32_bf16 v[52:55], a[216:219], a[128:131], v[52:55]
v_mfma_f32_16x16x32_bf16 v[52:55], a[220:223], a[132:135], v[52:55]
ds_read_b128 a[244:247], v4 offset:62464
s_waitcnt lgkmcnt(4)
v_mfma_f32_16x16x32_bf16 v[56:59], a[224:227], a[56:59], v[56:59]
v_mfma_f32_16x16x32_bf16 v[56:59], a[228:231], a[60:63], v[56:59]
ds_read_b128 a[216:219], v4 offset:55296
v_mfma_f32_16x16x32_bf16 v[60:63], a[224:227], a[128:131], v[60:63]
v_mfma_f32_16x16x32_bf16 v[60:63], a[228:231], a[132:135], v[60:63]
ds_read_b128 a[220:223], v4 offset:63488
s_waitcnt lgkmcnt(4)
v_mfma_f32_16x16x32_bf16 v[64:67], a[232:235], a[56:59], v[64:67]
v_mfma_f32_16x16x32_bf16 v[64:67], a[236:239], a[60:63], v[64:67]
ds_read_b128 a[224:227], v4 offset:56320
v_mfma_f32_16x16x32_bf16 v[68:71], a[232:235], a[128:131], v[68:71]
v_mfma_f32_16x16x32_bf16 v[68:71], a[236:239], a[132:135], v[68:71]
ds_read_b128 a[228:231], v4 offset:64512
s_waitcnt lgkmcnt(4)
v_mfma_f32_16x16x32_bf16 v[72:75], a[56:59], a[240:243], v[72:75]
v_mfma_f32_16x16x32_bf16 v[72:75], a[60:63], a[244:247], v[72:75]
ds_read_b128 a[232:235], v7 offset:49152
v_mfma_f32_16x16x32_bf16 v[76:79], a[128:131], a[240:243], v[76:79]
v_mfma_f32_16x16x32_bf16 v[76:79], a[132:135], a[244:247], v[76:79]
ds_read_b128 a[236:239], v7 offset:57344
s_waitcnt lgkmcnt(4)
v_mfma_f32_16x16x32_bf16 v[80:83], a[56:59], a[216:219], v[80:83]
v_mfma_f32_16x16x32_bf16 v[80:83], a[60:63], a[220:223], v[80:83]
ds_read_b128 a[240:243], v10 offset:49152
v_mfma_f32_16x16x32_bf16 v[84:87], a[128:131], a[216:219], v[84:87]
v_mfma_f32_16x16x32_bf16 v[84:87], a[132:135], a[220:223], v[84:87]
ds_read_b128 a[244:247], v10 offset:57344
s_waitcnt lgkmcnt(4)
v_mfma_f32_16x16x32_bf16 v[88:91], a[56:59], a[224:227], v[88:91]
v_mfma_f32_16x16x32_bf16 v[88:91], a[60:63], a[228:231], v[88:91]
ds_read_b128 a[216:219], v5 offset:0
v_mfma_f32_16x16x32_bf16 v[92:95], a[128:131], a[224:227], v[92:95]
v_mfma_f32_16x16x32_bf16 v[92:95], a[132:135], a[228:231], v[92:95]
ds_read_b128 a[220:223], v5 offset:8192
s_waitcnt lgkmcnt(4)
v_mfma_f32_16x16x32_bf16 v[96:99], a[232:235], a[200:203], v[96:99]
ds_read_b128 a[224:227], v5 offset:1024
v_mfma_f32_16x16x32_bf16 v[96:99], a[236:239], a[204:207], v[96:99]
ds_read_b128 a[228:231], v5 offset:9216
s_waitcnt lgkmcnt(4)
v_mfma_f32_16x16x32_bf16 v[100:103], a[200:203], a[240:243], v[100:103]
ds_read_b128 a[232:235], v5 offset:2048
v_mfma_f32_16x16x32_bf16 v[100:103], a[204:207], a[244:247], v[100:103]
ds_read_b128 a[236:239], v5 offset:10240
s_waitcnt vmcnt(20)
s_waitcnt lgkmcnt(4)
v_mfma_f32_16x16x32_bf16 v[32:35], a[216:219], a[64:67], v[32:35]
v_mfma_f32_16x16x32_bf16 v[32:35], a[220:223], a[68:71], v[32:35]
ds_read_b128 a[240:243], v5 offset:3072
v_mfma_f32_16x16x32_bf16 v[36:39], a[216:219], a[136:139], v[36:39]
v_mfma_f32_16x16x32_bf16 v[36:39], a[220:223], a[140:143], v[36:39]
ds_read_b128 a[244:247], v5 offset:11264
s_waitcnt lgkmcnt(4)
v_mfma_f32_16x16x32_bf16 v[40:43], a[224:227], a[64:67], v[40:43]
v_mfma_f32_16x16x32_bf16 v[40:43], a[228:231], a[68:71], v[40:43]
ds_read_b128 a[216:219], v5 offset:4096
v_mfma_f32_16x16x32_bf16 v[44:47], a[224:227], a[136:139], v[44:47]
v_mfma_f32_16x16x32_bf16 v[44:47], a[228:231], a[140:143], v[44:47]
ds_read_b128 a[220:223], v5 offset:12288
s_waitcnt lgkmcnt(4)
v_mfma_f32_16x16x32_bf16 v[48:51], a[232:235], a[64:67], v[48:51]
v_mfma_f32_16x16x32_bf16 v[48:51], a[236:239], a[68:71], v[48:51]
ds_read_b128 a[224:227], v5 offset:5120
v_mfma_f32_16x16x32_bf16 v[52:55], a[232:235], a[136:139], v[52:55]
v_mfma_f32_16x16x32_bf16 v[52:55], a[236:239], a[140:143], v[52:55]
ds_read_b128 a[228:231], v5 offset:13312
s_waitcnt lgkmcnt(4)
v_mfma_f32_16x16x32_bf16 v[56:59], a[240:243], a[64:67], v[56:59]
v_mfma_f32_16x16x32_bf16 v[56:59], a[244:247], a[68:71], v[56:59]
ds_read_b128 a[232:235], v5 offset:6144
v_mfma_f32_16x16x32_bf16 v[60:63], a[240:243], a[136:139], v[60:63]
v_mfma_f32_16x16x32_bf16 v[60:63], a[244:247], a[140:143], v[60:63]
ds_read_b128 a[236:239], v5 offset:14336
s_waitcnt lgkmcnt(4)
v_mfma_f32_16x16x32_bf16 v[64:67], a[216:219], a[64:67], v[64:67]
v_mfma_f32_16x16x32_bf16 v[64:67], a[220:223], a[68:71], v[64:67]
ds_read_b128 a[240:243], v5 offset:7168
v_mfma_f32_16x16x32_bf16 v[68:71], a[216:219], a[136:139], v[68:71]
v_mfma_f32_16x16x32_bf16 v[68:71], a[220:223], a[140:143], v[68:71]
ds_read_b128 a[244:247], v5 offset:15360
s_waitcnt lgkmcnt(4)
v_mfma_f32_16x16x32_bf16 v[72:75], a[64:67], a[224:227], v[72:75]
v_mfma_f32_16x16x32_bf16 v[72:75], a[68:71], a[228:231], v[72:75]
ds_read_b128 a[216:219], v8 offset:0
v_mfma_f32_16x16x32_bf16 v[76:79], a[136:139], a[224:227], v[76:79]
v_mfma_f32_16x16x32_bf16 v[76:79], a[140:143], a[228:231], v[76:79]
ds_read_b128 a[220:223], v8 offset:8192
s_waitcnt lgkmcnt(4)
v_mfma_f32_16x16x32_bf16 v[80:83], a[64:67], a[232:235], v[80:83]
v_mfma_f32_16x16x32_bf16 v[80:83], a[68:71], a[236:239], v[80:83]
ds_read_b128 a[224:227], v11 offset:0
v_mfma_f32_16x16x32_bf16 v[84:87], a[136:139], a[232:235], v[84:87]
v_mfma_f32_16x16x32_bf16 v[84:87], a[140:143], a[236:239], v[84:87]
ds_read_b128 a[228:231], v11 offset:8192
s_waitcnt lgkmcnt(4)
v_mfma_f32_16x16x32_bf16 v[88:91], a[64:67], a[240:243], v[88:91]
v_mfma_f32_16x16x32_bf16 v[88:91], a[68:71], a[244:247], v[88:91]
v_mfma_f32_16x16x32_bf16 v[92:95], a[136:139], a[240:243], v[92:95]
v_mfma_f32_16x16x32_bf16 v[92:95], a[140:143], a[244:247], v[92:95]
s_waitcnt lgkmcnt(2)
v_mfma_f32_16x16x32_bf16 v[96:99], a[216:219], a[208:211], v[96:99]
v_mfma_f32_16x16x32_bf16 v[96:99], a[220:223], a[212:215], v[96:99]
s_waitcnt lgkmcnt(0)
v_mfma_f32_16x16x32_bf16 v[100:103], a[208:211], a[224:227], v[100:103]
v_mfma_f32_16x16x32_bf16 v[100:103], a[212:215], a[228:231], v[100:103]
L_att:
v_cvt_pk_bf16_f32 v116, v52, v53
v_cvt_pk_bf16_f32 v117, v54, v55
v_cvt_pk_bf16_f32 v120, v60, v61
v_cvt_pk_bf16_f32 v121, v62, v63
v_cvt_pk_bf16_f32 v160, v68, v69
v_cvt_pk_bf16_f32 v161, v70, v71
v_cvt_pk_bf16_f32 v126, v76, v77
v_cvt_pk_bf16_f32 v127, v78, v79
v_cvt_pk_bf16_f32 v132, v84, v85
v_cvt_pk_bf16_f32 v133, v86, v87
v_cvt_pk_bf16_f32 v138, v92, v93
v_cvt_pk_bf16_f32 v139, v94, v95
v_cvt_pk_bf16_f32 v156, v96, v97
v_cvt_pk_bf16_f32 v157, v98, v99
v_cvt_pk_bf16_f32 v158, v100, v101
v_cvt_pk_bf16_f32 v159, v102, v103
v_lshlrev_b32 v14, 3, v1
s_mul_i32 s31, s4, 3072
s_add_u32 s32, s31, 147456
v_add_u32 v15, s32, v14
s_lshl_b32 s33, s29, 9
s_add_u32 s33, s33, 147456
v_add_u32 v16, s33, v14
s_cmp_eq_u32 s4, 3
s_cbranch_scc1 L_a1_noxch
ds_write_b64 v16, v[156:157]
ds_write_b64 v16, v[158:159] offset:1536
ds_write_b64 v15, v[116:117] offset:3072
ds_write_b64 v15, v[120:121] offset:3584
ds_write_b64 v15, v[160:161] offset:4096
ds_write_b64 v15, v[126:127] offset:4608
ds_write_b64 v15, v[132:133] offset:5120
ds_write_b64 v15, v[138:139] offset:5632
L_a1_noxch:
v_cvt_pk_bf16_f32 v110, v48, v49
v_cvt_pk_bf16_f32 v111, v50, v51
v_cvt_pk_bf16_f32 v114, v56, v57
v_cvt_pk_bf16_f32 v115, v58, v59
v_cvt_pk_bf16_f32 v124, v72, v73
v_cvt_pk_bf16_f32 v125, v74, v75
v_cvt_pk_bf16_f32 v130, v80, v81
v_cvt_pk_bf16_f32 v131, v82, v83
v_cvt_pk_bf16_f32 v136, v88, v89
v_cvt_pk_bf16_f32 v137, v90, v91
v_cvt_pk_bf16_f32 v140, v32, v33
v_cvt_pk_bf16_f32 v141, v34, v35
v_cvt_pk_bf16_f32 v146, v40, v41
v_cvt_pk_bf16_f32 v147, v42, v43
v_cvt_pk_bf16_f32 v142, v64, v65
v_cvt_pk_bf16_f32 v145, v66, v67
v_mov_b32 v143, 0
v_mov_b32 v144, 0
v_mov_b32 v112, 0
v_mov_b32 v113, 0
s_nop 0
v_permlane16_swap_b32 v142, v112
v_permlane16_swap_b32 v145, v113
v_cvt_pk_bf16_f32 v148, v36, v37
v_cvt_pk_bf16_f32 v149, v38, v39
v_cvt_pk_bf16_f32 v154, v44, v45
v_cvt_pk_bf16_f32 v155, v46, v47
v_cvt_pk_bf16_f32 v150, v68, v69
v_cvt_pk_bf16_f32 v153, v70, v71
v_mov_b32 v151, 0
v_mov_b32 v152, 0
v_mov_b32 v118, 0
v_mov_b32 v119, 0
s_nop 0
v_permlane16_swap_b32 v150, v118
v_permlane16_swap_b32 v153, v119
v_add_u32 v17, 16, v12
v_add_u32 v18, 32, v12
v_cmp_gt_u32 vcc, 16, v1
s_nop 1
v_cndmask_b32 v17, v18, v17, vcc
v_lshlrev_b32 v17, 3, v17
v_add_u32 v17, s32, v17
s_waitcnt lgkmcnt(0)
s_barrier
ds_read_b64 v[104:105], v15
ds_read_b64 v[108:109], v15 offset:512
ds_read_b64 v[106:107], v17 offset:1024
ds_read_b64 v[122:123], v15 offset:1536
ds_read_b64 v[128:129], v15 offset:2048
ds_read_b64 v[134:135], v15 offset:2560
v_mfma_f32_16x16x32_bf16 v[32:35], v[110:113], v[148:151], 0
v_mfma_f32_16x16x32_bf16 v[36:39], v[116:119], v[148:151], 0
v_mfma_f32_16x16x32_bf16 v[40:43], v[112:115], v[152:155], 0
v_mfma_f32_16x16x32_bf16 v[44:47], v[118:121], v[152:155], 0
s_waitcnt lgkmcnt(0)
v_mfma_f32_16x16x32_bf16 v[48:51], v[104:107], v[140:143], 0
v_mfma_f32_16x16x32_bf16 v[52:55], v[110:113], v[140:143], 0
v_mfma_f32_16x16x32_bf16 v[56:59], v[106:109], v[144:147], 0
v_mfma_f32_16x16x32_bf16 v[60:63], v[112:115], v[144:147], 0
v_mov_b32 v18, 0xff61b1e6
s_mov_b32 s34, 0x3eae1a93
v_cndmask_b32 v32, v18, v32, s[44:45]
v_cndmask_b32 v40, v18, v40, s[44:45]
s_nop 0
v_cndmask_b32 v48, v18, v48, s[60:61]
s_nop 0
v_cndmask_b32 v56, v18, v56, s[60:61]
v_cndmask_b32 v33, v18, v33, s[46:47]
v_cndmask_b32 v41, v18, v41, s[46:47]
v_cndmask_b32 v49, v18, v49, s[62:63]
v_cndmask_b32 v57, v18, v57, s[62:63]
v_cndmask_b32 v34, v18, v34, s[48:49]
v_cndmask_b32 v42, v18, v42, s[48:49]
v_cndmask_b32 v50, v18, v50, s[64:65]
v_cndmask_b32 v58, v18, v58, s[64:65]
v_cndmask_b32 v35, v18, v35, s[50:51]
v_cndmask_b32 v43, v18, v43, s[50:51]
v_cndmask_b32 v51, v18, v51, s[66:67]
v_cndmask_b32 v59, v18, v59, s[66:67]
v_cndmask_b32 v36, v18, v36, s[52:53]
v_cndmask_b32 v44, v18, v44, s[52:53]
v_cndmask_b32 v52, v18, v52, s[52:53]
v_cndmask_b32 v60, v18, v60, s[52:53]
v_cndmask_b32 v37, v18, v37, s[54:55]
v_cndmask_b32 v45, v18, v45, s[54:55]
v_cndmask_b32 v53, v18, v53, s[54:55]
v_cndmask_b32 v61, v18, v61, s[54:55]
v_cndmask_b32 v38, v18, v38, s[56:57]
v_cndmask_b32 v46, v18, v46, s[56:57]
v_cndmask_b32 v54, v18, v54, s[56:57]
v_cndmask_b32 v62, v18, v62, s[56:57]
v_cndmask_b32 v39, v18, v39, s[58:59]
v_cndmask_b32 v47, v18, v47, s[58:59]
v_cndmask_b32 v55, v18, v55, s[58:59]
v_cndmask_b32 v63, v18, v63, s[58:59]
v_max3_f32 v20, v32, v33, v34
v_max3_f32 v21, v40, v41, v42
v_max3_f32 v22, v48, v49, v50
v_max3_f32 v23, v56, v57, v58
v_max3_f32 v20, v20, v35, v36
v_max3_f32 v21, v21, v43, v44
v_max3_f32 v22, v22, v51, v52
v_max3_f32 v23, v23, v59, v60
v_max3_f32 v20, v20, v37, v38
v_max3_f32 v21, v21, v45, v46
v_max3_f32 v22, v22, v53, v54
v_max3_f32 v23, v23, v61, v62
v_max_f32 v20, v20, v39
v_max_f32 v21, v21, v47
v_max_f32 v22, v22, v55
v_max_f32 v23, v23, v63
v_mov_b32 v24, v20
v_mov_b32 v25, v21
v_mov_b32 v26, v22
v_mov_b32 v27, v23
v_permlane16_swap_b32 v20, v24
v_permlane16_swap_b32 v21, v25
v_permlane16_swap_b32 v22, v26
v_permlane16_swap_b32 v23, v27
v_max_f32 v20, v20, v24
v_max_f32 v21, v21, v25
v_max_f32 v22, v22, v26
v_max_f32 v23, v23, v27
v_mov_b32 v24, v20
v_mov_b32 v25, v21
v_mov_b32 v26, v22
v_mov_b32 v27, v23
v_permlane32_swap_b32 v20, v24
v_permlane32_swap_b32 v21, v25
v_permlane32_swap_b32 v22, v26
v_permlane32_swap_b32 v23, v27
v_max_f32 v20, v20, v24
v_max_f32 v21, v21, v25
v_max_f32 v22, v22, v26
v_max_f32 v23, v23, v27
v_mul_f32 v20, s34, v20
v_mul_f32 v21, s34, v21
v_mul_f32 v22, s34, v22
v_mul_f32 v23, s34, v23
v_fma_f32 v32, v32, s34, -v20
v_fma_f32 v40, v40, s34, -v21
v_fma_f32 v48, v48, s34, -v22
v_fma_f32 v56, v56, s34, -v23
v_exp_f32 v32, v32
v_exp_f32 v40, v40
v_exp_f32 v48, v48
v_exp_f32 v56, v56
v_fma_f32 v33, v33, s34, -v20
v_fma_f32 v41, v41, s34, -v21
v_fma_f32 v49, v49, s34, -v22
v_fma_f32 v57, v57, s34, -v23
v_exp_f32 v33, v33
v_exp_f32 v41, v41
v_exp_f32 v49, v49
v_exp_f32 v57, v57
v_fma_f32 v34, v34, s34, -v20
v_fma_f32 v42, v42, s34, -v21
v_fma_f32 v50, v50, s34, -v22
v_fma_f32 v58, v58, s34, -v23
v_exp_f32 v34, v34
v_exp_f32 v42, v42
v_exp_f32 v50, v50
v_exp_f32 v58, v58
v_fma_f32 v35, v35, s34, -v20
v_fma_f32 v43, v43, s34, -v21
v_fma_f32 v51, v51, s34, -v22
v_fma_f32 v59, v59, s34, -v23
v_exp_f32 v35, v35
v_exp_f32 v43, v43
v_exp_f32 v51, v51
v_exp_f32 v59, v59
v_fma_f32 v36, v36, s34, -v20
v_fma_f32 v44, v44, s34, -v21
v_fma_f32 v52, v52, s34, -v22
v_fma_f32 v60, v60, s34, -v23
v_exp_f32 v36, v36
v_exp_f32 v44, v44
v_exp_f32 v52, v52
v_exp_f32 v60, v60
v_fma_f32 v37, v37, s34, -v20
v_fma_f32 v45, v45, s34, -v21
v_fma_f32 v53, v53, s34, -v22
v_fma_f32 v61, v61, s34, -v23
v_exp_f32 v37, v37
v_exp_f32 v45, v45
v_exp_f32 v53, v53
v_exp_f32 v61, v61
v_fma_f32 v38, v38, s34, -v20
v_fma_f32 v46, v46, s34, -v21
v_fma_f32 v54, v54, s34, -v22
v_fma_f32 v62, v62, s34, -v23
v_exp_f32 v38, v38
v_exp_f32 v46, v46
v_exp_f32 v54, v54
v_exp_f32 v62, v62
v_fma_f32 v39, v39, s34, -v20
v_fma_f32 v47, v47, s34, -v21
v_fma_f32 v55, v55, s34, -v22
v_fma_f32 v63, v63, s34, -v23
v_exp_f32 v39, v39
v_exp_f32 v47, v47
v_exp_f32 v55, v55
v_exp_f32 v63, v63
v_add_f32 v28, v32, v33
v_add_f32 v29, v40, v41
v_add_f32 v30, v48, v49
v_add_f32 v31, v56, v57
v_add_f32 v28, v28, v34
v_add_f32 v29, v29, v42
v_add_f32 v30, v30, v50
v_add_f32 v31, v31, v58
v_add_f32 v28, v28, v35
v_add_f32 v29, v29, v43
v_add_f32 v30, v30, v51
v_add_f32 v31, v31, v59
v_add_f32 v28, v28, v36
v_add_f32 v29, v29, v44
v_add_f32 v30, v30, v52
v_add_f32 v31, v31, v60
v_add_f32 v28, v28, v37
v_add_f32 v29, v29, v45
v_add_f32 v30, v30, v53
v_add_f32 v31, v31, v61
v_add_f32 v28, v28, v38
v_add_f32 v29, v29, v46
v_add_f32 v30, v30, v54
v_add_f32 v31, v31, v62
v_add_f32 v28, v28, v39
v_add_f32 v29, v29, v47
v_add_f32 v30, v30, v55
v_add_f32 v31, v31, v63
v_mov_b32 v24, v28
v_mov_b32 v25, v29
v_mov_b32 v26, v30
v_mov_b32 v27, v31
v_permlane16_swap_b32 v28, v24
v_permlane16_swap_b32 v29, v25
v_permlane16_swap_b32 v30, v26
v_permlane16_swap_b32 v31, v27
v_add_f32 v28, v28, v24
v_add_f32 v29, v29, v25
v_add_f32 v30, v30, v26
v_add_f32 v31, v31, v27
v_mov_b32 v24, v28
v_mov_b32 v25, v29
v_mov_b32 v26, v30
v_mov_b32 v27, v31
v_permlane32_swap_b32 v28, v24
v_permlane32_swap_b32 v29, v25
v_permlane32_swap_b32 v30, v26
v_permlane32_swap_b32 v31, v27
v_add_f32 v28, v28, v24
v_add_f32 v29, v29, v25
v_add_f32 v30, v30, v26
v_add_f32 v31, v31, v27
v_rcp_f32 v28, v28
v_rcp_f32 v29, v29
v_rcp_f32 v30, v30
v_rcp_f32 v31, v31
v_mul_f32 v32, v32, v28
v_mul_f32 v40, v40, v29
v_mul_f32 v48, v48, v30
v_mul_f32 v56, v56, v31
v_mul_f32 v33, v33, v28
v_mul_f32 v41, v41, v29
v_mul_f32 v49, v49, v30
v_mul_f32 v57, v57, v31
v_mul_f32 v34, v34, v28
v_mul_f32 v42, v42, v29
v_mul_f32 v50, v50, v30
v_mul_f32 v58, v58, v31
v_mul_f32 v35, v35, v28
v_mul_f32 v43, v43, v29
v_mul_f32 v51, v51, v30
v_mul_f32 v59, v59, v31
v_mul_f32 v36, v36, v28
v_mul_f32 v44, v44, v29
v_mul_f32 v52, v52, v30
v_mul_f32 v60, v60, v31
v_mul_f32 v37, v37, v28
v_mul_f32 v45, v45, v29
v_mul_f32 v53, v53, v30
v_mul_f32 v61, v61, v31
v_mul_f32 v38, v38, v28
v_mul_f32 v46, v46, v29
v_mul_f32 v54, v54, v30
v_mul_f32 v62, v62, v31
v_mul_f32 v39, v39, v28
v_mul_f32 v47, v47, v29
v_mul_f32 v55, v55, v30
v_mul_f32 v63, v63, v31
v_cvt_pk_bf16_f32 v64, v32, v33
v_cvt_pk_bf16_f32 v65, v34, v35
v_cvt_pk_bf16_f32 v66, v36, v37
v_cvt_pk_bf16_f32 v67, v38, v39
v_cvt_pk_bf16_f32 v68, v40, v41
v_cvt_pk_bf16_f32 v69, v42, v43
v_cvt_pk_bf16_f32 v70, v44, v45
v_cvt_pk_bf16_f32 v71, v46, v47
v_cvt_pk_bf16_f32 v72, v48, v49
v_cvt_pk_bf16_f32 v73, v50, v51
v_cvt_pk_bf16_f32 v74, v52, v53
v_cvt_pk_bf16_f32 v75, v54, v55
v_cvt_pk_bf16_f32 v76, v56, v57
v_cvt_pk_bf16_f32 v77, v58, v59
v_cvt_pk_bf16_f32 v78, v60, v61
v_cvt_pk_bf16_f32 v79, v62, v63
v_mfma_f32_16x16x32_bf16 v[80:83], v[124:127], v[64:67], 0
v_mfma_f32_16x16x32_bf16 v[84:87], v[136:139], v[64:67], 0
v_mfma_f32_16x16x32_bf16 v[88:91], v[130:133], v[68:71], 0
v_mfma_f32_16x16x32_bf16 v[92:95], v[136:139], v[68:71], 0
v_mfma_f32_16x16x32_bf16 v[96:99], v[122:125], v[72:75], 0
v_mfma_f32_16x16x32_bf16 v[100:103], v[134:137], v[72:75], 0
v_mfma_f32_16x16x32_bf16 v[164:167], v[128:131], v[76:79], 0
v_mfma_f32_16x16x32_bf16 v[168:171], v[134:137], v[76:79], 0
v_lshlrev_b32 v14, 3, v12
v_mov_b32 v15, 2146435072
v_cmp_gt_u32 vcc, 16, v1
s_nop 1
v_cndmask_b32 v14, v15, v14, vcc
s_add_u32 s26, s24, s72
s_lshl_b32 s27, s21, 10
s_add_u32 s27, s27, s26
s_lshl_b32 s28, s21, 7
s_add_u32 s28, s28, 16384
s_add_u32 s28, s28, s26
s_add_u32 s30, s27, 18432
s_add_u32 s31, s28, 18432
v_cvt_pk_bf16_f32 v180, v80, v81
v_cvt_pk_bf16_f32 v181, v82, v83
v_cvt_pk_bf16_f32 v182, v88, v89
v_cvt_pk_bf16_f32 v183, v90, v91
v_cvt_pk_bf16_f32 v184, v84, v85
v_cvt_pk_bf16_f32 v185, v94, v95
buffer_store_dwordx4 v[180:183], v2, s[8:11], s30 offen sc1
buffer_store_dwordx2 v[184:185], v14, s[8:11], s31 offen sc1
v_cvt_pk_bf16_f32 v172, v96, v97
v_cvt_pk_bf16_f32 v173, v98, v99
v_cvt_pk_bf16_f32 v174, v164, v165
v_cvt_pk_bf16_f32 v175, v166, v167
v_cvt_pk_bf16_f32 v176, v100, v101
v_cvt_pk_bf16_f32 v177, v170, v171
buffer_store_dwordx4 v[172:175], v2, s[8:11], s27 offen sc1
buffer_store_dwordx2 v[176:177], v14, s[8:11], s28 offen sc1
s_lshl_b32 s26, s20, 2
s_add_u32 s26, s26, s4
s_lshl_b32 s26, s26, 4
s_add_u32 s26, s26, s21
s_lshl_b32 s26, s26, 7
s_add_u32 s26, s26, s77
s_add_u32 s26, s26, 393216
s_and_b32 s37, s6, 7
s_mul_i32 s37, s37, 92160
s_mul_i32 s38, s4, 23552
s_add_u32 s37, s37, s38
s_add_u32 s37, s37, 6557696
v_mov_b32 v13, 2146435072
v_cmp_eq_u32 vcc, 0, v1
v_mov_b32 v14, s68
v_mov_b32 v15, s69
v_cndmask_b32 v13, v13, 0, vcc
s_add_u32 m0, s38, 0
s_add_u32 s40, s37, 0
buffer_load_dwordx4 v2, s[8:11], s40 offen offset:0 sc1 lds
buffer_load_dwordx4 v2, s[8:11], s40 offen offset:1024 sc1 lds
buffer_load_dwordx4 v2, s[8:11], s40 offen offset:2048 sc1 lds
buffer_load_dwordx4 v2, s[8:11], s40 offen offset:3072 sc1 lds
s_add_u32 m0, s38, 4096
s_add_u32 s40, s37, 4096
buffer_load_dwordx4 v2, s[8:11], s40 offen offset:0 sc1 lds
buffer_load_dwordx4 v2, s[8:11], s40 offen offset:1024 sc1 lds
buffer_load_dwordx4 v2, s[8:11], s40 offen offset:2048 sc1 lds
buffer_load_dwordx4 v2, s[8:11], s40 offen offset:3072 sc1 lds
s_waitcnt vmcnt(8)
buffer_store_dwordx2 v[14:15], v13, s[8:11], s26 offen sc1
s_add_u32 m0, s38, 8192
s_add_u32 s40, s37, 8192
buffer_load_dwordx4 v2, s[8:11], s40 offen offset:0 sc1 lds
buffer_load_dwordx4 v2, s[8:11], s40 offen offset:1024 sc1 lds
buffer_load_dwordx4 v2, s[8:11], s40 offen offset:2048 sc1 lds
buffer_load_dwordx4 v2, s[8:11], s40 offen offset:3072 sc1 lds
s_add_u32 m0, s38, 12288
s_add_u32 s40, s37, 12288
buffer_load_dwordx4 v2, s[8:11], s40 offen offset:0 sc1 lds
buffer_load_dwordx4 v2, s[8:11], s40 offen offset:1024 sc1 lds
buffer_load_dwordx4 v2, s[8:11], s40 offen offset:2048 sc1 lds
buffer_load_dwordx4 v2, s[8:11], s40 offen offset:3072 sc1 lds
s_add_u32 m0, s38, 16384
s_add_u32 s40, s37, 16384
buffer_load_dwordx4 v2, s[8:11], s40 offen offset:0 sc1 lds
buffer_load_dwordx4 v2, s[8:11], s40 offen offset:1024 sc1 lds
buffer_load_dwordx4 v2, s[8:11], s40 offen offset:2048 sc1 lds
buffer_load_dwordx4 v2, s[8:11], s40 offen offset:3072 sc1 lds
s_add_u32 m0, s38, 20480
s_add_u32 s40, s37, 20480
buffer_load_dwordx4 v2, s[8:11], s40 offen offset:0 sc1 lds
buffer_load_dwordx4 v2, s[8:11], s40 offen offset:1024 sc1 lds
buffer_load_dwordx4 v2, s[8:11], s40 offen offset:2048 sc1 lds
s_lshr_b32 s20, s6, 3
s_lshl_b32 s21, s5, 2
s_add_u32 s20, s20, s21
s_lshl_b32 s20, s20, 2
s_add_u32 s20, s20, s4
s_and_b32 s21, s6, 7
s_mul_i32 s24, s20, 18432
s_add_u32 s25, s24, s72
s_mul_i32 s26, s21, 2304
s_add_u32 s26, s26, s24
s_add_u32 s27, s26, s71
v_and_b32 v6, 15, v1
v_lshrrev_b32 v7, 4, v1
v_lshlrev_b32 v8, 4, v6
v_lshl_add_u32 v8, v7, 3, v8
v_add_u32 v8, 2048, v8
v_mov_b32 v9, 2146435072
v_cmp_gt_u32 vcc, 32, v1
s_nop 1
v_cndmask_b32 v4, v9, v8, vcc
v_add_u32 v5, 0x10000, v2
s_lshr_b32 s22, s20, 1
s_lshl_b32 s22, s22, 11
s_add_u32 s22, s22, s77
s_add_u32 s22, s22, 393216
v_lshlrev_b32 v10, 7, v6
s_mul_i32 s30, s2, 7282
s_lshr_b32 s30, s30, 16
s_mul_i32 s31, s30, 9
s_sub_u32 s31, s2, s31
s_lshr_b32 s32, s30, 3
s_and_b32 s30, s30, 7
s_mul_i32 s32, s32, 9
s_add_u32 s31, s31, s32
s_lshl_b32 s30, s30, 5
s_add_u32 s30, s30, s31
s_lshl_b32 s39, s30, 7
s_add_u32 s39, s39, 1966080
s_or_b32 s30, s4, s7
s_cmp_lg_u32 s30, 0
s_cselect_b32 s39, 2146435072, s39
s_cmp_ge_u32 s2, 216
s_cselect_b32 s39, 2146435072, s39
v_lshlrev_b32 v11, 3, v6
v_lshl_add_u32 v11, v7, 8, v11
s_mov_b32 s52, 0
L_poll2:
buffer_load_dwordx2 v[14:15], v10, s[8:11], s22 offen sc1
s_add_u32 s52, s52, 1
s_waitcnt vmcnt(0)
v_cmp_ne_u64 vcc, s[68:69], v[14:15]
s_cmp_ge_u32 s52, 0x100000
s_cbranch_scc1 L_got2
s_and_b64 exec, exec, vcc
s_cbranch_execnz L_poll2
L_got2:
s_mov_b64 exec, -1
buffer_load_dwordx4 a[0:3], v2, s[8:11], s25 offen offset:0 sc1
buffer_load_dwordx4 a[4:7], v2, s[8:11], s25 offen offset:1024 sc1
buffer_load_dwordx4 a[8:11], v2, s[8:11], s25 offen offset:2048 sc1
buffer_load_dwordx4 a[12:15], v2, s[8:11], s25 offen offset:3072 sc1
s_add_u32 s25, s25, 4096
buffer_load_dwordx4 a[16:19], v2, s[8:11], s25 offen offset:0 sc1
buffer_load_dwordx4 a[20:23], v2, s[8:11], s25 offen offset:1024 sc1
buffer_load_dwordx4 a[24:27], v2, s[8:11], s25 offen offset:2048 sc1
buffer_load_dwordx4 a[28:31], v2, s[8:11], s25 offen offset:3072 sc1
s_add_u32 s25, s25, 4096
buffer_load_dwordx4 a[32:35], v2, s[8:11], s25 offen offset:0 sc1
buffer_load_dwordx4 a[36:39], v2, s[8:11], s25 offen offset:1024 sc1
buffer_load_dwordx4 a[40:43], v2, s[8:11], s25 offen offset:2048 sc1
buffer_load_dwordx4 a[44:47], v2, s[8:11], s25 offen offset:3072 sc1
s_barrier
ds_read_b128 a[216:219], v2 offset:0
ds_read_b128 a[220:223], v2 offset:5120
ds_read_b128 a[224:227], v2 offset:1024
ds_read_b128 a[228:231], v2 offset:6144
ds_read_b128 a[232:235], v2 offset:2048
ds_read_b128 a[236:239], v2 offset:7168
v_mov_b32 v13, 2146435072
v_cmp_eq_u32 vcc, 0, v1
v_mov_b32 v14, s68
v_mov_b32 v15, s69
v_cndmask_b32 v13, v13, 0, vcc
buffer_store_dwordx2 v[14:15], v13, s[8:11], s39 offen sc1
s_waitcnt vmcnt(11)
s_waitcnt lgkmcnt(4)
v_mfma_f32_16x16x32_bf16 v[32:35], a[216:219], a[0:3], 0
ds_read_b128 a[240:243], v2 offset:3072
v_mfma_f32_16x16x32_bf16 v[32:35], a[220:223], a[4:7], v[32:35]
ds_read_b128 a[244:247], v2 offset:8192
s_add_u32 s25, s25, 4096
buffer_load_dwordx4 a[48:51], v2, s[8:11], s25 offen offset:0 sc1
s_waitcnt lgkmcnt(4)
v_mfma_f32_16x16x32_bf16 v[36:39], a[224:227], a[0:3], 0
ds_read_b128 a[216:219], v2 offset:4096
v_mfma_f32_16x16x32_bf16 v[36:39], a[228:231], a[4:7], v[36:39]
ds_read_b128 a[220:223], v2 offset:9216
s_waitcnt lgkmcnt(4)
v_mfma_f32_16x16x32_bf16 v[40:43], a[232:235], a[0:3], 0
ds_read_b128 a[224:227], v2 offset:10240
v_mfma_f32_16x16x32_bf16 v[40:43], a[236:239], a[4:7], v[40:43]
ds_read_b128 a[228:231], v2 offset:15360
buffer_load_dwordx4 a[52:55], v2, s[8:11], s25 offen offset:1024 sc1
s_waitcnt lgkmcnt(4)
v_mfma_f32_16x16x32_bf16 v[44:47], a[240:243], a[0:3], 0
ds_read_b128 a[232:235], v2 offset:11264
v_mfma_f32_16x16x32_bf16 v[44:47], a[244:247], a[4:7], v[44:47]
ds_read_b128 a[236:239], v2 offset:16384
s_waitcnt lgkmcnt(4)
v_mfma_f32_16x16x32_bf16 v[48:51], a[216:219], a[0:3], 0
ds_read_b128 a[240:243], v2 offset:12288
v_mfma_f32_16x16x32_bf16 v[48:51], a[220:223], a[4:7], v[48:51]
ds_read_b128 a[244:247], v2 offset:17408
buffer_load_dwordx4 a[56:59], v2, s[8:11], s25 offen offset:2048 sc1
s_waitcnt vmcnt(12)
s_waitcnt lgkmcnt(4)
v_mfma_f32_16x16x32_bf16 v[32:35], a[224:227], a[8:11], v[32:35]
ds_read_b128 a[216:219], v2 offset:13312
v_mfma_f32_16x16x32_bf16 v[32:35], a[228:231], a[12:15], v[32:35]
ds_read_b128 a[220:223], v2 offset:18432
s_waitcnt lgkmcnt(4)
v_mfma_f32_16x16x32_bf16 v[36:39], a[232:235], a[8:11], v[36:39]
ds_read_b128 a[224:227], v2 offset:14336
v_mfma_f32_16x16x32_bf16 v[36:39], a[236:239], a[12:15], v[36:39]
ds_read_b128 a[228:231], v2 offset:19456
buffer_load_dwordx4 a[60:63], v2, s[8:11], s25 offen offset:3072 sc1
s_waitcnt lgkmcnt(4)
v_mfma_f32_16x16x32_bf16 v[40:43], a[240:243], a[8:11], v[40:43]
ds_read_b128 a[232:235], v2 offset:20480
v_mfma_f32_16x16x32_bf16 v[40:43], a[244:247], a[12:15], v[40:43]
ds_read_b128 a[236:239], v2 offset:25600
s_waitcnt lgkmcnt(4)
v_mfma_f32_16x16x32_bf16 v[44:47], a[216:219], a[8:11], v[44:47]
ds_read_b128 a[240:243], v2 offset:21504
v_mfma_f32_16x16x32_bf16 v[44:47], a[220:223], a[12:15], v[44:47]
ds_read_b128 a[244:247], v2 offset:26624
s_add_u32 s25, s25, 4096
buffer_load_dwordx2 a[64:65], v11, s[8:11], s25 offen offset:0 sc1
buffer_load_dwordx2 a[66:67], v11, s[8:11], s25 offen offset:128 sc1
s_waitcnt lgkmcnt(4)
v_mfma_f32_16x16x32_bf16 v[48:51], a[224:227], a[8:11], v[48:51]
ds_read_b128 a[216:219], v2 offset:22528
v_mfma_f32_16x16x32_bf16 v[48:51], a[228:231], a[12:15], v[48:51]
ds_read_b128 a[220:223], v2 offset:27648
s_waitcnt vmcnt(13)
s_waitcnt lgkmcnt(4)
v_mfma_f32_16x16x32_bf16 v[32:35], a[232:235], a[16:19], v[32:35]
ds_read_b128 a[224:227], v2 offset:23552
v_mfma_f32_16x16x32_bf16 v[32:35], a[236:239], a[20:23], v[32:35]
ds_read_b128 a[228:231], v2 offset:28672
buffer_load_dwordx2 a[68:69], v11, s[8:11], s25 offen offset:1024 sc1
buffer_load_dwordx2 a[70:71], v11, s[8:11], s25 offen offset:1152 sc1
s_waitcnt lgkmcnt(4)
v_mfma_f32_16x16x32_bf16 v[36:39], a[240:243], a[16:19], v[36:39]
ds_read_b128 a[232:235], v2 offset:24576
v_mfma_f32_16x16x32_bf16 v[36:39], a[244:247], a[20:23], v[36:39]
ds_read_b128 a[236:239], v2 offset:29696
s_waitcnt lgkmcnt(4)
v_mfma_f32_16x16x32_bf16 v[40:43], a[216:219], a[16:19], v[40:43]
ds_read_b128 a[240:243], v2 offset:30720
v_mfma_f32_16x16x32_bf16 v[40:43], a[220:223], a[20:23], v[40:43]
ds_read_b128 a[244:247], v2 offset:35840
buffer_load_dwordx4 v[56:59], v2, s[8:11], s27 offen sc1
s_waitcnt lgkmcnt(4)
v_mfma_f32_16x16x32_bf16 v[44:47], a[224:227], a[16:19], v[44:47]
ds_read_b128 a[216:219], v2 offset:31744
v_mfma_f32_16x16x32_bf16 v[44:47], a[228:231], a[20:23], v[44:47]
ds_read_b128 a[220:223], v2 offset:36864
s_waitcnt lgkmcnt(4)
v_mfma_f32_16x16x32_bf16 v[48:51], a[232:235], a[16:19], v[48:51]
ds_read_b128 a[224:227], v2 offset:32768
v_mfma_f32_16x16x32_bf16 v[48:51], a[236:239], a[20:23], v[48:51]
ds_read_b128 a[228:231], v2 offset:37888
buffer_load_dwordx4 v[60:63], v2, s[8:11], s27 offen offset:1024 sc1
s_waitcnt vmcnt(15)
s_waitcnt lgkmcnt(4)
v_mfma_f32_16x16x32_bf16 v[32:35], a[240:243], a[24:27], v[32:35]
ds_read_b128 a[232:235], v2 offset:33792
v_mfma_f32_16x16x32_bf16 v[32:35], a[244:247], a[28:31], v[32:35]
ds_read_b128 a[236:239], v2 offset:38912
s_waitcnt lgkmcnt(4)
v_mfma_f32_16x16x32_bf16 v[36:39], a[216:219], a[24:27], v[36:39]
ds_read_b128 a[240:243], v2 offset:34816
v_mfma_f32_16x16x32_bf16 v[36:39], a[220:223], a[28:31], v[36:39]
ds_read_b128 a[244:247], v2 offset:39936
buffer_load_dwordx2 v[64:65], v4, s[8:11], s27 offen sc1
s_waitcnt lgkmcnt(4)
v_mfma_f32_16x16x32_bf16 v[40:43], a[224:227], a[24:27], v[40:43]
ds_read_b128 a[216:219], v2 offset:40960
v_mfma_f32_16x16x32_bf16 v[40:43], a[228:231], a[28:31], v[40:43]
ds_read_b128 a[220:223], v2 offset:46080
s_waitcnt lgkmcnt(4)
v_mfma_f32_16x16x32_bf16 v[44:47], a[232:235], a[24:27], v[44:47]
ds_read_b128 a[224:227], v2 offset:41984
v_mfma_f32_16x16x32_bf16 v[44:47], a[236:239], a[28:31], v[44:47]
ds_read_b128 a[228:231], v2 offset:47104
s_waitcnt lgkmcnt(4)
v_mfma_f32_16x16x32_bf16 v[48:51], a[240:243], a[24:27], v[48:51]
ds_read_b128 a[232:235], v2 offset:43008
v_mfma_f32_16x16x32_bf16 v[48:51], a[244:247], a[28:31], v[48:51]
ds_read_b128 a[236:239], v2 offset:48128
s_waitcnt vmcnt(14)
s_waitcnt lgkmcnt(4)
v_mfma_f32_16x16x32_bf16 v[32:35], a[216:219], a[32:35], v[32:35]
ds_read_b128 a[240:243], v2 offset:44032
v_mfma_f32_16x16x32_bf16 v[32:35], a[220:223], a[36:39], v[32:35]
ds_read_b128 a[244:247], v2 offset:49152
s_waitcnt lgkmcnt(4)
v_mfma_f32_16x16x32_bf16 v[36:39], a[224:227], a[32:35], v[36:39]
ds_read_b128 a[216:219], v2 offset:45056
v_mfma_f32_16x16x32_bf16 v[36:39], a[228:231], a[36:39], v[36:39]
ds_read_b128 a[220:223], v2 offset:50176
s_waitcnt lgkmcnt(4)
v_mfma_f32_16x16x32_bf16 v[40:43], a[232:235], a[32:35], v[40:43]
ds_read_b128 a[224:227], v2 offset:51200
v_mfma_f32_16x16x32_bf16 v[40:43], a[236:239], a[36:39], v[40:43]
ds_read_b128 a[228:231], v2 offset:56320
s_waitcnt lgkmcnt(4)
v_mfma_f32_16x16x32_bf16 v[44:47], a[240:243], a[32:35], v[44:47]
ds_read_b128 a[232:235], v2 offset:52224
v_mfma_f32_16x16x32_bf16 v[44:47], a[244:247], a[36:39], v[44:47]
ds_read_b128 a[236:239], v2 offset:57344
s_waitcnt lgkmcnt(4)
v_mfma_f32_16x16x32_bf16 v[48:51], a[216:219], a[32:35], v[48:51]
ds_read_b128 a[240:243], v2 offset:53248
v_mfma_f32_16x16x32_bf16 v[48:51], a[220:223], a[36:39], v[48:51]
ds_read_b128 a[244:247], v2 offset:58368
s_waitcnt vmcnt(12)
s_waitcnt lgkmcnt(4)
v_mfma_f32_16x16x32_bf16 v[32:35], a[224:227], a[40:43], v[32:35]
ds_read_b128 a[216:219], v2 offset:54272
v_mfma_f32_16x16x32_bf16 v[32:35], a[228:231], a[44:47], v[32:35]
ds_read_b128 a[220:223], v2 offset:59392
s_waitcnt lgkmcnt(4)
v_mfma_f32_16x16x32_bf16 v[36:39], a[232:235], a[40:43], v[36:39]
ds_read_b128 a[224:227], v2 offset:55296
v_mfma_f32_16x16x32_bf16 v[36:39], a[236:239], a[44:47], v[36:39]
ds_read_b128 a[228:231], v2 offset:60416
s_waitcnt lgkmcnt(4)
v_mfma_f32_16x16x32_bf16 v[40:43], a[240:243], a[40:43], v[40:43]
ds_read_b128 a[232:235], v2 offset:61440
v_mfma_f32_16x16x32_bf16 v[40:43], a[244:247], a[44:47], v[40:43]
ds_read_b128 a[236:239], v5 offset:1024
s_waitcnt lgkmcnt(4)
v_mfma_f32_16x16x32_bf16 v[44:47], a[216:219], a[40:43], v[44:47]
ds_read_b128 a[240:243], v2 offset:62464
v_mfma_f32_16x16x32_bf16 v[44:47], a[220:223], a[44:47], v[44:47]
ds_read_b128 a[244:247], v5 offset:2048
s_waitcnt lgkmcnt(4)
v_mfma_f32_16x16x32_bf16 v[48:51], a[224:227], a[40:43], v[48:51]
ds_read_b128 a[216:219], v2 offset:63488
v_mfma_f32_16x16x32_bf16 v[48:51], a[228:231], a[44:47], v[48:51]
ds_read_b128 a[220:223], v5 offset:3072
s_waitcnt vmcnt(9)
s_waitcnt lgkmcnt(4)
v_mfma_f32_16x16x32_bf16 v[32:35], a[232:235], a[48:51], v[32:35]
ds_read_b128 a[224:227], v2 offset:64512
v_mfma_f32_16x16x32_bf16 v[32:35], a[236:239], a[52:55], v[32:35]
ds_read_b128 a[228:231], v5 offset:4096
s_waitcnt lgkmcnt(4)
v_mfma_f32_16x16x32_bf16 v[36:39], a[240:243], a[48:51], v[36:39]
ds_read_b128 a[232:235], v5 offset:0
v_mfma_f32_16x16x32_bf16 v[36:39], a[244:247], a[52:55], v[36:39]
ds_read_b128 a[236:239], v5 offset:5120
s_waitcnt lgkmcnt(4)
v_mfma_f32_16x16x32_bf16 v[40:43], a[216:219], a[48:51], v[40:43]
ds_read_b128 a[240:243], v5 offset:6144
v_mfma_f32_16x16x32_bf16 v[40:43], a[220:223], a[52:55], v[40:43]
ds_read_b128 a[244:247], v5 offset:11264
s_waitcnt lgkmcnt(4)
v_mfma_f32_16x16x32_bf16 v[44:47], a[224:227], a[48:51], v[44:47]
ds_read_b128 a[216:219], v5 offset:7168
v_mfma_f32_16x16x32_bf16 v[44:47], a[228:231], a[52:55], v[44:47]
ds_read_b128 a[220:223], v5 offset:12288
s_waitcnt lgkmcnt(4)
v_mfma_f32_16x16x32_bf16 v[48:51], a[232:235], a[48:51], v[48:51]
ds_read_b128 a[224:227], v5 offset:8192
v_mfma_f32_16x16x32_bf16 v[48:51], a[236:239], a[52:55], v[48:51]
ds_read_b128 a[228:231], v5 offset:13312
s_waitcnt vmcnt(7)
s_waitcnt lgkmcnt(4)
v_mfma_f32_16x16x32_bf16 v[32:35], a[240:243], a[56:59], v[32:35]
ds_read_b128 a[232:235], v5 offset:9216
v_mfma_f32_16x16x32_bf16 v[32:35], a[244:247], a[60:63], v[32:35]
ds_read_b128 a[236:239], v5 offset:14336
s_waitcnt lgkmcnt(4)
v_mfma_f32_16x16x32_bf16 v[36:39], a[216:219], a[56:59], v[36:39]
ds_read_b128 a[240:243], v5 offset:10240
v_mfma_f32_16x16x32_bf16 v[36:39], a[220:223], a[60:63], v[36:39]
ds_read_b128 a[244:247], v5 offset:15360
s_waitcnt lgkmcnt(4)
v_mfma_f32_16x16x32_bf16 v[40:43], a[224:227], a[56:59], v[40:43]
ds_read_b128 a[216:219], v5 offset:16384
v_mfma_f32_16x16x32_bf16 v[40:43], a[228:231], a[60:63], v[40:43]
ds_read_b128 a[220:223], v5 offset:21504
s_waitcnt lgkmcnt(4)
v_mfma_f32_16x16x32_bf16 v[44:47], a[232:235], a[56:59], v[44:47]
ds_read_b128 a[224:227], v5 offset:17408
v_mfma_f32_16x16x32_bf16 v[44:47], a[236:239], a[60:63], v[44:47]
ds_read_b128 a[228:231], v5 offset:22528
s_waitcnt lgkmcnt(4)
v_mfma_f32_16x16x32_bf16 v[48:51], a[240:243], a[56:59], v[48:51]
ds_read_b128 a[232:235], v5 offset:18432
v_mfma_f32_16x16x32_bf16 v[48:51], a[244:247], a[60:63], v[48:51]
ds_read_b128 a[236:239], v5 offset:23552
s_waitcnt vmcnt(3)
s_waitcnt lgkmcnt(4)
v_mfma_f32_16x16x32_bf16 v[32:35], a[216:219], a[64:67], v[32:35]
ds_read_b128 a[240:243], v5 offset:19456
v_mfma_f32_16x16x32_bf16 v[32:35], a[220:223], a[68:71], v[32:35]
ds_read_b128 a[244:247], v5 offset:24576
s_waitcnt lgkmcnt(4)
v_mfma_f32_16x16x32_bf16 v[36:39], a[224:227], a[64:67], v[36:39]
ds_read_b128 a[216:219], v5 offset:20480
v_mfma_f32_16x16x32_bf16 v[36:39], a[228:231], a[68:71], v[36:39]
ds_read_b128 a[220:223], v5 offset:25600
s_waitcnt lgkmcnt(4)
v_mfma_f32_16x16x32_bf16 v[40:43], a[232:235], a[64:67], v[40:43]
v_mfma_f32_16x16x32_bf16 v[40:43], a[236:239], a[68:71], v[40:43]
s_waitcnt lgkmcnt(2)
v_mfma_f32_16x16x32_bf16 v[44:47], a[240:243], a[64:67], v[44:47]
v_mfma_f32_16x16x32_bf16 v[44:47], a[244:247], a[68:71], v[44:47]
s_waitcnt lgkmcnt(0)
v_mfma_f32_16x16x32_bf16 v[48:51], a[216:219], a[64:67], v[48:51]
v_mfma_f32_16x16x32_bf16 v[48:51], a[220:223], a[68:71], v[48:51]
s_waitcnt vmcnt(0)
v_lshlrev_b32 v68, 16, v56
v_and_b32 v69, 0xffff0000, v56
v_add_f32 v32, v32, v68
v_add_f32 v33, v33, v69
v_lshlrev_b32 v70, 16, v57
v_and_b32 v71, 0xffff0000, v57
v_add_f32 v34, v34, v70
v_add_f32 v35, v35, v71
v_lshlrev_b32 v72, 16, v58
v_and_b32 v73, 0xffff0000, v58
v_add_f32 v36, v36, v72
v_add_f32 v37, v37, v73
v_lshlrev_b32 v74, 16, v59
v_and_b32 v75, 0xffff0000, v59
v_add_f32 v38, v38, v74
v_add_f32 v39, v39, v75
v_lshlrev_b32 v68, 16, v60
v_and_b32 v69, 0xffff0000, v60
v_add_f32 v40, v40, v68
v_add_f32 v41, v41, v69
v_lshlrev_b32 v70, 16, v61
v_and_b32 v71, 0xffff0000, v61
v_add_f32 v42, v42, v70
v_add_f32 v43, v43, v71
v_lshlrev_b32 v72, 16, v62
v_and_b32 v73, 0xffff0000, v62
v_add_f32 v44, v44, v72
v_add_f32 v45, v45, v73
v_lshlrev_b32 v74, 16, v63
v_and_b32 v75, 0xffff0000, v63
v_add_f32 v46, v46, v74
v_add_f32 v47, v47, v75
v_lshlrev_b32 v68, 16, v64
v_and_b32 v69, 0xffff0000, v64
v_add_f32 v48, v48, v68
v_add_f32 v49, v49, v69
v_lshlrev_b32 v70, 16, v65
v_and_b32 v71, 0xffff0000, v65
v_add_f32 v50, v50, v70
v_add_f32 v51, v51, v71
v_cvt_pk_bf16_f32 v80, v32, v33
v_cvt_pk_bf16_f32 v81, v34, v35
v_cvt_pk_bf16_f32 v82, v36, v37
v_cvt_pk_bf16_f32 v83, v38, v39
v_cvt_pk_bf16_f32 v84, v40, v41
v_cvt_pk_bf16_f32 v85, v42, v43
v_cvt_pk_bf16_f32 v86, v44, v45
v_cvt_pk_bf16_f32 v87, v46, v47
v_cvt_pk_bf16_f32 v88, v48, v49
v_cvt_pk_bf16_f32 v89, v50, v51
s_add_u32 s27, s26, s73
buffer_store_dwordx4 v[80:83], v2, s[8:11], s27 offen sc1
buffer_store_dwordx4 v[84:87], v2, s[8:11], s27 offen offset:1024 sc1
buffer_store_dwordx2 v[88:89], v4, s[8:11], s27 offen sc1
v_add_f32 v10, v32, v33
v_mul_f32 v11, v32, v32
v_mul_f32 v13, v33, v33
v_mov_b32 v12, 0
v_add_f32 v10, v10, v34
v_add_f32 v12, v12, v35
v_fmac_f32 v11, v34, v34
v_fmac_f32 v13, v35, v35
v_add_f32 v10, v10, v36
v_add_f32 v12, v12, v37
v_fmac_f32 v11, v36, v36
v_fmac_f32 v13, v37, v37
v_add_f32 v10, v10, v38
v_add_f32 v12, v12, v39
v_fmac_f32 v11, v38, v38
v_fmac_f32 v13, v39, v39
v_add_f32 v10, v10, v40
v_add_f32 v12, v12, v41
v_fmac_f32 v11, v40, v40
v_fmac_f32 v13, v41, v41
v_add_f32 v10, v10, v42
v_add_f32 v12, v12, v43
v_fmac_f32 v11, v42, v42
v_fmac_f32 v13, v43, v43
v_add_f32 v10, v10, v44
v_add_f32 v12, v12, v45
v_fmac_f32 v11, v44, v44
v_fmac_f32 v13, v45, v45
v_add_f32 v10, v10, v46
v_add_f32 v12, v12, v47
v_fmac_f32 v11, v46, v46
v_fmac_f32 v13, v47, v47
v_add_f32 v10, v10, v48
v_add_f32 v12, v12, v49
v_fmac_f32 v11, v48, v48
v_fmac_f32 v13, v49, v49
v_add_f32 v10, v10, v50
v_add_f32 v12, v12, v51
v_fmac_f32 v11, v50, v50
v_fmac_f32 v13, v51, v51
v_add_f32 v10, v10, v12
v_add_f32 v11, v11, v13
v_mov_b32 v12, v10
v_mov_b32 v13, v11
s_nop 0
v_permlane16_swap_b32 v10, v12
v_permlane16_swap_b32 v11, v13
v_add_f32 v10, v10, v12
v_add_f32 v11, v11, v13
v_mov_b32 v12, v10
v_mov_b32 v13, v11
s_nop 0
v_permlane32_swap_b32 v10, v12
v_permlane32_swap_b32 v11, v13
v_add_f32 v10, v10, v12
v_add_f32 v11, v11, v13
v_lshlrev_b32 v8, 3, v6
v_cmp_gt_u32 vcc, 16, v1
s_nop 1
v_cndmask_b32 v8, v9, v8, vcc
s_lshl_b32 s27, s20, 10
s_lshl_b32 s28, s21, 7
s_add_u32 s27, s27, s28
s_add_u32 s27, s27, s74
buffer_store_dwordx2 v[10:11], v8, s[8:11], s27 offen sc1
s_lshr_b32 s27, s20, 2
s_lshl_b32 s27, s27, 3
s_add_u32 s27, s27, s21
s_lshl_b32 s27, s27, 2
s_add_u32 s27, s27, s4
s_lshl_b32 s27, s27, 7
s_add_u32 s27, s27, s77
s_add_u32 s27, s27, 524288
v_mov_b32 v13, 2146435072
v_cmp_eq_u32 vcc, 0, v1
v_mov_b32 v14, s68
v_mov_b32 v15, s69
v_cndmask_b32 v13, v13, 0, vcc
s_waitcnt vmcnt(0)
buffer_store_dwordx2 v[14:15], v13, s[8:11], s27 offen sc1
s_barrier
s_lshr_b32 s40, s6, 2
s_lshl_b32 s41, s5, 2
s_and_b32 s42, s6, 3
s_add_u32 s41, s41, s42
s_lshr_b32 s42, s41, 2
s_and_b32 s43, s41, 3
s_mul_i32 s22, s4, 6144
s_mul_i32 s21, s41, 497664
s_add_u32 s21, s21, s22
s_add_u32 s21, s21, 7303168
v_add_u32 v3, s21, v2
s_cmp_eq_u32 s7, 0
s_cbranch_scc0 L_f_packed
s_lshl_b32 s47, s42, 12
s_add_u32 s47, s47, 1966080
v_min_u32 v16, 26, v1
v_lshlrev_b32 v16, 7, v16
s_mov_b32 s52, 0
L_poll3:
buffer_load_dwordx2 v[14:15], v16, s[8:11], s47 offen sc1
s_add_u32 s52, s52, 1
s_waitcnt vmcnt(0)
v_cmp_ne_u64 vcc, s[68:69], v[14:15]
s_cmp_ge_u32 s52, 0x100000
s_cbranch_scc1 L_got3
s_and_b64 exec, exec, vcc
s_cbranch_execnz L_poll3
L_got3:
s_mov_b64 exec, -1
L_f_packed:
s_add_u32 m0, s22, 0
s_nop 0
buffer_load_dwordx4 v3, s[8:11], 0 offen offset:0 sc1 lds
buffer_load_dwordx4 v3, s[8:11], 0 offen offset:1024 sc1 lds
buffer_load_dwordx4 v3, s[8:11], 0 offen offset:2048 sc1 lds
buffer_load_dwordx4 v3, s[8:11], 0 offen offset:3072 sc1 lds
s_add_u32 m0, s22, 4096
v_add_u32 v3, 4096, v3
buffer_load_dwordx4 v3, s[8:11], 0 offen offset:0 sc1 lds
buffer_load_dwordx4 v3, s[8:11], 0 offen offset:1024 sc1 lds
s_add_u32 m0, s22, 24576
v_add_u32 v3, 20480, v3
buffer_load_dwordx4 v3, s[8:11], 0 offen offset:0 sc1 lds
buffer_load_dwordx4 v3, s[8:11], 0 offen offset:1024 sc1 lds
buffer_load_dwordx4 v3, s[8:11], 0 offen offset:2048 sc1 lds
buffer_load_dwordx4 v3, s[8:11], 0 offen offset:3072 sc1 lds
s_add_u32 m0, s22, 28672
v_add_u32 v3, 4096, v3
buffer_load_dwordx4 v3, s[8:11], 0 offen offset:0 sc1 lds
buffer_load_dwordx4 v3, s[8:11], 0 offen offset:1024 sc1 lds
s_add_u32 m0, s22, 49152
v_add_u32 v3, 20480, v3
buffer_load_dwordx4 v3, s[8:11], 0 offen offset:0 sc1 lds
buffer_load_dwordx4 v3, s[8:11], 0 offen offset:1024 sc1 lds
buffer_load_dwordx4 v3, s[8:11], 0 offen offset:2048 sc1 lds
buffer_load_dwordx4 v3, s[8:11], 0 offen offset:3072 sc1 lds
s_add_u32 m0, s22, 53248
v_add_u32 v3, 4096, v3
buffer_load_dwordx4 v3, s[8:11], 0 offen offset:0 sc1 lds
buffer_load_dwordx4 v3, s[8:11], 0 offen offset:1024 sc1 lds
s_add_u32 m0, s22, 73728
v_add_u32 v3, 20480, v3
buffer_load_dwordx4 v3, s[8:11], 0 offen offset:0 sc1 lds
buffer_load_dwordx4 v3, s[8:11], 0 offen offset:1024 sc1 lds
buffer_load_dwordx4 v3, s[8:11], 0 offen offset:2048 sc1 lds
buffer_load_dwordx4 v3, s[8:11], 0 offen offset:3072 sc1 lds
s_add_u32 m0, s22, 77824
v_add_u32 v3, 4096, v3
buffer_load_dwordx4 v3, s[8:11], 0 offen offset:0 sc1 lds
buffer_load_dwordx4 v3, s[8:11], 0 offen offset:1024 sc1 lds
s_lshl_b32 s44, s40, 4
s_lshl_b32 s45, s4, 2
s_add_u32 s44, s44, s45
s_mul_i32 s46, s44, 18432
s_add_u32 s20, s46, s73
v_add_u32 v4, 18432, v2
v_add_u32 v5, 36864, v2
v_add_u32 v6, 55296, v2
v_lshlrev_b32 v244, 3, v1
v_add_u32 v245, 18432, v244
v_add_u32 v246, 36864, v244
v_add_u32 v247, 55296, v244
v_and_b32 v13, 15, v1
v_lshrrev_b32 v14, 4, v1
v_add_u32 v7, 0x10000, v2
v_add_u32 v8, 0x20000, v2
v_and_b32 v9, 1, v14
v_mul_u32_u24 v9, 18432, v9
v_lshrrev_b32 v15, 1, v14
v_lshlrev_b32 v15, 8, v15
v_lshl_add_u32 v15, v13, 4, v15
v_add_u32 v9, v9, v15
v_and_b32 v11, 3, v1
v_lshlrev_b32 v11, 7, v11
s_lshl_b32 s49, s43, 7
v_mov_b32 v10, 2146435072
v_mov_b32 v15, s49
v_cmp_eq_u32 vcc, 0, v1
s_nop 1
v_cndmask_b32 v10, v10, v15, vcc
s_lshl_b32 s49, s40, 3
s_add_u32 s49, s49, s42
s_lshl_b32 s50, s49, 2
s_add_u32 s50, s50, s4
s_lshl_b32 s50, s50, 9
s_add_u32 s34, s50, s77
s_add_u32 s34, s34, 0
s_lshl_b32 s49, s49, 4
s_add_u32 s49, s49, s45
s_mul_i32 s49, s49, 18432
s_add_u32 s49, s49, s75
s_add_u32 s50, s43, 0
s_and_b32 s50, s50, 3
s_mul_i32 s50, s50, 9
s_add_u32 s50, s50, 1
s_lshr_b32 s50, s50, 1
s_lshl_b32 s50, s50, 10
s_add_u32 s24, s49, s50
s_add_u32 s50, s43, 1
s_and_b32 s50, s50, 3
s_mul_i32 s50, s50, 9
s_add_u32 s50, s50, 1
s_lshr_b32 s50, s50, 1
s_lshl_b32 s50, s50, 10
s_add_u32 s25, s49, s50
s_add_u32 s50, s43, 2
s_and_b32 s50, s50, 3
s_mul_i32 s50, s50, 9
s_add_u32 s50, s50, 1
s_lshr_b32 s50, s50, 1
s_lshl_b32 s50, s50, 10
s_add_u32 s26, s49, s50
s_add_u32 s50, s43, 3
s_and_b32 s50, s50, 3
s_mul_i32 s50, s50, 9
s_add_u32 s50, s50, 1
s_lshr_b32 s50, s50, 1
s_lshl_b32 s50, s50, 10
s_add_u32 s27, s49, s50
s_add_u32 s28, s49, 4096
s_add_u32 s29, s49, 13312
s_cmp_ge_u32 s43, 2
s_cselect_b32 s50, s29, s28
s_and_b32 s51, s43, 1
s_lshl_b32 s51, s51, 9
s_add_u32 s30, s50, s51
s_mul_i32 s50, s42, 2359296
s_add_u32 s50, s50, s46
s_add_u32 s50, s50, s76
s_lshl_b32 s51, s43, 12
s_add_u32 s31, s50, s51
s_lshl_b32 s51, s43, 9
s_add_u32 s50, s50, s51
s_add_u32 s32, s50, 16384
s_add_u32 s33, s32, 36864
s_add_u32 s36, s31, 0
s_add_u32 s37, s31, 18432
s_add_u32 s38, s31, 36864
s_add_u32 s39, s31, 55296
v_lshlrev_b32 v252, 4, v13
v_lshl_add_u32 v252, v14, 9, v252
s_lshl_b32 s35, s40, 2
s_add_u32 s35, s35, s4
s_lshl_b32 s35, s35, 5
s_add_u32 s35, s35, s41
s_lshl_b32 s35, s35, 7
s_add_u32 s35, s35, s77
s_add_u32 s35, s35, 655360
v_lshlrev_b32 v17, 3, v13
v_lshl_add_u32 v17, v14, 8, v17
s_lshl_b32 s47, s44, 10
s_add_u32 s47, s47, s74
s_lshl_b32 s49, s44, 10
s_add_u32 s49, s49, s77
s_add_u32 s49, s49, 524288
v_and_b32 v16, 31, v1
v_lshlrev_b32 v16, 7, v16
s_mov_b32 s52, 0
L_poll4:
buffer_load_dwordx2 v[14:15], v16, s[8:11], s49 offen sc1
s_add_u32 s52, s52, 1
s_waitcnt vmcnt(0)
v_cmp_ne_u64 vcc, s[68:69], v[14:15]
s_cmp_ge_u32 s52, 0x100000
s_cbranch_scc1 L_got4
s_and_b64 exec, exec, vcc
s_cbranch_execnz L_poll4
L_got4:
s_mov_b64 exec, -1
s_add_u32 s48, s20, 0
buffer_load_dwordx4 a[0:3], v2, s[8:11], s48 offen offset:0 sc1
buffer_load_dwordx4 a[4:7], v4, s[8:11], s48 offen offset:0 sc1
buffer_load_dwordx4 a[8:11], v5, s[8:11], s48 offen offset:0 sc1
buffer_load_dwordx4 a[12:15], v6, s[8:11], s48 offen offset:0 sc1
buffer_load_dwordx4 a[16:19], v2, s[8:11], s48 offen offset:1024 sc1
buffer_load_dwordx4 a[20:23], v4, s[8:11], s48 offen offset:1024 sc1
buffer_load_dwordx4 a[24:27], v5, s[8:11], s48 offen offset:1024 sc1
buffer_load_dwordx4 a[28:31], v6, s[8:11], s48 offen offset:1024 sc1
buffer_load_dwordx2 v[144:145], v17, s[8:11], s47 offen offset:0 sc1
buffer_load_dwordx2 v[146:147], v17, s[8:11], s47 offen offset:128 sc1
buffer_load_dwordx2 v[148:149], v17, s[8:11], s47 offen offset:1024 sc1
buffer_load_dwordx2 v[150:151], v17, s[8:11], s47 offen offset:1152 sc1
buffer_load_dwordx2 v[152:153], v17, s[8:11], s47 offen offset:2048 sc1
buffer_load_dwordx2 v[154:155], v17, s[8:11], s47 offen offset:2176 sc1
buffer_load_dwordx2 v[156:157], v17, s[8:11], s47 offen offset:3072 sc1
buffer_load_dwordx2 v[158:159], v17, s[8:11], s47 offen offset:3200 sc1
buffer_load_dwordx4 a[32:35], v2, s[8:11], s48 offen offset:2048 sc1
buffer_load_dwordx4 a[36:39], v4, s[8:11], s48 offen offset:2048 sc1
buffer_load_dwordx4 a[40:43], v5, s[8:11], s48 offen offset:2048 sc1
buffer_load_dwordx4 a[44:47], v6, s[8:11], s48 offen offset:2048 sc1
buffer_load_dwordx4 a[48:51], v2, s[8:11], s48 offen offset:3072 sc1
buffer_load_dwordx4 a[52:55], v4, s[8:11], s48 offen offset:3072 sc1
buffer_load_dwordx4 a[56:59], v5, s[8:11], s48 offen offset:3072 sc1
buffer_load_dwordx4 a[60:63], v6, s[8:11], s48 offen offset:3072 sc1
s_add_u32 s48, s20, 4096
buffer_load_dwordx4 a[64:67], v2, s[8:11], s48 offen offset:0 sc1
buffer_load_dwordx4 a[68:71], v4, s[8:11], s48 offen offset:0 sc1
buffer_load_dwordx4 a[72:75], v5, s[8:11], s48 offen offset:0 sc1
buffer_load_dwordx4 a[76:79], v6, s[8:11], s48 offen offset:0 sc1
s_barrier
ds_read_b128 v[48:51], v2 offset:0
ds_read_b128 v[52:55], v2 offset:1024
ds_read_b128 v[56:59], v2 offset:2048
ds_read_b128 v[60:63], v2 offset:3072
ds_read_b128 v[64:67], v2 offset:4096
ds_read_b128 v[68:71], v2 offset:5120
s_waitcnt vmcnt(20)
s_waitcnt lgkmcnt(4)
v_mfma_f32_16x16x32_bf16 v[80:83], v[48:51], a[0:3], 0
buffer_load_dwordx4 a[80:83], v2, s[8:11], s48 offen offset:1024 sc1
v_mfma_f32_16x16x32_bf16 v[80:83], v[52:55], a[16:19], v[80:83]
v_mfma_f32_16x16x32_bf16 v[84:87], v[48:51], a[4:7], 0
ds_read_b128 v[72:75], v2 offset:6144
v_mfma_f32_16x16x32_bf16 v[84:87], v[52:55], a[20:23], v[84:87]
v_mfma_f32_16x16x32_bf16 v[88:91], v[48:51], a[8:11], 0
buffer_load_dwordx4 a[84:87], v4, s[8:11], s48 offen offset:1024 sc1
v_mfma_f32_16x16x32_bf16 v[88:91], v[52:55], a[24:27], v[88:91]
ds_read_b128 v[76:79], v2 offset:7168
v_mfma_f32_16x16x32_bf16 v[92:95], v[48:51], a[12:15], 0
v_mfma_f32_16x16x32_bf16 v[92:95], v[52:55], a[28:31], v[92:95]
s_waitcnt lgkmcnt(4)
v_mfma_f32_16x16x32_bf16 v[96:99], v[56:59], a[0:3], 0
buffer_load_dwordx4 a[88:91], v5, s[8:11], s48 offen offset:1024 sc1
v_mfma_f32_16x16x32_bf16 v[96:99], v[60:63], a[16:19], v[96:99]
v_mfma_f32_16x16x32_bf16 v[100:103], v[56:59], a[4:7], 0
ds_read_b128 v[48:51], v2 offset:8192
v_mfma_f32_16x16x32_bf16 v[100:103], v[60:63], a[20:23], v[100:103]
v_mfma_f32_16x16x32_bf16 v[104:107], v[56:59], a[8:11], 0
buffer_load_dwordx4 a[92:95], v6, s[8:11], s48 offen offset:1024 sc1
v_mfma_f32_16x16x32_bf16 v[104:107], v[60:63], a[24:27], v[104:107]
ds_read_b128 v[52:55], v2 offset:9216
v_mfma_f32_16x16x32_bf16 v[108:111], v[56:59], a[12:15], 0
v_mfma_f32_16x16x32_bf16 v[108:111], v[60:63], a[28:31], v[108:111]
s_waitcnt lgkmcnt(4)
v_mfma_f32_16x16x32_bf16 v[112:115], v[64:67], a[0:3], 0
buffer_load_dwordx4 a[96:99], v2, s[8:11], s48 offen offset:2048 sc1
v_mfma_f32_16x16x32_bf16 v[112:115], v[68:71], a[16:19], v[112:115]
v_mfma_f32_16x16x32_bf16 v[116:119], v[64:67], a[4:7], 0
ds_read_b128 v[56:59], v2 offset:10240
v_mfma_f32_16x16x32_bf16 v[116:119], v[68:71], a[20:23], v[116:119]
v_mfma_f32_16x16x32_bf16 v[120:123], v[64:67], a[8:11], 0
buffer_load_dwordx4 a[100:103], v4, s[8:11], s48 offen offset:2048 sc1
v_mfma_f32_16x16x32_bf16 v[120:123], v[68:71], a[24:27], v[120:123]
ds_read_b128 v[60:63], v2 offset:11264
v_mfma_f32_16x16x32_bf16 v[124:127], v[64:67], a[12:15], 0
v_mfma_f32_16x16x32_bf16 v[124:127], v[68:71], a[28:31], v[124:127]
s_waitcnt lgkmcnt(4)
v_mfma_f32_16x16x32_bf16 v[128:131], v[72:75], a[0:3], 0
buffer_load_dwordx4 a[104:107], v5, s[8:11], s48 offen offset:2048 sc1
v_mfma_f32_16x16x32_bf16 v[128:131], v[76:79], a[16:19], v[128:131]
v_mfma_f32_16x16x32_bf16 v[132:135], v[72:75], a[4:7], 0
ds_read_b128 v[64:67], v2 offset:12288
v_mfma_f32_16x16x32_bf16 v[132:135], v[76:79], a[20:23], v[132:135]
v_mfma_f32_16x16x32_bf16 v[136:139], v[72:75], a[8:11], 0
buffer_load_dwordx4 a[108:111], v6, s[8:11], s48 offen offset:2048 sc1
v_mfma_f32_16x16x32_bf16 v[136:139], v[76:79], a[24:27], v[136:139]
ds_read_b128 v[68:71], v2 offset:13312
v_mfma_f32_16x16x32_bf16 v[140:143], v[72:75], a[12:15], 0
v_mfma_f32_16x16x32_bf16 v[140:143], v[76:79], a[28:31], v[140:143]
s_waitcnt vmcnt(12)
s_waitcnt lgkmcnt(4)
v_mfma_f32_16x16x32_bf16 v[80:83], v[48:51], a[32:35], v[80:83]
buffer_load_dwordx4 a[112:115], v2, s[8:11], s48 offen offset:3072 sc1
v_mfma_f32_16x16x32_bf16 v[80:83], v[52:55], a[48:51], v[80:83]
v_mfma_f32_16x16x32_bf16 v[84:87], v[48:51], a[36:39], v[84:87]
ds_read_b128 v[72:75], v2 offset:14336
v_mfma_f32_16x16x32_bf16 v[84:87], v[52:55], a[52:55], v[84:87]
v_mfma_f32_16x16x32_bf16 v[88:91], v[48:51], a[40:43], v[88:91]
buffer_load_dwordx4 a[116:119], v4, s[8:11], s48 offen offset:3072 sc1
v_mfma_f32_16x16x32_bf16 v[88:91], v[52:55], a[56:59], v[88:91]
ds_read_b128 v[76:79], v2 offset:15360
v_mfma_f32_16x16x32_bf16 v[92:95], v[48:51], a[44:47], v[92:95]
v_mfma_f32_16x16x32_bf16 v[92:95], v[52:55], a[60:63], v[92:95]
s_waitcnt lgkmcnt(4)
v_mfma_f32_16x16x32_bf16 v[96:99], v[56:59], a[32:35], v[96:99]
buffer_load_dwordx4 a[120:123], v5, s[8:11], s48 offen offset:3072 sc1
v_mfma_f32_16x16x32_bf16 v[96:99], v[60:63], a[48:51], v[96:99]
v_mfma_f32_16x16x32_bf16 v[100:103], v[56:59], a[36:39], v[100:103]
ds_read_b128 v[48:51], v2 offset:16384
v_mfma_f32_16x16x32_bf16 v[100:103], v[60:63], a[52:55], v[100:103]
v_mfma_f32_16x16x32_bf16 v[104:107], v[56:59], a[40:43], v[104:107]
buffer_load_dwordx4 a[124:127], v6, s[8:11], s48 offen offset:3072 sc1
v_mfma_f32_16x16x32_bf16 v[104:107], v[60:63], a[56:59], v[104:107]
ds_read_b128 v[52:55], v2 offset:17408
s_add_u32 s48, s20, 8192
v_mfma_f32_16x16x32_bf16 v[108:111], v[56:59], a[44:47], v[108:111]
v_mfma_f32_16x16x32_bf16 v[108:111], v[60:63], a[60:63], v[108:111]
s_waitcnt lgkmcnt(4)
v_mfma_f32_16x16x32_bf16 v[112:115], v[64:67], a[32:35], v[112:115]
buffer_load_dwordx4 a[128:131], v2, s[8:11], s48 offen offset:0 sc1
v_mfma_f32_16x16x32_bf16 v[112:115], v[68:71], a[48:51], v[112:115]
v_mfma_f32_16x16x32_bf16 v[116:119], v[64:67], a[36:39], v[116:119]
ds_read_b128 v[56:59], v2 offset:18432
v_mfma_f32_16x16x32_bf16 v[116:119], v[68:71], a[52:55], v[116:119]
v_mfma_f32_16x16x32_bf16 v[120:123], v[64:67], a[40:43], v[120:123]
buffer_load_dwordx4 a[132:135], v4, s[8:11], s48 offen offset:0 sc1
v_mfma_f32_16x16x32_bf16 v[120:123], v[68:71], a[56:59], v[120:123]
ds_read_b128 v[60:63], v2 offset:19456
v_mfma_f32_16x16x32_bf16 v[124:127], v[64:67], a[44:47], v[124:127]
v_mfma_f32_16x16x32_bf16 v[124:127], v[68:71], a[60:63], v[124:127]
s_waitcnt lgkmcnt(4)
v_mfma_f32_16x16x32_bf16 v[128:131], v[72:75], a[32:35], v[128:131]
buffer_load_dwordx4 a[136:139], v5, s[8:11], s48 offen offset:0 sc1
v_mfma_f32_16x16x32_bf16 v[128:131], v[76:79], a[48:51], v[128:131]
v_mfma_f32_16x16x32_bf16 v[132:135], v[72:75], a[36:39], v[132:135]
ds_read_b128 v[64:67], v2 offset:20480
v_mfma_f32_16x16x32_bf16 v[132:135], v[76:79], a[52:55], v[132:135]
v_mfma_f32_16x16x32_bf16 v[136:139], v[72:75], a[40:43], v[136:139]
buffer_load_dwordx4 a[140:143], v6, s[8:11], s48 offen offset:0 sc1
v_mfma_f32_16x16x32_bf16 v[136:139], v[76:79], a[56:59], v[136:139]
ds_read_b128 v[68:71], v2 offset:21504
v_mfma_f32_16x16x32_bf16 v[140:143], v[72:75], a[44:47], v[140:143]
v_mfma_f32_16x16x32_bf16 v[140:143], v[76:79], a[60:63], v[140:143]
s_waitcnt vmcnt(12)
s_waitcnt lgkmcnt(4)
v_mfma_f32_16x16x32_bf16 v[80:83], v[48:51], a[64:67], v[80:83]
buffer_load_dwordx4 a[144:147], v2, s[8:11], s48 offen offset:1024 sc1
v_mfma_f32_16x16x32_bf16 v[80:83], v[52:55], a[80:83], v[80:83]
v_mfma_f32_16x16x32_bf16 v[84:87], v[48:51], a[68:71], v[84:87]
ds_read_b128 v[72:75], v2 offset:22528
v_mfma_f32_16x16x32_bf16 v[84:87], v[52:55], a[84:87], v[84:87]
v_add_f32 v144, v144, v146
v_add_f32 v145, v145, v147
v_mfma_f32_16x16x32_bf16 v[88:91], v[48:51], a[72:75], v[88:91]
buffer_load_dwordx4 a[148:151], v4, s[8:11], s48 offen offset:1024 sc1
v_mfma_f32_16x16x32_bf16 v[88:91], v[52:55], a[88:91], v[88:91]
ds_read_b128 v[76:79], v2 offset:23552
v_add_f32 v148, v148, v150
v_mfma_f32_16x16x32_bf16 v[92:95], v[48:51], a[76:79], v[92:95]
v_add_f32 v149, v149, v151
v_add_f32 v152, v152, v154
v_mfma_f32_16x16x32_bf16 v[92:95], v[52:55], a[92:95], v[92:95]
v_add_f32 v153, v153, v155
s_waitcnt lgkmcnt(4)
v_mfma_f32_16x16x32_bf16 v[96:99], v[56:59], a[64:67], v[96:99]
buffer_load_dwordx4 a[152:155], v5, s[8:11], s48 offen offset:1024 sc1
v_mfma_f32_16x16x32_bf16 v[96:99], v[60:63], a[80:83], v[96:99]
s_barrier
v_mfma_f32_16x16x32_bf16 v[100:103], v[56:59], a[68:71], v[100:103]
ds_read_b128 v[48:51], v2 offset:24576
v_add_f32 v156, v156, v158
v_mfma_f32_16x16x32_bf16 v[100:103], v[60:63], a[84:87], v[100:103]
v_add_f32 v157, v157, v159
v_mov_b32 v160, v144
v_mfma_f32_16x16x32_bf16 v[104:107], v[56:59], a[72:75], v[104:107]
buffer_load_dwordx4 a[156:159], v6, s[8:11], s48 offen offset:1024 sc1
v_mfma_f32_16x16x32_bf16 v[104:107], v[60:63], a[88:91], v[104:107]
ds_read_b128 v[52:55], v2 offset:25600
v_mov_b32 v161, v145
v_mfma_f32_16x16x32_bf16 v[108:111], v[56:59], a[76:79], v[108:111]
v_mov_b32 v162, v148
v_mov_b32 v163, v149
v_mfma_f32_16x16x32_bf16 v[108:111], v[60:63], a[92:95], v[108:111]
v_mov_b32 v164, v152
s_waitcnt lgkmcnt(4)
v_mfma_f32_16x16x32_bf16 v[112:115], v[64:67], a[64:67], v[112:115]
buffer_load_dwordx4 a[160:163], v2, s[8:11], s48 offen offset:2048 sc1
v_mfma_f32_16x16x32_bf16 v[112:115], v[68:71], a[80:83], v[112:115]
v_mov_b32 v165, v153
v_mov_b32 v166, v156
v_mfma_f32_16x16x32_bf16 v[116:119], v[64:67], a[68:71], v[116:119]
ds_read_b128 v[56:59], v2 offset:26624
v_mov_b32 v167, v157
v_mfma_f32_16x16x32_bf16 v[116:119], v[68:71], a[84:87], v[116:119]
v_permlane16_swap_b32 v144, v160
v_permlane16_swap_b32 v145, v161
v_mfma_f32_16x16x32_bf16 v[120:123], v[64:67], a[72:75], v[120:123]
buffer_load_dwordx4 a[164:167], v4, s[8:11], s48 offen offset:2048 sc1
v_mfma_f32_16x16x32_bf16 v[120:123], v[68:71], a[88:91], v[120:123]
ds_read_b128 v[60:63], v2 offset:27648
v_permlane16_swap_b32 v148, v162
v_mfma_f32_16x16x32_bf16 v[124:127], v[64:67], a[76:79], v[124:127]
v_permlane16_swap_b32 v149, v163
v_permlane16_swap_b32 v152, v164
v_mfma_f32_16x16x32_bf16 v[124:127], v[68:71], a[92:95], v[124:127]
v_permlane16_swap_b32 v153, v165
s_waitcnt lgkmcnt(4)
v_mfma_f32_16x16x32_bf16 v[128:131], v[72:75], a[64:67], v[128:131]
buffer_load_dwordx4 a[168:171], v5, s[8:11], s48 offen offset:2048 sc1
v_mfma_f32_16x16x32_bf16 v[128:131], v[76:79], a[80:83], v[128:131]
v_permlane16_swap_b32 v156, v166
v_permlane16_swap_b32 v157, v167
v_mfma_f32_16x16x32_bf16 v[132:135], v[72:75], a[68:71], v[132:135]
ds_read_b128 v[64:67], v2 offset:28672
v_add_f32 v144, v144, v160
v_mfma_f32_16x16x32_bf16 v[132:135], v[76:79], a[84:87], v[132:135]
v_add_f32 v145, v145, v161
v_add_f32 v148, v148, v162
v_mfma_f32_16x16x32_bf16 v[136:139], v[72:75], a[72:75], v[136:139]
buffer_load_dwordx4 a[172:175], v6, s[8:11], s48 offen offset:2048 sc1
v_mfma_f32_16x16x32_bf16 v[136:139], v[76:79], a[88:91], v[136:139]
ds_read_b128 v[68:71], v2 offset:29696
v_add_f32 v149, v149, v163
v_mfma_f32_16x16x32_bf16 v[140:143], v[72:75], a[76:79], v[140:143]
v_add_f32 v152, v152, v164
v_add_f32 v153, v153, v165
v_mfma_f32_16x16x32_bf16 v[140:143], v[76:79], a[92:95], v[140:143]
v_add_f32 v156, v156, v166
s_waitcnt vmcnt(12)
s_waitcnt lgkmcnt(4)
v_mfma_f32_16x16x32_bf16 v[80:83], v[48:51], a[96:99], v[80:83]
buffer_load_dwordx4 a[176:179], v2, s[8:11], s48 offen offset:3072 sc1
v_mfma_f32_16x16x32_bf16 v[80:83], v[52:55], a[112:115], v[80:83]
v_add_f32 v157, v157, v167
v_mov_b32 v160, v144
v_mfma_f32_16x16x32_bf16 v[84:87], v[48:51], a[100:103], v[84:87]
ds_read_b128 v[72:75], v2 offset:30720
v_mov_b32 v161, v145
v_mfma_f32_16x16x32_bf16 v[84:87], v[52:55], a[116:119], v[84:87]
v_mov_b32 v162, v148
v_mov_b32 v163, v149
v_mfma_f32_16x16x32_bf16 v[88:91], v[48:51], a[104:107], v[88:91]
buffer_load_dwordx4 a[180:183], v4, s[8:11], s48 offen offset:3072 sc1
v_mfma_f32_16x16x32_bf16 v[88:91], v[52:55], a[120:123], v[88:91]
ds_read_b128 v[76:79], v2 offset:31744
v_mov_b32 v164, v152
v_mfma_f32_16x16x32_bf16 v[92:95], v[48:51], a[108:111], v[92:95]
v_mov_b32 v165, v153
v_mov_b32 v166, v156
v_mfma_f32_16x16x32_bf16 v[92:95], v[52:55], a[124:127], v[92:95]
v_mov_b32 v167, v157
s_waitcnt lgkmcnt(4)
v_mfma_f32_16x16x32_bf16 v[96:99], v[56:59], a[96:99], v[96:99]
buffer_load_dwordx4 a[184:187], v5, s[8:11], s48 offen offset:3072 sc1
v_mfma_f32_16x16x32_bf16 v[96:99], v[60:63], a[112:115], v[96:99]
v_permlane32_swap_b32 v144, v160
v_permlane32_swap_b32 v145, v161
v_mfma_f32_16x16x32_bf16 v[100:103], v[56:59], a[100:103], v[100:103]
ds_read_b128 v[48:51], v2 offset:32768
v_permlane32_swap_b32 v148, v162
v_mfma_f32_16x16x32_bf16 v[100:103], v[60:63], a[116:119], v[100:103]
v_permlane32_swap_b32 v149, v163
v_permlane32_swap_b32 v152, v164
v_mfma_f32_16x16x32_bf16 v[104:107], v[56:59], a[104:107], v[104:107]
buffer_load_dwordx4 a[188:191], v6, s[8:11], s48 offen offset:3072 sc1
v_mfma_f32_16x16x32_bf16 v[104:107], v[60:63], a[120:123], v[104:107]
ds_read_b128 v[52:55], v2 offset:33792
s_add_u32 s48, s20, 12288
v_mfma_f32_16x16x32_bf16 v[108:111], v[56:59], a[108:111], v[108:111]
v_permlane32_swap_b32 v153, v165
v_permlane32_swap_b32 v156, v166
v_mfma_f32_16x16x32_bf16 v[108:111], v[60:63], a[124:127], v[108:111]
v_permlane32_swap_b32 v157, v167
s_waitcnt lgkmcnt(4)
v_mfma_f32_16x16x32_bf16 v[112:115], v[64:67], a[96:99], v[112:115]
buffer_load_dwordx4 a[192:195], v2, s[8:11], s48 offen offset:0 sc1
v_mfma_f32_16x16x32_bf16 v[112:115], v[68:71], a[112:115], v[112:115]
v_add_f32 v144, v144, v160
v_add_f32 v145, v145, v161
v_mfma_f32_16x16x32_bf16 v[116:119], v[64:67], a[100:103], v[116:119]
ds_read_b128 v[56:59], v2 offset:34816
v_add_f32 v148, v148, v162
v_mfma_f32_16x16x32_bf16 v[116:119], v[68:71], a[116:119], v[116:119]
v_add_f32 v149, v149, v163
v_add_f32 v152, v152, v164
v_mfma_f32_16x16x32_bf16 v[120:123], v[64:67], a[104:107], v[120:123]
buffer_load_dwordx4 a[196:199], v4, s[8:11], s48 offen offset:0 sc1
v_mfma_f32_16x16x32_bf16 v[120:123], v[68:71], a[120:123], v[120:123]
ds_read_b128 v[60:63], v2 offset:35840
v_add_f32 v153, v153, v165
v_mfma_f32_16x16x32_bf16 v[124:127], v[64:67], a[108:111], v[124:127]
v_add_f32 v156, v156, v166
v_add_f32 v157, v157, v167
v_mfma_f32_16x16x32_bf16 v[124:127], v[68:71], a[124:127], v[124:127]
v_mul_f32 v144, 0x3ae38e39, v144
s_waitcnt lgkmcnt(4)
v_mfma_f32_16x16x32_bf16 v[128:131], v[72:75], a[96:99], v[128:131]
buffer_load_dwordx4 a[200:203], v5, s[8:11], s48 offen offset:0 sc1
v_mfma_f32_16x16x32_bf16 v[128:131], v[76:79], a[112:115], v[128:131]
v_mul_f32 v148, 0x3ae38e39, v148
v_mul_f32 v152, 0x3ae38e39, v152
v_mfma_f32_16x16x32_bf16 v[132:135], v[72:75], a[100:103], v[132:135]
ds_read_b128 v[64:67], v2 offset:36864
v_mul_f32 v156, 0x3ae38e39, v156
v_mfma_f32_16x16x32_bf16 v[132:135], v[76:79], a[116:119], v[132:135]
v_mul_f32 v145, 0x3ae38e39, v145
v_mul_f32 v149, 0x3ae38e39, v149
v_mfma_f32_16x16x32_bf16 v[136:139], v[72:75], a[104:107], v[136:139]
buffer_load_dwordx4 a[204:207], v6, s[8:11], s48 offen offset:0 sc1
v_mfma_f32_16x16x32_bf16 v[136:139], v[76:79], a[120:123], v[136:139]
ds_read_b128 v[68:71], v2 offset:37888
v_mul_f32 v153, 0x3ae38e39, v153
v_mfma_f32_16x16x32_bf16 v[140:143], v[72:75], a[108:111], v[140:143]
v_mul_f32 v157, 0x3ae38e39, v157
v_fma_f32 v145, -v144, v144, v145
v_mfma_f32_16x16x32_bf16 v[140:143], v[76:79], a[124:127], v[140:143]
v_fma_f32 v149, -v148, v148, v149
s_waitcnt vmcnt(12)
s_waitcnt lgkmcnt(4)
v_mfma_f32_16x16x32_bf16 v[80:83], v[48:51], a[128:131], v[80:83]
buffer_load_dwordx4 a[208:211], v2, s[8:11], s48 offen offset:1024 sc1
v_mfma_f32_16x16x32_bf16 v[80:83], v[52:55], a[144:147], v[80:83]
v_fma_f32 v153, -v152, v152, v153
v_fma_f32 v157, -v156, v156, v157
v_mfma_f32_16x16x32_bf16 v[84:87], v[48:51], a[132:135], v[84:87]
ds_read_b128 v[72:75], v2 offset:38912
v_max_f32 v145, 0, v145
v_mfma_f32_16x16x32_bf16 v[84:87], v[52:55], a[148:151], v[84:87]
v_max_f32 v149, 0, v149
v_max_f32 v153, 0, v153
v_mfma_f32_16x16x32_bf16 v[88:91], v[48:51], a[136:139], v[88:91]
buffer_load_dwordx4 a[212:215], v4, s[8:11], s48 offen offset:1024 sc1
v_mfma_f32_16x16x32_bf16 v[88:91], v[52:55], a[152:155], v[88:91]
ds_read_b128 v[76:79], v2 offset:39936
v_max_f32 v157, 0, v157
v_mfma_f32_16x16x32_bf16 v[92:95], v[48:51], a[140:143], v[92:95]
v_add_f32 v234, 0x3727c5ac, v145
v_add_f32 v237, 0x3727c5ac, v149
v_mfma_f32_16x16x32_bf16 v[92:95], v[52:55], a[156:159], v[92:95]
v_add_f32 v240, 0x3727c5ac, v153
s_waitcnt lgkmcnt(4)
v_mfma_f32_16x16x32_bf16 v[96:99], v[56:59], a[128:131], v[96:99]
buffer_load_dwordx4 a[216:219], v5, s[8:11], s48 offen offset:1024 sc1
v_mfma_f32_16x16x32_bf16 v[96:99], v[60:63], a[144:147], v[96:99]
v_add_f32 v243, 0x3727c5ac, v157
v_mfma_f32_16x16x32_bf16 v[100:103], v[56:59], a[132:135], v[100:103]
ds_read_b128 v[48:51], v2 offset:40960
v_mfma_f32_16x16x32_bf16 v[100:103], v[60:63], a[148:151], v[100:103]
v_rsq_f32 v144, v234
v_mfma_f32_16x16x32_bf16 v[104:107], v[56:59], a[136:139], v[104:107]
buffer_load_dwordx4 a[220:223], v6, s[8:11], s48 offen offset:1024 sc1
v_mfma_f32_16x16x32_bf16 v[104:107], v[60:63], a[152:155], v[104:107]
ds_read_b128 v[52:55], v2 offset:41984
v_mul_f32 v232, 0xc0135761, v144
v_mfma_f32_16x16x32_bf16 v[108:111], v[56:59], a[140:143], v[108:111]
v_rsq_f32 v148, v237
v_mfma_f32_16x16x32_bf16 v[108:111], v[60:63], a[156:159], v[108:111]
v_mul_f32 v235, 0xc0135761, v148
s_waitcnt lgkmcnt(4)
v_mfma_f32_16x16x32_bf16 v[112:115], v[64:67], a[128:131], v[112:115]
buffer_load_dwordx4 a[224:227], v2, s[8:11], s48 offen offset:2048 sc1
v_mfma_f32_16x16x32_bf16 v[112:115], v[68:71], a[144:147], v[112:115]
v_rsq_f32 v152, v240
v_mfma_f32_16x16x32_bf16 v[116:119], v[64:67], a[132:135], v[116:119]
ds_read_b128 v[56:59], v2 offset:43008
v_mul_f32 v238, 0xc0135761, v152
v_mfma_f32_16x16x32_bf16 v[116:119], v[68:71], a[148:151], v[116:119]
v_rsq_f32 v156, v243
v_mfma_f32_16x16x32_bf16 v[120:123], v[64:67], a[136:139], v[120:123]
buffer_load_dwordx4 a[228:231], v4, s[8:11], s48 offen offset:2048 sc1
v_mfma_f32_16x16x32_bf16 v[120:123], v[68:71], a[152:155], v[120:123]
ds_read_b128 v[60:63], v2 offset:44032
v_mul_f32 v241, 0xc0135761, v156
v_mfma_f32_16x16x32_bf16 v[124:127], v[64:67], a[140:143], v[124:127]
v_mul_f32 v145, v144, v144
v_mul_f32 v149, v148, v148
v_mfma_f32_16x16x32_bf16 v[124:127], v[68:71], a[156:159], v[124:127]
v_mul_f32 v153, v152, v152
s_waitcnt lgkmcnt(4)
v_mfma_f32_16x16x32_bf16 v[128:131], v[72:75], a[128:131], v[128:131]
buffer_load_dwordx4 a[232:235], v5, s[8:11], s48 offen offset:2048 sc1
v_mfma_f32_16x16x32_bf16 v[128:131], v[76:79], a[144:147], v[128:131]
v_mul_f32 v157, v156, v156
v_mul_f32 v145, v145, v144
v_mfma_f32_16x16x32_bf16 v[132:135], v[72:75], a[132:135], v[132:135]
ds_read_b128 v[64:67], v2 offset:45056
v_mul_f32 v149, v149, v148
v_mfma_f32_16x16x32_bf16 v[132:135], v[76:79], a[148:151], v[132:135]
v_mul_f32 v153, v153, v152
v_mul_f32 v157, v157, v156
v_mfma_f32_16x16x32_bf16 v[136:139], v[72:75], a[136:139], v[136:139]
buffer_load_dwordx4 a[236:239], v6, s[8:11], s48 offen offset:2048 sc1
v_mfma_f32_16x16x32_bf16 v[136:139], v[76:79], a[152:155], v[136:139]
ds_read_b128 v[68:71], v2 offset:46080
v_mul_f32 v233, 0xbdd2d3e8, v145
v_mfma_f32_16x16x32_bf16 v[140:143], v[72:75], a[140:143], v[140:143]
v_mul_f32 v236, 0xbdd2d3e8, v149
v_mul_f32 v239, 0xbdd2d3e8, v153
v_mfma_f32_16x16x32_bf16 v[140:143], v[76:79], a[156:159], v[140:143]
v_mul_f32 v242, 0xbdd2d3e8, v157
s_waitcnt vmcnt(12)
s_waitcnt lgkmcnt(4)
v_mfma_f32_16x16x32_bf16 v[80:83], v[48:51], a[160:163], v[80:83]
buffer_load_dwordx4 a[240:243], v2, s[8:11], s48 offen offset:3072 sc1
v_mfma_f32_16x16x32_bf16 v[80:83], v[52:55], a[176:179], v[80:83]
v_mfma_f32_16x16x32_bf16 v[84:87], v[48:51], a[164:167], v[84:87]
ds_read_b128 v[72:75], v2 offset:47104
v_mfma_f32_16x16x32_bf16 v[84:87], v[52:55], a[180:183], v[84:87]
v_mfma_f32_16x16x32_bf16 v[88:91], v[48:51], a[168:171], v[88:91]
buffer_load_dwordx4 a[244:247], v4, s[8:11], s48 offen offset:3072 sc1
v_mfma_f32_16x16x32_bf16 v[88:91], v[52:55], a[184:187], v[88:91]
ds_read_b128 v[76:79], v2 offset:48128
v_mfma_f32_16x16x32_bf16 v[92:95], v[48:51], a[172:175], v[92:95]
v_mfma_f32_16x16x32_bf16 v[92:95], v[52:55], a[188:191], v[92:95]
s_waitcnt lgkmcnt(4)
v_mfma_f32_16x16x32_bf16 v[96:99], v[56:59], a[160:163], v[96:99]
buffer_load_dwordx4 a[248:251], v5, s[8:11], s48 offen offset:3072 sc1
v_mfma_f32_16x16x32_bf16 v[96:99], v[60:63], a[176:179], v[96:99]
s_barrier
v_mfma_f32_16x16x32_bf16 v[100:103], v[56:59], a[164:167], v[100:103]
ds_read_b128 v[48:51], v2 offset:49152
v_mfma_f32_16x16x32_bf16 v[100:103], v[60:63], a[180:183], v[100:103]
v_mfma_f32_16x16x32_bf16 v[104:107], v[56:59], a[168:171], v[104:107]
buffer_load_dwordx4 a[252:255], v6, s[8:11], s48 offen offset:3072 sc1
v_mfma_f32_16x16x32_bf16 v[104:107], v[60:63], a[184:187], v[104:107]
ds_read_b128 v[52:55], v2 offset:50176
s_add_u32 s48, s20, 16384
v_mfma_f32_16x16x32_bf16 v[108:111], v[56:59], a[172:175], v[108:111]
v_mfma_f32_16x16x32_bf16 v[108:111], v[60:63], a[188:191], v[108:111]
s_waitcnt lgkmcnt(4)
v_mfma_f32_16x16x32_bf16 v[112:115], v[64:67], a[160:163], v[112:115]
buffer_load_dwordx4 v[16:19], v2, s[8:11], s48 offen offset:0 sc1
v_mfma_f32_16x16x32_bf16 v[112:115], v[68:71], a[176:179], v[112:115]
v_mfma_f32_16x16x32_bf16 v[116:119], v[64:67], a[164:167], v[116:119]
ds_read_b128 v[56:59], v2 offset:51200
v_mfma_f32_16x16x32_bf16 v[116:119], v[68:71], a[180:183], v[116:119]
v_mfma_f32_16x16x32_bf16 v[120:123], v[64:67], a[168:171], v[120:123]
buffer_load_dwordx4 v[20:23], v4, s[8:11], s48 offen offset:0 sc1
v_mfma_f32_16x16x32_bf16 v[120:123], v[68:71], a[184:187], v[120:123]
ds_read_b128 v[60:63], v2 offset:52224
v_mfma_f32_16x16x32_bf16 v[124:127], v[64:67], a[172:175], v[124:127]
v_mfma_f32_16x16x32_bf16 v[124:127], v[68:71], a[188:191], v[124:127]
s_waitcnt lgkmcnt(4)
v_mfma_f32_16x16x32_bf16 v[128:131], v[72:75], a[160:163], v[128:131]
buffer_load_dwordx4 v[24:27], v5, s[8:11], s48 offen offset:0 sc1
v_mfma_f32_16x16x32_bf16 v[128:131], v[76:79], a[176:179], v[128:131]
v_mfma_f32_16x16x32_bf16 v[132:135], v[72:75], a[164:167], v[132:135]
ds_read_b128 v[64:67], v2 offset:53248
v_mfma_f32_16x16x32_bf16 v[132:135], v[76:79], a[180:183], v[132:135]
v_mfma_f32_16x16x32_bf16 v[136:139], v[72:75], a[168:171], v[136:139]
buffer_load_dwordx4 v[28:31], v6, s[8:11], s48 offen offset:0 sc1
v_mfma_f32_16x16x32_bf16 v[136:139], v[76:79], a[184:187], v[136:139]
ds_read_b128 v[68:71], v2 offset:54272
v_mfma_f32_16x16x32_bf16 v[140:143], v[72:75], a[172:175], v[140:143]
v_mfma_f32_16x16x32_bf16 v[140:143], v[76:79], a[188:191], v[140:143]
s_waitcnt vmcnt(12)
s_waitcnt lgkmcnt(4)
v_mfma_f32_16x16x32_bf16 v[80:83], v[48:51], a[192:195], v[80:83]
buffer_load_dwordx4 v[32:35], v2, s[8:11], s48 offen offset:1024 sc1
v_mfma_f32_16x16x32_bf16 v[80:83], v[52:55], a[208:211], v[80:83]
v_mfma_f32_16x16x32_bf16 v[84:87], v[48:51], a[196:199], v[84:87]
ds_read_b128 v[72:75], v2 offset:55296
v_mfma_f32_16x16x32_bf16 v[84:87], v[52:55], a[212:215], v[84:87]
v_mfma_f32_16x16x32_bf16 v[88:91], v[48:51], a[200:203], v[88:91]
buffer_load_dwordx4 v[36:39], v4, s[8:11], s48 offen offset:1024 sc1
v_mfma_f32_16x16x32_bf16 v[88:91], v[52:55], a[216:219], v[88:91]
ds_read_b128 v[76:79], v2 offset:56320
v_mfma_f32_16x16x32_bf16 v[92:95], v[48:51], a[204:207], v[92:95]
v_mfma_f32_16x16x32_bf16 v[92:95], v[52:55], a[220:223], v[92:95]
s_waitcnt lgkmcnt(4)
v_mfma_f32_16x16x32_bf16 v[96:99], v[56:59], a[192:195], v[96:99]
buffer_load_dwordx4 v[40:43], v5, s[8:11], s48 offen offset:1024 sc1
v_mfma_f32_16x16x32_bf16 v[96:99], v[60:63], a[208:211], v[96:99]
v_mfma_f32_16x16x32_bf16 v[100:103], v[56:59], a[196:199], v[100:103]
ds_read_b128 v[48:51], v2 offset:57344
v_mfma_f32_16x16x32_bf16 v[100:103], v[60:63], a[212:215], v[100:103]
v_mfma_f32_16x16x32_bf16 v[104:107], v[56:59], a[200:203], v[104:107]
buffer_load_dwordx4 v[44:47], v6, s[8:11], s48 offen offset:1024 sc1
v_mfma_f32_16x16x32_bf16 v[104:107], v[60:63], a[216:219], v[104:107]
ds_read_b128 v[52:55], v2 offset:58368
s_add_u32 m0, s22, 98304
v_mfma_f32_16x16x32_bf16 v[108:111], v[56:59], a[204:207], v[108:111]
v_add_u32 v3, 20480, v3
v_mfma_f32_16x16x32_bf16 v[108:111], v[60:63], a[220:223], v[108:111]
s_waitcnt lgkmcnt(4)
v_mfma_f32_16x16x32_bf16 v[112:115], v[64:67], a[192:195], v[112:115]
buffer_load_dwordx4 v3, s[8:11], 0 offen offset:0 sc1 lds
v_mfma_f32_16x16x32_bf16 v[112:115], v[68:71], a[208:211], v[112:115]
v_mfma_f32_16x16x32_bf16 v[116:119], v[64:67], a[196:199], v[116:119]
ds_read_b128 v[56:59], v2 offset:59392
v_mfma_f32_16x16x32_bf16 v[116:119], v[68:71], a[212:215], v[116:119]
v_mfma_f32_16x16x32_bf16 v[120:123], v[64:67], a[200:203], v[120:123]
buffer_load_dwordx4 v3, s[8:11], 0 offen offset:1024 sc1 lds
v_mfma_f32_16x16x32_bf16 v[120:123], v[68:71], a[216:219], v[120:123]
ds_read_b128 v[60:63], v2 offset:60416
v_mfma_f32_16x16x32_bf16 v[124:127], v[64:67], a[204:207], v[124:127]
v_mfma_f32_16x16x32_bf16 v[124:127], v[68:71], a[220:223], v[124:127]
s_waitcnt lgkmcnt(4)
v_mfma_f32_16x16x32_bf16 v[128:131], v[72:75], a[192:195], v[128:131]
buffer_load_dwordx4 v3, s[8:11], 0 offen offset:2048 sc1 lds
v_mfma_f32_16x16x32_bf16 v[128:131], v[76:79], a[208:211], v[128:131]
v_mfma_f32_16x16x32_bf16 v[132:135], v[72:75], a[196:199], v[132:135]
ds_read_b128 v[64:67], v2 offset:61440
v_mfma_f32_16x16x32_bf16 v[132:135], v[76:79], a[212:215], v[132:135]
v_mfma_f32_16x16x32_bf16 v[136:139], v[72:75], a[200:203], v[136:139]
buffer_load_dwordx4 v3, s[8:11], 0 offen offset:3072 sc1 lds
v_mfma_f32_16x16x32_bf16 v[136:139], v[76:79], a[216:219], v[136:139]
ds_read_b128 v[68:71], v2 offset:62464
s_add_u32 m0, s22, 102400
v_mfma_f32_16x16x32_bf16 v[140:143], v[72:75], a[204:207], v[140:143]
v_add_u32 v3, 4096, v3
v_mfma_f32_16x16x32_bf16 v[140:143], v[76:79], a[220:223], v[140:143]
s_waitcnt vmcnt(12)
s_waitcnt lgkmcnt(4)
v_mfma_f32_16x16x32_bf16 v[80:83], v[48:51], a[224:227], v[80:83]
buffer_load_dwordx4 v3, s[8:11], 0 offen offset:0 sc1 lds
v_mfma_f32_16x16x32_bf16 v[80:83], v[52:55], a[240:243], v[80:83]
v_mfma_f32_16x16x32_bf16 v[84:87], v[48:51], a[228:231], v[84:87]
ds_read_b128 v[72:75], v2 offset:63488
v_mfma_f32_16x16x32_bf16 v[84:87], v[52:55], a[244:247], v[84:87]
v_mfma_f32_16x16x32_bf16 v[88:91], v[48:51], a[232:235], v[88:91]
buffer_load_dwordx4 v3, s[8:11], 0 offen offset:1024 sc1 lds
v_mfma_f32_16x16x32_bf16 v[88:91], v[52:55], a[248:251], v[88:91]
ds_read_b128 v[76:79], v2 offset:64512
s_add_u32 m0, s22, 122880
v_mfma_f32_16x16x32_bf16 v[92:95], v[48:51], a[236:239], v[92:95]
v_add_u32 v3, 20480, v3
v_mfma_f32_16x16x32_bf16 v[92:95], v[52:55], a[252:255], v[92:95]
s_waitcnt lgkmcnt(4)
v_mfma_f32_16x16x32_bf16 v[96:99], v[56:59], a[224:227], v[96:99]
buffer_load_dwordx4 v3, s[8:11], 0 offen offset:0 sc1 lds
v_mfma_f32_16x16x32_bf16 v[96:99], v[60:63], a[240:243], v[96:99]
v_mfma_f32_16x16x32_bf16 v[100:103], v[56:59], a[228:231], v[100:103]
ds_read_b128 v[48:51], v7 offset:0
v_mfma_f32_16x16x32_bf16 v[100:103], v[60:63], a[244:247], v[100:103]
v_mfma_f32_16x16x32_bf16 v[104:107], v[56:59], a[232:235], v[104:107]
buffer_load_dwordx4 v3, s[8:11], 0 offen offset:1024 sc1 lds
v_mfma_f32_16x16x32_bf16 v[104:107], v[60:63], a[248:251], v[104:107]
ds_read_b128 v[52:55], v7 offset:1024
v_mfma_f32_16x16x32_bf16 v[108:111], v[56:59], a[236:239], v[108:111]
v_mfma_f32_16x16x32_bf16 v[108:111], v[60:63], a[252:255], v[108:111]
s_waitcnt lgkmcnt(4)
v_mfma_f32_16x16x32_bf16 v[112:115], v[64:67], a[224:227], v[112:115]
buffer_load_dwordx4 v3, s[8:11], 0 offen offset:2048 sc1 lds
v_mfma_f32_16x16x32_bf16 v[112:115], v[68:71], a[240:243], v[112:115]
v_mfma_f32_16x16x32_bf16 v[116:119], v[64:67], a[228:231], v[116:119]
ds_read_b128 v[56:59], v7 offset:2048
v_mfma_f32_16x16x32_bf16 v[116:119], v[68:71], a[244:247], v[116:119]
v_mfma_f32_16x16x32_bf16 v[120:123], v[64:67], a[232:235], v[120:123]
buffer_load_dwordx4 v3, s[8:11], 0 offen offset:3072 sc1 lds
v_mfma_f32_16x16x32_bf16 v[120:123], v[68:71], a[248:251], v[120:123]
ds_read_b128 v[60:63], v7 offset:3072
s_add_u32 m0, s22, 126976
v_mfma_f32_16x16x32_bf16 v[124:127], v[64:67], a[236:239], v[124:127]
v_add_u32 v3, 4096, v3
v_mfma_f32_16x16x32_bf16 v[124:127], v[68:71], a[252:255], v[124:127]
s_waitcnt lgkmcnt(4)
v_mfma_f32_16x16x32_bf16 v[128:131], v[72:75], a[224:227], v[128:131]
buffer_load_dwordx4 v3, s[8:11], 0 offen offset:0 sc1 lds
v_mfma_f32_16x16x32_bf16 v[128:131], v[76:79], a[240:243], v[128:131]
v_mfma_f32_16x16x32_bf16 v[132:135], v[72:75], a[228:231], v[132:135]
ds_read_b128 v[64:67], v7 offset:4096
v_mfma_f32_16x16x32_bf16 v[132:135], v[76:79], a[244:247], v[132:135]
v_mfma_f32_16x16x32_bf16 v[136:139], v[72:75], a[232:235], v[136:139]
buffer_load_dwordx4 v3, s[8:11], 0 offen offset:1024 sc1 lds
v_mfma_f32_16x16x32_bf16 v[136:139], v[76:79], a[248:251], v[136:139]
ds_read_b128 v[68:71], v7 offset:5120
s_add_u32 m0, s22, 0
v_mfma_f32_16x16x32_bf16 v[140:143], v[72:75], a[236:239], v[140:143]
v_add_u32 v3, 20480, v3
v_mfma_f32_16x16x32_bf16 v[140:143], v[76:79], a[252:255], v[140:143]
s_waitcnt vmcnt(12)
s_waitcnt lgkmcnt(4)
v_mfma_f32_16x16x32_bf16 v[80:83], v[48:51], v[16:19], v[80:83]
buffer_load_dwordx4 v3, s[8:11], 0 offen offset:0 sc1 lds
v_mfma_f32_16x16x32_bf16 v[80:83], v[52:55], v[32:35], v[80:83]
v_mfma_f32_16x16x32_bf16 v[84:87], v[48:51], v[20:23], v[84:87]
ds_read_b128 v[72:75], v7 offset:6144
v_mfma_f32_16x16x32_bf16 v[84:87], v[52:55], v[36:39], v[84:87]
v_mfma_f32_16x16x32_bf16 v[88:91], v[48:51], v[24:27], v[88:91]
buffer_load_dwordx4 v3, s[8:11], 0 offen offset:1024 sc1 lds
v_mfma_f32_16x16x32_bf16 v[88:91], v[52:55], v[40:43], v[88:91]
ds_read_b128 v[76:79], v7 offset:7168
v_mfma_f32_16x16x32_bf16 v[92:95], v[48:51], v[28:31], v[92:95]
v_mfma_f32_16x16x32_bf16 v[92:95], v[52:55], v[44:47], v[92:95]
s_waitcnt lgkmcnt(4)
v_mfma_f32_16x16x32_bf16 v[96:99], v[56:59], v[16:19], v[96:99]
buffer_load_dwordx4 v3, s[8:11], 0 offen offset:2048 sc1 lds
v_mfma_f32_16x16x32_bf16 v[96:99], v[60:63], v[32:35], v[96:99]
s_barrier
v_mfma_f32_16x16x32_bf16 v[100:103], v[56:59], v[20:23], v[100:103]
ds_read_b128 v[48:51], v7 offset:8192
v_mfma_f32_16x16x32_bf16 v[100:103], v[60:63], v[36:39], v[100:103]
v_mfma_f32_16x16x32_bf16 v[104:107], v[56:59], v[24:27], v[104:107]
buffer_load_dwordx4 v3, s[8:11], 0 offen offset:3072 sc1 lds
v_mfma_f32_16x16x32_bf16 v[104:107], v[60:63], v[40:43], v[104:107]
ds_read_b128 v[52:55], v7 offset:9216
s_add_u32 m0, s22, 4096
v_mfma_f32_16x16x32_bf16 v[108:111], v[56:59], v[28:31], v[108:111]
v_add_u32 v3, 4096, v3
v_mfma_f32_16x16x32_bf16 v[108:111], v[60:63], v[44:47], v[108:111]
s_waitcnt lgkmcnt(4)
v_mfma_f32_16x16x32_bf16 v[112:115], v[64:67], v[16:19], v[112:115]
buffer_load_dwordx4 v3, s[8:11], 0 offen offset:0 sc1 lds
v_mfma_f32_16x16x32_bf16 v[112:115], v[68:71], v[32:35], v[112:115]
v_mfma_f32_16x16x32_bf16 v[116:119], v[64:67], v[20:23], v[116:119]
ds_read_b128 v[56:59], v7 offset:10240
v_mfma_f32_16x16x32_bf16 v[116:119], v[68:71], v[36:39], v[116:119]
v_mfma_f32_16x16x32_bf16 v[120:123], v[64:67], v[24:27], v[120:123]
buffer_load_dwordx4 v3, s[8:11], 0 offen offset:1024 sc1 lds
v_mfma_f32_16x16x32_bf16 v[120:123], v[68:71], v[40:43], v[120:123]
ds_read_b128 v[60:63], v7 offset:11264
s_add_u32 m0, s22, 24576
v_mfma_f32_16x16x32_bf16 v[124:127], v[64:67], v[28:31], v[124:127]
v_add_u32 v3, 20480, v3
v_mfma_f32_16x16x32_bf16 v[124:127], v[68:71], v[44:47], v[124:127]
s_waitcnt lgkmcnt(4)
v_mfma_f32_16x16x32_bf16 v[128:131], v[72:75], v[16:19], v[128:131]
buffer_load_dwordx4 v3, s[8:11], 0 offen offset:0 sc1 lds
v_mfma_f32_16x16x32_bf16 v[128:131], v[76:79], v[32:35], v[128:131]
v_mfma_f32_16x16x32_bf16 v[132:135], v[72:75], v[20:23], v[132:135]
ds_read_b128 v[64:67], v7 offset:12288
v_mfma_f32_16x16x32_bf16 v[132:135], v[76:79], v[36:39], v[132:135]
v_mfma_f32_16x16x32_bf16 v[136:139], v[72:75], v[24:27], v[136:139]
buffer_load_dwordx4 v3, s[8:11], 0 offen offset:1024 sc1 lds
v_mfma_f32_16x16x32_bf16 v[136:139], v[76:79], v[40:43], v[136:139]
ds_read_b128 v[68:71], v7 offset:13312
v_mfma_f32_16x16x32_bf16 v[140:143], v[72:75], v[28:31], v[140:143]
v_mfma_f32_16x16x32_bf16 v[140:143], v[76:79], v[44:47], v[140:143]
s_waitcnt lgkmcnt(4)
v_mfma_f32_16x16x32_bf16 v[176:179], v[48:51], a[0:3], 0
buffer_load_dwordx4 v3, s[8:11], 0 offen offset:2048 sc1 lds
v_mfma_f32_16x16x32_bf16 v[176:179], v[52:55], a[16:19], v[176:179]
v_mfma_f32_16x16x32_bf16 v[180:183], v[48:51], a[4:7], 0
ds_read_b128 v[72:75], v7 offset:14336
v_mfma_f32_16x16x32_bf16 v[180:183], v[52:55], a[20:23], v[180:183]
v_mul_f32 v208, v80, v80
v_mul_f32 v210, v81, v81
v_mfma_f32_16x16x32_bf16 v[184:187], v[48:51], a[8:11], 0
buffer_load_dwordx4 v3, s[8:11], 0 offen offset:3072 sc1 lds
v_mfma_f32_16x16x32_bf16 v[184:187], v[52:55], a[24:27], v[184:187]
ds_read_b128 v[76:79], v7 offset:15360
s_add_u32 m0, s22, 28672
v_mfma_f32_16x16x32_bf16 v[188:191], v[48:51], a[12:15], 0
v_add_u32 v3, 4096, v3
v_fma_f32 v208, v208, v233, v232
v_mfma_f32_16x16x32_bf16 v[188:191], v[52:55], a[28:31], v[188:191]
v_fma_f32 v210, v210, v233, v232
s_waitcnt lgkmcnt(4)
v_mfma_f32_16x16x32_bf16 v[192:195], v[56:59], a[0:3], 0
buffer_load_dwordx4 v3, s[8:11], 0 offen offset:0 sc1 lds
v_mfma_f32_16x16x32_bf16 v[192:195], v[60:63], a[16:19], v[192:195]
v_mul_f32 v208, v208, v80
v_mul_f32 v210, v210, v81
v_mfma_f32_16x16x32_bf16 v[196:199], v[56:59], a[4:7], 0
ds_read_b128 v[48:51], v7 offset:16384
v_mul_f32 v209, v80, v96
v_mfma_f32_16x16x32_bf16 v[196:199], v[60:63], a[20:23], v[196:199]
v_exp_f32 v208, v208
v_mfma_f32_16x16x32_bf16 v[200:203], v[56:59], a[8:11], 0
buffer_load_dwordx4 v3, s[8:11], 0 offen offset:1024 sc1 lds
v_mfma_f32_16x16x32_bf16 v[200:203], v[60:63], a[24:27], v[200:203]
ds_read_b128 v[52:55], v7 offset:17408
v_mul_f32 v211, v81, v97
v_mfma_f32_16x16x32_bf16 v[204:207], v[56:59], a[12:15], 0
v_exp_f32 v210, v210
v_mfma_f32_16x16x32_bf16 v[204:207], v[60:63], a[28:31], v[204:207]
v_fma_f32 v208, v208, v234, v234
s_waitcnt lgkmcnt(4)
v_mfma_f32_16x16x32_bf16 v[176:179], v[64:67], a[32:35], v[176:179]
v_fma_f32 v210, v210, v234, v234
v_mul_f32 v212, v82, v82
v_mfma_f32_16x16x32_bf16 v[176:179], v[68:71], a[48:51], v[176:179]
v_rcp_f32 v208, v208
v_mfma_f32_16x16x32_bf16 v[180:183], v[64:67], a[36:39], v[180:183]
ds_read_b128 v[56:59], v7 offset:18432
v_mul_f32 v209, v209, v208
v_mfma_f32_16x16x32_bf16 v[180:183], v[68:71], a[52:55], v[180:183]
v_rcp_f32 v210, v210
v_mfma_f32_16x16x32_bf16 v[184:187], v[64:67], a[40:43], v[184:187]
v_mul_f32 v211, v211, v210
v_cvt_pk_bf16_f32 v224, v209, v211
v_mfma_f32_16x16x32_bf16 v[184:187], v[68:71], a[56:59], v[184:187]
ds_read_b128 v[60:63], v7 offset:19456
v_mul_f32 v214, v83, v83
v_mfma_f32_16x16x32_bf16 v[188:191], v[64:67], a[44:47], v[188:191]
v_fma_f32 v212, v212, v233, v232
v_fma_f32 v214, v214, v233, v232
v_mfma_f32_16x16x32_bf16 v[188:191], v[68:71], a[60:63], v[188:191]
v_mul_f32 v212, v212, v82
s_waitcnt lgkmcnt(4)
v_mfma_f32_16x16x32_bf16 v[192:195], v[72:75], a[32:35], v[192:195]
v_mul_f32 v214, v214, v83
v_mul_f32 v213, v82, v98
v_mfma_f32_16x16x32_bf16 v[192:195], v[76:79], a[48:51], v[192:195]
v_exp_f32 v212, v212
v_mfma_f32_16x16x32_bf16 v[196:199], v[72:75], a[36:39], v[196:199]
ds_read_b128 v[64:67], v7 offset:20480
v_mul_f32 v215, v83, v99
v_mfma_f32_16x16x32_bf16 v[196:199], v[76:79], a[52:55], v[196:199]
v_exp_f32 v214, v214
v_mfma_f32_16x16x32_bf16 v[200:203], v[72:75], a[40:43], v[200:203]
v_fma_f32 v212, v212, v234, v234
v_fma_f32 v214, v214, v234, v234
v_mfma_f32_16x16x32_bf16 v[200:203], v[76:79], a[56:59], v[200:203]
ds_read_b128 v[68:71], v7 offset:21504
v_mul_f32 v208, v84, v84
v_mfma_f32_16x16x32_bf16 v[204:207], v[72:75], a[44:47], v[204:207]
v_rcp_f32 v212, v212
v_mfma_f32_16x16x32_bf16 v[204:207], v[76:79], a[60:63], v[204:207]
v_mul_f32 v213, v213, v212
s_waitcnt lgkmcnt(4)
v_mfma_f32_16x16x32_bf16 v[176:179], v[48:51], a[64:67], v[176:179]
v_rcp_f32 v214, v214
v_mfma_f32_16x16x32_bf16 v[176:179], v[52:55], a[80:83], v[176:179]
v_mul_f32 v215, v215, v214
v_cvt_pk_bf16_f32 v225, v213, v215
v_mfma_f32_16x16x32_bf16 v[180:183], v[48:51], a[68:71], v[180:183]
ds_read_b128 v[72:75], v7 offset:22528
v_mul_f32 v210, v85, v85
v_mfma_f32_16x16x32_bf16 v[180:183], v[52:55], a[84:87], v[180:183]
buffer_store_dwordx2 v[224:225], v244, s[8:11], s30 offen sc1
v_mfma_f32_16x16x32_bf16 v[184:187], v[48:51], a[72:75], v[184:187]
v_fma_f32 v208, v208, v236, v235
v_fma_f32 v210, v210, v236, v235
v_mfma_f32_16x16x32_bf16 v[184:187], v[52:55], a[88:91], v[184:187]
ds_read_b128 v[76:79], v7 offset:23552
v_mul_f32 v208, v208, v84
v_mfma_f32_16x16x32_bf16 v[188:191], v[48:51], a[76:79], v[188:191]
v_mul_f32 v210, v210, v85
v_mul_f32 v209, v84, v100
v_mfma_f32_16x16x32_bf16 v[188:191], v[52:55], a[92:95], v[188:191]
v_mul_f32 v211, v85, v101
s_waitcnt lgkmcnt(4)
v_mfma_f32_16x16x32_bf16 v[192:195], v[56:59], a[64:67], v[192:195]
v_exp_f32 v208, v208
v_mfma_f32_16x16x32_bf16 v[192:195], v[60:63], a[80:83], v[192:195]
v_exp_f32 v210, v210
v_mfma_f32_16x16x32_bf16 v[196:199], v[56:59], a[68:71], v[196:199]
ds_read_b128 v[48:51], v7 offset:24576
v_fma_f32 v208, v208, v237, v237
v_mfma_f32_16x16x32_bf16 v[196:199], v[60:63], a[84:87], v[196:199]
v_fma_f32 v210, v210, v237, v237
v_mul_f32 v212, v86, v86
v_mfma_f32_16x16x32_bf16 v[200:203], v[56:59], a[72:75], v[200:203]
v_rcp_f32 v208, v208
v_mfma_f32_16x16x32_bf16 v[200:203], v[60:63], a[88:91], v[200:203]
ds_read_b128 v[52:55], v7 offset:25600
v_mul_f32 v209, v209, v208
v_mfma_f32_16x16x32_bf16 v[204:207], v[56:59], a[76:79], v[204:207]
v_rcp_f32 v210, v210
v_mfma_f32_16x16x32_bf16 v[204:207], v[60:63], a[92:95], v[204:207]
v_mul_f32 v211, v211, v210
s_waitcnt lgkmcnt(4)
v_mfma_f32_16x16x32_bf16 v[176:179], v[64:67], a[96:99], v[176:179]
v_cvt_pk_bf16_f32 v226, v209, v211
v_mul_f32 v214, v87, v87
v_mfma_f32_16x16x32_bf16 v[176:179], v[68:71], a[112:115], v[176:179]
v_fma_f32 v212, v212, v236, v235
v_fma_f32 v214, v214, v236, v235
v_mfma_f32_16x16x32_bf16 v[180:183], v[64:67], a[100:103], v[180:183]
ds_read_b128 v[56:59], v7 offset:26624
v_mul_f32 v212, v212, v86
v_mfma_f32_16x16x32_bf16 v[180:183], v[68:71], a[116:119], v[180:183]
v_mul_f32 v214, v214, v87
v_mul_f32 v213, v86, v102
v_mfma_f32_16x16x32_bf16 v[184:187], v[64:67], a[104:107], v[184:187]
v_exp_f32 v212, v212
v_mfma_f32_16x16x32_bf16 v[184:187], v[68:71], a[120:123], v[184:187]
ds_read_b128 v[60:63], v7 offset:27648
v_mul_f32 v215, v87, v103
v_mfma_f32_16x16x32_bf16 v[188:191], v[64:67], a[108:111], v[188:191]
v_exp_f32 v214, v214
v_mfma_f32_16x16x32_bf16 v[188:191], v[68:71], a[124:127], v[188:191]
v_fma_f32 v212, v212, v237, v237
s_waitcnt lgkmcnt(4)
v_mfma_f32_16x16x32_bf16 v[192:195], v[72:75], a[96:99], v[192:195]
v_fma_f32 v214, v214, v237, v237
v_mul_f32 v208, v88, v88
v_mfma_f32_16x16x32_bf16 v[192:195], v[76:79], a[112:115], v[192:195]
v_rcp_f32 v212, v212
v_mfma_f32_16x16x32_bf16 v[196:199], v[72:75], a[100:103], v[196:199]
ds_read_b128 v[64:67], v7 offset:28672
v_mul_f32 v213, v213, v212
v_mfma_f32_16x16x32_bf16 v[196:199], v[76:79], a[116:119], v[196:199]
v_rcp_f32 v214, v214
v_mfma_f32_16x16x32_bf16 v[200:203], v[72:75], a[104:107], v[200:203]
v_mul_f32 v215, v215, v214
v_cvt_pk_bf16_f32 v227, v213, v215
v_mfma_f32_16x16x32_bf16 v[200:203], v[76:79], a[120:123], v[200:203]
ds_read_b128 v[68:71], v7 offset:29696
v_mul_f32 v210, v89, v89
v_mfma_f32_16x16x32_bf16 v[204:207], v[72:75], a[108:111], v[204:207]
buffer_store_dwordx2 v[226:227], v245, s[8:11], s30 offen sc1
v_mfma_f32_16x16x32_bf16 v[204:207], v[76:79], a[124:127], v[204:207]
v_fma_f32 v208, v208, v239, v238
s_waitcnt lgkmcnt(4)
v_mfma_f32_16x16x32_bf16 v[176:179], v[48:51], a[128:131], v[176:179]
v_fma_f32 v210, v210, v239, v238
v_mul_f32 v208, v208, v88
v_mfma_f32_16x16x32_bf16 v[176:179], v[52:55], a[144:147], v[176:179]
v_mul_f32 v210, v210, v89
v_mul_f32 v209, v88, v104
v_mfma_f32_16x16x32_bf16 v[180:183], v[48:51], a[132:135], v[180:183]
ds_read_b128 v[72:75], v7 offset:30720
v_mul_f32 v211, v89, v105
v_mfma_f32_16x16x32_bf16 v[180:183], v[52:55], a[148:151], v[180:183]
v_exp_f32 v208, v208
v_mfma_f32_16x16x32_bf16 v[184:187], v[48:51], a[136:139], v[184:187]
v_exp_f32 v210, v210
v_mfma_f32_16x16x32_bf16 v[184:187], v[52:55], a[152:155], v[184:187]
ds_read_b128 v[76:79], v7 offset:31744
v_fma_f32 v208, v208, v240, v240
v_mfma_f32_16x16x32_bf16 v[188:191], v[48:51], a[140:143], v[188:191]
v_fma_f32 v210, v210, v240, v240
v_mul_f32 v212, v90, v90
v_mfma_f32_16x16x32_bf16 v[188:191], v[52:55], a[156:159], v[188:191]
v_mul_f32 v214, v91, v91
s_waitcnt lgkmcnt(4)
v_mfma_f32_16x16x32_bf16 v[192:195], v[56:59], a[128:131], v[192:195]
s_waitcnt vmcnt(20)
v_fma_f32 v212, v212, v239, v238
v_mfma_f32_16x16x32_bf16 v[192:195], v[60:63], a[144:147], v[192:195]
s_barrier
v_mfma_f32_16x16x32_bf16 v[196:199], v[56:59], a[132:135], v[196:199]
ds_read_b128 v[48:51], v7 offset:32768
s_add_u32 m0, s22, 49152
v_mfma_f32_16x16x32_bf16 v[196:199], v[60:63], a[148:151], v[196:199]
v_add_u32 v3, 20480, v3
buffer_load_dwordx4 v3, s[8:11], 0 offen offset:0 sc1 lds
v_mfma_f32_16x16x32_bf16 v[200:203], v[56:59], a[136:139], v[200:203]
v_rcp_f32 v208, v208
v_mfma_f32_16x16x32_bf16 v[200:203], v[60:63], a[152:155], v[200:203]
ds_read_b128 v[52:55], v7 offset:33792
v_mul_f32 v209, v209, v208
v_mfma_f32_16x16x32_bf16 v[204:207], v[56:59], a[140:143], v[204:207]
v_rcp_f32 v210, v210
v_mfma_f32_16x16x32_bf16 v[204:207], v[60:63], a[156:159], v[204:207]
v_mul_f32 v211, v211, v210
s_waitcnt lgkmcnt(4)
v_mfma_f32_16x16x32_bf16 v[176:179], v[64:67], a[160:163], v[176:179]
buffer_load_dwordx4 v3, s[8:11], 0 offen offset:1024 sc1 lds
v_mfma_f32_16x16x32_bf16 v[176:179], v[68:71], a[176:179], v[176:179]
v_cvt_pk_bf16_f32 v228, v209, v211
v_fma_f32 v214, v214, v239, v238
v_mfma_f32_16x16x32_bf16 v[180:183], v[64:67], a[164:167], v[180:183]
ds_read_b128 v[56:59], v7 offset:34816
v_mul_f32 v212, v212, v90
v_mfma_f32_16x16x32_bf16 v[180:183], v[68:71], a[180:183], v[180:183]
v_mul_f32 v214, v214, v91
v_mul_f32 v213, v90, v106
v_mfma_f32_16x16x32_bf16 v[184:187], v[64:67], a[168:171], v[184:187]
buffer_load_dwordx4 v3, s[8:11], 0 offen offset:2048 sc1 lds
v_mfma_f32_16x16x32_bf16 v[184:187], v[68:71], a[184:187], v[184:187]
ds_read_b128 v[60:63], v7 offset:35840
v_mul_f32 v215, v91, v107
v_mfma_f32_16x16x32_bf16 v[188:191], v[64:67], a[172:175], v[188:191]
v_exp_f32 v212, v212
v_mfma_f32_16x16x32_bf16 v[188:191], v[68:71], a[188:191], v[188:191]
v_fma_f32 v212, v212, v240, v240
s_waitcnt lgkmcnt(4)
v_mfma_f32_16x16x32_bf16 v[192:195], v[72:75], a[160:163], v[192:195]
buffer_load_dwordx4 v3, s[8:11], 0 offen offset:3072 sc1 lds
v_mfma_f32_16x16x32_bf16 v[192:195], v[76:79], a[176:179], v[192:195]
s_add_u32 m0, s22, 53248
v_add_u32 v3, 4096, v3
v_mfma_f32_16x16x32_bf16 v[196:199], v[72:75], a[164:167], v[196:199]
ds_read_b128 v[64:67], v7 offset:36864
v_mul_f32 v208, v92, v92
v_mfma_f32_16x16x32_bf16 v[196:199], v[76:79], a[180:183], v[196:199]
v_exp_f32 v214, v214
v_mfma_f32_16x16x32_bf16 v[200:203], v[72:75], a[168:171], v[200:203]
buffer_load_dwordx4 v3, s[8:11], 0 offen offset:0 sc1 lds
v_mfma_f32_16x16x32_bf16 v[200:203], v[76:79], a[184:187], v[200:203]
ds_read_b128 v[68:71], v7 offset:37888
v_fma_f32 v214, v214, v240, v240
v_mfma_f32_16x16x32_bf16 v[204:207], v[72:75], a[172:175], v[204:207]
v_rcp_f32 v212, v212
v_mfma_f32_16x16x32_bf16 v[204:207], v[76:79], a[188:191], v[204:207]
v_mul_f32 v213, v213, v212
s_waitcnt lgkmcnt(4)
v_mfma_f32_16x16x32_bf16 v[176:179], v[48:51], a[192:195], v[176:179]
buffer_load_dwordx4 v3, s[8:11], 0 offen offset:1024 sc1 lds
v_mfma_f32_16x16x32_bf16 v[176:179], v[52:55], a[208:211], v[176:179]
v_rcp_f32 v214, v214
v_mfma_f32_16x16x32_bf16 v[180:183], v[48:51], a[196:199], v[180:183]
ds_read_b128 v[72:75], v7 offset:38912
v_mul_f32 v215, v215, v214
v_mfma_f32_16x16x32_bf16 v[180:183], v[52:55], a[212:215], v[180:183]
v_cvt_pk_bf16_f32 v229, v213, v215
v_mul_f32 v210, v93, v93
v_mfma_f32_16x16x32_bf16 v[184:187], v[48:51], a[200:203], v[184:187]
buffer_store_dwordx2 v[228:229], v246, s[8:11], s30 offen sc1
v_mfma_f32_16x16x32_bf16 v[184:187], v[52:55], a[216:219], v[184:187]
ds_read_b128 v[76:79], v7 offset:39936
v_fma_f32 v208, v208, v242, v241
v_mfma_f32_16x16x32_bf16 v[188:191], v[48:51], a[204:207], v[188:191]
v_fma_f32 v210, v210, v242, v241
v_mul_f32 v208, v208, v92
v_mfma_f32_16x16x32_bf16 v[188:191], v[52:55], a[220:223], v[188:191]
v_mul_f32 v210, v210, v93
s_waitcnt lgkmcnt(4)
v_mfma_f32_16x16x32_bf16 v[192:195], v[56:59], a[192:195], v[192:195]
v_exp_f32 v208, v208
v_mfma_f32_16x16x32_bf16 v[192:195], v[60:63], a[208:211], v[192:195]
v_exp_f32 v210, v210
v_mfma_f32_16x16x32_bf16 v[196:199], v[56:59], a[196:199], v[196:199]
ds_read_b128 v[48:51], v7 offset:40960
v_mul_f32 v209, v92, v108
v_mfma_f32_16x16x32_bf16 v[196:199], v[60:63], a[212:215], v[196:199]
v_mul_f32 v211, v93, v109
v_fma_f32 v208, v208, v243, v243
v_mfma_f32_16x16x32_bf16 v[200:203], v[56:59], a[200:203], v[200:203]
v_fma_f32 v210, v210, v243, v243
v_mul_f32 v212, v94, v94
v_mfma_f32_16x16x32_bf16 v[200:203], v[60:63], a[216:219], v[200:203]
ds_read_b128 v[52:55], v7 offset:41984
v_mul_f32 v214, v95, v95
v_mfma_f32_16x16x32_bf16 v[204:207], v[56:59], a[204:207], v[204:207]
v_rcp_f32 v208, v208
v_mfma_f32_16x16x32_bf16 v[204:207], v[60:63], a[220:223], v[204:207]
v_mul_f32 v209, v209, v208
s_waitcnt lgkmcnt(4)
v_mfma_f32_16x16x32_bf16 v[176:179], v[64:67], a[224:227], v[176:179]
v_rcp_f32 v210, v210
v_mfma_f32_16x16x32_bf16 v[176:179], v[68:71], a[240:243], v[176:179]
v_mul_f32 v211, v211, v210
v_cvt_pk_bf16_f32 v230, v209, v211
v_mfma_f32_16x16x32_bf16 v[180:183], v[64:67], a[228:231], v[180:183]
ds_read_b128 v[56:59], v7 offset:43008
v_fma_f32 v212, v212, v242, v241
v_mfma_f32_16x16x32_bf16 v[180:183], v[68:71], a[244:247], v[180:183]
v_fma_f32 v214, v214, v242, v241
v_mul_f32 v212, v212, v94
v_mfma_f32_16x16x32_bf16 v[184:187], v[64:67], a[232:235], v[184:187]
v_mul_f32 v214, v214, v95
v_mul_f32 v213, v94, v110
v_mfma_f32_16x16x32_bf16 v[184:187], v[68:71], a[248:251], v[184:187]
ds_read_b128 v[60:63], v7 offset:44032
v_mul_f32 v215, v95, v111
v_mfma_f32_16x16x32_bf16 v[188:191], v[64:67], a[236:239], v[188:191]
v_exp_f32 v212, v212
v_mfma_f32_16x16x32_bf16 v[188:191], v[68:71], a[252:255], v[188:191]
v_fma_f32 v212, v212, v243, v243
s_waitcnt lgkmcnt(4)
v_mfma_f32_16x16x32_bf16 v[192:195], v[72:75], a[224:227], v[192:195]
v_exp_f32 v214, v214
v_mfma_f32_16x16x32_bf16 v[192:195], v[76:79], a[240:243], v[192:195]
v_fma_f32 v214, v214, v243, v243
v_mul_f32 v208, v112, v112
v_mfma_f32_16x16x32_bf16 v[196:199], v[72:75], a[228:231], v[196:199]
ds_read_b128 v[64:67], v7 offset:45056
v_mul_f32 v210, v113, v113
v_mfma_f32_16x16x32_bf16 v[196:199], v[76:79], a[244:247], v[196:199]
v_rcp_f32 v212, v212
v_mfma_f32_16x16x32_bf16 v[200:203], v[72:75], a[232:235], v[200:203]
v_rcp_f32 v214, v214
v_mfma_f32_16x16x32_bf16 v[200:203], v[76:79], a[248:251], v[200:203]
ds_read_b128 v[68:71], v7 offset:46080
v_mul_f32 v213, v213, v212
v_mfma_f32_16x16x32_bf16 v[204:207], v[72:75], a[236:239], v[204:207]
v_mul_f32 v215, v215, v214
v_cvt_pk_bf16_f32 v231, v213, v215
v_mfma_f32_16x16x32_bf16 v[204:207], v[76:79], a[252:255], v[204:207]
v_fma_f32 v208, v208, v233, v232
s_waitcnt lgkmcnt(4)
v_mfma_f32_16x16x32_bf16 v[176:179], v[48:51], v[16:19], v[176:179]
buffer_store_dwordx2 v[230:231], v247, s[8:11], s30 offen sc1
v_mfma_f32_16x16x32_bf16 v[176:179], v[52:55], v[32:35], v[176:179]
v_fma_f32 v210, v210, v233, v232
v_mul_f32 v208, v208, v112
v_mfma_f32_16x16x32_bf16 v[180:183], v[48:51], v[20:23], v[180:183]
ds_read_b128 v[72:75], v7 offset:47104
v_mul_f32 v210, v210, v113
v_mfma_f32_16x16x32_bf16 v[180:183], v[52:55], v[36:39], v[180:183]
v_exp_f32 v208, v208
v_mfma_f32_16x16x32_bf16 v[184:187], v[48:51], v[24:27], v[184:187]
v_exp_f32 v210, v210
v_mfma_f32_16x16x32_bf16 v[184:187], v[52:55], v[40:43], v[184:187]
ds_read_b128 v[76:79], v7 offset:48128
v_mul_f32 v209, v112, v128
v_mfma_f32_16x16x32_bf16 v[188:191], v[48:51], v[28:31], v[188:191]
v_mul_f32 v211, v113, v129
v_fma_f32 v208, v208, v234, v234
v_mfma_f32_16x16x32_bf16 v[188:191], v[52:55], v[44:47], v[188:191]
v_fma_f32 v210, v210, v234, v234
s_waitcnt lgkmcnt(4)
v_mfma_f32_16x16x32_bf16 v[192:195], v[56:59], v[16:19], v[192:195]
v_rcp_f32 v208, v208
v_mfma_f32_16x16x32_bf16 v[192:195], v[60:63], v[32:35], v[192:195]
v_rcp_f32 v210, v210
v_mfma_f32_16x16x32_bf16 v[196:199], v[56:59], v[20:23], v[196:199]
ds_read_b128 v[48:51], v7 offset:49152
v_mul_f32 v209, v209, v208
v_mfma_f32_16x16x32_bf16 v[196:199], v[60:63], v[36:39], v[196:199]
v_mul_f32 v211, v211, v210
v_cvt_pk_bf16_f32 v144, v209, v211
v_mfma_f32_16x16x32_bf16 v[200:203], v[56:59], v[24:27], v[200:203]
v_mul_f32 v212, v114, v114
v_mul_f32 v214, v115, v115
v_mfma_f32_16x16x32_bf16 v[200:203], v[60:63], v[40:43], v[200:203]
ds_read_b128 v[52:55], v7 offset:50176
v_fma_f32 v212, v212, v233, v232
v_mfma_f32_16x16x32_bf16 v[204:207], v[56:59], v[28:31], v[204:207]
v_fma_f32 v214, v214, v233, v232
v_mul_f32 v212, v212, v114
v_mfma_f32_16x16x32_bf16 v[204:207], v[60:63], v[44:47], v[204:207]
v_mul_f32 v214, v214, v115
s_waitcnt lgkmcnt(4)
v_mfma_f32_16x16x32_bf16 v[80:83], v[64:67], a[0:3], 0
v_exp_f32 v212, v212
v_mfma_f32_16x16x32_bf16 v[80:83], v[68:71], a[16:19], v[80:83]
v_exp_f32 v214, v214
v_mfma_f32_16x16x32_bf16 v[84:87], v[64:67], a[4:7], 0
ds_read_b128 v[56:59], v7 offset:51200
v_mul_f32 v213, v114, v130
v_mfma_f32_16x16x32_bf16 v[84:87], v[68:71], a[20:23], v[84:87]
v_mul_f32 v215, v115, v131
v_fma_f32 v212, v212, v234, v234
v_mfma_f32_16x16x32_bf16 v[88:91], v[64:67], a[8:11], 0
v_fma_f32 v214, v214, v234, v234
v_mul_f32 v208, v116, v116
v_mfma_f32_16x16x32_bf16 v[88:91], v[68:71], a[24:27], v[88:91]
ds_read_b128 v[60:63], v7 offset:52224
v_mul_f32 v210, v117, v117
v_mfma_f32_16x16x32_bf16 v[92:95], v[64:67], a[12:15], 0
v_rcp_f32 v212, v212
v_mfma_f32_16x16x32_bf16 v[92:95], v[68:71], a[28:31], v[92:95]
v_mul_f32 v213, v213, v212
s_waitcnt lgkmcnt(4)
v_mfma_f32_16x16x32_bf16 v[96:99], v[72:75], a[0:3], 0
v_rcp_f32 v214, v214
v_mfma_f32_16x16x32_bf16 v[96:99], v[76:79], a[16:19], v[96:99]
v_mul_f32 v215, v215, v214
v_cvt_pk_bf16_f32 v145, v213, v215
v_mfma_f32_16x16x32_bf16 v[100:103], v[72:75], a[4:7], 0
ds_read_b128 v[64:67], v7 offset:53248
v_fma_f32 v208, v208, v236, v235
v_mfma_f32_16x16x32_bf16 v[100:103], v[76:79], a[20:23], v[100:103]
v_fma_f32 v210, v210, v236, v235
v_mul_f32 v208, v208, v116
v_mfma_f32_16x16x32_bf16 v[104:107], v[72:75], a[8:11], 0
v_mul_f32 v210, v210, v117
v_mul_f32 v209, v116, v132
v_mfma_f32_16x16x32_bf16 v[104:107], v[76:79], a[24:27], v[104:107]
ds_read_b128 v[68:71], v7 offset:54272
v_mul_f32 v211, v117, v133
v_mfma_f32_16x16x32_bf16 v[108:111], v[72:75], a[12:15], 0
v_exp_f32 v208, v208
v_mfma_f32_16x16x32_bf16 v[108:111], v[76:79], a[28:31], v[108:111]
v_fma_f32 v208, v208, v237, v237
s_waitcnt lgkmcnt(4)
v_mfma_f32_16x16x32_bf16 v[80:83], v[48:51], a[32:35], v[80:83]
v_exp_f32 v210, v210
v_mfma_f32_16x16x32_bf16 v[80:83], v[52:55], a[48:51], v[80:83]
v_fma_f32 v210, v210, v237, v237
v_mul_f32 v212, v118, v118
v_mfma_f32_16x16x32_bf16 v[84:87], v[48:51], a[36:39], v[84:87]
ds_read_b128 v[72:75], v7 offset:55296
v_mul_f32 v214, v119, v119
v_mfma_f32_16x16x32_bf16 v[84:87], v[52:55], a[52:55], v[84:87]
v_rcp_f32 v208, v208
v_mfma_f32_16x16x32_bf16 v[88:91], v[48:51], a[40:43], v[88:91]
v_rcp_f32 v210, v210
v_mfma_f32_16x16x32_bf16 v[88:91], v[52:55], a[56:59], v[88:91]
ds_read_b128 v[76:79], v7 offset:56320
v_mul_f32 v209, v209, v208
v_mfma_f32_16x16x32_bf16 v[92:95], v[48:51], a[44:47], v[92:95]
v_mul_f32 v211, v211, v210
v_cvt_pk_bf16_f32 v148, v209, v211
v_mfma_f32_16x16x32_bf16 v[92:95], v[52:55], a[60:63], v[92:95]
v_fma_f32 v212, v212, v236, v235
s_waitcnt lgkmcnt(4)
v_mfma_f32_16x16x32_bf16 v[96:99], v[56:59], a[32:35], v[96:99]
s_waitcnt vmcnt(22)
v_fma_f32 v214, v214, v236, v235
v_mfma_f32_16x16x32_bf16 v[96:99], v[60:63], a[48:51], v[96:99]
s_barrier
v_mfma_f32_16x16x32_bf16 v[100:103], v[56:59], a[36:39], v[100:103]
ds_read_b128 v[48:51], v7 offset:57344
s_add_u32 m0, s22, 73728
v_mfma_f32_16x16x32_bf16 v[100:103], v[60:63], a[52:55], v[100:103]
v_add_u32 v3, 20480, v3
buffer_load_dwordx4 v3, s[8:11], 0 offen offset:0 sc1 lds
v_mfma_f32_16x16x32_bf16 v[104:107], v[56:59], a[40:43], v[104:107]
v_mul_f32 v212, v212, v118
v_mul_f32 v214, v214, v119
v_mfma_f32_16x16x32_bf16 v[104:107], v[60:63], a[56:59], v[104:107]
ds_read_b128 v[52:55], v7 offset:58368
v_mul_f32 v213, v118, v134
v_mfma_f32_16x16x32_bf16 v[108:111], v[56:59], a[44:47], v[108:111]
v_exp_f32 v212, v212
v_mfma_f32_16x16x32_bf16 v[108:111], v[60:63], a[60:63], v[108:111]
v_mul_f32 v215, v119, v135
s_waitcnt lgkmcnt(4)
v_mfma_f32_16x16x32_bf16 v[80:83], v[64:67], a[64:67], v[80:83]
buffer_load_dwordx4 v3, s[8:11], 0 offen offset:1024 sc1 lds
v_mfma_f32_16x16x32_bf16 v[80:83], v[68:71], a[80:83], v[80:83]
v_exp_f32 v214, v214
v_mfma_f32_16x16x32_bf16 v[84:87], v[64:67], a[68:71], v[84:87]
ds_read_b128 v[56:59], v7 offset:59392
v_fma_f32 v212, v212, v237, v237
v_mfma_f32_16x16x32_bf16 v[84:87], v[68:71], a[84:87], v[84:87]
v_fma_f32 v214, v214, v237, v237
v_mul_f32 v208, v120, v120
v_mfma_f32_16x16x32_bf16 v[88:91], v[64:67], a[72:75], v[88:91]
buffer_load_dwordx4 v3, s[8:11], 0 offen offset:2048 sc1 lds
v_mfma_f32_16x16x32_bf16 v[88:91], v[68:71], a[88:91], v[88:91]
ds_read_b128 v[60:63], v7 offset:60416
v_mul_f32 v210, v121, v121
v_mfma_f32_16x16x32_bf16 v[92:95], v[64:67], a[76:79], v[92:95]
v_rcp_f32 v212, v212
v_mfma_f32_16x16x32_bf16 v[92:95], v[68:71], a[92:95], v[92:95]
v_mul_f32 v213, v213, v212
s_waitcnt lgkmcnt(4)
v_mfma_f32_16x16x32_bf16 v[96:99], v[72:75], a[64:67], v[96:99]
buffer_load_dwordx4 v3, s[8:11], 0 offen offset:3072 sc1 lds
v_mfma_f32_16x16x32_bf16 v[96:99], v[76:79], a[80:83], v[96:99]
s_add_u32 m0, s22, 77824
v_add_u32 v3, 4096, v3
v_mfma_f32_16x16x32_bf16 v[100:103], v[72:75], a[68:71], v[100:103]
ds_read_b128 v[64:67], v7 offset:61440
v_fma_f32 v208, v208, v239, v238
v_mfma_f32_16x16x32_bf16 v[100:103], v[76:79], a[84:87], v[100:103]
v_rcp_f32 v214, v214
v_mfma_f32_16x16x32_bf16 v[104:107], v[72:75], a[72:75], v[104:107]
buffer_load_dwordx4 v3, s[8:11], 0 offen offset:0 sc1 lds
v_mfma_f32_16x16x32_bf16 v[104:107], v[76:79], a[88:91], v[104:107]
ds_read_b128 v[68:71], v7 offset:62464
v_mul_f32 v215, v215, v214
v_mfma_f32_16x16x32_bf16 v[108:111], v[72:75], a[76:79], v[108:111]
v_cvt_pk_bf16_f32 v149, v213, v215
v_fma_f32 v210, v210, v239, v238
v_mfma_f32_16x16x32_bf16 v[108:111], v[76:79], a[92:95], v[108:111]
v_mul_f32 v208, v208, v120
s_waitcnt lgkmcnt(4)
v_mfma_f32_16x16x32_bf16 v[80:83], v[48:51], a[96:99], v[80:83]
buffer_load_dwordx4 v3, s[8:11], 0 offen offset:1024 sc1 lds
v_mfma_f32_16x16x32_bf16 v[80:83], v[52:55], a[112:115], v[80:83]
v_mul_f32 v210, v210, v121
v_mul_f32 v209, v120, v136
v_mfma_f32_16x16x32_bf16 v[84:87], v[48:51], a[100:103], v[84:87]
ds_read_b128 v[72:75], v7 offset:63488
v_mul_f32 v211, v121, v137
v_mfma_f32_16x16x32_bf16 v[84:87], v[52:55], a[116:119], v[84:87]
v_exp_f32 v208, v208
v_mfma_f32_16x16x32_bf16 v[88:91], v[48:51], a[104:107], v[88:91]
v_exp_f32 v210, v210
v_mfma_f32_16x16x32_bf16 v[88:91], v[52:55], a[120:123], v[88:91]
ds_read_b128 v[76:79], v7 offset:64512
v_fma_f32 v208, v208, v240, v240
v_mfma_f32_16x16x32_bf16 v[92:95], v[48:51], a[108:111], v[92:95]
v_fma_f32 v210, v210, v240, v240
v_mul_f32 v212, v122, v122
v_mfma_f32_16x16x32_bf16 v[92:95], v[52:55], a[124:127], v[92:95]
v_mul_f32 v214, v123, v123
s_waitcnt lgkmcnt(4)
v_mfma_f32_16x16x32_bf16 v[96:99], v[56:59], a[96:99], v[96:99]
v_rcp_f32 v208, v208
v_mfma_f32_16x16x32_bf16 v[96:99], v[60:63], a[112:115], v[96:99]
v_rcp_f32 v210, v210
v_mfma_f32_16x16x32_bf16 v[100:103], v[56:59], a[100:103], v[100:103]
ds_read_b128 v[48:51], v8 offset:0
v_mul_f32 v209, v209, v208
v_mfma_f32_16x16x32_bf16 v[100:103], v[60:63], a[116:119], v[100:103]
v_mul_f32 v211, v211, v210
v_cvt_pk_bf16_f32 v152, v209, v211
v_mfma_f32_16x16x32_bf16 v[104:107], v[56:59], a[104:107], v[104:107]
v_fma_f32 v212, v212, v239, v238
v_fma_f32 v214, v214, v239, v238
v_mfma_f32_16x16x32_bf16 v[104:107], v[60:63], a[120:123], v[104:107]
ds_read_b128 v[52:55], v8 offset:1024
v_mul_f32 v212, v212, v122
v_mfma_f32_16x16x32_bf16 v[108:111], v[56:59], a[108:111], v[108:111]
v_mul_f32 v214, v214, v123
v_mul_f32 v213, v122, v138
v_mfma_f32_16x16x32_bf16 v[108:111], v[60:63], a[124:127], v[108:111]
v_mul_f32 v215, v123, v139
s_waitcnt lgkmcnt(4)
v_mfma_f32_16x16x32_bf16 v[80:83], v[64:67], a[128:131], v[80:83]
v_exp_f32 v212, v212
v_mfma_f32_16x16x32_bf16 v[80:83], v[68:71], a[144:147], v[80:83]
v_exp_f32 v214, v214
v_mfma_f32_16x16x32_bf16 v[84:87], v[64:67], a[132:135], v[84:87]
ds_read_b128 v[56:59], v8 offset:2048
v_fma_f32 v212, v212, v240, v240
v_mfma_f32_16x16x32_bf16 v[84:87], v[68:71], a[148:151], v[84:87]
v_fma_f32 v214, v214, v240, v240
v_mul_f32 v208, v124, v124
v_mfma_f32_16x16x32_bf16 v[88:91], v[64:67], a[136:139], v[88:91]
v_rcp_f32 v212, v212
v_mfma_f32_16x16x32_bf16 v[88:91], v[68:71], a[152:155], v[88:91]
ds_read_b128 v[60:63], v8 offset:3072
v_mul_f32 v213, v213, v212
v_mfma_f32_16x16x32_bf16 v[92:95], v[64:67], a[140:143], v[92:95]
v_rcp_f32 v214, v214
v_mfma_f32_16x16x32_bf16 v[92:95], v[68:71], a[156:159], v[92:95]
v_mul_f32 v215, v215, v214
s_waitcnt lgkmcnt(4)
v_mfma_f32_16x16x32_bf16 v[96:99], v[72:75], a[128:131], v[96:99]
v_cvt_pk_bf16_f32 v153, v213, v215
v_mul_f32 v210, v125, v125
v_mfma_f32_16x16x32_bf16 v[96:99], v[76:79], a[144:147], v[96:99]
v_fma_f32 v208, v208, v242, v241
v_fma_f32 v210, v210, v242, v241
v_mfma_f32_16x16x32_bf16 v[100:103], v[72:75], a[132:135], v[100:103]
ds_read_b128 v[64:67], v8 offset:4096
v_mul_f32 v208, v208, v124
v_mfma_f32_16x16x32_bf16 v[100:103], v[76:79], a[148:151], v[100:103]
v_mul_f32 v210, v210, v125
v_mul_f32 v209, v124, v140
v_mfma_f32_16x16x32_bf16 v[104:107], v[72:75], a[136:139], v[104:107]
v_exp_f32 v208, v208
v_mfma_f32_16x16x32_bf16 v[104:107], v[76:79], a[152:155], v[104:107]
ds_read_b128 v[68:71], v8 offset:5120
v_mul_f32 v211, v125, v141
v_mfma_f32_16x16x32_bf16 v[108:111], v[72:75], a[140:143], v[108:111]
v_exp_f32 v210, v210
v_mfma_f32_16x16x32_bf16 v[108:111], v[76:79], a[156:159], v[108:111]
v_fma_f32 v208, v208, v243, v243
s_waitcnt lgkmcnt(4)
v_mfma_f32_16x16x32_bf16 v[80:83], v[48:51], a[160:163], v[80:83]
v_fma_f32 v210, v210, v243, v243
v_mul_f32 v212, v126, v126
v_mfma_f32_16x16x32_bf16 v[80:83], v[52:55], a[176:179], v[80:83]
v_rcp_f32 v208, v208
v_mfma_f32_16x16x32_bf16 v[84:87], v[48:51], a[164:167], v[84:87]
ds_read_b128 v[72:75], v8 offset:6144
v_mul_f32 v209, v209, v208
v_mfma_f32_16x16x32_bf16 v[84:87], v[52:55], a[180:183], v[84:87]
v_rcp_f32 v210, v210
v_mfma_f32_16x16x32_bf16 v[88:91], v[48:51], a[168:171], v[88:91]
v_mul_f32 v211, v211, v210
v_cvt_pk_bf16_f32 v156, v209, v211
v_mfma_f32_16x16x32_bf16 v[88:91], v[52:55], a[184:187], v[88:91]
ds_read_b128 v[76:79], v8 offset:7168
v_mul_f32 v214, v127, v127
v_mfma_f32_16x16x32_bf16 v[92:95], v[48:51], a[172:175], v[92:95]
v_fma_f32 v212, v212, v242, v241
v_fma_f32 v214, v214, v242, v241
v_mfma_f32_16x16x32_bf16 v[92:95], v[52:55], a[188:191], v[92:95]
v_mul_f32 v212, v212, v126
s_waitcnt lgkmcnt(4)
v_mfma_f32_16x16x32_bf16 v[96:99], v[56:59], a[160:163], v[96:99]
v_mul_f32 v214, v214, v127
v_mul_f32 v213, v126, v142
v_mfma_f32_16x16x32_bf16 v[96:99], v[60:63], a[176:179], v[96:99]
v_exp_f32 v212, v212
v_mfma_f32_16x16x32_bf16 v[100:103], v[56:59], a[164:167], v[100:103]
ds_read_b128 v[48:51], v8 offset:8192
v_mul_f32 v215, v127, v143
v_mfma_f32_16x16x32_bf16 v[100:103], v[60:63], a[180:183], v[100:103]
v_exp_f32 v214, v214
v_mfma_f32_16x16x32_bf16 v[104:107], v[56:59], a[168:171], v[104:107]
v_fma_f32 v212, v212, v243, v243
v_fma_f32 v214, v214, v243, v243
v_mfma_f32_16x16x32_bf16 v[104:107], v[60:63], a[184:187], v[104:107]
ds_read_b128 v[52:55], v8 offset:9216
v_mul_f32 v216, v176, v176
v_mfma_f32_16x16x32_bf16 v[108:111], v[56:59], a[172:175], v[108:111]
v_rcp_f32 v212, v212
v_mfma_f32_16x16x32_bf16 v[108:111], v[60:63], a[188:191], v[108:111]
v_mul_f32 v213, v213, v212
s_waitcnt lgkmcnt(4)
v_mfma_f32_16x16x32_bf16 v[80:83], v[64:67], a[192:195], v[80:83]
v_rcp_f32 v214, v214
v_mfma_f32_16x16x32_bf16 v[80:83], v[68:71], a[208:211], v[80:83]
v_mul_f32 v215, v215, v214
v_cvt_pk_bf16_f32 v157, v213, v215
v_mfma_f32_16x16x32_bf16 v[84:87], v[64:67], a[196:199], v[84:87]
ds_read_b128 v[56:59], v8 offset:10240
v_mul_f32 v218, v177, v177
v_mfma_f32_16x16x32_bf16 v[84:87], v[68:71], a[212:215], v[84:87]
v_fma_f32 v216, v216, v233, v232
v_fma_f32 v218, v218, v233, v232
v_mfma_f32_16x16x32_bf16 v[88:91], v[64:67], a[200:203], v[88:91]
v_mul_f32 v216, v216, v176
v_mul_f32 v218, v218, v177
v_mfma_f32_16x16x32_bf16 v[88:91], v[68:71], a[216:219], v[88:91]
ds_read_b128 v[60:63], v8 offset:11264
v_mul_f32 v217, v176, v192
v_mfma_f32_16x16x32_bf16 v[92:95], v[64:67], a[204:207], v[92:95]
v_exp_f32 v216, v216
v_mfma_f32_16x16x32_bf16 v[92:95], v[68:71], a[220:223], v[92:95]
v_mul_f32 v219, v177, v193
s_waitcnt lgkmcnt(4)
v_mfma_f32_16x16x32_bf16 v[96:99], v[72:75], a[192:195], v[96:99]
v_exp_f32 v218, v218
v_mfma_f32_16x16x32_bf16 v[96:99], v[76:79], a[208:211], v[96:99]
v_fma_f32 v216, v216, v234, v234
v_fma_f32 v218, v218, v234, v234
v_mfma_f32_16x16x32_bf16 v[100:103], v[72:75], a[196:199], v[100:103]
ds_read_b128 v[64:67], v8 offset:12288
v_mul_f32 v220, v178, v178
v_mfma_f32_16x16x32_bf16 v[100:103], v[76:79], a[212:215], v[100:103]
v_rcp_f32 v216, v216
v_mfma_f32_16x16x32_bf16 v[104:107], v[72:75], a[200:203], v[104:107]
v_rcp_f32 v218, v218
v_mfma_f32_16x16x32_bf16 v[104:107], v[76:79], a[216:219], v[104:107]
ds_read_b128 v[68:71], v8 offset:13312
v_mul_f32 v217, v217, v216
v_mfma_f32_16x16x32_bf16 v[108:111], v[72:75], a[204:207], v[108:111]
v_mul_f32 v219, v219, v218
v_cvt_pk_bf16_f32 v146, v217, v219
v_mfma_f32_16x16x32_bf16 v[108:111], v[76:79], a[220:223], v[108:111]
v_mul_f32 v222, v179, v179
s_waitcnt lgkmcnt(4)
v_mfma_f32_16x16x32_bf16 v[80:83], v[48:51], a[224:227], v[80:83]
v_fma_f32 v220, v220, v233, v232
v_fma_f32 v222, v222, v233, v232
v_mfma_f32_16x16x32_bf16 v[80:83], v[52:55], a[240:243], v[80:83]
v_mul_f32 v220, v220, v178
v_mul_f32 v222, v222, v179
v_mfma_f32_16x16x32_bf16 v[84:87], v[48:51], a[228:231], v[84:87]
ds_read_b128 v[72:75], v8 offset:14336
v_mul_f32 v221, v178, v194
v_mfma_f32_16x16x32_bf16 v[84:87], v[52:55], a[244:247], v[84:87]
v_exp_f32 v220, v220
v_mfma_f32_16x16x32_bf16 v[88:91], v[48:51], a[232:235], v[88:91]
v_exp_f32 v222, v222
v_mfma_f32_16x16x32_bf16 v[88:91], v[52:55], a[248:251], v[88:91]
ds_read_b128 v[76:79], v8 offset:15360
v_mul_f32 v223, v179, v195
v_mfma_f32_16x16x32_bf16 v[92:95], v[48:51], a[236:239], v[92:95]
v_fma_f32 v220, v220, v234, v234
v_fma_f32 v222, v222, v234, v234
v_mfma_f32_16x16x32_bf16 v[92:95], v[52:55], a[252:255], v[92:95]
v_mul_f32 v216, v180, v180
s_waitcnt lgkmcnt(4)
v_mfma_f32_16x16x32_bf16 v[96:99], v[56:59], a[224:227], v[96:99]
s_waitcnt vmcnt(22)
v_mul_f32 v218, v181, v181
v_mfma_f32_16x16x32_bf16 v[96:99], v[60:63], a[240:243], v[96:99]
s_barrier
v_mfma_f32_16x16x32_bf16 v[100:103], v[56:59], a[228:231], v[100:103]
ds_read_b128 v[48:51], v2 offset:0
s_add_u32 m0, s22, 98304
v_mfma_f32_16x16x32_bf16 v[100:103], v[60:63], a[244:247], v[100:103]
v_add_u32 v3, 20480, v3
buffer_load_dwordx4 v3, s[8:11], 0 offen offset:0 sc1 lds
v_mfma_f32_16x16x32_bf16 v[104:107], v[56:59], a[232:235], v[104:107]
v_rcp_f32 v220, v220
v_mfma_f32_16x16x32_bf16 v[104:107], v[60:63], a[248:251], v[104:107]
ds_read_b128 v[52:55], v2 offset:1024
v_mul_f32 v221, v221, v220
v_mfma_f32_16x16x32_bf16 v[108:111], v[56:59], a[236:239], v[108:111]
v_rcp_f32 v222, v222
v_mfma_f32_16x16x32_bf16 v[108:111], v[60:63], a[252:255], v[108:111]
v_mul_f32 v223, v223, v222
s_waitcnt lgkmcnt(4)
v_mfma_f32_16x16x32_bf16 v[80:83], v[64:67], v[16:19], v[80:83]
buffer_load_dwordx4 v3, s[8:11], 0 offen offset:1024 sc1 lds
v_mfma_f32_16x16x32_bf16 v[80:83], v[68:71], v[32:35], v[80:83]
v_cvt_pk_bf16_f32 v147, v221, v223
v_fma_f32 v216, v216, v236, v235
v_mfma_f32_16x16x32_bf16 v[84:87], v[64:67], v[20:23], v[84:87]
ds_read_b128 v[56:59], v2 offset:2048
v_fma_f32 v218, v218, v236, v235
v_mfma_f32_16x16x32_bf16 v[84:87], v[68:71], v[36:39], v[84:87]
buffer_store_dwordx4 v[144:147], v2, s[8:11], s24 offen offset:0 sc1
v_mfma_f32_16x16x32_bf16 v[88:91], v[64:67], v[24:27], v[88:91]
v_mul_f32 v216, v216, v180
v_mul_f32 v218, v218, v181
v_mfma_f32_16x16x32_bf16 v[88:91], v[68:71], v[40:43], v[88:91]
ds_read_b128 v[60:63], v2 offset:3072
v_mul_f32 v217, v180, v196
v_mfma_f32_16x16x32_bf16 v[92:95], v[64:67], v[28:31], v[92:95]
v_exp_f32 v216, v216
v_mfma_f32_16x16x32_bf16 v[92:95], v[68:71], v[44:47], v[92:95]
v_mul_f32 v219, v181, v197
s_waitcnt lgkmcnt(4)
v_mfma_f32_16x16x32_bf16 v[96:99], v[72:75], v[16:19], v[96:99]
buffer_load_dwordx4 v3, s[8:11], 0 offen offset:2048 sc1 lds
v_mfma_f32_16x16x32_bf16 v[96:99], v[76:79], v[32:35], v[96:99]
v_exp_f32 v218, v218
v_mfma_f32_16x16x32_bf16 v[100:103], v[72:75], v[20:23], v[100:103]
ds_read_b128 v[64:67], v2 offset:4096
v_fma_f32 v216, v216, v237, v237
v_mfma_f32_16x16x32_bf16 v[100:103], v[76:79], v[36:39], v[100:103]
v_fma_f32 v218, v218, v237, v237
v_mul_f32 v220, v182, v182
v_mfma_f32_16x16x32_bf16 v[104:107], v[72:75], v[24:27], v[104:107]
buffer_load_dwordx4 v3, s[8:11], 0 offen offset:3072 sc1 lds
v_mfma_f32_16x16x32_bf16 v[104:107], v[76:79], v[40:43], v[104:107]
ds_read_b128 v[68:71], v2 offset:5120
s_add_u32 m0, s22, 102400
v_mfma_f32_16x16x32_bf16 v[108:111], v[72:75], v[28:31], v[108:111]
v_add_u32 v3, 4096, v3
v_mul_f32 v222, v183, v183
v_mfma_f32_16x16x32_bf16 v[108:111], v[76:79], v[44:47], v[108:111]
v_fma_f32 v220, v220, v236, v235
s_waitcnt lgkmcnt(4)
v_mfma_f32_16x16x32_bf16 v[112:115], v[48:51], a[0:3], 0
buffer_load_dwordx4 v3, s[8:11], 0 offen offset:0 sc1 lds
v_mfma_f32_16x16x32_bf16 v[112:115], v[52:55], a[16:19], v[112:115]
v_rcp_f32 v216, v216
v_mfma_f32_16x16x32_bf16 v[116:119], v[48:51], a[4:7], 0
ds_read_b128 v[72:75], v2 offset:6144
v_mul_f32 v217, v217, v216
v_mfma_f32_16x16x32_bf16 v[116:119], v[52:55], a[20:23], v[116:119]
v_mul_f32 v208, v80, v80
v_mul_f32 v210, v81, v81
v_mfma_f32_16x16x32_bf16 v[120:123], v[48:51], a[8:11], 0
buffer_load_dwordx4 v3, s[8:11], 0 offen offset:1024 sc1 lds
v_mfma_f32_16x16x32_bf16 v[120:123], v[52:55], a[24:27], v[120:123]
ds_read_b128 v[76:79], v2 offset:7168
v_fma_f32 v208, v208, v233, v232
v_mfma_f32_16x16x32_bf16 v[124:127], v[48:51], a[12:15], 0
v_fma_f32 v210, v210, v233, v232
v_mul_f32 v208, v208, v80
v_mfma_f32_16x16x32_bf16 v[124:127], v[52:55], a[28:31], v[124:127]
v_mul_f32 v210, v210, v81
s_waitcnt lgkmcnt(4)
v_mfma_f32_16x16x32_bf16 v[128:131], v[56:59], a[0:3], 0
v_exp_f32 v208, v208
v_mfma_f32_16x16x32_bf16 v[128:131], v[60:63], a[16:19], v[128:131]
v_exp_f32 v210, v210
v_mfma_f32_16x16x32_bf16 v[132:135], v[56:59], a[4:7], 0
ds_read_b128 v[48:51], v2 offset:8192
v_mul_f32 v209, v80, v96
v_mfma_f32_16x16x32_bf16 v[132:135], v[60:63], a[20:23], v[132:135]
v_mul_f32 v211, v81, v97
v_fma_f32 v208, v208, v234, v234
v_mfma_f32_16x16x32_bf16 v[136:139], v[56:59], a[8:11], 0
v_fma_f32 v210, v210, v234, v234
v_mul_f32 v212, v82, v82
v_mfma_f32_16x16x32_bf16 v[136:139], v[60:63], a[24:27], v[136:139]
ds_read_b128 v[52:55], v2 offset:9216
v_mul_f32 v214, v83, v83
v_mfma_f32_16x16x32_bf16 v[140:143], v[56:59], a[12:15], 0
v_rcp_f32 v208, v208
v_mfma_f32_16x16x32_bf16 v[140:143], v[60:63], a[28:31], v[140:143]
v_mul_f32 v209, v209, v208
s_waitcnt lgkmcnt(4)
v_mfma_f32_16x16x32_bf16 v[112:115], v[64:67], a[32:35], v[112:115]
v_rcp_f32 v210, v210
v_mfma_f32_16x16x32_bf16 v[112:115], v[68:71], a[48:51], v[112:115]
v_mul_f32 v211, v211, v210
v_cvt_pk_bf16_f32 v160, v209, v211
v_mfma_f32_16x16x32_bf16 v[116:119], v[64:67], a[36:39], v[116:119]
ds_read_b128 v[56:59], v2 offset:10240
v_fma_f32 v212, v212, v233, v232
v_mfma_f32_16x16x32_bf16 v[116:119], v[68:71], a[52:55], v[116:119]
v_fma_f32 v214, v214, v233, v232
v_mul_f32 v212, v212, v82
v_mfma_f32_16x16x32_bf16 v[120:123], v[64:67], a[40:43], v[120:123]
v_mul_f32 v214, v214, v83
v_mul_f32 v213, v82, v98
v_mfma_f32_16x16x32_bf16 v[120:123], v[68:71], a[56:59], v[120:123]
ds_read_b128 v[60:63], v2 offset:11264
v_mul_f32 v215, v83, v99
v_mfma_f32_16x16x32_bf16 v[124:127], v[64:67], a[44:47], v[124:127]
v_exp_f32 v212, v212
v_mfma_f32_16x16x32_bf16 v[124:127], v[68:71], a[60:63], v[124:127]
v_fma_f32 v212, v212, v234, v234
s_waitcnt lgkmcnt(4)
v_mfma_f32_16x16x32_bf16 v[128:131], v[72:75], a[32:35], v[128:131]
v_exp_f32 v214, v214
v_mfma_f32_16x16x32_bf16 v[128:131], v[76:79], a[48:51], v[128:131]
v_fma_f32 v214, v214, v234, v234
v_mul_f32 v208, v84, v84
v_mfma_f32_16x16x32_bf16 v[132:135], v[72:75], a[36:39], v[132:135]
ds_read_b128 v[64:67], v2 offset:12288
v_mul_f32 v210, v85, v85
v_mfma_f32_16x16x32_bf16 v[132:135], v[76:79], a[52:55], v[132:135]
v_rcp_f32 v212, v212
v_mfma_f32_16x16x32_bf16 v[136:139], v[72:75], a[40:43], v[136:139]
v_rcp_f32 v214, v214
v_mfma_f32_16x16x32_bf16 v[136:139], v[76:79], a[56:59], v[136:139]
ds_read_b128 v[68:71], v2 offset:13312
v_mul_f32 v213, v213, v212
v_mfma_f32_16x16x32_bf16 v[140:143], v[72:75], a[44:47], v[140:143]
v_mul_f32 v215, v215, v214
v_cvt_pk_bf16_f32 v161, v213, v215
v_mfma_f32_16x16x32_bf16 v[140:143], v[76:79], a[60:63], v[140:143]
v_fma_f32 v208, v208, v236, v235
s_waitcnt lgkmcnt(4)
v_mfma_f32_16x16x32_bf16 v[112:115], v[48:51], a[64:67], v[112:115]
v_fma_f32 v210, v210, v236, v235
v_mul_f32 v208, v208, v84
v_mfma_f32_16x16x32_bf16 v[112:115], v[52:55], a[80:83], v[112:115]
v_mul_f32 v210, v210, v85
v_mul_f32 v209, v84, v100
v_mfma_f32_16x16x32_bf16 v[116:119], v[48:51], a[68:71], v[116:119]
ds_read_b128 v[72:75], v2 offset:14336
v_mul_f32 v211, v85, v101
v_mfma_f32_16x16x32_bf16 v[116:119], v[52:55], a[84:87], v[116:119]
v_exp_f32 v208, v208
v_mfma_f32_16x16x32_bf16 v[120:123], v[48:51], a[72:75], v[120:123]
v_exp_f32 v210, v210
v_mfma_f32_16x16x32_bf16 v[120:123], v[52:55], a[88:91], v[120:123]
ds_read_b128 v[76:79], v2 offset:15360
v_fma_f32 v208, v208, v237, v237
v_mfma_f32_16x16x32_bf16 v[124:127], v[48:51], a[76:79], v[124:127]
v_fma_f32 v210, v210, v237, v237
v_mul_f32 v212, v86, v86
v_mfma_f32_16x16x32_bf16 v[124:127], v[52:55], a[92:95], v[124:127]
v_mul_f32 v214, v87, v87
s_waitcnt lgkmcnt(4)
v_mfma_f32_16x16x32_bf16 v[128:131], v[56:59], a[64:67], v[128:131]
v_rcp_f32 v208, v208
v_mfma_f32_16x16x32_bf16 v[128:131], v[60:63], a[80:83], v[128:131]
v_rcp_f32 v210, v210
v_mfma_f32_16x16x32_bf16 v[132:135], v[56:59], a[68:71], v[132:135]
ds_read_b128 v[48:51], v2 offset:16384
v_mul_f32 v209, v209, v208
v_mfma_f32_16x16x32_bf16 v[132:135], v[60:63], a[84:87], v[132:135]
v_mul_f32 v211, v211, v210
v_cvt_pk_bf16_f32 v164, v209, v211
v_mfma_f32_16x16x32_bf16 v[136:139], v[56:59], a[72:75], v[136:139]
v_fma_f32 v212, v212, v236, v235
v_fma_f32 v214, v214, v236, v235
v_mfma_f32_16x16x32_bf16 v[136:139], v[60:63], a[88:91], v[136:139]
ds_read_b128 v[52:55], v2 offset:17408
v_mul_f32 v212, v212, v86
v_mfma_f32_16x16x32_bf16 v[140:143], v[56:59], a[76:79], v[140:143]
v_mul_f32 v214, v214, v87
v_mul_f32 v213, v86, v102
v_mfma_f32_16x16x32_bf16 v[140:143], v[60:63], a[92:95], v[140:143]
v_mul_f32 v215, v87, v103
s_waitcnt lgkmcnt(4)
v_mfma_f32_16x16x32_bf16 v[112:115], v[64:67], a[96:99], v[112:115]
v_exp_f32 v212, v212
v_mfma_f32_16x16x32_bf16 v[112:115], v[68:71], a[112:115], v[112:115]
v_exp_f32 v214, v214
v_mfma_f32_16x16x32_bf16 v[116:119], v[64:67], a[100:103], v[116:119]
ds_read_b128 v[56:59], v2 offset:18432
v_fma_f32 v212, v212, v237, v237
v_mfma_f32_16x16x32_bf16 v[116:119], v[68:71], a[116:119], v[116:119]
v_fma_f32 v214, v214, v237, v237
v_mul_f32 v208, v88, v88
v_mfma_f32_16x16x32_bf16 v[120:123], v[64:67], a[104:107], v[120:123]
v_rcp_f32 v212, v212
v_mfma_f32_16x16x32_bf16 v[120:123], v[68:71], a[120:123], v[120:123]
ds_read_b128 v[60:63], v2 offset:19456
v_mul_f32 v213, v213, v212
v_mfma_f32_16x16x32_bf16 v[124:127], v[64:67], a[108:111], v[124:127]
v_rcp_f32 v214, v214
v_mfma_f32_16x16x32_bf16 v[124:127], v[68:71], a[124:127], v[124:127]
v_mul_f32 v215, v215, v214
s_waitcnt lgkmcnt(4)
v_mfma_f32_16x16x32_bf16 v[128:131], v[72:75], a[96:99], v[128:131]
v_cvt_pk_bf16_f32 v165, v213, v215
v_mul_f32 v210, v89, v89
v_mfma_f32_16x16x32_bf16 v[128:131], v[76:79], a[112:115], v[128:131]
v_fma_f32 v208, v208, v239, v238
v_fma_f32 v210, v210, v239, v238
v_mfma_f32_16x16x32_bf16 v[132:135], v[72:75], a[100:103], v[132:135]
ds_read_b128 v[64:67], v2 offset:20480
v_mul_f32 v208, v208, v88
v_mfma_f32_16x16x32_bf16 v[132:135], v[76:79], a[116:119], v[132:135]
v_mul_f32 v210, v210, v89
v_mul_f32 v209, v88, v104
v_mfma_f32_16x16x32_bf16 v[136:139], v[72:75], a[104:107], v[136:139]
v_exp_f32 v208, v208
v_mfma_f32_16x16x32_bf16 v[136:139], v[76:79], a[120:123], v[136:139]
ds_read_b128 v[68:71], v2 offset:21504
v_mul_f32 v211, v89, v105
v_mfma_f32_16x16x32_bf16 v[140:143], v[72:75], a[108:111], v[140:143]
v_exp_f32 v210, v210
v_mfma_f32_16x16x32_bf16 v[140:143], v[76:79], a[124:127], v[140:143]
v_fma_f32 v208, v208, v240, v240
s_waitcnt lgkmcnt(4)
v_mfma_f32_16x16x32_bf16 v[112:115], v[48:51], a[128:131], v[112:115]
v_fma_f32 v210, v210, v240, v240
v_mul_f32 v212, v90, v90
v_mfma_f32_16x16x32_bf16 v[112:115], v[52:55], a[144:147], v[112:115]
v_rcp_f32 v208, v208
v_mfma_f32_16x16x32_bf16 v[116:119], v[48:51], a[132:135], v[116:119]
ds_read_b128 v[72:75], v2 offset:22528
v_mul_f32 v209, v209, v208
v_mfma_f32_16x16x32_bf16 v[116:119], v[52:55], a[148:151], v[116:119]
v_rcp_f32 v210, v210
v_mfma_f32_16x16x32_bf16 v[120:123], v[48:51], a[136:139], v[120:123]
v_mul_f32 v211, v211, v210
v_cvt_pk_bf16_f32 v168, v209, v211
v_mfma_f32_16x16x32_bf16 v[120:123], v[52:55], a[152:155], v[120:123]
ds_read_b128 v[76:79], v2 offset:23552
v_mul_f32 v214, v91, v91
v_mfma_f32_16x16x32_bf16 v[124:127], v[48:51], a[140:143], v[124:127]
v_fma_f32 v212, v212, v239, v238
v_fma_f32 v214, v214, v239, v238
v_mfma_f32_16x16x32_bf16 v[124:127], v[52:55], a[156:159], v[124:127]
v_mul_f32 v212, v212, v90
s_waitcnt lgkmcnt(4)
v_mfma_f32_16x16x32_bf16 v[128:131], v[56:59], a[128:131], v[128:131]
s_waitcnt vmcnt(23)
v_mul_f32 v214, v214, v91
v_mfma_f32_16x16x32_bf16 v[128:131], v[60:63], a[144:147], v[128:131]
s_barrier
v_mfma_f32_16x16x32_bf16 v[132:135], v[56:59], a[132:135], v[132:135]
ds_read_b128 v[48:51], v2 offset:24576
s_add_u32 m0, s22, 122880
v_mfma_f32_16x16x32_bf16 v[132:135], v[60:63], a[148:151], v[132:135]
v_add_u32 v3, 20480, v3
buffer_load_dwordx4 v3, s[8:11], 0 offen offset:0 sc1 lds
v_mfma_f32_16x16x32_bf16 v[136:139], v[56:59], a[136:139], v[136:139]
v_exp_f32 v212, v212
v_mfma_f32_16x16x32_bf16 v[136:139], v[60:63], a[152:155], v[136:139]
ds_read_b128 v[52:55], v2 offset:25600
v_mul_f32 v213, v90, v106
v_mfma_f32_16x16x32_bf16 v[140:143], v[56:59], a[140:143], v[140:143]
v_exp_f32 v214, v214
v_mfma_f32_16x16x32_bf16 v[140:143], v[60:63], a[156:159], v[140:143]
v_mul_f32 v215, v91, v107
s_waitcnt lgkmcnt(4)
v_mfma_f32_16x16x32_bf16 v[112:115], v[64:67], a[160:163], v[112:115]
buffer_load_dwordx4 v3, s[8:11], 0 offen offset:1024 sc1 lds
v_mfma_f32_16x16x32_bf16 v[112:115], v[68:71], a[176:179], v[112:115]
v_fma_f32 v212, v212, v240, v240
v_fma_f32 v214, v214, v240, v240
v_mfma_f32_16x16x32_bf16 v[116:119], v[64:67], a[164:167], v[116:119]
ds_read_b128 v[56:59], v2 offset:26624
v_mul_f32 v208, v92, v92
v_mfma_f32_16x16x32_bf16 v[116:119], v[68:71], a[180:183], v[116:119]
v_rcp_f32 v212, v212
v_mfma_f32_16x16x32_bf16 v[120:123], v[64:67], a[168:171], v[120:123]
buffer_load_dwordx4 v3, s[8:11], 0 offen offset:2048 sc1 lds
v_mfma_f32_16x16x32_bf16 v[120:123], v[68:71], a[184:187], v[120:123]
ds_read_b128 v[60:63], v2 offset:27648
v_mul_f32 v213, v213, v212
v_mfma_f32_16x16x32_bf16 v[124:127], v[64:67], a[172:175], v[124:127]
v_rcp_f32 v214, v214
v_mfma_f32_16x16x32_bf16 v[124:127], v[68:71], a[188:191], v[124:127]
v_mul_f32 v215, v215, v214
s_waitcnt lgkmcnt(4)
v_mfma_f32_16x16x32_bf16 v[128:131], v[72:75], a[160:163], v[128:131]
buffer_load_dwordx4 v3, s[8:11], 0 offen offset:3072 sc1 lds
v_mfma_f32_16x16x32_bf16 v[128:131], v[76:79], a[176:179], v[128:131]
s_add_u32 m0, s22, 126976
v_add_u32 v3, 4096, v3
v_mfma_f32_16x16x32_bf16 v[132:135], v[72:75], a[164:167], v[132:135]
ds_read_b128 v[64:67], v2 offset:28672
v_cvt_pk_bf16_f32 v169, v213, v215
v_mfma_f32_16x16x32_bf16 v[132:135], v[76:79], a[180:183], v[132:135]
v_mul_f32 v210, v93, v93
v_fma_f32 v208, v208, v242, v241
v_mfma_f32_16x16x32_bf16 v[136:139], v[72:75], a[168:171], v[136:139]
buffer_load_dwordx4 v3, s[8:11], 0 offen offset:0 sc1 lds
v_mfma_f32_16x16x32_bf16 v[136:139], v[76:79], a[184:187], v[136:139]
ds_read_b128 v[68:71], v2 offset:29696
v_fma_f32 v210, v210, v242, v241
v_mfma_f32_16x16x32_bf16 v[140:143], v[72:75], a[172:175], v[140:143]
v_mul_f32 v208, v208, v92
v_mul_f32 v210, v210, v93
v_mfma_f32_16x16x32_bf16 v[140:143], v[76:79], a[188:191], v[140:143]
v_mul_f32 v209, v92, v108
s_waitcnt lgkmcnt(4)
v_mfma_f32_16x16x32_bf16 v[112:115], v[48:51], a[192:195], v[112:115]
buffer_load_dwordx4 v3, s[8:11], 0 offen offset:1024 sc1 lds
v_mfma_f32_16x16x32_bf16 v[112:115], v[52:55], a[208:211], v[112:115]
v_exp_f32 v208, v208
v_mfma_f32_16x16x32_bf16 v[116:119], v[48:51], a[196:199], v[116:119]
ds_read_b128 v[72:75], v2 offset:30720
v_mul_f32 v211, v93, v109
v_mfma_f32_16x16x32_bf16 v[116:119], v[52:55], a[212:215], v[116:119]
v_exp_f32 v210, v210
v_mfma_f32_16x16x32_bf16 v[120:123], v[48:51], a[200:203], v[120:123]
v_fma_f32 v208, v208, v243, v243
v_fma_f32 v210, v210, v243, v243
v_mfma_f32_16x16x32_bf16 v[120:123], v[52:55], a[216:219], v[120:123]
ds_read_b128 v[76:79], v2 offset:31744
v_mul_f32 v212, v94, v94
v_mfma_f32_16x16x32_bf16 v[124:127], v[48:51], a[204:207], v[124:127]
v_rcp_f32 v208, v208
v_mfma_f32_16x16x32_bf16 v[124:127], v[52:55], a[220:223], v[124:127]
v_mul_f32 v209, v209, v208
s_waitcnt lgkmcnt(4)
v_mfma_f32_16x16x32_bf16 v[128:131], v[56:59], a[192:195], v[128:131]
v_rcp_f32 v210, v210
v_mfma_f32_16x16x32_bf16 v[128:131], v[60:63], a[208:211], v[128:131]
v_mul_f32 v211, v211, v210
v_cvt_pk_bf16_f32 v172, v209, v211
v_mfma_f32_16x16x32_bf16 v[132:135], v[56:59], a[196:199], v[132:135]
ds_read_b128 v[48:51], v2 offset:32768
v_mul_f32 v214, v95, v95
v_mfma_f32_16x16x32_bf16 v[132:135], v[60:63], a[212:215], v[132:135]
v_fma_f32 v212, v212, v242, v241
v_fma_f32 v214, v214, v242, v241
v_mfma_f32_16x16x32_bf16 v[136:139], v[56:59], a[200:203], v[136:139]
v_mul_f32 v212, v212, v94
v_mul_f32 v214, v214, v95
v_mfma_f32_16x16x32_bf16 v[136:139], v[60:63], a[216:219], v[136:139]
ds_read_b128 v[52:55], v2 offset:33792
v_mul_f32 v213, v94, v110
v_mfma_f32_16x16x32_bf16 v[140:143], v[56:59], a[204:207], v[140:143]
v_exp_f32 v212, v212
v_mfma_f32_16x16x32_bf16 v[140:143], v[60:63], a[220:223], v[140:143]
v_mul_f32 v215, v95, v111
s_waitcnt lgkmcnt(4)
v_mfma_f32_16x16x32_bf16 v[112:115], v[64:67], a[224:227], v[112:115]
v_exp_f32 v214, v214
v_mfma_f32_16x16x32_bf16 v[112:115], v[68:71], a[240:243], v[112:115]
v_fma_f32 v212, v212, v243, v243
v_fma_f32 v214, v214, v243, v243
v_mfma_f32_16x16x32_bf16 v[116:119], v[64:67], a[228:231], v[116:119]
ds_read_b128 v[56:59], v2 offset:34816
v_fma_f32 v222, v222, v236, v235
v_mfma_f32_16x16x32_bf16 v[116:119], v[68:71], a[244:247], v[116:119]
v_rcp_f32 v212, v212
v_mfma_f32_16x16x32_bf16 v[120:123], v[64:67], a[232:235], v[120:123]
v_rcp_f32 v214, v214
v_mfma_f32_16x16x32_bf16 v[120:123], v[68:71], a[248:251], v[120:123]
ds_read_b128 v[60:63], v2 offset:35840
v_mul_f32 v213, v213, v212
v_mfma_f32_16x16x32_bf16 v[124:127], v[64:67], a[236:239], v[124:127]
v_mul_f32 v215, v215, v214
v_cvt_pk_bf16_f32 v173, v213, v215
v_mfma_f32_16x16x32_bf16 v[124:127], v[68:71], a[252:255], v[124:127]
v_mul_f32 v220, v220, v182
s_waitcnt lgkmcnt(4)
v_mfma_f32_16x16x32_bf16 v[128:131], v[72:75], a[224:227], v[128:131]
v_rcp_f32 v218, v218
v_mfma_f32_16x16x32_bf16 v[128:131], v[76:79], a[240:243], v[128:131]
v_mul_f32 v219, v219, v218
v_cvt_pk_bf16_f32 v150, v217, v219
v_mfma_f32_16x16x32_bf16 v[132:135], v[72:75], a[228:231], v[132:135]
ds_read_b128 v[64:67], v2 offset:36864
v_mul_f32 v222, v222, v183
v_mfma_f32_16x16x32_bf16 v[132:135], v[76:79], a[244:247], v[132:135]
v_exp_f32 v220, v220
v_mfma_f32_16x16x32_bf16 v[136:139], v[72:75], a[232:235], v[136:139]
v_exp_f32 v222, v222
v_mfma_f32_16x16x32_bf16 v[136:139], v[76:79], a[248:251], v[136:139]
ds_read_b128 v[68:71], v2 offset:37888
v_mul_f32 v221, v182, v198
v_mfma_f32_16x16x32_bf16 v[140:143], v[72:75], a[236:239], v[140:143]
v_mul_f32 v223, v183, v199
v_fma_f32 v220, v220, v237, v237
v_mfma_f32_16x16x32_bf16 v[140:143], v[76:79], a[252:255], v[140:143]
v_fma_f32 v222, v222, v237, v237
s_waitcnt lgkmcnt(4)
v_mfma_f32_16x16x32_bf16 v[112:115], v[48:51], v[16:19], v[112:115]
v_rcp_f32 v220, v220
v_mfma_f32_16x16x32_bf16 v[112:115], v[52:55], v[32:35], v[112:115]
v_rcp_f32 v222, v222
v_mfma_f32_16x16x32_bf16 v[116:119], v[48:51], v[20:23], v[116:119]
ds_read_b128 v[72:75], v2 offset:38912
v_mul_f32 v221, v221, v220
v_mfma_f32_16x16x32_bf16 v[116:119], v[52:55], v[36:39], v[116:119]
v_mul_f32 v223, v223, v222
v_cvt_pk_bf16_f32 v151, v221, v223
v_mfma_f32_16x16x32_bf16 v[120:123], v[48:51], v[24:27], v[120:123]
buffer_store_dwordx4 v[148:151], v4, s[8:11], s24 offen offset:0 sc1
v_mfma_f32_16x16x32_bf16 v[120:123], v[52:55], v[40:43], v[120:123]
ds_read_b128 v[76:79], v2 offset:39936
v_mul_f32 v216, v184, v184
v_mfma_f32_16x16x32_bf16 v[124:127], v[48:51], v[28:31], v[124:127]
v_mul_f32 v218, v185, v185
v_fma_f32 v216, v216, v239, v238
v_mfma_f32_16x16x32_bf16 v[124:127], v[52:55], v[44:47], v[124:127]
v_fma_f32 v218, v218, v239, v238
s_waitcnt lgkmcnt(4)
v_mfma_f32_16x16x32_bf16 v[128:131], v[56:59], v[16:19], v[128:131]
v_mul_f32 v216, v216, v184
v_mul_f32 v218, v218, v185
v_mfma_f32_16x16x32_bf16 v[128:131], v[60:63], v[32:35], v[128:131]
v_exp_f32 v216, v216
v_mfma_f32_16x16x32_bf16 v[132:135], v[56:59], v[20:23], v[132:135]
ds_read_b128 v[48:51], v2 offset:40960
v_mul_f32 v217, v184, v200
v_mfma_f32_16x16x32_bf16 v[132:135], v[60:63], v[36:39], v[132:135]
v_exp_f32 v218, v218
v_mfma_f32_16x16x32_bf16 v[136:139], v[56:59], v[24:27], v[136:139]
v_mul_f32 v219, v185, v201
v_fma_f32 v216, v216, v240, v240
v_mfma_f32_16x16x32_bf16 v[136:139], v[60:63], v[40:43], v[136:139]
ds_read_b128 v[52:55], v2 offset:41984
v_fma_f32 v218, v218, v240, v240
v_mfma_f32_16x16x32_bf16 v[140:143], v[56:59], v[28:31], v[140:143]
v_rcp_f32 v216, v216
v_mfma_f32_16x16x32_bf16 v[140:143], v[60:63], v[44:47], v[140:143]
v_mul_f32 v217, v217, v216
s_waitcnt lgkmcnt(4)
v_mfma_f32_16x16x32_bf16 v[80:83], v[64:67], a[0:3], 0
v_rcp_f32 v218, v218
v_mfma_f32_16x16x32_bf16 v[80:83], v[68:71], a[16:19], v[80:83]
v_mul_f32 v219, v219, v218
v_cvt_pk_bf16_f32 v154, v217, v219
v_mfma_f32_16x16x32_bf16 v[84:87], v[64:67], a[4:7], 0
ds_read_b128 v[56:59], v2 offset:43008
v_mul_f32 v220, v186, v186
v_mfma_f32_16x16x32_bf16 v[84:87], v[68:71], a[20:23], v[84:87]
v_mul_f32 v208, v112, v112
v_mul_f32 v210, v113, v113
v_mfma_f32_16x16x32_bf16 v[88:91], v[64:67], a[8:11], 0
v_fma_f32 v208, v208, v233, v232
v_fma_f32 v210, v210, v233, v232
v_mfma_f32_16x16x32_bf16 v[88:91], v[68:71], a[24:27], v[88:91]
ds_read_b128 v[60:63], v2 offset:44032
v_mul_f32 v208, v208, v112
v_mfma_f32_16x16x32_bf16 v[92:95], v[64:67], a[12:15], 0
v_mul_f32 v210, v210, v113
v_mul_f32 v209, v112, v128
v_mfma_f32_16x16x32_bf16 v[92:95], v[68:71], a[28:31], v[92:95]
v_mul_f32 v211, v113, v129
s_waitcnt lgkmcnt(4)
v_mfma_f32_16x16x32_bf16 v[96:99], v[72:75], a[0:3], 0
v_exp_f32 v208, v208
v_mfma_f32_16x16x32_bf16 v[96:99], v[76:79], a[16:19], v[96:99]
v_exp_f32 v210, v210
v_mfma_f32_16x16x32_bf16 v[100:103], v[72:75], a[4:7], 0
ds_read_b128 v[64:67], v2 offset:45056
v_fma_f32 v208, v208, v234, v234
v_mfma_f32_16x16x32_bf16 v[100:103], v[76:79], a[20:23], v[100:103]
v_fma_f32 v210, v210, v234, v234
v_mul_f32 v212, v114, v114
v_mfma_f32_16x16x32_bf16 v[104:107], v[72:75], a[8:11], 0
v_rcp_f32 v208, v208
v_mfma_f32_16x16x32_bf16 v[104:107], v[76:79], a[24:27], v[104:107]
ds_read_b128 v[68:71], v2 offset:46080
v_mul_f32 v209, v209, v208
v_mfma_f32_16x16x32_bf16 v[108:111], v[72:75], a[12:15], 0
v_rcp_f32 v210, v210
v_mfma_f32_16x16x32_bf16 v[108:111], v[76:79], a[28:31], v[108:111]
v_mul_f32 v211, v211, v210
s_waitcnt lgkmcnt(4)
v_mfma_f32_16x16x32_bf16 v[80:83], v[48:51], a[32:35], v[80:83]
v_cvt_pk_bf16_f32 v162, v209, v211
v_mul_f32 v214, v115, v115
v_mfma_f32_16x16x32_bf16 v[80:83], v[52:55], a[48:51], v[80:83]
v_fma_f32 v212, v212, v233, v232
v_fma_f32 v214, v214, v233, v232
v_mfma_f32_16x16x32_bf16 v[84:87], v[48:51], a[36:39], v[84:87]
ds_read_b128 v[72:75], v2 offset:47104
v_mul_f32 v212, v212, v114
v_mfma_f32_16x16x32_bf16 v[84:87], v[52:55], a[52:55], v[84:87]
v_mul_f32 v214, v214, v115
v_mul_f32 v213, v114, v130
v_mfma_f32_16x16x32_bf16 v[88:91], v[48:51], a[40:43], v[88:91]
v_exp_f32 v212, v212
v_mfma_f32_16x16x32_bf16 v[88:91], v[52:55], a[56:59], v[88:91]
ds_read_b128 v[76:79], v2 offset:48128
v_mul_f32 v215, v115, v131
v_mfma_f32_16x16x32_bf16 v[92:95], v[48:51], a[44:47], v[92:95]
v_exp_f32 v214, v214
v_mfma_f32_16x16x32_bf16 v[92:95], v[52:55], a[60:63], v[92:95]
v_fma_f32 v212, v212, v234, v234
s_waitcnt lgkmcnt(4)
v_mfma_f32_16x16x32_bf16 v[96:99], v[56:59], a[32:35], v[96:99]
s_waitcnt vmcnt(22)
v_fma_f32 v214, v214, v234, v234
v_mfma_f32_16x16x32_bf16 v[96:99], v[60:63], a[48:51], v[96:99]
s_barrier
v_mfma_f32_16x16x32_bf16 v[100:103], v[56:59], a[36:39], v[100:103]
ds_read_b128 v[48:51], v2 offset:49152
s_add_u32 m0, s22, 0
v_mfma_f32_16x16x32_bf16 v[100:103], v[60:63], a[52:55], v[100:103]
v_add_u32 v3, 20480, v3
buffer_load_dwordx4 v3, s[8:11], 0 offen offset:0 sc1 lds
v_mfma_f32_16x16x32_bf16 v[104:107], v[56:59], a[40:43], v[104:107]
v_rcp_f32 v212, v212
v_mfma_f32_16x16x32_bf16 v[104:107], v[60:63], a[56:59], v[104:107]
ds_read_b128 v[52:55], v2 offset:50176
v_mul_f32 v213, v213, v212
v_mfma_f32_16x16x32_bf16 v[108:111], v[56:59], a[44:47], v[108:111]
v_rcp_f32 v214, v214
v_mfma_f32_16x16x32_bf16 v[108:111], v[60:63], a[60:63], v[108:111]
v_mul_f32 v215, v215, v214
s_waitcnt lgkmcnt(4)
v_mfma_f32_16x16x32_bf16 v[80:83], v[64:67], a[64:67], v[80:83]
buffer_load_dwordx4 v3, s[8:11], 0 offen offset:1024 sc1 lds
v_mfma_f32_16x16x32_bf16 v[80:83], v[68:71], a[80:83], v[80:83]
v_cvt_pk_bf16_f32 v163, v213, v215
v_mul_f32 v208, v116, v116
v_mfma_f32_16x16x32_bf16 v[84:87], v[64:67], a[68:71], v[84:87]
ds_read_b128 v[56:59], v2 offset:51200
v_mul_f32 v210, v117, v117
v_mfma_f32_16x16x32_bf16 v[84:87], v[68:71], a[84:87], v[84:87]
buffer_store_dwordx4 v[160:163], v2, s[8:11], s24 offen offset:1024 sc1
v_mfma_f32_16x16x32_bf16 v[88:91], v[64:67], a[72:75], v[88:91]
v_fma_f32 v208, v208, v236, v235
v_fma_f32 v210, v210, v236, v235
v_mfma_f32_16x16x32_bf16 v[88:91], v[68:71], a[88:91], v[88:91]
ds_read_b128 v[60:63], v2 offset:52224
v_mul_f32 v208, v208, v116
v_mfma_f32_16x16x32_bf16 v[92:95], v[64:67], a[76:79], v[92:95]
v_mul_f32 v210, v210, v117
v_mul_f32 v209, v116, v132
v_mfma_f32_16x16x32_bf16 v[92:95], v[68:71], a[92:95], v[92:95]
v_mul_f32 v211, v117, v133
s_waitcnt lgkmcnt(4)
v_mfma_f32_16x16x32_bf16 v[96:99], v[72:75], a[64:67], v[96:99]
buffer_load_dwordx4 v3, s[8:11], 0 offen offset:2048 sc1 lds
v_mfma_f32_16x16x32_bf16 v[96:99], v[76:79], a[80:83], v[96:99]
v_exp_f32 v208, v208
v_mfma_f32_16x16x32_bf16 v[100:103], v[72:75], a[68:71], v[100:103]
ds_read_b128 v[64:67], v2 offset:53248
v_fma_f32 v208, v208, v237, v237
v_mfma_f32_16x16x32_bf16 v[100:103], v[76:79], a[84:87], v[100:103]
v_exp_f32 v210, v210
v_mfma_f32_16x16x32_bf16 v[104:107], v[72:75], a[72:75], v[104:107]
buffer_load_dwordx4 v3, s[8:11], 0 offen offset:3072 sc1 lds
v_mfma_f32_16x16x32_bf16 v[104:107], v[76:79], a[88:91], v[104:107]
ds_read_b128 v[68:71], v2 offset:54272
s_add_u32 m0, s22, 4096
v_mfma_f32_16x16x32_bf16 v[108:111], v[72:75], a[76:79], v[108:111]
v_add_u32 v3, 4096, v3
v_fma_f32 v210, v210, v237, v237
v_mfma_f32_16x16x32_bf16 v[108:111], v[76:79], a[92:95], v[108:111]
v_mul_f32 v212, v118, v118
s_waitcnt lgkmcnt(4)
v_mfma_f32_16x16x32_bf16 v[80:83], v[48:51], a[96:99], v[80:83]
buffer_load_dwordx4 v3, s[8:11], 0 offen offset:0 sc1 lds
v_mfma_f32_16x16x32_bf16 v[80:83], v[52:55], a[112:115], v[80:83]
v_rcp_f32 v208, v208
v_mfma_f32_16x16x32_bf16 v[84:87], v[48:51], a[100:103], v[84:87]
ds_read_b128 v[72:75], v2 offset:55296
v_mul_f32 v209, v209, v208
v_mfma_f32_16x16x32_bf16 v[84:87], v[52:55], a[116:119], v[84:87]
v_rcp_f32 v210, v210
v_mfma_f32_16x16x32_bf16 v[88:91], v[48:51], a[104:107], v[88:91]
buffer_load_dwordx4 v3, s[8:11], 0 offen offset:1024 sc1 lds
v_mfma_f32_16x16x32_bf16 v[88:91], v[52:55], a[120:123], v[88:91]
ds_read_b128 v[76:79], v2 offset:56320
v_mul_f32 v211, v211, v210
v_mfma_f32_16x16x32_bf16 v[92:95], v[48:51], a[108:111], v[92:95]
v_cvt_pk_bf16_f32 v166, v209, v211
v_mul_f32 v214, v119, v119
v_mfma_f32_16x16x32_bf16 v[92:95], v[52:55], a[124:127], v[92:95]
v_fma_f32 v212, v212, v236, v235
s_waitcnt lgkmcnt(4)
v_mfma_f32_16x16x32_bf16 v[96:99], v[56:59], a[96:99], v[96:99]
v_fma_f32 v214, v214, v236, v235
v_mul_f32 v212, v212, v118
v_mfma_f32_16x16x32_bf16 v[96:99], v[60:63], a[112:115], v[96:99]
v_mul_f32 v214, v214, v119
v_mul_f32 v213, v118, v134
v_mfma_f32_16x16x32_bf16 v[100:103], v[56:59], a[100:103], v[100:103]
ds_read_b128 v[48:51], v2 offset:57344
v_mul_f32 v215, v119, v135
v_mfma_f32_16x16x32_bf16 v[100:103], v[60:63], a[116:119], v[100:103]
v_exp_f32 v212, v212
v_mfma_f32_16x16x32_bf16 v[104:107], v[56:59], a[104:107], v[104:107]
v_exp_f32 v214, v214
v_mfma_f32_16x16x32_bf16 v[104:107], v[60:63], a[120:123], v[104:107]
ds_read_b128 v[52:55], v2 offset:58368
v_fma_f32 v212, v212, v237, v237
v_mfma_f32_16x16x32_bf16 v[108:111], v[56:59], a[108:111], v[108:111]
v_fma_f32 v214, v214, v237, v237
v_mul_f32 v208, v120, v120
v_mfma_f32_16x16x32_bf16 v[108:111], v[60:63], a[124:127], v[108:111]
v_mul_f32 v210, v121, v121
s_waitcnt lgkmcnt(4)
v_mfma_f32_16x16x32_bf16 v[80:83], v[64:67], a[128:131], v[80:83]
v_rcp_f32 v212, v212
v_mfma_f32_16x16x32_bf16 v[80:83], v[68:71], a[144:147], v[80:83]
v_rcp_f32 v214, v214
v_mfma_f32_16x16x32_bf16 v[84:87], v[64:67], a[132:135], v[84:87]
ds_read_b128 v[56:59], v2 offset:59392
v_mul_f32 v213, v213, v212
v_mfma_f32_16x16x32_bf16 v[84:87], v[68:71], a[148:151], v[84:87]
v_mul_f32 v215, v215, v214
v_cvt_pk_bf16_f32 v167, v213, v215
v_mfma_f32_16x16x32_bf16 v[88:91], v[64:67], a[136:139], v[88:91]
buffer_store_dwordx4 v[164:167], v4, s[8:11], s24 offen offset:1024 sc1
v_mfma_f32_16x16x32_bf16 v[88:91], v[68:71], a[152:155], v[88:91]
ds_read_b128 v[60:63], v2 offset:60416
v_fma_f32 v208, v208, v239, v238
v_mfma_f32_16x16x32_bf16 v[92:95], v[64:67], a[140:143], v[92:95]
v_fma_f32 v210, v210, v239, v238
v_mul_f32 v208, v208, v120
v_mfma_f32_16x16x32_bf16 v[92:95], v[68:71], a[156:159], v[92:95]
v_mul_f32 v210, v210, v121
s_waitcnt lgkmcnt(4)
v_mfma_f32_16x16x32_bf16 v[96:99], v[72:75], a[128:131], v[96:99]
v_exp_f32 v208, v208
v_mfma_f32_16x16x32_bf16 v[96:99], v[76:79], a[144:147], v[96:99]
v_exp_f32 v210, v210
v_mfma_f32_16x16x32_bf16 v[100:103], v[72:75], a[132:135], v[100:103]
ds_read_b128 v[64:67], v2 offset:61440
v_mul_f32 v209, v120, v136
v_mfma_f32_16x16x32_bf16 v[100:103], v[76:79], a[148:151], v[100:103]
v_mul_f32 v211, v121, v137
v_fma_f32 v208, v208, v240, v240
v_mfma_f32_16x16x32_bf16 v[104:107], v[72:75], a[136:139], v[104:107]
v_fma_f32 v210, v210, v240, v240
v_mul_f32 v212, v122, v122
v_mfma_f32_16x16x32_bf16 v[104:107], v[76:79], a[152:155], v[104:107]
ds_read_b128 v[68:71], v2 offset:62464
v_mul_f32 v214, v123, v123
v_mfma_f32_16x16x32_bf16 v[108:111], v[72:75], a[140:143], v[108:111]
v_rcp_f32 v208, v208
v_mfma_f32_16x16x32_bf16 v[108:111], v[76:79], a[156:159], v[108:111]
v_mul_f32 v209, v209, v208
s_waitcnt lgkmcnt(4)
v_mfma_f32_16x16x32_bf16 v[80:83], v[48:51], a[160:163], v[80:83]
v_rcp_f32 v210, v210
v_mfma_f32_16x16x32_bf16 v[80:83], v[52:55], a[176:179], v[80:83]
v_mul_f32 v211, v211, v210
v_cvt_pk_bf16_f32 v170, v209, v211
v_mfma_f32_16x16x32_bf16 v[84:87], v[48:51], a[164:167], v[84:87]
ds_read_b128 v[72:75], v2 offset:63488
v_fma_f32 v212, v212, v239, v238
v_mfma_f32_16x16x32_bf16 v[84:87], v[52:55], a[180:183], v[84:87]
v_fma_f32 v214, v214, v239, v238
v_mul_f32 v212, v212, v122
v_mfma_f32_16x16x32_bf16 v[88:91], v[48:51], a[168:171], v[88:91]
v_mul_f32 v214, v214, v123
v_mul_f32 v213, v122, v138
v_mfma_f32_16x16x32_bf16 v[88:91], v[52:55], a[184:187], v[88:91]
ds_read_b128 v[76:79], v2 offset:64512
v_mul_f32 v215, v123, v139
v_mfma_f32_16x16x32_bf16 v[92:95], v[48:51], a[172:175], v[92:95]
v_exp_f32 v212, v212
v_mfma_f32_16x16x32_bf16 v[92:95], v[52:55], a[188:191], v[92:95]
v_fma_f32 v212, v212, v240, v240
s_waitcnt lgkmcnt(4)
v_mfma_f32_16x16x32_bf16 v[96:99], v[56:59], a[160:163], v[96:99]
v_exp_f32 v214, v214
v_mfma_f32_16x16x32_bf16 v[96:99], v[60:63], a[176:179], v[96:99]
v_fma_f32 v214, v214, v240, v240
v_mul_f32 v208, v124, v124
v_mfma_f32_16x16x32_bf16 v[100:103], v[56:59], a[164:167], v[100:103]
ds_read_b128 v[48:51], v7 offset:0
v_mul_f32 v210, v125, v125
v_mfma_f32_16x16x32_bf16 v[100:103], v[60:63], a[180:183], v[100:103]
v_rcp_f32 v212, v212
v_mfma_f32_16x16x32_bf16 v[104:107], v[56:59], a[168:171], v[104:107]
v_rcp_f32 v214, v214
v_mfma_f32_16x16x32_bf16 v[104:107], v[60:63], a[184:187], v[104:107]
ds_read_b128 v[52:55], v7 offset:1024
v_mul_f32 v213, v213, v212
v_mfma_f32_16x16x32_bf16 v[108:111], v[56:59], a[172:175], v[108:111]
v_mul_f32 v215, v215, v214
v_cvt_pk_bf16_f32 v171, v213, v215
v_mfma_f32_16x16x32_bf16 v[108:111], v[60:63], a[188:191], v[108:111]
v_fma_f32 v208, v208, v242, v241
s_waitcnt lgkmcnt(4)
v_mfma_f32_16x16x32_bf16 v[80:83], v[64:67], a[192:195], v[80:83]
buffer_store_dwordx4 v[168:171], v5, s[8:11], s24 offen offset:1024 sc1
v_mfma_f32_16x16x32_bf16 v[80:83], v[68:71], a[208:211], v[80:83]
v_fma_f32 v210, v210, v242, v241
v_mul_f32 v208, v208, v124
v_mfma_f32_16x16x32_bf16 v[84:87], v[64:67], a[196:199], v[84:87]
ds_read_b128 v[56:59], v7 offset:2048
v_mul_f32 v210, v210, v125
v_mfma_f32_16x16x32_bf16 v[84:87], v[68:71], a[212:215], v[84:87]
v_exp_f32 v208, v208
v_mfma_f32_16x16x32_bf16 v[88:91], v[64:67], a[200:203], v[88:91]
v_exp_f32 v210, v210
v_mfma_f32_16x16x32_bf16 v[88:91], v[68:71], a[216:219], v[88:91]
ds_read_b128 v[60:63], v7 offset:3072
v_mul_f32 v209, v124, v140
v_mfma_f32_16x16x32_bf16 v[92:95], v[64:67], a[204:207], v[92:95]
v_mul_f32 v211, v125, v141
v_fma_f32 v208, v208, v243, v243
v_mfma_f32_16x16x32_bf16 v[92:95], v[68:71], a[220:223], v[92:95]
v_fma_f32 v210, v210, v243, v243
s_waitcnt lgkmcnt(4)
v_mfma_f32_16x16x32_bf16 v[96:99], v[72:75], a[192:195], v[96:99]
v_rcp_f32 v208, v208
v_mfma_f32_16x16x32_bf16 v[96:99], v[76:79], a[208:211], v[96:99]
v_rcp_f32 v210, v210
v_mfma_f32_16x16x32_bf16 v[100:103], v[72:75], a[196:199], v[100:103]
ds_read_b128 v[64:67], v7 offset:4096
v_mul_f32 v209, v209, v208
v_mfma_f32_16x16x32_bf16 v[100:103], v[76:79], a[212:215], v[100:103]
v_mul_f32 v211, v211, v210
v_cvt_pk_bf16_f32 v174, v209, v211
v_mfma_f32_16x16x32_bf16 v[104:107], v[72:75], a[200:203], v[104:107]
v_mul_f32 v212, v126, v126
v_mul_f32 v214, v127, v127
v_mfma_f32_16x16x32_bf16 v[104:107], v[76:79], a[216:219], v[104:107]
ds_read_b128 v[68:71], v7 offset:5120
v_fma_f32 v212, v212, v242, v241
v_mfma_f32_16x16x32_bf16 v[108:111], v[72:75], a[204:207], v[108:111]
v_fma_f32 v214, v214, v242, v241
v_mul_f32 v212, v212, v126
v_mfma_f32_16x16x32_bf16 v[108:111], v[76:79], a[220:223], v[108:111]
v_mul_f32 v214, v214, v127
s_waitcnt lgkmcnt(4)
v_mfma_f32_16x16x32_bf16 v[80:83], v[48:51], a[224:227], v[80:83]
v_exp_f32 v212, v212
v_mfma_f32_16x16x32_bf16 v[80:83], v[52:55], a[240:243], v[80:83]
v_exp_f32 v214, v214
v_mfma_f32_16x16x32_bf16 v[84:87], v[48:51], a[228:231], v[84:87]
ds_read_b128 v[72:75], v7 offset:6144
v_mul_f32 v213, v126, v142
v_mfma_f32_16x16x32_bf16 v[84:87], v[52:55], a[244:247], v[84:87]
v_mul_f32 v215, v127, v143
v_fma_f32 v212, v212, v243, v243
v_mfma_f32_16x16x32_bf16 v[88:91], v[48:51], a[232:235], v[88:91]
v_fma_f32 v214, v214, v243, v243
v_mul_f32 v222, v187, v187
v_mfma_f32_16x16x32_bf16 v[88:91], v[52:55], a[248:251], v[88:91]
ds_read_b128 v[76:79], v7 offset:7168
v_fma_f32 v220, v220, v239, v238
v_mfma_f32_16x16x32_bf16 v[92:95], v[48:51], a[236:239], v[92:95]
v_rcp_f32 v212, v212
v_mfma_f32_16x16x32_bf16 v[92:95], v[52:55], a[252:255], v[92:95]
v_mul_f32 v213, v213, v212
s_waitcnt lgkmcnt(4)
v_mfma_f32_16x16x32_bf16 v[96:99], v[56:59], a[224:227], v[96:99]
s_waitcnt vmcnt(23)
v_fma_f32 v222, v222, v239, v238
v_mfma_f32_16x16x32_bf16 v[96:99], v[60:63], a[240:243], v[96:99]
s_barrier
v_mfma_f32_16x16x32_bf16 v[100:103], v[56:59], a[228:231], v[100:103]
ds_read_b128 v[48:51], v7 offset:8192
s_add_u32 m0, s22, 24576
v_mfma_f32_16x16x32_bf16 v[100:103], v[60:63], a[244:247], v[100:103]
v_add_u32 v3, 20480, v3
buffer_load_dwordx4 v3, s[8:11], 0 offen offset:0 sc1 lds
v_mfma_f32_16x16x32_bf16 v[104:107], v[56:59], a[232:235], v[104:107]
v_rcp_f32 v214, v214
v_mfma_f32_16x16x32_bf16 v[104:107], v[60:63], a[248:251], v[104:107]
ds_read_b128 v[52:55], v7 offset:9216
v_mul_f32 v215, v215, v214
v_mfma_f32_16x16x32_bf16 v[108:111], v[56:59], a[236:239], v[108:111]
v_cvt_pk_bf16_f32 v175, v213, v215
v_mul_f32 v220, v220, v186
v_mfma_f32_16x16x32_bf16 v[108:111], v[60:63], a[252:255], v[108:111]
v_mul_f32 v222, v222, v187
s_waitcnt lgkmcnt(4)
v_mfma_f32_16x16x32_bf16 v[80:83], v[64:67], v[16:19], v[80:83]
buffer_load_dwordx4 v3, s[8:11], 0 offen offset:1024 sc1 lds
v_mfma_f32_16x16x32_bf16 v[80:83], v[68:71], v[32:35], v[80:83]
v_exp_f32 v220, v220
v_mfma_f32_16x16x32_bf16 v[84:87], v[64:67], v[20:23], v[84:87]
ds_read_b128 v[56:59], v7 offset:10240
v_mul_f32 v221, v186, v202
v_mfma_f32_16x16x32_bf16 v[84:87], v[68:71], v[36:39], v[84:87]
buffer_store_dwordx4 v[172:175], v6, s[8:11], s24 offen offset:1024 sc1
v_mfma_f32_16x16x32_bf16 v[88:91], v[64:67], v[24:27], v[88:91]
v_exp_f32 v222, v222
v_mfma_f32_16x16x32_bf16 v[88:91], v[68:71], v[40:43], v[88:91]
ds_read_b128 v[60:63], v7 offset:11264
v_mul_f32 v223, v187, v203
v_mfma_f32_16x16x32_bf16 v[92:95], v[64:67], v[28:31], v[92:95]
v_fma_f32 v220, v220, v240, v240
v_fma_f32 v222, v222, v240, v240
v_mfma_f32_16x16x32_bf16 v[92:95], v[68:71], v[44:47], v[92:95]
v_mul_f32 v216, v188, v188
s_waitcnt lgkmcnt(4)
v_mfma_f32_16x16x32_bf16 v[96:99], v[72:75], v[16:19], v[96:99]
buffer_load_dwordx4 v3, s[8:11], 0 offen offset:2048 sc1 lds
v_mfma_f32_16x16x32_bf16 v[96:99], v[76:79], v[32:35], v[96:99]
v_rcp_f32 v220, v220
v_mfma_f32_16x16x32_bf16 v[100:103], v[72:75], v[20:23], v[100:103]
ds_read_b128 v[64:67], v7 offset:12288
v_mul_f32 v221, v221, v220
v_mfma_f32_16x16x32_bf16 v[100:103], v[76:79], v[36:39], v[100:103]
v_rcp_f32 v222, v222
v_mfma_f32_16x16x32_bf16 v[104:107], v[72:75], v[24:27], v[104:107]
buffer_load_dwordx4 v3, s[8:11], 0 offen offset:3072 sc1 lds
v_mfma_f32_16x16x32_bf16 v[104:107], v[76:79], v[40:43], v[104:107]
ds_read_b128 v[68:71], v7 offset:13312
s_add_u32 m0, s22, 28672
v_mfma_f32_16x16x32_bf16 v[108:111], v[72:75], v[28:31], v[108:111]
v_add_u32 v3, 4096, v3
v_mul_f32 v223, v223, v222
v_mfma_f32_16x16x32_bf16 v[108:111], v[76:79], v[44:47], v[108:111]
v_cvt_pk_bf16_f32 v155, v221, v223
s_waitcnt lgkmcnt(4)
v_mfma_f32_16x16x32_bf16 v[112:115], v[48:51], a[0:3], 0
buffer_load_dwordx4 v3, s[8:11], 0 offen offset:0 sc1 lds
v_mfma_f32_16x16x32_bf16 v[112:115], v[52:55], a[16:19], v[112:115]
v_mul_f32 v218, v189, v189
v_fma_f32 v216, v216, v242, v241
v_mfma_f32_16x16x32_bf16 v[116:119], v[48:51], a[4:7], 0
ds_read_b128 v[72:75], v7 offset:14336
v_fma_f32 v218, v218, v242, v241
v_mfma_f32_16x16x32_bf16 v[116:119], v[52:55], a[20:23], v[116:119]
buffer_store_dwordx4 v[152:155], v5, s[8:11], s24 offen offset:0 sc1
v_mfma_f32_16x16x32_bf16 v[120:123], v[48:51], a[8:11], 0
v_mul_f32 v216, v216, v188
v_mul_f32 v218, v218, v189
v_mfma_f32_16x16x32_bf16 v[120:123], v[52:55], a[24:27], v[120:123]
ds_read_b128 v[76:79], v7 offset:15360
v_mul_f32 v217, v188, v204
v_mfma_f32_16x16x32_bf16 v[124:127], v[48:51], a[12:15], 0
v_exp_f32 v216, v216
v_mfma_f32_16x16x32_bf16 v[124:127], v[52:55], a[28:31], v[124:127]
v_mul_f32 v219, v189, v205
s_waitcnt lgkmcnt(4)
v_mfma_f32_16x16x32_bf16 v[128:131], v[56:59], a[0:3], 0
buffer_load_dwordx4 v3, s[8:11], 0 offen offset:1024 sc1 lds
v_mfma_f32_16x16x32_bf16 v[128:131], v[60:63], a[16:19], v[128:131]
v_exp_f32 v218, v218
v_mfma_f32_16x16x32_bf16 v[132:135], v[56:59], a[4:7], 0
ds_read_b128 v[48:51], v7 offset:16384
v_fma_f32 v216, v216, v243, v243
v_mfma_f32_16x16x32_bf16 v[132:135], v[60:63], a[20:23], v[132:135]
v_fma_f32 v218, v218, v243, v243
v_mul_f32 v220, v190, v190
v_mfma_f32_16x16x32_bf16 v[136:139], v[56:59], a[8:11], 0
v_rcp_f32 v216, v216
v_mfma_f32_16x16x32_bf16 v[136:139], v[60:63], a[24:27], v[136:139]
ds_read_b128 v[52:55], v7 offset:17408
v_mul_f32 v217, v217, v216
v_mfma_f32_16x16x32_bf16 v[140:143], v[56:59], a[12:15], 0
v_rcp_f32 v218, v218
v_mfma_f32_16x16x32_bf16 v[140:143], v[60:63], a[28:31], v[140:143]
v_mul_f32 v219, v219, v218
s_waitcnt lgkmcnt(4)
v_mfma_f32_16x16x32_bf16 v[112:115], v[64:67], a[32:35], v[112:115]
v_cvt_pk_bf16_f32 v158, v217, v219
v_mul_f32 v222, v191, v191
v_mfma_f32_16x16x32_bf16 v[112:115], v[68:71], a[48:51], v[112:115]
v_fma_f32 v220, v220, v242, v241
v_fma_f32 v222, v222, v242, v241
v_mfma_f32_16x16x32_bf16 v[116:119], v[64:67], a[36:39], v[116:119]
ds_read_b128 v[56:59], v7 offset:18432
v_mul_f32 v220, v220, v190
v_mfma_f32_16x16x32_bf16 v[116:119], v[68:71], a[52:55], v[116:119]
v_mul_f32 v222, v222, v191
v_mul_f32 v221, v190, v206
v_mfma_f32_16x16x32_bf16 v[120:123], v[64:67], a[40:43], v[120:123]
v_exp_f32 v220, v220
v_mfma_f32_16x16x32_bf16 v[120:123], v[68:71], a[56:59], v[120:123]
ds_read_b128 v[60:63], v7 offset:19456
v_mul_f32 v223, v191, v207
v_mfma_f32_16x16x32_bf16 v[124:127], v[64:67], a[44:47], v[124:127]
v_exp_f32 v222, v222
v_mfma_f32_16x16x32_bf16 v[124:127], v[68:71], a[60:63], v[124:127]
v_fma_f32 v220, v220, v243, v243
s_waitcnt lgkmcnt(4)
v_mfma_f32_16x16x32_bf16 v[128:131], v[72:75], a[32:35], v[128:131]
v_fma_f32 v222, v222, v243, v243
v_mfma_f32_16x16x32_bf16 v[128:131], v[76:79], a[48:51], v[128:131]
v_rcp_f32 v220, v220
v_mfma_f32_16x16x32_bf16 v[132:135], v[72:75], a[36:39], v[132:135]
ds_read_b128 v[64:67], v7 offset:20480
v_mul_f32 v221, v221, v220
v_mfma_f32_16x16x32_bf16 v[132:135], v[76:79], a[52:55], v[132:135]
v_rcp_f32 v222, v222
v_mfma_f32_16x16x32_bf16 v[136:139], v[72:75], a[40:43], v[136:139]
v_mul_f32 v223, v223, v222
v_cvt_pk_bf16_f32 v159, v221, v223
v_mfma_f32_16x16x32_bf16 v[136:139], v[76:79], a[56:59], v[136:139]
ds_read_b128 v[68:71], v7 offset:21504
v_mfma_f32_16x16x32_bf16 v[140:143], v[72:75], a[44:47], v[140:143]
buffer_store_dwordx4 v[156:159], v6, s[8:11], s24 offen offset:0 sc1
v_mfma_f32_16x16x32_bf16 v[140:143], v[76:79], a[60:63], v[140:143]
v_mul_f32 v208, v80, v80
s_waitcnt lgkmcnt(4)
v_mfma_f32_16x16x32_bf16 v[112:115], v[48:51], a[64:67], v[112:115]
v_mul_f32 v210, v81, v81
v_fma_f32 v208, v208, v233, v232
v_mfma_f32_16x16x32_bf16 v[112:115], v[52:55], a[80:83], v[112:115]
v_fma_f32 v210, v210, v233, v232
v_mul_f32 v208, v208, v80
v_mfma_f32_16x16x32_bf16 v[116:119], v[48:51], a[68:71], v[116:119]
ds_read_b128 v[72:75], v7 offset:22528
v_mul_f32 v210, v210, v81
v_mfma_f32_16x16x32_bf16 v[116:119], v[52:55], a[84:87], v[116:119]
v_exp_f32 v208, v208
v_mfma_f32_16x16x32_bf16 v[120:123], v[48:51], a[72:75], v[120:123]
v_exp_f32 v210, v210
v_mfma_f32_16x16x32_bf16 v[120:123], v[52:55], a[88:91], v[120:123]
ds_read_b128 v[76:79], v7 offset:23552
v_mul_f32 v209, v80, v96
v_mfma_f32_16x16x32_bf16 v[124:127], v[48:51], a[76:79], v[124:127]
v_mul_f32 v211, v81, v97
v_fma_f32 v208, v208, v234, v234
v_mfma_f32_16x16x32_bf16 v[124:127], v[52:55], a[92:95], v[124:127]
v_fma_f32 v210, v210, v234, v234
s_waitcnt lgkmcnt(4)
v_mfma_f32_16x16x32_bf16 v[128:131], v[56:59], a[64:67], v[128:131]
v_rcp_f32 v208, v208
v_mfma_f32_16x16x32_bf16 v[128:131], v[60:63], a[80:83], v[128:131]
v_rcp_f32 v210, v210
v_mfma_f32_16x16x32_bf16 v[132:135], v[56:59], a[68:71], v[132:135]
ds_read_b128 v[48:51], v7 offset:24576
v_mul_f32 v209, v209, v208
v_mfma_f32_16x16x32_bf16 v[132:135], v[60:63], a[84:87], v[132:135]
v_mul_f32 v211, v211, v210
v_cvt_pk_bf16_f32 v176, v209, v211
v_mfma_f32_16x16x32_bf16 v[136:139], v[56:59], a[72:75], v[136:139]
v_mul_f32 v212, v82, v82
v_mul_f32 v214, v83, v83
v_mfma_f32_16x16x32_bf16 v[136:139], v[60:63], a[88:91], v[136:139]
ds_read_b128 v[52:55], v7 offset:25600
v_fma_f32 v212, v212, v233, v232
v_mfma_f32_16x16x32_bf16 v[140:143], v[56:59], a[76:79], v[140:143]
v_fma_f32 v214, v214, v233, v232
v_mul_f32 v212, v212, v82
v_mfma_f32_16x16x32_bf16 v[140:143], v[60:63], a[92:95], v[140:143]
v_mul_f32 v214, v214, v83
s_waitcnt lgkmcnt(4)
v_mfma_f32_16x16x32_bf16 v[112:115], v[64:67], a[96:99], v[112:115]
v_exp_f32 v212, v212
v_mfma_f32_16x16x32_bf16 v[112:115], v[68:71], a[112:115], v[112:115]
v_exp_f32 v214, v214
v_mfma_f32_16x16x32_bf16 v[116:119], v[64:67], a[100:103], v[116:119]
ds_read_b128 v[56:59], v7 offset:26624
v_mul_f32 v213, v82, v98
v_mfma_f32_16x16x32_bf16 v[116:119], v[68:71], a[116:119], v[116:119]
v_mul_f32 v215, v83, v99
v_fma_f32 v212, v212, v234, v234
v_mfma_f32_16x16x32_bf16 v[120:123], v[64:67], a[104:107], v[120:123]
v_fma_f32 v214, v214, v234, v234
v_mul_f32 v208, v84, v84
v_mfma_f32_16x16x32_bf16 v[120:123], v[68:71], a[120:123], v[120:123]
ds_read_b128 v[60:63], v7 offset:27648
v_mul_f32 v210, v85, v85
v_mfma_f32_16x16x32_bf16 v[124:127], v[64:67], a[108:111], v[124:127]
v_rcp_f32 v212, v212
v_mfma_f32_16x16x32_bf16 v[124:127], v[68:71], a[124:127], v[124:127]
v_mul_f32 v213, v213, v212
s_waitcnt lgkmcnt(4)
v_mfma_f32_16x16x32_bf16 v[128:131], v[72:75], a[96:99], v[128:131]
v_rcp_f32 v214, v214
v_mfma_f32_16x16x32_bf16 v[128:131], v[76:79], a[112:115], v[128:131]
v_mul_f32 v215, v215, v214
v_cvt_pk_bf16_f32 v177, v213, v215
v_mfma_f32_16x16x32_bf16 v[132:135], v[72:75], a[100:103], v[132:135]
ds_read_b128 v[64:67], v7 offset:28672
v_fma_f32 v208, v208, v236, v235
v_mfma_f32_16x16x32_bf16 v[132:135], v[76:79], a[116:119], v[132:135]
v_fma_f32 v210, v210, v236, v235
v_mul_f32 v208, v208, v84
v_mfma_f32_16x16x32_bf16 v[136:139], v[72:75], a[104:107], v[136:139]
v_mul_f32 v210, v210, v85
v_mul_f32 v209, v84, v100
v_mfma_f32_16x16x32_bf16 v[136:139], v[76:79], a[120:123], v[136:139]
ds_read_b128 v[68:71], v7 offset:29696
v_mul_f32 v211, v85, v101
v_mfma_f32_16x16x32_bf16 v[140:143], v[72:75], a[108:111], v[140:143]
v_exp_f32 v208, v208
v_mfma_f32_16x16x32_bf16 v[140:143], v[76:79], a[124:127], v[140:143]
v_fma_f32 v208, v208, v237, v237
s_waitcnt lgkmcnt(4)
v_mfma_f32_16x16x32_bf16 v[112:115], v[48:51], a[128:131], v[112:115]
v_exp_f32 v210, v210
v_mfma_f32_16x16x32_bf16 v[112:115], v[52:55], a[144:147], v[112:115]
v_fma_f32 v210, v210, v237, v237
v_mul_f32 v212, v86, v86
v_mfma_f32_16x16x32_bf16 v[116:119], v[48:51], a[132:135], v[116:119]
ds_read_b128 v[72:75], v7 offset:30720
v_mul_f32 v214, v87, v87
v_mfma_f32_16x16x32_bf16 v[116:119], v[52:55], a[148:151], v[116:119]
v_rcp_f32 v208, v208
v_mfma_f32_16x16x32_bf16 v[120:123], v[48:51], a[136:139], v[120:123]
v_rcp_f32 v210, v210
v_mfma_f32_16x16x32_bf16 v[120:123], v[52:55], a[152:155], v[120:123]
ds_read_b128 v[76:79], v7 offset:31744
v_mul_f32 v209, v209, v208
v_mfma_f32_16x16x32_bf16 v[124:127], v[48:51], a[140:143], v[124:127]
v_mul_f32 v211, v211, v210
v_cvt_pk_bf16_f32 v180, v209, v211
v_mfma_f32_16x16x32_bf16 v[124:127], v[52:55], a[156:159], v[124:127]
v_fma_f32 v212, v212, v236, v235
s_waitcnt lgkmcnt(4)
v_mfma_f32_16x16x32_bf16 v[128:131], v[56:59], a[128:131], v[128:131]
s_waitcnt vmcnt(25)
v_fma_f32 v214, v214, v236, v235
v_mfma_f32_16x16x32_bf16 v[128:131], v[60:63], a[144:147], v[128:131]
s_barrier
v_mfma_f32_16x16x32_bf16 v[132:135], v[56:59], a[132:135], v[132:135]
ds_read_b128 v[48:51], v7 offset:32768
s_add_u32 m0, s22, 49152
v_mfma_f32_16x16x32_bf16 v[132:135], v[60:63], a[148:151], v[132:135]
v_add_u32 v3, 20480, v3
buffer_load_dwordx4 v3, s[8:11], 0 offen offset:0 sc1 lds
v_mfma_f32_16x16x32_bf16 v[136:139], v[56:59], a[136:139], v[136:139]
v_mul_f32 v212, v212, v86
v_mul_f32 v214, v214, v87
v_mfma_f32_16x16x32_bf16 v[136:139], v[60:63], a[152:155], v[136:139]
ds_read_b128 v[52:55], v7 offset:33792
v_mul_f32 v213, v86, v102
v_mfma_f32_16x16x32_bf16 v[140:143], v[56:59], a[140:143], v[140:143]
v_exp_f32 v212, v212
v_mfma_f32_16x16x32_bf16 v[140:143], v[60:63], a[156:159], v[140:143]
v_mul_f32 v215, v87, v103
s_waitcnt lgkmcnt(4)
v_mfma_f32_16x16x32_bf16 v[112:115], v[64:67], a[160:163], v[112:115]
buffer_load_dwordx4 v3, s[8:11], 0 offen offset:1024 sc1 lds
v_mfma_f32_16x16x32_bf16 v[112:115], v[68:71], a[176:179], v[112:115]
v_exp_f32 v214, v214
v_mfma_f32_16x16x32_bf16 v[116:119], v[64:67], a[164:167], v[116:119]
ds_read_b128 v[56:59], v7 offset:34816
v_fma_f32 v212, v212, v237, v237
v_mfma_f32_16x16x32_bf16 v[116:119], v[68:71], a[180:183], v[116:119]
v_fma_f32 v214, v214, v237, v237
v_mul_f32 v208, v88, v88
v_mfma_f32_16x16x32_bf16 v[120:123], v[64:67], a[168:171], v[120:123]
buffer_load_dwordx4 v3, s[8:11], 0 offen offset:2048 sc1 lds
v_mfma_f32_16x16x32_bf16 v[120:123], v[68:71], a[184:187], v[120:123]
ds_read_b128 v[60:63], v7 offset:35840
v_mul_f32 v210, v89, v89
v_mfma_f32_16x16x32_bf16 v[124:127], v[64:67], a[172:175], v[124:127]
v_rcp_f32 v212, v212
v_mfma_f32_16x16x32_bf16 v[124:127], v[68:71], a[188:191], v[124:127]
v_mul_f32 v213, v213, v212
s_waitcnt lgkmcnt(4)
v_mfma_f32_16x16x32_bf16 v[128:131], v[72:75], a[160:163], v[128:131]
buffer_load_dwordx4 v3, s[8:11], 0 offen offset:3072 sc1 lds
v_mfma_f32_16x16x32_bf16 v[128:131], v[76:79], a[176:179], v[128:131]
s_add_u32 m0, s22, 53248
v_add_u32 v3, 4096, v3
v_mfma_f32_16x16x32_bf16 v[132:135], v[72:75], a[164:167], v[132:135]
ds_read_b128 v[64:67], v7 offset:36864
v_fma_f32 v208, v208, v239, v238
v_mfma_f32_16x16x32_bf16 v[132:135], v[76:79], a[180:183], v[132:135]
v_rcp_f32 v214, v214
v_mfma_f32_16x16x32_bf16 v[136:139], v[72:75], a[168:171], v[136:139]
buffer_load_dwordx4 v3, s[8:11], 0 offen offset:0 sc1 lds
v_mfma_f32_16x16x32_bf16 v[136:139], v[76:79], a[184:187], v[136:139]
ds_read_b128 v[68:71], v7 offset:37888
v_mul_f32 v215, v215, v214
v_mfma_f32_16x16x32_bf16 v[140:143], v[72:75], a[172:175], v[140:143]
v_cvt_pk_bf16_f32 v181, v213, v215
v_fma_f32 v210, v210, v239, v238
v_mfma_f32_16x16x32_bf16 v[140:143], v[76:79], a[188:191], v[140:143]
v_mul_f32 v208, v208, v88
s_waitcnt lgkmcnt(4)
v_mfma_f32_16x16x32_bf16 v[112:115], v[48:51], a[192:195], v[112:115]
buffer_load_dwordx4 v3, s[8:11], 0 offen offset:1024 sc1 lds
v_mfma_f32_16x16x32_bf16 v[112:115], v[52:55], a[208:211], v[112:115]
v_mul_f32 v210, v210, v89
v_mul_f32 v209, v88, v104
v_mfma_f32_16x16x32_bf16 v[116:119], v[48:51], a[196:199], v[116:119]
ds_read_b128 v[72:75], v7 offset:38912
v_mul_f32 v211, v89, v105
v_mfma_f32_16x16x32_bf16 v[116:119], v[52:55], a[212:215], v[116:119]
v_exp_f32 v208, v208
v_mfma_f32_16x16x32_bf16 v[120:123], v[48:51], a[200:203], v[120:123]
v_exp_f32 v210, v210
v_mfma_f32_16x16x32_bf16 v[120:123], v[52:55], a[216:219], v[120:123]
ds_read_b128 v[76:79], v7 offset:39936
v_fma_f32 v208, v208, v240, v240
v_mfma_f32_16x16x32_bf16 v[124:127], v[48:51], a[204:207], v[124:127]
v_fma_f32 v210, v210, v240, v240
v_mul_f32 v212, v90, v90
v_mfma_f32_16x16x32_bf16 v[124:127], v[52:55], a[220:223], v[124:127]
v_mul_f32 v214, v91, v91
s_waitcnt lgkmcnt(4)
v_mfma_f32_16x16x32_bf16 v[128:131], v[56:59], a[192:195], v[128:131]
v_mov_b32 v12, s68
v_mov_b32 v13, s69
v_mfma_f32_16x16x32_bf16 v[128:131], v[60:63], a[208:211], v[128:131]
s_add_u32 s53, s34, 0
s_waitcnt vmcnt(6)
buffer_store_dwordx2 v[12:13], v10, s[8:11], s53 offen sc1
v_mfma_f32_16x16x32_bf16 v[132:135], v[56:59], a[196:199], v[132:135]
ds_read_b128 v[48:51], v7 offset:40960
v_fma_f32 v212, v212, v239, v238
v_mfma_f32_16x16x32_bf16 v[132:135], v[60:63], a[212:215], v[132:135]
v_rcp_f32 v208, v208
v_mfma_f32_16x16x32_bf16 v[136:139], v[56:59], a[200:203], v[136:139]
v_rcp_f32 v210, v210
v_mfma_f32_16x16x32_bf16 v[136:139], v[60:63], a[216:219], v[136:139]
ds_read_b128 v[52:55], v7 offset:41984
v_mul_f32 v209, v209, v208
v_mfma_f32_16x16x32_bf16 v[140:143], v[56:59], a[204:207], v[140:143]
v_mul_f32 v211, v211, v210
v_cvt_pk_bf16_f32 v184, v209, v211
v_mfma_f32_16x16x32_bf16 v[140:143], v[60:63], a[220:223], v[140:143]
v_fma_f32 v214, v214, v239, v238
s_waitcnt lgkmcnt(4)
v_mfma_f32_16x16x32_bf16 v[112:115], v[64:67], a[224:227], v[112:115]
v_mul_f32 v212, v212, v90
v_mul_f32 v214, v214, v91
v_mfma_f32_16x16x32_bf16 v[112:115], v[68:71], a[240:243], v[112:115]
v_exp_f32 v212, v212
v_mfma_f32_16x16x32_bf16 v[116:119], v[64:67], a[228:231], v[116:119]
ds_read_b128 v[56:59], v7 offset:43008
v_exp_f32 v214, v214
v_mfma_f32_16x16x32_bf16 v[116:119], v[68:71], a[244:247], v[116:119]
v_mul_f32 v213, v90, v106
v_mul_f32 v215, v91, v107
v_mfma_f32_16x16x32_bf16 v[120:123], v[64:67], a[232:235], v[120:123]
v_fma_f32 v212, v212, v240, v240
v_fma_f32 v214, v214, v240, v240
v_mfma_f32_16x16x32_bf16 v[120:123], v[68:71], a[248:251], v[120:123]
ds_read_b128 v[60:63], v7 offset:44032
v_rcp_f32 v212, v212
v_mfma_f32_16x16x32_bf16 v[124:127], v[64:67], a[236:239], v[124:127]
v_rcp_f32 v214, v214
v_mfma_f32_16x16x32_bf16 v[124:127], v[68:71], a[252:255], v[124:127]
v_mul_f32 v213, v213, v212
s_waitcnt lgkmcnt(4)
v_mfma_f32_16x16x32_bf16 v[128:131], v[72:75], a[224:227], v[128:131]
v_mul_f32 v215, v215, v214
v_cvt_pk_bf16_f32 v185, v213, v215
v_mfma_f32_16x16x32_bf16 v[128:131], v[76:79], a[240:243], v[128:131]
v_mul_f32 v208, v92, v92
v_mul_f32 v210, v93, v93
v_mfma_f32_16x16x32_bf16 v[132:135], v[72:75], a[228:231], v[132:135]
ds_read_b128 v[64:67], v7 offset:45056
v_fma_f32 v208, v208, v242, v241
v_mfma_f32_16x16x32_bf16 v[132:135], v[76:79], a[244:247], v[132:135]
v_fma_f32 v210, v210, v242, v241
v_mul_f32 v208, v208, v92
v_mfma_f32_16x16x32_bf16 v[136:139], v[72:75], a[232:235], v[136:139]
v_mul_f32 v210, v210, v93
v_exp_f32 v208, v208
v_mfma_f32_16x16x32_bf16 v[136:139], v[76:79], a[248:251], v[136:139]
ds_read_b128 v[68:71], v7 offset:46080
v_exp_f32 v210, v210
v_mfma_f32_16x16x32_bf16 v[140:143], v[72:75], a[236:239], v[140:143]
v_mul_f32 v209, v92, v108
v_mul_f32 v211, v93, v109
v_mfma_f32_16x16x32_bf16 v[140:143], v[76:79], a[252:255], v[140:143]
v_fma_f32 v208, v208, v243, v243
s_waitcnt lgkmcnt(4)
v_mfma_f32_16x16x32_bf16 v[112:115], v[48:51], v[16:19], v[112:115]
v_fma_f32 v210, v210, v243, v243
v_rcp_f32 v208, v208
v_mfma_f32_16x16x32_bf16 v[112:115], v[52:55], v[32:35], v[112:115]
v_rcp_f32 v210, v210
v_mfma_f32_16x16x32_bf16 v[116:119], v[48:51], v[20:23], v[116:119]
ds_read_b128 v[72:75], v7 offset:47104
v_mul_f32 v209, v209, v208
v_mfma_f32_16x16x32_bf16 v[116:119], v[52:55], v[36:39], v[116:119]
v_mul_f32 v211, v211, v210
v_cvt_pk_bf16_f32 v188, v209, v211
v_mfma_f32_16x16x32_bf16 v[120:123], v[48:51], v[24:27], v[120:123]
v_mul_f32 v212, v94, v94
v_mul_f32 v214, v95, v95
v_mfma_f32_16x16x32_bf16 v[120:123], v[52:55], v[40:43], v[120:123]
ds_read_b128 v[76:79], v7 offset:48128
v_fma_f32 v212, v212, v242, v241
v_mfma_f32_16x16x32_bf16 v[124:127], v[48:51], v[28:31], v[124:127]
v_fma_f32 v214, v214, v242, v241
v_mul_f32 v212, v212, v94
v_mfma_f32_16x16x32_bf16 v[124:127], v[52:55], v[44:47], v[124:127]
v_mul_f32 v214, v214, v95
s_waitcnt lgkmcnt(4)
v_mfma_f32_16x16x32_bf16 v[128:131], v[56:59], v[16:19], v[128:131]
v_exp_f32 v212, v212
v_mfma_f32_16x16x32_bf16 v[128:131], v[60:63], v[32:35], v[128:131]
v_exp_f32 v214, v214
v_mfma_f32_16x16x32_bf16 v[132:135], v[56:59], v[20:23], v[132:135]
ds_read_b128 v[48:51], v7 offset:49152
v_mul_f32 v213, v94, v110
v_mfma_f32_16x16x32_bf16 v[132:135], v[60:63], v[36:39], v[132:135]
v_mul_f32 v215, v95, v111
v_fma_f32 v212, v212, v243, v243
v_mfma_f32_16x16x32_bf16 v[136:139], v[56:59], v[24:27], v[136:139]
v_fma_f32 v214, v214, v243, v243
v_rcp_f32 v212, v212
v_mfma_f32_16x16x32_bf16 v[136:139], v[60:63], v[40:43], v[136:139]
ds_read_b128 v[52:55], v7 offset:50176
v_rcp_f32 v214, v214
v_mfma_f32_16x16x32_bf16 v[140:143], v[56:59], v[28:31], v[140:143]
v_mul_f32 v213, v213, v212
v_mul_f32 v215, v215, v214
v_mfma_f32_16x16x32_bf16 v[140:143], v[60:63], v[44:47], v[140:143]
v_cvt_pk_bf16_f32 v189, v213, v215
s_waitcnt lgkmcnt(4)
v_mfma_f32_16x16x32_bf16 v[80:83], v[64:67], a[0:3], 0
v_mfma_f32_16x16x32_bf16 v[80:83], v[68:71], a[16:19], v[80:83]
v_mfma_f32_16x16x32_bf16 v[84:87], v[64:67], a[4:7], 0
ds_read_b128 v[56:59], v7 offset:51200
v_mfma_f32_16x16x32_bf16 v[84:87], v[68:71], a[20:23], v[84:87]
v_mul_f32 v208, v112, v112
v_mul_f32 v210, v113, v113
v_mfma_f32_16x16x32_bf16 v[88:91], v[64:67], a[8:11], 0
v_fma_f32 v208, v208, v233, v232
v_fma_f32 v210, v210, v233, v232
v_mfma_f32_16x16x32_bf16 v[88:91], v[68:71], a[24:27], v[88:91]
ds_read_b128 v[60:63], v7 offset:52224
v_mul_f32 v208, v208, v112
v_mfma_f32_16x16x32_bf16 v[92:95], v[64:67], a[12:15], 0
v_mul_f32 v210, v210, v113
v_mul_f32 v209, v112, v128
v_mfma_f32_16x16x32_bf16 v[92:95], v[68:71], a[28:31], v[92:95]
v_mul_f32 v211, v113, v129
s_waitcnt lgkmcnt(4)
v_mfma_f32_16x16x32_bf16 v[96:99], v[72:75], a[0:3], 0
v_exp_f32 v208, v208
v_mfma_f32_16x16x32_bf16 v[96:99], v[76:79], a[16:19], v[96:99]
v_exp_f32 v210, v210
v_mfma_f32_16x16x32_bf16 v[100:103], v[72:75], a[4:7], 0
ds_read_b128 v[64:67], v7 offset:53248
v_fma_f32 v208, v208, v234, v234
v_mfma_f32_16x16x32_bf16 v[100:103], v[76:79], a[20:23], v[100:103]
v_fma_f32 v210, v210, v234, v234
v_mul_f32 v212, v114, v114
v_mfma_f32_16x16x32_bf16 v[104:107], v[72:75], a[8:11], 0
v_rcp_f32 v208, v208
v_mfma_f32_16x16x32_bf16 v[104:107], v[76:79], a[24:27], v[104:107]
ds_read_b128 v[68:71], v7 offset:54272
v_mul_f32 v209, v209, v208
v_mfma_f32_16x16x32_bf16 v[108:111], v[72:75], a[12:15], 0
v_rcp_f32 v210, v210
v_mfma_f32_16x16x32_bf16 v[108:111], v[76:79], a[28:31], v[108:111]
v_mul_f32 v211, v211, v210
s_waitcnt lgkmcnt(4)
v_mfma_f32_16x16x32_bf16 v[80:83], v[48:51], a[32:35], v[80:83]
v_cvt_pk_bf16_f32 v178, v209, v211
v_mul_f32 v214, v115, v115
v_mfma_f32_16x16x32_bf16 v[80:83], v[52:55], a[48:51], v[80:83]
v_fma_f32 v212, v212, v233, v232
v_fma_f32 v214, v214, v233, v232
v_mfma_f32_16x16x32_bf16 v[84:87], v[48:51], a[36:39], v[84:87]
ds_read_b128 v[72:75], v7 offset:55296
v_mul_f32 v212, v212, v114
v_mfma_f32_16x16x32_bf16 v[84:87], v[52:55], a[52:55], v[84:87]
v_mul_f32 v214, v214, v115
v_mul_f32 v213, v114, v130
v_mfma_f32_16x16x32_bf16 v[88:91], v[48:51], a[40:43], v[88:91]
v_exp_f32 v212, v212
v_mfma_f32_16x16x32_bf16 v[88:91], v[52:55], a[56:59], v[88:91]
ds_read_b128 v[76:79], v7 offset:56320
v_mul_f32 v215, v115, v131
v_mfma_f32_16x16x32_bf16 v[92:95], v[48:51], a[44:47], v[92:95]
v_exp_f32 v214, v214
v_mfma_f32_16x16x32_bf16 v[92:95], v[52:55], a[60:63], v[92:95]
v_fma_f32 v212, v212, v234, v234
s_waitcnt lgkmcnt(4)
v_mfma_f32_16x16x32_bf16 v[96:99], v[56:59], a[32:35], v[96:99]
s_waitcnt vmcnt(26)
v_fma_f32 v214, v214, v234, v234
v_mfma_f32_16x16x32_bf16 v[96:99], v[60:63], a[48:51], v[96:99]
s_barrier
v_mfma_f32_16x16x32_bf16 v[100:103], v[56:59], a[36:39], v[100:103]
ds_read_b128 v[48:51], v7 offset:57344
s_add_u32 m0, s22, 73728
v_mfma_f32_16x16x32_bf16 v[100:103], v[60:63], a[52:55], v[100:103]
v_add_u32 v3, 20480, v3
buffer_load_dwordx4 v3, s[8:11], 0 offen offset:0 sc1 lds
v_mfma_f32_16x16x32_bf16 v[104:107], v[56:59], a[40:43], v[104:107]
v_rcp_f32 v212, v212
v_mfma_f32_16x16x32_bf16 v[104:107], v[60:63], a[56:59], v[104:107]
ds_read_b128 v[52:55], v7 offset:58368
v_mul_f32 v213, v213, v212
v_mfma_f32_16x16x32_bf16 v[108:111], v[56:59], a[44:47], v[108:111]
v_rcp_f32 v214, v214
v_mfma_f32_16x16x32_bf16 v[108:111], v[60:63], a[60:63], v[108:111]
v_mul_f32 v215, v215, v214
s_waitcnt lgkmcnt(4)
v_mfma_f32_16x16x32_bf16 v[80:83], v[64:67], a[64:67], v[80:83]
buffer_load_dwordx4 v3, s[8:11], 0 offen offset:1024 sc1 lds
v_mfma_f32_16x16x32_bf16 v[80:83], v[68:71], a[80:83], v[80:83]
v_cvt_pk_bf16_f32 v179, v213, v215
v_mul_f32 v208, v116, v116
v_mfma_f32_16x16x32_bf16 v[84:87], v[64:67], a[68:71], v[84:87]
ds_read_b128 v[56:59], v7 offset:59392
v_mul_f32 v210, v117, v117
v_mfma_f32_16x16x32_bf16 v[84:87], v[68:71], a[84:87], v[84:87]
buffer_store_dwordx4 v[176:179], v2, s[8:11], s24 offen offset:2048 sc1
v_mfma_f32_16x16x32_bf16 v[88:91], v[64:67], a[72:75], v[88:91]
v_fma_f32 v208, v208, v236, v235
v_fma_f32 v210, v210, v236, v235
v_mfma_f32_16x16x32_bf16 v[88:91], v[68:71], a[88:91], v[88:91]
ds_read_b128 v[60:63], v7 offset:60416
v_mul_f32 v208, v208, v116
v_mfma_f32_16x16x32_bf16 v[92:95], v[64:67], a[76:79], v[92:95]
v_mul_f32 v210, v210, v117
v_mul_f32 v209, v116, v132
v_mfma_f32_16x16x32_bf16 v[92:95], v[68:71], a[92:95], v[92:95]
v_mul_f32 v211, v117, v133
s_waitcnt lgkmcnt(4)
v_mfma_f32_16x16x32_bf16 v[96:99], v[72:75], a[64:67], v[96:99]
buffer_load_dwordx4 v3, s[8:11], 0 offen offset:2048 sc1 lds
v_mfma_f32_16x16x32_bf16 v[96:99], v[76:79], a[80:83], v[96:99]
v_exp_f32 v208, v208
v_mfma_f32_16x16x32_bf16 v[100:103], v[72:75], a[68:71], v[100:103]
ds_read_b128 v[64:67], v7 offset:61440
v_fma_f32 v208, v208, v237, v237
v_mfma_f32_16x16x32_bf16 v[100:103], v[76:79], a[84:87], v[100:103]
v_exp_f32 v210, v210
v_mfma_f32_16x16x32_bf16 v[104:107], v[72:75], a[72:75], v[104:107]
buffer_load_dwordx4 v3, s[8:11], 0 offen offset:3072 sc1 lds
v_mfma_f32_16x16x32_bf16 v[104:107], v[76:79], a[88:91], v[104:107]
ds_read_b128 v[68:71], v7 offset:62464
s_add_u32 m0, s22, 77824
v_mfma_f32_16x16x32_bf16 v[108:111], v[72:75], a[76:79], v[108:111]
v_add_u32 v3, 4096, v3
v_fma_f32 v210, v210, v237, v237
v_mfma_f32_16x16x32_bf16 v[108:111], v[76:79], a[92:95], v[108:111]
v_mul_f32 v212, v118, v118
s_waitcnt lgkmcnt(4)
v_mfma_f32_16x16x32_bf16 v[80:83], v[48:51], a[96:99], v[80:83]
buffer_load_dwordx4 v3, s[8:11], 0 offen offset:0 sc1 lds
v_mfma_f32_16x16x32_bf16 v[80:83], v[52:55], a[112:115], v[80:83]
v_rcp_f32 v208, v208
v_mfma_f32_16x16x32_bf16 v[84:87], v[48:51], a[100:103], v[84:87]
ds_read_b128 v[72:75], v7 offset:63488
v_mul_f32 v209, v209, v208
v_mfma_f32_16x16x32_bf16 v[84:87], v[52:55], a[116:119], v[84:87]
v_rcp_f32 v210, v210
v_mfma_f32_16x16x32_bf16 v[88:91], v[48:51], a[104:107], v[88:91]
buffer_load_dwordx4 v3, s[8:11], 0 offen offset:1024 sc1 lds
v_mfma_f32_16x16x32_bf16 v[88:91], v[52:55], a[120:123], v[88:91]
ds_read_b128 v[76:79], v7 offset:64512
s_add_u32 s23, s34, 0
v_mfma_f32_16x16x32_bf16 v[92:95], v[48:51], a[108:111], v[92:95]
v_mul_f32 v211, v211, v210
v_cvt_pk_bf16_f32 v182, v209, v211
v_mfma_f32_16x16x32_bf16 v[92:95], v[52:55], a[124:127], v[92:95]
v_mul_f32 v214, v119, v119
s_waitcnt lgkmcnt(4)
v_mfma_f32_16x16x32_bf16 v[96:99], v[56:59], a[96:99], v[96:99]
buffer_load_dwordx2 v[14:15], v11, s[8:11], s23 offen sc1
v_mfma_f32_16x16x32_bf16 v[96:99], v[60:63], a[112:115], v[96:99]
v_fma_f32 v212, v212, v236, v235
v_fma_f32 v214, v214, v236, v235
v_mfma_f32_16x16x32_bf16 v[100:103], v[56:59], a[100:103], v[100:103]
ds_read_b128 v[48:51], v8 offset:0
v_mul_f32 v212, v212, v118
v_mfma_f32_16x16x32_bf16 v[100:103], v[60:63], a[116:119], v[100:103]
v_mul_f32 v214, v214, v119
v_mul_f32 v213, v118, v134
v_mfma_f32_16x16x32_bf16 v[104:107], v[56:59], a[104:107], v[104:107]
v_exp_f32 v212, v212
v_mfma_f32_16x16x32_bf16 v[104:107], v[60:63], a[120:123], v[104:107]
ds_read_b128 v[52:55], v8 offset:1024
v_mul_f32 v215, v119, v135
v_mfma_f32_16x16x32_bf16 v[108:111], v[56:59], a[108:111], v[108:111]
v_exp_f32 v214, v214
v_mfma_f32_16x16x32_bf16 v[108:111], v[60:63], a[124:127], v[108:111]
v_fma_f32 v212, v212, v237, v237
s_waitcnt lgkmcnt(4)
v_mfma_f32_16x16x32_bf16 v[80:83], v[64:67], a[128:131], v[80:83]
v_fma_f32 v214, v214, v237, v237
v_mul_f32 v208, v120, v120
v_mfma_f32_16x16x32_bf16 v[80:83], v[68:71], a[144:147], v[80:83]
v_rcp_f32 v212, v212
v_mfma_f32_16x16x32_bf16 v[84:87], v[64:67], a[132:135], v[84:87]
ds_read_b128 v[56:59], v8 offset:2048
v_mul_f32 v213, v213, v212
v_mfma_f32_16x16x32_bf16 v[84:87], v[68:71], a[148:151], v[84:87]
v_rcp_f32 v214, v214
v_mfma_f32_16x16x32_bf16 v[88:91], v[64:67], a[136:139], v[88:91]
v_mul_f32 v215, v215, v214
v_cvt_pk_bf16_f32 v183, v213, v215
v_mfma_f32_16x16x32_bf16 v[88:91], v[68:71], a[152:155], v[88:91]
ds_read_b128 v[60:63], v8 offset:3072
v_mul_f32 v210, v121, v121
v_mfma_f32_16x16x32_bf16 v[92:95], v[64:67], a[140:143], v[92:95]
buffer_store_dwordx4 v[180:183], v4, s[8:11], s24 offen offset:2048 sc1
v_mfma_f32_16x16x32_bf16 v[92:95], v[68:71], a[156:159], v[92:95]
v_fma_f32 v208, v208, v239, v238
s_waitcnt lgkmcnt(4)
v_mfma_f32_16x16x32_bf16 v[96:99], v[72:75], a[128:131], v[96:99]
v_fma_f32 v210, v210, v239, v238
v_mul_f32 v208, v208, v120
v_mfma_f32_16x16x32_bf16 v[96:99], v[76:79], a[144:147], v[96:99]
v_mul_f32 v210, v210, v121
v_mul_f32 v209, v120, v136
v_mfma_f32_16x16x32_bf16 v[100:103], v[72:75], a[132:135], v[100:103]
ds_read_b128 v[64:67], v8 offset:4096
v_mul_f32 v211, v121, v137
v_mfma_f32_16x16x32_bf16 v[100:103], v[76:79], a[148:151], v[100:103]
v_exp_f32 v208, v208
v_mfma_f32_16x16x32_bf16 v[104:107], v[72:75], a[136:139], v[104:107]
v_exp_f32 v210, v210
v_mfma_f32_16x16x32_bf16 v[104:107], v[76:79], a[152:155], v[104:107]
ds_read_b128 v[68:71], v8 offset:5120
v_fma_f32 v208, v208, v240, v240
v_mfma_f32_16x16x32_bf16 v[108:111], v[72:75], a[140:143], v[108:111]
v_fma_f32 v210, v210, v240, v240
v_mul_f32 v212, v122, v122
v_mfma_f32_16x16x32_bf16 v[108:111], v[76:79], a[156:159], v[108:111]
v_mul_f32 v214, v123, v123
s_waitcnt lgkmcnt(4)
v_mfma_f32_16x16x32_bf16 v[80:83], v[48:51], a[160:163], v[80:83]
v_rcp_f32 v208, v208
v_mfma_f32_16x16x32_bf16 v[80:83], v[52:55], a[176:179], v[80:83]
v_rcp_f32 v210, v210
v_mfma_f32_16x16x32_bf16 v[84:87], v[48:51], a[164:167], v[84:87]
ds_read_b128 v[72:75], v8 offset:6144
v_mul_f32 v209, v209, v208
v_mfma_f32_16x16x32_bf16 v[84:87], v[52:55], a[180:183], v[84:87]
v_mul_f32 v211, v211, v210
v_cvt_pk_bf16_f32 v186, v209, v211
v_mfma_f32_16x16x32_bf16 v[88:91], v[48:51], a[168:171], v[88:91]
v_fma_f32 v212, v212, v239, v238
v_fma_f32 v214, v214, v239, v238
v_mfma_f32_16x16x32_bf16 v[88:91], v[52:55], a[184:187], v[88:91]
ds_read_b128 v[76:79], v8 offset:7168
v_mul_f32 v212, v212, v122
v_mfma_f32_16x16x32_bf16 v[92:95], v[48:51], a[172:175], v[92:95]
v_mul_f32 v214, v214, v123
v_mul_f32 v213, v122, v138
v_mfma_f32_16x16x32_bf16 v[92:95], v[52:55], a[188:191], v[92:95]
v_mul_f32 v215, v123, v139
s_waitcnt lgkmcnt(4)
v_mfma_f32_16x16x32_bf16 v[96:99], v[56:59], a[160:163], v[96:99]
v_exp_f32 v212, v212
v_mfma_f32_16x16x32_bf16 v[96:99], v[60:63], a[176:179], v[96:99]
v_exp_f32 v214, v214
v_mfma_f32_16x16x32_bf16 v[100:103], v[56:59], a[164:167], v[100:103]
ds_read_b128 v[48:51], v8 offset:8192
v_fma_f32 v212, v212, v240, v240
v_mfma_f32_16x16x32_bf16 v[100:103], v[60:63], a[180:183], v[100:103]
v_fma_f32 v214, v214, v240, v240
v_mul_f32 v208, v124, v124
v_mfma_f32_16x16x32_bf16 v[104:107], v[56:59], a[168:171], v[104:107]
v_rcp_f32 v212, v212
v_mfma_f32_16x16x32_bf16 v[104:107], v[60:63], a[184:187], v[104:107]
ds_read_b128 v[52:55], v8 offset:9216
v_mfma_f32_16x16x32_bf16 v[108:111], v[56:59], a[172:175], v[108:111]
v_rcp_f32 v214, v214
v_mfma_f32_16x16x32_bf16 v[108:111], v[60:63], a[188:191], v[108:111]
s_waitcnt lgkmcnt(4)
v_mfma_f32_16x16x32_bf16 v[80:83], v[64:67], a[192:195], v[80:83]
v_mul_f32 v213, v213, v212
v_mul_f32 v215, v215, v214
v_mfma_f32_16x16x32_bf16 v[80:83], v[68:71], a[208:211], v[80:83]
v_cvt_pk_bf16_f32 v187, v213, v215
v_mul_f32 v210, v125, v125
v_mfma_f32_16x16x32_bf16 v[84:87], v[64:67], a[196:199], v[84:87]
ds_read_b128 v[56:59], v8 offset:10240
v_mfma_f32_16x16x32_bf16 v[84:87], v[68:71], a[212:215], v[84:87]
buffer_store_dwordx4 v[184:187], v5, s[8:11], s24 offen offset:2048 sc1
v_mfma_f32_16x16x32_bf16 v[88:91], v[64:67], a[200:203], v[88:91]
v_mfma_f32_16x16x32_bf16 v[88:91], v[68:71], a[216:219], v[88:91]
ds_read_b128 v[60:63], v8 offset:11264
v_fma_f32 v208, v208, v242, v241
v_mfma_f32_16x16x32_bf16 v[92:95], v[64:67], a[204:207], v[92:95]
v_fma_f32 v210, v210, v242, v241
v_mul_f32 v208, v208, v124
v_mfma_f32_16x16x32_bf16 v[92:95], v[68:71], a[220:223], v[92:95]
v_mul_f32 v210, v210, v125
s_waitcnt lgkmcnt(4)
v_mfma_f32_16x16x32_bf16 v[96:99], v[72:75], a[192:195], v[96:99]
v_exp_f32 v208, v208
v_mfma_f32_16x16x32_bf16 v[96:99], v[76:79], a[208:211], v[96:99]
v_mfma_f32_16x16x32_bf16 v[100:103], v[72:75], a[196:199], v[100:103]
ds_read_b128 v[64:67], v8 offset:12288
v_mul_f32 v209, v124, v140
v_mfma_f32_16x16x32_bf16 v[100:103], v[76:79], a[212:215], v[100:103]
v_exp_f32 v210, v210
v_mfma_f32_16x16x32_bf16 v[104:107], v[72:75], a[200:203], v[104:107]
v_mfma_f32_16x16x32_bf16 v[104:107], v[76:79], a[216:219], v[104:107]
ds_read_b128 v[68:71], v8 offset:13312
v_mul_f32 v211, v125, v141
v_mfma_f32_16x16x32_bf16 v[108:111], v[72:75], a[204:207], v[108:111]
v_fma_f32 v208, v208, v243, v243
v_fma_f32 v210, v210, v243, v243
v_mfma_f32_16x16x32_bf16 v[108:111], v[76:79], a[220:223], v[108:111]
v_mul_f32 v212, v126, v126
s_waitcnt lgkmcnt(4)
v_mfma_f32_16x16x32_bf16 v[80:83], v[48:51], a[224:227], v[80:83]
v_rcp_f32 v208, v208
v_mfma_f32_16x16x32_bf16 v[80:83], v[52:55], a[240:243], v[80:83]
v_mfma_f32_16x16x32_bf16 v[84:87], v[48:51], a[228:231], v[84:87]
ds_read_b128 v[72:75], v8 offset:14336
v_mul_f32 v209, v209, v208
v_mfma_f32_16x16x32_bf16 v[84:87], v[52:55], a[244:247], v[84:87]
v_rcp_f32 v210, v210
v_mfma_f32_16x16x32_bf16 v[88:91], v[48:51], a[232:235], v[88:91]
v_mul_f32 v211, v211, v210
v_cvt_pk_bf16_f32 v190, v209, v211
v_mfma_f32_16x16x32_bf16 v[88:91], v[52:55], a[248:251], v[88:91]
ds_read_b128 v[76:79], v8 offset:15360
v_mfma_f32_16x16x32_bf16 v[92:95], v[48:51], a[236:239], v[92:95]
v_mul_f32 v214, v127, v127
v_fma_f32 v212, v212, v242, v241
v_mfma_f32_16x16x32_bf16 v[92:95], v[52:55], a[252:255], v[92:95]
s_waitcnt lgkmcnt(4)
v_mfma_f32_16x16x32_bf16 v[96:99], v[56:59], a[224:227], v[96:99]
s_waitcnt vmcnt(28)
v_fma_f32 v214, v214, v242, v241
v_mfma_f32_16x16x32_bf16 v[96:99], v[60:63], a[240:243], v[96:99]
s_barrier
v_mfma_f32_16x16x32_bf16 v[100:103], v[56:59], a[228:231], v[100:103]
ds_read_b128 v[48:51], v2 offset:0
s_add_u32 m0, s22, 98304
v_mfma_f32_16x16x32_bf16 v[100:103], v[60:63], a[244:247], v[100:103]
v_add_u32 v3, 20480, v3
buffer_load_dwordx4 v3, s[8:11], 0 offen offset:0 sc1 lds
v_mfma_f32_16x16x32_bf16 v[104:107], v[56:59], a[232:235], v[104:107]
v_mul_f32 v212, v212, v126
v_mul_f32 v214, v214, v127
v_mfma_f32_16x16x32_bf16 v[104:107], v[60:63], a[248:251], v[104:107]
ds_read_b128 v[52:55], v2 offset:1024
v_mul_f32 v213, v126, v142
v_mfma_f32_16x16x32_bf16 v[108:111], v[56:59], a[236:239], v[108:111]
v_exp_f32 v212, v212
v_mfma_f32_16x16x32_bf16 v[108:111], v[60:63], a[252:255], v[108:111]
v_mul_f32 v215, v127, v143
s_waitcnt lgkmcnt(4)
v_mfma_f32_16x16x32_bf16 v[80:83], v[64:67], v[16:19], v[80:83]
buffer_load_dwordx4 v3, s[8:11], 0 offen offset:1024 sc1 lds
v_mfma_f32_16x16x32_bf16 v[80:83], v[68:71], v[32:35], v[80:83]
v_exp_f32 v214, v214
v_mfma_f32_16x16x32_bf16 v[84:87], v[64:67], v[20:23], v[84:87]
ds_read_b128 v[56:59], v2 offset:2048
v_fma_f32 v212, v212, v243, v243
v_mfma_f32_16x16x32_bf16 v[84:87], v[68:71], v[36:39], v[84:87]
v_fma_f32 v214, v214, v243, v243
v_mfma_f32_16x16x32_bf16 v[88:91], v[64:67], v[24:27], v[88:91]
buffer_load_dwordx4 v3, s[8:11], 0 offen offset:2048 sc1 lds
v_mfma_f32_16x16x32_bf16 v[88:91], v[68:71], v[40:43], v[88:91]
ds_read_b128 v[60:63], v2 offset:3072
v_mfma_f32_16x16x32_bf16 v[92:95], v[64:67], v[28:31], v[92:95]
v_rcp_f32 v212, v212
v_mfma_f32_16x16x32_bf16 v[92:95], v[68:71], v[44:47], v[92:95]
v_mul_f32 v213, v213, v212
s_waitcnt lgkmcnt(4)
v_mfma_f32_16x16x32_bf16 v[96:99], v[72:75], v[16:19], v[96:99]
buffer_load_dwordx4 v3, s[8:11], 0 offen offset:3072 sc1 lds
v_mfma_f32_16x16x32_bf16 v[96:99], v[76:79], v[32:35], v[96:99]
s_add_u32 m0, s22, 102400
v_add_u32 v3, 4096, v3
v_mfma_f32_16x16x32_bf16 v[100:103], v[72:75], v[20:23], v[100:103]
ds_read_b128 v[64:67], v2 offset:4096
v_mfma_f32_16x16x32_bf16 v[100:103], v[76:79], v[36:39], v[100:103]
v_rcp_f32 v214, v214
v_mfma_f32_16x16x32_bf16 v[104:107], v[72:75], v[24:27], v[104:107]
buffer_load_dwordx4 v3, s[8:11], 0 offen offset:0 sc1 lds
v_mul_f32 v215, v215, v214
v_mfma_f32_16x16x32_bf16 v[104:107], v[76:79], v[40:43], v[104:107]
ds_read_b128 v[68:71], v2 offset:5120
v_cvt_pk_bf16_f32 v191, v213, v215
v_mfma_f32_16x16x32_bf16 v[108:111], v[72:75], v[28:31], v[108:111]
buffer_store_dwordx4 v[188:191], v6, s[8:11], s24 offen offset:2048 sc1
v_mfma_f32_16x16x32_bf16 v[108:111], v[76:79], v[44:47], v[108:111]
s_waitcnt lgkmcnt(4)
v_mfma_f32_16x16x32_bf16 v[112:115], v[48:51], a[0:3], 0
v_mfma_f32_16x16x32_bf16 v[112:115], v[52:55], a[16:19], v[112:115]
v_mfma_f32_16x16x32_bf16 v[116:119], v[48:51], a[4:7], 0
ds_read_b128 v[72:75], v2 offset:6144
v_mfma_f32_16x16x32_bf16 v[116:119], v[52:55], a[20:23], v[116:119]
buffer_load_dwordx4 v3, s[8:11], 0 offen offset:1024 sc1 lds
v_mfma_f32_16x16x32_bf16 v[120:123], v[48:51], a[8:11], 0
s_waitcnt vmcnt(9)
v_cmp_eq_u64 vcc, s[68:69], v[14:15]
s_nop 0
s_cmp_eq_u64 vcc, exec
s_cbranch_scc0 L_f_slow1
L_f_back1:
v_mul_f32 v208, v80, v80
v_mfma_f32_16x16x32_bf16 v[120:123], v[52:55], a[24:27], v[120:123]
ds_read_b128 v[76:79], v2 offset:7168
v_mul_f32 v210, v81, v81
v_mfma_f32_16x16x32_bf16 v[124:127], v[48:51], a[12:15], 0
v_fma_f32 v208, v208, v233, v232
v_fma_f32 v210, v210, v233, v232
v_mfma_f32_16x16x32_bf16 v[124:127], v[52:55], a[28:31], v[124:127]
v_mul_f32 v208, v208, v80
s_waitcnt lgkmcnt(4)
v_mfma_f32_16x16x32_bf16 v[128:131], v[56:59], a[0:3], 0
v_mul_f32 v210, v210, v81
v_mul_f32 v209, v80, v96
v_mfma_f32_16x16x32_bf16 v[128:131], v[60:63], a[16:19], v[128:131]
v_exp_f32 v208, v208
v_mfma_f32_16x16x32_bf16 v[132:135], v[56:59], a[4:7], 0
ds_read_b128 v[48:51], v2 offset:8192
v_mul_f32 v211, v81, v97
v_mfma_f32_16x16x32_bf16 v[132:135], v[60:63], a[20:23], v[132:135]
v_exp_f32 v210, v210
v_mfma_f32_16x16x32_bf16 v[136:139], v[56:59], a[8:11], 0
v_fma_f32 v208, v208, v234, v234
v_fma_f32 v210, v210, v234, v234
v_mfma_f32_16x16x32_bf16 v[136:139], v[60:63], a[24:27], v[136:139]
ds_read_b128 v[52:55], v2 offset:9216
v_mul_f32 v212, v82, v82
v_mfma_f32_16x16x32_bf16 v[140:143], v[56:59], a[12:15], 0
v_rcp_f32 v208, v208
v_mfma_f32_16x16x32_bf16 v[140:143], v[60:63], a[28:31], v[140:143]
v_mul_f32 v209, v209, v208
s_waitcnt lgkmcnt(4)
v_mfma_f32_16x16x32_bf16 v[112:115], v[64:67], a[32:35], v[112:115]
v_rcp_f32 v210, v210
v_mfma_f32_16x16x32_bf16 v[112:115], v[68:71], a[48:51], v[112:115]
v_mul_f32 v211, v211, v210
v_cvt_pk_bf16_f32 v192, v209, v211
v_mfma_f32_16x16x32_bf16 v[116:119], v[64:67], a[36:39], v[116:119]
ds_read_b128 v[56:59], v2 offset:10240
v_mul_f32 v214, v83, v83
v_mfma_f32_16x16x32_bf16 v[116:119], v[68:71], a[52:55], v[116:119]
v_fma_f32 v212, v212, v233, v232
v_fma_f32 v214, v214, v233, v232
v_mfma_f32_16x16x32_bf16 v[120:123], v[64:67], a[40:43], v[120:123]
v_mul_f32 v212, v212, v82
v_mul_f32 v214, v214, v83
v_mfma_f32_16x16x32_bf16 v[120:123], v[68:71], a[56:59], v[120:123]
ds_read_b128 v[60:63], v2 offset:11264
v_mul_f32 v213, v82, v98
v_mfma_f32_16x16x32_bf16 v[124:127], v[64:67], a[44:47], v[124:127]
v_exp_f32 v212, v212
v_mfma_f32_16x16x32_bf16 v[124:127], v[68:71], a[60:63], v[124:127]
v_mul_f32 v215, v83, v99
s_waitcnt lgkmcnt(4)
v_mfma_f32_16x16x32_bf16 v[128:131], v[72:75], a[32:35], v[128:131]
buffer_load_dwordx4 a[0:3], v2, s[8:11], s25 offen offset:0 sc1
v_mfma_f32_16x16x32_bf16 v[128:131], v[76:79], a[48:51], v[128:131]
v_exp_f32 v214, v214
v_mfma_f32_16x16x32_bf16 v[132:135], v[72:75], a[36:39], v[132:135]
ds_read_b128 v[64:67], v2 offset:12288
v_fma_f32 v212, v212, v234, v234
v_mfma_f32_16x16x32_bf16 v[132:135], v[76:79], a[52:55], v[132:135]
v_fma_f32 v214, v214, v234, v234
v_mul_f32 v208, v84, v84
v_mfma_f32_16x16x32_bf16 v[136:139], v[72:75], a[40:43], v[136:139]
buffer_load_dwordx4 a[4:7], v4, s[8:11], s25 offen offset:0 sc1
v_mfma_f32_16x16x32_bf16 v[136:139], v[76:79], a[56:59], v[136:139]
ds_read_b128 v[68:71], v2 offset:13312
v_mul_f32 v210, v85, v85
v_mfma_f32_16x16x32_bf16 v[140:143], v[72:75], a[44:47], v[140:143]
v_rcp_f32 v212, v212
v_mfma_f32_16x16x32_bf16 v[140:143], v[76:79], a[60:63], v[140:143]
v_mul_f32 v213, v213, v212
s_waitcnt lgkmcnt(4)
v_mfma_f32_16x16x32_bf16 v[112:115], v[48:51], a[64:67], v[112:115]
buffer_load_dwordx4 a[8:11], v5, s[8:11], s25 offen offset:0 sc1
v_mfma_f32_16x16x32_bf16 v[112:115], v[52:55], a[80:83], v[112:115]
v_rcp_f32 v214, v214
v_mfma_f32_16x16x32_bf16 v[116:119], v[48:51], a[68:71], v[116:119]
ds_read_b128 v[72:75], v2 offset:14336
v_mul_f32 v215, v215, v214
v_mfma_f32_16x16x32_bf16 v[116:119], v[52:55], a[84:87], v[116:119]
v_cvt_pk_bf16_f32 v193, v213, v215
v_fma_f32 v208, v208, v236, v235
v_mfma_f32_16x16x32_bf16 v[120:123], v[48:51], a[72:75], v[120:123]
buffer_load_dwordx4 a[12:15], v6, s[8:11], s25 offen offset:0 sc1
v_mfma_f32_16x16x32_bf16 v[120:123], v[52:55], a[88:91], v[120:123]
ds_read_b128 v[76:79], v2 offset:15360
v_fma_f32 v210, v210, v236, v235
v_mfma_f32_16x16x32_bf16 v[124:127], v[48:51], a[76:79], v[124:127]
v_mul_f32 v208, v208, v84
v_mul_f32 v210, v210, v85
v_mfma_f32_16x16x32_bf16 v[124:127], v[52:55], a[92:95], v[124:127]
v_mul_f32 v209, v84, v100
s_waitcnt lgkmcnt(4)
v_mfma_f32_16x16x32_bf16 v[128:131], v[56:59], a[64:67], v[128:131]
v_exp_f32 v208, v208
v_mfma_f32_16x16x32_bf16 v[128:131], v[60:63], a[80:83], v[128:131]
v_exp_f32 v210, v210
v_mfma_f32_16x16x32_bf16 v[132:135], v[56:59], a[68:71], v[132:135]
ds_read_b128 v[48:51], v2 offset:16384
v_mul_f32 v211, v85, v101
v_mfma_f32_16x16x32_bf16 v[132:135], v[60:63], a[84:87], v[132:135]
v_fma_f32 v208, v208, v237, v237
v_fma_f32 v210, v210, v237, v237
v_mfma_f32_16x16x32_bf16 v[136:139], v[56:59], a[72:75], v[136:139]
v_rcp_f32 v208, v208
v_mfma_f32_16x16x32_bf16 v[136:139], v[60:63], a[88:91], v[136:139]
ds_read_b128 v[52:55], v2 offset:17408
v_mul_f32 v209, v209, v208
v_mfma_f32_16x16x32_bf16 v[140:143], v[56:59], a[76:79], v[140:143]
v_rcp_f32 v210, v210
v_mfma_f32_16x16x32_bf16 v[140:143], v[60:63], a[92:95], v[140:143]
v_mul_f32 v211, v211, v210
s_waitcnt lgkmcnt(4)
v_mfma_f32_16x16x32_bf16 v[112:115], v[64:67], a[96:99], v[112:115]
v_mov_b32 v12, s68
v_mov_b32 v13, s69
v_mfma_f32_16x16x32_bf16 v[112:115], v[68:71], a[112:115], v[112:115]
s_add_u32 s53, s34, 131072
s_waitcnt vmcnt(5)
buffer_store_dwordx2 v[12:13], v10, s[8:11], s53 offen sc1
v_mfma_f32_16x16x32_bf16 v[116:119], v[64:67], a[100:103], v[116:119]
ds_read_b128 v[56:59], v2 offset:18432
v_cvt_pk_bf16_f32 v196, v209, v211
v_mfma_f32_16x16x32_bf16 v[116:119], v[68:71], a[116:119], v[116:119]
v_mul_f32 v212, v86, v86
v_mul_f32 v214, v87, v87
v_mfma_f32_16x16x32_bf16 v[120:123], v[64:67], a[104:107], v[120:123]
v_fma_f32 v212, v212, v236, v235
v_fma_f32 v214, v214, v236, v235
v_mfma_f32_16x16x32_bf16 v[120:123], v[68:71], a[120:123], v[120:123]
ds_read_b128 v[60:63], v2 offset:19456
v_mul_f32 v212, v212, v86
v_mfma_f32_16x16x32_bf16 v[124:127], v[64:67], a[108:111], v[124:127]
buffer_load_dwordx4 a[16:19], v2, s[8:11], s26 offen offset:0 sc1
v_mfma_f32_16x16x32_bf16 v[124:127], v[68:71], a[124:127], v[124:127]
v_mul_f32 v214, v214, v87
s_waitcnt lgkmcnt(4)
v_mfma_f32_16x16x32_bf16 v[128:131], v[72:75], a[96:99], v[128:131]
v_exp_f32 v212, v212
v_mfma_f32_16x16x32_bf16 v[128:131], v[76:79], a[112:115], v[128:131]
v_exp_f32 v214, v214
v_mfma_f32_16x16x32_bf16 v[132:135], v[72:75], a[100:103], v[132:135]
ds_read_b128 v[64:67], v2 offset:20480
v_mul_f32 v213, v86, v102
v_mfma_f32_16x16x32_bf16 v[132:135], v[76:79], a[116:119], v[132:135]
buffer_load_dwordx4 a[20:23], v4, s[8:11], s26 offen offset:0 sc1
v_mfma_f32_16x16x32_bf16 v[136:139], v[72:75], a[104:107], v[136:139]
v_mul_f32 v215, v87, v103
v_fma_f32 v212, v212, v237, v237
v_mfma_f32_16x16x32_bf16 v[136:139], v[76:79], a[120:123], v[136:139]
ds_read_b128 v[68:71], v2 offset:21504
v_fma_f32 v214, v214, v237, v237
v_mfma_f32_16x16x32_bf16 v[140:143], v[72:75], a[108:111], v[140:143]
v_rcp_f32 v212, v212
v_mfma_f32_16x16x32_bf16 v[140:143], v[76:79], a[124:127], v[140:143]
v_mul_f32 v213, v213, v212
s_waitcnt lgkmcnt(4)
v_mfma_f32_16x16x32_bf16 v[112:115], v[48:51], a[128:131], v[112:115]
buffer_load_dwordx4 a[24:27], v5, s[8:11], s26 offen offset:0 sc1
v_mfma_f32_16x16x32_bf16 v[112:115], v[52:55], a[144:147], v[112:115]
v_rcp_f32 v214, v214
v_mfma_f32_16x16x32_bf16 v[116:119], v[48:51], a[132:135], v[116:119]
ds_read_b128 v[72:75], v2 offset:22528
v_mul_f32 v215, v215, v214
v_mfma_f32_16x16x32_bf16 v[116:119], v[52:55], a[148:151], v[116:119]
v_cvt_pk_bf16_f32 v197, v213, v215
v_mul_f32 v208, v88, v88
v_mfma_f32_16x16x32_bf16 v[120:123], v[48:51], a[136:139], v[120:123]
buffer_load_dwordx4 a[28:31], v6, s[8:11], s26 offen offset:0 sc1
v_mfma_f32_16x16x32_bf16 v[120:123], v[52:55], a[152:155], v[120:123]
ds_read_b128 v[76:79], v2 offset:23552
v_mul_f32 v210, v89, v89
v_mfma_f32_16x16x32_bf16 v[124:127], v[48:51], a[140:143], v[124:127]
v_fma_f32 v208, v208, v239, v238
v_fma_f32 v210, v210, v239, v238
v_mfma_f32_16x16x32_bf16 v[124:127], v[52:55], a[156:159], v[124:127]
v_mul_f32 v208, v208, v88
s_waitcnt lgkmcnt(4)
v_mfma_f32_16x16x32_bf16 v[128:131], v[56:59], a[128:131], v[128:131]
s_waitcnt vmcnt(34)
v_mul_f32 v210, v210, v89
v_mfma_f32_16x16x32_bf16 v[128:131], v[60:63], a[144:147], v[128:131]
s_barrier
v_mfma_f32_16x16x32_bf16 v[132:135], v[56:59], a[132:135], v[132:135]
ds_read_b128 v[48:51], v2 offset:24576
v_mul_f32 v209, v88, v104
v_mfma_f32_16x16x32_bf16 v[132:135], v[60:63], a[148:151], v[132:135]
buffer_load_dwordx4 a[32:35], v2, s[8:11], s27 offen offset:0 sc1
v_mfma_f32_16x16x32_bf16 v[136:139], v[56:59], a[136:139], v[136:139]
v_exp_f32 v208, v208
v_mfma_f32_16x16x32_bf16 v[136:139], v[60:63], a[152:155], v[136:139]
ds_read_b128 v[52:55], v2 offset:25600
v_mul_f32 v211, v89, v105
v_mfma_f32_16x16x32_bf16 v[140:143], v[56:59], a[140:143], v[140:143]
v_exp_f32 v210, v210
v_mfma_f32_16x16x32_bf16 v[140:143], v[60:63], a[156:159], v[140:143]
v_fma_f32 v208, v208, v240, v240
s_waitcnt lgkmcnt(4)
v_mfma_f32_16x16x32_bf16 v[112:115], v[64:67], a[160:163], v[112:115]
buffer_load_dwordx4 a[36:39], v4, s[8:11], s27 offen offset:0 sc1
v_mfma_f32_16x16x32_bf16 v[112:115], v[68:71], a[176:179], v[112:115]
v_fma_f32 v210, v210, v240, v240
v_mul_f32 v212, v90, v90
v_mfma_f32_16x16x32_bf16 v[116:119], v[64:67], a[164:167], v[116:119]
ds_read_b128 v[56:59], v2 offset:26624
v_mul_f32 v214, v91, v91
v_mfma_f32_16x16x32_bf16 v[116:119], v[68:71], a[180:183], v[116:119]
v_rcp_f32 v208, v208
v_mfma_f32_16x16x32_bf16 v[120:123], v[64:67], a[168:171], v[120:123]
buffer_load_dwordx4 a[40:43], v5, s[8:11], s27 offen offset:0 sc1
v_mfma_f32_16x16x32_bf16 v[120:123], v[68:71], a[184:187], v[120:123]
ds_read_b128 v[60:63], v2 offset:27648
v_mul_f32 v209, v209, v208
v_mfma_f32_16x16x32_bf16 v[124:127], v[64:67], a[172:175], v[124:127]
v_rcp_f32 v210, v210
v_mfma_f32_16x16x32_bf16 v[124:127], v[68:71], a[188:191], v[124:127]
v_mul_f32 v211, v211, v210
s_waitcnt lgkmcnt(4)
v_mfma_f32_16x16x32_bf16 v[128:131], v[72:75], a[160:163], v[128:131]
buffer_load_dwordx4 a[44:47], v6, s[8:11], s27 offen offset:0 sc1
v_mfma_f32_16x16x32_bf16 v[128:131], v[76:79], a[176:179], v[128:131]
s_add_u32 m0, s22, 122880
v_add_u32 v3, 20480, v3
v_mfma_f32_16x16x32_bf16 v[132:135], v[72:75], a[164:167], v[132:135]
ds_read_b128 v[64:67], v2 offset:28672
v_cvt_pk_bf16_f32 v200, v209, v211
v_mfma_f32_16x16x32_bf16 v[132:135], v[76:79], a[180:183], v[132:135]
v_fma_f32 v212, v212, v239, v238
v_fma_f32 v214, v214, v239, v238
v_mfma_f32_16x16x32_bf16 v[136:139], v[72:75], a[168:171], v[136:139]
buffer_load_dwordx4 v3, s[8:11], 0 offen offset:0 sc1 lds
v_mfma_f32_16x16x32_bf16 v[136:139], v[76:79], a[184:187], v[136:139]
ds_read_b128 v[68:71], v2 offset:29696
v_mul_f32 v212, v212, v90
v_mfma_f32_16x16x32_bf16 v[140:143], v[72:75], a[172:175], v[140:143]
v_mul_f32 v214, v214, v91
v_mul_f32 v213, v90, v106
v_mfma_f32_16x16x32_bf16 v[140:143], v[76:79], a[188:191], v[140:143]
v_mul_f32 v215, v91, v107
s_waitcnt lgkmcnt(4)
v_mfma_f32_16x16x32_bf16 v[112:115], v[48:51], a[192:195], v[112:115]
buffer_load_dwordx4 v3, s[8:11], 0 offen offset:1024 sc1 lds
v_mfma_f32_16x16x32_bf16 v[112:115], v[52:55], a[208:211], v[112:115]
v_exp_f32 v212, v212
v_mfma_f32_16x16x32_bf16 v[116:119], v[48:51], a[196:199], v[116:119]
ds_read_b128 v[72:75], v2 offset:30720
v_fma_f32 v212, v212, v240, v240
v_mfma_f32_16x16x32_bf16 v[116:119], v[52:55], a[212:215], v[116:119]
v_exp_f32 v214, v214
v_mfma_f32_16x16x32_bf16 v[120:123], v[48:51], a[200:203], v[120:123]
buffer_load_dwordx4 v3, s[8:11], 0 offen offset:2048 sc1 lds
v_mfma_f32_16x16x32_bf16 v[120:123], v[52:55], a[216:219], v[120:123]
ds_read_b128 v[76:79], v2 offset:31744
v_fma_f32 v214, v214, v240, v240
v_mfma_f32_16x16x32_bf16 v[124:127], v[48:51], a[204:207], v[124:127]
v_rcp_f32 v212, v212
v_mfma_f32_16x16x32_bf16 v[124:127], v[52:55], a[220:223], v[124:127]
v_mul_f32 v213, v213, v212
s_waitcnt lgkmcnt(4)
v_mfma_f32_16x16x32_bf16 v[128:131], v[56:59], a[192:195], v[128:131]
buffer_load_dwordx4 v3, s[8:11], 0 offen offset:3072 sc1 lds
v_mfma_f32_16x16x32_bf16 v[128:131], v[60:63], a[208:211], v[128:131]
s_add_u32 m0, s22, 126976
v_add_u32 v3, 4096, v3
v_mfma_f32_16x16x32_bf16 v[132:135], v[56:59], a[196:199], v[132:135]
ds_read_b128 v[48:51], v2 offset:32768
v_mul_f32 v208, v92, v92
v_mfma_f32_16x16x32_bf16 v[132:135], v[60:63], a[212:215], v[132:135]
v_rcp_f32 v214, v214
v_mfma_f32_16x16x32_bf16 v[136:139], v[56:59], a[200:203], v[136:139]
buffer_load_dwordx4 v3, s[8:11], 0 offen offset:0 sc1 lds
v_mfma_f32_16x16x32_bf16 v[136:139], v[60:63], a[216:219], v[136:139]
ds_read_b128 v[52:55], v2 offset:33792
v_mul_f32 v215, v215, v214
v_mfma_f32_16x16x32_bf16 v[140:143], v[56:59], a[204:207], v[140:143]
v_cvt_pk_bf16_f32 v201, v213, v215
v_mul_f32 v210, v93, v93
v_mfma_f32_16x16x32_bf16 v[140:143], v[60:63], a[220:223], v[140:143]
v_fma_f32 v208, v208, v242, v241
s_waitcnt lgkmcnt(4)
v_mfma_f32_16x16x32_bf16 v[112:115], v[64:67], a[224:227], v[112:115]
buffer_load_dwordx4 v3, s[8:11], 0 offen offset:1024 sc1 lds
v_mfma_f32_16x16x32_bf16 v[112:115], v[68:71], a[240:243], v[112:115]
v_fma_f32 v210, v210, v242, v241
v_mul_f32 v208, v208, v92
v_mfma_f32_16x16x32_bf16 v[116:119], v[64:67], a[228:231], v[116:119]
ds_read_b128 v[56:59], v2 offset:34816
v_mul_f32 v210, v210, v93
v_mfma_f32_16x16x32_bf16 v[116:119], v[68:71], a[244:247], v[116:119]
v_exp_f32 v208, v208
v_mfma_f32_16x16x32_bf16 v[120:123], v[64:67], a[232:235], v[120:123]
buffer_load_dwordx4 a[48:51], v2, s[8:11], s25 offen offset:1024 sc1
v_mfma_f32_16x16x32_bf16 v[120:123], v[68:71], a[248:251], v[120:123]
ds_read_b128 v[60:63], v2 offset:35840
v_mul_f32 v209, v92, v108
v_mfma_f32_16x16x32_bf16 v[124:127], v[64:67], a[236:239], v[124:127]
v_exp_f32 v210, v210
v_mfma_f32_16x16x32_bf16 v[124:127], v[68:71], a[252:255], v[124:127]
v_mul_f32 v211, v93, v109
s_waitcnt lgkmcnt(4)
v_mfma_f32_16x16x32_bf16 v[128:131], v[72:75], a[224:227], v[128:131]
buffer_load_dwordx4 a[52:55], v4, s[8:11], s25 offen offset:1024 sc1
v_mfma_f32_16x16x32_bf16 v[128:131], v[76:79], a[240:243], v[128:131]
v_fma_f32 v208, v208, v243, v243
v_fma_f32 v210, v210, v243, v243
v_mfma_f32_16x16x32_bf16 v[132:135], v[72:75], a[228:231], v[132:135]
ds_read_b128 v[64:67], v2 offset:36864
v_mul_f32 v212, v94, v94
v_mfma_f32_16x16x32_bf16 v[132:135], v[76:79], a[244:247], v[132:135]
v_rcp_f32 v208, v208
v_mfma_f32_16x16x32_bf16 v[136:139], v[72:75], a[232:235], v[136:139]
buffer_load_dwordx4 a[56:59], v5, s[8:11], s25 offen offset:1024 sc1
v_mfma_f32_16x16x32_bf16 v[136:139], v[76:79], a[248:251], v[136:139]
ds_read_b128 v[68:71], v2 offset:37888
v_mul_f32 v209, v209, v208
v_mfma_f32_16x16x32_bf16 v[140:143], v[72:75], a[236:239], v[140:143]
v_rcp_f32 v210, v210
v_mfma_f32_16x16x32_bf16 v[140:143], v[76:79], a[252:255], v[140:143]
v_mul_f32 v211, v211, v210
s_waitcnt lgkmcnt(4)
v_mfma_f32_16x16x32_bf16 v[112:115], v[48:51], v[16:19], v[112:115]
buffer_load_dwordx4 a[60:63], v6, s[8:11], s25 offen offset:1024 sc1
v_mfma_f32_16x16x32_bf16 v[112:115], v[52:55], v[32:35], v[112:115]
v_cvt_pk_bf16_f32 v204, v209, v211
v_mul_f32 v214, v95, v95
v_mfma_f32_16x16x32_bf16 v[116:119], v[48:51], v[20:23], v[116:119]
ds_read_b128 v[72:75], v2 offset:38912
v_fma_f32 v212, v212, v242, v241
v_mfma_f32_16x16x32_bf16 v[116:119], v[52:55], v[36:39], v[116:119]
v_fma_f32 v214, v214, v242, v241
v_mul_f32 v212, v212, v94
v_mfma_f32_16x16x32_bf16 v[120:123], v[48:51], v[24:27], v[120:123]
buffer_load_dwordx4 a[64:67], v2, s[8:11], s26 offen offset:1024 sc1
v_mfma_f32_16x16x32_bf16 v[120:123], v[52:55], v[40:43], v[120:123]
ds_read_b128 v[76:79], v2 offset:39936
v_mul_f32 v214, v214, v95
v_mfma_f32_16x16x32_bf16 v[124:127], v[48:51], v[28:31], v[124:127]
v_exp_f32 v212, v212
v_mfma_f32_16x16x32_bf16 v[124:127], v[52:55], v[44:47], v[124:127]
v_mul_f32 v213, v94, v110
s_waitcnt lgkmcnt(4)
v_mfma_f32_16x16x32_bf16 v[128:131], v[56:59], v[16:19], v[128:131]
buffer_load_dwordx4 a[68:71], v4, s[8:11], s26 offen offset:1024 sc1
v_mfma_f32_16x16x32_bf16 v[128:131], v[60:63], v[32:35], v[128:131]
v_exp_f32 v214, v214
v_mfma_f32_16x16x32_bf16 v[132:135], v[56:59], v[20:23], v[132:135]
ds_read_b128 v[48:51], v2 offset:40960
v_mul_f32 v215, v95, v111
v_mfma_f32_16x16x32_bf16 v[132:135], v[60:63], v[36:39], v[132:135]
v_fma_f32 v212, v212, v243, v243
v_fma_f32 v214, v214, v243, v243
v_mfma_f32_16x16x32_bf16 v[136:139], v[56:59], v[24:27], v[136:139]
buffer_load_dwordx4 a[72:75], v5, s[8:11], s26 offen offset:1024 sc1
v_mfma_f32_16x16x32_bf16 v[136:139], v[60:63], v[40:43], v[136:139]
ds_read_b128 v[52:55], v2 offset:41984
v_mfma_f32_16x16x32_bf16 v[140:143], v[56:59], v[28:31], v[140:143]
v_rcp_f32 v212, v212
v_mfma_f32_16x16x32_bf16 v[140:143], v[60:63], v[44:47], v[140:143]
v_mul_f32 v213, v213, v212
s_waitcnt lgkmcnt(4)
v_mfma_f32_16x16x32_bf16 a[112:115], v[64:67], v[144:147], 0
buffer_load_dwordx4 a[76:79], v6, s[8:11], s26 offen offset:1024 sc1
v_mfma_f32_16x16x32_bf16 a[112:115], v[68:71], v[160:163], a[112:115]
v_rcp_f32 v214, v214
v_mfma_f32_16x16x32_bf16 a[116:119], v[64:67], v[148:151], 0
ds_read_b128 v[56:59], v2 offset:43008
v_mul_f32 v215, v215, v214
v_mfma_f32_16x16x32_bf16 a[116:119], v[68:71], v[164:167], a[116:119]
v_cvt_pk_bf16_f32 v205, v213, v215
v_mfma_f32_16x16x32_bf16 a[120:123], v[64:67], v[152:155], 0
buffer_load_dwordx4 a[80:83], v2, s[8:11], s27 offen offset:1024 sc1
v_mfma_f32_16x16x32_bf16 a[120:123], v[68:71], v[168:171], a[120:123]
ds_read_b128 v[60:63], v2 offset:44032
v_mul_f32 v208, v112, v112
v_mfma_f32_16x16x32_bf16 a[124:127], v[64:67], v[156:159], 0
v_mul_f32 v210, v113, v113
v_fma_f32 v208, v208, v233, v232
v_mfma_f32_16x16x32_bf16 a[124:127], v[68:71], v[172:175], a[124:127]
v_fma_f32 v210, v210, v233, v232
s_waitcnt lgkmcnt(4)
v_mfma_f32_16x16x32_bf16 a[128:131], v[72:75], v[144:147], 0
buffer_load_dwordx4 a[84:87], v4, s[8:11], s27 offen offset:1024 sc1
v_mfma_f32_16x16x32_bf16 a[128:131], v[76:79], v[160:163], a[128:131]
v_mul_f32 v208, v208, v112
v_mul_f32 v210, v210, v113
v_mfma_f32_16x16x32_bf16 a[132:135], v[72:75], v[148:151], 0
ds_read_b128 v[64:67], v2 offset:45056
v_mul_f32 v209, v112, v128
v_mfma_f32_16x16x32_bf16 a[132:135], v[76:79], v[164:167], a[132:135]
v_exp_f32 v208, v208
v_mfma_f32_16x16x32_bf16 a[136:139], v[72:75], v[152:155], 0
buffer_load_dwordx4 a[88:91], v5, s[8:11], s27 offen offset:1024 sc1
v_mfma_f32_16x16x32_bf16 a[136:139], v[76:79], v[168:171], a[136:139]
ds_read_b128 v[68:71], v2 offset:46080
v_mul_f32 v211, v113, v129
v_mfma_f32_16x16x32_bf16 a[140:143], v[72:75], v[156:159], 0
v_exp_f32 v210, v210
v_mfma_f32_16x16x32_bf16 a[140:143], v[76:79], v[172:175], a[140:143]
v_fma_f32 v208, v208, v234, v234
s_waitcnt lgkmcnt(4)
v_mfma_f32_16x16x32_bf16 a[144:147], v[48:51], v[144:147], 0
buffer_load_dwordx4 a[92:95], v6, s[8:11], s27 offen offset:1024 sc1
v_mfma_f32_16x16x32_bf16 a[144:147], v[52:55], v[160:163], a[144:147]
v_fma_f32 v210, v210, v234, v234
v_mul_f32 v212, v114, v114
v_mfma_f32_16x16x32_bf16 a[148:151], v[48:51], v[148:151], 0
ds_read_b128 v[72:75], v2 offset:47104
v_mul_f32 v214, v115, v115
v_mfma_f32_16x16x32_bf16 a[148:151], v[52:55], v[164:167], a[148:151]
v_rcp_f32 v208, v208
v_mfma_f32_16x16x32_bf16 a[152:155], v[48:51], v[152:155], 0
v_rcp_f32 v210, v210
v_mfma_f32_16x16x32_bf16 a[152:155], v[52:55], v[168:171], a[152:155]
ds_read_b128 v[76:79], v2 offset:48128
v_mul_f32 v209, v209, v208
v_mfma_f32_16x16x32_bf16 a[156:159], v[48:51], v[156:159], 0
v_mul_f32 v211, v211, v210
v_cvt_pk_bf16_f32 v194, v209, v211
v_mfma_f32_16x16x32_bf16 a[156:159], v[52:55], v[172:175], a[156:159]
v_fma_f32 v212, v212, v233, v232
s_waitcnt lgkmcnt(4)
v_mfma_f32_16x16x32_bf16 a[160:163], v[56:59], v[144:147], 0
s_waitcnt vmcnt(49)
buffer_load_dwordx2 a[96:97], v244, s[8:11], s28 offen offset:0 sc1
v_mfma_f32_16x16x32_bf16 a[160:163], v[60:63], v[160:163], a[160:163]
s_barrier
v_mfma_f32_16x16x32_bf16 a[164:167], v[56:59], v[148:151], 0
ds_read_b128 v[48:51], v2 offset:49152
v_fma_f32 v214, v214, v233, v232
v_mfma_f32_16x16x32_bf16 a[164:167], v[60:63], v[164:167], a[164:167]
v_mul_f32 v212, v212, v114
v_mul_f32 v214, v214, v115
v_mfma_f32_16x16x32_bf16 a[168:171], v[56:59], v[152:155], 0
buffer_load_dwordx2 a[98:99], v244, s[8:11], s28 offen offset:512 sc1
v_mfma_f32_16x16x32_bf16 a[168:171], v[60:63], v[168:171], a[168:171]
ds_read_b128 v[52:55], v2 offset:50176
v_mul_f32 v213, v114, v130
v_mfma_f32_16x16x32_bf16 a[172:175], v[56:59], v[156:159], 0
v_exp_f32 v212, v212
v_mfma_f32_16x16x32_bf16 a[172:175], v[60:63], v[172:175], a[172:175]
v_mul_f32 v215, v115, v131
s_waitcnt lgkmcnt(4)
v_mfma_f32_16x16x32_bf16 a[176:179], v[64:67], v[144:147], 0
buffer_load_dwordx2 a[100:101], v245, s[8:11], s28 offen offset:0 sc1
v_mfma_f32_16x16x32_bf16 a[176:179], v[68:71], v[160:163], a[176:179]
v_exp_f32 v214, v214
v_mfma_f32_16x16x32_bf16 a[180:183], v[64:67], v[148:151], 0
ds_read_b128 v[56:59], v2 offset:51200
v_fma_f32 v212, v212, v234, v234
v_mfma_f32_16x16x32_bf16 a[180:183], v[68:71], v[164:167], a[180:183]
v_fma_f32 v214, v214, v234, v234
v_mul_f32 v208, v116, v116
v_mfma_f32_16x16x32_bf16 a[184:187], v[64:67], v[152:155], 0
buffer_load_dwordx2 a[102:103], v245, s[8:11], s28 offen offset:512 sc1
v_mfma_f32_16x16x32_bf16 a[184:187], v[68:71], v[168:171], a[184:187]
ds_read_b128 v[60:63], v2 offset:52224
v_mul_f32 v210, v117, v117
v_mfma_f32_16x16x32_bf16 a[188:191], v[64:67], v[156:159], 0
v_rcp_f32 v212, v212
v_mfma_f32_16x16x32_bf16 a[188:191], v[68:71], v[172:175], a[188:191]
v_mul_f32 v213, v213, v212
s_waitcnt lgkmcnt(4)
v_mfma_f32_16x16x32_bf16 a[192:195], v[72:75], v[144:147], 0
buffer_load_dwordx2 a[104:105], v246, s[8:11], s28 offen offset:0 sc1
v_mfma_f32_16x16x32_bf16 a[192:195], v[76:79], v[160:163], a[192:195]
v_rcp_f32 v214, v214
v_mfma_f32_16x16x32_bf16 a[196:199], v[72:75], v[148:151], 0
ds_read_b128 v[64:67], v2 offset:53248
v_mul_f32 v215, v215, v214
v_mfma_f32_16x16x32_bf16 a[196:199], v[76:79], v[164:167], a[196:199]
v_cvt_pk_bf16_f32 v195, v213, v215
v_fma_f32 v208, v208, v236, v235
v_mfma_f32_16x16x32_bf16 a[200:203], v[72:75], v[152:155], 0
buffer_load_dwordx2 a[106:107], v246, s[8:11], s28 offen offset:512 sc1
v_mfma_f32_16x16x32_bf16 a[200:203], v[76:79], v[168:171], a[200:203]
ds_read_b128 v[68:71], v2 offset:54272
v_fma_f32 v210, v210, v236, v235
v_mfma_f32_16x16x32_bf16 a[204:207], v[72:75], v[156:159], 0
buffer_store_dwordx4 v[192:195], v2, s[8:11], s24 offen offset:3072 sc1
v_mfma_f32_16x16x32_bf16 a[204:207], v[76:79], v[172:175], a[204:207]
v_mul_f32 v208, v208, v116
s_waitcnt lgkmcnt(4)
v_mfma_f32_16x16x32_bf16 a[208:211], v[48:51], v[144:147], 0
v_mul_f32 v210, v210, v117
v_mul_f32 v209, v116, v132
v_mfma_f32_16x16x32_bf16 a[208:211], v[52:55], v[160:163], a[208:211]
v_exp_f32 v208, v208
v_mfma_f32_16x16x32_bf16 a[212:215], v[48:51], v[148:151], 0
ds_read_b128 v[72:75], v2 offset:55296
v_mul_f32 v211, v117, v133
v_mfma_f32_16x16x32_bf16 a[212:215], v[52:55], v[164:167], a[212:215]
buffer_load_dwordx2 a[108:109], v247, s[8:11], s28 offen offset:0 sc1
v_mfma_f32_16x16x32_bf16 a[216:219], v[48:51], v[152:155], 0
v_exp_f32 v210, v210
v_mfma_f32_16x16x32_bf16 a[216:219], v[52:55], v[168:171], a[216:219]
ds_read_b128 v[76:79], v2 offset:56320
v_fma_f32 v208, v208, v237, v237
v_mfma_f32_16x16x32_bf16 a[220:223], v[48:51], v[156:159], 0
v_fma_f32 v210, v210, v237, v237
v_mul_f32 v212, v118, v118
v_mfma_f32_16x16x32_bf16 a[220:223], v[52:55], v[172:175], a[220:223]
v_mul_f32 v214, v119, v119
s_waitcnt lgkmcnt(4)
v_mfma_f32_16x16x32_bf16 a[224:227], v[56:59], v[144:147], 0
buffer_load_dwordx2 a[110:111], v247, s[8:11], s28 offen offset:512 sc1
v_mfma_f32_16x16x32_bf16 a[224:227], v[60:63], v[160:163], a[224:227]
s_add_u32 m0, s22, 0
v_add_u32 v3, 20480, v3
v_mfma_f32_16x16x32_bf16 a[228:231], v[56:59], v[148:151], 0
ds_read_b128 v[48:51], v2 offset:57344
v_fma_f32 v212, v212, v236, v235
v_mfma_f32_16x16x32_bf16 a[228:231], v[60:63], v[164:167], a[228:231]
v_rcp_f32 v208, v208
v_mfma_f32_16x16x32_bf16 a[232:235], v[56:59], v[152:155], 0
buffer_load_dwordx4 v3, s[8:11], 0 offen offset:0 sc1 lds
v_mfma_f32_16x16x32_bf16 a[232:235], v[60:63], v[168:171], a[232:235]
ds_read_b128 v[52:55], v2 offset:58368
v_mul_f32 v209, v209, v208
v_mfma_f32_16x16x32_bf16 a[236:239], v[56:59], v[156:159], 0
v_rcp_f32 v210, v210
v_mfma_f32_16x16x32_bf16 a[236:239], v[60:63], v[172:175], a[236:239]
v_mul_f32 v211, v211, v210
s_waitcnt lgkmcnt(4)
v_mfma_f32_16x16x32_bf16 a[240:243], v[64:67], v[144:147], 0
buffer_load_dwordx4 v3, s[8:11], 0 offen offset:1024 sc1 lds
v_mfma_f32_16x16x32_bf16 a[240:243], v[68:71], v[160:163], a[240:243]
v_cvt_pk_bf16_f32 v198, v209, v211
v_fma_f32 v214, v214, v236, v235
v_mfma_f32_16x16x32_bf16 a[244:247], v[64:67], v[148:151], 0
ds_read_b128 v[56:59], v2 offset:59392
v_mul_f32 v212, v212, v118
v_mfma_f32_16x16x32_bf16 a[244:247], v[68:71], v[164:167], a[244:247]
v_mul_f32 v214, v214, v119
v_mul_f32 v213, v118, v134
v_mfma_f32_16x16x32_bf16 a[248:251], v[64:67], v[152:155], 0
buffer_load_dwordx4 v3, s[8:11], 0 offen offset:2048 sc1 lds
v_mfma_f32_16x16x32_bf16 a[248:251], v[68:71], v[168:171], a[248:251]
ds_read_b128 v[60:63], v2 offset:60416
v_mul_f32 v215, v119, v135
v_mfma_f32_16x16x32_bf16 a[252:255], v[64:67], v[156:159], 0
v_exp_f32 v212, v212
v_mfma_f32_16x16x32_bf16 a[252:255], v[68:71], v[172:175], a[252:255]
v_fma_f32 v212, v212, v237, v237
s_waitcnt vmcnt(39)
s_waitcnt lgkmcnt(4)
v_mfma_f32_16x16x32_bf16 a[112:115], v[72:75], v[176:179], a[112:115]
buffer_load_dwordx4 v3, s[8:11], 0 offen offset:3072 sc1 lds
v_mfma_f32_16x16x32_bf16 a[112:115], v[76:79], a[0:3], a[112:115]
s_add_u32 m0, s22, 4096
v_add_u32 v3, 4096, v3
v_mfma_f32_16x16x32_bf16 a[116:119], v[72:75], v[180:183], a[116:119]
ds_read_b128 v[64:67], v2 offset:61440
v_mul_f32 v208, v120, v120
v_mfma_f32_16x16x32_bf16 a[116:119], v[76:79], a[4:7], a[116:119]
v_exp_f32 v214, v214
v_mfma_f32_16x16x32_bf16 a[120:123], v[72:75], v[184:187], a[120:123]
buffer_load_dwordx4 v3, s[8:11], 0 offen offset:0 sc1 lds
v_mfma_f32_16x16x32_bf16 a[120:123], v[76:79], a[8:11], a[120:123]
ds_read_b128 v[68:71], v2 offset:62464
v_fma_f32 v214, v214, v237, v237
v_mfma_f32_16x16x32_bf16 a[124:127], v[72:75], v[188:191], a[124:127]
v_rcp_f32 v212, v212
v_mfma_f32_16x16x32_bf16 a[124:127], v[76:79], a[12:15], a[124:127]
v_mul_f32 v213, v213, v212
s_waitcnt lgkmcnt(4)
v_mfma_f32_16x16x32_bf16 a[128:131], v[48:51], v[176:179], a[128:131]
buffer_load_dwordx4 v3, s[8:11], 0 offen offset:1024 sc1 lds
v_mfma_f32_16x16x32_bf16 a[128:131], v[52:55], a[0:3], a[128:131]
s_add_u32 s23, s34, 131072
v_mul_f32 v210, v121, v121
v_mfma_f32_16x16x32_bf16 a[132:135], v[48:51], v[180:183], a[132:135]
ds_read_b128 v[72:75], v2 offset:63488
v_fma_f32 v208, v208, v239, v238
v_mfma_f32_16x16x32_bf16 a[132:135], v[52:55], a[4:7], a[132:135]
v_rcp_f32 v214, v214
v_mfma_f32_16x16x32_bf16 a[136:139], v[48:51], v[184:187], a[136:139]
buffer_load_dwordx2 v[14:15], v11, s[8:11], s23 offen sc1
v_mfma_f32_16x16x32_bf16 a[136:139], v[52:55], a[8:11], a[136:139]
ds_read_b128 v[76:79], v2 offset:64512
v_mul_f32 v215, v215, v214
v_mfma_f32_16x16x32_bf16 a[140:143], v[48:51], v[188:191], a[140:143]
v_cvt_pk_bf16_f32 v199, v213, v215
v_fma_f32 v210, v210, v239, v238
v_mfma_f32_16x16x32_bf16 a[140:143], v[52:55], a[12:15], a[140:143]
v_mul_f32 v208, v208, v120
s_waitcnt lgkmcnt(4)
v_mfma_f32_16x16x32_bf16 a[144:147], v[56:59], v[176:179], a[144:147]
buffer_load_dwordx2 v[16:17], v244, s[8:11], s29 offen offset:0 sc1
v_mfma_f32_16x16x32_bf16 a[144:147], v[60:63], a[0:3], a[144:147]
v_mul_f32 v210, v210, v121
v_mul_f32 v209, v120, v136
v_mfma_f32_16x16x32_bf16 a[148:151], v[56:59], v[180:183], a[148:151]
ds_read_b128 v[48:51], v7 offset:0
v_mul_f32 v211, v121, v137
v_mfma_f32_16x16x32_bf16 a[148:151], v[60:63], a[4:7], a[148:151]
buffer_store_dwordx4 v[196:199], v4, s[8:11], s24 offen offset:3072 sc1
v_mfma_f32_16x16x32_bf16 a[152:155], v[56:59], v[184:187], a[152:155]
v_exp_f32 v208, v208
v_mfma_f32_16x16x32_bf16 a[152:155], v[60:63], a[8:11], a[152:155]
ds_read_b128 v[52:55], v7 offset:1024
v_fma_f32 v208, v208, v240, v240
v_mfma_f32_16x16x32_bf16 a[156:159], v[56:59], v[188:191], a[156:159]
v_exp_f32 v210, v210
v_mfma_f32_16x16x32_bf16 a[156:159], v[60:63], a[12:15], a[156:159]
v_fma_f32 v210, v210, v240, v240
s_waitcnt lgkmcnt(4)
v_mfma_f32_16x16x32_bf16 a[160:163], v[64:67], v[176:179], a[160:163]
buffer_load_dwordx2 v[18:19], v244, s[8:11], s29 offen offset:512 sc1
v_mfma_f32_16x16x32_bf16 a[160:163], v[68:71], a[0:3], a[160:163]
v_rcp_f32 v208, v208
v_mfma_f32_16x16x32_bf16 a[164:167], v[64:67], v[180:183], a[164:167]
ds_read_b128 v[56:59], v7 offset:2048
v_mul_f32 v209, v209, v208
v_mfma_f32_16x16x32_bf16 a[164:167], v[68:71], a[4:7], a[164:167]
v_rcp_f32 v210, v210
v_mfma_f32_16x16x32_bf16 a[168:171], v[64:67], v[184:187], a[168:171]
buffer_load_dwordx2 v[20:21], v245, s[8:11], s29 offen offset:0 sc1
v_mfma_f32_16x16x32_bf16 a[168:171], v[68:71], a[8:11], a[168:171]
ds_read_b128 v[60:63], v7 offset:3072
v_mul_f32 v211, v211, v210
v_mfma_f32_16x16x32_bf16 a[172:175], v[64:67], v[188:191], a[172:175]
v_cvt_pk_bf16_f32 v202, v209, v211
v_mul_f32 v212, v122, v122
v_mfma_f32_16x16x32_bf16 a[172:175], v[68:71], a[12:15], a[172:175]
v_mul_f32 v214, v123, v123
s_waitcnt lgkmcnt(4)
v_mfma_f32_16x16x32_bf16 a[176:179], v[72:75], v[176:179], a[176:179]
buffer_load_dwordx2 v[22:23], v245, s[8:11], s29 offen offset:512 sc1
v_mfma_f32_16x16x32_bf16 a[176:179], v[76:79], a[0:3], a[176:179]
v_fma_f32 v212, v212, v239, v238
v_fma_f32 v214, v214, v239, v238
v_mfma_f32_16x16x32_bf16 a[180:183], v[72:75], v[180:183], a[180:183]
ds_read_b128 v[64:67], v7 offset:4096
v_mul_f32 v212, v212, v122
v_mfma_f32_16x16x32_bf16 a[180:183], v[76:79], a[4:7], a[180:183]
v_mul_f32 v214, v214, v123
v_mul_f32 v213, v122, v138
v_mfma_f32_16x16x32_bf16 a[184:187], v[72:75], v[184:187], a[184:187]
buffer_load_dwordx2 v[24:25], v246, s[8:11], s29 offen offset:0 sc1
v_mfma_f32_16x16x32_bf16 a[184:187], v[76:79], a[8:11], a[184:187]
ds_read_b128 v[68:71], v7 offset:5120
v_mul_f32 v215, v123, v139
v_mfma_f32_16x16x32_bf16 a[188:191], v[72:75], v[188:191], a[188:191]
v_exp_f32 v212, v212
v_mfma_f32_16x16x32_bf16 a[188:191], v[76:79], a[12:15], a[188:191]
v_fma_f32 v212, v212, v240, v240
s_waitcnt lgkmcnt(4)
v_mfma_f32_16x16x32_bf16 a[192:195], v[48:51], v[176:179], a[192:195]
buffer_load_dwordx2 v[26:27], v246, s[8:11], s29 offen offset:512 sc1
v_mfma_f32_16x16x32_bf16 a[192:195], v[52:55], a[0:3], a[192:195]
v_exp_f32 v214, v214
v_mfma_f32_16x16x32_bf16 a[196:199], v[48:51], v[180:183], a[196:199]
ds_read_b128 v[72:75], v7 offset:6144
v_fma_f32 v214, v214, v240, v240
v_mfma_f32_16x16x32_bf16 a[196:199], v[52:55], a[4:7], a[196:199]
v_rcp_f32 v212, v212
v_mfma_f32_16x16x32_bf16 a[200:203], v[48:51], v[184:187], a[200:203]
buffer_load_dwordx2 v[28:29], v247, s[8:11], s29 offen offset:0 sc1
v_mfma_f32_16x16x32_bf16 a[200:203], v[52:55], a[8:11], a[200:203]
ds_read_b128 v[76:79], v7 offset:7168
v_mul_f32 v213, v213, v212
v_mfma_f32_16x16x32_bf16 a[204:207], v[48:51], v[188:191], a[204:207]
v_rcp_f32 v214, v214
v_mfma_f32_16x16x32_bf16 a[204:207], v[52:55], a[12:15], a[204:207]
v_mul_f32 v215, v215, v214
s_waitcnt lgkmcnt(4)
v_mfma_f32_16x16x32_bf16 a[208:211], v[56:59], v[176:179], a[208:211]
s_waitcnt vmcnt(63)
v_cvt_pk_bf16_f32 v203, v213, v215
v_mfma_f32_16x16x32_bf16 a[208:211], v[60:63], a[0:3], a[208:211]
s_barrier
v_mfma_f32_16x16x32_bf16 a[212:215], v[56:59], v[180:183], a[212:215]
ds_read_b128 v[48:51], v7 offset:8192
v_mul_f32 v208, v124, v124
v_mfma_f32_16x16x32_bf16 a[212:215], v[60:63], a[4:7], a[212:215]
buffer_load_dwordx2 v[30:31], v247, s[8:11], s29 offen offset:512 sc1
v_mfma_f32_16x16x32_bf16 a[216:219], v[56:59], v[184:187], a[216:219]
s_add_u32 m0, s22, 24576
v_add_u32 v3, 20480, v3
v_mfma_f32_16x16x32_bf16 a[216:219], v[60:63], a[8:11], a[216:219]
ds_read_b128 v[52:55], v7 offset:9216
v_mul_f32 v210, v125, v125
v_mfma_f32_16x16x32_bf16 a[220:223], v[56:59], v[188:191], a[220:223]
buffer_store_dwordx4 v[200:203], v5, s[8:11], s24 offen offset:3072 sc1
v_mfma_f32_16x16x32_bf16 a[220:223], v[60:63], a[12:15], a[220:223]
v_fma_f32 v208, v208, v242, v241
s_waitcnt lgkmcnt(4)
v_mfma_f32_16x16x32_bf16 a[224:227], v[64:67], v[176:179], a[224:227]
v_fma_f32 v210, v210, v242, v241
v_mul_f32 v208, v208, v124
v_mfma_f32_16x16x32_bf16 a[224:227], v[68:71], a[0:3], a[224:227]
v_mul_f32 v210, v210, v125
v_mul_f32 v209, v124, v140
v_mfma_f32_16x16x32_bf16 a[228:231], v[64:67], v[180:183], a[228:231]
ds_read_b128 v[56:59], v7 offset:10240
v_mul_f32 v211, v125, v141
v_mfma_f32_16x16x32_bf16 a[228:231], v[68:71], a[4:7], a[228:231]
buffer_load_dwordx4 v3, s[8:11], 0 offen offset:0 sc1 lds
v_mfma_f32_16x16x32_bf16 a[232:235], v[64:67], v[184:187], a[232:235]
v_exp_f32 v208, v208
v_mfma_f32_16x16x32_bf16 a[232:235], v[68:71], a[8:11], a[232:235]
ds_read_b128 v[60:63], v7 offset:11264
v_exp_f32 v210, v210
v_mfma_f32_16x16x32_bf16 a[236:239], v[64:67], v[188:191], a[236:239]
v_fma_f32 v208, v208, v243, v243
v_fma_f32 v210, v210, v243, v243
v_mfma_f32_16x16x32_bf16 a[236:239], v[68:71], a[12:15], a[236:239]
v_rcp_f32 v208, v208
s_waitcnt lgkmcnt(4)
v_mfma_f32_16x16x32_bf16 a[240:243], v[72:75], v[176:179], a[240:243]
buffer_load_dwordx4 v3, s[8:11], 0 offen offset:1024 sc1 lds
v_rcp_f32 v210, v210
v_mfma_f32_16x16x32_bf16 a[240:243], v[76:79], a[0:3], a[240:243]
v_mul_f32 v209, v209, v208
v_mul_f32 v211, v211, v210
v_mfma_f32_16x16x32_bf16 a[244:247], v[72:75], v[180:183], a[244:247]
ds_read_b128 v[64:67], v7 offset:12288
v_cvt_pk_bf16_f32 v206, v209, v211
v_mfma_f32_16x16x32_bf16 a[244:247], v[76:79], a[4:7], a[244:247]
v_mul_f32 v212, v126, v126
v_mul_f32 v214, v127, v127
v_mfma_f32_16x16x32_bf16 a[248:251], v[72:75], v[184:187], a[248:251]
buffer_load_dwordx4 v3, s[8:11], 0 offen offset:2048 sc1 lds
v_fma_f32 v212, v212, v242, v241
v_mfma_f32_16x16x32_bf16 a[248:251], v[76:79], a[8:11], a[248:251]
ds_read_b128 v[68:71], v7 offset:13312
v_fma_f32 v214, v214, v242, v241
v_mfma_f32_16x16x32_bf16 a[252:255], v[72:75], v[188:191], a[252:255]
v_mul_f32 v212, v212, v126
v_mul_f32 v214, v214, v127
v_mfma_f32_16x16x32_bf16 a[252:255], v[76:79], a[12:15], a[252:255]
v_exp_f32 v212, v212
s_waitcnt vmcnt(47)
s_waitcnt lgkmcnt(4)
v_mfma_f32_16x16x32_bf16 a[112:115], v[48:51], a[16:19], a[112:115]
buffer_load_dwordx4 v3, s[8:11], 0 offen offset:3072 sc1 lds
v_exp_f32 v214, v214
v_mfma_f32_16x16x32_bf16 a[112:115], v[52:55], a[32:35], a[112:115]
s_add_u32 m0, s22, 28672
v_add_u32 v3, 4096, v3
v_mul_f32 v213, v126, v142
v_mfma_f32_16x16x32_bf16 a[116:119], v[48:51], a[20:23], a[116:119]
ds_read_b128 v[72:75], v7 offset:14336
v_mul_f32 v215, v127, v143
v_mfma_f32_16x16x32_bf16 a[116:119], v[52:55], a[36:39], a[116:119]
v_fma_f32 v212, v212, v243, v243
v_fma_f32 v214, v214, v243, v243
v_mfma_f32_16x16x32_bf16 a[120:123], v[48:51], a[24:27], a[120:123]
buffer_load_dwordx4 v3, s[8:11], 0 offen offset:0 sc1 lds
v_rcp_f32 v212, v212
v_mfma_f32_16x16x32_bf16 a[120:123], v[52:55], a[40:43], a[120:123]
ds_read_b128 v[76:79], v7 offset:15360
v_rcp_f32 v214, v214
v_mfma_f32_16x16x32_bf16 a[124:127], v[48:51], a[28:31], a[124:127]
v_mul_f32 v213, v213, v212
v_mul_f32 v215, v215, v214
v_mfma_f32_16x16x32_bf16 a[124:127], v[52:55], a[44:47], a[124:127]
v_cvt_pk_bf16_f32 v207, v213, v215
buffer_store_dwordx4 v[204:207], v6, s[8:11], s24 offen offset:3072 sc1
s_waitcnt lgkmcnt(4)
v_mfma_f32_16x16x32_bf16 a[128:131], v[56:59], a[16:19], a[128:131]
buffer_load_dwordx4 v3, s[8:11], 0 offen offset:1024 sc1 lds
v_mfma_f32_16x16x32_bf16 a[128:131], v[60:63], a[32:35], a[128:131]
s_waitcnt vmcnt(17)
v_cmp_eq_u64 vcc, s[68:69], v[14:15]
s_nop 0
s_cmp_eq_u64 vcc, exec
s_cbranch_scc0 L_f_slow2
L_f_back2:
v_mfma_f32_16x16x32_bf16 a[132:135], v[56:59], a[20:23], a[132:135]
ds_read_b128 v[48:51], v7 offset:16384
v_mfma_f32_16x16x32_bf16 a[132:135], v[60:63], a[36:39], a[132:135]
v_mfma_f32_16x16x32_bf16 a[136:139], v[56:59], a[24:27], a[136:139]
buffer_load_dwordx4 v[32:35], v2, s[8:11], s25 offen offset:2048 sc1
v_mfma_f32_16x16x32_bf16 a[136:139], v[60:63], a[40:43], a[136:139]
ds_read_b128 v[52:55], v7 offset:17408
v_mfma_f32_16x16x32_bf16 a[140:143], v[56:59], a[28:31], a[140:143]
v_mfma_f32_16x16x32_bf16 a[140:143], v[60:63], a[44:47], a[140:143]
s_waitcnt lgkmcnt(4)
v_mfma_f32_16x16x32_bf16 a[144:147], v[64:67], a[16:19], a[144:147]
buffer_load_dwordx4 v[36:39], v4, s[8:11], s25 offen offset:2048 sc1
v_mfma_f32_16x16x32_bf16 a[144:147], v[68:71], a[32:35], a[144:147]
v_mfma_f32_16x16x32_bf16 a[148:151], v[64:67], a[20:23], a[148:151]
ds_read_b128 v[56:59], v7 offset:18432
v_mfma_f32_16x16x32_bf16 a[148:151], v[68:71], a[36:39], a[148:151]
v_mfma_f32_16x16x32_bf16 a[152:155], v[64:67], a[24:27], a[152:155]
buffer_load_dwordx4 v[40:43], v5, s[8:11], s25 offen offset:2048 sc1
v_mfma_f32_16x16x32_bf16 a[152:155], v[68:71], a[40:43], a[152:155]
ds_read_b128 v[60:63], v7 offset:19456
v_mfma_f32_16x16x32_bf16 a[156:159], v[64:67], a[28:31], a[156:159]
v_mfma_f32_16x16x32_bf16 a[156:159], v[68:71], a[44:47], a[156:159]
s_waitcnt lgkmcnt(4)
v_mfma_f32_16x16x32_bf16 a[160:163], v[72:75], a[16:19], a[160:163]
buffer_load_dwordx4 v[44:47], v6, s[8:11], s25 offen offset:2048 sc1
v_mfma_f32_16x16x32_bf16 a[160:163], v[76:79], a[32:35], a[160:163]
v_mfma_f32_16x16x32_bf16 a[164:167], v[72:75], a[20:23], a[164:167]
ds_read_b128 v[64:67], v7 offset:20480
v_mfma_f32_16x16x32_bf16 a[164:167], v[76:79], a[36:39], a[164:167]
v_mfma_f32_16x16x32_bf16 a[168:171], v[72:75], a[24:27], a[168:171]
buffer_load_dwordx4 v[80:83], v2, s[8:11], s26 offen offset:2048 sc1
v_mfma_f32_16x16x32_bf16 a[168:171], v[76:79], a[40:43], a[168:171]
ds_read_b128 v[68:71], v7 offset:21504
v_mfma_f32_16x16x32_bf16 a[172:175], v[72:75], a[28:31], a[172:175]
v_mfma_f32_16x16x32_bf16 a[172:175], v[76:79], a[44:47], a[172:175]
s_waitcnt lgkmcnt(4)
v_mfma_f32_16x16x32_bf16 a[176:179], v[48:51], a[16:19], a[176:179]
buffer_load_dwordx4 v[84:87], v4, s[8:11], s26 offen offset:2048 sc1
v_mfma_f32_16x16x32_bf16 a[176:179], v[52:55], a[32:35], a[176:179]
v_mfma_f32_16x16x32_bf16 a[180:183], v[48:51], a[20:23], a[180:183]
ds_read_b128 v[72:75], v7 offset:22528
v_mfma_f32_16x16x32_bf16 a[180:183], v[52:55], a[36:39], a[180:183]
v_mfma_f32_16x16x32_bf16 a[184:187], v[48:51], a[24:27], a[184:187]
buffer_load_dwordx4 v[88:91], v5, s[8:11], s26 offen offset:2048 sc1
v_mfma_f32_16x16x32_bf16 a[184:187], v[52:55], a[40:43], a[184:187]
ds_read_b128 v[76:79], v7 offset:23552
v_mfma_f32_16x16x32_bf16 a[188:191], v[48:51], a[28:31], a[188:191]
v_mfma_f32_16x16x32_bf16 a[188:191], v[52:55], a[44:47], a[188:191]
s_waitcnt lgkmcnt(4)
v_mfma_f32_16x16x32_bf16 a[192:195], v[56:59], a[16:19], a[192:195]
buffer_load_dwordx4 v[92:95], v6, s[8:11], s26 offen offset:2048 sc1
v_mfma_f32_16x16x32_bf16 a[192:195], v[60:63], a[32:35], a[192:195]
v_mfma_f32_16x16x32_bf16 a[196:199], v[56:59], a[20:23], a[196:199]
ds_read_b128 v[48:51], v7 offset:24576
v_mfma_f32_16x16x32_bf16 a[196:199], v[60:63], a[36:39], a[196:199]
v_mfma_f32_16x16x32_bf16 a[200:203], v[56:59], a[24:27], a[200:203]
buffer_load_dwordx4 v[96:99], v2, s[8:11], s27 offen offset:2048 sc1
v_mfma_f32_16x16x32_bf16 a[200:203], v[60:63], a[40:43], a[200:203]
ds_read_b128 v[52:55], v7 offset:25600
v_mfma_f32_16x16x32_bf16 a[204:207], v[56:59], a[28:31], a[204:207]
v_mfma_f32_16x16x32_bf16 a[204:207], v[60:63], a[44:47], a[204:207]
s_waitcnt lgkmcnt(4)
v_mfma_f32_16x16x32_bf16 a[208:211], v[64:67], a[16:19], a[208:211]
buffer_load_dwordx4 v[100:103], v4, s[8:11], s27 offen offset:2048 sc1
v_mfma_f32_16x16x32_bf16 a[208:211], v[68:71], a[32:35], a[208:211]
v_mfma_f32_16x16x32_bf16 a[212:215], v[64:67], a[20:23], a[212:215]
ds_read_b128 v[56:59], v7 offset:26624
v_mfma_f32_16x16x32_bf16 a[212:215], v[68:71], a[36:39], a[212:215]
v_mfma_f32_16x16x32_bf16 a[216:219], v[64:67], a[24:27], a[216:219]
buffer_load_dwordx4 v[104:107], v5, s[8:11], s27 offen offset:2048 sc1
v_mfma_f32_16x16x32_bf16 a[216:219], v[68:71], a[40:43], a[216:219]
ds_read_b128 v[60:63], v7 offset:27648
v_mfma_f32_16x16x32_bf16 a[220:223], v[64:67], a[28:31], a[220:223]
v_mfma_f32_16x16x32_bf16 a[220:223], v[68:71], a[44:47], a[220:223]
s_waitcnt lgkmcnt(4)
v_mfma_f32_16x16x32_bf16 a[224:227], v[72:75], a[16:19], a[224:227]
buffer_load_dwordx4 v[108:111], v6, s[8:11], s27 offen offset:2048 sc1
v_mfma_f32_16x16x32_bf16 a[224:227], v[76:79], a[32:35], a[224:227]
v_mov_b32 v12, s68
v_mov_b32 v13, s69
v_mfma_f32_16x16x32_bf16 a[228:231], v[72:75], a[20:23], a[228:231]
ds_read_b128 v[64:67], v7 offset:28672
s_add_u32 s53, s34, 262144
v_mfma_f32_16x16x32_bf16 a[228:231], v[76:79], a[36:39], a[228:231]
s_waitcnt vmcnt(13)
v_mfma_f32_16x16x32_bf16 a[232:235], v[72:75], a[24:27], a[232:235]
buffer_store_dwordx2 v[12:13], v10, s[8:11], s53 offen sc1
v_mfma_f32_16x16x32_bf16 a[232:235], v[76:79], a[40:43], a[232:235]
ds_read_b128 v[68:71], v7 offset:29696
v_mfma_f32_16x16x32_bf16 a[236:239], v[72:75], a[28:31], a[236:239]
v_mfma_f32_16x16x32_bf16 a[236:239], v[76:79], a[44:47], a[236:239]
s_waitcnt lgkmcnt(4)
v_mfma_f32_16x16x32_bf16 a[240:243], v[48:51], a[16:19], a[240:243]
s_mul_i32 s48, s7, 2146435072
s_lshl_b32 s49, s6, 2
v_mfma_f32_16x16x32_bf16 a[240:243], v[52:55], a[32:35], a[240:243]
s_add_u32 s49, s49, s4
s_mul_i32 s50, s49, 6144
v_mfma_f32_16x16x32_bf16 a[244:247], v[48:51], a[20:23], a[244:247]
ds_read_b128 v[72:75], v7 offset:30720
s_add_u32 s50, s50, s48
v_mfma_f32_16x16x32_bf16 a[244:247], v[52:55], a[36:39], a[244:247]
s_add_u32 s50, s50, 6557696
s_mul_i32 s49, s49, 5120
v_mfma_f32_16x16x32_bf16 a[248:251], v[48:51], a[24:27], a[248:251]
s_add_u32 s48, s48, s49
s_and_b32 s49, s5, 3
v_mfma_f32_16x16x32_bf16 a[248:251], v[52:55], a[40:43], a[248:251]
ds_read_b128 v[76:79], v7 offset:31744
s_mul_i32 s49, s49, 589824
v_mfma_f32_16x16x32_bf16 a[252:255], v[48:51], a[28:31], a[252:255]
s_add_u32 s48, s48, s49
s_add_u32 s48, s48, 4198400
buffer_load_dwordx4 v[248:251], v2, s[8:11], s48 offen offset:0
v_mfma_f32_16x16x32_bf16 a[252:255], v[52:55], a[44:47], a[252:255]
s_waitcnt vmcnt(51)
s_waitcnt lgkmcnt(4)
v_mfma_f32_16x16x32_bf16 a[112:115], v[56:59], a[48:51], a[112:115]
s_waitcnt vmcnt(63)
v_mfma_f32_16x16x32_bf16 a[112:115], v[60:63], a[64:67], a[112:115]
s_barrier
v_mfma_f32_16x16x32_bf16 a[116:119], v[56:59], a[52:55], a[116:119]
ds_read_b128 v[48:51], v7 offset:32768
v_mfma_f32_16x16x32_bf16 a[116:119], v[60:63], a[68:71], a[116:119]
buffer_load_dwordx4 v[248:251], v2, s[8:11], s48 offen offset:1024
v_mfma_f32_16x16x32_bf16 a[120:123], v[56:59], a[56:59], a[120:123]
v_mfma_f32_16x16x32_bf16 a[120:123], v[60:63], a[72:75], a[120:123]
ds_read_b128 v[52:55], v7 offset:33792
v_mfma_f32_16x16x32_bf16 a[124:127], v[56:59], a[60:63], a[124:127]
v_mfma_f32_16x16x32_bf16 a[124:127], v[60:63], a[76:79], a[124:127]
s_waitcnt lgkmcnt(4)
v_mfma_f32_16x16x32_bf16 a[128:131], v[64:67], a[48:51], a[128:131]
buffer_load_dwordx4 v[248:251], v2, s[8:11], s48 offen offset:2048
v_mfma_f32_16x16x32_bf16 a[128:131], v[68:71], a[64:67], a[128:131]
v_mfma_f32_16x16x32_bf16 a[132:135], v[64:67], a[52:55], a[132:135]
ds_read_b128 v[56:59], v7 offset:34816
v_mfma_f32_16x16x32_bf16 a[132:135], v[68:71], a[68:71], a[132:135]
v_mfma_f32_16x16x32_bf16 a[136:139], v[64:67], a[56:59], a[136:139]
buffer_load_dwordx4 v[248:251], v2, s[8:11], s48 offen offset:3072
v_mfma_f32_16x16x32_bf16 a[136:139], v[68:71], a[72:75], a[136:139]
ds_read_b128 v[60:63], v7 offset:35840
s_add_u32 s48, s48, 4096
v_mfma_f32_16x16x32_bf16 a[140:143], v[64:67], a[60:63], a[140:143]
v_mfma_f32_16x16x32_bf16 a[140:143], v[68:71], a[76:79], a[140:143]
s_waitcnt lgkmcnt(4)
v_mfma_f32_16x16x32_bf16 a[144:147], v[72:75], a[48:51], a[144:147]
buffer_load_dwordx4 v[248:251], v2, s[8:11], s48 offen offset:0
v_mfma_f32_16x16x32_bf16 a[144:147], v[76:79], a[64:67], a[144:147]
v_mfma_f32_16x16x32_bf16 a[148:151], v[72:75], a[52:55], a[148:151]
ds_read_b128 v[64:67], v7 offset:36864
v_mfma_f32_16x16x32_bf16 a[148:151], v[76:79], a[68:71], a[148:151]
v_mfma_f32_16x16x32_bf16 a[152:155], v[72:75], a[56:59], a[152:155]
buffer_load_dwordx4 v[248:251], v2, s[8:11], s50 offen offset:0
v_mfma_f32_16x16x32_bf16 a[152:155], v[76:79], a[72:75], a[152:155]
ds_read_b128 v[68:71], v7 offset:37888
v_mfma_f32_16x16x32_bf16 a[156:159], v[72:75], a[60:63], a[156:159]
v_mfma_f32_16x16x32_bf16 a[156:159], v[76:79], a[76:79], a[156:159]
s_waitcnt lgkmcnt(4)
v_mfma_f32_16x16x32_bf16 a[160:163], v[48:51], a[48:51], a[160:163]
buffer_load_dwordx4 v[248:251], v2, s[8:11], s50 offen offset:1024
v_mfma_f32_16x16x32_bf16 a[160:163], v[52:55], a[64:67], a[160:163]
v_mfma_f32_16x16x32_bf16 a[164:167], v[48:51], a[52:55], a[164:167]
ds_read_b128 v[72:75], v7 offset:38912
v_mfma_f32_16x16x32_bf16 a[164:167], v[52:55], a[68:71], a[164:167]
v_mfma_f32_16x16x32_bf16 a[168:171], v[48:51], a[56:59], a[168:171]
buffer_load_dwordx4 v[248:251], v2, s[8:11], s50 offen offset:2048
v_mfma_f32_16x16x32_bf16 a[168:171], v[52:55], a[72:75], a[168:171]
ds_read_b128 v[76:79], v7 offset:39936
v_mfma_f32_16x16x32_bf16 a[172:175], v[48:51], a[60:63], a[172:175]
v_mfma_f32_16x16x32_bf16 a[172:175], v[52:55], a[76:79], a[172:175]
s_waitcnt lgkmcnt(4)
v_mfma_f32_16x16x32_bf16 a[176:179], v[56:59], a[48:51], a[176:179]
buffer_load_dwordx4 v[248:251], v2, s[8:11], s50 offen offset:3072
v_mfma_f32_16x16x32_bf16 a[176:179], v[60:63], a[64:67], a[176:179]
s_add_u32 s50, s50, 4096
v_mfma_f32_16x16x32_bf16 a[180:183], v[56:59], a[52:55], a[180:183]
ds_read_b128 v[48:51], v7 offset:40960
v_mfma_f32_16x16x32_bf16 a[180:183], v[60:63], a[68:71], a[180:183]
v_mfma_f32_16x16x32_bf16 a[184:187], v[56:59], a[56:59], a[184:187]
buffer_load_dwordx4 v[248:251], v2, s[8:11], s50 offen offset:0
v_mfma_f32_16x16x32_bf16 a[184:187], v[60:63], a[72:75], a[184:187]
ds_read_b128 v[52:55], v7 offset:41984
v_mfma_f32_16x16x32_bf16 a[188:191], v[56:59], a[60:63], a[188:191]
v_mfma_f32_16x16x32_bf16 a[188:191], v[60:63], a[76:79], a[188:191]
s_waitcnt lgkmcnt(4)
v_mfma_f32_16x16x32_bf16 a[192:195], v[64:67], a[48:51], a[192:195]
buffer_load_dwordx4 v[248:251], v2, s[8:11], s50 offen offset:1024
v_mfma_f32_16x16x32_bf16 a[192:195], v[68:71], a[64:67], a[192:195]
s_add_u32 m0, s22, 49152
v_add_u32 v3, 20480, v3
v_mfma_f32_16x16x32_bf16 a[196:199], v[64:67], a[52:55], a[196:199]
ds_read_b128 v[56:59], v7 offset:43008
v_mfma_f32_16x16x32_bf16 a[196:199], v[68:71], a[68:71], a[196:199]
v_mfma_f32_16x16x32_bf16 a[200:203], v[64:67], a[56:59], a[200:203]
buffer_load_dwordx4 v3, s[8:11], 0 offen offset:0 sc1 lds
v_mfma_f32_16x16x32_bf16 a[200:203], v[68:71], a[72:75], a[200:203]
ds_read_b128 v[60:63], v7 offset:44032
v_mfma_f32_16x16x32_bf16 a[204:207], v[64:67], a[60:63], a[204:207]
v_mfma_f32_16x16x32_bf16 a[204:207], v[68:71], a[76:79], a[204:207]
s_waitcnt lgkmcnt(4)
v_mfma_f32_16x16x32_bf16 a[208:211], v[72:75], a[48:51], a[208:211]
buffer_load_dwordx4 v3, s[8:11], 0 offen offset:1024 sc1 lds
v_mfma_f32_16x16x32_bf16 a[208:211], v[76:79], a[64:67], a[208:211]
v_mfma_f32_16x16x32_bf16 a[212:215], v[72:75], a[52:55], a[212:215]
ds_read_b128 v[64:67], v7 offset:45056
v_mfma_f32_16x16x32_bf16 a[212:215], v[76:79], a[68:71], a[212:215]
v_mfma_f32_16x16x32_bf16 a[216:219], v[72:75], a[56:59], a[216:219]
buffer_load_dwordx4 v3, s[8:11], 0 offen offset:2048 sc1 lds
v_mfma_f32_16x16x32_bf16 a[216:219], v[76:79], a[72:75], a[216:219]
ds_read_b128 v[68:71], v7 offset:46080
v_mfma_f32_16x16x32_bf16 a[220:223], v[72:75], a[60:63], a[220:223]
v_mfma_f32_16x16x32_bf16 a[220:223], v[76:79], a[76:79], a[220:223]
s_waitcnt lgkmcnt(4)
v_mfma_f32_16x16x32_bf16 a[224:227], v[48:51], a[48:51], a[224:227]
buffer_load_dwordx4 v3, s[8:11], 0 offen offset:3072 sc1 lds
v_mfma_f32_16x16x32_bf16 a[224:227], v[52:55], a[64:67], a[224:227]
s_add_u32 m0, s22, 53248
v_add_u32 v3, 4096, v3
v_mfma_f32_16x16x32_bf16 a[228:231], v[48:51], a[52:55], a[228:231]
ds_read_b128 v[72:75], v7 offset:47104
v_mfma_f32_16x16x32_bf16 a[228:231], v[52:55], a[68:71], a[228:231]
v_mfma_f32_16x16x32_bf16 a[232:235], v[48:51], a[56:59], a[232:235]
buffer_load_dwordx4 v3, s[8:11], 0 offen offset:0 sc1 lds
v_mfma_f32_16x16x32_bf16 a[232:235], v[52:55], a[72:75], a[232:235]
ds_read_b128 v[76:79], v7 offset:48128
v_mfma_f32_16x16x32_bf16 a[236:239], v[48:51], a[60:63], a[236:239]
v_mfma_f32_16x16x32_bf16 a[236:239], v[52:55], a[76:79], a[236:239]
s_waitcnt lgkmcnt(4)
v_mfma_f32_16x16x32_bf16 a[240:243], v[56:59], a[48:51], a[240:243]
buffer_load_dwordx4 v3, s[8:11], 0 offen offset:1024 sc1 lds
v_mfma_f32_16x16x32_bf16 a[240:243], v[60:63], a[64:67], a[240:243]
s_add_u32 s23, s34, 262144
v_mfma_f32_16x16x32_bf16 a[244:247], v[56:59], a[52:55], a[244:247]
ds_read_b128 v[48:51], v7 offset:49152
v_mfma_f32_16x16x32_bf16 a[244:247], v[60:63], a[68:71], a[244:247]
v_mfma_f32_16x16x32_bf16 a[248:251], v[56:59], a[56:59], a[248:251]
buffer_load_dwordx2 v[14:15], v11, s[8:11], s23 offen sc1
v_mfma_f32_16x16x32_bf16 a[248:251], v[60:63], a[72:75], a[248:251]
ds_read_b128 v[52:55], v7 offset:50176
v_mfma_f32_16x16x32_bf16 a[252:255], v[56:59], a[60:63], a[252:255]
v_mfma_f32_16x16x32_bf16 a[252:255], v[60:63], a[76:79], a[252:255]
s_waitcnt vmcnt(55)
s_waitcnt lgkmcnt(4)
v_mfma_f32_16x16x32_bf16 a[112:115], v[64:67], a[80:83], a[112:115]
v_mfma_f32_16x16x32_bf16 a[112:115], v[68:71], a[96:99], a[112:115]
v_mfma_f32_16x16x32_bf16 a[116:119], v[64:67], a[84:87], a[116:119]
ds_read_b128 v[56:59], v7 offset:51200
v_mfma_f32_16x16x32_bf16 a[116:119], v[68:71], a[100:103], a[116:119]
v_mfma_f32_16x16x32_bf16 a[120:123], v[64:67], a[88:91], a[120:123]
v_mfma_f32_16x16x32_bf16 a[120:123], v[68:71], a[104:107], a[120:123]
ds_read_b128 v[60:63], v7 offset:52224
v_mfma_f32_16x16x32_bf16 a[124:127], v[64:67], a[92:95], a[124:127]
v_mfma_f32_16x16x32_bf16 a[124:127], v[68:71], a[108:111], a[124:127]
s_waitcnt lgkmcnt(4)
v_mfma_f32_16x16x32_bf16 a[128:131], v[72:75], a[80:83], a[128:131]
v_mfma_f32_16x16x32_bf16 a[128:131], v[76:79], a[96:99], a[128:131]
v_mfma_f32_16x16x32_bf16 a[132:135], v[72:75], a[84:87], a[132:135]
ds_read_b128 v[64:67], v7 offset:53248
v_mfma_f32_16x16x32_bf16 a[132:135], v[76:79], a[100:103], a[132:135]
v_mfma_f32_16x16x32_bf16 a[136:139], v[72:75], a[88:91], a[136:139]
v_mfma_f32_16x16x32_bf16 a[136:139], v[76:79], a[104:107], a[136:139]
ds_read_b128 v[68:71], v7 offset:54272
v_mfma_f32_16x16x32_bf16 a[140:143], v[72:75], a[92:95], a[140:143]
v_mfma_f32_16x16x32_bf16 a[140:143], v[76:79], a[108:111], a[140:143]
s_waitcnt lgkmcnt(4)
v_mfma_f32_16x16x32_bf16 a[144:147], v[48:51], a[80:83], a[144:147]
v_mfma_f32_16x16x32_bf16 a[144:147], v[52:55], a[96:99], a[144:147]
v_mfma_f32_16x16x32_bf16 a[148:151], v[48:51], a[84:87], a[148:151]
ds_read_b128 v[72:75], v7 offset:55296
v_mfma_f32_16x16x32_bf16 a[148:151], v[52:55], a[100:103], a[148:151]
v_mfma_f32_16x16x32_bf16 a[152:155], v[48:51], a[88:91], a[152:155]
v_mfma_f32_16x16x32_bf16 a[152:155], v[52:55], a[104:107], a[152:155]
ds_read_b128 v[76:79], v7 offset:56320
v_mfma_f32_16x16x32_bf16 a[156:159], v[48:51], a[92:95], a[156:159]
v_mfma_f32_16x16x32_bf16 a[156:159], v[52:55], a[108:111], a[156:159]
s_waitcnt lgkmcnt(4)
v_mfma_f32_16x16x32_bf16 a[160:163], v[56:59], a[80:83], a[160:163]
s_waitcnt vmcnt(63)
v_mfma_f32_16x16x32_bf16 a[160:163], v[60:63], a[96:99], a[160:163]
s_barrier
v_mfma_f32_16x16x32_bf16 a[164:167], v[56:59], a[84:87], a[164:167]
ds_read_b128 v[48:51], v7 offset:57344
v_mfma_f32_16x16x32_bf16 a[164:167], v[60:63], a[100:103], a[164:167]
v_mfma_f32_16x16x32_bf16 a[168:171], v[56:59], a[88:91], a[168:171]
v_mfma_f32_16x16x32_bf16 a[168:171], v[60:63], a[104:107], a[168:171]
ds_read_b128 v[52:55], v7 offset:58368
v_mfma_f32_16x16x32_bf16 a[172:175], v[56:59], a[92:95], a[172:175]
v_mfma_f32_16x16x32_bf16 a[172:175], v[60:63], a[108:111], a[172:175]
s_waitcnt lgkmcnt(4)
v_mfma_f32_16x16x32_bf16 a[176:179], v[64:67], a[80:83], a[176:179]
v_mfma_f32_16x16x32_bf16 a[176:179], v[68:71], a[96:99], a[176:179]
v_mfma_f32_16x16x32_bf16 a[180:183], v[64:67], a[84:87], a[180:183]
ds_read_b128 v[56:59], v7 offset:59392
v_mfma_f32_16x16x32_bf16 a[180:183], v[68:71], a[100:103], a[180:183]
v_mfma_f32_16x16x32_bf16 a[184:187], v[64:67], a[88:91], a[184:187]
v_mfma_f32_16x16x32_bf16 a[184:187], v[68:71], a[104:107], a[184:187]
ds_read_b128 v[60:63], v7 offset:60416
v_mfma_f32_16x16x32_bf16 a[188:191], v[64:67], a[92:95], a[188:191]
v_mfma_f32_16x16x32_bf16 a[188:191], v[68:71], a[108:111], a[188:191]
s_waitcnt lgkmcnt(4)
v_mfma_f32_16x16x32_bf16 a[192:195], v[72:75], a[80:83], a[192:195]
v_mfma_f32_16x16x32_bf16 a[192:195], v[76:79], a[96:99], a[192:195]
v_mfma_f32_16x16x32_bf16 a[196:199], v[72:75], a[84:87], a[196:199]
ds_read_b128 v[64:67], v7 offset:61440
v_mfma_f32_16x16x32_bf16 a[196:199], v[76:79], a[100:103], a[196:199]
v_mfma_f32_16x16x32_bf16 a[200:203], v[72:75], a[88:91], a[200:203]
v_mfma_f32_16x16x32_bf16 a[200:203], v[76:79], a[104:107], a[200:203]
ds_read_b128 v[68:71], v7 offset:62464
v_mfma_f32_16x16x32_bf16 a[204:207], v[72:75], a[92:95], a[204:207]
v_mfma_f32_16x16x32_bf16 a[204:207], v[76:79], a[108:111], a[204:207]
s_waitcnt lgkmcnt(4)
v_mfma_f32_16x16x32_bf16 a[208:211], v[48:51], a[80:83], a[208:211]
v_mfma_f32_16x16x32_bf16 a[208:211], v[52:55], a[96:99], a[208:211]
v_mfma_f32_16x16x32_bf16 a[212:215], v[48:51], a[84:87], a[212:215]
ds_read_b128 v[72:75], v7 offset:63488
v_mfma_f32_16x16x32_bf16 a[212:215], v[52:55], a[100:103], a[212:215]
v_mfma_f32_16x16x32_bf16 a[216:219], v[48:51], a[88:91], a[216:219]
v_mfma_f32_16x16x32_bf16 a[216:219], v[52:55], a[104:107], a[216:219]
ds_read_b128 v[76:79], v7 offset:64512
v_mfma_f32_16x16x32_bf16 a[220:223], v[48:51], a[92:95], a[220:223]
v_mfma_f32_16x16x32_bf16 a[220:223], v[52:55], a[108:111], a[220:223]
s_waitcnt lgkmcnt(4)
v_mfma_f32_16x16x32_bf16 a[224:227], v[56:59], a[80:83], a[224:227]
v_mfma_f32_16x16x32_bf16 a[224:227], v[60:63], a[96:99], a[224:227]
v_mfma_f32_16x16x32_bf16 a[228:231], v[56:59], a[84:87], a[228:231]
ds_read_b128 v[48:51], v8 offset:0
v_mfma_f32_16x16x32_bf16 a[228:231], v[60:63], a[100:103], a[228:231]
v_mfma_f32_16x16x32_bf16 a[232:235], v[56:59], a[88:91], a[232:235]
v_mfma_f32_16x16x32_bf16 a[232:235], v[60:63], a[104:107], a[232:235]
ds_read_b128 v[52:55], v8 offset:1024
v_mfma_f32_16x16x32_bf16 a[236:239], v[56:59], a[92:95], a[236:239]
v_mfma_f32_16x16x32_bf16 a[236:239], v[60:63], a[108:111], a[236:239]
s_waitcnt lgkmcnt(4)
v_mfma_f32_16x16x32_bf16 a[240:243], v[64:67], a[80:83], a[240:243]
s_waitcnt vmcnt(0)
v_cmp_eq_u64 vcc, s[68:69], v[14:15]
s_nop 0
s_cmp_eq_u64 vcc, exec
s_cbranch_scc0 L_f_slow3
L_f_back3:
buffer_load_dwordx4 v[112:115], v2, s[8:11], s25 offen offset:3072 sc1
v_mfma_f32_16x16x32_bf16 a[240:243], v[68:71], a[96:99], a[240:243]
v_mfma_f32_16x16x32_bf16 a[244:247], v[64:67], a[84:87], a[244:247]
ds_read_b128 v[56:59], v8 offset:2048
v_mfma_f32_16x16x32_bf16 a[244:247], v[68:71], a[100:103], a[244:247]
v_mfma_f32_16x16x32_bf16 a[248:251], v[64:67], a[88:91], a[248:251]
buffer_load_dwordx4 v[116:119], v4, s[8:11], s25 offen offset:3072 sc1
v_mfma_f32_16x16x32_bf16 a[248:251], v[68:71], a[104:107], a[248:251]
ds_read_b128 v[60:63], v8 offset:3072
v_mfma_f32_16x16x32_bf16 a[252:255], v[64:67], a[92:95], a[252:255]
v_mfma_f32_16x16x32_bf16 a[252:255], v[68:71], a[108:111], a[252:255]
s_waitcnt vmcnt(41)
s_waitcnt lgkmcnt(4)
v_mfma_f32_16x16x32_bf16 a[112:115], v[72:75], v[16:19], a[112:115]
buffer_load_dwordx4 v[120:123], v5, s[8:11], s25 offen offset:3072 sc1
v_mfma_f32_16x16x32_bf16 a[112:115], v[76:79], v[192:195], a[112:115]
v_mfma_f32_16x16x32_bf16 a[116:119], v[72:75], v[20:23], a[116:119]
ds_read_b128 v[64:67], v8 offset:4096
v_mfma_f32_16x16x32_bf16 a[116:119], v[76:79], v[196:199], a[116:119]
v_mfma_f32_16x16x32_bf16 a[120:123], v[72:75], v[24:27], a[120:123]
buffer_load_dwordx4 v[124:127], v6, s[8:11], s25 offen offset:3072 sc1
v_mfma_f32_16x16x32_bf16 a[120:123], v[76:79], v[200:203], a[120:123]
ds_read_b128 v[68:71], v8 offset:5120
v_mfma_f32_16x16x32_bf16 a[124:127], v[72:75], v[28:31], a[124:127]
v_mfma_f32_16x16x32_bf16 a[124:127], v[76:79], v[204:207], a[124:127]
s_waitcnt lgkmcnt(4)
v_mfma_f32_16x16x32_bf16 a[128:131], v[48:51], v[16:19], a[128:131]
buffer_load_dwordx4 v[128:131], v2, s[8:11], s26 offen offset:3072 sc1
v_mfma_f32_16x16x32_bf16 a[128:131], v[52:55], v[192:195], a[128:131]
v_mfma_f32_16x16x32_bf16 a[132:135], v[48:51], v[20:23], a[132:135]
ds_read_b128 v[72:75], v8 offset:6144
v_mfma_f32_16x16x32_bf16 a[132:135], v[52:55], v[196:199], a[132:135]
v_mfma_f32_16x16x32_bf16 a[136:139], v[48:51], v[24:27], a[136:139]
buffer_load_dwordx4 v[132:135], v4, s[8:11], s26 offen offset:3072 sc1
v_mfma_f32_16x16x32_bf16 a[136:139], v[52:55], v[200:203], a[136:139]
ds_read_b128 v[76:79], v8 offset:7168
v_mfma_f32_16x16x32_bf16 a[140:143], v[48:51], v[28:31], a[140:143]
v_mfma_f32_16x16x32_bf16 a[140:143], v[52:55], v[204:207], a[140:143]
s_waitcnt lgkmcnt(4)
v_mfma_f32_16x16x32_bf16 a[144:147], v[56:59], v[16:19], a[144:147]
buffer_load_dwordx4 v[136:139], v5, s[8:11], s26 offen offset:3072 sc1
v_mfma_f32_16x16x32_bf16 a[144:147], v[60:63], v[192:195], a[144:147]
v_mfma_f32_16x16x32_bf16 a[148:151], v[56:59], v[20:23], a[148:151]
ds_read_b128 v[48:51], v8 offset:8192
v_mfma_f32_16x16x32_bf16 a[148:151], v[60:63], v[196:199], a[148:151]
v_mfma_f32_16x16x32_bf16 a[152:155], v[56:59], v[24:27], a[152:155]
buffer_load_dwordx4 v[140:143], v6, s[8:11], s26 offen offset:3072 sc1
v_mfma_f32_16x16x32_bf16 a[152:155], v[60:63], v[200:203], a[152:155]
ds_read_b128 v[52:55], v8 offset:9216
v_mfma_f32_16x16x32_bf16 a[156:159], v[56:59], v[28:31], a[156:159]
v_mfma_f32_16x16x32_bf16 a[156:159], v[60:63], v[204:207], a[156:159]
s_waitcnt lgkmcnt(4)
v_mfma_f32_16x16x32_bf16 a[160:163], v[64:67], v[16:19], a[160:163]
buffer_load_dwordx4 v[144:147], v2, s[8:11], s27 offen offset:3072 sc1
v_mfma_f32_16x16x32_bf16 a[160:163], v[68:71], v[192:195], a[160:163]
v_mfma_f32_16x16x32_bf16 a[164:167], v[64:67], v[20:23], a[164:167]
ds_read_b128 v[56:59], v8 offset:10240
v_mfma_f32_16x16x32_bf16 a[164:167], v[68:71], v[196:199], a[164:167]
v_mfma_f32_16x16x32_bf16 a[168:171], v[64:67], v[24:27], a[168:171]
buffer_load_dwordx4 v[148:151], v4, s[8:11], s27 offen offset:3072 sc1
v_mfma_f32_16x16x32_bf16 a[168:171], v[68:71], v[200:203], a[168:171]
ds_read_b128 v[60:63], v8 offset:11264
v_mfma_f32_16x16x32_bf16 a[172:175], v[64:67], v[28:31], a[172:175]
v_mfma_f32_16x16x32_bf16 a[172:175], v[68:71], v[204:207], a[172:175]
s_waitcnt lgkmcnt(4)
v_mfma_f32_16x16x32_bf16 a[176:179], v[72:75], v[16:19], a[176:179]
buffer_load_dwordx4 v[152:155], v5, s[8:11], s27 offen offset:3072 sc1
v_mfma_f32_16x16x32_bf16 a[176:179], v[76:79], v[192:195], a[176:179]
v_mfma_f32_16x16x32_bf16 a[180:183], v[72:75], v[20:23], a[180:183]
ds_read_b128 v[64:67], v8 offset:12288
v_mfma_f32_16x16x32_bf16 a[180:183], v[76:79], v[196:199], a[180:183]
v_mfma_f32_16x16x32_bf16 a[184:187], v[72:75], v[24:27], a[184:187]
buffer_load_dwordx4 v[156:159], v6, s[8:11], s27 offen offset:3072 sc1
v_mfma_f32_16x16x32_bf16 a[184:187], v[76:79], v[200:203], a[184:187]
ds_read_b128 v[68:71], v8 offset:13312
v_mfma_f32_16x16x32_bf16 a[188:191], v[72:75], v[28:31], a[188:191]
v_mfma_f32_16x16x32_bf16 a[188:191], v[76:79], v[204:207], a[188:191]
s_waitcnt lgkmcnt(4)
v_mfma_f32_16x16x32_bf16 a[192:195], v[48:51], v[16:19], a[192:195]
v_mfma_f32_16x16x32_bf16 a[192:195], v[52:55], v[192:195], a[192:195]
v_mfma_f32_16x16x32_bf16 a[196:199], v[48:51], v[20:23], a[196:199]
ds_read_b128 v[72:75], v8 offset:14336
v_mfma_f32_16x16x32_bf16 a[196:199], v[52:55], v[196:199], a[196:199]
v_mfma_f32_16x16x32_bf16 a[200:203], v[48:51], v[24:27], a[200:203]
v_mfma_f32_16x16x32_bf16 a[200:203], v[52:55], v[200:203], a[200:203]
ds_read_b128 v[76:79], v8 offset:15360
v_mfma_f32_16x16x32_bf16 a[204:207], v[48:51], v[28:31], a[204:207]
v_mfma_f32_16x16x32_bf16 a[204:207], v[52:55], v[204:207], a[204:207]
s_waitcnt lgkmcnt(4)
v_mfma_f32_16x16x32_bf16 a[208:211], v[56:59], v[16:19], a[208:211]
s_waitcnt vmcnt(61)
v_mfma_f32_16x16x32_bf16 a[208:211], v[60:63], v[192:195], a[208:211]
s_barrier
v_mfma_f32_16x16x32_bf16 a[212:215], v[56:59], v[20:23], a[212:215]
ds_read_b128 v[48:51], v2 offset:0
v_mfma_f32_16x16x32_bf16 a[212:215], v[60:63], v[196:199], a[212:215]
v_mfma_f32_16x16x32_bf16 a[216:219], v[56:59], v[24:27], a[216:219]
v_mfma_f32_16x16x32_bf16 a[216:219], v[60:63], v[200:203], a[216:219]
ds_read_b128 v[52:55], v2 offset:1024
v_mfma_f32_16x16x32_bf16 a[220:223], v[56:59], v[28:31], a[220:223]
v_mfma_f32_16x16x32_bf16 a[220:223], v[60:63], v[204:207], a[220:223]
s_waitcnt lgkmcnt(4)
v_mfma_f32_16x16x32_bf16 a[224:227], v[64:67], v[16:19], a[224:227]
v_mfma_f32_16x16x32_bf16 a[224:227], v[68:71], v[192:195], a[224:227]
v_mfma_f32_16x16x32_bf16 a[228:231], v[64:67], v[20:23], a[228:231]
ds_read_b128 v[56:59], v2 offset:2048
v_mfma_f32_16x16x32_bf16 a[228:231], v[68:71], v[196:199], a[228:231]
v_mfma_f32_16x16x32_bf16 a[232:235], v[64:67], v[24:27], a[232:235]
v_mfma_f32_16x16x32_bf16 a[232:235], v[68:71], v[200:203], a[232:235]
ds_read_b128 v[60:63], v2 offset:3072
v_mfma_f32_16x16x32_bf16 a[236:239], v[64:67], v[28:31], a[236:239]
v_mfma_f32_16x16x32_bf16 a[236:239], v[68:71], v[204:207], a[236:239]
s_waitcnt vmcnt(35)
s_waitcnt lgkmcnt(4)
v_mfma_f32_16x16x32_bf16 a[112:115], v[72:75], v[32:35], a[112:115]
v_mfma_f32_16x16x32_bf16 a[112:115], v[76:79], v[80:83], a[112:115]
v_mfma_f32_16x16x32_bf16 a[116:119], v[72:75], v[36:39], a[116:119]
ds_read_b128 v[64:67], v2 offset:4096
v_mfma_f32_16x16x32_bf16 a[116:119], v[76:79], v[84:87], a[116:119]
v_mfma_f32_16x16x32_bf16 a[120:123], v[72:75], v[40:43], a[120:123]
v_mfma_f32_16x16x32_bf16 a[120:123], v[76:79], v[88:91], a[120:123]
ds_read_b128 v[68:71], v2 offset:5120
v_mfma_f32_16x16x32_bf16 a[124:127], v[72:75], v[44:47], a[124:127]
v_mfma_f32_16x16x32_bf16 a[124:127], v[76:79], v[92:95], a[124:127]
s_waitcnt lgkmcnt(4)
v_mfma_f32_16x16x32_bf16 a[128:131], v[48:51], v[32:35], a[128:131]
v_mfma_f32_16x16x32_bf16 a[128:131], v[52:55], v[80:83], a[128:131]
v_mfma_f32_16x16x32_bf16 a[132:135], v[48:51], v[36:39], a[132:135]
ds_read_b128 v[72:75], v2 offset:6144
v_mfma_f32_16x16x32_bf16 a[132:135], v[52:55], v[84:87], a[132:135]
v_mfma_f32_16x16x32_bf16 a[136:139], v[48:51], v[40:43], a[136:139]
v_mfma_f32_16x16x32_bf16 a[136:139], v[52:55], v[88:91], a[136:139]
ds_read_b128 v[76:79], v2 offset:7168
v_mfma_f32_16x16x32_bf16 a[140:143], v[48:51], v[44:47], a[140:143]
v_mfma_f32_16x16x32_bf16 a[140:143], v[52:55], v[92:95], a[140:143]
s_waitcnt lgkmcnt(4)
v_mfma_f32_16x16x32_bf16 a[144:147], v[56:59], v[32:35], a[144:147]
v_mfma_f32_16x16x32_bf16 a[144:147], v[60:63], v[80:83], a[144:147]
v_mfma_f32_16x16x32_bf16 a[148:151], v[56:59], v[36:39], a[148:151]
ds_read_b128 v[48:51], v2 offset:8192
v_mfma_f32_16x16x32_bf16 a[148:151], v[60:63], v[84:87], a[148:151]
v_mfma_f32_16x16x32_bf16 a[152:155], v[56:59], v[40:43], a[152:155]
v_mfma_f32_16x16x32_bf16 a[152:155], v[60:63], v[88:91], a[152:155]
ds_read_b128 v[52:55], v2 offset:9216
v_mfma_f32_16x16x32_bf16 a[156:159], v[56:59], v[44:47], a[156:159]
v_mfma_f32_16x16x32_bf16 a[156:159], v[60:63], v[92:95], a[156:159]
s_waitcnt lgkmcnt(4)
v_mfma_f32_16x16x32_bf16 a[160:163], v[64:67], v[32:35], a[160:163]
v_mfma_f32_16x16x32_bf16 a[160:163], v[68:71], v[80:83], a[160:163]
v_mfma_f32_16x16x32_bf16 a[164:167], v[64:67], v[36:39], a[164:167]
ds_read_b128 v[56:59], v2 offset:10240
v_mfma_f32_16x16x32_bf16 a[164:167], v[68:71], v[84:87], a[164:167]
v_mfma_f32_16x16x32_bf16 a[168:171], v[64:67], v[40:43], a[168:171]
v_mfma_f32_16x16x32_bf16 a[168:171], v[68:71], v[88:91], a[168:171]
ds_read_b128 v[60:63], v2 offset:11264
v_mfma_f32_16x16x32_bf16 a[172:175], v[64:67], v[44:47], a[172:175]
v_mfma_f32_16x16x32_bf16 a[172:175], v[68:71], v[92:95], a[172:175]
s_waitcnt lgkmcnt(4)
v_mfma_f32_16x16x32_bf16 a[176:179], v[72:75], v[32:35], a[176:179]
v_mfma_f32_16x16x32_bf16 a[176:179], v[76:79], v[80:83], a[176:179]
v_mfma_f32_16x16x32_bf16 a[180:183], v[72:75], v[36:39], a[180:183]
ds_read_b128 v[64:67], v2 offset:12288
v_mfma_f32_16x16x32_bf16 a[180:183], v[76:79], v[84:87], a[180:183]
v_mfma_f32_16x16x32_bf16 a[184:187], v[72:75], v[40:43], a[184:187]
v_mfma_f32_16x16x32_bf16 a[184:187], v[76:79], v[88:91], a[184:187]
ds_read_b128 v[68:71], v2 offset:13312
v_mfma_f32_16x16x32_bf16 a[188:191], v[72:75], v[44:47], a[188:191]
v_mfma_f32_16x16x32_bf16 a[188:191], v[76:79], v[92:95], a[188:191]
s_waitcnt lgkmcnt(4)
v_mfma_f32_16x16x32_bf16 a[192:195], v[48:51], v[32:35], a[192:195]
v_mfma_f32_16x16x32_bf16 a[192:195], v[52:55], v[80:83], a[192:195]
v_mfma_f32_16x16x32_bf16 a[196:199], v[48:51], v[36:39], a[196:199]
ds_read_b128 v[72:75], v2 offset:14336
v_mfma_f32_16x16x32_bf16 a[196:199], v[52:55], v[84:87], a[196:199]
v_mfma_f32_16x16x32_bf16 a[200:203], v[48:51], v[40:43], a[200:203]
v_mfma_f32_16x16x32_bf16 a[200:203], v[52:55], v[88:91], a[200:203]
ds_read_b128 v[76:79], v2 offset:15360
v_mfma_f32_16x16x32_bf16 a[204:207], v[48:51], v[44:47], a[204:207]
v_mfma_f32_16x16x32_bf16 a[204:207], v[52:55], v[92:95], a[204:207]
s_waitcnt lgkmcnt(4)
v_mfma_f32_16x16x32_bf16 a[208:211], v[56:59], v[32:35], a[208:211]
v_mfma_f32_16x16x32_bf16 a[208:211], v[60:63], v[80:83], a[208:211]
v_mfma_f32_16x16x32_bf16 a[212:215], v[56:59], v[36:39], a[212:215]
ds_read_b128 v[48:51], v2 offset:16384
v_mfma_f32_16x16x32_bf16 a[212:215], v[60:63], v[84:87], a[212:215]
v_mfma_f32_16x16x32_bf16 a[216:219], v[56:59], v[40:43], a[216:219]
v_mfma_f32_16x16x32_bf16 a[216:219], v[60:63], v[88:91], a[216:219]
ds_read_b128 v[52:55], v2 offset:17408
v_mfma_f32_16x16x32_bf16 a[220:223], v[56:59], v[44:47], a[220:223]
v_mfma_f32_16x16x32_bf16 a[220:223], v[60:63], v[92:95], a[220:223]
s_waitcnt lgkmcnt(4)
v_mfma_f32_16x16x32_bf16 a[224:227], v[64:67], v[32:35], a[224:227]
v_mfma_f32_16x16x32_bf16 a[224:227], v[68:71], v[80:83], a[224:227]
v_mfma_f32_16x16x32_bf16 a[228:231], v[64:67], v[36:39], a[228:231]
ds_read_b128 v[56:59], v2 offset:18432
v_mfma_f32_16x16x32_bf16 a[228:231], v[68:71], v[84:87], a[228:231]
v_mfma_f32_16x16x32_bf16 a[232:235], v[64:67], v[40:43], a[232:235]
v_mfma_f32_16x16x32_bf16 a[232:235], v[68:71], v[88:91], a[232:235]
ds_read_b128 v[60:63], v2 offset:19456
v_mfma_f32_16x16x32_bf16 a[236:239], v[64:67], v[44:47], a[236:239]
v_mfma_f32_16x16x32_bf16 a[236:239], v[68:71], v[92:95], a[236:239]
s_waitcnt vmcnt(8)
s_waitcnt lgkmcnt(4)
v_mfma_f32_16x16x32_bf16 a[112:115], v[72:75], v[96:99], a[112:115]
v_mfma_f32_16x16x32_bf16 a[112:115], v[76:79], v[112:115], a[112:115]
v_mfma_f32_16x16x32_bf16 a[116:119], v[72:75], v[100:103], a[116:119]
ds_read_b128 v[64:67], v2 offset:20480
v_mfma_f32_16x16x32_bf16 a[116:119], v[76:79], v[116:119], a[116:119]
v_mfma_f32_16x16x32_bf16 a[120:123], v[72:75], v[104:107], a[120:123]
v_mfma_f32_16x16x32_bf16 a[120:123], v[76:79], v[120:123], a[120:123]
ds_read_b128 v[68:71], v2 offset:21504
v_mfma_f32_16x16x32_bf16 a[124:127], v[72:75], v[108:111], a[124:127]
v_mfma_f32_16x16x32_bf16 a[124:127], v[76:79], v[124:127], a[124:127]
s_waitcnt vmcnt(0)
s_waitcnt lgkmcnt(4)
v_mfma_f32_16x16x32_bf16 a[112:115], v[48:51], v[128:131], a[112:115]
v_mfma_f32_16x16x32_bf16 a[112:115], v[52:55], v[144:147], a[112:115]
v_mfma_f32_16x16x32_bf16 a[116:119], v[48:51], v[132:135], a[116:119]
ds_read_b128 v[72:75], v2 offset:22528
v_mfma_f32_16x16x32_bf16 a[116:119], v[52:55], v[148:151], a[116:119]
v_mfma_f32_16x16x32_bf16 a[120:123], v[48:51], v[136:139], a[120:123]
v_mfma_f32_16x16x32_bf16 a[120:123], v[52:55], v[152:155], a[120:123]
ds_read_b128 v[76:79], v2 offset:23552
v_mfma_f32_16x16x32_bf16 a[124:127], v[48:51], v[140:143], a[124:127]
v_mfma_f32_16x16x32_bf16 a[124:127], v[52:55], v[156:159], a[124:127]
s_waitcnt lgkmcnt(4)
v_mfma_f32_16x16x32_bf16 a[128:131], v[56:59], v[96:99], a[128:131]
s_waitcnt vmcnt(43)
v_mfma_f32_16x16x32_bf16 a[128:131], v[60:63], v[112:115], a[128:131]
s_barrier
v_mfma_f32_16x16x32_bf16 a[132:135], v[56:59], v[100:103], a[132:135]
ds_read_b128 v[48:51], v2 offset:24576
v_mfma_f32_16x16x32_bf16 a[132:135], v[60:63], v[116:119], a[132:135]
v_mfma_f32_16x16x32_bf16 a[136:139], v[56:59], v[104:107], a[136:139]
v_mfma_f32_16x16x32_bf16 a[136:139], v[60:63], v[120:123], a[136:139]
ds_read_b128 v[52:55], v2 offset:25600
v_mfma_f32_16x16x32_bf16 a[140:143], v[56:59], v[108:111], a[140:143]
v_mfma_f32_16x16x32_bf16 a[140:143], v[60:63], v[124:127], a[140:143]
s_waitcnt lgkmcnt(4)
v_mfma_f32_16x16x32_bf16 a[128:131], v[64:67], v[128:131], a[128:131]
v_mfma_f32_16x16x32_bf16 a[128:131], v[68:71], v[144:147], a[128:131]
v_mfma_f32_16x16x32_bf16 a[132:135], v[64:67], v[132:135], a[132:135]
ds_read_b128 v[56:59], v2 offset:26624
v_mfma_f32_16x16x32_bf16 a[132:135], v[68:71], v[148:151], a[132:135]
v_mfma_f32_16x16x32_bf16 a[136:139], v[64:67], v[136:139], a[136:139]
v_mfma_f32_16x16x32_bf16 a[136:139], v[68:71], v[152:155], a[136:139]
ds_read_b128 v[60:63], v2 offset:27648
v_mfma_f32_16x16x32_bf16 a[140:143], v[64:67], v[140:143], a[140:143]
v_mfma_f32_16x16x32_bf16 a[140:143], v[68:71], v[156:159], a[140:143]
s_waitcnt lgkmcnt(4)
v_mfma_f32_16x16x32_bf16 a[144:147], v[72:75], v[96:99], a[144:147]
v_mfma_f32_16x16x32_bf16 a[144:147], v[76:79], v[112:115], a[144:147]
v_mfma_f32_16x16x32_bf16 a[148:151], v[72:75], v[100:103], a[148:151]
ds_read_b128 v[64:67], v2 offset:28672
v_mfma_f32_16x16x32_bf16 a[148:151], v[76:79], v[116:119], a[148:151]
v_mfma_f32_16x16x32_bf16 a[152:155], v[72:75], v[104:107], a[152:155]
v_mfma_f32_16x16x32_bf16 a[152:155], v[76:79], v[120:123], a[152:155]
ds_read_b128 v[68:71], v2 offset:29696
v_mfma_f32_16x16x32_bf16 a[156:159], v[72:75], v[108:111], a[156:159]
v_mfma_f32_16x16x32_bf16 a[156:159], v[76:79], v[124:127], a[156:159]
s_waitcnt lgkmcnt(4)
v_mfma_f32_16x16x32_bf16 a[144:147], v[48:51], v[128:131], a[144:147]
v_mfma_f32_16x16x32_bf16 a[144:147], v[52:55], v[144:147], a[144:147]
v_mfma_f32_16x16x32_bf16 a[148:151], v[48:51], v[132:135], a[148:151]
ds_read_b128 v[72:75], v2 offset:30720
v_mfma_f32_16x16x32_bf16 a[148:151], v[52:55], v[148:151], a[148:151]
v_mfma_f32_16x16x32_bf16 a[152:155], v[48:51], v[136:139], a[152:155]
v_mfma_f32_16x16x32_bf16 a[152:155], v[52:55], v[152:155], a[152:155]
ds_read_b128 v[76:79], v2 offset:31744
v_mfma_f32_16x16x32_bf16 a[156:159], v[48:51], v[140:143], a[156:159]
v_mfma_f32_16x16x32_bf16 a[156:159], v[52:55], v[156:159], a[156:159]
s_waitcnt lgkmcnt(4)
v_mfma_f32_16x16x32_bf16 a[160:163], v[56:59], v[96:99], a[160:163]
v_mfma_f32_16x16x32_bf16 a[160:163], v[60:63], v[112:115], a[160:163]
v_mfma_f32_16x16x32_bf16 a[164:167], v[56:59], v[100:103], a[164:167]
ds_read_b128 v[48:51], v2 offset:32768
v_mfma_f32_16x16x32_bf16 a[164:167], v[60:63], v[116:119], a[164:167]
v_mfma_f32_16x16x32_bf16 a[168:171], v[56:59], v[104:107], a[168:171]
v_mfma_f32_16x16x32_bf16 a[168:171], v[60:63], v[120:123], a[168:171]
ds_read_b128 v[52:55], v2 offset:33792
v_mfma_f32_16x16x32_bf16 a[172:175], v[56:59], v[108:111], a[172:175]
v_mfma_f32_16x16x32_bf16 a[172:175], v[60:63], v[124:127], a[172:175]
s_waitcnt lgkmcnt(4)
v_mfma_f32_16x16x32_bf16 a[160:163], v[64:67], v[128:131], a[160:163]
v_mfma_f32_16x16x32_bf16 a[160:163], v[68:71], v[144:147], a[160:163]
v_mfma_f32_16x16x32_bf16 a[164:167], v[64:67], v[132:135], a[164:167]
ds_read_b128 v[56:59], v2 offset:34816
v_mfma_f32_16x16x32_bf16 a[164:167], v[68:71], v[148:151], a[164:167]
v_mfma_f32_16x16x32_bf16 a[168:171], v[64:67], v[136:139], a[168:171]
v_mfma_f32_16x16x32_bf16 a[168:171], v[68:71], v[152:155], a[168:171]
ds_read_b128 v[60:63], v2 offset:35840
v_mfma_f32_16x16x32_bf16 a[172:175], v[64:67], v[140:143], a[172:175]
v_mfma_f32_16x16x32_bf16 a[172:175], v[68:71], v[156:159], a[172:175]
s_waitcnt lgkmcnt(4)
v_mfma_f32_16x16x32_bf16 a[176:179], v[72:75], v[96:99], a[176:179]
v_mfma_f32_16x16x32_bf16 a[176:179], v[76:79], v[112:115], a[176:179]
v_mfma_f32_16x16x32_bf16 a[180:183], v[72:75], v[100:103], a[180:183]
ds_read_b128 v[64:67], v2 offset:36864
v_mfma_f32_16x16x32_bf16 a[180:183], v[76:79], v[116:119], a[180:183]
v_accvgpr_read_b32 v208, a112
v_accvgpr_read_b32 v209, a128
v_mfma_f32_16x16x32_bf16 a[184:187], v[72:75], v[104:107], a[184:187]
v_accvgpr_read_b32 v210, a144
v_accvgpr_read_b32 v211, a160
v_mfma_f32_16x16x32_bf16 a[184:187], v[76:79], v[120:123], a[184:187]
ds_read_b128 v[68:71], v2 offset:37888
v_accvgpr_read_b32 v212, a113
v_mfma_f32_16x16x32_bf16 a[188:191], v[72:75], v[108:111], a[188:191]
v_accvgpr_read_b32 v213, a129
v_accvgpr_read_b32 v214, a145
v_mfma_f32_16x16x32_bf16 a[188:191], v[76:79], v[124:127], a[188:191]
v_accvgpr_read_b32 v215, a161
s_waitcnt lgkmcnt(4)
v_mfma_f32_16x16x32_bf16 a[176:179], v[48:51], v[128:131], a[176:179]
v_cvt_pk_bf16_f32 v224, v208, v209
v_cvt_pk_bf16_f32 v225, v210, v211
v_mfma_f32_16x16x32_bf16 a[176:179], v[52:55], v[144:147], a[176:179]
v_cvt_pk_bf16_f32 v226, v212, v213
v_cvt_pk_bf16_f32 v227, v214, v215
v_mfma_f32_16x16x32_bf16 a[180:183], v[48:51], v[132:135], a[180:183]
ds_read_b128 v[72:75], v2 offset:38912
buffer_store_dwordx4 v[224:227], v252, s[8:11], s36 offen offset:0 sc1
v_mfma_f32_16x16x32_bf16 a[180:183], v[52:55], v[148:151], a[180:183]
v_accvgpr_read_b32 v216, a114
v_accvgpr_read_b32 v217, a130
v_mfma_f32_16x16x32_bf16 a[184:187], v[48:51], v[136:139], a[184:187]
v_accvgpr_read_b32 v218, a146
v_accvgpr_read_b32 v219, a162
v_mfma_f32_16x16x32_bf16 a[184:187], v[52:55], v[152:155], a[184:187]
ds_read_b128 v[76:79], v2 offset:39936
v_accvgpr_read_b32 v220, a115
v_mfma_f32_16x16x32_bf16 a[188:191], v[48:51], v[140:143], a[188:191]
v_accvgpr_read_b32 v221, a131
v_accvgpr_read_b32 v222, a147
v_mfma_f32_16x16x32_bf16 a[188:191], v[52:55], v[156:159], a[188:191]
v_accvgpr_read_b32 v223, a163
s_waitcnt lgkmcnt(4)
v_mfma_f32_16x16x32_bf16 a[192:195], v[56:59], v[96:99], a[192:195]
v_cvt_pk_bf16_f32 v228, v216, v217
v_cvt_pk_bf16_f32 v229, v218, v219
v_mfma_f32_16x16x32_bf16 a[192:195], v[60:63], v[112:115], a[192:195]
v_cvt_pk_bf16_f32 v230, v220, v221
v_cvt_pk_bf16_f32 v231, v222, v223
v_mfma_f32_16x16x32_bf16 a[196:199], v[56:59], v[100:103], a[196:199]
ds_read_b128 v[48:51], v2 offset:40960
buffer_store_dwordx4 v[228:231], v252, s[8:11], s36 offen offset:256 sc1
v_mfma_f32_16x16x32_bf16 a[196:199], v[60:63], v[116:119], a[196:199]
v_accvgpr_read_b32 v208, a116
v_accvgpr_read_b32 v209, a132
v_mfma_f32_16x16x32_bf16 a[200:203], v[56:59], v[104:107], a[200:203]
v_accvgpr_read_b32 v210, a148
v_accvgpr_read_b32 v211, a164
v_mfma_f32_16x16x32_bf16 a[200:203], v[60:63], v[120:123], a[200:203]
ds_read_b128 v[52:55], v2 offset:41984
v_accvgpr_read_b32 v212, a117
v_mfma_f32_16x16x32_bf16 a[204:207], v[56:59], v[108:111], a[204:207]
v_accvgpr_read_b32 v213, a133
v_accvgpr_read_b32 v214, a149
v_mfma_f32_16x16x32_bf16 a[204:207], v[60:63], v[124:127], a[204:207]
v_accvgpr_read_b32 v215, a165
s_waitcnt lgkmcnt(4)
v_mfma_f32_16x16x32_bf16 a[192:195], v[64:67], v[128:131], a[192:195]
v_cvt_pk_bf16_f32 v224, v208, v209
v_cvt_pk_bf16_f32 v225, v210, v211
v_mfma_f32_16x16x32_bf16 a[192:195], v[68:71], v[144:147], a[192:195]
v_cvt_pk_bf16_f32 v226, v212, v213
v_cvt_pk_bf16_f32 v227, v214, v215
v_mfma_f32_16x16x32_bf16 a[196:199], v[64:67], v[132:135], a[196:199]
ds_read_b128 v[56:59], v2 offset:43008
buffer_store_dwordx4 v[224:227], v252, s[8:11], s37 offen offset:0 sc1
v_mfma_f32_16x16x32_bf16 a[196:199], v[68:71], v[148:151], a[196:199]
v_accvgpr_read_b32 v216, a118
v_accvgpr_read_b32 v217, a134
v_mfma_f32_16x16x32_bf16 a[200:203], v[64:67], v[136:139], a[200:203]
v_accvgpr_read_b32 v218, a150
v_accvgpr_read_b32 v219, a166
v_mfma_f32_16x16x32_bf16 a[200:203], v[68:71], v[152:155], a[200:203]
ds_read_b128 v[60:63], v2 offset:44032
v_accvgpr_read_b32 v220, a119
v_mfma_f32_16x16x32_bf16 a[204:207], v[64:67], v[140:143], a[204:207]
v_accvgpr_read_b32 v221, a135
v_accvgpr_read_b32 v222, a151
v_mfma_f32_16x16x32_bf16 a[204:207], v[68:71], v[156:159], a[204:207]
v_accvgpr_read_b32 v223, a167
s_waitcnt lgkmcnt(4)
v_mfma_f32_16x16x32_bf16 a[208:211], v[72:75], v[96:99], a[208:211]
v_cvt_pk_bf16_f32 v228, v216, v217
v_cvt_pk_bf16_f32 v229, v218, v219
v_mfma_f32_16x16x32_bf16 a[208:211], v[76:79], v[112:115], a[208:211]
v_cvt_pk_bf16_f32 v230, v220, v221
v_cvt_pk_bf16_f32 v231, v222, v223
v_mfma_f32_16x16x32_bf16 a[212:215], v[72:75], v[100:103], a[212:215]
ds_read_b128 v[64:67], v2 offset:45056
buffer_store_dwordx4 v[228:231], v252, s[8:11], s37 offen offset:256 sc1
v_mfma_f32_16x16x32_bf16 a[212:215], v[76:79], v[116:119], a[212:215]
v_accvgpr_read_b32 v208, a120
v_accvgpr_read_b32 v209, a136
v_mfma_f32_16x16x32_bf16 a[216:219], v[72:75], v[104:107], a[216:219]
v_accvgpr_read_b32 v210, a152
v_accvgpr_read_b32 v211, a168
v_mfma_f32_16x16x32_bf16 a[216:219], v[76:79], v[120:123], a[216:219]
ds_read_b128 v[68:71], v2 offset:46080
v_accvgpr_read_b32 v212, a121
v_mfma_f32_16x16x32_bf16 a[220:223], v[72:75], v[108:111], a[220:223]
v_accvgpr_read_b32 v213, a137
v_accvgpr_read_b32 v214, a153
v_mfma_f32_16x16x32_bf16 a[220:223], v[76:79], v[124:127], a[220:223]
v_accvgpr_read_b32 v215, a169
s_waitcnt lgkmcnt(4)
v_mfma_f32_16x16x32_bf16 a[208:211], v[48:51], v[128:131], a[208:211]
v_cvt_pk_bf16_f32 v224, v208, v209
v_cvt_pk_bf16_f32 v225, v210, v211
v_mfma_f32_16x16x32_bf16 a[208:211], v[52:55], v[144:147], a[208:211]
v_cvt_pk_bf16_f32 v226, v212, v213
v_cvt_pk_bf16_f32 v227, v214, v215
v_mfma_f32_16x16x32_bf16 a[212:215], v[48:51], v[132:135], a[212:215]
ds_read_b128 v[72:75], v2 offset:47104
buffer_store_dwordx4 v[224:227], v252, s[8:11], s38 offen offset:0 sc1
v_mfma_f32_16x16x32_bf16 a[212:215], v[52:55], v[148:151], a[212:215]
v_accvgpr_read_b32 v216, a122
v_accvgpr_read_b32 v217, a138
v_mfma_f32_16x16x32_bf16 a[216:219], v[48:51], v[136:139], a[216:219]
v_accvgpr_read_b32 v218, a154
v_accvgpr_read_b32 v219, a170
v_mfma_f32_16x16x32_bf16 a[216:219], v[52:55], v[152:155], a[216:219]
ds_read_b128 v[76:79], v2 offset:48128
v_accvgpr_read_b32 v220, a123
v_mfma_f32_16x16x32_bf16 a[220:223], v[48:51], v[140:143], a[220:223]
v_accvgpr_read_b32 v221, a139
v_accvgpr_read_b32 v222, a155
v_mfma_f32_16x16x32_bf16 a[220:223], v[52:55], v[156:159], a[220:223]
v_accvgpr_read_b32 v223, a171
s_waitcnt lgkmcnt(4)
v_mfma_f32_16x16x32_bf16 a[224:227], v[56:59], v[96:99], a[224:227]
s_waitcnt vmcnt(18)
v_cvt_pk_bf16_f32 v228, v216, v217
v_mfma_f32_16x16x32_bf16 a[224:227], v[60:63], v[112:115], a[224:227]
s_barrier
v_mfma_f32_16x16x32_bf16 a[228:231], v[56:59], v[100:103], a[228:231]
ds_read_b128 v[48:51], v2 offset:49152
v_cvt_pk_bf16_f32 v229, v218, v219
v_mfma_f32_16x16x32_bf16 a[228:231], v[60:63], v[116:119], a[228:231]
v_cvt_pk_bf16_f32 v230, v220, v221
v_cvt_pk_bf16_f32 v231, v222, v223
v_mfma_f32_16x16x32_bf16 a[232:235], v[56:59], v[104:107], a[232:235]
buffer_store_dwordx4 v[228:231], v252, s[8:11], s38 offen offset:256 sc1
v_mfma_f32_16x16x32_bf16 a[232:235], v[60:63], v[120:123], a[232:235]
ds_read_b128 v[52:55], v2 offset:50176
v_accvgpr_read_b32 v208, a124
v_mfma_f32_16x16x32_bf16 a[236:239], v[56:59], v[108:111], a[236:239]
v_accvgpr_read_b32 v209, a140
v_accvgpr_read_b32 v210, a156
v_mfma_f32_16x16x32_bf16 a[236:239], v[60:63], v[124:127], a[236:239]
v_accvgpr_read_b32 v211, a172
s_waitcnt lgkmcnt(4)
v_mfma_f32_16x16x32_bf16 a[224:227], v[64:67], v[128:131], a[224:227]
v_accvgpr_read_b32 v212, a125
v_accvgpr_read_b32 v213, a141
v_mfma_f32_16x16x32_bf16 a[224:227], v[68:71], v[144:147], a[224:227]
v_accvgpr_read_b32 v214, a157
v_accvgpr_read_b32 v215, a173
v_mfma_f32_16x16x32_bf16 a[228:231], v[64:67], v[132:135], a[228:231]
ds_read_b128 v[56:59], v2 offset:51200
v_cvt_pk_bf16_f32 v224, v208, v209
v_mfma_f32_16x16x32_bf16 a[228:231], v[68:71], v[148:151], a[228:231]
v_cvt_pk_bf16_f32 v225, v210, v211
v_cvt_pk_bf16_f32 v226, v212, v213
v_mfma_f32_16x16x32_bf16 a[232:235], v[64:67], v[136:139], a[232:235]
v_cvt_pk_bf16_f32 v227, v214, v215
buffer_store_dwordx4 v[224:227], v252, s[8:11], s39 offen offset:0 sc1
v_mfma_f32_16x16x32_bf16 a[232:235], v[68:71], v[152:155], a[232:235]
ds_read_b128 v[60:63], v2 offset:52224
v_accvgpr_read_b32 v216, a126
v_mfma_f32_16x16x32_bf16 a[236:239], v[64:67], v[140:143], a[236:239]
v_accvgpr_read_b32 v217, a142
v_accvgpr_read_b32 v218, a158
v_mfma_f32_16x16x32_bf16 a[236:239], v[68:71], v[156:159], a[236:239]
v_accvgpr_read_b32 v219, a174
v_accvgpr_read_b32 v220, a127
v_accvgpr_read_b32 v221, a143
v_accvgpr_read_b32 v222, a159
v_accvgpr_read_b32 v223, a175
v_cvt_pk_bf16_f32 v228, v216, v217
v_cvt_pk_bf16_f32 v229, v218, v219
v_cvt_pk_bf16_f32 v230, v220, v221
v_cvt_pk_bf16_f32 v231, v222, v223
buffer_store_dwordx4 v[228:231], v252, s[8:11], s39 offen offset:256 sc1
s_waitcnt lgkmcnt(4)
v_mfma_f32_16x16x32_bf16 a[240:243], v[72:75], v[16:19], a[240:243]
v_mfma_f32_16x16x32_bf16 a[240:243], v[76:79], v[192:195], a[240:243]
v_mfma_f32_16x16x32_bf16 a[244:247], v[72:75], v[20:23], a[244:247]
ds_read_b128 v[64:67], v2 offset:53248
v_mfma_f32_16x16x32_bf16 a[244:247], v[76:79], v[196:199], a[244:247]
v_accvgpr_read_b32 v208, a176
v_accvgpr_read_b32 v209, a192
v_mfma_f32_16x16x32_bf16 a[248:251], v[72:75], v[24:27], a[248:251]
v_accvgpr_read_b32 v210, a208
v_accvgpr_read_b32 v211, a224
v_mfma_f32_16x16x32_bf16 a[248:251], v[76:79], v[200:203], a[248:251]
ds_read_b128 v[68:71], v2 offset:54272
v_accvgpr_read_b32 v212, a177
v_mfma_f32_16x16x32_bf16 a[252:255], v[72:75], v[28:31], a[252:255]
v_accvgpr_read_b32 v213, a193
v_accvgpr_read_b32 v214, a209
v_mfma_f32_16x16x32_bf16 a[252:255], v[76:79], v[204:207], a[252:255]
v_accvgpr_read_b32 v215, a225
s_waitcnt lgkmcnt(4)
v_mfma_f32_16x16x32_bf16 a[240:243], v[48:51], v[32:35], a[240:243]
v_cvt_pk_bf16_f32 v224, v208, v209
v_cvt_pk_bf16_f32 v225, v210, v211
v_mfma_f32_16x16x32_bf16 a[240:243], v[52:55], v[80:83], a[240:243]
v_cvt_pk_bf16_f32 v226, v212, v213
v_cvt_pk_bf16_f32 v227, v214, v215
v_mfma_f32_16x16x32_bf16 a[244:247], v[48:51], v[36:39], a[244:247]
buffer_store_dwordx4 v[224:227], v252, s[8:11], s36 offen offset:2048 sc1
v_mfma_f32_16x16x32_bf16 a[244:247], v[52:55], v[84:87], a[244:247]
v_accvgpr_read_b32 v216, a178
v_accvgpr_read_b32 v217, a194
v_mfma_f32_16x16x32_bf16 a[248:251], v[48:51], v[40:43], a[248:251]
v_accvgpr_read_b32 v218, a210
v_accvgpr_read_b32 v219, a226
v_mfma_f32_16x16x32_bf16 a[248:251], v[52:55], v[88:91], a[248:251]
v_accvgpr_read_b32 v220, a179
v_accvgpr_read_b32 v221, a195
v_mfma_f32_16x16x32_bf16 a[252:255], v[48:51], v[44:47], a[252:255]
v_accvgpr_read_b32 v222, a211
v_accvgpr_read_b32 v223, a227
v_mfma_f32_16x16x32_bf16 a[252:255], v[52:55], v[92:95], a[252:255]
v_cvt_pk_bf16_f32 v228, v216, v217
s_waitcnt lgkmcnt(2)
v_mfma_f32_16x16x32_bf16 a[240:243], v[56:59], v[96:99], a[240:243]
v_cvt_pk_bf16_f32 v229, v218, v219
v_cvt_pk_bf16_f32 v230, v220, v221
v_mfma_f32_16x16x32_bf16 a[240:243], v[60:63], v[112:115], a[240:243]
v_cvt_pk_bf16_f32 v231, v222, v223
buffer_store_dwordx4 v[228:231], v252, s[8:11], s36 offen offset:2304 sc1
v_mfma_f32_16x16x32_bf16 a[244:247], v[56:59], v[100:103], a[244:247]
v_accvgpr_read_b32 v208, a180
v_accvgpr_read_b32 v209, a196
v_mfma_f32_16x16x32_bf16 a[244:247], v[60:63], v[116:119], a[244:247]
v_accvgpr_read_b32 v210, a212
v_accvgpr_read_b32 v211, a228
v_mfma_f32_16x16x32_bf16 a[248:251], v[56:59], v[104:107], a[248:251]
v_accvgpr_read_b32 v212, a181
v_accvgpr_read_b32 v213, a197
v_mfma_f32_16x16x32_bf16 a[248:251], v[60:63], v[120:123], a[248:251]
v_accvgpr_read_b32 v214, a213
v_accvgpr_read_b32 v215, a229
v_mfma_f32_16x16x32_bf16 a[252:255], v[56:59], v[108:111], a[252:255]
v_cvt_pk_bf16_f32 v224, v208, v209
v_cvt_pk_bf16_f32 v225, v210, v211
v_mfma_f32_16x16x32_bf16 a[252:255], v[60:63], v[124:127], a[252:255]
v_cvt_pk_bf16_f32 v226, v212, v213
s_waitcnt lgkmcnt(0)
v_mfma_f32_16x16x32_bf16 a[240:243], v[64:67], v[128:131], a[240:243]
v_cvt_pk_bf16_f32 v227, v214, v215
buffer_store_dwordx4 v[224:227], v252, s[8:11], s37 offen offset:2048 sc1
v_mfma_f32_16x16x32_bf16 a[240:243], v[68:71], v[144:147], a[240:243]
v_accvgpr_read_b32 v216, a182
v_accvgpr_read_b32 v217, a198
v_mfma_f32_16x16x32_bf16 a[244:247], v[64:67], v[132:135], a[244:247]
v_accvgpr_read_b32 v218, a214
v_accvgpr_read_b32 v219, a230
v_mfma_f32_16x16x32_bf16 a[244:247], v[68:71], v[148:151], a[244:247]
v_accvgpr_read_b32 v220, a183
v_accvgpr_read_b32 v221, a199
v_mfma_f32_16x16x32_bf16 a[248:251], v[64:67], v[136:139], a[248:251]
v_accvgpr_read_b32 v222, a215
v_accvgpr_read_b32 v223, a231
v_mfma_f32_16x16x32_bf16 a[248:251], v[68:71], v[152:155], a[248:251]
v_cvt_pk_bf16_f32 v228, v216, v217
v_cvt_pk_bf16_f32 v229, v218, v219
v_mfma_f32_16x16x32_bf16 a[252:255], v[64:67], v[140:143], a[252:255]
v_cvt_pk_bf16_f32 v230, v220, v221
v_cvt_pk_bf16_f32 v231, v222, v223
v_mfma_f32_16x16x32_bf16 a[252:255], v[68:71], v[156:159], a[252:255]
buffer_store_dwordx4 v[228:231], v252, s[8:11], s37 offen offset:2304 sc1
s_barrier
v_accvgpr_read_b32 v208, a184
v_accvgpr_read_b32 v209, a200
v_accvgpr_read_b32 v210, a216
v_accvgpr_read_b32 v211, a232
v_accvgpr_read_b32 v212, a185
v_accvgpr_read_b32 v213, a201
v_accvgpr_read_b32 v214, a217
v_accvgpr_read_b32 v215, a233
v_cvt_pk_bf16_f32 v224, v208, v209
v_cvt_pk_bf16_f32 v225, v210, v211
v_cvt_pk_bf16_f32 v226, v212, v213
v_cvt_pk_bf16_f32 v227, v214, v215
buffer_store_dwordx4 v[224:227], v252, s[8:11], s38 offen offset:2048 sc1
v_accvgpr_read_b32 v216, a186
v_accvgpr_read_b32 v217, a202
v_accvgpr_read_b32 v218, a218
v_accvgpr_read_b32 v219, a234
v_accvgpr_read_b32 v220, a187
v_accvgpr_read_b32 v221, a203
v_accvgpr_read_b32 v222, a219
v_accvgpr_read_b32 v223, a235
v_cvt_pk_bf16_f32 v228, v216, v217
v_cvt_pk_bf16_f32 v229, v218, v219
v_cvt_pk_bf16_f32 v230, v220, v221
v_cvt_pk_bf16_f32 v231, v222, v223
buffer_store_dwordx4 v[228:231], v252, s[8:11], s38 offen offset:2304 sc1
v_accvgpr_read_b32 v208, a188
v_accvgpr_read_b32 v209, a204
v_accvgpr_read_b32 v210, a220
v_accvgpr_read_b32 v211, a236
v_accvgpr_read_b32 v212, a189
v_accvgpr_read_b32 v213, a205
v_accvgpr_read_b32 v214, a221
v_accvgpr_read_b32 v215, a237
v_cvt_pk_bf16_f32 v224, v208, v209
v_cvt_pk_bf16_f32 v225, v210, v211
v_cvt_pk_bf16_f32 v226, v212, v213
v_cvt_pk_bf16_f32 v227, v214, v215
buffer_store_dwordx4 v[224:227], v252, s[8:11], s39 offen offset:2048 sc1
v_accvgpr_read_b32 v216, a190
v_accvgpr_read_b32 v217, a206
v_accvgpr_read_b32 v218, a222
v_accvgpr_read_b32 v219, a238
v_accvgpr_read_b32 v220, a191
v_accvgpr_read_b32 v221, a207
v_accvgpr_read_b32 v222, a223
v_accvgpr_read_b32 v223, a239
v_cvt_pk_bf16_f32 v228, v216, v217
v_cvt_pk_bf16_f32 v229, v218, v219
v_cvt_pk_bf16_f32 v230, v220, v221
v_cvt_pk_bf16_f32 v231, v222, v223
buffer_store_dwordx4 v[228:231], v252, s[8:11], s39 offen offset:2304 sc1
v_accvgpr_read_b32 v208, a240
v_accvgpr_read_b32 v209, a241
v_accvgpr_read_b32 v210, a242
v_accvgpr_read_b32 v211, a243
v_accvgpr_read_b32 v212, a244
v_accvgpr_read_b32 v213, a245
v_accvgpr_read_b32 v214, a246
v_accvgpr_read_b32 v215, a247
v_cvt_pk_bf16_f32 v224, v208, v209
v_cvt_pk_bf16_f32 v225, v210, v211
v_cvt_pk_bf16_f32 v226, v212, v213
v_cvt_pk_bf16_f32 v227, v214, v215
s_nop 0
v_permlane16_swap_b32 v224, v226
v_permlane16_swap_b32 v225, v227
buffer_store_dwordx4 v[224:227], v9, s[8:11], s32 offen sc1
v_accvgpr_read_b32 v216, a248
v_accvgpr_read_b32 v217, a249
v_accvgpr_read_b32 v218, a250
v_accvgpr_read_b32 v219, a251
v_accvgpr_read_b32 v220, a252
v_accvgpr_read_b32 v221, a253
v_accvgpr_read_b32 v222, a254
v_accvgpr_read_b32 v223, a255
v_cvt_pk_bf16_f32 v228, v216, v217
v_cvt_pk_bf16_f32 v229, v218, v219
v_cvt_pk_bf16_f32 v230, v220, v221
v_cvt_pk_bf16_f32 v231, v222, v223
s_nop 0
v_permlane16_swap_b32 v228, v230
v_permlane16_swap_b32 v229, v231
buffer_store_dwordx4 v[228:231], v9, s[8:11], s33 offen sc1
v_mov_b32 v13, 2146435072
v_cmp_eq_u32 vcc, 0, v1
v_mov_b32 v14, s68
v_mov_b32 v15, s69
v_cndmask_b32 v13, v13, 0, vcc
s_waitcnt vmcnt(0)
buffer_store_dwordx2 v[14:15], v13, s[8:11], s35 offen sc1
s_cmp_eq_u32 s7, 1
s_cbranch_scc1 L_last
s_lshr_b32 s20, s5, 2
s_lshl_b32 s20, s20, 3
s_lshr_b32 s21, s6, 2
s_add_u32 s20, s20, s21
s_and_b32 s21, s5, 3
s_lshl_b32 s21, s21, 2
s_and_b32 s22, s6, 3
s_add_u32 s21, s21, s22
s_mul_i32 s22, s21, 147456
s_add_u32 s22, s22, 4198400
s_mul_i32 s23, s4, 36864
s_add_u32 s22, s22, s23
s_add_u32 m0, s23, 0
s_add_u32 s40, s22, 0
buffer_load_dwordx4 v2, s[8:11], s40 offen offset:0 sc1 lds
buffer_load_dwordx4 v2, s[8:11], s40 offen offset:1024 sc1 lds
buffer_load_dwordx4 v2, s[8:11], s40 offen offset:2048 sc1 lds
buffer_load_dwordx4 v2, s[8:11], s40 offen offset:3072 sc1 lds
s_add_u32 m0, s23, 4096
s_add_u32 s40, s22, 4096
buffer_load_dwordx4 v2, s[8:11], s40 offen offset:0 sc1 lds
buffer_load_dwordx4 v2, s[8:11], s40 offen offset:1024 sc1 lds
buffer_load_dwordx4 v2, s[8:11], s40 offen offset:2048 sc1 lds
buffer_load_dwordx4 v2, s[8:11], s40 offen offset:3072 sc1 lds
s_add_u32 m0, s23, 8192
s_add_u32 s40, s22, 8192
buffer_load_dwordx4 v2, s[8:11], s40 offen offset:0 sc1 lds
buffer_load_dwordx4 v2, s[8:11], s40 offen offset:1024 sc1 lds
buffer_load_dwordx4 v2, s[8:11], s40 offen offset:2048 sc1 lds
buffer_load_dwordx4 v2, s[8:11], s40 offen offset:3072 sc1 lds
s_add_u32 m0, s23, 12288
s_add_u32 s40, s22, 12288
buffer_load_dwordx4 v2, s[8:11], s40 offen offset:0 sc1 lds
buffer_load_dwordx4 v2, s[8:11], s40 offen offset:1024 sc1 lds
buffer_load_dwordx4 v2, s[8:11], s40 offen offset:2048 sc1 lds
buffer_load_dwordx4 v2, s[8:11], s40 offen offset:3072 sc1 lds
s_add_u32 m0, s23, 16384
s_add_u32 s40, s22, 16384
buffer_load_dwordx4 v2, s[8:11], s40 offen offset:0 sc1 lds
buffer_load_dwordx4 v2, s[8:11], s40 offen offset:1024 sc1 lds
buffer_load_dwordx4 v2, s[8:11], s40 offen offset:2048 sc1 lds
buffer_load_dwordx4 v2, s[8:11], s40 offen offset:3072 sc1 lds
s_add_u32 m0, s23, 20480
s_add_u32 s40, s22, 20480
buffer_load_dwordx4 v2, s[8:11], s40 offen offset:0 sc1 lds
buffer_load_dwordx4 v2, s[8:11], s40 offen offset:1024 sc1 lds
buffer_load_dwordx4 v2, s[8:11], s40 offen offset:2048 sc1 lds
buffer_load_dwordx4 v2, s[8:11], s40 offen offset:3072 sc1 lds
s_add_u32 m0, s23, 24576
s_add_u32 s40, s22, 24576
buffer_load_dwordx4 v2, s[8:11], s40 offen offset:0 sc1 lds
buffer_load_dwordx4 v2, s[8:11], s40 offen offset:1024 sc1 lds
buffer_load_dwordx4 v2, s[8:11], s40 offen offset:2048 sc1 lds
buffer_load_dwordx4 v2, s[8:11], s40 offen offset:3072 sc1 lds
s_add_u32 m0, s23, 28672
s_add_u32 s40, s22, 28672
buffer_load_dwordx4 v2, s[8:11], s40 offen offset:0 sc1 lds
buffer_load_dwordx4 v2, s[8:11], s40 offen offset:1024 sc1 lds
buffer_load_dwordx4 v2, s[8:11], s40 offen offset:2048 sc1 lds
buffer_load_dwordx4 v2, s[8:11], s40 offen offset:3072 sc1 lds
s_add_u32 m0, s23, 32768
s_add_u32 s40, s22, 32768
buffer_load_dwordx4 v2, s[8:11], s40 offen offset:0 sc1 lds
buffer_load_dwordx4 v2, s[8:11], s40 offen offset:1024 sc1 lds
buffer_load_dwordx4 v2, s[8:11], s40 offen offset:2048 sc1 lds
buffer_load_dwordx4 v2, s[8:11], s40 offen offset:3072 sc1 lds
s_cmp_eq_u32 s4, 3
s_cbranch_scc1 L_r_side
v_and_b32 v6, 7, v1
v_lshrrev_b32 v7, 3, v1
s_mul_i32 s22, s4, 24
v_add_u32 v7, s22, v7
s_and_b32 s23, s6, 1
s_lshl_b32 s23, s23, 3
v_add_u32 v8, s23, v6
v_lshlrev_b32 v8, 4, v8
v_lshl_add_u32 v4, v7, 8, v8
s_lshl_b32 s24, s5, 4
s_lshr_b32 s25, s6, 1
s_add_u32 s24, s24, s25
s_mul_i32 s20, s24, 18432
s_add_u32 s24, s20, 37416960
s_add_u32 s25, s24, 4096
buffer_load_dwordx4 v[16:19], v4, s[8:11], s24 offen offset:0 sc1
buffer_load_dwordx4 v[20:23], v4, s[8:11], s24 offen offset:2048 sc1
buffer_load_dwordx4 v[24:27], v4, s[8:11], s25 offen offset:0 sc1
s_lshl_b32 s24, s5, 2
s_lshr_b32 s25, s6, 3
s_add_u32 s24, s24, s25
s_lshl_b32 s24, s24, 12
s_add_u32 s24, s24, 655360
v_and_b32 v6, 31, v1
v_lshlrev_b32 v6, 7, v6
s_mov_b32 s52, 0
L_poll5:
buffer_load_dwordx2 v[14:15], v6, s[8:11], s24 offen sc1
s_add_u32 s52, s52, 1
s_waitcnt vmcnt(0)
v_cmp_ne_u64 vcc, s[68:69], v[14:15]
s_cmp_ge_u32 s52, 0x100000
s_cbranch_scc1 L_got5
s_and_b64 exec, exec, vcc
s_cbranch_execnz L_poll5
L_got5:
s_mov_b64 exec, -1
s_add_u32 s24, s20, 80146432
s_add_u32 s25, s24, 4096
buffer_load_dwordx4 v[28:31], v4, s[8:11], s24 offen offset:0 sc1
buffer_load_dwordx4 v[32:35], v4, s[8:11], s24 offen offset:2048 sc1
buffer_load_dwordx4 v[36:39], v4, s[8:11], s25 offen offset:0 sc1
s_add_u32 s24, s20, 82505728
s_add_u32 s25, s24, 4096
buffer_load_dwordx4 v[40:43], v4, s[8:11], s24 offen offset:0 sc1
buffer_load_dwordx4 v[44:47], v4, s[8:11], s24 offen offset:2048 sc1
buffer_load_dwordx4 v[48:51], v4, s[8:11], s25 offen offset:0 sc1
s_add_u32 s24, s20, 84865024
s_add_u32 s25, s24, 4096
buffer_load_dwordx4 v[52:55], v4, s[8:11], s24 offen offset:0 sc1
buffer_load_dwordx4 v[56:59], v4, s[8:11], s24 offen offset:2048 sc1
buffer_load_dwordx4 v[60:63], v4, s[8:11], s25 offen offset:0 sc1
s_add_u32 s24, s20, 87224320
s_add_u32 s25, s24, 4096
buffer_load_dwordx4 v[64:67], v4, s[8:11], s24 offen offset:0 sc1
buffer_load_dwordx4 v[68:71], v4, s[8:11], s24 offen offset:2048 sc1
buffer_load_dwordx4 v[72:75], v4, s[8:11], s25 offen offset:0 sc1
s_add_u32 s24, s20, 89583616
s_add_u32 s25, s24, 4096
buffer_load_dwordx4 v[76:79], v4, s[8:11], s24 offen offset:0 sc1
buffer_load_dwordx4 v[80:83], v4, s[8:11], s24 offen offset:2048 sc1
buffer_load_dwordx4 v[84:87], v4, s[8:11], s25 offen offset:0 sc1
s_add_u32 s24, s20, 91942912
s_add_u32 s25, s24, 4096
buffer_load_dwordx4 v[88:91], v4, s[8:11], s24 offen offset:0 sc1
buffer_load_dwordx4 v[92:95], v4, s[8:11], s24 offen offset:2048 sc1
buffer_load_dwordx4 v[96:99], v4, s[8:11], s25 offen offset:0 sc1
s_add_u32 s24, s20, 94302208
s_add_u32 s25, s24, 4096
buffer_load_dwordx4 v[100:103], v4, s[8:11], s24 offen offset:0 sc1
buffer_load_dwordx4 v[104:107], v4, s[8:11], s24 offen offset:2048 sc1
buffer_load_dwordx4 v[108:111], v4, s[8:11], s25 offen offset:0 sc1
s_add_u32 s24, s20, 96661504
s_add_u32 s25, s24, 4096
buffer_load_dwordx4 v[112:115], v4, s[8:11], s24 offen offset:0 sc1
buffer_load_dwordx4 v[116:119], v4, s[8:11], s24 offen offset:2048 sc1
buffer_load_dwordx4 v[120:123], v4, s[8:11], s25 offen offset:0 sc1
s_waitcnt vmcnt(26)
v_lshlrev_b32 v128, 16, v16
v_and_b32 v129, 0xffff0000, v16
v_lshlrev_b32 v130, 16, v17
v_and_b32 v131, 0xffff0000, v17
v_lshlrev_b32 v132, 16, v18
v_and_b32 v133, 0xffff0000, v18
v_lshlrev_b32 v134, 16, v19
v_and_b32 v135, 0xffff0000, v19
s_waitcnt vmcnt(25)
v_lshlrev_b32 v136, 16, v20
v_and_b32 v137, 0xffff0000, v20
v_lshlrev_b32 v138, 16, v21
v_and_b32 v139, 0xffff0000, v21
v_lshlrev_b32 v140, 16, v22
v_and_b32 v141, 0xffff0000, v22
v_lshlrev_b32 v142, 16, v23
v_and_b32 v143, 0xffff0000, v23
s_waitcnt vmcnt(24)
v_lshlrev_b32 v144, 16, v24
v_and_b32 v145, 0xffff0000, v24
v_lshlrev_b32 v146, 16, v25
v_and_b32 v147, 0xffff0000, v25
v_lshlrev_b32 v148, 16, v26
v_and_b32 v149, 0xffff0000, v26
v_lshlrev_b32 v150, 16, v27
v_and_b32 v151, 0xffff0000, v27
s_waitcnt vmcnt(23)
v_lshlrev_b32 v6, 16, v28
v_and_b32 v7, 0xffff0000, v28
v_add_f32 v128, v128, v6
v_add_f32 v129, v129, v7
v_lshlrev_b32 v8, 16, v29
v_and_b32 v9, 0xffff0000, v29
v_add_f32 v130, v130, v8
v_add_f32 v131, v131, v9
v_lshlrev_b32 v6, 16, v30
v_and_b32 v7, 0xffff0000, v30
v_add_f32 v132, v132, v6
v_add_f32 v133, v133, v7
v_lshlrev_b32 v8, 16, v31
v_and_b32 v9, 0xffff0000, v31
v_add_f32 v134, v134, v8
v_add_f32 v135, v135, v9
s_waitcnt vmcnt(22)
v_lshlrev_b32 v6, 16, v32
v_and_b32 v7, 0xffff0000, v32
v_add_f32 v136, v136, v6
v_add_f32 v137, v137, v7
v_lshlrev_b32 v8, 16, v33
v_and_b32 v9, 0xffff0000, v33
v_add_f32 v138, v138, v8
v_add_f32 v139, v139, v9
v_lshlrev_b32 v6, 16, v34
v_and_b32 v7, 0xffff0000, v34
v_add_f32 v140, v140, v6
v_add_f32 v141, v141, v7
v_lshlrev_b32 v8, 16, v35
v_and_b32 v9, 0xffff0000, v35
v_add_f32 v142, v142, v8
v_add_f32 v143, v143, v9
s_waitcnt vmcnt(21)
v_lshlrev_b32 v6, 16, v36
v_and_b32 v7, 0xffff0000, v36
v_add_f32 v144, v144, v6
v_add_f32 v145, v145, v7
v_lshlrev_b32 v8, 16, v37
v_and_b32 v9, 0xffff0000, v37
v_add_f32 v146, v146, v8
v_add_f32 v147, v147, v9
v_lshlrev_b32 v6, 16, v38
v_and_b32 v7, 0xffff0000, v38
v_add_f32 v148, v148, v6
v_add_f32 v149, v149, v7
v_lshlrev_b32 v8, 16, v39
v_and_b32 v9, 0xffff0000, v39
v_add_f32 v150, v150, v8
v_add_f32 v151, v151, v9
s_waitcnt vmcnt(20)
v_lshlrev_b32 v6, 16, v40
v_and_b32 v7, 0xffff0000, v40
v_add_f32 v128, v128, v6
v_add_f32 v129, v129, v7
v_lshlrev_b32 v8, 16, v41
v_and_b32 v9, 0xffff0000, v41
v_add_f32 v130, v130, v8
v_add_f32 v131, v131, v9
v_lshlrev_b32 v6, 16, v42
v_and_b32 v7, 0xffff0000, v42
v_add_f32 v132, v132, v6
v_add_f32 v133, v133, v7
v_lshlrev_b32 v8, 16, v43
v_and_b32 v9, 0xffff0000, v43
v_add_f32 v134, v134, v8
v_add_f32 v135, v135, v9
s_waitcnt vmcnt(19)
v_lshlrev_b32 v6, 16, v44
v_and_b32 v7, 0xffff0000, v44
v_add_f32 v136, v136, v6
v_add_f32 v137, v137, v7
v_lshlrev_b32 v8, 16, v45
v_and_b32 v9, 0xffff0000, v45
v_add_f32 v138, v138, v8
v_add_f32 v139, v139, v9
v_lshlrev_b32 v6, 16, v46
v_and_b32 v7, 0xffff0000, v46
v_add_f32 v140, v140, v6
v_add_f32 v141, v141, v7
v_lshlrev_b32 v8, 16, v47
v_and_b32 v9, 0xffff0000, v47
v_add_f32 v142, v142, v8
v_add_f32 v143, v143, v9
s_waitcnt vmcnt(18)
v_lshlrev_b32 v6, 16, v48
v_and_b32 v7, 0xffff0000, v48
v_add_f32 v144, v144, v6
v_add_f32 v145, v145, v7
v_lshlrev_b32 v8, 16, v49
v_and_b32 v9, 0xffff0000, v49
v_add_f32 v146, v146, v8
v_add_f32 v147, v147, v9
v_lshlrev_b32 v6, 16, v50
v_and_b32 v7, 0xffff0000, v50
v_add_f32 v148, v148, v6
v_add_f32 v149, v149, v7
v_lshlrev_b32 v8, 16, v51
v_and_b32 v9, 0xffff0000, v51
v_add_f32 v150, v150, v8
v_add_f32 v151, v151, v9
s_waitcnt vmcnt(17)
v_lshlrev_b32 v6, 16, v52
v_and_b32 v7, 0xffff0000, v52
v_add_f32 v128, v128, v6
v_add_f32 v129, v129, v7
v_lshlrev_b32 v8, 16, v53
v_and_b32 v9, 0xffff0000, v53
v_add_f32 v130, v130, v8
v_add_f32 v131, v131, v9
v_lshlrev_b32 v6, 16, v54
v_and_b32 v7, 0xffff0000, v54
v_add_f32 v132, v132, v6
v_add_f32 v133, v133, v7
v_lshlrev_b32 v8, 16, v55
v_and_b32 v9, 0xffff0000, v55
v_add_f32 v134, v134, v8
v_add_f32 v135, v135, v9
s_waitcnt vmcnt(16)
v_lshlrev_b32 v6, 16, v56
v_and_b32 v7, 0xffff0000, v56
v_add_f32 v136, v136, v6
v_add_f32 v137, v137, v7
v_lshlrev_b32 v8, 16, v57
v_and_b32 v9, 0xffff0000, v57
v_add_f32 v138, v138, v8
v_add_f32 v139, v139, v9
v_lshlrev_b32 v6, 16, v58
v_and_b32 v7, 0xffff0000, v58
v_add_f32 v140, v140, v6
v_add_f32 v141, v141, v7
v_lshlrev_b32 v8, 16, v59
v_and_b32 v9, 0xffff0000, v59
v_add_f32 v142, v142, v8
v_add_f32 v143, v143, v9
s_waitcnt vmcnt(15)
v_lshlrev_b32 v6, 16, v60
v_and_b32 v7, 0xffff0000, v60
v_add_f32 v144, v144, v6
v_add_f32 v145, v145, v7
v_lshlrev_b32 v8, 16, v61
v_and_b32 v9, 0xffff0000, v61
v_add_f32 v146, v146, v8
v_add_f32 v147, v147, v9
v_lshlrev_b32 v6, 16, v62
v_and_b32 v7, 0xffff0000, v62
v_add_f32 v148, v148, v6
v_add_f32 v149, v149, v7
v_lshlrev_b32 v8, 16, v63
v_and_b32 v9, 0xffff0000, v63
v_add_f32 v150, v150, v8
v_add_f32 v151, v151, v9
s_waitcnt vmcnt(14)
v_lshlrev_b32 v6, 16, v64
v_and_b32 v7, 0xffff0000, v64
v_add_f32 v128, v128, v6
v_add_f32 v129, v129, v7
v_lshlrev_b32 v8, 16, v65
v_and_b32 v9, 0xffff0000, v65
v_add_f32 v130, v130, v8
v_add_f32 v131, v131, v9
v_lshlrev_b32 v6, 16, v66
v_and_b32 v7, 0xffff0000, v66
v_add_f32 v132, v132, v6
v_add_f32 v133, v133, v7
v_lshlrev_b32 v8, 16, v67
v_and_b32 v9, 0xffff0000, v67
v_add_f32 v134, v134, v8
v_add_f32 v135, v135, v9
s_waitcnt vmcnt(13)
v_lshlrev_b32 v6, 16, v68
v_and_b32 v7, 0xffff0000, v68
v_add_f32 v136, v136, v6
v_add_f32 v137, v137, v7
v_lshlrev_b32 v8, 16, v69
v_and_b32 v9, 0xffff0000, v69
v_add_f32 v138, v138, v8
v_add_f32 v139, v139, v9
v_lshlrev_b32 v6, 16, v70
v_and_b32 v7, 0xffff0000, v70
v_add_f32 v140, v140, v6
v_add_f32 v141, v141, v7
v_lshlrev_b32 v8, 16, v71
v_and_b32 v9, 0xffff0000, v71
v_add_f32 v142, v142, v8
v_add_f32 v143, v143, v9
s_waitcnt vmcnt(12)
v_lshlrev_b32 v6, 16, v72
v_and_b32 v7, 0xffff0000, v72
v_add_f32 v144, v144, v6
v_add_f32 v145, v145, v7
v_lshlrev_b32 v8, 16, v73
v_and_b32 v9, 0xffff0000, v73
v_add_f32 v146, v146, v8
v_add_f32 v147, v147, v9
v_lshlrev_b32 v6, 16, v74
v_and_b32 v7, 0xffff0000, v74
v_add_f32 v148, v148, v6
v_add_f32 v149, v149, v7
v_lshlrev_b32 v8, 16, v75
v_and_b32 v9, 0xffff0000, v75
v_add_f32 v150, v150, v8
v_add_f32 v151, v151, v9
s_waitcnt vmcnt(11)
v_lshlrev_b32 v6, 16, v76
v_and_b32 v7, 0xffff0000, v76
v_add_f32 v128, v128, v6
v_add_f32 v129, v129, v7
v_lshlrev_b32 v8, 16, v77
v_and_b32 v9, 0xffff0000, v77
v_add_f32 v130, v130, v8
v_add_f32 v131, v131, v9
v_lshlrev_b32 v6, 16, v78
v_and_b32 v7, 0xffff0000, v78
v_add_f32 v132, v132, v6
v_add_f32 v133, v133, v7
v_lshlrev_b32 v8, 16, v79
v_and_b32 v9, 0xffff0000, v79
v_add_f32 v134, v134, v8
v_add_f32 v135, v135, v9
s_waitcnt vmcnt(10)
v_lshlrev_b32 v6, 16, v80
v_and_b32 v7, 0xffff0000, v80
v_add_f32 v136, v136, v6
v_add_f32 v137, v137, v7
v_lshlrev_b32 v8, 16, v81
v_and_b32 v9, 0xffff0000, v81
v_add_f32 v138, v138, v8
v_add_f32 v139, v139, v9
v_lshlrev_b32 v6, 16, v82
v_and_b32 v7, 0xffff0000, v82
v_add_f32 v140, v140, v6
v_add_f32 v141, v141, v7
v_lshlrev_b32 v8, 16, v83
v_and_b32 v9, 0xffff0000, v83
v_add_f32 v142, v142, v8
v_add_f32 v143, v143, v9
s_waitcnt vmcnt(9)
v_lshlrev_b32 v6, 16, v84
v_and_b32 v7, 0xffff0000, v84
v_add_f32 v144, v144, v6
v_add_f32 v145, v145, v7
v_lshlrev_b32 v8, 16, v85
v_and_b32 v9, 0xffff0000, v85
v_add_f32 v146, v146, v8
v_add_f32 v147, v147, v9
v_lshlrev_b32 v6, 16, v86
v_and_b32 v7, 0xffff0000, v86
v_add_f32 v148, v148, v6
v_add_f32 v149, v149, v7
v_lshlrev_b32 v8, 16, v87
v_and_b32 v9, 0xffff0000, v87
v_add_f32 v150, v150, v8
v_add_f32 v151, v151, v9
s_waitcnt vmcnt(8)
v_lshlrev_b32 v6, 16, v88
v_and_b32 v7, 0xffff0000, v88
v_add_f32 v128, v128, v6
v_add_f32 v129, v129, v7
v_lshlrev_b32 v8, 16, v89
v_and_b32 v9, 0xffff0000, v89
v_add_f32 v130, v130, v8
v_add_f32 v131, v131, v9
v_lshlrev_b32 v6, 16, v90
v_and_b32 v7, 0xffff0000, v90
v_add_f32 v132, v132, v6
v_add_f32 v133, v133, v7
v_lshlrev_b32 v8, 16, v91
v_and_b32 v9, 0xffff0000, v91
v_add_f32 v134, v134, v8
v_add_f32 v135, v135, v9
s_waitcnt vmcnt(7)
v_lshlrev_b32 v6, 16, v92
v_and_b32 v7, 0xffff0000, v92
v_add_f32 v136, v136, v6
v_add_f32 v137, v137, v7
v_lshlrev_b32 v8, 16, v93
v_and_b32 v9, 0xffff0000, v93
v_add_f32 v138, v138, v8
v_add_f32 v139, v139, v9
v_lshlrev_b32 v6, 16, v94
v_and_b32 v7, 0xffff0000, v94
v_add_f32 v140, v140, v6
v_add_f32 v141, v141, v7
v_lshlrev_b32 v8, 16, v95
v_and_b32 v9, 0xffff0000, v95
v_add_f32 v142, v142, v8
v_add_f32 v143, v143, v9
s_waitcnt vmcnt(6)
v_lshlrev_b32 v6, 16, v96
v_and_b32 v7, 0xffff0000, v96
v_add_f32 v144, v144, v6
v_add_f32 v145, v145, v7
v_lshlrev_b32 v8, 16, v97
v_and_b32 v9, 0xffff0000, v97
v_add_f32 v146, v146, v8
v_add_f32 v147, v147, v9
v_lshlrev_b32 v6, 16, v98
v_and_b32 v7, 0xffff0000, v98
v_add_f32 v148, v148, v6
v_add_f32 v149, v149, v7
v_lshlrev_b32 v8, 16, v99
v_and_b32 v9, 0xffff0000, v99
v_add_f32 v150, v150, v8
v_add_f32 v151, v151, v9
s_waitcnt vmcnt(5)
v_lshlrev_b32 v6, 16, v100
v_and_b32 v7, 0xffff0000, v100
v_add_f32 v128, v128, v6
v_add_f32 v129, v129, v7
v_lshlrev_b32 v8, 16, v101
v_and_b32 v9, 0xffff0000, v101
v_add_f32 v130, v130, v8
v_add_f32 v131, v131, v9
v_lshlrev_b32 v6, 16, v102
v_and_b32 v7, 0xffff0000, v102
v_add_f32 v132, v132, v6
v_add_f32 v133, v133, v7
v_lshlrev_b32 v8, 16, v103
v_and_b32 v9, 0xffff0000, v103
v_add_f32 v134, v134, v8
v_add_f32 v135, v135, v9
s_waitcnt vmcnt(4)
v_lshlrev_b32 v6, 16, v104
v_and_b32 v7, 0xffff0000, v104
v_add_f32 v136, v136, v6
v_add_f32 v137, v137, v7
v_lshlrev_b32 v8, 16, v105
v_and_b32 v9, 0xffff0000, v105
v_add_f32 v138, v138, v8
v_add_f32 v139, v139, v9
v_lshlrev_b32 v6, 16, v106
v_and_b32 v7, 0xffff0000, v106
v_add_f32 v140, v140, v6
v_add_f32 v141, v141, v7
v_lshlrev_b32 v8, 16, v107
v_and_b32 v9, 0xffff0000, v107
v_add_f32 v142, v142, v8
v_add_f32 v143, v143, v9
s_waitcnt vmcnt(3)
v_lshlrev_b32 v6, 16, v108
v_and_b32 v7, 0xffff0000, v108
v_add_f32 v144, v144, v6
v_add_f32 v145, v145, v7
v_lshlrev_b32 v8, 16, v109
v_and_b32 v9, 0xffff0000, v109
v_add_f32 v146, v146, v8
v_add_f32 v147, v147, v9
v_lshlrev_b32 v6, 16, v110
v_and_b32 v7, 0xffff0000, v110
v_add_f32 v148, v148, v6
v_add_f32 v149, v149, v7
v_lshlrev_b32 v8, 16, v111
v_and_b32 v9, 0xffff0000, v111
v_add_f32 v150, v150, v8
v_add_f32 v151, v151, v9
s_waitcnt vmcnt(2)
v_lshlrev_b32 v6, 16, v112
v_and_b32 v7, 0xffff0000, v112
v_add_f32 v128, v128, v6
v_add_f32 v129, v129, v7
v_lshlrev_b32 v8, 16, v113
v_and_b32 v9, 0xffff0000, v113
v_add_f32 v130, v130, v8
v_add_f32 v131, v131, v9
v_lshlrev_b32 v6, 16, v114
v_and_b32 v7, 0xffff0000, v114
v_add_f32 v132, v132, v6
v_add_f32 v133, v133, v7
v_lshlrev_b32 v8, 16, v115
v_and_b32 v9, 0xffff0000, v115
v_add_f32 v134, v134, v8
v_add_f32 v135, v135, v9
s_waitcnt vmcnt(1)
v_lshlrev_b32 v6, 16, v116
v_and_b32 v7, 0xffff0000, v116
v_add_f32 v136, v136, v6
v_add_f32 v137, v137, v7
v_lshlrev_b32 v8, 16, v117
v_and_b32 v9, 0xffff0000, v117
v_add_f32 v138, v138, v8
v_add_f32 v139, v139, v9
v_lshlrev_b32 v6, 16, v118
v_and_b32 v7, 0xffff0000, v118
v_add_f32 v140, v140, v6
v_add_f32 v141, v141, v7
v_lshlrev_b32 v8, 16, v119
v_and_b32 v9, 0xffff0000, v119
v_add_f32 v142, v142, v8
v_add_f32 v143, v143, v9
s_waitcnt vmcnt(0)
v_lshlrev_b32 v6, 16, v120
v_and_b32 v7, 0xffff0000, v120
v_add_f32 v144, v144, v6
v_add_f32 v145, v145, v7
v_lshlrev_b32 v8, 16, v121
v_and_b32 v9, 0xffff0000, v121
v_add_f32 v146, v146, v8
v_add_f32 v147, v147, v9
v_lshlrev_b32 v6, 16, v122
v_and_b32 v7, 0xffff0000, v122
v_add_f32 v148, v148, v6
v_add_f32 v149, v149, v7
v_lshlrev_b32 v8, 16, v123
v_and_b32 v9, 0xffff0000, v123
v_add_f32 v150, v150, v8
v_add_f32 v151, v151, v9
v_cvt_pk_bf16_f32 v152, v128, v129
v_cvt_pk_bf16_f32 v153, v130, v131
v_cvt_pk_bf16_f32 v154, v132, v133
v_cvt_pk_bf16_f32 v155, v134, v135
v_cvt_pk_bf16_f32 v156, v136, v137
v_cvt_pk_bf16_f32 v157, v138, v139
v_cvt_pk_bf16_f32 v158, v140, v141
v_cvt_pk_bf16_f32 v159, v142, v143
v_cvt_pk_bf16_f32 v160, v144, v145
v_cvt_pk_bf16_f32 v161, v146, v147
v_cvt_pk_bf16_f32 v162, v148, v149
v_cvt_pk_bf16_f32 v163, v150, v151
s_add_u32 s24, s20, 30339072
s_add_u32 s25, s24, 4096
buffer_store_dwordx4 v[152:155], v4, s[8:11], s24 offen offset:0 sc1
buffer_store_dwordx4 v[156:159], v4, s[8:11], s24 offen offset:2048 sc1
buffer_store_dwordx4 v[160:163], v4, s[8:11], s25 offen offset:0 sc1
v_add_f32 v6, v128, v129
v_mul_f32 v7, v128, v128
v_mul_f32 v9, v129, v129
v_mov_b32 v8, 0
v_add_f32 v6, v6, v130
v_add_f32 v8, v8, v131
v_fmac_f32 v7, v130, v130
v_fmac_f32 v9, v131, v131
v_add_f32 v6, v6, v132
v_add_f32 v8, v8, v133
v_fmac_f32 v7, v132, v132
v_fmac_f32 v9, v133, v133
v_add_f32 v6, v6, v134
v_add_f32 v8, v8, v135
v_fmac_f32 v7, v134, v134
v_fmac_f32 v9, v135, v135
v_add_f32 v6, v6, v136
v_add_f32 v8, v8, v137
v_fmac_f32 v7, v136, v136
v_fmac_f32 v9, v137, v137
v_add_f32 v6, v6, v138
v_add_f32 v8, v8, v139
v_fmac_f32 v7, v138, v138
v_fmac_f32 v9, v139, v139
v_add_f32 v6, v6, v140
v_add_f32 v8, v8, v141
v_fmac_f32 v7, v140, v140
v_fmac_f32 v9, v141, v141
v_add_f32 v6, v6, v142
v_add_f32 v8, v8, v143
v_fmac_f32 v7, v142, v142
v_fmac_f32 v9, v143, v143
v_add_f32 v6, v6, v144
v_add_f32 v8, v8, v145
v_fmac_f32 v7, v144, v144
v_fmac_f32 v9, v145, v145
v_add_f32 v6, v6, v146
v_add_f32 v8, v8, v147
v_fmac_f32 v7, v146, v146
v_fmac_f32 v9, v147, v147
v_add_f32 v6, v6, v148
v_add_f32 v8, v8, v149
v_fmac_f32 v7, v148, v148
v_fmac_f32 v9, v149, v149
v_add_f32 v6, v6, v150
v_add_f32 v8, v8, v151
v_fmac_f32 v7, v150, v150
v_fmac_f32 v9, v151, v151
v_add_f32 v6, v6, v8
v_add_f32 v7, v7, v9
s_nop 0
v_add_f32_dpp v6, v6, v6 row_ror:8 row_mask:0xf bank_mask:0xf
v_add_f32_dpp v7, v7, v7 row_ror:8 row_mask:0xf bank_mask:0xf
v_mov_b32 v8, v6
v_mov_b32 v9, v7
s_nop 0
v_permlane16_swap_b32 v6, v8
v_permlane16_swap_b32 v7, v9
v_add_f32 v6, v6, v8
v_add_f32 v7, v7, v9
v_mov_b32 v8, v6
v_mov_b32 v9, v7
s_nop 0
v_permlane32_swap_b32 v6, v8
v_permlane32_swap_b32 v7, v9
v_add_f32 v6, v6, v8
v_add_f32 v7, v7, v9
v_and_b32 v10, 7, v1
v_lshlrev_b32 v10, 3, v10
v_add_u32 v10, 147456, v10
s_lshl_b32 s24, s4, 6
v_add_u32 v11, s24, v10
ds_write_b64 v11, v[6:7]
s_waitcnt lgkmcnt(0)
s_barrier
ds_read_b64 v[6:7], v10
ds_read_b64 v[8:9], v10 offset:64
ds_read_b64 v[12:13], v10 offset:128
s_waitcnt lgkmcnt(0)
v_add_f32 v6, v6, v8
v_add_f32 v7, v7, v9
v_add_f32 v6, v6, v12
v_add_f32 v7, v7, v13
v_mul_f32 v6, 0x3ae38e39, v6
v_mul_f32 v7, 0x3ae38e39, v7
v_fma_f32 v7, -v6, v6, v7
v_max_f32 v7, 0, v7
v_add_f32 v7, 0x3727c5ac, v7
v_rsq_f32 v7, v7
s_nop 0
v_mul_f32 v6, v6, v7
v_fma_f32 v128, v128, v7, -v6
v_fma_f32 v129, v129, v7, -v6
v_fma_f32 v130, v130, v7, -v6
v_fma_f32 v131, v131, v7, -v6
v_fma_f32 v132, v132, v7, -v6
v_fma_f32 v133, v133, v7, -v6
v_fma_f32 v134, v134, v7, -v6
v_fma_f32 v135, v135, v7, -v6
v_fma_f32 v136, v136, v7, -v6
v_fma_f32 v137, v137, v7, -v6
v_fma_f32 v138, v138, v7, -v6
v_fma_f32 v139, v139, v7, -v6
v_fma_f32 v140, v140, v7, -v6
v_fma_f32 v141, v141, v7, -v6
v_fma_f32 v142, v142, v7, -v6
v_fma_f32 v143, v143, v7, -v6
v_fma_f32 v144, v144, v7, -v6
v_fma_f32 v145, v145, v7, -v6
v_fma_f32 v146, v146, v7, -v6
v_fma_f32 v147, v147, v7, -v6
v_fma_f32 v148, v148, v7, -v6
v_fma_f32 v149, v149, v7, -v6
v_fma_f32 v150, v150, v7, -v6
v_fma_f32 v151, v151, v7, -v6
v_cvt_pk_bf16_f32 v168, v128, v129
v_cvt_pk_bf16_f32 v169, v130, v131
v_cvt_pk_bf16_f32 v170, v132, v133
v_cvt_pk_bf16_f32 v171, v134, v135
v_cvt_pk_bf16_f32 v172, v136, v137
v_cvt_pk_bf16_f32 v173, v138, v139
v_cvt_pk_bf16_f32 v174, v140, v141
v_cvt_pk_bf16_f32 v175, v142, v143
v_cvt_pk_bf16_f32 v176, v144, v145
v_cvt_pk_bf16_f32 v177, v146, v147
v_cvt_pk_bf16_f32 v178, v148, v149
v_cvt_pk_bf16_f32 v179, v150, v151
s_add_u32 s24, s20, 25620480
s_add_u32 s25, s24, 4096
buffer_store_dwordx4 v[168:171], v4, s[8:11], s24 offen offset:0 sc1
buffer_store_dwordx4 v[172:175], v4, s[8:11], s24 offen offset:2048 sc1
buffer_store_dwordx4 v[176:179], v4, s[8:11], s25 offen offset:0 sc1
s_lshl_b32 s24, s5, 4
s_lshr_b32 s25, s6, 1
s_add_u32 s24, s24, s25
s_lshl_b32 s24, s24, 3
s_and_b32 s25, s6, 1
s_mul_i32 s25, s25, 3
s_add_u32 s24, s24, s25
s_add_u32 s24, s24, s4
s_lshl_b32 s24, s24, 7
s_add_u32 s24, s24, 1835008
v_mov_b32 v13, 2146435072
v_cmp_eq_u32 vcc, 0, v1
v_mov_b32 v14, s68
v_mov_b32 v15, s69
v_cndmask_b32 v13, v13, 0, vcc
s_waitcnt vmcnt(0)
buffer_store_dwordx2 v[14:15], v13, s[8:11], s24 offen sc1
s_branch L_r_done
L_r_side:
s_barrier
s_waitcnt vmcnt(0)
L_r_done:
s_barrier
s_mov_b32 s70, 25620480
s_mov_b32 s71, 30339072
s_mov_b32 s72, 35057664
s_mov_b32 s73, 39776256
s_mov_b32 s74, 42266624
s_mov_b32 s75, 61272064
s_mov_b32 s76, 99020800
s_mov_b32 s77, 1048576
s_mov_b32 s7, 1
s_lshr_b32 s20, s5, 2
s_lshl_b32 s20, s20, 3
s_lshr_b32 s21, s6, 2
s_add_u32 s20, s20, s21
s_and_b32 s21, s5, 3
s_lshl_b32 s21, s21, 2
s_and_b32 s22, s6, 3
s_add_u32 s21, s21, s22
s_lshl_b32 s24, s20, 3
s_sub_u32 s25, s24, 1
s_max_i32 s35, s25, 0
s_mul_i32 s25, s35, 18432
s_lshl_b32 s26, s4, 1
s_add_u32 s36, s24, s26
s_mul_i32 s24, s36, 18432
s_add_u32 s26, s24, s70
s_add_u32 s27, s26, 18432
s_add_u32 s28, s25, s70
v_add_u32 v4, 0x10000, v2
v_add_u32 v5, 0x20000, v2
s_cmp_eq_u32 s4, 3
s_cselect_b32 s29, 0, s4
s_cselect_b32 s31, 16, 9
s_lshl_b32 s30, s29, 10
v_and_b32 v12, 15, v1
v_mov_b32 v13, 2146435072
v_cmp_le_u32 vcc, s31, v12
s_nop 1
v_cndmask_b32 v3, v13, v2, vcc
s_add_u32 s31, s30, 2048
v_add_u32 v6, s31, v2
v_add_u32 v7, s31, v4
v_add_u32 v8, s31, v5
s_add_u32 s31, s30, 5120
v_add_u32 v9, s31, v2
v_add_u32 v10, s31, v4
v_add_u32 v11, s31, v5
v_mul_u32_u24 v14, 43, v1
v_lshrrev_b32 v14, 8, v14
v_mul_u32_u24 v15, 6, v14
v_sub_u32 v15, v1, v15
v_cmp_eq_u32 vcc, 1, v14
v_mov_b32 v16, s36
s_nop 0
v_addc_co_u32 v16, vcc, 0, v16, vcc
v_cmp_eq_u32 vcc, 2, v14
v_mov_b32 v17, s35
s_nop 0
v_cndmask_b32 v16, v16, v17, vcc
v_lshlrev_b32 v16, 3, v16
v_add_lshl_u32 v16, v16, v15, 7
s_add_u32 s22, s77, 786432
s_mov_b32 s52, 0
L_poll6:
buffer_load_dwordx2 v[14:15], v16, s[8:11], s22 offen sc1
s_add_u32 s52, s52, 1
s_waitcnt vmcnt(0)
v_cmp_ne_u64 vcc, s[68:69], v[14:15]
s_cmp_ge_u32 s52, 0x100000
s_cbranch_scc1 L_got6
s_and_b64 exec, exec, vcc
s_cbranch_execnz L_poll6
L_got6:
s_mov_b64 exec, -1
buffer_load_dwordx4 a[0:3], v2, s[8:11], s26 offen offset:0 sc1
buffer_load_dwordx4 a[72:75], v2, s[8:11], s27 offen offset:0 sc1
buffer_load_dwordx4 a[144:147], v3, s[8:11], s28 offen offset:0 sc1
buffer_load_dwordx4 a[4:7], v2, s[8:11], s26 offen offset:1024 sc1
buffer_load_dwordx4 a[76:79], v2, s[8:11], s27 offen offset:1024 sc1
buffer_load_dwordx4 a[148:151], v3, s[8:11], s28 offen offset:1024 sc1
buffer_load_dwordx4 a[8:11], v2, s[8:11], s26 offen offset:2048 sc1
buffer_load_dwordx4 a[80:83], v2, s[8:11], s27 offen offset:2048 sc1
buffer_load_dwordx4 a[152:155], v3, s[8:11], s28 offen offset:2048 sc1
buffer_load_dwordx4 a[12:15], v2, s[8:11], s26 offen offset:3072 sc1
buffer_load_dwordx4 a[84:87], v2, s[8:11], s27 offen offset:3072 sc1
buffer_load_dwordx4 a[156:159], v3, s[8:11], s28 offen offset:3072 sc1
s_add_u32 s26, s26, 4096
s_add_u32 s27, s27, 4096
s_add_u32 s28, s28, 4096
buffer_load_dwordx4 a[16:19], v2, s[8:11], s26 offen offset:0 sc1
buffer_load_dwordx4 a[88:91], v2, s[8:11], s27 offen offset:0 sc1
buffer_load_dwordx4 a[160:163], v3, s[8:11], s28 offen offset:0 sc1
buffer_load_dwordx4 a[20:23], v2, s[8:11], s26 offen offset:1024 sc1
buffer_load_dwordx4 a[92:95], v2, s[8:11], s27 offen offset:1024 sc1
buffer_load_dwordx4 a[164:167], v3, s[8:11], s28 offen offset:1024 sc1
buffer_load_dwordx4 a[24:27], v2, s[8:11], s26 offen offset:2048 sc1
buffer_load_dwordx4 a[96:99], v2, s[8:11], s27 offen offset:2048 sc1
buffer_load_dwordx4 a[168:171], v3, s[8:11], s28 offen offset:2048 sc1
buffer_load_dwordx4 a[28:31], v2, s[8:11], s26 offen offset:3072 sc1
buffer_load_dwordx4 a[100:103], v2, s[8:11], s27 offen offset:3072 sc1
buffer_load_dwordx4 a[172:175], v3, s[8:11], s28 offen offset:3072 sc1
v_lshrrev_b32 v13, 4, v1
v_lshlrev_b32 v14, 2, v13
v_sub_u32 v14, v12, v14
v_subrev_u32 v15, 0, v14
v_cmp_gt_u32 s[52:53], 8, v15
v_cmp_gt_i32 s[44:45], -8, v15
v_subrev_u32 v15, 1, v14
v_cmp_gt_u32 s[54:55], 8, v15
v_cmp_gt_i32 s[46:47], -8, v15
v_subrev_u32 v15, 2, v14
v_cmp_gt_u32 s[56:57], 8, v15
v_cmp_gt_i32 s[48:49], -8, v15
v_subrev_u32 v15, 3, v14
v_cmp_gt_u32 s[58:59], 8, v15
v_cmp_gt_i32 s[50:51], -8, v15
s_and_b32 s31, s20, 7
s_or_b32 s31, s31, s4
s_cmp_eq_u32 s31, 0
s_cselect_b64 s[60:61], 0, s[44:45]
s_cselect_b64 s[62:63], 0, s[46:47]
s_cselect_b64 s[64:65], 0, s[48:49]
s_cselect_b64 s[66:67], 0, s[50:51]
ds_read_b128 a[216:219], v2 offset:0
ds_read_b128 a[220:223], v2 offset:8192
ds_read_b128 a[224:227], v2 offset:1024
ds_read_b128 a[228:231], v2 offset:9216
ds_read_b128 a[232:235], v2 offset:2048
ds_read_b128 a[236:239], v2 offset:10240
s_waitcnt vmcnt(18)
s_waitcnt lgkmcnt(4)
v_mfma_f32_16x16x32_bf16 v[32:35], a[216:219], a[0:3], 0
s_add_u32 s26, s26, 4096
s_add_u32 s27, s27, 4096
s_add_u32 s28, s28, 4096
buffer_load_dwordx4 a[32:35], v2, s[8:11], s26 offen offset:0 sc1
v_mfma_f32_16x16x32_bf16 v[32:35], a[220:223], a[4:7], v[32:35]
ds_read_b128 a[240:243], v2 offset:3072
v_mfma_f32_16x16x32_bf16 v[36:39], a[216:219], a[72:75], 0
v_mfma_f32_16x16x32_bf16 v[36:39], a[220:223], a[76:79], v[36:39]
ds_read_b128 a[244:247], v2 offset:11264
s_waitcnt lgkmcnt(4)
v_mfma_f32_16x16x32_bf16 v[40:43], a[224:227], a[0:3], 0
buffer_load_dwordx4 a[104:107], v2, s[8:11], s27 offen offset:0 sc1
v_mfma_f32_16x16x32_bf16 v[40:43], a[228:231], a[4:7], v[40:43]
ds_read_b128 a[216:219], v2 offset:4096
v_mfma_f32_16x16x32_bf16 v[44:47], a[224:227], a[72:75], 0
v_mfma_f32_16x16x32_bf16 v[44:47], a[228:231], a[76:79], v[44:47]
ds_read_b128 a[220:223], v2 offset:12288
s_waitcnt lgkmcnt(4)
v_mfma_f32_16x16x32_bf16 v[48:51], a[232:235], a[0:3], 0
buffer_load_dwordx4 a[176:179], v3, s[8:11], s28 offen offset:0 sc1
v_mfma_f32_16x16x32_bf16 v[48:51], a[236:239], a[4:7], v[48:51]
ds_read_b128 a[224:227], v2 offset:5120
v_mfma_f32_16x16x32_bf16 v[52:55], a[232:235], a[72:75], 0
v_mfma_f32_16x16x32_bf16 v[52:55], a[236:239], a[76:79], v[52:55]
ds_read_b128 a[228:231], v2 offset:13312
s_waitcnt lgkmcnt(4)
v_mfma_f32_16x16x32_bf16 v[56:59], a[240:243], a[0:3], 0
buffer_load_dwordx4 a[36:39], v2, s[8:11], s26 offen offset:1024 sc1
v_mfma_f32_16x16x32_bf16 v[56:59], a[244:247], a[4:7], v[56:59]
ds_read_b128 a[232:235], v2 offset:6144
v_mfma_f32_16x16x32_bf16 v[60:63], a[240:243], a[72:75], 0
v_mfma_f32_16x16x32_bf16 v[60:63], a[244:247], a[76:79], v[60:63]
ds_read_b128 a[236:239], v2 offset:14336
s_waitcnt lgkmcnt(4)
v_mfma_f32_16x16x32_bf16 v[64:67], a[216:219], a[0:3], 0
buffer_load_dwordx4 a[108:111], v2, s[8:11], s27 offen offset:1024 sc1
v_mfma_f32_16x16x32_bf16 v[64:67], a[220:223], a[4:7], v[64:67]
ds_read_b128 a[240:243], v2 offset:7168
v_mfma_f32_16x16x32_bf16 v[68:71], a[216:219], a[72:75], 0
v_mfma_f32_16x16x32_bf16 v[68:71], a[220:223], a[76:79], v[68:71]
ds_read_b128 a[244:247], v2 offset:15360
s_waitcnt lgkmcnt(4)
v_mfma_f32_16x16x32_bf16 v[72:75], a[0:3], a[224:227], 0
buffer_load_dwordx4 a[180:183], v3, s[8:11], s28 offen offset:1024 sc1
v_mfma_f32_16x16x32_bf16 v[72:75], a[4:7], a[228:231], v[72:75]
ds_read_b128 a[216:219], v6 offset:0
v_mfma_f32_16x16x32_bf16 v[76:79], a[72:75], a[224:227], 0
v_mfma_f32_16x16x32_bf16 v[76:79], a[76:79], a[228:231], v[76:79]
ds_read_b128 a[220:223], v6 offset:8192
s_waitcnt lgkmcnt(4)
v_mfma_f32_16x16x32_bf16 v[80:83], a[0:3], a[232:235], 0
buffer_load_dwordx4 a[40:43], v2, s[8:11], s26 offen offset:2048 sc1
v_mfma_f32_16x16x32_bf16 v[80:83], a[4:7], a[236:239], v[80:83]
ds_read_b128 a[224:227], v9 offset:0
v_mfma_f32_16x16x32_bf16 v[84:87], a[72:75], a[232:235], 0
v_mfma_f32_16x16x32_bf16 v[84:87], a[76:79], a[236:239], v[84:87]
ds_read_b128 a[228:231], v9 offset:8192
s_waitcnt lgkmcnt(4)
v_mfma_f32_16x16x32_bf16 v[88:91], a[0:3], a[240:243], 0
buffer_load_dwordx4 a[112:115], v2, s[8:11], s27 offen offset:2048 sc1
v_mfma_f32_16x16x32_bf16 v[88:91], a[4:7], a[244:247], v[88:91]
ds_read_b128 a[232:235], v2 offset:16384
v_mfma_f32_16x16x32_bf16 v[92:95], a[72:75], a[240:243], 0
v_mfma_f32_16x16x32_bf16 v[92:95], a[76:79], a[244:247], v[92:95]
ds_read_b128 a[236:239], v2 offset:24576
s_waitcnt lgkmcnt(4)
v_mfma_f32_16x16x32_bf16 v[96:99], a[216:219], a[144:147], 0
ds_read_b128 a[240:243], v2 offset:17408
buffer_load_dwordx4 a[184:187], v3, s[8:11], s28 offen offset:2048 sc1
v_mfma_f32_16x16x32_bf16 v[96:99], a[220:223], a[148:151], v[96:99]
ds_read_b128 a[244:247], v2 offset:25600
s_waitcnt lgkmcnt(4)
v_mfma_f32_16x16x32_bf16 v[100:103], a[144:147], a[224:227], 0
ds_read_b128 a[216:219], v2 offset:18432
v_mfma_f32_16x16x32_bf16 v[100:103], a[148:151], a[228:231], v[100:103]
ds_read_b128 a[220:223], v2 offset:26624
s_waitcnt vmcnt(21)
s_waitcnt lgkmcnt(4)
v_mfma_f32_16x16x32_bf16 v[32:35], a[232:235], a[8:11], v[32:35]
buffer_load_dwordx4 a[44:47], v2, s[8:11], s26 offen offset:3072 sc1
v_mfma_f32_16x16x32_bf16 v[32:35], a[236:239], a[12:15], v[32:35]
ds_read_b128 a[224:227], v2 offset:19456
v_mfma_f32_16x16x32_bf16 v[36:39], a[232:235], a[80:83], v[36:39]
v_mfma_f32_16x16x32_bf16 v[36:39], a[236:239], a[84:87], v[36:39]
ds_read_b128 a[228:231], v2 offset:27648
s_waitcnt lgkmcnt(4)
v_mfma_f32_16x16x32_bf16 v[40:43], a[240:243], a[8:11], v[40:43]
buffer_load_dwordx4 a[116:119], v2, s[8:11], s27 offen offset:3072 sc1
v_mfma_f32_16x16x32_bf16 v[40:43], a[244:247], a[12:15], v[40:43]
ds_read_b128 a[232:235], v2 offset:20480
v_mfma_f32_16x16x32_bf16 v[44:47], a[240:243], a[80:83], v[44:47]
v_mfma_f32_16x16x32_bf16 v[44:47], a[244:247], a[84:87], v[44:47]
ds_read_b128 a[236:239], v2 offset:28672
s_waitcnt lgkmcnt(4)
v_mfma_f32_16x16x32_bf16 v[48:51], a[216:219], a[8:11], v[48:51]
buffer_load_dwordx4 a[188:191], v3, s[8:11], s28 offen offset:3072 sc1
v_mfma_f32_16x16x32_bf16 v[48:51], a[220:223], a[12:15], v[48:51]
ds_read_b128 a[240:243], v2 offset:21504
v_mfma_f32_16x16x32_bf16 v[52:55], a[216:219], a[80:83], v[52:55]
v_mfma_f32_16x16x32_bf16 v[52:55], a[220:223], a[84:87], v[52:55]
ds_read_b128 a[244:247], v2 offset:29696
s_waitcnt lgkmcnt(4)
v_mfma_f32_16x16x32_bf16 v[56:59], a[224:227], a[8:11], v[56:59]
s_add_u32 s26, s26, 4096
s_add_u32 s27, s27, 4096
s_add_u32 s28, s28, 4096
buffer_load_dwordx4 a[48:51], v2, s[8:11], s26 offen offset:0 sc1
v_mfma_f32_16x16x32_bf16 v[56:59], a[228:231], a[12:15], v[56:59]
ds_read_b128 a[216:219], v2 offset:22528
v_mfma_f32_16x16x32_bf16 v[60:63], a[224:227], a[80:83], v[60:63]
v_mfma_f32_16x16x32_bf16 v[60:63], a[228:231], a[84:87], v[60:63]
ds_read_b128 a[220:223], v2 offset:30720
s_waitcnt lgkmcnt(4)
v_mfma_f32_16x16x32_bf16 v[64:67], a[232:235], a[8:11], v[64:67]
buffer_load_dwordx4 a[120:123], v2, s[8:11], s27 offen offset:0 sc1
v_mfma_f32_16x16x32_bf16 v[64:67], a[236:239], a[12:15], v[64:67]
ds_read_b128 a[224:227], v2 offset:23552
v_mfma_f32_16x16x32_bf16 v[68:71], a[232:235], a[80:83], v[68:71]
v_mfma_f32_16x16x32_bf16 v[68:71], a[236:239], a[84:87], v[68:71]
ds_read_b128 a[228:231], v2 offset:31744
s_waitcnt lgkmcnt(4)
v_mfma_f32_16x16x32_bf16 v[72:75], a[8:11], a[240:243], v[72:75]
buffer_load_dwordx4 a[192:195], v3, s[8:11], s28 offen offset:0 sc1
v_mfma_f32_16x16x32_bf16 v[72:75], a[12:15], a[244:247], v[72:75]
ds_read_b128 a[232:235], v6 offset:16384
v_mfma_f32_16x16x32_bf16 v[76:79], a[80:83], a[240:243], v[76:79]
v_mfma_f32_16x16x32_bf16 v[76:79], a[84:87], a[244:247], v[76:79]
ds_read_b128 a[236:239], v6 offset:24576
s_waitcnt lgkmcnt(4)
v_mfma_f32_16x16x32_bf16 v[80:83], a[8:11], a[216:219], v[80:83]
buffer_load_dwordx4 a[52:55], v2, s[8:11], s26 offen offset:1024 sc1
v_mfma_f32_16x16x32_bf16 v[80:83], a[12:15], a[220:223], v[80:83]
ds_read_b128 a[240:243], v9 offset:16384
v_mfma_f32_16x16x32_bf16 v[84:87], a[80:83], a[216:219], v[84:87]
v_mfma_f32_16x16x32_bf16 v[84:87], a[84:87], a[220:223], v[84:87]
ds_read_b128 a[244:247], v9 offset:24576
s_waitcnt lgkmcnt(4)
v_mfma_f32_16x16x32_bf16 v[88:91], a[8:11], a[224:227], v[88:91]
buffer_load_dwordx4 a[124:127], v2, s[8:11], s27 offen offset:1024 sc1
v_mfma_f32_16x16x32_bf16 v[88:91], a[12:15], a[228:231], v[88:91]
ds_read_b128 a[216:219], v2 offset:32768
v_mfma_f32_16x16x32_bf16 v[92:95], a[80:83], a[224:227], v[92:95]
v_mfma_f32_16x16x32_bf16 v[92:95], a[84:87], a[228:231], v[92:95]
ds_read_b128 a[220:223], v2 offset:40960
s_waitcnt lgkmcnt(4)
v_mfma_f32_16x16x32_bf16 v[96:99], a[232:235], a[152:155], v[96:99]
ds_read_b128 a[224:227], v2 offset:33792
buffer_load_dwordx4 a[196:199], v3, s[8:11], s28 offen offset:1024 sc1
v_mfma_f32_16x16x32_bf16 v[96:99], a[236:239], a[156:159], v[96:99]
ds_read_b128 a[228:231], v2 offset:41984
s_waitcnt lgkmcnt(4)
v_mfma_f32_16x16x32_bf16 v[100:103], a[152:155], a[240:243], v[100:103]
ds_read_b128 a[232:235], v2 offset:34816
v_mfma_f32_16x16x32_bf16 v[100:103], a[156:159], a[244:247], v[100:103]
ds_read_b128 a[236:239], v2 offset:43008
s_waitcnt vmcnt(24)
s_waitcnt lgkmcnt(4)
v_mfma_f32_16x16x32_bf16 v[32:35], a[216:219], a[16:19], v[32:35]
buffer_load_dwordx4 a[56:59], v2, s[8:11], s26 offen offset:2048 sc1
v_mfma_f32_16x16x32_bf16 v[32:35], a[220:223], a[20:23], v[32:35]
ds_read_b128 a[240:243], v2 offset:35840
v_mfma_f32_16x16x32_bf16 v[36:39], a[216:219], a[88:91], v[36:39]
v_mfma_f32_16x16x32_bf16 v[36:39], a[220:223], a[92:95], v[36:39]
ds_read_b128 a[244:247], v2 offset:44032
s_waitcnt lgkmcnt(4)
v_mfma_f32_16x16x32_bf16 v[40:43], a[224:227], a[16:19], v[40:43]
buffer_load_dwordx4 a[128:131], v2, s[8:11], s27 offen offset:2048 sc1
v_mfma_f32_16x16x32_bf16 v[40:43], a[228:231], a[20:23], v[40:43]
ds_read_b128 a[216:219], v2 offset:36864
v_mfma_f32_16x16x32_bf16 v[44:47], a[224:227], a[88:91], v[44:47]
v_mfma_f32_16x16x32_bf16 v[44:47], a[228:231], a[92:95], v[44:47]
ds_read_b128 a[220:223], v2 offset:45056
s_waitcnt lgkmcnt(4)
v_mfma_f32_16x16x32_bf16 v[48:51], a[232:235], a[16:19], v[48:51]
buffer_load_dwordx4 a[200:203], v3, s[8:11], s28 offen offset:2048 sc1
v_mfma_f32_16x16x32_bf16 v[48:51], a[236:239], a[20:23], v[48:51]
ds_read_b128 a[224:227], v2 offset:37888
v_mfma_f32_16x16x32_bf16 v[52:55], a[232:235], a[88:91], v[52:55]
v_mfma_f32_16x16x32_bf16 v[52:55], a[236:239], a[92:95], v[52:55]
ds_read_b128 a[228:231], v2 offset:46080
s_waitcnt lgkmcnt(4)
v_mfma_f32_16x16x32_bf16 v[56:59], a[240:243], a[16:19], v[56:59]
buffer_load_dwordx4 a[60:63], v2, s[8:11], s26 offen offset:3072 sc1
v_mfma_f32_16x16x32_bf16 v[56:59], a[244:247], a[20:23], v[56:59]
ds_read_b128 a[232:235], v2 offset:38912
v_mfma_f32_16x16x32_bf16 v[60:63], a[240:243], a[88:91], v[60:63]
v_mfma_f32_16x16x32_bf16 v[60:63], a[244:247], a[92:95], v[60:63]
ds_read_b128 a[236:239], v2 offset:47104
s_waitcnt lgkmcnt(4)
v_mfma_f32_16x16x32_bf16 v[64:67], a[216:219], a[16:19], v[64:67]
buffer_load_dwordx4 a[132:135], v2, s[8:11], s27 offen offset:3072 sc1
v_mfma_f32_16x16x32_bf16 v[64:67], a[220:223], a[20:23], v[64:67]
ds_read_b128 a[240:243], v2 offset:39936
v_mfma_f32_16x16x32_bf16 v[68:71], a[216:219], a[88:91], v[68:71]
v_mfma_f32_16x16x32_bf16 v[68:71], a[220:223], a[92:95], v[68:71]
ds_read_b128 a[244:247], v2 offset:48128
s_waitcnt lgkmcnt(4)
v_mfma_f32_16x16x32_bf16 v[72:75], a[16:19], a[224:227], v[72:75]
buffer_load_dwordx4 a[204:207], v3, s[8:11], s28 offen offset:3072 sc1
v_mfma_f32_16x16x32_bf16 v[72:75], a[20:23], a[228:231], v[72:75]
ds_read_b128 a[216:219], v6 offset:32768
v_mfma_f32_16x16x32_bf16 v[76:79], a[88:91], a[224:227], v[76:79]
v_mfma_f32_16x16x32_bf16 v[76:79], a[92:95], a[228:231], v[76:79]
ds_read_b128 a[220:223], v6 offset:40960
s_waitcnt lgkmcnt(4)
v_mfma_f32_16x16x32_bf16 v[80:83], a[16:19], a[232:235], v[80:83]
s_add_u32 s26, s26, 4096
s_add_u32 s27, s27, 4096
s_add_u32 s28, s28, 4096
buffer_load_dwordx4 a[64:67], v2, s[8:11], s26 offen offset:0 sc1
v_mfma_f32_16x16x32_bf16 v[80:83], a[20:23], a[236:239], v[80:83]
ds_read_b128 a[224:227], v9 offset:32768
v_mfma_f32_16x16x32_bf16 v[84:87], a[88:91], a[232:235], v[84:87]
v_mfma_f32_16x16x32_bf16 v[84:87], a[92:95], a[236:239], v[84:87]
ds_read_b128 a[228:231], v9 offset:40960
s_waitcnt lgkmcnt(4)
v_mfma_f32_16x16x32_bf16 v[88:91], a[16:19], a[240:243], v[88:91]
buffer_load_dwordx4 a[136:139], v2, s[8:11], s27 offen offset:0 sc1
v_mfma_f32_16x16x32_bf16 v[88:91], a[20:23], a[244:247], v[88:91]
ds_read_b128 a[232:235], v2 offset:49152
v_mfma_f32_16x16x32_bf16 v[92:95], a[88:91], a[240:243], v[92:95]
v_mfma_f32_16x16x32_bf16 v[92:95], a[92:95], a[244:247], v[92:95]
ds_read_b128 a[236:239], v2 offset:57344
s_waitcnt lgkmcnt(4)
v_mfma_f32_16x16x32_bf16 v[96:99], a[216:219], a[160:163], v[96:99]
ds_read_b128 a[240:243], v2 offset:50176
buffer_load_dwordx4 a[208:211], v3, s[8:11], s28 offen offset:0 sc1
v_mfma_f32_16x16x32_bf16 v[96:99], a[220:223], a[164:167], v[96:99]
ds_read_b128 a[244:247], v2 offset:58368
s_waitcnt lgkmcnt(4)
v_mfma_f32_16x16x32_bf16 v[100:103], a[160:163], a[224:227], v[100:103]
ds_read_b128 a[216:219], v2 offset:51200
v_mfma_f32_16x16x32_bf16 v[100:103], a[164:167], a[228:231], v[100:103]
ds_read_b128 a[220:223], v2 offset:59392
s_waitcnt vmcnt(27)
s_waitcnt lgkmcnt(4)
v_mfma_f32_16x16x32_bf16 v[32:35], a[232:235], a[24:27], v[32:35]
buffer_load_dwordx4 a[68:71], v2, s[8:11], s26 offen offset:1024 sc1
v_mfma_f32_16x16x32_bf16 v[32:35], a[236:239], a[28:31], v[32:35]
ds_read_b128 a[224:227], v2 offset:52224
v_mfma_f32_16x16x32_bf16 v[36:39], a[232:235], a[96:99], v[36:39]
v_mfma_f32_16x16x32_bf16 v[36:39], a[236:239], a[100:103], v[36:39]
ds_read_b128 a[228:231], v2 offset:60416
s_waitcnt lgkmcnt(4)
v_mfma_f32_16x16x32_bf16 v[40:43], a[240:243], a[24:27], v[40:43]
buffer_load_dwordx4 a[140:143], v2, s[8:11], s27 offen offset:1024 sc1
v_mfma_f32_16x16x32_bf16 v[40:43], a[244:247], a[28:31], v[40:43]
ds_read_b128 a[232:235], v2 offset:53248
v_mfma_f32_16x16x32_bf16 v[44:47], a[240:243], a[96:99], v[44:47]
v_mfma_f32_16x16x32_bf16 v[44:47], a[244:247], a[100:103], v[44:47]
ds_read_b128 a[236:239], v2 offset:61440
s_waitcnt lgkmcnt(4)
v_mfma_f32_16x16x32_bf16 v[48:51], a[216:219], a[24:27], v[48:51]
buffer_load_dwordx4 a[212:215], v3, s[8:11], s28 offen offset:1024 sc1
v_mfma_f32_16x16x32_bf16 v[48:51], a[220:223], a[28:31], v[48:51]
ds_read_b128 a[240:243], v2 offset:54272
v_mfma_f32_16x16x32_bf16 v[52:55], a[216:219], a[96:99], v[52:55]
v_mfma_f32_16x16x32_bf16 v[52:55], a[220:223], a[100:103], v[52:55]
ds_read_b128 a[244:247], v2 offset:62464
s_waitcnt lgkmcnt(4)
v_mfma_f32_16x16x32_bf16 v[56:59], a[224:227], a[24:27], v[56:59]
v_mfma_f32_16x16x32_bf16 v[56:59], a[228:231], a[28:31], v[56:59]
ds_read_b128 a[216:219], v2 offset:55296
v_mfma_f32_16x16x32_bf16 v[60:63], a[224:227], a[96:99], v[60:63]
v_mfma_f32_16x16x32_bf16 v[60:63], a[228:231], a[100:103], v[60:63]
ds_read_b128 a[220:223], v2 offset:63488
s_waitcnt lgkmcnt(4)
v_mfma_f32_16x16x32_bf16 v[64:67], a[232:235], a[24:27], v[64:67]
v_mfma_f32_16x16x32_bf16 v[64:67], a[236:239], a[28:31], v[64:67]
ds_read_b128 a[224:227], v2 offset:56320
v_mfma_f32_16x16x32_bf16 v[68:71], a[232:235], a[96:99], v[68:71]
v_mfma_f32_16x16x32_bf16 v[68:71], a[236:239], a[100:103], v[68:71]
ds_read_b128 a[228:231], v2 offset:64512
s_waitcnt lgkmcnt(4)
v_mfma_f32_16x16x32_bf16 v[72:75], a[24:27], a[240:243], v[72:75]
v_mfma_f32_16x16x32_bf16 v[72:75], a[28:31], a[244:247], v[72:75]
ds_read_b128 a[232:235], v6 offset:49152
v_mfma_f32_16x16x32_bf16 v[76:79], a[96:99], a[240:243], v[76:79]
v_mfma_f32_16x16x32_bf16 v[76:79], a[100:103], a[244:247], v[76:79]
ds_read_b128 a[236:239], v6 offset:57344
s_waitcnt lgkmcnt(4)
v_mfma_f32_16x16x32_bf16 v[80:83], a[24:27], a[216:219], v[80:83]
v_mfma_f32_16x16x32_bf16 v[80:83], a[28:31], a[220:223], v[80:83]
ds_read_b128 a[240:243], v9 offset:49152
v_mfma_f32_16x16x32_bf16 v[84:87], a[96:99], a[216:219], v[84:87]
v_mfma_f32_16x16x32_bf16 v[84:87], a[100:103], a[220:223], v[84:87]
ds_read_b128 a[244:247], v9 offset:57344
s_waitcnt lgkmcnt(4)
v_mfma_f32_16x16x32_bf16 v[88:91], a[24:27], a[224:227], v[88:91]
v_mfma_f32_16x16x32_bf16 v[88:91], a[28:31], a[228:231], v[88:91]
ds_read_b128 a[216:219], v4 offset:0
v_mfma_f32_16x16x32_bf16 v[92:95], a[96:99], a[224:227], v[92:95]
v_mfma_f32_16x16x32_bf16 v[92:95], a[100:103], a[228:231], v[92:95]
ds_read_b128 a[220:223], v4 offset:8192
s_waitcnt lgkmcnt(4)
v_mfma_f32_16x16x32_bf16 v[96:99], a[232:235], a[168:171], v[96:99]
ds_read_b128 a[224:227], v4 offset:1024
v_mfma_f32_16x16x32_bf16 v[96:99], a[236:239], a[172:175], v[96:99]
ds_read_b128 a[228:231], v4 offset:9216
s_waitcnt lgkmcnt(4)
v_mfma_f32_16x16x32_bf16 v[100:103], a[168:171], a[240:243], v[100:103]
ds_read_b128 a[232:235], v4 offset:2048
v_mfma_f32_16x16x32_bf16 v[100:103], a[172:175], a[244:247], v[100:103]
ds_read_b128 a[236:239], v4 offset:10240
s_waitcnt vmcnt(24)
s_waitcnt lgkmcnt(4)
v_mfma_f32_16x16x32_bf16 v[32:35], a[216:219], a[32:35], v[32:35]
v_mfma_f32_16x16x32_bf16 v[32:35], a[220:223], a[36:39], v[32:35]
ds_read_b128 a[240:243], v4 offset:3072
v_mfma_f32_16x16x32_bf16 v[36:39], a[216:219], a[104:107], v[36:39]
v_mfma_f32_16x16x32_bf16 v[36:39], a[220:223], a[108:111], v[36:39]
ds_read_b128 a[244:247], v4 offset:11264
s_waitcnt lgkmcnt(4)
v_mfma_f32_16x16x32_bf16 v[40:43], a[224:227], a[32:35], v[40:43]
v_mfma_f32_16x16x32_bf16 v[40:43], a[228:231], a[36:39], v[40:43]
ds_read_b128 a[216:219], v4 offset:4096
v_mfma_f32_16x16x32_bf16 v[44:47], a[224:227], a[104:107], v[44:47]
v_mfma_f32_16x16x32_bf16 v[44:47], a[228:231], a[108:111], v[44:47]
ds_read_b128 a[220:223], v4 offset:12288
s_waitcnt lgkmcnt(4)
v_mfma_f32_16x16x32_bf16 v[48:51], a[232:235], a[32:35], v[48:51]
v_mfma_f32_16x16x32_bf16 v[48:51], a[236:239], a[36:39], v[48:51]
ds_read_b128 a[224:227], v4 offset:5120
v_mfma_f32_16x16x32_bf16 v[52:55], a[232:235], a[104:107], v[52:55]
v_mfma_f32_16x16x32_bf16 v[52:55], a[236:239], a[108:111], v[52:55]
ds_read_b128 a[228:231], v4 offset:13312
s_waitcnt lgkmcnt(4)
v_mfma_f32_16x16x32_bf16 v[56:59], a[240:243], a[32:35], v[56:59]
v_mfma_f32_16x16x32_bf16 v[56:59], a[244:247], a[36:39], v[56:59]
ds_read_b128 a[232:235], v4 offset:6144
v_mfma_f32_16x16x32_bf16 v[60:63], a[240:243], a[104:107], v[60:63]
v_mfma_f32_16x16x32_bf16 v[60:63], a[244:247], a[108:111], v[60:63]
ds_read_b128 a[236:239], v4 offset:14336
s_waitcnt lgkmcnt(4)
v_mfma_f32_16x16x32_bf16 v[64:67], a[216:219], a[32:35], v[64:67]
v_mfma_f32_16x16x32_bf16 v[64:67], a[220:223], a[36:39], v[64:67]
ds_read_b128 a[240:243], v4 offset:7168
v_mfma_f32_16x16x32_bf16 v[68:71], a[216:219], a[104:107], v[68:71]
v_mfma_f32_16x16x32_bf16 v[68:71], a[220:223], a[108:111], v[68:71]
ds_read_b128 a[244:247], v4 offset:15360
s_waitcnt lgkmcnt(4)
v_mfma_f32_16x16x32_bf16 v[72:75], a[32:35], a[224:227], v[72:75]
v_mfma_f32_16x16x32_bf16 v[72:75], a[36:39], a[228:231], v[72:75]
ds_read_b128 a[216:219], v7 offset:0
v_mfma_f32_16x16x32_bf16 v[76:79], a[104:107], a[224:227], v[76:79]
v_mfma_f32_16x16x32_bf16 v[76:79], a[108:111], a[228:231], v[76:79]
ds_read_b128 a[220:223], v7 offset:8192
s_waitcnt lgkmcnt(4)
v_mfma_f32_16x16x32_bf16 v[80:83], a[32:35], a[232:235], v[80:83]
v_mfma_f32_16x16x32_bf16 v[80:83], a[36:39], a[236:239], v[80:83]
ds_read_b128 a[224:227], v10 offset:0
v_mfma_f32_16x16x32_bf16 v[84:87], a[104:107], a[232:235], v[84:87]
v_mfma_f32_16x16x32_bf16 v[84:87], a[108:111], a[236:239], v[84:87]
ds_read_b128 a[228:231], v10 offset:8192
s_waitcnt lgkmcnt(4)
v_mfma_f32_16x16x32_bf16 v[88:91], a[32:35], a[240:243], v[88:91]
v_mfma_f32_16x16x32_bf16 v[88:91], a[36:39], a[244:247], v[88:91]
ds_read_b128 a[232:235], v4 offset:16384
v_mfma_f32_16x16x32_bf16 v[92:95], a[104:107], a[240:243], v[92:95]
v_mfma_f32_16x16x32_bf16 v[92:95], a[108:111], a[244:247], v[92:95]
ds_read_b128 a[236:239], v4 offset:24576
s_waitcnt lgkmcnt(4)
v_mfma_f32_16x16x32_bf16 v[96:99], a[216:219], a[176:179], v[96:99]
ds_read_b128 a[240:243], v4 offset:17408
v_mfma_f32_16x16x32_bf16 v[96:99], a[220:223], a[180:183], v[96:99]
ds_read_b128 a[244:247], v4 offset:25600
s_waitcnt lgkmcnt(4)
v_mfma_f32_16x16x32_bf16 v[100:103], a[176:179], a[224:227], v[100:103]
ds_read_b128 a[216:219], v4 offset:18432
v_mfma_f32_16x16x32_bf16 v[100:103], a[180:183], a[228:231], v[100:103]
ds_read_b128 a[220:223], v4 offset:26624
s_waitcnt vmcnt(18)
s_waitcnt lgkmcnt(4)
v_mfma_f32_16x16x32_bf16 v[32:35], a[232:235], a[40:43], v[32:35]
v_mfma_f32_16x16x32_bf16 v[32:35], a[236:239], a[44:47], v[32:35]
ds_read_b128 a[224:227], v4 offset:19456
v_mfma_f32_16x16x32_bf16 v[36:39], a[232:235], a[112:115], v[36:39]
v_mfma_f32_16x16x32_bf16 v[36:39], a[236:239], a[116:119], v[36:39]
ds_read_b128 a[228:231], v4 offset:27648
s_waitcnt lgkmcnt(4)
v_mfma_f32_16x16x32_bf16 v[40:43], a[240:243], a[40:43], v[40:43]
v_mfma_f32_16x16x32_bf16 v[40:43], a[244:247], a[44:47], v[40:43]
ds_read_b128 a[232:235], v4 offset:20480
v_mfma_f32_16x16x32_bf16 v[44:47], a[240:243], a[112:115], v[44:47]
v_mfma_f32_16x16x32_bf16 v[44:47], a[244:247], a[116:119], v[44:47]
ds_read_b128 a[236:239], v4 offset:28672
s_waitcnt lgkmcnt(4)
v_mfma_f32_16x16x32_bf16 v[48:51], a[216:219], a[40:43], v[48:51]
v_mfma_f32_16x16x32_bf16 v[48:51], a[220:223], a[44:47], v[48:51]
ds_read_b128 a[240:243], v4 offset:21504
v_mfma_f32_16x16x32_bf16 v[52:55], a[216:219], a[112:115], v[52:55]
v_mfma_f32_16x16x32_bf16 v[52:55], a[220:223], a[116:119], v[52:55]
ds_read_b128 a[244:247], v4 offset:29696
s_waitcnt lgkmcnt(4)
v_mfma_f32_16x16x32_bf16 v[56:59], a[224:227], a[40:43], v[56:59]
v_mfma_f32_16x16x32_bf16 v[56:59], a[228:231], a[44:47], v[56:59]
ds_read_b128 a[216:219], v4 offset:22528
v_mfma_f32_16x16x32_bf16 v[60:63], a[224:227], a[112:115], v[60:63]
v_mfma_f32_16x16x32_bf16 v[60:63], a[228:231], a[116:119], v[60:63]
ds_read_b128 a[220:223], v4 offset:30720
s_waitcnt lgkmcnt(4)
v_mfma_f32_16x16x32_bf16 v[64:67], a[232:235], a[40:43], v[64:67]
v_mfma_f32_16x16x32_bf16 v[64:67], a[236:239], a[44:47], v[64:67]
ds_read_b128 a[224:227], v4 offset:23552
v_mfma_f32_16x16x32_bf16 v[68:71], a[232:235], a[112:115], v[68:71]
v_mfma_f32_16x16x32_bf16 v[68:71], a[236:239], a[116:119], v[68:71]
ds_read_b128 a[228:231], v4 offset:31744
s_waitcnt lgkmcnt(4)
v_mfma_f32_16x16x32_bf16 v[72:75], a[40:43], a[240:243], v[72:75]
v_mfma_f32_16x16x32_bf16 v[72:75], a[44:47], a[244:247], v[72:75]
ds_read_b128 a[232:235], v7 offset:16384
v_mfma_f32_16x16x32_bf16 v[76:79], a[112:115], a[240:243], v[76:79]
v_mfma_f32_16x16x32_bf16 v[76:79], a[116:119], a[244:247], v[76:79]
ds_read_b128 a[236:239], v7 offset:24576
s_waitcnt lgkmcnt(4)
v_mfma_f32_16x16x32_bf16 v[80:83], a[40:43], a[216:219], v[80:83]
v_mfma_f32_16x16x32_bf16 v[80:83], a[44:47], a[220:223], v[80:83]
ds_read_b128 a[240:243], v10 offset:16384
v_mfma_f32_16x16x32_bf16 v[84:87], a[112:115], a[216:219], v[84:87]
v_mfma_f32_16x16x32_bf16 v[84:87], a[116:119], a[220:223], v[84:87]
ds_read_b128 a[244:247], v10 offset:24576
s_waitcnt lgkmcnt(4)
v_mfma_f32_16x16x32_bf16 v[88:91], a[40:43], a[224:227], v[88:91]
v_mfma_f32_16x16x32_bf16 v[88:91], a[44:47], a[228:231], v[88:91]
ds_read_b128 a[216:219], v4 offset:32768
v_mfma_f32_16x16x32_bf16 v[92:95], a[112:115], a[224:227], v[92:95]
v_mfma_f32_16x16x32_bf16 v[92:95], a[116:119], a[228:231], v[92:95]
ds_read_b128 a[220:223], v4 offset:40960
s_waitcnt lgkmcnt(4)
v_mfma_f32_16x16x32_bf16 v[96:99], a[232:235], a[184:187], v[96:99]
ds_read_b128 a[224:227], v4 offset:33792
v_mfma_f32_16x16x32_bf16 v[96:99], a[236:239], a[188:191], v[96:99]
ds_read_b128 a[228:231], v4 offset:41984
s_waitcnt lgkmcnt(4)
v_mfma_f32_16x16x32_bf16 v[100:103], a[184:187], a[240:243], v[100:103]
ds_read_b128 a[232:235], v4 offset:34816
v_mfma_f32_16x16x32_bf16 v[100:103], a[188:191], a[244:247], v[100:103]
ds_read_b128 a[236:239], v4 offset:43008
s_waitcnt vmcnt(12)
s_waitcnt lgkmcnt(4)
v_mfma_f32_16x16x32_bf16 v[32:35], a[216:219], a[48:51], v[32:35]
v_mfma_f32_16x16x32_bf16 v[32:35], a[220:223], a[52:55], v[32:35]
ds_read_b128 a[240:243], v4 offset:35840
v_mfma_f32_16x16x32_bf16 v[36:39], a[216:219], a[120:123], v[36:39]
v_mfma_f32_16x16x32_bf16 v[36:39], a[220:223], a[124:127], v[36:39]
ds_read_b128 a[244:247], v4 offset:44032
s_waitcnt lgkmcnt(4)
v_mfma_f32_16x16x32_bf16 v[40:43], a[224:227], a[48:51], v[40:43]
v_mfma_f32_16x16x32_bf16 v[40:43], a[228:231], a[52:55], v[40:43]
ds_read_b128 a[216:219], v4 offset:36864
v_mfma_f32_16x16x32_bf16 v[44:47], a[224:227], a[120:123], v[44:47]
v_mfma_f32_16x16x32_bf16 v[44:47], a[228:231], a[124:127], v[44:47]
ds_read_b128 a[220:223], v4 offset:45056
s_waitcnt lgkmcnt(4)
v_mfma_f32_16x16x32_bf16 v[48:51], a[232:235], a[48:51], v[48:51]
v_mfma_f32_16x16x32_bf16 v[48:51], a[236:239], a[52:55], v[48:51]
ds_read_b128 a[224:227], v4 offset:37888
v_mfma_f32_16x16x32_bf16 v[52:55], a[232:235], a[120:123], v[52:55]
v_mfma_f32_16x16x32_bf16 v[52:55], a[236:239], a[124:127], v[52:55]
ds_read_b128 a[228:231], v4 offset:46080
s_waitcnt lgkmcnt(4)
v_mfma_f32_16x16x32_bf16 v[56:59], a[240:243], a[48:51], v[56:59]
v_mfma_f32_16x16x32_bf16 v[56:59], a[244:247], a[52:55], v[56:59]
ds_read_b128 a[232:235], v4 offset:38912
v_mfma_f32_16x16x32_bf16 v[60:63], a[240:243], a[120:123], v[60:63]
v_mfma_f32_16x16x32_bf16 v[60:63], a[244:247], a[124:127], v[60:63]
ds_read_b128 a[236:239], v4 offset:47104
s_waitcnt lgkmcnt(4)
v_mfma_f32_16x16x32_bf16 v[64:67], a[216:219], a[48:51], v[64:67]
v_mfma_f32_16x16x32_bf16 v[64:67], a[220:223], a[52:55], v[64:67]
ds_read_b128 a[240:243], v4 offset:39936
v_mfma_f32_16x16x32_bf16 v[68:71], a[216:219], a[120:123], v[68:71]
v_mfma_f32_16x16x32_bf16 v[68:71], a[220:223], a[124:127], v[68:71]
ds_read_b128 a[244:247], v4 offset:48128
s_waitcnt lgkmcnt(4)
v_mfma_f32_16x16x32_bf16 v[72:75], a[48:51], a[224:227], v[72:75]
v_mfma_f32_16x16x32_bf16 v[72:75], a[52:55], a[228:231], v[72:75]
ds_read_b128 a[216:219], v7 offset:32768
v_mfma_f32_16x16x32_bf16 v[76:79], a[120:123], a[224:227], v[76:79]
v_mfma_f32_16x16x32_bf16 v[76:79], a[124:127], a[228:231], v[76:79]
ds_read_b128 a[220:223], v7 offset:40960
s_waitcnt lgkmcnt(4)
v_mfma_f32_16x16x32_bf16 v[80:83], a[48:51], a[232:235], v[80:83]
v_mfma_f32_16x16x32_bf16 v[80:83], a[52:55], a[236:239], v[80:83]
ds_read_b128 a[224:227], v10 offset:32768
v_mfma_f32_16x16x32_bf16 v[84:87], a[120:123], a[232:235], v[84:87]
v_mfma_f32_16x16x32_bf16 v[84:87], a[124:127], a[236:239], v[84:87]
ds_read_b128 a[228:231], v10 offset:40960
s_waitcnt lgkmcnt(4)
v_mfma_f32_16x16x32_bf16 v[88:91], a[48:51], a[240:243], v[88:91]
v_mfma_f32_16x16x32_bf16 v[88:91], a[52:55], a[244:247], v[88:91]
ds_read_b128 a[232:235], v4 offset:49152
v_mfma_f32_16x16x32_bf16 v[92:95], a[120:123], a[240:243], v[92:95]
v_mfma_f32_16x16x32_bf16 v[92:95], a[124:127], a[244:247], v[92:95]
ds_read_b128 a[236:239], v4 offset:57344
s_waitcnt lgkmcnt(4)
v_mfma_f32_16x16x32_bf16 v[96:99], a[216:219], a[192:195], v[96:99]
ds_read_b128 a[240:243], v4 offset:50176
v_mfma_f32_16x16x32_bf16 v[96:99], a[220:223], a[196:199], v[96:99]
ds_read_b128 a[244:247], v4 offset:58368
s_waitcnt lgkmcnt(4)
v_mfma_f32_16x16x32_bf16 v[100:103], a[192:195], a[224:227], v[100:103]
ds_read_b128 a[216:219], v4 offset:51200
v_mfma_f32_16x16x32_bf16 v[100:103], a[196:199], a[228:231], v[100:103]
ds_read_b128 a[220:223], v4 offset:59392
s_waitcnt vmcnt(6)
s_waitcnt lgkmcnt(4)
v_mfma_f32_16x16x32_bf16 v[32:35], a[232:235], a[56:59], v[32:35]
v_mfma_f32_16x16x32_bf16 v[32:35], a[236:239], a[60:63], v[32:35]
ds_read_b128 a[224:227], v4 offset:52224
v_mfma_f32_16x16x32_bf16 v[36:39], a[232:235], a[128:131], v[36:39]
v_mfma_f32_16x16x32_bf16 v[36:39], a[236:239], a[132:135], v[36:39]
ds_read_b128 a[228:231], v4 offset:60416
s_waitcnt lgkmcnt(4)
v_mfma_f32_16x16x32_bf16 v[40:43], a[240:243], a[56:59], v[40:43]
v_mfma_f32_16x16x32_bf16 v[40:43], a[244:247], a[60:63], v[40:43]
ds_read_b128 a[232:235], v4 offset:53248
v_mfma_f32_16x16x32_bf16 v[44:47], a[240:243], a[128:131], v[44:47]
v_mfma_f32_16x16x32_bf16 v[44:47], a[244:247], a[132:135], v[44:47]
ds_read_b128 a[236:239], v4 offset:61440
s_waitcnt lgkmcnt(4)
v_mfma_f32_16x16x32_bf16 v[48:51], a[216:219], a[56:59], v[48:51]
v_mfma_f32_16x16x32_bf16 v[48:51], a[220:223], a[60:63], v[48:51]
ds_read_b128 a[240:243], v4 offset:54272
v_mfma_f32_16x16x32_bf16 v[52:55], a[216:219], a[128:131], v[52:55]
v_mfma_f32_16x16x32_bf16 v[52:55], a[220:223], a[132:135], v[52:55]
ds_read_b128 a[244:247], v4 offset:62464
s_waitcnt lgkmcnt(4)
v_mfma_f32_16x16x32_bf16 v[56:59], a[224:227], a[56:59], v[56:59]
v_mfma_f32_16x16x32_bf16 v[56:59], a[228:231], a[60:63], v[56:59]
ds_read_b128 a[216:219], v4 offset:55296
v_mfma_f32_16x16x32_bf16 v[60:63], a[224:227], a[128:131], v[60:63]
v_mfma_f32_16x16x32_bf16 v[60:63], a[228:231], a[132:135], v[60:63]
ds_read_b128 a[220:223], v4 offset:63488
s_waitcnt lgkmcnt(4)
v_mfma_f32_16x16x32_bf16 v[64:67], a[232:235], a[56:59], v[64:67]
v_mfma_f32_16x16x32_bf16 v[64:67], a[236:239], a[60:63], v[64:67]
ds_read_b128 a[224:227], v4 offset:56320
v_mfma_f32_16x16x32_bf16 v[68:71], a[232:235], a[128:131], v[68:71]
v_mfma_f32_16x16x32_bf16 v[68:71], a[236:239], a[132:135], v[68:71]
ds_read_b128 a[228:231], v4 offset:64512
s_waitcnt lgkmcnt(4)
v_mfma_f32_16x16x32_bf16 v[72:75], a[56:59], a[240:243], v[72:75]
v_mfma_f32_16x16x32_bf16 v[72:75], a[60:63], a[244:247], v[72:75]
ds_read_b128 a[232:235], v7 offset:49152
v_mfma_f32_16x16x32_bf16 v[76:79], a[128:131], a[240:243], v[76:79]
v_mfma_f32_16x16x32_bf16 v[76:79], a[132:135], a[244:247], v[76:79]
ds_read_b128 a[236:239], v7 offset:57344
s_waitcnt lgkmcnt(4)
v_mfma_f32_16x16x32_bf16 v[80:83], a[56:59], a[216:219], v[80:83]
v_mfma_f32_16x16x32_bf16 v[80:83], a[60:63], a[220:223], v[80:83]
ds_read_b128 a[240:243], v10 offset:49152
v_mfma_f32_16x16x32_bf16 v[84:87], a[128:131], a[216:219], v[84:87]
v_mfma_f32_16x16x32_bf16 v[84:87], a[132:135], a[220:223], v[84:87]
ds_read_b128 a[244:247], v10 offset:57344
s_waitcnt lgkmcnt(4)
v_mfma_f32_16x16x32_bf16 v[88:91], a[56:59], a[224:227], v[88:91]
v_mfma_f32_16x16x32_bf16 v[88:91], a[60:63], a[228:231], v[88:91]
ds_read_b128 a[216:219], v5 offset:0
v_mfma_f32_16x16x32_bf16 v[92:95], a[128:131], a[224:227], v[92:95]
v_mfma_f32_16x16x32_bf16 v[92:95], a[132:135], a[228:231], v[92:95]
ds_read_b128 a[220:223], v5 offset:8192
s_waitcnt lgkmcnt(4)
v_mfma_f32_16x16x32_bf16 v[96:99], a[232:235], a[200:203], v[96:99]
ds_read_b128 a[224:227], v5 offset:1024
v_mfma_f32_16x16x32_bf16 v[96:99], a[236:239], a[204:207], v[96:99]
ds_read_b128 a[228:231], v5 offset:9216
s_waitcnt lgkmcnt(4)
v_mfma_f32_16x16x32_bf16 v[100:103], a[200:203], a[240:243], v[100:103]
ds_read_b128 a[232:235], v5 offset:2048
v_mfma_f32_16x16x32_bf16 v[100:103], a[204:207], a[244:247], v[100:103]
ds_read_b128 a[236:239], v5 offset:10240
s_waitcnt vmcnt(0)
s_waitcnt lgkmcnt(4)
v_mfma_f32_16x16x32_bf16 v[32:35], a[216:219], a[64:67], v[32:35]
v_mfma_f32_16x16x32_bf16 v[32:35], a[220:223], a[68:71], v[32:35]
ds_read_b128 a[240:243], v5 offset:3072
v_mfma_f32_16x16x32_bf16 v[36:39], a[216:219], a[136:139], v[36:39]
v_mfma_f32_16x16x32_bf16 v[36:39], a[220:223], a[140:143], v[36:39]
ds_read_b128 a[244:247], v5 offset:11264
s_waitcnt lgkmcnt(4)
v_mfma_f32_16x16x32_bf16 v[40:43], a[224:227], a[64:67], v[40:43]
v_mfma_f32_16x16x32_bf16 v[40:43], a[228:231], a[68:71], v[40:43]
ds_read_b128 a[216:219], v5 offset:4096
v_mfma_f32_16x16x32_bf16 v[44:47], a[224:227], a[136:139], v[44:47]
v_mfma_f32_16x16x32_bf16 v[44:47], a[228:231], a[140:143], v[44:47]
ds_read_b128 a[220:223], v5 offset:12288
s_waitcnt lgkmcnt(4)
v_mfma_f32_16x16x32_bf16 v[48:51], a[232:235], a[64:67], v[48:51]
v_mfma_f32_16x16x32_bf16 v[48:51], a[236:239], a[68:71], v[48:51]
ds_read_b128 a[224:227], v5 offset:5120
v_mfma_f32_16x16x32_bf16 v[52:55], a[232:235], a[136:139], v[52:55]
v_mfma_f32_16x16x32_bf16 v[52:55], a[236:239], a[140:143], v[52:55]
ds_read_b128 a[228:231], v5 offset:13312
s_waitcnt lgkmcnt(4)
v_mfma_f32_16x16x32_bf16 v[56:59], a[240:243], a[64:67], v[56:59]
v_mfma_f32_16x16x32_bf16 v[56:59], a[244:247], a[68:71], v[56:59]
ds_read_b128 a[232:235], v5 offset:6144
v_mfma_f32_16x16x32_bf16 v[60:63], a[240:243], a[136:139], v[60:63]
v_mfma_f32_16x16x32_bf16 v[60:63], a[244:247], a[140:143], v[60:63]
ds_read_b128 a[236:239], v5 offset:14336
s_waitcnt lgkmcnt(4)
v_mfma_f32_16x16x32_bf16 v[64:67], a[216:219], a[64:67], v[64:67]
v_mfma_f32_16x16x32_bf16 v[64:67], a[220:223], a[68:71], v[64:67]
ds_read_b128 a[240:243], v5 offset:7168
v_mfma_f32_16x16x32_bf16 v[68:71], a[216:219], a[136:139], v[68:71]
v_mfma_f32_16x16x32_bf16 v[68:71], a[220:223], a[140:143], v[68:71]
ds_read_b128 a[244:247], v5 offset:15360
s_waitcnt lgkmcnt(4)
v_mfma_f32_16x16x32_bf16 v[72:75], a[64:67], a[224:227], v[72:75]
v_mfma_f32_16x16x32_bf16 v[72:75], a[68:71], a[228:231], v[72:75]
ds_read_b128 a[216:219], v8 offset:0
v_mfma_f32_16x16x32_bf16 v[76:79], a[136:139], a[224:227], v[76:79]
v_mfma_f32_16x16x32_bf16 v[76:79], a[140:143], a[228:231], v[76:79]
ds_read_b128 a[220:223], v8 offset:8192
s_waitcnt lgkmcnt(4)
v_mfma_f32_16x16x32_bf16 v[80:83], a[64:67], a[232:235], v[80:83]
v_mfma_f32_16x16x32_bf16 v[80:83], a[68:71], a[236:239], v[80:83]
ds_read_b128 a[224:227], v11 offset:0
v_mfma_f32_16x16x32_bf16 v[84:87], a[136:139], a[232:235], v[84:87]
v_mfma_f32_16x16x32_bf16 v[84:87], a[140:143], a[236:239], v[84:87]
ds_read_b128 a[228:231], v11 offset:8192
s_waitcnt lgkmcnt(4)
v_mfma_f32_16x16x32_bf16 v[88:91], a[64:67], a[240:243], v[88:91]
v_mfma_f32_16x16x32_bf16 v[88:91], a[68:71], a[244:247], v[88:91]
v_mfma_f32_16x16x32_bf16 v[92:95], a[136:139], a[240:243], v[92:95]
v_mfma_f32_16x16x32_bf16 v[92:95], a[140:143], a[244:247], v[92:95]
s_waitcnt lgkmcnt(2)
v_mfma_f32_16x16x32_bf16 v[96:99], a[216:219], a[208:211], v[96:99]
v_mfma_f32_16x16x32_bf16 v[96:99], a[220:223], a[212:215], v[96:99]
s_waitcnt lgkmcnt(0)
v_mfma_f32_16x16x32_bf16 v[100:103], a[208:211], a[224:227], v[100:103]
v_mfma_f32_16x16x32_bf16 v[100:103], a[212:215], a[228:231], v[100:103]
s_branch L_att
L_last:
s_cmp_eq_u32 s4, 3
s_cbranch_scc1 L_epoch
v_and_b32 v6, 7, v1
v_lshrrev_b32 v7, 3, v1
s_mul_i32 s22, s4, 24
v_add_u32 v7, s22, v7
s_and_b32 s23, s6, 1
s_lshl_b32 s23, s23, 3
v_add_u32 v8, s23, v6
v_lshlrev_b32 v8, 4, v8
v_lshl_add_u32 v4, v7, 8, v8
s_lshl_b32 s24, s5, 4
s_lshr_b32 s25, s6, 1
s_add_u32 s24, s24, s25
s_mul_i32 s20, s24, 18432
s_lshl_b32 s24, s5, 8
s_lshl_b32 s25, s6, 3
s_add_u32 s24, s24, s25
s_and_b32 s25, s24, 1023
s_lshl_b32 s25, s25, 1
s_lshr_b32 s24, s24, 10
s_add_u32 s24, s24, s25
s_mul_i32 s21, s24, 1152
v_mul_u32_u24 v8, 2304, v6
v_lshl_add_u32 v5, v7, 4, v8
s_load_dwordx2 s[12:13], s[0:1], 56
s_waitcnt lgkmcnt(0)
s_mov_b32 s16, s12
s_and_b32 s17, s13, 0xffff
s_mov_b32 s18, 2359296
s_mov_b32 s19, 0x20000
s_add_u32 s24, s20, 39776256
s_add_u32 s25, s24, 4096
buffer_load_dwordx4 v[16:19], v4, s[8:11], s24 offen offset:0 sc1
buffer_load_dwordx4 v[20:23], v4, s[8:11], s24 offen offset:2048 sc1
buffer_load_dwordx4 v[24:27], v4, s[8:11], s25 offen offset:0 sc1
s_lshl_b32 s24, s5, 2
s_lshr_b32 s25, s6, 3
s_add_u32 s24, s24, s25
s_lshl_b32 s24, s24, 12
s_add_u32 s24, s24, 1703936
v_and_b32 v6, 31, v1
v_lshlrev_b32 v6, 7, v6
s_mov_b32 s52, 0
L_poll7:
buffer_load_dwordx2 v[14:15], v6, s[8:11], s24 offen sc1
s_add_u32 s52, s52, 1
s_waitcnt vmcnt(0)
v_cmp_ne_u64 vcc, s[68:69], v[14:15]
s_cmp_ge_u32 s52, 0x100000
s_cbranch_scc1 L_got7
s_and_b64 exec, exec, vcc
s_cbranch_execnz L_poll7
L_got7:
s_mov_b64 exec, -1
s_add_u32 s24, s20, 99020800
s_add_u32 s25, s24, 4096
buffer_load_dwordx4 v[28:31], v4, s[8:11], s24 offen offset:0 sc1
buffer_load_dwordx4 v[32:35], v4, s[8:11], s24 offen offset:2048 sc1
buffer_load_dwordx4 v[36:39], v4, s[8:11], s25 offen offset:0 sc1
s_add_u32 s24, s20, 101380096
s_add_u32 s25, s24, 4096
buffer_load_dwordx4 v[40:43], v4, s[8:11], s24 offen offset:0 sc1
buffer_load_dwordx4 v[44:47], v4, s[8:11], s24 offen offset:2048 sc1
buffer_load_dwordx4 v[48:51], v4, s[8:11], s25 offen offset:0 sc1
s_add_u32 s24, s20, 103739392
s_add_u32 s25, s24, 4096
buffer_load_dwordx4 v[52:55], v4, s[8:11], s24 offen offset:0 sc1
buffer_load_dwordx4 v[56:59], v4, s[8:11], s24 offen offset:2048 sc1
buffer_load_dwordx4 v[60:63], v4, s[8:11], s25 offen offset:0 sc1
s_add_u32 s24, s20, 106098688
s_add_u32 s25, s24, 4096
buffer_load_dwordx4 v[64:67], v4, s[8:11], s24 offen offset:0 sc1
buffer_load_dwordx4 v[68:71], v4, s[8:11], s24 offen offset:2048 sc1
buffer_load_dwordx4 v[72:75], v4, s[8:11], s25 offen offset:0 sc1
s_add_u32 s24, s20, 108457984
s_add_u32 s25, s24, 4096
buffer_load_dwordx4 v[76:79], v4, s[8:11], s24 offen offset:0 sc1
buffer_load_dwordx4 v[80:83], v4, s[8:11], s24 offen offset:2048 sc1
buffer_load_dwordx4 v[84:87], v4, s[8:11], s25 offen offset:0 sc1
s_add_u32 s24, s20, 110817280
s_add_u32 s25, s24, 4096
buffer_load_dwordx4 v[88:91], v4, s[8:11], s24 offen offset:0 sc1
buffer_load_dwordx4 v[92:95], v4, s[8:11], s24 offen offset:2048 sc1
buffer_load_dwordx4 v[96:99], v4, s[8:11], s25 offen offset:0 sc1
s_add_u32 s24, s20, 113176576
s_add_u32 s25, s24, 4096
buffer_load_dwordx4 v[100:103], v4, s[8:11], s24 offen offset:0 sc1
buffer_load_dwordx4 v[104:107], v4, s[8:11], s24 offen offset:2048 sc1
buffer_load_dwordx4 v[108:111], v4, s[8:11], s25 offen offset:0 sc1
s_add_u32 s24, s20, 115535872
s_add_u32 s25, s24, 4096
buffer_load_dwordx4 v[112:115], v4, s[8:11], s24 offen offset:0 sc1
buffer_load_dwordx4 v[116:119], v4, s[8:11], s24 offen offset:2048 sc1
buffer_load_dwordx4 v[120:123], v4, s[8:11], s25 offen offset:0 sc1
s_waitcnt vmcnt(26)
v_lshlrev_b32 v128, 16, v16
v_and_b32 v129, 0xffff0000, v16
v_lshlrev_b32 v130, 16, v17
v_and_b32 v131, 0xffff0000, v17
v_lshlrev_b32 v132, 16, v18
v_and_b32 v133, 0xffff0000, v18
v_lshlrev_b32 v134, 16, v19
v_and_b32 v135, 0xffff0000, v19
s_waitcnt vmcnt(25)
v_lshlrev_b32 v136, 16, v20
v_and_b32 v137, 0xffff0000, v20
v_lshlrev_b32 v138, 16, v21
v_and_b32 v139, 0xffff0000, v21
v_lshlrev_b32 v140, 16, v22
v_and_b32 v141, 0xffff0000, v22
v_lshlrev_b32 v142, 16, v23
v_and_b32 v143, 0xffff0000, v23
s_waitcnt vmcnt(24)
v_lshlrev_b32 v144, 16, v24
v_and_b32 v145, 0xffff0000, v24
v_lshlrev_b32 v146, 16, v25
v_and_b32 v147, 0xffff0000, v25
v_lshlrev_b32 v148, 16, v26
v_and_b32 v149, 0xffff0000, v26
v_lshlrev_b32 v150, 16, v27
v_and_b32 v151, 0xffff0000, v27
s_waitcnt vmcnt(23)
v_lshlrev_b32 v6, 16, v28
v_and_b32 v7, 0xffff0000, v28
v_add_f32 v128, v128, v6
v_add_f32 v129, v129, v7
v_lshlrev_b32 v8, 16, v29
v_and_b32 v9, 0xffff0000, v29
v_add_f32 v130, v130, v8
v_add_f32 v131, v131, v9
v_lshlrev_b32 v6, 16, v30
v_and_b32 v7, 0xffff0000, v30
v_add_f32 v132, v132, v6
v_add_f32 v133, v133, v7
v_lshlrev_b32 v8, 16, v31
v_and_b32 v9, 0xffff0000, v31
v_add_f32 v134, v134, v8
v_add_f32 v135, v135, v9
s_waitcnt vmcnt(22)
v_lshlrev_b32 v6, 16, v32
v_and_b32 v7, 0xffff0000, v32
v_add_f32 v136, v136, v6
v_add_f32 v137, v137, v7
v_lshlrev_b32 v8, 16, v33
v_and_b32 v9, 0xffff0000, v33
v_add_f32 v138, v138, v8
v_add_f32 v139, v139, v9
v_lshlrev_b32 v6, 16, v34
v_and_b32 v7, 0xffff0000, v34
v_add_f32 v140, v140, v6
v_add_f32 v141, v141, v7
v_lshlrev_b32 v8, 16, v35
v_and_b32 v9, 0xffff0000, v35
v_add_f32 v142, v142, v8
v_add_f32 v143, v143, v9
s_waitcnt vmcnt(21)
v_lshlrev_b32 v6, 16, v36
v_and_b32 v7, 0xffff0000, v36
v_add_f32 v144, v144, v6
v_add_f32 v145, v145, v7
v_lshlrev_b32 v8, 16, v37
v_and_b32 v9, 0xffff0000, v37
v_add_f32 v146, v146, v8
v_add_f32 v147, v147, v9
v_lshlrev_b32 v6, 16, v38
v_and_b32 v7, 0xffff0000, v38
v_add_f32 v148, v148, v6
v_add_f32 v149, v149, v7
v_lshlrev_b32 v8, 16, v39
v_and_b32 v9, 0xffff0000, v39
v_add_f32 v150, v150, v8
v_add_f32 v151, v151, v9
s_waitcnt vmcnt(20)
v_lshlrev_b32 v6, 16, v40
v_and_b32 v7, 0xffff0000, v40
v_add_f32 v128, v128, v6
v_add_f32 v129, v129, v7
v_lshlrev_b32 v8, 16, v41
v_and_b32 v9, 0xffff0000, v41
v_add_f32 v130, v130, v8
v_add_f32 v131, v131, v9
v_lshlrev_b32 v6, 16, v42
v_and_b32 v7, 0xffff0000, v42
v_add_f32 v132, v132, v6
v_add_f32 v133, v133, v7
v_lshlrev_b32 v8, 16, v43
v_and_b32 v9, 0xffff0000, v43
v_add_f32 v134, v134, v8
v_add_f32 v135, v135, v9
s_waitcnt vmcnt(19)
v_lshlrev_b32 v6, 16, v44
v_and_b32 v7, 0xffff0000, v44
v_add_f32 v136, v136, v6
v_add_f32 v137, v137, v7
v_lshlrev_b32 v8, 16, v45
v_and_b32 v9, 0xffff0000, v45
v_add_f32 v138, v138, v8
v_add_f32 v139, v139, v9
v_lshlrev_b32 v6, 16, v46
v_and_b32 v7, 0xffff0000, v46
v_add_f32 v140, v140, v6
v_add_f32 v141, v141, v7
v_lshlrev_b32 v8, 16, v47
v_and_b32 v9, 0xffff0000, v47
v_add_f32 v142, v142, v8
v_add_f32 v143, v143, v9
s_waitcnt vmcnt(18)
v_lshlrev_b32 v6, 16, v48
v_and_b32 v7, 0xffff0000, v48
v_add_f32 v144, v144, v6
v_add_f32 v145, v145, v7
v_lshlrev_b32 v8, 16, v49
v_and_b32 v9, 0xffff0000, v49
v_add_f32 v146, v146, v8
v_add_f32 v147, v147, v9
v_lshlrev_b32 v6, 16, v50
v_and_b32 v7, 0xffff0000, v50
v_add_f32 v148, v148, v6
v_add_f32 v149, v149, v7
v_lshlrev_b32 v8, 16, v51
v_and_b32 v9, 0xffff0000, v51
v_add_f32 v150, v150, v8
v_add_f32 v151, v151, v9
s_waitcnt vmcnt(17)
v_lshlrev_b32 v6, 16, v52
v_and_b32 v7, 0xffff0000, v52
v_add_f32 v128, v128, v6
v_add_f32 v129, v129, v7
v_lshlrev_b32 v8, 16, v53
v_and_b32 v9, 0xffff0000, v53
v_add_f32 v130, v130, v8
v_add_f32 v131, v131, v9
v_lshlrev_b32 v6, 16, v54
v_and_b32 v7, 0xffff0000, v54
v_add_f32 v132, v132, v6
v_add_f32 v133, v133, v7
v_lshlrev_b32 v8, 16, v55
v_and_b32 v9, 0xffff0000, v55
v_add_f32 v134, v134, v8
v_add_f32 v135, v135, v9
s_waitcnt vmcnt(16)
v_lshlrev_b32 v6, 16, v56
v_and_b32 v7, 0xffff0000, v56
v_add_f32 v136, v136, v6
v_add_f32 v137, v137, v7
v_lshlrev_b32 v8, 16, v57
v_and_b32 v9, 0xffff0000, v57
v_add_f32 v138, v138, v8
v_add_f32 v139, v139, v9
v_lshlrev_b32 v6, 16, v58
v_and_b32 v7, 0xffff0000, v58
v_add_f32 v140, v140, v6
v_add_f32 v141, v141, v7
v_lshlrev_b32 v8, 16, v59
v_and_b32 v9, 0xffff0000, v59
v_add_f32 v142, v142, v8
v_add_f32 v143, v143, v9
s_waitcnt vmcnt(15)
v_lshlrev_b32 v6, 16, v60
v_and_b32 v7, 0xffff0000, v60
v_add_f32 v144, v144, v6
v_add_f32 v145, v145, v7
v_lshlrev_b32 v8, 16, v61
v_and_b32 v9, 0xffff0000, v61
v_add_f32 v146, v146, v8
v_add_f32 v147, v147, v9
v_lshlrev_b32 v6, 16, v62
v_and_b32 v7, 0xffff0000, v62
v_add_f32 v148, v148, v6
v_add_f32 v149, v149, v7
v_lshlrev_b32 v8, 16, v63
v_and_b32 v9, 0xffff0000, v63
v_add_f32 v150, v150, v8
v_add_f32 v151, v151, v9
s_waitcnt vmcnt(14)
v_lshlrev_b32 v6, 16, v64
v_and_b32 v7, 0xffff0000, v64
v_add_f32 v128, v128, v6
v_add_f32 v129, v129, v7
v_lshlrev_b32 v8, 16, v65
v_and_b32 v9, 0xffff0000, v65
v_add_f32 v130, v130, v8
v_add_f32 v131, v131, v9
v_lshlrev_b32 v6, 16, v66
v_and_b32 v7, 0xffff0000, v66
v_add_f32 v132, v132, v6
v_add_f32 v133, v133, v7
v_lshlrev_b32 v8, 16, v67
v_and_b32 v9, 0xffff0000, v67
v_add_f32 v134, v134, v8
v_add_f32 v135, v135, v9
s_waitcnt vmcnt(13)
v_lshlrev_b32 v6, 16, v68
v_and_b32 v7, 0xffff0000, v68
v_add_f32 v136, v136, v6
v_add_f32 v137, v137, v7
v_lshlrev_b32 v8, 16, v69
v_and_b32 v9, 0xffff0000, v69
v_add_f32 v138, v138, v8
v_add_f32 v139, v139, v9
v_lshlrev_b32 v6, 16, v70
v_and_b32 v7, 0xffff0000, v70
v_add_f32 v140, v140, v6
v_add_f32 v141, v141, v7
v_lshlrev_b32 v8, 16, v71
v_and_b32 v9, 0xffff0000, v71
v_add_f32 v142, v142, v8
v_add_f32 v143, v143, v9
s_waitcnt vmcnt(12)
v_lshlrev_b32 v6, 16, v72
v_and_b32 v7, 0xffff0000, v72
v_add_f32 v144, v144, v6
v_add_f32 v145, v145, v7
v_lshlrev_b32 v8, 16, v73
v_and_b32 v9, 0xffff0000, v73
v_add_f32 v146, v146, v8
v_add_f32 v147, v147, v9
v_lshlrev_b32 v6, 16, v74
v_and_b32 v7, 0xffff0000, v74
v_add_f32 v148, v148, v6
v_add_f32 v149, v149, v7
v_lshlrev_b32 v8, 16, v75
v_and_b32 v9, 0xffff0000, v75
v_add_f32 v150, v150, v8
v_add_f32 v151, v151, v9
s_waitcnt vmcnt(11)
v_lshlrev_b32 v6, 16, v76
v_and_b32 v7, 0xffff0000, v76
v_add_f32 v128, v128, v6
v_add_f32 v129, v129, v7
v_lshlrev_b32 v8, 16, v77
v_and_b32 v9, 0xffff0000, v77
v_add_f32 v130, v130, v8
v_add_f32 v131, v131, v9
v_lshlrev_b32 v6, 16, v78
v_and_b32 v7, 0xffff0000, v78
v_add_f32 v132, v132, v6
v_add_f32 v133, v133, v7
v_lshlrev_b32 v8, 16, v79
v_and_b32 v9, 0xffff0000, v79
v_add_f32 v134, v134, v8
v_add_f32 v135, v135, v9
s_waitcnt vmcnt(10)
v_lshlrev_b32 v6, 16, v80
v_and_b32 v7, 0xffff0000, v80
v_add_f32 v136, v136, v6
v_add_f32 v137, v137, v7
v_lshlrev_b32 v8, 16, v81
v_and_b32 v9, 0xffff0000, v81
v_add_f32 v138, v138, v8
v_add_f32 v139, v139, v9
v_lshlrev_b32 v6, 16, v82
v_and_b32 v7, 0xffff0000, v82
v_add_f32 v140, v140, v6
v_add_f32 v141, v141, v7
v_lshlrev_b32 v8, 16, v83
v_and_b32 v9, 0xffff0000, v83
v_add_f32 v142, v142, v8
v_add_f32 v143, v143, v9
s_waitcnt vmcnt(9)
v_lshlrev_b32 v6, 16, v84
v_and_b32 v7, 0xffff0000, v84
v_add_f32 v144, v144, v6
v_add_f32 v145, v145, v7
v_lshlrev_b32 v8, 16, v85
v_and_b32 v9, 0xffff0000, v85
v_add_f32 v146, v146, v8
v_add_f32 v147, v147, v9
v_lshlrev_b32 v6, 16, v86
v_and_b32 v7, 0xffff0000, v86
v_add_f32 v148, v148, v6
v_add_f32 v149, v149, v7
v_lshlrev_b32 v8, 16, v87
v_and_b32 v9, 0xffff0000, v87
v_add_f32 v150, v150, v8
v_add_f32 v151, v151, v9
s_waitcnt vmcnt(8)
v_lshlrev_b32 v6, 16, v88
v_and_b32 v7, 0xffff0000, v88
v_add_f32 v128, v128, v6
v_add_f32 v129, v129, v7
v_lshlrev_b32 v8, 16, v89
v_and_b32 v9, 0xffff0000, v89
v_add_f32 v130, v130, v8
v_add_f32 v131, v131, v9
v_lshlrev_b32 v6, 16, v90
v_and_b32 v7, 0xffff0000, v90
v_add_f32 v132, v132, v6
v_add_f32 v133, v133, v7
v_lshlrev_b32 v8, 16, v91
v_and_b32 v9, 0xffff0000, v91
v_add_f32 v134, v134, v8
v_add_f32 v135, v135, v9
s_waitcnt vmcnt(7)
v_lshlrev_b32 v6, 16, v92
v_and_b32 v7, 0xffff0000, v92
v_add_f32 v136, v136, v6
v_add_f32 v137, v137, v7
v_lshlrev_b32 v8, 16, v93
v_and_b32 v9, 0xffff0000, v93
v_add_f32 v138, v138, v8
v_add_f32 v139, v139, v9
v_lshlrev_b32 v6, 16, v94
v_and_b32 v7, 0xffff0000, v94
v_add_f32 v140, v140, v6
v_add_f32 v141, v141, v7
v_lshlrev_b32 v8, 16, v95
v_and_b32 v9, 0xffff0000, v95
v_add_f32 v142, v142, v8
v_add_f32 v143, v143, v9
s_waitcnt vmcnt(6)
v_lshlrev_b32 v6, 16, v96
v_and_b32 v7, 0xffff0000, v96
v_add_f32 v144, v144, v6
v_add_f32 v145, v145, v7
v_lshlrev_b32 v8, 16, v97
v_and_b32 v9, 0xffff0000, v97
v_add_f32 v146, v146, v8
v_add_f32 v147, v147, v9
v_lshlrev_b32 v6, 16, v98
v_and_b32 v7, 0xffff0000, v98
v_add_f32 v148, v148, v6
v_add_f32 v149, v149, v7
v_lshlrev_b32 v8, 16, v99
v_and_b32 v9, 0xffff0000, v99
v_add_f32 v150, v150, v8
v_add_f32 v151, v151, v9
s_waitcnt vmcnt(5)
v_lshlrev_b32 v6, 16, v100
v_and_b32 v7, 0xffff0000, v100
v_add_f32 v128, v128, v6
v_add_f32 v129, v129, v7
v_lshlrev_b32 v8, 16, v101
v_and_b32 v9, 0xffff0000, v101
v_add_f32 v130, v130, v8
v_add_f32 v131, v131, v9
v_lshlrev_b32 v6, 16, v102
v_and_b32 v7, 0xffff0000, v102
v_add_f32 v132, v132, v6
v_add_f32 v133, v133, v7
v_lshlrev_b32 v8, 16, v103
v_and_b32 v9, 0xffff0000, v103
v_add_f32 v134, v134, v8
v_add_f32 v135, v135, v9
s_waitcnt vmcnt(4)
v_lshlrev_b32 v6, 16, v104
v_and_b32 v7, 0xffff0000, v104
v_add_f32 v136, v136, v6
v_add_f32 v137, v137, v7
v_lshlrev_b32 v8, 16, v105
v_and_b32 v9, 0xffff0000, v105
v_add_f32 v138, v138, v8
v_add_f32 v139, v139, v9
v_lshlrev_b32 v6, 16, v106
v_and_b32 v7, 0xffff0000, v106
v_add_f32 v140, v140, v6
v_add_f32 v141, v141, v7
v_lshlrev_b32 v8, 16, v107
v_and_b32 v9, 0xffff0000, v107
v_add_f32 v142, v142, v8
v_add_f32 v143, v143, v9
s_waitcnt vmcnt(3)
v_lshlrev_b32 v6, 16, v108
v_and_b32 v7, 0xffff0000, v108
v_add_f32 v144, v144, v6
v_add_f32 v145, v145, v7
v_lshlrev_b32 v8, 16, v109
v_and_b32 v9, 0xffff0000, v109
v_add_f32 v146, v146, v8
v_add_f32 v147, v147, v9
v_lshlrev_b32 v6, 16, v110
v_and_b32 v7, 0xffff0000, v110
v_add_f32 v148, v148, v6
v_add_f32 v149, v149, v7
v_lshlrev_b32 v8, 16, v111
v_and_b32 v9, 0xffff0000, v111
v_add_f32 v150, v150, v8
v_add_f32 v151, v151, v9
s_waitcnt vmcnt(2)
v_lshlrev_b32 v6, 16, v112
v_and_b32 v7, 0xffff0000, v112
v_add_f32 v128, v128, v6
v_add_f32 v129, v129, v7
v_lshlrev_b32 v8, 16, v113
v_and_b32 v9, 0xffff0000, v113
v_add_f32 v130, v130, v8
v_add_f32 v131, v131, v9
v_lshlrev_b32 v6, 16, v114
v_and_b32 v7, 0xffff0000, v114
v_add_f32 v132, v132, v6
v_add_f32 v133, v133, v7
v_lshlrev_b32 v8, 16, v115
v_and_b32 v9, 0xffff0000, v115
v_add_f32 v134, v134, v8
v_add_f32 v135, v135, v9
s_waitcnt vmcnt(1)
v_lshlrev_b32 v6, 16, v116
v_and_b32 v7, 0xffff0000, v116
v_add_f32 v136, v136, v6
v_add_f32 v137, v137, v7
v_lshlrev_b32 v8, 16, v117
v_and_b32 v9, 0xffff0000, v117
v_add_f32 v138, v138, v8
v_add_f32 v139, v139, v9
v_lshlrev_b32 v6, 16, v118
v_and_b32 v7, 0xffff0000, v118
v_add_f32 v140, v140, v6
v_add_f32 v141, v141, v7
v_lshlrev_b32 v8, 16, v119
v_and_b32 v9, 0xffff0000, v119
v_add_f32 v142, v142, v8
v_add_f32 v143, v143, v9
s_waitcnt vmcnt(0)
v_lshlrev_b32 v6, 16, v120
v_and_b32 v7, 0xffff0000, v120
v_add_f32 v144, v144, v6
v_add_f32 v145, v145, v7
v_lshlrev_b32 v8, 16, v121
v_and_b32 v9, 0xffff0000, v121
v_add_f32 v146, v146, v8
v_add_f32 v147, v147, v9
v_lshlrev_b32 v6, 16, v122
v_and_b32 v7, 0xffff0000, v122
v_add_f32 v148, v148, v6
v_add_f32 v149, v149, v7
v_lshlrev_b32 v8, 16, v123
v_and_b32 v9, 0xffff0000, v123
v_add_f32 v150, v150, v8
v_add_f32 v151, v151, v9
v_cvt_pk_bf16_f32 v152, v128, v129
v_cvt_pk_bf16_f32 v153, v130, v131
v_cvt_pk_bf16_f32 v154, v132, v133
v_cvt_pk_bf16_f32 v155, v134, v135
v_cvt_pk_bf16_f32 v156, v136, v137
v_cvt_pk_bf16_f32 v157, v138, v139
v_cvt_pk_bf16_f32 v158, v140, v141
v_cvt_pk_bf16_f32 v159, v142, v143
v_cvt_pk_bf16_f32 v160, v144, v145
v_cvt_pk_bf16_f32 v161, v146, v147
v_cvt_pk_bf16_f32 v162, v148, v149
v_cvt_pk_bf16_f32 v163, v150, v151
buffer_store_dwordx4 v[152:155], v5, s[16:19], s21 offen offset:0
buffer_store_dwordx4 v[156:159], v5, s[16:19], s21 offen offset:128
buffer_store_dwordx4 v[160:163], v5, s[16:19], s21 offen offset:256
L_end:
s_endpgm
L_f_slow1:
s_mov_b32 s52, 0
L_f_spin1:
buffer_load_dwordx2 v[14:15], v11, s[8:11], s23 offen sc1
s_add_u32 s52, s52, 1
s_waitcnt vmcnt(0)
v_cmp_eq_u64 vcc, s[68:69], v[14:15]
s_cmp_gt_u32 s52, 0x100000
s_cbranch_scc1 L_f_back1
s_cmp_eq_u64 vcc, exec
s_cbranch_scc0 L_f_spin1
s_branch L_f_back1
L_f_slow2:
s_mov_b32 s52, 0
L_f_spin2:
buffer_load_dwordx2 v[14:15], v11, s[8:11], s23 offen sc1
s_add_u32 s52, s52, 1
s_waitcnt vmcnt(0)
v_cmp_eq_u64 vcc, s[68:69], v[14:15]
s_cmp_gt_u32 s52, 0x100000
s_cbranch_scc1 L_f_back2
s_cmp_eq_u64 vcc, exec
s_cbranch_scc0 L_f_spin2
s_branch L_f_back2
L_f_slow3:
s_mov_b32 s52, 0
L_f_spin3:
buffer_load_dwordx2 v[14:15], v11, s[8:11], s23 offen sc1
s_add_u32 s52, s52, 1
s_waitcnt vmcnt(0)
v_cmp_eq_u64 vcc, s[68:69], v[14:15]
s_cmp_gt_u32 s52, 0x100000
s_cbranch_scc1 L_f_back3
s_cmp_eq_u64 vcc, exec
s_cbranch_scc0 L_f_spin3
s_branch L_f_back3
L_epoch:
s_cmp_lg_u32 s2, 0
s_cbranch_scc1 L_end
s_load_dwordx2 s[12:13], s[0:1], 64
s_waitcnt lgkmcnt(0)
s_mov_b32 s44, s12
s_and_b32 s45, s13, 0xffff
s_mov_b32 s46, 256
s_mov_b32 s47, 0x20000
v_mov_b32 v3, 0
s_mov_b32 s52, 0
L_ep:
buffer_load_dword v4, v3, s[44:47], 0 offen sc1
s_add_u32 s52, s52, 1
s_waitcnt vmcnt(0)
v_readfirstlane_b32 s40, v4
s_cmp_ge_u32 s52, 0x100000
s_cbranch_scc1 L_end
s_cmp_lt_u32 s40, 256
s_cbranch_scc1 L_ep
s_mov_b32 s40, 4194304
v_mov_b32 v13, 2146435072
v_cmp_eq_u32 vcc, 0, v1
v_mov_b32 v14, s68
v_mov_b32 v15, s69
v_cndmask_b32 v13, v13, 0, vcc
buffer_store_dwordx2 v[14:15], v13, s[8:11], s40 offen sc1
s_branch L_end
L_code_end:
s_endpgm
.section .rodata,"a"
.p2align 6
.amdhsa_kernel interleave_layers__sliding_local_dilated__glu_gated_geglu__prompt_kernel
  .amdhsa_next_free_vgpr 512
  .amdhsa_next_free_sgpr 102
  .amdhsa_accum_offset 256
  .amdhsa_group_segment_fixed_size 0
  .amdhsa_kernarg_size 80
  .amdhsa_user_sgpr_count 2
  .amdhsa_user_sgpr_kernarg_segment_ptr 1
  .amdhsa_system_sgpr_workgroup_id_x 1
.end_amdhsa_kernel
```

```asm
; @launch grid=(256,1,1) block=(256,1,1) lds=160768
.amdgcn_target "amdgcn-amd-amdhsa--gfx950"
.text
.p2align 8
.globl interleave_layers__sliding_local_dilated__glu_gated_geglu__prompt_kernel
.type interleave_layers__sliding_local_dilated__glu_gated_geglu__prompt_kernel,@function
interleave_layers__sliding_local_dilated__glu_gated_geglu__prompt_kernel:
s_cmp_ge_u32 s2, 256
s_cbranch_scc1 L_end
s_getpc_b64 s[40:41]
L_warm_pc:
s_lshr_b32 s42, s2, 3
s_lshl_b32 s42, s42, 11
v_lshlrev_b32 v10, 3, v0
v_add_u32 v10, s42, v10
v_min_u32 v10, L_code_end - L_warm_pc - 8, v10
v_mov_b32 v11, s41
v_add_co_u32 v10, vcc, s40, v10
s_nop 1
v_addc_co_u32 v11, vcc, 0, v11, vcc
global_load_dwordx2 a[0:1], v[10:11], off
v_add_co_u32 v10, vcc, 0x10000, v10
s_nop 1
v_addc_co_u32 v11, vcc, 0, v11, vcc
s_add_u32 s42, s42, 67584
s_cmp_le_u32 s42, L_code_end - L_warm_pc - 8
s_cbranch_scc0 L_warm_done
global_load_dwordx2 a[2:3], v[10:11], off
L_warm_done:
s_load_dwordx4 s[56:59], s[0:1], 0
s_load_dwordx2 s[60:61], s[0:1], 16
s_load_dwordx4 s[64:67], s[0:1], 32
s_load_dwordx2 s[62:63], s[0:1], 48
s_load_dwordx2 s[26:27], s[0:1], 64
s_load_dwordx2 s[12:13], s[0:1], 72
v_and_b32 v1, 63, v0
v_lshrrev_b32 v3, 6, v0
v_lshlrev_b32 v2, 4, v1
v_readfirstlane_b32 s4, v3
s_and_b32 s5, s2, 7
s_lshr_b32 s6, s2, 3
s_waitcnt lgkmcnt(0)
s_mov_b32 s8, s12
s_and_b32 s9, s13, 0xffff
s_mov_b32 s10, 268435456
s_mov_b32 s11, 0x20000
s_mov_b32 s16, s56
s_and_b32 s17, s57, 0xffff
s_mov_b32 s18, 2359296
s_mov_b32 s19, 0x20000
v_mov_b32 v3, 4194304
buffer_load_dwordx2 v[14:15], v3, s[8:11], 0 offen sc1
v_and_b32 v6, 7, v1
v_lshrrev_b32 v7, 3, v1
s_mul_i32 s22, s4, 24
v_add_u32 v7, s22, v7
s_and_b32 s23, s6, 1
s_lshl_b32 s23, s23, 3
v_add_u32 v8, s23, v6
v_lshlrev_b32 v8, 4, v8
v_lshl_add_u32 v4, v7, 8, v8
s_lshl_b32 s24, s5, 4
s_lshr_b32 s25, s6, 1
s_add_u32 s24, s24, s25
s_mul_i32 s20, s24, 18432
s_lshl_b32 s24, s5, 8
s_lshl_b32 s25, s6, 3
s_add_u32 s24, s24, s25
s_and_b32 s25, s24, 1023
s_lshl_b32 s25, s25, 1
s_lshr_b32 s24, s24, 10
s_add_u32 s24, s24, s25
s_mul_i32 s21, s24, 1152
v_mul_u32_u24 v8, 2304, v6
v_lshl_add_u32 v5, v7, 4, v8
s_cmp_eq_u32 s4, 3
s_cselect_b64 vcc, -1, 0
v_mov_b32 v8, 2146435072
v_cndmask_b32 v4, v4, v8, vcc
v_cndmask_b32 v5, v5, v8, vcc
buffer_load_dwordx4 v[16:19], v5, s[16:19], s21 offen offset:0 nt
buffer_load_dwordx4 v[20:23], v5, s[16:19], s21 offen offset:128 nt
buffer_load_dwordx4 v[24:27], v5, s[16:19], s21 offen offset:256 nt
s_lshl_b32 s40, s6, 2
s_add_u32 s40, s40, s4
v_and_b32 v6, 15, v1
v_lshrrev_b32 v7, 4, v1
v_lshrrev_b32 v8, 2, v6
v_mov_b32 v12, 2146435072
s_cmp_ge_u32 s40, 96
s_cbranch_scc1 L_g_o
s_mov_b32 s44, s58
s_and_b32 s45, s59, 0xffff
s_mov_b32 s46, 1990656
s_mov_b32 s47, 0x20000
s_cmp_ge_u32 s40, 48
s_cselect_b32 s41, 1, 0
s_mul_i32 s42, s41, 48
s_sub_u32 s40, s40, s42
s_mul_i32 s40, s40, 3
s_lshl_b32 s42, s5, 1
s_add_u32 s41, s41, s42
s_mul_i32 s38, s41, 147456
s_lshl_b32 s42, s40, 10
s_add_u32 s38, s38, s42
s_add_u32 s38, s38, 4198400
s_mul_i32 s41, s41, 36
v_and_b32 v9, 1, v6
v_bfe_u32 v10, v6, 1, 1
v_mul_u32_u24 v10, 18, v10
v_add_u32 v9, v9, v10
v_mul_u32_u24 v10, 576, v8
v_add_u32 v9, v9, v10
v_mul_u32_u24 v10, 27648, v7
s_add_u32 s42, s40, 0
s_and_b32 s43, s42, 7
s_lshr_b32 s42, s42, 3
s_mul_i32 s42, s42, 110592
s_mov_b32 s35, 0
s_cmp_eq_u32 s43, 1
s_cselect_b32 s35, 18, s35
s_cmp_eq_u32 s43, 2
s_cselect_b32 s35, 576, s35
s_cmp_eq_u32 s43, 3
s_cselect_b32 s35, 594, s35
s_cmp_eq_u32 s43, 4
s_cselect_b32 s35, 16, s35
s_cmp_eq_u32 s43, 5
s_cselect_b32 s35, 1152, s35
s_cmp_eq_u32 s43, 6
s_cselect_b32 s35, 1170, s35
s_cmp_eq_u32 s43, 7
s_cselect_b32 s35, 1168, s35
s_add_u32 s35, s35, s41
s_mov_b32 s36, 16
s_cmp_eq_u32 s43, 4
s_cselect_b32 s36, 8, s36
s_cmp_eq_u32 s43, 7
s_cselect_b32 s36, 4, s36
s_cmp_lg_u32 s36, 16
s_cselect_b64 vcc, -1, 0
v_cndmask_b32 v11, v6, v9, vcc
v_add_u32 v11, s35, v11
v_lshl_add_u32 v11, v11, 1, v10
v_cmp_gt_u32 vcc, s36, v6
s_nop 1
v_cndmask_b32 v11, v12, v11, vcc
buffer_load_ushort v52, v11, s[44:47], s42 offen
s_add_u32 s42, s42, 3456
buffer_load_ushort v53, v11, s[44:47], s42 offen
s_add_u32 s42, s42, 3456
buffer_load_ushort v54, v11, s[44:47], s42 offen
s_add_u32 s42, s42, 3456
buffer_load_ushort v55, v11, s[44:47], s42 offen
s_add_u32 s42, s42, 3456
buffer_load_ushort v56, v11, s[44:47], s42 offen
s_add_u32 s42, s42, 3456
buffer_load_ushort v57, v11, s[44:47], s42 offen
s_add_u32 s42, s42, 3456
buffer_load_ushort v58, v11, s[44:47], s42 offen
s_add_u32 s42, s42, 3456
buffer_load_ushort v59, v11, s[44:47], s42 offen
s_add_u32 s42, s40, 1
s_and_b32 s43, s42, 7
s_lshr_b32 s42, s42, 3
s_mul_i32 s42, s42, 110592
s_mov_b32 s35, 0
s_cmp_eq_u32 s43, 1
s_cselect_b32 s35, 18, s35
s_cmp_eq_u32 s43, 2
s_cselect_b32 s35, 576, s35
s_cmp_eq_u32 s43, 3
s_cselect_b32 s35, 594, s35
s_cmp_eq_u32 s43, 4
s_cselect_b32 s35, 16, s35
s_cmp_eq_u32 s43, 5
s_cselect_b32 s35, 1152, s35
s_cmp_eq_u32 s43, 6
s_cselect_b32 s35, 1170, s35
s_cmp_eq_u32 s43, 7
s_cselect_b32 s35, 1168, s35
s_add_u32 s35, s35, s41
s_mov_b32 s36, 16
s_cmp_eq_u32 s43, 4
s_cselect_b32 s36, 8, s36
s_cmp_eq_u32 s43, 7
s_cselect_b32 s36, 4, s36
s_cmp_lg_u32 s36, 16
s_cselect_b64 vcc, -1, 0
v_cndmask_b32 v11, v6, v9, vcc
v_add_u32 v11, s35, v11
v_lshl_add_u32 v11, v11, 1, v10
v_cmp_gt_u32 vcc, s36, v6
s_nop 1
v_cndmask_b32 v11, v12, v11, vcc
buffer_load_ushort v60, v11, s[44:47], s42 offen
s_add_u32 s42, s42, 3456
buffer_load_ushort v61, v11, s[44:47], s42 offen
s_add_u32 s42, s42, 3456
buffer_load_ushort v62, v11, s[44:47], s42 offen
s_add_u32 s42, s42, 3456
buffer_load_ushort v63, v11, s[44:47], s42 offen
s_add_u32 s42, s42, 3456
buffer_load_ushort v64, v11, s[44:47], s42 offen
s_add_u32 s42, s42, 3456
buffer_load_ushort v65, v11, s[44:47], s42 offen
s_add_u32 s42, s42, 3456
buffer_load_ushort v66, v11, s[44:47], s42 offen
s_add_u32 s42, s42, 3456
buffer_load_ushort v67, v11, s[44:47], s42 offen
s_add_u32 s42, s40, 2
s_and_b32 s43, s42, 7
s_lshr_b32 s42, s42, 3
s_mul_i32 s42, s42, 110592
s_mov_b32 s35, 0
s_cmp_eq_u32 s43, 1
s_cselect_b32 s35, 18, s35
s_cmp_eq_u32 s43, 2
s_cselect_b32 s35, 576, s35
s_cmp_eq_u32 s43, 3
s_cselect_b32 s35, 594, s35
s_cmp_eq_u32 s43, 4
s_cselect_b32 s35, 16, s35
s_cmp_eq_u32 s43, 5
s_cselect_b32 s35, 1152, s35
s_cmp_eq_u32 s43, 6
s_cselect_b32 s35, 1170, s35
s_cmp_eq_u32 s43, 7
s_cselect_b32 s35, 1168, s35
s_add_u32 s35, s35, s41
s_mov_b32 s36, 16
s_cmp_eq_u32 s43, 4
s_cselect_b32 s36, 8, s36
s_cmp_eq_u32 s43, 7
s_cselect_b32 s36, 4, s36
s_cmp_lg_u32 s36, 16
s_cselect_b64 vcc, -1, 0
v_cndmask_b32 v11, v6, v9, vcc
v_add_u32 v11, s35, v11
v_lshl_add_u32 v11, v11, 1, v10
v_cmp_gt_u32 vcc, s36, v6
s_nop 1
v_cndmask_b32 v11, v12, v11, vcc
buffer_load_ushort v68, v11, s[44:47], s42 offen
s_add_u32 s42, s42, 3456
buffer_load_ushort v69, v11, s[44:47], s42 offen
s_add_u32 s42, s42, 3456
buffer_load_ushort v70, v11, s[44:47], s42 offen
s_add_u32 s42, s42, 3456
buffer_load_ushort v71, v11, s[44:47], s42 offen
s_add_u32 s42, s42, 3456
buffer_load_ushort v72, v11, s[44:47], s42 offen
s_add_u32 s42, s42, 3456
buffer_load_ushort v73, v11, s[44:47], s42 offen
s_add_u32 s42, s42, 3456
buffer_load_ushort v74, v11, s[44:47], s42 offen
s_add_u32 s42, s42, 3456
buffer_load_ushort v75, v11, s[44:47], s42 offen
s_branch L_g_done
L_g_o:
s_mov_b32 s44, s60
s_and_b32 s45, s61, 0xffff
s_mov_b32 s46, 663552
s_mov_b32 s47, 0x20000
s_sub_u32 s40, s40, 96
s_mul_i32 s40, s40, 3
s_mul_i32 s38, s5, 92160
s_lshl_b32 s42, s40, 10
s_add_u32 s38, s38, s42
s_add_u32 s38, s38, 6557696
s_cmp_ge_u32 s40, 90
s_cselect_b32 s38, 2146435072, s38
s_mul_i32 s41, s5, 72
v_and_b32 v9, 3, v6
v_lshl_add_u32 v9, v8, 3, v9
s_add_u32 s42, s40, 0
s_mul_i32 s43, s42, 13108
s_lshr_b32 s43, s43, 16
s_mul_i32 s35, s43, 5
s_sub_u32 s42, s42, s35
s_lshr_b32 s35, s42, 1
s_lshl_b32 s35, s35, 5
s_and_b32 s36, s42, 1
s_lshl_b32 s36, s36, 2
s_add_u32 s35, s35, s36
s_add_u32 s35, s35, s41
s_cmp_eq_u32 s42, 4
s_cselect_b64 vcc, -1, 0
s_cselect_b32 s36, 8, 16
v_cndmask_b32 v11, v9, v6, vcc
v_add_u32 v11, s35, v11
s_mul_i32 s35, s43, 41472
s_sub_u32 s37, s43, 16
s_mul_i32 s37, s37, 331776
s_cmp_lt_u32 s43, 16
s_cselect_b32 s35, s35, s37
s_cselect_b32 s37, 4, 72
s_cselect_b32 s34, 0, 1
s_mul_i32 s37, s37, 1152
v_mul_lo_u32 v10, s37, v7
v_lshl_add_u32 v11, v11, 1, v10
v_cmp_gt_u32 vcc, s36, v6
s_nop 1
v_cndmask_b32 v11, v12, v11, vcc
s_mul_i32 s42, s34, 18432
s_add_u32 s42, s42, 0
s_add_u32 s42, s42, s35
buffer_load_ushort v52, v11, s[44:47], s42 offen
s_mul_i32 s42, s34, 18432
s_add_u32 s42, s42, 1152
s_add_u32 s42, s42, s35
buffer_load_ushort v53, v11, s[44:47], s42 offen
s_mul_i32 s42, s34, 36864
s_add_u32 s42, s42, 2304
s_add_u32 s42, s42, s35
buffer_load_ushort v54, v11, s[44:47], s42 offen
s_mul_i32 s42, s34, 36864
s_add_u32 s42, s42, 3456
s_add_u32 s42, s42, s35
buffer_load_ushort v55, v11, s[44:47], s42 offen
s_mul_i32 s42, s34, 39168
s_add_u32 s42, s42, 20736
s_add_u32 s42, s42, s35
buffer_load_ushort v56, v11, s[44:47], s42 offen
s_mul_i32 s42, s34, 39168
s_add_u32 s42, s42, 21888
s_add_u32 s42, s42, s35
buffer_load_ushort v57, v11, s[44:47], s42 offen
s_mul_i32 s42, s34, 57600
s_add_u32 s42, s42, 23040
s_add_u32 s42, s42, s35
buffer_load_ushort v58, v11, s[44:47], s42 offen
s_mul_i32 s42, s34, 57600
s_add_u32 s42, s42, 24192
s_add_u32 s42, s42, s35
buffer_load_ushort v59, v11, s[44:47], s42 offen
s_add_u32 s42, s40, 1
s_mul_i32 s43, s42, 13108
s_lshr_b32 s43, s43, 16
s_mul_i32 s35, s43, 5
s_sub_u32 s42, s42, s35
s_lshr_b32 s35, s42, 1
s_lshl_b32 s35, s35, 5
s_and_b32 s36, s42, 1
s_lshl_b32 s36, s36, 2
s_add_u32 s35, s35, s36
s_add_u32 s35, s35, s41
s_cmp_eq_u32 s42, 4
s_cselect_b64 vcc, -1, 0
s_cselect_b32 s36, 8, 16
v_cndmask_b32 v11, v9, v6, vcc
v_add_u32 v11, s35, v11
s_mul_i32 s35, s43, 41472
s_sub_u32 s37, s43, 16
s_mul_i32 s37, s37, 331776
s_cmp_lt_u32 s43, 16
s_cselect_b32 s35, s35, s37
s_cselect_b32 s37, 4, 72
s_cselect_b32 s34, 0, 1
s_mul_i32 s37, s37, 1152
v_mul_lo_u32 v10, s37, v7
v_lshl_add_u32 v11, v11, 1, v10
v_cmp_gt_u32 vcc, s36, v6
s_nop 1
v_cndmask_b32 v11, v12, v11, vcc
s_mul_i32 s42, s34, 18432
s_add_u32 s42, s42, 0
s_add_u32 s42, s42, s35
buffer_load_ushort v60, v11, s[44:47], s42 offen
s_mul_i32 s42, s34, 18432
s_add_u32 s42, s42, 1152
s_add_u32 s42, s42, s35
buffer_load_ushort v61, v11, s[44:47], s42 offen
s_mul_i32 s42, s34, 36864
s_add_u32 s42, s42, 2304
s_add_u32 s42, s42, s35
buffer_load_ushort v62, v11, s[44:47], s42 offen
s_mul_i32 s42, s34, 36864
s_add_u32 s42, s42, 3456
s_add_u32 s42, s42, s35
buffer_load_ushort v63, v11, s[44:47], s42 offen
s_mul_i32 s42, s34, 39168
s_add_u32 s42, s42, 20736
s_add_u32 s42, s42, s35
buffer_load_ushort v64, v11, s[44:47], s42 offen
s_mul_i32 s42, s34, 39168
s_add_u32 s42, s42, 21888
s_add_u32 s42, s42, s35
buffer_load_ushort v65, v11, s[44:47], s42 offen
s_mul_i32 s42, s34, 57600
s_add_u32 s42, s42, 23040
s_add_u32 s42, s42, s35
buffer_load_ushort v66, v11, s[44:47], s42 offen
s_mul_i32 s42, s34, 57600
s_add_u32 s42, s42, 24192
s_add_u32 s42, s42, s35
buffer_load_ushort v67, v11, s[44:47], s42 offen
s_add_u32 s42, s40, 2
s_mul_i32 s43, s42, 13108
s_lshr_b32 s43, s43, 16
s_mul_i32 s35, s43, 5
s_sub_u32 s42, s42, s35
s_lshr_b32 s35, s42, 1
s_lshl_b32 s35, s35, 5
s_and_b32 s36, s42, 1
s_lshl_b32 s36, s36, 2
s_add_u32 s35, s35, s36
s_add_u32 s35, s35, s41
s_cmp_eq_u32 s42, 4
s_cselect_b64 vcc, -1, 0
s_cselect_b32 s36, 8, 16
v_cndmask_b32 v11, v9, v6, vcc
v_add_u32 v11, s35, v11
s_mul_i32 s35, s43, 41472
s_sub_u32 s37, s43, 16
s_mul_i32 s37, s37, 331776
s_cmp_lt_u32 s43, 16
s_cselect_b32 s35, s35, s37
s_cselect_b32 s37, 4, 72
s_cselect_b32 s34, 0, 1
s_mul_i32 s37, s37, 1152
v_mul_lo_u32 v10, s37, v7
v_lshl_add_u32 v11, v11, 1, v10
v_cmp_gt_u32 vcc, s36, v6
s_nop 1
v_cndmask_b32 v11, v12, v11, vcc
s_mul_i32 s42, s34, 18432
s_add_u32 s42, s42, 0
s_add_u32 s42, s42, s35
buffer_load_ushort v68, v11, s[44:47], s42 offen
s_mul_i32 s42, s34, 18432
s_add_u32 s42, s42, 1152
s_add_u32 s42, s42, s35
buffer_load_ushort v69, v11, s[44:47], s42 offen
s_mul_i32 s42, s34, 36864
s_add_u32 s42, s42, 2304
s_add_u32 s42, s42, s35
buffer_load_ushort v70, v11, s[44:47], s42 offen
s_mul_i32 s42, s34, 36864
s_add_u32 s42, s42, 3456
s_add_u32 s42, s42, s35
buffer_load_ushort v71, v11, s[44:47], s42 offen
s_mul_i32 s42, s34, 39168
s_add_u32 s42, s42, 20736
s_add_u32 s42, s42, s35
buffer_load_ushort v72, v11, s[44:47], s42 offen
s_mul_i32 s42, s34, 39168
s_add_u32 s42, s42, 21888
s_add_u32 s42, s42, s35
buffer_load_ushort v73, v11, s[44:47], s42 offen
s_mul_i32 s42, s34, 57600
s_add_u32 s42, s42, 23040
s_add_u32 s42, s42, s35
buffer_load_ushort v74, v11, s[44:47], s42 offen
s_mul_i32 s42, s34, 57600
s_add_u32 s42, s42, 24192
s_add_u32 s42, s42, s35
buffer_load_ushort v75, v11, s[44:47], s42 offen
L_g_done:
s_cmp_ge_u32 s2, 144
s_cbranch_scc1 L_l1_d
s_mul_i32 s40, s2, 911
s_lshr_b32 s40, s40, 16
s_mul_i32 s41, s40, 72
s_sub_u32 s41, s2, s41
s_cmp_eq_u32 s40, 0
s_cselect_b64 s[12:13], s[64:65], s[66:67]
s_mov_b32 s48, s12
s_and_b32 s49, s13, 0xffff
s_mov_b32 s50, 5308416
s_mov_b32 s51, 0x20000
s_lshl_b32 s42, s41, 7
v_lshlrev_b32 v9, 3, v6
v_mul_u32_u24 v10, 73728, v7
v_add3_u32 v254, v9, v10, s42
s_bitcmp1_b32 s4, 0
s_cselect_b64 vcc, -1, 0
v_cndmask_b32 v255, v254, v12, vcc
s_mul_i32 s43, s4, 9
s_add_u32 s43, s43, 1
s_lshr_b32 s43, s43, 1
s_mul_i32 s53, s43, 294912
buffer_load_dwordx2 v[76:77], v254, s[48:51], s53 offen nt
s_add_u32 s53, s53, 9216
buffer_load_dwordx2 v[78:79], v254, s[48:51], s53 offen nt
s_add_u32 s53, s53, 9216
buffer_load_dwordx2 v[80:81], v254, s[48:51], s53 offen nt
s_add_u32 s53, s53, 9216
buffer_load_dwordx2 v[82:83], v254, s[48:51], s53 offen nt
s_add_u32 s53, s53, 9216
buffer_load_dwordx2 v[84:85], v254, s[48:51], s53 offen nt
s_add_u32 s53, s53, 9216
buffer_load_dwordx2 v[86:87], v254, s[48:51], s53 offen nt
s_add_u32 s53, s53, 9216
buffer_load_dwordx2 v[88:89], v254, s[48:51], s53 offen nt
s_add_u32 s53, s53, 9216
buffer_load_dwordx2 v[90:91], v254, s[48:51], s53 offen nt
s_add_u32 s53, s53, 230400
buffer_load_dwordx2 v[92:93], v254, s[48:51], s53 offen nt
s_add_u32 s53, s53, 9216
s_mul_i32 s42, s41, 7282
s_lshr_b32 s42, s42, 16
s_mul_i32 s35, s42, 9
s_sub_u32 s41, s41, s35
s_lshl_b32 s41, s41, 2
s_lshl_b32 s42, s42, 2
s_lshl_b32 s40, s40, 11
s_add_u32 s40, s40, 7303168
s_mov_b32 s35, 497664
v_and_b32 v6, 3, v1
v_add_u32 v6, s41, v6
v_mul_u32_u24 v7, 57, v6
v_lshrrev_b32 v7, 9, v7
v_mul_u32_u24 v8, 9, v7
v_sub_u32 v6, v6, v8
v_add_u32 v8, 1, v6
v_cmp_eq_u32 vcc, 9, v8
s_nop 1
v_cndmask_b32 v8, v8, 0, vcc
v_and_b32 v9, 1, v7
v_cmp_eq_u32 vcc, 0, v9
s_nop 1
v_cndmask_b32 v6, v6, v8, vcc
v_add_u32 v7, s42, v7
v_mul_lo_u32 v7, v7, s35
v_add_u32 v7, s40, v7
v_lshrrev_b32 v8, 2, v1
v_add_u32 v8, s43, v8
v_and_b32 v9, 1, v8
v_lshl_add_u32 v7, v9, 10, v7
v_lshrrev_b32 v9, 1, v8
v_lshlrev_b32 v9, 12, v9
v_add_u32 v7, v7, v9
v_lshl_add_u32 v9, v6, 12, v9
v_mul_u32_u24 v10, 36864, v6
v_cmp_gt_u32 vcc, 2, v6
s_nop 1
v_cndmask_b32 v9, v10, v9, vcc
v_add_u32 v7, v7, v9
v_cmp_gt_u32 vcc, 18, v8
s_nop 1
v_cndmask_b32 v7, v12, v7, vcc
s_bitcmp1_b32 s4, 0
s_cselect_b32 s41, 16, 20
v_cmp_gt_u32 vcc, s41, v1
s_nop 1
v_cndmask_b32 v7, v12, v7, vcc
s_nop 0
v_readlane_b32 s40, v7, 0
v_readlane_b32 s41, v7, 1
v_readlane_b32 s42, v7, 2
v_readlane_b32 s43, v7, 3
v_add_u32 v156, s40, v2
v_add_u32 v157, s41, v2
v_add_u32 v158, s42, v2
v_add_u32 v159, s43, v2
v_readlane_b32 s40, v7, 4
v_readlane_b32 s41, v7, 5
v_readlane_b32 s42, v7, 6
v_readlane_b32 s43, v7, 7
v_add_u32 v160, s40, v2
v_add_u32 v161, s41, v2
v_add_u32 v162, s42, v2
v_add_u32 v163, s43, v2
v_readlane_b32 s40, v7, 8
v_readlane_b32 s41, v7, 9
v_readlane_b32 s42, v7, 10
v_readlane_b32 s43, v7, 11
v_add_u32 v164, s40, v2
v_add_u32 v165, s41, v2
v_add_u32 v166, s42, v2
v_add_u32 v167, s43, v2
v_readlane_b32 s40, v7, 12
v_readlane_b32 s41, v7, 13
v_readlane_b32 s42, v7, 14
v_readlane_b32 s43, v7, 15
v_add_u32 v168, s40, v2
v_add_u32 v169, s41, v2
v_add_u32 v170, s42, v2
v_add_u32 v171, s43, v2
v_readlane_b32 s40, v7, 16
v_readlane_b32 s41, v7, 17
v_readlane_b32 s42, v7, 18
v_readlane_b32 s43, v7, 19
v_add_u32 v172, s40, v2
v_add_u32 v173, s41, v2
v_add_u32 v174, s42, v2
v_add_u32 v175, s43, v2
s_waitcnt vmcnt(33)
s_branch L_l1_e
L_l1_d:
s_cmp_ge_u32 s2, 216
s_cbranch_scc1 L_l1_n
s_mov_b32 s48, s62
s_and_b32 s49, s63, 0xffff
s_mov_b32 s50, 5308416
s_mov_b32 s51, 0x20000
s_sub_u32 s40, s2, 144
s_mul_i32 s53, s40, 73728
s_lshl_b32 s41, s4, 8
s_lshl_b32 s42, s4, 5
v_mul_u32_u24 v10, 18432, v7
v_lshl_add_u32 v9, v6, 3, v10
v_add_u32 v254, s41, v9
v_lshl_add_u32 v9, v6, 1, v10
v_add_u32 v255, s42, v9
s_add_u32 s43, s53, 0
buffer_load_dwordx2 v[76:77], v254, s[48:51], s43 offen offset:0 nt
buffer_load_dwordx2 v[92:93], v254, s[48:51], s43 offen offset:128 nt
buffer_load_ushort v108, v255, s[48:51], s43 offen offset:1024 nt
s_add_u32 s43, s53, 4608
buffer_load_dwordx2 v[78:79], v254, s[48:51], s43 offen offset:0 nt
buffer_load_dwordx2 v[94:95], v254, s[48:51], s43 offen offset:128 nt
buffer_load_ushort v109, v255, s[48:51], s43 offen offset:1024 nt
s_add_u32 s43, s53, 9216
buffer_load_dwordx2 v[80:81], v254, s[48:51], s43 offen offset:0 nt
buffer_load_dwordx2 v[96:97], v254, s[48:51], s43 offen offset:128 nt
buffer_load_ushort v110, v255, s[48:51], s43 offen offset:1024 nt
s_mul_i32 s41, s40, 7282
s_lshr_b32 s41, s41, 16
s_mul_i32 s42, s41, 9
s_sub_u32 s40, s40, s42
s_lshl_b32 s40, s40, 1
s_lshl_b32 s41, s41, 2
s_add_u32 s41, s41, s4
s_mul_i32 s41, s41, 497664
s_add_u32 s41, s41, 7634944
v_cmp_lt_u32 vcc, 8, v1
s_nop 1
v_cndmask_b32 v6, 0, 1, vcc
v_mul_u32_u24 v7, 9, v6
v_sub_u32 v7, v1, v7
v_add_u32 v6, s40, v6
v_mov_b32 v8, 0
v_cmp_lt_u32 vcc, 4, v6
s_nop 1
v_addc_co_u32 v8, vcc, 0, v8, vcc
v_cmp_lt_u32 vcc, 8, v6
s_nop 1
v_addc_co_u32 v8, vcc, 0, v8, vcc
v_cmp_lt_u32 vcc, 13, v6
s_nop 1
v_addc_co_u32 v8, vcc, 0, v8, vcc
v_mul_u32_u24 v9, 9, v8
v_add_u32 v9, 1, v9
v_lshrrev_b32 v9, 1, v9
v_sub_u32 v9, v6, v9
v_subrev_u32 v8, s4, v8
v_and_b32 v8, 3, v8
v_mul_u32_u24 v10, 3, v9
v_add3_u32 v10, v10, v8, 2
v_add_u32 v11, 3, v10
v_cmp_lt_u32 vcc, 1, v9
s_nop 1
v_cndmask_b32 v10, v10, v11, vcc
v_cmp_eq_u32 vcc, 3, v9
s_nop 1
v_cndmask_b32 v9, v9, 11, vcc
v_cmp_eq_u32 vcc, 0, v8
s_nop 1
v_cndmask_b32 v10, v10, v9, vcc
v_cmp_eq_u32 vcc, 4, v6
s_nop 1
v_cndmask_b32 v10, v10, 9, vcc
v_cmp_eq_u32 vcc, 13, v6
s_nop 1
v_cndmask_b32 v10, v10, 10, vcc
v_and_b32 v6, 30, v10
v_and_b32 v8, 1, v10
v_lshl_add_u32 v8, v7, 1, v8
v_lshl_add_u32 v9, v6, 3, v8
v_lshl_add_u32 v6, v7, 2, v10
v_add_u32 v6, 104, v6
v_cmp_gt_u32 vcc, 14, v10
s_nop 1
v_cndmask_b32 v9, v6, v9, vcc
v_add_u32 v6, 144, v10
v_add_u32 v11, 112, v10
v_cmp_gt_u32 vcc, 6, v10
s_nop 1
v_cndmask_b32 v6, v6, v11, vcc
v_cmp_eq_u32 vcc, 8, v7
s_nop 1
v_cndmask_b32 v9, v9, v6, vcc
v_lshlrev_b32 v9, 10, v9
v_add_u32 v9, s41, v9
v_cmp_gt_u32 vcc, 18, v1
s_nop 1
v_cndmask_b32 v9, v12, v9, vcc
s_nop 0
v_readlane_b32 s40, v9, 0
v_readlane_b32 s41, v9, 1
v_readlane_b32 s42, v9, 2
v_readlane_b32 s43, v9, 3
v_add_u32 v156, s40, v2
v_add_u32 v157, s41, v2
v_add_u32 v158, s42, v2
v_add_u32 v159, s43, v2
v_readlane_b32 s40, v9, 4
v_readlane_b32 s41, v9, 5
v_readlane_b32 s42, v9, 6
v_readlane_b32 s43, v9, 7
v_add_u32 v160, s40, v2
v_add_u32 v161, s41, v2
v_add_u32 v162, s42, v2
v_add_u32 v163, s43, v2
v_readlane_b32 s40, v9, 8
v_readlane_b32 s41, v9, 9
v_readlane_b32 s42, v9, 10
v_readlane_b32 s43, v9, 11
v_add_u32 v164, s40, v2
v_add_u32 v165, s41, v2
v_add_u32 v166, s42, v2
v_add_u32 v167, s43, v2
v_readlane_b32 s40, v9, 12
v_readlane_b32 s41, v9, 13
v_readlane_b32 s42, v9, 14
v_readlane_b32 s43, v9, 15
v_add_u32 v168, s40, v2
v_add_u32 v169, s41, v2
v_add_u32 v170, s42, v2
v_add_u32 v171, s43, v2
v_readlane_b32 s40, v9, 16
v_readlane_b32 s41, v9, 17
v_readlane_b32 s42, v9, 18
v_readlane_b32 s43, v9, 19
v_add_u32 v172, s40, v2
v_add_u32 v173, s41, v2
v_add_u32 v174, s42, v2
v_add_u32 v175, s43, v2
s_waitcnt vmcnt(33)
s_branch L_l1_e
L_l1_n:
v_mov_b32 v156, v12
v_mov_b32 v157, v12
v_mov_b32 v158, v12
v_mov_b32 v159, v12
v_mov_b32 v160, v12
v_mov_b32 v161, v12
v_mov_b32 v162, v12
v_mov_b32 v163, v12
v_mov_b32 v164, v12
v_mov_b32 v165, v12
v_mov_b32 v166, v12
v_mov_b32 v167, v12
v_mov_b32 v168, v12
v_mov_b32 v169, v12
v_mov_b32 v170, v12
v_mov_b32 v171, v12
v_mov_b32 v172, v12
v_mov_b32 v173, v12
v_mov_b32 v174, v12
v_mov_b32 v175, v12
s_waitcnt vmcnt(24)
L_l1_e:
v_readfirstlane_b32 s40, v14
v_readfirstlane_b32 s41, v15
s_add_u32 s68, s40, 1
s_addc_u32 s69, s41, 0
v_lshlrev_b32 v28, 16, v16
v_and_b32 v29, 0xffff0000, v16
v_lshlrev_b32 v30, 16, v17
v_and_b32 v31, 0xffff0000, v17
v_lshlrev_b32 v32, 16, v18
v_and_b32 v33, 0xffff0000, v18
v_lshlrev_b32 v34, 16, v19
v_and_b32 v35, 0xffff0000, v19
v_lshlrev_b32 v36, 16, v20
v_and_b32 v37, 0xffff0000, v20
v_lshlrev_b32 v38, 16, v21
v_and_b32 v39, 0xffff0000, v21
v_lshlrev_b32 v40, 16, v22
v_and_b32 v41, 0xffff0000, v22
v_lshlrev_b32 v42, 16, v23
v_and_b32 v43, 0xffff0000, v23
v_lshlrev_b32 v44, 16, v24
v_and_b32 v45, 0xffff0000, v24
v_lshlrev_b32 v46, 16, v25
v_and_b32 v47, 0xffff0000, v25
v_lshlrev_b32 v48, 16, v26
v_and_b32 v49, 0xffff0000, v26
v_lshlrev_b32 v50, 16, v27
v_and_b32 v51, 0xffff0000, v27
s_add_u32 s24, s20, 27979776
s_add_u32 s25, s24, 4096
buffer_store_dwordx4 v[16:19], v4, s[8:11], s24 offen offset:0 sc1
buffer_store_dwordx4 v[20:23], v4, s[8:11], s24 offen offset:2048 sc1
buffer_store_dwordx4 v[24:27], v4, s[8:11], s25 offen offset:0 sc1
v_add_f32 v6, v28, v29
v_mul_f32 v7, v28, v28
v_mul_f32 v9, v29, v29
v_mov_b32 v8, 0
v_add_f32 v6, v6, v30
v_add_f32 v8, v8, v31
v_fmac_f32 v7, v30, v30
v_fmac_f32 v9, v31, v31
v_add_f32 v6, v6, v32
v_add_f32 v8, v8, v33
v_fmac_f32 v7, v32, v32
v_fmac_f32 v9, v33, v33
v_add_f32 v6, v6, v34
v_add_f32 v8, v8, v35
v_fmac_f32 v7, v34, v34
v_fmac_f32 v9, v35, v35
v_add_f32 v6, v6, v36
v_add_f32 v8, v8, v37
v_fmac_f32 v7, v36, v36
v_fmac_f32 v9, v37, v37
v_add_f32 v6, v6, v38
v_add_f32 v8, v8, v39
v_fmac_f32 v7, v38, v38
v_fmac_f32 v9, v39, v39
v_add_f32 v6, v6, v40
v_add_f32 v8, v8, v41
v_fmac_f32 v7, v40, v40
v_fmac_f32 v9, v41, v41
v_add_f32 v6, v6, v42
v_add_f32 v8, v8, v43
v_fmac_f32 v7, v42, v42
v_fmac_f32 v9, v43, v43
v_add_f32 v6, v6, v44
v_add_f32 v8, v8, v45
v_fmac_f32 v7, v44, v44
v_fmac_f32 v9, v45, v45
v_add_f32 v6, v6, v46
v_add_f32 v8, v8, v47
v_fmac_f32 v7, v46, v46
v_fmac_f32 v9, v47, v47
v_add_f32 v6, v6, v48
v_add_f32 v8, v8, v49
v_fmac_f32 v7, v48, v48
v_fmac_f32 v9, v49, v49
v_add_f32 v6, v6, v50
v_add_f32 v8, v8, v51
v_fmac_f32 v7, v50, v50
v_fmac_f32 v9, v51, v51
v_add_f32 v6, v6, v8
v_add_f32 v7, v7, v9
s_nop 0
v_add_f32_dpp v6, v6, v6 row_ror:8 row_mask:0xf bank_mask:0xf
v_add_f32_dpp v7, v7, v7 row_ror:8 row_mask:0xf bank_mask:0xf
v_mov_b32 v8, v6
v_mov_b32 v9, v7
s_nop 0
v_permlane16_swap_b32 v6, v8
v_permlane16_swap_b32 v7, v9
v_add_f32 v6, v6, v8
v_add_f32 v7, v7, v9
v_mov_b32 v8, v6
v_mov_b32 v9, v7
s_nop 0
v_permlane32_swap_b32 v6, v8
v_permlane32_swap_b32 v7, v9
v_add_f32 v6, v6, v8
v_add_f32 v7, v7, v9
v_and_b32 v10, 7, v1
v_lshlrev_b32 v10, 3, v10
v_add_u32 v10, 147456, v10
s_lshl_b32 s24, s4, 6
v_add_u32 v11, s24, v10
ds_write_b64 v11, v[6:7]
s_waitcnt lgkmcnt(0)
s_barrier
ds_read_b64 v[6:7], v10
ds_read_b64 v[8:9], v10 offset:64
ds_read_b64 v[12:13], v10 offset:128
s_waitcnt lgkmcnt(0)
v_add_f32 v6, v6, v8
v_add_f32 v7, v7, v9
v_add_f32 v6, v6, v12
v_add_f32 v7, v7, v13
v_mul_f32 v6, 0x3ae38e39, v6
v_mul_f32 v7, 0x3ae38e39, v7
v_fma_f32 v7, -v6, v6, v7
v_max_f32 v7, 0, v7
v_add_f32 v7, 0x3727c5ac, v7
v_rsq_f32 v7, v7
s_nop 0
v_mul_f32 v6, v6, v7
v_fma_f32 v28, v28, v7, -v6
v_fma_f32 v29, v29, v7, -v6
v_fma_f32 v30, v30, v7, -v6
v_fma_f32 v31, v31, v7, -v6
v_fma_f32 v32, v32, v7, -v6
v_fma_f32 v33, v33, v7, -v6
v_fma_f32 v34, v34, v7, -v6
v_fma_f32 v35, v35, v7, -v6
v_fma_f32 v36, v36, v7, -v6
v_fma_f32 v37, v37, v7, -v6
v_fma_f32 v38, v38, v7, -v6
v_fma_f32 v39, v39, v7, -v6
v_fma_f32 v40, v40, v7, -v6
v_fma_f32 v41, v41, v7, -v6
v_fma_f32 v42, v42, v7, -v6
v_fma_f32 v43, v43, v7, -v6
v_fma_f32 v44, v44, v7, -v6
v_fma_f32 v45, v45, v7, -v6
v_fma_f32 v46, v46, v7, -v6
v_fma_f32 v47, v47, v7, -v6
v_fma_f32 v48, v48, v7, -v6
v_fma_f32 v49, v49, v7, -v6
v_fma_f32 v50, v50, v7, -v6
v_fma_f32 v51, v51, v7, -v6
v_cvt_pk_bf16_f32 v16, v28, v29
v_cvt_pk_bf16_f32 v17, v30, v31
v_cvt_pk_bf16_f32 v18, v32, v33
v_cvt_pk_bf16_f32 v19, v34, v35
v_cvt_pk_bf16_f32 v20, v36, v37
v_cvt_pk_bf16_f32 v21, v38, v39
v_cvt_pk_bf16_f32 v22, v40, v41
v_cvt_pk_bf16_f32 v23, v42, v43
v_cvt_pk_bf16_f32 v24, v44, v45
v_cvt_pk_bf16_f32 v25, v46, v47
v_cvt_pk_bf16_f32 v26, v48, v49
v_cvt_pk_bf16_f32 v27, v50, v51
s_add_u32 s24, s20, 23261184
s_add_u32 s25, s24, 4096
buffer_store_dwordx4 v[16:19], v4, s[8:11], s24 offen offset:0 sc1
buffer_store_dwordx4 v[20:23], v4, s[8:11], s24 offen offset:2048 sc1
buffer_store_dwordx4 v[24:27], v4, s[8:11], s25 offen offset:0 sc1
s_lshl_b32 s24, s5, 5
s_add_u32 s24, s24, s6
s_lshl_b32 s14, s24, 7
s_add_u32 s14, s14, 786432
s_waitcnt vmcnt(6)
v_lshl_or_b32 v52, v53, 16, v52
v_lshl_or_b32 v53, v55, 16, v54
v_lshl_or_b32 v54, v57, 16, v56
v_lshl_or_b32 v55, v59, 16, v58
buffer_store_dwordx4 v[52:55], v2, s[8:11], s38 offen offset:0 sc1
v_lshl_or_b32 v60, v61, 16, v60
v_lshl_or_b32 v61, v63, 16, v62
v_lshl_or_b32 v62, v65, 16, v64
v_lshl_or_b32 v63, v67, 16, v66
buffer_store_dwordx4 v[60:63], v2, s[8:11], s38 offen offset:1024 sc1
v_lshl_or_b32 v68, v69, 16, v68
v_lshl_or_b32 v69, v71, 16, v70
v_lshl_or_b32 v70, v73, 16, v72
v_lshl_or_b32 v71, v75, 16, v74
buffer_store_dwordx4 v[68:71], v2, s[8:11], s38 offen offset:2048 sc1
v_mov_b32 v13, 2146435072
v_cmp_eq_u32 vcc, 0, v0
v_mov_b32 v14, s68
v_mov_b32 v15, s69
v_cndmask_b32 v13, v13, 0, vcc
s_waitcnt vmcnt(0)
s_barrier
buffer_store_dwordx2 v[14:15], v13, s[8:11], s14 offen sc1
s_mov_b32 s44, s26
s_and_b32 s45, s27, 0xffff
s_mov_b32 s46, 256
s_mov_b32 s47, 0x20000
v_mov_b32 v3, 1
buffer_atomic_add v3, v13, s[44:47], 0 offen sc1
s_cmp_ge_u32 s2, 144
s_cbranch_scc1 L_l2_d
buffer_load_dwordx2 v[94:95], v254, s[48:51], s53 offen nt
s_add_u32 s53, s53, 9216
buffer_load_dwordx2 v[96:97], v254, s[48:51], s53 offen nt
s_add_u32 s53, s53, 9216
buffer_load_dwordx2 v[98:99], v254, s[48:51], s53 offen nt
s_add_u32 s53, s53, 9216
buffer_load_dwordx2 v[100:101], v254, s[48:51], s53 offen nt
s_add_u32 s53, s53, 9216
buffer_load_dwordx2 v[102:103], v254, s[48:51], s53 offen nt
s_add_u32 s53, s53, 9216
buffer_load_dwordx2 v[104:105], v254, s[48:51], s53 offen nt
s_add_u32 s53, s53, 9216
buffer_load_dwordx2 v[106:107], v254, s[48:51], s53 offen nt
s_add_u32 s53, s53, 230400
buffer_load_dwordx2 v[108:109], v254, s[48:51], s53 offen nt
s_add_u32 s53, s53, 9216
buffer_load_dwordx2 v[110:111], v254, s[48:51], s53 offen nt
s_add_u32 s53, s53, 9216
buffer_load_dwordx2 v[112:113], v254, s[48:51], s53 offen nt
s_add_u32 s53, s53, 9216
buffer_load_dwordx2 v[114:115], v254, s[48:51], s53 offen nt
s_add_u32 s53, s53, 9216
buffer_load_dwordx2 v[116:117], v254, s[48:51], s53 offen nt
s_add_u32 s53, s53, 9216
buffer_load_dwordx2 v[118:119], v254, s[48:51], s53 offen nt
s_add_u32 s53, s53, 9216
buffer_load_dwordx2 v[120:121], v254, s[48:51], s53 offen nt
s_add_u32 s53, s53, 9216
buffer_load_dwordx2 v[122:123], v254, s[48:51], s53 offen nt
s_add_u32 s53, s53, 230400
buffer_load_dwordx2 v[124:125], v254, s[48:51], s53 offen nt
s_add_u32 s53, s53, 9216
buffer_load_dwordx2 v[126:127], v254, s[48:51], s53 offen nt
s_add_u32 s53, s53, 9216
buffer_load_dwordx2 v[128:129], v254, s[48:51], s53 offen nt
s_add_u32 s53, s53, 9216
buffer_load_dwordx2 v[130:131], v254, s[48:51], s53 offen nt
s_add_u32 s53, s53, 9216
buffer_load_dwordx2 v[132:133], v254, s[48:51], s53 offen nt
s_add_u32 s53, s53, 9216
buffer_load_dwordx2 v[134:135], v254, s[48:51], s53 offen nt
s_add_u32 s53, s53, 9216
buffer_load_dwordx2 v[136:137], v254, s[48:51], s53 offen nt
s_add_u32 s53, s53, 9216
buffer_load_dwordx2 v[138:139], v254, s[48:51], s53 offen nt
s_add_u32 s53, s53, 230400
buffer_load_dwordx2 v[140:141], v255, s[48:51], s53 offen nt
s_add_u32 s53, s53, 9216
buffer_load_dwordx2 v[142:143], v255, s[48:51], s53 offen nt
s_add_u32 s53, s53, 9216
buffer_load_dwordx2 v[144:145], v255, s[48:51], s53 offen nt
s_add_u32 s53, s53, 9216
buffer_load_dwordx2 v[146:147], v255, s[48:51], s53 offen nt
s_add_u32 s53, s53, 9216
buffer_load_dwordx2 v[148:149], v255, s[48:51], s53 offen nt
s_add_u32 s53, s53, 9216
buffer_load_dwordx2 v[150:151], v255, s[48:51], s53 offen nt
s_add_u32 s53, s53, 9216
buffer_load_dwordx2 v[152:153], v255, s[48:51], s53 offen nt
s_add_u32 s53, s53, 9216
buffer_load_dwordx2 v[154:155], v255, s[48:51], s53 offen nt
s_add_u32 s53, s53, 230400
s_branch L_l2_e
L_l2_d:
s_cmp_ge_u32 s2, 216
s_cbranch_scc1 L_l2_n
s_add_u32 s43, s53, 13824
buffer_load_dwordx2 v[82:83], v254, s[48:51], s43 offen offset:0 nt
buffer_load_dwordx2 v[98:99], v254, s[48:51], s43 offen offset:128 nt
buffer_load_ushort v111, v255, s[48:51], s43 offen offset:1024 nt
s_add_u32 s43, s53, 1152
buffer_load_dwordx2 v[84:85], v254, s[48:51], s43 offen offset:0 nt
buffer_load_dwordx2 v[100:101], v254, s[48:51], s43 offen offset:128 nt
buffer_load_ushort v112, v255, s[48:51], s43 offen offset:1024 nt
s_add_u32 s43, s53, 5760
buffer_load_dwordx2 v[86:87], v254, s[48:51], s43 offen offset:0 nt
buffer_load_dwordx2 v[102:103], v254, s[48:51], s43 offen offset:128 nt
buffer_load_ushort v113, v255, s[48:51], s43 offen offset:1024 nt
s_add_u32 s43, s53, 10368
buffer_load_dwordx2 v[88:89], v254, s[48:51], s43 offen offset:0 nt
buffer_load_dwordx2 v[104:105], v254, s[48:51], s43 offen offset:128 nt
buffer_load_ushort v114, v255, s[48:51], s43 offen offset:1024 nt
s_add_u32 s43, s53, 14976
buffer_load_dwordx2 v[90:91], v254, s[48:51], s43 offen offset:0 nt
buffer_load_dwordx2 v[106:107], v254, s[48:51], s43 offen offset:128 nt
buffer_load_ushort v115, v255, s[48:51], s43 offen offset:1024 nt
s_add_u32 s43, s53, 2304
buffer_load_dwordx2 v[116:117], v254, s[48:51], s43 offen offset:0 nt
buffer_load_dwordx2 v[132:133], v254, s[48:51], s43 offen offset:128 nt
buffer_load_ushort v148, v255, s[48:51], s43 offen offset:1024 nt
s_add_u32 s43, s53, 6912
buffer_load_dwordx2 v[118:119], v254, s[48:51], s43 offen offset:0 nt
buffer_load_dwordx2 v[134:135], v254, s[48:51], s43 offen offset:128 nt
buffer_load_ushort v149, v255, s[48:51], s43 offen offset:1024 nt
s_add_u32 s43, s53, 11520
buffer_load_dwordx2 v[120:121], v254, s[48:51], s43 offen offset:0 nt
buffer_load_dwordx2 v[136:137], v254, s[48:51], s43 offen offset:128 nt
buffer_load_ushort v150, v255, s[48:51], s43 offen offset:1024 nt
s_add_u32 s43, s53, 16128
buffer_load_dwordx2 v[122:123], v254, s[48:51], s43 offen offset:0 nt
buffer_load_dwordx2 v[138:139], v254, s[48:51], s43 offen offset:128 nt
buffer_load_ushort v151, v255, s[48:51], s43 offen offset:1024 nt
s_add_u32 s43, s53, 3456
buffer_load_dwordx2 v[124:125], v254, s[48:51], s43 offen offset:0 nt
buffer_load_dwordx2 v[140:141], v254, s[48:51], s43 offen offset:128 nt
buffer_load_ushort v152, v255, s[48:51], s43 offen offset:1024 nt
s_add_u32 s43, s53, 8064
buffer_load_dwordx2 v[126:127], v254, s[48:51], s43 offen offset:0 nt
buffer_load_dwordx2 v[142:143], v254, s[48:51], s43 offen offset:128 nt
buffer_load_ushort v153, v255, s[48:51], s43 offen offset:1024 nt
s_add_u32 s43, s53, 12672
buffer_load_dwordx2 v[128:129], v254, s[48:51], s43 offen offset:0 nt
buffer_load_dwordx2 v[144:145], v254, s[48:51], s43 offen offset:128 nt
buffer_load_ushort v154, v255, s[48:51], s43 offen offset:1024 nt
s_add_u32 s43, s53, 17280
buffer_load_dwordx2 v[130:131], v254, s[48:51], s43 offen offset:0 nt
buffer_load_dwordx2 v[146:147], v254, s[48:51], s43 offen offset:128 nt
buffer_load_ushort v155, v255, s[48:51], s43 offen offset:1024 nt
L_l2_n:
L_l2_e:
s_mov_b32 s70, 23261184
s_mov_b32 s71, 27979776
s_mov_b32 s72, 32698368
s_mov_b32 s73, 37416960
s_mov_b32 s74, 42135552
s_mov_b32 s75, 42397696
s_mov_b32 s76, 80146432
s_mov_b32 s77, 0
s_mov_b32 s7, 0
s_lshr_b32 s20, s5, 2
s_lshl_b32 s20, s20, 3
s_lshr_b32 s21, s6, 2
s_add_u32 s20, s20, s21
s_and_b32 s21, s5, 3
s_lshl_b32 s21, s21, 2
s_and_b32 s22, s6, 3
s_add_u32 s21, s21, s22
s_lshl_b32 s24, s20, 3
s_sub_u32 s25, s24, 1
s_max_i32 s35, s25, 0
s_mul_i32 s25, s35, 18432
s_lshl_b32 s26, s4, 1
s_add_u32 s36, s24, s26
s_mul_i32 s24, s36, 18432
s_add_u32 s26, s24, s70
s_add_u32 s27, s26, 18432
s_add_u32 s28, s25, s70
v_add_u32 v4, 0x10000, v2
v_add_u32 v5, 0x20000, v2
s_cmp_eq_u32 s4, 3
s_cselect_b32 s29, 0, s4
s_cselect_b32 s31, 16, 9
s_lshl_b32 s30, s29, 10
v_and_b32 v12, 15, v1
v_mov_b32 v13, 2146435072
v_cmp_le_u32 vcc, s31, v12
s_nop 1
v_cndmask_b32 v3, v13, v2, vcc
s_add_u32 s31, s30, 2048
v_add_u32 v6, s31, v2
v_add_u32 v7, s31, v4
v_add_u32 v8, s31, v5
s_add_u32 s31, s30, 5120
v_add_u32 v9, s31, v2
v_add_u32 v10, s31, v4
v_add_u32 v11, s31, v5
s_lshl_b32 s22, s36, 1
s_lshl_b32 s23, s35, 1
s_add_u32 s23, s23, 1
v_and_b32 v16, 3, v1
v_add_u32 v16, s22, v16
v_mov_b32 v17, s23
v_cmp_eq_u32 vcc, 4, v1
s_nop 1
v_cndmask_b32 v16, v16, v17, vcc
s_lshr_b32 s22, s21, 1
s_lshl_b32 s22, s22, 5
s_and_b32 s23, s21, 1
s_mul_i32 s23, s23, 12
s_add_u32 s22, s22, s23
s_sub_u32 s22, s22, 8
v_add_u32 v17, s22, v1
v_subrev_u32 v14, 8, v1
v_cmp_gt_u32 vcc, 12, v14
s_nop 1
v_cndmask_b32 v16, v16, v17, vcc
s_and_b32 s22, s6, 7
s_lshl_b32 s22, s22, 5
v_add_u32 v17, s22, v1
v_subrev_u32 v14, 24, v1
v_cmp_gt_u32 vcc, 8, v14
s_nop 1
v_cndmask_b32 v16, v16, v17, vcc
v_lshlrev_b32 v16, 7, v16
s_add_u32 s22, s77, 786432
s_mov_b32 s52, 0
L_poll1:
buffer_load_dwordx2 v[14:15], v16, s[8:11], s22 offen sc1
s_add_u32 s52, s52, 1
s_waitcnt vmcnt(0)
v_cmp_ne_u64 vcc, s[68:69], v[14:15]
s_cmp_ge_u32 s52, 1048576
s_cbranch_scc1 L_got1
s_and_b64 exec, exec, vcc
s_cbranch_execnz L_poll1
L_got1:
s_mov_b64 exec, -1
s_lshr_b32 s20, s5, 2
s_lshl_b32 s20, s20, 3
s_lshr_b32 s21, s6, 2
s_add_u32 s20, s20, s21
s_and_b32 s21, s5, 3
s_lshl_b32 s21, s21, 2
s_and_b32 s22, s6, 3
s_add_u32 s21, s21, s22
s_mul_i32 s32, s21, 147456
s_add_u32 s32, s32, 4198400
s_mul_i32 s33, s4, 36864
s_add_u32 s32, s32, s33
s_mov_b32 s34, 0x05040100
s_mov_b32 s37, s35
s_mov_b32 s35, 0x07060302
s_mov_b32 s38, 0x00003f80
s_mov_b32 s39, 0x3f800000
v_mov_b32 v20, 0
v_mov_b32 v21, 0
v_mov_b32 v22, 0
v_mov_b32 v23, 0
s_cmp_ge_u32 s2, 144
s_cbranch_scc1 L_tr_d
v_mov_b32 v68, 0x3f803f80
v_mov_b32 v69, 0x3f803f80
s_add_u32 m0, s33, 0
s_add_u32 s40, s32, 0
buffer_load_dwordx4 v2, s[8:11], s40 offen offset:0 sc1 lds
v_mov_b32 v70, 0x3f803f80
v_mov_b32 v71, 0x3f803f80
v_perm_b32 v176, v78, v76, s34
v_perm_b32 v177, v82, v80, s34
v_perm_b32 v178, v86, v84, s34
v_perm_b32 v179, v90, v88, s34
buffer_load_dwordx4 v2, s[8:11], s40 offen offset:1024 sc1 lds
v_perm_b32 v180, v78, v76, s35
v_perm_b32 v181, v82, v80, s35
v_perm_b32 v182, v86, v84, s35
v_perm_b32 v183, v90, v88, s35
v_perm_b32 v184, v79, v77, s34
v_perm_b32 v185, v83, v81, s34
buffer_load_dwordx4 v2, s[8:11], s40 offen offset:2048 sc1 lds
v_perm_b32 v186, v87, v85, s34
v_perm_b32 v187, v91, v89, s34
v_perm_b32 v188, v79, v77, s35
v_perm_b32 v189, v83, v81, s35
v_perm_b32 v190, v87, v85, s35
v_perm_b32 v191, v91, v89, s35
buffer_load_dwordx4 v2, s[8:11], s40 offen offset:3072 sc1 lds
v_perm_b32 v192, v94, v92, s34
v_perm_b32 v193, v98, v96, s34
v_perm_b32 v194, v102, v100, s34
v_perm_b32 v195, v106, v104, s34
v_perm_b32 v196, v94, v92, s35
v_perm_b32 v197, v98, v96, s35
s_add_u32 m0, s33, 4096
s_add_u32 s40, s32, 4096
buffer_load_dwordx4 v2, s[8:11], s40 offen offset:0 sc1 lds
v_perm_b32 v198, v102, v100, s35
v_perm_b32 v199, v106, v104, s35
v_perm_b32 v200, v95, v93, s34
v_perm_b32 v201, v99, v97, s34
v_perm_b32 v202, v103, v101, s34
v_perm_b32 v203, v107, v105, s34
buffer_load_dwordx4 v2, s[8:11], s40 offen offset:1024 sc1 lds
v_perm_b32 v204, v95, v93, s35
v_perm_b32 v205, v99, v97, s35
v_perm_b32 v206, v103, v101, s35
v_perm_b32 v207, v107, v105, s35
v_perm_b32 v208, v110, v108, s34
v_perm_b32 v209, v114, v112, s34
buffer_load_dwordx4 v2, s[8:11], s40 offen offset:2048 sc1 lds
v_perm_b32 v210, v118, v116, s34
v_perm_b32 v211, v122, v120, s34
v_perm_b32 v212, v110, v108, s35
v_perm_b32 v213, v114, v112, s35
v_perm_b32 v214, v118, v116, s35
v_perm_b32 v215, v122, v120, s35
buffer_load_dwordx4 v2, s[8:11], s40 offen offset:3072 sc1 lds
v_perm_b32 v216, v111, v109, s34
v_perm_b32 v217, v115, v113, s34
v_perm_b32 v218, v119, v117, s34
v_perm_b32 v219, v123, v121, s34
v_perm_b32 v220, v111, v109, s35
v_perm_b32 v221, v115, v113, s35
s_add_u32 m0, s33, 8192
s_add_u32 s40, s32, 8192
buffer_load_dwordx4 v2, s[8:11], s40 offen offset:0 sc1 lds
v_perm_b32 v222, v119, v117, s35
v_perm_b32 v223, v123, v121, s35
v_perm_b32 v224, v126, v124, s34
v_perm_b32 v225, v130, v128, s34
v_perm_b32 v226, v134, v132, s34
v_perm_b32 v227, v138, v136, s34
buffer_load_dwordx4 v2, s[8:11], s40 offen offset:1024 sc1 lds
v_perm_b32 v228, v126, v124, s35
v_perm_b32 v229, v130, v128, s35
v_perm_b32 v230, v134, v132, s35
v_perm_b32 v231, v138, v136, s35
v_perm_b32 v232, v127, v125, s34
v_perm_b32 v233, v131, v129, s34
buffer_load_dwordx4 v2, s[8:11], s40 offen offset:2048 sc1 lds
v_perm_b32 v234, v135, v133, s34
v_perm_b32 v235, v139, v137, s34
v_perm_b32 v236, v127, v125, s35
v_perm_b32 v237, v131, v129, s35
v_perm_b32 v238, v135, v133, s35
v_perm_b32 v239, v139, v137, s35
buffer_load_dwordx4 v2, s[8:11], s40 offen offset:3072 sc1 lds
v_perm_b32 v240, v142, v140, s34
v_perm_b32 v241, v146, v144, s34
v_perm_b32 v242, v150, v148, s34
v_perm_b32 v243, v154, v152, s34
v_perm_b32 v244, v142, v140, s35
v_perm_b32 v245, v146, v144, s35
s_add_u32 m0, s33, 12288
s_add_u32 s40, s32, 12288
buffer_load_dwordx4 v2, s[8:11], s40 offen offset:0 sc1 lds
v_perm_b32 v246, v150, v148, s35
v_perm_b32 v247, v154, v152, s35
v_perm_b32 v248, v143, v141, s34
v_perm_b32 v249, v147, v145, s34
v_perm_b32 v250, v151, v149, s34
v_perm_b32 v251, v155, v153, s34
buffer_load_dwordx4 v2, s[8:11], s40 offen offset:1024 sc1 lds
v_perm_b32 v252, v143, v141, s35
v_perm_b32 v253, v147, v145, s35
v_perm_b32 v254, v151, v149, s35
v_perm_b32 v255, v155, v153, s35
v_mfma_f32_16x16x32_bf16 v[52:55], v[68:71], v[176:179], 0
v_mfma_f32_16x16x32_bf16 v[56:59], v[68:71], v[180:183], 0
buffer_load_dwordx4 v2, s[8:11], s40 offen offset:2048 sc1 lds
v_mfma_f32_16x16x32_bf16 v[60:63], v[68:71], v[184:187], 0
v_mfma_f32_16x16x32_bf16 v[64:67], v[68:71], v[188:191], 0
v_mfma_f32_16x16x32_bf16 v[52:55], v[68:71], v[192:195], v[52:55]
v_mfma_f32_16x16x32_bf16 v[56:59], v[68:71], v[196:199], v[56:59]
v_mfma_f32_16x16x32_bf16 v[60:63], v[68:71], v[200:203], v[60:63]
v_mfma_f32_16x16x32_bf16 v[64:67], v[68:71], v[204:207], v[64:67]
buffer_load_dwordx4 v2, s[8:11], s40 offen offset:3072 sc1 lds
v_mfma_f32_16x16x32_bf16 v[52:55], v[68:71], v[208:211], v[52:55]
v_mfma_f32_16x16x32_bf16 v[56:59], v[68:71], v[212:215], v[56:59]
v_mfma_f32_16x16x32_bf16 v[60:63], v[68:71], v[216:219], v[60:63]
v_mfma_f32_16x16x32_bf16 v[64:67], v[68:71], v[220:223], v[64:67]
v_mfma_f32_16x16x32_bf16 v[52:55], v[68:71], v[224:227], v[52:55]
v_mfma_f32_16x16x32_bf16 v[56:59], v[68:71], v[228:231], v[56:59]
s_add_u32 m0, s33, 16384
s_add_u32 s40, s32, 16384
buffer_load_dwordx4 v2, s[8:11], s40 offen offset:0 sc1 lds
v_mfma_f32_16x16x32_bf16 v[60:63], v[68:71], v[232:235], v[60:63]
v_mfma_f32_16x16x32_bf16 v[64:67], v[68:71], v[236:239], v[64:67]
v_mfma_f32_16x16x32_bf16 v[52:55], v[68:71], v[240:243], v[52:55]
v_mfma_f32_16x16x32_bf16 v[56:59], v[68:71], v[244:247], v[56:59]
v_mfma_f32_16x16x32_bf16 v[60:63], v[68:71], v[248:251], v[60:63]
v_mfma_f32_16x16x32_bf16 v[64:67], v[68:71], v[252:255], v[64:67]
buffer_load_dwordx4 v2, s[8:11], s40 offen offset:1024 sc1 lds
v_and_b32 v72, 15, v1
v_lshlrev_b32 v72, 4, v72
v_add_u32 v72, 159744, v72
s_lshl_b32 s44, s4, 2
v_add_u32 v73, s44, v72
ds_write_b32 v73, v52 offset:0
buffer_load_dwordx4 v2, s[8:11], s40 offen offset:2048 sc1 lds
ds_write_b32 v73, v56 offset:256
ds_write_b32 v73, v60 offset:512
ds_write_b32 v73, v64 offset:768
s_waitcnt lgkmcnt(0)
s_barrier
ds_read_b128 v[52:55], v72 offset:0
buffer_load_dwordx4 v2, s[8:11], s40 offen offset:3072 sc1 lds
ds_read_b128 v[56:59], v72 offset:256
ds_read_b128 v[60:63], v72 offset:512
ds_read_b128 v[64:67], v72 offset:768
s_waitcnt lgkmcnt(0)
v_add_f32 v52, v52, v53
v_add_f32 v54, v54, v55
s_add_u32 m0, s33, 20480
s_add_u32 s40, s32, 20480
buffer_load_dwordx4 v2, s[8:11], s40 offen offset:0 sc1 lds
v_add_f32 v56, v56, v57
v_add_f32 v58, v58, v59
v_add_f32 v60, v60, v61
v_add_f32 v62, v62, v63
v_add_f32 v64, v64, v65
v_add_f32 v66, v66, v67
buffer_load_dwordx4 v2, s[8:11], s40 offen offset:1024 sc1 lds
v_add_f32 v52, v52, v54
v_add_f32 v56, v56, v58
v_add_f32 v60, v60, v62
v_add_f32 v64, v64, v66
v_mul_f32 v20, 0xbae38e39, v52
v_mul_f32 v21, 0xbae38e39, v56
buffer_load_dwordx4 v2, s[8:11], s40 offen offset:2048 sc1 lds
v_mul_f32 v22, 0xbae38e39, v60
v_mul_f32 v23, 0xbae38e39, v64
v_dot2_f32_bf16 v24, v176, s38, v20
v_dot2_f32_bf16 v25, v176, s39, v20
v_dot2_f32_bf16 v26, v177, s38, v20
v_dot2_f32_bf16 v27, v177, s39, v20
buffer_load_dwordx4 v2, s[8:11], s40 offen offset:3072 sc1 lds
v_dot2_f32_bf16 v28, v178, s38, v20
v_dot2_f32_bf16 v29, v178, s39, v20
v_dot2_f32_bf16 v30, v179, s38, v20
v_dot2_f32_bf16 v31, v179, s39, v20
v_cvt_pk_bf16_f32 v176, v24, v25
v_cvt_pk_bf16_f32 v177, v26, v27
s_add_u32 m0, s33, 24576
s_add_u32 s40, s32, 24576
buffer_load_dwordx4 v2, s[8:11], s40 offen offset:0 sc1 lds
v_cvt_pk_bf16_f32 v178, v28, v29
v_cvt_pk_bf16_f32 v179, v30, v31
v_dot2_f32_bf16 v24, v180, s38, v21
v_dot2_f32_bf16 v25, v180, s39, v21
v_dot2_f32_bf16 v26, v181, s38, v21
v_dot2_f32_bf16 v27, v181, s39, v21
buffer_load_dwordx4 v2, s[8:11], s40 offen offset:1024 sc1 lds
v_dot2_f32_bf16 v28, v182, s38, v21
v_dot2_f32_bf16 v29, v182, s39, v21
v_dot2_f32_bf16 v30, v183, s38, v21
v_dot2_f32_bf16 v31, v183, s39, v21
v_cvt_pk_bf16_f32 v180, v24, v25
v_cvt_pk_bf16_f32 v181, v26, v27
buffer_load_dwordx4 v2, s[8:11], s40 offen offset:2048 sc1 lds
v_cvt_pk_bf16_f32 v182, v28, v29
v_cvt_pk_bf16_f32 v183, v30, v31
v_dot2_f32_bf16 v24, v184, s38, v22
v_dot2_f32_bf16 v25, v184, s39, v22
v_dot2_f32_bf16 v26, v185, s38, v22
v_dot2_f32_bf16 v27, v185, s39, v22
buffer_load_dwordx4 v2, s[8:11], s40 offen offset:3072 sc1 lds
v_dot2_f32_bf16 v28, v186, s38, v22
v_dot2_f32_bf16 v29, v186, s39, v22
v_dot2_f32_bf16 v30, v187, s38, v22
v_dot2_f32_bf16 v31, v187, s39, v22
v_cvt_pk_bf16_f32 v184, v24, v25
v_cvt_pk_bf16_f32 v185, v26, v27
s_add_u32 m0, s33, 28672
s_add_u32 s40, s32, 28672
buffer_load_dwordx4 v2, s[8:11], s40 offen offset:0 sc1 lds
v_cvt_pk_bf16_f32 v186, v28, v29
v_cvt_pk_bf16_f32 v187, v30, v31
v_dot2_f32_bf16 v24, v188, s38, v23
v_dot2_f32_bf16 v25, v188, s39, v23
v_dot2_f32_bf16 v26, v189, s38, v23
v_dot2_f32_bf16 v27, v189, s39, v23
buffer_load_dwordx4 v2, s[8:11], s40 offen offset:1024 sc1 lds
v_dot2_f32_bf16 v28, v190, s38, v23
v_dot2_f32_bf16 v29, v190, s39, v23
v_dot2_f32_bf16 v30, v191, s38, v23
v_dot2_f32_bf16 v31, v191, s39, v23
v_cvt_pk_bf16_f32 v188, v24, v25
v_cvt_pk_bf16_f32 v189, v26, v27
buffer_load_dwordx4 v2, s[8:11], s40 offen offset:2048 sc1 lds
v_cvt_pk_bf16_f32 v190, v28, v29
v_cvt_pk_bf16_f32 v191, v30, v31
v_dot2_f32_bf16 v24, v192, s38, v20
v_dot2_f32_bf16 v25, v192, s39, v20
v_dot2_f32_bf16 v26, v193, s38, v20
v_dot2_f32_bf16 v27, v193, s39, v20
buffer_load_dwordx4 v2, s[8:11], s40 offen offset:3072 sc1 lds
v_dot2_f32_bf16 v28, v194, s38, v20
v_dot2_f32_bf16 v29, v194, s39, v20
v_dot2_f32_bf16 v30, v195, s38, v20
v_dot2_f32_bf16 v31, v195, s39, v20
v_cvt_pk_bf16_f32 v192, v24, v25
v_cvt_pk_bf16_f32 v193, v26, v27
s_add_u32 m0, s33, 32768
s_add_u32 s40, s32, 32768
buffer_load_dwordx4 v2, s[8:11], s40 offen offset:0 sc1 lds
v_cvt_pk_bf16_f32 v194, v28, v29
v_cvt_pk_bf16_f32 v195, v30, v31
v_dot2_f32_bf16 v24, v196, s38, v21
v_dot2_f32_bf16 v25, v196, s39, v21
v_dot2_f32_bf16 v26, v197, s38, v21
v_dot2_f32_bf16 v27, v197, s39, v21
buffer_load_dwordx4 v2, s[8:11], s40 offen offset:1024 sc1 lds
v_dot2_f32_bf16 v28, v198, s38, v21
v_dot2_f32_bf16 v29, v198, s39, v21
v_dot2_f32_bf16 v30, v199, s38, v21
v_dot2_f32_bf16 v31, v199, s39, v21
v_cvt_pk_bf16_f32 v196, v24, v25
v_cvt_pk_bf16_f32 v197, v26, v27
buffer_load_dwordx4 v2, s[8:11], s40 offen offset:2048 sc1 lds
v_cvt_pk_bf16_f32 v198, v28, v29
v_cvt_pk_bf16_f32 v199, v30, v31
v_dot2_f32_bf16 v24, v200, s38, v22
v_dot2_f32_bf16 v25, v200, s39, v22
v_dot2_f32_bf16 v26, v201, s38, v22
v_dot2_f32_bf16 v27, v201, s39, v22
buffer_load_dwordx4 v2, s[8:11], s40 offen offset:3072 sc1 lds
v_dot2_f32_bf16 v28, v202, s38, v22
v_dot2_f32_bf16 v29, v202, s39, v22
v_dot2_f32_bf16 v30, v203, s38, v22
v_dot2_f32_bf16 v31, v203, s39, v22
v_cvt_pk_bf16_f32 v200, v24, v25
v_cvt_pk_bf16_f32 v201, v26, v27
v_cvt_pk_bf16_f32 v202, v28, v29
v_cvt_pk_bf16_f32 v203, v30, v31
v_dot2_f32_bf16 v24, v204, s38, v23
v_dot2_f32_bf16 v25, v204, s39, v23
v_dot2_f32_bf16 v26, v205, s38, v23
v_dot2_f32_bf16 v27, v205, s39, v23
v_dot2_f32_bf16 v28, v206, s38, v23
v_dot2_f32_bf16 v29, v206, s39, v23
v_dot2_f32_bf16 v30, v207, s38, v23
v_dot2_f32_bf16 v31, v207, s39, v23
v_cvt_pk_bf16_f32 v204, v24, v25
v_cvt_pk_bf16_f32 v205, v26, v27
v_cvt_pk_bf16_f32 v206, v28, v29
v_cvt_pk_bf16_f32 v207, v30, v31
s_branch L_tr_e
L_tr_d:
s_cmp_ge_u32 s2, 216
s_cbranch_scc1 L_tr_n
v_perm_b32 v176, v78, v76, s34
v_perm_b32 v177, v82, v80, s34
s_add_u32 m0, s33, 0
s_add_u32 s40, s32, 0
buffer_load_dwordx4 v2, s[8:11], s40 offen offset:0 sc1 lds
v_perm_b32 v178, v86, v84, s34
v_perm_b32 v179, v90, v88, s34
buffer_load_dwordx4 v2, s[8:11], s40 offen offset:1024 sc1 lds
v_perm_b32 v180, v78, v76, s35
v_perm_b32 v181, v82, v80, s35
buffer_load_dwordx4 v2, s[8:11], s40 offen offset:2048 sc1 lds
v_perm_b32 v182, v86, v84, s35
v_perm_b32 v183, v90, v88, s35
buffer_load_dwordx4 v2, s[8:11], s40 offen offset:3072 sc1 lds
v_perm_b32 v184, v79, v77, s34
v_perm_b32 v185, v83, v81, s34
s_add_u32 m0, s33, 4096
s_add_u32 s40, s32, 4096
buffer_load_dwordx4 v2, s[8:11], s40 offen offset:0 sc1 lds
v_perm_b32 v186, v87, v85, s34
v_perm_b32 v187, v91, v89, s34
buffer_load_dwordx4 v2, s[8:11], s40 offen offset:1024 sc1 lds
v_perm_b32 v188, v79, v77, s35
v_perm_b32 v189, v83, v81, s35
buffer_load_dwordx4 v2, s[8:11], s40 offen offset:2048 sc1 lds
v_perm_b32 v190, v87, v85, s35
v_perm_b32 v191, v91, v89, s35
buffer_load_dwordx4 v2, s[8:11], s40 offen offset:3072 sc1 lds
v_perm_b32 v192, v94, v92, s34
v_perm_b32 v193, v98, v96, s34
s_add_u32 m0, s33, 8192
s_add_u32 s40, s32, 8192
buffer_load_dwordx4 v2, s[8:11], s40 offen offset:0 sc1 lds
v_perm_b32 v194, v102, v100, s34
v_perm_b32 v195, v106, v104, s34
buffer_load_dwordx4 v2, s[8:11], s40 offen offset:1024 sc1 lds
v_perm_b32 v196, v94, v92, s35
v_perm_b32 v197, v98, v96, s35
buffer_load_dwordx4 v2, s[8:11], s40 offen offset:2048 sc1 lds
v_perm_b32 v198, v102, v100, s35
v_perm_b32 v199, v106, v104, s35
buffer_load_dwordx4 v2, s[8:11], s40 offen offset:3072 sc1 lds
v_perm_b32 v200, v95, v93, s34
v_perm_b32 v201, v99, v97, s34
s_add_u32 m0, s33, 12288
s_add_u32 s40, s32, 12288
buffer_load_dwordx4 v2, s[8:11], s40 offen offset:0 sc1 lds
v_perm_b32 v202, v103, v101, s34
v_perm_b32 v203, v107, v105, s34
buffer_load_dwordx4 v2, s[8:11], s40 offen offset:1024 sc1 lds
v_perm_b32 v204, v95, v93, s35
v_perm_b32 v205, v99, v97, s35
buffer_load_dwordx4 v2, s[8:11], s40 offen offset:2048 sc1 lds
v_perm_b32 v206, v103, v101, s35
v_perm_b32 v207, v107, v105, s35
buffer_load_dwordx4 v2, s[8:11], s40 offen offset:3072 sc1 lds
v_lshl_or_b32 v208, v109, 16, v108
v_lshl_or_b32 v209, v111, 16, v110
s_add_u32 m0, s33, 16384
s_add_u32 s40, s32, 16384
buffer_load_dwordx4 v2, s[8:11], s40 offen offset:0 sc1 lds
v_lshl_or_b32 v210, v113, 16, v112
v_lshl_or_b32 v211, v115, 16, v114
buffer_load_dwordx4 v2, s[8:11], s40 offen offset:1024 sc1 lds
v_perm_b32 v212, v118, v116, s34
v_perm_b32 v213, v122, v120, s34
buffer_load_dwordx4 v2, s[8:11], s40 offen offset:2048 sc1 lds
v_perm_b32 v214, v126, v124, s34
v_perm_b32 v215, v130, v128, s34
buffer_load_dwordx4 v2, s[8:11], s40 offen offset:3072 sc1 lds
v_perm_b32 v216, v118, v116, s35
v_perm_b32 v217, v122, v120, s35
s_add_u32 m0, s33, 20480
s_add_u32 s40, s32, 20480
buffer_load_dwordx4 v2, s[8:11], s40 offen offset:0 sc1 lds
v_perm_b32 v218, v126, v124, s35
v_perm_b32 v219, v130, v128, s35
buffer_load_dwordx4 v2, s[8:11], s40 offen offset:1024 sc1 lds
v_perm_b32 v220, v119, v117, s34
v_perm_b32 v221, v123, v121, s34
buffer_load_dwordx4 v2, s[8:11], s40 offen offset:2048 sc1 lds
v_perm_b32 v222, v127, v125, s34
v_perm_b32 v223, v131, v129, s34
buffer_load_dwordx4 v2, s[8:11], s40 offen offset:3072 sc1 lds
v_perm_b32 v224, v119, v117, s35
v_perm_b32 v225, v123, v121, s35
s_add_u32 m0, s33, 24576
s_add_u32 s40, s32, 24576
buffer_load_dwordx4 v2, s[8:11], s40 offen offset:0 sc1 lds
v_perm_b32 v226, v127, v125, s35
v_perm_b32 v227, v131, v129, s35
buffer_load_dwordx4 v2, s[8:11], s40 offen offset:1024 sc1 lds
v_perm_b32 v228, v134, v132, s34
v_perm_b32 v229, v138, v136, s34
buffer_load_dwordx4 v2, s[8:11], s40 offen offset:2048 sc1 lds
v_perm_b32 v230, v142, v140, s34
v_perm_b32 v231, v146, v144, s34
buffer_load_dwordx4 v2, s[8:11], s40 offen offset:3072 sc1 lds
v_perm_b32 v232, v134, v132, s35
v_perm_b32 v233, v138, v136, s35
s_add_u32 m0, s33, 28672
s_add_u32 s40, s32, 28672
buffer_load_dwordx4 v2, s[8:11], s40 offen offset:0 sc1 lds
v_perm_b32 v234, v142, v140, s35
v_perm_b32 v235, v146, v144, s35
buffer_load_dwordx4 v2, s[8:11], s40 offen offset:1024 sc1 lds
v_perm_b32 v236, v135, v133, s34
v_perm_b32 v237, v139, v137, s34
buffer_load_dwordx4 v2, s[8:11], s40 offen offset:2048 sc1 lds
v_perm_b32 v238, v143, v141, s34
v_perm_b32 v239, v147, v145, s34
buffer_load_dwordx4 v2, s[8:11], s40 offen offset:3072 sc1 lds
v_perm_b32 v240, v135, v133, s35
v_perm_b32 v241, v139, v137, s35
s_add_u32 m0, s33, 32768
s_add_u32 s40, s32, 32768
buffer_load_dwordx4 v2, s[8:11], s40 offen offset:0 sc1 lds
v_perm_b32 v242, v143, v141, s35
v_perm_b32 v243, v147, v145, s35
buffer_load_dwordx4 v2, s[8:11], s40 offen offset:1024 sc1 lds
v_lshl_or_b32 v244, v149, 16, v148
v_lshl_or_b32 v245, v151, 16, v150
buffer_load_dwordx4 v2, s[8:11], s40 offen offset:2048 sc1 lds
v_lshl_or_b32 v246, v153, 16, v152
v_lshl_or_b32 v247, v155, 16, v154
buffer_load_dwordx4 v2, s[8:11], s40 offen offset:3072 sc1 lds
s_branch L_tr_e
L_tr_n:
s_add_u32 m0, s33, 0
s_add_u32 s40, s32, 0
buffer_load_dwordx4 v2, s[8:11], s40 offen offset:0 sc1 lds
buffer_load_dwordx4 v2, s[8:11], s40 offen offset:1024 sc1 lds
buffer_load_dwordx4 v2, s[8:11], s40 offen offset:2048 sc1 lds
buffer_load_dwordx4 v2, s[8:11], s40 offen offset:3072 sc1 lds
s_add_u32 m0, s33, 4096
s_add_u32 s40, s32, 4096
buffer_load_dwordx4 v2, s[8:11], s40 offen offset:0 sc1 lds
buffer_load_dwordx4 v2, s[8:11], s40 offen offset:1024 sc1 lds
buffer_load_dwordx4 v2, s[8:11], s40 offen offset:2048 sc1 lds
buffer_load_dwordx4 v2, s[8:11], s40 offen offset:3072 sc1 lds
s_add_u32 m0, s33, 8192
s_add_u32 s40, s32, 8192
buffer_load_dwordx4 v2, s[8:11], s40 offen offset:0 sc1 lds
buffer_load_dwordx4 v2, s[8:11], s40 offen offset:1024 sc1 lds
buffer_load_dwordx4 v2, s[8:11], s40 offen offset:2048 sc1 lds
buffer_load_dwordx4 v2, s[8:11], s40 offen offset:3072 sc1 lds
s_add_u32 m0, s33, 12288
s_add_u32 s40, s32, 12288
buffer_load_dwordx4 v2, s[8:11], s40 offen offset:0 sc1 lds
buffer_load_dwordx4 v2, s[8:11], s40 offen offset:1024 sc1 lds
buffer_load_dwordx4 v2, s[8:11], s40 offen offset:2048 sc1 lds
buffer_load_dwordx4 v2, s[8:11], s40 offen offset:3072 sc1 lds
s_add_u32 m0, s33, 16384
s_add_u32 s40, s32, 16384
buffer_load_dwordx4 v2, s[8:11], s40 offen offset:0 sc1 lds
buffer_load_dwordx4 v2, s[8:11], s40 offen offset:1024 sc1 lds
buffer_load_dwordx4 v2, s[8:11], s40 offen offset:2048 sc1 lds
buffer_load_dwordx4 v2, s[8:11], s40 offen offset:3072 sc1 lds
s_add_u32 m0, s33, 20480
s_add_u32 s40, s32, 20480
buffer_load_dwordx4 v2, s[8:11], s40 offen offset:0 sc1 lds
buffer_load_dwordx4 v2, s[8:11], s40 offen offset:1024 sc1 lds
buffer_load_dwordx4 v2, s[8:11], s40 offen offset:2048 sc1 lds
buffer_load_dwordx4 v2, s[8:11], s40 offen offset:3072 sc1 lds
s_add_u32 m0, s33, 24576
s_add_u32 s40, s32, 24576
buffer_load_dwordx4 v2, s[8:11], s40 offen offset:0 sc1 lds
buffer_load_dwordx4 v2, s[8:11], s40 offen offset:1024 sc1 lds
buffer_load_dwordx4 v2, s[8:11], s40 offen offset:2048 sc1 lds
buffer_load_dwordx4 v2, s[8:11], s40 offen offset:3072 sc1 lds
s_add_u32 m0, s33, 28672
s_add_u32 s40, s32, 28672
buffer_load_dwordx4 v2, s[8:11], s40 offen offset:0 sc1 lds
buffer_load_dwordx4 v2, s[8:11], s40 offen offset:1024 sc1 lds
buffer_load_dwordx4 v2, s[8:11], s40 offen offset:2048 sc1 lds
buffer_load_dwordx4 v2, s[8:11], s40 offen offset:3072 sc1 lds
s_add_u32 m0, s33, 32768
s_add_u32 s40, s32, 32768
buffer_load_dwordx4 v2, s[8:11], s40 offen offset:0 sc1 lds
buffer_load_dwordx4 v2, s[8:11], s40 offen offset:1024 sc1 lds
buffer_load_dwordx4 v2, s[8:11], s40 offen offset:2048 sc1 lds
buffer_load_dwordx4 v2, s[8:11], s40 offen offset:3072 sc1 lds
L_tr_e:
s_mov_b32 s35, s37
buffer_load_dwordx4 a[0:3], v2, s[8:11], s26 offen offset:0 sc1
buffer_load_dwordx4 a[72:75], v2, s[8:11], s27 offen offset:0 sc1
buffer_load_dwordx4 a[144:147], v3, s[8:11], s28 offen offset:0 sc1
buffer_load_dwordx4 a[4:7], v2, s[8:11], s26 offen offset:1024 sc1
buffer_load_dwordx4 a[76:79], v2, s[8:11], s27 offen offset:1024 sc1
buffer_load_dwordx4 a[148:151], v3, s[8:11], s28 offen offset:1024 sc1
buffer_load_dwordx4 a[8:11], v2, s[8:11], s26 offen offset:2048 sc1
buffer_load_dwordx4 a[80:83], v2, s[8:11], s27 offen offset:2048 sc1
buffer_load_dwordx4 a[152:155], v3, s[8:11], s28 offen offset:2048 sc1
buffer_load_dwordx4 a[12:15], v2, s[8:11], s26 offen offset:3072 sc1
buffer_load_dwordx4 a[84:87], v2, s[8:11], s27 offen offset:3072 sc1
buffer_load_dwordx4 a[156:159], v3, s[8:11], s28 offen offset:3072 sc1
s_add_u32 s26, s26, 4096
s_add_u32 s27, s27, 4096
s_add_u32 s28, s28, 4096
buffer_load_dwordx4 a[16:19], v2, s[8:11], s26 offen offset:0 sc1
buffer_load_dwordx4 a[88:91], v2, s[8:11], s27 offen offset:0 sc1
buffer_load_dwordx4 a[160:163], v3, s[8:11], s28 offen offset:0 sc1
buffer_load_dwordx4 a[20:23], v2, s[8:11], s26 offen offset:1024 sc1
buffer_load_dwordx4 a[92:95], v2, s[8:11], s27 offen offset:1024 sc1
buffer_load_dwordx4 a[164:167], v3, s[8:11], s28 offen offset:1024 sc1
buffer_load_dwordx4 a[24:27], v2, s[8:11], s26 offen offset:2048 sc1
buffer_load_dwordx4 a[96:99], v2, s[8:11], s27 offen offset:2048 sc1
buffer_load_dwordx4 a[168:171], v3, s[8:11], s28 offen offset:2048 sc1
buffer_load_dwordx4 a[28:31], v2, s[8:11], s26 offen offset:3072 sc1
buffer_load_dwordx4 a[100:103], v2, s[8:11], s27 offen offset:3072 sc1
buffer_load_dwordx4 a[172:175], v3, s[8:11], s28 offen offset:3072 sc1
v_lshrrev_b32 v13, 4, v1
v_lshlrev_b32 v14, 2, v13
v_sub_u32 v14, v12, v14
v_subrev_u32 v15, 0, v14
v_cmp_gt_u32 s[52:53], 8, v15
v_cmp_gt_i32 s[44:45], -8, v15
v_subrev_u32 v15, 1, v14
v_cmp_gt_u32 s[54:55], 8, v15
v_cmp_gt_i32 s[46:47], -8, v15
v_subrev_u32 v15, 2, v14
v_cmp_gt_u32 s[56:57], 8, v15
v_cmp_gt_i32 s[48:49], -8, v15
v_subrev_u32 v15, 3, v14
v_cmp_gt_u32 s[58:59], 8, v15
v_cmp_gt_i32 s[50:51], -8, v15
s_and_b32 s31, s20, 7
s_or_b32 s31, s31, s4
s_cmp_eq_u32 s31, 0
s_cselect_b64 s[60:61], 0, s[44:45]
s_cselect_b64 s[62:63], 0, s[46:47]
s_cselect_b64 s[64:65], 0, s[48:49]
s_cselect_b64 s[66:67], 0, s[50:51]
s_waitcnt vmcnt(24)
s_barrier
ds_read_b128 a[216:219], v2 offset:0
ds_read_b128 a[220:223], v2 offset:8192
ds_read_b128 a[224:227], v2 offset:1024
ds_read_b128 a[228:231], v2 offset:9216
ds_read_b128 a[232:235], v2 offset:2048
ds_read_b128 a[236:239], v2 offset:10240
s_waitcnt vmcnt(18)
s_waitcnt lgkmcnt(4)
v_mfma_f32_16x16x32_bf16 v[32:35], a[216:219], a[0:3], 0
s_add_u32 s26, s26, 4096
s_add_u32 s27, s27, 4096
s_add_u32 s28, s28, 4096
buffer_load_dwordx4 a[32:35], v2, s[8:11], s26 offen offset:0 sc1
v_mfma_f32_16x16x32_bf16 v[32:35], a[220:223], a[4:7], v[32:35]
ds_read_b128 a[240:243], v2 offset:3072
v_dot2_f32_bf16 v24, v208, s38, v20
v_mfma_f32_16x16x32_bf16 v[36:39], a[216:219], a[72:75], 0
v_dot2_f32_bf16 v25, v208, s39, v20
v_dot2_f32_bf16 v26, v209, s38, v20
v_mfma_f32_16x16x32_bf16 v[36:39], a[220:223], a[76:79], v[36:39]
ds_read_b128 a[244:247], v2 offset:11264
s_waitcnt lgkmcnt(4)
v_mfma_f32_16x16x32_bf16 v[40:43], a[224:227], a[0:3], 0
buffer_load_dwordx4 a[104:107], v2, s[8:11], s27 offen offset:0 sc1
v_mfma_f32_16x16x32_bf16 v[40:43], a[228:231], a[4:7], v[40:43]
ds_read_b128 a[216:219], v2 offset:4096
v_dot2_f32_bf16 v27, v209, s39, v20
v_mfma_f32_16x16x32_bf16 v[44:47], a[224:227], a[72:75], 0
v_dot2_f32_bf16 v28, v210, s38, v20
v_dot2_f32_bf16 v29, v210, s39, v20
v_mfma_f32_16x16x32_bf16 v[44:47], a[228:231], a[76:79], v[44:47]
ds_read_b128 a[220:223], v2 offset:12288
s_waitcnt lgkmcnt(4)
v_mfma_f32_16x16x32_bf16 v[48:51], a[232:235], a[0:3], 0
buffer_load_dwordx4 a[176:179], v3, s[8:11], s28 offen offset:0 sc1
v_mfma_f32_16x16x32_bf16 v[48:51], a[236:239], a[4:7], v[48:51]
ds_read_b128 a[224:227], v2 offset:5120
v_dot2_f32_bf16 v30, v211, s38, v20
v_mfma_f32_16x16x32_bf16 v[52:55], a[232:235], a[72:75], 0
v_dot2_f32_bf16 v31, v211, s39, v20
v_cvt_pk_bf16_f32 v208, v24, v25
v_mfma_f32_16x16x32_bf16 v[52:55], a[236:239], a[76:79], v[52:55]
ds_read_b128 a[228:231], v2 offset:13312
s_waitcnt lgkmcnt(4)
v_mfma_f32_16x16x32_bf16 v[56:59], a[240:243], a[0:3], 0
buffer_load_dwordx4 a[36:39], v2, s[8:11], s26 offen offset:1024 sc1
v_mfma_f32_16x16x32_bf16 v[56:59], a[244:247], a[4:7], v[56:59]
ds_read_b128 a[232:235], v2 offset:6144
v_cvt_pk_bf16_f32 v209, v26, v27
v_mfma_f32_16x16x32_bf16 v[60:63], a[240:243], a[72:75], 0
v_cvt_pk_bf16_f32 v210, v28, v29
v_cvt_pk_bf16_f32 v211, v30, v31
v_mfma_f32_16x16x32_bf16 v[60:63], a[244:247], a[76:79], v[60:63]
ds_read_b128 a[236:239], v2 offset:14336
s_waitcnt lgkmcnt(4)
v_mfma_f32_16x16x32_bf16 v[64:67], a[216:219], a[0:3], 0
buffer_load_dwordx4 a[108:111], v2, s[8:11], s27 offen offset:1024 sc1
v_mfma_f32_16x16x32_bf16 v[64:67], a[220:223], a[4:7], v[64:67]
ds_read_b128 a[240:243], v2 offset:7168
v_dot2_f32_bf16 v24, v212, s38, v21
v_mfma_f32_16x16x32_bf16 v[68:71], a[216:219], a[72:75], 0
v_dot2_f32_bf16 v25, v212, s39, v21
v_dot2_f32_bf16 v26, v213, s38, v21
v_mfma_f32_16x16x32_bf16 v[68:71], a[220:223], a[76:79], v[68:71]
ds_read_b128 a[244:247], v2 offset:15360
s_waitcnt lgkmcnt(4)
v_mfma_f32_16x16x32_bf16 v[72:75], a[0:3], a[224:227], 0
buffer_load_dwordx4 a[180:183], v3, s[8:11], s28 offen offset:1024 sc1
v_mfma_f32_16x16x32_bf16 v[72:75], a[4:7], a[228:231], v[72:75]
ds_read_b128 a[216:219], v6 offset:0
v_dot2_f32_bf16 v27, v213, s39, v21
v_mfma_f32_16x16x32_bf16 v[76:79], a[72:75], a[224:227], 0
v_dot2_f32_bf16 v28, v214, s38, v21
v_dot2_f32_bf16 v29, v214, s39, v21
v_mfma_f32_16x16x32_bf16 v[76:79], a[76:79], a[228:231], v[76:79]
ds_read_b128 a[220:223], v6 offset:8192
s_waitcnt lgkmcnt(4)
v_mfma_f32_16x16x32_bf16 v[80:83], a[0:3], a[232:235], 0
buffer_load_dwordx4 a[40:43], v2, s[8:11], s26 offen offset:2048 sc1
v_mfma_f32_16x16x32_bf16 v[80:83], a[4:7], a[236:239], v[80:83]
ds_read_b128 a[224:227], v9 offset:0
v_dot2_f32_bf16 v30, v215, s38, v21
v_mfma_f32_16x16x32_bf16 v[84:87], a[72:75], a[232:235], 0
v_dot2_f32_bf16 v31, v215, s39, v21
v_cvt_pk_bf16_f32 v212, v24, v25
v_mfma_f32_16x16x32_bf16 v[84:87], a[76:79], a[236:239], v[84:87]
ds_read_b128 a[228:231], v9 offset:8192
s_waitcnt lgkmcnt(4)
v_mfma_f32_16x16x32_bf16 v[88:91], a[0:3], a[240:243], 0
buffer_load_dwordx4 a[112:115], v2, s[8:11], s27 offen offset:2048 sc1
v_mfma_f32_16x16x32_bf16 v[88:91], a[4:7], a[244:247], v[88:91]
ds_read_b128 a[232:235], v2 offset:16384
v_cvt_pk_bf16_f32 v213, v26, v27
v_mfma_f32_16x16x32_bf16 v[92:95], a[72:75], a[240:243], 0
v_cvt_pk_bf16_f32 v214, v28, v29
v_cvt_pk_bf16_f32 v215, v30, v31
v_mfma_f32_16x16x32_bf16 v[92:95], a[76:79], a[244:247], v[92:95]
ds_read_b128 a[236:239], v2 offset:24576
s_waitcnt lgkmcnt(4)
v_mfma_f32_16x16x32_bf16 v[96:99], a[216:219], a[144:147], 0
ds_read_b128 a[240:243], v2 offset:17408
buffer_load_dwordx4 a[184:187], v3, s[8:11], s28 offen offset:2048 sc1
v_mfma_f32_16x16x32_bf16 v[96:99], a[220:223], a[148:151], v[96:99]
ds_read_b128 a[244:247], v2 offset:25600
s_waitcnt lgkmcnt(4)
v_mfma_f32_16x16x32_bf16 v[100:103], a[144:147], a[224:227], 0
ds_read_b128 a[216:219], v2 offset:18432
v_dot2_f32_bf16 v24, v216, s38, v22
v_mfma_f32_16x16x32_bf16 v[100:103], a[148:151], a[228:231], v[100:103]
ds_read_b128 a[220:223], v2 offset:26624
s_waitcnt vmcnt(21)
s_waitcnt lgkmcnt(4)
v_mfma_f32_16x16x32_bf16 v[32:35], a[232:235], a[8:11], v[32:35]
buffer_load_dwordx4 a[44:47], v2, s[8:11], s26 offen offset:3072 sc1
v_mfma_f32_16x16x32_bf16 v[32:35], a[236:239], a[12:15], v[32:35]
ds_read_b128 a[224:227], v2 offset:19456
v_dot2_f32_bf16 v25, v216, s39, v22
v_mfma_f32_16x16x32_bf16 v[36:39], a[232:235], a[80:83], v[36:39]
v_dot2_f32_bf16 v26, v217, s38, v22
v_dot2_f32_bf16 v27, v217, s39, v22
v_mfma_f32_16x16x32_bf16 v[36:39], a[236:239], a[84:87], v[36:39]
ds_read_b128 a[228:231], v2 offset:27648
s_waitcnt lgkmcnt(4)
v_mfma_f32_16x16x32_bf16 v[40:43], a[240:243], a[8:11], v[40:43]
buffer_load_dwordx4 a[116:119], v2, s[8:11], s27 offen offset:3072 sc1
v_mfma_f32_16x16x32_bf16 v[40:43], a[244:247], a[12:15], v[40:43]
ds_read_b128 a[232:235], v2 offset:20480
v_dot2_f32_bf16 v28, v218, s38, v22
v_mfma_f32_16x16x32_bf16 v[44:47], a[240:243], a[80:83], v[44:47]
v_dot2_f32_bf16 v29, v218, s39, v22
v_dot2_f32_bf16 v30, v219, s38, v22
v_mfma_f32_16x16x32_bf16 v[44:47], a[244:247], a[84:87], v[44:47]
ds_read_b128 a[236:239], v2 offset:28672
s_waitcnt lgkmcnt(4)
v_mfma_f32_16x16x32_bf16 v[48:51], a[216:219], a[8:11], v[48:51]
buffer_load_dwordx4 a[188:191], v3, s[8:11], s28 offen offset:3072 sc1
v_mfma_f32_16x16x32_bf16 v[48:51], a[220:223], a[12:15], v[48:51]
ds_read_b128 a[240:243], v2 offset:21504
v_dot2_f32_bf16 v31, v219, s39, v22
v_mfma_f32_16x16x32_bf16 v[52:55], a[216:219], a[80:83], v[52:55]
v_cvt_pk_bf16_f32 v216, v24, v25
v_cvt_pk_bf16_f32 v217, v26, v27
v_mfma_f32_16x16x32_bf16 v[52:55], a[220:223], a[84:87], v[52:55]
ds_read_b128 a[244:247], v2 offset:29696
s_waitcnt lgkmcnt(4)
v_mfma_f32_16x16x32_bf16 v[56:59], a[224:227], a[8:11], v[56:59]
s_add_u32 s26, s26, 4096
s_add_u32 s27, s27, 4096
s_add_u32 s28, s28, 4096
buffer_load_dwordx4 a[48:51], v2, s[8:11], s26 offen offset:0 sc1
v_mfma_f32_16x16x32_bf16 v[56:59], a[228:231], a[12:15], v[56:59]
ds_read_b128 a[216:219], v2 offset:22528
v_cvt_pk_bf16_f32 v218, v28, v29
v_mfma_f32_16x16x32_bf16 v[60:63], a[224:227], a[80:83], v[60:63]
v_cvt_pk_bf16_f32 v219, v30, v31
v_dot2_f32_bf16 v24, v220, s38, v23
v_mfma_f32_16x16x32_bf16 v[60:63], a[228:231], a[84:87], v[60:63]
ds_read_b128 a[220:223], v2 offset:30720
s_waitcnt lgkmcnt(4)
v_mfma_f32_16x16x32_bf16 v[64:67], a[232:235], a[8:11], v[64:67]
buffer_load_dwordx4 a[120:123], v2, s[8:11], s27 offen offset:0 sc1
v_mfma_f32_16x16x32_bf16 v[64:67], a[236:239], a[12:15], v[64:67]
ds_read_b128 a[224:227], v2 offset:23552
v_dot2_f32_bf16 v25, v220, s39, v23
v_mfma_f32_16x16x32_bf16 v[68:71], a[232:235], a[80:83], v[68:71]
v_dot2_f32_bf16 v26, v221, s38, v23
v_dot2_f32_bf16 v27, v221, s39, v23
v_mfma_f32_16x16x32_bf16 v[68:71], a[236:239], a[84:87], v[68:71]
ds_read_b128 a[228:231], v2 offset:31744
s_waitcnt lgkmcnt(4)
v_mfma_f32_16x16x32_bf16 v[72:75], a[8:11], a[240:243], v[72:75]
buffer_load_dwordx4 a[192:195], v3, s[8:11], s28 offen offset:0 sc1
v_mfma_f32_16x16x32_bf16 v[72:75], a[12:15], a[244:247], v[72:75]
ds_read_b128 a[232:235], v6 offset:16384
v_dot2_f32_bf16 v28, v222, s38, v23
v_mfma_f32_16x16x32_bf16 v[76:79], a[80:83], a[240:243], v[76:79]
v_dot2_f32_bf16 v29, v222, s39, v23
v_dot2_f32_bf16 v30, v223, s38, v23
v_mfma_f32_16x16x32_bf16 v[76:79], a[84:87], a[244:247], v[76:79]
ds_read_b128 a[236:239], v6 offset:24576
s_waitcnt lgkmcnt(4)
v_mfma_f32_16x16x32_bf16 v[80:83], a[8:11], a[216:219], v[80:83]
buffer_load_dwordx4 a[52:55], v2, s[8:11], s26 offen offset:1024 sc1
v_mfma_f32_16x16x32_bf16 v[80:83], a[12:15], a[220:223], v[80:83]
ds_read_b128 a[240:243], v9 offset:16384
v_dot2_f32_bf16 v31, v223, s39, v23
v_mfma_f32_16x16x32_bf16 v[84:87], a[80:83], a[216:219], v[84:87]
v_cvt_pk_bf16_f32 v220, v24, v25
v_cvt_pk_bf16_f32 v221, v26, v27
v_mfma_f32_16x16x32_bf16 v[84:87], a[84:87], a[220:223], v[84:87]
ds_read_b128 a[244:247], v9 offset:24576
s_waitcnt lgkmcnt(4)
v_mfma_f32_16x16x32_bf16 v[88:91], a[8:11], a[224:227], v[88:91]
buffer_load_dwordx4 a[124:127], v2, s[8:11], s27 offen offset:1024 sc1
v_mfma_f32_16x16x32_bf16 v[88:91], a[12:15], a[228:231], v[88:91]
ds_read_b128 a[216:219], v2 offset:32768
v_cvt_pk_bf16_f32 v222, v28, v29
v_mfma_f32_16x16x32_bf16 v[92:95], a[80:83], a[224:227], v[92:95]
v_cvt_pk_bf16_f32 v223, v30, v31
v_dot2_f32_bf16 v24, v224, s38, v20
v_mfma_f32_16x16x32_bf16 v[92:95], a[84:87], a[228:231], v[92:95]
ds_read_b128 a[220:223], v2 offset:40960
s_waitcnt lgkmcnt(4)
v_mfma_f32_16x16x32_bf16 v[96:99], a[232:235], a[152:155], v[96:99]
ds_read_b128 a[224:227], v2 offset:33792
buffer_load_dwordx4 a[196:199], v3, s[8:11], s28 offen offset:1024 sc1
v_mfma_f32_16x16x32_bf16 v[96:99], a[236:239], a[156:159], v[96:99]
ds_read_b128 a[228:231], v2 offset:41984
s_waitcnt lgkmcnt(4)
v_mfma_f32_16x16x32_bf16 v[100:103], a[152:155], a[240:243], v[100:103]
ds_read_b128 a[232:235], v2 offset:34816
v_dot2_f32_bf16 v25, v224, s39, v20
v_mfma_f32_16x16x32_bf16 v[100:103], a[156:159], a[244:247], v[100:103]
ds_read_b128 a[236:239], v2 offset:43008
s_waitcnt vmcnt(24)
s_waitcnt lgkmcnt(4)
v_mfma_f32_16x16x32_bf16 v[32:35], a[216:219], a[16:19], v[32:35]
buffer_load_dwordx4 a[56:59], v2, s[8:11], s26 offen offset:2048 sc1
v_mfma_f32_16x16x32_bf16 v[32:35], a[220:223], a[20:23], v[32:35]
ds_read_b128 a[240:243], v2 offset:35840
v_dot2_f32_bf16 v26, v225, s38, v20
v_mfma_f32_16x16x32_bf16 v[36:39], a[216:219], a[88:91], v[36:39]
v_dot2_f32_bf16 v27, v225, s39, v20
v_dot2_f32_bf16 v28, v226, s38, v20
v_mfma_f32_16x16x32_bf16 v[36:39], a[220:223], a[92:95], v[36:39]
ds_read_b128 a[244:247], v2 offset:44032
s_waitcnt lgkmcnt(4)
v_mfma_f32_16x16x32_bf16 v[40:43], a[224:227], a[16:19], v[40:43]
buffer_load_dwordx4 a[128:131], v2, s[8:11], s27 offen offset:2048 sc1
v_mfma_f32_16x16x32_bf16 v[40:43], a[228:231], a[20:23], v[40:43]
ds_read_b128 a[216:219], v2 offset:36864
v_dot2_f32_bf16 v29, v226, s39, v20
v_mfma_f32_16x16x32_bf16 v[44:47], a[224:227], a[88:91], v[44:47]
v_dot2_f32_bf16 v30, v227, s38, v20
v_dot2_f32_bf16 v31, v227, s39, v20
v_mfma_f32_16x16x32_bf16 v[44:47], a[228:231], a[92:95], v[44:47]
ds_read_b128 a[220:223], v2 offset:45056
s_waitcnt lgkmcnt(4)
v_mfma_f32_16x16x32_bf16 v[48:51], a[232:235], a[16:19], v[48:51]
buffer_load_dwordx4 a[200:203], v3, s[8:11], s28 offen offset:2048 sc1
v_mfma_f32_16x16x32_bf16 v[48:51], a[236:239], a[20:23], v[48:51]
ds_read_b128 a[224:227], v2 offset:37888
v_cvt_pk_bf16_f32 v224, v24, v25
v_mfma_f32_16x16x32_bf16 v[52:55], a[232:235], a[88:91], v[52:55]
v_cvt_pk_bf16_f32 v225, v26, v27
v_cvt_pk_bf16_f32 v226, v28, v29
v_mfma_f32_16x16x32_bf16 v[52:55], a[236:239], a[92:95], v[52:55]
ds_read_b128 a[228:231], v2 offset:46080
s_waitcnt lgkmcnt(4)
v_mfma_f32_16x16x32_bf16 v[56:59], a[240:243], a[16:19], v[56:59]
buffer_load_dwordx4 a[60:63], v2, s[8:11], s26 offen offset:3072 sc1
v_mfma_f32_16x16x32_bf16 v[56:59], a[244:247], a[20:23], v[56:59]
ds_read_b128 a[232:235], v2 offset:38912
v_cvt_pk_bf16_f32 v227, v30, v31
v_mfma_f32_16x16x32_bf16 v[60:63], a[240:243], a[88:91], v[60:63]
v_dot2_f32_bf16 v24, v228, s38, v21
v_dot2_f32_bf16 v25, v228, s39, v21
v_mfma_f32_16x16x32_bf16 v[60:63], a[244:247], a[92:95], v[60:63]
ds_read_b128 a[236:239], v2 offset:47104
s_waitcnt lgkmcnt(4)
v_mfma_f32_16x16x32_bf16 v[64:67], a[216:219], a[16:19], v[64:67]
buffer_load_dwordx4 a[132:135], v2, s[8:11], s27 offen offset:3072 sc1
v_mfma_f32_16x16x32_bf16 v[64:67], a[220:223], a[20:23], v[64:67]
ds_read_b128 a[240:243], v2 offset:39936
v_dot2_f32_bf16 v26, v229, s38, v21
v_mfma_f32_16x16x32_bf16 v[68:71], a[216:219], a[88:91], v[68:71]
v_dot2_f32_bf16 v27, v229, s39, v21
v_dot2_f32_bf16 v28, v230, s38, v21
v_mfma_f32_16x16x32_bf16 v[68:71], a[220:223], a[92:95], v[68:71]
ds_read_b128 a[244:247], v2 offset:48128
s_waitcnt lgkmcnt(4)
v_mfma_f32_16x16x32_bf16 v[72:75], a[16:19], a[224:227], v[72:75]
buffer_load_dwordx4 a[204:207], v3, s[8:11], s28 offen offset:3072 sc1
v_mfma_f32_16x16x32_bf16 v[72:75], a[20:23], a[228:231], v[72:75]
ds_read_b128 a[216:219], v6 offset:32768
v_dot2_f32_bf16 v29, v230, s39, v21
v_mfma_f32_16x16x32_bf16 v[76:79], a[88:91], a[224:227], v[76:79]
v_dot2_f32_bf16 v30, v231, s38, v21
v_dot2_f32_bf16 v31, v231, s39, v21
v_mfma_f32_16x16x32_bf16 v[76:79], a[92:95], a[228:231], v[76:79]
ds_read_b128 a[220:223], v6 offset:40960
s_waitcnt lgkmcnt(4)
v_mfma_f32_16x16x32_bf16 v[80:83], a[16:19], a[232:235], v[80:83]
s_add_u32 s26, s26, 4096
s_add_u32 s27, s27, 4096
s_add_u32 s28, s28, 4096
buffer_load_dwordx4 a[64:67], v2, s[8:11], s26 offen offset:0 sc1
v_mfma_f32_16x16x32_bf16 v[80:83], a[20:23], a[236:239], v[80:83]
ds_read_b128 a[224:227], v9 offset:32768
v_cvt_pk_bf16_f32 v228, v24, v25
v_mfma_f32_16x16x32_bf16 v[84:87], a[88:91], a[232:235], v[84:87]
v_cvt_pk_bf16_f32 v229, v26, v27
v_cvt_pk_bf16_f32 v230, v28, v29
v_mfma_f32_16x16x32_bf16 v[84:87], a[92:95], a[236:239], v[84:87]
ds_read_b128 a[228:231], v9 offset:40960
s_waitcnt lgkmcnt(4)
v_mfma_f32_16x16x32_bf16 v[88:91], a[16:19], a[240:243], v[88:91]
buffer_load_dwordx4 a[136:139], v2, s[8:11], s27 offen offset:0 sc1
v_mfma_f32_16x16x32_bf16 v[88:91], a[20:23], a[244:247], v[88:91]
ds_read_b128 a[232:235], v2 offset:49152
v_cvt_pk_bf16_f32 v231, v30, v31
v_mfma_f32_16x16x32_bf16 v[92:95], a[88:91], a[240:243], v[92:95]
v_dot2_f32_bf16 v24, v232, s38, v22
v_dot2_f32_bf16 v25, v232, s39, v22
v_mfma_f32_16x16x32_bf16 v[92:95], a[92:95], a[244:247], v[92:95]
ds_read_b128 a[236:239], v2 offset:57344
s_waitcnt lgkmcnt(4)
v_mfma_f32_16x16x32_bf16 v[96:99], a[216:219], a[160:163], v[96:99]
ds_read_b128 a[240:243], v2 offset:50176
buffer_load_dwordx4 a[208:211], v3, s[8:11], s28 offen offset:0 sc1
v_mfma_f32_16x16x32_bf16 v[96:99], a[220:223], a[164:167], v[96:99]
ds_read_b128 a[244:247], v2 offset:58368
s_waitcnt lgkmcnt(4)
v_mfma_f32_16x16x32_bf16 v[100:103], a[160:163], a[224:227], v[100:103]
ds_read_b128 a[216:219], v2 offset:51200
v_dot2_f32_bf16 v26, v233, s38, v22
v_mfma_f32_16x16x32_bf16 v[100:103], a[164:167], a[228:231], v[100:103]
ds_read_b128 a[220:223], v2 offset:59392
s_waitcnt vmcnt(27)
s_waitcnt lgkmcnt(4)
v_mfma_f32_16x16x32_bf16 v[32:35], a[232:235], a[24:27], v[32:35]
buffer_load_dwordx4 a[68:71], v2, s[8:11], s26 offen offset:1024 sc1
v_mfma_f32_16x16x32_bf16 v[32:35], a[236:239], a[28:31], v[32:35]
ds_read_b128 a[224:227], v2 offset:52224
v_dot2_f32_bf16 v27, v233, s39, v22
v_mfma_f32_16x16x32_bf16 v[36:39], a[232:235], a[96:99], v[36:39]
v_dot2_f32_bf16 v28, v234, s38, v22
v_dot2_f32_bf16 v29, v234, s39, v22
v_mfma_f32_16x16x32_bf16 v[36:39], a[236:239], a[100:103], v[36:39]
ds_read_b128 a[228:231], v2 offset:60416
s_waitcnt lgkmcnt(4)
v_mfma_f32_16x16x32_bf16 v[40:43], a[240:243], a[24:27], v[40:43]
buffer_load_dwordx4 a[140:143], v2, s[8:11], s27 offen offset:1024 sc1
v_mfma_f32_16x16x32_bf16 v[40:43], a[244:247], a[28:31], v[40:43]
ds_read_b128 a[232:235], v2 offset:53248
v_dot2_f32_bf16 v30, v235, s38, v22
v_mfma_f32_16x16x32_bf16 v[44:47], a[240:243], a[96:99], v[44:47]
v_dot2_f32_bf16 v31, v235, s39, v22
v_cvt_pk_bf16_f32 v232, v24, v25
v_mfma_f32_16x16x32_bf16 v[44:47], a[244:247], a[100:103], v[44:47]
ds_read_b128 a[236:239], v2 offset:61440
s_waitcnt lgkmcnt(4)
v_mfma_f32_16x16x32_bf16 v[48:51], a[216:219], a[24:27], v[48:51]
buffer_load_dwordx4 a[212:215], v3, s[8:11], s28 offen offset:1024 sc1
v_mfma_f32_16x16x32_bf16 v[48:51], a[220:223], a[28:31], v[48:51]
ds_read_b128 a[240:243], v2 offset:54272
v_cvt_pk_bf16_f32 v233, v26, v27
v_mfma_f32_16x16x32_bf16 v[52:55], a[216:219], a[96:99], v[52:55]
v_cvt_pk_bf16_f32 v234, v28, v29
v_cvt_pk_bf16_f32 v235, v30, v31
v_mfma_f32_16x16x32_bf16 v[52:55], a[220:223], a[100:103], v[52:55]
ds_read_b128 a[244:247], v2 offset:62464
s_waitcnt lgkmcnt(4)
v_mfma_f32_16x16x32_bf16 v[56:59], a[224:227], a[24:27], v[56:59]
buffer_store_dwordx4 v[176:179], v156, s[8:11], 0 offen sc1
v_dot2_f32_bf16 v24, v236, s38, v23
v_mfma_f32_16x16x32_bf16 v[56:59], a[228:231], a[28:31], v[56:59]
ds_read_b128 a[216:219], v2 offset:55296
v_dot2_f32_bf16 v25, v236, s39, v23
v_mfma_f32_16x16x32_bf16 v[60:63], a[224:227], a[96:99], v[60:63]
v_dot2_f32_bf16 v26, v237, s38, v23
v_dot2_f32_bf16 v27, v237, s39, v23
v_mfma_f32_16x16x32_bf16 v[60:63], a[228:231], a[100:103], v[60:63]
ds_read_b128 a[220:223], v2 offset:63488
s_waitcnt lgkmcnt(4)
v_mfma_f32_16x16x32_bf16 v[64:67], a[232:235], a[24:27], v[64:67]
buffer_store_dwordx4 v[180:183], v157, s[8:11], 0 offen sc1
v_dot2_f32_bf16 v28, v238, s38, v23
v_mfma_f32_16x16x32_bf16 v[64:67], a[236:239], a[28:31], v[64:67]
ds_read_b128 a[224:227], v2 offset:56320
v_dot2_f32_bf16 v29, v238, s39, v23
v_mfma_f32_16x16x32_bf16 v[68:71], a[232:235], a[96:99], v[68:71]
v_dot2_f32_bf16 v30, v239, s38, v23
v_dot2_f32_bf16 v31, v239, s39, v23
v_mfma_f32_16x16x32_bf16 v[68:71], a[236:239], a[100:103], v[68:71]
ds_read_b128 a[228:231], v2 offset:64512
s_waitcnt lgkmcnt(4)
v_mfma_f32_16x16x32_bf16 v[72:75], a[24:27], a[240:243], v[72:75]
buffer_store_dwordx4 v[184:187], v158, s[8:11], 0 offen sc1
v_cvt_pk_bf16_f32 v236, v24, v25
v_mfma_f32_16x16x32_bf16 v[72:75], a[28:31], a[244:247], v[72:75]
ds_read_b128 a[232:235], v6 offset:49152
v_cvt_pk_bf16_f32 v237, v26, v27
v_mfma_f32_16x16x32_bf16 v[76:79], a[96:99], a[240:243], v[76:79]
v_cvt_pk_bf16_f32 v238, v28, v29
v_cvt_pk_bf16_f32 v239, v30, v31
v_mfma_f32_16x16x32_bf16 v[76:79], a[100:103], a[244:247], v[76:79]
ds_read_b128 a[236:239], v6 offset:57344
s_waitcnt lgkmcnt(4)
v_mfma_f32_16x16x32_bf16 v[80:83], a[24:27], a[216:219], v[80:83]
buffer_store_dwordx4 v[188:191], v159, s[8:11], 0 offen sc1
v_dot2_f32_bf16 v24, v240, s38, v20
v_mfma_f32_16x16x32_bf16 v[80:83], a[28:31], a[220:223], v[80:83]
ds_read_b128 a[240:243], v9 offset:49152
v_dot2_f32_bf16 v25, v240, s39, v20
v_mfma_f32_16x16x32_bf16 v[84:87], a[96:99], a[216:219], v[84:87]
v_dot2_f32_bf16 v26, v241, s38, v20
v_dot2_f32_bf16 v27, v241, s39, v20
v_mfma_f32_16x16x32_bf16 v[84:87], a[100:103], a[220:223], v[84:87]
ds_read_b128 a[244:247], v9 offset:57344
s_waitcnt lgkmcnt(4)
v_mfma_f32_16x16x32_bf16 v[88:91], a[24:27], a[224:227], v[88:91]
buffer_store_dwordx4 v[192:195], v160, s[8:11], 0 offen sc1
v_dot2_f32_bf16 v28, v242, s38, v20
v_mfma_f32_16x16x32_bf16 v[88:91], a[28:31], a[228:231], v[88:91]
ds_read_b128 a[216:219], v4 offset:0
v_dot2_f32_bf16 v29, v242, s39, v20
v_mfma_f32_16x16x32_bf16 v[92:95], a[96:99], a[224:227], v[92:95]
v_dot2_f32_bf16 v30, v243, s38, v20
v_dot2_f32_bf16 v31, v243, s39, v20
v_mfma_f32_16x16x32_bf16 v[92:95], a[100:103], a[228:231], v[92:95]
ds_read_b128 a[220:223], v4 offset:8192
s_waitcnt lgkmcnt(4)
v_mfma_f32_16x16x32_bf16 v[96:99], a[232:235], a[168:171], v[96:99]
ds_read_b128 a[224:227], v4 offset:1024
buffer_store_dwordx4 v[196:199], v161, s[8:11], 0 offen sc1
v_cvt_pk_bf16_f32 v240, v24, v25
v_mfma_f32_16x16x32_bf16 v[96:99], a[236:239], a[172:175], v[96:99]
ds_read_b128 a[228:231], v4 offset:9216
s_waitcnt lgkmcnt(4)
v_mfma_f32_16x16x32_bf16 v[100:103], a[168:171], a[240:243], v[100:103]
ds_read_b128 a[232:235], v4 offset:2048
v_cvt_pk_bf16_f32 v241, v26, v27
v_mfma_f32_16x16x32_bf16 v[100:103], a[172:175], a[244:247], v[100:103]
ds_read_b128 a[236:239], v4 offset:10240
s_waitcnt vmcnt(30)
s_waitcnt lgkmcnt(4)
v_mfma_f32_16x16x32_bf16 v[32:35], a[216:219], a[32:35], v[32:35]
buffer_store_dwordx4 v[200:203], v162, s[8:11], 0 offen sc1
v_cvt_pk_bf16_f32 v242, v28, v29
v_mfma_f32_16x16x32_bf16 v[32:35], a[220:223], a[36:39], v[32:35]
ds_read_b128 a[240:243], v4 offset:3072
v_cvt_pk_bf16_f32 v243, v30, v31
v_mfma_f32_16x16x32_bf16 v[36:39], a[216:219], a[104:107], v[36:39]
v_dot2_f32_bf16 v24, v244, s38, v21
v_dot2_f32_bf16 v25, v244, s39, v21
v_mfma_f32_16x16x32_bf16 v[36:39], a[220:223], a[108:111], v[36:39]
ds_read_b128 a[244:247], v4 offset:11264
s_waitcnt lgkmcnt(4)
v_mfma_f32_16x16x32_bf16 v[40:43], a[224:227], a[32:35], v[40:43]
buffer_store_dwordx4 v[204:207], v163, s[8:11], 0 offen sc1
v_dot2_f32_bf16 v26, v245, s38, v21
v_mfma_f32_16x16x32_bf16 v[40:43], a[228:231], a[36:39], v[40:43]
ds_read_b128 a[216:219], v4 offset:4096
v_dot2_f32_bf16 v27, v245, s39, v21
v_mfma_f32_16x16x32_bf16 v[44:47], a[224:227], a[104:107], v[44:47]
v_dot2_f32_bf16 v28, v246, s38, v21
v_dot2_f32_bf16 v29, v246, s39, v21
v_mfma_f32_16x16x32_bf16 v[44:47], a[228:231], a[108:111], v[44:47]
ds_read_b128 a[220:223], v4 offset:12288
s_waitcnt lgkmcnt(4)
v_mfma_f32_16x16x32_bf16 v[48:51], a[232:235], a[32:35], v[48:51]
buffer_store_dwordx4 v[208:211], v164, s[8:11], 0 offen sc1
v_dot2_f32_bf16 v30, v247, s38, v21
v_mfma_f32_16x16x32_bf16 v[48:51], a[236:239], a[36:39], v[48:51]
ds_read_b128 a[224:227], v4 offset:5120
v_dot2_f32_bf16 v31, v247, s39, v21
v_mfma_f32_16x16x32_bf16 v[52:55], a[232:235], a[104:107], v[52:55]
v_cvt_pk_bf16_f32 v244, v24, v25
v_cvt_pk_bf16_f32 v245, v26, v27
v_mfma_f32_16x16x32_bf16 v[52:55], a[236:239], a[108:111], v[52:55]
ds_read_b128 a[228:231], v4 offset:13312
s_waitcnt lgkmcnt(4)
v_mfma_f32_16x16x32_bf16 v[56:59], a[240:243], a[32:35], v[56:59]
buffer_store_dwordx4 v[212:215], v165, s[8:11], 0 offen sc1
v_cvt_pk_bf16_f32 v246, v28, v29
v_mfma_f32_16x16x32_bf16 v[56:59], a[244:247], a[36:39], v[56:59]
ds_read_b128 a[232:235], v4 offset:6144
v_cvt_pk_bf16_f32 v247, v30, v31
v_mfma_f32_16x16x32_bf16 v[60:63], a[240:243], a[104:107], v[60:63]
v_dot2_f32_bf16 v24, v248, s38, v22
v_dot2_f32_bf16 v25, v248, s39, v22
v_mfma_f32_16x16x32_bf16 v[60:63], a[244:247], a[108:111], v[60:63]
ds_read_b128 a[236:239], v4 offset:14336
s_waitcnt lgkmcnt(4)
v_mfma_f32_16x16x32_bf16 v[64:67], a[216:219], a[32:35], v[64:67]
buffer_store_dwordx4 v[216:219], v166, s[8:11], 0 offen sc1
v_dot2_f32_bf16 v26, v249, s38, v22
v_mfma_f32_16x16x32_bf16 v[64:67], a[220:223], a[36:39], v[64:67]
ds_read_b128 a[240:243], v4 offset:7168
v_dot2_f32_bf16 v27, v249, s39, v22
v_mfma_f32_16x16x32_bf16 v[68:71], a[216:219], a[104:107], v[68:71]
v_dot2_f32_bf16 v28, v250, s38, v22
v_dot2_f32_bf16 v29, v250, s39, v22
v_mfma_f32_16x16x32_bf16 v[68:71], a[220:223], a[108:111], v[68:71]
ds_read_b128 a[244:247], v4 offset:15360
s_waitcnt lgkmcnt(4)
v_mfma_f32_16x16x32_bf16 v[72:75], a[32:35], a[224:227], v[72:75]
buffer_store_dwordx4 v[220:223], v167, s[8:11], 0 offen sc1
v_dot2_f32_bf16 v30, v251, s38, v22
v_mfma_f32_16x16x32_bf16 v[72:75], a[36:39], a[228:231], v[72:75]
ds_read_b128 a[216:219], v7 offset:0
v_dot2_f32_bf16 v31, v251, s39, v22
v_mfma_f32_16x16x32_bf16 v[76:79], a[104:107], a[224:227], v[76:79]
v_cvt_pk_bf16_f32 v248, v24, v25
v_cvt_pk_bf16_f32 v249, v26, v27
v_mfma_f32_16x16x32_bf16 v[76:79], a[108:111], a[228:231], v[76:79]
ds_read_b128 a[220:223], v7 offset:8192
s_waitcnt lgkmcnt(4)
v_mfma_f32_16x16x32_bf16 v[80:83], a[32:35], a[232:235], v[80:83]
buffer_store_dwordx4 v[224:227], v168, s[8:11], 0 offen sc1
v_cvt_pk_bf16_f32 v250, v28, v29
v_mfma_f32_16x16x32_bf16 v[80:83], a[36:39], a[236:239], v[80:83]
ds_read_b128 a[224:227], v10 offset:0
v_cvt_pk_bf16_f32 v251, v30, v31
v_mfma_f32_16x16x32_bf16 v[84:87], a[104:107], a[232:235], v[84:87]
v_dot2_f32_bf16 v24, v252, s38, v23
v_dot2_f32_bf16 v25, v252, s39, v23
v_mfma_f32_16x16x32_bf16 v[84:87], a[108:111], a[236:239], v[84:87]
ds_read_b128 a[228:231], v10 offset:8192
s_waitcnt lgkmcnt(4)
v_mfma_f32_16x16x32_bf16 v[88:91], a[32:35], a[240:243], v[88:91]
buffer_store_dwordx4 v[228:231], v169, s[8:11], 0 offen sc1
v_dot2_f32_bf16 v26, v253, s38, v23
v_mfma_f32_16x16x32_bf16 v[88:91], a[36:39], a[244:247], v[88:91]
ds_read_b128 a[232:235], v4 offset:16384
v_dot2_f32_bf16 v27, v253, s39, v23
v_mfma_f32_16x16x32_bf16 v[92:95], a[104:107], a[240:243], v[92:95]
v_dot2_f32_bf16 v28, v254, s38, v23
v_dot2_f32_bf16 v29, v254, s39, v23
v_mfma_f32_16x16x32_bf16 v[92:95], a[108:111], a[244:247], v[92:95]
ds_read_b128 a[236:239], v4 offset:24576
s_waitcnt lgkmcnt(4)
v_mfma_f32_16x16x32_bf16 v[96:99], a[216:219], a[176:179], v[96:99]
ds_read_b128 a[240:243], v4 offset:17408
buffer_store_dwordx4 v[232:235], v170, s[8:11], 0 offen sc1
v_dot2_f32_bf16 v30, v255, s38, v23
v_mfma_f32_16x16x32_bf16 v[96:99], a[220:223], a[180:183], v[96:99]
ds_read_b128 a[244:247], v4 offset:25600
s_waitcnt lgkmcnt(4)
v_mfma_f32_16x16x32_bf16 v[100:103], a[176:179], a[224:227], v[100:103]
ds_read_b128 a[216:219], v4 offset:18432
v_dot2_f32_bf16 v31, v255, s39, v23
v_mfma_f32_16x16x32_bf16 v[100:103], a[180:183], a[228:231], v[100:103]
ds_read_b128 a[220:223], v4 offset:26624
s_waitcnt vmcnt(33)
s_waitcnt lgkmcnt(4)
v_mfma_f32_16x16x32_bf16 v[32:35], a[232:235], a[40:43], v[32:35]
buffer_store_dwordx4 v[236:239], v171, s[8:11], 0 offen sc1
v_cvt_pk_bf16_f32 v252, v24, v25
v_mfma_f32_16x16x32_bf16 v[32:35], a[236:239], a[44:47], v[32:35]
ds_read_b128 a[224:227], v4 offset:19456
v_cvt_pk_bf16_f32 v253, v26, v27
v_mfma_f32_16x16x32_bf16 v[36:39], a[232:235], a[112:115], v[36:39]
v_cvt_pk_bf16_f32 v254, v28, v29
v_cvt_pk_bf16_f32 v255, v30, v31
v_mfma_f32_16x16x32_bf16 v[36:39], a[236:239], a[116:119], v[36:39]
ds_read_b128 a[228:231], v4 offset:27648
s_waitcnt lgkmcnt(4)
v_mfma_f32_16x16x32_bf16 v[40:43], a[240:243], a[40:43], v[40:43]
buffer_store_dwordx4 v[240:243], v172, s[8:11], 0 offen sc1
v_mfma_f32_16x16x32_bf16 v[40:43], a[244:247], a[44:47], v[40:43]
ds_read_b128 a[232:235], v4 offset:20480
v_mfma_f32_16x16x32_bf16 v[44:47], a[240:243], a[112:115], v[44:47]
v_mfma_f32_16x16x32_bf16 v[44:47], a[244:247], a[116:119], v[44:47]
ds_read_b128 a[236:239], v4 offset:28672
s_waitcnt lgkmcnt(4)
v_mfma_f32_16x16x32_bf16 v[48:51], a[216:219], a[40:43], v[48:51]
buffer_store_dwordx4 v[244:247], v173, s[8:11], 0 offen sc1
v_mfma_f32_16x16x32_bf16 v[48:51], a[220:223], a[44:47], v[48:51]
ds_read_b128 a[240:243], v4 offset:21504
v_mfma_f32_16x16x32_bf16 v[52:55], a[216:219], a[112:115], v[52:55]
v_mfma_f32_16x16x32_bf16 v[52:55], a[220:223], a[116:119], v[52:55]
ds_read_b128 a[244:247], v4 offset:29696
s_waitcnt lgkmcnt(4)
v_mfma_f32_16x16x32_bf16 v[56:59], a[224:227], a[40:43], v[56:59]
buffer_store_dwordx4 v[248:251], v174, s[8:11], 0 offen sc1
v_mfma_f32_16x16x32_bf16 v[56:59], a[228:231], a[44:47], v[56:59]
ds_read_b128 a[216:219], v4 offset:22528
v_mfma_f32_16x16x32_bf16 v[60:63], a[224:227], a[112:115], v[60:63]
v_mfma_f32_16x16x32_bf16 v[60:63], a[228:231], a[116:119], v[60:63]
ds_read_b128 a[220:223], v4 offset:30720
s_waitcnt lgkmcnt(4)
v_mfma_f32_16x16x32_bf16 v[64:67], a[232:235], a[40:43], v[64:67]
buffer_store_dwordx4 v[252:255], v175, s[8:11], 0 offen sc1
v_mfma_f32_16x16x32_bf16 v[64:67], a[236:239], a[44:47], v[64:67]
ds_read_b128 a[224:227], v4 offset:23552
v_mfma_f32_16x16x32_bf16 v[68:71], a[232:235], a[112:115], v[68:71]
v_mfma_f32_16x16x32_bf16 v[68:71], a[236:239], a[116:119], v[68:71]
ds_read_b128 a[228:231], v4 offset:31744
s_waitcnt lgkmcnt(4)
v_mfma_f32_16x16x32_bf16 v[72:75], a[40:43], a[240:243], v[72:75]
v_mfma_f32_16x16x32_bf16 v[72:75], a[44:47], a[244:247], v[72:75]
ds_read_b128 a[232:235], v7 offset:16384
v_mfma_f32_16x16x32_bf16 v[76:79], a[112:115], a[240:243], v[76:79]
v_mfma_f32_16x16x32_bf16 v[76:79], a[116:119], a[244:247], v[76:79]
ds_read_b128 a[236:239], v7 offset:24576
s_waitcnt lgkmcnt(4)
v_mfma_f32_16x16x32_bf16 v[80:83], a[40:43], a[216:219], v[80:83]
v_mfma_f32_16x16x32_bf16 v[80:83], a[44:47], a[220:223], v[80:83]
ds_read_b128 a[240:243], v10 offset:16384
v_mfma_f32_16x16x32_bf16 v[84:87], a[112:115], a[216:219], v[84:87]
v_mfma_f32_16x16x32_bf16 v[84:87], a[116:119], a[220:223], v[84:87]
ds_read_b128 a[244:247], v10 offset:24576
s_waitcnt lgkmcnt(4)
v_mfma_f32_16x16x32_bf16 v[88:91], a[40:43], a[224:227], v[88:91]
v_mfma_f32_16x16x32_bf16 v[88:91], a[44:47], a[228:231], v[88:91]
ds_read_b128 a[216:219], v4 offset:32768
v_mfma_f32_16x16x32_bf16 v[92:95], a[112:115], a[224:227], v[92:95]
v_mfma_f32_16x16x32_bf16 v[92:95], a[116:119], a[228:231], v[92:95]
ds_read_b128 a[220:223], v4 offset:40960
s_waitcnt lgkmcnt(4)
v_mfma_f32_16x16x32_bf16 v[96:99], a[232:235], a[184:187], v[96:99]
ds_read_b128 a[224:227], v4 offset:33792
v_mfma_f32_16x16x32_bf16 v[96:99], a[236:239], a[188:191], v[96:99]
ds_read_b128 a[228:231], v4 offset:41984
s_waitcnt lgkmcnt(4)
v_mfma_f32_16x16x32_bf16 v[100:103], a[184:187], a[240:243], v[100:103]
ds_read_b128 a[232:235], v4 offset:34816
v_mfma_f32_16x16x32_bf16 v[100:103], a[188:191], a[244:247], v[100:103]
ds_read_b128 a[236:239], v4 offset:43008
s_waitcnt vmcnt(32)
s_waitcnt lgkmcnt(4)
v_mfma_f32_16x16x32_bf16 v[32:35], a[216:219], a[48:51], v[32:35]
v_mfma_f32_16x16x32_bf16 v[32:35], a[220:223], a[52:55], v[32:35]
ds_read_b128 a[240:243], v4 offset:35840
v_mfma_f32_16x16x32_bf16 v[36:39], a[216:219], a[120:123], v[36:39]
v_mfma_f32_16x16x32_bf16 v[36:39], a[220:223], a[124:127], v[36:39]
ds_read_b128 a[244:247], v4 offset:44032
s_waitcnt lgkmcnt(4)
v_mfma_f32_16x16x32_bf16 v[40:43], a[224:227], a[48:51], v[40:43]
v_mfma_f32_16x16x32_bf16 v[40:43], a[228:231], a[52:55], v[40:43]
ds_read_b128 a[216:219], v4 offset:36864
v_mfma_f32_16x16x32_bf16 v[44:47], a[224:227], a[120:123], v[44:47]
v_mfma_f32_16x16x32_bf16 v[44:47], a[228:231], a[124:127], v[44:47]
ds_read_b128 a[220:223], v4 offset:45056
s_waitcnt lgkmcnt(4)
v_mfma_f32_16x16x32_bf16 v[48:51], a[232:235], a[48:51], v[48:51]
v_mfma_f32_16x16x32_bf16 v[48:51], a[236:239], a[52:55], v[48:51]
ds_read_b128 a[224:227], v4 offset:37888
v_mfma_f32_16x16x32_bf16 v[52:55], a[232:235], a[120:123], v[52:55]
v_mfma_f32_16x16x32_bf16 v[52:55], a[236:239], a[124:127], v[52:55]
ds_read_b128 a[228:231], v4 offset:46080
s_waitcnt lgkmcnt(4)
v_mfma_f32_16x16x32_bf16 v[56:59], a[240:243], a[48:51], v[56:59]
v_mfma_f32_16x16x32_bf16 v[56:59], a[244:247], a[52:55], v[56:59]
ds_read_b128 a[232:235], v4 offset:38912
v_mfma_f32_16x16x32_bf16 v[60:63], a[240:243], a[120:123], v[60:63]
v_mfma_f32_16x16x32_bf16 v[60:63], a[244:247], a[124:127], v[60:63]
ds_read_b128 a[236:239], v4 offset:47104
s_waitcnt lgkmcnt(4)
v_mfma_f32_16x16x32_bf16 v[64:67], a[216:219], a[48:51], v[64:67]
v_mfma_f32_16x16x32_bf16 v[64:67], a[220:223], a[52:55], v[64:67]
ds_read_b128 a[240:243], v4 offset:39936
v_mfma_f32_16x16x32_bf16 v[68:71], a[216:219], a[120:123], v[68:71]
v_mfma_f32_16x16x32_bf16 v[68:71], a[220:223], a[124:127], v[68:71]
ds_read_b128 a[244:247], v4 offset:48128
s_waitcnt lgkmcnt(4)
v_mfma_f32_16x16x32_bf16 v[72:75], a[48:51], a[224:227], v[72:75]
v_mfma_f32_16x16x32_bf16 v[72:75], a[52:55], a[228:231], v[72:75]
ds_read_b128 a[216:219], v7 offset:32768
v_mfma_f32_16x16x32_bf16 v[76:79], a[120:123], a[224:227], v[76:79]
v_mfma_f32_16x16x32_bf16 v[76:79], a[124:127], a[228:231], v[76:79]
ds_read_b128 a[220:223], v7 offset:40960
s_waitcnt lgkmcnt(4)
v_mfma_f32_16x16x32_bf16 v[80:83], a[48:51], a[232:235], v[80:83]
v_mfma_f32_16x16x32_bf16 v[80:83], a[52:55], a[236:239], v[80:83]
ds_read_b128 a[224:227], v10 offset:32768
v_mfma_f32_16x16x32_bf16 v[84:87], a[120:123], a[232:235], v[84:87]
v_mfma_f32_16x16x32_bf16 v[84:87], a[124:127], a[236:239], v[84:87]
ds_read_b128 a[228:231], v10 offset:40960
s_waitcnt lgkmcnt(4)
v_mfma_f32_16x16x32_bf16 v[88:91], a[48:51], a[240:243], v[88:91]
v_mfma_f32_16x16x32_bf16 v[88:91], a[52:55], a[244:247], v[88:91]
ds_read_b128 a[232:235], v4 offset:49152
v_mfma_f32_16x16x32_bf16 v[92:95], a[120:123], a[240:243], v[92:95]
v_mfma_f32_16x16x32_bf16 v[92:95], a[124:127], a[244:247], v[92:95]
ds_read_b128 a[236:239], v4 offset:57344
s_waitcnt lgkmcnt(4)
v_mfma_f32_16x16x32_bf16 v[96:99], a[216:219], a[192:195], v[96:99]
ds_read_b128 a[240:243], v4 offset:50176
v_mfma_f32_16x16x32_bf16 v[96:99], a[220:223], a[196:199], v[96:99]
ds_read_b128 a[244:247], v4 offset:58368
s_waitcnt lgkmcnt(4)
v_mfma_f32_16x16x32_bf16 v[100:103], a[192:195], a[224:227], v[100:103]
ds_read_b128 a[216:219], v4 offset:51200
v_mfma_f32_16x16x32_bf16 v[100:103], a[196:199], a[228:231], v[100:103]
ds_read_b128 a[220:223], v4 offset:59392
s_waitcnt vmcnt(26)
s_waitcnt lgkmcnt(4)
v_mfma_f32_16x16x32_bf16 v[32:35], a[232:235], a[56:59], v[32:35]
v_mfma_f32_16x16x32_bf16 v[32:35], a[236:239], a[60:63], v[32:35]
ds_read_b128 a[224:227], v4 offset:52224
v_mfma_f32_16x16x32_bf16 v[36:39], a[232:235], a[128:131], v[36:39]
v_mfma_f32_16x16x32_bf16 v[36:39], a[236:239], a[132:135], v[36:39]
ds_read_b128 a[228:231], v4 offset:60416
s_waitcnt lgkmcnt(4)
v_mfma_f32_16x16x32_bf16 v[40:43], a[240:243], a[56:59], v[40:43]
v_mfma_f32_16x16x32_bf16 v[40:43], a[244:247], a[60:63], v[40:43]
ds_read_b128 a[232:235], v4 offset:53248
v_mfma_f32_16x16x32_bf16 v[44:47], a[240:243], a[128:131], v[44:47]
v_mfma_f32_16x16x32_bf16 v[44:47], a[244:247], a[132:135], v[44:47]
ds_read_b128 a[236:239], v4 offset:61440
s_waitcnt lgkmcnt(4)
v_mfma_f32_16x16x32_bf16 v[48:51], a[216:219], a[56:59], v[48:51]
v_mfma_f32_16x16x32_bf16 v[48:51], a[220:223], a[60:63], v[48:51]
ds_read_b128 a[240:243], v4 offset:54272
v_mfma_f32_16x16x32_bf16 v[52:55], a[216:219], a[128:131], v[52:55]
v_mfma_f32_16x16x32_bf16 v[52:55], a[220:223], a[132:135], v[52:55]
ds_read_b128 a[244:247], v4 offset:62464
s_waitcnt lgkmcnt(4)
v_mfma_f32_16x16x32_bf16 v[56:59], a[224:227], a[56:59], v[56:59]
v_mfma_f32_16x16x32_bf16 v[56:59], a[228:231], a[60:63], v[56:59]
ds_read_b128 a[216:219], v4 offset:55296
v_mfma_f32_16x16x32_bf16 v[60:63], a[224:227], a[128:131], v[60:63]
v_mfma_f32_16x16x32_bf16 v[60:63], a[228:231], a[132:135], v[60:63]
ds_read_b128 a[220:223], v4 offset:63488
s_waitcnt lgkmcnt(4)
v_mfma_f32_16x16x32_bf16 v[64:67], a[232:235], a[56:59], v[64:67]
v_mfma_f32_16x16x32_bf16 v[64:67], a[236:239], a[60:63], v[64:67]
ds_read_b128 a[224:227], v4 offset:56320
v_mfma_f32_16x16x32_bf16 v[68:71], a[232:235], a[128:131], v[68:71]
v_mfma_f32_16x16x32_bf16 v[68:71], a[236:239], a[132:135], v[68:71]
ds_read_b128 a[228:231], v4 offset:64512
s_waitcnt lgkmcnt(4)
v_mfma_f32_16x16x32_bf16 v[72:75], a[56:59], a[240:243], v[72:75]
v_mfma_f32_16x16x32_bf16 v[72:75], a[60:63], a[244:247], v[72:75]
ds_read_b128 a[232:235], v7 offset:49152
v_mfma_f32_16x16x32_bf16 v[76:79], a[128:131], a[240:243], v[76:79]
v_mfma_f32_16x16x32_bf16 v[76:79], a[132:135], a[244:247], v[76:79]
ds_read_b128 a[236:239], v7 offset:57344
s_waitcnt lgkmcnt(4)
v_mfma_f32_16x16x32_bf16 v[80:83], a[56:59], a[216:219], v[80:83]
v_mfma_f32_16x16x32_bf16 v[80:83], a[60:63], a[220:223], v[80:83]
ds_read_b128 a[240:243], v10 offset:49152
v_mfma_f32_16x16x32_bf16 v[84:87], a[128:131], a[216:219], v[84:87]
v_mfma_f32_16x16x32_bf16 v[84:87], a[132:135], a[220:223], v[84:87]
ds_read_b128 a[244:247], v10 offset:57344
s_waitcnt lgkmcnt(4)
v_mfma_f32_16x16x32_bf16 v[88:91], a[56:59], a[224:227], v[88:91]
v_mfma_f32_16x16x32_bf16 v[88:91], a[60:63], a[228:231], v[88:91]
ds_read_b128 a[216:219], v5 offset:0
v_mfma_f32_16x16x32_bf16 v[92:95], a[128:131], a[224:227], v[92:95]
v_mfma_f32_16x16x32_bf16 v[92:95], a[132:135], a[228:231], v[92:95]
ds_read_b128 a[220:223], v5 offset:8192
s_waitcnt lgkmcnt(4)
v_mfma_f32_16x16x32_bf16 v[96:99], a[232:235], a[200:203], v[96:99]
ds_read_b128 a[224:227], v5 offset:1024
v_mfma_f32_16x16x32_bf16 v[96:99], a[236:239], a[204:207], v[96:99]
ds_read_b128 a[228:231], v5 offset:9216
s_waitcnt lgkmcnt(4)
v_mfma_f32_16x16x32_bf16 v[100:103], a[200:203], a[240:243], v[100:103]
ds_read_b128 a[232:235], v5 offset:2048
v_mfma_f32_16x16x32_bf16 v[100:103], a[204:207], a[244:247], v[100:103]
ds_read_b128 a[236:239], v5 offset:10240
s_waitcnt vmcnt(20)
s_waitcnt lgkmcnt(4)
v_mfma_f32_16x16x32_bf16 v[32:35], a[216:219], a[64:67], v[32:35]
v_mfma_f32_16x16x32_bf16 v[32:35], a[220:223], a[68:71], v[32:35]
ds_read_b128 a[240:243], v5 offset:3072
v_mfma_f32_16x16x32_bf16 v[36:39], a[216:219], a[136:139], v[36:39]
v_mfma_f32_16x16x32_bf16 v[36:39], a[220:223], a[140:143], v[36:39]
ds_read_b128 a[244:247], v5 offset:11264
s_waitcnt lgkmcnt(4)
v_mfma_f32_16x16x32_bf16 v[40:43], a[224:227], a[64:67], v[40:43]
v_mfma_f32_16x16x32_bf16 v[40:43], a[228:231], a[68:71], v[40:43]
ds_read_b128 a[216:219], v5 offset:4096
v_mfma_f32_16x16x32_bf16 v[44:47], a[224:227], a[136:139], v[44:47]
v_mfma_f32_16x16x32_bf16 v[44:47], a[228:231], a[140:143], v[44:47]
ds_read_b128 a[220:223], v5 offset:12288
s_waitcnt lgkmcnt(4)
v_mfma_f32_16x16x32_bf16 v[48:51], a[232:235], a[64:67], v[48:51]
v_mfma_f32_16x16x32_bf16 v[48:51], a[236:239], a[68:71], v[48:51]
ds_read_b128 a[224:227], v5 offset:5120
v_mfma_f32_16x16x32_bf16 v[52:55], a[232:235], a[136:139], v[52:55]
v_mfma_f32_16x16x32_bf16 v[52:55], a[236:239], a[140:143], v[52:55]
ds_read_b128 a[228:231], v5 offset:13312
s_waitcnt lgkmcnt(4)
v_mfma_f32_16x16x32_bf16 v[56:59], a[240:243], a[64:67], v[56:59]
v_mfma_f32_16x16x32_bf16 v[56:59], a[244:247], a[68:71], v[56:59]
ds_read_b128 a[232:235], v5 offset:6144
v_mfma_f32_16x16x32_bf16 v[60:63], a[240:243], a[136:139], v[60:63]
v_mfma_f32_16x16x32_bf16 v[60:63], a[244:247], a[140:143], v[60:63]
ds_read_b128 a[236:239], v5 offset:14336
s_waitcnt lgkmcnt(4)
v_mfma_f32_16x16x32_bf16 v[64:67], a[216:219], a[64:67], v[64:67]
v_mfma_f32_16x16x32_bf16 v[64:67], a[220:223], a[68:71], v[64:67]
ds_read_b128 a[240:243], v5 offset:7168
v_mfma_f32_16x16x32_bf16 v[68:71], a[216:219], a[136:139], v[68:71]
v_mfma_f32_16x16x32_bf16 v[68:71], a[220:223], a[140:143], v[68:71]
ds_read_b128 a[244:247], v5 offset:15360
s_waitcnt lgkmcnt(4)
v_mfma_f32_16x16x32_bf16 v[72:75], a[64:67], a[224:227], v[72:75]
v_mfma_f32_16x16x32_bf16 v[72:75], a[68:71], a[228:231], v[72:75]
ds_read_b128 a[216:219], v8 offset:0
v_mfma_f32_16x16x32_bf16 v[76:79], a[136:139], a[224:227], v[76:79]
v_mfma_f32_16x16x32_bf16 v[76:79], a[140:143], a[228:231], v[76:79]
ds_read_b128 a[220:223], v8 offset:8192
s_waitcnt lgkmcnt(4)
v_mfma_f32_16x16x32_bf16 v[80:83], a[64:67], a[232:235], v[80:83]
v_mfma_f32_16x16x32_bf16 v[80:83], a[68:71], a[236:239], v[80:83]
ds_read_b128 a[224:227], v11 offset:0
v_mfma_f32_16x16x32_bf16 v[84:87], a[136:139], a[232:235], v[84:87]
v_mfma_f32_16x16x32_bf16 v[84:87], a[140:143], a[236:239], v[84:87]
ds_read_b128 a[228:231], v11 offset:8192
s_waitcnt lgkmcnt(4)
v_mfma_f32_16x16x32_bf16 v[88:91], a[64:67], a[240:243], v[88:91]
v_mfma_f32_16x16x32_bf16 v[88:91], a[68:71], a[244:247], v[88:91]
v_mfma_f32_16x16x32_bf16 v[92:95], a[136:139], a[240:243], v[92:95]
v_mfma_f32_16x16x32_bf16 v[92:95], a[140:143], a[244:247], v[92:95]
s_waitcnt lgkmcnt(2)
v_mfma_f32_16x16x32_bf16 v[96:99], a[216:219], a[208:211], v[96:99]
v_mfma_f32_16x16x32_bf16 v[96:99], a[220:223], a[212:215], v[96:99]
s_waitcnt lgkmcnt(0)
v_mfma_f32_16x16x32_bf16 v[100:103], a[208:211], a[224:227], v[100:103]
v_mfma_f32_16x16x32_bf16 v[100:103], a[212:215], a[228:231], v[100:103]
L_att:
v_cvt_pk_bf16_f32 v116, v52, v53
v_cvt_pk_bf16_f32 v117, v54, v55
v_cvt_pk_bf16_f32 v120, v60, v61
v_cvt_pk_bf16_f32 v121, v62, v63
v_cvt_pk_bf16_f32 v160, v68, v69
v_cvt_pk_bf16_f32 v161, v70, v71
v_cvt_pk_bf16_f32 v126, v76, v77
v_cvt_pk_bf16_f32 v127, v78, v79
v_cvt_pk_bf16_f32 v132, v84, v85
v_cvt_pk_bf16_f32 v133, v86, v87
v_cvt_pk_bf16_f32 v138, v92, v93
v_cvt_pk_bf16_f32 v139, v94, v95
v_cvt_pk_bf16_f32 v156, v96, v97
v_cvt_pk_bf16_f32 v157, v98, v99
v_cvt_pk_bf16_f32 v158, v100, v101
v_cvt_pk_bf16_f32 v159, v102, v103
v_lshlrev_b32 v14, 3, v1
s_mul_i32 s31, s4, 3072
s_add_u32 s32, s31, 147456
v_add_u32 v15, s32, v14
s_lshl_b32 s33, s29, 9
s_add_u32 s33, s33, 147456
v_add_u32 v16, s33, v14
s_cmp_eq_u32 s4, 3
s_cbranch_scc1 L_a1_noxch
ds_write_b64 v16, v[156:157]
ds_write_b64 v16, v[158:159] offset:1536
ds_write_b64 v15, v[116:117] offset:3072
ds_write_b64 v15, v[120:121] offset:3584
ds_write_b64 v15, v[160:161] offset:4096
ds_write_b64 v15, v[126:127] offset:4608
ds_write_b64 v15, v[132:133] offset:5120
ds_write_b64 v15, v[138:139] offset:5632
L_a1_noxch:
v_cvt_pk_bf16_f32 v110, v48, v49
v_cvt_pk_bf16_f32 v111, v50, v51
v_cvt_pk_bf16_f32 v114, v56, v57
v_cvt_pk_bf16_f32 v115, v58, v59
v_cvt_pk_bf16_f32 v124, v72, v73
v_cvt_pk_bf16_f32 v125, v74, v75
v_cvt_pk_bf16_f32 v130, v80, v81
v_cvt_pk_bf16_f32 v131, v82, v83
v_cvt_pk_bf16_f32 v136, v88, v89
v_cvt_pk_bf16_f32 v137, v90, v91
v_cvt_pk_bf16_f32 v140, v32, v33
v_cvt_pk_bf16_f32 v141, v34, v35
v_cvt_pk_bf16_f32 v146, v40, v41
v_cvt_pk_bf16_f32 v147, v42, v43
v_cvt_pk_bf16_f32 v142, v64, v65
v_cvt_pk_bf16_f32 v145, v66, v67
v_mov_b32 v143, 0
v_mov_b32 v144, 0
v_mov_b32 v112, 0
v_mov_b32 v113, 0
s_nop 0
v_permlane16_swap_b32 v142, v112
v_permlane16_swap_b32 v145, v113
v_cvt_pk_bf16_f32 v148, v36, v37
v_cvt_pk_bf16_f32 v149, v38, v39
v_cvt_pk_bf16_f32 v154, v44, v45
v_cvt_pk_bf16_f32 v155, v46, v47
v_cvt_pk_bf16_f32 v150, v68, v69
v_cvt_pk_bf16_f32 v153, v70, v71
v_mov_b32 v151, 0
v_mov_b32 v152, 0
v_mov_b32 v118, 0
v_mov_b32 v119, 0
s_nop 0
v_permlane16_swap_b32 v150, v118
v_permlane16_swap_b32 v153, v119
v_add_u32 v17, 16, v12
v_add_u32 v18, 32, v12
v_cmp_gt_u32 vcc, 16, v1
s_nop 1
v_cndmask_b32 v17, v18, v17, vcc
v_lshlrev_b32 v17, 3, v17
v_add_u32 v17, s32, v17
s_waitcnt lgkmcnt(0)
s_barrier
s_and_b32 s37, s6, 7
s_mul_i32 s37, s37, 92160
s_mul_i32 s38, s4, 23552
s_add_u32 s37, s37, s38
s_add_u32 s37, s37, 6557696
ds_read_b64 v[104:105], v15
ds_read_b64 v[108:109], v15 offset:512
ds_read_b64 v[106:107], v17 offset:1024
ds_read_b64 v[122:123], v15 offset:1536
ds_read_b64 v[128:129], v15 offset:2048
ds_read_b64 v[134:135], v15 offset:2560
v_mfma_f32_16x16x32_bf16 v[32:35], v[110:113], v[148:151], 0
v_mfma_f32_16x16x32_bf16 v[36:39], v[116:119], v[148:151], 0
v_mfma_f32_16x16x32_bf16 v[40:43], v[112:115], v[152:155], 0
v_mfma_f32_16x16x32_bf16 v[44:47], v[118:121], v[152:155], 0
s_waitcnt lgkmcnt(0)
v_mfma_f32_16x16x32_bf16 v[48:51], v[104:107], v[140:143], 0
v_mfma_f32_16x16x32_bf16 v[52:55], v[110:113], v[140:143], 0
v_mfma_f32_16x16x32_bf16 v[56:59], v[106:109], v[144:147], 0
v_mfma_f32_16x16x32_bf16 v[60:63], v[112:115], v[144:147], 0
v_mov_b32 v18, 0xff61b1e6
s_mov_b32 s34, 0x3eae1a93
v_cndmask_b32 v32, v18, v32, s[44:45]
v_cndmask_b32 v40, v18, v40, s[44:45]
s_nop 0
v_cndmask_b32 v48, v18, v48, s[60:61]
s_nop 0
v_cndmask_b32 v56, v18, v56, s[60:61]
v_cndmask_b32 v33, v18, v33, s[46:47]
v_cndmask_b32 v41, v18, v41, s[46:47]
v_cndmask_b32 v49, v18, v49, s[62:63]
v_cndmask_b32 v57, v18, v57, s[62:63]
v_cndmask_b32 v34, v18, v34, s[48:49]
v_cndmask_b32 v42, v18, v42, s[48:49]
v_cndmask_b32 v50, v18, v50, s[64:65]
v_cndmask_b32 v58, v18, v58, s[64:65]
v_cndmask_b32 v35, v18, v35, s[50:51]
v_cndmask_b32 v43, v18, v43, s[50:51]
v_cndmask_b32 v51, v18, v51, s[66:67]
v_cndmask_b32 v59, v18, v59, s[66:67]
v_cndmask_b32 v36, v18, v36, s[52:53]
v_cndmask_b32 v44, v18, v44, s[52:53]
v_cndmask_b32 v52, v18, v52, s[52:53]
v_cndmask_b32 v60, v18, v60, s[52:53]
v_cndmask_b32 v37, v18, v37, s[54:55]
v_cndmask_b32 v45, v18, v45, s[54:55]
v_cndmask_b32 v53, v18, v53, s[54:55]
v_cndmask_b32 v61, v18, v61, s[54:55]
v_cndmask_b32 v38, v18, v38, s[56:57]
v_cndmask_b32 v46, v18, v46, s[56:57]
v_cndmask_b32 v54, v18, v54, s[56:57]
v_cndmask_b32 v62, v18, v62, s[56:57]
v_cndmask_b32 v39, v18, v39, s[58:59]
v_cndmask_b32 v47, v18, v47, s[58:59]
v_cndmask_b32 v55, v18, v55, s[58:59]
v_cndmask_b32 v63, v18, v63, s[58:59]
v_max3_f32 v20, v32, v33, v34
v_max3_f32 v21, v40, v41, v42
v_max3_f32 v22, v48, v49, v50
v_max3_f32 v23, v56, v57, v58
v_max3_f32 v20, v20, v35, v36
v_max3_f32 v21, v21, v43, v44
v_max3_f32 v22, v22, v51, v52
v_max3_f32 v23, v23, v59, v60
v_max3_f32 v20, v20, v37, v38
v_max3_f32 v21, v21, v45, v46
v_max3_f32 v22, v22, v53, v54
v_max3_f32 v23, v23, v61, v62
v_max_f32 v20, v20, v39
v_max_f32 v21, v21, v47
v_max_f32 v22, v22, v55
v_max_f32 v23, v23, v63
v_mov_b32 v24, v20
v_mov_b32 v25, v21
v_mov_b32 v26, v22
v_mov_b32 v27, v23
v_permlane16_swap_b32 v20, v24
v_permlane16_swap_b32 v21, v25
v_permlane16_swap_b32 v22, v26
v_permlane16_swap_b32 v23, v27
v_max_f32 v20, v20, v24
v_max_f32 v21, v21, v25
v_max_f32 v22, v22, v26
v_max_f32 v23, v23, v27
v_mov_b32 v24, v20
v_mov_b32 v25, v21
v_mov_b32 v26, v22
v_mov_b32 v27, v23
v_permlane32_swap_b32 v20, v24
v_permlane32_swap_b32 v21, v25
v_permlane32_swap_b32 v22, v26
v_permlane32_swap_b32 v23, v27
v_max_f32 v20, v20, v24
v_max_f32 v21, v21, v25
v_max_f32 v22, v22, v26
v_max_f32 v23, v23, v27
v_mul_f32 v20, s34, v20
v_mul_f32 v21, s34, v21
v_mul_f32 v22, s34, v22
v_mul_f32 v23, s34, v23
v_fma_f32 v32, v32, s34, -v20
v_fma_f32 v40, v40, s34, -v21
v_fma_f32 v48, v48, s34, -v22
v_fma_f32 v56, v56, s34, -v23
v_exp_f32 v32, v32
v_exp_f32 v40, v40
v_exp_f32 v48, v48
v_exp_f32 v56, v56
v_fma_f32 v33, v33, s34, -v20
v_fma_f32 v41, v41, s34, -v21
v_fma_f32 v49, v49, s34, -v22
v_fma_f32 v57, v57, s34, -v23
v_exp_f32 v33, v33
v_exp_f32 v41, v41
v_exp_f32 v49, v49
v_exp_f32 v57, v57
v_fma_f32 v34, v34, s34, -v20
v_fma_f32 v42, v42, s34, -v21
v_fma_f32 v50, v50, s34, -v22
v_fma_f32 v58, v58, s34, -v23
v_exp_f32 v34, v34
v_exp_f32 v42, v42
v_exp_f32 v50, v50
v_exp_f32 v58, v58
v_fma_f32 v35, v35, s34, -v20
v_fma_f32 v43, v43, s34, -v21
v_fma_f32 v51, v51, s34, -v22
v_fma_f32 v59, v59, s34, -v23
v_exp_f32 v35, v35
v_exp_f32 v43, v43
v_exp_f32 v51, v51
v_exp_f32 v59, v59
v_fma_f32 v36, v36, s34, -v20
v_fma_f32 v44, v44, s34, -v21
v_fma_f32 v52, v52, s34, -v22
v_fma_f32 v60, v60, s34, -v23
v_exp_f32 v36, v36
v_exp_f32 v44, v44
v_exp_f32 v52, v52
v_exp_f32 v60, v60
v_fma_f32 v37, v37, s34, -v20
v_fma_f32 v45, v45, s34, -v21
v_fma_f32 v53, v53, s34, -v22
v_fma_f32 v61, v61, s34, -v23
v_exp_f32 v37, v37
v_exp_f32 v45, v45
v_exp_f32 v53, v53
v_exp_f32 v61, v61
v_fma_f32 v38, v38, s34, -v20
v_fma_f32 v46, v46, s34, -v21
v_fma_f32 v54, v54, s34, -v22
v_fma_f32 v62, v62, s34, -v23
v_exp_f32 v38, v38
v_exp_f32 v46, v46
v_exp_f32 v54, v54
v_exp_f32 v62, v62
v_fma_f32 v39, v39, s34, -v20
v_fma_f32 v47, v47, s34, -v21
v_fma_f32 v55, v55, s34, -v22
v_fma_f32 v63, v63, s34, -v23
v_exp_f32 v39, v39
v_exp_f32 v47, v47
v_exp_f32 v55, v55
v_exp_f32 v63, v63
v_add_f32 v28, v32, v33
v_add_f32 v29, v40, v41
v_add_f32 v30, v48, v49
v_add_f32 v31, v56, v57
v_add_f32 v28, v28, v34
v_add_f32 v29, v29, v42
v_add_f32 v30, v30, v50
v_add_f32 v31, v31, v58
v_add_f32 v28, v28, v35
v_add_f32 v29, v29, v43
v_add_f32 v30, v30, v51
v_add_f32 v31, v31, v59
v_add_f32 v28, v28, v36
v_add_f32 v29, v29, v44
v_add_f32 v30, v30, v52
v_add_f32 v31, v31, v60
v_add_f32 v28, v28, v37
v_add_f32 v29, v29, v45
v_add_f32 v30, v30, v53
v_add_f32 v31, v31, v61
v_add_f32 v28, v28, v38
v_add_f32 v29, v29, v46
v_add_f32 v30, v30, v54
v_add_f32 v31, v31, v62
v_add_f32 v28, v28, v39
v_add_f32 v29, v29, v47
v_add_f32 v30, v30, v55
v_add_f32 v31, v31, v63
v_mov_b32 v24, v28
v_mov_b32 v25, v29
v_mov_b32 v26, v30
v_mov_b32 v27, v31
v_permlane16_swap_b32 v28, v24
v_permlane16_swap_b32 v29, v25
v_permlane16_swap_b32 v30, v26
v_permlane16_swap_b32 v31, v27
v_add_f32 v28, v28, v24
v_add_f32 v29, v29, v25
v_add_f32 v30, v30, v26
v_add_f32 v31, v31, v27
v_mov_b32 v24, v28
v_mov_b32 v25, v29
v_mov_b32 v26, v30
v_mov_b32 v27, v31
v_permlane32_swap_b32 v28, v24
v_permlane32_swap_b32 v29, v25
v_permlane32_swap_b32 v30, v26
v_permlane32_swap_b32 v31, v27
v_add_f32 v28, v28, v24
v_add_f32 v29, v29, v25
v_add_f32 v30, v30, v26
v_add_f32 v31, v31, v27
v_rcp_f32 v28, v28
v_rcp_f32 v29, v29
v_rcp_f32 v30, v30
v_rcp_f32 v31, v31
v_mul_f32 v32, v32, v28
v_mul_f32 v40, v40, v29
v_mul_f32 v48, v48, v30
v_mul_f32 v56, v56, v31
v_mul_f32 v33, v33, v28
v_mul_f32 v41, v41, v29
v_mul_f32 v49, v49, v30
v_mul_f32 v57, v57, v31
v_mul_f32 v34, v34, v28
v_mul_f32 v42, v42, v29
v_mul_f32 v50, v50, v30
v_mul_f32 v58, v58, v31
v_mul_f32 v35, v35, v28
v_mul_f32 v43, v43, v29
v_mul_f32 v51, v51, v30
v_mul_f32 v59, v59, v31
v_mul_f32 v36, v36, v28
v_mul_f32 v44, v44, v29
v_mul_f32 v52, v52, v30
v_mul_f32 v60, v60, v31
v_mul_f32 v37, v37, v28
v_mul_f32 v45, v45, v29
v_mul_f32 v53, v53, v30
v_mul_f32 v61, v61, v31
v_mul_f32 v38, v38, v28
v_mul_f32 v46, v46, v29
v_mul_f32 v54, v54, v30
v_mul_f32 v62, v62, v31
v_mul_f32 v39, v39, v28
v_mul_f32 v47, v47, v29
v_mul_f32 v55, v55, v30
v_mul_f32 v63, v63, v31
v_cvt_pk_bf16_f32 v64, v32, v33
v_cvt_pk_bf16_f32 v65, v34, v35
v_cvt_pk_bf16_f32 v66, v36, v37
v_cvt_pk_bf16_f32 v67, v38, v39
v_cvt_pk_bf16_f32 v68, v40, v41
v_cvt_pk_bf16_f32 v69, v42, v43
v_cvt_pk_bf16_f32 v70, v44, v45
v_cvt_pk_bf16_f32 v71, v46, v47
v_cvt_pk_bf16_f32 v72, v48, v49
v_cvt_pk_bf16_f32 v73, v50, v51
v_cvt_pk_bf16_f32 v74, v52, v53
v_cvt_pk_bf16_f32 v75, v54, v55
v_cvt_pk_bf16_f32 v76, v56, v57
v_cvt_pk_bf16_f32 v77, v58, v59
v_cvt_pk_bf16_f32 v78, v60, v61
v_cvt_pk_bf16_f32 v79, v62, v63
v_mfma_f32_16x16x32_bf16 v[80:83], v[124:127], v[64:67], 0
v_mfma_f32_16x16x32_bf16 v[84:87], v[136:139], v[64:67], 0
v_mfma_f32_16x16x32_bf16 v[88:91], v[130:133], v[68:71], 0
v_mfma_f32_16x16x32_bf16 v[92:95], v[136:139], v[68:71], 0
v_mfma_f32_16x16x32_bf16 v[96:99], v[122:125], v[72:75], 0
v_mfma_f32_16x16x32_bf16 v[100:103], v[134:137], v[72:75], 0
v_mfma_f32_16x16x32_bf16 v[164:167], v[128:131], v[76:79], 0
v_mfma_f32_16x16x32_bf16 v[168:171], v[134:137], v[76:79], 0
v_lshlrev_b32 v14, 3, v12
v_mov_b32 v15, 2146435072
v_cmp_gt_u32 vcc, 16, v1
s_nop 1
v_cndmask_b32 v14, v15, v14, vcc
s_add_u32 s26, s24, s72
s_lshl_b32 s27, s21, 10
s_add_u32 s27, s27, s26
s_lshl_b32 s28, s21, 7
s_add_u32 s28, s28, 16384
s_add_u32 s28, s28, s26
s_add_u32 s30, s27, 18432
s_add_u32 s31, s28, 18432
v_cvt_pk_bf16_f32 v180, v80, v81
v_cvt_pk_bf16_f32 v181, v82, v83
v_cvt_pk_bf16_f32 v182, v88, v89
v_cvt_pk_bf16_f32 v183, v90, v91
v_cvt_pk_bf16_f32 v184, v84, v85
v_cvt_pk_bf16_f32 v185, v94, v95
buffer_store_dwordx4 v[180:183], v2, s[8:11], s30 offen sc1
buffer_store_dwordx2 v[184:185], v14, s[8:11], s31 offen sc1
v_cvt_pk_bf16_f32 v172, v96, v97
v_cvt_pk_bf16_f32 v173, v98, v99
v_cvt_pk_bf16_f32 v174, v164, v165
v_cvt_pk_bf16_f32 v175, v166, v167
v_cvt_pk_bf16_f32 v176, v100, v101
v_cvt_pk_bf16_f32 v177, v170, v171
buffer_store_dwordx4 v[172:175], v2, s[8:11], s27 offen sc1
buffer_store_dwordx2 v[176:177], v14, s[8:11], s28 offen sc1
s_lshl_b32 s26, s20, 4
s_add_u32 s26, s26, s21
s_lshl_b32 s14, s26, 7
s_add_u32 s14, s14, 393216
s_add_u32 s14, s14, s77
s_lshr_b32 s20, s6, 3
s_lshl_b32 s21, s5, 2
s_add_u32 s20, s20, s21
s_lshl_b32 s20, s20, 2
s_add_u32 s20, s20, s4
s_and_b32 s21, s6, 7
s_mul_i32 s24, s20, 18432
s_add_u32 s25, s24, s72
s_mul_i32 s26, s21, 2304
s_add_u32 s26, s26, s24
s_add_u32 s27, s26, s71
v_and_b32 v6, 15, v1
v_lshrrev_b32 v7, 4, v1
v_lshlrev_b32 v8, 4, v6
v_lshl_add_u32 v8, v7, 3, v8
v_add_u32 v8, 2048, v8
v_mov_b32 v9, 2146435072
v_cmp_gt_u32 vcc, 32, v1
s_nop 1
v_cndmask_b32 v4, v9, v8, vcc
v_add_u32 v5, 0x10000, v2
s_and_b32 s40, s5, 1
s_lshl_b32 s40, s40, 2
s_lshr_b32 s41, s6, 3
s_add_u32 s40, s40, s41
s_lshr_b32 s41, s5, 1
s_lshl_b32 s41, s41, 3
s_and_b32 s42, s6, 7
s_add_u32 s41, s41, s42
s_lshr_b32 s42, s41, 2
s_and_b32 s43, s41, 3
s_lshr_b32 s22, s20, 3
s_lshl_b32 s22, s22, 4
v_add_u32 v10, s22, v6
v_subrev_u32 v12, 16, v1
v_min_u32 v12, 26, v12
v_mul_u32_u24 v16, 57, v12
v_lshrrev_b32 v16, 9, v16
v_mad_u32_u24 v12, v16, 63, v12
s_mul_i32 s22, s42, 9
v_add_u32 v12, s22, v12
v_and_b32 v16, 7, v12
v_lshrrev_b32 v12, 3, v12
v_lshrrev_b32 v17, 2, v16
v_lshlrev_b32 v17, 3, v17
v_lshrrev_b32 v18, 2, v12
v_add_lshl_u32 v17, v17, v18, 4
v_and_b32 v16, 3, v16
v_lshl_add_u32 v17, v16, 2, v17
v_and_b32 v12, 3, v12
v_add_u32 v17, v17, v12
s_cmp_eq_u32 s7, 0
s_cselect_b32 s22, 16, 64
v_cmp_le_u32 vcc, s22, v1
s_nop 1
v_cndmask_b32 v10, v10, v17, vcc
v_lshlrev_b32 v10, 7, v10
s_add_u32 s22, s77, 393216
v_lshlrev_b32 v11, 3, v6
v_lshl_add_u32 v11, v7, 8, v11
v_mov_b32 v13, 2146435072
v_cmp_eq_u32 vcc, 0, v0
v_mov_b32 v14, s68
v_mov_b32 v15, s69
v_cndmask_b32 v13, v13, 0, vcc
s_waitcnt vmcnt(0)
s_barrier
buffer_store_dwordx2 v[14:15], v13, s[8:11], s14 offen sc1
s_add_u32 m0, s38, 0
s_add_u32 s39, s37, 0
buffer_load_dwordx4 v2, s[8:11], s39 offen offset:0 sc1 lds
buffer_load_dwordx4 v2, s[8:11], s39 offen offset:1024 sc1 lds
buffer_load_dwordx4 v2, s[8:11], s39 offen offset:2048 sc1 lds
buffer_load_dwordx4 v2, s[8:11], s39 offen offset:3072 sc1 lds
s_add_u32 m0, s38, 4096
s_add_u32 s39, s37, 4096
buffer_load_dwordx4 v2, s[8:11], s39 offen offset:0 sc1 lds
buffer_load_dwordx4 v2, s[8:11], s39 offen offset:1024 sc1 lds
buffer_load_dwordx4 v2, s[8:11], s39 offen offset:2048 sc1 lds
buffer_load_dwordx4 v2, s[8:11], s39 offen offset:3072 sc1 lds
s_add_u32 m0, s38, 8192
s_add_u32 s39, s37, 8192
buffer_load_dwordx4 v2, s[8:11], s39 offen offset:0 sc1 lds
buffer_load_dwordx4 v2, s[8:11], s39 offen offset:1024 sc1 lds
buffer_load_dwordx4 v2, s[8:11], s39 offen offset:2048 sc1 lds
buffer_load_dwordx4 v2, s[8:11], s39 offen offset:3072 sc1 lds
s_add_u32 m0, s38, 12288
s_add_u32 s39, s37, 12288
buffer_load_dwordx4 v2, s[8:11], s39 offen offset:0 sc1 lds
buffer_load_dwordx4 v2, s[8:11], s39 offen offset:1024 sc1 lds
buffer_load_dwordx4 v2, s[8:11], s39 offen offset:2048 sc1 lds
buffer_load_dwordx4 v2, s[8:11], s39 offen offset:3072 sc1 lds
s_add_u32 m0, s38, 16384
s_add_u32 s39, s37, 16384
buffer_load_dwordx4 v2, s[8:11], s39 offen offset:0 sc1 lds
buffer_load_dwordx4 v2, s[8:11], s39 offen offset:1024 sc1 lds
buffer_load_dwordx4 v2, s[8:11], s39 offen offset:2048 sc1 lds
buffer_load_dwordx4 v2, s[8:11], s39 offen offset:3072 sc1 lds
s_add_u32 m0, s38, 20480
s_add_u32 s39, s37, 20480
buffer_load_dwordx4 v2, s[8:11], s39 offen offset:0 sc1 lds
buffer_load_dwordx4 v2, s[8:11], s39 offen offset:1024 sc1 lds
buffer_load_dwordx4 v2, s[8:11], s39 offen offset:2048 sc1 lds
s_mov_b32 s52, 0
L_poll2:
buffer_load_dwordx2 v[14:15], v10, s[8:11], s22 offen sc1
s_add_u32 s52, s52, 1
s_waitcnt vmcnt(0)
v_cmp_ne_u64 vcc, s[68:69], v[14:15]
s_cmp_ge_u32 s52, 1048576
s_cbranch_scc1 L_got2
s_and_b64 exec, exec, vcc
s_cbranch_execnz L_poll2
L_got2:
s_mov_b64 exec, -1
buffer_load_dwordx4 a[0:3], v2, s[8:11], s25 offen offset:0 sc1
buffer_load_dwordx4 a[4:7], v2, s[8:11], s25 offen offset:1024 sc1
buffer_load_dwordx4 a[8:11], v2, s[8:11], s25 offen offset:2048 sc1
buffer_load_dwordx4 a[12:15], v2, s[8:11], s25 offen offset:3072 sc1
s_add_u32 s25, s25, 4096
buffer_load_dwordx4 a[16:19], v2, s[8:11], s25 offen offset:0 sc1
buffer_load_dwordx4 a[20:23], v2, s[8:11], s25 offen offset:1024 sc1
buffer_load_dwordx4 a[24:27], v2, s[8:11], s25 offen offset:2048 sc1
buffer_load_dwordx4 a[28:31], v2, s[8:11], s25 offen offset:3072 sc1
s_add_u32 s25, s25, 4096
buffer_load_dwordx4 a[32:35], v2, s[8:11], s25 offen offset:0 sc1
buffer_load_dwordx4 a[36:39], v2, s[8:11], s25 offen offset:1024 sc1
buffer_load_dwordx4 a[40:43], v2, s[8:11], s25 offen offset:2048 sc1
buffer_load_dwordx4 a[44:47], v2, s[8:11], s25 offen offset:3072 sc1
s_barrier
ds_read_b128 a[216:219], v2 offset:0
ds_read_b128 a[220:223], v2 offset:5120
ds_read_b128 a[224:227], v2 offset:1024
ds_read_b128 a[228:231], v2 offset:6144
ds_read_b128 a[232:235], v2 offset:2048
ds_read_b128 a[236:239], v2 offset:7168
s_mul_i32 s22, s4, 6144
s_mul_i32 s23, s41, 497664
s_add_u32 s23, s23, s22
s_add_u32 s23, s23, 7303168
v_add_u32 v3, s23, v2
s_waitcnt vmcnt(10)
s_waitcnt lgkmcnt(4)
v_mfma_f32_16x16x32_bf16 v[32:35], a[216:219], a[0:3], 0
ds_read_b128 a[240:243], v2 offset:3072
v_mfma_f32_16x16x32_bf16 v[32:35], a[220:223], a[4:7], v[32:35]
ds_read_b128 a[244:247], v2 offset:8192
s_add_u32 s25, s25, 4096
buffer_load_dwordx4 a[48:51], v2, s[8:11], s25 offen offset:0 sc1
s_waitcnt lgkmcnt(4)
v_mfma_f32_16x16x32_bf16 v[36:39], a[224:227], a[0:3], 0
ds_read_b128 a[216:219], v2 offset:4096
v_mfma_f32_16x16x32_bf16 v[36:39], a[228:231], a[4:7], v[36:39]
ds_read_b128 a[220:223], v2 offset:9216
s_waitcnt lgkmcnt(4)
v_mfma_f32_16x16x32_bf16 v[40:43], a[232:235], a[0:3], 0
ds_read_b128 a[224:227], v2 offset:10240
v_mfma_f32_16x16x32_bf16 v[40:43], a[236:239], a[4:7], v[40:43]
ds_read_b128 a[228:231], v2 offset:15360
buffer_load_dwordx4 a[52:55], v2, s[8:11], s25 offen offset:1024 sc1
s_waitcnt lgkmcnt(4)
v_mfma_f32_16x16x32_bf16 v[44:47], a[240:243], a[0:3], 0
ds_read_b128 a[232:235], v2 offset:11264
v_mfma_f32_16x16x32_bf16 v[44:47], a[244:247], a[4:7], v[44:47]
ds_read_b128 a[236:239], v2 offset:16384
s_waitcnt lgkmcnt(4)
v_mfma_f32_16x16x32_bf16 v[48:51], a[216:219], a[0:3], 0
ds_read_b128 a[240:243], v2 offset:12288
v_mfma_f32_16x16x32_bf16 v[48:51], a[220:223], a[4:7], v[48:51]
ds_read_b128 a[244:247], v2 offset:17408
buffer_load_dwordx4 a[56:59], v2, s[8:11], s25 offen offset:2048 sc1
s_waitcnt vmcnt(11)
s_waitcnt lgkmcnt(4)
v_mfma_f32_16x16x32_bf16 v[32:35], a[224:227], a[8:11], v[32:35]
ds_read_b128 a[216:219], v2 offset:13312
v_mfma_f32_16x16x32_bf16 v[32:35], a[228:231], a[12:15], v[32:35]
ds_read_b128 a[220:223], v2 offset:18432
s_waitcnt lgkmcnt(4)
v_mfma_f32_16x16x32_bf16 v[36:39], a[232:235], a[8:11], v[36:39]
ds_read_b128 a[224:227], v2 offset:14336
v_mfma_f32_16x16x32_bf16 v[36:39], a[236:239], a[12:15], v[36:39]
ds_read_b128 a[228:231], v2 offset:19456
buffer_load_dwordx4 a[60:63], v2, s[8:11], s25 offen offset:3072 sc1
s_waitcnt lgkmcnt(4)
v_mfma_f32_16x16x32_bf16 v[40:43], a[240:243], a[8:11], v[40:43]
ds_read_b128 a[232:235], v2 offset:20480
v_mfma_f32_16x16x32_bf16 v[40:43], a[244:247], a[12:15], v[40:43]
ds_read_b128 a[236:239], v2 offset:25600
s_waitcnt lgkmcnt(4)
v_mfma_f32_16x16x32_bf16 v[44:47], a[216:219], a[8:11], v[44:47]
ds_read_b128 a[240:243], v2 offset:21504
v_mfma_f32_16x16x32_bf16 v[44:47], a[220:223], a[12:15], v[44:47]
ds_read_b128 a[244:247], v2 offset:26624
s_add_u32 s25, s25, 4096
buffer_load_dwordx2 a[64:65], v11, s[8:11], s25 offen offset:0 sc1
buffer_load_dwordx2 a[66:67], v11, s[8:11], s25 offen offset:128 sc1
s_waitcnt lgkmcnt(4)
v_mfma_f32_16x16x32_bf16 v[48:51], a[224:227], a[8:11], v[48:51]
ds_read_b128 a[216:219], v2 offset:22528
v_mfma_f32_16x16x32_bf16 v[48:51], a[228:231], a[12:15], v[48:51]
ds_read_b128 a[220:223], v2 offset:27648
s_waitcnt vmcnt(12)
s_waitcnt lgkmcnt(4)
v_mfma_f32_16x16x32_bf16 v[32:35], a[232:235], a[16:19], v[32:35]
ds_read_b128 a[224:227], v2 offset:23552
v_mfma_f32_16x16x32_bf16 v[32:35], a[236:239], a[20:23], v[32:35]
ds_read_b128 a[228:231], v2 offset:28672
buffer_load_dwordx2 a[68:69], v11, s[8:11], s25 offen offset:1024 sc1
buffer_load_dwordx2 a[70:71], v11, s[8:11], s25 offen offset:1152 sc1
s_waitcnt lgkmcnt(4)
v_mfma_f32_16x16x32_bf16 v[36:39], a[240:243], a[16:19], v[36:39]
ds_read_b128 a[232:235], v2 offset:24576
v_mfma_f32_16x16x32_bf16 v[36:39], a[244:247], a[20:23], v[36:39]
ds_read_b128 a[236:239], v2 offset:29696
s_waitcnt lgkmcnt(4)
v_mfma_f32_16x16x32_bf16 v[40:43], a[216:219], a[16:19], v[40:43]
ds_read_b128 a[240:243], v2 offset:30720
v_mfma_f32_16x16x32_bf16 v[40:43], a[220:223], a[20:23], v[40:43]
ds_read_b128 a[244:247], v2 offset:35840
buffer_load_dwordx4 v[56:59], v2, s[8:11], s27 offen sc1
s_waitcnt lgkmcnt(4)
v_mfma_f32_16x16x32_bf16 v[44:47], a[224:227], a[16:19], v[44:47]
ds_read_b128 a[216:219], v2 offset:31744
v_mfma_f32_16x16x32_bf16 v[44:47], a[228:231], a[20:23], v[44:47]
ds_read_b128 a[220:223], v2 offset:36864
s_waitcnt lgkmcnt(4)
v_mfma_f32_16x16x32_bf16 v[48:51], a[232:235], a[16:19], v[48:51]
ds_read_b128 a[224:227], v2 offset:32768
v_mfma_f32_16x16x32_bf16 v[48:51], a[236:239], a[20:23], v[48:51]
ds_read_b128 a[228:231], v2 offset:37888
buffer_load_dwordx4 v[60:63], v2, s[8:11], s27 offen offset:1024 sc1
s_waitcnt vmcnt(14)
s_waitcnt lgkmcnt(4)
v_mfma_f32_16x16x32_bf16 v[32:35], a[240:243], a[24:27], v[32:35]
ds_read_b128 a[232:235], v2 offset:33792
v_mfma_f32_16x16x32_bf16 v[32:35], a[244:247], a[28:31], v[32:35]
ds_read_b128 a[236:239], v2 offset:38912
s_waitcnt lgkmcnt(4)
v_mfma_f32_16x16x32_bf16 v[36:39], a[216:219], a[24:27], v[36:39]
ds_read_b128 a[240:243], v2 offset:34816
v_mfma_f32_16x16x32_bf16 v[36:39], a[220:223], a[28:31], v[36:39]
ds_read_b128 a[244:247], v2 offset:39936
buffer_load_dwordx2 v[64:65], v4, s[8:11], s27 offen sc1
s_waitcnt lgkmcnt(4)
v_mfma_f32_16x16x32_bf16 v[40:43], a[224:227], a[24:27], v[40:43]
ds_read_b128 a[216:219], v2 offset:40960
v_mfma_f32_16x16x32_bf16 v[40:43], a[228:231], a[28:31], v[40:43]
ds_read_b128 a[220:223], v2 offset:46080
s_waitcnt lgkmcnt(4)
v_mfma_f32_16x16x32_bf16 v[44:47], a[232:235], a[24:27], v[44:47]
ds_read_b128 a[224:227], v2 offset:41984
v_mfma_f32_16x16x32_bf16 v[44:47], a[236:239], a[28:31], v[44:47]
ds_read_b128 a[228:231], v2 offset:47104
s_add_u32 m0, s22, 98304
s_nop 0
buffer_load_dwordx4 v3, s[8:11], 0 offen offset:0 sc1 lds
s_waitcnt lgkmcnt(4)
v_mfma_f32_16x16x32_bf16 v[48:51], a[240:243], a[24:27], v[48:51]
ds_read_b128 a[232:235], v2 offset:43008
v_mfma_f32_16x16x32_bf16 v[48:51], a[244:247], a[28:31], v[48:51]
ds_read_b128 a[236:239], v2 offset:48128
s_waitcnt vmcnt(14)
s_waitcnt lgkmcnt(4)
v_mfma_f32_16x16x32_bf16 v[32:35], a[216:219], a[32:35], v[32:35]
ds_read_b128 a[240:243], v2 offset:44032
v_mfma_f32_16x16x32_bf16 v[32:35], a[220:223], a[36:39], v[32:35]
ds_read_b128 a[244:247], v2 offset:49152
buffer_load_dwordx4 v3, s[8:11], 0 offen offset:1024 sc1 lds
s_waitcnt lgkmcnt(4)
v_mfma_f32_16x16x32_bf16 v[36:39], a[224:227], a[32:35], v[36:39]
ds_read_b128 a[216:219], v2 offset:45056
v_mfma_f32_16x16x32_bf16 v[36:39], a[228:231], a[36:39], v[36:39]
ds_read_b128 a[220:223], v2 offset:50176
s_waitcnt lgkmcnt(4)
v_mfma_f32_16x16x32_bf16 v[40:43], a[232:235], a[32:35], v[40:43]
ds_read_b128 a[224:227], v2 offset:51200
v_mfma_f32_16x16x32_bf16 v[40:43], a[236:239], a[36:39], v[40:43]
ds_read_b128 a[228:231], v2 offset:56320
buffer_load_dwordx4 v3, s[8:11], 0 offen offset:2048 sc1 lds
s_waitcnt lgkmcnt(4)
v_mfma_f32_16x16x32_bf16 v[44:47], a[240:243], a[32:35], v[44:47]
ds_read_b128 a[232:235], v2 offset:52224
v_mfma_f32_16x16x32_bf16 v[44:47], a[244:247], a[36:39], v[44:47]
ds_read_b128 a[236:239], v2 offset:57344
s_waitcnt lgkmcnt(4)
v_mfma_f32_16x16x32_bf16 v[48:51], a[216:219], a[32:35], v[48:51]
ds_read_b128 a[240:243], v2 offset:53248
v_mfma_f32_16x16x32_bf16 v[48:51], a[220:223], a[36:39], v[48:51]
ds_read_b128 a[244:247], v2 offset:58368
buffer_load_dwordx4 v3, s[8:11], 0 offen offset:3072 sc1 lds
s_waitcnt vmcnt(15)
s_waitcnt lgkmcnt(4)
v_mfma_f32_16x16x32_bf16 v[32:35], a[224:227], a[40:43], v[32:35]
ds_read_b128 a[216:219], v2 offset:54272
v_mfma_f32_16x16x32_bf16 v[32:35], a[228:231], a[44:47], v[32:35]
ds_read_b128 a[220:223], v2 offset:59392
s_waitcnt lgkmcnt(4)
v_mfma_f32_16x16x32_bf16 v[36:39], a[232:235], a[40:43], v[36:39]
ds_read_b128 a[224:227], v2 offset:55296
v_mfma_f32_16x16x32_bf16 v[36:39], a[236:239], a[44:47], v[36:39]
ds_read_b128 a[228:231], v2 offset:60416
s_add_u32 m0, s22, 102400
v_add_u32 v3, 4096, v3
buffer_load_dwordx4 v3, s[8:11], 0 offen offset:0 sc1 lds
s_waitcnt lgkmcnt(4)
v_mfma_f32_16x16x32_bf16 v[40:43], a[240:243], a[40:43], v[40:43]
ds_read_b128 a[232:235], v2 offset:61440
v_mfma_f32_16x16x32_bf16 v[40:43], a[244:247], a[44:47], v[40:43]
ds_read_b128 a[236:239], v5 offset:1024
s_waitcnt lgkmcnt(4)
v_mfma_f32_16x16x32_bf16 v[44:47], a[216:219], a[40:43], v[44:47]
ds_read_b128 a[240:243], v2 offset:62464
v_mfma_f32_16x16x32_bf16 v[44:47], a[220:223], a[44:47], v[44:47]
ds_read_b128 a[244:247], v5 offset:2048
buffer_load_dwordx4 v3, s[8:11], 0 offen offset:1024 sc1 lds
s_waitcnt lgkmcnt(4)
v_mfma_f32_16x16x32_bf16 v[48:51], a[224:227], a[40:43], v[48:51]
ds_read_b128 a[216:219], v2 offset:63488
v_mfma_f32_16x16x32_bf16 v[48:51], a[228:231], a[44:47], v[48:51]
ds_read_b128 a[220:223], v5 offset:3072
s_waitcnt vmcnt(15)
s_waitcnt lgkmcnt(4)
v_mfma_f32_16x16x32_bf16 v[32:35], a[232:235], a[48:51], v[32:35]
ds_read_b128 a[224:227], v2 offset:64512
v_mfma_f32_16x16x32_bf16 v[32:35], a[236:239], a[52:55], v[32:35]
ds_read_b128 a[228:231], v5 offset:4096
s_add_u32 m0, s22, 122880
v_add_u32 v3, 20480, v3
buffer_load_dwordx4 v3, s[8:11], 0 offen offset:0 sc1 lds
s_waitcnt lgkmcnt(4)
v_mfma_f32_16x16x32_bf16 v[36:39], a[240:243], a[48:51], v[36:39]
ds_read_b128 a[232:235], v5 offset:0
v_mfma_f32_16x16x32_bf16 v[36:39], a[244:247], a[52:55], v[36:39]
ds_read_b128 a[236:239], v5 offset:5120
s_waitcnt lgkmcnt(4)
v_mfma_f32_16x16x32_bf16 v[40:43], a[216:219], a[48:51], v[40:43]
ds_read_b128 a[240:243], v5 offset:6144
v_mfma_f32_16x16x32_bf16 v[40:43], a[220:223], a[52:55], v[40:43]
ds_read_b128 a[244:247], v5 offset:11264
buffer_load_dwordx4 v3, s[8:11], 0 offen offset:1024 sc1 lds
s_waitcnt lgkmcnt(4)
v_mfma_f32_16x16x32_bf16 v[44:47], a[224:227], a[48:51], v[44:47]
ds_read_b128 a[216:219], v5 offset:7168
v_mfma_f32_16x16x32_bf16 v[44:47], a[228:231], a[52:55], v[44:47]
ds_read_b128 a[220:223], v5 offset:12288
s_waitcnt lgkmcnt(4)
v_mfma_f32_16x16x32_bf16 v[48:51], a[232:235], a[48:51], v[48:51]
ds_read_b128 a[224:227], v5 offset:8192
v_mfma_f32_16x16x32_bf16 v[48:51], a[236:239], a[52:55], v[48:51]
ds_read_b128 a[228:231], v5 offset:13312
buffer_load_dwordx4 v3, s[8:11], 0 offen offset:2048 sc1 lds
s_waitcnt vmcnt(16)
s_waitcnt lgkmcnt(4)
v_mfma_f32_16x16x32_bf16 v[32:35], a[240:243], a[56:59], v[32:35]
ds_read_b128 a[232:235], v5 offset:9216
v_mfma_f32_16x16x32_bf16 v[32:35], a[244:247], a[60:63], v[32:35]
ds_read_b128 a[236:239], v5 offset:14336
s_waitcnt lgkmcnt(4)
v_mfma_f32_16x16x32_bf16 v[36:39], a[216:219], a[56:59], v[36:39]
ds_read_b128 a[240:243], v5 offset:10240
v_mfma_f32_16x16x32_bf16 v[36:39], a[220:223], a[60:63], v[36:39]
ds_read_b128 a[244:247], v5 offset:15360
buffer_load_dwordx4 v3, s[8:11], 0 offen offset:3072 sc1 lds
s_waitcnt lgkmcnt(4)
v_mfma_f32_16x16x32_bf16 v[40:43], a[224:227], a[56:59], v[40:43]
ds_read_b128 a[216:219], v5 offset:16384
v_mfma_f32_16x16x32_bf16 v[40:43], a[228:231], a[60:63], v[40:43]
ds_read_b128 a[220:223], v5 offset:21504
s_waitcnt lgkmcnt(4)
v_mfma_f32_16x16x32_bf16 v[44:47], a[232:235], a[56:59], v[44:47]
ds_read_b128 a[224:227], v5 offset:17408
v_mfma_f32_16x16x32_bf16 v[44:47], a[236:239], a[60:63], v[44:47]
ds_read_b128 a[228:231], v5 offset:22528
s_add_u32 m0, s22, 126976
v_add_u32 v3, 4096, v3
buffer_load_dwordx4 v3, s[8:11], 0 offen offset:0 sc1 lds
s_waitcnt lgkmcnt(4)
v_mfma_f32_16x16x32_bf16 v[48:51], a[240:243], a[56:59], v[48:51]
ds_read_b128 a[232:235], v5 offset:18432
v_mfma_f32_16x16x32_bf16 v[48:51], a[244:247], a[60:63], v[48:51]
ds_read_b128 a[236:239], v5 offset:23552
s_waitcnt vmcnt(14)
s_waitcnt lgkmcnt(4)
v_mfma_f32_16x16x32_bf16 v[32:35], a[216:219], a[64:67], v[32:35]
ds_read_b128 a[240:243], v5 offset:19456
v_mfma_f32_16x16x32_bf16 v[32:35], a[220:223], a[68:71], v[32:35]
ds_read_b128 a[244:247], v5 offset:24576
buffer_load_dwordx4 v3, s[8:11], 0 offen offset:1024 sc1 lds
s_waitcnt lgkmcnt(4)
v_mfma_f32_16x16x32_bf16 v[36:39], a[224:227], a[64:67], v[36:39]
ds_read_b128 a[216:219], v5 offset:20480
v_mfma_f32_16x16x32_bf16 v[36:39], a[228:231], a[68:71], v[36:39]
ds_read_b128 a[220:223], v5 offset:25600
s_waitcnt lgkmcnt(4)
v_mfma_f32_16x16x32_bf16 v[40:43], a[232:235], a[64:67], v[40:43]
v_mfma_f32_16x16x32_bf16 v[40:43], a[236:239], a[68:71], v[40:43]
s_waitcnt lgkmcnt(2)
v_mfma_f32_16x16x32_bf16 v[44:47], a[240:243], a[64:67], v[44:47]
v_mfma_f32_16x16x32_bf16 v[44:47], a[244:247], a[68:71], v[44:47]
s_waitcnt lgkmcnt(0)
v_mfma_f32_16x16x32_bf16 v[48:51], a[216:219], a[64:67], v[48:51]
v_mfma_f32_16x16x32_bf16 v[48:51], a[220:223], a[68:71], v[48:51]
s_waitcnt vmcnt(12)
v_lshlrev_b32 v68, 16, v56
v_and_b32 v69, 0xffff0000, v56
v_add_f32 v32, v32, v68
v_add_f32 v33, v33, v69
v_lshlrev_b32 v70, 16, v57
v_and_b32 v71, 0xffff0000, v57
v_add_f32 v34, v34, v70
v_add_f32 v35, v35, v71
v_lshlrev_b32 v72, 16, v58
v_and_b32 v73, 0xffff0000, v58
v_add_f32 v36, v36, v72
v_add_f32 v37, v37, v73
v_lshlrev_b32 v74, 16, v59
v_and_b32 v75, 0xffff0000, v59
v_add_f32 v38, v38, v74
v_add_f32 v39, v39, v75
v_lshlrev_b32 v68, 16, v60
v_and_b32 v69, 0xffff0000, v60
v_add_f32 v40, v40, v68
v_add_f32 v41, v41, v69
v_lshlrev_b32 v70, 16, v61
v_and_b32 v71, 0xffff0000, v61
v_add_f32 v42, v42, v70
v_add_f32 v43, v43, v71
v_lshlrev_b32 v72, 16, v62
v_and_b32 v73, 0xffff0000, v62
v_add_f32 v44, v44, v72
v_add_f32 v45, v45, v73
v_lshlrev_b32 v74, 16, v63
v_and_b32 v75, 0xffff0000, v63
v_add_f32 v46, v46, v74
v_add_f32 v47, v47, v75
v_lshlrev_b32 v68, 16, v64
v_and_b32 v69, 0xffff0000, v64
v_add_f32 v48, v48, v68
v_add_f32 v49, v49, v69
v_lshlrev_b32 v70, 16, v65
v_and_b32 v71, 0xffff0000, v65
v_add_f32 v50, v50, v70
v_add_f32 v51, v51, v71
v_cvt_pk_bf16_f32 v80, v32, v33
v_cvt_pk_bf16_f32 v81, v34, v35
v_cvt_pk_bf16_f32 v82, v36, v37
v_cvt_pk_bf16_f32 v83, v38, v39
v_cvt_pk_bf16_f32 v84, v40, v41
v_cvt_pk_bf16_f32 v85, v42, v43
v_cvt_pk_bf16_f32 v86, v44, v45
v_cvt_pk_bf16_f32 v87, v46, v47
v_cvt_pk_bf16_f32 v88, v48, v49
v_cvt_pk_bf16_f32 v89, v50, v51
s_add_u32 s27, s26, s73
buffer_store_dwordx4 v[80:83], v2, s[8:11], s27 offen sc1
buffer_store_dwordx4 v[84:87], v2, s[8:11], s27 offen offset:1024 sc1
buffer_store_dwordx2 v[88:89], v4, s[8:11], s27 offen sc1
v_add_f32 v10, v32, v33
v_mul_f32 v11, v32, v32
v_mul_f32 v13, v33, v33
v_mov_b32 v12, 0
v_add_f32 v10, v10, v34
v_add_f32 v12, v12, v35
v_fmac_f32 v11, v34, v34
v_fmac_f32 v13, v35, v35
v_add_f32 v10, v10, v36
v_add_f32 v12, v12, v37
v_fmac_f32 v11, v36, v36
v_fmac_f32 v13, v37, v37
v_add_f32 v10, v10, v38
v_add_f32 v12, v12, v39
v_fmac_f32 v11, v38, v38
v_fmac_f32 v13, v39, v39
v_add_f32 v10, v10, v40
v_add_f32 v12, v12, v41
v_fmac_f32 v11, v40, v40
v_fmac_f32 v13, v41, v41
v_add_f32 v10, v10, v42
v_add_f32 v12, v12, v43
v_fmac_f32 v11, v42, v42
v_fmac_f32 v13, v43, v43
v_add_f32 v10, v10, v44
v_add_f32 v12, v12, v45
v_fmac_f32 v11, v44, v44
v_fmac_f32 v13, v45, v45
v_add_f32 v10, v10, v46
v_add_f32 v12, v12, v47
v_fmac_f32 v11, v46, v46
v_fmac_f32 v13, v47, v47
v_add_f32 v10, v10, v48
v_add_f32 v12, v12, v49
v_fmac_f32 v11, v48, v48
v_fmac_f32 v13, v49, v49
v_add_f32 v10, v10, v50
v_add_f32 v12, v12, v51
v_fmac_f32 v11, v50, v50
v_fmac_f32 v13, v51, v51
v_add_f32 v10, v10, v12
v_add_f32 v11, v11, v13
v_mov_b32 v12, v10
v_mov_b32 v13, v11
s_nop 0
v_permlane16_swap_b32 v10, v12
v_permlane16_swap_b32 v11, v13
v_add_f32 v10, v10, v12
v_add_f32 v11, v11, v13
v_mov_b32 v12, v10
v_mov_b32 v13, v11
s_nop 0
v_permlane32_swap_b32 v10, v12
v_permlane32_swap_b32 v11, v13
v_add_f32 v10, v10, v12
v_add_f32 v11, v11, v13
v_lshlrev_b32 v8, 3, v6
v_cmp_gt_u32 vcc, 16, v1
s_nop 1
v_cndmask_b32 v8, v9, v8, vcc
s_lshl_b32 s27, s20, 10
s_lshl_b32 s28, s21, 7
s_add_u32 s27, s27, s28
s_add_u32 s27, s27, s74
buffer_store_dwordx2 v[10:11], v8, s[8:11], s27 offen sc1
s_lshr_b32 s27, s20, 2
s_lshl_b32 s27, s27, 3
s_add_u32 s27, s27, s21
s_lshl_b32 s14, s27, 7
s_add_u32 s14, s14, 524288
s_add_u32 s14, s14, s77
s_lshl_b32 s44, s40, 4
s_lshl_b32 s45, s4, 2
s_add_u32 s44, s44, s45
s_mul_i32 s46, s44, 18432
s_add_u32 s20, s46, s73
v_add_u32 v4, 18432, v2
v_add_u32 v5, 36864, v2
v_add_u32 v6, 55296, v2
v_lshlrev_b32 v248, 3, v1
v_add_u32 v249, 18432, v248
v_add_u32 v250, 36864, v248
v_add_u32 v251, 55296, v248
v_and_b32 v13, 15, v1
v_lshrrev_b32 v14, 4, v1
v_add_u32 v7, 0x10000, v2
v_add_u32 v8, 0x20000, v2
v_and_b32 v9, 1, v14
v_mul_u32_u24 v9, 18432, v9
v_lshrrev_b32 v15, 1, v14
v_lshlrev_b32 v15, 8, v15
v_lshl_add_u32 v15, v13, 4, v15
v_add_u32 v9, v9, v15
v_and_b32 v11, 3, v1
v_lshlrev_b32 v11, 7, v11
s_lshl_b32 s49, s43, 7
v_mov_b32 v10, 2146435072
v_mov_b32 v15, s49
v_cmp_eq_u32 vcc, 0, v1
s_nop 1
v_cndmask_b32 v10, v10, v15, vcc
s_lshl_b32 s49, s40, 3
s_add_u32 s49, s49, s42
s_lshl_b32 s50, s49, 2
s_add_u32 s50, s50, s4
s_lshl_b32 s50, s50, 9
s_add_u32 s34, s50, s77
s_add_u32 s34, s34, 0
s_lshl_b32 s49, s49, 4
s_add_u32 s49, s49, s45
s_mul_i32 s49, s49, 18432
s_add_u32 s49, s49, s75
s_add_u32 s50, s43, 0
s_and_b32 s50, s50, 3
s_mul_i32 s50, s50, 9
s_add_u32 s50, s50, 1
s_lshr_b32 s50, s50, 1
s_lshl_b32 s50, s50, 10
s_add_u32 s24, s49, s50
s_add_u32 s50, s43, 1
s_and_b32 s50, s50, 3
s_mul_i32 s50, s50, 9
s_add_u32 s50, s50, 1
s_lshr_b32 s50, s50, 1
s_lshl_b32 s50, s50, 10
s_add_u32 s25, s49, s50
s_add_u32 s50, s43, 2
s_and_b32 s50, s50, 3
s_mul_i32 s50, s50, 9
s_add_u32 s50, s50, 1
s_lshr_b32 s50, s50, 1
s_lshl_b32 s50, s50, 10
s_add_u32 s26, s49, s50
s_add_u32 s50, s43, 3
s_and_b32 s50, s50, 3
s_mul_i32 s50, s50, 9
s_add_u32 s50, s50, 1
s_lshr_b32 s50, s50, 1
s_lshl_b32 s50, s50, 10
s_add_u32 s27, s49, s50
s_add_u32 s28, s49, 4096
s_add_u32 s29, s49, 13312
s_cmp_ge_u32 s43, 2
s_cselect_b32 s50, s29, s28
s_and_b32 s51, s43, 1
s_lshl_b32 s51, s51, 9
s_add_u32 s30, s50, s51
s_mul_i32 s50, s42, 2359296
s_add_u32 s50, s50, s46
s_add_u32 s50, s50, s76
s_lshl_b32 s51, s43, 12
s_add_u32 s31, s50, s51
s_lshl_b32 s51, s43, 9
s_add_u32 s50, s50, s51
s_add_u32 s32, s50, 16384
s_add_u32 s33, s32, 36864
s_add_u32 s36, s31, 0
s_add_u32 s37, s31, 18432
s_add_u32 s38, s31, 36864
s_add_u32 s39, s31, 55296
v_lshlrev_b32 v252, 4, v13
v_lshl_add_u32 v252, v14, 9, v252
s_lshl_b32 s35, s40, 5
s_add_u32 s35, s35, s41
s_lshl_b32 s35, s35, 7
s_add_u32 s35, s35, s77
s_add_u32 s35, s35, 655360
v_lshlrev_b32 v17, 3, v13
v_lshl_add_u32 v17, v14, 8, v17
s_lshl_b32 s47, s44, 10
s_add_u32 s47, s47, s74
s_lshl_b32 s49, s44, 8
s_add_u32 s49, s49, s77
s_add_u32 s49, s49, 524288
v_and_b32 v16, 7, v1
v_lshlrev_b32 v16, 7, v16
v_mov_b32 v13, 2146435072
v_cmp_eq_u32 vcc, 0, v0
v_mov_b32 v14, s68
v_mov_b32 v15, s69
v_cndmask_b32 v13, v13, 0, vcc
s_waitcnt vmcnt(0)
s_barrier
buffer_store_dwordx2 v[14:15], v13, s[8:11], s14 offen sc1
s_add_u32 m0, s22, 0
v_add_u32 v3, 20480, v3
buffer_load_dwordx4 v3, s[8:11], 0 offen offset:0 sc1 lds
buffer_load_dwordx4 v3, s[8:11], 0 offen offset:1024 sc1 lds
buffer_load_dwordx4 v3, s[8:11], 0 offen offset:2048 sc1 lds
buffer_load_dwordx4 v3, s[8:11], 0 offen offset:3072 sc1 lds
s_add_u32 m0, s22, 4096
v_add_u32 v3, 4096, v3
buffer_load_dwordx4 v3, s[8:11], 0 offen offset:0 sc1 lds
buffer_load_dwordx4 v3, s[8:11], 0 offen offset:1024 sc1 lds
s_add_u32 m0, s22, 24576
v_add_u32 v3, 20480, v3
buffer_load_dwordx4 v3, s[8:11], 0 offen offset:0 sc1 lds
buffer_load_dwordx4 v3, s[8:11], 0 offen offset:1024 sc1 lds
buffer_load_dwordx4 v3, s[8:11], 0 offen offset:2048 sc1 lds
buffer_load_dwordx4 v3, s[8:11], 0 offen offset:3072 sc1 lds
s_add_u32 m0, s22, 28672
v_add_u32 v3, 4096, v3
buffer_load_dwordx4 v3, s[8:11], 0 offen offset:0 sc1 lds
buffer_load_dwordx4 v3, s[8:11], 0 offen offset:1024 sc1 lds
ds_read_b128 v[48:51], v7 offset:32768
ds_read_b128 v[52:55], v7 offset:33792
ds_read_b128 v[56:59], v7 offset:34816
ds_read_b128 v[60:63], v7 offset:35840
ds_read_b128 v[64:67], v7 offset:36864
ds_read_b128 v[68:71], v7 offset:37888
s_mov_b32 s52, 0
L_poll3:
buffer_load_dwordx2 v[14:15], v16, s[8:11], s49 offen sc1
s_add_u32 s52, s52, 1
s_waitcnt vmcnt(0)
v_cmp_ne_u64 vcc, s[68:69], v[14:15]
s_cmp_ge_u32 s52, 1048576
s_cbranch_scc1 L_got3
s_and_b64 exec, exec, vcc
s_cbranch_execnz L_poll3
L_got3:
s_mov_b64 exec, -1
s_add_u32 s48, s20, 0
buffer_load_dwordx4 a[0:3], v2, s[8:11], s48 offen offset:0 sc1
buffer_load_dwordx4 a[4:7], v4, s[8:11], s48 offen offset:0 sc1
buffer_load_dwordx4 a[8:11], v5, s[8:11], s48 offen offset:0 sc1
buffer_load_dwordx4 a[12:15], v6, s[8:11], s48 offen offset:0 sc1
buffer_load_dwordx4 a[16:19], v2, s[8:11], s48 offen offset:1024 sc1
buffer_load_dwordx4 a[20:23], v4, s[8:11], s48 offen offset:1024 sc1
buffer_load_dwordx4 a[24:27], v5, s[8:11], s48 offen offset:1024 sc1
buffer_load_dwordx4 a[28:31], v6, s[8:11], s48 offen offset:1024 sc1
buffer_load_dwordx2 v[144:145], v17, s[8:11], s47 offen offset:0 sc1
buffer_load_dwordx2 v[146:147], v17, s[8:11], s47 offen offset:128 sc1
buffer_load_dwordx2 v[148:149], v17, s[8:11], s47 offen offset:1024 sc1
buffer_load_dwordx2 v[150:151], v17, s[8:11], s47 offen offset:1152 sc1
buffer_load_dwordx2 v[152:153], v17, s[8:11], s47 offen offset:2048 sc1
buffer_load_dwordx2 v[154:155], v17, s[8:11], s47 offen offset:2176 sc1
buffer_load_dwordx2 v[156:157], v17, s[8:11], s47 offen offset:3072 sc1
buffer_load_dwordx2 v[158:159], v17, s[8:11], s47 offen offset:3200 sc1
buffer_load_dwordx4 a[32:35], v2, s[8:11], s48 offen offset:2048 sc1
buffer_load_dwordx4 a[36:39], v4, s[8:11], s48 offen offset:2048 sc1
buffer_load_dwordx4 a[40:43], v5, s[8:11], s48 offen offset:2048 sc1
buffer_load_dwordx4 a[44:47], v6, s[8:11], s48 offen offset:2048 sc1
buffer_load_dwordx4 a[48:51], v2, s[8:11], s48 offen offset:3072 sc1
buffer_load_dwordx4 a[52:55], v4, s[8:11], s48 offen offset:3072 sc1
buffer_load_dwordx4 a[56:59], v5, s[8:11], s48 offen offset:3072 sc1
buffer_load_dwordx4 a[60:63], v6, s[8:11], s48 offen offset:3072 sc1
s_add_u32 s48, s20, 4096
buffer_load_dwordx4 a[64:67], v2, s[8:11], s48 offen offset:0 sc1
buffer_load_dwordx4 a[68:71], v4, s[8:11], s48 offen offset:0 sc1
buffer_load_dwordx4 a[72:75], v5, s[8:11], s48 offen offset:0 sc1
buffer_load_dwordx4 a[76:79], v6, s[8:11], s48 offen offset:0 sc1
buffer_load_dwordx4 a[80:83], v2, s[8:11], s48 offen offset:1024 sc1
buffer_load_dwordx4 a[84:87], v4, s[8:11], s48 offen offset:1024 sc1
buffer_load_dwordx4 a[88:91], v5, s[8:11], s48 offen offset:1024 sc1
buffer_load_dwordx4 a[92:95], v6, s[8:11], s48 offen offset:1024 sc1
s_waitcnt vmcnt(24)
s_waitcnt lgkmcnt(4)
v_mfma_f32_16x16x32_bf16 v[80:83], v[48:51], a[0:3], 0
buffer_load_dwordx4 a[96:99], v2, s[8:11], s48 offen offset:2048 sc1
v_mfma_f32_16x16x32_bf16 v[80:83], v[52:55], a[16:19], v[80:83]
v_mfma_f32_16x16x32_bf16 v[84:87], v[48:51], a[4:7], 0
ds_read_b128 v[72:75], v7 offset:38912
v_mfma_f32_16x16x32_bf16 v[84:87], v[52:55], a[20:23], v[84:87]
v_mfma_f32_16x16x32_bf16 v[88:91], v[48:51], a[8:11], 0
buffer_load_dwordx4 a[100:103], v4, s[8:11], s48 offen offset:2048 sc1
v_mfma_f32_16x16x32_bf16 v[88:91], v[52:55], a[24:27], v[88:91]
ds_read_b128 v[76:79], v7 offset:39936
v_mfma_f32_16x16x32_bf16 v[92:95], v[48:51], a[12:15], 0
v_mfma_f32_16x16x32_bf16 v[92:95], v[52:55], a[28:31], v[92:95]
s_waitcnt lgkmcnt(4)
v_mfma_f32_16x16x32_bf16 v[96:99], v[56:59], a[0:3], 0
buffer_load_dwordx4 a[104:107], v5, s[8:11], s48 offen offset:2048 sc1
v_mfma_f32_16x16x32_bf16 v[96:99], v[60:63], a[16:19], v[96:99]
v_mfma_f32_16x16x32_bf16 v[100:103], v[56:59], a[4:7], 0
ds_read_b128 v[48:51], v7 offset:40960
v_mfma_f32_16x16x32_bf16 v[100:103], v[60:63], a[20:23], v[100:103]
v_mfma_f32_16x16x32_bf16 v[104:107], v[56:59], a[8:11], 0
buffer_load_dwordx4 a[108:111], v6, s[8:11], s48 offen offset:2048 sc1
v_mfma_f32_16x16x32_bf16 v[104:107], v[60:63], a[24:27], v[104:107]
ds_read_b128 v[52:55], v7 offset:41984
v_mfma_f32_16x16x32_bf16 v[108:111], v[56:59], a[12:15], 0
v_mfma_f32_16x16x32_bf16 v[108:111], v[60:63], a[28:31], v[108:111]
s_waitcnt lgkmcnt(4)
v_mfma_f32_16x16x32_bf16 v[112:115], v[64:67], a[0:3], 0
buffer_load_dwordx4 a[112:115], v2, s[8:11], s48 offen offset:3072 sc1
v_mfma_f32_16x16x32_bf16 v[112:115], v[68:71], a[16:19], v[112:115]
v_mfma_f32_16x16x32_bf16 v[116:119], v[64:67], a[4:7], 0
ds_read_b128 v[56:59], v7 offset:43008
v_mfma_f32_16x16x32_bf16 v[116:119], v[68:71], a[20:23], v[116:119]
v_mfma_f32_16x16x32_bf16 v[120:123], v[64:67], a[8:11], 0
buffer_load_dwordx4 a[116:119], v4, s[8:11], s48 offen offset:3072 sc1
v_mfma_f32_16x16x32_bf16 v[120:123], v[68:71], a[24:27], v[120:123]
ds_read_b128 v[60:63], v7 offset:44032
v_mfma_f32_16x16x32_bf16 v[124:127], v[64:67], a[12:15], 0
v_mfma_f32_16x16x32_bf16 v[124:127], v[68:71], a[28:31], v[124:127]
s_waitcnt lgkmcnt(4)
v_mfma_f32_16x16x32_bf16 v[128:131], v[72:75], a[0:3], 0
buffer_load_dwordx4 a[120:123], v5, s[8:11], s48 offen offset:3072 sc1
v_mfma_f32_16x16x32_bf16 v[128:131], v[76:79], a[16:19], v[128:131]
v_mfma_f32_16x16x32_bf16 v[132:135], v[72:75], a[4:7], 0
ds_read_b128 v[64:67], v7 offset:45056
v_mfma_f32_16x16x32_bf16 v[132:135], v[76:79], a[20:23], v[132:135]
v_mfma_f32_16x16x32_bf16 v[136:139], v[72:75], a[8:11], 0
buffer_load_dwordx4 a[124:127], v6, s[8:11], s48 offen offset:3072 sc1
v_mfma_f32_16x16x32_bf16 v[136:139], v[76:79], a[24:27], v[136:139]
ds_read_b128 v[68:71], v7 offset:46080
s_add_u32 s48, s20, 8192
v_mfma_f32_16x16x32_bf16 v[140:143], v[72:75], a[12:15], 0
v_mfma_f32_16x16x32_bf16 v[140:143], v[76:79], a[28:31], v[140:143]
s_waitcnt vmcnt(16)
s_waitcnt lgkmcnt(4)
v_mfma_f32_16x16x32_bf16 v[80:83], v[48:51], a[32:35], v[80:83]
buffer_load_dwordx4 a[128:131], v2, s[8:11], s48 offen offset:0 sc1
v_mfma_f32_16x16x32_bf16 v[80:83], v[52:55], a[48:51], v[80:83]
v_mfma_f32_16x16x32_bf16 v[84:87], v[48:51], a[36:39], v[84:87]
ds_read_b128 v[72:75], v7 offset:47104
v_mfma_f32_16x16x32_bf16 v[84:87], v[52:55], a[52:55], v[84:87]
v_mfma_f32_16x16x32_bf16 v[88:91], v[48:51], a[40:43], v[88:91]
buffer_load_dwordx4 a[132:135], v4, s[8:11], s48 offen offset:0 sc1
v_mfma_f32_16x16x32_bf16 v[88:91], v[52:55], a[56:59], v[88:91]
ds_read_b128 v[76:79], v7 offset:48128
v_mfma_f32_16x16x32_bf16 v[92:95], v[48:51], a[44:47], v[92:95]
v_mfma_f32_16x16x32_bf16 v[92:95], v[52:55], a[60:63], v[92:95]
s_waitcnt lgkmcnt(4)
v_mfma_f32_16x16x32_bf16 v[96:99], v[56:59], a[32:35], v[96:99]
buffer_load_dwordx4 a[136:139], v5, s[8:11], s48 offen offset:0 sc1
v_mfma_f32_16x16x32_bf16 v[96:99], v[60:63], a[48:51], v[96:99]
v_mfma_f32_16x16x32_bf16 v[100:103], v[56:59], a[36:39], v[100:103]
ds_read_b128 v[48:51], v7 offset:49152
v_mfma_f32_16x16x32_bf16 v[100:103], v[60:63], a[52:55], v[100:103]
v_mfma_f32_16x16x32_bf16 v[104:107], v[56:59], a[40:43], v[104:107]
buffer_load_dwordx4 a[140:143], v6, s[8:11], s48 offen offset:0 sc1
v_mfma_f32_16x16x32_bf16 v[104:107], v[60:63], a[56:59], v[104:107]
ds_read_b128 v[52:55], v7 offset:50176
v_mfma_f32_16x16x32_bf16 v[108:111], v[56:59], a[44:47], v[108:111]
v_mfma_f32_16x16x32_bf16 v[108:111], v[60:63], a[60:63], v[108:111]
s_waitcnt lgkmcnt(4)
v_mfma_f32_16x16x32_bf16 v[112:115], v[64:67], a[32:35], v[112:115]
buffer_load_dwordx4 a[144:147], v2, s[8:11], s48 offen offset:1024 sc1
v_mfma_f32_16x16x32_bf16 v[112:115], v[68:71], a[48:51], v[112:115]
v_mfma_f32_16x16x32_bf16 v[116:119], v[64:67], a[36:39], v[116:119]
ds_read_b128 v[56:59], v7 offset:51200
v_mfma_f32_16x16x32_bf16 v[116:119], v[68:71], a[52:55], v[116:119]
v_mfma_f32_16x16x32_bf16 v[120:123], v[64:67], a[40:43], v[120:123]
buffer_load_dwordx4 a[148:151], v4, s[8:11], s48 offen offset:1024 sc1
v_mfma_f32_16x16x32_bf16 v[120:123], v[68:71], a[56:59], v[120:123]
ds_read_b128 v[60:63], v7 offset:52224
v_mfma_f32_16x16x32_bf16 v[124:127], v[64:67], a[44:47], v[124:127]
v_mfma_f32_16x16x32_bf16 v[124:127], v[68:71], a[60:63], v[124:127]
s_waitcnt lgkmcnt(4)
v_mfma_f32_16x16x32_bf16 v[128:131], v[72:75], a[32:35], v[128:131]
buffer_load_dwordx4 a[152:155], v5, s[8:11], s48 offen offset:1024 sc1
v_mfma_f32_16x16x32_bf16 v[128:131], v[76:79], a[48:51], v[128:131]
v_mfma_f32_16x16x32_bf16 v[132:135], v[72:75], a[36:39], v[132:135]
ds_read_b128 v[64:67], v7 offset:53248
v_mfma_f32_16x16x32_bf16 v[132:135], v[76:79], a[52:55], v[132:135]
v_mfma_f32_16x16x32_bf16 v[136:139], v[72:75], a[40:43], v[136:139]
buffer_load_dwordx4 a[156:159], v6, s[8:11], s48 offen offset:1024 sc1
v_mfma_f32_16x16x32_bf16 v[136:139], v[76:79], a[56:59], v[136:139]
ds_read_b128 v[68:71], v7 offset:54272
v_mfma_f32_16x16x32_bf16 v[140:143], v[72:75], a[44:47], v[140:143]
v_mfma_f32_16x16x32_bf16 v[140:143], v[76:79], a[60:63], v[140:143]
s_waitcnt vmcnt(16)
s_waitcnt lgkmcnt(4)
v_mfma_f32_16x16x32_bf16 v[80:83], v[48:51], a[64:67], v[80:83]
buffer_load_dwordx4 a[160:163], v2, s[8:11], s48 offen offset:2048 sc1
v_mfma_f32_16x16x32_bf16 v[80:83], v[52:55], a[80:83], v[80:83]
v_mfma_f32_16x16x32_bf16 v[84:87], v[48:51], a[68:71], v[84:87]
ds_read_b128 v[72:75], v7 offset:55296
v_mfma_f32_16x16x32_bf16 v[84:87], v[52:55], a[84:87], v[84:87]
v_add_f32 v144, v144, v146
v_add_f32 v145, v145, v147
v_mfma_f32_16x16x32_bf16 v[88:91], v[48:51], a[72:75], v[88:91]
buffer_load_dwordx4 a[164:167], v4, s[8:11], s48 offen offset:2048 sc1
v_mfma_f32_16x16x32_bf16 v[88:91], v[52:55], a[88:91], v[88:91]
ds_read_b128 v[76:79], v7 offset:56320
v_add_f32 v148, v148, v150
v_mfma_f32_16x16x32_bf16 v[92:95], v[48:51], a[76:79], v[92:95]
v_add_f32 v149, v149, v151
v_add_f32 v152, v152, v154
v_mfma_f32_16x16x32_bf16 v[92:95], v[52:55], a[92:95], v[92:95]
v_add_f32 v153, v153, v155
s_waitcnt lgkmcnt(4)
v_mfma_f32_16x16x32_bf16 v[96:99], v[56:59], a[64:67], v[96:99]
buffer_load_dwordx4 a[168:171], v5, s[8:11], s48 offen offset:2048 sc1
v_mfma_f32_16x16x32_bf16 v[96:99], v[60:63], a[80:83], v[96:99]
s_barrier
v_mfma_f32_16x16x32_bf16 v[100:103], v[56:59], a[68:71], v[100:103]
ds_read_b128 v[48:51], v7 offset:57344
v_add_f32 v156, v156, v158
v_mfma_f32_16x16x32_bf16 v[100:103], v[60:63], a[84:87], v[100:103]
v_add_f32 v157, v157, v159
v_mov_b32 v160, v144
v_mfma_f32_16x16x32_bf16 v[104:107], v[56:59], a[72:75], v[104:107]
buffer_load_dwordx4 a[172:175], v6, s[8:11], s48 offen offset:2048 sc1
v_mfma_f32_16x16x32_bf16 v[104:107], v[60:63], a[88:91], v[104:107]
ds_read_b128 v[52:55], v7 offset:58368
v_mov_b32 v161, v145
v_mfma_f32_16x16x32_bf16 v[108:111], v[56:59], a[76:79], v[108:111]
v_mov_b32 v162, v148
v_mov_b32 v163, v149
v_mfma_f32_16x16x32_bf16 v[108:111], v[60:63], a[92:95], v[108:111]
v_mov_b32 v164, v152
s_waitcnt lgkmcnt(4)
v_mfma_f32_16x16x32_bf16 v[112:115], v[64:67], a[64:67], v[112:115]
buffer_load_dwordx4 a[176:179], v2, s[8:11], s48 offen offset:3072 sc1
v_mfma_f32_16x16x32_bf16 v[112:115], v[68:71], a[80:83], v[112:115]
v_mov_b32 v165, v153
v_mov_b32 v166, v156
v_mfma_f32_16x16x32_bf16 v[116:119], v[64:67], a[68:71], v[116:119]
ds_read_b128 v[56:59], v7 offset:59392
v_mov_b32 v167, v157
v_mfma_f32_16x16x32_bf16 v[116:119], v[68:71], a[84:87], v[116:119]
v_permlane16_swap_b32 v144, v160
v_permlane16_swap_b32 v145, v161
v_mfma_f32_16x16x32_bf16 v[120:123], v[64:67], a[72:75], v[120:123]
buffer_load_dwordx4 a[180:183], v4, s[8:11], s48 offen offset:3072 sc1
v_mfma_f32_16x16x32_bf16 v[120:123], v[68:71], a[88:91], v[120:123]
ds_read_b128 v[60:63], v7 offset:60416
v_permlane16_swap_b32 v148, v162
v_mfma_f32_16x16x32_bf16 v[124:127], v[64:67], a[76:79], v[124:127]
v_permlane16_swap_b32 v149, v163
v_permlane16_swap_b32 v152, v164
v_mfma_f32_16x16x32_bf16 v[124:127], v[68:71], a[92:95], v[124:127]
v_permlane16_swap_b32 v153, v165
s_waitcnt lgkmcnt(4)
v_mfma_f32_16x16x32_bf16 v[128:131], v[72:75], a[64:67], v[128:131]
buffer_load_dwordx4 a[184:187], v5, s[8:11], s48 offen offset:3072 sc1
v_mfma_f32_16x16x32_bf16 v[128:131], v[76:79], a[80:83], v[128:131]
v_permlane16_swap_b32 v156, v166
v_permlane16_swap_b32 v157, v167
v_mfma_f32_16x16x32_bf16 v[132:135], v[72:75], a[68:71], v[132:135]
ds_read_b128 v[64:67], v7 offset:61440
v_add_f32 v144, v144, v160
v_mfma_f32_16x16x32_bf16 v[132:135], v[76:79], a[84:87], v[132:135]
v_add_f32 v145, v145, v161
v_add_f32 v148, v148, v162
v_mfma_f32_16x16x32_bf16 v[136:139], v[72:75], a[72:75], v[136:139]
buffer_load_dwordx4 a[188:191], v6, s[8:11], s48 offen offset:3072 sc1
v_mfma_f32_16x16x32_bf16 v[136:139], v[76:79], a[88:91], v[136:139]
ds_read_b128 v[68:71], v7 offset:62464
s_add_u32 s48, s20, 12288
v_mfma_f32_16x16x32_bf16 v[140:143], v[72:75], a[76:79], v[140:143]
v_add_f32 v149, v149, v163
v_add_f32 v152, v152, v164
v_mfma_f32_16x16x32_bf16 v[140:143], v[76:79], a[92:95], v[140:143]
v_add_f32 v153, v153, v165
s_waitcnt vmcnt(16)
s_waitcnt lgkmcnt(4)
v_mfma_f32_16x16x32_bf16 v[80:83], v[48:51], a[96:99], v[80:83]
buffer_load_dwordx4 a[192:195], v2, s[8:11], s48 offen offset:0 sc1
v_mfma_f32_16x16x32_bf16 v[80:83], v[52:55], a[112:115], v[80:83]
v_add_f32 v156, v156, v166
v_add_f32 v157, v157, v167
v_mfma_f32_16x16x32_bf16 v[84:87], v[48:51], a[100:103], v[84:87]
ds_read_b128 v[72:75], v7 offset:63488
v_mov_b32 v160, v144
v_mfma_f32_16x16x32_bf16 v[84:87], v[52:55], a[116:119], v[84:87]
v_mov_b32 v161, v145
v_mov_b32 v162, v148
v_mfma_f32_16x16x32_bf16 v[88:91], v[48:51], a[104:107], v[88:91]
buffer_load_dwordx4 a[196:199], v4, s[8:11], s48 offen offset:0 sc1
v_mfma_f32_16x16x32_bf16 v[88:91], v[52:55], a[120:123], v[88:91]
ds_read_b128 v[76:79], v7 offset:64512
v_mov_b32 v163, v149
v_mfma_f32_16x16x32_bf16 v[92:95], v[48:51], a[108:111], v[92:95]
v_mov_b32 v164, v152
v_mov_b32 v165, v153
v_mfma_f32_16x16x32_bf16 v[92:95], v[52:55], a[124:127], v[92:95]
v_mov_b32 v166, v156
s_waitcnt lgkmcnt(4)
v_mfma_f32_16x16x32_bf16 v[96:99], v[56:59], a[96:99], v[96:99]
buffer_load_dwordx4 a[200:203], v5, s[8:11], s48 offen offset:0 sc1
v_mfma_f32_16x16x32_bf16 v[96:99], v[60:63], a[112:115], v[96:99]
v_mov_b32 v167, v157
v_permlane32_swap_b32 v144, v160
v_mfma_f32_16x16x32_bf16 v[100:103], v[56:59], a[100:103], v[100:103]
ds_read_b128 v[48:51], v8 offset:0
v_permlane32_swap_b32 v145, v161
v_mfma_f32_16x16x32_bf16 v[100:103], v[60:63], a[116:119], v[100:103]
v_permlane32_swap_b32 v148, v162
v_permlane32_swap_b32 v149, v163
v_mfma_f32_16x16x32_bf16 v[104:107], v[56:59], a[104:107], v[104:107]
buffer_load_dwordx4 a[204:207], v6, s[8:11], s48 offen offset:0 sc1
v_mfma_f32_16x16x32_bf16 v[104:107], v[60:63], a[120:123], v[104:107]
ds_read_b128 v[52:55], v8 offset:1024
v_permlane32_swap_b32 v152, v164
v_mfma_f32_16x16x32_bf16 v[108:111], v[56:59], a[108:111], v[108:111]
v_permlane32_swap_b32 v153, v165
v_permlane32_swap_b32 v156, v166
v_mfma_f32_16x16x32_bf16 v[108:111], v[60:63], a[124:127], v[108:111]
v_permlane32_swap_b32 v157, v167
s_waitcnt lgkmcnt(4)
v_mfma_f32_16x16x32_bf16 v[112:115], v[64:67], a[96:99], v[112:115]
buffer_load_dwordx4 a[208:211], v2, s[8:11], s48 offen offset:1024 sc1
v_mfma_f32_16x16x32_bf16 v[112:115], v[68:71], a[112:115], v[112:115]
v_add_f32 v144, v144, v160
v_add_f32 v145, v145, v161
v_mfma_f32_16x16x32_bf16 v[116:119], v[64:67], a[100:103], v[116:119]
ds_read_b128 v[56:59], v8 offset:2048
v_add_f32 v148, v148, v162
v_mfma_f32_16x16x32_bf16 v[116:119], v[68:71], a[116:119], v[116:119]
v_add_f32 v149, v149, v163
v_add_f32 v152, v152, v164
v_mfma_f32_16x16x32_bf16 v[120:123], v[64:67], a[104:107], v[120:123]
buffer_load_dwordx4 a[212:215], v4, s[8:11], s48 offen offset:1024 sc1
v_mfma_f32_16x16x32_bf16 v[120:123], v[68:71], a[120:123], v[120:123]
ds_read_b128 v[60:63], v8 offset:3072
v_add_f32 v153, v153, v165
v_mfma_f32_16x16x32_bf16 v[124:127], v[64:67], a[108:111], v[124:127]
v_add_f32 v156, v156, v166
v_add_f32 v157, v157, v167
v_mfma_f32_16x16x32_bf16 v[124:127], v[68:71], a[124:127], v[124:127]
v_mul_f32 v144, 0x3ae38e39, v144
s_waitcnt lgkmcnt(4)
v_mfma_f32_16x16x32_bf16 v[128:131], v[72:75], a[96:99], v[128:131]
buffer_load_dwordx4 a[216:219], v5, s[8:11], s48 offen offset:1024 sc1
v_mfma_f32_16x16x32_bf16 v[128:131], v[76:79], a[112:115], v[128:131]
v_mul_f32 v148, 0x3ae38e39, v148
v_mul_f32 v152, 0x3ae38e39, v152
v_mfma_f32_16x16x32_bf16 v[132:135], v[72:75], a[100:103], v[132:135]
ds_read_b128 v[64:67], v8 offset:4096
v_mul_f32 v156, 0x3ae38e39, v156
v_mfma_f32_16x16x32_bf16 v[132:135], v[76:79], a[116:119], v[132:135]
v_mul_f32 v145, 0x3ae38e39, v145
v_mul_f32 v149, 0x3ae38e39, v149
v_mfma_f32_16x16x32_bf16 v[136:139], v[72:75], a[104:107], v[136:139]
buffer_load_dwordx4 a[220:223], v6, s[8:11], s48 offen offset:1024 sc1
v_mfma_f32_16x16x32_bf16 v[136:139], v[76:79], a[120:123], v[136:139]
ds_read_b128 v[68:71], v8 offset:5120
v_mul_f32 v153, 0x3ae38e39, v153
v_mfma_f32_16x16x32_bf16 v[140:143], v[72:75], a[108:111], v[140:143]
v_mul_f32 v157, 0x3ae38e39, v157
v_fma_f32 v145, -v144, v144, v145
v_mfma_f32_16x16x32_bf16 v[140:143], v[76:79], a[124:127], v[140:143]
v_fma_f32 v149, -v148, v148, v149
s_waitcnt vmcnt(16)
s_waitcnt lgkmcnt(4)
v_mfma_f32_16x16x32_bf16 v[80:83], v[48:51], a[128:131], v[80:83]
buffer_load_dwordx4 a[224:227], v2, s[8:11], s48 offen offset:2048 sc1
v_mfma_f32_16x16x32_bf16 v[80:83], v[52:55], a[144:147], v[80:83]
v_fma_f32 v153, -v152, v152, v153
v_fma_f32 v157, -v156, v156, v157
v_mfma_f32_16x16x32_bf16 v[84:87], v[48:51], a[132:135], v[84:87]
ds_read_b128 v[72:75], v8 offset:6144
v_max_f32 v145, 0, v145
v_mfma_f32_16x16x32_bf16 v[84:87], v[52:55], a[148:151], v[84:87]
v_max_f32 v149, 0, v149
v_max_f32 v153, 0, v153
v_mfma_f32_16x16x32_bf16 v[88:91], v[48:51], a[136:139], v[88:91]
buffer_load_dwordx4 a[228:231], v4, s[8:11], s48 offen offset:2048 sc1
v_mfma_f32_16x16x32_bf16 v[88:91], v[52:55], a[152:155], v[88:91]
ds_read_b128 v[76:79], v8 offset:7168
v_max_f32 v157, 0, v157
v_mfma_f32_16x16x32_bf16 v[92:95], v[48:51], a[140:143], v[92:95]
v_add_f32 v234, 0x3727c5ac, v145
v_add_f32 v238, 0x3727c5ac, v149
v_mfma_f32_16x16x32_bf16 v[92:95], v[52:55], a[156:159], v[92:95]
v_add_f32 v242, 0x3727c5ac, v153
s_waitcnt lgkmcnt(4)
v_mfma_f32_16x16x32_bf16 v[96:99], v[56:59], a[128:131], v[96:99]
buffer_load_dwordx4 a[232:235], v5, s[8:11], s48 offen offset:2048 sc1
v_mfma_f32_16x16x32_bf16 v[96:99], v[60:63], a[144:147], v[96:99]
v_add_f32 v246, 0x3727c5ac, v157
v_mfma_f32_16x16x32_bf16 v[100:103], v[56:59], a[132:135], v[100:103]
ds_read_b128 v[48:51], v8 offset:8192
v_mfma_f32_16x16x32_bf16 v[100:103], v[60:63], a[148:151], v[100:103]
v_rsq_f32 v144, v234
v_mfma_f32_16x16x32_bf16 v[104:107], v[56:59], a[136:139], v[104:107]
buffer_load_dwordx4 a[236:239], v6, s[8:11], s48 offen offset:2048 sc1
v_mfma_f32_16x16x32_bf16 v[104:107], v[60:63], a[152:155], v[104:107]
ds_read_b128 v[52:55], v8 offset:9216
v_mul_f32 v232, 0xc0135761, v144
v_mfma_f32_16x16x32_bf16 v[108:111], v[56:59], a[140:143], v[108:111]
v_rsq_f32 v148, v238
v_mfma_f32_16x16x32_bf16 v[108:111], v[60:63], a[156:159], v[108:111]
v_mul_f32 v236, 0xc0135761, v148
s_waitcnt lgkmcnt(4)
v_mfma_f32_16x16x32_bf16 v[112:115], v[64:67], a[128:131], v[112:115]
buffer_load_dwordx4 a[240:243], v2, s[8:11], s48 offen offset:3072 sc1
v_mfma_f32_16x16x32_bf16 v[112:115], v[68:71], a[144:147], v[112:115]
v_rsq_f32 v152, v242
v_mfma_f32_16x16x32_bf16 v[116:119], v[64:67], a[132:135], v[116:119]
ds_read_b128 v[56:59], v8 offset:10240
v_mul_f32 v240, 0xc0135761, v152
v_mfma_f32_16x16x32_bf16 v[116:119], v[68:71], a[148:151], v[116:119]
v_rsq_f32 v156, v246
v_mfma_f32_16x16x32_bf16 v[120:123], v[64:67], a[136:139], v[120:123]
buffer_load_dwordx4 a[244:247], v4, s[8:11], s48 offen offset:3072 sc1
v_mfma_f32_16x16x32_bf16 v[120:123], v[68:71], a[152:155], v[120:123]
ds_read_b128 v[60:63], v8 offset:11264
v_mul_f32 v244, 0xc0135761, v156
v_mfma_f32_16x16x32_bf16 v[124:127], v[64:67], a[140:143], v[124:127]
v_mul_f32 v145, v144, v144
v_mul_f32 v149, v148, v148
v_mfma_f32_16x16x32_bf16 v[124:127], v[68:71], a[156:159], v[124:127]
v_mul_f32 v153, v152, v152
s_waitcnt lgkmcnt(4)
v_mfma_f32_16x16x32_bf16 v[128:131], v[72:75], a[128:131], v[128:131]
buffer_load_dwordx4 a[248:251], v5, s[8:11], s48 offen offset:3072 sc1
v_mfma_f32_16x16x32_bf16 v[128:131], v[76:79], a[144:147], v[128:131]
v_mul_f32 v157, v156, v156
v_mul_f32 v145, v145, v144
v_mfma_f32_16x16x32_bf16 v[132:135], v[72:75], a[132:135], v[132:135]
ds_read_b128 v[64:67], v8 offset:12288
v_mul_f32 v149, v149, v148
v_mfma_f32_16x16x32_bf16 v[132:135], v[76:79], a[148:151], v[132:135]
v_mul_f32 v153, v153, v152
v_mul_f32 v157, v157, v156
v_mfma_f32_16x16x32_bf16 v[136:139], v[72:75], a[136:139], v[136:139]
buffer_load_dwordx4 a[252:255], v6, s[8:11], s48 offen offset:3072 sc1
v_mfma_f32_16x16x32_bf16 v[136:139], v[76:79], a[152:155], v[136:139]
ds_read_b128 v[68:71], v8 offset:13312
s_add_u32 s48, s20, 16384
v_mfma_f32_16x16x32_bf16 v[140:143], v[72:75], a[140:143], v[140:143]
v_mul_f32 v233, 0xbdd2d3e8, v145
v_mul_f32 v237, 0xbdd2d3e8, v149
v_mfma_f32_16x16x32_bf16 v[140:143], v[76:79], a[156:159], v[140:143]
v_mul_f32 v241, 0xbdd2d3e8, v153
s_waitcnt vmcnt(16)
s_waitcnt lgkmcnt(4)
v_mfma_f32_16x16x32_bf16 v[80:83], v[48:51], a[160:163], v[80:83]
buffer_load_dwordx4 v[16:19], v2, s[8:11], s48 offen offset:0 sc1
v_mfma_f32_16x16x32_bf16 v[80:83], v[52:55], a[176:179], v[80:83]
v_mul_f32 v245, 0xbdd2d3e8, v157
v_mfma_f32_16x16x32_bf16 v[84:87], v[48:51], a[164:167], v[84:87]
ds_read_b128 v[72:75], v8 offset:14336
v_mfma_f32_16x16x32_bf16 v[84:87], v[52:55], a[180:183], v[84:87]
v_mfma_f32_16x16x32_bf16 v[88:91], v[48:51], a[168:171], v[88:91]
buffer_load_dwordx4 v[20:23], v4, s[8:11], s48 offen offset:0 sc1
v_mfma_f32_16x16x32_bf16 v[88:91], v[52:55], a[184:187], v[88:91]
ds_read_b128 v[76:79], v8 offset:15360
v_mfma_f32_16x16x32_bf16 v[92:95], v[48:51], a[172:175], v[92:95]
v_mfma_f32_16x16x32_bf16 v[92:95], v[52:55], a[188:191], v[92:95]
s_waitcnt lgkmcnt(4)
v_mfma_f32_16x16x32_bf16 v[96:99], v[56:59], a[160:163], v[96:99]
buffer_load_dwordx4 v[24:27], v5, s[8:11], s48 offen offset:0 sc1
v_mfma_f32_16x16x32_bf16 v[96:99], v[60:63], a[176:179], v[96:99]
s_barrier
v_mfma_f32_16x16x32_bf16 v[100:103], v[56:59], a[164:167], v[100:103]
ds_read_b128 v[48:51], v2 offset:0
v_mfma_f32_16x16x32_bf16 v[100:103], v[60:63], a[180:183], v[100:103]
v_mfma_f32_16x16x32_bf16 v[104:107], v[56:59], a[168:171], v[104:107]
buffer_load_dwordx4 v[28:31], v6, s[8:11], s48 offen offset:0 sc1
v_mfma_f32_16x16x32_bf16 v[104:107], v[60:63], a[184:187], v[104:107]
ds_read_b128 v[52:55], v2 offset:1024
v_mfma_f32_16x16x32_bf16 v[108:111], v[56:59], a[172:175], v[108:111]
v_mfma_f32_16x16x32_bf16 v[108:111], v[60:63], a[188:191], v[108:111]
s_waitcnt lgkmcnt(4)
v_mfma_f32_16x16x32_bf16 v[112:115], v[64:67], a[160:163], v[112:115]
buffer_load_dwordx4 v[32:35], v2, s[8:11], s48 offen offset:1024 sc1
v_mfma_f32_16x16x32_bf16 v[112:115], v[68:71], a[176:179], v[112:115]
v_mfma_f32_16x16x32_bf16 v[116:119], v[64:67], a[164:167], v[116:119]
ds_read_b128 v[56:59], v2 offset:2048
v_mfma_f32_16x16x32_bf16 v[116:119], v[68:71], a[180:183], v[116:119]
v_mfma_f32_16x16x32_bf16 v[120:123], v[64:67], a[168:171], v[120:123]
buffer_load_dwordx4 v[36:39], v4, s[8:11], s48 offen offset:1024 sc1
v_mfma_f32_16x16x32_bf16 v[120:123], v[68:71], a[184:187], v[120:123]
ds_read_b128 v[60:63], v2 offset:3072
v_mfma_f32_16x16x32_bf16 v[124:127], v[64:67], a[172:175], v[124:127]
v_mfma_f32_16x16x32_bf16 v[124:127], v[68:71], a[188:191], v[124:127]
s_waitcnt lgkmcnt(4)
v_mfma_f32_16x16x32_bf16 v[128:131], v[72:75], a[160:163], v[128:131]
buffer_load_dwordx4 v[40:43], v5, s[8:11], s48 offen offset:1024 sc1
v_mfma_f32_16x16x32_bf16 v[128:131], v[76:79], a[176:179], v[128:131]
v_mfma_f32_16x16x32_bf16 v[132:135], v[72:75], a[164:167], v[132:135]
ds_read_b128 v[64:67], v2 offset:4096
v_mfma_f32_16x16x32_bf16 v[132:135], v[76:79], a[180:183], v[132:135]
v_mfma_f32_16x16x32_bf16 v[136:139], v[72:75], a[168:171], v[136:139]
buffer_load_dwordx4 v[44:47], v6, s[8:11], s48 offen offset:1024 sc1
v_mfma_f32_16x16x32_bf16 v[136:139], v[76:79], a[184:187], v[136:139]
ds_read_b128 v[68:71], v2 offset:5120
s_add_u32 m0, s22, 49152
v_mfma_f32_16x16x32_bf16 v[140:143], v[72:75], a[172:175], v[140:143]
v_add_u32 v3, 20480, v3
v_mfma_f32_16x16x32_bf16 v[140:143], v[76:79], a[188:191], v[140:143]
s_waitcnt vmcnt(16)
s_waitcnt lgkmcnt(4)
v_mfma_f32_16x16x32_bf16 v[80:83], v[48:51], a[192:195], v[80:83]
v_mfma_f32_16x16x32_bf16 v[80:83], v[52:55], a[208:211], v[80:83]
buffer_load_dwordx4 v3, s[8:11], 0 offen offset:0 sc1 lds
v_mfma_f32_16x16x32_bf16 v[84:87], v[48:51], a[196:199], v[84:87]
ds_read_b128 v[72:75], v2 offset:6144
v_mfma_f32_16x16x32_bf16 v[84:87], v[52:55], a[212:215], v[84:87]
v_mfma_f32_16x16x32_bf16 v[88:91], v[48:51], a[200:203], v[88:91]
v_mfma_f32_16x16x32_bf16 v[88:91], v[52:55], a[216:219], v[88:91]
ds_read_b128 v[76:79], v2 offset:7168
v_mfma_f32_16x16x32_bf16 v[92:95], v[48:51], a[204:207], v[92:95]
buffer_load_dwordx4 v3, s[8:11], 0 offen offset:1024 sc1 lds
v_mfma_f32_16x16x32_bf16 v[92:95], v[52:55], a[220:223], v[92:95]
s_waitcnt lgkmcnt(4)
v_mfma_f32_16x16x32_bf16 v[96:99], v[56:59], a[192:195], v[96:99]
v_mfma_f32_16x16x32_bf16 v[96:99], v[60:63], a[208:211], v[96:99]
v_mfma_f32_16x16x32_bf16 v[100:103], v[56:59], a[196:199], v[100:103]
ds_read_b128 v[48:51], v2 offset:8192
v_mfma_f32_16x16x32_bf16 v[100:103], v[60:63], a[212:215], v[100:103]
buffer_load_dwordx4 v3, s[8:11], 0 offen offset:2048 sc1 lds
v_mfma_f32_16x16x32_bf16 v[104:107], v[56:59], a[200:203], v[104:107]
v_mfma_f32_16x16x32_bf16 v[104:107], v[60:63], a[216:219], v[104:107]
ds_read_b128 v[52:55], v2 offset:9216
v_mfma_f32_16x16x32_bf16 v[108:111], v[56:59], a[204:207], v[108:111]
v_mfma_f32_16x16x32_bf16 v[108:111], v[60:63], a[220:223], v[108:111]
s_waitcnt lgkmcnt(4)
v_mfma_f32_16x16x32_bf16 v[112:115], v[64:67], a[192:195], v[112:115]
buffer_load_dwordx4 v3, s[8:11], 0 offen offset:3072 sc1 lds
v_mfma_f32_16x16x32_bf16 v[112:115], v[68:71], a[208:211], v[112:115]
s_add_u32 m0, s22, 53248
v_add_u32 v3, 4096, v3
v_mfma_f32_16x16x32_bf16 v[116:119], v[64:67], a[196:199], v[116:119]
ds_read_b128 v[56:59], v2 offset:10240
v_mfma_f32_16x16x32_bf16 v[116:119], v[68:71], a[212:215], v[116:119]
v_mfma_f32_16x16x32_bf16 v[120:123], v[64:67], a[200:203], v[120:123]
v_mfma_f32_16x16x32_bf16 v[120:123], v[68:71], a[216:219], v[120:123]
ds_read_b128 v[60:63], v2 offset:11264
v_mfma_f32_16x16x32_bf16 v[124:127], v[64:67], a[204:207], v[124:127]
buffer_load_dwordx4 v3, s[8:11], 0 offen offset:0 sc1 lds
v_mfma_f32_16x16x32_bf16 v[124:127], v[68:71], a[220:223], v[124:127]
s_waitcnt lgkmcnt(4)
v_mfma_f32_16x16x32_bf16 v[128:131], v[72:75], a[192:195], v[128:131]
v_mfma_f32_16x16x32_bf16 v[128:131], v[76:79], a[208:211], v[128:131]
v_mfma_f32_16x16x32_bf16 v[132:135], v[72:75], a[196:199], v[132:135]
ds_read_b128 v[64:67], v2 offset:12288
v_mfma_f32_16x16x32_bf16 v[132:135], v[76:79], a[212:215], v[132:135]
buffer_load_dwordx4 v3, s[8:11], 0 offen offset:1024 sc1 lds
v_mfma_f32_16x16x32_bf16 v[136:139], v[72:75], a[200:203], v[136:139]
s_add_u32 m0, s22, 73728
v_add_u32 v3, 20480, v3
v_mfma_f32_16x16x32_bf16 v[136:139], v[76:79], a[216:219], v[136:139]
ds_read_b128 v[68:71], v2 offset:13312
v_mfma_f32_16x16x32_bf16 v[140:143], v[72:75], a[204:207], v[140:143]
v_mfma_f32_16x16x32_bf16 v[140:143], v[76:79], a[220:223], v[140:143]
s_waitcnt vmcnt(14)
s_waitcnt lgkmcnt(4)
v_mfma_f32_16x16x32_bf16 v[80:83], v[48:51], a[224:227], v[80:83]
buffer_load_dwordx4 v3, s[8:11], 0 offen offset:0 sc1 lds
v_mfma_f32_16x16x32_bf16 v[80:83], v[52:55], a[240:243], v[80:83]
v_mfma_f32_16x16x32_bf16 v[84:87], v[48:51], a[228:231], v[84:87]
ds_read_b128 v[72:75], v2 offset:14336
v_mfma_f32_16x16x32_bf16 v[84:87], v[52:55], a[244:247], v[84:87]
v_mfma_f32_16x16x32_bf16 v[88:91], v[48:51], a[232:235], v[88:91]
v_mfma_f32_16x16x32_bf16 v[88:91], v[52:55], a[248:251], v[88:91]
ds_read_b128 v[76:79], v2 offset:15360
v_mfma_f32_16x16x32_bf16 v[92:95], v[48:51], a[236:239], v[92:95]
buffer_load_dwordx4 v3, s[8:11], 0 offen offset:1024 sc1 lds
v_mfma_f32_16x16x32_bf16 v[92:95], v[52:55], a[252:255], v[92:95]
s_waitcnt lgkmcnt(4)
v_mfma_f32_16x16x32_bf16 v[96:99], v[56:59], a[224:227], v[96:99]
v_mfma_f32_16x16x32_bf16 v[96:99], v[60:63], a[240:243], v[96:99]
v_mfma_f32_16x16x32_bf16 v[100:103], v[56:59], a[228:231], v[100:103]
ds_read_b128 v[48:51], v2 offset:16384
v_mfma_f32_16x16x32_bf16 v[100:103], v[60:63], a[244:247], v[100:103]
buffer_load_dwordx4 v3, s[8:11], 0 offen offset:2048 sc1 lds
v_mfma_f32_16x16x32_bf16 v[104:107], v[56:59], a[232:235], v[104:107]
v_mfma_f32_16x16x32_bf16 v[104:107], v[60:63], a[248:251], v[104:107]
ds_read_b128 v[52:55], v2 offset:17408
v_mfma_f32_16x16x32_bf16 v[108:111], v[56:59], a[236:239], v[108:111]
v_mfma_f32_16x16x32_bf16 v[108:111], v[60:63], a[252:255], v[108:111]
s_waitcnt lgkmcnt(4)
v_mfma_f32_16x16x32_bf16 v[112:115], v[64:67], a[224:227], v[112:115]
buffer_load_dwordx4 v3, s[8:11], 0 offen offset:3072 sc1 lds
v_mfma_f32_16x16x32_bf16 v[112:115], v[68:71], a[240:243], v[112:115]
s_add_u32 m0, s22, 77824
v_add_u32 v3, 4096, v3
v_mfma_f32_16x16x32_bf16 v[116:119], v[64:67], a[228:231], v[116:119]
ds_read_b128 v[56:59], v2 offset:18432
v_mfma_f32_16x16x32_bf16 v[116:119], v[68:71], a[244:247], v[116:119]
v_mfma_f32_16x16x32_bf16 v[120:123], v[64:67], a[232:235], v[120:123]
v_mfma_f32_16x16x32_bf16 v[120:123], v[68:71], a[248:251], v[120:123]
ds_read_b128 v[60:63], v2 offset:19456
v_mfma_f32_16x16x32_bf16 v[124:127], v[64:67], a[236:239], v[124:127]
buffer_load_dwordx4 v3, s[8:11], 0 offen offset:0 sc1 lds
v_mfma_f32_16x16x32_bf16 v[124:127], v[68:71], a[252:255], v[124:127]
s_waitcnt lgkmcnt(4)
v_mfma_f32_16x16x32_bf16 v[128:131], v[72:75], a[224:227], v[128:131]
v_mfma_f32_16x16x32_bf16 v[128:131], v[76:79], a[240:243], v[128:131]
v_mfma_f32_16x16x32_bf16 v[132:135], v[72:75], a[228:231], v[132:135]
ds_read_b128 v[64:67], v2 offset:20480
v_mfma_f32_16x16x32_bf16 v[132:135], v[76:79], a[244:247], v[132:135]
buffer_load_dwordx4 v3, s[8:11], 0 offen offset:1024 sc1 lds
v_mfma_f32_16x16x32_bf16 v[136:139], v[72:75], a[232:235], v[136:139]
s_add_u32 m0, s22, 98304
v_add_u32 v3, 20480, v3
v_mfma_f32_16x16x32_bf16 v[136:139], v[76:79], a[248:251], v[136:139]
ds_read_b128 v[68:71], v2 offset:21504
v_mfma_f32_16x16x32_bf16 v[140:143], v[72:75], a[236:239], v[140:143]
v_mfma_f32_16x16x32_bf16 v[140:143], v[76:79], a[252:255], v[140:143]
s_waitcnt vmcnt(12)
s_waitcnt lgkmcnt(4)
v_mfma_f32_16x16x32_bf16 v[80:83], v[48:51], v[16:19], v[80:83]
buffer_load_dwordx4 v3, s[8:11], 0 offen offset:0 sc1 lds
v_mfma_f32_16x16x32_bf16 v[80:83], v[52:55], v[32:35], v[80:83]
v_mfma_f32_16x16x32_bf16 v[84:87], v[48:51], v[20:23], v[84:87]
ds_read_b128 v[72:75], v2 offset:22528
v_mfma_f32_16x16x32_bf16 v[84:87], v[52:55], v[36:39], v[84:87]
v_mfma_f32_16x16x32_bf16 v[88:91], v[48:51], v[24:27], v[88:91]
v_mfma_f32_16x16x32_bf16 v[88:91], v[52:55], v[40:43], v[88:91]
ds_read_b128 v[76:79], v2 offset:23552
v_mfma_f32_16x16x32_bf16 v[92:95], v[48:51], v[28:31], v[92:95]
buffer_load_dwordx4 v3, s[8:11], 0 offen offset:1024 sc1 lds
v_mfma_f32_16x16x32_bf16 v[92:95], v[52:55], v[44:47], v[92:95]
s_waitcnt lgkmcnt(4)
v_mfma_f32_16x16x32_bf16 v[96:99], v[56:59], v[16:19], v[96:99]
v_mfma_f32_16x16x32_bf16 v[96:99], v[60:63], v[32:35], v[96:99]
s_barrier
v_mfma_f32_16x16x32_bf16 v[100:103], v[56:59], v[20:23], v[100:103]
ds_read_b128 v[48:51], v2 offset:24576
v_mfma_f32_16x16x32_bf16 v[100:103], v[60:63], v[36:39], v[100:103]
buffer_load_dwordx4 v3, s[8:11], 0 offen offset:2048 sc1 lds
v_mfma_f32_16x16x32_bf16 v[104:107], v[56:59], v[24:27], v[104:107]
v_mfma_f32_16x16x32_bf16 v[104:107], v[60:63], v[40:43], v[104:107]
ds_read_b128 v[52:55], v2 offset:25600
v_mfma_f32_16x16x32_bf16 v[108:111], v[56:59], v[28:31], v[108:111]
v_mfma_f32_16x16x32_bf16 v[108:111], v[60:63], v[44:47], v[108:111]
s_waitcnt lgkmcnt(4)
v_mfma_f32_16x16x32_bf16 v[112:115], v[64:67], v[16:19], v[112:115]
buffer_load_dwordx4 v3, s[8:11], 0 offen offset:3072 sc1 lds
v_mfma_f32_16x16x32_bf16 v[112:115], v[68:71], v[32:35], v[112:115]
s_add_u32 m0, s22, 102400
v_add_u32 v3, 4096, v3
v_mfma_f32_16x16x32_bf16 v[116:119], v[64:67], v[20:23], v[116:119]
ds_read_b128 v[56:59], v2 offset:26624
v_mfma_f32_16x16x32_bf16 v[116:119], v[68:71], v[36:39], v[116:119]
v_mfma_f32_16x16x32_bf16 v[120:123], v[64:67], v[24:27], v[120:123]
v_mfma_f32_16x16x32_bf16 v[120:123], v[68:71], v[40:43], v[120:123]
ds_read_b128 v[60:63], v2 offset:27648
v_mfma_f32_16x16x32_bf16 v[124:127], v[64:67], v[28:31], v[124:127]
buffer_load_dwordx4 v3, s[8:11], 0 offen offset:0 sc1 lds
v_mfma_f32_16x16x32_bf16 v[124:127], v[68:71], v[44:47], v[124:127]
s_waitcnt lgkmcnt(4)
v_mfma_f32_16x16x32_bf16 v[128:131], v[72:75], v[16:19], v[128:131]
v_mfma_f32_16x16x32_bf16 v[128:131], v[76:79], v[32:35], v[128:131]
v_mfma_f32_16x16x32_bf16 v[132:135], v[72:75], v[20:23], v[132:135]
ds_read_b128 v[64:67], v2 offset:28672
v_mfma_f32_16x16x32_bf16 v[132:135], v[76:79], v[36:39], v[132:135]
buffer_load_dwordx4 v3, s[8:11], 0 offen offset:1024 sc1 lds
v_mfma_f32_16x16x32_bf16 v[136:139], v[72:75], v[24:27], v[136:139]
s_add_u32 m0, s22, 122880
v_add_u32 v3, 20480, v3
v_mfma_f32_16x16x32_bf16 v[136:139], v[76:79], v[40:43], v[136:139]
ds_read_b128 v[68:71], v2 offset:29696
v_mfma_f32_16x16x32_bf16 v[140:143], v[72:75], v[28:31], v[140:143]
v_mfma_f32_16x16x32_bf16 v[140:143], v[76:79], v[44:47], v[140:143]
s_waitcnt lgkmcnt(4)
v_mfma_f32_16x16x32_bf16 v[176:179], v[48:51], a[0:3], 0
buffer_load_dwordx4 v3, s[8:11], 0 offen offset:0 sc1 lds
v_mfma_f32_16x16x32_bf16 v[176:179], v[52:55], a[16:19], v[176:179]
v_mfma_f32_16x16x32_bf16 v[180:183], v[48:51], a[4:7], 0
ds_read_b128 v[72:75], v2 offset:30720
v_mfma_f32_16x16x32_bf16 v[180:183], v[52:55], a[20:23], v[180:183]
v_mul_f32 v208, v80, v80
v_mul_f32 v210, v81, v81
v_mfma_f32_16x16x32_bf16 v[184:187], v[48:51], a[8:11], 0
v_fma_f32 v208, v208, v233, v232
v_fma_f32 v210, v210, v233, v232
v_mfma_f32_16x16x32_bf16 v[184:187], v[52:55], a[24:27], v[184:187]
ds_read_b128 v[76:79], v2 offset:31744
v_mul_f32 v208, v208, v80
v_mfma_f32_16x16x32_bf16 v[188:191], v[48:51], a[12:15], 0
buffer_load_dwordx4 v3, s[8:11], 0 offen offset:1024 sc1 lds
v_mfma_f32_16x16x32_bf16 v[188:191], v[52:55], a[28:31], v[188:191]
v_mul_f32 v210, v210, v81
s_waitcnt lgkmcnt(4)
v_mfma_f32_16x16x32_bf16 v[192:195], v[56:59], a[0:3], 0
v_exp_f32 v208, v208
v_mfma_f32_16x16x32_bf16 v[192:195], v[60:63], a[16:19], v[192:195]
v_exp_f32 v210, v210
v_mfma_f32_16x16x32_bf16 v[196:199], v[56:59], a[4:7], 0
ds_read_b128 v[48:51], v2 offset:32768
v_mul_f32 v209, v80, v96
v_mfma_f32_16x16x32_bf16 v[196:199], v[60:63], a[20:23], v[196:199]
buffer_load_dwordx4 v3, s[8:11], 0 offen offset:2048 sc1 lds
v_mfma_f32_16x16x32_bf16 v[200:203], v[56:59], a[8:11], 0
v_mul_f32 v211, v81, v97
v_fma_f32 v208, v208, v234, v234
v_mfma_f32_16x16x32_bf16 v[200:203], v[60:63], a[24:27], v[200:203]
ds_read_b128 v[52:55], v2 offset:33792
v_fma_f32 v210, v210, v234, v234
v_mfma_f32_16x16x32_bf16 v[204:207], v[56:59], a[12:15], 0
v_rcp_f32 v208, v208
v_mfma_f32_16x16x32_bf16 v[204:207], v[60:63], a[28:31], v[204:207]
v_mul_f32 v209, v209, v208
s_waitcnt lgkmcnt(4)
v_mfma_f32_16x16x32_bf16 v[176:179], v[64:67], a[32:35], v[176:179]
buffer_load_dwordx4 v3, s[8:11], 0 offen offset:3072 sc1 lds
v_mfma_f32_16x16x32_bf16 v[176:179], v[68:71], a[48:51], v[176:179]
s_add_u32 m0, s22, 126976
v_add_u32 v3, 4096, v3
v_mfma_f32_16x16x32_bf16 v[180:183], v[64:67], a[36:39], v[180:183]
ds_read_b128 v[56:59], v2 offset:34816
v_mul_f32 v212, v82, v82
v_mfma_f32_16x16x32_bf16 v[180:183], v[68:71], a[52:55], v[180:183]
v_rcp_f32 v210, v210
v_mfma_f32_16x16x32_bf16 v[184:187], v[64:67], a[40:43], v[184:187]
v_mul_f32 v211, v211, v210
v_cvt_pk_bf16_f32 v224, v209, v211
v_mfma_f32_16x16x32_bf16 v[184:187], v[68:71], a[56:59], v[184:187]
ds_read_b128 v[60:63], v2 offset:35840
v_mul_f32 v214, v83, v83
v_mfma_f32_16x16x32_bf16 v[188:191], v[64:67], a[44:47], v[188:191]
buffer_load_dwordx4 v3, s[8:11], 0 offen offset:0 sc1 lds
v_mfma_f32_16x16x32_bf16 v[188:191], v[68:71], a[60:63], v[188:191]
v_fma_f32 v212, v212, v233, v232
s_waitcnt lgkmcnt(4)
v_mfma_f32_16x16x32_bf16 v[192:195], v[72:75], a[32:35], v[192:195]
v_fma_f32 v214, v214, v233, v232
v_mul_f32 v212, v212, v82
v_mfma_f32_16x16x32_bf16 v[192:195], v[76:79], a[48:51], v[192:195]
v_mul_f32 v214, v214, v83
v_mul_f32 v213, v82, v98
v_mfma_f32_16x16x32_bf16 v[196:199], v[72:75], a[36:39], v[196:199]
ds_read_b128 v[64:67], v2 offset:36864
v_mul_f32 v215, v83, v99
v_mfma_f32_16x16x32_bf16 v[196:199], v[76:79], a[52:55], v[196:199]
buffer_load_dwordx4 v3, s[8:11], 0 offen offset:1024 sc1 lds
v_mfma_f32_16x16x32_bf16 v[200:203], v[72:75], a[40:43], v[200:203]
v_exp_f32 v212, v212
v_mfma_f32_16x16x32_bf16 v[200:203], v[76:79], a[56:59], v[200:203]
ds_read_b128 v[68:71], v2 offset:37888
v_fma_f32 v212, v212, v234, v234
v_mfma_f32_16x16x32_bf16 v[204:207], v[72:75], a[44:47], v[204:207]
v_exp_f32 v214, v214
v_mfma_f32_16x16x32_bf16 v[204:207], v[76:79], a[60:63], v[204:207]
v_fma_f32 v214, v214, v234, v234
s_waitcnt lgkmcnt(4)
v_mfma_f32_16x16x32_bf16 v[176:179], v[48:51], a[64:67], v[176:179]
v_rcp_f32 v212, v212
v_mfma_f32_16x16x32_bf16 v[176:179], v[52:55], a[80:83], v[176:179]
v_rcp_f32 v214, v214
v_mfma_f32_16x16x32_bf16 v[180:183], v[48:51], a[68:71], v[180:183]
ds_read_b128 v[72:75], v2 offset:38912
v_mul_f32 v213, v213, v212
v_mfma_f32_16x16x32_bf16 v[180:183], v[52:55], a[84:87], v[180:183]
v_mul_f32 v215, v215, v214
v_cvt_pk_bf16_f32 v225, v213, v215
v_mfma_f32_16x16x32_bf16 v[184:187], v[48:51], a[72:75], v[184:187]
buffer_store_dwordx2 v[224:225], v248, s[8:11], s30 offen sc1
v_mfma_f32_16x16x32_bf16 v[184:187], v[52:55], a[88:91], v[184:187]
ds_read_b128 v[76:79], v2 offset:39936
v_mul_f32 v208, v84, v84
v_mfma_f32_16x16x32_bf16 v[188:191], v[48:51], a[76:79], v[188:191]
v_mul_f32 v210, v85, v85
v_fma_f32 v208, v208, v237, v236
v_mfma_f32_16x16x32_bf16 v[188:191], v[52:55], a[92:95], v[188:191]
v_fma_f32 v210, v210, v237, v236
s_waitcnt lgkmcnt(4)
v_mfma_f32_16x16x32_bf16 v[192:195], v[56:59], a[64:67], v[192:195]
v_mul_f32 v208, v208, v84
v_mul_f32 v210, v210, v85
v_mfma_f32_16x16x32_bf16 v[192:195], v[60:63], a[80:83], v[192:195]
v_exp_f32 v208, v208
v_mfma_f32_16x16x32_bf16 v[196:199], v[56:59], a[68:71], v[196:199]
ds_read_b128 v[48:51], v2 offset:40960
v_mul_f32 v209, v84, v100
v_mfma_f32_16x16x32_bf16 v[196:199], v[60:63], a[84:87], v[196:199]
v_exp_f32 v210, v210
v_mfma_f32_16x16x32_bf16 v[200:203], v[56:59], a[72:75], v[200:203]
v_mul_f32 v211, v85, v101
v_fma_f32 v208, v208, v238, v238
v_mfma_f32_16x16x32_bf16 v[200:203], v[60:63], a[88:91], v[200:203]
ds_read_b128 v[52:55], v2 offset:41984
v_fma_f32 v210, v210, v238, v238
v_mfma_f32_16x16x32_bf16 v[204:207], v[56:59], a[76:79], v[204:207]
v_rcp_f32 v208, v208
v_mfma_f32_16x16x32_bf16 v[204:207], v[60:63], a[92:95], v[204:207]
v_mul_f32 v209, v209, v208
s_waitcnt lgkmcnt(4)
v_mfma_f32_16x16x32_bf16 v[176:179], v[64:67], a[96:99], v[176:179]
v_rcp_f32 v210, v210
v_mfma_f32_16x16x32_bf16 v[176:179], v[68:71], a[112:115], v[176:179]
v_mul_f32 v211, v211, v210
v_cvt_pk_bf16_f32 v226, v209, v211
v_mfma_f32_16x16x32_bf16 v[180:183], v[64:67], a[100:103], v[180:183]
ds_read_b128 v[56:59], v2 offset:43008
v_mul_f32 v212, v86, v86
v_mfma_f32_16x16x32_bf16 v[180:183], v[68:71], a[116:119], v[180:183]
v_mul_f32 v214, v87, v87
v_fma_f32 v212, v212, v237, v236
v_mfma_f32_16x16x32_bf16 v[184:187], v[64:67], a[104:107], v[184:187]
v_fma_f32 v214, v214, v237, v236
v_mul_f32 v212, v212, v86
v_mfma_f32_16x16x32_bf16 v[184:187], v[68:71], a[120:123], v[184:187]
ds_read_b128 v[60:63], v2 offset:44032
v_mul_f32 v214, v214, v87
v_mfma_f32_16x16x32_bf16 v[188:191], v[64:67], a[108:111], v[188:191]
v_exp_f32 v212, v212
v_mfma_f32_16x16x32_bf16 v[188:191], v[68:71], a[124:127], v[188:191]
v_mul_f32 v213, v86, v102
s_waitcnt lgkmcnt(4)
v_mfma_f32_16x16x32_bf16 v[192:195], v[72:75], a[96:99], v[192:195]
v_exp_f32 v214, v214
v_mfma_f32_16x16x32_bf16 v[192:195], v[76:79], a[112:115], v[192:195]
v_mul_f32 v215, v87, v103
v_fma_f32 v212, v212, v238, v238
v_mfma_f32_16x16x32_bf16 v[196:199], v[72:75], a[100:103], v[196:199]
ds_read_b128 v[64:67], v2 offset:45056
v_fma_f32 v214, v214, v238, v238
v_mfma_f32_16x16x32_bf16 v[196:199], v[76:79], a[116:119], v[196:199]
v_rcp_f32 v212, v212
v_mfma_f32_16x16x32_bf16 v[200:203], v[72:75], a[104:107], v[200:203]
v_rcp_f32 v214, v214
v_mfma_f32_16x16x32_bf16 v[200:203], v[76:79], a[120:123], v[200:203]
ds_read_b128 v[68:71], v2 offset:46080
v_mul_f32 v213, v213, v212
v_mfma_f32_16x16x32_bf16 v[204:207], v[72:75], a[108:111], v[204:207]
v_mul_f32 v215, v215, v214
v_cvt_pk_bf16_f32 v227, v213, v215
v_mfma_f32_16x16x32_bf16 v[204:207], v[76:79], a[124:127], v[204:207]
v_mul_f32 v208, v88, v88
s_waitcnt lgkmcnt(4)
v_mfma_f32_16x16x32_bf16 v[176:179], v[48:51], a[128:131], v[176:179]
buffer_store_dwordx2 v[226:227], v249, s[8:11], s30 offen sc1
v_mfma_f32_16x16x32_bf16 v[176:179], v[52:55], a[144:147], v[176:179]
v_mul_f32 v210, v89, v89
v_fma_f32 v208, v208, v241, v240
v_mfma_f32_16x16x32_bf16 v[180:183], v[48:51], a[132:135], v[180:183]
ds_read_b128 v[72:75], v2 offset:47104
v_fma_f32 v210, v210, v241, v240
v_mfma_f32_16x16x32_bf16 v[180:183], v[52:55], a[148:151], v[180:183]
v_mul_f32 v208, v208, v88
v_mul_f32 v210, v210, v89
v_mfma_f32_16x16x32_bf16 v[184:187], v[48:51], a[136:139], v[184:187]
v_exp_f32 v208, v208
v_mfma_f32_16x16x32_bf16 v[184:187], v[52:55], a[152:155], v[184:187]
ds_read_b128 v[76:79], v2 offset:48128
v_mul_f32 v209, v88, v104
v_mfma_f32_16x16x32_bf16 v[188:191], v[48:51], a[140:143], v[188:191]
v_exp_f32 v210, v210
v_mfma_f32_16x16x32_bf16 v[188:191], v[52:55], a[156:159], v[188:191]
v_mul_f32 v211, v89, v105
s_waitcnt lgkmcnt(4)
v_mfma_f32_16x16x32_bf16 v[192:195], v[56:59], a[128:131], v[192:195]
s_waitcnt vmcnt(20)
v_fma_f32 v208, v208, v242, v242
v_mfma_f32_16x16x32_bf16 v[192:195], v[60:63], a[144:147], v[192:195]
s_barrier
v_mfma_f32_16x16x32_bf16 v[196:199], v[56:59], a[132:135], v[196:199]
ds_read_b128 v[48:51], v2 offset:49152
s_add_u32 m0, s22, 0
v_mfma_f32_16x16x32_bf16 v[196:199], v[60:63], a[148:151], v[196:199]
v_add_u32 v3, 20480, v3
buffer_load_dwordx4 v3, s[8:11], 0 offen offset:0 sc1 lds
v_mfma_f32_16x16x32_bf16 v[200:203], v[56:59], a[136:139], v[200:203]
v_fma_f32 v210, v210, v242, v242
v_mul_f32 v212, v90, v90
v_mfma_f32_16x16x32_bf16 v[200:203], v[60:63], a[152:155], v[200:203]
ds_read_b128 v[52:55], v2 offset:50176
v_mul_f32 v214, v91, v91
v_mfma_f32_16x16x32_bf16 v[204:207], v[56:59], a[140:143], v[204:207]
v_rcp_f32 v208, v208
v_mfma_f32_16x16x32_bf16 v[204:207], v[60:63], a[156:159], v[204:207]
v_mul_f32 v209, v209, v208
s_waitcnt lgkmcnt(4)
v_mfma_f32_16x16x32_bf16 v[176:179], v[64:67], a[160:163], v[176:179]
buffer_load_dwordx4 v3, s[8:11], 0 offen offset:1024 sc1 lds
v_mfma_f32_16x16x32_bf16 v[176:179], v[68:71], a[176:179], v[176:179]
v_rcp_f32 v210, v210
v_mfma_f32_16x16x32_bf16 v[180:183], v[64:67], a[164:167], v[180:183]
ds_read_b128 v[56:59], v2 offset:51200
v_mul_f32 v211, v211, v210
v_mfma_f32_16x16x32_bf16 v[180:183], v[68:71], a[180:183], v[180:183]
v_cvt_pk_bf16_f32 v228, v209, v211
v_fma_f32 v212, v212, v241, v240
v_mfma_f32_16x16x32_bf16 v[184:187], v[64:67], a[168:171], v[184:187]
v_fma_f32 v214, v214, v241, v240
v_mul_f32 v212, v212, v90
v_mfma_f32_16x16x32_bf16 v[184:187], v[68:71], a[184:187], v[184:187]
ds_read_b128 v[60:63], v2 offset:52224
v_mul_f32 v214, v214, v91
v_mfma_f32_16x16x32_bf16 v[188:191], v[64:67], a[172:175], v[188:191]
buffer_load_dwordx4 v3, s[8:11], 0 offen offset:2048 sc1 lds
v_mfma_f32_16x16x32_bf16 v[188:191], v[68:71], a[188:191], v[188:191]
v_mul_f32 v213, v90, v106
s_waitcnt lgkmcnt(4)
v_mfma_f32_16x16x32_bf16 v[192:195], v[72:75], a[160:163], v[192:195]
v_exp_f32 v212, v212
v_mfma_f32_16x16x32_bf16 v[192:195], v[76:79], a[176:179], v[192:195]
v_exp_f32 v214, v214
v_mfma_f32_16x16x32_bf16 v[196:199], v[72:75], a[164:167], v[196:199]
ds_read_b128 v[64:67], v2 offset:53248
v_mul_f32 v215, v91, v107
v_mfma_f32_16x16x32_bf16 v[196:199], v[76:79], a[180:183], v[196:199]
buffer_load_dwordx4 v3, s[8:11], 0 offen offset:3072 sc1 lds
v_mfma_f32_16x16x32_bf16 v[200:203], v[72:75], a[168:171], v[200:203]
s_add_u32 m0, s22, 4096
v_add_u32 v3, 4096, v3
v_mfma_f32_16x16x32_bf16 v[200:203], v[76:79], a[184:187], v[200:203]
ds_read_b128 v[68:71], v2 offset:54272
v_fma_f32 v212, v212, v242, v242
v_mfma_f32_16x16x32_bf16 v[204:207], v[72:75], a[172:175], v[204:207]
v_fma_f32 v214, v214, v242, v242
v_mul_f32 v208, v92, v92
v_mfma_f32_16x16x32_bf16 v[204:207], v[76:79], a[188:191], v[204:207]
v_mul_f32 v210, v93, v93
s_waitcnt lgkmcnt(4)
v_mfma_f32_16x16x32_bf16 v[176:179], v[48:51], a[192:195], v[176:179]
buffer_load_dwordx4 v3, s[8:11], 0 offen offset:0 sc1 lds
v_mfma_f32_16x16x32_bf16 v[176:179], v[52:55], a[208:211], v[176:179]
v_rcp_f32 v212, v212
v_mfma_f32_16x16x32_bf16 v[180:183], v[48:51], a[196:199], v[180:183]
ds_read_b128 v[72:75], v2 offset:55296
v_mul_f32 v213, v213, v212
v_mfma_f32_16x16x32_bf16 v[180:183], v[52:55], a[212:215], v[180:183]
v_rcp_f32 v214, v214
v_mfma_f32_16x16x32_bf16 v[184:187], v[48:51], a[200:203], v[184:187]
v_mul_f32 v215, v215, v214
v_cvt_pk_bf16_f32 v229, v213, v215
v_mfma_f32_16x16x32_bf16 v[184:187], v[52:55], a[216:219], v[184:187]
ds_read_b128 v[76:79], v2 offset:56320
v_fma_f32 v208, v208, v245, v244
v_mfma_f32_16x16x32_bf16 v[188:191], v[48:51], a[204:207], v[188:191]
buffer_load_dwordx4 v3, s[8:11], 0 offen offset:1024 sc1 lds
v_mfma_f32_16x16x32_bf16 v[188:191], v[52:55], a[220:223], v[188:191]
v_fma_f32 v210, v210, v245, v244
s_waitcnt lgkmcnt(4)
v_mfma_f32_16x16x32_bf16 v[192:195], v[56:59], a[192:195], v[192:195]
buffer_store_dwordx2 v[228:229], v250, s[8:11], s30 offen sc1
v_mfma_f32_16x16x32_bf16 v[192:195], v[60:63], a[208:211], v[192:195]
v_mul_f32 v208, v208, v92
v_mul_f32 v210, v210, v93
v_mfma_f32_16x16x32_bf16 v[196:199], v[56:59], a[196:199], v[196:199]
ds_read_b128 v[48:51], v2 offset:57344
v_mul_f32 v209, v92, v108
v_mfma_f32_16x16x32_bf16 v[196:199], v[60:63], a[212:215], v[196:199]
v_exp_f32 v208, v208
v_mfma_f32_16x16x32_bf16 v[200:203], v[56:59], a[200:203], v[200:203]
v_exp_f32 v210, v210
v_mfma_f32_16x16x32_bf16 v[200:203], v[60:63], a[216:219], v[200:203]
ds_read_b128 v[52:55], v2 offset:58368
v_mul_f32 v211, v93, v109
v_mfma_f32_16x16x32_bf16 v[204:207], v[56:59], a[204:207], v[204:207]
v_fma_f32 v208, v208, v246, v246
v_fma_f32 v210, v210, v246, v246
v_mfma_f32_16x16x32_bf16 v[204:207], v[60:63], a[220:223], v[204:207]
v_mul_f32 v212, v94, v94
s_waitcnt lgkmcnt(4)
v_mfma_f32_16x16x32_bf16 v[176:179], v[64:67], a[224:227], v[176:179]
v_rcp_f32 v208, v208
v_mfma_f32_16x16x32_bf16 v[176:179], v[68:71], a[240:243], v[176:179]
v_rcp_f32 v210, v210
v_mfma_f32_16x16x32_bf16 v[180:183], v[64:67], a[228:231], v[180:183]
ds_read_b128 v[56:59], v2 offset:59392
v_mul_f32 v209, v209, v208
v_mfma_f32_16x16x32_bf16 v[180:183], v[68:71], a[244:247], v[180:183]
v_mul_f32 v211, v211, v210
v_cvt_pk_bf16_f32 v230, v209, v211
v_mfma_f32_16x16x32_bf16 v[184:187], v[64:67], a[232:235], v[184:187]
v_mul_f32 v214, v95, v95
v_fma_f32 v212, v212, v245, v244
v_mfma_f32_16x16x32_bf16 v[184:187], v[68:71], a[248:251], v[184:187]
ds_read_b128 v[60:63], v2 offset:60416
v_fma_f32 v214, v214, v245, v244
v_mfma_f32_16x16x32_bf16 v[188:191], v[64:67], a[236:239], v[188:191]
v_mul_f32 v212, v212, v94
v_mul_f32 v214, v214, v95
v_mfma_f32_16x16x32_bf16 v[188:191], v[68:71], a[252:255], v[188:191]
v_mul_f32 v213, v94, v110
s_waitcnt lgkmcnt(4)
v_mfma_f32_16x16x32_bf16 v[192:195], v[72:75], a[224:227], v[192:195]
v_exp_f32 v212, v212
v_mfma_f32_16x16x32_bf16 v[192:195], v[76:79], a[240:243], v[192:195]
v_exp_f32 v214, v214
v_mfma_f32_16x16x32_bf16 v[196:199], v[72:75], a[228:231], v[196:199]
ds_read_b128 v[64:67], v2 offset:61440
v_mul_f32 v215, v95, v111
v_mfma_f32_16x16x32_bf16 v[196:199], v[76:79], a[244:247], v[196:199]
v_fma_f32 v212, v212, v246, v246
v_fma_f32 v214, v214, v246, v246
v_mfma_f32_16x16x32_bf16 v[200:203], v[72:75], a[232:235], v[200:203]
v_rcp_f32 v212, v212
v_mfma_f32_16x16x32_bf16 v[200:203], v[76:79], a[248:251], v[200:203]
ds_read_b128 v[68:71], v2 offset:62464
v_mul_f32 v213, v213, v212
v_mfma_f32_16x16x32_bf16 v[204:207], v[72:75], a[236:239], v[204:207]
v_rcp_f32 v214, v214
v_mfma_f32_16x16x32_bf16 v[204:207], v[76:79], a[252:255], v[204:207]
v_mul_f32 v215, v215, v214
s_waitcnt lgkmcnt(4)
v_mfma_f32_16x16x32_bf16 v[176:179], v[48:51], v[16:19], v[176:179]
v_cvt_pk_bf16_f32 v231, v213, v215
v_mul_f32 v208, v112, v112
v_mfma_f32_16x16x32_bf16 v[176:179], v[52:55], v[32:35], v[176:179]
buffer_store_dwordx2 v[230:231], v251, s[8:11], s30 offen sc1
v_mfma_f32_16x16x32_bf16 v[180:183], v[48:51], v[20:23], v[180:183]
ds_read_b128 v[72:75], v2 offset:63488
v_mul_f32 v210, v113, v113
v_mfma_f32_16x16x32_bf16 v[180:183], v[52:55], v[36:39], v[180:183]
v_fma_f32 v208, v208, v233, v232
v_fma_f32 v210, v210, v233, v232
v_mfma_f32_16x16x32_bf16 v[184:187], v[48:51], v[24:27], v[184:187]
v_mul_f32 v208, v208, v112
v_mul_f32 v210, v210, v113
v_mfma_f32_16x16x32_bf16 v[184:187], v[52:55], v[40:43], v[184:187]
ds_read_b128 v[76:79], v2 offset:64512
v_mul_f32 v209, v112, v128
v_mfma_f32_16x16x32_bf16 v[188:191], v[48:51], v[28:31], v[188:191]
v_exp_f32 v208, v208
v_mfma_f32_16x16x32_bf16 v[188:191], v[52:55], v[44:47], v[188:191]
v_mul_f32 v211, v113, v129
s_waitcnt lgkmcnt(4)
v_mfma_f32_16x16x32_bf16 v[192:195], v[56:59], v[16:19], v[192:195]
v_exp_f32 v210, v210
v_mfma_f32_16x16x32_bf16 v[192:195], v[60:63], v[32:35], v[192:195]
v_fma_f32 v208, v208, v234, v234
v_fma_f32 v210, v210, v234, v234
v_mfma_f32_16x16x32_bf16 v[196:199], v[56:59], v[20:23], v[196:199]
ds_read_b128 v[48:51], v7 offset:0
v_mul_f32 v212, v114, v114
v_mfma_f32_16x16x32_bf16 v[196:199], v[60:63], v[36:39], v[196:199]
v_rcp_f32 v208, v208
v_mfma_f32_16x16x32_bf16 v[200:203], v[56:59], v[24:27], v[200:203]
v_rcp_f32 v210, v210
v_mfma_f32_16x16x32_bf16 v[200:203], v[60:63], v[40:43], v[200:203]
ds_read_b128 v[52:55], v7 offset:1024
v_mul_f32 v209, v209, v208
v_mfma_f32_16x16x32_bf16 v[204:207], v[56:59], v[28:31], v[204:207]
v_mul_f32 v211, v211, v210
v_cvt_pk_bf16_f32 v144, v209, v211
v_mfma_f32_16x16x32_bf16 v[204:207], v[60:63], v[44:47], v[204:207]
v_mul_f32 v214, v115, v115
s_waitcnt lgkmcnt(4)
v_mfma_f32_16x16x32_bf16 v[80:83], v[64:67], a[0:3], 0
v_fma_f32 v212, v212, v233, v232
v_fma_f32 v214, v214, v233, v232
v_mfma_f32_16x16x32_bf16 v[80:83], v[68:71], a[16:19], v[80:83]
v_mul_f32 v212, v212, v114
v_mul_f32 v214, v214, v115
v_mfma_f32_16x16x32_bf16 v[84:87], v[64:67], a[4:7], 0
ds_read_b128 v[56:59], v7 offset:2048
v_mul_f32 v213, v114, v130
v_mfma_f32_16x16x32_bf16 v[84:87], v[68:71], a[20:23], v[84:87]
v_exp_f32 v212, v212
v_mfma_f32_16x16x32_bf16 v[88:91], v[64:67], a[8:11], 0
v_exp_f32 v214, v214
v_mfma_f32_16x16x32_bf16 v[88:91], v[68:71], a[24:27], v[88:91]
ds_read_b128 v[60:63], v7 offset:3072
v_mul_f32 v215, v115, v131
v_mfma_f32_16x16x32_bf16 v[92:95], v[64:67], a[12:15], 0
v_fma_f32 v212, v212, v234, v234
v_fma_f32 v214, v214, v234, v234
v_mfma_f32_16x16x32_bf16 v[92:95], v[68:71], a[28:31], v[92:95]
v_mul_f32 v208, v116, v116
s_waitcnt lgkmcnt(4)
v_mfma_f32_16x16x32_bf16 v[96:99], v[72:75], a[0:3], 0
v_rcp_f32 v212, v212
v_mfma_f32_16x16x32_bf16 v[96:99], v[76:79], a[16:19], v[96:99]
v_rcp_f32 v214, v214
v_mfma_f32_16x16x32_bf16 v[100:103], v[72:75], a[4:7], 0
ds_read_b128 v[64:67], v7 offset:4096
v_mul_f32 v213, v213, v212
v_mfma_f32_16x16x32_bf16 v[100:103], v[76:79], a[20:23], v[100:103]
v_mul_f32 v215, v215, v214
v_cvt_pk_bf16_f32 v145, v213, v215
v_mfma_f32_16x16x32_bf16 v[104:107], v[72:75], a[8:11], 0
v_mul_f32 v210, v117, v117
v_fma_f32 v208, v208, v237, v236
v_mfma_f32_16x16x32_bf16 v[104:107], v[76:79], a[24:27], v[104:107]
ds_read_b128 v[68:71], v7 offset:5120
v_fma_f32 v210, v210, v237, v236
v_mfma_f32_16x16x32_bf16 v[108:111], v[72:75], a[12:15], 0
v_mul_f32 v208, v208, v116
v_mul_f32 v210, v210, v117
v_mfma_f32_16x16x32_bf16 v[108:111], v[76:79], a[28:31], v[108:111]
v_mul_f32 v209, v116, v132
s_waitcnt lgkmcnt(4)
v_mfma_f32_16x16x32_bf16 v[80:83], v[48:51], a[32:35], v[80:83]
v_exp_f32 v208, v208
v_mfma_f32_16x16x32_bf16 v[80:83], v[52:55], a[48:51], v[80:83]
v_exp_f32 v210, v210
v_mfma_f32_16x16x32_bf16 v[84:87], v[48:51], a[36:39], v[84:87]
ds_read_b128 v[72:75], v7 offset:6144
v_mul_f32 v211, v117, v133
v_mfma_f32_16x16x32_bf16 v[84:87], v[52:55], a[52:55], v[84:87]
v_fma_f32 v208, v208, v238, v238
v_fma_f32 v210, v210, v238, v238
v_mfma_f32_16x16x32_bf16 v[88:91], v[48:51], a[40:43], v[88:91]
v_rcp_f32 v208, v208
v_mfma_f32_16x16x32_bf16 v[88:91], v[52:55], a[56:59], v[88:91]
ds_read_b128 v[76:79], v7 offset:7168
v_mul_f32 v209, v209, v208
v_mfma_f32_16x16x32_bf16 v[92:95], v[48:51], a[44:47], v[92:95]
v_rcp_f32 v210, v210
v_mfma_f32_16x16x32_bf16 v[92:95], v[52:55], a[60:63], v[92:95]
v_mul_f32 v211, v211, v210
s_waitcnt lgkmcnt(4)
v_mfma_f32_16x16x32_bf16 v[96:99], v[56:59], a[32:35], v[96:99]
s_waitcnt vmcnt(22)
v_cvt_pk_bf16_f32 v148, v209, v211
v_mfma_f32_16x16x32_bf16 v[96:99], v[60:63], a[48:51], v[96:99]
s_barrier
v_mfma_f32_16x16x32_bf16 v[100:103], v[56:59], a[36:39], v[100:103]
ds_read_b128 v[48:51], v7 offset:8192
s_add_u32 m0, s22, 24576
v_mfma_f32_16x16x32_bf16 v[100:103], v[60:63], a[52:55], v[100:103]
v_add_u32 v3, 20480, v3
buffer_load_dwordx4 v3, s[8:11], 0 offen offset:0 sc1 lds
v_mfma_f32_16x16x32_bf16 v[104:107], v[56:59], a[40:43], v[104:107]
v_mul_f32 v212, v118, v118
v_mul_f32 v214, v119, v119
v_mfma_f32_16x16x32_bf16 v[104:107], v[60:63], a[56:59], v[104:107]
ds_read_b128 v[52:55], v7 offset:9216
v_fma_f32 v212, v212, v237, v236
v_mfma_f32_16x16x32_bf16 v[108:111], v[56:59], a[44:47], v[108:111]
v_fma_f32 v214, v214, v237, v236
v_mul_f32 v212, v212, v118
v_mfma_f32_16x16x32_bf16 v[108:111], v[60:63], a[60:63], v[108:111]
v_mul_f32 v214, v214, v119
s_waitcnt lgkmcnt(4)
v_mfma_f32_16x16x32_bf16 v[80:83], v[64:67], a[64:67], v[80:83]
buffer_load_dwordx4 v3, s[8:11], 0 offen offset:1024 sc1 lds
v_mfma_f32_16x16x32_bf16 v[80:83], v[68:71], a[80:83], v[80:83]
v_exp_f32 v212, v212
v_mfma_f32_16x16x32_bf16 v[84:87], v[64:67], a[68:71], v[84:87]
ds_read_b128 v[56:59], v7 offset:10240
v_mul_f32 v213, v118, v134
v_mfma_f32_16x16x32_bf16 v[84:87], v[68:71], a[84:87], v[84:87]
v_exp_f32 v214, v214
v_mfma_f32_16x16x32_bf16 v[88:91], v[64:67], a[72:75], v[88:91]
v_mul_f32 v215, v119, v135
v_fma_f32 v212, v212, v238, v238
v_mfma_f32_16x16x32_bf16 v[88:91], v[68:71], a[88:91], v[88:91]
ds_read_b128 v[60:63], v7 offset:11264
v_fma_f32 v214, v214, v238, v238
v_mfma_f32_16x16x32_bf16 v[92:95], v[64:67], a[76:79], v[92:95]
buffer_load_dwordx4 v3, s[8:11], 0 offen offset:2048 sc1 lds
v_mfma_f32_16x16x32_bf16 v[92:95], v[68:71], a[92:95], v[92:95]
v_mul_f32 v208, v120, v120
s_waitcnt lgkmcnt(4)
v_mfma_f32_16x16x32_bf16 v[96:99], v[72:75], a[64:67], v[96:99]
v_rcp_f32 v212, v212
v_mfma_f32_16x16x32_bf16 v[96:99], v[76:79], a[80:83], v[96:99]
v_rcp_f32 v214, v214
v_mfma_f32_16x16x32_bf16 v[100:103], v[72:75], a[68:71], v[100:103]
ds_read_b128 v[64:67], v7 offset:12288
v_mul_f32 v213, v213, v212
v_mfma_f32_16x16x32_bf16 v[100:103], v[76:79], a[84:87], v[100:103]
buffer_load_dwordx4 v3, s[8:11], 0 offen offset:3072 sc1 lds
v_mfma_f32_16x16x32_bf16 v[104:107], v[72:75], a[72:75], v[104:107]
s_add_u32 m0, s22, 28672
v_add_u32 v3, 4096, v3
v_mfma_f32_16x16x32_bf16 v[104:107], v[76:79], a[88:91], v[104:107]
ds_read_b128 v[68:71], v7 offset:13312
v_mul_f32 v215, v215, v214
v_mfma_f32_16x16x32_bf16 v[108:111], v[72:75], a[76:79], v[108:111]
v_cvt_pk_bf16_f32 v149, v213, v215
v_mul_f32 v210, v121, v121
v_mfma_f32_16x16x32_bf16 v[108:111], v[76:79], a[92:95], v[108:111]
v_fma_f32 v208, v208, v241, v240
s_waitcnt lgkmcnt(4)
v_mfma_f32_16x16x32_bf16 v[80:83], v[48:51], a[96:99], v[80:83]
buffer_load_dwordx4 v3, s[8:11], 0 offen offset:0 sc1 lds
v_mfma_f32_16x16x32_bf16 v[80:83], v[52:55], a[112:115], v[80:83]
v_fma_f32 v210, v210, v241, v240
v_mul_f32 v208, v208, v120
v_mfma_f32_16x16x32_bf16 v[84:87], v[48:51], a[100:103], v[84:87]
ds_read_b128 v[72:75], v7 offset:14336
v_mul_f32 v210, v210, v121
v_mfma_f32_16x16x32_bf16 v[84:87], v[52:55], a[116:119], v[84:87]
v_exp_f32 v208, v208
v_mfma_f32_16x16x32_bf16 v[88:91], v[48:51], a[104:107], v[88:91]
v_exp_f32 v210, v210
v_mfma_f32_16x16x32_bf16 v[88:91], v[52:55], a[120:123], v[88:91]
ds_read_b128 v[76:79], v7 offset:15360
v_mul_f32 v209, v120, v136
v_mfma_f32_16x16x32_bf16 v[92:95], v[48:51], a[108:111], v[92:95]
buffer_load_dwordx4 v3, s[8:11], 0 offen offset:1024 sc1 lds
v_mfma_f32_16x16x32_bf16 v[92:95], v[52:55], a[124:127], v[92:95]
v_mul_f32 v211, v121, v137
s_waitcnt lgkmcnt(4)
v_mfma_f32_16x16x32_bf16 v[96:99], v[56:59], a[96:99], v[96:99]
v_fma_f32 v208, v208, v242, v242
v_fma_f32 v210, v210, v242, v242
v_mfma_f32_16x16x32_bf16 v[96:99], v[60:63], a[112:115], v[96:99]
v_rcp_f32 v208, v208
v_mfma_f32_16x16x32_bf16 v[100:103], v[56:59], a[100:103], v[100:103]
ds_read_b128 v[48:51], v7 offset:16384
v_mul_f32 v209, v209, v208
v_mfma_f32_16x16x32_bf16 v[100:103], v[60:63], a[116:119], v[100:103]
v_rcp_f32 v210, v210
v_mfma_f32_16x16x32_bf16 v[104:107], v[56:59], a[104:107], v[104:107]
v_mul_f32 v211, v211, v210
v_cvt_pk_bf16_f32 v152, v209, v211
v_mfma_f32_16x16x32_bf16 v[104:107], v[60:63], a[120:123], v[104:107]
ds_read_b128 v[52:55], v7 offset:17408
v_mul_f32 v212, v122, v122
v_mfma_f32_16x16x32_bf16 v[108:111], v[56:59], a[108:111], v[108:111]
v_mul_f32 v214, v123, v123
v_fma_f32 v212, v212, v241, v240
v_mfma_f32_16x16x32_bf16 v[108:111], v[60:63], a[124:127], v[108:111]
v_fma_f32 v214, v214, v241, v240
s_waitcnt lgkmcnt(4)
v_mfma_f32_16x16x32_bf16 v[80:83], v[64:67], a[128:131], v[80:83]
v_mul_f32 v212, v212, v122
v_mul_f32 v214, v214, v123
v_mfma_f32_16x16x32_bf16 v[80:83], v[68:71], a[144:147], v[80:83]
v_exp_f32 v212, v212
v_mfma_f32_16x16x32_bf16 v[84:87], v[64:67], a[132:135], v[84:87]
ds_read_b128 v[56:59], v7 offset:18432
v_mul_f32 v213, v122, v138
v_mfma_f32_16x16x32_bf16 v[84:87], v[68:71], a[148:151], v[84:87]
v_exp_f32 v214, v214
v_mfma_f32_16x16x32_bf16 v[88:91], v[64:67], a[136:139], v[88:91]
v_mul_f32 v215, v123, v139
v_fma_f32 v212, v212, v242, v242
v_mfma_f32_16x16x32_bf16 v[88:91], v[68:71], a[152:155], v[88:91]
ds_read_b128 v[60:63], v7 offset:19456
v_fma_f32 v214, v214, v242, v242
v_mfma_f32_16x16x32_bf16 v[92:95], v[64:67], a[140:143], v[92:95]
v_rcp_f32 v212, v212
v_mfma_f32_16x16x32_bf16 v[92:95], v[68:71], a[156:159], v[92:95]
v_mul_f32 v213, v213, v212
s_waitcnt lgkmcnt(4)
v_mfma_f32_16x16x32_bf16 v[96:99], v[72:75], a[128:131], v[96:99]
v_rcp_f32 v214, v214
v_mfma_f32_16x16x32_bf16 v[96:99], v[76:79], a[144:147], v[96:99]
v_mul_f32 v215, v215, v214
v_cvt_pk_bf16_f32 v153, v213, v215
v_mfma_f32_16x16x32_bf16 v[100:103], v[72:75], a[132:135], v[100:103]
ds_read_b128 v[64:67], v7 offset:20480
v_mul_f32 v208, v124, v124
v_mfma_f32_16x16x32_bf16 v[100:103], v[76:79], a[148:151], v[100:103]
v_mul_f32 v210, v125, v125
v_fma_f32 v208, v208, v245, v244
v_mfma_f32_16x16x32_bf16 v[104:107], v[72:75], a[136:139], v[104:107]
v_fma_f32 v210, v210, v245, v244
v_mul_f32 v208, v208, v124
v_mfma_f32_16x16x32_bf16 v[104:107], v[76:79], a[152:155], v[104:107]
ds_read_b128 v[68:71], v7 offset:21504
v_mul_f32 v210, v210, v125
v_mfma_f32_16x16x32_bf16 v[108:111], v[72:75], a[140:143], v[108:111]
v_exp_f32 v208, v208
v_mfma_f32_16x16x32_bf16 v[108:111], v[76:79], a[156:159], v[108:111]
v_mul_f32 v209, v124, v140
s_waitcnt lgkmcnt(4)
v_mfma_f32_16x16x32_bf16 v[80:83], v[48:51], a[160:163], v[80:83]
v_exp_f32 v210, v210
v_mfma_f32_16x16x32_bf16 v[80:83], v[52:55], a[176:179], v[80:83]
v_mul_f32 v211, v125, v141
v_fma_f32 v208, v208, v246, v246
v_mfma_f32_16x16x32_bf16 v[84:87], v[48:51], a[164:167], v[84:87]
ds_read_b128 v[72:75], v7 offset:22528
v_fma_f32 v210, v210, v246, v246
v_mfma_f32_16x16x32_bf16 v[84:87], v[52:55], a[180:183], v[84:87]
v_rcp_f32 v208, v208
v_mfma_f32_16x16x32_bf16 v[88:91], v[48:51], a[168:171], v[88:91]
v_rcp_f32 v210, v210
v_mfma_f32_16x16x32_bf16 v[88:91], v[52:55], a[184:187], v[88:91]
ds_read_b128 v[76:79], v7 offset:23552
v_mul_f32 v209, v209, v208
v_mfma_f32_16x16x32_bf16 v[92:95], v[48:51], a[172:175], v[92:95]
v_mul_f32 v211, v211, v210
v_cvt_pk_bf16_f32 v156, v209, v211
v_mfma_f32_16x16x32_bf16 v[92:95], v[52:55], a[188:191], v[92:95]
v_mul_f32 v212, v126, v126
s_waitcnt lgkmcnt(4)
v_mfma_f32_16x16x32_bf16 v[96:99], v[56:59], a[160:163], v[96:99]
v_mul_f32 v214, v127, v127
v_fma_f32 v212, v212, v245, v244
v_mfma_f32_16x16x32_bf16 v[96:99], v[60:63], a[176:179], v[96:99]
v_fma_f32 v214, v214, v245, v244
v_mul_f32 v212, v212, v126
v_mfma_f32_16x16x32_bf16 v[100:103], v[56:59], a[164:167], v[100:103]
ds_read_b128 v[48:51], v7 offset:24576
v_mul_f32 v214, v214, v127
v_mfma_f32_16x16x32_bf16 v[100:103], v[60:63], a[180:183], v[100:103]
v_exp_f32 v212, v212
v_mfma_f32_16x16x32_bf16 v[104:107], v[56:59], a[168:171], v[104:107]
v_exp_f32 v214, v214
v_mfma_f32_16x16x32_bf16 v[104:107], v[60:63], a[184:187], v[104:107]
ds_read_b128 v[52:55], v7 offset:25600
v_mul_f32 v213, v126, v142
v_mfma_f32_16x16x32_bf16 v[108:111], v[56:59], a[172:175], v[108:111]
v_mul_f32 v215, v127, v143
v_fma_f32 v212, v212, v246, v246
v_mfma_f32_16x16x32_bf16 v[108:111], v[60:63], a[188:191], v[108:111]
v_fma_f32 v214, v214, v246, v246
s_waitcnt lgkmcnt(4)
v_mfma_f32_16x16x32_bf16 v[80:83], v[64:67], a[192:195], v[80:83]
v_rcp_f32 v212, v212
v_mfma_f32_16x16x32_bf16 v[80:83], v[68:71], a[208:211], v[80:83]
v_rcp_f32 v214, v214
v_mfma_f32_16x16x32_bf16 v[84:87], v[64:67], a[196:199], v[84:87]
ds_read_b128 v[56:59], v7 offset:26624
v_mul_f32 v213, v213, v212
v_mfma_f32_16x16x32_bf16 v[84:87], v[68:71], a[212:215], v[84:87]
v_mul_f32 v215, v215, v214
v_cvt_pk_bf16_f32 v157, v213, v215
v_mfma_f32_16x16x32_bf16 v[88:91], v[64:67], a[200:203], v[88:91]
v_mul_f32 v216, v176, v176
v_mul_f32 v218, v177, v177
v_mfma_f32_16x16x32_bf16 v[88:91], v[68:71], a[216:219], v[88:91]
ds_read_b128 v[60:63], v7 offset:27648
v_fma_f32 v216, v216, v233, v232
v_mfma_f32_16x16x32_bf16 v[92:95], v[64:67], a[204:207], v[92:95]
v_fma_f32 v218, v218, v233, v232
v_mul_f32 v216, v216, v176
v_mfma_f32_16x16x32_bf16 v[92:95], v[68:71], a[220:223], v[92:95]
v_mul_f32 v218, v218, v177
s_waitcnt lgkmcnt(4)
v_mfma_f32_16x16x32_bf16 v[96:99], v[72:75], a[192:195], v[96:99]
v_exp_f32 v216, v216
v_mfma_f32_16x16x32_bf16 v[96:99], v[76:79], a[208:211], v[96:99]
v_exp_f32 v218, v218
v_mfma_f32_16x16x32_bf16 v[100:103], v[72:75], a[196:199], v[100:103]
ds_read_b128 v[64:67], v7 offset:28672
v_mul_f32 v217, v176, v192
v_mfma_f32_16x16x32_bf16 v[100:103], v[76:79], a[212:215], v[100:103]
v_mul_f32 v219, v177, v193
v_fma_f32 v216, v216, v234, v234
v_mfma_f32_16x16x32_bf16 v[104:107], v[72:75], a[200:203], v[104:107]
v_fma_f32 v218, v218, v234, v234
v_mul_f32 v220, v178, v178
v_mfma_f32_16x16x32_bf16 v[104:107], v[76:79], a[216:219], v[104:107]
ds_read_b128 v[68:71], v7 offset:29696
v_mul_f32 v222, v179, v179
v_mfma_f32_16x16x32_bf16 v[108:111], v[72:75], a[204:207], v[108:111]
v_rcp_f32 v216, v216
v_mfma_f32_16x16x32_bf16 v[108:111], v[76:79], a[220:223], v[108:111]
v_mul_f32 v217, v217, v216
s_waitcnt lgkmcnt(4)
v_mfma_f32_16x16x32_bf16 v[80:83], v[48:51], a[224:227], v[80:83]
v_rcp_f32 v218, v218
v_mfma_f32_16x16x32_bf16 v[80:83], v[52:55], a[240:243], v[80:83]
v_mul_f32 v219, v219, v218
v_cvt_pk_bf16_f32 v146, v217, v219
v_mfma_f32_16x16x32_bf16 v[84:87], v[48:51], a[228:231], v[84:87]
ds_read_b128 v[72:75], v7 offset:30720
v_fma_f32 v220, v220, v233, v232
v_mfma_f32_16x16x32_bf16 v[84:87], v[52:55], a[244:247], v[84:87]
v_fma_f32 v222, v222, v233, v232
v_mul_f32 v220, v220, v178
v_mfma_f32_16x16x32_bf16 v[88:91], v[48:51], a[232:235], v[88:91]
v_mul_f32 v222, v222, v179
v_mul_f32 v221, v178, v194
v_mfma_f32_16x16x32_bf16 v[88:91], v[52:55], a[248:251], v[88:91]
ds_read_b128 v[76:79], v7 offset:31744
v_mul_f32 v223, v179, v195
v_mfma_f32_16x16x32_bf16 v[92:95], v[48:51], a[236:239], v[92:95]
v_exp_f32 v220, v220
v_mfma_f32_16x16x32_bf16 v[92:95], v[52:55], a[252:255], v[92:95]
v_fma_f32 v220, v220, v234, v234
s_waitcnt lgkmcnt(4)
v_mfma_f32_16x16x32_bf16 v[96:99], v[56:59], a[224:227], v[96:99]
s_waitcnt vmcnt(22)
v_mul_f32 v216, v180, v180
v_mfma_f32_16x16x32_bf16 v[96:99], v[60:63], a[240:243], v[96:99]
s_barrier
v_mfma_f32_16x16x32_bf16 v[100:103], v[56:59], a[228:231], v[100:103]
ds_read_b128 v[48:51], v7 offset:32768
s_add_u32 m0, s22, 49152
v_mfma_f32_16x16x32_bf16 v[100:103], v[60:63], a[244:247], v[100:103]
v_add_u32 v3, 20480, v3
buffer_load_dwordx4 v3, s[8:11], 0 offen offset:0 sc1 lds
v_mfma_f32_16x16x32_bf16 v[104:107], v[56:59], a[232:235], v[104:107]
v_exp_f32 v222, v222
v_mfma_f32_16x16x32_bf16 v[104:107], v[60:63], a[248:251], v[104:107]
ds_read_b128 v[52:55], v7 offset:33792
v_fma_f32 v222, v222, v234, v234
v_mfma_f32_16x16x32_bf16 v[108:111], v[56:59], a[236:239], v[108:111]
v_rcp_f32 v220, v220
v_mfma_f32_16x16x32_bf16 v[108:111], v[60:63], a[252:255], v[108:111]
v_mul_f32 v221, v221, v220
s_waitcnt lgkmcnt(4)
v_mfma_f32_16x16x32_bf16 v[80:83], v[64:67], v[16:19], v[80:83]
buffer_load_dwordx4 v3, s[8:11], 0 offen offset:1024 sc1 lds
v_mfma_f32_16x16x32_bf16 v[80:83], v[68:71], v[32:35], v[80:83]
v_rcp_f32 v222, v222
v_mfma_f32_16x16x32_bf16 v[84:87], v[64:67], v[20:23], v[84:87]
ds_read_b128 v[56:59], v7 offset:34816
v_mul_f32 v223, v223, v222
v_mfma_f32_16x16x32_bf16 v[84:87], v[68:71], v[36:39], v[84:87]
v_cvt_pk_bf16_f32 v147, v221, v223
v_mul_f32 v218, v181, v181
v_mfma_f32_16x16x32_bf16 v[88:91], v[64:67], v[24:27], v[88:91]
buffer_store_dwordx4 v[144:147], v2, s[8:11], s24 offen offset:0 sc1
v_mfma_f32_16x16x32_bf16 v[88:91], v[68:71], v[40:43], v[88:91]
ds_read_b128 v[60:63], v7 offset:35840
v_fma_f32 v216, v216, v237, v236
v_mfma_f32_16x16x32_bf16 v[92:95], v[64:67], v[28:31], v[92:95]
v_fma_f32 v218, v218, v237, v236
v_mul_f32 v216, v216, v180
v_mfma_f32_16x16x32_bf16 v[92:95], v[68:71], v[44:47], v[92:95]
v_mul_f32 v218, v218, v181
s_waitcnt lgkmcnt(4)
v_mfma_f32_16x16x32_bf16 v[96:99], v[72:75], v[16:19], v[96:99]
v_exp_f32 v216, v216
v_mfma_f32_16x16x32_bf16 v[96:99], v[76:79], v[32:35], v[96:99]
buffer_load_dwordx4 v3, s[8:11], 0 offen offset:2048 sc1 lds
v_mfma_f32_16x16x32_bf16 v[100:103], v[72:75], v[20:23], v[100:103]
ds_read_b128 v[64:67], v7 offset:36864
v_mul_f32 v217, v180, v196
v_mfma_f32_16x16x32_bf16 v[100:103], v[76:79], v[36:39], v[100:103]
v_exp_f32 v218, v218
v_mfma_f32_16x16x32_bf16 v[104:107], v[72:75], v[24:27], v[104:107]
v_mul_f32 v219, v181, v197
v_fma_f32 v216, v216, v238, v238
v_mfma_f32_16x16x32_bf16 v[104:107], v[76:79], v[40:43], v[104:107]
ds_read_b128 v[68:71], v7 offset:37888
v_fma_f32 v218, v218, v238, v238
v_mfma_f32_16x16x32_bf16 v[108:111], v[72:75], v[28:31], v[108:111]
buffer_load_dwordx4 v3, s[8:11], 0 offen offset:3072 sc1 lds
v_mfma_f32_16x16x32_bf16 v[108:111], v[76:79], v[44:47], v[108:111]
s_add_u32 m0, s22, 53248
s_waitcnt lgkmcnt(4)
v_mfma_f32_16x16x32_bf16 v[112:115], v[48:51], a[0:3], 0
v_add_u32 v3, 4096, v3
v_mul_f32 v220, v182, v182
v_mfma_f32_16x16x32_bf16 v[112:115], v[52:55], a[16:19], v[112:115]
v_rcp_f32 v216, v216
v_mfma_f32_16x16x32_bf16 v[116:119], v[48:51], a[4:7], 0
ds_read_b128 v[72:75], v7 offset:38912
v_mul_f32 v217, v217, v216
v_mfma_f32_16x16x32_bf16 v[116:119], v[52:55], a[20:23], v[116:119]
buffer_load_dwordx4 v3, s[8:11], 0 offen offset:0 sc1 lds
v_mfma_f32_16x16x32_bf16 v[120:123], v[48:51], a[8:11], 0
v_mul_f32 v208, v80, v80
v_mul_f32 v210, v81, v81
v_mfma_f32_16x16x32_bf16 v[120:123], v[52:55], a[24:27], v[120:123]
ds_read_b128 v[76:79], v7 offset:39936
v_fma_f32 v208, v208, v233, v232
v_mfma_f32_16x16x32_bf16 v[124:127], v[48:51], a[12:15], 0
v_fma_f32 v210, v210, v233, v232
v_mul_f32 v208, v208, v80
v_mfma_f32_16x16x32_bf16 v[124:127], v[52:55], a[28:31], v[124:127]
v_mul_f32 v210, v210, v81
s_waitcnt lgkmcnt(4)
v_mfma_f32_16x16x32_bf16 v[128:131], v[56:59], a[0:3], 0
buffer_load_dwordx4 v3, s[8:11], 0 offen offset:1024 sc1 lds
v_mfma_f32_16x16x32_bf16 v[128:131], v[60:63], a[16:19], v[128:131]
v_exp_f32 v208, v208
v_mfma_f32_16x16x32_bf16 v[132:135], v[56:59], a[4:7], 0
ds_read_b128 v[48:51], v7 offset:40960
v_mul_f32 v209, v80, v96
v_mfma_f32_16x16x32_bf16 v[132:135], v[60:63], a[20:23], v[132:135]
v_exp_f32 v210, v210
v_mfma_f32_16x16x32_bf16 v[136:139], v[56:59], a[8:11], 0
v_mul_f32 v211, v81, v97
v_fma_f32 v208, v208, v234, v234
v_mfma_f32_16x16x32_bf16 v[136:139], v[60:63], a[24:27], v[136:139]
ds_read_b128 v[52:55], v7 offset:41984
v_fma_f32 v210, v210, v234, v234
v_mfma_f32_16x16x32_bf16 v[140:143], v[56:59], a[12:15], 0
v_rcp_f32 v208, v208
v_mfma_f32_16x16x32_bf16 v[140:143], v[60:63], a[28:31], v[140:143]
v_mul_f32 v209, v209, v208
s_waitcnt lgkmcnt(4)
v_mfma_f32_16x16x32_bf16 v[112:115], v[64:67], a[32:35], v[112:115]
v_rcp_f32 v210, v210
v_mfma_f32_16x16x32_bf16 v[112:115], v[68:71], a[48:51], v[112:115]
v_mul_f32 v211, v211, v210
v_cvt_pk_bf16_f32 v160, v209, v211
v_mfma_f32_16x16x32_bf16 v[116:119], v[64:67], a[36:39], v[116:119]
ds_read_b128 v[56:59], v7 offset:43008
v_mul_f32 v212, v82, v82
v_mfma_f32_16x16x32_bf16 v[116:119], v[68:71], a[52:55], v[116:119]
v_mul_f32 v214, v83, v83
v_fma_f32 v212, v212, v233, v232
v_mfma_f32_16x16x32_bf16 v[120:123], v[64:67], a[40:43], v[120:123]
v_fma_f32 v214, v214, v233, v232
v_mul_f32 v212, v212, v82
v_mfma_f32_16x16x32_bf16 v[120:123], v[68:71], a[56:59], v[120:123]
ds_read_b128 v[60:63], v7 offset:44032
v_mul_f32 v214, v214, v83
v_mfma_f32_16x16x32_bf16 v[124:127], v[64:67], a[44:47], v[124:127]
v_exp_f32 v212, v212
v_mfma_f32_16x16x32_bf16 v[124:127], v[68:71], a[60:63], v[124:127]
v_mul_f32 v213, v82, v98
s_waitcnt lgkmcnt(4)
v_mfma_f32_16x16x32_bf16 v[128:131], v[72:75], a[32:35], v[128:131]
v_exp_f32 v214, v214
v_mfma_f32_16x16x32_bf16 v[128:131], v[76:79], a[48:51], v[128:131]
v_mul_f32 v215, v83, v99
v_fma_f32 v212, v212, v234, v234
v_mfma_f32_16x16x32_bf16 v[132:135], v[72:75], a[36:39], v[132:135]
ds_read_b128 v[64:67], v7 offset:45056
v_fma_f32 v214, v214, v234, v234
v_mfma_f32_16x16x32_bf16 v[132:135], v[76:79], a[52:55], v[132:135]
v_rcp_f32 v212, v212
v_mfma_f32_16x16x32_bf16 v[136:139], v[72:75], a[40:43], v[136:139]
v_rcp_f32 v214, v214
v_mfma_f32_16x16x32_bf16 v[136:139], v[76:79], a[56:59], v[136:139]
ds_read_b128 v[68:71], v7 offset:46080
v_mul_f32 v213, v213, v212
v_mfma_f32_16x16x32_bf16 v[140:143], v[72:75], a[44:47], v[140:143]
v_mul_f32 v215, v215, v214
v_cvt_pk_bf16_f32 v161, v213, v215
v_mfma_f32_16x16x32_bf16 v[140:143], v[76:79], a[60:63], v[140:143]
v_mul_f32 v208, v84, v84
s_waitcnt lgkmcnt(4)
v_mfma_f32_16x16x32_bf16 v[112:115], v[48:51], a[64:67], v[112:115]
v_mul_f32 v210, v85, v85
v_fma_f32 v208, v208, v237, v236
v_mfma_f32_16x16x32_bf16 v[112:115], v[52:55], a[80:83], v[112:115]
v_fma_f32 v210, v210, v237, v236
v_mul_f32 v208, v208, v84
v_mfma_f32_16x16x32_bf16 v[116:119], v[48:51], a[68:71], v[116:119]
ds_read_b128 v[72:75], v7 offset:47104
v_mul_f32 v210, v210, v85
v_mfma_f32_16x16x32_bf16 v[116:119], v[52:55], a[84:87], v[116:119]
v_exp_f32 v208, v208
v_mfma_f32_16x16x32_bf16 v[120:123], v[48:51], a[72:75], v[120:123]
v_exp_f32 v210, v210
v_mfma_f32_16x16x32_bf16 v[120:123], v[52:55], a[88:91], v[120:123]
ds_read_b128 v[76:79], v7 offset:48128
v_mul_f32 v209, v84, v100
v_mfma_f32_16x16x32_bf16 v[124:127], v[48:51], a[76:79], v[124:127]
v_mul_f32 v211, v85, v101
v_fma_f32 v208, v208, v238, v238
v_mfma_f32_16x16x32_bf16 v[124:127], v[52:55], a[92:95], v[124:127]
v_fma_f32 v210, v210, v238, v238
s_waitcnt lgkmcnt(4)
v_mfma_f32_16x16x32_bf16 v[128:131], v[56:59], a[64:67], v[128:131]
v_rcp_f32 v208, v208
v_mfma_f32_16x16x32_bf16 v[128:131], v[60:63], a[80:83], v[128:131]
v_rcp_f32 v210, v210
v_mfma_f32_16x16x32_bf16 v[132:135], v[56:59], a[68:71], v[132:135]
ds_read_b128 v[48:51], v7 offset:49152
v_mul_f32 v209, v209, v208
v_mfma_f32_16x16x32_bf16 v[132:135], v[60:63], a[84:87], v[132:135]
v_mul_f32 v211, v211, v210
v_cvt_pk_bf16_f32 v164, v209, v211
v_mfma_f32_16x16x32_bf16 v[136:139], v[56:59], a[72:75], v[136:139]
v_mul_f32 v212, v86, v86
v_mul_f32 v214, v87, v87
v_mfma_f32_16x16x32_bf16 v[136:139], v[60:63], a[88:91], v[136:139]
ds_read_b128 v[52:55], v7 offset:50176
v_fma_f32 v212, v212, v237, v236
v_mfma_f32_16x16x32_bf16 v[140:143], v[56:59], a[76:79], v[140:143]
v_fma_f32 v214, v214, v237, v236
v_mul_f32 v212, v212, v86
v_mfma_f32_16x16x32_bf16 v[140:143], v[60:63], a[92:95], v[140:143]
v_mul_f32 v214, v214, v87
s_waitcnt lgkmcnt(4)
v_mfma_f32_16x16x32_bf16 v[112:115], v[64:67], a[96:99], v[112:115]
v_exp_f32 v212, v212
v_mfma_f32_16x16x32_bf16 v[112:115], v[68:71], a[112:115], v[112:115]
v_exp_f32 v214, v214
v_mfma_f32_16x16x32_bf16 v[116:119], v[64:67], a[100:103], v[116:119]
ds_read_b128 v[56:59], v7 offset:51200
v_mul_f32 v213, v86, v102
v_mfma_f32_16x16x32_bf16 v[116:119], v[68:71], a[116:119], v[116:119]
v_mul_f32 v215, v87, v103
v_fma_f32 v212, v212, v238, v238
v_mfma_f32_16x16x32_bf16 v[120:123], v[64:67], a[104:107], v[120:123]
v_fma_f32 v214, v214, v238, v238
v_mul_f32 v208, v88, v88
v_mfma_f32_16x16x32_bf16 v[120:123], v[68:71], a[120:123], v[120:123]
ds_read_b128 v[60:63], v7 offset:52224
v_mul_f32 v210, v89, v89
v_mfma_f32_16x16x32_bf16 v[124:127], v[64:67], a[108:111], v[124:127]
v_rcp_f32 v212, v212
v_mfma_f32_16x16x32_bf16 v[124:127], v[68:71], a[124:127], v[124:127]
v_mul_f32 v213, v213, v212
s_waitcnt lgkmcnt(4)
v_mfma_f32_16x16x32_bf16 v[128:131], v[72:75], a[96:99], v[128:131]
v_rcp_f32 v214, v214
v_mfma_f32_16x16x32_bf16 v[128:131], v[76:79], a[112:115], v[128:131]
v_mul_f32 v215, v215, v214
v_cvt_pk_bf16_f32 v165, v213, v215
v_mfma_f32_16x16x32_bf16 v[132:135], v[72:75], a[100:103], v[132:135]
ds_read_b128 v[64:67], v7 offset:53248
v_fma_f32 v208, v208, v241, v240
v_mfma_f32_16x16x32_bf16 v[132:135], v[76:79], a[116:119], v[132:135]
v_fma_f32 v210, v210, v241, v240
v_mul_f32 v208, v208, v88
v_mfma_f32_16x16x32_bf16 v[136:139], v[72:75], a[104:107], v[136:139]
v_mul_f32 v210, v210, v89
v_mul_f32 v209, v88, v104
v_mfma_f32_16x16x32_bf16 v[136:139], v[76:79], a[120:123], v[136:139]
ds_read_b128 v[68:71], v7 offset:54272
v_mul_f32 v211, v89, v105
v_mfma_f32_16x16x32_bf16 v[140:143], v[72:75], a[108:111], v[140:143]
v_exp_f32 v208, v208
v_mfma_f32_16x16x32_bf16 v[140:143], v[76:79], a[124:127], v[140:143]
v_fma_f32 v208, v208, v242, v242
s_waitcnt lgkmcnt(4)
v_mfma_f32_16x16x32_bf16 v[112:115], v[48:51], a[128:131], v[112:115]
v_exp_f32 v210, v210
v_mfma_f32_16x16x32_bf16 v[112:115], v[52:55], a[144:147], v[112:115]
v_fma_f32 v210, v210, v242, v242
v_mul_f32 v212, v90, v90
v_mfma_f32_16x16x32_bf16 v[116:119], v[48:51], a[132:135], v[116:119]
ds_read_b128 v[72:75], v7 offset:55296
v_mul_f32 v214, v91, v91
v_mfma_f32_16x16x32_bf16 v[116:119], v[52:55], a[148:151], v[116:119]
v_rcp_f32 v208, v208
v_mfma_f32_16x16x32_bf16 v[120:123], v[48:51], a[136:139], v[120:123]
v_rcp_f32 v210, v210
v_mfma_f32_16x16x32_bf16 v[120:123], v[52:55], a[152:155], v[120:123]
ds_read_b128 v[76:79], v7 offset:56320
v_mul_f32 v209, v209, v208
v_mfma_f32_16x16x32_bf16 v[124:127], v[48:51], a[140:143], v[124:127]
v_mul_f32 v211, v211, v210
v_cvt_pk_bf16_f32 v168, v209, v211
v_mfma_f32_16x16x32_bf16 v[124:127], v[52:55], a[156:159], v[124:127]
v_fma_f32 v212, v212, v241, v240
s_waitcnt lgkmcnt(4)
v_mfma_f32_16x16x32_bf16 v[128:131], v[56:59], a[128:131], v[128:131]
s_waitcnt vmcnt(23)
v_fma_f32 v214, v214, v241, v240
v_mfma_f32_16x16x32_bf16 v[128:131], v[60:63], a[144:147], v[128:131]
s_barrier
v_mfma_f32_16x16x32_bf16 v[132:135], v[56:59], a[132:135], v[132:135]
ds_read_b128 v[48:51], v7 offset:57344
s_add_u32 m0, s22, 73728
v_mfma_f32_16x16x32_bf16 v[132:135], v[60:63], a[148:151], v[132:135]
v_add_u32 v3, 20480, v3
buffer_load_dwordx4 v3, s[8:11], 0 offen offset:0 sc1 lds
v_mfma_f32_16x16x32_bf16 v[136:139], v[56:59], a[136:139], v[136:139]
v_mul_f32 v212, v212, v90
v_mul_f32 v214, v214, v91
v_mfma_f32_16x16x32_bf16 v[136:139], v[60:63], a[152:155], v[136:139]
ds_read_b128 v[52:55], v7 offset:58368
v_mul_f32 v213, v90, v106
v_mfma_f32_16x16x32_bf16 v[140:143], v[56:59], a[140:143], v[140:143]
v_exp_f32 v212, v212
v_mfma_f32_16x16x32_bf16 v[140:143], v[60:63], a[156:159], v[140:143]
v_mul_f32 v215, v91, v107
s_waitcnt lgkmcnt(4)
v_mfma_f32_16x16x32_bf16 v[112:115], v[64:67], a[160:163], v[112:115]
buffer_load_dwordx4 v3, s[8:11], 0 offen offset:1024 sc1 lds
v_mfma_f32_16x16x32_bf16 v[112:115], v[68:71], a[176:179], v[112:115]
v_exp_f32 v214, v214
v_mfma_f32_16x16x32_bf16 v[116:119], v[64:67], a[164:167], v[116:119]
ds_read_b128 v[56:59], v7 offset:59392
v_fma_f32 v212, v212, v242, v242
v_mfma_f32_16x16x32_bf16 v[116:119], v[68:71], a[180:183], v[116:119]
v_fma_f32 v214, v214, v242, v242
v_mul_f32 v208, v92, v92
v_mfma_f32_16x16x32_bf16 v[120:123], v[64:67], a[168:171], v[120:123]
v_rcp_f32 v212, v212
v_mfma_f32_16x16x32_bf16 v[120:123], v[68:71], a[184:187], v[120:123]
ds_read_b128 v[60:63], v7 offset:60416
v_mul_f32 v213, v213, v212
v_mfma_f32_16x16x32_bf16 v[124:127], v[64:67], a[172:175], v[124:127]
buffer_load_dwordx4 v3, s[8:11], 0 offen offset:2048 sc1 lds
v_mfma_f32_16x16x32_bf16 v[124:127], v[68:71], a[188:191], v[124:127]
v_mul_f32 v210, v93, v93
s_waitcnt lgkmcnt(4)
v_mfma_f32_16x16x32_bf16 v[128:131], v[72:75], a[160:163], v[128:131]
v_rcp_f32 v214, v214
v_mfma_f32_16x16x32_bf16 v[128:131], v[76:79], a[176:179], v[128:131]
v_mul_f32 v215, v215, v214
v_cvt_pk_bf16_f32 v169, v213, v215
v_mfma_f32_16x16x32_bf16 v[132:135], v[72:75], a[164:167], v[132:135]
ds_read_b128 v[64:67], v7 offset:61440
v_fma_f32 v208, v208, v245, v244
v_mfma_f32_16x16x32_bf16 v[132:135], v[76:79], a[180:183], v[132:135]
buffer_load_dwordx4 v3, s[8:11], 0 offen offset:3072 sc1 lds
v_mfma_f32_16x16x32_bf16 v[136:139], v[72:75], a[168:171], v[136:139]
s_add_u32 m0, s22, 77824
v_add_u32 v3, 4096, v3
v_mfma_f32_16x16x32_bf16 v[136:139], v[76:79], a[184:187], v[136:139]
ds_read_b128 v[68:71], v7 offset:62464
v_fma_f32 v210, v210, v245, v244
v_mfma_f32_16x16x32_bf16 v[140:143], v[72:75], a[172:175], v[140:143]
v_mul_f32 v208, v208, v92
v_mul_f32 v210, v210, v93
v_mfma_f32_16x16x32_bf16 v[140:143], v[76:79], a[188:191], v[140:143]
v_mul_f32 v209, v92, v108
s_waitcnt lgkmcnt(4)
v_mfma_f32_16x16x32_bf16 v[112:115], v[48:51], a[192:195], v[112:115]
buffer_load_dwordx4 v3, s[8:11], 0 offen offset:0 sc1 lds
v_mfma_f32_16x16x32_bf16 v[112:115], v[52:55], a[208:211], v[112:115]
v_exp_f32 v208, v208
v_mfma_f32_16x16x32_bf16 v[116:119], v[48:51], a[196:199], v[116:119]
ds_read_b128 v[72:75], v7 offset:63488
v_mul_f32 v211, v93, v109
v_mfma_f32_16x16x32_bf16 v[116:119], v[52:55], a[212:215], v[116:119]
v_exp_f32 v210, v210
v_mfma_f32_16x16x32_bf16 v[120:123], v[48:51], a[200:203], v[120:123]
v_fma_f32 v208, v208, v246, v246
v_fma_f32 v210, v210, v246, v246
v_mfma_f32_16x16x32_bf16 v[120:123], v[52:55], a[216:219], v[120:123]
ds_read_b128 v[76:79], v7 offset:64512
v_mul_f32 v212, v94, v94
v_mfma_f32_16x16x32_bf16 v[124:127], v[48:51], a[204:207], v[124:127]
buffer_load_dwordx4 v3, s[8:11], 0 offen offset:1024 sc1 lds
v_mfma_f32_16x16x32_bf16 v[124:127], v[52:55], a[220:223], v[124:127]
v_mul_f32 v214, v95, v95
s_waitcnt lgkmcnt(4)
v_mfma_f32_16x16x32_bf16 v[128:131], v[56:59], a[192:195], v[128:131]
v_rcp_f32 v208, v208
v_mfma_f32_16x16x32_bf16 v[128:131], v[60:63], a[208:211], v[128:131]
v_rcp_f32 v210, v210
v_mfma_f32_16x16x32_bf16 v[132:135], v[56:59], a[196:199], v[132:135]
ds_read_b128 v[48:51], v8 offset:0
v_mul_f32 v209, v209, v208
v_mfma_f32_16x16x32_bf16 v[132:135], v[60:63], a[212:215], v[132:135]
v_mul_f32 v211, v211, v210
v_cvt_pk_bf16_f32 v172, v209, v211
v_mfma_f32_16x16x32_bf16 v[136:139], v[56:59], a[200:203], v[136:139]
v_fma_f32 v212, v212, v245, v244
v_fma_f32 v214, v214, v245, v244
v_mfma_f32_16x16x32_bf16 v[136:139], v[60:63], a[216:219], v[136:139]
ds_read_b128 v[52:55], v8 offset:1024
v_mul_f32 v212, v212, v94
v_mfma_f32_16x16x32_bf16 v[140:143], v[56:59], a[204:207], v[140:143]
v_mul_f32 v214, v214, v95
v_mul_f32 v213, v94, v110
v_mfma_f32_16x16x32_bf16 v[140:143], v[60:63], a[220:223], v[140:143]
v_mul_f32 v215, v95, v111
s_waitcnt lgkmcnt(4)
v_mfma_f32_16x16x32_bf16 v[112:115], v[64:67], a[224:227], v[112:115]
v_exp_f32 v212, v212
v_mfma_f32_16x16x32_bf16 v[112:115], v[68:71], a[240:243], v[112:115]
v_exp_f32 v214, v214
v_mfma_f32_16x16x32_bf16 v[116:119], v[64:67], a[228:231], v[116:119]
ds_read_b128 v[56:59], v8 offset:2048
v_fma_f32 v212, v212, v246, v246
v_mfma_f32_16x16x32_bf16 v[116:119], v[68:71], a[244:247], v[116:119]
v_fma_f32 v214, v214, v246, v246
v_mul_f32 v222, v183, v183
v_mfma_f32_16x16x32_bf16 v[120:123], v[64:67], a[232:235], v[120:123]
v_rcp_f32 v212, v212
v_mfma_f32_16x16x32_bf16 v[120:123], v[68:71], a[248:251], v[120:123]
ds_read_b128 v[60:63], v8 offset:3072
v_mul_f32 v213, v213, v212
v_mfma_f32_16x16x32_bf16 v[124:127], v[64:67], a[236:239], v[124:127]
v_rcp_f32 v214, v214
v_mfma_f32_16x16x32_bf16 v[124:127], v[68:71], a[252:255], v[124:127]
v_mul_f32 v215, v215, v214
s_waitcnt lgkmcnt(4)
v_mfma_f32_16x16x32_bf16 v[128:131], v[72:75], a[224:227], v[128:131]
v_cvt_pk_bf16_f32 v173, v213, v215
v_fma_f32 v220, v220, v237, v236
v_mfma_f32_16x16x32_bf16 v[128:131], v[76:79], a[240:243], v[128:131]
v_rcp_f32 v218, v218
v_mfma_f32_16x16x32_bf16 v[132:135], v[72:75], a[228:231], v[132:135]
ds_read_b128 v[64:67], v8 offset:4096
v_mul_f32 v219, v219, v218
v_mfma_f32_16x16x32_bf16 v[132:135], v[76:79], a[244:247], v[132:135]
v_cvt_pk_bf16_f32 v150, v217, v219
v_fma_f32 v222, v222, v237, v236
v_mfma_f32_16x16x32_bf16 v[136:139], v[72:75], a[232:235], v[136:139]
v_mul_f32 v220, v220, v182
v_mul_f32 v222, v222, v183
v_mfma_f32_16x16x32_bf16 v[136:139], v[76:79], a[248:251], v[136:139]
ds_read_b128 v[68:71], v8 offset:5120
v_mul_f32 v221, v182, v198
v_mfma_f32_16x16x32_bf16 v[140:143], v[72:75], a[236:239], v[140:143]
v_exp_f32 v220, v220
v_mfma_f32_16x16x32_bf16 v[140:143], v[76:79], a[252:255], v[140:143]
v_mul_f32 v223, v183, v199
s_waitcnt lgkmcnt(4)
v_mfma_f32_16x16x32_bf16 v[112:115], v[48:51], v[16:19], v[112:115]
v_exp_f32 v222, v222
v_mfma_f32_16x16x32_bf16 v[112:115], v[52:55], v[32:35], v[112:115]
v_fma_f32 v220, v220, v238, v238
v_fma_f32 v222, v222, v238, v238
v_mfma_f32_16x16x32_bf16 v[116:119], v[48:51], v[20:23], v[116:119]
ds_read_b128 v[72:75], v8 offset:6144
v_mul_f32 v216, v184, v184
v_mfma_f32_16x16x32_bf16 v[116:119], v[52:55], v[36:39], v[116:119]
v_rcp_f32 v220, v220
v_mfma_f32_16x16x32_bf16 v[120:123], v[48:51], v[24:27], v[120:123]
v_rcp_f32 v222, v222
v_mfma_f32_16x16x32_bf16 v[120:123], v[52:55], v[40:43], v[120:123]
ds_read_b128 v[76:79], v8 offset:7168
v_mul_f32 v221, v221, v220
v_mfma_f32_16x16x32_bf16 v[124:127], v[48:51], v[28:31], v[124:127]
v_mul_f32 v223, v223, v222
v_cvt_pk_bf16_f32 v151, v221, v223
v_mfma_f32_16x16x32_bf16 v[124:127], v[52:55], v[44:47], v[124:127]
v_mul_f32 v218, v185, v185
s_waitcnt lgkmcnt(4)
v_mfma_f32_16x16x32_bf16 v[128:131], v[56:59], v[16:19], v[128:131]
buffer_store_dwordx4 v[148:151], v4, s[8:11], s24 offen offset:0 sc1
v_mfma_f32_16x16x32_bf16 v[128:131], v[60:63], v[32:35], v[128:131]
v_fma_f32 v216, v216, v241, v240
v_fma_f32 v218, v218, v241, v240
v_mfma_f32_16x16x32_bf16 v[132:135], v[56:59], v[20:23], v[132:135]
ds_read_b128 v[48:51], v8 offset:8192
v_mul_f32 v216, v216, v184
v_mfma_f32_16x16x32_bf16 v[132:135], v[60:63], v[36:39], v[132:135]
v_mul_f32 v218, v218, v185
v_mul_f32 v217, v184, v200
v_mfma_f32_16x16x32_bf16 v[136:139], v[56:59], v[24:27], v[136:139]
v_exp_f32 v216, v216
v_mfma_f32_16x16x32_bf16 v[136:139], v[60:63], v[40:43], v[136:139]
ds_read_b128 v[52:55], v8 offset:9216
v_mul_f32 v219, v185, v201
v_mfma_f32_16x16x32_bf16 v[140:143], v[56:59], v[28:31], v[140:143]
v_exp_f32 v218, v218
v_mfma_f32_16x16x32_bf16 v[140:143], v[60:63], v[44:47], v[140:143]
v_fma_f32 v216, v216, v242, v242
s_waitcnt lgkmcnt(4)
v_mfma_f32_16x16x32_bf16 v[80:83], v[64:67], a[0:3], 0
v_fma_f32 v218, v218, v242, v242
v_mul_f32 v220, v186, v186
v_mfma_f32_16x16x32_bf16 v[80:83], v[68:71], a[16:19], v[80:83]
v_rcp_f32 v216, v216
v_mfma_f32_16x16x32_bf16 v[84:87], v[64:67], a[4:7], 0
ds_read_b128 v[56:59], v8 offset:10240
v_mul_f32 v217, v217, v216
v_mfma_f32_16x16x32_bf16 v[84:87], v[68:71], a[20:23], v[84:87]
v_mul_f32 v208, v112, v112
v_mul_f32 v210, v113, v113
v_mfma_f32_16x16x32_bf16 v[88:91], v[64:67], a[8:11], 0
v_fma_f32 v208, v208, v233, v232
v_fma_f32 v210, v210, v233, v232
v_mfma_f32_16x16x32_bf16 v[88:91], v[68:71], a[24:27], v[88:91]
ds_read_b128 v[60:63], v8 offset:11264
v_mul_f32 v208, v208, v112
v_mfma_f32_16x16x32_bf16 v[92:95], v[64:67], a[12:15], 0
v_mul_f32 v210, v210, v113
v_mul_f32 v209, v112, v128
v_mfma_f32_16x16x32_bf16 v[92:95], v[68:71], a[28:31], v[92:95]
v_mul_f32 v211, v113, v129
s_waitcnt lgkmcnt(4)
v_mfma_f32_16x16x32_bf16 v[96:99], v[72:75], a[0:3], 0
v_exp_f32 v208, v208
v_mfma_f32_16x16x32_bf16 v[96:99], v[76:79], a[16:19], v[96:99]
v_exp_f32 v210, v210
v_mfma_f32_16x16x32_bf16 v[100:103], v[72:75], a[4:7], 0
ds_read_b128 v[64:67], v8 offset:12288
v_fma_f32 v208, v208, v234, v234
v_mfma_f32_16x16x32_bf16 v[100:103], v[76:79], a[20:23], v[100:103]
v_fma_f32 v210, v210, v234, v234
v_mul_f32 v212, v114, v114
v_mfma_f32_16x16x32_bf16 v[104:107], v[72:75], a[8:11], 0
v_rcp_f32 v208, v208
v_mfma_f32_16x16x32_bf16 v[104:107], v[76:79], a[24:27], v[104:107]
ds_read_b128 v[68:71], v8 offset:13312
v_mul_f32 v209, v209, v208
v_mfma_f32_16x16x32_bf16 v[108:111], v[72:75], a[12:15], 0
v_rcp_f32 v210, v210
v_mfma_f32_16x16x32_bf16 v[108:111], v[76:79], a[28:31], v[108:111]
v_mul_f32 v211, v211, v210
s_waitcnt lgkmcnt(4)
v_mfma_f32_16x16x32_bf16 v[80:83], v[48:51], a[32:35], v[80:83]
v_cvt_pk_bf16_f32 v162, v209, v211
v_mul_f32 v214, v115, v115
v_mfma_f32_16x16x32_bf16 v[80:83], v[52:55], a[48:51], v[80:83]
v_fma_f32 v212, v212, v233, v232
v_fma_f32 v214, v214, v233, v232
v_mfma_f32_16x16x32_bf16 v[84:87], v[48:51], a[36:39], v[84:87]
ds_read_b128 v[72:75], v8 offset:14336
v_mul_f32 v212, v212, v114
v_mfma_f32_16x16x32_bf16 v[84:87], v[52:55], a[52:55], v[84:87]
v_mul_f32 v214, v214, v115
v_mul_f32 v213, v114, v130
v_mfma_f32_16x16x32_bf16 v[88:91], v[48:51], a[40:43], v[88:91]
v_exp_f32 v212, v212
v_mfma_f32_16x16x32_bf16 v[88:91], v[52:55], a[56:59], v[88:91]
ds_read_b128 v[76:79], v8 offset:15360
v_mul_f32 v215, v115, v131
v_mfma_f32_16x16x32_bf16 v[92:95], v[48:51], a[44:47], v[92:95]
v_exp_f32 v214, v214
v_mfma_f32_16x16x32_bf16 v[92:95], v[52:55], a[60:63], v[92:95]
v_fma_f32 v212, v212, v234, v234
s_waitcnt lgkmcnt(4)
v_mfma_f32_16x16x32_bf16 v[96:99], v[56:59], a[32:35], v[96:99]
s_waitcnt vmcnt(22)
v_fma_f32 v214, v214, v234, v234
v_mfma_f32_16x16x32_bf16 v[96:99], v[60:63], a[48:51], v[96:99]
s_barrier
v_mfma_f32_16x16x32_bf16 v[100:103], v[56:59], a[36:39], v[100:103]
ds_read_b128 v[48:51], v2 offset:0
s_add_u32 m0, s22, 98304
v_mfma_f32_16x16x32_bf16 v[100:103], v[60:63], a[52:55], v[100:103]
v_add_u32 v3, 20480, v3
buffer_load_dwordx4 v3, s[8:11], 0 offen offset:0 sc1 lds
v_mfma_f32_16x16x32_bf16 v[104:107], v[56:59], a[40:43], v[104:107]
v_rcp_f32 v212, v212
v_mfma_f32_16x16x32_bf16 v[104:107], v[60:63], a[56:59], v[104:107]
ds_read_b128 v[52:55], v2 offset:1024
v_mul_f32 v213, v213, v212
v_mfma_f32_16x16x32_bf16 v[108:111], v[56:59], a[44:47], v[108:111]
v_rcp_f32 v214, v214
v_mfma_f32_16x16x32_bf16 v[108:111], v[60:63], a[60:63], v[108:111]
v_mul_f32 v215, v215, v214
s_waitcnt lgkmcnt(4)
v_mfma_f32_16x16x32_bf16 v[80:83], v[64:67], a[64:67], v[80:83]
buffer_load_dwordx4 v3, s[8:11], 0 offen offset:1024 sc1 lds
v_mfma_f32_16x16x32_bf16 v[80:83], v[68:71], a[80:83], v[80:83]
v_cvt_pk_bf16_f32 v163, v213, v215
v_mul_f32 v208, v116, v116
v_mfma_f32_16x16x32_bf16 v[84:87], v[64:67], a[68:71], v[84:87]
ds_read_b128 v[56:59], v2 offset:2048
v_mul_f32 v210, v117, v117
v_mfma_f32_16x16x32_bf16 v[84:87], v[68:71], a[84:87], v[84:87]
buffer_store_dwordx4 v[160:163], v2, s[8:11], s24 offen offset:1024 sc1
v_mfma_f32_16x16x32_bf16 v[88:91], v[64:67], a[72:75], v[88:91]
v_fma_f32 v208, v208, v237, v236
v_fma_f32 v210, v210, v237, v236
v_mfma_f32_16x16x32_bf16 v[88:91], v[68:71], a[88:91], v[88:91]
ds_read_b128 v[60:63], v2 offset:3072
v_mul_f32 v208, v208, v116
v_mfma_f32_16x16x32_bf16 v[92:95], v[64:67], a[76:79], v[92:95]
v_mul_f32 v210, v210, v117
v_mul_f32 v209, v116, v132
v_mfma_f32_16x16x32_bf16 v[92:95], v[68:71], a[92:95], v[92:95]
v_mul_f32 v211, v117, v133
s_waitcnt lgkmcnt(4)
v_mfma_f32_16x16x32_bf16 v[96:99], v[72:75], a[64:67], v[96:99]
buffer_load_dwordx4 v3, s[8:11], 0 offen offset:2048 sc1 lds
v_mfma_f32_16x16x32_bf16 v[96:99], v[76:79], a[80:83], v[96:99]
v_exp_f32 v208, v208
v_mfma_f32_16x16x32_bf16 v[100:103], v[72:75], a[68:71], v[100:103]
ds_read_b128 v[64:67], v2 offset:4096
v_fma_f32 v208, v208, v238, v238
v_mfma_f32_16x16x32_bf16 v[100:103], v[76:79], a[84:87], v[100:103]
v_exp_f32 v210, v210
v_mfma_f32_16x16x32_bf16 v[104:107], v[72:75], a[72:75], v[104:107]
v_fma_f32 v210, v210, v238, v238
v_mul_f32 v212, v118, v118
v_mfma_f32_16x16x32_bf16 v[104:107], v[76:79], a[88:91], v[104:107]
ds_read_b128 v[68:71], v2 offset:5120
v_mul_f32 v214, v119, v119
v_mfma_f32_16x16x32_bf16 v[108:111], v[72:75], a[76:79], v[108:111]
buffer_load_dwordx4 v3, s[8:11], 0 offen offset:3072 sc1 lds
v_mfma_f32_16x16x32_bf16 v[108:111], v[76:79], a[92:95], v[108:111]
s_add_u32 m0, s22, 102400
s_waitcnt lgkmcnt(4)
v_mfma_f32_16x16x32_bf16 v[80:83], v[48:51], a[96:99], v[80:83]
v_add_u32 v3, 4096, v3
v_fma_f32 v212, v212, v237, v236
v_mfma_f32_16x16x32_bf16 v[80:83], v[52:55], a[112:115], v[80:83]
v_rcp_f32 v208, v208
v_mfma_f32_16x16x32_bf16 v[84:87], v[48:51], a[100:103], v[84:87]
ds_read_b128 v[72:75], v2 offset:6144
v_mul_f32 v209, v209, v208
v_mfma_f32_16x16x32_bf16 v[84:87], v[52:55], a[116:119], v[84:87]
buffer_load_dwordx4 v3, s[8:11], 0 offen offset:0 sc1 lds
v_mfma_f32_16x16x32_bf16 v[88:91], v[48:51], a[104:107], v[88:91]
v_rcp_f32 v210, v210
v_mfma_f32_16x16x32_bf16 v[88:91], v[52:55], a[120:123], v[88:91]
ds_read_b128 v[76:79], v2 offset:7168
v_mul_f32 v211, v211, v210
v_mfma_f32_16x16x32_bf16 v[92:95], v[48:51], a[108:111], v[92:95]
v_cvt_pk_bf16_f32 v166, v209, v211
v_fma_f32 v214, v214, v237, v236
v_mfma_f32_16x16x32_bf16 v[92:95], v[52:55], a[124:127], v[92:95]
v_mul_f32 v212, v212, v118
s_waitcnt lgkmcnt(4)
v_mfma_f32_16x16x32_bf16 v[96:99], v[56:59], a[96:99], v[96:99]
buffer_load_dwordx4 v3, s[8:11], 0 offen offset:1024 sc1 lds
v_mfma_f32_16x16x32_bf16 v[96:99], v[60:63], a[112:115], v[96:99]
v_mul_f32 v214, v214, v119
v_mul_f32 v213, v118, v134
v_mfma_f32_16x16x32_bf16 v[100:103], v[56:59], a[100:103], v[100:103]
ds_read_b128 v[48:51], v2 offset:8192
v_mul_f32 v215, v119, v135
v_mfma_f32_16x16x32_bf16 v[100:103], v[60:63], a[116:119], v[100:103]
v_exp_f32 v212, v212
v_mfma_f32_16x16x32_bf16 v[104:107], v[56:59], a[104:107], v[104:107]
v_exp_f32 v214, v214
v_mfma_f32_16x16x32_bf16 v[104:107], v[60:63], a[120:123], v[104:107]
ds_read_b128 v[52:55], v2 offset:9216
v_fma_f32 v212, v212, v238, v238
v_mfma_f32_16x16x32_bf16 v[108:111], v[56:59], a[108:111], v[108:111]
v_fma_f32 v214, v214, v238, v238
v_mul_f32 v208, v120, v120
v_mfma_f32_16x16x32_bf16 v[108:111], v[60:63], a[124:127], v[108:111]
v_mul_f32 v210, v121, v121
s_waitcnt lgkmcnt(4)
v_mfma_f32_16x16x32_bf16 v[80:83], v[64:67], a[128:131], v[80:83]
v_rcp_f32 v212, v212
v_mfma_f32_16x16x32_bf16 v[80:83], v[68:71], a[144:147], v[80:83]
v_rcp_f32 v214, v214
v_mfma_f32_16x16x32_bf16 v[84:87], v[64:67], a[132:135], v[84:87]
ds_read_b128 v[56:59], v2 offset:10240
v_mul_f32 v213, v213, v212
v_mfma_f32_16x16x32_bf16 v[84:87], v[68:71], a[148:151], v[84:87]
v_mul_f32 v215, v215, v214
v_cvt_pk_bf16_f32 v167, v213, v215
v_mfma_f32_16x16x32_bf16 v[88:91], v[64:67], a[136:139], v[88:91]
buffer_store_dwordx4 v[164:167], v4, s[8:11], s24 offen offset:1024 sc1
v_mfma_f32_16x16x32_bf16 v[88:91], v[68:71], a[152:155], v[88:91]
ds_read_b128 v[60:63], v2 offset:11264
v_fma_f32 v208, v208, v241, v240
v_mfma_f32_16x16x32_bf16 v[92:95], v[64:67], a[140:143], v[92:95]
v_fma_f32 v210, v210, v241, v240
v_mul_f32 v208, v208, v120
v_mfma_f32_16x16x32_bf16 v[92:95], v[68:71], a[156:159], v[92:95]
v_mul_f32 v210, v210, v121
s_waitcnt lgkmcnt(4)
v_mfma_f32_16x16x32_bf16 v[96:99], v[72:75], a[128:131], v[96:99]
v_exp_f32 v208, v208
v_mfma_f32_16x16x32_bf16 v[96:99], v[76:79], a[144:147], v[96:99]
v_exp_f32 v210, v210
v_mfma_f32_16x16x32_bf16 v[100:103], v[72:75], a[132:135], v[100:103]
ds_read_b128 v[64:67], v2 offset:12288
v_mul_f32 v209, v120, v136
v_mfma_f32_16x16x32_bf16 v[100:103], v[76:79], a[148:151], v[100:103]
v_mul_f32 v211, v121, v137
v_fma_f32 v208, v208, v242, v242
v_mfma_f32_16x16x32_bf16 v[104:107], v[72:75], a[136:139], v[104:107]
v_fma_f32 v210, v210, v242, v242
v_mul_f32 v212, v122, v122
v_mfma_f32_16x16x32_bf16 v[104:107], v[76:79], a[152:155], v[104:107]
ds_read_b128 v[68:71], v2 offset:13312
v_mul_f32 v214, v123, v123
v_mfma_f32_16x16x32_bf16 v[108:111], v[72:75], a[140:143], v[108:111]
v_rcp_f32 v208, v208
v_mfma_f32_16x16x32_bf16 v[108:111], v[76:79], a[156:159], v[108:111]
v_mul_f32 v209, v209, v208
s_waitcnt lgkmcnt(4)
v_mfma_f32_16x16x32_bf16 v[80:83], v[48:51], a[160:163], v[80:83]
v_rcp_f32 v210, v210
v_mfma_f32_16x16x32_bf16 v[80:83], v[52:55], a[176:179], v[80:83]
v_mul_f32 v211, v211, v210
v_cvt_pk_bf16_f32 v170, v209, v211
v_mfma_f32_16x16x32_bf16 v[84:87], v[48:51], a[164:167], v[84:87]
ds_read_b128 v[72:75], v2 offset:14336
v_fma_f32 v212, v212, v241, v240
v_mfma_f32_16x16x32_bf16 v[84:87], v[52:55], a[180:183], v[84:87]
v_fma_f32 v214, v214, v241, v240
v_mul_f32 v212, v212, v122
v_mfma_f32_16x16x32_bf16 v[88:91], v[48:51], a[168:171], v[88:91]
v_mul_f32 v214, v214, v123
v_mul_f32 v213, v122, v138
v_mfma_f32_16x16x32_bf16 v[88:91], v[52:55], a[184:187], v[88:91]
ds_read_b128 v[76:79], v2 offset:15360
v_mul_f32 v215, v123, v139
v_mfma_f32_16x16x32_bf16 v[92:95], v[48:51], a[172:175], v[92:95]
v_exp_f32 v212, v212
v_mfma_f32_16x16x32_bf16 v[92:95], v[52:55], a[188:191], v[92:95]
v_fma_f32 v212, v212, v242, v242
s_waitcnt lgkmcnt(4)
v_mfma_f32_16x16x32_bf16 v[96:99], v[56:59], a[160:163], v[96:99]
v_exp_f32 v214, v214
v_mfma_f32_16x16x32_bf16 v[96:99], v[60:63], a[176:179], v[96:99]
v_fma_f32 v214, v214, v242, v242
v_mul_f32 v208, v124, v124
v_mfma_f32_16x16x32_bf16 v[100:103], v[56:59], a[164:167], v[100:103]
ds_read_b128 v[48:51], v2 offset:16384
v_mul_f32 v210, v125, v125
v_mfma_f32_16x16x32_bf16 v[100:103], v[60:63], a[180:183], v[100:103]
v_rcp_f32 v212, v212
v_mfma_f32_16x16x32_bf16 v[104:107], v[56:59], a[168:171], v[104:107]
v_rcp_f32 v214, v214
v_mfma_f32_16x16x32_bf16 v[104:107], v[60:63], a[184:187], v[104:107]
ds_read_b128 v[52:55], v2 offset:17408
v_mul_f32 v213, v213, v212
v_mfma_f32_16x16x32_bf16 v[108:111], v[56:59], a[172:175], v[108:111]
v_mul_f32 v215, v215, v214
v_cvt_pk_bf16_f32 v171, v213, v215
v_mfma_f32_16x16x32_bf16 v[108:111], v[60:63], a[188:191], v[108:111]
v_fma_f32 v208, v208, v245, v244
s_waitcnt lgkmcnt(4)
v_mfma_f32_16x16x32_bf16 v[80:83], v[64:67], a[192:195], v[80:83]
buffer_store_dwordx4 v[168:171], v5, s[8:11], s24 offen offset:1024 sc1
v_mfma_f32_16x16x32_bf16 v[80:83], v[68:71], a[208:211], v[80:83]
v_fma_f32 v210, v210, v245, v244
v_mul_f32 v208, v208, v124
v_mfma_f32_16x16x32_bf16 v[84:87], v[64:67], a[196:199], v[84:87]
ds_read_b128 v[56:59], v2 offset:18432
v_mul_f32 v210, v210, v125
v_mfma_f32_16x16x32_bf16 v[84:87], v[68:71], a[212:215], v[84:87]
v_exp_f32 v208, v208
v_mfma_f32_16x16x32_bf16 v[88:91], v[64:67], a[200:203], v[88:91]
v_exp_f32 v210, v210
v_mfma_f32_16x16x32_bf16 v[88:91], v[68:71], a[216:219], v[88:91]
ds_read_b128 v[60:63], v2 offset:19456
v_mul_f32 v209, v124, v140
v_mfma_f32_16x16x32_bf16 v[92:95], v[64:67], a[204:207], v[92:95]
v_mul_f32 v211, v125, v141
v_fma_f32 v208, v208, v246, v246
v_mfma_f32_16x16x32_bf16 v[92:95], v[68:71], a[220:223], v[92:95]
v_fma_f32 v210, v210, v246, v246
s_waitcnt lgkmcnt(4)
v_mfma_f32_16x16x32_bf16 v[96:99], v[72:75], a[192:195], v[96:99]
v_rcp_f32 v208, v208
v_mfma_f32_16x16x32_bf16 v[96:99], v[76:79], a[208:211], v[96:99]
v_rcp_f32 v210, v210
v_mfma_f32_16x16x32_bf16 v[100:103], v[72:75], a[196:199], v[100:103]
ds_read_b128 v[64:67], v2 offset:20480
v_mul_f32 v209, v209, v208
v_mfma_f32_16x16x32_bf16 v[100:103], v[76:79], a[212:215], v[100:103]
v_mul_f32 v211, v211, v210
v_cvt_pk_bf16_f32 v174, v209, v211
v_mfma_f32_16x16x32_bf16 v[104:107], v[72:75], a[200:203], v[104:107]
v_mul_f32 v212, v126, v126
v_mul_f32 v214, v127, v127
v_mfma_f32_16x16x32_bf16 v[104:107], v[76:79], a[216:219], v[104:107]
ds_read_b128 v[68:71], v2 offset:21504
v_fma_f32 v212, v212, v245, v244
v_mfma_f32_16x16x32_bf16 v[108:111], v[72:75], a[204:207], v[108:111]
v_fma_f32 v214, v214, v245, v244
v_mul_f32 v212, v212, v126
v_mfma_f32_16x16x32_bf16 v[108:111], v[76:79], a[220:223], v[108:111]
v_mul_f32 v214, v214, v127
s_waitcnt lgkmcnt(4)
v_mfma_f32_16x16x32_bf16 v[80:83], v[48:51], a[224:227], v[80:83]
v_exp_f32 v212, v212
v_mfma_f32_16x16x32_bf16 v[80:83], v[52:55], a[240:243], v[80:83]
v_exp_f32 v214, v214
v_mfma_f32_16x16x32_bf16 v[84:87], v[48:51], a[228:231], v[84:87]
ds_read_b128 v[72:75], v2 offset:22528
v_mul_f32 v213, v126, v142
v_mfma_f32_16x16x32_bf16 v[84:87], v[52:55], a[244:247], v[84:87]
v_mul_f32 v215, v127, v143
v_fma_f32 v212, v212, v246, v246
v_mfma_f32_16x16x32_bf16 v[88:91], v[48:51], a[232:235], v[88:91]
v_fma_f32 v214, v214, v246, v246
v_mul_f32 v222, v187, v187
v_mfma_f32_16x16x32_bf16 v[88:91], v[52:55], a[248:251], v[88:91]
ds_read_b128 v[76:79], v2 offset:23552
v_fma_f32 v220, v220, v241, v240
v_mfma_f32_16x16x32_bf16 v[92:95], v[48:51], a[236:239], v[92:95]
v_rcp_f32 v212, v212
v_mfma_f32_16x16x32_bf16 v[92:95], v[52:55], a[252:255], v[92:95]
v_mul_f32 v213, v213, v212
s_waitcnt lgkmcnt(4)
v_mfma_f32_16x16x32_bf16 v[96:99], v[56:59], a[224:227], v[96:99]
s_waitcnt vmcnt(23)
v_fma_f32 v222, v222, v241, v240
v_mfma_f32_16x16x32_bf16 v[96:99], v[60:63], a[240:243], v[96:99]
s_barrier
v_mfma_f32_16x16x32_bf16 v[100:103], v[56:59], a[228:231], v[100:103]
ds_read_b128 v[48:51], v2 offset:24576
s_add_u32 m0, s22, 122880
v_mfma_f32_16x16x32_bf16 v[100:103], v[60:63], a[244:247], v[100:103]
v_add_u32 v3, 20480, v3
buffer_load_dwordx4 v3, s[8:11], 0 offen offset:0 sc1 lds
v_mfma_f32_16x16x32_bf16 v[104:107], v[56:59], a[232:235], v[104:107]
v_rcp_f32 v214, v214
v_mfma_f32_16x16x32_bf16 v[104:107], v[60:63], a[248:251], v[104:107]
ds_read_b128 v[52:55], v2 offset:25600
v_mul_f32 v215, v215, v214
v_mfma_f32_16x16x32_bf16 v[108:111], v[56:59], a[236:239], v[108:111]
v_cvt_pk_bf16_f32 v175, v213, v215
v_mul_f32 v220, v220, v186
v_mfma_f32_16x16x32_bf16 v[108:111], v[60:63], a[252:255], v[108:111]
v_mul_f32 v222, v222, v187
s_waitcnt lgkmcnt(4)
v_mfma_f32_16x16x32_bf16 v[80:83], v[64:67], v[16:19], v[80:83]
buffer_load_dwordx4 v3, s[8:11], 0 offen offset:1024 sc1 lds
v_mfma_f32_16x16x32_bf16 v[80:83], v[68:71], v[32:35], v[80:83]
v_rcp_f32 v218, v218
v_mfma_f32_16x16x32_bf16 v[84:87], v[64:67], v[20:23], v[84:87]
ds_read_b128 v[56:59], v2 offset:26624
v_mul_f32 v219, v219, v218
v_mfma_f32_16x16x32_bf16 v[84:87], v[68:71], v[36:39], v[84:87]
buffer_store_dwordx4 v[172:175], v6, s[8:11], s24 offen offset:1024 sc1
v_mfma_f32_16x16x32_bf16 v[88:91], v[64:67], v[24:27], v[88:91]
v_cvt_pk_bf16_f32 v154, v217, v219
v_mul_f32 v221, v186, v202
v_mfma_f32_16x16x32_bf16 v[88:91], v[68:71], v[40:43], v[88:91]
ds_read_b128 v[60:63], v2 offset:27648
v_mul_f32 v223, v187, v203
v_mfma_f32_16x16x32_bf16 v[92:95], v[64:67], v[28:31], v[92:95]
v_exp_f32 v220, v220
v_mfma_f32_16x16x32_bf16 v[92:95], v[68:71], v[44:47], v[92:95]
v_fma_f32 v220, v220, v242, v242
s_waitcnt lgkmcnt(4)
v_mfma_f32_16x16x32_bf16 v[96:99], v[72:75], v[16:19], v[96:99]
buffer_load_dwordx4 v3, s[8:11], 0 offen offset:2048 sc1 lds
v_mfma_f32_16x16x32_bf16 v[96:99], v[76:79], v[32:35], v[96:99]
v_exp_f32 v222, v222
v_mfma_f32_16x16x32_bf16 v[100:103], v[72:75], v[20:23], v[100:103]
ds_read_b128 v[64:67], v2 offset:28672
v_fma_f32 v222, v222, v242, v242
v_mfma_f32_16x16x32_bf16 v[100:103], v[76:79], v[36:39], v[100:103]
v_rcp_f32 v220, v220
v_mfma_f32_16x16x32_bf16 v[104:107], v[72:75], v[24:27], v[104:107]
v_rcp_f32 v222, v222
v_mfma_f32_16x16x32_bf16 v[104:107], v[76:79], v[40:43], v[104:107]
ds_read_b128 v[68:71], v2 offset:29696
v_mul_f32 v221, v221, v220
v_mfma_f32_16x16x32_bf16 v[108:111], v[72:75], v[28:31], v[108:111]
buffer_load_dwordx4 v3, s[8:11], 0 offen offset:3072 sc1 lds
v_mfma_f32_16x16x32_bf16 v[108:111], v[76:79], v[44:47], v[108:111]
s_add_u32 m0, s22, 126976
s_waitcnt lgkmcnt(4)
v_mfma_f32_16x16x32_bf16 v[112:115], v[48:51], a[0:3], 0
v_add_u32 v3, 4096, v3
v_mul_f32 v223, v223, v222
v_mfma_f32_16x16x32_bf16 v[112:115], v[52:55], a[16:19], v[112:115]
v_cvt_pk_bf16_f32 v155, v221, v223
v_mul_f32 v216, v188, v188
v_mfma_f32_16x16x32_bf16 v[116:119], v[48:51], a[4:7], 0
ds_read_b128 v[72:75], v2 offset:30720
v_mul_f32 v218, v189, v189
v_mfma_f32_16x16x32_bf16 v[116:119], v[52:55], a[20:23], v[116:119]
buffer_load_dwordx4 v3, s[8:11], 0 offen offset:0 sc1 lds
v_mfma_f32_16x16x32_bf16 v[120:123], v[48:51], a[8:11], 0
v_fma_f32 v216, v216, v245, v244
v_fma_f32 v218, v218, v245, v244
v_mfma_f32_16x16x32_bf16 v[120:123], v[52:55], a[24:27], v[120:123]
ds_read_b128 v[76:79], v2 offset:31744
v_mul_f32 v216, v216, v188
v_mfma_f32_16x16x32_bf16 v[124:127], v[48:51], a[12:15], 0
buffer_store_dwordx4 v[152:155], v5, s[8:11], s24 offen offset:0 sc1
v_mfma_f32_16x16x32_bf16 v[124:127], v[52:55], a[28:31], v[124:127]
v_mul_f32 v218, v218, v189
s_waitcnt lgkmcnt(4)
v_mfma_f32_16x16x32_bf16 v[128:131], v[56:59], a[0:3], 0
v_exp_f32 v216, v216
v_mfma_f32_16x16x32_bf16 v[128:131], v[60:63], a[16:19], v[128:131]
v_exp_f32 v218, v218
v_mfma_f32_16x16x32_bf16 v[132:135], v[56:59], a[4:7], 0
ds_read_b128 v[48:51], v2 offset:32768
v_mul_f32 v217, v188, v204
v_mfma_f32_16x16x32_bf16 v[132:135], v[60:63], a[20:23], v[132:135]
buffer_load_dwordx4 v3, s[8:11], 0 offen offset:1024 sc1 lds
v_mfma_f32_16x16x32_bf16 v[136:139], v[56:59], a[8:11], 0
v_mul_f32 v219, v189, v205
v_fma_f32 v216, v216, v246, v246
v_mfma_f32_16x16x32_bf16 v[136:139], v[60:63], a[24:27], v[136:139]
ds_read_b128 v[52:55], v2 offset:33792
v_fma_f32 v218, v218, v246, v246
v_mfma_f32_16x16x32_bf16 v[140:143], v[56:59], a[12:15], 0
v_rcp_f32 v216, v216
v_mfma_f32_16x16x32_bf16 v[140:143], v[60:63], a[28:31], v[140:143]
v_mul_f32 v217, v217, v216
s_waitcnt lgkmcnt(4)
v_mfma_f32_16x16x32_bf16 v[112:115], v[64:67], a[32:35], v[112:115]
v_rcp_f32 v218, v218
v_mfma_f32_16x16x32_bf16 v[112:115], v[68:71], a[48:51], v[112:115]
v_mul_f32 v219, v219, v218
v_cvt_pk_bf16_f32 v158, v217, v219
v_mfma_f32_16x16x32_bf16 v[116:119], v[64:67], a[36:39], v[116:119]
ds_read_b128 v[56:59], v2 offset:34816
v_mul_f32 v220, v190, v190
v_mfma_f32_16x16x32_bf16 v[116:119], v[68:71], a[52:55], v[116:119]
v_mul_f32 v222, v191, v191
v_fma_f32 v220, v220, v245, v244
v_mfma_f32_16x16x32_bf16 v[120:123], v[64:67], a[40:43], v[120:123]
v_fma_f32 v222, v222, v245, v244
v_mul_f32 v220, v220, v190
v_mfma_f32_16x16x32_bf16 v[120:123], v[68:71], a[56:59], v[120:123]
ds_read_b128 v[60:63], v2 offset:35840
v_mul_f32 v222, v222, v191
v_mfma_f32_16x16x32_bf16 v[124:127], v[64:67], a[44:47], v[124:127]
v_exp_f32 v220, v220
v_mfma_f32_16x16x32_bf16 v[124:127], v[68:71], a[60:63], v[124:127]
v_mul_f32 v221, v190, v206
s_waitcnt lgkmcnt(4)
v_mfma_f32_16x16x32_bf16 v[128:131], v[72:75], a[32:35], v[128:131]
v_exp_f32 v222, v222
v_mfma_f32_16x16x32_bf16 v[128:131], v[76:79], a[48:51], v[128:131]
v_mul_f32 v223, v191, v207
v_fma_f32 v220, v220, v246, v246
v_mfma_f32_16x16x32_bf16 v[132:135], v[72:75], a[36:39], v[132:135]
ds_read_b128 v[64:67], v2 offset:36864
v_fma_f32 v222, v222, v246, v246
v_mfma_f32_16x16x32_bf16 v[132:135], v[76:79], a[52:55], v[132:135]
v_rcp_f32 v220, v220
v_mfma_f32_16x16x32_bf16 v[136:139], v[72:75], a[40:43], v[136:139]
v_rcp_f32 v222, v222
v_mfma_f32_16x16x32_bf16 v[136:139], v[76:79], a[56:59], v[136:139]
ds_read_b128 v[68:71], v2 offset:37888
v_mul_f32 v221, v221, v220
v_mfma_f32_16x16x32_bf16 v[140:143], v[72:75], a[44:47], v[140:143]
v_mul_f32 v223, v223, v222
v_cvt_pk_bf16_f32 v159, v221, v223
v_mfma_f32_16x16x32_bf16 v[140:143], v[76:79], a[60:63], v[140:143]
s_waitcnt lgkmcnt(4)
v_mfma_f32_16x16x32_bf16 v[112:115], v[48:51], a[64:67], v[112:115]
buffer_store_dwordx4 v[156:159], v6, s[8:11], s24 offen offset:0 sc1
v_mfma_f32_16x16x32_bf16 v[112:115], v[52:55], a[80:83], v[112:115]
v_mul_f32 v208, v80, v80
v_mul_f32 v210, v81, v81
v_mfma_f32_16x16x32_bf16 v[116:119], v[48:51], a[68:71], v[116:119]
ds_read_b128 v[72:75], v2 offset:38912
v_fma_f32 v208, v208, v233, v232
v_mfma_f32_16x16x32_bf16 v[116:119], v[52:55], a[84:87], v[116:119]
v_fma_f32 v210, v210, v233, v232
v_mul_f32 v208, v208, v80
v_mfma_f32_16x16x32_bf16 v[120:123], v[48:51], a[72:75], v[120:123]
v_mul_f32 v210, v210, v81
v_mul_f32 v209, v80, v96
v_mfma_f32_16x16x32_bf16 v[120:123], v[52:55], a[88:91], v[120:123]
ds_read_b128 v[76:79], v2 offset:39936
v_mul_f32 v211, v81, v97
v_mfma_f32_16x16x32_bf16 v[124:127], v[48:51], a[76:79], v[124:127]
v_exp_f32 v208, v208
v_mfma_f32_16x16x32_bf16 v[124:127], v[52:55], a[92:95], v[124:127]
v_fma_f32 v208, v208, v234, v234
s_waitcnt lgkmcnt(4)
v_mfma_f32_16x16x32_bf16 v[128:131], v[56:59], a[64:67], v[128:131]
v_exp_f32 v210, v210
v_mfma_f32_16x16x32_bf16 v[128:131], v[60:63], a[80:83], v[128:131]
v_fma_f32 v210, v210, v234, v234
v_mul_f32 v212, v82, v82
v_mfma_f32_16x16x32_bf16 v[132:135], v[56:59], a[68:71], v[132:135]
ds_read_b128 v[48:51], v2 offset:40960
v_mul_f32 v214, v83, v83
v_mfma_f32_16x16x32_bf16 v[132:135], v[60:63], a[84:87], v[132:135]
v_rcp_f32 v208, v208
v_mfma_f32_16x16x32_bf16 v[136:139], v[56:59], a[72:75], v[136:139]
v_rcp_f32 v210, v210
v_mfma_f32_16x16x32_bf16 v[136:139], v[60:63], a[88:91], v[136:139]
ds_read_b128 v[52:55], v2 offset:41984
v_mul_f32 v209, v209, v208
v_mfma_f32_16x16x32_bf16 v[140:143], v[56:59], a[76:79], v[140:143]
v_mul_f32 v211, v211, v210
v_cvt_pk_bf16_f32 v176, v209, v211
v_mfma_f32_16x16x32_bf16 v[140:143], v[60:63], a[92:95], v[140:143]
v_fma_f32 v212, v212, v233, v232
s_waitcnt lgkmcnt(4)
v_mfma_f32_16x16x32_bf16 v[112:115], v[64:67], a[96:99], v[112:115]
v_fma_f32 v214, v214, v233, v232
v_mul_f32 v212, v212, v82
v_mfma_f32_16x16x32_bf16 v[112:115], v[68:71], a[112:115], v[112:115]
v_mul_f32 v214, v214, v83
v_mul_f32 v213, v82, v98
v_mfma_f32_16x16x32_bf16 v[116:119], v[64:67], a[100:103], v[116:119]
ds_read_b128 v[56:59], v2 offset:43008
v_mul_f32 v215, v83, v99
v_mfma_f32_16x16x32_bf16 v[116:119], v[68:71], a[116:119], v[116:119]
v_exp_f32 v212, v212
v_mfma_f32_16x16x32_bf16 v[120:123], v[64:67], a[104:107], v[120:123]
v_exp_f32 v214, v214
v_mfma_f32_16x16x32_bf16 v[120:123], v[68:71], a[120:123], v[120:123]
ds_read_b128 v[60:63], v2 offset:44032
v_fma_f32 v212, v212, v234, v234
v_mfma_f32_16x16x32_bf16 v[124:127], v[64:67], a[108:111], v[124:127]
v_fma_f32 v214, v214, v234, v234
v_mul_f32 v208, v84, v84
v_mfma_f32_16x16x32_bf16 v[124:127], v[68:71], a[124:127], v[124:127]
v_mul_f32 v210, v85, v85
s_waitcnt lgkmcnt(4)
v_mfma_f32_16x16x32_bf16 v[128:131], v[72:75], a[96:99], v[128:131]
v_rcp_f32 v212, v212
v_mfma_f32_16x16x32_bf16 v[128:131], v[76:79], a[112:115], v[128:131]
v_rcp_f32 v214, v214
v_mfma_f32_16x16x32_bf16 v[132:135], v[72:75], a[100:103], v[132:135]
ds_read_b128 v[64:67], v2 offset:45056
v_mul_f32 v213, v213, v212
v_mfma_f32_16x16x32_bf16 v[132:135], v[76:79], a[116:119], v[132:135]
v_mul_f32 v215, v215, v214
v_cvt_pk_bf16_f32 v177, v213, v215
v_mfma_f32_16x16x32_bf16 v[136:139], v[72:75], a[104:107], v[136:139]
v_fma_f32 v208, v208, v237, v236
v_fma_f32 v210, v210, v237, v236
v_mfma_f32_16x16x32_bf16 v[136:139], v[76:79], a[120:123], v[136:139]
ds_read_b128 v[68:71], v2 offset:46080
v_mul_f32 v208, v208, v84
v_mfma_f32_16x16x32_bf16 v[140:143], v[72:75], a[108:111], v[140:143]
v_mul_f32 v210, v210, v85
v_mul_f32 v209, v84, v100
v_mfma_f32_16x16x32_bf16 v[140:143], v[76:79], a[124:127], v[140:143]
v_mul_f32 v211, v85, v101
s_waitcnt lgkmcnt(4)
v_mfma_f32_16x16x32_bf16 v[112:115], v[48:51], a[128:131], v[112:115]
v_exp_f32 v208, v208
v_mfma_f32_16x16x32_bf16 v[112:115], v[52:55], a[144:147], v[112:115]
v_exp_f32 v210, v210
v_mfma_f32_16x16x32_bf16 v[116:119], v[48:51], a[132:135], v[116:119]
ds_read_b128 v[72:75], v2 offset:47104
v_fma_f32 v208, v208, v238, v238
v_mfma_f32_16x16x32_bf16 v[116:119], v[52:55], a[148:151], v[116:119]
v_fma_f32 v210, v210, v238, v238
v_mul_f32 v212, v86, v86
v_mfma_f32_16x16x32_bf16 v[120:123], v[48:51], a[136:139], v[120:123]
v_rcp_f32 v208, v208
v_mfma_f32_16x16x32_bf16 v[120:123], v[52:55], a[152:155], v[120:123]
ds_read_b128 v[76:79], v2 offset:48128
v_mul_f32 v209, v209, v208
v_mfma_f32_16x16x32_bf16 v[124:127], v[48:51], a[140:143], v[124:127]
v_rcp_f32 v210, v210
v_mfma_f32_16x16x32_bf16 v[124:127], v[52:55], a[156:159], v[124:127]
v_mul_f32 v211, v211, v210
s_waitcnt lgkmcnt(4)
v_mfma_f32_16x16x32_bf16 v[128:131], v[56:59], a[128:131], v[128:131]
s_waitcnt vmcnt(25)
v_cvt_pk_bf16_f32 v180, v209, v211
v_mfma_f32_16x16x32_bf16 v[128:131], v[60:63], a[144:147], v[128:131]
s_barrier
v_mfma_f32_16x16x32_bf16 v[132:135], v[56:59], a[132:135], v[132:135]
ds_read_b128 v[48:51], v2 offset:49152
s_add_u32 m0, s22, 0
v_mfma_f32_16x16x32_bf16 v[132:135], v[60:63], a[148:151], v[132:135]
v_add_u32 v3, 20480, v3
buffer_load_dwordx4 v3, s[8:11], 0 offen offset:0 sc1 lds
v_mfma_f32_16x16x32_bf16 v[136:139], v[56:59], a[136:139], v[136:139]
v_mul_f32 v214, v87, v87
v_fma_f32 v212, v212, v237, v236
v_mfma_f32_16x16x32_bf16 v[136:139], v[60:63], a[152:155], v[136:139]
ds_read_b128 v[52:55], v2 offset:50176
v_fma_f32 v214, v214, v237, v236
v_mfma_f32_16x16x32_bf16 v[140:143], v[56:59], a[140:143], v[140:143]
v_mul_f32 v212, v212, v86
v_mul_f32 v214, v214, v87
v_mfma_f32_16x16x32_bf16 v[140:143], v[60:63], a[156:159], v[140:143]
v_mul_f32 v213, v86, v102
s_waitcnt lgkmcnt(4)
v_mfma_f32_16x16x32_bf16 v[112:115], v[64:67], a[160:163], v[112:115]
buffer_load_dwordx4 v3, s[8:11], 0 offen offset:1024 sc1 lds
v_mfma_f32_16x16x32_bf16 v[112:115], v[68:71], a[176:179], v[112:115]
v_exp_f32 v212, v212
v_mfma_f32_16x16x32_bf16 v[116:119], v[64:67], a[164:167], v[116:119]
ds_read_b128 v[56:59], v2 offset:51200
v_mul_f32 v215, v87, v103
v_mfma_f32_16x16x32_bf16 v[116:119], v[68:71], a[180:183], v[116:119]
v_exp_f32 v214, v214
v_mfma_f32_16x16x32_bf16 v[120:123], v[64:67], a[168:171], v[120:123]
v_fma_f32 v212, v212, v238, v238
v_fma_f32 v214, v214, v238, v238
v_mfma_f32_16x16x32_bf16 v[120:123], v[68:71], a[184:187], v[120:123]
ds_read_b128 v[60:63], v2 offset:52224
v_mul_f32 v208, v88, v88
v_mfma_f32_16x16x32_bf16 v[124:127], v[64:67], a[172:175], v[124:127]
buffer_load_dwordx4 v3, s[8:11], 0 offen offset:2048 sc1 lds
v_mfma_f32_16x16x32_bf16 v[124:127], v[68:71], a[188:191], v[124:127]
v_mul_f32 v210, v89, v89
s_waitcnt lgkmcnt(4)
v_mfma_f32_16x16x32_bf16 v[128:131], v[72:75], a[160:163], v[128:131]
v_rcp_f32 v212, v212
v_mfma_f32_16x16x32_bf16 v[128:131], v[76:79], a[176:179], v[128:131]
v_rcp_f32 v214, v214
v_mfma_f32_16x16x32_bf16 v[132:135], v[72:75], a[164:167], v[132:135]
ds_read_b128 v[64:67], v2 offset:53248
v_mul_f32 v213, v213, v212
v_mfma_f32_16x16x32_bf16 v[132:135], v[76:79], a[180:183], v[132:135]
buffer_load_dwordx4 v3, s[8:11], 0 offen offset:3072 sc1 lds
v_mfma_f32_16x16x32_bf16 v[136:139], v[72:75], a[168:171], v[136:139]
s_add_u32 m0, s22, 4096
v_add_u32 v3, 4096, v3
v_mfma_f32_16x16x32_bf16 v[136:139], v[76:79], a[184:187], v[136:139]
ds_read_b128 v[68:71], v2 offset:54272
v_mul_f32 v215, v215, v214
v_mfma_f32_16x16x32_bf16 v[140:143], v[72:75], a[172:175], v[140:143]
v_cvt_pk_bf16_f32 v181, v213, v215
v_fma_f32 v208, v208, v241, v240
v_mfma_f32_16x16x32_bf16 v[140:143], v[76:79], a[188:191], v[140:143]
v_fma_f32 v210, v210, v241, v240
s_waitcnt lgkmcnt(4)
v_mfma_f32_16x16x32_bf16 v[112:115], v[48:51], a[192:195], v[112:115]
buffer_load_dwordx4 v3, s[8:11], 0 offen offset:0 sc1 lds
v_mfma_f32_16x16x32_bf16 v[112:115], v[52:55], a[208:211], v[112:115]
v_mul_f32 v208, v208, v88
v_mul_f32 v210, v210, v89
v_mfma_f32_16x16x32_bf16 v[116:119], v[48:51], a[196:199], v[116:119]
ds_read_b128 v[72:75], v2 offset:55296
v_mul_f32 v209, v88, v104
v_mfma_f32_16x16x32_bf16 v[116:119], v[52:55], a[212:215], v[116:119]
v_exp_f32 v208, v208
v_mfma_f32_16x16x32_bf16 v[120:123], v[48:51], a[200:203], v[120:123]
v_exp_f32 v210, v210
v_mfma_f32_16x16x32_bf16 v[120:123], v[52:55], a[216:219], v[120:123]
ds_read_b128 v[76:79], v2 offset:56320
v_mul_f32 v211, v89, v105
v_mfma_f32_16x16x32_bf16 v[124:127], v[48:51], a[204:207], v[124:127]
buffer_load_dwordx4 v3, s[8:11], 0 offen offset:1024 sc1 lds
v_mfma_f32_16x16x32_bf16 v[124:127], v[52:55], a[220:223], v[124:127]
v_fma_f32 v208, v208, v242, v242
s_waitcnt lgkmcnt(4)
v_mfma_f32_16x16x32_bf16 v[128:131], v[56:59], a[192:195], v[128:131]
v_mov_b32 v12, s68
v_mov_b32 v13, s69
v_mfma_f32_16x16x32_bf16 v[128:131], v[60:63], a[208:211], v[128:131]
s_add_u32 s53, s34, 0
s_waitcnt vmcnt(6)
v_fma_f32 v210, v210, v242, v242
v_mfma_f32_16x16x32_bf16 v[132:135], v[56:59], a[196:199], v[132:135]
ds_read_b128 v[48:51], v2 offset:57344
v_rcp_f32 v208, v208
v_mfma_f32_16x16x32_bf16 v[132:135], v[60:63], a[212:215], v[132:135]
buffer_store_dwordx2 v[12:13], v10, s[8:11], s53 offen sc1
v_rcp_f32 v210, v210
v_mfma_f32_16x16x32_bf16 v[136:139], v[56:59], a[200:203], v[136:139]
v_mul_f32 v209, v209, v208
v_mul_f32 v211, v211, v210
v_mfma_f32_16x16x32_bf16 v[136:139], v[60:63], a[216:219], v[136:139]
ds_read_b128 v[52:55], v2 offset:58368
v_cvt_pk_bf16_f32 v184, v209, v211
v_mfma_f32_16x16x32_bf16 v[140:143], v[56:59], a[204:207], v[140:143]
v_mul_f32 v212, v90, v90
v_mul_f32 v214, v91, v91
v_mfma_f32_16x16x32_bf16 v[140:143], v[60:63], a[220:223], v[140:143]
v_fma_f32 v212, v212, v241, v240
s_waitcnt lgkmcnt(4)
v_mfma_f32_16x16x32_bf16 v[112:115], v[64:67], a[224:227], v[112:115]
v_fma_f32 v214, v214, v241, v240
v_mul_f32 v212, v212, v90
v_mfma_f32_16x16x32_bf16 v[112:115], v[68:71], a[240:243], v[112:115]
v_mul_f32 v214, v214, v91
v_exp_f32 v212, v212
v_mfma_f32_16x16x32_bf16 v[116:119], v[64:67], a[228:231], v[116:119]
ds_read_b128 v[56:59], v2 offset:59392
v_exp_f32 v214, v214
v_mfma_f32_16x16x32_bf16 v[116:119], v[68:71], a[244:247], v[116:119]
v_mul_f32 v213, v90, v106
v_mul_f32 v215, v91, v107
v_mfma_f32_16x16x32_bf16 v[120:123], v[64:67], a[232:235], v[120:123]
v_fma_f32 v212, v212, v242, v242
v_fma_f32 v214, v214, v242, v242
v_mfma_f32_16x16x32_bf16 v[120:123], v[68:71], a[248:251], v[120:123]
ds_read_b128 v[60:63], v2 offset:60416
v_rcp_f32 v212, v212
v_mfma_f32_16x16x32_bf16 v[124:127], v[64:67], a[236:239], v[124:127]
v_rcp_f32 v214, v214
v_mfma_f32_16x16x32_bf16 v[124:127], v[68:71], a[252:255], v[124:127]
v_mul_f32 v213, v213, v212
s_waitcnt lgkmcnt(4)
v_mfma_f32_16x16x32_bf16 v[128:131], v[72:75], a[224:227], v[128:131]
v_mul_f32 v215, v215, v214
v_cvt_pk_bf16_f32 v185, v213, v215
v_mfma_f32_16x16x32_bf16 v[128:131], v[76:79], a[240:243], v[128:131]
v_mul_f32 v208, v92, v92
v_mul_f32 v210, v93, v93
v_mfma_f32_16x16x32_bf16 v[132:135], v[72:75], a[228:231], v[132:135]
ds_read_b128 v[64:67], v2 offset:61440
v_fma_f32 v208, v208, v245, v244
v_mfma_f32_16x16x32_bf16 v[132:135], v[76:79], a[244:247], v[132:135]
v_fma_f32 v210, v210, v245, v244
v_mul_f32 v208, v208, v92
v_mfma_f32_16x16x32_bf16 v[136:139], v[72:75], a[232:235], v[136:139]
v_mul_f32 v210, v210, v93
v_exp_f32 v208, v208
v_mfma_f32_16x16x32_bf16 v[136:139], v[76:79], a[248:251], v[136:139]
ds_read_b128 v[68:71], v2 offset:62464
v_exp_f32 v210, v210
v_mfma_f32_16x16x32_bf16 v[140:143], v[72:75], a[236:239], v[140:143]
v_mul_f32 v209, v92, v108
v_mul_f32 v211, v93, v109
v_mfma_f32_16x16x32_bf16 v[140:143], v[76:79], a[252:255], v[140:143]
v_fma_f32 v208, v208, v246, v246
s_waitcnt lgkmcnt(4)
v_mfma_f32_16x16x32_bf16 v[112:115], v[48:51], v[16:19], v[112:115]
v_fma_f32 v210, v210, v246, v246
v_rcp_f32 v208, v208
v_mfma_f32_16x16x32_bf16 v[112:115], v[52:55], v[32:35], v[112:115]
v_rcp_f32 v210, v210
v_mfma_f32_16x16x32_bf16 v[116:119], v[48:51], v[20:23], v[116:119]
ds_read_b128 v[72:75], v2 offset:63488
v_mul_f32 v209, v209, v208
v_mfma_f32_16x16x32_bf16 v[116:119], v[52:55], v[36:39], v[116:119]
v_mul_f32 v211, v211, v210
v_cvt_pk_bf16_f32 v188, v209, v211
v_mfma_f32_16x16x32_bf16 v[120:123], v[48:51], v[24:27], v[120:123]
v_mul_f32 v212, v94, v94
v_mul_f32 v214, v95, v95
v_mfma_f32_16x16x32_bf16 v[120:123], v[52:55], v[40:43], v[120:123]
ds_read_b128 v[76:79], v2 offset:64512
v_fma_f32 v212, v212, v245, v244
v_mfma_f32_16x16x32_bf16 v[124:127], v[48:51], v[28:31], v[124:127]
v_fma_f32 v214, v214, v245, v244
v_mul_f32 v212, v212, v94
v_mfma_f32_16x16x32_bf16 v[124:127], v[52:55], v[44:47], v[124:127]
v_mul_f32 v214, v214, v95
s_waitcnt lgkmcnt(4)
v_mfma_f32_16x16x32_bf16 v[128:131], v[56:59], v[16:19], v[128:131]
v_exp_f32 v212, v212
v_mfma_f32_16x16x32_bf16 v[128:131], v[60:63], v[32:35], v[128:131]
v_exp_f32 v214, v214
v_mfma_f32_16x16x32_bf16 v[132:135], v[56:59], v[20:23], v[132:135]
ds_read_b128 v[48:51], v7 offset:0
v_mul_f32 v213, v94, v110
v_mfma_f32_16x16x32_bf16 v[132:135], v[60:63], v[36:39], v[132:135]
v_mul_f32 v215, v95, v111
v_fma_f32 v212, v212, v246, v246
v_mfma_f32_16x16x32_bf16 v[136:139], v[56:59], v[24:27], v[136:139]
v_fma_f32 v214, v214, v246, v246
v_rcp_f32 v212, v212
v_mfma_f32_16x16x32_bf16 v[136:139], v[60:63], v[40:43], v[136:139]
ds_read_b128 v[52:55], v7 offset:1024
v_rcp_f32 v214, v214
v_mfma_f32_16x16x32_bf16 v[140:143], v[56:59], v[28:31], v[140:143]
v_mul_f32 v213, v213, v212
v_mul_f32 v215, v215, v214
v_mfma_f32_16x16x32_bf16 v[140:143], v[60:63], v[44:47], v[140:143]
v_cvt_pk_bf16_f32 v189, v213, v215
s_waitcnt lgkmcnt(4)
v_mfma_f32_16x16x32_bf16 v[80:83], v[64:67], a[0:3], 0
v_mfma_f32_16x16x32_bf16 v[80:83], v[68:71], a[16:19], v[80:83]
v_mfma_f32_16x16x32_bf16 v[84:87], v[64:67], a[4:7], 0
ds_read_b128 v[56:59], v7 offset:2048
v_mfma_f32_16x16x32_bf16 v[84:87], v[68:71], a[20:23], v[84:87]
v_mul_f32 v208, v112, v112
v_mul_f32 v210, v113, v113
v_mfma_f32_16x16x32_bf16 v[88:91], v[64:67], a[8:11], 0
v_fma_f32 v208, v208, v233, v232
v_fma_f32 v210, v210, v233, v232
v_mfma_f32_16x16x32_bf16 v[88:91], v[68:71], a[24:27], v[88:91]
ds_read_b128 v[60:63], v7 offset:3072
v_mul_f32 v208, v208, v112
v_mfma_f32_16x16x32_bf16 v[92:95], v[64:67], a[12:15], 0
v_mul_f32 v210, v210, v113
v_mul_f32 v209, v112, v128
v_mfma_f32_16x16x32_bf16 v[92:95], v[68:71], a[28:31], v[92:95]
v_mul_f32 v211, v113, v129
s_waitcnt lgkmcnt(4)
v_mfma_f32_16x16x32_bf16 v[96:99], v[72:75], a[0:3], 0
v_exp_f32 v208, v208
v_mfma_f32_16x16x32_bf16 v[96:99], v[76:79], a[16:19], v[96:99]
v_exp_f32 v210, v210
v_mfma_f32_16x16x32_bf16 v[100:103], v[72:75], a[4:7], 0
ds_read_b128 v[64:67], v7 offset:4096
v_fma_f32 v208, v208, v234, v234
v_mfma_f32_16x16x32_bf16 v[100:103], v[76:79], a[20:23], v[100:103]
v_fma_f32 v210, v210, v234, v234
v_mul_f32 v212, v114, v114
v_mfma_f32_16x16x32_bf16 v[104:107], v[72:75], a[8:11], 0
v_rcp_f32 v208, v208
v_mfma_f32_16x16x32_bf16 v[104:107], v[76:79], a[24:27], v[104:107]
ds_read_b128 v[68:71], v7 offset:5120
v_mul_f32 v209, v209, v208
v_mfma_f32_16x16x32_bf16 v[108:111], v[72:75], a[12:15], 0
v_rcp_f32 v210, v210
v_mfma_f32_16x16x32_bf16 v[108:111], v[76:79], a[28:31], v[108:111]
v_mul_f32 v211, v211, v210
s_waitcnt lgkmcnt(4)
v_mfma_f32_16x16x32_bf16 v[80:83], v[48:51], a[32:35], v[80:83]
v_cvt_pk_bf16_f32 v178, v209, v211
v_mul_f32 v214, v115, v115
v_mfma_f32_16x16x32_bf16 v[80:83], v[52:55], a[48:51], v[80:83]
v_fma_f32 v212, v212, v233, v232
v_fma_f32 v214, v214, v233, v232
v_mfma_f32_16x16x32_bf16 v[84:87], v[48:51], a[36:39], v[84:87]
ds_read_b128 v[72:75], v7 offset:6144
v_mul_f32 v212, v212, v114
v_mfma_f32_16x16x32_bf16 v[84:87], v[52:55], a[52:55], v[84:87]
v_mul_f32 v214, v214, v115
v_mul_f32 v213, v114, v130
v_mfma_f32_16x16x32_bf16 v[88:91], v[48:51], a[40:43], v[88:91]
v_exp_f32 v212, v212
v_mfma_f32_16x16x32_bf16 v[88:91], v[52:55], a[56:59], v[88:91]
ds_read_b128 v[76:79], v7 offset:7168
v_mul_f32 v215, v115, v131
v_mfma_f32_16x16x32_bf16 v[92:95], v[48:51], a[44:47], v[92:95]
v_exp_f32 v214, v214
v_mfma_f32_16x16x32_bf16 v[92:95], v[52:55], a[60:63], v[92:95]
v_fma_f32 v212, v212, v234, v234
s_waitcnt lgkmcnt(4)
v_mfma_f32_16x16x32_bf16 v[96:99], v[56:59], a[32:35], v[96:99]
s_waitcnt vmcnt(26)
v_fma_f32 v214, v214, v234, v234
v_mfma_f32_16x16x32_bf16 v[96:99], v[60:63], a[48:51], v[96:99]
s_barrier
v_mfma_f32_16x16x32_bf16 v[100:103], v[56:59], a[36:39], v[100:103]
ds_read_b128 v[48:51], v7 offset:8192
s_add_u32 m0, s22, 24576
v_mfma_f32_16x16x32_bf16 v[100:103], v[60:63], a[52:55], v[100:103]
v_add_u32 v3, 20480, v3
buffer_load_dwordx4 v3, s[8:11], 0 offen offset:0 sc1 lds
v_mfma_f32_16x16x32_bf16 v[104:107], v[56:59], a[40:43], v[104:107]
v_rcp_f32 v212, v212
v_mfma_f32_16x16x32_bf16 v[104:107], v[60:63], a[56:59], v[104:107]
ds_read_b128 v[52:55], v7 offset:9216
v_mul_f32 v213, v213, v212
v_mfma_f32_16x16x32_bf16 v[108:111], v[56:59], a[44:47], v[108:111]
v_rcp_f32 v214, v214
v_mfma_f32_16x16x32_bf16 v[108:111], v[60:63], a[60:63], v[108:111]
v_mul_f32 v215, v215, v214
s_waitcnt lgkmcnt(4)
v_mfma_f32_16x16x32_bf16 v[80:83], v[64:67], a[64:67], v[80:83]
buffer_load_dwordx4 v3, s[8:11], 0 offen offset:1024 sc1 lds
v_mfma_f32_16x16x32_bf16 v[80:83], v[68:71], a[80:83], v[80:83]
v_cvt_pk_bf16_f32 v179, v213, v215
v_mul_f32 v208, v116, v116
v_mfma_f32_16x16x32_bf16 v[84:87], v[64:67], a[68:71], v[84:87]
ds_read_b128 v[56:59], v7 offset:10240
v_mul_f32 v210, v117, v117
v_mfma_f32_16x16x32_bf16 v[84:87], v[68:71], a[84:87], v[84:87]
buffer_store_dwordx4 v[176:179], v2, s[8:11], s24 offen offset:2048 sc1
v_mfma_f32_16x16x32_bf16 v[88:91], v[64:67], a[72:75], v[88:91]
v_fma_f32 v208, v208, v237, v236
v_fma_f32 v210, v210, v237, v236
v_mfma_f32_16x16x32_bf16 v[88:91], v[68:71], a[88:91], v[88:91]
ds_read_b128 v[60:63], v7 offset:11264
v_mul_f32 v208, v208, v116
v_mfma_f32_16x16x32_bf16 v[92:95], v[64:67], a[76:79], v[92:95]
v_mul_f32 v210, v210, v117
v_mul_f32 v209, v116, v132
v_mfma_f32_16x16x32_bf16 v[92:95], v[68:71], a[92:95], v[92:95]
v_mul_f32 v211, v117, v133
s_waitcnt lgkmcnt(4)
v_mfma_f32_16x16x32_bf16 v[96:99], v[72:75], a[64:67], v[96:99]
buffer_load_dwordx4 v3, s[8:11], 0 offen offset:2048 sc1 lds
v_mfma_f32_16x16x32_bf16 v[96:99], v[76:79], a[80:83], v[96:99]
v_exp_f32 v208, v208
v_mfma_f32_16x16x32_bf16 v[100:103], v[72:75], a[68:71], v[100:103]
ds_read_b128 v[64:67], v7 offset:12288
v_fma_f32 v208, v208, v238, v238
v_mfma_f32_16x16x32_bf16 v[100:103], v[76:79], a[84:87], v[100:103]
v_exp_f32 v210, v210
v_mfma_f32_16x16x32_bf16 v[104:107], v[72:75], a[72:75], v[104:107]
v_fma_f32 v210, v210, v238, v238
v_mul_f32 v212, v118, v118
v_mfma_f32_16x16x32_bf16 v[104:107], v[76:79], a[88:91], v[104:107]
ds_read_b128 v[68:71], v7 offset:13312
v_mul_f32 v214, v119, v119
v_mfma_f32_16x16x32_bf16 v[108:111], v[72:75], a[76:79], v[108:111]
buffer_load_dwordx4 v3, s[8:11], 0 offen offset:3072 sc1 lds
v_mfma_f32_16x16x32_bf16 v[108:111], v[76:79], a[92:95], v[108:111]
s_add_u32 m0, s22, 28672
s_waitcnt lgkmcnt(4)
v_mfma_f32_16x16x32_bf16 v[80:83], v[48:51], a[96:99], v[80:83]
v_add_u32 v3, 4096, v3
v_fma_f32 v212, v212, v237, v236
v_mfma_f32_16x16x32_bf16 v[80:83], v[52:55], a[112:115], v[80:83]
v_rcp_f32 v208, v208
v_mfma_f32_16x16x32_bf16 v[84:87], v[48:51], a[100:103], v[84:87]
ds_read_b128 v[72:75], v7 offset:14336
v_mul_f32 v209, v209, v208
v_mfma_f32_16x16x32_bf16 v[84:87], v[52:55], a[116:119], v[84:87]
buffer_load_dwordx4 v3, s[8:11], 0 offen offset:0 sc1 lds
v_mfma_f32_16x16x32_bf16 v[88:91], v[48:51], a[104:107], v[88:91]
v_rcp_f32 v210, v210
v_mfma_f32_16x16x32_bf16 v[88:91], v[52:55], a[120:123], v[88:91]
ds_read_b128 v[76:79], v7 offset:15360
v_mul_f32 v211, v211, v210
v_mfma_f32_16x16x32_bf16 v[92:95], v[48:51], a[108:111], v[92:95]
v_cvt_pk_bf16_f32 v182, v209, v211
v_fma_f32 v214, v214, v237, v236
v_mfma_f32_16x16x32_bf16 v[92:95], v[52:55], a[124:127], v[92:95]
v_mul_f32 v212, v212, v118
s_waitcnt lgkmcnt(4)
v_mfma_f32_16x16x32_bf16 v[96:99], v[56:59], a[96:99], v[96:99]
buffer_load_dwordx4 v3, s[8:11], 0 offen offset:1024 sc1 lds
v_mfma_f32_16x16x32_bf16 v[96:99], v[60:63], a[112:115], v[96:99]
s_add_u32 s23, s34, 0
v_mul_f32 v214, v214, v119
v_mfma_f32_16x16x32_bf16 v[100:103], v[56:59], a[100:103], v[100:103]
ds_read_b128 v[48:51], v7 offset:16384
v_mul_f32 v213, v118, v134
v_mfma_f32_16x16x32_bf16 v[100:103], v[60:63], a[116:119], v[100:103]
v_exp_f32 v212, v212
v_mfma_f32_16x16x32_bf16 v[104:107], v[56:59], a[104:107], v[104:107]
v_exp_f32 v214, v214
v_mfma_f32_16x16x32_bf16 v[104:107], v[60:63], a[120:123], v[104:107]
ds_read_b128 v[52:55], v7 offset:17408
v_mul_f32 v215, v119, v135
v_mfma_f32_16x16x32_bf16 v[108:111], v[56:59], a[108:111], v[108:111]
buffer_load_dwordx2 v[14:15], v11, s[8:11], s23 offen sc1
v_mfma_f32_16x16x32_bf16 v[108:111], v[60:63], a[124:127], v[108:111]
v_fma_f32 v212, v212, v238, v238
s_waitcnt lgkmcnt(4)
v_mfma_f32_16x16x32_bf16 v[80:83], v[64:67], a[128:131], v[80:83]
v_fma_f32 v214, v214, v238, v238
v_mul_f32 v208, v120, v120
v_mfma_f32_16x16x32_bf16 v[80:83], v[68:71], a[144:147], v[80:83]
v_rcp_f32 v212, v212
v_mfma_f32_16x16x32_bf16 v[84:87], v[64:67], a[132:135], v[84:87]
ds_read_b128 v[56:59], v7 offset:18432
v_mul_f32 v213, v213, v212
v_mfma_f32_16x16x32_bf16 v[84:87], v[68:71], a[148:151], v[84:87]
v_rcp_f32 v214, v214
v_mfma_f32_16x16x32_bf16 v[88:91], v[64:67], a[136:139], v[88:91]
v_mul_f32 v215, v215, v214
v_cvt_pk_bf16_f32 v183, v213, v215
v_mfma_f32_16x16x32_bf16 v[88:91], v[68:71], a[152:155], v[88:91]
ds_read_b128 v[60:63], v7 offset:19456
v_mul_f32 v210, v121, v121
v_mfma_f32_16x16x32_bf16 v[92:95], v[64:67], a[140:143], v[92:95]
buffer_store_dwordx4 v[180:183], v4, s[8:11], s24 offen offset:2048 sc1
v_mfma_f32_16x16x32_bf16 v[92:95], v[68:71], a[156:159], v[92:95]
v_fma_f32 v208, v208, v241, v240
s_waitcnt lgkmcnt(4)
v_mfma_f32_16x16x32_bf16 v[96:99], v[72:75], a[128:131], v[96:99]
v_fma_f32 v210, v210, v241, v240
v_mul_f32 v208, v208, v120
v_mfma_f32_16x16x32_bf16 v[96:99], v[76:79], a[144:147], v[96:99]
v_mul_f32 v210, v210, v121
v_mul_f32 v209, v120, v136
v_mfma_f32_16x16x32_bf16 v[100:103], v[72:75], a[132:135], v[100:103]
ds_read_b128 v[64:67], v7 offset:20480
v_mul_f32 v211, v121, v137
v_mfma_f32_16x16x32_bf16 v[100:103], v[76:79], a[148:151], v[100:103]
v_exp_f32 v208, v208
v_mfma_f32_16x16x32_bf16 v[104:107], v[72:75], a[136:139], v[104:107]
v_exp_f32 v210, v210
v_mfma_f32_16x16x32_bf16 v[104:107], v[76:79], a[152:155], v[104:107]
ds_read_b128 v[68:71], v7 offset:21504
v_fma_f32 v208, v208, v242, v242
v_mfma_f32_16x16x32_bf16 v[108:111], v[72:75], a[140:143], v[108:111]
v_fma_f32 v210, v210, v242, v242
v_mul_f32 v212, v122, v122
v_mfma_f32_16x16x32_bf16 v[108:111], v[76:79], a[156:159], v[108:111]
v_mul_f32 v214, v123, v123
s_waitcnt lgkmcnt(4)
v_mfma_f32_16x16x32_bf16 v[80:83], v[48:51], a[160:163], v[80:83]
v_rcp_f32 v208, v208
v_mfma_f32_16x16x32_bf16 v[80:83], v[52:55], a[176:179], v[80:83]
v_rcp_f32 v210, v210
v_mfma_f32_16x16x32_bf16 v[84:87], v[48:51], a[164:167], v[84:87]
ds_read_b128 v[72:75], v7 offset:22528
v_mul_f32 v209, v209, v208
v_mfma_f32_16x16x32_bf16 v[84:87], v[52:55], a[180:183], v[84:87]
v_mul_f32 v211, v211, v210
v_cvt_pk_bf16_f32 v186, v209, v211
v_mfma_f32_16x16x32_bf16 v[88:91], v[48:51], a[168:171], v[88:91]
v_fma_f32 v212, v212, v241, v240
v_fma_f32 v214, v214, v241, v240
v_mfma_f32_16x16x32_bf16 v[88:91], v[52:55], a[184:187], v[88:91]
ds_read_b128 v[76:79], v7 offset:23552
v_mul_f32 v212, v212, v122
v_mfma_f32_16x16x32_bf16 v[92:95], v[48:51], a[172:175], v[92:95]
v_mul_f32 v214, v214, v123
v_mul_f32 v213, v122, v138
v_mfma_f32_16x16x32_bf16 v[92:95], v[52:55], a[188:191], v[92:95]
v_mul_f32 v215, v123, v139
s_waitcnt lgkmcnt(4)
v_mfma_f32_16x16x32_bf16 v[96:99], v[56:59], a[160:163], v[96:99]
v_exp_f32 v212, v212
v_mfma_f32_16x16x32_bf16 v[96:99], v[60:63], a[176:179], v[96:99]
v_exp_f32 v214, v214
v_mfma_f32_16x16x32_bf16 v[100:103], v[56:59], a[164:167], v[100:103]
ds_read_b128 v[48:51], v7 offset:24576
v_fma_f32 v212, v212, v242, v242
v_mfma_f32_16x16x32_bf16 v[100:103], v[60:63], a[180:183], v[100:103]
v_fma_f32 v214, v214, v242, v242
v_mul_f32 v208, v124, v124
v_mfma_f32_16x16x32_bf16 v[104:107], v[56:59], a[168:171], v[104:107]
v_rcp_f32 v212, v212
v_mfma_f32_16x16x32_bf16 v[104:107], v[60:63], a[184:187], v[104:107]
ds_read_b128 v[52:55], v7 offset:25600
v_mfma_f32_16x16x32_bf16 v[108:111], v[56:59], a[172:175], v[108:111]
v_rcp_f32 v214, v214
v_mfma_f32_16x16x32_bf16 v[108:111], v[60:63], a[188:191], v[108:111]
s_waitcnt lgkmcnt(4)
v_mfma_f32_16x16x32_bf16 v[80:83], v[64:67], a[192:195], v[80:83]
v_mul_f32 v213, v213, v212
v_mul_f32 v215, v215, v214
v_mfma_f32_16x16x32_bf16 v[80:83], v[68:71], a[208:211], v[80:83]
v_cvt_pk_bf16_f32 v187, v213, v215
v_mul_f32 v210, v125, v125
v_mfma_f32_16x16x32_bf16 v[84:87], v[64:67], a[196:199], v[84:87]
ds_read_b128 v[56:59], v7 offset:26624
v_mfma_f32_16x16x32_bf16 v[84:87], v[68:71], a[212:215], v[84:87]
buffer_store_dwordx4 v[184:187], v5, s[8:11], s24 offen offset:2048 sc1
v_mfma_f32_16x16x32_bf16 v[88:91], v[64:67], a[200:203], v[88:91]
v_mfma_f32_16x16x32_bf16 v[88:91], v[68:71], a[216:219], v[88:91]
ds_read_b128 v[60:63], v7 offset:27648
v_fma_f32 v208, v208, v245, v244
v_mfma_f32_16x16x32_bf16 v[92:95], v[64:67], a[204:207], v[92:95]
v_fma_f32 v210, v210, v245, v244
v_mul_f32 v208, v208, v124
v_mfma_f32_16x16x32_bf16 v[92:95], v[68:71], a[220:223], v[92:95]
v_mul_f32 v210, v210, v125
s_waitcnt lgkmcnt(4)
v_mfma_f32_16x16x32_bf16 v[96:99], v[72:75], a[192:195], v[96:99]
v_exp_f32 v208, v208
v_mfma_f32_16x16x32_bf16 v[96:99], v[76:79], a[208:211], v[96:99]
v_mfma_f32_16x16x32_bf16 v[100:103], v[72:75], a[196:199], v[100:103]
ds_read_b128 v[64:67], v7 offset:28672
v_mul_f32 v209, v124, v140
v_mfma_f32_16x16x32_bf16 v[100:103], v[76:79], a[212:215], v[100:103]
v_exp_f32 v210, v210
v_mfma_f32_16x16x32_bf16 v[104:107], v[72:75], a[200:203], v[104:107]
v_mfma_f32_16x16x32_bf16 v[104:107], v[76:79], a[216:219], v[104:107]
ds_read_b128 v[68:71], v7 offset:29696
v_mul_f32 v211, v125, v141
v_mfma_f32_16x16x32_bf16 v[108:111], v[72:75], a[204:207], v[108:111]
v_fma_f32 v208, v208, v246, v246
v_fma_f32 v210, v210, v246, v246
v_mfma_f32_16x16x32_bf16 v[108:111], v[76:79], a[220:223], v[108:111]
v_mul_f32 v212, v126, v126
s_waitcnt lgkmcnt(4)
v_mfma_f32_16x16x32_bf16 v[80:83], v[48:51], a[224:227], v[80:83]
v_rcp_f32 v208, v208
v_mfma_f32_16x16x32_bf16 v[80:83], v[52:55], a[240:243], v[80:83]
v_mfma_f32_16x16x32_bf16 v[84:87], v[48:51], a[228:231], v[84:87]
ds_read_b128 v[72:75], v7 offset:30720
v_mul_f32 v209, v209, v208
v_mfma_f32_16x16x32_bf16 v[84:87], v[52:55], a[244:247], v[84:87]
v_rcp_f32 v210, v210
v_mfma_f32_16x16x32_bf16 v[88:91], v[48:51], a[232:235], v[88:91]
v_mul_f32 v211, v211, v210
v_cvt_pk_bf16_f32 v190, v209, v211
v_mfma_f32_16x16x32_bf16 v[88:91], v[52:55], a[248:251], v[88:91]
ds_read_b128 v[76:79], v7 offset:31744
v_mfma_f32_16x16x32_bf16 v[92:95], v[48:51], a[236:239], v[92:95]
v_mul_f32 v214, v127, v127
v_fma_f32 v212, v212, v245, v244
v_mfma_f32_16x16x32_bf16 v[92:95], v[52:55], a[252:255], v[92:95]
s_waitcnt lgkmcnt(4)
v_mfma_f32_16x16x32_bf16 v[96:99], v[56:59], a[224:227], v[96:99]
s_waitcnt vmcnt(28)
v_fma_f32 v214, v214, v245, v244
v_mfma_f32_16x16x32_bf16 v[96:99], v[60:63], a[240:243], v[96:99]
s_barrier
v_mfma_f32_16x16x32_bf16 v[100:103], v[56:59], a[228:231], v[100:103]
ds_read_b128 v[48:51], v7 offset:32768
s_add_u32 m0, s22, 49152
v_mfma_f32_16x16x32_bf16 v[100:103], v[60:63], a[244:247], v[100:103]
v_add_u32 v3, 20480, v3
buffer_load_dwordx4 v3, s[8:11], 0 offen offset:0 sc1 lds
v_mfma_f32_16x16x32_bf16 v[104:107], v[56:59], a[232:235], v[104:107]
v_mul_f32 v212, v212, v126
v_mul_f32 v214, v214, v127
v_mfma_f32_16x16x32_bf16 v[104:107], v[60:63], a[248:251], v[104:107]
ds_read_b128 v[52:55], v7 offset:33792
v_mul_f32 v213, v126, v142
v_mfma_f32_16x16x32_bf16 v[108:111], v[56:59], a[236:239], v[108:111]
v_exp_f32 v212, v212
v_mfma_f32_16x16x32_bf16 v[108:111], v[60:63], a[252:255], v[108:111]
v_mul_f32 v215, v127, v143
s_waitcnt lgkmcnt(4)
v_mfma_f32_16x16x32_bf16 v[80:83], v[64:67], v[16:19], v[80:83]
buffer_load_dwordx4 v3, s[8:11], 0 offen offset:1024 sc1 lds
v_mfma_f32_16x16x32_bf16 v[80:83], v[68:71], v[32:35], v[80:83]
v_exp_f32 v214, v214
v_mfma_f32_16x16x32_bf16 v[84:87], v[64:67], v[20:23], v[84:87]
ds_read_b128 v[56:59], v7 offset:34816
v_fma_f32 v212, v212, v246, v246
v_mfma_f32_16x16x32_bf16 v[84:87], v[68:71], v[36:39], v[84:87]
v_fma_f32 v214, v214, v246, v246
v_mfma_f32_16x16x32_bf16 v[88:91], v[64:67], v[24:27], v[88:91]
v_rcp_f32 v212, v212
v_mfma_f32_16x16x32_bf16 v[88:91], v[68:71], v[40:43], v[88:91]
ds_read_b128 v[60:63], v7 offset:35840
v_mul_f32 v213, v213, v212
v_mfma_f32_16x16x32_bf16 v[92:95], v[64:67], v[28:31], v[92:95]
buffer_load_dwordx4 v3, s[8:11], 0 offen offset:2048 sc1 lds
v_mfma_f32_16x16x32_bf16 v[92:95], v[68:71], v[44:47], v[92:95]
s_waitcnt lgkmcnt(4)
v_mfma_f32_16x16x32_bf16 v[96:99], v[72:75], v[16:19], v[96:99]
v_rcp_f32 v214, v214
v_mfma_f32_16x16x32_bf16 v[96:99], v[76:79], v[32:35], v[96:99]
v_mul_f32 v215, v215, v214
v_cvt_pk_bf16_f32 v191, v213, v215
v_mfma_f32_16x16x32_bf16 v[100:103], v[72:75], v[20:23], v[100:103]
ds_read_b128 v[64:67], v7 offset:36864
v_mfma_f32_16x16x32_bf16 v[100:103], v[76:79], v[36:39], v[100:103]
buffer_load_dwordx4 v3, s[8:11], 0 offen offset:3072 sc1 lds
v_mfma_f32_16x16x32_bf16 v[104:107], v[72:75], v[24:27], v[104:107]
s_add_u32 m0, s22, 53248
v_add_u32 v3, 4096, v3
v_mfma_f32_16x16x32_bf16 v[104:107], v[76:79], v[40:43], v[104:107]
ds_read_b128 v[68:71], v7 offset:37888
buffer_store_dwordx4 v[188:191], v6, s[8:11], s24 offen offset:2048 sc1
v_mfma_f32_16x16x32_bf16 v[108:111], v[72:75], v[28:31], v[108:111]
v_mfma_f32_16x16x32_bf16 v[108:111], v[76:79], v[44:47], v[108:111]
s_waitcnt lgkmcnt(4)
v_mfma_f32_16x16x32_bf16 v[112:115], v[48:51], a[0:3], 0
v_mfma_f32_16x16x32_bf16 v[112:115], v[52:55], a[16:19], v[112:115]
v_mfma_f32_16x16x32_bf16 v[116:119], v[48:51], a[4:7], 0
ds_read_b128 v[72:75], v7 offset:38912
v_mfma_f32_16x16x32_bf16 v[116:119], v[52:55], a[20:23], v[116:119]
buffer_load_dwordx4 v3, s[8:11], 0 offen offset:0 sc1 lds
v_mfma_f32_16x16x32_bf16 v[120:123], v[48:51], a[8:11], 0
v_mul_f32 v208, v80, v80
v_mul_f32 v210, v81, v81
v_mfma_f32_16x16x32_bf16 v[120:123], v[52:55], a[24:27], v[120:123]
ds_read_b128 v[76:79], v7 offset:39936
v_fma_f32 v208, v208, v233, v232
v_mfma_f32_16x16x32_bf16 v[124:127], v[48:51], a[12:15], 0
v_fma_f32 v210, v210, v233, v232
v_mul_f32 v208, v208, v80
v_mfma_f32_16x16x32_bf16 v[124:127], v[52:55], a[28:31], v[124:127]
v_mul_f32 v210, v210, v81
s_waitcnt lgkmcnt(4)
v_mfma_f32_16x16x32_bf16 v[128:131], v[56:59], a[0:3], 0
buffer_load_dwordx4 v3, s[8:11], 0 offen offset:1024 sc1 lds
v_mfma_f32_16x16x32_bf16 v[128:131], v[60:63], a[16:19], v[128:131]
s_waitcnt vmcnt(9)
v_cmp_eq_u64 vcc, s[68:69], v[14:15]
s_nop 0
s_cmp_eq_u64 vcc, exec
s_cbranch_scc0 L_f_slow1
L_f_back1:
v_mul_f32 v209, v80, v96
v_mfma_f32_16x16x32_bf16 v[132:135], v[56:59], a[4:7], 0
ds_read_b128 v[48:51], v7 offset:40960
v_mul_f32 v211, v81, v97
v_mfma_f32_16x16x32_bf16 v[132:135], v[60:63], a[20:23], v[132:135]
v_exp_f32 v208, v208
v_mfma_f32_16x16x32_bf16 v[136:139], v[56:59], a[8:11], 0
v_exp_f32 v210, v210
v_mfma_f32_16x16x32_bf16 v[136:139], v[60:63], a[24:27], v[136:139]
ds_read_b128 v[52:55], v7 offset:41984
v_fma_f32 v208, v208, v234, v234
v_mfma_f32_16x16x32_bf16 v[140:143], v[56:59], a[12:15], 0
v_fma_f32 v210, v210, v234, v234
v_mul_f32 v212, v82, v82
v_mfma_f32_16x16x32_bf16 v[140:143], v[60:63], a[28:31], v[140:143]
v_mul_f32 v214, v83, v83
s_waitcnt lgkmcnt(4)
v_mfma_f32_16x16x32_bf16 v[112:115], v[64:67], a[32:35], v[112:115]
v_rcp_f32 v208, v208
v_mfma_f32_16x16x32_bf16 v[112:115], v[68:71], a[48:51], v[112:115]
v_rcp_f32 v210, v210
v_mfma_f32_16x16x32_bf16 v[116:119], v[64:67], a[36:39], v[116:119]
ds_read_b128 v[56:59], v7 offset:43008
v_mul_f32 v209, v209, v208
v_mfma_f32_16x16x32_bf16 v[116:119], v[68:71], a[52:55], v[116:119]
v_mul_f32 v211, v211, v210
v_cvt_pk_bf16_f32 v192, v209, v211
v_mfma_f32_16x16x32_bf16 v[120:123], v[64:67], a[40:43], v[120:123]
v_fma_f32 v212, v212, v233, v232
v_fma_f32 v214, v214, v233, v232
v_mfma_f32_16x16x32_bf16 v[120:123], v[68:71], a[56:59], v[120:123]
ds_read_b128 v[60:63], v7 offset:44032
v_mul_f32 v212, v212, v82
v_mfma_f32_16x16x32_bf16 v[124:127], v[64:67], a[44:47], v[124:127]
v_mul_f32 v214, v214, v83
v_mul_f32 v213, v82, v98
v_mfma_f32_16x16x32_bf16 v[124:127], v[68:71], a[60:63], v[124:127]
v_mul_f32 v215, v83, v99
s_waitcnt lgkmcnt(4)
v_mfma_f32_16x16x32_bf16 v[128:131], v[72:75], a[32:35], v[128:131]
buffer_load_dwordx4 a[0:3], v2, s[8:11], s25 offen offset:0 sc1
v_mfma_f32_16x16x32_bf16 v[128:131], v[76:79], a[48:51], v[128:131]
v_exp_f32 v212, v212
v_mfma_f32_16x16x32_bf16 v[132:135], v[72:75], a[36:39], v[132:135]
ds_read_b128 v[64:67], v7 offset:45056
v_fma_f32 v212, v212, v234, v234
v_mfma_f32_16x16x32_bf16 v[132:135], v[76:79], a[52:55], v[132:135]
v_exp_f32 v214, v214
v_mfma_f32_16x16x32_bf16 v[136:139], v[72:75], a[40:43], v[136:139]
v_fma_f32 v214, v214, v234, v234
v_mul_f32 v208, v84, v84
v_mfma_f32_16x16x32_bf16 v[136:139], v[76:79], a[56:59], v[136:139]
ds_read_b128 v[68:71], v7 offset:46080
v_mul_f32 v210, v85, v85
v_mfma_f32_16x16x32_bf16 v[140:143], v[72:75], a[44:47], v[140:143]
buffer_load_dwordx4 a[4:7], v4, s[8:11], s25 offen offset:0 sc1
v_mfma_f32_16x16x32_bf16 v[140:143], v[76:79], a[60:63], v[140:143]
v_fma_f32 v208, v208, v237, v236
s_waitcnt lgkmcnt(4)
v_mfma_f32_16x16x32_bf16 v[112:115], v[48:51], a[64:67], v[112:115]
v_rcp_f32 v212, v212
v_mfma_f32_16x16x32_bf16 v[112:115], v[52:55], a[80:83], v[112:115]
v_rcp_f32 v214, v214
v_mfma_f32_16x16x32_bf16 v[116:119], v[48:51], a[68:71], v[116:119]
ds_read_b128 v[72:75], v7 offset:47104
v_mul_f32 v213, v213, v212
v_mfma_f32_16x16x32_bf16 v[116:119], v[52:55], a[84:87], v[116:119]
buffer_load_dwordx4 a[8:11], v5, s[8:11], s25 offen offset:0 sc1
v_mfma_f32_16x16x32_bf16 v[120:123], v[48:51], a[72:75], v[120:123]
v_mul_f32 v215, v215, v214
v_cvt_pk_bf16_f32 v193, v213, v215
v_mfma_f32_16x16x32_bf16 v[120:123], v[52:55], a[88:91], v[120:123]
ds_read_b128 v[76:79], v7 offset:48128
v_fma_f32 v210, v210, v237, v236
v_mfma_f32_16x16x32_bf16 v[124:127], v[48:51], a[76:79], v[124:127]
v_mul_f32 v208, v208, v84
v_mul_f32 v210, v210, v85
v_mfma_f32_16x16x32_bf16 v[124:127], v[52:55], a[92:95], v[124:127]
v_mul_f32 v209, v84, v100
s_waitcnt lgkmcnt(4)
v_mfma_f32_16x16x32_bf16 v[128:131], v[56:59], a[64:67], v[128:131]
buffer_load_dwordx4 a[12:15], v6, s[8:11], s25 offen offset:0 sc1
v_mfma_f32_16x16x32_bf16 v[128:131], v[60:63], a[80:83], v[128:131]
v_exp_f32 v208, v208
v_mfma_f32_16x16x32_bf16 v[132:135], v[56:59], a[68:71], v[132:135]
ds_read_b128 v[48:51], v7 offset:49152
v_mul_f32 v211, v85, v101
v_mfma_f32_16x16x32_bf16 v[132:135], v[60:63], a[84:87], v[132:135]
v_exp_f32 v210, v210
v_mfma_f32_16x16x32_bf16 v[136:139], v[56:59], a[72:75], v[136:139]
v_fma_f32 v208, v208, v238, v238
v_fma_f32 v210, v210, v238, v238
v_mfma_f32_16x16x32_bf16 v[136:139], v[60:63], a[88:91], v[136:139]
ds_read_b128 v[52:55], v7 offset:50176
v_mul_f32 v212, v86, v86
v_mfma_f32_16x16x32_bf16 v[140:143], v[56:59], a[76:79], v[140:143]
buffer_load_dwordx4 a[16:19], v2, s[8:11], s26 offen offset:0 sc1
v_mfma_f32_16x16x32_bf16 v[140:143], v[60:63], a[92:95], v[140:143]
v_mul_f32 v214, v87, v87
s_waitcnt lgkmcnt(4)
v_mfma_f32_16x16x32_bf16 v[112:115], v[64:67], a[96:99], v[112:115]
v_rcp_f32 v208, v208
v_mfma_f32_16x16x32_bf16 v[112:115], v[68:71], a[112:115], v[112:115]
v_rcp_f32 v210, v210
v_mfma_f32_16x16x32_bf16 v[116:119], v[64:67], a[100:103], v[116:119]
ds_read_b128 v[56:59], v7 offset:51200
v_mul_f32 v209, v209, v208
v_mfma_f32_16x16x32_bf16 v[116:119], v[68:71], a[116:119], v[116:119]
buffer_load_dwordx4 a[20:23], v4, s[8:11], s26 offen offset:0 sc1
v_mfma_f32_16x16x32_bf16 v[120:123], v[64:67], a[104:107], v[120:123]
v_mul_f32 v211, v211, v210
v_cvt_pk_bf16_f32 v196, v209, v211
v_mfma_f32_16x16x32_bf16 v[120:123], v[68:71], a[120:123], v[120:123]
ds_read_b128 v[60:63], v7 offset:52224
v_fma_f32 v212, v212, v237, v236
v_mfma_f32_16x16x32_bf16 v[124:127], v[64:67], a[108:111], v[124:127]
v_fma_f32 v214, v214, v237, v236
v_mul_f32 v212, v212, v86
v_mfma_f32_16x16x32_bf16 v[124:127], v[68:71], a[124:127], v[124:127]
v_mul_f32 v214, v214, v87
s_waitcnt lgkmcnt(4)
v_mfma_f32_16x16x32_bf16 v[128:131], v[72:75], a[96:99], v[128:131]
buffer_load_dwordx4 a[24:27], v5, s[8:11], s26 offen offset:0 sc1
v_mfma_f32_16x16x32_bf16 v[128:131], v[76:79], a[112:115], v[128:131]
v_exp_f32 v212, v212
v_mfma_f32_16x16x32_bf16 v[132:135], v[72:75], a[100:103], v[132:135]
ds_read_b128 v[64:67], v7 offset:53248
v_mul_f32 v213, v86, v102
v_mfma_f32_16x16x32_bf16 v[132:135], v[76:79], a[116:119], v[132:135]
v_exp_f32 v214, v214
v_mfma_f32_16x16x32_bf16 v[136:139], v[72:75], a[104:107], v[136:139]
v_mul_f32 v215, v87, v103
v_fma_f32 v212, v212, v238, v238
v_mfma_f32_16x16x32_bf16 v[136:139], v[76:79], a[120:123], v[136:139]
ds_read_b128 v[68:71], v7 offset:54272
v_fma_f32 v214, v214, v238, v238
v_mfma_f32_16x16x32_bf16 v[140:143], v[72:75], a[108:111], v[140:143]
buffer_load_dwordx4 a[28:31], v6, s[8:11], s26 offen offset:0 sc1
v_mfma_f32_16x16x32_bf16 v[140:143], v[76:79], a[124:127], v[140:143]
v_mul_f32 v208, v88, v88
s_waitcnt lgkmcnt(4)
v_mfma_f32_16x16x32_bf16 v[112:115], v[48:51], a[128:131], v[112:115]
v_rcp_f32 v212, v212
v_mfma_f32_16x16x32_bf16 v[112:115], v[52:55], a[144:147], v[112:115]
v_rcp_f32 v214, v214
v_mfma_f32_16x16x32_bf16 v[116:119], v[48:51], a[132:135], v[116:119]
ds_read_b128 v[72:75], v7 offset:55296
v_mul_f32 v213, v213, v212
v_mfma_f32_16x16x32_bf16 v[116:119], v[52:55], a[148:151], v[116:119]
v_mul_f32 v215, v215, v214
v_cvt_pk_bf16_f32 v197, v213, v215
v_mfma_f32_16x16x32_bf16 v[120:123], v[48:51], a[136:139], v[120:123]
v_mul_f32 v210, v89, v89
v_fma_f32 v208, v208, v241, v240
v_mfma_f32_16x16x32_bf16 v[120:123], v[52:55], a[152:155], v[120:123]
ds_read_b128 v[76:79], v7 offset:56320
v_fma_f32 v210, v210, v241, v240
v_mfma_f32_16x16x32_bf16 v[124:127], v[48:51], a[140:143], v[124:127]
v_mul_f32 v208, v208, v88
v_mul_f32 v210, v210, v89
v_mfma_f32_16x16x32_bf16 v[124:127], v[52:55], a[156:159], v[124:127]
v_mul_f32 v209, v88, v104
s_waitcnt lgkmcnt(4)
v_mfma_f32_16x16x32_bf16 v[128:131], v[56:59], a[128:131], v[128:131]
s_waitcnt vmcnt(33)
v_mul_f32 v211, v89, v105
v_mfma_f32_16x16x32_bf16 v[128:131], v[60:63], a[144:147], v[128:131]
s_barrier
v_mfma_f32_16x16x32_bf16 v[132:135], v[56:59], a[132:135], v[132:135]
ds_read_b128 v[48:51], v7 offset:57344
s_add_u32 m0, s22, 73728
v_mfma_f32_16x16x32_bf16 v[132:135], v[60:63], a[148:151], v[132:135]
v_add_u32 v3, 20480, v3
buffer_load_dwordx4 v3, s[8:11], 0 offen offset:0 sc1 lds
v_mfma_f32_16x16x32_bf16 v[136:139], v[56:59], a[136:139], v[136:139]
v_exp_f32 v208, v208
v_mfma_f32_16x16x32_bf16 v[136:139], v[60:63], a[152:155], v[136:139]
ds_read_b128 v[52:55], v7 offset:58368
v_fma_f32 v208, v208, v242, v242
v_mfma_f32_16x16x32_bf16 v[140:143], v[56:59], a[140:143], v[140:143]
v_exp_f32 v210, v210
v_mfma_f32_16x16x32_bf16 v[140:143], v[60:63], a[156:159], v[140:143]
v_fma_f32 v210, v210, v242, v242
s_waitcnt lgkmcnt(4)
v_mfma_f32_16x16x32_bf16 v[112:115], v[64:67], a[160:163], v[112:115]
buffer_load_dwordx4 v3, s[8:11], 0 offen offset:1024 sc1 lds
v_mfma_f32_16x16x32_bf16 v[112:115], v[68:71], a[176:179], v[112:115]
v_rcp_f32 v208, v208
v_mfma_f32_16x16x32_bf16 v[116:119], v[64:67], a[164:167], v[116:119]
ds_read_b128 v[56:59], v7 offset:59392
v_mul_f32 v209, v209, v208
v_mfma_f32_16x16x32_bf16 v[116:119], v[68:71], a[180:183], v[116:119]
v_rcp_f32 v210, v210
v_mfma_f32_16x16x32_bf16 v[120:123], v[64:67], a[168:171], v[120:123]
v_mul_f32 v211, v211, v210
v_cvt_pk_bf16_f32 v200, v209, v211
v_mfma_f32_16x16x32_bf16 v[120:123], v[68:71], a[184:187], v[120:123]
ds_read_b128 v[60:63], v7 offset:60416
v_mul_f32 v212, v90, v90
v_mfma_f32_16x16x32_bf16 v[124:127], v[64:67], a[172:175], v[124:127]
buffer_load_dwordx4 v3, s[8:11], 0 offen offset:2048 sc1 lds
v_mfma_f32_16x16x32_bf16 v[124:127], v[68:71], a[188:191], v[124:127]
v_mul_f32 v214, v91, v91
s_waitcnt lgkmcnt(4)
v_mfma_f32_16x16x32_bf16 v[128:131], v[72:75], a[160:163], v[128:131]
v_fma_f32 v212, v212, v241, v240
v_fma_f32 v214, v214, v241, v240
v_mfma_f32_16x16x32_bf16 v[128:131], v[76:79], a[176:179], v[128:131]
v_mul_f32 v212, v212, v90
v_mul_f32 v214, v214, v91
v_mfma_f32_16x16x32_bf16 v[132:135], v[72:75], a[164:167], v[132:135]
ds_read_b128 v[64:67], v7 offset:61440
v_mul_f32 v213, v90, v106
v_mfma_f32_16x16x32_bf16 v[132:135], v[76:79], a[180:183], v[132:135]
buffer_load_dwordx4 v3, s[8:11], 0 offen offset:3072 sc1 lds
v_mfma_f32_16x16x32_bf16 v[136:139], v[72:75], a[168:171], v[136:139]
s_add_u32 m0, s22, 77824
v_add_u32 v3, 4096, v3
v_mfma_f32_16x16x32_bf16 v[136:139], v[76:79], a[184:187], v[136:139]
ds_read_b128 v[68:71], v7 offset:62464
v_mul_f32 v215, v91, v107
v_mfma_f32_16x16x32_bf16 v[140:143], v[72:75], a[172:175], v[140:143]
v_exp_f32 v212, v212
v_mfma_f32_16x16x32_bf16 v[140:143], v[76:79], a[188:191], v[140:143]
v_fma_f32 v212, v212, v242, v242
s_waitcnt lgkmcnt(4)
v_mfma_f32_16x16x32_bf16 v[112:115], v[48:51], a[192:195], v[112:115]
buffer_load_dwordx4 v3, s[8:11], 0 offen offset:0 sc1 lds
v_mfma_f32_16x16x32_bf16 v[112:115], v[52:55], a[208:211], v[112:115]
v_exp_f32 v214, v214
v_mfma_f32_16x16x32_bf16 v[116:119], v[48:51], a[196:199], v[116:119]
ds_read_b128 v[72:75], v7 offset:63488
v_fma_f32 v214, v214, v242, v242
v_mfma_f32_16x16x32_bf16 v[116:119], v[52:55], a[212:215], v[116:119]
v_rcp_f32 v212, v212
v_mfma_f32_16x16x32_bf16 v[120:123], v[48:51], a[200:203], v[120:123]
v_rcp_f32 v214, v214
v_mfma_f32_16x16x32_bf16 v[120:123], v[52:55], a[216:219], v[120:123]
ds_read_b128 v[76:79], v7 offset:64512
v_mul_f32 v213, v213, v212
v_mfma_f32_16x16x32_bf16 v[124:127], v[48:51], a[204:207], v[124:127]
buffer_load_dwordx4 v3, s[8:11], 0 offen offset:1024 sc1 lds
v_mfma_f32_16x16x32_bf16 v[124:127], v[52:55], a[220:223], v[124:127]
v_mov_b32 v12, s68
s_waitcnt lgkmcnt(4)
v_mfma_f32_16x16x32_bf16 v[128:131], v[56:59], a[192:195], v[128:131]
v_mov_b32 v13, s69
s_add_u32 s53, s34, 131072
v_mfma_f32_16x16x32_bf16 v[128:131], v[60:63], a[208:211], v[128:131]
s_waitcnt vmcnt(16)
v_mul_f32 v215, v215, v214
v_mfma_f32_16x16x32_bf16 v[132:135], v[56:59], a[196:199], v[132:135]
ds_read_b128 v[48:51], v8 offset:0
v_cvt_pk_bf16_f32 v201, v213, v215
v_mfma_f32_16x16x32_bf16 v[132:135], v[60:63], a[212:215], v[132:135]
buffer_store_dwordx2 v[12:13], v10, s[8:11], s53 offen sc1
v_mfma_f32_16x16x32_bf16 v[136:139], v[56:59], a[200:203], v[136:139]
v_mul_f32 v208, v92, v92
v_mul_f32 v210, v93, v93
v_mfma_f32_16x16x32_bf16 v[136:139], v[60:63], a[216:219], v[136:139]
ds_read_b128 v[52:55], v8 offset:1024
v_fma_f32 v208, v208, v245, v244
v_mfma_f32_16x16x32_bf16 v[140:143], v[56:59], a[204:207], v[140:143]
v_fma_f32 v210, v210, v245, v244
v_mul_f32 v208, v208, v92
v_mfma_f32_16x16x32_bf16 v[140:143], v[60:63], a[220:223], v[140:143]
v_mul_f32 v210, v210, v93
s_waitcnt lgkmcnt(4)
v_mfma_f32_16x16x32_bf16 v[112:115], v[64:67], a[224:227], v[112:115]
buffer_load_dwordx4 a[32:35], v2, s[8:11], s27 offen offset:0 sc1
v_mfma_f32_16x16x32_bf16 v[112:115], v[68:71], a[240:243], v[112:115]
v_exp_f32 v208, v208
v_mfma_f32_16x16x32_bf16 v[116:119], v[64:67], a[228:231], v[116:119]
ds_read_b128 v[56:59], v8 offset:2048
v_mul_f32 v209, v92, v108
v_mfma_f32_16x16x32_bf16 v[116:119], v[68:71], a[244:247], v[116:119]
v_exp_f32 v210, v210
v_mfma_f32_16x16x32_bf16 v[120:123], v[64:67], a[232:235], v[120:123]
v_mul_f32 v211, v93, v109
v_fma_f32 v208, v208, v246, v246
v_mfma_f32_16x16x32_bf16 v[120:123], v[68:71], a[248:251], v[120:123]
ds_read_b128 v[60:63], v8 offset:3072
v_fma_f32 v210, v210, v246, v246
v_mfma_f32_16x16x32_bf16 v[124:127], v[64:67], a[236:239], v[124:127]
buffer_load_dwordx4 a[36:39], v4, s[8:11], s27 offen offset:0 sc1
v_mfma_f32_16x16x32_bf16 v[124:127], v[68:71], a[252:255], v[124:127]
v_mul_f32 v212, v94, v94
s_waitcnt lgkmcnt(4)
v_mfma_f32_16x16x32_bf16 v[128:131], v[72:75], a[224:227], v[128:131]
v_rcp_f32 v208, v208
v_mfma_f32_16x16x32_bf16 v[128:131], v[76:79], a[240:243], v[128:131]
v_rcp_f32 v210, v210
v_mfma_f32_16x16x32_bf16 v[132:135], v[72:75], a[228:231], v[132:135]
ds_read_b128 v[64:67], v8 offset:4096
v_mul_f32 v209, v209, v208
v_mfma_f32_16x16x32_bf16 v[132:135], v[76:79], a[244:247], v[132:135]
buffer_load_dwordx4 a[40:43], v5, s[8:11], s27 offen offset:0 sc1
v_mfma_f32_16x16x32_bf16 v[136:139], v[72:75], a[232:235], v[136:139]
v_mul_f32 v211, v211, v210
v_cvt_pk_bf16_f32 v204, v209, v211
v_mfma_f32_16x16x32_bf16 v[136:139], v[76:79], a[248:251], v[136:139]
ds_read_b128 v[68:71], v8 offset:5120
v_mul_f32 v214, v95, v95
v_mfma_f32_16x16x32_bf16 v[140:143], v[72:75], a[236:239], v[140:143]
v_fma_f32 v212, v212, v245, v244
v_fma_f32 v214, v214, v245, v244
v_mfma_f32_16x16x32_bf16 v[140:143], v[76:79], a[252:255], v[140:143]
v_mul_f32 v212, v212, v94
s_waitcnt lgkmcnt(4)
v_mfma_f32_16x16x32_bf16 v[112:115], v[48:51], v[16:19], v[112:115]
buffer_load_dwordx4 a[44:47], v6, s[8:11], s27 offen offset:0 sc1
v_mfma_f32_16x16x32_bf16 v[112:115], v[52:55], v[32:35], v[112:115]
v_mul_f32 v214, v214, v95
v_mul_f32 v213, v94, v110
v_mfma_f32_16x16x32_bf16 v[116:119], v[48:51], v[20:23], v[116:119]
ds_read_b128 v[72:75], v8 offset:6144
v_mul_f32 v215, v95, v111
v_mfma_f32_16x16x32_bf16 v[116:119], v[52:55], v[36:39], v[116:119]
v_exp_f32 v212, v212
v_mfma_f32_16x16x32_bf16 v[120:123], v[48:51], v[24:27], v[120:123]
v_exp_f32 v214, v214
v_mfma_f32_16x16x32_bf16 v[120:123], v[52:55], v[40:43], v[120:123]
ds_read_b128 v[76:79], v8 offset:7168
v_fma_f32 v212, v212, v246, v246
v_mfma_f32_16x16x32_bf16 v[124:127], v[48:51], v[28:31], v[124:127]
buffer_load_dwordx4 a[48:51], v2, s[8:11], s25 offen offset:1024 sc1
v_mfma_f32_16x16x32_bf16 v[124:127], v[52:55], v[44:47], v[124:127]
v_fma_f32 v214, v214, v246, v246
s_waitcnt lgkmcnt(4)
v_mfma_f32_16x16x32_bf16 v[128:131], v[56:59], v[16:19], v[128:131]
v_rcp_f32 v212, v212
v_mfma_f32_16x16x32_bf16 v[128:131], v[60:63], v[32:35], v[128:131]
v_rcp_f32 v214, v214
v_mfma_f32_16x16x32_bf16 v[132:135], v[56:59], v[20:23], v[132:135]
ds_read_b128 v[48:51], v8 offset:8192
v_mul_f32 v213, v213, v212
v_mfma_f32_16x16x32_bf16 v[132:135], v[60:63], v[36:39], v[132:135]
buffer_load_dwordx4 a[52:55], v4, s[8:11], s25 offen offset:1024 sc1
v_mfma_f32_16x16x32_bf16 v[136:139], v[56:59], v[24:27], v[136:139]
v_mul_f32 v215, v215, v214
v_cvt_pk_bf16_f32 v205, v213, v215
v_mfma_f32_16x16x32_bf16 v[136:139], v[60:63], v[40:43], v[136:139]
ds_read_b128 v[52:55], v8 offset:9216
v_mfma_f32_16x16x32_bf16 v[140:143], v[56:59], v[28:31], v[140:143]
v_mfma_f32_16x16x32_bf16 v[140:143], v[60:63], v[44:47], v[140:143]
s_waitcnt lgkmcnt(4)
v_mfma_f32_16x16x32_bf16 a[112:115], v[64:67], v[144:147], 0
buffer_load_dwordx4 a[56:59], v5, s[8:11], s25 offen offset:1024 sc1
v_mfma_f32_16x16x32_bf16 a[112:115], v[68:71], v[160:163], a[112:115]
v_mfma_f32_16x16x32_bf16 a[116:119], v[64:67], v[148:151], 0
ds_read_b128 v[56:59], v8 offset:10240
v_mfma_f32_16x16x32_bf16 a[116:119], v[68:71], v[164:167], a[116:119]
v_mul_f32 v208, v112, v112
v_mul_f32 v210, v113, v113
v_mfma_f32_16x16x32_bf16 a[120:123], v[64:67], v[152:155], 0
v_fma_f32 v208, v208, v233, v232
v_fma_f32 v210, v210, v233, v232
v_mfma_f32_16x16x32_bf16 a[120:123], v[68:71], v[168:171], a[120:123]
ds_read_b128 v[60:63], v8 offset:11264
v_mul_f32 v208, v208, v112
v_mfma_f32_16x16x32_bf16 a[124:127], v[64:67], v[156:159], 0
buffer_load_dwordx4 a[60:63], v6, s[8:11], s25 offen offset:1024 sc1
v_mfma_f32_16x16x32_bf16 a[124:127], v[68:71], v[172:175], a[124:127]
v_mul_f32 v210, v210, v113
s_waitcnt lgkmcnt(4)
v_mfma_f32_16x16x32_bf16 a[128:131], v[72:75], v[144:147], 0
v_exp_f32 v208, v208
v_mfma_f32_16x16x32_bf16 a[128:131], v[76:79], v[160:163], a[128:131]
v_exp_f32 v210, v210
v_mfma_f32_16x16x32_bf16 a[132:135], v[72:75], v[148:151], 0
ds_read_b128 v[64:67], v8 offset:12288
v_mul_f32 v209, v112, v128
v_mfma_f32_16x16x32_bf16 a[132:135], v[76:79], v[164:167], a[132:135]
v_mul_f32 v211, v113, v129
v_fma_f32 v208, v208, v234, v234
v_mfma_f32_16x16x32_bf16 a[136:139], v[72:75], v[152:155], 0
v_fma_f32 v210, v210, v234, v234
v_mul_f32 v212, v114, v114
v_mfma_f32_16x16x32_bf16 a[136:139], v[76:79], v[168:171], a[136:139]
ds_read_b128 v[68:71], v8 offset:13312
v_mul_f32 v214, v115, v115
v_mfma_f32_16x16x32_bf16 a[140:143], v[72:75], v[156:159], 0
v_rcp_f32 v208, v208
v_mfma_f32_16x16x32_bf16 a[140:143], v[76:79], v[172:175], a[140:143]
v_mul_f32 v209, v209, v208
s_waitcnt lgkmcnt(4)
v_mfma_f32_16x16x32_bf16 a[144:147], v[48:51], v[144:147], 0
v_rcp_f32 v210, v210
v_mfma_f32_16x16x32_bf16 a[144:147], v[52:55], v[160:163], a[144:147]
v_mul_f32 v211, v211, v210
v_cvt_pk_bf16_f32 v194, v209, v211
v_mfma_f32_16x16x32_bf16 a[148:151], v[48:51], v[148:151], 0
ds_read_b128 v[72:75], v8 offset:14336
v_fma_f32 v212, v212, v233, v232
v_mfma_f32_16x16x32_bf16 a[148:151], v[52:55], v[164:167], a[148:151]
v_fma_f32 v214, v214, v233, v232
v_mul_f32 v212, v212, v114
v_mfma_f32_16x16x32_bf16 a[152:155], v[48:51], v[152:155], 0
v_mul_f32 v214, v214, v115
v_mul_f32 v213, v114, v130
v_mfma_f32_16x16x32_bf16 a[152:155], v[52:55], v[168:171], a[152:155]
ds_read_b128 v[76:79], v8 offset:15360
v_mul_f32 v215, v115, v131
v_mfma_f32_16x16x32_bf16 a[156:159], v[48:51], v[156:159], 0
v_exp_f32 v212, v212
v_mfma_f32_16x16x32_bf16 a[156:159], v[52:55], v[172:175], a[156:159]
v_fma_f32 v212, v212, v234, v234
s_waitcnt lgkmcnt(4)
v_mfma_f32_16x16x32_bf16 a[160:163], v[56:59], v[144:147], 0
s_waitcnt vmcnt(41)
v_mul_f32 v208, v116, v116
v_mfma_f32_16x16x32_bf16 a[160:163], v[60:63], v[160:163], a[160:163]
s_barrier
v_mfma_f32_16x16x32_bf16 a[164:167], v[56:59], v[148:151], 0
ds_read_b128 v[48:51], v2 offset:0
s_add_u32 m0, s22, 98304
v_mfma_f32_16x16x32_bf16 a[164:167], v[60:63], v[164:167], a[164:167]
v_add_u32 v3, 20480, v3
buffer_load_dwordx4 v3, s[8:11], 0 offen offset:0 sc1 lds
v_mfma_f32_16x16x32_bf16 a[168:171], v[56:59], v[152:155], 0
v_exp_f32 v214, v214
v_mfma_f32_16x16x32_bf16 a[168:171], v[60:63], v[168:171], a[168:171]
ds_read_b128 v[52:55], v2 offset:1024
v_fma_f32 v214, v214, v234, v234
v_mfma_f32_16x16x32_bf16 a[172:175], v[56:59], v[156:159], 0
v_rcp_f32 v212, v212
v_mfma_f32_16x16x32_bf16 a[172:175], v[60:63], v[172:175], a[172:175]
v_mul_f32 v213, v213, v212
s_waitcnt lgkmcnt(4)
v_mfma_f32_16x16x32_bf16 a[176:179], v[64:67], v[144:147], 0
buffer_load_dwordx4 v3, s[8:11], 0 offen offset:1024 sc1 lds
v_mfma_f32_16x16x32_bf16 a[176:179], v[68:71], v[160:163], a[176:179]
v_rcp_f32 v214, v214
v_mfma_f32_16x16x32_bf16 a[180:183], v[64:67], v[148:151], 0
ds_read_b128 v[56:59], v2 offset:2048
v_mul_f32 v215, v215, v214
v_mfma_f32_16x16x32_bf16 a[180:183], v[68:71], v[164:167], a[180:183]
v_cvt_pk_bf16_f32 v195, v213, v215
v_mul_f32 v210, v117, v117
v_mfma_f32_16x16x32_bf16 a[184:187], v[64:67], v[152:155], 0
buffer_store_dwordx4 v[192:195], v2, s[8:11], s24 offen offset:3072 sc1
v_mfma_f32_16x16x32_bf16 a[184:187], v[68:71], v[168:171], a[184:187]
ds_read_b128 v[60:63], v2 offset:3072
v_fma_f32 v208, v208, v237, v236
v_mfma_f32_16x16x32_bf16 a[188:191], v[64:67], v[156:159], 0
v_fma_f32 v210, v210, v237, v236
v_mul_f32 v208, v208, v116
v_mfma_f32_16x16x32_bf16 a[188:191], v[68:71], v[172:175], a[188:191]
v_mul_f32 v210, v210, v117
s_waitcnt lgkmcnt(4)
v_mfma_f32_16x16x32_bf16 a[192:195], v[72:75], v[144:147], 0
v_exp_f32 v208, v208
v_mfma_f32_16x16x32_bf16 a[192:195], v[76:79], v[160:163], a[192:195]
buffer_load_dwordx4 v3, s[8:11], 0 offen offset:2048 sc1 lds
v_mfma_f32_16x16x32_bf16 a[196:199], v[72:75], v[148:151], 0
ds_read_b128 v[64:67], v2 offset:4096
v_mul_f32 v209, v116, v132
v_mfma_f32_16x16x32_bf16 a[196:199], v[76:79], v[164:167], a[196:199]
v_exp_f32 v210, v210
v_mfma_f32_16x16x32_bf16 a[200:203], v[72:75], v[152:155], 0
v_mul_f32 v211, v117, v133
v_fma_f32 v208, v208, v238, v238
v_mfma_f32_16x16x32_bf16 a[200:203], v[76:79], v[168:171], a[200:203]
ds_read_b128 v[68:71], v2 offset:5120
v_fma_f32 v210, v210, v238, v238
v_mfma_f32_16x16x32_bf16 a[204:207], v[72:75], v[156:159], 0
buffer_load_dwordx4 v3, s[8:11], 0 offen offset:3072 sc1 lds
v_mfma_f32_16x16x32_bf16 a[204:207], v[76:79], v[172:175], a[204:207]
s_add_u32 m0, s22, 102400
s_waitcnt lgkmcnt(4)
v_mfma_f32_16x16x32_bf16 a[208:211], v[48:51], v[144:147], 0
v_add_u32 v3, 4096, v3
v_mul_f32 v212, v118, v118
v_mfma_f32_16x16x32_bf16 a[208:211], v[52:55], v[160:163], a[208:211]
v_rcp_f32 v208, v208
v_mfma_f32_16x16x32_bf16 a[212:215], v[48:51], v[148:151], 0
ds_read_b128 v[72:75], v2 offset:6144
v_mul_f32 v209, v209, v208
v_mfma_f32_16x16x32_bf16 a[212:215], v[52:55], v[164:167], a[212:215]
buffer_load_dwordx4 v3, s[8:11], 0 offen offset:0 sc1 lds
v_mfma_f32_16x16x32_bf16 a[216:219], v[48:51], v[152:155], 0
v_rcp_f32 v210, v210
v_mfma_f32_16x16x32_bf16 a[216:219], v[52:55], v[168:171], a[216:219]
ds_read_b128 v[76:79], v2 offset:7168
v_mul_f32 v211, v211, v210
v_mfma_f32_16x16x32_bf16 a[220:223], v[48:51], v[156:159], 0
v_cvt_pk_bf16_f32 v198, v209, v211
v_mul_f32 v214, v119, v119
v_mfma_f32_16x16x32_bf16 a[220:223], v[52:55], v[172:175], a[220:223]
v_fma_f32 v212, v212, v237, v236
s_waitcnt lgkmcnt(4)
v_mfma_f32_16x16x32_bf16 a[224:227], v[56:59], v[144:147], 0
buffer_load_dwordx4 v3, s[8:11], 0 offen offset:1024 sc1 lds
v_mfma_f32_16x16x32_bf16 a[224:227], v[60:63], v[160:163], a[224:227]
s_add_u32 s23, s34, 131072
v_fma_f32 v214, v214, v237, v236
v_mfma_f32_16x16x32_bf16 a[228:231], v[56:59], v[148:151], 0
ds_read_b128 v[48:51], v2 offset:8192
v_mul_f32 v212, v212, v118
v_mfma_f32_16x16x32_bf16 a[228:231], v[60:63], v[164:167], a[228:231]
v_mul_f32 v214, v214, v119
v_mul_f32 v213, v118, v134
v_mfma_f32_16x16x32_bf16 a[232:235], v[56:59], v[152:155], 0
v_exp_f32 v212, v212
v_mfma_f32_16x16x32_bf16 a[232:235], v[60:63], v[168:171], a[232:235]
ds_read_b128 v[52:55], v2 offset:9216
v_mul_f32 v215, v119, v135
v_mfma_f32_16x16x32_bf16 a[236:239], v[56:59], v[156:159], 0
buffer_load_dwordx2 v[14:15], v11, s[8:11], s23 offen sc1
v_mfma_f32_16x16x32_bf16 a[236:239], v[60:63], v[172:175], a[236:239]
v_fma_f32 v212, v212, v238, v238
s_waitcnt vmcnt(27)
s_waitcnt lgkmcnt(4)
v_mfma_f32_16x16x32_bf16 a[112:115], v[64:67], v[176:179], a[112:115]
v_exp_f32 v214, v214
v_mfma_f32_16x16x32_bf16 a[112:115], v[68:71], a[0:3], a[112:115]
v_fma_f32 v214, v214, v238, v238
v_mul_f32 v208, v120, v120
v_mfma_f32_16x16x32_bf16 a[116:119], v[64:67], v[180:183], a[116:119]
ds_read_b128 v[56:59], v2 offset:10240
v_mul_f32 v210, v121, v121
v_mfma_f32_16x16x32_bf16 a[116:119], v[68:71], a[4:7], a[116:119]
buffer_load_dwordx4 a[64:67], v2, s[8:11], s26 offen offset:1024 sc1
v_mfma_f32_16x16x32_bf16 a[120:123], v[64:67], v[184:187], a[120:123]
v_rcp_f32 v212, v212
v_mfma_f32_16x16x32_bf16 a[120:123], v[68:71], a[8:11], a[120:123]
ds_read_b128 v[60:63], v2 offset:11264
v_mul_f32 v213, v213, v212
v_mfma_f32_16x16x32_bf16 a[124:127], v[64:67], v[188:191], a[124:127]
v_rcp_f32 v214, v214
v_mfma_f32_16x16x32_bf16 a[124:127], v[68:71], a[12:15], a[124:127]
v_mul_f32 v215, v215, v214
s_waitcnt lgkmcnt(4)
v_mfma_f32_16x16x32_bf16 a[128:131], v[72:75], v[176:179], a[128:131]
buffer_load_dwordx4 a[68:71], v4, s[8:11], s26 offen offset:1024 sc1
v_mfma_f32_16x16x32_bf16 a[128:131], v[76:79], a[0:3], a[128:131]
v_cvt_pk_bf16_f32 v199, v213, v215
v_fma_f32 v208, v208, v241, v240
v_mfma_f32_16x16x32_bf16 a[132:135], v[72:75], v[180:183], a[132:135]
ds_read_b128 v[64:67], v2 offset:12288
v_fma_f32 v210, v210, v241, v240
v_mfma_f32_16x16x32_bf16 a[132:135], v[76:79], a[4:7], a[132:135]
buffer_store_dwordx4 v[196:199], v4, s[8:11], s24 offen offset:3072 sc1
v_mfma_f32_16x16x32_bf16 a[136:139], v[72:75], v[184:187], a[136:139]
v_mul_f32 v208, v208, v120
v_mul_f32 v210, v210, v121
v_mfma_f32_16x16x32_bf16 a[136:139], v[76:79], a[8:11], a[136:139]
ds_read_b128 v[68:71], v2 offset:13312
v_mul_f32 v209, v120, v136
v_mfma_f32_16x16x32_bf16 a[140:143], v[72:75], v[188:191], a[140:143]
v_exp_f32 v208, v208
v_mfma_f32_16x16x32_bf16 a[140:143], v[76:79], a[12:15], a[140:143]
v_mul_f32 v211, v121, v137
s_waitcnt lgkmcnt(4)
v_mfma_f32_16x16x32_bf16 a[144:147], v[48:51], v[176:179], a[144:147]
buffer_load_dwordx4 a[72:75], v5, s[8:11], s26 offen offset:1024 sc1
v_mfma_f32_16x16x32_bf16 a[144:147], v[52:55], a[0:3], a[144:147]
v_exp_f32 v210, v210
v_mfma_f32_16x16x32_bf16 a[148:151], v[48:51], v[180:183], a[148:151]
ds_read_b128 v[72:75], v2 offset:14336
v_fma_f32 v208, v208, v242, v242
v_mfma_f32_16x16x32_bf16 a[148:151], v[52:55], a[4:7], a[148:151]
v_fma_f32 v210, v210, v242, v242
v_mul_f32 v212, v122, v122
v_mfma_f32_16x16x32_bf16 a[152:155], v[48:51], v[184:187], a[152:155]
v_rcp_f32 v208, v208
v_mfma_f32_16x16x32_bf16 a[152:155], v[52:55], a[8:11], a[152:155]
ds_read_b128 v[76:79], v2 offset:15360
v_mul_f32 v209, v209, v208
v_mfma_f32_16x16x32_bf16 a[156:159], v[48:51], v[188:191], a[156:159]
buffer_load_dwordx4 a[76:79], v6, s[8:11], s26 offen offset:1024 sc1
v_mfma_f32_16x16x32_bf16 a[156:159], v[52:55], a[12:15], a[156:159]
v_mul_f32 v214, v123, v123
s_waitcnt lgkmcnt(4)
v_mfma_f32_16x16x32_bf16 a[160:163], v[56:59], v[176:179], a[160:163]
v_rcp_f32 v210, v210
v_mfma_f32_16x16x32_bf16 a[160:163], v[60:63], a[0:3], a[160:163]
v_mul_f32 v211, v211, v210
v_cvt_pk_bf16_f32 v202, v209, v211
v_mfma_f32_16x16x32_bf16 a[164:167], v[56:59], v[180:183], a[164:167]
ds_read_b128 v[48:51], v2 offset:16384
v_fma_f32 v212, v212, v241, v240
v_mfma_f32_16x16x32_bf16 a[164:167], v[60:63], a[4:7], a[164:167]
buffer_load_dwordx4 a[80:83], v2, s[8:11], s27 offen offset:1024 sc1
v_mfma_f32_16x16x32_bf16 a[168:171], v[56:59], v[184:187], a[168:171]
v_fma_f32 v214, v214, v241, v240
v_mul_f32 v212, v212, v122
v_mfma_f32_16x16x32_bf16 a[168:171], v[60:63], a[8:11], a[168:171]
ds_read_b128 v[52:55], v2 offset:17408
v_mul_f32 v214, v214, v123
v_mfma_f32_16x16x32_bf16 a[172:175], v[56:59], v[188:191], a[172:175]
v_exp_f32 v212, v212
v_mfma_f32_16x16x32_bf16 a[172:175], v[60:63], a[12:15], a[172:175]
v_exp_f32 v214, v214
s_waitcnt lgkmcnt(4)
v_mfma_f32_16x16x32_bf16 a[176:179], v[64:67], v[176:179], a[176:179]
buffer_load_dwordx4 a[84:87], v4, s[8:11], s27 offen offset:1024 sc1
v_mfma_f32_16x16x32_bf16 a[176:179], v[68:71], a[0:3], a[176:179]
v_mul_f32 v213, v122, v138
v_mul_f32 v215, v123, v139
v_mfma_f32_16x16x32_bf16 a[180:183], v[64:67], v[180:183], a[180:183]
ds_read_b128 v[56:59], v2 offset:18432
v_fma_f32 v212, v212, v242, v242
v_mfma_f32_16x16x32_bf16 a[180:183], v[68:71], a[4:7], a[180:183]
v_fma_f32 v214, v214, v242, v242
v_rcp_f32 v212, v212
v_mfma_f32_16x16x32_bf16 a[184:187], v[64:67], v[184:187], a[184:187]
v_rcp_f32 v214, v214
v_mfma_f32_16x16x32_bf16 a[184:187], v[68:71], a[8:11], a[184:187]
ds_read_b128 v[60:63], v2 offset:19456
v_mul_f32 v213, v213, v212
v_mfma_f32_16x16x32_bf16 a[188:191], v[64:67], v[188:191], a[188:191]
buffer_load_dwordx4 a[88:91], v5, s[8:11], s27 offen offset:1024 sc1
v_mul_f32 v215, v215, v214
v_mfma_f32_16x16x32_bf16 a[188:191], v[68:71], a[12:15], a[188:191]
v_cvt_pk_bf16_f32 v203, v213, v215
s_waitcnt lgkmcnt(4)
v_mfma_f32_16x16x32_bf16 a[192:195], v[72:75], v[176:179], a[192:195]
buffer_store_dwordx4 v[200:203], v5, s[8:11], s24 offen offset:3072 sc1
v_mfma_f32_16x16x32_bf16 a[192:195], v[76:79], a[0:3], a[192:195]
v_mul_f32 v208, v124, v124
v_mul_f32 v210, v125, v125
v_mfma_f32_16x16x32_bf16 a[196:199], v[72:75], v[180:183], a[196:199]
ds_read_b128 v[64:67], v2 offset:20480
v_fma_f32 v208, v208, v245, v244
v_mfma_f32_16x16x32_bf16 a[196:199], v[76:79], a[4:7], a[196:199]
v_fma_f32 v210, v210, v245, v244
v_mul_f32 v208, v208, v124
v_mfma_f32_16x16x32_bf16 a[200:203], v[72:75], v[184:187], a[200:203]
v_mul_f32 v210, v210, v125
v_exp_f32 v208, v208
v_mfma_f32_16x16x32_bf16 a[200:203], v[76:79], a[8:11], a[200:203]
ds_read_b128 v[68:71], v2 offset:21504
v_exp_f32 v210, v210
v_mfma_f32_16x16x32_bf16 a[204:207], v[72:75], v[188:191], a[204:207]
buffer_load_dwordx4 a[92:95], v6, s[8:11], s27 offen offset:1024 sc1
v_mul_f32 v209, v124, v140
v_mfma_f32_16x16x32_bf16 a[204:207], v[76:79], a[12:15], a[204:207]
v_mul_f32 v211, v125, v141
s_waitcnt lgkmcnt(4)
v_mfma_f32_16x16x32_bf16 a[208:211], v[48:51], v[176:179], a[208:211]
v_fma_f32 v208, v208, v246, v246
v_fma_f32 v210, v210, v246, v246
v_mfma_f32_16x16x32_bf16 a[208:211], v[52:55], a[0:3], a[208:211]
v_rcp_f32 v208, v208
v_mfma_f32_16x16x32_bf16 a[212:215], v[48:51], v[180:183], a[212:215]
ds_read_b128 v[72:75], v2 offset:22528
v_rcp_f32 v210, v210
v_mfma_f32_16x16x32_bf16 a[212:215], v[52:55], a[4:7], a[212:215]
buffer_load_dwordx2 a[96:97], v248, s[8:11], s28 offen offset:0 sc1
v_mul_f32 v209, v209, v208
v_mfma_f32_16x16x32_bf16 a[216:219], v[48:51], v[184:187], a[216:219]
v_mul_f32 v211, v211, v210
v_cvt_pk_bf16_f32 v206, v209, v211
v_mfma_f32_16x16x32_bf16 a[216:219], v[52:55], a[8:11], a[216:219]
ds_read_b128 v[76:79], v2 offset:23552
v_mul_f32 v212, v126, v126
v_mfma_f32_16x16x32_bf16 a[220:223], v[48:51], v[188:191], a[220:223]
v_mul_f32 v214, v127, v127
v_fma_f32 v212, v212, v245, v244
v_mfma_f32_16x16x32_bf16 a[220:223], v[52:55], a[12:15], a[220:223]
v_fma_f32 v214, v214, v245, v244
s_waitcnt lgkmcnt(4)
v_mfma_f32_16x16x32_bf16 a[224:227], v[56:59], v[176:179], a[224:227]
s_waitcnt vmcnt(52)
v_mul_f32 v212, v212, v126
v_mfma_f32_16x16x32_bf16 a[224:227], v[60:63], a[0:3], a[224:227]
s_barrier
v_mfma_f32_16x16x32_bf16 a[228:231], v[56:59], v[180:183], a[228:231]
ds_read_b128 v[48:51], v2 offset:24576
buffer_load_dwordx2 a[98:99], v248, s[8:11], s28 offen offset:512 sc1
v_mul_f32 v214, v214, v127
v_mfma_f32_16x16x32_bf16 a[228:231], v[60:63], a[4:7], a[228:231]
v_exp_f32 v212, v212
v_mfma_f32_16x16x32_bf16 a[232:235], v[56:59], v[184:187], a[232:235]
v_exp_f32 v214, v214
v_mfma_f32_16x16x32_bf16 a[232:235], v[60:63], a[8:11], a[232:235]
ds_read_b128 v[52:55], v2 offset:25600
v_mul_f32 v213, v126, v142
v_mfma_f32_16x16x32_bf16 a[236:239], v[56:59], v[188:191], a[236:239]
v_mul_f32 v215, v127, v143
v_fma_f32 v212, v212, v246, v246
v_mfma_f32_16x16x32_bf16 a[236:239], v[60:63], a[12:15], a[236:239]
v_fma_f32 v214, v214, v246, v246
v_rcp_f32 v212, v212
v_rcp_f32 v214, v214
v_mul_f32 v213, v213, v212
v_mul_f32 v215, v215, v214
v_cvt_pk_bf16_f32 v207, v213, v215
buffer_store_dwordx4 v[204:207], v6, s[8:11], s24 offen offset:3072 sc1
s_waitcnt vmcnt(25)
s_waitcnt lgkmcnt(4)
v_mfma_f32_16x16x32_bf16 a[112:115], v[64:67], a[16:19], a[112:115]
buffer_load_dwordx2 a[100:101], v249, s[8:11], s28 offen offset:0 sc1
v_mfma_f32_16x16x32_bf16 a[112:115], v[68:71], a[32:35], a[112:115]
v_mfma_f32_16x16x32_bf16 a[116:119], v[64:67], a[20:23], a[116:119]
ds_read_b128 v[56:59], v2 offset:26624
v_mfma_f32_16x16x32_bf16 a[116:119], v[68:71], a[36:39], a[116:119]
v_mfma_f32_16x16x32_bf16 a[120:123], v[64:67], a[24:27], a[120:123]
v_mfma_f32_16x16x32_bf16 a[120:123], v[68:71], a[40:43], a[120:123]
ds_read_b128 v[60:63], v2 offset:27648
v_mfma_f32_16x16x32_bf16 a[124:127], v[64:67], a[28:31], a[124:127]
buffer_load_dwordx2 a[102:103], v249, s[8:11], s28 offen offset:512 sc1
v_mfma_f32_16x16x32_bf16 a[124:127], v[68:71], a[44:47], a[124:127]
s_waitcnt lgkmcnt(4)
v_mfma_f32_16x16x32_bf16 a[128:131], v[72:75], a[16:19], a[128:131]
v_mfma_f32_16x16x32_bf16 a[128:131], v[76:79], a[32:35], a[128:131]
v_mfma_f32_16x16x32_bf16 a[132:135], v[72:75], a[20:23], a[132:135]
ds_read_b128 v[64:67], v2 offset:28672
v_mfma_f32_16x16x32_bf16 a[132:135], v[76:79], a[36:39], a[132:135]
buffer_load_dwordx2 a[104:105], v250, s[8:11], s28 offen offset:0 sc1
v_mfma_f32_16x16x32_bf16 a[136:139], v[72:75], a[24:27], a[136:139]
v_mfma_f32_16x16x32_bf16 a[136:139], v[76:79], a[40:43], a[136:139]
ds_read_b128 v[68:71], v2 offset:29696
v_mfma_f32_16x16x32_bf16 a[140:143], v[72:75], a[28:31], a[140:143]
v_mfma_f32_16x16x32_bf16 a[140:143], v[76:79], a[44:47], a[140:143]
s_waitcnt lgkmcnt(4)
v_mfma_f32_16x16x32_bf16 a[144:147], v[48:51], a[16:19], a[144:147]
buffer_load_dwordx2 a[106:107], v250, s[8:11], s28 offen offset:512 sc1
v_mfma_f32_16x16x32_bf16 a[144:147], v[52:55], a[32:35], a[144:147]
v_mfma_f32_16x16x32_bf16 a[148:151], v[48:51], a[20:23], a[148:151]
ds_read_b128 v[72:75], v2 offset:30720
v_mfma_f32_16x16x32_bf16 a[148:151], v[52:55], a[36:39], a[148:151]
v_mfma_f32_16x16x32_bf16 a[152:155], v[48:51], a[24:27], a[152:155]
v_mfma_f32_16x16x32_bf16 a[152:155], v[52:55], a[40:43], a[152:155]
ds_read_b128 v[76:79], v2 offset:31744
v_mfma_f32_16x16x32_bf16 a[156:159], v[48:51], a[28:31], a[156:159]
buffer_load_dwordx2 a[108:109], v251, s[8:11], s28 offen offset:0 sc1
v_mfma_f32_16x16x32_bf16 a[156:159], v[52:55], a[44:47], a[156:159]
s_waitcnt lgkmcnt(4)
v_mfma_f32_16x16x32_bf16 a[160:163], v[56:59], a[16:19], a[160:163]
v_mfma_f32_16x16x32_bf16 a[160:163], v[60:63], a[32:35], a[160:163]
v_mfma_f32_16x16x32_bf16 a[164:167], v[56:59], a[20:23], a[164:167]
ds_read_b128 v[48:51], v2 offset:32768
v_mfma_f32_16x16x32_bf16 a[164:167], v[60:63], a[36:39], a[164:167]
buffer_load_dwordx2 a[110:111], v251, s[8:11], s28 offen offset:512 sc1
v_mfma_f32_16x16x32_bf16 a[168:171], v[56:59], a[24:27], a[168:171]
s_add_u32 m0, s22, 122880
v_add_u32 v3, 20480, v3
v_mfma_f32_16x16x32_bf16 a[168:171], v[60:63], a[40:43], a[168:171]
ds_read_b128 v[52:55], v2 offset:33792
v_mfma_f32_16x16x32_bf16 a[172:175], v[56:59], a[28:31], a[172:175]
v_mfma_f32_16x16x32_bf16 a[172:175], v[60:63], a[44:47], a[172:175]
s_waitcnt lgkmcnt(4)
v_mfma_f32_16x16x32_bf16 a[176:179], v[64:67], a[16:19], a[176:179]
buffer_load_dwordx4 v3, s[8:11], 0 offen offset:0 sc1 lds
v_mfma_f32_16x16x32_bf16 a[176:179], v[68:71], a[32:35], a[176:179]
v_mfma_f32_16x16x32_bf16 a[180:183], v[64:67], a[20:23], a[180:183]
ds_read_b128 v[56:59], v2 offset:34816
v_mfma_f32_16x16x32_bf16 a[180:183], v[68:71], a[36:39], a[180:183]
v_mfma_f32_16x16x32_bf16 a[184:187], v[64:67], a[24:27], a[184:187]
v_mfma_f32_16x16x32_bf16 a[184:187], v[68:71], a[40:43], a[184:187]
ds_read_b128 v[60:63], v2 offset:35840
v_mfma_f32_16x16x32_bf16 a[188:191], v[64:67], a[28:31], a[188:191]
buffer_load_dwordx4 v3, s[8:11], 0 offen offset:1024 sc1 lds
v_mfma_f32_16x16x32_bf16 a[188:191], v[68:71], a[44:47], a[188:191]
s_waitcnt lgkmcnt(4)
v_mfma_f32_16x16x32_bf16 a[192:195], v[72:75], a[16:19], a[192:195]
v_mfma_f32_16x16x32_bf16 a[192:195], v[76:79], a[32:35], a[192:195]
v_mfma_f32_16x16x32_bf16 a[196:199], v[72:75], a[20:23], a[196:199]
ds_read_b128 v[64:67], v2 offset:36864
v_mfma_f32_16x16x32_bf16 a[196:199], v[76:79], a[36:39], a[196:199]
buffer_load_dwordx4 v3, s[8:11], 0 offen offset:2048 sc1 lds
v_mfma_f32_16x16x32_bf16 a[200:203], v[72:75], a[24:27], a[200:203]
v_mfma_f32_16x16x32_bf16 a[200:203], v[76:79], a[40:43], a[200:203]
ds_read_b128 v[68:71], v2 offset:37888
v_mfma_f32_16x16x32_bf16 a[204:207], v[72:75], a[28:31], a[204:207]
v_mfma_f32_16x16x32_bf16 a[204:207], v[76:79], a[44:47], a[204:207]
s_waitcnt lgkmcnt(4)
v_mfma_f32_16x16x32_bf16 a[208:211], v[48:51], a[16:19], a[208:211]
buffer_load_dwordx4 v3, s[8:11], 0 offen offset:3072 sc1 lds
v_mfma_f32_16x16x32_bf16 a[208:211], v[52:55], a[32:35], a[208:211]
s_add_u32 m0, s22, 126976
v_add_u32 v3, 4096, v3
v_mfma_f32_16x16x32_bf16 a[212:215], v[48:51], a[20:23], a[212:215]
ds_read_b128 v[72:75], v2 offset:38912
v_mfma_f32_16x16x32_bf16 a[212:215], v[52:55], a[36:39], a[212:215]
v_mfma_f32_16x16x32_bf16 a[216:219], v[48:51], a[24:27], a[216:219]
v_mfma_f32_16x16x32_bf16 a[216:219], v[52:55], a[40:43], a[216:219]
ds_read_b128 v[76:79], v2 offset:39936
v_mfma_f32_16x16x32_bf16 a[220:223], v[48:51], a[28:31], a[220:223]
buffer_load_dwordx4 v3, s[8:11], 0 offen offset:0 sc1 lds
v_mfma_f32_16x16x32_bf16 a[220:223], v[52:55], a[44:47], a[220:223]
s_waitcnt lgkmcnt(4)
v_mfma_f32_16x16x32_bf16 a[224:227], v[56:59], a[16:19], a[224:227]
v_mfma_f32_16x16x32_bf16 a[224:227], v[60:63], a[32:35], a[224:227]
v_mfma_f32_16x16x32_bf16 a[228:231], v[56:59], a[20:23], a[228:231]
ds_read_b128 v[48:51], v2 offset:40960
v_mfma_f32_16x16x32_bf16 a[228:231], v[60:63], a[36:39], a[228:231]
buffer_load_dwordx4 v3, s[8:11], 0 offen offset:1024 sc1 lds
v_mfma_f32_16x16x32_bf16 a[232:235], v[56:59], a[24:27], a[232:235]
v_mfma_f32_16x16x32_bf16 a[232:235], v[60:63], a[40:43], a[232:235]
ds_read_b128 v[52:55], v2 offset:41984
v_mfma_f32_16x16x32_bf16 a[236:239], v[56:59], a[28:31], a[236:239]
v_mfma_f32_16x16x32_bf16 a[236:239], v[60:63], a[44:47], a[236:239]
s_waitcnt vmcnt(20)
s_waitcnt lgkmcnt(4)
v_mfma_f32_16x16x32_bf16 a[112:115], v[64:67], a[48:51], a[112:115]
buffer_load_dwordx2 v[16:17], v248, s[8:11], s29 offen offset:0 sc1
v_mfma_f32_16x16x32_bf16 a[112:115], v[68:71], a[64:67], a[112:115]
v_mfma_f32_16x16x32_bf16 a[116:119], v[64:67], a[52:55], a[116:119]
ds_read_b128 v[56:59], v2 offset:43008
v_mfma_f32_16x16x32_bf16 a[116:119], v[68:71], a[68:71], a[116:119]
v_mfma_f32_16x16x32_bf16 a[120:123], v[64:67], a[56:59], a[120:123]
v_mfma_f32_16x16x32_bf16 a[120:123], v[68:71], a[72:75], a[120:123]
ds_read_b128 v[60:63], v2 offset:44032
v_mfma_f32_16x16x32_bf16 a[124:127], v[64:67], a[60:63], a[124:127]
buffer_load_dwordx2 v[18:19], v248, s[8:11], s29 offen offset:512 sc1
v_mfma_f32_16x16x32_bf16 a[124:127], v[68:71], a[76:79], a[124:127]
s_waitcnt lgkmcnt(4)
v_mfma_f32_16x16x32_bf16 a[128:131], v[72:75], a[48:51], a[128:131]
v_mfma_f32_16x16x32_bf16 a[128:131], v[76:79], a[64:67], a[128:131]
v_mfma_f32_16x16x32_bf16 a[132:135], v[72:75], a[52:55], a[132:135]
ds_read_b128 v[64:67], v2 offset:45056
v_mfma_f32_16x16x32_bf16 a[132:135], v[76:79], a[68:71], a[132:135]
buffer_load_dwordx2 v[20:21], v249, s[8:11], s29 offen offset:0 sc1
v_mfma_f32_16x16x32_bf16 a[136:139], v[72:75], a[56:59], a[136:139]
v_mfma_f32_16x16x32_bf16 a[136:139], v[76:79], a[72:75], a[136:139]
ds_read_b128 v[68:71], v2 offset:46080
v_mfma_f32_16x16x32_bf16 a[140:143], v[72:75], a[60:63], a[140:143]
v_mfma_f32_16x16x32_bf16 a[140:143], v[76:79], a[76:79], a[140:143]
s_waitcnt lgkmcnt(4)
v_mfma_f32_16x16x32_bf16 a[144:147], v[48:51], a[48:51], a[144:147]
v_mov_b32 v12, s68
v_mov_b32 v13, s69
v_mfma_f32_16x16x32_bf16 a[144:147], v[52:55], a[64:67], a[144:147]
s_add_u32 s53, s34, 262144
s_waitcnt vmcnt(15)
v_mfma_f32_16x16x32_bf16 a[148:151], v[48:51], a[52:55], a[148:151]
ds_read_b128 v[72:75], v2 offset:47104
buffer_store_dwordx2 v[12:13], v10, s[8:11], s53 offen sc1
v_mfma_f32_16x16x32_bf16 a[148:151], v[52:55], a[68:71], a[148:151]
v_mfma_f32_16x16x32_bf16 a[152:155], v[48:51], a[56:59], a[152:155]
v_mfma_f32_16x16x32_bf16 a[152:155], v[52:55], a[72:75], a[152:155]
ds_read_b128 v[76:79], v2 offset:48128
v_mfma_f32_16x16x32_bf16 a[156:159], v[48:51], a[60:63], a[156:159]
v_mfma_f32_16x16x32_bf16 a[156:159], v[52:55], a[76:79], a[156:159]
s_waitcnt lgkmcnt(4)
v_mfma_f32_16x16x32_bf16 a[160:163], v[56:59], a[48:51], a[160:163]
s_waitcnt vmcnt(60)
v_mfma_f32_16x16x32_bf16 a[160:163], v[60:63], a[64:67], a[160:163]
s_barrier
v_mfma_f32_16x16x32_bf16 a[164:167], v[56:59], a[52:55], a[164:167]
ds_read_b128 v[48:51], v2 offset:49152
buffer_load_dwordx2 v[22:23], v249, s[8:11], s29 offen offset:512 sc1
v_mfma_f32_16x16x32_bf16 a[164:167], v[60:63], a[68:71], a[164:167]
v_mfma_f32_16x16x32_bf16 a[168:171], v[56:59], a[56:59], a[168:171]
v_mfma_f32_16x16x32_bf16 a[168:171], v[60:63], a[72:75], a[168:171]
ds_read_b128 v[52:55], v2 offset:50176
v_mfma_f32_16x16x32_bf16 a[172:175], v[56:59], a[60:63], a[172:175]
v_mfma_f32_16x16x32_bf16 a[172:175], v[60:63], a[76:79], a[172:175]
s_waitcnt lgkmcnt(4)
v_mfma_f32_16x16x32_bf16 a[176:179], v[64:67], a[48:51], a[176:179]
buffer_load_dwordx2 v[24:25], v250, s[8:11], s29 offen offset:0 sc1
v_mfma_f32_16x16x32_bf16 a[176:179], v[68:71], a[64:67], a[176:179]
v_mfma_f32_16x16x32_bf16 a[180:183], v[64:67], a[52:55], a[180:183]
ds_read_b128 v[56:59], v2 offset:51200
v_mfma_f32_16x16x32_bf16 a[180:183], v[68:71], a[68:71], a[180:183]
v_mfma_f32_16x16x32_bf16 a[184:187], v[64:67], a[56:59], a[184:187]
v_mfma_f32_16x16x32_bf16 a[184:187], v[68:71], a[72:75], a[184:187]
ds_read_b128 v[60:63], v2 offset:52224
v_mfma_f32_16x16x32_bf16 a[188:191], v[64:67], a[60:63], a[188:191]
buffer_load_dwordx2 v[26:27], v250, s[8:11], s29 offen offset:512 sc1
v_mfma_f32_16x16x32_bf16 a[188:191], v[68:71], a[76:79], a[188:191]
s_waitcnt lgkmcnt(4)
v_mfma_f32_16x16x32_bf16 a[192:195], v[72:75], a[48:51], a[192:195]
v_mfma_f32_16x16x32_bf16 a[192:195], v[76:79], a[64:67], a[192:195]
v_mfma_f32_16x16x32_bf16 a[196:199], v[72:75], a[52:55], a[196:199]
ds_read_b128 v[64:67], v2 offset:53248
v_mfma_f32_16x16x32_bf16 a[196:199], v[76:79], a[68:71], a[196:199]
buffer_load_dwordx2 v[28:29], v251, s[8:11], s29 offen offset:0 sc1
v_mfma_f32_16x16x32_bf16 a[200:203], v[72:75], a[56:59], a[200:203]
v_mfma_f32_16x16x32_bf16 a[200:203], v[76:79], a[72:75], a[200:203]
ds_read_b128 v[68:71], v2 offset:54272
v_mfma_f32_16x16x32_bf16 a[204:207], v[72:75], a[60:63], a[204:207]
v_mfma_f32_16x16x32_bf16 a[204:207], v[76:79], a[76:79], a[204:207]
s_waitcnt lgkmcnt(4)
v_mfma_f32_16x16x32_bf16 a[208:211], v[48:51], a[48:51], a[208:211]
buffer_load_dwordx2 v[30:31], v251, s[8:11], s29 offen offset:512 sc1
v_mfma_f32_16x16x32_bf16 a[208:211], v[52:55], a[64:67], a[208:211]
s_waitcnt vmcnt(34)
v_cmp_eq_u64 vcc, s[68:69], v[14:15]
s_nop 0
s_cmp_eq_u64 vcc, exec
s_cbranch_scc0 L_f_slow2
L_f_back2:
v_mfma_f32_16x16x32_bf16 a[212:215], v[48:51], a[52:55], a[212:215]
ds_read_b128 v[72:75], v2 offset:55296
v_mfma_f32_16x16x32_bf16 a[212:215], v[52:55], a[68:71], a[212:215]
v_mfma_f32_16x16x32_bf16 a[216:219], v[48:51], a[56:59], a[216:219]
v_mfma_f32_16x16x32_bf16 a[216:219], v[52:55], a[72:75], a[216:219]
ds_read_b128 v[76:79], v2 offset:56320
v_mfma_f32_16x16x32_bf16 a[220:223], v[48:51], a[60:63], a[220:223]
buffer_load_dwordx4 v[32:35], v2, s[8:11], s25 offen offset:2048 sc1
v_mfma_f32_16x16x32_bf16 a[220:223], v[52:55], a[76:79], a[220:223]
s_waitcnt lgkmcnt(4)
v_mfma_f32_16x16x32_bf16 a[224:227], v[56:59], a[48:51], a[224:227]
v_mfma_f32_16x16x32_bf16 a[224:227], v[60:63], a[64:67], a[224:227]
v_mfma_f32_16x16x32_bf16 a[228:231], v[56:59], a[52:55], a[228:231]
ds_read_b128 v[48:51], v2 offset:57344
v_mfma_f32_16x16x32_bf16 a[228:231], v[60:63], a[68:71], a[228:231]
buffer_load_dwordx4 v[36:39], v4, s[8:11], s25 offen offset:2048 sc1
v_mfma_f32_16x16x32_bf16 a[232:235], v[56:59], a[56:59], a[232:235]
v_mfma_f32_16x16x32_bf16 a[232:235], v[60:63], a[72:75], a[232:235]
ds_read_b128 v[52:55], v2 offset:58368
v_mfma_f32_16x16x32_bf16 a[236:239], v[56:59], a[60:63], a[236:239]
v_mfma_f32_16x16x32_bf16 a[236:239], v[60:63], a[76:79], a[236:239]
s_waitcnt vmcnt(17)
s_waitcnt lgkmcnt(4)
v_mfma_f32_16x16x32_bf16 a[112:115], v[64:67], a[80:83], a[112:115]
buffer_load_dwordx4 v[40:43], v5, s[8:11], s25 offen offset:2048 sc1
v_mfma_f32_16x16x32_bf16 a[112:115], v[68:71], a[96:99], a[112:115]
v_mfma_f32_16x16x32_bf16 a[116:119], v[64:67], a[84:87], a[116:119]
ds_read_b128 v[56:59], v2 offset:59392
v_mfma_f32_16x16x32_bf16 a[116:119], v[68:71], a[100:103], a[116:119]
v_mfma_f32_16x16x32_bf16 a[120:123], v[64:67], a[88:91], a[120:123]
v_mfma_f32_16x16x32_bf16 a[120:123], v[68:71], a[104:107], a[120:123]
ds_read_b128 v[60:63], v2 offset:60416
v_mfma_f32_16x16x32_bf16 a[124:127], v[64:67], a[92:95], a[124:127]
buffer_load_dwordx4 v[44:47], v6, s[8:11], s25 offen offset:2048 sc1
v_mfma_f32_16x16x32_bf16 a[124:127], v[68:71], a[108:111], a[124:127]
s_waitcnt lgkmcnt(4)
v_mfma_f32_16x16x32_bf16 a[128:131], v[72:75], a[80:83], a[128:131]
v_mfma_f32_16x16x32_bf16 a[128:131], v[76:79], a[96:99], a[128:131]
v_mfma_f32_16x16x32_bf16 a[132:135], v[72:75], a[84:87], a[132:135]
ds_read_b128 v[64:67], v2 offset:61440
v_mfma_f32_16x16x32_bf16 a[132:135], v[76:79], a[100:103], a[132:135]
buffer_load_dwordx4 v[80:83], v2, s[8:11], s26 offen offset:2048 sc1
v_mfma_f32_16x16x32_bf16 a[136:139], v[72:75], a[88:91], a[136:139]
v_mfma_f32_16x16x32_bf16 a[136:139], v[76:79], a[104:107], a[136:139]
ds_read_b128 v[68:71], v2 offset:62464
v_mfma_f32_16x16x32_bf16 a[140:143], v[72:75], a[92:95], a[140:143]
v_mfma_f32_16x16x32_bf16 a[140:143], v[76:79], a[108:111], a[140:143]
s_waitcnt lgkmcnt(4)
v_mfma_f32_16x16x32_bf16 a[144:147], v[48:51], a[80:83], a[144:147]
s_add_u32 s23, s34, 262144
v_mfma_f32_16x16x32_bf16 a[144:147], v[52:55], a[96:99], a[144:147]
buffer_load_dwordx2 v[14:15], v11, s[8:11], s23 offen sc1
v_mfma_f32_16x16x32_bf16 a[148:151], v[48:51], a[84:87], a[148:151]
ds_read_b128 v[72:75], v2 offset:63488
v_mfma_f32_16x16x32_bf16 a[148:151], v[52:55], a[100:103], a[148:151]
v_mfma_f32_16x16x32_bf16 a[152:155], v[48:51], a[88:91], a[152:155]
v_mfma_f32_16x16x32_bf16 a[152:155], v[52:55], a[104:107], a[152:155]
ds_read_b128 v[76:79], v2 offset:64512
v_mfma_f32_16x16x32_bf16 a[156:159], v[48:51], a[92:95], a[156:159]
buffer_load_dwordx4 v[84:87], v4, s[8:11], s26 offen offset:2048 sc1
v_mfma_f32_16x16x32_bf16 a[156:159], v[52:55], a[108:111], a[156:159]
s_waitcnt lgkmcnt(4)
v_mfma_f32_16x16x32_bf16 a[160:163], v[56:59], a[80:83], a[160:163]
v_mfma_f32_16x16x32_bf16 a[160:163], v[60:63], a[96:99], a[160:163]
v_mfma_f32_16x16x32_bf16 a[164:167], v[56:59], a[84:87], a[164:167]
ds_read_b128 v[48:51], v7 offset:0
v_mfma_f32_16x16x32_bf16 a[164:167], v[60:63], a[100:103], a[164:167]
buffer_load_dwordx4 v[88:91], v5, s[8:11], s26 offen offset:2048 sc1
v_mfma_f32_16x16x32_bf16 a[168:171], v[56:59], a[88:91], a[168:171]
v_mfma_f32_16x16x32_bf16 a[168:171], v[60:63], a[104:107], a[168:171]
ds_read_b128 v[52:55], v7 offset:1024
v_mfma_f32_16x16x32_bf16 a[172:175], v[56:59], a[92:95], a[172:175]
v_mfma_f32_16x16x32_bf16 a[172:175], v[60:63], a[108:111], a[172:175]
s_waitcnt lgkmcnt(4)
v_mfma_f32_16x16x32_bf16 a[176:179], v[64:67], a[80:83], a[176:179]
buffer_load_dwordx4 v[92:95], v6, s[8:11], s26 offen offset:2048 sc1
v_mfma_f32_16x16x32_bf16 a[176:179], v[68:71], a[96:99], a[176:179]
s_lshl_b32 s21, s4, 11
s_add_u32 m0, s21, 0
v_mfma_f32_16x16x32_bf16 a[180:183], v[64:67], a[84:87], a[180:183]
ds_read_b128 v[56:59], v7 offset:2048
s_sub_u32 s21, s21, s22
v_mfma_f32_16x16x32_bf16 a[180:183], v[68:71], a[100:103], a[180:183]
s_add_u32 s21, s21, 20480
v_add_u32 v3, s21, v3
v_mfma_f32_16x16x32_bf16 a[184:187], v[64:67], a[88:91], a[184:187]
v_mfma_f32_16x16x32_bf16 a[184:187], v[68:71], a[104:107], a[184:187]
ds_read_b128 v[60:63], v7 offset:3072
v_mfma_f32_16x16x32_bf16 a[188:191], v[64:67], a[92:95], a[188:191]
buffer_load_dwordx4 v3, s[8:11], 0 offen offset:0 sc1 lds
v_mfma_f32_16x16x32_bf16 a[188:191], v[68:71], a[108:111], a[188:191]
s_waitcnt lgkmcnt(4)
v_mfma_f32_16x16x32_bf16 a[192:195], v[72:75], a[80:83], a[192:195]
v_mfma_f32_16x16x32_bf16 a[192:195], v[76:79], a[96:99], a[192:195]
v_mfma_f32_16x16x32_bf16 a[196:199], v[72:75], a[84:87], a[196:199]
ds_read_b128 v[64:67], v7 offset:4096
v_mfma_f32_16x16x32_bf16 a[196:199], v[76:79], a[100:103], a[196:199]
buffer_load_dwordx4 v3, s[8:11], 0 offen offset:1024 sc1 lds
v_mfma_f32_16x16x32_bf16 a[200:203], v[72:75], a[88:91], a[200:203]
v_mfma_f32_16x16x32_bf16 a[200:203], v[76:79], a[104:107], a[200:203]
ds_read_b128 v[68:71], v7 offset:5120
v_mfma_f32_16x16x32_bf16 a[204:207], v[72:75], a[92:95], a[204:207]
v_mfma_f32_16x16x32_bf16 a[204:207], v[76:79], a[108:111], a[204:207]
s_waitcnt lgkmcnt(4)
v_mfma_f32_16x16x32_bf16 a[208:211], v[48:51], a[80:83], a[208:211]
buffer_load_dwordx4 v[96:99], v2, s[8:11], s27 offen offset:2048 sc1
v_mfma_f32_16x16x32_bf16 a[208:211], v[52:55], a[96:99], a[208:211]
v_mfma_f32_16x16x32_bf16 a[212:215], v[48:51], a[84:87], a[212:215]
ds_read_b128 v[72:75], v7 offset:6144
v_mfma_f32_16x16x32_bf16 a[212:215], v[52:55], a[100:103], a[212:215]
v_mfma_f32_16x16x32_bf16 a[216:219], v[48:51], a[88:91], a[216:219]
v_mfma_f32_16x16x32_bf16 a[216:219], v[52:55], a[104:107], a[216:219]
ds_read_b128 v[76:79], v7 offset:7168
v_mfma_f32_16x16x32_bf16 a[220:223], v[48:51], a[92:95], a[220:223]
buffer_load_dwordx4 v[100:103], v4, s[8:11], s27 offen offset:2048 sc1
v_mfma_f32_16x16x32_bf16 a[220:223], v[52:55], a[108:111], a[220:223]
s_waitcnt lgkmcnt(4)
v_mfma_f32_16x16x32_bf16 a[224:227], v[56:59], a[80:83], a[224:227]
s_waitcnt vmcnt(63)
v_mfma_f32_16x16x32_bf16 a[224:227], v[60:63], a[96:99], a[224:227]
s_barrier
v_mfma_f32_16x16x32_bf16 a[228:231], v[56:59], a[84:87], a[228:231]
ds_read_b128 v[48:51], v7 offset:8192
v_mfma_f32_16x16x32_bf16 a[228:231], v[60:63], a[100:103], a[228:231]
buffer_load_dwordx4 v[104:107], v5, s[8:11], s27 offen offset:2048 sc1
v_mfma_f32_16x16x32_bf16 a[232:235], v[56:59], a[88:91], a[232:235]
v_mfma_f32_16x16x32_bf16 a[232:235], v[60:63], a[104:107], a[232:235]
ds_read_b128 v[52:55], v7 offset:9216
v_mfma_f32_16x16x32_bf16 a[236:239], v[56:59], a[92:95], a[236:239]
v_mfma_f32_16x16x32_bf16 a[236:239], v[60:63], a[108:111], a[236:239]
s_waitcnt vmcnt(14)
s_waitcnt lgkmcnt(4)
v_mfma_f32_16x16x32_bf16 a[112:115], v[64:67], v[16:19], a[112:115]
buffer_load_dwordx4 v[108:111], v6, s[8:11], s27 offen offset:2048 sc1
v_mfma_f32_16x16x32_bf16 a[112:115], v[68:71], v[192:195], a[112:115]
v_mfma_f32_16x16x32_bf16 a[116:119], v[64:67], v[20:23], a[116:119]
ds_read_b128 v[56:59], v7 offset:10240
v_mfma_f32_16x16x32_bf16 a[116:119], v[68:71], v[196:199], a[116:119]
v_mfma_f32_16x16x32_bf16 a[120:123], v[64:67], v[24:27], a[120:123]
v_mfma_f32_16x16x32_bf16 a[120:123], v[68:71], v[200:203], a[120:123]
ds_read_b128 v[60:63], v7 offset:11264
v_mfma_f32_16x16x32_bf16 a[124:127], v[64:67], v[28:31], a[124:127]
v_mfma_f32_16x16x32_bf16 a[124:127], v[68:71], v[204:207], a[124:127]
s_waitcnt lgkmcnt(4)
v_mfma_f32_16x16x32_bf16 a[128:131], v[72:75], v[16:19], a[128:131]
v_mfma_f32_16x16x32_bf16 a[128:131], v[76:79], v[192:195], a[128:131]
v_mfma_f32_16x16x32_bf16 a[132:135], v[72:75], v[20:23], a[132:135]
ds_read_b128 v[64:67], v7 offset:12288
v_mfma_f32_16x16x32_bf16 a[132:135], v[76:79], v[196:199], a[132:135]
v_mfma_f32_16x16x32_bf16 a[136:139], v[72:75], v[24:27], a[136:139]
v_mfma_f32_16x16x32_bf16 a[136:139], v[76:79], v[200:203], a[136:139]
ds_read_b128 v[68:71], v7 offset:13312
v_mfma_f32_16x16x32_bf16 a[140:143], v[72:75], v[28:31], a[140:143]
v_mfma_f32_16x16x32_bf16 a[140:143], v[76:79], v[204:207], a[140:143]
s_waitcnt lgkmcnt(4)
v_mfma_f32_16x16x32_bf16 a[144:147], v[48:51], v[16:19], a[144:147]
v_mfma_f32_16x16x32_bf16 a[144:147], v[52:55], v[192:195], a[144:147]
v_mfma_f32_16x16x32_bf16 a[148:151], v[48:51], v[20:23], a[148:151]
ds_read_b128 v[72:75], v7 offset:14336
v_mfma_f32_16x16x32_bf16 a[148:151], v[52:55], v[196:199], a[148:151]
v_mfma_f32_16x16x32_bf16 a[152:155], v[48:51], v[24:27], a[152:155]
v_mfma_f32_16x16x32_bf16 a[152:155], v[52:55], v[200:203], a[152:155]
ds_read_b128 v[76:79], v7 offset:15360
v_mfma_f32_16x16x32_bf16 a[156:159], v[48:51], v[28:31], a[156:159]
v_mfma_f32_16x16x32_bf16 a[156:159], v[52:55], v[204:207], a[156:159]
s_waitcnt lgkmcnt(4)
v_mfma_f32_16x16x32_bf16 a[160:163], v[56:59], v[16:19], a[160:163]
v_mfma_f32_16x16x32_bf16 a[160:163], v[60:63], v[192:195], a[160:163]
v_mfma_f32_16x16x32_bf16 a[164:167], v[56:59], v[20:23], a[164:167]
ds_read_b128 v[48:51], v7 offset:16384
v_mfma_f32_16x16x32_bf16 a[164:167], v[60:63], v[196:199], a[164:167]
v_mfma_f32_16x16x32_bf16 a[168:171], v[56:59], v[24:27], a[168:171]
v_mfma_f32_16x16x32_bf16 a[168:171], v[60:63], v[200:203], a[168:171]
ds_read_b128 v[52:55], v7 offset:17408
v_mfma_f32_16x16x32_bf16 a[172:175], v[56:59], v[28:31], a[172:175]
v_mfma_f32_16x16x32_bf16 a[172:175], v[60:63], v[204:207], a[172:175]
s_waitcnt lgkmcnt(4)
v_mfma_f32_16x16x32_bf16 a[176:179], v[64:67], v[16:19], a[176:179]
v_mfma_f32_16x16x32_bf16 a[176:179], v[68:71], v[192:195], a[176:179]
v_mfma_f32_16x16x32_bf16 a[180:183], v[64:67], v[20:23], a[180:183]
ds_read_b128 v[56:59], v7 offset:18432
v_mfma_f32_16x16x32_bf16 a[180:183], v[68:71], v[196:199], a[180:183]
v_mfma_f32_16x16x32_bf16 a[184:187], v[64:67], v[24:27], a[184:187]
v_mfma_f32_16x16x32_bf16 a[184:187], v[68:71], v[200:203], a[184:187]
ds_read_b128 v[60:63], v7 offset:19456
v_mfma_f32_16x16x32_bf16 a[188:191], v[64:67], v[28:31], a[188:191]
v_mfma_f32_16x16x32_bf16 a[188:191], v[68:71], v[204:207], a[188:191]
s_waitcnt lgkmcnt(4)
v_mfma_f32_16x16x32_bf16 a[192:195], v[72:75], v[16:19], a[192:195]
s_waitcnt vmcnt(9)
v_cmp_eq_u64 vcc, s[68:69], v[14:15]
s_nop 0
s_cmp_eq_u64 vcc, exec
s_cbranch_scc0 L_f_slow3
L_f_back3:
buffer_load_dwordx4 v[112:115], v2, s[8:11], s25 offen offset:3072 sc1
v_mfma_f32_16x16x32_bf16 a[192:195], v[76:79], v[192:195], a[192:195]
v_mfma_f32_16x16x32_bf16 a[196:199], v[72:75], v[20:23], a[196:199]
ds_read_b128 v[64:67], v7 offset:20480
v_mfma_f32_16x16x32_bf16 a[196:199], v[76:79], v[196:199], a[196:199]
v_mfma_f32_16x16x32_bf16 a[200:203], v[72:75], v[24:27], a[200:203]
buffer_load_dwordx4 v[116:119], v4, s[8:11], s25 offen offset:3072 sc1
v_mfma_f32_16x16x32_bf16 a[200:203], v[76:79], v[200:203], a[200:203]
ds_read_b128 v[68:71], v7 offset:21504
v_mfma_f32_16x16x32_bf16 a[204:207], v[72:75], v[28:31], a[204:207]
v_mfma_f32_16x16x32_bf16 a[204:207], v[76:79], v[204:207], a[204:207]
s_waitcnt lgkmcnt(4)
v_mfma_f32_16x16x32_bf16 a[208:211], v[48:51], v[16:19], a[208:211]
buffer_load_dwordx4 v[120:123], v5, s[8:11], s25 offen offset:3072 sc1
v_mfma_f32_16x16x32_bf16 a[208:211], v[52:55], v[192:195], a[208:211]
v_mfma_f32_16x16x32_bf16 a[212:215], v[48:51], v[20:23], a[212:215]
ds_read_b128 v[72:75], v7 offset:22528
v_mfma_f32_16x16x32_bf16 a[212:215], v[52:55], v[196:199], a[212:215]
v_mfma_f32_16x16x32_bf16 a[216:219], v[48:51], v[24:27], a[216:219]
buffer_load_dwordx4 v[124:127], v6, s[8:11], s25 offen offset:3072 sc1
v_mfma_f32_16x16x32_bf16 a[216:219], v[52:55], v[200:203], a[216:219]
ds_read_b128 v[76:79], v7 offset:23552
v_mfma_f32_16x16x32_bf16 a[220:223], v[48:51], v[28:31], a[220:223]
v_mfma_f32_16x16x32_bf16 a[220:223], v[52:55], v[204:207], a[220:223]
s_waitcnt lgkmcnt(4)
v_mfma_f32_16x16x32_bf16 a[224:227], v[56:59], v[16:19], a[224:227]
buffer_load_dwordx4 v[128:131], v2, s[8:11], s26 offen offset:3072 sc1
v_mfma_f32_16x16x32_bf16 a[224:227], v[60:63], v[192:195], a[224:227]
v_mfma_f32_16x16x32_bf16 a[228:231], v[56:59], v[20:23], a[228:231]
ds_read_b128 v[48:51], v7 offset:24576
v_mfma_f32_16x16x32_bf16 a[228:231], v[60:63], v[196:199], a[228:231]
v_mfma_f32_16x16x32_bf16 a[232:235], v[56:59], v[24:27], a[232:235]
buffer_load_dwordx4 v[132:135], v4, s[8:11], s26 offen offset:3072 sc1
v_mfma_f32_16x16x32_bf16 a[232:235], v[60:63], v[200:203], a[232:235]
ds_read_b128 v[52:55], v7 offset:25600
v_mfma_f32_16x16x32_bf16 a[236:239], v[56:59], v[28:31], a[236:239]
v_mfma_f32_16x16x32_bf16 a[236:239], v[60:63], v[204:207], a[236:239]
s_waitcnt vmcnt(12)
s_waitcnt lgkmcnt(4)
v_mfma_f32_16x16x32_bf16 a[112:115], v[64:67], v[32:35], a[112:115]
buffer_load_dwordx4 v[136:139], v5, s[8:11], s26 offen offset:3072 sc1
v_mfma_f32_16x16x32_bf16 a[112:115], v[68:71], v[80:83], a[112:115]
v_mfma_f32_16x16x32_bf16 a[116:119], v[64:67], v[36:39], a[116:119]
ds_read_b128 v[56:59], v7 offset:26624
v_mfma_f32_16x16x32_bf16 a[116:119], v[68:71], v[84:87], a[116:119]
v_mfma_f32_16x16x32_bf16 a[120:123], v[64:67], v[40:43], a[120:123]
buffer_load_dwordx4 v[140:143], v6, s[8:11], s26 offen offset:3072 sc1
v_mfma_f32_16x16x32_bf16 a[120:123], v[68:71], v[88:91], a[120:123]
ds_read_b128 v[60:63], v7 offset:27648
v_mfma_f32_16x16x32_bf16 a[124:127], v[64:67], v[44:47], a[124:127]
v_mfma_f32_16x16x32_bf16 a[124:127], v[68:71], v[92:95], a[124:127]
s_waitcnt lgkmcnt(4)
v_mfma_f32_16x16x32_bf16 a[128:131], v[72:75], v[32:35], a[128:131]
buffer_load_dwordx4 v[232:235], v2, s[8:11], s27 offen offset:3072 sc1
v_mfma_f32_16x16x32_bf16 a[128:131], v[76:79], v[80:83], a[128:131]
v_mfma_f32_16x16x32_bf16 a[132:135], v[72:75], v[36:39], a[132:135]
ds_read_b128 v[64:67], v7 offset:28672
v_mfma_f32_16x16x32_bf16 a[132:135], v[76:79], v[84:87], a[132:135]
v_mfma_f32_16x16x32_bf16 a[136:139], v[72:75], v[40:43], a[136:139]
buffer_load_dwordx4 v[236:239], v4, s[8:11], s27 offen offset:3072 sc1
v_mfma_f32_16x16x32_bf16 a[136:139], v[76:79], v[88:91], a[136:139]
ds_read_b128 v[68:71], v7 offset:29696
v_mfma_f32_16x16x32_bf16 a[140:143], v[72:75], v[44:47], a[140:143]
v_mfma_f32_16x16x32_bf16 a[140:143], v[76:79], v[92:95], a[140:143]
s_waitcnt lgkmcnt(4)
v_mfma_f32_16x16x32_bf16 a[144:147], v[48:51], v[32:35], a[144:147]
buffer_load_dwordx4 v[240:243], v5, s[8:11], s27 offen offset:3072 sc1
v_mfma_f32_16x16x32_bf16 a[144:147], v[52:55], v[80:83], a[144:147]
v_mfma_f32_16x16x32_bf16 a[148:151], v[48:51], v[36:39], a[148:151]
ds_read_b128 v[72:75], v7 offset:30720
v_mfma_f32_16x16x32_bf16 a[148:151], v[52:55], v[84:87], a[148:151]
v_mfma_f32_16x16x32_bf16 a[152:155], v[48:51], v[40:43], a[152:155]
buffer_load_dwordx4 v[244:247], v6, s[8:11], s27 offen offset:3072 sc1
v_mfma_f32_16x16x32_bf16 a[152:155], v[52:55], v[88:91], a[152:155]
ds_read_b128 v[76:79], v7 offset:31744
v_mfma_f32_16x16x32_bf16 a[156:159], v[48:51], v[44:47], a[156:159]
v_mfma_f32_16x16x32_bf16 a[156:159], v[52:55], v[92:95], a[156:159]
s_waitcnt lgkmcnt(4)
v_mfma_f32_16x16x32_bf16 a[160:163], v[56:59], v[32:35], a[160:163]
s_waitcnt vmcnt(62)
v_mfma_f32_16x16x32_bf16 a[160:163], v[60:63], v[80:83], a[160:163]
s_barrier
v_mfma_f32_16x16x32_bf16 a[164:167], v[56:59], v[36:39], a[164:167]
ds_read_b128 v[48:51], v7 offset:32768
v_mfma_f32_16x16x32_bf16 a[164:167], v[60:63], v[84:87], a[164:167]
v_mfma_f32_16x16x32_bf16 a[168:171], v[56:59], v[40:43], a[168:171]
v_mfma_f32_16x16x32_bf16 a[168:171], v[60:63], v[88:91], a[168:171]
ds_read_b128 v[52:55], v7 offset:33792
v_mfma_f32_16x16x32_bf16 a[172:175], v[56:59], v[44:47], a[172:175]
v_mfma_f32_16x16x32_bf16 a[172:175], v[60:63], v[92:95], a[172:175]
s_waitcnt lgkmcnt(4)
v_mfma_f32_16x16x32_bf16 a[176:179], v[64:67], v[32:35], a[176:179]
v_mfma_f32_16x16x32_bf16 a[176:179], v[68:71], v[80:83], a[176:179]
v_mfma_f32_16x16x32_bf16 a[180:183], v[64:67], v[36:39], a[180:183]
ds_read_b128 v[56:59], v7 offset:34816
v_mfma_f32_16x16x32_bf16 a[180:183], v[68:71], v[84:87], a[180:183]
v_mfma_f32_16x16x32_bf16 a[184:187], v[64:67], v[40:43], a[184:187]
v_mfma_f32_16x16x32_bf16 a[184:187], v[68:71], v[88:91], a[184:187]
ds_read_b128 v[60:63], v7 offset:35840
v_mfma_f32_16x16x32_bf16 a[188:191], v[64:67], v[44:47], a[188:191]
v_mfma_f32_16x16x32_bf16 a[188:191], v[68:71], v[92:95], a[188:191]
s_waitcnt lgkmcnt(4)
v_mfma_f32_16x16x32_bf16 a[192:195], v[72:75], v[32:35], a[192:195]
v_mfma_f32_16x16x32_bf16 a[192:195], v[76:79], v[80:83], a[192:195]
v_mfma_f32_16x16x32_bf16 a[196:199], v[72:75], v[36:39], a[196:199]
ds_read_b128 v[64:67], v7 offset:36864
v_mfma_f32_16x16x32_bf16 a[196:199], v[76:79], v[84:87], a[196:199]
v_mfma_f32_16x16x32_bf16 a[200:203], v[72:75], v[40:43], a[200:203]
v_mfma_f32_16x16x32_bf16 a[200:203], v[76:79], v[88:91], a[200:203]
ds_read_b128 v[68:71], v7 offset:37888
v_mfma_f32_16x16x32_bf16 a[204:207], v[72:75], v[44:47], a[204:207]
v_mfma_f32_16x16x32_bf16 a[204:207], v[76:79], v[92:95], a[204:207]
s_waitcnt lgkmcnt(4)
v_mfma_f32_16x16x32_bf16 a[208:211], v[48:51], v[32:35], a[208:211]
v_mfma_f32_16x16x32_bf16 a[208:211], v[52:55], v[80:83], a[208:211]
v_mfma_f32_16x16x32_bf16 a[212:215], v[48:51], v[36:39], a[212:215]
ds_read_b128 v[72:75], v7 offset:38912
v_mfma_f32_16x16x32_bf16 a[212:215], v[52:55], v[84:87], a[212:215]
v_mfma_f32_16x16x32_bf16 a[216:219], v[48:51], v[40:43], a[216:219]
v_mfma_f32_16x16x32_bf16 a[216:219], v[52:55], v[88:91], a[216:219]
ds_read_b128 v[76:79], v7 offset:39936
v_mfma_f32_16x16x32_bf16 a[220:223], v[48:51], v[44:47], a[220:223]
v_mfma_f32_16x16x32_bf16 a[220:223], v[52:55], v[92:95], a[220:223]
s_waitcnt lgkmcnt(4)
v_mfma_f32_16x16x32_bf16 a[224:227], v[56:59], v[32:35], a[224:227]
v_mfma_f32_16x16x32_bf16 a[224:227], v[60:63], v[80:83], a[224:227]
v_mfma_f32_16x16x32_bf16 a[228:231], v[56:59], v[36:39], a[228:231]
ds_read_b128 v[48:51], v7 offset:40960
v_mfma_f32_16x16x32_bf16 a[228:231], v[60:63], v[84:87], a[228:231]
v_mfma_f32_16x16x32_bf16 a[232:235], v[56:59], v[40:43], a[232:235]
v_mfma_f32_16x16x32_bf16 a[232:235], v[60:63], v[88:91], a[232:235]
ds_read_b128 v[52:55], v7 offset:41984
v_mfma_f32_16x16x32_bf16 a[236:239], v[56:59], v[44:47], a[236:239]
v_mfma_f32_16x16x32_bf16 a[236:239], v[60:63], v[92:95], a[236:239]
s_waitcnt lgkmcnt(4)
v_mfma_f32_16x16x32_bf16 a[240:243], v[64:67], v[144:147], 0
v_mfma_f32_16x16x32_bf16 a[240:243], v[68:71], v[160:163], a[240:243]
v_mfma_f32_16x16x32_bf16 a[244:247], v[64:67], v[148:151], 0
ds_read_b128 v[56:59], v7 offset:43008
v_mfma_f32_16x16x32_bf16 a[244:247], v[68:71], v[164:167], a[244:247]
v_mfma_f32_16x16x32_bf16 a[248:251], v[64:67], v[152:155], 0
v_mfma_f32_16x16x32_bf16 a[248:251], v[68:71], v[168:171], a[248:251]
ds_read_b128 v[60:63], v7 offset:44032
v_mfma_f32_16x16x32_bf16 a[252:255], v[64:67], v[156:159], 0
v_mfma_f32_16x16x32_bf16 a[252:255], v[68:71], v[172:175], a[252:255]
s_waitcnt lgkmcnt(4)
v_mfma_f32_16x16x32_bf16 a[240:243], v[72:75], v[176:179], a[240:243]
v_mfma_f32_16x16x32_bf16 a[240:243], v[76:79], a[0:3], a[240:243]
v_mfma_f32_16x16x32_bf16 a[244:247], v[72:75], v[180:183], a[244:247]
ds_read_b128 v[64:67], v7 offset:45056
v_mfma_f32_16x16x32_bf16 a[244:247], v[76:79], a[4:7], a[244:247]
v_mfma_f32_16x16x32_bf16 a[248:251], v[72:75], v[184:187], a[248:251]
v_mfma_f32_16x16x32_bf16 a[248:251], v[76:79], a[8:11], a[248:251]
ds_read_b128 v[68:71], v7 offset:46080
v_mfma_f32_16x16x32_bf16 a[252:255], v[72:75], v[188:191], a[252:255]
v_mfma_f32_16x16x32_bf16 a[252:255], v[76:79], a[12:15], a[252:255]
s_waitcnt lgkmcnt(4)
v_mfma_f32_16x16x32_bf16 a[240:243], v[48:51], a[16:19], a[240:243]
v_mfma_f32_16x16x32_bf16 a[240:243], v[52:55], a[32:35], a[240:243]
v_mfma_f32_16x16x32_bf16 a[244:247], v[48:51], a[20:23], a[244:247]
ds_read_b128 v[72:75], v7 offset:47104
v_mfma_f32_16x16x32_bf16 a[244:247], v[52:55], a[36:39], a[244:247]
v_mfma_f32_16x16x32_bf16 a[248:251], v[48:51], a[24:27], a[248:251]
v_mfma_f32_16x16x32_bf16 a[248:251], v[52:55], a[40:43], a[248:251]
ds_read_b128 v[76:79], v7 offset:48128
v_mfma_f32_16x16x32_bf16 a[252:255], v[48:51], a[28:31], a[252:255]
v_mfma_f32_16x16x32_bf16 a[252:255], v[52:55], a[44:47], a[252:255]
s_waitcnt vmcnt(8)
s_waitcnt lgkmcnt(4)
v_mfma_f32_16x16x32_bf16 a[112:115], v[56:59], v[96:99], a[112:115]
v_mfma_f32_16x16x32_bf16 a[112:115], v[60:63], v[112:115], a[112:115]
v_mfma_f32_16x16x32_bf16 a[116:119], v[56:59], v[100:103], a[116:119]
ds_read_b128 v[48:51], v7 offset:49152
v_mfma_f32_16x16x32_bf16 a[116:119], v[60:63], v[116:119], a[116:119]
v_mfma_f32_16x16x32_bf16 a[120:123], v[56:59], v[104:107], a[120:123]
v_mfma_f32_16x16x32_bf16 a[120:123], v[60:63], v[120:123], a[120:123]
ds_read_b128 v[52:55], v7 offset:50176
v_mfma_f32_16x16x32_bf16 a[124:127], v[56:59], v[108:111], a[124:127]
v_mfma_f32_16x16x32_bf16 a[124:127], v[60:63], v[124:127], a[124:127]
s_waitcnt vmcnt(0)
s_waitcnt lgkmcnt(4)
v_mfma_f32_16x16x32_bf16 a[112:115], v[64:67], v[128:131], a[112:115]
v_mfma_f32_16x16x32_bf16 a[112:115], v[68:71], v[232:235], a[112:115]
v_mfma_f32_16x16x32_bf16 a[116:119], v[64:67], v[132:135], a[116:119]
ds_read_b128 v[56:59], v7 offset:51200
v_mfma_f32_16x16x32_bf16 a[116:119], v[68:71], v[236:239], a[116:119]
v_mfma_f32_16x16x32_bf16 a[120:123], v[64:67], v[136:139], a[120:123]
v_mfma_f32_16x16x32_bf16 a[120:123], v[68:71], v[240:243], a[120:123]
ds_read_b128 v[60:63], v7 offset:52224
v_mfma_f32_16x16x32_bf16 a[124:127], v[64:67], v[140:143], a[124:127]
v_mfma_f32_16x16x32_bf16 a[124:127], v[68:71], v[244:247], a[124:127]
s_waitcnt lgkmcnt(4)
v_mfma_f32_16x16x32_bf16 a[128:131], v[72:75], v[96:99], a[128:131]
v_mfma_f32_16x16x32_bf16 a[128:131], v[76:79], v[112:115], a[128:131]
v_mfma_f32_16x16x32_bf16 a[132:135], v[72:75], v[100:103], a[132:135]
ds_read_b128 v[64:67], v7 offset:53248
v_mfma_f32_16x16x32_bf16 a[132:135], v[76:79], v[116:119], a[132:135]
v_mfma_f32_16x16x32_bf16 a[136:139], v[72:75], v[104:107], a[136:139]
v_mfma_f32_16x16x32_bf16 a[136:139], v[76:79], v[120:123], a[136:139]
ds_read_b128 v[68:71], v7 offset:54272
v_mfma_f32_16x16x32_bf16 a[140:143], v[72:75], v[108:111], a[140:143]
v_mfma_f32_16x16x32_bf16 a[140:143], v[76:79], v[124:127], a[140:143]
s_waitcnt lgkmcnt(4)
v_mfma_f32_16x16x32_bf16 a[128:131], v[48:51], v[128:131], a[128:131]
v_mfma_f32_16x16x32_bf16 a[128:131], v[52:55], v[232:235], a[128:131]
v_mfma_f32_16x16x32_bf16 a[132:135], v[48:51], v[132:135], a[132:135]
ds_read_b128 v[72:75], v7 offset:55296
v_mfma_f32_16x16x32_bf16 a[132:135], v[52:55], v[236:239], a[132:135]
v_mfma_f32_16x16x32_bf16 a[136:139], v[48:51], v[136:139], a[136:139]
v_mfma_f32_16x16x32_bf16 a[136:139], v[52:55], v[240:243], a[136:139]
ds_read_b128 v[76:79], v7 offset:56320
v_mfma_f32_16x16x32_bf16 a[140:143], v[48:51], v[140:143], a[140:143]
v_mfma_f32_16x16x32_bf16 a[140:143], v[52:55], v[244:247], a[140:143]
s_waitcnt lgkmcnt(4)
v_mfma_f32_16x16x32_bf16 a[144:147], v[56:59], v[96:99], a[144:147]
s_waitcnt vmcnt(36)
v_mfma_f32_16x16x32_bf16 a[144:147], v[60:63], v[112:115], a[144:147]
s_barrier
v_mfma_f32_16x16x32_bf16 a[148:151], v[56:59], v[100:103], a[148:151]
ds_read_b128 v[48:51], v7 offset:57344
v_mfma_f32_16x16x32_bf16 a[148:151], v[60:63], v[116:119], a[148:151]
v_mfma_f32_16x16x32_bf16 a[152:155], v[56:59], v[104:107], a[152:155]
v_mfma_f32_16x16x32_bf16 a[152:155], v[60:63], v[120:123], a[152:155]
ds_read_b128 v[52:55], v7 offset:58368
v_mfma_f32_16x16x32_bf16 a[156:159], v[56:59], v[108:111], a[156:159]
v_mfma_f32_16x16x32_bf16 a[156:159], v[60:63], v[124:127], a[156:159]
s_waitcnt lgkmcnt(4)
v_mfma_f32_16x16x32_bf16 a[144:147], v[64:67], v[128:131], a[144:147]
v_mfma_f32_16x16x32_bf16 a[144:147], v[68:71], v[232:235], a[144:147]
v_mfma_f32_16x16x32_bf16 a[148:151], v[64:67], v[132:135], a[148:151]
ds_read_b128 v[56:59], v7 offset:59392
v_mfma_f32_16x16x32_bf16 a[148:151], v[68:71], v[236:239], a[148:151]
v_mfma_f32_16x16x32_bf16 a[152:155], v[64:67], v[136:139], a[152:155]
v_mfma_f32_16x16x32_bf16 a[152:155], v[68:71], v[240:243], a[152:155]
ds_read_b128 v[60:63], v7 offset:60416
v_mfma_f32_16x16x32_bf16 a[156:159], v[64:67], v[140:143], a[156:159]
v_mfma_f32_16x16x32_bf16 a[156:159], v[68:71], v[244:247], a[156:159]
s_waitcnt lgkmcnt(4)
v_mfma_f32_16x16x32_bf16 a[160:163], v[72:75], v[96:99], a[160:163]
v_mfma_f32_16x16x32_bf16 a[160:163], v[76:79], v[112:115], a[160:163]
v_mfma_f32_16x16x32_bf16 a[164:167], v[72:75], v[100:103], a[164:167]
ds_read_b128 v[64:67], v7 offset:61440
v_mfma_f32_16x16x32_bf16 a[164:167], v[76:79], v[116:119], a[164:167]
v_mfma_f32_16x16x32_bf16 a[168:171], v[72:75], v[104:107], a[168:171]
v_mfma_f32_16x16x32_bf16 a[168:171], v[76:79], v[120:123], a[168:171]
ds_read_b128 v[68:71], v7 offset:62464
v_mfma_f32_16x16x32_bf16 a[172:175], v[72:75], v[108:111], a[172:175]
v_mfma_f32_16x16x32_bf16 a[172:175], v[76:79], v[124:127], a[172:175]
s_waitcnt lgkmcnt(4)
v_mfma_f32_16x16x32_bf16 a[160:163], v[48:51], v[128:131], a[160:163]
v_mfma_f32_16x16x32_bf16 a[160:163], v[52:55], v[232:235], a[160:163]
v_mfma_f32_16x16x32_bf16 a[164:167], v[48:51], v[132:135], a[164:167]
ds_read_b128 v[72:75], v7 offset:63488
v_mfma_f32_16x16x32_bf16 a[164:167], v[52:55], v[236:239], a[164:167]
v_mfma_f32_16x16x32_bf16 a[168:171], v[48:51], v[136:139], a[168:171]
v_mfma_f32_16x16x32_bf16 a[168:171], v[52:55], v[240:243], a[168:171]
ds_read_b128 v[76:79], v7 offset:64512
v_mfma_f32_16x16x32_bf16 a[172:175], v[48:51], v[140:143], a[172:175]
v_mfma_f32_16x16x32_bf16 a[172:175], v[52:55], v[244:247], a[172:175]
s_waitcnt lgkmcnt(4)
v_mfma_f32_16x16x32_bf16 a[176:179], v[56:59], v[96:99], a[176:179]
v_mfma_f32_16x16x32_bf16 a[176:179], v[60:63], v[112:115], a[176:179]
v_mfma_f32_16x16x32_bf16 a[180:183], v[56:59], v[100:103], a[180:183]
ds_read_b128 v[48:51], v8 offset:0
v_mfma_f32_16x16x32_bf16 a[180:183], v[60:63], v[116:119], a[180:183]
v_accvgpr_read_b32 v208, a112
v_accvgpr_read_b32 v209, a128
v_mfma_f32_16x16x32_bf16 a[184:187], v[56:59], v[104:107], a[184:187]
v_accvgpr_read_b32 v210, a144
v_accvgpr_read_b32 v211, a160
v_mfma_f32_16x16x32_bf16 a[184:187], v[60:63], v[120:123], a[184:187]
ds_read_b128 v[52:55], v8 offset:1024
v_accvgpr_read_b32 v212, a113
v_mfma_f32_16x16x32_bf16 a[188:191], v[56:59], v[108:111], a[188:191]
v_accvgpr_read_b32 v213, a129
v_accvgpr_read_b32 v214, a145
v_mfma_f32_16x16x32_bf16 a[188:191], v[60:63], v[124:127], a[188:191]
v_accvgpr_read_b32 v215, a161
s_waitcnt lgkmcnt(4)
v_mfma_f32_16x16x32_bf16 a[176:179], v[64:67], v[128:131], a[176:179]
v_cvt_pk_bf16_f32 v224, v208, v209
v_cvt_pk_bf16_f32 v225, v210, v211
v_mfma_f32_16x16x32_bf16 a[176:179], v[68:71], v[232:235], a[176:179]
v_cvt_pk_bf16_f32 v226, v212, v213
v_cvt_pk_bf16_f32 v227, v214, v215
v_mfma_f32_16x16x32_bf16 a[180:183], v[64:67], v[132:135], a[180:183]
ds_read_b128 v[56:59], v8 offset:2048
buffer_store_dwordx4 v[224:227], v252, s[8:11], s36 offen offset:0 sc1
v_mfma_f32_16x16x32_bf16 a[180:183], v[68:71], v[236:239], a[180:183]
v_accvgpr_read_b32 v216, a114
v_accvgpr_read_b32 v217, a130
v_mfma_f32_16x16x32_bf16 a[184:187], v[64:67], v[136:139], a[184:187]
v_accvgpr_read_b32 v218, a146
v_accvgpr_read_b32 v219, a162
v_mfma_f32_16x16x32_bf16 a[184:187], v[68:71], v[240:243], a[184:187]
ds_read_b128 v[60:63], v8 offset:3072
v_accvgpr_read_b32 v220, a115
v_mfma_f32_16x16x32_bf16 a[188:191], v[64:67], v[140:143], a[188:191]
v_accvgpr_read_b32 v221, a131
v_accvgpr_read_b32 v222, a147
v_mfma_f32_16x16x32_bf16 a[188:191], v[68:71], v[244:247], a[188:191]
v_accvgpr_read_b32 v223, a163
s_waitcnt lgkmcnt(4)
v_mfma_f32_16x16x32_bf16 a[192:195], v[72:75], v[96:99], a[192:195]
v_cvt_pk_bf16_f32 v228, v216, v217
v_cvt_pk_bf16_f32 v229, v218, v219
v_mfma_f32_16x16x32_bf16 a[192:195], v[76:79], v[112:115], a[192:195]
v_cvt_pk_bf16_f32 v230, v220, v221
v_cvt_pk_bf16_f32 v231, v222, v223
v_mfma_f32_16x16x32_bf16 a[196:199], v[72:75], v[100:103], a[196:199]
ds_read_b128 v[64:67], v8 offset:4096
buffer_store_dwordx4 v[228:231], v252, s[8:11], s36 offen offset:256 sc1
v_mfma_f32_16x16x32_bf16 a[196:199], v[76:79], v[116:119], a[196:199]
v_accvgpr_read_b32 v208, a116
v_accvgpr_read_b32 v209, a132
v_mfma_f32_16x16x32_bf16 a[200:203], v[72:75], v[104:107], a[200:203]
v_accvgpr_read_b32 v210, a148
v_accvgpr_read_b32 v211, a164
v_mfma_f32_16x16x32_bf16 a[200:203], v[76:79], v[120:123], a[200:203]
ds_read_b128 v[68:71], v8 offset:5120
v_accvgpr_read_b32 v212, a117
v_mfma_f32_16x16x32_bf16 a[204:207], v[72:75], v[108:111], a[204:207]
v_accvgpr_read_b32 v213, a133
v_accvgpr_read_b32 v214, a149
v_mfma_f32_16x16x32_bf16 a[204:207], v[76:79], v[124:127], a[204:207]
v_accvgpr_read_b32 v215, a165
s_waitcnt lgkmcnt(4)
v_mfma_f32_16x16x32_bf16 a[192:195], v[48:51], v[128:131], a[192:195]
v_cvt_pk_bf16_f32 v224, v208, v209
v_cvt_pk_bf16_f32 v225, v210, v211
v_mfma_f32_16x16x32_bf16 a[192:195], v[52:55], v[232:235], a[192:195]
v_cvt_pk_bf16_f32 v226, v212, v213
v_cvt_pk_bf16_f32 v227, v214, v215
v_mfma_f32_16x16x32_bf16 a[196:199], v[48:51], v[132:135], a[196:199]
ds_read_b128 v[72:75], v8 offset:6144
buffer_store_dwordx4 v[224:227], v252, s[8:11], s37 offen offset:0 sc1
v_mfma_f32_16x16x32_bf16 a[196:199], v[52:55], v[236:239], a[196:199]
v_accvgpr_read_b32 v216, a118
v_accvgpr_read_b32 v217, a134
v_mfma_f32_16x16x32_bf16 a[200:203], v[48:51], v[136:139], a[200:203]
v_accvgpr_read_b32 v218, a150
v_accvgpr_read_b32 v219, a166
v_mfma_f32_16x16x32_bf16 a[200:203], v[52:55], v[240:243], a[200:203]
ds_read_b128 v[76:79], v8 offset:7168
v_accvgpr_read_b32 v220, a119
v_mfma_f32_16x16x32_bf16 a[204:207], v[48:51], v[140:143], a[204:207]
v_accvgpr_read_b32 v221, a135
v_accvgpr_read_b32 v222, a151
v_mfma_f32_16x16x32_bf16 a[204:207], v[52:55], v[244:247], a[204:207]
v_accvgpr_read_b32 v223, a167
s_waitcnt lgkmcnt(4)
v_mfma_f32_16x16x32_bf16 a[208:211], v[56:59], v[96:99], a[208:211]
v_cvt_pk_bf16_f32 v228, v216, v217
v_cvt_pk_bf16_f32 v229, v218, v219
v_mfma_f32_16x16x32_bf16 a[208:211], v[60:63], v[112:115], a[208:211]
v_cvt_pk_bf16_f32 v230, v220, v221
v_cvt_pk_bf16_f32 v231, v222, v223
v_mfma_f32_16x16x32_bf16 a[212:215], v[56:59], v[100:103], a[212:215]
ds_read_b128 v[48:51], v8 offset:8192
buffer_store_dwordx4 v[228:231], v252, s[8:11], s37 offen offset:256 sc1
v_mfma_f32_16x16x32_bf16 a[212:215], v[60:63], v[116:119], a[212:215]
v_accvgpr_read_b32 v208, a120
v_accvgpr_read_b32 v209, a136
v_mfma_f32_16x16x32_bf16 a[216:219], v[56:59], v[104:107], a[216:219]
v_accvgpr_read_b32 v210, a152
v_accvgpr_read_b32 v211, a168
v_mfma_f32_16x16x32_bf16 a[216:219], v[60:63], v[120:123], a[216:219]
ds_read_b128 v[52:55], v8 offset:9216
v_accvgpr_read_b32 v212, a121
v_mfma_f32_16x16x32_bf16 a[220:223], v[56:59], v[108:111], a[220:223]
v_accvgpr_read_b32 v213, a137
v_accvgpr_read_b32 v214, a153
v_mfma_f32_16x16x32_bf16 a[220:223], v[60:63], v[124:127], a[220:223]
v_accvgpr_read_b32 v215, a169
s_waitcnt lgkmcnt(4)
v_mfma_f32_16x16x32_bf16 a[208:211], v[64:67], v[128:131], a[208:211]
v_cvt_pk_bf16_f32 v224, v208, v209
v_cvt_pk_bf16_f32 v225, v210, v211
v_mfma_f32_16x16x32_bf16 a[208:211], v[68:71], v[232:235], a[208:211]
v_cvt_pk_bf16_f32 v226, v212, v213
v_cvt_pk_bf16_f32 v227, v214, v215
v_mfma_f32_16x16x32_bf16 a[212:215], v[64:67], v[132:135], a[212:215]
ds_read_b128 v[56:59], v8 offset:10240
buffer_store_dwordx4 v[224:227], v252, s[8:11], s38 offen offset:0 sc1
v_mfma_f32_16x16x32_bf16 a[212:215], v[68:71], v[236:239], a[212:215]
v_accvgpr_read_b32 v216, a122
v_accvgpr_read_b32 v217, a138
v_mfma_f32_16x16x32_bf16 a[216:219], v[64:67], v[136:139], a[216:219]
v_accvgpr_read_b32 v218, a154
v_accvgpr_read_b32 v219, a170
v_mfma_f32_16x16x32_bf16 a[216:219], v[68:71], v[240:243], a[216:219]
ds_read_b128 v[60:63], v8 offset:11264
v_accvgpr_read_b32 v220, a123
v_mfma_f32_16x16x32_bf16 a[220:223], v[64:67], v[140:143], a[220:223]
v_accvgpr_read_b32 v221, a139
v_accvgpr_read_b32 v222, a155
v_mfma_f32_16x16x32_bf16 a[220:223], v[68:71], v[244:247], a[220:223]
v_accvgpr_read_b32 v223, a171
s_waitcnt lgkmcnt(4)
v_mfma_f32_16x16x32_bf16 a[224:227], v[72:75], v[96:99], a[224:227]
v_cvt_pk_bf16_f32 v228, v216, v217
v_cvt_pk_bf16_f32 v229, v218, v219
v_mfma_f32_16x16x32_bf16 a[224:227], v[76:79], v[112:115], a[224:227]
v_cvt_pk_bf16_f32 v230, v220, v221
v_cvt_pk_bf16_f32 v231, v222, v223
v_mfma_f32_16x16x32_bf16 a[228:231], v[72:75], v[100:103], a[228:231]
ds_read_b128 v[64:67], v8 offset:12288
buffer_store_dwordx4 v[228:231], v252, s[8:11], s38 offen offset:256 sc1
v_mfma_f32_16x16x32_bf16 a[228:231], v[76:79], v[116:119], a[228:231]
v_accvgpr_read_b32 v208, a124
v_accvgpr_read_b32 v209, a140
v_mfma_f32_16x16x32_bf16 a[232:235], v[72:75], v[104:107], a[232:235]
v_accvgpr_read_b32 v210, a156
v_accvgpr_read_b32 v211, a172
v_mfma_f32_16x16x32_bf16 a[232:235], v[76:79], v[120:123], a[232:235]
ds_read_b128 v[68:71], v8 offset:13312
v_accvgpr_read_b32 v212, a125
v_mfma_f32_16x16x32_bf16 a[236:239], v[72:75], v[108:111], a[236:239]
v_accvgpr_read_b32 v213, a141
v_accvgpr_read_b32 v214, a157
v_mfma_f32_16x16x32_bf16 a[236:239], v[76:79], v[124:127], a[236:239]
v_accvgpr_read_b32 v215, a173
s_waitcnt lgkmcnt(4)
v_mfma_f32_16x16x32_bf16 a[224:227], v[48:51], v[128:131], a[224:227]
v_cvt_pk_bf16_f32 v224, v208, v209
v_cvt_pk_bf16_f32 v225, v210, v211
v_mfma_f32_16x16x32_bf16 a[224:227], v[52:55], v[232:235], a[224:227]
v_cvt_pk_bf16_f32 v226, v212, v213
v_cvt_pk_bf16_f32 v227, v214, v215
v_mfma_f32_16x16x32_bf16 a[228:231], v[48:51], v[132:135], a[228:231]
ds_read_b128 v[72:75], v8 offset:14336
buffer_store_dwordx4 v[224:227], v252, s[8:11], s39 offen offset:0 sc1
v_mfma_f32_16x16x32_bf16 a[228:231], v[52:55], v[236:239], a[228:231]
v_accvgpr_read_b32 v216, a126
v_accvgpr_read_b32 v217, a142
v_mfma_f32_16x16x32_bf16 a[232:235], v[48:51], v[136:139], a[232:235]
v_accvgpr_read_b32 v218, a158
v_accvgpr_read_b32 v219, a174
v_mfma_f32_16x16x32_bf16 a[232:235], v[52:55], v[240:243], a[232:235]
ds_read_b128 v[76:79], v8 offset:15360
v_accvgpr_read_b32 v220, a127
v_mfma_f32_16x16x32_bf16 a[236:239], v[48:51], v[140:143], a[236:239]
v_accvgpr_read_b32 v221, a143
v_accvgpr_read_b32 v222, a159
v_mfma_f32_16x16x32_bf16 a[236:239], v[52:55], v[244:247], a[236:239]
v_accvgpr_read_b32 v223, a175
v_cvt_pk_bf16_f32 v228, v216, v217
v_cvt_pk_bf16_f32 v229, v218, v219
v_cvt_pk_bf16_f32 v230, v220, v221
v_cvt_pk_bf16_f32 v231, v222, v223
buffer_store_dwordx4 v[228:231], v252, s[8:11], s39 offen offset:256 sc1
s_waitcnt lgkmcnt(4)
v_mfma_f32_16x16x32_bf16 a[240:243], v[56:59], a[48:51], a[240:243]
s_waitcnt vmcnt(24)
v_mfma_f32_16x16x32_bf16 a[240:243], v[60:63], a[64:67], a[240:243]
s_barrier
v_mfma_f32_16x16x32_bf16 a[244:247], v[56:59], a[52:55], a[244:247]
ds_read_b128 v[48:51], v2 offset:0
v_mfma_f32_16x16x32_bf16 a[244:247], v[60:63], a[68:71], a[244:247]
v_accvgpr_read_b32 v208, a176
v_accvgpr_read_b32 v209, a192
v_mfma_f32_16x16x32_bf16 a[248:251], v[56:59], a[56:59], a[248:251]
v_accvgpr_read_b32 v210, a208
v_accvgpr_read_b32 v211, a224
v_mfma_f32_16x16x32_bf16 a[248:251], v[60:63], a[72:75], a[248:251]
ds_read_b128 v[52:55], v2 offset:1024
v_accvgpr_read_b32 v212, a177
v_mfma_f32_16x16x32_bf16 a[252:255], v[56:59], a[60:63], a[252:255]
v_accvgpr_read_b32 v213, a193
v_accvgpr_read_b32 v214, a209
v_mfma_f32_16x16x32_bf16 a[252:255], v[60:63], a[76:79], a[252:255]
v_accvgpr_read_b32 v215, a225
s_waitcnt lgkmcnt(4)
v_mfma_f32_16x16x32_bf16 a[240:243], v[64:67], a[80:83], a[240:243]
v_cvt_pk_bf16_f32 v224, v208, v209
v_cvt_pk_bf16_f32 v225, v210, v211
v_mfma_f32_16x16x32_bf16 a[240:243], v[68:71], a[96:99], a[240:243]
v_cvt_pk_bf16_f32 v226, v212, v213
v_cvt_pk_bf16_f32 v227, v214, v215
v_mfma_f32_16x16x32_bf16 a[244:247], v[64:67], a[84:87], a[244:247]
ds_read_b128 v[56:59], v2 offset:2048
buffer_store_dwordx4 v[224:227], v252, s[8:11], s36 offen offset:2048 sc1
v_mfma_f32_16x16x32_bf16 a[244:247], v[68:71], a[100:103], a[244:247]
v_accvgpr_read_b32 v216, a178
v_accvgpr_read_b32 v217, a194
v_mfma_f32_16x16x32_bf16 a[248:251], v[64:67], a[88:91], a[248:251]
v_accvgpr_read_b32 v218, a210
v_accvgpr_read_b32 v219, a226
v_mfma_f32_16x16x32_bf16 a[248:251], v[68:71], a[104:107], a[248:251]
ds_read_b128 v[60:63], v2 offset:3072
v_accvgpr_read_b32 v220, a179
v_mfma_f32_16x16x32_bf16 a[252:255], v[64:67], a[92:95], a[252:255]
v_accvgpr_read_b32 v221, a195
v_accvgpr_read_b32 v222, a211
v_mfma_f32_16x16x32_bf16 a[252:255], v[68:71], a[108:111], a[252:255]
v_accvgpr_read_b32 v223, a227
s_waitcnt lgkmcnt(4)
v_mfma_f32_16x16x32_bf16 a[240:243], v[72:75], v[16:19], a[240:243]
v_cvt_pk_bf16_f32 v228, v216, v217
v_cvt_pk_bf16_f32 v229, v218, v219
v_mfma_f32_16x16x32_bf16 a[240:243], v[76:79], v[192:195], a[240:243]
v_cvt_pk_bf16_f32 v230, v220, v221
v_cvt_pk_bf16_f32 v231, v222, v223
v_mfma_f32_16x16x32_bf16 a[244:247], v[72:75], v[20:23], a[244:247]
ds_read_b128 v[64:67], v2 offset:4096
buffer_store_dwordx4 v[228:231], v252, s[8:11], s36 offen offset:2304 sc1
v_mfma_f32_16x16x32_bf16 a[244:247], v[76:79], v[196:199], a[244:247]
v_accvgpr_read_b32 v208, a180
v_accvgpr_read_b32 v209, a196
v_mfma_f32_16x16x32_bf16 a[248:251], v[72:75], v[24:27], a[248:251]
v_accvgpr_read_b32 v210, a212
v_accvgpr_read_b32 v211, a228
v_mfma_f32_16x16x32_bf16 a[248:251], v[76:79], v[200:203], a[248:251]
ds_read_b128 v[68:71], v2 offset:5120
v_accvgpr_read_b32 v212, a181
v_mfma_f32_16x16x32_bf16 a[252:255], v[72:75], v[28:31], a[252:255]
v_accvgpr_read_b32 v213, a197
v_accvgpr_read_b32 v214, a213
v_mfma_f32_16x16x32_bf16 a[252:255], v[76:79], v[204:207], a[252:255]
v_accvgpr_read_b32 v215, a229
s_waitcnt lgkmcnt(4)
v_mfma_f32_16x16x32_bf16 a[240:243], v[48:51], v[32:35], a[240:243]
v_cvt_pk_bf16_f32 v224, v208, v209
v_cvt_pk_bf16_f32 v225, v210, v211
v_mfma_f32_16x16x32_bf16 a[240:243], v[52:55], v[80:83], a[240:243]
v_cvt_pk_bf16_f32 v226, v212, v213
v_cvt_pk_bf16_f32 v227, v214, v215
v_mfma_f32_16x16x32_bf16 a[244:247], v[48:51], v[36:39], a[244:247]
buffer_store_dwordx4 v[224:227], v252, s[8:11], s37 offen offset:2048 sc1
v_mfma_f32_16x16x32_bf16 a[244:247], v[52:55], v[84:87], a[244:247]
v_accvgpr_read_b32 v216, a182
v_accvgpr_read_b32 v217, a198
v_mfma_f32_16x16x32_bf16 a[248:251], v[48:51], v[40:43], a[248:251]
v_accvgpr_read_b32 v218, a214
v_accvgpr_read_b32 v219, a230
v_mfma_f32_16x16x32_bf16 a[248:251], v[52:55], v[88:91], a[248:251]
v_accvgpr_read_b32 v220, a183
v_accvgpr_read_b32 v221, a199
v_mfma_f32_16x16x32_bf16 a[252:255], v[48:51], v[44:47], a[252:255]
v_accvgpr_read_b32 v222, a215
v_accvgpr_read_b32 v223, a231
v_mfma_f32_16x16x32_bf16 a[252:255], v[52:55], v[92:95], a[252:255]
v_cvt_pk_bf16_f32 v228, v216, v217
s_waitcnt lgkmcnt(2)
v_mfma_f32_16x16x32_bf16 a[240:243], v[56:59], v[96:99], a[240:243]
v_cvt_pk_bf16_f32 v229, v218, v219
v_cvt_pk_bf16_f32 v230, v220, v221
v_mfma_f32_16x16x32_bf16 a[240:243], v[60:63], v[112:115], a[240:243]
v_cvt_pk_bf16_f32 v231, v222, v223
buffer_store_dwordx4 v[228:231], v252, s[8:11], s37 offen offset:2304 sc1
v_mfma_f32_16x16x32_bf16 a[244:247], v[56:59], v[100:103], a[244:247]
v_accvgpr_read_b32 v208, a184
v_accvgpr_read_b32 v209, a200
v_mfma_f32_16x16x32_bf16 a[244:247], v[60:63], v[116:119], a[244:247]
v_accvgpr_read_b32 v210, a216
v_accvgpr_read_b32 v211, a232
v_mfma_f32_16x16x32_bf16 a[248:251], v[56:59], v[104:107], a[248:251]
v_accvgpr_read_b32 v212, a185
v_accvgpr_read_b32 v213, a201
v_mfma_f32_16x16x32_bf16 a[248:251], v[60:63], v[120:123], a[248:251]
v_accvgpr_read_b32 v214, a217
v_accvgpr_read_b32 v215, a233
v_mfma_f32_16x16x32_bf16 a[252:255], v[56:59], v[108:111], a[252:255]
v_cvt_pk_bf16_f32 v224, v208, v209
v_cvt_pk_bf16_f32 v225, v210, v211
v_mfma_f32_16x16x32_bf16 a[252:255], v[60:63], v[124:127], a[252:255]
v_cvt_pk_bf16_f32 v226, v212, v213
s_waitcnt lgkmcnt(0)
v_mfma_f32_16x16x32_bf16 a[240:243], v[64:67], v[128:131], a[240:243]
v_cvt_pk_bf16_f32 v227, v214, v215
buffer_store_dwordx4 v[224:227], v252, s[8:11], s38 offen offset:2048 sc1
v_mfma_f32_16x16x32_bf16 a[240:243], v[68:71], v[232:235], a[240:243]
v_accvgpr_read_b32 v216, a186
v_accvgpr_read_b32 v217, a202
v_mfma_f32_16x16x32_bf16 a[244:247], v[64:67], v[132:135], a[244:247]
v_accvgpr_read_b32 v218, a218
v_accvgpr_read_b32 v219, a234
v_mfma_f32_16x16x32_bf16 a[244:247], v[68:71], v[236:239], a[244:247]
v_accvgpr_read_b32 v220, a187
v_accvgpr_read_b32 v221, a203
v_mfma_f32_16x16x32_bf16 a[248:251], v[64:67], v[136:139], a[248:251]
v_accvgpr_read_b32 v222, a219
v_accvgpr_read_b32 v223, a235
v_mfma_f32_16x16x32_bf16 a[248:251], v[68:71], v[240:243], a[248:251]
v_cvt_pk_bf16_f32 v228, v216, v217
v_cvt_pk_bf16_f32 v229, v218, v219
v_mfma_f32_16x16x32_bf16 a[252:255], v[64:67], v[140:143], a[252:255]
v_cvt_pk_bf16_f32 v230, v220, v221
v_cvt_pk_bf16_f32 v231, v222, v223
v_mfma_f32_16x16x32_bf16 a[252:255], v[68:71], v[244:247], a[252:255]
buffer_store_dwordx4 v[228:231], v252, s[8:11], s38 offen offset:2304 sc1
v_accvgpr_read_b32 v208, a188
v_accvgpr_read_b32 v209, a204
v_accvgpr_read_b32 v210, a220
v_accvgpr_read_b32 v211, a236
v_accvgpr_read_b32 v212, a189
v_accvgpr_read_b32 v213, a205
v_accvgpr_read_b32 v214, a221
v_accvgpr_read_b32 v215, a237
v_cvt_pk_bf16_f32 v224, v208, v209
v_cvt_pk_bf16_f32 v225, v210, v211
v_cvt_pk_bf16_f32 v226, v212, v213
v_cvt_pk_bf16_f32 v227, v214, v215
buffer_store_dwordx4 v[224:227], v252, s[8:11], s39 offen offset:2048 sc1
v_accvgpr_read_b32 v216, a190
v_accvgpr_read_b32 v217, a206
v_accvgpr_read_b32 v218, a222
v_accvgpr_read_b32 v219, a238
v_accvgpr_read_b32 v220, a191
v_accvgpr_read_b32 v221, a207
v_accvgpr_read_b32 v222, a223
v_accvgpr_read_b32 v223, a239
v_cvt_pk_bf16_f32 v228, v216, v217
v_cvt_pk_bf16_f32 v229, v218, v219
v_cvt_pk_bf16_f32 v230, v220, v221
v_cvt_pk_bf16_f32 v231, v222, v223
buffer_store_dwordx4 v[228:231], v252, s[8:11], s39 offen offset:2304 sc1
v_accvgpr_read_b32 v208, a240
v_accvgpr_read_b32 v209, a241
v_accvgpr_read_b32 v210, a242
v_accvgpr_read_b32 v211, a243
v_accvgpr_read_b32 v212, a244
v_accvgpr_read_b32 v213, a245
v_accvgpr_read_b32 v214, a246
v_accvgpr_read_b32 v215, a247
v_cvt_pk_bf16_f32 v224, v208, v209
v_cvt_pk_bf16_f32 v225, v210, v211
v_cvt_pk_bf16_f32 v226, v212, v213
v_cvt_pk_bf16_f32 v227, v214, v215
s_nop 0
v_permlane16_swap_b32 v224, v226
v_permlane16_swap_b32 v225, v227
buffer_store_dwordx4 v[224:227], v9, s[8:11], s32 offen sc1
v_accvgpr_read_b32 v216, a248
v_accvgpr_read_b32 v217, a249
v_accvgpr_read_b32 v218, a250
v_accvgpr_read_b32 v219, a251
v_accvgpr_read_b32 v220, a252
v_accvgpr_read_b32 v221, a253
v_accvgpr_read_b32 v222, a254
v_accvgpr_read_b32 v223, a255
v_cvt_pk_bf16_f32 v228, v216, v217
v_cvt_pk_bf16_f32 v229, v218, v219
v_cvt_pk_bf16_f32 v230, v220, v221
v_cvt_pk_bf16_f32 v231, v222, v223
s_nop 0
v_permlane16_swap_b32 v228, v230
v_permlane16_swap_b32 v229, v231
buffer_store_dwordx4 v[228:231], v9, s[8:11], s33 offen sc1
s_mov_b32 s14, s35
s_cmp_eq_u32 s7, 1
s_cbranch_scc1 L_last
s_cmp_eq_u32 s4, 3
s_cbranch_scc1 L_r_side
v_and_b32 v6, 7, v1
v_lshrrev_b32 v7, 3, v1
s_mul_i32 s22, s4, 24
v_add_u32 v7, s22, v7
s_and_b32 s23, s6, 1
s_lshl_b32 s23, s23, 3
v_add_u32 v8, s23, v6
v_lshlrev_b32 v8, 4, v8
v_lshl_add_u32 v4, v7, 8, v8
s_lshl_b32 s24, s5, 4
s_lshr_b32 s25, s6, 1
s_add_u32 s24, s24, s25
s_mul_i32 s20, s24, 18432
v_mov_b32 v13, 2146435072
v_cmp_eq_u32 vcc, 0, v0
v_mov_b32 v14, s68
v_mov_b32 v15, s69
v_cndmask_b32 v13, v13, 0, vcc
s_waitcnt vmcnt(0)
s_barrier
buffer_store_dwordx2 v[14:15], v13, s[8:11], s14 offen sc1
s_add_u32 s24, s20, 37416960
s_add_u32 s25, s24, 4096
buffer_load_dwordx4 v[16:19], v4, s[8:11], s24 offen offset:0 sc1
buffer_load_dwordx4 v[20:23], v4, s[8:11], s24 offen offset:2048 sc1
buffer_load_dwordx4 v[24:27], v4, s[8:11], s25 offen offset:0 sc1
s_lshl_b32 s24, s5, 12
s_add_u32 s24, s24, 655360
v_and_b32 v6, 31, v1
v_lshlrev_b32 v6, 7, v6
s_mov_b32 s52, 0
L_poll4:
buffer_load_dwordx2 v[14:15], v6, s[8:11], s24 offen sc1
s_add_u32 s52, s52, 1
s_waitcnt vmcnt(0)
v_cmp_ne_u64 vcc, s[68:69], v[14:15]
s_cmp_ge_u32 s52, 1048576
s_cbranch_scc1 L_got4
s_and_b64 exec, exec, vcc
s_cbranch_execnz L_poll4
L_got4:
s_mov_b64 exec, -1
s_add_u32 s24, s20, 80146432
s_add_u32 s25, s24, 4096
buffer_load_dwordx4 v[28:31], v4, s[8:11], s24 offen offset:0 sc1
buffer_load_dwordx4 v[32:35], v4, s[8:11], s24 offen offset:2048 sc1
buffer_load_dwordx4 v[36:39], v4, s[8:11], s25 offen offset:0 sc1
s_add_u32 s24, s20, 82505728
s_add_u32 s25, s24, 4096
buffer_load_dwordx4 v[40:43], v4, s[8:11], s24 offen offset:0 sc1
buffer_load_dwordx4 v[44:47], v4, s[8:11], s24 offen offset:2048 sc1
buffer_load_dwordx4 v[48:51], v4, s[8:11], s25 offen offset:0 sc1
s_add_u32 s24, s20, 84865024
s_add_u32 s25, s24, 4096
buffer_load_dwordx4 v[52:55], v4, s[8:11], s24 offen offset:0 sc1
buffer_load_dwordx4 v[56:59], v4, s[8:11], s24 offen offset:2048 sc1
buffer_load_dwordx4 v[60:63], v4, s[8:11], s25 offen offset:0 sc1
s_add_u32 s24, s20, 87224320
s_add_u32 s25, s24, 4096
buffer_load_dwordx4 v[64:67], v4, s[8:11], s24 offen offset:0 sc1
buffer_load_dwordx4 v[68:71], v4, s[8:11], s24 offen offset:2048 sc1
buffer_load_dwordx4 v[72:75], v4, s[8:11], s25 offen offset:0 sc1
s_add_u32 s24, s20, 89583616
s_add_u32 s25, s24, 4096
buffer_load_dwordx4 v[76:79], v4, s[8:11], s24 offen offset:0 sc1
buffer_load_dwordx4 v[80:83], v4, s[8:11], s24 offen offset:2048 sc1
buffer_load_dwordx4 v[84:87], v4, s[8:11], s25 offen offset:0 sc1
s_add_u32 s24, s20, 91942912
s_add_u32 s25, s24, 4096
buffer_load_dwordx4 v[88:91], v4, s[8:11], s24 offen offset:0 sc1
buffer_load_dwordx4 v[92:95], v4, s[8:11], s24 offen offset:2048 sc1
buffer_load_dwordx4 v[96:99], v4, s[8:11], s25 offen offset:0 sc1
s_add_u32 s24, s20, 94302208
s_add_u32 s25, s24, 4096
buffer_load_dwordx4 v[100:103], v4, s[8:11], s24 offen offset:0 sc1
buffer_load_dwordx4 v[104:107], v4, s[8:11], s24 offen offset:2048 sc1
buffer_load_dwordx4 v[108:111], v4, s[8:11], s25 offen offset:0 sc1
s_add_u32 s24, s20, 96661504
s_add_u32 s25, s24, 4096
buffer_load_dwordx4 v[112:115], v4, s[8:11], s24 offen offset:0 sc1
buffer_load_dwordx4 v[116:119], v4, s[8:11], s24 offen offset:2048 sc1
buffer_load_dwordx4 v[120:123], v4, s[8:11], s25 offen offset:0 sc1
s_mov_b64 s[28:29], s[20:21]
s_lshr_b32 s20, s5, 2
s_lshl_b32 s20, s20, 3
s_lshr_b32 s21, s6, 2
s_add_u32 s20, s20, s21
s_and_b32 s21, s5, 3
s_lshl_b32 s21, s21, 2
s_and_b32 s22, s6, 3
s_add_u32 s21, s21, s22
s_mov_b32 s30, s21
s_mov_b64 s[20:21], s[28:29]
s_mul_i32 s32, s30, 147456
s_add_u32 s32, s32, 4198400
s_mul_i32 s33, s4, 24576
s_add_u32 s32, s32, s33
s_waitcnt vmcnt(26)
v_lshlrev_b32 v128, 16, v16
v_and_b32 v129, 0xffff0000, v16
v_lshlrev_b32 v130, 16, v17
v_and_b32 v131, 0xffff0000, v17
v_lshlrev_b32 v132, 16, v18
v_and_b32 v133, 0xffff0000, v18
v_lshlrev_b32 v134, 16, v19
v_and_b32 v135, 0xffff0000, v19
s_add_u32 m0, s33, 0
s_add_u32 s40, s32, 0
buffer_load_dwordx4 v2, s[8:11], s40 offen offset:0 sc1 lds
s_waitcnt vmcnt(26)
v_lshlrev_b32 v136, 16, v20
v_and_b32 v137, 0xffff0000, v20
v_lshlrev_b32 v138, 16, v21
v_and_b32 v139, 0xffff0000, v21
v_lshlrev_b32 v140, 16, v22
v_and_b32 v141, 0xffff0000, v22
v_lshlrev_b32 v142, 16, v23
v_and_b32 v143, 0xffff0000, v23
buffer_load_dwordx4 v2, s[8:11], s40 offen offset:1024 sc1 lds
s_waitcnt vmcnt(26)
v_lshlrev_b32 v144, 16, v24
v_and_b32 v145, 0xffff0000, v24
v_lshlrev_b32 v146, 16, v25
v_and_b32 v147, 0xffff0000, v25
v_lshlrev_b32 v148, 16, v26
v_and_b32 v149, 0xffff0000, v26
v_lshlrev_b32 v150, 16, v27
v_and_b32 v151, 0xffff0000, v27
buffer_load_dwordx4 v2, s[8:11], s40 offen offset:2048 sc1 lds
s_waitcnt vmcnt(26)
v_lshlrev_b32 v6, 16, v28
v_and_b32 v7, 0xffff0000, v28
v_add_f32 v128, v128, v6
v_add_f32 v129, v129, v7
v_lshlrev_b32 v8, 16, v29
v_and_b32 v9, 0xffff0000, v29
v_add_f32 v130, v130, v8
v_add_f32 v131, v131, v9
v_lshlrev_b32 v6, 16, v30
v_and_b32 v7, 0xffff0000, v30
v_add_f32 v132, v132, v6
v_add_f32 v133, v133, v7
v_lshlrev_b32 v8, 16, v31
v_and_b32 v9, 0xffff0000, v31
v_add_f32 v134, v134, v8
v_add_f32 v135, v135, v9
buffer_load_dwordx4 v2, s[8:11], s40 offen offset:3072 sc1 lds
s_waitcnt vmcnt(26)
v_lshlrev_b32 v6, 16, v32
v_and_b32 v7, 0xffff0000, v32
v_add_f32 v136, v136, v6
v_add_f32 v137, v137, v7
v_lshlrev_b32 v8, 16, v33
v_and_b32 v9, 0xffff0000, v33
v_add_f32 v138, v138, v8
v_add_f32 v139, v139, v9
v_lshlrev_b32 v6, 16, v34
v_and_b32 v7, 0xffff0000, v34
v_add_f32 v140, v140, v6
v_add_f32 v141, v141, v7
v_lshlrev_b32 v8, 16, v35
v_and_b32 v9, 0xffff0000, v35
v_add_f32 v142, v142, v8
v_add_f32 v143, v143, v9
s_add_u32 m0, s33, 4096
s_add_u32 s40, s32, 4096
buffer_load_dwordx4 v2, s[8:11], s40 offen offset:0 sc1 lds
s_waitcnt vmcnt(26)
v_lshlrev_b32 v6, 16, v36
v_and_b32 v7, 0xffff0000, v36
v_add_f32 v144, v144, v6
v_add_f32 v145, v145, v7
v_lshlrev_b32 v8, 16, v37
v_and_b32 v9, 0xffff0000, v37
v_add_f32 v146, v146, v8
v_add_f32 v147, v147, v9
v_lshlrev_b32 v6, 16, v38
v_and_b32 v7, 0xffff0000, v38
v_add_f32 v148, v148, v6
v_add_f32 v149, v149, v7
v_lshlrev_b32 v8, 16, v39
v_and_b32 v9, 0xffff0000, v39
v_add_f32 v150, v150, v8
v_add_f32 v151, v151, v9
buffer_load_dwordx4 v2, s[8:11], s40 offen offset:1024 sc1 lds
s_waitcnt vmcnt(26)
v_lshlrev_b32 v6, 16, v40
v_and_b32 v7, 0xffff0000, v40
v_add_f32 v128, v128, v6
v_add_f32 v129, v129, v7
v_lshlrev_b32 v8, 16, v41
v_and_b32 v9, 0xffff0000, v41
v_add_f32 v130, v130, v8
v_add_f32 v131, v131, v9
v_lshlrev_b32 v6, 16, v42
v_and_b32 v7, 0xffff0000, v42
v_add_f32 v132, v132, v6
v_add_f32 v133, v133, v7
v_lshlrev_b32 v8, 16, v43
v_and_b32 v9, 0xffff0000, v43
v_add_f32 v134, v134, v8
v_add_f32 v135, v135, v9
buffer_load_dwordx4 v2, s[8:11], s40 offen offset:2048 sc1 lds
s_waitcnt vmcnt(26)
v_lshlrev_b32 v6, 16, v44
v_and_b32 v7, 0xffff0000, v44
v_add_f32 v136, v136, v6
v_add_f32 v137, v137, v7
v_lshlrev_b32 v8, 16, v45
v_and_b32 v9, 0xffff0000, v45
v_add_f32 v138, v138, v8
v_add_f32 v139, v139, v9
v_lshlrev_b32 v6, 16, v46
v_and_b32 v7, 0xffff0000, v46
v_add_f32 v140, v140, v6
v_add_f32 v141, v141, v7
v_lshlrev_b32 v8, 16, v47
v_and_b32 v9, 0xffff0000, v47
v_add_f32 v142, v142, v8
v_add_f32 v143, v143, v9
buffer_load_dwordx4 v2, s[8:11], s40 offen offset:3072 sc1 lds
s_waitcnt vmcnt(26)
v_lshlrev_b32 v6, 16, v48
v_and_b32 v7, 0xffff0000, v48
v_add_f32 v144, v144, v6
v_add_f32 v145, v145, v7
v_lshlrev_b32 v8, 16, v49
v_and_b32 v9, 0xffff0000, v49
v_add_f32 v146, v146, v8
v_add_f32 v147, v147, v9
v_lshlrev_b32 v6, 16, v50
v_and_b32 v7, 0xffff0000, v50
v_add_f32 v148, v148, v6
v_add_f32 v149, v149, v7
v_lshlrev_b32 v8, 16, v51
v_and_b32 v9, 0xffff0000, v51
v_add_f32 v150, v150, v8
v_add_f32 v151, v151, v9
s_add_u32 m0, s33, 8192
s_add_u32 s40, s32, 8192
buffer_load_dwordx4 v2, s[8:11], s40 offen offset:0 sc1 lds
s_waitcnt vmcnt(26)
v_lshlrev_b32 v6, 16, v52
v_and_b32 v7, 0xffff0000, v52
v_add_f32 v128, v128, v6
v_add_f32 v129, v129, v7
v_lshlrev_b32 v8, 16, v53
v_and_b32 v9, 0xffff0000, v53
v_add_f32 v130, v130, v8
v_add_f32 v131, v131, v9
v_lshlrev_b32 v6, 16, v54
v_and_b32 v7, 0xffff0000, v54
v_add_f32 v132, v132, v6
v_add_f32 v133, v133, v7
v_lshlrev_b32 v8, 16, v55
v_and_b32 v9, 0xffff0000, v55
v_add_f32 v134, v134, v8
v_add_f32 v135, v135, v9
buffer_load_dwordx4 v2, s[8:11], s40 offen offset:1024 sc1 lds
s_waitcnt vmcnt(26)
v_lshlrev_b32 v6, 16, v56
v_and_b32 v7, 0xffff0000, v56
v_add_f32 v136, v136, v6
v_add_f32 v137, v137, v7
v_lshlrev_b32 v8, 16, v57
v_and_b32 v9, 0xffff0000, v57
v_add_f32 v138, v138, v8
v_add_f32 v139, v139, v9
v_lshlrev_b32 v6, 16, v58
v_and_b32 v7, 0xffff0000, v58
v_add_f32 v140, v140, v6
v_add_f32 v141, v141, v7
v_lshlrev_b32 v8, 16, v59
v_and_b32 v9, 0xffff0000, v59
v_add_f32 v142, v142, v8
v_add_f32 v143, v143, v9
buffer_load_dwordx4 v2, s[8:11], s40 offen offset:2048 sc1 lds
s_waitcnt vmcnt(26)
v_lshlrev_b32 v6, 16, v60
v_and_b32 v7, 0xffff0000, v60
v_add_f32 v144, v144, v6
v_add_f32 v145, v145, v7
v_lshlrev_b32 v8, 16, v61
v_and_b32 v9, 0xffff0000, v61
v_add_f32 v146, v146, v8
v_add_f32 v147, v147, v9
v_lshlrev_b32 v6, 16, v62
v_and_b32 v7, 0xffff0000, v62
v_add_f32 v148, v148, v6
v_add_f32 v149, v149, v7
v_lshlrev_b32 v8, 16, v63
v_and_b32 v9, 0xffff0000, v63
v_add_f32 v150, v150, v8
v_add_f32 v151, v151, v9
buffer_load_dwordx4 v2, s[8:11], s40 offen offset:3072 sc1 lds
s_waitcnt vmcnt(26)
v_lshlrev_b32 v6, 16, v64
v_and_b32 v7, 0xffff0000, v64
v_add_f32 v128, v128, v6
v_add_f32 v129, v129, v7
v_lshlrev_b32 v8, 16, v65
v_and_b32 v9, 0xffff0000, v65
v_add_f32 v130, v130, v8
v_add_f32 v131, v131, v9
v_lshlrev_b32 v6, 16, v66
v_and_b32 v7, 0xffff0000, v66
v_add_f32 v132, v132, v6
v_add_f32 v133, v133, v7
v_lshlrev_b32 v8, 16, v67
v_and_b32 v9, 0xffff0000, v67
v_add_f32 v134, v134, v8
v_add_f32 v135, v135, v9
s_add_u32 m0, s33, 12288
s_add_u32 s40, s32, 12288
buffer_load_dwordx4 v2, s[8:11], s40 offen offset:0 sc1 lds
s_waitcnt vmcnt(26)
v_lshlrev_b32 v6, 16, v68
v_and_b32 v7, 0xffff0000, v68
v_add_f32 v136, v136, v6
v_add_f32 v137, v137, v7
v_lshlrev_b32 v8, 16, v69
v_and_b32 v9, 0xffff0000, v69
v_add_f32 v138, v138, v8
v_add_f32 v139, v139, v9
v_lshlrev_b32 v6, 16, v70
v_and_b32 v7, 0xffff0000, v70
v_add_f32 v140, v140, v6
v_add_f32 v141, v141, v7
v_lshlrev_b32 v8, 16, v71
v_and_b32 v9, 0xffff0000, v71
v_add_f32 v142, v142, v8
v_add_f32 v143, v143, v9
buffer_load_dwordx4 v2, s[8:11], s40 offen offset:1024 sc1 lds
s_waitcnt vmcnt(26)
v_lshlrev_b32 v6, 16, v72
v_and_b32 v7, 0xffff0000, v72
v_add_f32 v144, v144, v6
v_add_f32 v145, v145, v7
v_lshlrev_b32 v8, 16, v73
v_and_b32 v9, 0xffff0000, v73
v_add_f32 v146, v146, v8
v_add_f32 v147, v147, v9
v_lshlrev_b32 v6, 16, v74
v_and_b32 v7, 0xffff0000, v74
v_add_f32 v148, v148, v6
v_add_f32 v149, v149, v7
v_lshlrev_b32 v8, 16, v75
v_and_b32 v9, 0xffff0000, v75
v_add_f32 v150, v150, v8
v_add_f32 v151, v151, v9
buffer_load_dwordx4 v2, s[8:11], s40 offen offset:2048 sc1 lds
s_waitcnt vmcnt(26)
v_lshlrev_b32 v6, 16, v76
v_and_b32 v7, 0xffff0000, v76
v_add_f32 v128, v128, v6
v_add_f32 v129, v129, v7
v_lshlrev_b32 v8, 16, v77
v_and_b32 v9, 0xffff0000, v77
v_add_f32 v130, v130, v8
v_add_f32 v131, v131, v9
v_lshlrev_b32 v6, 16, v78
v_and_b32 v7, 0xffff0000, v78
v_add_f32 v132, v132, v6
v_add_f32 v133, v133, v7
v_lshlrev_b32 v8, 16, v79
v_and_b32 v9, 0xffff0000, v79
v_add_f32 v134, v134, v8
v_add_f32 v135, v135, v9
buffer_load_dwordx4 v2, s[8:11], s40 offen offset:3072 sc1 lds
s_waitcnt vmcnt(26)
v_lshlrev_b32 v6, 16, v80
v_and_b32 v7, 0xffff0000, v80
v_add_f32 v136, v136, v6
v_add_f32 v137, v137, v7
v_lshlrev_b32 v8, 16, v81
v_and_b32 v9, 0xffff0000, v81
v_add_f32 v138, v138, v8
v_add_f32 v139, v139, v9
v_lshlrev_b32 v6, 16, v82
v_and_b32 v7, 0xffff0000, v82
v_add_f32 v140, v140, v6
v_add_f32 v141, v141, v7
v_lshlrev_b32 v8, 16, v83
v_and_b32 v9, 0xffff0000, v83
v_add_f32 v142, v142, v8
v_add_f32 v143, v143, v9
s_add_u32 m0, s33, 16384
s_add_u32 s40, s32, 16384
buffer_load_dwordx4 v2, s[8:11], s40 offen offset:0 sc1 lds
s_waitcnt vmcnt(26)
v_lshlrev_b32 v6, 16, v84
v_and_b32 v7, 0xffff0000, v84
v_add_f32 v144, v144, v6
v_add_f32 v145, v145, v7
v_lshlrev_b32 v8, 16, v85
v_and_b32 v9, 0xffff0000, v85
v_add_f32 v146, v146, v8
v_add_f32 v147, v147, v9
v_lshlrev_b32 v6, 16, v86
v_and_b32 v7, 0xffff0000, v86
v_add_f32 v148, v148, v6
v_add_f32 v149, v149, v7
v_lshlrev_b32 v8, 16, v87
v_and_b32 v9, 0xffff0000, v87
v_add_f32 v150, v150, v8
v_add_f32 v151, v151, v9
buffer_load_dwordx4 v2, s[8:11], s40 offen offset:1024 sc1 lds
s_waitcnt vmcnt(26)
v_lshlrev_b32 v6, 16, v88
v_and_b32 v7, 0xffff0000, v88
v_add_f32 v128, v128, v6
v_add_f32 v129, v129, v7
v_lshlrev_b32 v8, 16, v89
v_and_b32 v9, 0xffff0000, v89
v_add_f32 v130, v130, v8
v_add_f32 v131, v131, v9
v_lshlrev_b32 v6, 16, v90
v_and_b32 v7, 0xffff0000, v90
v_add_f32 v132, v132, v6
v_add_f32 v133, v133, v7
v_lshlrev_b32 v8, 16, v91
v_and_b32 v9, 0xffff0000, v91
v_add_f32 v134, v134, v8
v_add_f32 v135, v135, v9
buffer_load_dwordx4 v2, s[8:11], s40 offen offset:2048 sc1 lds
s_waitcnt vmcnt(26)
v_lshlrev_b32 v6, 16, v92
v_and_b32 v7, 0xffff0000, v92
v_add_f32 v136, v136, v6
v_add_f32 v137, v137, v7
v_lshlrev_b32 v8, 16, v93
v_and_b32 v9, 0xffff0000, v93
v_add_f32 v138, v138, v8
v_add_f32 v139, v139, v9
v_lshlrev_b32 v6, 16, v94
v_and_b32 v7, 0xffff0000, v94
v_add_f32 v140, v140, v6
v_add_f32 v141, v141, v7
v_lshlrev_b32 v8, 16, v95
v_and_b32 v9, 0xffff0000, v95
v_add_f32 v142, v142, v8
v_add_f32 v143, v143, v9
buffer_load_dwordx4 v2, s[8:11], s40 offen offset:3072 sc1 lds
s_waitcnt vmcnt(26)
v_lshlrev_b32 v6, 16, v96
v_and_b32 v7, 0xffff0000, v96
v_add_f32 v144, v144, v6
v_add_f32 v145, v145, v7
v_lshlrev_b32 v8, 16, v97
v_and_b32 v9, 0xffff0000, v97
v_add_f32 v146, v146, v8
v_add_f32 v147, v147, v9
v_lshlrev_b32 v6, 16, v98
v_and_b32 v7, 0xffff0000, v98
v_add_f32 v148, v148, v6
v_add_f32 v149, v149, v7
v_lshlrev_b32 v8, 16, v99
v_and_b32 v9, 0xffff0000, v99
v_add_f32 v150, v150, v8
v_add_f32 v151, v151, v9
s_add_u32 m0, s33, 20480
s_add_u32 s40, s32, 20480
buffer_load_dwordx4 v2, s[8:11], s40 offen offset:0 sc1 lds
s_waitcnt vmcnt(26)
v_lshlrev_b32 v6, 16, v100
v_and_b32 v7, 0xffff0000, v100
v_add_f32 v128, v128, v6
v_add_f32 v129, v129, v7
v_lshlrev_b32 v8, 16, v101
v_and_b32 v9, 0xffff0000, v101
v_add_f32 v130, v130, v8
v_add_f32 v131, v131, v9
v_lshlrev_b32 v6, 16, v102
v_and_b32 v7, 0xffff0000, v102
v_add_f32 v132, v132, v6
v_add_f32 v133, v133, v7
v_lshlrev_b32 v8, 16, v103
v_and_b32 v9, 0xffff0000, v103
v_add_f32 v134, v134, v8
v_add_f32 v135, v135, v9
buffer_load_dwordx4 v2, s[8:11], s40 offen offset:1024 sc1 lds
s_waitcnt vmcnt(26)
v_lshlrev_b32 v6, 16, v104
v_and_b32 v7, 0xffff0000, v104
v_add_f32 v136, v136, v6
v_add_f32 v137, v137, v7
v_lshlrev_b32 v8, 16, v105
v_and_b32 v9, 0xffff0000, v105
v_add_f32 v138, v138, v8
v_add_f32 v139, v139, v9
v_lshlrev_b32 v6, 16, v106
v_and_b32 v7, 0xffff0000, v106
v_add_f32 v140, v140, v6
v_add_f32 v141, v141, v7
v_lshlrev_b32 v8, 16, v107
v_and_b32 v9, 0xffff0000, v107
v_add_f32 v142, v142, v8
v_add_f32 v143, v143, v9
buffer_load_dwordx4 v2, s[8:11], s40 offen offset:2048 sc1 lds
s_waitcnt vmcnt(26)
v_lshlrev_b32 v6, 16, v108
v_and_b32 v7, 0xffff0000, v108
v_add_f32 v144, v144, v6
v_add_f32 v145, v145, v7
v_lshlrev_b32 v8, 16, v109
v_and_b32 v9, 0xffff0000, v109
v_add_f32 v146, v146, v8
v_add_f32 v147, v147, v9
v_lshlrev_b32 v6, 16, v110
v_and_b32 v7, 0xffff0000, v110
v_add_f32 v148, v148, v6
v_add_f32 v149, v149, v7
v_lshlrev_b32 v8, 16, v111
v_and_b32 v9, 0xffff0000, v111
v_add_f32 v150, v150, v8
v_add_f32 v151, v151, v9
buffer_load_dwordx4 v2, s[8:11], s40 offen offset:3072 sc1 lds
s_waitcnt vmcnt(26)
v_lshlrev_b32 v6, 16, v112
v_and_b32 v7, 0xffff0000, v112
v_add_f32 v128, v128, v6
v_add_f32 v129, v129, v7
v_lshlrev_b32 v8, 16, v113
v_and_b32 v9, 0xffff0000, v113
v_add_f32 v130, v130, v8
v_add_f32 v131, v131, v9
v_lshlrev_b32 v6, 16, v114
v_and_b32 v7, 0xffff0000, v114
v_add_f32 v132, v132, v6
v_add_f32 v133, v133, v7
v_lshlrev_b32 v8, 16, v115
v_and_b32 v9, 0xffff0000, v115
v_add_f32 v134, v134, v8
v_add_f32 v135, v135, v9
s_waitcnt vmcnt(25)
v_lshlrev_b32 v6, 16, v116
v_and_b32 v7, 0xffff0000, v116
v_add_f32 v136, v136, v6
v_add_f32 v137, v137, v7
v_lshlrev_b32 v8, 16, v117
v_and_b32 v9, 0xffff0000, v117
v_add_f32 v138, v138, v8
v_add_f32 v139, v139, v9
v_lshlrev_b32 v6, 16, v118
v_and_b32 v7, 0xffff0000, v118
v_add_f32 v140, v140, v6
v_add_f32 v141, v141, v7
v_lshlrev_b32 v8, 16, v119
v_and_b32 v9, 0xffff0000, v119
v_add_f32 v142, v142, v8
v_add_f32 v143, v143, v9
s_waitcnt vmcnt(24)
v_lshlrev_b32 v6, 16, v120
v_and_b32 v7, 0xffff0000, v120
v_add_f32 v144, v144, v6
v_add_f32 v145, v145, v7
v_lshlrev_b32 v8, 16, v121
v_and_b32 v9, 0xffff0000, v121
v_add_f32 v146, v146, v8
v_add_f32 v147, v147, v9
v_lshlrev_b32 v6, 16, v122
v_and_b32 v7, 0xffff0000, v122
v_add_f32 v148, v148, v6
v_add_f32 v149, v149, v7
v_lshlrev_b32 v8, 16, v123
v_and_b32 v9, 0xffff0000, v123
v_add_f32 v150, v150, v8
v_add_f32 v151, v151, v9
v_cvt_pk_bf16_f32 v152, v128, v129
v_cvt_pk_bf16_f32 v153, v130, v131
v_cvt_pk_bf16_f32 v154, v132, v133
v_cvt_pk_bf16_f32 v155, v134, v135
v_cvt_pk_bf16_f32 v156, v136, v137
v_cvt_pk_bf16_f32 v157, v138, v139
v_cvt_pk_bf16_f32 v158, v140, v141
v_cvt_pk_bf16_f32 v159, v142, v143
v_cvt_pk_bf16_f32 v160, v144, v145
v_cvt_pk_bf16_f32 v161, v146, v147
v_cvt_pk_bf16_f32 v162, v148, v149
v_cvt_pk_bf16_f32 v163, v150, v151
s_add_u32 s24, s20, 30339072
s_add_u32 s25, s24, 4096
buffer_store_dwordx4 v[152:155], v4, s[8:11], s24 offen offset:0 sc1
buffer_store_dwordx4 v[156:159], v4, s[8:11], s24 offen offset:2048 sc1
buffer_store_dwordx4 v[160:163], v4, s[8:11], s25 offen offset:0 sc1
v_add_f32 v6, v128, v129
v_mul_f32 v7, v128, v128
v_mul_f32 v9, v129, v129
v_mov_b32 v8, 0
v_add_f32 v6, v6, v130
v_add_f32 v8, v8, v131
v_fmac_f32 v7, v130, v130
v_fmac_f32 v9, v131, v131
v_add_f32 v6, v6, v132
v_add_f32 v8, v8, v133
v_fmac_f32 v7, v132, v132
v_fmac_f32 v9, v133, v133
v_add_f32 v6, v6, v134
v_add_f32 v8, v8, v135
v_fmac_f32 v7, v134, v134
v_fmac_f32 v9, v135, v135
v_add_f32 v6, v6, v136
v_add_f32 v8, v8, v137
v_fmac_f32 v7, v136, v136
v_fmac_f32 v9, v137, v137
v_add_f32 v6, v6, v138
v_add_f32 v8, v8, v139
v_fmac_f32 v7, v138, v138
v_fmac_f32 v9, v139, v139
v_add_f32 v6, v6, v140
v_add_f32 v8, v8, v141
v_fmac_f32 v7, v140, v140
v_fmac_f32 v9, v141, v141
v_add_f32 v6, v6, v142
v_add_f32 v8, v8, v143
v_fmac_f32 v7, v142, v142
v_fmac_f32 v9, v143, v143
v_add_f32 v6, v6, v144
v_add_f32 v8, v8, v145
v_fmac_f32 v7, v144, v144
v_fmac_f32 v9, v145, v145
v_add_f32 v6, v6, v146
v_add_f32 v8, v8, v147
v_fmac_f32 v7, v146, v146
v_fmac_f32 v9, v147, v147
v_add_f32 v6, v6, v148
v_add_f32 v8, v8, v149
v_fmac_f32 v7, v148, v148
v_fmac_f32 v9, v149, v149
v_add_f32 v6, v6, v150
v_add_f32 v8, v8, v151
v_fmac_f32 v7, v150, v150
v_fmac_f32 v9, v151, v151
v_add_f32 v6, v6, v8
v_add_f32 v7, v7, v9
s_nop 0
v_add_f32_dpp v6, v6, v6 row_ror:8 row_mask:0xf bank_mask:0xf
v_add_f32_dpp v7, v7, v7 row_ror:8 row_mask:0xf bank_mask:0xf
v_mov_b32 v8, v6
v_mov_b32 v9, v7
s_nop 0
v_permlane16_swap_b32 v6, v8
v_permlane16_swap_b32 v7, v9
v_add_f32 v6, v6, v8
v_add_f32 v7, v7, v9
v_mov_b32 v8, v6
v_mov_b32 v9, v7
s_nop 0
v_permlane32_swap_b32 v6, v8
v_permlane32_swap_b32 v7, v9
v_add_f32 v6, v6, v8
v_add_f32 v7, v7, v9
v_and_b32 v10, 7, v1
v_lshlrev_b32 v10, 3, v10
v_add_u32 v10, 147456, v10
s_lshl_b32 s24, s4, 6
v_add_u32 v11, s24, v10
ds_write_b64 v11, v[6:7]
s_waitcnt lgkmcnt(0)
s_barrier
ds_read_b64 v[6:7], v10
ds_read_b64 v[8:9], v10 offset:64
ds_read_b64 v[12:13], v10 offset:128
s_waitcnt lgkmcnt(0)
v_add_f32 v6, v6, v8
v_add_f32 v7, v7, v9
v_add_f32 v6, v6, v12
v_add_f32 v7, v7, v13
v_mul_f32 v6, 0x3ae38e39, v6
v_mul_f32 v7, 0x3ae38e39, v7
v_fma_f32 v7, -v6, v6, v7
v_max_f32 v7, 0, v7
v_add_f32 v7, 0x3727c5ac, v7
v_rsq_f32 v7, v7
s_nop 0
v_mul_f32 v6, v6, v7
v_fma_f32 v128, v128, v7, -v6
v_fma_f32 v129, v129, v7, -v6
v_fma_f32 v130, v130, v7, -v6
v_fma_f32 v131, v131, v7, -v6
v_fma_f32 v132, v132, v7, -v6
v_fma_f32 v133, v133, v7, -v6
v_fma_f32 v134, v134, v7, -v6
v_fma_f32 v135, v135, v7, -v6
v_fma_f32 v136, v136, v7, -v6
v_fma_f32 v137, v137, v7, -v6
v_fma_f32 v138, v138, v7, -v6
v_fma_f32 v139, v139, v7, -v6
v_fma_f32 v140, v140, v7, -v6
v_fma_f32 v141, v141, v7, -v6
v_fma_f32 v142, v142, v7, -v6
v_fma_f32 v143, v143, v7, -v6
v_fma_f32 v144, v144, v7, -v6
v_fma_f32 v145, v145, v7, -v6
v_fma_f32 v146, v146, v7, -v6
v_fma_f32 v147, v147, v7, -v6
v_fma_f32 v148, v148, v7, -v6
v_fma_f32 v149, v149, v7, -v6
v_fma_f32 v150, v150, v7, -v6
v_fma_f32 v151, v151, v7, -v6
v_cvt_pk_bf16_f32 v168, v128, v129
v_cvt_pk_bf16_f32 v169, v130, v131
v_cvt_pk_bf16_f32 v170, v132, v133
v_cvt_pk_bf16_f32 v171, v134, v135
v_cvt_pk_bf16_f32 v172, v136, v137
v_cvt_pk_bf16_f32 v173, v138, v139
v_cvt_pk_bf16_f32 v174, v140, v141
v_cvt_pk_bf16_f32 v175, v142, v143
v_cvt_pk_bf16_f32 v176, v144, v145
v_cvt_pk_bf16_f32 v177, v146, v147
v_cvt_pk_bf16_f32 v178, v148, v149
v_cvt_pk_bf16_f32 v179, v150, v151
s_add_u32 s24, s20, 25620480
s_add_u32 s25, s24, 4096
buffer_store_dwordx4 v[168:171], v4, s[8:11], s24 offen offset:0 sc1
buffer_store_dwordx4 v[172:175], v4, s[8:11], s24 offen offset:2048 sc1
buffer_store_dwordx4 v[176:179], v4, s[8:11], s25 offen offset:0 sc1
s_lshl_b32 s24, s5, 5
s_add_u32 s24, s24, s6
s_lshl_b32 s14, s24, 7
s_add_u32 s14, s14, 1835008
s_branch L_r_done
L_r_side:
v_mov_b32 v13, 2146435072
v_cmp_eq_u32 vcc, 0, v0
v_mov_b32 v14, s68
v_mov_b32 v15, s69
v_cndmask_b32 v13, v13, 0, vcc
s_waitcnt vmcnt(0)
s_barrier
buffer_store_dwordx2 v[14:15], v13, s[8:11], s14 offen sc1
s_lshr_b32 s20, s5, 2
s_lshl_b32 s20, s20, 3
s_lshr_b32 s21, s6, 2
s_add_u32 s20, s20, s21
s_and_b32 s21, s5, 3
s_lshl_b32 s21, s21, 2
s_and_b32 s22, s6, 3
s_add_u32 s21, s21, s22
s_mul_i32 s32, s21, 147456
s_add_u32 s32, s32, 4198400
s_mul_i32 s33, s4, 24576
s_add_u32 s32, s32, s33
s_add_u32 m0, s33, 0
s_add_u32 s40, s32, 0
buffer_load_dwordx4 v2, s[8:11], s40 offen offset:0 sc1 lds
buffer_load_dwordx4 v2, s[8:11], s40 offen offset:1024 sc1 lds
buffer_load_dwordx4 v2, s[8:11], s40 offen offset:2048 sc1 lds
buffer_load_dwordx4 v2, s[8:11], s40 offen offset:3072 sc1 lds
s_add_u32 m0, s33, 4096
s_add_u32 s40, s32, 4096
buffer_load_dwordx4 v2, s[8:11], s40 offen offset:0 sc1 lds
buffer_load_dwordx4 v2, s[8:11], s40 offen offset:1024 sc1 lds
buffer_load_dwordx4 v2, s[8:11], s40 offen offset:2048 sc1 lds
buffer_load_dwordx4 v2, s[8:11], s40 offen offset:3072 sc1 lds
s_add_u32 m0, s33, 8192
s_add_u32 s40, s32, 8192
buffer_load_dwordx4 v2, s[8:11], s40 offen offset:0 sc1 lds
buffer_load_dwordx4 v2, s[8:11], s40 offen offset:1024 sc1 lds
buffer_load_dwordx4 v2, s[8:11], s40 offen offset:2048 sc1 lds
buffer_load_dwordx4 v2, s[8:11], s40 offen offset:3072 sc1 lds
s_add_u32 m0, s33, 12288
s_add_u32 s40, s32, 12288
buffer_load_dwordx4 v2, s[8:11], s40 offen offset:0 sc1 lds
buffer_load_dwordx4 v2, s[8:11], s40 offen offset:1024 sc1 lds
buffer_load_dwordx4 v2, s[8:11], s40 offen offset:2048 sc1 lds
buffer_load_dwordx4 v2, s[8:11], s40 offen offset:3072 sc1 lds
s_add_u32 m0, s33, 16384
s_add_u32 s40, s32, 16384
buffer_load_dwordx4 v2, s[8:11], s40 offen offset:0 sc1 lds
buffer_load_dwordx4 v2, s[8:11], s40 offen offset:1024 sc1 lds
buffer_load_dwordx4 v2, s[8:11], s40 offen offset:2048 sc1 lds
buffer_load_dwordx4 v2, s[8:11], s40 offen offset:3072 sc1 lds
s_add_u32 m0, s33, 20480
s_add_u32 s40, s32, 20480
buffer_load_dwordx4 v2, s[8:11], s40 offen offset:0 sc1 lds
buffer_load_dwordx4 v2, s[8:11], s40 offen offset:1024 sc1 lds
buffer_load_dwordx4 v2, s[8:11], s40 offen offset:2048 sc1 lds
buffer_load_dwordx4 v2, s[8:11], s40 offen offset:3072 sc1 lds
s_add_u32 m0, s33, 24576
s_add_u32 s40, s32, 24576
buffer_load_dwordx4 v2, s[8:11], s40 offen offset:0 sc1 lds
buffer_load_dwordx4 v2, s[8:11], s40 offen offset:1024 sc1 lds
buffer_load_dwordx4 v2, s[8:11], s40 offen offset:2048 sc1 lds
buffer_load_dwordx4 v2, s[8:11], s40 offen offset:3072 sc1 lds
s_add_u32 m0, s33, 28672
s_add_u32 s40, s32, 28672
buffer_load_dwordx4 v2, s[8:11], s40 offen offset:0 sc1 lds
buffer_load_dwordx4 v2, s[8:11], s40 offen offset:1024 sc1 lds
buffer_load_dwordx4 v2, s[8:11], s40 offen offset:2048 sc1 lds
buffer_load_dwordx4 v2, s[8:11], s40 offen offset:3072 sc1 lds
s_add_u32 m0, s33, 32768
s_add_u32 s40, s32, 32768
buffer_load_dwordx4 v2, s[8:11], s40 offen offset:0 sc1 lds
buffer_load_dwordx4 v2, s[8:11], s40 offen offset:1024 sc1 lds
buffer_load_dwordx4 v2, s[8:11], s40 offen offset:2048 sc1 lds
buffer_load_dwordx4 v2, s[8:11], s40 offen offset:3072 sc1 lds
s_add_u32 m0, s33, 36864
s_add_u32 s40, s32, 36864
buffer_load_dwordx4 v2, s[8:11], s40 offen offset:0 sc1 lds
buffer_load_dwordx4 v2, s[8:11], s40 offen offset:1024 sc1 lds
buffer_load_dwordx4 v2, s[8:11], s40 offen offset:2048 sc1 lds
buffer_load_dwordx4 v2, s[8:11], s40 offen offset:3072 sc1 lds
s_add_u32 m0, s33, 40960
s_add_u32 s40, s32, 40960
buffer_load_dwordx4 v2, s[8:11], s40 offen offset:0 sc1 lds
buffer_load_dwordx4 v2, s[8:11], s40 offen offset:1024 sc1 lds
buffer_load_dwordx4 v2, s[8:11], s40 offen offset:2048 sc1 lds
buffer_load_dwordx4 v2, s[8:11], s40 offen offset:3072 sc1 lds
s_add_u32 m0, s33, 45056
s_add_u32 s40, s32, 45056
buffer_load_dwordx4 v2, s[8:11], s40 offen offset:0 sc1 lds
buffer_load_dwordx4 v2, s[8:11], s40 offen offset:1024 sc1 lds
buffer_load_dwordx4 v2, s[8:11], s40 offen offset:2048 sc1 lds
buffer_load_dwordx4 v2, s[8:11], s40 offen offset:3072 sc1 lds
s_add_u32 m0, s33, 49152
s_add_u32 s40, s32, 49152
buffer_load_dwordx4 v2, s[8:11], s40 offen offset:0 sc1 lds
buffer_load_dwordx4 v2, s[8:11], s40 offen offset:1024 sc1 lds
buffer_load_dwordx4 v2, s[8:11], s40 offen offset:2048 sc1 lds
buffer_load_dwordx4 v2, s[8:11], s40 offen offset:3072 sc1 lds
s_add_u32 m0, s33, 53248
s_add_u32 s40, s32, 53248
buffer_load_dwordx4 v2, s[8:11], s40 offen offset:0 sc1 lds
buffer_load_dwordx4 v2, s[8:11], s40 offen offset:1024 sc1 lds
buffer_load_dwordx4 v2, s[8:11], s40 offen offset:2048 sc1 lds
buffer_load_dwordx4 v2, s[8:11], s40 offen offset:3072 sc1 lds
s_add_u32 m0, s33, 57344
s_add_u32 s40, s32, 57344
buffer_load_dwordx4 v2, s[8:11], s40 offen offset:0 sc1 lds
buffer_load_dwordx4 v2, s[8:11], s40 offen offset:1024 sc1 lds
buffer_load_dwordx4 v2, s[8:11], s40 offen offset:2048 sc1 lds
buffer_load_dwordx4 v2, s[8:11], s40 offen offset:3072 sc1 lds
s_add_u32 m0, s33, 61440
s_add_u32 s40, s32, 61440
buffer_load_dwordx4 v2, s[8:11], s40 offen offset:0 sc1 lds
buffer_load_dwordx4 v2, s[8:11], s40 offen offset:1024 sc1 lds
buffer_load_dwordx4 v2, s[8:11], s40 offen offset:2048 sc1 lds
buffer_load_dwordx4 v2, s[8:11], s40 offen offset:3072 sc1 lds
s_add_u32 m0, s33, 65536
s_add_u32 s40, s32, 65536
buffer_load_dwordx4 v2, s[8:11], s40 offen offset:0 sc1 lds
buffer_load_dwordx4 v2, s[8:11], s40 offen offset:1024 sc1 lds
buffer_load_dwordx4 v2, s[8:11], s40 offen offset:2048 sc1 lds
buffer_load_dwordx4 v2, s[8:11], s40 offen offset:3072 sc1 lds
s_add_u32 m0, s33, 69632
s_add_u32 s40, s32, 69632
buffer_load_dwordx4 v2, s[8:11], s40 offen offset:0 sc1 lds
buffer_load_dwordx4 v2, s[8:11], s40 offen offset:1024 sc1 lds
buffer_load_dwordx4 v2, s[8:11], s40 offen offset:2048 sc1 lds
buffer_load_dwordx4 v2, s[8:11], s40 offen offset:3072 sc1 lds
s_barrier
L_r_done:
s_mov_b32 s70, 25620480
s_mov_b32 s71, 30339072
s_mov_b32 s72, 35057664
s_mov_b32 s73, 39776256
s_mov_b32 s74, 42266624
s_mov_b32 s75, 61272064
s_mov_b32 s76, 99020800
s_mov_b32 s77, 1048576
s_mov_b32 s7, 1
s_lshr_b32 s20, s5, 2
s_lshl_b32 s20, s20, 3
s_lshr_b32 s21, s6, 2
s_add_u32 s20, s20, s21
s_and_b32 s21, s5, 3
s_lshl_b32 s21, s21, 2
s_and_b32 s22, s6, 3
s_add_u32 s21, s21, s22
s_lshl_b32 s24, s20, 3
s_sub_u32 s25, s24, 1
s_max_i32 s35, s25, 0
s_mul_i32 s25, s35, 18432
s_lshl_b32 s26, s4, 1
s_add_u32 s36, s24, s26
s_mul_i32 s24, s36, 18432
s_add_u32 s26, s24, s70
s_add_u32 s27, s26, 18432
s_add_u32 s28, s25, s70
v_add_u32 v4, 0x10000, v2
v_add_u32 v5, 0x20000, v2
s_cmp_eq_u32 s4, 3
s_cselect_b32 s29, 0, s4
s_cselect_b32 s31, 16, 9
s_lshl_b32 s30, s29, 10
v_and_b32 v12, 15, v1
v_mov_b32 v13, 2146435072
v_cmp_le_u32 vcc, s31, v12
s_nop 1
v_cndmask_b32 v3, v13, v2, vcc
s_add_u32 s31, s30, 2048
v_add_u32 v6, s31, v2
v_add_u32 v7, s31, v4
v_add_u32 v8, s31, v5
s_add_u32 s31, s30, 5120
v_add_u32 v9, s31, v2
v_add_u32 v10, s31, v4
v_add_u32 v11, s31, v5
s_lshl_b32 s22, s36, 1
s_lshl_b32 s23, s35, 1
s_add_u32 s23, s23, 1
v_and_b32 v16, 3, v1
v_add_u32 v16, s22, v16
v_mov_b32 v17, s23
v_cmp_eq_u32 vcc, 4, v1
s_nop 1
v_cndmask_b32 v16, v16, v17, vcc
v_lshlrev_b32 v16, 7, v16
s_add_u32 s22, s77, 786432
v_mov_b32 v13, 2146435072
v_cmp_eq_u32 vcc, 0, v0
v_mov_b32 v14, s68
v_mov_b32 v15, s69
v_cndmask_b32 v13, v13, 0, vcc
s_waitcnt vmcnt(0)
s_barrier
buffer_store_dwordx2 v[14:15], v13, s[8:11], s14 offen sc1
s_mov_b32 s52, 0
L_poll5:
buffer_load_dwordx2 v[14:15], v16, s[8:11], s22 offen sc1
s_add_u32 s52, s52, 1
s_waitcnt vmcnt(0)
v_cmp_ne_u64 vcc, s[68:69], v[14:15]
s_cmp_ge_u32 s52, 1048576
s_cbranch_scc1 L_got5
s_and_b64 exec, exec, vcc
s_cbranch_execnz L_poll5
L_got5:
s_mov_b64 exec, -1
buffer_load_dwordx4 a[0:3], v2, s[8:11], s26 offen offset:0 sc1
buffer_load_dwordx4 a[72:75], v2, s[8:11], s27 offen offset:0 sc1
buffer_load_dwordx4 a[144:147], v3, s[8:11], s28 offen offset:0 sc1
buffer_load_dwordx4 a[4:7], v2, s[8:11], s26 offen offset:1024 sc1
buffer_load_dwordx4 a[76:79], v2, s[8:11], s27 offen offset:1024 sc1
buffer_load_dwordx4 a[148:151], v3, s[8:11], s28 offen offset:1024 sc1
buffer_load_dwordx4 a[8:11], v2, s[8:11], s26 offen offset:2048 sc1
buffer_load_dwordx4 a[80:83], v2, s[8:11], s27 offen offset:2048 sc1
buffer_load_dwordx4 a[152:155], v3, s[8:11], s28 offen offset:2048 sc1
buffer_load_dwordx4 a[12:15], v2, s[8:11], s26 offen offset:3072 sc1
buffer_load_dwordx4 a[84:87], v2, s[8:11], s27 offen offset:3072 sc1
buffer_load_dwordx4 a[156:159], v3, s[8:11], s28 offen offset:3072 sc1
s_add_u32 s26, s26, 4096
s_add_u32 s27, s27, 4096
s_add_u32 s28, s28, 4096
buffer_load_dwordx4 a[16:19], v2, s[8:11], s26 offen offset:0 sc1
buffer_load_dwordx4 a[88:91], v2, s[8:11], s27 offen offset:0 sc1
buffer_load_dwordx4 a[160:163], v3, s[8:11], s28 offen offset:0 sc1
buffer_load_dwordx4 a[20:23], v2, s[8:11], s26 offen offset:1024 sc1
buffer_load_dwordx4 a[92:95], v2, s[8:11], s27 offen offset:1024 sc1
buffer_load_dwordx4 a[164:167], v3, s[8:11], s28 offen offset:1024 sc1
buffer_load_dwordx4 a[24:27], v2, s[8:11], s26 offen offset:2048 sc1
buffer_load_dwordx4 a[96:99], v2, s[8:11], s27 offen offset:2048 sc1
buffer_load_dwordx4 a[168:171], v3, s[8:11], s28 offen offset:2048 sc1
buffer_load_dwordx4 a[28:31], v2, s[8:11], s26 offen offset:3072 sc1
buffer_load_dwordx4 a[100:103], v2, s[8:11], s27 offen offset:3072 sc1
buffer_load_dwordx4 a[172:175], v3, s[8:11], s28 offen offset:3072 sc1
v_lshrrev_b32 v13, 4, v1
v_lshlrev_b32 v14, 2, v13
v_sub_u32 v14, v12, v14
v_subrev_u32 v15, 0, v14
v_cmp_gt_u32 s[52:53], 8, v15
v_cmp_gt_i32 s[44:45], -8, v15
v_subrev_u32 v15, 1, v14
v_cmp_gt_u32 s[54:55], 8, v15
v_cmp_gt_i32 s[46:47], -8, v15
v_subrev_u32 v15, 2, v14
v_cmp_gt_u32 s[56:57], 8, v15
v_cmp_gt_i32 s[48:49], -8, v15
v_subrev_u32 v15, 3, v14
v_cmp_gt_u32 s[58:59], 8, v15
v_cmp_gt_i32 s[50:51], -8, v15
s_and_b32 s31, s20, 7
s_or_b32 s31, s31, s4
s_cmp_eq_u32 s31, 0
s_cselect_b64 s[60:61], 0, s[44:45]
s_cselect_b64 s[62:63], 0, s[46:47]
s_cselect_b64 s[64:65], 0, s[48:49]
s_cselect_b64 s[66:67], 0, s[50:51]
ds_read_b128 a[216:219], v2 offset:0
ds_read_b128 a[220:223], v2 offset:8192
ds_read_b128 a[224:227], v2 offset:1024
ds_read_b128 a[228:231], v2 offset:9216
ds_read_b128 a[232:235], v2 offset:2048
ds_read_b128 a[236:239], v2 offset:10240
s_waitcnt vmcnt(18)
s_waitcnt lgkmcnt(4)
v_mfma_f32_16x16x32_bf16 v[32:35], a[216:219], a[0:3], 0
s_add_u32 s26, s26, 4096
s_add_u32 s27, s27, 4096
s_add_u32 s28, s28, 4096
buffer_load_dwordx4 a[32:35], v2, s[8:11], s26 offen offset:0 sc1
v_mfma_f32_16x16x32_bf16 v[32:35], a[220:223], a[4:7], v[32:35]
ds_read_b128 a[240:243], v2 offset:3072
v_mfma_f32_16x16x32_bf16 v[36:39], a[216:219], a[72:75], 0
v_mfma_f32_16x16x32_bf16 v[36:39], a[220:223], a[76:79], v[36:39]
ds_read_b128 a[244:247], v2 offset:11264
s_waitcnt lgkmcnt(4)
v_mfma_f32_16x16x32_bf16 v[40:43], a[224:227], a[0:3], 0
buffer_load_dwordx4 a[104:107], v2, s[8:11], s27 offen offset:0 sc1
v_mfma_f32_16x16x32_bf16 v[40:43], a[228:231], a[4:7], v[40:43]
ds_read_b128 a[216:219], v2 offset:4096
v_mfma_f32_16x16x32_bf16 v[44:47], a[224:227], a[72:75], 0
v_mfma_f32_16x16x32_bf16 v[44:47], a[228:231], a[76:79], v[44:47]
ds_read_b128 a[220:223], v2 offset:12288
s_waitcnt lgkmcnt(4)
v_mfma_f32_16x16x32_bf16 v[48:51], a[232:235], a[0:3], 0
buffer_load_dwordx4 a[176:179], v3, s[8:11], s28 offen offset:0 sc1
v_mfma_f32_16x16x32_bf16 v[48:51], a[236:239], a[4:7], v[48:51]
ds_read_b128 a[224:227], v2 offset:5120
v_mfma_f32_16x16x32_bf16 v[52:55], a[232:235], a[72:75], 0
v_mfma_f32_16x16x32_bf16 v[52:55], a[236:239], a[76:79], v[52:55]
ds_read_b128 a[228:231], v2 offset:13312
s_waitcnt lgkmcnt(4)
v_mfma_f32_16x16x32_bf16 v[56:59], a[240:243], a[0:3], 0
buffer_load_dwordx4 a[36:39], v2, s[8:11], s26 offen offset:1024 sc1
v_mfma_f32_16x16x32_bf16 v[56:59], a[244:247], a[4:7], v[56:59]
ds_read_b128 a[232:235], v2 offset:6144
v_mfma_f32_16x16x32_bf16 v[60:63], a[240:243], a[72:75], 0
v_mfma_f32_16x16x32_bf16 v[60:63], a[244:247], a[76:79], v[60:63]
ds_read_b128 a[236:239], v2 offset:14336
s_waitcnt lgkmcnt(4)
v_mfma_f32_16x16x32_bf16 v[64:67], a[216:219], a[0:3], 0
buffer_load_dwordx4 a[108:111], v2, s[8:11], s27 offen offset:1024 sc1
v_mfma_f32_16x16x32_bf16 v[64:67], a[220:223], a[4:7], v[64:67]
ds_read_b128 a[240:243], v2 offset:7168
v_mfma_f32_16x16x32_bf16 v[68:71], a[216:219], a[72:75], 0
v_mfma_f32_16x16x32_bf16 v[68:71], a[220:223], a[76:79], v[68:71]
ds_read_b128 a[244:247], v2 offset:15360
s_waitcnt lgkmcnt(4)
v_mfma_f32_16x16x32_bf16 v[72:75], a[0:3], a[224:227], 0
buffer_load_dwordx4 a[180:183], v3, s[8:11], s28 offen offset:1024 sc1
v_mfma_f32_16x16x32_bf16 v[72:75], a[4:7], a[228:231], v[72:75]
ds_read_b128 a[216:219], v6 offset:0
v_mfma_f32_16x16x32_bf16 v[76:79], a[72:75], a[224:227], 0
v_mfma_f32_16x16x32_bf16 v[76:79], a[76:79], a[228:231], v[76:79]
ds_read_b128 a[220:223], v6 offset:8192
s_waitcnt lgkmcnt(4)
v_mfma_f32_16x16x32_bf16 v[80:83], a[0:3], a[232:235], 0
buffer_load_dwordx4 a[40:43], v2, s[8:11], s26 offen offset:2048 sc1
v_mfma_f32_16x16x32_bf16 v[80:83], a[4:7], a[236:239], v[80:83]
ds_read_b128 a[224:227], v9 offset:0
v_mfma_f32_16x16x32_bf16 v[84:87], a[72:75], a[232:235], 0
v_mfma_f32_16x16x32_bf16 v[84:87], a[76:79], a[236:239], v[84:87]
ds_read_b128 a[228:231], v9 offset:8192
s_waitcnt lgkmcnt(4)
v_mfma_f32_16x16x32_bf16 v[88:91], a[0:3], a[240:243], 0
buffer_load_dwordx4 a[112:115], v2, s[8:11], s27 offen offset:2048 sc1
v_mfma_f32_16x16x32_bf16 v[88:91], a[4:7], a[244:247], v[88:91]
ds_read_b128 a[232:235], v2 offset:16384
v_mfma_f32_16x16x32_bf16 v[92:95], a[72:75], a[240:243], 0
v_mfma_f32_16x16x32_bf16 v[92:95], a[76:79], a[244:247], v[92:95]
ds_read_b128 a[236:239], v2 offset:24576
s_waitcnt lgkmcnt(4)
v_mfma_f32_16x16x32_bf16 v[96:99], a[216:219], a[144:147], 0
ds_read_b128 a[240:243], v2 offset:17408
buffer_load_dwordx4 a[184:187], v3, s[8:11], s28 offen offset:2048 sc1
v_mfma_f32_16x16x32_bf16 v[96:99], a[220:223], a[148:151], v[96:99]
ds_read_b128 a[244:247], v2 offset:25600
s_waitcnt lgkmcnt(4)
v_mfma_f32_16x16x32_bf16 v[100:103], a[144:147], a[224:227], 0
ds_read_b128 a[216:219], v2 offset:18432
v_mfma_f32_16x16x32_bf16 v[100:103], a[148:151], a[228:231], v[100:103]
ds_read_b128 a[220:223], v2 offset:26624
s_waitcnt vmcnt(21)
s_waitcnt lgkmcnt(4)
v_mfma_f32_16x16x32_bf16 v[32:35], a[232:235], a[8:11], v[32:35]
buffer_load_dwordx4 a[44:47], v2, s[8:11], s26 offen offset:3072 sc1
v_mfma_f32_16x16x32_bf16 v[32:35], a[236:239], a[12:15], v[32:35]
ds_read_b128 a[224:227], v2 offset:19456
v_mfma_f32_16x16x32_bf16 v[36:39], a[232:235], a[80:83], v[36:39]
v_mfma_f32_16x16x32_bf16 v[36:39], a[236:239], a[84:87], v[36:39]
ds_read_b128 a[228:231], v2 offset:27648
s_waitcnt lgkmcnt(4)
v_mfma_f32_16x16x32_bf16 v[40:43], a[240:243], a[8:11], v[40:43]
buffer_load_dwordx4 a[116:119], v2, s[8:11], s27 offen offset:3072 sc1
v_mfma_f32_16x16x32_bf16 v[40:43], a[244:247], a[12:15], v[40:43]
ds_read_b128 a[232:235], v2 offset:20480
v_mfma_f32_16x16x32_bf16 v[44:47], a[240:243], a[80:83], v[44:47]
v_mfma_f32_16x16x32_bf16 v[44:47], a[244:247], a[84:87], v[44:47]
ds_read_b128 a[236:239], v2 offset:28672
s_waitcnt lgkmcnt(4)
v_mfma_f32_16x16x32_bf16 v[48:51], a[216:219], a[8:11], v[48:51]
buffer_load_dwordx4 a[188:191], v3, s[8:11], s28 offen offset:3072 sc1
v_mfma_f32_16x16x32_bf16 v[48:51], a[220:223], a[12:15], v[48:51]
ds_read_b128 a[240:243], v2 offset:21504
v_mfma_f32_16x16x32_bf16 v[52:55], a[216:219], a[80:83], v[52:55]
v_mfma_f32_16x16x32_bf16 v[52:55], a[220:223], a[84:87], v[52:55]
ds_read_b128 a[244:247], v2 offset:29696
s_waitcnt lgkmcnt(4)
v_mfma_f32_16x16x32_bf16 v[56:59], a[224:227], a[8:11], v[56:59]
s_add_u32 s26, s26, 4096
s_add_u32 s27, s27, 4096
s_add_u32 s28, s28, 4096
buffer_load_dwordx4 a[48:51], v2, s[8:11], s26 offen offset:0 sc1
v_mfma_f32_16x16x32_bf16 v[56:59], a[228:231], a[12:15], v[56:59]
ds_read_b128 a[216:219], v2 offset:22528
v_mfma_f32_16x16x32_bf16 v[60:63], a[224:227], a[80:83], v[60:63]
v_mfma_f32_16x16x32_bf16 v[60:63], a[228:231], a[84:87], v[60:63]
ds_read_b128 a[220:223], v2 offset:30720
s_waitcnt lgkmcnt(4)
v_mfma_f32_16x16x32_bf16 v[64:67], a[232:235], a[8:11], v[64:67]
buffer_load_dwordx4 a[120:123], v2, s[8:11], s27 offen offset:0 sc1
v_mfma_f32_16x16x32_bf16 v[64:67], a[236:239], a[12:15], v[64:67]
ds_read_b128 a[224:227], v2 offset:23552
v_mfma_f32_16x16x32_bf16 v[68:71], a[232:235], a[80:83], v[68:71]
v_mfma_f32_16x16x32_bf16 v[68:71], a[236:239], a[84:87], v[68:71]
ds_read_b128 a[228:231], v2 offset:31744
s_waitcnt lgkmcnt(4)
v_mfma_f32_16x16x32_bf16 v[72:75], a[8:11], a[240:243], v[72:75]
buffer_load_dwordx4 a[192:195], v3, s[8:11], s28 offen offset:0 sc1
v_mfma_f32_16x16x32_bf16 v[72:75], a[12:15], a[244:247], v[72:75]
ds_read_b128 a[232:235], v6 offset:16384
v_mfma_f32_16x16x32_bf16 v[76:79], a[80:83], a[240:243], v[76:79]
v_mfma_f32_16x16x32_bf16 v[76:79], a[84:87], a[244:247], v[76:79]
ds_read_b128 a[236:239], v6 offset:24576
s_waitcnt lgkmcnt(4)
v_mfma_f32_16x16x32_bf16 v[80:83], a[8:11], a[216:219], v[80:83]
buffer_load_dwordx4 a[52:55], v2, s[8:11], s26 offen offset:1024 sc1
v_mfma_f32_16x16x32_bf16 v[80:83], a[12:15], a[220:223], v[80:83]
ds_read_b128 a[240:243], v9 offset:16384
v_mfma_f32_16x16x32_bf16 v[84:87], a[80:83], a[216:219], v[84:87]
v_mfma_f32_16x16x32_bf16 v[84:87], a[84:87], a[220:223], v[84:87]
ds_read_b128 a[244:247], v9 offset:24576
s_waitcnt lgkmcnt(4)
v_mfma_f32_16x16x32_bf16 v[88:91], a[8:11], a[224:227], v[88:91]
buffer_load_dwordx4 a[124:127], v2, s[8:11], s27 offen offset:1024 sc1
v_mfma_f32_16x16x32_bf16 v[88:91], a[12:15], a[228:231], v[88:91]
ds_read_b128 a[216:219], v2 offset:32768
v_mfma_f32_16x16x32_bf16 v[92:95], a[80:83], a[224:227], v[92:95]
v_mfma_f32_16x16x32_bf16 v[92:95], a[84:87], a[228:231], v[92:95]
ds_read_b128 a[220:223], v2 offset:40960
s_waitcnt lgkmcnt(4)
v_mfma_f32_16x16x32_bf16 v[96:99], a[232:235], a[152:155], v[96:99]
ds_read_b128 a[224:227], v2 offset:33792
buffer_load_dwordx4 a[196:199], v3, s[8:11], s28 offen offset:1024 sc1
v_mfma_f32_16x16x32_bf16 v[96:99], a[236:239], a[156:159], v[96:99]
ds_read_b128 a[228:231], v2 offset:41984
s_waitcnt lgkmcnt(4)
v_mfma_f32_16x16x32_bf16 v[100:103], a[152:155], a[240:243], v[100:103]
ds_read_b128 a[232:235], v2 offset:34816
v_mfma_f32_16x16x32_bf16 v[100:103], a[156:159], a[244:247], v[100:103]
ds_read_b128 a[236:239], v2 offset:43008
s_waitcnt vmcnt(24)
s_waitcnt lgkmcnt(4)
v_mfma_f32_16x16x32_bf16 v[32:35], a[216:219], a[16:19], v[32:35]
buffer_load_dwordx4 a[56:59], v2, s[8:11], s26 offen offset:2048 sc1
v_mfma_f32_16x16x32_bf16 v[32:35], a[220:223], a[20:23], v[32:35]
ds_read_b128 a[240:243], v2 offset:35840
v_mfma_f32_16x16x32_bf16 v[36:39], a[216:219], a[88:91], v[36:39]
v_mfma_f32_16x16x32_bf16 v[36:39], a[220:223], a[92:95], v[36:39]
ds_read_b128 a[244:247], v2 offset:44032
s_waitcnt lgkmcnt(4)
v_mfma_f32_16x16x32_bf16 v[40:43], a[224:227], a[16:19], v[40:43]
buffer_load_dwordx4 a[128:131], v2, s[8:11], s27 offen offset:2048 sc1
v_mfma_f32_16x16x32_bf16 v[40:43], a[228:231], a[20:23], v[40:43]
ds_read_b128 a[216:219], v2 offset:36864
v_mfma_f32_16x16x32_bf16 v[44:47], a[224:227], a[88:91], v[44:47]
v_mfma_f32_16x16x32_bf16 v[44:47], a[228:231], a[92:95], v[44:47]
ds_read_b128 a[220:223], v2 offset:45056
s_waitcnt lgkmcnt(4)
v_mfma_f32_16x16x32_bf16 v[48:51], a[232:235], a[16:19], v[48:51]
buffer_load_dwordx4 a[200:203], v3, s[8:11], s28 offen offset:2048 sc1
v_mfma_f32_16x16x32_bf16 v[48:51], a[236:239], a[20:23], v[48:51]
ds_read_b128 a[224:227], v2 offset:37888
v_mfma_f32_16x16x32_bf16 v[52:55], a[232:235], a[88:91], v[52:55]
v_mfma_f32_16x16x32_bf16 v[52:55], a[236:239], a[92:95], v[52:55]
ds_read_b128 a[228:231], v2 offset:46080
s_waitcnt lgkmcnt(4)
v_mfma_f32_16x16x32_bf16 v[56:59], a[240:243], a[16:19], v[56:59]
buffer_load_dwordx4 a[60:63], v2, s[8:11], s26 offen offset:3072 sc1
v_mfma_f32_16x16x32_bf16 v[56:59], a[244:247], a[20:23], v[56:59]
ds_read_b128 a[232:235], v2 offset:38912
v_mfma_f32_16x16x32_bf16 v[60:63], a[240:243], a[88:91], v[60:63]
v_mfma_f32_16x16x32_bf16 v[60:63], a[244:247], a[92:95], v[60:63]
ds_read_b128 a[236:239], v2 offset:47104
s_waitcnt lgkmcnt(4)
v_mfma_f32_16x16x32_bf16 v[64:67], a[216:219], a[16:19], v[64:67]
buffer_load_dwordx4 a[132:135], v2, s[8:11], s27 offen offset:3072 sc1
v_mfma_f32_16x16x32_bf16 v[64:67], a[220:223], a[20:23], v[64:67]
ds_read_b128 a[240:243], v2 offset:39936
v_mfma_f32_16x16x32_bf16 v[68:71], a[216:219], a[88:91], v[68:71]
v_mfma_f32_16x16x32_bf16 v[68:71], a[220:223], a[92:95], v[68:71]
ds_read_b128 a[244:247], v2 offset:48128
s_waitcnt lgkmcnt(4)
v_mfma_f32_16x16x32_bf16 v[72:75], a[16:19], a[224:227], v[72:75]
buffer_load_dwordx4 a[204:207], v3, s[8:11], s28 offen offset:3072 sc1
v_mfma_f32_16x16x32_bf16 v[72:75], a[20:23], a[228:231], v[72:75]
ds_read_b128 a[216:219], v6 offset:32768
v_mfma_f32_16x16x32_bf16 v[76:79], a[88:91], a[224:227], v[76:79]
v_mfma_f32_16x16x32_bf16 v[76:79], a[92:95], a[228:231], v[76:79]
ds_read_b128 a[220:223], v6 offset:40960
s_waitcnt lgkmcnt(4)
v_mfma_f32_16x16x32_bf16 v[80:83], a[16:19], a[232:235], v[80:83]
s_add_u32 s26, s26, 4096
s_add_u32 s27, s27, 4096
s_add_u32 s28, s28, 4096
buffer_load_dwordx4 a[64:67], v2, s[8:11], s26 offen offset:0 sc1
v_mfma_f32_16x16x32_bf16 v[80:83], a[20:23], a[236:239], v[80:83]
ds_read_b128 a[224:227], v9 offset:32768
v_mfma_f32_16x16x32_bf16 v[84:87], a[88:91], a[232:235], v[84:87]
v_mfma_f32_16x16x32_bf16 v[84:87], a[92:95], a[236:239], v[84:87]
ds_read_b128 a[228:231], v9 offset:40960
s_waitcnt lgkmcnt(4)
v_mfma_f32_16x16x32_bf16 v[88:91], a[16:19], a[240:243], v[88:91]
buffer_load_dwordx4 a[136:139], v2, s[8:11], s27 offen offset:0 sc1
v_mfma_f32_16x16x32_bf16 v[88:91], a[20:23], a[244:247], v[88:91]
ds_read_b128 a[232:235], v2 offset:49152
v_mfma_f32_16x16x32_bf16 v[92:95], a[88:91], a[240:243], v[92:95]
v_mfma_f32_16x16x32_bf16 v[92:95], a[92:95], a[244:247], v[92:95]
ds_read_b128 a[236:239], v2 offset:57344
s_waitcnt lgkmcnt(4)
v_mfma_f32_16x16x32_bf16 v[96:99], a[216:219], a[160:163], v[96:99]
ds_read_b128 a[240:243], v2 offset:50176
buffer_load_dwordx4 a[208:211], v3, s[8:11], s28 offen offset:0 sc1
v_mfma_f32_16x16x32_bf16 v[96:99], a[220:223], a[164:167], v[96:99]
ds_read_b128 a[244:247], v2 offset:58368
s_waitcnt lgkmcnt(4)
v_mfma_f32_16x16x32_bf16 v[100:103], a[160:163], a[224:227], v[100:103]
ds_read_b128 a[216:219], v2 offset:51200
v_mfma_f32_16x16x32_bf16 v[100:103], a[164:167], a[228:231], v[100:103]
ds_read_b128 a[220:223], v2 offset:59392
s_waitcnt vmcnt(27)
s_waitcnt lgkmcnt(4)
v_mfma_f32_16x16x32_bf16 v[32:35], a[232:235], a[24:27], v[32:35]
buffer_load_dwordx4 a[68:71], v2, s[8:11], s26 offen offset:1024 sc1
v_mfma_f32_16x16x32_bf16 v[32:35], a[236:239], a[28:31], v[32:35]
ds_read_b128 a[224:227], v2 offset:52224
v_mfma_f32_16x16x32_bf16 v[36:39], a[232:235], a[96:99], v[36:39]
v_mfma_f32_16x16x32_bf16 v[36:39], a[236:239], a[100:103], v[36:39]
ds_read_b128 a[228:231], v2 offset:60416
s_waitcnt lgkmcnt(4)
v_mfma_f32_16x16x32_bf16 v[40:43], a[240:243], a[24:27], v[40:43]
buffer_load_dwordx4 a[140:143], v2, s[8:11], s27 offen offset:1024 sc1
v_mfma_f32_16x16x32_bf16 v[40:43], a[244:247], a[28:31], v[40:43]
ds_read_b128 a[232:235], v2 offset:53248
v_mfma_f32_16x16x32_bf16 v[44:47], a[240:243], a[96:99], v[44:47]
v_mfma_f32_16x16x32_bf16 v[44:47], a[244:247], a[100:103], v[44:47]
ds_read_b128 a[236:239], v2 offset:61440
s_waitcnt lgkmcnt(4)
v_mfma_f32_16x16x32_bf16 v[48:51], a[216:219], a[24:27], v[48:51]
buffer_load_dwordx4 a[212:215], v3, s[8:11], s28 offen offset:1024 sc1
v_mfma_f32_16x16x32_bf16 v[48:51], a[220:223], a[28:31], v[48:51]
ds_read_b128 a[240:243], v2 offset:54272
v_mfma_f32_16x16x32_bf16 v[52:55], a[216:219], a[96:99], v[52:55]
v_mfma_f32_16x16x32_bf16 v[52:55], a[220:223], a[100:103], v[52:55]
ds_read_b128 a[244:247], v2 offset:62464
s_waitcnt lgkmcnt(4)
v_mfma_f32_16x16x32_bf16 v[56:59], a[224:227], a[24:27], v[56:59]
v_mfma_f32_16x16x32_bf16 v[56:59], a[228:231], a[28:31], v[56:59]
ds_read_b128 a[216:219], v2 offset:55296
v_mfma_f32_16x16x32_bf16 v[60:63], a[224:227], a[96:99], v[60:63]
v_mfma_f32_16x16x32_bf16 v[60:63], a[228:231], a[100:103], v[60:63]
ds_read_b128 a[220:223], v2 offset:63488
s_waitcnt lgkmcnt(4)
v_mfma_f32_16x16x32_bf16 v[64:67], a[232:235], a[24:27], v[64:67]
v_mfma_f32_16x16x32_bf16 v[64:67], a[236:239], a[28:31], v[64:67]
ds_read_b128 a[224:227], v2 offset:56320
v_mfma_f32_16x16x32_bf16 v[68:71], a[232:235], a[96:99], v[68:71]
v_mfma_f32_16x16x32_bf16 v[68:71], a[236:239], a[100:103], v[68:71]
ds_read_b128 a[228:231], v2 offset:64512
s_waitcnt lgkmcnt(4)
v_mfma_f32_16x16x32_bf16 v[72:75], a[24:27], a[240:243], v[72:75]
v_mfma_f32_16x16x32_bf16 v[72:75], a[28:31], a[244:247], v[72:75]
ds_read_b128 a[232:235], v6 offset:49152
v_mfma_f32_16x16x32_bf16 v[76:79], a[96:99], a[240:243], v[76:79]
v_mfma_f32_16x16x32_bf16 v[76:79], a[100:103], a[244:247], v[76:79]
ds_read_b128 a[236:239], v6 offset:57344
s_waitcnt lgkmcnt(4)
v_mfma_f32_16x16x32_bf16 v[80:83], a[24:27], a[216:219], v[80:83]
v_mfma_f32_16x16x32_bf16 v[80:83], a[28:31], a[220:223], v[80:83]
ds_read_b128 a[240:243], v9 offset:49152
v_mfma_f32_16x16x32_bf16 v[84:87], a[96:99], a[216:219], v[84:87]
v_mfma_f32_16x16x32_bf16 v[84:87], a[100:103], a[220:223], v[84:87]
ds_read_b128 a[244:247], v9 offset:57344
s_waitcnt lgkmcnt(4)
v_mfma_f32_16x16x32_bf16 v[88:91], a[24:27], a[224:227], v[88:91]
v_mfma_f32_16x16x32_bf16 v[88:91], a[28:31], a[228:231], v[88:91]
ds_read_b128 a[216:219], v4 offset:0
v_mfma_f32_16x16x32_bf16 v[92:95], a[96:99], a[224:227], v[92:95]
v_mfma_f32_16x16x32_bf16 v[92:95], a[100:103], a[228:231], v[92:95]
ds_read_b128 a[220:223], v4 offset:8192
s_waitcnt lgkmcnt(4)
v_mfma_f32_16x16x32_bf16 v[96:99], a[232:235], a[168:171], v[96:99]
ds_read_b128 a[224:227], v4 offset:1024
v_mfma_f32_16x16x32_bf16 v[96:99], a[236:239], a[172:175], v[96:99]
ds_read_b128 a[228:231], v4 offset:9216
s_waitcnt lgkmcnt(4)
v_mfma_f32_16x16x32_bf16 v[100:103], a[168:171], a[240:243], v[100:103]
ds_read_b128 a[232:235], v4 offset:2048
v_mfma_f32_16x16x32_bf16 v[100:103], a[172:175], a[244:247], v[100:103]
ds_read_b128 a[236:239], v4 offset:10240
s_waitcnt vmcnt(24)
s_waitcnt lgkmcnt(4)
v_mfma_f32_16x16x32_bf16 v[32:35], a[216:219], a[32:35], v[32:35]
v_mfma_f32_16x16x32_bf16 v[32:35], a[220:223], a[36:39], v[32:35]
ds_read_b128 a[240:243], v4 offset:3072
v_mfma_f32_16x16x32_bf16 v[36:39], a[216:219], a[104:107], v[36:39]
v_mfma_f32_16x16x32_bf16 v[36:39], a[220:223], a[108:111], v[36:39]
ds_read_b128 a[244:247], v4 offset:11264
s_waitcnt lgkmcnt(4)
v_mfma_f32_16x16x32_bf16 v[40:43], a[224:227], a[32:35], v[40:43]
v_mfma_f32_16x16x32_bf16 v[40:43], a[228:231], a[36:39], v[40:43]
ds_read_b128 a[216:219], v4 offset:4096
v_mfma_f32_16x16x32_bf16 v[44:47], a[224:227], a[104:107], v[44:47]
v_mfma_f32_16x16x32_bf16 v[44:47], a[228:231], a[108:111], v[44:47]
ds_read_b128 a[220:223], v4 offset:12288
s_waitcnt lgkmcnt(4)
v_mfma_f32_16x16x32_bf16 v[48:51], a[232:235], a[32:35], v[48:51]
v_mfma_f32_16x16x32_bf16 v[48:51], a[236:239], a[36:39], v[48:51]
ds_read_b128 a[224:227], v4 offset:5120
v_mfma_f32_16x16x32_bf16 v[52:55], a[232:235], a[104:107], v[52:55]
v_mfma_f32_16x16x32_bf16 v[52:55], a[236:239], a[108:111], v[52:55]
ds_read_b128 a[228:231], v4 offset:13312
s_waitcnt lgkmcnt(4)
v_mfma_f32_16x16x32_bf16 v[56:59], a[240:243], a[32:35], v[56:59]
v_mfma_f32_16x16x32_bf16 v[56:59], a[244:247], a[36:39], v[56:59]
ds_read_b128 a[232:235], v4 offset:6144
v_mfma_f32_16x16x32_bf16 v[60:63], a[240:243], a[104:107], v[60:63]
v_mfma_f32_16x16x32_bf16 v[60:63], a[244:247], a[108:111], v[60:63]
ds_read_b128 a[236:239], v4 offset:14336
s_waitcnt lgkmcnt(4)
v_mfma_f32_16x16x32_bf16 v[64:67], a[216:219], a[32:35], v[64:67]
v_mfma_f32_16x16x32_bf16 v[64:67], a[220:223], a[36:39], v[64:67]
ds_read_b128 a[240:243], v4 offset:7168
v_mfma_f32_16x16x32_bf16 v[68:71], a[216:219], a[104:107], v[68:71]
v_mfma_f32_16x16x32_bf16 v[68:71], a[220:223], a[108:111], v[68:71]
ds_read_b128 a[244:247], v4 offset:15360
s_waitcnt lgkmcnt(4)
v_mfma_f32_16x16x32_bf16 v[72:75], a[32:35], a[224:227], v[72:75]
v_mfma_f32_16x16x32_bf16 v[72:75], a[36:39], a[228:231], v[72:75]
ds_read_b128 a[216:219], v7 offset:0
v_mfma_f32_16x16x32_bf16 v[76:79], a[104:107], a[224:227], v[76:79]
v_mfma_f32_16x16x32_bf16 v[76:79], a[108:111], a[228:231], v[76:79]
ds_read_b128 a[220:223], v7 offset:8192
s_waitcnt lgkmcnt(4)
v_mfma_f32_16x16x32_bf16 v[80:83], a[32:35], a[232:235], v[80:83]
v_mfma_f32_16x16x32_bf16 v[80:83], a[36:39], a[236:239], v[80:83]
ds_read_b128 a[224:227], v10 offset:0
v_mfma_f32_16x16x32_bf16 v[84:87], a[104:107], a[232:235], v[84:87]
v_mfma_f32_16x16x32_bf16 v[84:87], a[108:111], a[236:239], v[84:87]
ds_read_b128 a[228:231], v10 offset:8192
s_waitcnt lgkmcnt(4)
v_mfma_f32_16x16x32_bf16 v[88:91], a[32:35], a[240:243], v[88:91]
v_mfma_f32_16x16x32_bf16 v[88:91], a[36:39], a[244:247], v[88:91]
ds_read_b128 a[232:235], v4 offset:16384
v_mfma_f32_16x16x32_bf16 v[92:95], a[104:107], a[240:243], v[92:95]
v_mfma_f32_16x16x32_bf16 v[92:95], a[108:111], a[244:247], v[92:95]
ds_read_b128 a[236:239], v4 offset:24576
s_waitcnt lgkmcnt(4)
v_mfma_f32_16x16x32_bf16 v[96:99], a[216:219], a[176:179], v[96:99]
ds_read_b128 a[240:243], v4 offset:17408
v_mfma_f32_16x16x32_bf16 v[96:99], a[220:223], a[180:183], v[96:99]
ds_read_b128 a[244:247], v4 offset:25600
s_waitcnt lgkmcnt(4)
v_mfma_f32_16x16x32_bf16 v[100:103], a[176:179], a[224:227], v[100:103]
ds_read_b128 a[216:219], v4 offset:18432
v_mfma_f32_16x16x32_bf16 v[100:103], a[180:183], a[228:231], v[100:103]
ds_read_b128 a[220:223], v4 offset:26624
s_waitcnt vmcnt(18)
s_waitcnt lgkmcnt(4)
v_mfma_f32_16x16x32_bf16 v[32:35], a[232:235], a[40:43], v[32:35]
v_mfma_f32_16x16x32_bf16 v[32:35], a[236:239], a[44:47], v[32:35]
ds_read_b128 a[224:227], v4 offset:19456
v_mfma_f32_16x16x32_bf16 v[36:39], a[232:235], a[112:115], v[36:39]
v_mfma_f32_16x16x32_bf16 v[36:39], a[236:239], a[116:119], v[36:39]
ds_read_b128 a[228:231], v4 offset:27648
s_waitcnt lgkmcnt(4)
v_mfma_f32_16x16x32_bf16 v[40:43], a[240:243], a[40:43], v[40:43]
v_mfma_f32_16x16x32_bf16 v[40:43], a[244:247], a[44:47], v[40:43]
ds_read_b128 a[232:235], v4 offset:20480
v_mfma_f32_16x16x32_bf16 v[44:47], a[240:243], a[112:115], v[44:47]
v_mfma_f32_16x16x32_bf16 v[44:47], a[244:247], a[116:119], v[44:47]
ds_read_b128 a[236:239], v4 offset:28672
s_waitcnt lgkmcnt(4)
v_mfma_f32_16x16x32_bf16 v[48:51], a[216:219], a[40:43], v[48:51]
v_mfma_f32_16x16x32_bf16 v[48:51], a[220:223], a[44:47], v[48:51]
ds_read_b128 a[240:243], v4 offset:21504
v_mfma_f32_16x16x32_bf16 v[52:55], a[216:219], a[112:115], v[52:55]
v_mfma_f32_16x16x32_bf16 v[52:55], a[220:223], a[116:119], v[52:55]
ds_read_b128 a[244:247], v4 offset:29696
s_waitcnt lgkmcnt(4)
v_mfma_f32_16x16x32_bf16 v[56:59], a[224:227], a[40:43], v[56:59]
v_mfma_f32_16x16x32_bf16 v[56:59], a[228:231], a[44:47], v[56:59]
ds_read_b128 a[216:219], v4 offset:22528
v_mfma_f32_16x16x32_bf16 v[60:63], a[224:227], a[112:115], v[60:63]
v_mfma_f32_16x16x32_bf16 v[60:63], a[228:231], a[116:119], v[60:63]
ds_read_b128 a[220:223], v4 offset:30720
s_waitcnt lgkmcnt(4)
v_mfma_f32_16x16x32_bf16 v[64:67], a[232:235], a[40:43], v[64:67]
v_mfma_f32_16x16x32_bf16 v[64:67], a[236:239], a[44:47], v[64:67]
ds_read_b128 a[224:227], v4 offset:23552
v_mfma_f32_16x16x32_bf16 v[68:71], a[232:235], a[112:115], v[68:71]
v_mfma_f32_16x16x32_bf16 v[68:71], a[236:239], a[116:119], v[68:71]
ds_read_b128 a[228:231], v4 offset:31744
s_waitcnt lgkmcnt(4)
v_mfma_f32_16x16x32_bf16 v[72:75], a[40:43], a[240:243], v[72:75]
v_mfma_f32_16x16x32_bf16 v[72:75], a[44:47], a[244:247], v[72:75]
ds_read_b128 a[232:235], v7 offset:16384
v_mfma_f32_16x16x32_bf16 v[76:79], a[112:115], a[240:243], v[76:79]
v_mfma_f32_16x16x32_bf16 v[76:79], a[116:119], a[244:247], v[76:79]
ds_read_b128 a[236:239], v7 offset:24576
s_waitcnt lgkmcnt(4)
v_mfma_f32_16x16x32_bf16 v[80:83], a[40:43], a[216:219], v[80:83]
v_mfma_f32_16x16x32_bf16 v[80:83], a[44:47], a[220:223], v[80:83]
ds_read_b128 a[240:243], v10 offset:16384
v_mfma_f32_16x16x32_bf16 v[84:87], a[112:115], a[216:219], v[84:87]
v_mfma_f32_16x16x32_bf16 v[84:87], a[116:119], a[220:223], v[84:87]
ds_read_b128 a[244:247], v10 offset:24576
s_waitcnt lgkmcnt(4)
v_mfma_f32_16x16x32_bf16 v[88:91], a[40:43], a[224:227], v[88:91]
v_mfma_f32_16x16x32_bf16 v[88:91], a[44:47], a[228:231], v[88:91]
ds_read_b128 a[216:219], v4 offset:32768
v_mfma_f32_16x16x32_bf16 v[92:95], a[112:115], a[224:227], v[92:95]
v_mfma_f32_16x16x32_bf16 v[92:95], a[116:119], a[228:231], v[92:95]
ds_read_b128 a[220:223], v4 offset:40960
s_waitcnt lgkmcnt(4)
v_mfma_f32_16x16x32_bf16 v[96:99], a[232:235], a[184:187], v[96:99]
ds_read_b128 a[224:227], v4 offset:33792
v_mfma_f32_16x16x32_bf16 v[96:99], a[236:239], a[188:191], v[96:99]
ds_read_b128 a[228:231], v4 offset:41984
s_waitcnt lgkmcnt(4)
v_mfma_f32_16x16x32_bf16 v[100:103], a[184:187], a[240:243], v[100:103]
ds_read_b128 a[232:235], v4 offset:34816
v_mfma_f32_16x16x32_bf16 v[100:103], a[188:191], a[244:247], v[100:103]
ds_read_b128 a[236:239], v4 offset:43008
s_waitcnt vmcnt(12)
s_waitcnt lgkmcnt(4)
v_mfma_f32_16x16x32_bf16 v[32:35], a[216:219], a[48:51], v[32:35]
v_mfma_f32_16x16x32_bf16 v[32:35], a[220:223], a[52:55], v[32:35]
ds_read_b128 a[240:243], v4 offset:35840
v_mfma_f32_16x16x32_bf16 v[36:39], a[216:219], a[120:123], v[36:39]
v_mfma_f32_16x16x32_bf16 v[36:39], a[220:223], a[124:127], v[36:39]
ds_read_b128 a[244:247], v4 offset:44032
s_waitcnt lgkmcnt(4)
v_mfma_f32_16x16x32_bf16 v[40:43], a[224:227], a[48:51], v[40:43]
v_mfma_f32_16x16x32_bf16 v[40:43], a[228:231], a[52:55], v[40:43]
ds_read_b128 a[216:219], v4 offset:36864
v_mfma_f32_16x16x32_bf16 v[44:47], a[224:227], a[120:123], v[44:47]
v_mfma_f32_16x16x32_bf16 v[44:47], a[228:231], a[124:127], v[44:47]
ds_read_b128 a[220:223], v4 offset:45056
s_waitcnt lgkmcnt(4)
v_mfma_f32_16x16x32_bf16 v[48:51], a[232:235], a[48:51], v[48:51]
v_mfma_f32_16x16x32_bf16 v[48:51], a[236:239], a[52:55], v[48:51]
ds_read_b128 a[224:227], v4 offset:37888
v_mfma_f32_16x16x32_bf16 v[52:55], a[232:235], a[120:123], v[52:55]
v_mfma_f32_16x16x32_bf16 v[52:55], a[236:239], a[124:127], v[52:55]
ds_read_b128 a[228:231], v4 offset:46080
s_waitcnt lgkmcnt(4)
v_mfma_f32_16x16x32_bf16 v[56:59], a[240:243], a[48:51], v[56:59]
v_mfma_f32_16x16x32_bf16 v[56:59], a[244:247], a[52:55], v[56:59]
ds_read_b128 a[232:235], v4 offset:38912
v_mfma_f32_16x16x32_bf16 v[60:63], a[240:243], a[120:123], v[60:63]
v_mfma_f32_16x16x32_bf16 v[60:63], a[244:247], a[124:127], v[60:63]
ds_read_b128 a[236:239], v4 offset:47104
s_waitcnt lgkmcnt(4)
v_mfma_f32_16x16x32_bf16 v[64:67], a[216:219], a[48:51], v[64:67]
v_mfma_f32_16x16x32_bf16 v[64:67], a[220:223], a[52:55], v[64:67]
ds_read_b128 a[240:243], v4 offset:39936
v_mfma_f32_16x16x32_bf16 v[68:71], a[216:219], a[120:123], v[68:71]
v_mfma_f32_16x16x32_bf16 v[68:71], a[220:223], a[124:127], v[68:71]
ds_read_b128 a[244:247], v4 offset:48128
s_waitcnt lgkmcnt(4)
v_mfma_f32_16x16x32_bf16 v[72:75], a[48:51], a[224:227], v[72:75]
v_mfma_f32_16x16x32_bf16 v[72:75], a[52:55], a[228:231], v[72:75]
ds_read_b128 a[216:219], v7 offset:32768
v_mfma_f32_16x16x32_bf16 v[76:79], a[120:123], a[224:227], v[76:79]
v_mfma_f32_16x16x32_bf16 v[76:79], a[124:127], a[228:231], v[76:79]
ds_read_b128 a[220:223], v7 offset:40960
s_waitcnt lgkmcnt(4)
v_mfma_f32_16x16x32_bf16 v[80:83], a[48:51], a[232:235], v[80:83]
v_mfma_f32_16x16x32_bf16 v[80:83], a[52:55], a[236:239], v[80:83]
ds_read_b128 a[224:227], v10 offset:32768
v_mfma_f32_16x16x32_bf16 v[84:87], a[120:123], a[232:235], v[84:87]
v_mfma_f32_16x16x32_bf16 v[84:87], a[124:127], a[236:239], v[84:87]
ds_read_b128 a[228:231], v10 offset:40960
s_waitcnt lgkmcnt(4)
v_mfma_f32_16x16x32_bf16 v[88:91], a[48:51], a[240:243], v[88:91]
v_mfma_f32_16x16x32_bf16 v[88:91], a[52:55], a[244:247], v[88:91]
ds_read_b128 a[232:235], v4 offset:49152
v_mfma_f32_16x16x32_bf16 v[92:95], a[120:123], a[240:243], v[92:95]
v_mfma_f32_16x16x32_bf16 v[92:95], a[124:127], a[244:247], v[92:95]
ds_read_b128 a[236:239], v4 offset:57344
s_waitcnt lgkmcnt(4)
v_mfma_f32_16x16x32_bf16 v[96:99], a[216:219], a[192:195], v[96:99]
ds_read_b128 a[240:243], v4 offset:50176
v_mfma_f32_16x16x32_bf16 v[96:99], a[220:223], a[196:199], v[96:99]
ds_read_b128 a[244:247], v4 offset:58368
s_waitcnt lgkmcnt(4)
v_mfma_f32_16x16x32_bf16 v[100:103], a[192:195], a[224:227], v[100:103]
ds_read_b128 a[216:219], v4 offset:51200
v_mfma_f32_16x16x32_bf16 v[100:103], a[196:199], a[228:231], v[100:103]
ds_read_b128 a[220:223], v4 offset:59392
s_waitcnt vmcnt(6)
s_waitcnt lgkmcnt(4)
v_mfma_f32_16x16x32_bf16 v[32:35], a[232:235], a[56:59], v[32:35]
v_mfma_f32_16x16x32_bf16 v[32:35], a[236:239], a[60:63], v[32:35]
ds_read_b128 a[224:227], v4 offset:52224
v_mfma_f32_16x16x32_bf16 v[36:39], a[232:235], a[128:131], v[36:39]
v_mfma_f32_16x16x32_bf16 v[36:39], a[236:239], a[132:135], v[36:39]
ds_read_b128 a[228:231], v4 offset:60416
s_waitcnt lgkmcnt(4)
v_mfma_f32_16x16x32_bf16 v[40:43], a[240:243], a[56:59], v[40:43]
v_mfma_f32_16x16x32_bf16 v[40:43], a[244:247], a[60:63], v[40:43]
ds_read_b128 a[232:235], v4 offset:53248
v_mfma_f32_16x16x32_bf16 v[44:47], a[240:243], a[128:131], v[44:47]
v_mfma_f32_16x16x32_bf16 v[44:47], a[244:247], a[132:135], v[44:47]
ds_read_b128 a[236:239], v4 offset:61440
s_waitcnt lgkmcnt(4)
v_mfma_f32_16x16x32_bf16 v[48:51], a[216:219], a[56:59], v[48:51]
v_mfma_f32_16x16x32_bf16 v[48:51], a[220:223], a[60:63], v[48:51]
ds_read_b128 a[240:243], v4 offset:54272
v_mfma_f32_16x16x32_bf16 v[52:55], a[216:219], a[128:131], v[52:55]
v_mfma_f32_16x16x32_bf16 v[52:55], a[220:223], a[132:135], v[52:55]
ds_read_b128 a[244:247], v4 offset:62464
s_waitcnt lgkmcnt(4)
v_mfma_f32_16x16x32_bf16 v[56:59], a[224:227], a[56:59], v[56:59]
v_mfma_f32_16x16x32_bf16 v[56:59], a[228:231], a[60:63], v[56:59]
ds_read_b128 a[216:219], v4 offset:55296
v_mfma_f32_16x16x32_bf16 v[60:63], a[224:227], a[128:131], v[60:63]
v_mfma_f32_16x16x32_bf16 v[60:63], a[228:231], a[132:135], v[60:63]
ds_read_b128 a[220:223], v4 offset:63488
s_waitcnt lgkmcnt(4)
v_mfma_f32_16x16x32_bf16 v[64:67], a[232:235], a[56:59], v[64:67]
v_mfma_f32_16x16x32_bf16 v[64:67], a[236:239], a[60:63], v[64:67]
ds_read_b128 a[224:227], v4 offset:56320
v_mfma_f32_16x16x32_bf16 v[68:71], a[232:235], a[128:131], v[68:71]
v_mfma_f32_16x16x32_bf16 v[68:71], a[236:239], a[132:135], v[68:71]
ds_read_b128 a[228:231], v4 offset:64512
s_waitcnt lgkmcnt(4)
v_mfma_f32_16x16x32_bf16 v[72:75], a[56:59], a[240:243], v[72:75]
v_mfma_f32_16x16x32_bf16 v[72:75], a[60:63], a[244:247], v[72:75]
ds_read_b128 a[232:235], v7 offset:49152
v_mfma_f32_16x16x32_bf16 v[76:79], a[128:131], a[240:243], v[76:79]
v_mfma_f32_16x16x32_bf16 v[76:79], a[132:135], a[244:247], v[76:79]
ds_read_b128 a[236:239], v7 offset:57344
s_waitcnt lgkmcnt(4)
v_mfma_f32_16x16x32_bf16 v[80:83], a[56:59], a[216:219], v[80:83]
v_mfma_f32_16x16x32_bf16 v[80:83], a[60:63], a[220:223], v[80:83]
ds_read_b128 a[240:243], v10 offset:49152
v_mfma_f32_16x16x32_bf16 v[84:87], a[128:131], a[216:219], v[84:87]
v_mfma_f32_16x16x32_bf16 v[84:87], a[132:135], a[220:223], v[84:87]
ds_read_b128 a[244:247], v10 offset:57344
s_waitcnt lgkmcnt(4)
v_mfma_f32_16x16x32_bf16 v[88:91], a[56:59], a[224:227], v[88:91]
v_mfma_f32_16x16x32_bf16 v[88:91], a[60:63], a[228:231], v[88:91]
ds_read_b128 a[216:219], v5 offset:0
v_mfma_f32_16x16x32_bf16 v[92:95], a[128:131], a[224:227], v[92:95]
v_mfma_f32_16x16x32_bf16 v[92:95], a[132:135], a[228:231], v[92:95]
ds_read_b128 a[220:223], v5 offset:8192
s_waitcnt lgkmcnt(4)
v_mfma_f32_16x16x32_bf16 v[96:99], a[232:235], a[200:203], v[96:99]
ds_read_b128 a[224:227], v5 offset:1024
v_mfma_f32_16x16x32_bf16 v[96:99], a[236:239], a[204:207], v[96:99]
ds_read_b128 a[228:231], v5 offset:9216
s_waitcnt lgkmcnt(4)
v_mfma_f32_16x16x32_bf16 v[100:103], a[200:203], a[240:243], v[100:103]
ds_read_b128 a[232:235], v5 offset:2048
v_mfma_f32_16x16x32_bf16 v[100:103], a[204:207], a[244:247], v[100:103]
ds_read_b128 a[236:239], v5 offset:10240
s_waitcnt vmcnt(0)
s_waitcnt lgkmcnt(4)
v_mfma_f32_16x16x32_bf16 v[32:35], a[216:219], a[64:67], v[32:35]
v_mfma_f32_16x16x32_bf16 v[32:35], a[220:223], a[68:71], v[32:35]
ds_read_b128 a[240:243], v5 offset:3072
v_mfma_f32_16x16x32_bf16 v[36:39], a[216:219], a[136:139], v[36:39]
v_mfma_f32_16x16x32_bf16 v[36:39], a[220:223], a[140:143], v[36:39]
ds_read_b128 a[244:247], v5 offset:11264
s_waitcnt lgkmcnt(4)
v_mfma_f32_16x16x32_bf16 v[40:43], a[224:227], a[64:67], v[40:43]
v_mfma_f32_16x16x32_bf16 v[40:43], a[228:231], a[68:71], v[40:43]
ds_read_b128 a[216:219], v5 offset:4096
v_mfma_f32_16x16x32_bf16 v[44:47], a[224:227], a[136:139], v[44:47]
v_mfma_f32_16x16x32_bf16 v[44:47], a[228:231], a[140:143], v[44:47]
ds_read_b128 a[220:223], v5 offset:12288
s_waitcnt lgkmcnt(4)
v_mfma_f32_16x16x32_bf16 v[48:51], a[232:235], a[64:67], v[48:51]
v_mfma_f32_16x16x32_bf16 v[48:51], a[236:239], a[68:71], v[48:51]
ds_read_b128 a[224:227], v5 offset:5120
v_mfma_f32_16x16x32_bf16 v[52:55], a[232:235], a[136:139], v[52:55]
v_mfma_f32_16x16x32_bf16 v[52:55], a[236:239], a[140:143], v[52:55]
ds_read_b128 a[228:231], v5 offset:13312
s_waitcnt lgkmcnt(4)
v_mfma_f32_16x16x32_bf16 v[56:59], a[240:243], a[64:67], v[56:59]
v_mfma_f32_16x16x32_bf16 v[56:59], a[244:247], a[68:71], v[56:59]
ds_read_b128 a[232:235], v5 offset:6144
v_mfma_f32_16x16x32_bf16 v[60:63], a[240:243], a[136:139], v[60:63]
v_mfma_f32_16x16x32_bf16 v[60:63], a[244:247], a[140:143], v[60:63]
ds_read_b128 a[236:239], v5 offset:14336
s_waitcnt lgkmcnt(4)
v_mfma_f32_16x16x32_bf16 v[64:67], a[216:219], a[64:67], v[64:67]
v_mfma_f32_16x16x32_bf16 v[64:67], a[220:223], a[68:71], v[64:67]
ds_read_b128 a[240:243], v5 offset:7168
v_mfma_f32_16x16x32_bf16 v[68:71], a[216:219], a[136:139], v[68:71]
v_mfma_f32_16x16x32_bf16 v[68:71], a[220:223], a[140:143], v[68:71]
ds_read_b128 a[244:247], v5 offset:15360
s_waitcnt lgkmcnt(4)
v_mfma_f32_16x16x32_bf16 v[72:75], a[64:67], a[224:227], v[72:75]
v_mfma_f32_16x16x32_bf16 v[72:75], a[68:71], a[228:231], v[72:75]
ds_read_b128 a[216:219], v8 offset:0
v_mfma_f32_16x16x32_bf16 v[76:79], a[136:139], a[224:227], v[76:79]
v_mfma_f32_16x16x32_bf16 v[76:79], a[140:143], a[228:231], v[76:79]
ds_read_b128 a[220:223], v8 offset:8192
s_waitcnt lgkmcnt(4)
v_mfma_f32_16x16x32_bf16 v[80:83], a[64:67], a[232:235], v[80:83]
v_mfma_f32_16x16x32_bf16 v[80:83], a[68:71], a[236:239], v[80:83]
ds_read_b128 a[224:227], v11 offset:0
v_mfma_f32_16x16x32_bf16 v[84:87], a[136:139], a[232:235], v[84:87]
v_mfma_f32_16x16x32_bf16 v[84:87], a[140:143], a[236:239], v[84:87]
ds_read_b128 a[228:231], v11 offset:8192
s_waitcnt lgkmcnt(4)
v_mfma_f32_16x16x32_bf16 v[88:91], a[64:67], a[240:243], v[88:91]
v_mfma_f32_16x16x32_bf16 v[88:91], a[68:71], a[244:247], v[88:91]
v_mfma_f32_16x16x32_bf16 v[92:95], a[136:139], a[240:243], v[92:95]
v_mfma_f32_16x16x32_bf16 v[92:95], a[140:143], a[244:247], v[92:95]
s_waitcnt lgkmcnt(2)
v_mfma_f32_16x16x32_bf16 v[96:99], a[216:219], a[208:211], v[96:99]
v_mfma_f32_16x16x32_bf16 v[96:99], a[220:223], a[212:215], v[96:99]
s_waitcnt lgkmcnt(0)
v_mfma_f32_16x16x32_bf16 v[100:103], a[208:211], a[224:227], v[100:103]
v_mfma_f32_16x16x32_bf16 v[100:103], a[212:215], a[228:231], v[100:103]
s_branch L_att
L_last:
s_cmp_eq_u32 s4, 3
s_cbranch_scc1 L_epoch
v_and_b32 v6, 7, v1
v_lshrrev_b32 v7, 3, v1
s_mul_i32 s22, s4, 24
v_add_u32 v7, s22, v7
s_and_b32 s23, s6, 1
s_lshl_b32 s23, s23, 3
v_add_u32 v8, s23, v6
v_lshlrev_b32 v8, 4, v8
v_lshl_add_u32 v4, v7, 8, v8
s_lshl_b32 s24, s5, 4
s_lshr_b32 s25, s6, 1
s_add_u32 s24, s24, s25
s_mul_i32 s20, s24, 18432
s_lshl_b32 s24, s5, 8
s_lshl_b32 s25, s6, 3
s_add_u32 s24, s24, s25
s_and_b32 s25, s24, 1023
s_lshl_b32 s25, s25, 1
s_lshr_b32 s24, s24, 10
s_add_u32 s24, s24, s25
s_mul_i32 s21, s24, 1152
v_mul_u32_u24 v8, 2304, v6
v_lshl_add_u32 v5, v7, 4, v8
s_load_dwordx2 s[12:13], s[0:1], 56
s_waitcnt lgkmcnt(0)
s_mov_b32 s16, s12
s_and_b32 s17, s13, 0xffff
s_mov_b32 s18, 2359296
s_mov_b32 s19, 0x20000
v_mov_b32 v13, 2146435072
v_cmp_eq_u32 vcc, 0, v0
v_mov_b32 v14, s68
v_mov_b32 v15, s69
v_cndmask_b32 v13, v13, 0, vcc
s_waitcnt vmcnt(0)
s_barrier
buffer_store_dwordx2 v[14:15], v13, s[8:11], s14 offen sc1
s_add_u32 s24, s20, 39776256
s_add_u32 s25, s24, 4096
buffer_load_dwordx4 v[16:19], v4, s[8:11], s24 offen offset:0 sc1
buffer_load_dwordx4 v[20:23], v4, s[8:11], s24 offen offset:2048 sc1
buffer_load_dwordx4 v[24:27], v4, s[8:11], s25 offen offset:0 sc1
s_lshl_b32 s24, s5, 12
s_add_u32 s24, s24, 1703936
v_and_b32 v6, 31, v1
v_lshlrev_b32 v6, 7, v6
s_mov_b32 s52, 0
L_poll6:
buffer_load_dwordx2 v[14:15], v6, s[8:11], s24 offen sc1
s_add_u32 s52, s52, 1
s_waitcnt vmcnt(0)
v_cmp_ne_u64 vcc, s[68:69], v[14:15]
s_cmp_ge_u32 s52, 1048576
s_cbranch_scc1 L_got6
s_and_b64 exec, exec, vcc
s_cbranch_execnz L_poll6
L_got6:
s_mov_b64 exec, -1
s_add_u32 s24, s20, 99020800
s_add_u32 s25, s24, 4096
buffer_load_dwordx4 v[28:31], v4, s[8:11], s24 offen offset:0 sc1
buffer_load_dwordx4 v[32:35], v4, s[8:11], s24 offen offset:2048 sc1
buffer_load_dwordx4 v[36:39], v4, s[8:11], s25 offen offset:0 sc1
s_add_u32 s24, s20, 101380096
s_add_u32 s25, s24, 4096
buffer_load_dwordx4 v[40:43], v4, s[8:11], s24 offen offset:0 sc1
buffer_load_dwordx4 v[44:47], v4, s[8:11], s24 offen offset:2048 sc1
buffer_load_dwordx4 v[48:51], v4, s[8:11], s25 offen offset:0 sc1
s_add_u32 s24, s20, 103739392
s_add_u32 s25, s24, 4096
buffer_load_dwordx4 v[52:55], v4, s[8:11], s24 offen offset:0 sc1
buffer_load_dwordx4 v[56:59], v4, s[8:11], s24 offen offset:2048 sc1
buffer_load_dwordx4 v[60:63], v4, s[8:11], s25 offen offset:0 sc1
s_add_u32 s24, s20, 106098688
s_add_u32 s25, s24, 4096
buffer_load_dwordx4 v[64:67], v4, s[8:11], s24 offen offset:0 sc1
buffer_load_dwordx4 v[68:71], v4, s[8:11], s24 offen offset:2048 sc1
buffer_load_dwordx4 v[72:75], v4, s[8:11], s25 offen offset:0 sc1
s_add_u32 s24, s20, 108457984
s_add_u32 s25, s24, 4096
buffer_load_dwordx4 v[76:79], v4, s[8:11], s24 offen offset:0 sc1
buffer_load_dwordx4 v[80:83], v4, s[8:11], s24 offen offset:2048 sc1
buffer_load_dwordx4 v[84:87], v4, s[8:11], s25 offen offset:0 sc1
s_add_u32 s24, s20, 110817280
s_add_u32 s25, s24, 4096
buffer_load_dwordx4 v[88:91], v4, s[8:11], s24 offen offset:0 sc1
buffer_load_dwordx4 v[92:95], v4, s[8:11], s24 offen offset:2048 sc1
buffer_load_dwordx4 v[96:99], v4, s[8:11], s25 offen offset:0 sc1
s_add_u32 s24, s20, 113176576
s_add_u32 s25, s24, 4096
buffer_load_dwordx4 v[100:103], v4, s[8:11], s24 offen offset:0 sc1
buffer_load_dwordx4 v[104:107], v4, s[8:11], s24 offen offset:2048 sc1
buffer_load_dwordx4 v[108:111], v4, s[8:11], s25 offen offset:0 sc1
s_add_u32 s24, s20, 115535872
s_add_u32 s25, s24, 4096
buffer_load_dwordx4 v[112:115], v4, s[8:11], s24 offen offset:0 sc1
buffer_load_dwordx4 v[116:119], v4, s[8:11], s24 offen offset:2048 sc1
buffer_load_dwordx4 v[120:123], v4, s[8:11], s25 offen offset:0 sc1
s_waitcnt vmcnt(26)
v_lshlrev_b32 v128, 16, v16
v_and_b32 v129, 0xffff0000, v16
v_lshlrev_b32 v130, 16, v17
v_and_b32 v131, 0xffff0000, v17
v_lshlrev_b32 v132, 16, v18
v_and_b32 v133, 0xffff0000, v18
v_lshlrev_b32 v134, 16, v19
v_and_b32 v135, 0xffff0000, v19
s_waitcnt vmcnt(25)
v_lshlrev_b32 v136, 16, v20
v_and_b32 v137, 0xffff0000, v20
v_lshlrev_b32 v138, 16, v21
v_and_b32 v139, 0xffff0000, v21
v_lshlrev_b32 v140, 16, v22
v_and_b32 v141, 0xffff0000, v22
v_lshlrev_b32 v142, 16, v23
v_and_b32 v143, 0xffff0000, v23
s_waitcnt vmcnt(24)
v_lshlrev_b32 v144, 16, v24
v_and_b32 v145, 0xffff0000, v24
v_lshlrev_b32 v146, 16, v25
v_and_b32 v147, 0xffff0000, v25
v_lshlrev_b32 v148, 16, v26
v_and_b32 v149, 0xffff0000, v26
v_lshlrev_b32 v150, 16, v27
v_and_b32 v151, 0xffff0000, v27
s_waitcnt vmcnt(23)
v_lshlrev_b32 v6, 16, v28
v_and_b32 v7, 0xffff0000, v28
v_add_f32 v128, v128, v6
v_add_f32 v129, v129, v7
v_lshlrev_b32 v8, 16, v29
v_and_b32 v9, 0xffff0000, v29
v_add_f32 v130, v130, v8
v_add_f32 v131, v131, v9
v_lshlrev_b32 v6, 16, v30
v_and_b32 v7, 0xffff0000, v30
v_add_f32 v132, v132, v6
v_add_f32 v133, v133, v7
v_lshlrev_b32 v8, 16, v31
v_and_b32 v9, 0xffff0000, v31
v_add_f32 v134, v134, v8
v_add_f32 v135, v135, v9
s_waitcnt vmcnt(22)
v_lshlrev_b32 v6, 16, v32
v_and_b32 v7, 0xffff0000, v32
v_add_f32 v136, v136, v6
v_add_f32 v137, v137, v7
v_lshlrev_b32 v8, 16, v33
v_and_b32 v9, 0xffff0000, v33
v_add_f32 v138, v138, v8
v_add_f32 v139, v139, v9
v_lshlrev_b32 v6, 16, v34
v_and_b32 v7, 0xffff0000, v34
v_add_f32 v140, v140, v6
v_add_f32 v141, v141, v7
v_lshlrev_b32 v8, 16, v35
v_and_b32 v9, 0xffff0000, v35
v_add_f32 v142, v142, v8
v_add_f32 v143, v143, v9
s_waitcnt vmcnt(21)
v_lshlrev_b32 v6, 16, v36
v_and_b32 v7, 0xffff0000, v36
v_add_f32 v144, v144, v6
v_add_f32 v145, v145, v7
v_lshlrev_b32 v8, 16, v37
v_and_b32 v9, 0xffff0000, v37
v_add_f32 v146, v146, v8
v_add_f32 v147, v147, v9
v_lshlrev_b32 v6, 16, v38
v_and_b32 v7, 0xffff0000, v38
v_add_f32 v148, v148, v6
v_add_f32 v149, v149, v7
v_lshlrev_b32 v8, 16, v39
v_and_b32 v9, 0xffff0000, v39
v_add_f32 v150, v150, v8
v_add_f32 v151, v151, v9
s_waitcnt vmcnt(20)
v_lshlrev_b32 v6, 16, v40
v_and_b32 v7, 0xffff0000, v40
v_add_f32 v128, v128, v6
v_add_f32 v129, v129, v7
v_lshlrev_b32 v8, 16, v41
v_and_b32 v9, 0xffff0000, v41
v_add_f32 v130, v130, v8
v_add_f32 v131, v131, v9
v_lshlrev_b32 v6, 16, v42
v_and_b32 v7, 0xffff0000, v42
v_add_f32 v132, v132, v6
v_add_f32 v133, v133, v7
v_lshlrev_b32 v8, 16, v43
v_and_b32 v9, 0xffff0000, v43
v_add_f32 v134, v134, v8
v_add_f32 v135, v135, v9
s_waitcnt vmcnt(19)
v_lshlrev_b32 v6, 16, v44
v_and_b32 v7, 0xffff0000, v44
v_add_f32 v136, v136, v6
v_add_f32 v137, v137, v7
v_lshlrev_b32 v8, 16, v45
v_and_b32 v9, 0xffff0000, v45
v_add_f32 v138, v138, v8
v_add_f32 v139, v139, v9
v_lshlrev_b32 v6, 16, v46
v_and_b32 v7, 0xffff0000, v46
v_add_f32 v140, v140, v6
v_add_f32 v141, v141, v7
v_lshlrev_b32 v8, 16, v47
v_and_b32 v9, 0xffff0000, v47
v_add_f32 v142, v142, v8
v_add_f32 v143, v143, v9
s_waitcnt vmcnt(18)
v_lshlrev_b32 v6, 16, v48
v_and_b32 v7, 0xffff0000, v48
v_add_f32 v144, v144, v6
v_add_f32 v145, v145, v7
v_lshlrev_b32 v8, 16, v49
v_and_b32 v9, 0xffff0000, v49
v_add_f32 v146, v146, v8
v_add_f32 v147, v147, v9
v_lshlrev_b32 v6, 16, v50
v_and_b32 v7, 0xffff0000, v50
v_add_f32 v148, v148, v6
v_add_f32 v149, v149, v7
v_lshlrev_b32 v8, 16, v51
v_and_b32 v9, 0xffff0000, v51
v_add_f32 v150, v150, v8
v_add_f32 v151, v151, v9
s_waitcnt vmcnt(17)
v_lshlrev_b32 v6, 16, v52
v_and_b32 v7, 0xffff0000, v52
v_add_f32 v128, v128, v6
v_add_f32 v129, v129, v7
v_lshlrev_b32 v8, 16, v53
v_and_b32 v9, 0xffff0000, v53
v_add_f32 v130, v130, v8
v_add_f32 v131, v131, v9
v_lshlrev_b32 v6, 16, v54
v_and_b32 v7, 0xffff0000, v54
v_add_f32 v132, v132, v6
v_add_f32 v133, v133, v7
v_lshlrev_b32 v8, 16, v55
v_and_b32 v9, 0xffff0000, v55
v_add_f32 v134, v134, v8
v_add_f32 v135, v135, v9
s_waitcnt vmcnt(16)
v_lshlrev_b32 v6, 16, v56
v_and_b32 v7, 0xffff0000, v56
v_add_f32 v136, v136, v6
v_add_f32 v137, v137, v7
v_lshlrev_b32 v8, 16, v57
v_and_b32 v9, 0xffff0000, v57
v_add_f32 v138, v138, v8
v_add_f32 v139, v139, v9
v_lshlrev_b32 v6, 16, v58
v_and_b32 v7, 0xffff0000, v58
v_add_f32 v140, v140, v6
v_add_f32 v141, v141, v7
v_lshlrev_b32 v8, 16, v59
v_and_b32 v9, 0xffff0000, v59
v_add_f32 v142, v142, v8
v_add_f32 v143, v143, v9
s_waitcnt vmcnt(15)
v_lshlrev_b32 v6, 16, v60
v_and_b32 v7, 0xffff0000, v60
v_add_f32 v144, v144, v6
v_add_f32 v145, v145, v7
v_lshlrev_b32 v8, 16, v61
v_and_b32 v9, 0xffff0000, v61
v_add_f32 v146, v146, v8
v_add_f32 v147, v147, v9
v_lshlrev_b32 v6, 16, v62
v_and_b32 v7, 0xffff0000, v62
v_add_f32 v148, v148, v6
v_add_f32 v149, v149, v7
v_lshlrev_b32 v8, 16, v63
v_and_b32 v9, 0xffff0000, v63
v_add_f32 v150, v150, v8
v_add_f32 v151, v151, v9
s_waitcnt vmcnt(14)
v_lshlrev_b32 v6, 16, v64
v_and_b32 v7, 0xffff0000, v64
v_add_f32 v128, v128, v6
v_add_f32 v129, v129, v7
v_lshlrev_b32 v8, 16, v65
v_and_b32 v9, 0xffff0000, v65
v_add_f32 v130, v130, v8
v_add_f32 v131, v131, v9
v_lshlrev_b32 v6, 16, v66
v_and_b32 v7, 0xffff0000, v66
v_add_f32 v132, v132, v6
v_add_f32 v133, v133, v7
v_lshlrev_b32 v8, 16, v67
v_and_b32 v9, 0xffff0000, v67
v_add_f32 v134, v134, v8
v_add_f32 v135, v135, v9
s_waitcnt vmcnt(13)
v_lshlrev_b32 v6, 16, v68
v_and_b32 v7, 0xffff0000, v68
v_add_f32 v136, v136, v6
v_add_f32 v137, v137, v7
v_lshlrev_b32 v8, 16, v69
v_and_b32 v9, 0xffff0000, v69
v_add_f32 v138, v138, v8
v_add_f32 v139, v139, v9
v_lshlrev_b32 v6, 16, v70
v_and_b32 v7, 0xffff0000, v70
v_add_f32 v140, v140, v6
v_add_f32 v141, v141, v7
v_lshlrev_b32 v8, 16, v71
v_and_b32 v9, 0xffff0000, v71
v_add_f32 v142, v142, v8
v_add_f32 v143, v143, v9
s_waitcnt vmcnt(12)
v_lshlrev_b32 v6, 16, v72
v_and_b32 v7, 0xffff0000, v72
v_add_f32 v144, v144, v6
v_add_f32 v145, v145, v7
v_lshlrev_b32 v8, 16, v73
v_and_b32 v9, 0xffff0000, v73
v_add_f32 v146, v146, v8
v_add_f32 v147, v147, v9
v_lshlrev_b32 v6, 16, v74
v_and_b32 v7, 0xffff0000, v74
v_add_f32 v148, v148, v6
v_add_f32 v149, v149, v7
v_lshlrev_b32 v8, 16, v75
v_and_b32 v9, 0xffff0000, v75
v_add_f32 v150, v150, v8
v_add_f32 v151, v151, v9
s_waitcnt vmcnt(11)
v_lshlrev_b32 v6, 16, v76
v_and_b32 v7, 0xffff0000, v76
v_add_f32 v128, v128, v6
v_add_f32 v129, v129, v7
v_lshlrev_b32 v8, 16, v77
v_and_b32 v9, 0xffff0000, v77
v_add_f32 v130, v130, v8
v_add_f32 v131, v131, v9
v_lshlrev_b32 v6, 16, v78
v_and_b32 v7, 0xffff0000, v78
v_add_f32 v132, v132, v6
v_add_f32 v133, v133, v7
v_lshlrev_b32 v8, 16, v79
v_and_b32 v9, 0xffff0000, v79
v_add_f32 v134, v134, v8
v_add_f32 v135, v135, v9
s_waitcnt vmcnt(10)
v_lshlrev_b32 v6, 16, v80
v_and_b32 v7, 0xffff0000, v80
v_add_f32 v136, v136, v6
v_add_f32 v137, v137, v7
v_lshlrev_b32 v8, 16, v81
v_and_b32 v9, 0xffff0000, v81
v_add_f32 v138, v138, v8
v_add_f32 v139, v139, v9
v_lshlrev_b32 v6, 16, v82
v_and_b32 v7, 0xffff0000, v82
v_add_f32 v140, v140, v6
v_add_f32 v141, v141, v7
v_lshlrev_b32 v8, 16, v83
v_and_b32 v9, 0xffff0000, v83
v_add_f32 v142, v142, v8
v_add_f32 v143, v143, v9
s_waitcnt vmcnt(9)
v_lshlrev_b32 v6, 16, v84
v_and_b32 v7, 0xffff0000, v84
v_add_f32 v144, v144, v6
v_add_f32 v145, v145, v7
v_lshlrev_b32 v8, 16, v85
v_and_b32 v9, 0xffff0000, v85
v_add_f32 v146, v146, v8
v_add_f32 v147, v147, v9
v_lshlrev_b32 v6, 16, v86
v_and_b32 v7, 0xffff0000, v86
v_add_f32 v148, v148, v6
v_add_f32 v149, v149, v7
v_lshlrev_b32 v8, 16, v87
v_and_b32 v9, 0xffff0000, v87
v_add_f32 v150, v150, v8
v_add_f32 v151, v151, v9
s_waitcnt vmcnt(8)
v_lshlrev_b32 v6, 16, v88
v_and_b32 v7, 0xffff0000, v88
v_add_f32 v128, v128, v6
v_add_f32 v129, v129, v7
v_lshlrev_b32 v8, 16, v89
v_and_b32 v9, 0xffff0000, v89
v_add_f32 v130, v130, v8
v_add_f32 v131, v131, v9
v_lshlrev_b32 v6, 16, v90
v_and_b32 v7, 0xffff0000, v90
v_add_f32 v132, v132, v6
v_add_f32 v133, v133, v7
v_lshlrev_b32 v8, 16, v91
v_and_b32 v9, 0xffff0000, v91
v_add_f32 v134, v134, v8
v_add_f32 v135, v135, v9
s_waitcnt vmcnt(7)
v_lshlrev_b32 v6, 16, v92
v_and_b32 v7, 0xffff0000, v92
v_add_f32 v136, v136, v6
v_add_f32 v137, v137, v7
v_lshlrev_b32 v8, 16, v93
v_and_b32 v9, 0xffff0000, v93
v_add_f32 v138, v138, v8
v_add_f32 v139, v139, v9
v_lshlrev_b32 v6, 16, v94
v_and_b32 v7, 0xffff0000, v94
v_add_f32 v140, v140, v6
v_add_f32 v141, v141, v7
v_lshlrev_b32 v8, 16, v95
v_and_b32 v9, 0xffff0000, v95
v_add_f32 v142, v142, v8
v_add_f32 v143, v143, v9
s_waitcnt vmcnt(6)
v_lshlrev_b32 v6, 16, v96
v_and_b32 v7, 0xffff0000, v96
v_add_f32 v144, v144, v6
v_add_f32 v145, v145, v7
v_lshlrev_b32 v8, 16, v97
v_and_b32 v9, 0xffff0000, v97
v_add_f32 v146, v146, v8
v_add_f32 v147, v147, v9
v_lshlrev_b32 v6, 16, v98
v_and_b32 v7, 0xffff0000, v98
v_add_f32 v148, v148, v6
v_add_f32 v149, v149, v7
v_lshlrev_b32 v8, 16, v99
v_and_b32 v9, 0xffff0000, v99
v_add_f32 v150, v150, v8
v_add_f32 v151, v151, v9
s_waitcnt vmcnt(5)
v_lshlrev_b32 v6, 16, v100
v_and_b32 v7, 0xffff0000, v100
v_add_f32 v128, v128, v6
v_add_f32 v129, v129, v7
v_lshlrev_b32 v8, 16, v101
v_and_b32 v9, 0xffff0000, v101
v_add_f32 v130, v130, v8
v_add_f32 v131, v131, v9
v_lshlrev_b32 v6, 16, v102
v_and_b32 v7, 0xffff0000, v102
v_add_f32 v132, v132, v6
v_add_f32 v133, v133, v7
v_lshlrev_b32 v8, 16, v103
v_and_b32 v9, 0xffff0000, v103
v_add_f32 v134, v134, v8
v_add_f32 v135, v135, v9
s_waitcnt vmcnt(4)
v_lshlrev_b32 v6, 16, v104
v_and_b32 v7, 0xffff0000, v104
v_add_f32 v136, v136, v6
v_add_f32 v137, v137, v7
v_lshlrev_b32 v8, 16, v105
v_and_b32 v9, 0xffff0000, v105
v_add_f32 v138, v138, v8
v_add_f32 v139, v139, v9
v_lshlrev_b32 v6, 16, v106
v_and_b32 v7, 0xffff0000, v106
v_add_f32 v140, v140, v6
v_add_f32 v141, v141, v7
v_lshlrev_b32 v8, 16, v107
v_and_b32 v9, 0xffff0000, v107
v_add_f32 v142, v142, v8
v_add_f32 v143, v143, v9
s_waitcnt vmcnt(3)
v_lshlrev_b32 v6, 16, v108
v_and_b32 v7, 0xffff0000, v108
v_add_f32 v144, v144, v6
v_add_f32 v145, v145, v7
v_lshlrev_b32 v8, 16, v109
v_and_b32 v9, 0xffff0000, v109
v_add_f32 v146, v146, v8
v_add_f32 v147, v147, v9
v_lshlrev_b32 v6, 16, v110
v_and_b32 v7, 0xffff0000, v110
v_add_f32 v148, v148, v6
v_add_f32 v149, v149, v7
v_lshlrev_b32 v8, 16, v111
v_and_b32 v9, 0xffff0000, v111
v_add_f32 v150, v150, v8
v_add_f32 v151, v151, v9
s_waitcnt vmcnt(2)
v_lshlrev_b32 v6, 16, v112
v_and_b32 v7, 0xffff0000, v112
v_add_f32 v128, v128, v6
v_add_f32 v129, v129, v7
v_lshlrev_b32 v8, 16, v113
v_and_b32 v9, 0xffff0000, v113
v_add_f32 v130, v130, v8
v_add_f32 v131, v131, v9
v_lshlrev_b32 v6, 16, v114
v_and_b32 v7, 0xffff0000, v114
v_add_f32 v132, v132, v6
v_add_f32 v133, v133, v7
v_lshlrev_b32 v8, 16, v115
v_and_b32 v9, 0xffff0000, v115
v_add_f32 v134, v134, v8
v_add_f32 v135, v135, v9
s_waitcnt vmcnt(1)
v_lshlrev_b32 v6, 16, v116
v_and_b32 v7, 0xffff0000, v116
v_add_f32 v136, v136, v6
v_add_f32 v137, v137, v7
v_lshlrev_b32 v8, 16, v117
v_and_b32 v9, 0xffff0000, v117
v_add_f32 v138, v138, v8
v_add_f32 v139, v139, v9
v_lshlrev_b32 v6, 16, v118
v_and_b32 v7, 0xffff0000, v118
v_add_f32 v140, v140, v6
v_add_f32 v141, v141, v7
v_lshlrev_b32 v8, 16, v119
v_and_b32 v9, 0xffff0000, v119
v_add_f32 v142, v142, v8
v_add_f32 v143, v143, v9
s_waitcnt vmcnt(0)
v_lshlrev_b32 v6, 16, v120
v_and_b32 v7, 0xffff0000, v120
v_add_f32 v144, v144, v6
v_add_f32 v145, v145, v7
v_lshlrev_b32 v8, 16, v121
v_and_b32 v9, 0xffff0000, v121
v_add_f32 v146, v146, v8
v_add_f32 v147, v147, v9
v_lshlrev_b32 v6, 16, v122
v_and_b32 v7, 0xffff0000, v122
v_add_f32 v148, v148, v6
v_add_f32 v149, v149, v7
v_lshlrev_b32 v8, 16, v123
v_and_b32 v9, 0xffff0000, v123
v_add_f32 v150, v150, v8
v_add_f32 v151, v151, v9
v_cvt_pk_bf16_f32 v152, v128, v129
v_cvt_pk_bf16_f32 v153, v130, v131
v_cvt_pk_bf16_f32 v154, v132, v133
v_cvt_pk_bf16_f32 v155, v134, v135
v_cvt_pk_bf16_f32 v156, v136, v137
v_cvt_pk_bf16_f32 v157, v138, v139
v_cvt_pk_bf16_f32 v158, v140, v141
v_cvt_pk_bf16_f32 v159, v142, v143
v_cvt_pk_bf16_f32 v160, v144, v145
v_cvt_pk_bf16_f32 v161, v146, v147
v_cvt_pk_bf16_f32 v162, v148, v149
v_cvt_pk_bf16_f32 v163, v150, v151
buffer_store_dwordx4 v[152:155], v5, s[16:19], s21 offen offset:0
buffer_store_dwordx4 v[156:159], v5, s[16:19], s21 offen offset:128
buffer_store_dwordx4 v[160:163], v5, s[16:19], s21 offen offset:256
L_end:
s_endpgm
L_f_slow1:
s_mov_b32 s52, 0
L_f_spin1:
buffer_load_dwordx2 v[14:15], v11, s[8:11], s23 offen sc1
s_add_u32 s52, s52, 1
s_waitcnt vmcnt(0)
v_cmp_eq_u64 vcc, s[68:69], v[14:15]
s_cmp_gt_u32 s52, 1048576
s_cbranch_scc1 L_f_back1
s_cmp_eq_u64 vcc, exec
s_cbranch_scc0 L_f_spin1
s_branch L_f_back1
L_f_slow2:
s_mov_b32 s52, 0
L_f_spin2:
buffer_load_dwordx2 v[14:15], v11, s[8:11], s23 offen sc1
s_add_u32 s52, s52, 1
s_waitcnt vmcnt(0)
v_cmp_eq_u64 vcc, s[68:69], v[14:15]
s_cmp_gt_u32 s52, 1048576
s_cbranch_scc1 L_f_back2
s_cmp_eq_u64 vcc, exec
s_cbranch_scc0 L_f_spin2
s_branch L_f_back2
L_f_slow3:
s_mov_b32 s52, 0
L_f_spin3:
buffer_load_dwordx2 v[14:15], v11, s[8:11], s23 offen sc1
s_add_u32 s52, s52, 1
s_waitcnt vmcnt(0)
v_cmp_eq_u64 vcc, s[68:69], v[14:15]
s_cmp_gt_u32 s52, 1048576
s_cbranch_scc1 L_f_back3
s_cmp_eq_u64 vcc, exec
s_cbranch_scc0 L_f_spin3
s_branch L_f_back3
L_epoch:
v_mov_b32 v13, 2146435072
v_cmp_eq_u32 vcc, 0, v0
v_mov_b32 v14, s68
v_mov_b32 v15, s69
v_cndmask_b32 v13, v13, 0, vcc
s_waitcnt vmcnt(0)
s_barrier
buffer_store_dwordx2 v[14:15], v13, s[8:11], s14 offen sc1
s_cmp_lg_u32 s2, 0
s_cbranch_scc1 L_end
s_load_dwordx2 s[12:13], s[0:1], 64
s_waitcnt lgkmcnt(0)
s_mov_b32 s44, s12
s_and_b32 s45, s13, 0xffff
s_mov_b32 s46, 256
s_mov_b32 s47, 0x20000
v_mov_b32 v3, 0
s_mov_b32 s52, 0
L_ep:
buffer_load_dword v4, v3, s[44:47], 0 offen sc1
s_add_u32 s52, s52, 1
s_waitcnt vmcnt(0)
v_readfirstlane_b32 s40, v4
s_cmp_ge_u32 s52, 0x100000
s_cbranch_scc1 L_end
s_cmp_lt_u32 s40, 256
s_cbranch_scc1 L_ep
s_mov_b32 s40, 4194304
v_mov_b32 v13, 2146435072
v_cmp_eq_u32 vcc, 0, v1
v_mov_b32 v14, s68
v_mov_b32 v15, s69
v_cndmask_b32 v13, v13, 0, vcc
buffer_store_dwordx2 v[14:15], v13, s[8:11], s40 offen sc1
s_branch L_end
L_code_end:
s_endpgm
.section .rodata,"a"
.p2align 6
.amdhsa_kernel interleave_layers__sliding_local_dilated__glu_gated_geglu__prompt_kernel
  .amdhsa_next_free_vgpr 512
  .amdhsa_next_free_sgpr 102
  .amdhsa_accum_offset 256
  .amdhsa_group_segment_fixed_size 0
  .amdhsa_kernarg_size 80
  .amdhsa_user_sgpr_count 2
  .amdhsa_user_sgpr_kernarg_segment_ptr 1
  .amdhsa_system_sgpr_workgroup_id_x 1
.end_amdhsa_kernel
```

```asm
; @launch grid=(256,1,1) block=(256,1,1) lds=160768
.amdgcn_target "amdgcn-amd-amdhsa--gfx950"
.text
.p2align 8
.globl interleave_layers__sliding_local_dilated__glu_gated_geglu__prompt_kernel
.type interleave_layers__sliding_local_dilated__glu_gated_geglu__prompt_kernel,@function
interleave_layers__sliding_local_dilated__glu_gated_geglu__prompt_kernel:
s_cmp_ge_u32 s2, 256
s_cbranch_scc1 L_end
s_getpc_b64 s[40:41]
L_warm_pc:
s_lshr_b32 s42, s2, 3
s_lshl_b32 s42, s42, 11
v_lshlrev_b32 v10, 3, v0
v_add_u32 v10, s42, v10
v_min_u32 v10, L_code_end - L_warm_pc - 8, v10
v_mov_b32 v11, s41
v_add_co_u32 v10, vcc, s40, v10
s_nop 1
v_addc_co_u32 v11, vcc, 0, v11, vcc
global_load_dwordx2 a[0:1], v[10:11], off
v_add_co_u32 v10, vcc, 0x10000, v10
s_nop 1
v_addc_co_u32 v11, vcc, 0, v11, vcc
s_add_u32 s42, s42, 67584
s_cmp_le_u32 s42, L_code_end - L_warm_pc - 8
s_cbranch_scc0 L_warm_done
global_load_dwordx2 a[2:3], v[10:11], off
L_warm_done:
s_load_dwordx4 s[56:59], s[0:1], 0
s_load_dwordx2 s[60:61], s[0:1], 16
s_load_dwordx4 s[64:67], s[0:1], 32
s_load_dwordx2 s[62:63], s[0:1], 48
s_load_dwordx2 s[54:55], s[0:1], 64
s_load_dwordx2 s[12:13], s[0:1], 72
v_and_b32 v1, 63, v0
v_lshrrev_b32 v3, 6, v0
v_lshlrev_b32 v2, 4, v1
v_readfirstlane_b32 s4, v3
s_and_b32 s5, s2, 7
s_lshr_b32 s6, s2, 3
s_waitcnt lgkmcnt(0)
s_mov_b32 s8, s12
s_and_b32 s9, s13, 0xffff
s_mov_b32 s10, 268435456
s_mov_b32 s11, 0x20000
s_mov_b32 s16, s56
s_and_b32 s17, s57, 0xffff
s_mov_b32 s18, 2359296
s_mov_b32 s19, 0x20000
v_mov_b32 v3, 4194304
buffer_load_dwordx2 v[14:15], v3, s[8:11], 0 offen sc1
v_and_b32 v6, 7, v1
v_lshrrev_b32 v7, 3, v1
s_and_b32 s23, s6, 1
s_lshl_b32 s23, s23, 3
v_add_u32 v8, s23, v6
v_lshlrev_b32 v8, 4, v8
v_lshl_add_u32 v4, v7, 8, v8
s_lshl_b32 s24, s5, 4
s_lshr_b32 s25, s6, 1
s_add_u32 s24, s24, s25
s_mul_i32 s20, s24, 18432
s_lshl_b32 s24, s5, 8
s_lshl_b32 s25, s6, 3
s_add_u32 s24, s24, s25
s_and_b32 s25, s24, 1023
s_lshl_b32 s25, s25, 1
s_lshr_b32 s24, s24, 10
s_add_u32 s24, s24, s25
s_mul_i32 s21, s24, 1152
v_mul_u32_u24 v8, 2304, v6
v_lshl_add_u32 v5, v7, 4, v8
s_lshl_b32 s22, s4, 2
s_lshr_b32 s23, 1056, s22
s_and_b32 s23, s23, 15
s_lshl_b32 s24, s23, 11
s_add_u32 s28, s20, s24
s_lshl_b32 s24, s23, 7
s_add_u32 s31, s21, s24
s_lshr_b32 s23, 790, s22
s_and_b32 s23, s23, 15
s_lshl_b32 s24, s23, 11
s_add_u32 s29, s20, s24
s_lshl_b32 s24, s23, 7
s_add_u32 s32, s21, s24
s_lshr_b32 s23, 2165, s22
s_and_b32 s23, s23, 15
s_lshl_b32 s24, s23, 11
s_add_u32 s30, s20, s24
s_lshl_b32 s24, s23, 7
s_add_u32 s33, s21, s24
s_cmp_eq_u32 s4, 3
s_cselect_b64 vcc, -1, 0
v_mov_b32 v8, 2146435072
v_cndmask_b32 v4, v4, v8, vcc
v_cndmask_b32 v5, v5, v8, vcc
buffer_load_dwordx4 v[16:19], v5, s[16:19], s31 offen nt
buffer_load_dwordx4 v[20:23], v5, s[16:19], s32 offen nt
buffer_load_dwordx4 v[24:27], v5, s[16:19], s33 offen nt
s_lshl_b32 s40, s6, 2
s_add_u32 s40, s40, s4
v_and_b32 v6, 15, v1
v_lshrrev_b32 v7, 4, v1
v_lshrrev_b32 v8, 2, v6
v_mov_b32 v12, 2146435072
s_cmp_ge_u32 s40, 96
s_cbranch_scc1 L_g_o
s_mov_b32 s44, s58
s_and_b32 s45, s59, 0xffff
s_mov_b32 s46, 1990656
s_mov_b32 s47, 0x20000
s_cmp_ge_u32 s40, 48
s_cselect_b32 s41, 1, 0
s_mul_i32 s42, s41, 48
s_sub_u32 s40, s40, s42
s_mul_i32 s40, s40, 3
s_lshl_b32 s42, s5, 1
s_add_u32 s41, s41, s42
s_mul_i32 s38, s41, 147456
s_lshl_b32 s42, s40, 10
s_add_u32 s38, s38, s42
s_add_u32 s38, s38, 4198400
s_mul_i32 s41, s41, 36
v_and_b32 v9, 1, v6
v_bfe_u32 v10, v6, 1, 1
v_mul_u32_u24 v10, 18, v10
v_add_u32 v9, v9, v10
v_mul_u32_u24 v10, 576, v8
v_add_u32 v9, v9, v10
v_mul_u32_u24 v10, 27648, v7
s_add_u32 s42, s40, 0
s_and_b32 s43, s42, 7
s_lshr_b32 s42, s42, 3
s_mul_i32 s42, s42, 110592
s_mov_b32 s35, 0
s_cmp_eq_u32 s43, 1
s_cselect_b32 s35, 18, s35
s_cmp_eq_u32 s43, 2
s_cselect_b32 s35, 576, s35
s_cmp_eq_u32 s43, 3
s_cselect_b32 s35, 594, s35
s_cmp_eq_u32 s43, 4
s_cselect_b32 s35, 16, s35
s_cmp_eq_u32 s43, 5
s_cselect_b32 s35, 1152, s35
s_cmp_eq_u32 s43, 6
s_cselect_b32 s35, 1170, s35
s_cmp_eq_u32 s43, 7
s_cselect_b32 s35, 1168, s35
s_add_u32 s35, s35, s41
s_mov_b32 s36, 16
s_cmp_eq_u32 s43, 4
s_cselect_b32 s36, 8, s36
s_cmp_eq_u32 s43, 7
s_cselect_b32 s36, 4, s36
s_cmp_lg_u32 s36, 16
s_cselect_b64 vcc, -1, 0
v_cndmask_b32 v11, v6, v9, vcc
v_add_u32 v11, s35, v11
v_lshl_add_u32 v11, v11, 1, v10
v_cmp_gt_u32 vcc, s36, v6
s_nop 1
v_cndmask_b32 v11, v12, v11, vcc
buffer_load_ushort v52, v11, s[44:47], s42 offen
s_add_u32 s42, s42, 3456
buffer_load_ushort v53, v11, s[44:47], s42 offen
s_add_u32 s42, s42, 3456
buffer_load_ushort v54, v11, s[44:47], s42 offen
s_add_u32 s42, s42, 3456
buffer_load_ushort v55, v11, s[44:47], s42 offen
s_add_u32 s42, s42, 3456
buffer_load_ushort v56, v11, s[44:47], s42 offen
s_add_u32 s42, s42, 3456
buffer_load_ushort v57, v11, s[44:47], s42 offen
s_add_u32 s42, s42, 3456
buffer_load_ushort v58, v11, s[44:47], s42 offen
s_add_u32 s42, s42, 3456
buffer_load_ushort v59, v11, s[44:47], s42 offen
s_add_u32 s42, s40, 1
s_and_b32 s43, s42, 7
s_lshr_b32 s42, s42, 3
s_mul_i32 s42, s42, 110592
s_mov_b32 s35, 0
s_cmp_eq_u32 s43, 1
s_cselect_b32 s35, 18, s35
s_cmp_eq_u32 s43, 2
s_cselect_b32 s35, 576, s35
s_cmp_eq_u32 s43, 3
s_cselect_b32 s35, 594, s35
s_cmp_eq_u32 s43, 4
s_cselect_b32 s35, 16, s35
s_cmp_eq_u32 s43, 5
s_cselect_b32 s35, 1152, s35
s_cmp_eq_u32 s43, 6
s_cselect_b32 s35, 1170, s35
s_cmp_eq_u32 s43, 7
s_cselect_b32 s35, 1168, s35
s_add_u32 s35, s35, s41
s_mov_b32 s36, 16
s_cmp_eq_u32 s43, 4
s_cselect_b32 s36, 8, s36
s_cmp_eq_u32 s43, 7
s_cselect_b32 s36, 4, s36
s_cmp_lg_u32 s36, 16
s_cselect_b64 vcc, -1, 0
v_cndmask_b32 v11, v6, v9, vcc
v_add_u32 v11, s35, v11
v_lshl_add_u32 v11, v11, 1, v10
v_cmp_gt_u32 vcc, s36, v6
s_nop 1
v_cndmask_b32 v11, v12, v11, vcc
buffer_load_ushort v60, v11, s[44:47], s42 offen
s_add_u32 s42, s42, 3456
buffer_load_ushort v61, v11, s[44:47], s42 offen
s_add_u32 s42, s42, 3456
buffer_load_ushort v62, v11, s[44:47], s42 offen
s_add_u32 s42, s42, 3456
buffer_load_ushort v63, v11, s[44:47], s42 offen
s_add_u32 s42, s42, 3456
buffer_load_ushort v64, v11, s[44:47], s42 offen
s_add_u32 s42, s42, 3456
buffer_load_ushort v65, v11, s[44:47], s42 offen
s_add_u32 s42, s42, 3456
buffer_load_ushort v66, v11, s[44:47], s42 offen
s_add_u32 s42, s42, 3456
buffer_load_ushort v67, v11, s[44:47], s42 offen
s_add_u32 s42, s40, 2
s_and_b32 s43, s42, 7
s_lshr_b32 s42, s42, 3
s_mul_i32 s42, s42, 110592
s_mov_b32 s35, 0
s_cmp_eq_u32 s43, 1
s_cselect_b32 s35, 18, s35
s_cmp_eq_u32 s43, 2
s_cselect_b32 s35, 576, s35
s_cmp_eq_u32 s43, 3
s_cselect_b32 s35, 594, s35
s_cmp_eq_u32 s43, 4
s_cselect_b32 s35, 16, s35
s_cmp_eq_u32 s43, 5
s_cselect_b32 s35, 1152, s35
s_cmp_eq_u32 s43, 6
s_cselect_b32 s35, 1170, s35
s_cmp_eq_u32 s43, 7
s_cselect_b32 s35, 1168, s35
s_add_u32 s35, s35, s41
s_mov_b32 s36, 16
s_cmp_eq_u32 s43, 4
s_cselect_b32 s36, 8, s36
s_cmp_eq_u32 s43, 7
s_cselect_b32 s36, 4, s36
s_cmp_lg_u32 s36, 16
s_cselect_b64 vcc, -1, 0
v_cndmask_b32 v11, v6, v9, vcc
v_add_u32 v11, s35, v11
v_lshl_add_u32 v11, v11, 1, v10
v_cmp_gt_u32 vcc, s36, v6
s_nop 1
v_cndmask_b32 v11, v12, v11, vcc
buffer_load_ushort v68, v11, s[44:47], s42 offen
s_add_u32 s42, s42, 3456
buffer_load_ushort v69, v11, s[44:47], s42 offen
s_add_u32 s42, s42, 3456
buffer_load_ushort v70, v11, s[44:47], s42 offen
s_add_u32 s42, s42, 3456
buffer_load_ushort v71, v11, s[44:47], s42 offen
s_add_u32 s42, s42, 3456
buffer_load_ushort v72, v11, s[44:47], s42 offen
s_add_u32 s42, s42, 3456
buffer_load_ushort v73, v11, s[44:47], s42 offen
s_add_u32 s42, s42, 3456
buffer_load_ushort v74, v11, s[44:47], s42 offen
s_add_u32 s42, s42, 3456
buffer_load_ushort v75, v11, s[44:47], s42 offen
s_branch L_g_done
L_g_o:
s_mov_b32 s44, s60
s_and_b32 s45, s61, 0xffff
s_mov_b32 s46, 663552
s_mov_b32 s47, 0x20000
s_sub_u32 s40, s40, 96
s_mul_i32 s40, s40, 3
s_mul_i32 s38, s5, 92160
s_lshl_b32 s42, s40, 10
s_add_u32 s38, s38, s42
s_add_u32 s38, s38, 6557696
s_cmp_ge_u32 s40, 90
s_cselect_b32 s38, 2146435072, s38
s_mul_i32 s41, s5, 72
v_and_b32 v9, 3, v6
v_lshl_add_u32 v9, v8, 3, v9
s_add_u32 s42, s40, 0
s_mul_i32 s43, s42, 13108
s_lshr_b32 s43, s43, 16
s_mul_i32 s35, s43, 5
s_sub_u32 s42, s42, s35
s_lshr_b32 s35, s42, 1
s_lshl_b32 s35, s35, 5
s_and_b32 s36, s42, 1
s_lshl_b32 s36, s36, 2
s_add_u32 s35, s35, s36
s_add_u32 s35, s35, s41
s_cmp_eq_u32 s42, 4
s_cselect_b64 vcc, -1, 0
s_cselect_b32 s36, 8, 16
v_cndmask_b32 v11, v9, v6, vcc
v_add_u32 v11, s35, v11
s_mul_i32 s35, s43, 41472
s_sub_u32 s37, s43, 16
s_mul_i32 s37, s37, 331776
s_cmp_lt_u32 s43, 16
s_cselect_b32 s35, s35, s37
s_cselect_b32 s37, 4, 72
s_cselect_b32 s34, 0, 1
s_mul_i32 s37, s37, 1152
v_mul_lo_u32 v10, s37, v7
v_lshl_add_u32 v11, v11, 1, v10
v_cmp_gt_u32 vcc, s36, v6
s_nop 1
v_cndmask_b32 v11, v12, v11, vcc
s_mul_i32 s42, s34, 18432
s_add_u32 s42, s42, 0
s_add_u32 s42, s42, s35
buffer_load_ushort v52, v11, s[44:47], s42 offen
s_mul_i32 s42, s34, 18432
s_add_u32 s42, s42, 1152
s_add_u32 s42, s42, s35
buffer_load_ushort v53, v11, s[44:47], s42 offen
s_mul_i32 s42, s34, 36864
s_add_u32 s42, s42, 2304
s_add_u32 s42, s42, s35
buffer_load_ushort v54, v11, s[44:47], s42 offen
s_mul_i32 s42, s34, 36864
s_add_u32 s42, s42, 3456
s_add_u32 s42, s42, s35
buffer_load_ushort v55, v11, s[44:47], s42 offen
s_mul_i32 s42, s34, 39168
s_add_u32 s42, s42, 20736
s_add_u32 s42, s42, s35
buffer_load_ushort v56, v11, s[44:47], s42 offen
s_mul_i32 s42, s34, 39168
s_add_u32 s42, s42, 21888
s_add_u32 s42, s42, s35
buffer_load_ushort v57, v11, s[44:47], s42 offen
s_mul_i32 s42, s34, 57600
s_add_u32 s42, s42, 23040
s_add_u32 s42, s42, s35
buffer_load_ushort v58, v11, s[44:47], s42 offen
s_mul_i32 s42, s34, 57600
s_add_u32 s42, s42, 24192
s_add_u32 s42, s42, s35
buffer_load_ushort v59, v11, s[44:47], s42 offen
s_add_u32 s42, s40, 1
s_mul_i32 s43, s42, 13108
s_lshr_b32 s43, s43, 16
s_mul_i32 s35, s43, 5
s_sub_u32 s42, s42, s35
s_lshr_b32 s35, s42, 1
s_lshl_b32 s35, s35, 5
s_and_b32 s36, s42, 1
s_lshl_b32 s36, s36, 2
s_add_u32 s35, s35, s36
s_add_u32 s35, s35, s41
s_cmp_eq_u32 s42, 4
s_cselect_b64 vcc, -1, 0
s_cselect_b32 s36, 8, 16
v_cndmask_b32 v11, v9, v6, vcc
v_add_u32 v11, s35, v11
s_mul_i32 s35, s43, 41472
s_sub_u32 s37, s43, 16
s_mul_i32 s37, s37, 331776
s_cmp_lt_u32 s43, 16
s_cselect_b32 s35, s35, s37
s_cselect_b32 s37, 4, 72
s_cselect_b32 s34, 0, 1
s_mul_i32 s37, s37, 1152
v_mul_lo_u32 v10, s37, v7
v_lshl_add_u32 v11, v11, 1, v10
v_cmp_gt_u32 vcc, s36, v6
s_nop 1
v_cndmask_b32 v11, v12, v11, vcc
s_mul_i32 s42, s34, 18432
s_add_u32 s42, s42, 0
s_add_u32 s42, s42, s35
buffer_load_ushort v60, v11, s[44:47], s42 offen
s_mul_i32 s42, s34, 18432
s_add_u32 s42, s42, 1152
s_add_u32 s42, s42, s35
buffer_load_ushort v61, v11, s[44:47], s42 offen
s_mul_i32 s42, s34, 36864
s_add_u32 s42, s42, 2304
s_add_u32 s42, s42, s35
buffer_load_ushort v62, v11, s[44:47], s42 offen
s_mul_i32 s42, s34, 36864
s_add_u32 s42, s42, 3456
s_add_u32 s42, s42, s35
buffer_load_ushort v63, v11, s[44:47], s42 offen
s_mul_i32 s42, s34, 39168
s_add_u32 s42, s42, 20736
s_add_u32 s42, s42, s35
buffer_load_ushort v64, v11, s[44:47], s42 offen
s_mul_i32 s42, s34, 39168
s_add_u32 s42, s42, 21888
s_add_u32 s42, s42, s35
buffer_load_ushort v65, v11, s[44:47], s42 offen
s_mul_i32 s42, s34, 57600
s_add_u32 s42, s42, 23040
s_add_u32 s42, s42, s35
buffer_load_ushort v66, v11, s[44:47], s42 offen
s_mul_i32 s42, s34, 57600
s_add_u32 s42, s42, 24192
s_add_u32 s42, s42, s35
buffer_load_ushort v67, v11, s[44:47], s42 offen
s_add_u32 s42, s40, 2
s_mul_i32 s43, s42, 13108
s_lshr_b32 s43, s43, 16
s_mul_i32 s35, s43, 5
s_sub_u32 s42, s42, s35
s_lshr_b32 s35, s42, 1
s_lshl_b32 s35, s35, 5
s_and_b32 s36, s42, 1
s_lshl_b32 s36, s36, 2
s_add_u32 s35, s35, s36
s_add_u32 s35, s35, s41
s_cmp_eq_u32 s42, 4
s_cselect_b64 vcc, -1, 0
s_cselect_b32 s36, 8, 16
v_cndmask_b32 v11, v9, v6, vcc
v_add_u32 v11, s35, v11
s_mul_i32 s35, s43, 41472
s_sub_u32 s37, s43, 16
s_mul_i32 s37, s37, 331776
s_cmp_lt_u32 s43, 16
s_cselect_b32 s35, s35, s37
s_cselect_b32 s37, 4, 72
s_cselect_b32 s34, 0, 1
s_mul_i32 s37, s37, 1152
v_mul_lo_u32 v10, s37, v7
v_lshl_add_u32 v11, v11, 1, v10
v_cmp_gt_u32 vcc, s36, v6
s_nop 1
v_cndmask_b32 v11, v12, v11, vcc
s_mul_i32 s42, s34, 18432
s_add_u32 s42, s42, 0
s_add_u32 s42, s42, s35
buffer_load_ushort v68, v11, s[44:47], s42 offen
s_mul_i32 s42, s34, 18432
s_add_u32 s42, s42, 1152
s_add_u32 s42, s42, s35
buffer_load_ushort v69, v11, s[44:47], s42 offen
s_mul_i32 s42, s34, 36864
s_add_u32 s42, s42, 2304
s_add_u32 s42, s42, s35
buffer_load_ushort v70, v11, s[44:47], s42 offen
s_mul_i32 s42, s34, 36864
s_add_u32 s42, s42, 3456
s_add_u32 s42, s42, s35
buffer_load_ushort v71, v11, s[44:47], s42 offen
s_mul_i32 s42, s34, 39168
s_add_u32 s42, s42, 20736
s_add_u32 s42, s42, s35
buffer_load_ushort v72, v11, s[44:47], s42 offen
s_mul_i32 s42, s34, 39168
s_add_u32 s42, s42, 21888
s_add_u32 s42, s42, s35
buffer_load_ushort v73, v11, s[44:47], s42 offen
s_mul_i32 s42, s34, 57600
s_add_u32 s42, s42, 23040
s_add_u32 s42, s42, s35
buffer_load_ushort v74, v11, s[44:47], s42 offen
s_mul_i32 s42, s34, 57600
s_add_u32 s42, s42, 24192
s_add_u32 s42, s42, s35
buffer_load_ushort v75, v11, s[44:47], s42 offen
L_g_done:
s_cmp_ge_u32 s2, 144
s_cbranch_scc1 L_l1_d
s_mul_i32 s40, s2, 911
s_lshr_b32 s40, s40, 16
s_mul_i32 s41, s40, 72
s_sub_u32 s41, s2, s41
s_cmp_eq_u32 s40, 0
s_cselect_b64 s[12:13], s[64:65], s[66:67]
s_mov_b32 s48, s12
s_and_b32 s49, s13, 0xffff
s_mov_b32 s50, 5308416
s_mov_b32 s51, 0x20000
s_lshl_b32 s42, s41, 7
v_lshlrev_b32 v9, 3, v6
v_mul_u32_u24 v10, 73728, v7
v_add3_u32 v254, v9, v10, s42
s_bitcmp1_b32 s4, 0
s_cselect_b64 vcc, -1, 0
v_cndmask_b32 v255, v254, v12, vcc
s_mul_i32 s43, s4, 9
s_add_u32 s43, s43, 1
s_lshr_b32 s43, s43, 1
s_mul_i32 s53, s43, 294912
buffer_load_dwordx2 v[76:77], v254, s[48:51], s53 offen nt
s_add_u32 s53, s53, 9216
buffer_load_dwordx2 v[78:79], v254, s[48:51], s53 offen nt
s_add_u32 s53, s53, 9216
buffer_load_dwordx2 v[80:81], v254, s[48:51], s53 offen nt
s_add_u32 s53, s53, 9216
buffer_load_dwordx2 v[82:83], v254, s[48:51], s53 offen nt
s_add_u32 s53, s53, 9216
buffer_load_dwordx2 v[84:85], v254, s[48:51], s53 offen nt
s_add_u32 s53, s53, 9216
buffer_load_dwordx2 v[86:87], v254, s[48:51], s53 offen nt
s_add_u32 s53, s53, 9216
buffer_load_dwordx2 v[88:89], v254, s[48:51], s53 offen nt
s_add_u32 s53, s53, 9216
buffer_load_dwordx2 v[90:91], v254, s[48:51], s53 offen nt
s_add_u32 s53, s53, 230400
buffer_load_dwordx2 v[92:93], v254, s[48:51], s53 offen nt
s_add_u32 s53, s53, 9216
s_mul_i32 s42, s41, 7282
s_lshr_b32 s42, s42, 16
s_mul_i32 s35, s42, 9
s_sub_u32 s41, s41, s35
s_lshl_b32 s41, s41, 2
s_lshl_b32 s42, s42, 2
s_lshl_b32 s40, s40, 11
s_add_u32 s40, s40, 7303168
s_mov_b32 s35, 497664
v_and_b32 v6, 3, v1
v_add_u32 v6, s41, v6
v_mul_u32_u24 v7, 57, v6
v_lshrrev_b32 v7, 9, v7
v_mul_u32_u24 v8, 9, v7
v_sub_u32 v6, v6, v8
v_add_u32 v8, 1, v6
v_cmp_eq_u32 vcc, 9, v8
s_nop 1
v_cndmask_b32 v8, v8, 0, vcc
v_and_b32 v9, 1, v7
v_cmp_eq_u32 vcc, 0, v9
s_nop 1
v_cndmask_b32 v6, v6, v8, vcc
v_add_u32 v7, s42, v7
v_mul_lo_u32 v7, v7, s35
v_add_u32 v7, s40, v7
v_lshrrev_b32 v8, 2, v1
v_add_u32 v8, s43, v8
v_and_b32 v9, 1, v8
v_lshl_add_u32 v7, v9, 10, v7
v_lshrrev_b32 v9, 1, v8
v_lshlrev_b32 v9, 12, v9
v_add_u32 v7, v7, v9
v_lshl_add_u32 v9, v6, 12, v9
v_mul_u32_u24 v10, 36864, v6
v_cmp_gt_u32 vcc, 2, v6
s_nop 1
v_cndmask_b32 v9, v10, v9, vcc
v_add_u32 v7, v7, v9
v_cmp_gt_u32 vcc, 18, v8
s_nop 1
v_cndmask_b32 v7, v12, v7, vcc
s_bitcmp1_b32 s4, 0
s_cselect_b32 s41, 16, 20
v_cmp_gt_u32 vcc, s41, v1
s_nop 1
v_cndmask_b32 v7, v12, v7, vcc
s_nop 0
v_readlane_b32 s40, v7, 0
v_readlane_b32 s41, v7, 1
v_readlane_b32 s42, v7, 2
v_readlane_b32 s43, v7, 3
v_add_u32 v156, s40, v2
v_add_u32 v157, s41, v2
v_add_u32 v158, s42, v2
v_add_u32 v159, s43, v2
v_readlane_b32 s40, v7, 4
v_readlane_b32 s41, v7, 5
v_readlane_b32 s42, v7, 6
v_readlane_b32 s43, v7, 7
v_add_u32 v160, s40, v2
v_add_u32 v161, s41, v2
v_add_u32 v162, s42, v2
v_add_u32 v163, s43, v2
v_readlane_b32 s40, v7, 8
v_readlane_b32 s41, v7, 9
v_readlane_b32 s42, v7, 10
v_readlane_b32 s43, v7, 11
v_add_u32 v164, s40, v2
v_add_u32 v165, s41, v2
v_add_u32 v166, s42, v2
v_add_u32 v167, s43, v2
v_readlane_b32 s40, v7, 12
v_readlane_b32 s41, v7, 13
v_readlane_b32 s42, v7, 14
v_readlane_b32 s43, v7, 15
v_add_u32 v168, s40, v2
v_add_u32 v169, s41, v2
v_add_u32 v170, s42, v2
v_add_u32 v171, s43, v2
v_readlane_b32 s40, v7, 16
v_readlane_b32 s41, v7, 17
v_readlane_b32 s42, v7, 18
v_readlane_b32 s43, v7, 19
v_add_u32 v172, s40, v2
v_add_u32 v173, s41, v2
v_add_u32 v174, s42, v2
v_add_u32 v175, s43, v2
s_waitcnt vmcnt(33)
s_branch L_l1_e
L_l1_d:
s_cmp_ge_u32 s2, 216
s_cbranch_scc1 L_l1_n
s_mov_b32 s48, s62
s_and_b32 s49, s63, 0xffff
s_mov_b32 s50, 5308416
s_mov_b32 s51, 0x20000
s_sub_u32 s40, s2, 144
s_mul_i32 s53, s40, 73728
s_lshl_b32 s41, s4, 8
s_lshl_b32 s42, s4, 5
v_mul_u32_u24 v10, 18432, v7
v_lshl_add_u32 v9, v6, 3, v10
v_add_u32 v254, s41, v9
v_lshl_add_u32 v9, v6, 1, v10
v_add_u32 v255, s42, v9
s_add_u32 s43, s53, 0
buffer_load_dwordx2 v[76:77], v254, s[48:51], s43 offen offset:0 nt
buffer_load_dwordx2 v[92:93], v254, s[48:51], s43 offen offset:128 nt
buffer_load_ushort v108, v255, s[48:51], s43 offen offset:1024 nt
s_add_u32 s43, s53, 4608
buffer_load_dwordx2 v[78:79], v254, s[48:51], s43 offen offset:0 nt
buffer_load_dwordx2 v[94:95], v254, s[48:51], s43 offen offset:128 nt
buffer_load_ushort v109, v255, s[48:51], s43 offen offset:1024 nt
s_add_u32 s43, s53, 9216
buffer_load_dwordx2 v[80:81], v254, s[48:51], s43 offen offset:0 nt
buffer_load_dwordx2 v[96:97], v254, s[48:51], s43 offen offset:128 nt
buffer_load_ushort v110, v255, s[48:51], s43 offen offset:1024 nt
s_mul_i32 s41, s40, 7282
s_lshr_b32 s41, s41, 16
s_mul_i32 s42, s41, 9
s_sub_u32 s40, s40, s42
s_lshl_b32 s40, s40, 1
s_lshl_b32 s41, s41, 2
s_add_u32 s41, s41, s4
s_mul_i32 s41, s41, 497664
s_add_u32 s41, s41, 7634944
v_cmp_lt_u32 vcc, 8, v1
s_nop 1
v_cndmask_b32 v6, 0, 1, vcc
v_mul_u32_u24 v7, 9, v6
v_sub_u32 v7, v1, v7
v_add_u32 v6, s40, v6
v_mov_b32 v8, 0
v_cmp_lt_u32 vcc, 4, v6
s_nop 1
v_addc_co_u32 v8, vcc, 0, v8, vcc
v_cmp_lt_u32 vcc, 8, v6
s_nop 1
v_addc_co_u32 v8, vcc, 0, v8, vcc
v_cmp_lt_u32 vcc, 13, v6
s_nop 1
v_addc_co_u32 v8, vcc, 0, v8, vcc
v_mul_u32_u24 v9, 9, v8
v_add_u32 v9, 1, v9
v_lshrrev_b32 v9, 1, v9
v_sub_u32 v9, v6, v9
v_subrev_u32 v8, s4, v8
v_and_b32 v8, 3, v8
v_mul_u32_u24 v10, 3, v9
v_add3_u32 v10, v10, v8, 2
v_add_u32 v11, 3, v10
v_cmp_lt_u32 vcc, 1, v9
s_nop 1
v_cndmask_b32 v10, v10, v11, vcc
v_cmp_eq_u32 vcc, 3, v9
s_nop 1
v_cndmask_b32 v9, v9, 11, vcc
v_cmp_eq_u32 vcc, 0, v8
s_nop 1
v_cndmask_b32 v10, v10, v9, vcc
v_cmp_eq_u32 vcc, 4, v6
s_nop 1
v_cndmask_b32 v10, v10, 9, vcc
v_cmp_eq_u32 vcc, 13, v6
s_nop 1
v_cndmask_b32 v10, v10, 10, vcc
v_and_b32 v6, 30, v10
v_and_b32 v8, 1, v10
v_lshl_add_u32 v8, v7, 1, v8
v_lshl_add_u32 v9, v6, 3, v8
v_lshrrev_b32 v11, 2, v7
v_mul_u32_u24 v13, 24, v11
v_lshl_add_u32 v6, v6, 2, v8
v_add3_u32 v6, v6, v13, 40
v_cmp_gt_u32 vcc, 10, v10
s_nop 1
v_cndmask_b32 v9, v6, v9, vcc
v_lshl_add_u32 v6, v7, 2, v10
v_lshl_add_u32 v6, v11, 4, v6
v_add_u32 v6, 82, v6
v_cmp_gt_u32 vcc, 14, v10
s_nop 1
v_cndmask_b32 v9, v6, v9, vcc
v_add_u32 v6, 144, v10
v_add_u32 v11, 96, v10
v_cmp_gt_u32 vcc, 0, v10
s_nop 1
v_cndmask_b32 v6, v6, v11, vcc
v_cmp_eq_u32 vcc, 8, v7
s_nop 1
v_cndmask_b32 v9, v9, v6, vcc
v_lshlrev_b32 v9, 10, v9
v_add_u32 v9, s41, v9
v_cmp_gt_u32 vcc, 18, v1
s_nop 1
v_cndmask_b32 v9, v12, v9, vcc
s_nop 0
v_readlane_b32 s40, v9, 0
v_readlane_b32 s41, v9, 1
v_readlane_b32 s42, v9, 2
v_readlane_b32 s43, v9, 3
v_add_u32 v156, s40, v2
v_add_u32 v157, s41, v2
v_add_u32 v158, s42, v2
v_add_u32 v159, s43, v2
v_readlane_b32 s40, v9, 4
v_readlane_b32 s41, v9, 5
v_readlane_b32 s42, v9, 6
v_readlane_b32 s43, v9, 7
v_add_u32 v160, s40, v2
v_add_u32 v161, s41, v2
v_add_u32 v162, s42, v2
v_add_u32 v163, s43, v2
v_readlane_b32 s40, v9, 8
v_readlane_b32 s41, v9, 9
v_readlane_b32 s42, v9, 10
v_readlane_b32 s43, v9, 11
v_add_u32 v164, s40, v2
v_add_u32 v165, s41, v2
v_add_u32 v166, s42, v2
v_add_u32 v167, s43, v2
v_readlane_b32 s40, v9, 12
v_readlane_b32 s41, v9, 13
v_readlane_b32 s42, v9, 14
v_readlane_b32 s43, v9, 15
v_add_u32 v168, s40, v2
v_add_u32 v169, s41, v2
v_add_u32 v170, s42, v2
v_add_u32 v171, s43, v2
v_readlane_b32 s40, v9, 16
v_readlane_b32 s41, v9, 17
v_readlane_b32 s42, v9, 18
v_readlane_b32 s43, v9, 19
v_add_u32 v172, s40, v2
v_add_u32 v173, s41, v2
v_add_u32 v174, s42, v2
v_add_u32 v175, s43, v2
s_waitcnt vmcnt(33)
s_branch L_l1_e
L_l1_n:
v_mov_b32 v156, v12
v_mov_b32 v157, v12
v_mov_b32 v158, v12
v_mov_b32 v159, v12
v_mov_b32 v160, v12
v_mov_b32 v161, v12
v_mov_b32 v162, v12
v_mov_b32 v163, v12
v_mov_b32 v164, v12
v_mov_b32 v165, v12
v_mov_b32 v166, v12
v_mov_b32 v167, v12
v_mov_b32 v168, v12
v_mov_b32 v169, v12
v_mov_b32 v170, v12
v_mov_b32 v171, v12
v_mov_b32 v172, v12
v_mov_b32 v173, v12
v_mov_b32 v174, v12
v_mov_b32 v175, v12
s_waitcnt vmcnt(24)
L_l1_e:
v_readfirstlane_b32 s40, v14
v_readfirstlane_b32 s41, v15
s_add_u32 s68, s40, 1
s_addc_u32 s69, s41, 0
v_lshlrev_b32 v28, 16, v16
v_and_b32 v29, 0xffff0000, v16
v_lshlrev_b32 v30, 16, v17
v_and_b32 v31, 0xffff0000, v17
v_lshlrev_b32 v32, 16, v18
v_and_b32 v33, 0xffff0000, v18
v_lshlrev_b32 v34, 16, v19
v_and_b32 v35, 0xffff0000, v19
v_lshlrev_b32 v36, 16, v20
v_and_b32 v37, 0xffff0000, v20
v_lshlrev_b32 v38, 16, v21
v_and_b32 v39, 0xffff0000, v21
v_lshlrev_b32 v40, 16, v22
v_and_b32 v41, 0xffff0000, v22
v_lshlrev_b32 v42, 16, v23
v_and_b32 v43, 0xffff0000, v23
v_lshlrev_b32 v44, 16, v24
v_and_b32 v45, 0xffff0000, v24
v_lshlrev_b32 v46, 16, v25
v_and_b32 v47, 0xffff0000, v25
v_lshlrev_b32 v48, 16, v26
v_and_b32 v49, 0xffff0000, v26
v_lshlrev_b32 v50, 16, v27
v_and_b32 v51, 0xffff0000, v27
v_add_f32 v6, v28, v29
v_mul_f32 v7, v28, v28
v_mul_f32 v9, v29, v29
v_mov_b32 v8, 0
v_add_f32 v6, v6, v30
v_add_f32 v8, v8, v31
v_fmac_f32 v7, v30, v30
v_fmac_f32 v9, v31, v31
v_add_f32 v6, v6, v32
v_add_f32 v8, v8, v33
v_fmac_f32 v7, v32, v32
v_fmac_f32 v9, v33, v33
v_add_f32 v6, v6, v34
v_add_f32 v8, v8, v35
v_fmac_f32 v7, v34, v34
v_fmac_f32 v9, v35, v35
v_add_f32 v6, v6, v36
v_add_f32 v8, v8, v37
v_fmac_f32 v7, v36, v36
v_fmac_f32 v9, v37, v37
v_add_f32 v6, v6, v38
v_add_f32 v8, v8, v39
v_fmac_f32 v7, v38, v38
v_fmac_f32 v9, v39, v39
v_add_f32 v6, v6, v40
v_add_f32 v8, v8, v41
v_fmac_f32 v7, v40, v40
v_fmac_f32 v9, v41, v41
v_add_f32 v6, v6, v42
v_add_f32 v8, v8, v43
v_fmac_f32 v7, v42, v42
v_fmac_f32 v9, v43, v43
v_add_f32 v6, v6, v44
v_add_f32 v8, v8, v45
v_fmac_f32 v7, v44, v44
v_fmac_f32 v9, v45, v45
v_add_f32 v6, v6, v46
v_add_f32 v8, v8, v47
v_fmac_f32 v7, v46, v46
v_fmac_f32 v9, v47, v47
v_add_f32 v6, v6, v48
v_add_f32 v8, v8, v49
v_fmac_f32 v7, v48, v48
v_fmac_f32 v9, v49, v49
v_add_f32 v6, v6, v50
v_add_f32 v8, v8, v51
v_fmac_f32 v7, v50, v50
v_fmac_f32 v9, v51, v51
v_add_f32 v6, v6, v8
v_add_f32 v7, v7, v9
s_nop 0
v_add_f32_dpp v6, v6, v6 row_ror:8 row_mask:0xf bank_mask:0xf
v_add_f32_dpp v7, v7, v7 row_ror:8 row_mask:0xf bank_mask:0xf
v_mov_b32 v8, v6
v_mov_b32 v9, v7
s_nop 0
v_permlane16_swap_b32 v6, v8
v_permlane16_swap_b32 v7, v9
v_add_f32 v6, v6, v8
v_add_f32 v7, v7, v9
v_mov_b32 v8, v6
v_mov_b32 v9, v7
s_nop 0
v_permlane32_swap_b32 v6, v8
v_permlane32_swap_b32 v7, v9
v_add_f32 v6, v6, v8
v_add_f32 v7, v7, v9
v_and_b32 v10, 7, v1
v_lshlrev_b32 v10, 3, v10
v_add_u32 v10, 147456, v10
s_lshl_b32 s24, s4, 6
v_add_u32 v11, s24, v10
ds_write_b64 v11, v[6:7]
s_add_u32 s24, s28, 27979776
buffer_store_dwordx4 v[16:19], v4, s[8:11], s24 offen sc1
s_add_u32 s25, s29, 27979776
buffer_store_dwordx4 v[20:23], v4, s[8:11], s25 offen sc1
s_add_u32 s24, s30, 27979776
buffer_store_dwordx4 v[24:27], v4, s[8:11], s24 offen sc1
s_waitcnt lgkmcnt(0)
s_barrier
ds_read_b64 v[6:7], v10
ds_read_b64 v[8:9], v10 offset:64
ds_read_b64 v[12:13], v10 offset:128
s_waitcnt lgkmcnt(0)
v_add_f32 v6, v6, v8
v_add_f32 v7, v7, v9
v_add_f32 v6, v6, v12
v_add_f32 v7, v7, v13
v_mul_f32 v6, 0x3ae38e39, v6
v_mul_f32 v7, 0x3ae38e39, v7
v_fma_f32 v7, -v6, v6, v7
v_max_f32 v7, 0, v7
v_add_f32 v7, 0x3727c5ac, v7
v_rsq_f32 v7, v7
s_nop 0
v_mul_f32 v6, v6, v7
v_fma_f32 v28, v28, v7, -v6
v_fma_f32 v29, v29, v7, -v6
v_fma_f32 v30, v30, v7, -v6
v_fma_f32 v31, v31, v7, -v6
v_fma_f32 v32, v32, v7, -v6
v_fma_f32 v33, v33, v7, -v6
v_fma_f32 v34, v34, v7, -v6
v_fma_f32 v35, v35, v7, -v6
v_cvt_pk_bf16_f32 v16, v28, v29
v_cvt_pk_bf16_f32 v17, v30, v31
v_cvt_pk_bf16_f32 v18, v32, v33
v_cvt_pk_bf16_f32 v19, v34, v35
s_add_u32 s24, s28, 23261184
buffer_store_dwordx4 v[16:19], v4, s[8:11], s24 offen sc1
v_fma_f32 v36, v36, v7, -v6
v_fma_f32 v37, v37, v7, -v6
v_fma_f32 v38, v38, v7, -v6
v_fma_f32 v39, v39, v7, -v6
v_fma_f32 v40, v40, v7, -v6
v_fma_f32 v41, v41, v7, -v6
v_fma_f32 v42, v42, v7, -v6
v_fma_f32 v43, v43, v7, -v6
v_cvt_pk_bf16_f32 v20, v36, v37
v_cvt_pk_bf16_f32 v21, v38, v39
v_cvt_pk_bf16_f32 v22, v40, v41
v_cvt_pk_bf16_f32 v23, v42, v43
s_add_u32 s25, s29, 23261184
buffer_store_dwordx4 v[20:23], v4, s[8:11], s25 offen sc1
v_fma_f32 v44, v44, v7, -v6
v_fma_f32 v45, v45, v7, -v6
v_fma_f32 v46, v46, v7, -v6
v_fma_f32 v47, v47, v7, -v6
v_fma_f32 v48, v48, v7, -v6
v_fma_f32 v49, v49, v7, -v6
v_fma_f32 v50, v50, v7, -v6
v_fma_f32 v51, v51, v7, -v6
v_cvt_pk_bf16_f32 v24, v44, v45
v_cvt_pk_bf16_f32 v25, v46, v47
v_cvt_pk_bf16_f32 v26, v48, v49
v_cvt_pk_bf16_f32 v27, v50, v51
s_add_u32 s24, s30, 23261184
buffer_store_dwordx4 v[24:27], v4, s[8:11], s24 offen sc1
s_lshl_b32 s24, s5, 5
s_add_u32 s24, s24, s6
s_lshl_b32 s14, s24, 7
s_add_u32 s14, s14, 786432
s_waitcnt vmcnt(6)
v_lshl_or_b32 v52, v53, 16, v52
v_lshl_or_b32 v53, v55, 16, v54
v_lshl_or_b32 v54, v57, 16, v56
v_lshl_or_b32 v55, v59, 16, v58
buffer_store_dwordx4 v[52:55], v2, s[8:11], s38 offen offset:0 sc1
v_lshl_or_b32 v60, v61, 16, v60
v_lshl_or_b32 v61, v63, 16, v62
v_lshl_or_b32 v62, v65, 16, v64
v_lshl_or_b32 v63, v67, 16, v66
buffer_store_dwordx4 v[60:63], v2, s[8:11], s38 offen offset:1024 sc1
v_lshl_or_b32 v68, v69, 16, v68
v_lshl_or_b32 v69, v71, 16, v70
v_lshl_or_b32 v70, v73, 16, v72
v_lshl_or_b32 v71, v75, 16, v74
buffer_store_dwordx4 v[68:71], v2, s[8:11], s38 offen offset:2048 sc1
v_mov_b32 v13, 2146435072
v_cmp_gt_u32 vcc, 16, v0
v_lshlrev_b32 v14, 3, v0
s_nop 0
v_cndmask_b32 v13, v13, v14, vcc
v_mov_b32 v14, s68
v_mov_b32 v15, s69
s_waitcnt vmcnt(0)
s_barrier
buffer_store_dwordx2 v[14:15], v13, s[8:11], s14 offen sc1
s_mov_b32 s44, s54
s_and_b32 s45, s55, 0xffff
s_mov_b32 s46, 256
s_mov_b32 s47, 0x20000
v_mov_b32 v3, 1
v_mov_b32 v13, 2146435072
v_cmp_eq_u32 vcc, 0, v0
s_nop 1
v_cndmask_b32 v13, v13, 0, vcc
buffer_atomic_add v3, v13, s[44:47], 0 offen sc1
s_cmp_ge_u32 s2, 144
s_cbranch_scc1 L_l2_d
buffer_load_dwordx2 v[94:95], v254, s[48:51], s53 offen nt
s_add_u32 s53, s53, 9216
buffer_load_dwordx2 v[96:97], v254, s[48:51], s53 offen nt
s_add_u32 s53, s53, 9216
buffer_load_dwordx2 v[98:99], v254, s[48:51], s53 offen nt
s_add_u32 s53, s53, 9216
buffer_load_dwordx2 v[100:101], v254, s[48:51], s53 offen nt
s_add_u32 s53, s53, 9216
buffer_load_dwordx2 v[102:103], v254, s[48:51], s53 offen nt
s_add_u32 s53, s53, 9216
buffer_load_dwordx2 v[104:105], v254, s[48:51], s53 offen nt
s_add_u32 s53, s53, 9216
buffer_load_dwordx2 v[106:107], v254, s[48:51], s53 offen nt
s_add_u32 s53, s53, 230400
buffer_load_dwordx2 v[108:109], v254, s[48:51], s53 offen nt
s_add_u32 s53, s53, 9216
buffer_load_dwordx2 v[110:111], v254, s[48:51], s53 offen nt
s_add_u32 s53, s53, 9216
buffer_load_dwordx2 v[112:113], v254, s[48:51], s53 offen nt
s_add_u32 s53, s53, 9216
buffer_load_dwordx2 v[114:115], v254, s[48:51], s53 offen nt
s_add_u32 s53, s53, 9216
buffer_load_dwordx2 v[116:117], v254, s[48:51], s53 offen nt
s_add_u32 s53, s53, 9216
buffer_load_dwordx2 v[118:119], v254, s[48:51], s53 offen nt
s_add_u32 s53, s53, 9216
buffer_load_dwordx2 v[120:121], v254, s[48:51], s53 offen nt
s_add_u32 s53, s53, 9216
buffer_load_dwordx2 v[122:123], v254, s[48:51], s53 offen nt
s_add_u32 s53, s53, 230400
buffer_load_dwordx2 v[124:125], v254, s[48:51], s53 offen nt
s_add_u32 s53, s53, 9216
buffer_load_dwordx2 v[126:127], v254, s[48:51], s53 offen nt
s_add_u32 s53, s53, 9216
buffer_load_dwordx2 v[128:129], v254, s[48:51], s53 offen nt
s_add_u32 s53, s53, 9216
buffer_load_dwordx2 v[130:131], v254, s[48:51], s53 offen nt
s_add_u32 s53, s53, 9216
buffer_load_dwordx2 v[132:133], v254, s[48:51], s53 offen nt
s_add_u32 s53, s53, 9216
buffer_load_dwordx2 v[134:135], v254, s[48:51], s53 offen nt
s_add_u32 s53, s53, 9216
buffer_load_dwordx2 v[136:137], v254, s[48:51], s53 offen nt
s_add_u32 s53, s53, 9216
buffer_load_dwordx2 v[138:139], v254, s[48:51], s53 offen nt
s_add_u32 s53, s53, 230400
buffer_load_dwordx2 v[140:141], v255, s[48:51], s53 offen nt
s_add_u32 s53, s53, 9216
buffer_load_dwordx2 v[142:143], v255, s[48:51], s53 offen nt
s_add_u32 s53, s53, 9216
buffer_load_dwordx2 v[144:145], v255, s[48:51], s53 offen nt
s_add_u32 s53, s53, 9216
buffer_load_dwordx2 v[146:147], v255, s[48:51], s53 offen nt
s_add_u32 s53, s53, 9216
buffer_load_dwordx2 v[148:149], v255, s[48:51], s53 offen nt
s_add_u32 s53, s53, 9216
buffer_load_dwordx2 v[150:151], v255, s[48:51], s53 offen nt
s_add_u32 s53, s53, 9216
buffer_load_dwordx2 v[152:153], v255, s[48:51], s53 offen nt
s_add_u32 s53, s53, 9216
buffer_load_dwordx2 v[154:155], v255, s[48:51], s53 offen nt
s_add_u32 s53, s53, 230400
s_branch L_l2_e
L_l2_d:
s_cmp_ge_u32 s2, 216
s_cbranch_scc1 L_l2_n
s_add_u32 s43, s53, 13824
buffer_load_dwordx2 v[82:83], v254, s[48:51], s43 offen offset:0 nt
buffer_load_dwordx2 v[98:99], v254, s[48:51], s43 offen offset:128 nt
buffer_load_ushort v111, v255, s[48:51], s43 offen offset:1024 nt
s_add_u32 s43, s53, 1152
buffer_load_dwordx2 v[84:85], v254, s[48:51], s43 offen offset:0 nt
buffer_load_dwordx2 v[100:101], v254, s[48:51], s43 offen offset:128 nt
buffer_load_ushort v112, v255, s[48:51], s43 offen offset:1024 nt
s_add_u32 s43, s53, 5760
buffer_load_dwordx2 v[86:87], v254, s[48:51], s43 offen offset:0 nt
buffer_load_dwordx2 v[102:103], v254, s[48:51], s43 offen offset:128 nt
buffer_load_ushort v113, v255, s[48:51], s43 offen offset:1024 nt
s_add_u32 s43, s53, 10368
buffer_load_dwordx2 v[88:89], v254, s[48:51], s43 offen offset:0 nt
buffer_load_dwordx2 v[104:105], v254, s[48:51], s43 offen offset:128 nt
buffer_load_ushort v114, v255, s[48:51], s43 offen offset:1024 nt
s_add_u32 s43, s53, 14976
buffer_load_dwordx2 v[90:91], v254, s[48:51], s43 offen offset:0 nt
buffer_load_dwordx2 v[106:107], v254, s[48:51], s43 offen offset:128 nt
buffer_load_ushort v115, v255, s[48:51], s43 offen offset:1024 nt
s_add_u32 s43, s53, 2304
buffer_load_dwordx2 v[116:117], v254, s[48:51], s43 offen offset:0 nt
buffer_load_dwordx2 v[132:133], v254, s[48:51], s43 offen offset:128 nt
buffer_load_ushort v148, v255, s[48:51], s43 offen offset:1024 nt
s_add_u32 s43, s53, 6912
buffer_load_dwordx2 v[118:119], v254, s[48:51], s43 offen offset:0 nt
buffer_load_dwordx2 v[134:135], v254, s[48:51], s43 offen offset:128 nt
buffer_load_ushort v149, v255, s[48:51], s43 offen offset:1024 nt
s_add_u32 s43, s53, 11520
buffer_load_dwordx2 v[120:121], v254, s[48:51], s43 offen offset:0 nt
buffer_load_dwordx2 v[136:137], v254, s[48:51], s43 offen offset:128 nt
buffer_load_ushort v150, v255, s[48:51], s43 offen offset:1024 nt
s_add_u32 s43, s53, 16128
buffer_load_dwordx2 v[122:123], v254, s[48:51], s43 offen offset:0 nt
buffer_load_dwordx2 v[138:139], v254, s[48:51], s43 offen offset:128 nt
buffer_load_ushort v151, v255, s[48:51], s43 offen offset:1024 nt
s_add_u32 s43, s53, 3456
buffer_load_dwordx2 v[124:125], v254, s[48:51], s43 offen offset:0 nt
buffer_load_dwordx2 v[140:141], v254, s[48:51], s43 offen offset:128 nt
buffer_load_ushort v152, v255, s[48:51], s43 offen offset:1024 nt
s_add_u32 s43, s53, 8064
buffer_load_dwordx2 v[126:127], v254, s[48:51], s43 offen offset:0 nt
buffer_load_dwordx2 v[142:143], v254, s[48:51], s43 offen offset:128 nt
buffer_load_ushort v153, v255, s[48:51], s43 offen offset:1024 nt
s_add_u32 s43, s53, 12672
buffer_load_dwordx2 v[128:129], v254, s[48:51], s43 offen offset:0 nt
buffer_load_dwordx2 v[144:145], v254, s[48:51], s43 offen offset:128 nt
buffer_load_ushort v154, v255, s[48:51], s43 offen offset:1024 nt
s_add_u32 s43, s53, 17280
buffer_load_dwordx2 v[130:131], v254, s[48:51], s43 offen offset:0 nt
buffer_load_dwordx2 v[146:147], v254, s[48:51], s43 offen offset:128 nt
buffer_load_ushort v155, v255, s[48:51], s43 offen offset:1024 nt
L_l2_n:
L_l2_e:
s_mov_b32 s70, 23261184
s_mov_b32 s71, 27979776
s_mov_b32 s72, 32698368
s_mov_b32 s73, 37416960
s_mov_b32 s74, 42135552
s_mov_b32 s75, 42397696
s_mov_b32 s76, 80146432
s_mov_b32 s77, 0
s_mov_b32 s7, 0
s_lshr_b32 s20, s5, 2
s_lshl_b32 s20, s20, 3
s_lshr_b32 s21, s6, 2
s_add_u32 s20, s20, s21
s_and_b32 s21, s5, 3
s_lshl_b32 s21, s21, 2
s_and_b32 s22, s6, 3
s_add_u32 s21, s21, s22
s_lshl_b32 s24, s20, 3
s_sub_u32 s25, s24, 1
s_max_i32 s35, s25, 0
s_mul_i32 s25, s35, 18432
s_lshl_b32 s26, s4, 1
s_add_u32 s36, s24, s26
s_mul_i32 s24, s36, 18432
s_add_u32 s26, s24, s70
s_add_u32 s27, s26, 18432
s_add_u32 s28, s25, s70
v_add_u32 v4, 0x10000, v2
v_add_u32 v5, 0x20000, v2
s_cmp_eq_u32 s4, 3
s_cselect_b32 s29, 0, s4
s_cselect_b32 s31, 16, 9
s_lshl_b32 s30, s29, 10
v_and_b32 v12, 15, v1
v_mov_b32 v13, 2146435072
v_cmp_le_u32 vcc, s31, v12
s_nop 1
v_cndmask_b32 v3, v13, v2, vcc
s_add_u32 s31, s30, 2048
v_add_u32 v6, s31, v2
v_add_u32 v7, s31, v4
v_add_u32 v8, s31, v5
s_add_u32 s31, s30, 5120
v_add_u32 v9, s31, v2
v_add_u32 v10, s31, v4
v_add_u32 v11, s31, v5
s_lshl_b32 s22, s36, 1
s_lshl_b32 s23, s35, 1
s_add_u32 s23, s23, 1
v_and_b32 v16, 3, v1
v_add_u32 v16, s22, v16
v_mov_b32 v17, s23
v_cmp_eq_u32 vcc, 4, v1
s_nop 1
v_cndmask_b32 v16, v16, v17, vcc
s_lshr_b32 s22, s21, 1
s_lshl_b32 s22, s22, 5
s_and_b32 s23, s21, 1
s_mul_i32 s23, s23, 12
s_add_u32 s22, s22, s23
s_sub_u32 s22, s22, 8
v_add_u32 v17, s22, v1
v_subrev_u32 v14, 8, v1
v_cmp_gt_u32 vcc, 12, v14
s_nop 1
v_cndmask_b32 v16, v16, v17, vcc
s_and_b32 s22, s6, 7
s_lshl_b32 s22, s22, 5
v_add_u32 v17, s22, v1
v_subrev_u32 v14, 24, v1
v_cmp_gt_u32 vcc, 8, v14
s_nop 1
v_cndmask_b32 v16, v16, v17, vcc
v_lshlrev_b32 v16, 7, v16
s_add_u32 s22, s77, 786432
s_mov_b32 s52, 0
L_poll1:
buffer_load_dwordx2 v[14:15], v16, s[8:11], s22 offen sc1
s_add_u32 s52, s52, 1
s_waitcnt vmcnt(0)
v_cmp_ne_u64 vcc, s[68:69], v[14:15]
s_cmp_ge_u32 s52, 1048576
s_cbranch_scc1 L_got1
s_and_b64 exec, exec, vcc
s_cbranch_execnz L_poll1
L_got1:
s_mov_b64 exec, -1
s_lshr_b32 s20, s5, 2
s_lshl_b32 s20, s20, 3
s_lshr_b32 s21, s6, 2
s_add_u32 s20, s20, s21
s_and_b32 s21, s5, 3
s_lshl_b32 s21, s21, 2
s_and_b32 s22, s6, 3
s_add_u32 s21, s21, s22
s_mul_i32 s32, s21, 147456
s_add_u32 s32, s32, 4198400
s_mul_i32 s33, s4, 36864
s_add_u32 s32, s32, s33
s_mov_b32 s34, 0x05040100
s_mov_b32 s37, s35
s_mov_b32 s35, 0x07060302
s_mov_b32 s38, 0x00003f80
s_mov_b32 s39, 0x3f800000
v_mov_b32 v20, 0
v_mov_b32 v21, 0
v_mov_b32 v22, 0
v_mov_b32 v23, 0
s_cmp_ge_u32 s2, 144
s_cbranch_scc1 L_tr_d
v_mov_b32 v68, 0x3f803f80
v_mov_b32 v69, 0x3f803f80
s_add_u32 m0, s33, 0
s_add_u32 s40, s32, 0
buffer_load_dwordx4 v2, s[8:11], s40 offen offset:0 sc1 lds
v_mov_b32 v70, 0x3f803f80
v_mov_b32 v71, 0x3f803f80
v_perm_b32 v176, v78, v76, s34
v_perm_b32 v177, v82, v80, s34
v_perm_b32 v178, v86, v84, s34
v_perm_b32 v179, v90, v88, s34
buffer_load_dwordx4 v2, s[8:11], s40 offen offset:1024 sc1 lds
v_perm_b32 v180, v78, v76, s35
v_perm_b32 v181, v82, v80, s35
v_perm_b32 v182, v86, v84, s35
v_perm_b32 v183, v90, v88, s35
v_perm_b32 v184, v79, v77, s34
v_perm_b32 v185, v83, v81, s34
buffer_load_dwordx4 v2, s[8:11], s40 offen offset:2048 sc1 lds
v_perm_b32 v186, v87, v85, s34
v_perm_b32 v187, v91, v89, s34
v_perm_b32 v188, v79, v77, s35
v_perm_b32 v189, v83, v81, s35
v_perm_b32 v190, v87, v85, s35
v_perm_b32 v191, v91, v89, s35
buffer_load_dwordx4 v2, s[8:11], s40 offen offset:3072 sc1 lds
v_perm_b32 v192, v94, v92, s34
v_perm_b32 v193, v98, v96, s34
v_perm_b32 v194, v102, v100, s34
v_perm_b32 v195, v106, v104, s34
v_perm_b32 v196, v94, v92, s35
v_perm_b32 v197, v98, v96, s35
s_add_u32 m0, s33, 4096
s_add_u32 s40, s32, 4096
buffer_load_dwordx4 v2, s[8:11], s40 offen offset:0 sc1 lds
v_perm_b32 v198, v102, v100, s35
v_perm_b32 v199, v106, v104, s35
v_perm_b32 v200, v95, v93, s34
v_perm_b32 v201, v99, v97, s34
v_perm_b32 v202, v103, v101, s34
v_perm_b32 v203, v107, v105, s34
buffer_load_dwordx4 v2, s[8:11], s40 offen offset:1024 sc1 lds
v_perm_b32 v204, v95, v93, s35
v_perm_b32 v205, v99, v97, s35
v_perm_b32 v206, v103, v101, s35
v_perm_b32 v207, v107, v105, s35
v_perm_b32 v208, v110, v108, s34
v_perm_b32 v209, v114, v112, s34
buffer_load_dwordx4 v2, s[8:11], s40 offen offset:2048 sc1 lds
v_perm_b32 v210, v118, v116, s34
v_perm_b32 v211, v122, v120, s34
v_perm_b32 v212, v110, v108, s35
v_perm_b32 v213, v114, v112, s35
v_perm_b32 v214, v118, v116, s35
v_perm_b32 v215, v122, v120, s35
buffer_load_dwordx4 v2, s[8:11], s40 offen offset:3072 sc1 lds
v_perm_b32 v216, v111, v109, s34
v_perm_b32 v217, v115, v113, s34
v_perm_b32 v218, v119, v117, s34
v_perm_b32 v219, v123, v121, s34
v_perm_b32 v220, v111, v109, s35
v_perm_b32 v221, v115, v113, s35
s_add_u32 m0, s33, 8192
s_add_u32 s40, s32, 8192
buffer_load_dwordx4 v2, s[8:11], s40 offen offset:0 sc1 lds
v_perm_b32 v222, v119, v117, s35
v_perm_b32 v223, v123, v121, s35
v_perm_b32 v224, v126, v124, s34
v_perm_b32 v225, v130, v128, s34
v_perm_b32 v226, v134, v132, s34
v_perm_b32 v227, v138, v136, s34
buffer_load_dwordx4 v2, s[8:11], s40 offen offset:1024 sc1 lds
v_perm_b32 v228, v126, v124, s35
v_perm_b32 v229, v130, v128, s35
v_perm_b32 v230, v134, v132, s35
v_perm_b32 v231, v138, v136, s35
v_perm_b32 v232, v127, v125, s34
v_perm_b32 v233, v131, v129, s34
buffer_load_dwordx4 v2, s[8:11], s40 offen offset:2048 sc1 lds
v_perm_b32 v234, v135, v133, s34
v_perm_b32 v235, v139, v137, s34
v_perm_b32 v236, v127, v125, s35
v_perm_b32 v237, v131, v129, s35
v_perm_b32 v238, v135, v133, s35
v_perm_b32 v239, v139, v137, s35
buffer_load_dwordx4 v2, s[8:11], s40 offen offset:3072 sc1 lds
v_perm_b32 v240, v142, v140, s34
v_perm_b32 v241, v146, v144, s34
v_perm_b32 v242, v150, v148, s34
v_perm_b32 v243, v154, v152, s34
v_perm_b32 v244, v142, v140, s35
v_perm_b32 v245, v146, v144, s35
s_add_u32 m0, s33, 12288
s_add_u32 s40, s32, 12288
buffer_load_dwordx4 v2, s[8:11], s40 offen offset:0 sc1 lds
v_perm_b32 v246, v150, v148, s35
v_perm_b32 v247, v154, v152, s35
v_perm_b32 v248, v143, v141, s34
v_perm_b32 v249, v147, v145, s34
v_perm_b32 v250, v151, v149, s34
v_perm_b32 v251, v155, v153, s34
buffer_load_dwordx4 v2, s[8:11], s40 offen offset:1024 sc1 lds
v_perm_b32 v252, v143, v141, s35
v_perm_b32 v253, v147, v145, s35
v_perm_b32 v254, v151, v149, s35
v_perm_b32 v255, v155, v153, s35
v_mfma_f32_16x16x32_bf16 v[52:55], v[68:71], v[176:179], 0
v_mfma_f32_16x16x32_bf16 v[56:59], v[68:71], v[180:183], 0
buffer_load_dwordx4 v2, s[8:11], s40 offen offset:2048 sc1 lds
v_mfma_f32_16x16x32_bf16 v[60:63], v[68:71], v[184:187], 0
v_mfma_f32_16x16x32_bf16 v[64:67], v[68:71], v[188:191], 0
v_mfma_f32_16x16x32_bf16 v[52:55], v[68:71], v[192:195], v[52:55]
v_mfma_f32_16x16x32_bf16 v[56:59], v[68:71], v[196:199], v[56:59]
v_mfma_f32_16x16x32_bf16 v[60:63], v[68:71], v[200:203], v[60:63]
v_mfma_f32_16x16x32_bf16 v[64:67], v[68:71], v[204:207], v[64:67]
buffer_load_dwordx4 v2, s[8:11], s40 offen offset:3072 sc1 lds
v_mfma_f32_16x16x32_bf16 v[52:55], v[68:71], v[208:211], v[52:55]
v_mfma_f32_16x16x32_bf16 v[56:59], v[68:71], v[212:215], v[56:59]
v_mfma_f32_16x16x32_bf16 v[60:63], v[68:71], v[216:219], v[60:63]
v_mfma_f32_16x16x32_bf16 v[64:67], v[68:71], v[220:223], v[64:67]
v_mfma_f32_16x16x32_bf16 v[52:55], v[68:71], v[224:227], v[52:55]
v_mfma_f32_16x16x32_bf16 v[56:59], v[68:71], v[228:231], v[56:59]
s_add_u32 m0, s33, 16384
s_add_u32 s40, s32, 16384
buffer_load_dwordx4 v2, s[8:11], s40 offen offset:0 sc1 lds
v_mfma_f32_16x16x32_bf16 v[60:63], v[68:71], v[232:235], v[60:63]
v_mfma_f32_16x16x32_bf16 v[64:67], v[68:71], v[236:239], v[64:67]
v_mfma_f32_16x16x32_bf16 v[52:55], v[68:71], v[240:243], v[52:55]
v_mfma_f32_16x16x32_bf16 v[56:59], v[68:71], v[244:247], v[56:59]
v_mfma_f32_16x16x32_bf16 v[60:63], v[68:71], v[248:251], v[60:63]
v_mfma_f32_16x16x32_bf16 v[64:67], v[68:71], v[252:255], v[64:67]
buffer_load_dwordx4 v2, s[8:11], s40 offen offset:1024 sc1 lds
v_and_b32 v72, 15, v1
v_lshlrev_b32 v72, 4, v72
v_add_u32 v72, 159744, v72
s_lshl_b32 s44, s4, 2
v_add_u32 v73, s44, v72
ds_write_b32 v73, v52 offset:0
buffer_load_dwordx4 v2, s[8:11], s40 offen offset:2048 sc1 lds
ds_write_b32 v73, v56 offset:256
ds_write_b32 v73, v60 offset:512
ds_write_b32 v73, v64 offset:768
s_waitcnt lgkmcnt(0)
s_barrier
ds_read_b128 v[52:55], v72 offset:0
buffer_load_dwordx4 v2, s[8:11], s40 offen offset:3072 sc1 lds
ds_read_b128 v[56:59], v72 offset:256
ds_read_b128 v[60:63], v72 offset:512
ds_read_b128 v[64:67], v72 offset:768
s_waitcnt lgkmcnt(0)
v_add_f32 v52, v52, v53
v_add_f32 v54, v54, v55
s_add_u32 m0, s33, 20480
s_add_u32 s40, s32, 20480
buffer_load_dwordx4 v2, s[8:11], s40 offen offset:0 sc1 lds
v_add_f32 v56, v56, v57
v_add_f32 v58, v58, v59
v_add_f32 v60, v60, v61
v_add_f32 v62, v62, v63
v_add_f32 v64, v64, v65
v_add_f32 v66, v66, v67
buffer_load_dwordx4 v2, s[8:11], s40 offen offset:1024 sc1 lds
v_add_f32 v52, v52, v54
v_add_f32 v56, v56, v58
v_add_f32 v60, v60, v62
v_add_f32 v64, v64, v66
v_mul_f32 v20, 0xbae38e39, v52
v_mul_f32 v21, 0xbae38e39, v56
buffer_load_dwordx4 v2, s[8:11], s40 offen offset:2048 sc1 lds
v_mul_f32 v22, 0xbae38e39, v60
v_mul_f32 v23, 0xbae38e39, v64
v_dot2_f32_bf16 v24, v176, s38, v20
v_dot2_f32_bf16 v25, v176, s39, v20
v_dot2_f32_bf16 v26, v177, s38, v20
v_dot2_f32_bf16 v27, v177, s39, v20
buffer_load_dwordx4 v2, s[8:11], s40 offen offset:3072 sc1 lds
v_dot2_f32_bf16 v28, v178, s38, v20
v_dot2_f32_bf16 v29, v178, s39, v20
v_dot2_f32_bf16 v30, v179, s38, v20
v_dot2_f32_bf16 v31, v179, s39, v20
v_cvt_pk_bf16_f32 v176, v24, v25
v_cvt_pk_bf16_f32 v177, v26, v27
s_add_u32 m0, s33, 24576
s_add_u32 s40, s32, 24576
buffer_load_dwordx4 v2, s[8:11], s40 offen offset:0 sc1 lds
v_cvt_pk_bf16_f32 v178, v28, v29
v_cvt_pk_bf16_f32 v179, v30, v31
v_dot2_f32_bf16 v24, v180, s38, v21
v_dot2_f32_bf16 v25, v180, s39, v21
v_dot2_f32_bf16 v26, v181, s38, v21
v_dot2_f32_bf16 v27, v181, s39, v21
buffer_load_dwordx4 v2, s[8:11], s40 offen offset:1024 sc1 lds
v_dot2_f32_bf16 v28, v182, s38, v21
v_dot2_f32_bf16 v29, v182, s39, v21
v_dot2_f32_bf16 v30, v183, s38, v21
v_dot2_f32_bf16 v31, v183, s39, v21
v_cvt_pk_bf16_f32 v180, v24, v25
v_cvt_pk_bf16_f32 v181, v26, v27
buffer_load_dwordx4 v2, s[8:11], s40 offen offset:2048 sc1 lds
v_cvt_pk_bf16_f32 v182, v28, v29
v_cvt_pk_bf16_f32 v183, v30, v31
v_dot2_f32_bf16 v24, v184, s38, v22
v_dot2_f32_bf16 v25, v184, s39, v22
v_dot2_f32_bf16 v26, v185, s38, v22
v_dot2_f32_bf16 v27, v185, s39, v22
buffer_load_dwordx4 v2, s[8:11], s40 offen offset:3072 sc1 lds
v_dot2_f32_bf16 v28, v186, s38, v22
v_dot2_f32_bf16 v29, v186, s39, v22
v_dot2_f32_bf16 v30, v187, s38, v22
v_dot2_f32_bf16 v31, v187, s39, v22
v_cvt_pk_bf16_f32 v184, v24, v25
v_cvt_pk_bf16_f32 v185, v26, v27
s_add_u32 m0, s33, 28672
s_add_u32 s40, s32, 28672
buffer_load_dwordx4 v2, s[8:11], s40 offen offset:0 sc1 lds
v_cvt_pk_bf16_f32 v186, v28, v29
v_cvt_pk_bf16_f32 v187, v30, v31
v_dot2_f32_bf16 v24, v188, s38, v23
v_dot2_f32_bf16 v25, v188, s39, v23
v_dot2_f32_bf16 v26, v189, s38, v23
v_dot2_f32_bf16 v27, v189, s39, v23
buffer_load_dwordx4 v2, s[8:11], s40 offen offset:1024 sc1 lds
v_dot2_f32_bf16 v28, v190, s38, v23
v_dot2_f32_bf16 v29, v190, s39, v23
v_dot2_f32_bf16 v30, v191, s38, v23
v_dot2_f32_bf16 v31, v191, s39, v23
v_cvt_pk_bf16_f32 v188, v24, v25
v_cvt_pk_bf16_f32 v189, v26, v27
buffer_load_dwordx4 v2, s[8:11], s40 offen offset:2048 sc1 lds
v_cvt_pk_bf16_f32 v190, v28, v29
v_cvt_pk_bf16_f32 v191, v30, v31
v_dot2_f32_bf16 v24, v192, s38, v20
v_dot2_f32_bf16 v25, v192, s39, v20
v_dot2_f32_bf16 v26, v193, s38, v20
v_dot2_f32_bf16 v27, v193, s39, v20
buffer_load_dwordx4 v2, s[8:11], s40 offen offset:3072 sc1 lds
v_dot2_f32_bf16 v28, v194, s38, v20
v_dot2_f32_bf16 v29, v194, s39, v20
v_dot2_f32_bf16 v30, v195, s38, v20
v_dot2_f32_bf16 v31, v195, s39, v20
v_cvt_pk_bf16_f32 v192, v24, v25
v_cvt_pk_bf16_f32 v193, v26, v27
s_add_u32 m0, s33, 32768
s_add_u32 s40, s32, 32768
buffer_load_dwordx4 v2, s[8:11], s40 offen offset:0 sc1 lds
v_cvt_pk_bf16_f32 v194, v28, v29
v_cvt_pk_bf16_f32 v195, v30, v31
v_dot2_f32_bf16 v24, v196, s38, v21
v_dot2_f32_bf16 v25, v196, s39, v21
v_dot2_f32_bf16 v26, v197, s38, v21
v_dot2_f32_bf16 v27, v197, s39, v21
buffer_load_dwordx4 v2, s[8:11], s40 offen offset:1024 sc1 lds
v_dot2_f32_bf16 v28, v198, s38, v21
v_dot2_f32_bf16 v29, v198, s39, v21
v_dot2_f32_bf16 v30, v199, s38, v21
v_dot2_f32_bf16 v31, v199, s39, v21
v_cvt_pk_bf16_f32 v196, v24, v25
v_cvt_pk_bf16_f32 v197, v26, v27
buffer_load_dwordx4 v2, s[8:11], s40 offen offset:2048 sc1 lds
v_cvt_pk_bf16_f32 v198, v28, v29
v_cvt_pk_bf16_f32 v199, v30, v31
v_dot2_f32_bf16 v24, v200, s38, v22
v_dot2_f32_bf16 v25, v200, s39, v22
v_dot2_f32_bf16 v26, v201, s38, v22
v_dot2_f32_bf16 v27, v201, s39, v22
buffer_load_dwordx4 v2, s[8:11], s40 offen offset:3072 sc1 lds
v_dot2_f32_bf16 v28, v202, s38, v22
v_dot2_f32_bf16 v29, v202, s39, v22
v_dot2_f32_bf16 v30, v203, s38, v22
v_dot2_f32_bf16 v31, v203, s39, v22
v_cvt_pk_bf16_f32 v200, v24, v25
v_cvt_pk_bf16_f32 v201, v26, v27
v_cvt_pk_bf16_f32 v202, v28, v29
v_cvt_pk_bf16_f32 v203, v30, v31
v_dot2_f32_bf16 v24, v204, s38, v23
v_dot2_f32_bf16 v25, v204, s39, v23
v_dot2_f32_bf16 v26, v205, s38, v23
v_dot2_f32_bf16 v27, v205, s39, v23
v_dot2_f32_bf16 v28, v206, s38, v23
v_dot2_f32_bf16 v29, v206, s39, v23
v_dot2_f32_bf16 v30, v207, s38, v23
v_dot2_f32_bf16 v31, v207, s39, v23
v_cvt_pk_bf16_f32 v204, v24, v25
v_cvt_pk_bf16_f32 v205, v26, v27
v_cvt_pk_bf16_f32 v206, v28, v29
v_cvt_pk_bf16_f32 v207, v30, v31
s_branch L_tr_e
L_tr_d:
s_cmp_ge_u32 s2, 216
s_cbranch_scc1 L_tr_n
v_perm_b32 v176, v78, v76, s34
v_perm_b32 v177, v82, v80, s34
s_add_u32 m0, s33, 0
s_add_u32 s40, s32, 0
buffer_load_dwordx4 v2, s[8:11], s40 offen offset:0 sc1 lds
v_perm_b32 v178, v86, v84, s34
v_perm_b32 v179, v90, v88, s34
buffer_load_dwordx4 v2, s[8:11], s40 offen offset:1024 sc1 lds
v_perm_b32 v180, v78, v76, s35
v_perm_b32 v181, v82, v80, s35
buffer_load_dwordx4 v2, s[8:11], s40 offen offset:2048 sc1 lds
v_perm_b32 v182, v86, v84, s35
v_perm_b32 v183, v90, v88, s35
buffer_load_dwordx4 v2, s[8:11], s40 offen offset:3072 sc1 lds
v_perm_b32 v184, v79, v77, s34
v_perm_b32 v185, v83, v81, s34
s_add_u32 m0, s33, 4096
s_add_u32 s40, s32, 4096
buffer_load_dwordx4 v2, s[8:11], s40 offen offset:0 sc1 lds
v_perm_b32 v186, v87, v85, s34
v_perm_b32 v187, v91, v89, s34
buffer_load_dwordx4 v2, s[8:11], s40 offen offset:1024 sc1 lds
v_perm_b32 v188, v79, v77, s35
v_perm_b32 v189, v83, v81, s35
buffer_load_dwordx4 v2, s[8:11], s40 offen offset:2048 sc1 lds
v_perm_b32 v190, v87, v85, s35
v_perm_b32 v191, v91, v89, s35
buffer_load_dwordx4 v2, s[8:11], s40 offen offset:3072 sc1 lds
v_perm_b32 v192, v94, v92, s34
v_perm_b32 v193, v98, v96, s34
s_add_u32 m0, s33, 8192
s_add_u32 s40, s32, 8192
buffer_load_dwordx4 v2, s[8:11], s40 offen offset:0 sc1 lds
v_perm_b32 v194, v102, v100, s34
v_perm_b32 v195, v106, v104, s34
buffer_load_dwordx4 v2, s[8:11], s40 offen offset:1024 sc1 lds
v_perm_b32 v196, v94, v92, s35
v_perm_b32 v197, v98, v96, s35
buffer_load_dwordx4 v2, s[8:11], s40 offen offset:2048 sc1 lds
v_perm_b32 v198, v102, v100, s35
v_perm_b32 v199, v106, v104, s35
buffer_load_dwordx4 v2, s[8:11], s40 offen offset:3072 sc1 lds
v_perm_b32 v200, v95, v93, s34
v_perm_b32 v201, v99, v97, s34
s_add_u32 m0, s33, 12288
s_add_u32 s40, s32, 12288
buffer_load_dwordx4 v2, s[8:11], s40 offen offset:0 sc1 lds
v_perm_b32 v202, v103, v101, s34
v_perm_b32 v203, v107, v105, s34
buffer_load_dwordx4 v2, s[8:11], s40 offen offset:1024 sc1 lds
v_perm_b32 v204, v95, v93, s35
v_perm_b32 v205, v99, v97, s35
buffer_load_dwordx4 v2, s[8:11], s40 offen offset:2048 sc1 lds
v_perm_b32 v206, v103, v101, s35
v_perm_b32 v207, v107, v105, s35
buffer_load_dwordx4 v2, s[8:11], s40 offen offset:3072 sc1 lds
v_lshl_or_b32 v208, v109, 16, v108
v_lshl_or_b32 v209, v111, 16, v110
s_add_u32 m0, s33, 16384
s_add_u32 s40, s32, 16384
buffer_load_dwordx4 v2, s[8:11], s40 offen offset:0 sc1 lds
v_lshl_or_b32 v210, v113, 16, v112
v_lshl_or_b32 v211, v115, 16, v114
buffer_load_dwordx4 v2, s[8:11], s40 offen offset:1024 sc1 lds
v_perm_b32 v212, v118, v116, s34
v_perm_b32 v213, v122, v120, s34
buffer_load_dwordx4 v2, s[8:11], s40 offen offset:2048 sc1 lds
v_perm_b32 v214, v126, v124, s34
v_perm_b32 v215, v130, v128, s34
buffer_load_dwordx4 v2, s[8:11], s40 offen offset:3072 sc1 lds
v_perm_b32 v216, v118, v116, s35
v_perm_b32 v217, v122, v120, s35
s_add_u32 m0, s33, 20480
s_add_u32 s40, s32, 20480
buffer_load_dwordx4 v2, s[8:11], s40 offen offset:0 sc1 lds
v_perm_b32 v218, v126, v124, s35
v_perm_b32 v219, v130, v128, s35
buffer_load_dwordx4 v2, s[8:11], s40 offen offset:1024 sc1 lds
v_perm_b32 v220, v119, v117, s34
v_perm_b32 v221, v123, v121, s34
buffer_load_dwordx4 v2, s[8:11], s40 offen offset:2048 sc1 lds
v_perm_b32 v222, v127, v125, s34
v_perm_b32 v223, v131, v129, s34
buffer_load_dwordx4 v2, s[8:11], s40 offen offset:3072 sc1 lds
v_perm_b32 v224, v119, v117, s35
v_perm_b32 v225, v123, v121, s35
s_add_u32 m0, s33, 24576
s_add_u32 s40, s32, 24576
buffer_load_dwordx4 v2, s[8:11], s40 offen offset:0 sc1 lds
v_perm_b32 v226, v127, v125, s35
v_perm_b32 v227, v131, v129, s35
buffer_load_dwordx4 v2, s[8:11], s40 offen offset:1024 sc1 lds
v_perm_b32 v228, v134, v132, s34
v_perm_b32 v229, v138, v136, s34
buffer_load_dwordx4 v2, s[8:11], s40 offen offset:2048 sc1 lds
v_perm_b32 v230, v142, v140, s34
v_perm_b32 v231, v146, v144, s34
buffer_load_dwordx4 v2, s[8:11], s40 offen offset:3072 sc1 lds
v_perm_b32 v232, v134, v132, s35
v_perm_b32 v233, v138, v136, s35
s_add_u32 m0, s33, 28672
s_add_u32 s40, s32, 28672
buffer_load_dwordx4 v2, s[8:11], s40 offen offset:0 sc1 lds
v_perm_b32 v234, v142, v140, s35
v_perm_b32 v235, v146, v144, s35
buffer_load_dwordx4 v2, s[8:11], s40 offen offset:1024 sc1 lds
v_perm_b32 v236, v135, v133, s34
v_perm_b32 v237, v139, v137, s34
buffer_load_dwordx4 v2, s[8:11], s40 offen offset:2048 sc1 lds
v_perm_b32 v238, v143, v141, s34
v_perm_b32 v239, v147, v145, s34
buffer_load_dwordx4 v2, s[8:11], s40 offen offset:3072 sc1 lds
v_perm_b32 v240, v135, v133, s35
v_perm_b32 v241, v139, v137, s35
s_add_u32 m0, s33, 32768
s_add_u32 s40, s32, 32768
buffer_load_dwordx4 v2, s[8:11], s40 offen offset:0 sc1 lds
v_perm_b32 v242, v143, v141, s35
v_perm_b32 v243, v147, v145, s35
buffer_load_dwordx4 v2, s[8:11], s40 offen offset:1024 sc1 lds
v_lshl_or_b32 v244, v149, 16, v148
v_lshl_or_b32 v245, v151, 16, v150
buffer_load_dwordx4 v2, s[8:11], s40 offen offset:2048 sc1 lds
v_lshl_or_b32 v246, v153, 16, v152
v_lshl_or_b32 v247, v155, 16, v154
buffer_load_dwordx4 v2, s[8:11], s40 offen offset:3072 sc1 lds
s_branch L_tr_e
L_tr_n:
s_add_u32 m0, s33, 0
s_add_u32 s40, s32, 0
buffer_load_dwordx4 v2, s[8:11], s40 offen offset:0 sc1 lds
buffer_load_dwordx4 v2, s[8:11], s40 offen offset:1024 sc1 lds
buffer_load_dwordx4 v2, s[8:11], s40 offen offset:2048 sc1 lds
buffer_load_dwordx4 v2, s[8:11], s40 offen offset:3072 sc1 lds
s_add_u32 m0, s33, 4096
s_add_u32 s40, s32, 4096
buffer_load_dwordx4 v2, s[8:11], s40 offen offset:0 sc1 lds
buffer_load_dwordx4 v2, s[8:11], s40 offen offset:1024 sc1 lds
buffer_load_dwordx4 v2, s[8:11], s40 offen offset:2048 sc1 lds
buffer_load_dwordx4 v2, s[8:11], s40 offen offset:3072 sc1 lds
s_add_u32 m0, s33, 8192
s_add_u32 s40, s32, 8192
buffer_load_dwordx4 v2, s[8:11], s40 offen offset:0 sc1 lds
buffer_load_dwordx4 v2, s[8:11], s40 offen offset:1024 sc1 lds
buffer_load_dwordx4 v2, s[8:11], s40 offen offset:2048 sc1 lds
buffer_load_dwordx4 v2, s[8:11], s40 offen offset:3072 sc1 lds
s_add_u32 m0, s33, 12288
s_add_u32 s40, s32, 12288
buffer_load_dwordx4 v2, s[8:11], s40 offen offset:0 sc1 lds
buffer_load_dwordx4 v2, s[8:11], s40 offen offset:1024 sc1 lds
buffer_load_dwordx4 v2, s[8:11], s40 offen offset:2048 sc1 lds
buffer_load_dwordx4 v2, s[8:11], s40 offen offset:3072 sc1 lds
s_add_u32 m0, s33, 16384
s_add_u32 s40, s32, 16384
buffer_load_dwordx4 v2, s[8:11], s40 offen offset:0 sc1 lds
buffer_load_dwordx4 v2, s[8:11], s40 offen offset:1024 sc1 lds
buffer_load_dwordx4 v2, s[8:11], s40 offen offset:2048 sc1 lds
buffer_load_dwordx4 v2, s[8:11], s40 offen offset:3072 sc1 lds
s_add_u32 m0, s33, 20480
s_add_u32 s40, s32, 20480
buffer_load_dwordx4 v2, s[8:11], s40 offen offset:0 sc1 lds
buffer_load_dwordx4 v2, s[8:11], s40 offen offset:1024 sc1 lds
buffer_load_dwordx4 v2, s[8:11], s40 offen offset:2048 sc1 lds
buffer_load_dwordx4 v2, s[8:11], s40 offen offset:3072 sc1 lds
s_add_u32 m0, s33, 24576
s_add_u32 s40, s32, 24576
buffer_load_dwordx4 v2, s[8:11], s40 offen offset:0 sc1 lds
buffer_load_dwordx4 v2, s[8:11], s40 offen offset:1024 sc1 lds
buffer_load_dwordx4 v2, s[8:11], s40 offen offset:2048 sc1 lds
buffer_load_dwordx4 v2, s[8:11], s40 offen offset:3072 sc1 lds
s_add_u32 m0, s33, 28672
s_add_u32 s40, s32, 28672
buffer_load_dwordx4 v2, s[8:11], s40 offen offset:0 sc1 lds
buffer_load_dwordx4 v2, s[8:11], s40 offen offset:1024 sc1 lds
buffer_load_dwordx4 v2, s[8:11], s40 offen offset:2048 sc1 lds
buffer_load_dwordx4 v2, s[8:11], s40 offen offset:3072 sc1 lds
s_add_u32 m0, s33, 32768
s_add_u32 s40, s32, 32768
buffer_load_dwordx4 v2, s[8:11], s40 offen offset:0 sc1 lds
buffer_load_dwordx4 v2, s[8:11], s40 offen offset:1024 sc1 lds
buffer_load_dwordx4 v2, s[8:11], s40 offen offset:2048 sc1 lds
buffer_load_dwordx4 v2, s[8:11], s40 offen offset:3072 sc1 lds
L_tr_e:
s_mov_b32 s35, s37
buffer_load_dwordx4 a[0:3], v2, s[8:11], s26 offen offset:0 sc1
buffer_load_dwordx4 a[72:75], v2, s[8:11], s27 offen offset:0 sc1
buffer_load_dwordx4 a[144:147], v3, s[8:11], s28 offen offset:0 sc1
buffer_load_dwordx4 a[4:7], v2, s[8:11], s26 offen offset:1024 sc1
buffer_load_dwordx4 a[76:79], v2, s[8:11], s27 offen offset:1024 sc1
buffer_load_dwordx4 a[148:151], v3, s[8:11], s28 offen offset:1024 sc1
buffer_load_dwordx4 a[8:11], v2, s[8:11], s26 offen offset:2048 sc1
buffer_load_dwordx4 a[80:83], v2, s[8:11], s27 offen offset:2048 sc1
buffer_load_dwordx4 a[152:155], v3, s[8:11], s28 offen offset:2048 sc1
buffer_load_dwordx4 a[12:15], v2, s[8:11], s26 offen offset:3072 sc1
buffer_load_dwordx4 a[84:87], v2, s[8:11], s27 offen offset:3072 sc1
buffer_load_dwordx4 a[156:159], v3, s[8:11], s28 offen offset:3072 sc1
s_add_u32 s26, s26, 4096
s_add_u32 s27, s27, 4096
s_add_u32 s28, s28, 4096
buffer_load_dwordx4 a[16:19], v2, s[8:11], s26 offen offset:0 sc1
buffer_load_dwordx4 a[88:91], v2, s[8:11], s27 offen offset:0 sc1
buffer_load_dwordx4 a[160:163], v3, s[8:11], s28 offen offset:0 sc1
buffer_load_dwordx4 a[20:23], v2, s[8:11], s26 offen offset:1024 sc1
buffer_load_dwordx4 a[92:95], v2, s[8:11], s27 offen offset:1024 sc1
buffer_load_dwordx4 a[164:167], v3, s[8:11], s28 offen offset:1024 sc1
buffer_load_dwordx4 a[24:27], v2, s[8:11], s26 offen offset:2048 sc1
buffer_load_dwordx4 a[96:99], v2, s[8:11], s27 offen offset:2048 sc1
buffer_load_dwordx4 a[168:171], v3, s[8:11], s28 offen offset:2048 sc1
buffer_load_dwordx4 a[28:31], v2, s[8:11], s26 offen offset:3072 sc1
buffer_load_dwordx4 a[100:103], v2, s[8:11], s27 offen offset:3072 sc1
buffer_load_dwordx4 a[172:175], v3, s[8:11], s28 offen offset:3072 sc1
v_lshrrev_b32 v13, 4, v1
v_lshlrev_b32 v14, 2, v13
v_sub_u32 v14, v12, v14
v_subrev_u32 v15, 0, v14
v_cmp_gt_u32 s[52:53], 8, v15
v_cmp_gt_i32 s[44:45], -8, v15
v_subrev_u32 v15, 1, v14
v_cmp_gt_u32 s[54:55], 8, v15
v_cmp_gt_i32 s[46:47], -8, v15
v_subrev_u32 v15, 2, v14
v_cmp_gt_u32 s[56:57], 8, v15
v_cmp_gt_i32 s[48:49], -8, v15
v_subrev_u32 v15, 3, v14
v_cmp_gt_u32 s[58:59], 8, v15
v_cmp_gt_i32 s[50:51], -8, v15
s_and_b32 s31, s20, 7
s_or_b32 s31, s31, s4
s_cmp_eq_u32 s31, 0
s_cselect_b64 s[60:61], 0, s[44:45]
s_cselect_b64 s[62:63], 0, s[46:47]
s_cselect_b64 s[64:65], 0, s[48:49]
s_cselect_b64 s[66:67], 0, s[50:51]
s_waitcnt vmcnt(24)
s_barrier
ds_read_b128 a[216:219], v2 offset:0
ds_read_b128 a[220:223], v2 offset:8192
ds_read_b128 a[224:227], v2 offset:1024
ds_read_b128 a[228:231], v2 offset:9216
ds_read_b128 a[232:235], v2 offset:2048
ds_read_b128 a[236:239], v2 offset:10240
s_waitcnt vmcnt(18)
s_waitcnt lgkmcnt(4)
v_mfma_f32_16x16x32_bf16 v[32:35], a[216:219], a[0:3], 0
s_add_u32 s26, s26, 4096
s_add_u32 s27, s27, 4096
s_add_u32 s28, s28, 4096
buffer_load_dwordx4 a[32:35], v2, s[8:11], s26 offen offset:0 sc1
v_mfma_f32_16x16x32_bf16 v[32:35], a[220:223], a[4:7], v[32:35]
ds_read_b128 a[240:243], v2 offset:3072
v_dot2_f32_bf16 v24, v208, s38, v20
v_mfma_f32_16x16x32_bf16 v[36:39], a[216:219], a[72:75], 0
v_dot2_f32_bf16 v25, v208, s39, v20
v_dot2_f32_bf16 v26, v209, s38, v20
v_mfma_f32_16x16x32_bf16 v[36:39], a[220:223], a[76:79], v[36:39]
ds_read_b128 a[244:247], v2 offset:11264
s_waitcnt lgkmcnt(4)
v_mfma_f32_16x16x32_bf16 v[40:43], a[224:227], a[0:3], 0
buffer_load_dwordx4 a[104:107], v2, s[8:11], s27 offen offset:0 sc1
v_mfma_f32_16x16x32_bf16 v[40:43], a[228:231], a[4:7], v[40:43]
ds_read_b128 a[216:219], v2 offset:4096
v_dot2_f32_bf16 v27, v209, s39, v20
v_mfma_f32_16x16x32_bf16 v[44:47], a[224:227], a[72:75], 0
v_dot2_f32_bf16 v28, v210, s38, v20
v_dot2_f32_bf16 v29, v210, s39, v20
v_mfma_f32_16x16x32_bf16 v[44:47], a[228:231], a[76:79], v[44:47]
ds_read_b128 a[220:223], v2 offset:12288
s_waitcnt lgkmcnt(4)
v_mfma_f32_16x16x32_bf16 v[48:51], a[232:235], a[0:3], 0
buffer_load_dwordx4 a[176:179], v3, s[8:11], s28 offen offset:0 sc1
v_mfma_f32_16x16x32_bf16 v[48:51], a[236:239], a[4:7], v[48:51]
ds_read_b128 a[224:227], v2 offset:5120
v_dot2_f32_bf16 v30, v211, s38, v20
v_mfma_f32_16x16x32_bf16 v[52:55], a[232:235], a[72:75], 0
v_dot2_f32_bf16 v31, v211, s39, v20
v_cvt_pk_bf16_f32 v208, v24, v25
v_mfma_f32_16x16x32_bf16 v[52:55], a[236:239], a[76:79], v[52:55]
ds_read_b128 a[228:231], v2 offset:13312
s_waitcnt lgkmcnt(4)
v_mfma_f32_16x16x32_bf16 v[56:59], a[240:243], a[0:3], 0
buffer_load_dwordx4 a[36:39], v2, s[8:11], s26 offen offset:1024 sc1
v_mfma_f32_16x16x32_bf16 v[56:59], a[244:247], a[4:7], v[56:59]
ds_read_b128 a[232:235], v2 offset:6144
v_cvt_pk_bf16_f32 v209, v26, v27
v_mfma_f32_16x16x32_bf16 v[60:63], a[240:243], a[72:75], 0
v_cvt_pk_bf16_f32 v210, v28, v29
v_cvt_pk_bf16_f32 v211, v30, v31
v_mfma_f32_16x16x32_bf16 v[60:63], a[244:247], a[76:79], v[60:63]
ds_read_b128 a[236:239], v2 offset:14336
s_waitcnt lgkmcnt(4)
v_mfma_f32_16x16x32_bf16 v[64:67], a[216:219], a[0:3], 0
buffer_load_dwordx4 a[108:111], v2, s[8:11], s27 offen offset:1024 sc1
v_mfma_f32_16x16x32_bf16 v[64:67], a[220:223], a[4:7], v[64:67]
ds_read_b128 a[240:243], v2 offset:7168
v_dot2_f32_bf16 v24, v212, s38, v21
v_mfma_f32_16x16x32_bf16 v[68:71], a[216:219], a[72:75], 0
v_dot2_f32_bf16 v25, v212, s39, v21
v_dot2_f32_bf16 v26, v213, s38, v21
v_mfma_f32_16x16x32_bf16 v[68:71], a[220:223], a[76:79], v[68:71]
ds_read_b128 a[244:247], v2 offset:15360
s_waitcnt lgkmcnt(4)
v_mfma_f32_16x16x32_bf16 v[72:75], a[0:3], a[224:227], 0
buffer_load_dwordx4 a[180:183], v3, s[8:11], s28 offen offset:1024 sc1
v_mfma_f32_16x16x32_bf16 v[72:75], a[4:7], a[228:231], v[72:75]
ds_read_b128 a[216:219], v6 offset:0
v_dot2_f32_bf16 v27, v213, s39, v21
v_mfma_f32_16x16x32_bf16 v[76:79], a[72:75], a[224:227], 0
v_dot2_f32_bf16 v28, v214, s38, v21
v_dot2_f32_bf16 v29, v214, s39, v21
v_mfma_f32_16x16x32_bf16 v[76:79], a[76:79], a[228:231], v[76:79]
ds_read_b128 a[220:223], v6 offset:8192
s_waitcnt lgkmcnt(4)
v_mfma_f32_16x16x32_bf16 v[80:83], a[0:3], a[232:235], 0
buffer_load_dwordx4 a[40:43], v2, s[8:11], s26 offen offset:2048 sc1
v_mfma_f32_16x16x32_bf16 v[80:83], a[4:7], a[236:239], v[80:83]
ds_read_b128 a[224:227], v9 offset:0
v_dot2_f32_bf16 v30, v215, s38, v21
v_mfma_f32_16x16x32_bf16 v[84:87], a[72:75], a[232:235], 0
v_dot2_f32_bf16 v31, v215, s39, v21
v_cvt_pk_bf16_f32 v212, v24, v25
v_mfma_f32_16x16x32_bf16 v[84:87], a[76:79], a[236:239], v[84:87]
ds_read_b128 a[228:231], v9 offset:8192
s_waitcnt lgkmcnt(4)
v_mfma_f32_16x16x32_bf16 v[88:91], a[0:3], a[240:243], 0
buffer_load_dwordx4 a[112:115], v2, s[8:11], s27 offen offset:2048 sc1
v_mfma_f32_16x16x32_bf16 v[88:91], a[4:7], a[244:247], v[88:91]
ds_read_b128 a[232:235], v2 offset:16384
v_cvt_pk_bf16_f32 v213, v26, v27
v_mfma_f32_16x16x32_bf16 v[92:95], a[72:75], a[240:243], 0
v_cvt_pk_bf16_f32 v214, v28, v29
v_cvt_pk_bf16_f32 v215, v30, v31
v_mfma_f32_16x16x32_bf16 v[92:95], a[76:79], a[244:247], v[92:95]
ds_read_b128 a[236:239], v2 offset:24576
s_waitcnt lgkmcnt(4)
v_mfma_f32_16x16x32_bf16 v[96:99], a[216:219], a[144:147], 0
ds_read_b128 a[240:243], v2 offset:17408
buffer_load_dwordx4 a[184:187], v3, s[8:11], s28 offen offset:2048 sc1
v_mfma_f32_16x16x32_bf16 v[96:99], a[220:223], a[148:151], v[96:99]
ds_read_b128 a[244:247], v2 offset:25600
s_waitcnt lgkmcnt(4)
v_mfma_f32_16x16x32_bf16 v[100:103], a[144:147], a[224:227], 0
ds_read_b128 a[216:219], v2 offset:18432
v_dot2_f32_bf16 v24, v216, s38, v22
v_mfma_f32_16x16x32_bf16 v[100:103], a[148:151], a[228:231], v[100:103]
ds_read_b128 a[220:223], v2 offset:26624
s_waitcnt vmcnt(21)
s_waitcnt lgkmcnt(4)
v_mfma_f32_16x16x32_bf16 v[32:35], a[232:235], a[8:11], v[32:35]
buffer_load_dwordx4 a[44:47], v2, s[8:11], s26 offen offset:3072 sc1
v_mfma_f32_16x16x32_bf16 v[32:35], a[236:239], a[12:15], v[32:35]
ds_read_b128 a[224:227], v2 offset:19456
v_dot2_f32_bf16 v25, v216, s39, v22
v_mfma_f32_16x16x32_bf16 v[36:39], a[232:235], a[80:83], v[36:39]
v_dot2_f32_bf16 v26, v217, s38, v22
v_dot2_f32_bf16 v27, v217, s39, v22
v_mfma_f32_16x16x32_bf16 v[36:39], a[236:239], a[84:87], v[36:39]
ds_read_b128 a[228:231], v2 offset:27648
s_waitcnt lgkmcnt(4)
v_mfma_f32_16x16x32_bf16 v[40:43], a[240:243], a[8:11], v[40:43]
buffer_load_dwordx4 a[116:119], v2, s[8:11], s27 offen offset:3072 sc1
v_mfma_f32_16x16x32_bf16 v[40:43], a[244:247], a[12:15], v[40:43]
ds_read_b128 a[232:235], v2 offset:20480
v_dot2_f32_bf16 v28, v218, s38, v22
v_mfma_f32_16x16x32_bf16 v[44:47], a[240:243], a[80:83], v[44:47]
v_dot2_f32_bf16 v29, v218, s39, v22
v_dot2_f32_bf16 v30, v219, s38, v22
v_mfma_f32_16x16x32_bf16 v[44:47], a[244:247], a[84:87], v[44:47]
ds_read_b128 a[236:239], v2 offset:28672
s_waitcnt lgkmcnt(4)
v_mfma_f32_16x16x32_bf16 v[48:51], a[216:219], a[8:11], v[48:51]
buffer_load_dwordx4 a[188:191], v3, s[8:11], s28 offen offset:3072 sc1
v_mfma_f32_16x16x32_bf16 v[48:51], a[220:223], a[12:15], v[48:51]
ds_read_b128 a[240:243], v2 offset:21504
v_dot2_f32_bf16 v31, v219, s39, v22
v_mfma_f32_16x16x32_bf16 v[52:55], a[216:219], a[80:83], v[52:55]
v_cvt_pk_bf16_f32 v216, v24, v25
v_cvt_pk_bf16_f32 v217, v26, v27
v_mfma_f32_16x16x32_bf16 v[52:55], a[220:223], a[84:87], v[52:55]
ds_read_b128 a[244:247], v2 offset:29696
s_waitcnt lgkmcnt(4)
v_mfma_f32_16x16x32_bf16 v[56:59], a[224:227], a[8:11], v[56:59]
s_add_u32 s26, s26, 4096
s_add_u32 s27, s27, 4096
s_add_u32 s28, s28, 4096
buffer_load_dwordx4 a[48:51], v2, s[8:11], s26 offen offset:0 sc1
v_mfma_f32_16x16x32_bf16 v[56:59], a[228:231], a[12:15], v[56:59]
ds_read_b128 a[216:219], v2 offset:22528
v_cvt_pk_bf16_f32 v218, v28, v29
v_mfma_f32_16x16x32_bf16 v[60:63], a[224:227], a[80:83], v[60:63]
v_cvt_pk_bf16_f32 v219, v30, v31
v_dot2_f32_bf16 v24, v220, s38, v23
v_mfma_f32_16x16x32_bf16 v[60:63], a[228:231], a[84:87], v[60:63]
ds_read_b128 a[220:223], v2 offset:30720
s_waitcnt lgkmcnt(4)
v_mfma_f32_16x16x32_bf16 v[64:67], a[232:235], a[8:11], v[64:67]
buffer_load_dwordx4 a[120:123], v2, s[8:11], s27 offen offset:0 sc1
v_mfma_f32_16x16x32_bf16 v[64:67], a[236:239], a[12:15], v[64:67]
ds_read_b128 a[224:227], v2 offset:23552
v_dot2_f32_bf16 v25, v220, s39, v23
v_mfma_f32_16x16x32_bf16 v[68:71], a[232:235], a[80:83], v[68:71]
v_dot2_f32_bf16 v26, v221, s38, v23
v_dot2_f32_bf16 v27, v221, s39, v23
v_mfma_f32_16x16x32_bf16 v[68:71], a[236:239], a[84:87], v[68:71]
ds_read_b128 a[228:231], v2 offset:31744
s_waitcnt lgkmcnt(4)
v_mfma_f32_16x16x32_bf16 v[72:75], a[8:11], a[240:243], v[72:75]
buffer_load_dwordx4 a[192:195], v3, s[8:11], s28 offen offset:0 sc1
v_mfma_f32_16x16x32_bf16 v[72:75], a[12:15], a[244:247], v[72:75]
ds_read_b128 a[232:235], v6 offset:16384
v_dot2_f32_bf16 v28, v222, s38, v23
v_mfma_f32_16x16x32_bf16 v[76:79], a[80:83], a[240:243], v[76:79]
v_dot2_f32_bf16 v29, v222, s39, v23
v_dot2_f32_bf16 v30, v223, s38, v23
v_mfma_f32_16x16x32_bf16 v[76:79], a[84:87], a[244:247], v[76:79]
ds_read_b128 a[236:239], v6 offset:24576
s_waitcnt lgkmcnt(4)
v_mfma_f32_16x16x32_bf16 v[80:83], a[8:11], a[216:219], v[80:83]
buffer_load_dwordx4 a[52:55], v2, s[8:11], s26 offen offset:1024 sc1
v_mfma_f32_16x16x32_bf16 v[80:83], a[12:15], a[220:223], v[80:83]
ds_read_b128 a[240:243], v9 offset:16384
v_dot2_f32_bf16 v31, v223, s39, v23
v_mfma_f32_16x16x32_bf16 v[84:87], a[80:83], a[216:219], v[84:87]
v_cvt_pk_bf16_f32 v220, v24, v25
v_cvt_pk_bf16_f32 v221, v26, v27
v_mfma_f32_16x16x32_bf16 v[84:87], a[84:87], a[220:223], v[84:87]
ds_read_b128 a[244:247], v9 offset:24576
s_waitcnt lgkmcnt(4)
v_mfma_f32_16x16x32_bf16 v[88:91], a[8:11], a[224:227], v[88:91]
buffer_load_dwordx4 a[124:127], v2, s[8:11], s27 offen offset:1024 sc1
v_mfma_f32_16x16x32_bf16 v[88:91], a[12:15], a[228:231], v[88:91]
ds_read_b128 a[216:219], v2 offset:32768
v_cvt_pk_bf16_f32 v222, v28, v29
v_mfma_f32_16x16x32_bf16 v[92:95], a[80:83], a[224:227], v[92:95]
v_cvt_pk_bf16_f32 v223, v30, v31
v_dot2_f32_bf16 v24, v224, s38, v20
v_mfma_f32_16x16x32_bf16 v[92:95], a[84:87], a[228:231], v[92:95]
ds_read_b128 a[220:223], v2 offset:40960
s_waitcnt lgkmcnt(4)
v_mfma_f32_16x16x32_bf16 v[96:99], a[232:235], a[152:155], v[96:99]
ds_read_b128 a[224:227], v2 offset:33792
buffer_load_dwordx4 a[196:199], v3, s[8:11], s28 offen offset:1024 sc1
v_mfma_f32_16x16x32_bf16 v[96:99], a[236:239], a[156:159], v[96:99]
ds_read_b128 a[228:231], v2 offset:41984
s_waitcnt lgkmcnt(4)
v_mfma_f32_16x16x32_bf16 v[100:103], a[152:155], a[240:243], v[100:103]
ds_read_b128 a[232:235], v2 offset:34816
v_dot2_f32_bf16 v25, v224, s39, v20
v_mfma_f32_16x16x32_bf16 v[100:103], a[156:159], a[244:247], v[100:103]
ds_read_b128 a[236:239], v2 offset:43008
s_waitcnt vmcnt(24)
s_waitcnt lgkmcnt(4)
v_mfma_f32_16x16x32_bf16 v[32:35], a[216:219], a[16:19], v[32:35]
buffer_load_dwordx4 a[56:59], v2, s[8:11], s26 offen offset:2048 sc1
v_mfma_f32_16x16x32_bf16 v[32:35], a[220:223], a[20:23], v[32:35]
ds_read_b128 a[240:243], v2 offset:35840
v_dot2_f32_bf16 v26, v225, s38, v20
v_mfma_f32_16x16x32_bf16 v[36:39], a[216:219], a[88:91], v[36:39]
v_dot2_f32_bf16 v27, v225, s39, v20
v_dot2_f32_bf16 v28, v226, s38, v20
v_mfma_f32_16x16x32_bf16 v[36:39], a[220:223], a[92:95], v[36:39]
ds_read_b128 a[244:247], v2 offset:44032
s_waitcnt lgkmcnt(4)
v_mfma_f32_16x16x32_bf16 v[40:43], a[224:227], a[16:19], v[40:43]
buffer_load_dwordx4 a[128:131], v2, s[8:11], s27 offen offset:2048 sc1
v_mfma_f32_16x16x32_bf16 v[40:43], a[228:231], a[20:23], v[40:43]
ds_read_b128 a[216:219], v2 offset:36864
v_dot2_f32_bf16 v29, v226, s39, v20
v_mfma_f32_16x16x32_bf16 v[44:47], a[224:227], a[88:91], v[44:47]
v_dot2_f32_bf16 v30, v227, s38, v20
v_dot2_f32_bf16 v31, v227, s39, v20
v_mfma_f32_16x16x32_bf16 v[44:47], a[228:231], a[92:95], v[44:47]
ds_read_b128 a[220:223], v2 offset:45056
s_waitcnt lgkmcnt(4)
v_mfma_f32_16x16x32_bf16 v[48:51], a[232:235], a[16:19], v[48:51]
buffer_load_dwordx4 a[200:203], v3, s[8:11], s28 offen offset:2048 sc1
v_mfma_f32_16x16x32_bf16 v[48:51], a[236:239], a[20:23], v[48:51]
ds_read_b128 a[224:227], v2 offset:37888
v_cvt_pk_bf16_f32 v224, v24, v25
v_mfma_f32_16x16x32_bf16 v[52:55], a[232:235], a[88:91], v[52:55]
v_cvt_pk_bf16_f32 v225, v26, v27
v_cvt_pk_bf16_f32 v226, v28, v29
v_mfma_f32_16x16x32_bf16 v[52:55], a[236:239], a[92:95], v[52:55]
ds_read_b128 a[228:231], v2 offset:46080
s_waitcnt lgkmcnt(4)
v_mfma_f32_16x16x32_bf16 v[56:59], a[240:243], a[16:19], v[56:59]
buffer_load_dwordx4 a[60:63], v2, s[8:11], s26 offen offset:3072 sc1
v_mfma_f32_16x16x32_bf16 v[56:59], a[244:247], a[20:23], v[56:59]
ds_read_b128 a[232:235], v2 offset:38912
v_cvt_pk_bf16_f32 v227, v30, v31
v_mfma_f32_16x16x32_bf16 v[60:63], a[240:243], a[88:91], v[60:63]
v_dot2_f32_bf16 v24, v228, s38, v21
v_dot2_f32_bf16 v25, v228, s39, v21
v_mfma_f32_16x16x32_bf16 v[60:63], a[244:247], a[92:95], v[60:63]
ds_read_b128 a[236:239], v2 offset:47104
s_waitcnt lgkmcnt(4)
v_mfma_f32_16x16x32_bf16 v[64:67], a[216:219], a[16:19], v[64:67]
buffer_load_dwordx4 a[132:135], v2, s[8:11], s27 offen offset:3072 sc1
v_mfma_f32_16x16x32_bf16 v[64:67], a[220:223], a[20:23], v[64:67]
ds_read_b128 a[240:243], v2 offset:39936
v_dot2_f32_bf16 v26, v229, s38, v21
v_mfma_f32_16x16x32_bf16 v[68:71], a[216:219], a[88:91], v[68:71]
v_dot2_f32_bf16 v27, v229, s39, v21
v_dot2_f32_bf16 v28, v230, s38, v21
v_mfma_f32_16x16x32_bf16 v[68:71], a[220:223], a[92:95], v[68:71]
ds_read_b128 a[244:247], v2 offset:48128
s_waitcnt lgkmcnt(4)
v_mfma_f32_16x16x32_bf16 v[72:75], a[16:19], a[224:227], v[72:75]
buffer_load_dwordx4 a[204:207], v3, s[8:11], s28 offen offset:3072 sc1
v_mfma_f32_16x16x32_bf16 v[72:75], a[20:23], a[228:231], v[72:75]
ds_read_b128 a[216:219], v6 offset:32768
v_dot2_f32_bf16 v29, v230, s39, v21
v_mfma_f32_16x16x32_bf16 v[76:79], a[88:91], a[224:227], v[76:79]
v_dot2_f32_bf16 v30, v231, s38, v21
v_dot2_f32_bf16 v31, v231, s39, v21
v_mfma_f32_16x16x32_bf16 v[76:79], a[92:95], a[228:231], v[76:79]
ds_read_b128 a[220:223], v6 offset:40960
s_waitcnt lgkmcnt(4)
v_mfma_f32_16x16x32_bf16 v[80:83], a[16:19], a[232:235], v[80:83]
s_add_u32 s26, s26, 4096
s_add_u32 s27, s27, 4096
s_add_u32 s28, s28, 4096
buffer_load_dwordx4 a[64:67], v2, s[8:11], s26 offen offset:0 sc1
v_mfma_f32_16x16x32_bf16 v[80:83], a[20:23], a[236:239], v[80:83]
ds_read_b128 a[224:227], v9 offset:32768
v_cvt_pk_bf16_f32 v228, v24, v25
v_mfma_f32_16x16x32_bf16 v[84:87], a[88:91], a[232:235], v[84:87]
v_cvt_pk_bf16_f32 v229, v26, v27
v_cvt_pk_bf16_f32 v230, v28, v29
v_mfma_f32_16x16x32_bf16 v[84:87], a[92:95], a[236:239], v[84:87]
ds_read_b128 a[228:231], v9 offset:40960
s_waitcnt lgkmcnt(4)
v_mfma_f32_16x16x32_bf16 v[88:91], a[16:19], a[240:243], v[88:91]
buffer_load_dwordx4 a[136:139], v2, s[8:11], s27 offen offset:0 sc1
v_mfma_f32_16x16x32_bf16 v[88:91], a[20:23], a[244:247], v[88:91]
ds_read_b128 a[232:235], v2 offset:49152
v_cvt_pk_bf16_f32 v231, v30, v31
v_mfma_f32_16x16x32_bf16 v[92:95], a[88:91], a[240:243], v[92:95]
v_dot2_f32_bf16 v24, v232, s38, v22
v_dot2_f32_bf16 v25, v232, s39, v22
v_mfma_f32_16x16x32_bf16 v[92:95], a[92:95], a[244:247], v[92:95]
ds_read_b128 a[236:239], v2 offset:57344
s_waitcnt lgkmcnt(4)
v_mfma_f32_16x16x32_bf16 v[96:99], a[216:219], a[160:163], v[96:99]
ds_read_b128 a[240:243], v2 offset:50176
buffer_load_dwordx4 a[208:211], v3, s[8:11], s28 offen offset:0 sc1
v_mfma_f32_16x16x32_bf16 v[96:99], a[220:223], a[164:167], v[96:99]
ds_read_b128 a[244:247], v2 offset:58368
s_waitcnt lgkmcnt(4)
v_mfma_f32_16x16x32_bf16 v[100:103], a[160:163], a[224:227], v[100:103]
ds_read_b128 a[216:219], v2 offset:51200
v_dot2_f32_bf16 v26, v233, s38, v22
v_mfma_f32_16x16x32_bf16 v[100:103], a[164:167], a[228:231], v[100:103]
ds_read_b128 a[220:223], v2 offset:59392
s_waitcnt vmcnt(27)
s_waitcnt lgkmcnt(4)
v_mfma_f32_16x16x32_bf16 v[32:35], a[232:235], a[24:27], v[32:35]
buffer_load_dwordx4 a[68:71], v2, s[8:11], s26 offen offset:1024 sc1
v_mfma_f32_16x16x32_bf16 v[32:35], a[236:239], a[28:31], v[32:35]
ds_read_b128 a[224:227], v2 offset:52224
v_dot2_f32_bf16 v27, v233, s39, v22
v_mfma_f32_16x16x32_bf16 v[36:39], a[232:235], a[96:99], v[36:39]
v_dot2_f32_bf16 v28, v234, s38, v22
v_dot2_f32_bf16 v29, v234, s39, v22
v_mfma_f32_16x16x32_bf16 v[36:39], a[236:239], a[100:103], v[36:39]
ds_read_b128 a[228:231], v2 offset:60416
s_waitcnt lgkmcnt(4)
v_mfma_f32_16x16x32_bf16 v[40:43], a[240:243], a[24:27], v[40:43]
buffer_load_dwordx4 a[140:143], v2, s[8:11], s27 offen offset:1024 sc1
v_mfma_f32_16x16x32_bf16 v[40:43], a[244:247], a[28:31], v[40:43]
ds_read_b128 a[232:235], v2 offset:53248
v_dot2_f32_bf16 v30, v235, s38, v22
v_mfma_f32_16x16x32_bf16 v[44:47], a[240:243], a[96:99], v[44:47]
v_dot2_f32_bf16 v31, v235, s39, v22
v_cvt_pk_bf16_f32 v232, v24, v25
v_mfma_f32_16x16x32_bf16 v[44:47], a[244:247], a[100:103], v[44:47]
ds_read_b128 a[236:239], v2 offset:61440
s_waitcnt lgkmcnt(4)
v_mfma_f32_16x16x32_bf16 v[48:51], a[216:219], a[24:27], v[48:51]
buffer_load_dwordx4 a[212:215], v3, s[8:11], s28 offen offset:1024 sc1
v_mfma_f32_16x16x32_bf16 v[48:51], a[220:223], a[28:31], v[48:51]
ds_read_b128 a[240:243], v2 offset:54272
v_cvt_pk_bf16_f32 v233, v26, v27
v_mfma_f32_16x16x32_bf16 v[52:55], a[216:219], a[96:99], v[52:55]
v_cvt_pk_bf16_f32 v234, v28, v29
v_cvt_pk_bf16_f32 v235, v30, v31
v_mfma_f32_16x16x32_bf16 v[52:55], a[220:223], a[100:103], v[52:55]
ds_read_b128 a[244:247], v2 offset:62464
s_waitcnt lgkmcnt(4)
v_mfma_f32_16x16x32_bf16 v[56:59], a[224:227], a[24:27], v[56:59]
buffer_store_dwordx4 v[176:179], v156, s[8:11], 0 offen sc1
v_dot2_f32_bf16 v24, v236, s38, v23
v_mfma_f32_16x16x32_bf16 v[56:59], a[228:231], a[28:31], v[56:59]
ds_read_b128 a[216:219], v2 offset:55296
v_dot2_f32_bf16 v25, v236, s39, v23
v_mfma_f32_16x16x32_bf16 v[60:63], a[224:227], a[96:99], v[60:63]
v_dot2_f32_bf16 v26, v237, s38, v23
v_dot2_f32_bf16 v27, v237, s39, v23
v_mfma_f32_16x16x32_bf16 v[60:63], a[228:231], a[100:103], v[60:63]
ds_read_b128 a[220:223], v2 offset:63488
s_waitcnt lgkmcnt(4)
v_mfma_f32_16x16x32_bf16 v[64:67], a[232:235], a[24:27], v[64:67]
buffer_store_dwordx4 v[180:183], v157, s[8:11], 0 offen sc1
v_dot2_f32_bf16 v28, v238, s38, v23
v_mfma_f32_16x16x32_bf16 v[64:67], a[236:239], a[28:31], v[64:67]
ds_read_b128 a[224:227], v2 offset:56320
v_dot2_f32_bf16 v29, v238, s39, v23
v_mfma_f32_16x16x32_bf16 v[68:71], a[232:235], a[96:99], v[68:71]
v_dot2_f32_bf16 v30, v239, s38, v23
v_dot2_f32_bf16 v31, v239, s39, v23
v_mfma_f32_16x16x32_bf16 v[68:71], a[236:239], a[100:103], v[68:71]
ds_read_b128 a[228:231], v2 offset:64512
s_waitcnt lgkmcnt(4)
v_mfma_f32_16x16x32_bf16 v[72:75], a[24:27], a[240:243], v[72:75]
buffer_store_dwordx4 v[184:187], v158, s[8:11], 0 offen sc1
v_cvt_pk_bf16_f32 v236, v24, v25
v_mfma_f32_16x16x32_bf16 v[72:75], a[28:31], a[244:247], v[72:75]
ds_read_b128 a[232:235], v6 offset:49152
v_cvt_pk_bf16_f32 v237, v26, v27
v_mfma_f32_16x16x32_bf16 v[76:79], a[96:99], a[240:243], v[76:79]
v_cvt_pk_bf16_f32 v238, v28, v29
v_cvt_pk_bf16_f32 v239, v30, v31
v_mfma_f32_16x16x32_bf16 v[76:79], a[100:103], a[244:247], v[76:79]
ds_read_b128 a[236:239], v6 offset:57344
s_waitcnt lgkmcnt(4)
v_mfma_f32_16x16x32_bf16 v[80:83], a[24:27], a[216:219], v[80:83]
buffer_store_dwordx4 v[188:191], v159, s[8:11], 0 offen sc1
v_dot2_f32_bf16 v24, v240, s38, v20
v_mfma_f32_16x16x32_bf16 v[80:83], a[28:31], a[220:223], v[80:83]
ds_read_b128 a[240:243], v9 offset:49152
v_dot2_f32_bf16 v25, v240, s39, v20
v_mfma_f32_16x16x32_bf16 v[84:87], a[96:99], a[216:219], v[84:87]
v_dot2_f32_bf16 v26, v241, s38, v20
v_dot2_f32_bf16 v27, v241, s39, v20
v_mfma_f32_16x16x32_bf16 v[84:87], a[100:103], a[220:223], v[84:87]
ds_read_b128 a[244:247], v9 offset:57344
s_waitcnt lgkmcnt(4)
v_mfma_f32_16x16x32_bf16 v[88:91], a[24:27], a[224:227], v[88:91]
buffer_store_dwordx4 v[192:195], v160, s[8:11], 0 offen sc1
v_dot2_f32_bf16 v28, v242, s38, v20
v_mfma_f32_16x16x32_bf16 v[88:91], a[28:31], a[228:231], v[88:91]
ds_read_b128 a[216:219], v4 offset:0
v_dot2_f32_bf16 v29, v242, s39, v20
v_mfma_f32_16x16x32_bf16 v[92:95], a[96:99], a[224:227], v[92:95]
v_dot2_f32_bf16 v30, v243, s38, v20
v_dot2_f32_bf16 v31, v243, s39, v20
v_mfma_f32_16x16x32_bf16 v[92:95], a[100:103], a[228:231], v[92:95]
ds_read_b128 a[220:223], v4 offset:8192
s_waitcnt lgkmcnt(4)
v_mfma_f32_16x16x32_bf16 v[96:99], a[232:235], a[168:171], v[96:99]
ds_read_b128 a[224:227], v4 offset:1024
buffer_store_dwordx4 v[196:199], v161, s[8:11], 0 offen sc1
v_cvt_pk_bf16_f32 v240, v24, v25
v_mfma_f32_16x16x32_bf16 v[96:99], a[236:239], a[172:175], v[96:99]
ds_read_b128 a[228:231], v4 offset:9216
s_waitcnt lgkmcnt(4)
v_mfma_f32_16x16x32_bf16 v[100:103], a[168:171], a[240:243], v[100:103]
ds_read_b128 a[232:235], v4 offset:2048
v_cvt_pk_bf16_f32 v241, v26, v27
v_mfma_f32_16x16x32_bf16 v[100:103], a[172:175], a[244:247], v[100:103]
ds_read_b128 a[236:239], v4 offset:10240
s_waitcnt vmcnt(30)
s_waitcnt lgkmcnt(4)
v_mfma_f32_16x16x32_bf16 v[32:35], a[216:219], a[32:35], v[32:35]
buffer_store_dwordx4 v[200:203], v162, s[8:11], 0 offen sc1
v_cvt_pk_bf16_f32 v242, v28, v29
v_mfma_f32_16x16x32_bf16 v[32:35], a[220:223], a[36:39], v[32:35]
ds_read_b128 a[240:243], v4 offset:3072
v_cvt_pk_bf16_f32 v243, v30, v31
v_mfma_f32_16x16x32_bf16 v[36:39], a[216:219], a[104:107], v[36:39]
v_dot2_f32_bf16 v24, v244, s38, v21
v_dot2_f32_bf16 v25, v244, s39, v21
v_mfma_f32_16x16x32_bf16 v[36:39], a[220:223], a[108:111], v[36:39]
ds_read_b128 a[244:247], v4 offset:11264
s_waitcnt lgkmcnt(4)
v_mfma_f32_16x16x32_bf16 v[40:43], a[224:227], a[32:35], v[40:43]
buffer_store_dwordx4 v[204:207], v163, s[8:11], 0 offen sc1
v_dot2_f32_bf16 v26, v245, s38, v21
v_mfma_f32_16x16x32_bf16 v[40:43], a[228:231], a[36:39], v[40:43]
ds_read_b128 a[216:219], v4 offset:4096
v_dot2_f32_bf16 v27, v245, s39, v21
v_mfma_f32_16x16x32_bf16 v[44:47], a[224:227], a[104:107], v[44:47]
v_dot2_f32_bf16 v28, v246, s38, v21
v_dot2_f32_bf16 v29, v246, s39, v21
v_mfma_f32_16x16x32_bf16 v[44:47], a[228:231], a[108:111], v[44:47]
ds_read_b128 a[220:223], v4 offset:12288
s_waitcnt lgkmcnt(4)
v_mfma_f32_16x16x32_bf16 v[48:51], a[232:235], a[32:35], v[48:51]
buffer_store_dwordx4 v[208:211], v164, s[8:11], 0 offen sc1
v_dot2_f32_bf16 v30, v247, s38, v21
v_mfma_f32_16x16x32_bf16 v[48:51], a[236:239], a[36:39], v[48:51]
ds_read_b128 a[224:227], v4 offset:5120
v_dot2_f32_bf16 v31, v247, s39, v21
v_mfma_f32_16x16x32_bf16 v[52:55], a[232:235], a[104:107], v[52:55]
v_cvt_pk_bf16_f32 v244, v24, v25
v_cvt_pk_bf16_f32 v245, v26, v27
v_mfma_f32_16x16x32_bf16 v[52:55], a[236:239], a[108:111], v[52:55]
ds_read_b128 a[228:231], v4 offset:13312
s_waitcnt lgkmcnt(4)
v_mfma_f32_16x16x32_bf16 v[56:59], a[240:243], a[32:35], v[56:59]
buffer_store_dwordx4 v[212:215], v165, s[8:11], 0 offen sc1
v_cvt_pk_bf16_f32 v246, v28, v29
v_mfma_f32_16x16x32_bf16 v[56:59], a[244:247], a[36:39], v[56:59]
ds_read_b128 a[232:235], v4 offset:6144
v_cvt_pk_bf16_f32 v247, v30, v31
v_mfma_f32_16x16x32_bf16 v[60:63], a[240:243], a[104:107], v[60:63]
v_dot2_f32_bf16 v24, v248, s38, v22
v_dot2_f32_bf16 v25, v248, s39, v22
v_mfma_f32_16x16x32_bf16 v[60:63], a[244:247], a[108:111], v[60:63]
ds_read_b128 a[236:239], v4 offset:14336
s_waitcnt lgkmcnt(4)
v_mfma_f32_16x16x32_bf16 v[64:67], a[216:219], a[32:35], v[64:67]
buffer_store_dwordx4 v[216:219], v166, s[8:11], 0 offen sc1
v_dot2_f32_bf16 v26, v249, s38, v22
v_mfma_f32_16x16x32_bf16 v[64:67], a[220:223], a[36:39], v[64:67]
ds_read_b128 a[240:243], v4 offset:7168
v_dot2_f32_bf16 v27, v249, s39, v22
v_mfma_f32_16x16x32_bf16 v[68:71], a[216:219], a[104:107], v[68:71]
v_dot2_f32_bf16 v28, v250, s38, v22
v_dot2_f32_bf16 v29, v250, s39, v22
v_mfma_f32_16x16x32_bf16 v[68:71], a[220:223], a[108:111], v[68:71]
ds_read_b128 a[244:247], v4 offset:15360
s_waitcnt lgkmcnt(4)
v_mfma_f32_16x16x32_bf16 v[72:75], a[32:35], a[224:227], v[72:75]
buffer_store_dwordx4 v[220:223], v167, s[8:11], 0 offen sc1
v_dot2_f32_bf16 v30, v251, s38, v22
v_mfma_f32_16x16x32_bf16 v[72:75], a[36:39], a[228:231], v[72:75]
ds_read_b128 a[216:219], v7 offset:0
v_dot2_f32_bf16 v31, v251, s39, v22
v_mfma_f32_16x16x32_bf16 v[76:79], a[104:107], a[224:227], v[76:79]
v_cvt_pk_bf16_f32 v248, v24, v25
v_cvt_pk_bf16_f32 v249, v26, v27
v_mfma_f32_16x16x32_bf16 v[76:79], a[108:111], a[228:231], v[76:79]
ds_read_b128 a[220:223], v7 offset:8192
s_waitcnt lgkmcnt(4)
v_mfma_f32_16x16x32_bf16 v[80:83], a[32:35], a[232:235], v[80:83]
buffer_store_dwordx4 v[224:227], v168, s[8:11], 0 offen sc1
v_cvt_pk_bf16_f32 v250, v28, v29
v_mfma_f32_16x16x32_bf16 v[80:83], a[36:39], a[236:239], v[80:83]
ds_read_b128 a[224:227], v10 offset:0
v_cvt_pk_bf16_f32 v251, v30, v31
v_mfma_f32_16x16x32_bf16 v[84:87], a[104:107], a[232:235], v[84:87]
v_dot2_f32_bf16 v24, v252, s38, v23
v_dot2_f32_bf16 v25, v252, s39, v23
v_mfma_f32_16x16x32_bf16 v[84:87], a[108:111], a[236:239], v[84:87]
ds_read_b128 a[228:231], v10 offset:8192
s_waitcnt lgkmcnt(4)
v_mfma_f32_16x16x32_bf16 v[88:91], a[32:35], a[240:243], v[88:91]
buffer_store_dwordx4 v[228:231], v169, s[8:11], 0 offen sc1
v_dot2_f32_bf16 v26, v253, s38, v23
v_mfma_f32_16x16x32_bf16 v[88:91], a[36:39], a[244:247], v[88:91]
ds_read_b128 a[232:235], v4 offset:16384
v_dot2_f32_bf16 v27, v253, s39, v23
v_mfma_f32_16x16x32_bf16 v[92:95], a[104:107], a[240:243], v[92:95]
v_dot2_f32_bf16 v28, v254, s38, v23
v_dot2_f32_bf16 v29, v254, s39, v23
v_mfma_f32_16x16x32_bf16 v[92:95], a[108:111], a[244:247], v[92:95]
ds_read_b128 a[236:239], v4 offset:24576
s_waitcnt lgkmcnt(4)
v_mfma_f32_16x16x32_bf16 v[96:99], a[216:219], a[176:179], v[96:99]
ds_read_b128 a[240:243], v4 offset:17408
buffer_store_dwordx4 v[232:235], v170, s[8:11], 0 offen sc1
v_dot2_f32_bf16 v30, v255, s38, v23
v_mfma_f32_16x16x32_bf16 v[96:99], a[220:223], a[180:183], v[96:99]
ds_read_b128 a[244:247], v4 offset:25600
s_waitcnt lgkmcnt(4)
v_mfma_f32_16x16x32_bf16 v[100:103], a[176:179], a[224:227], v[100:103]
ds_read_b128 a[216:219], v4 offset:18432
v_dot2_f32_bf16 v31, v255, s39, v23
v_mfma_f32_16x16x32_bf16 v[100:103], a[180:183], a[228:231], v[100:103]
ds_read_b128 a[220:223], v4 offset:26624
s_waitcnt vmcnt(33)
s_waitcnt lgkmcnt(4)
v_mfma_f32_16x16x32_bf16 v[32:35], a[232:235], a[40:43], v[32:35]
buffer_store_dwordx4 v[236:239], v171, s[8:11], 0 offen sc1
v_cvt_pk_bf16_f32 v252, v24, v25
v_mfma_f32_16x16x32_bf16 v[32:35], a[236:239], a[44:47], v[32:35]
ds_read_b128 a[224:227], v4 offset:19456
v_cvt_pk_bf16_f32 v253, v26, v27
v_mfma_f32_16x16x32_bf16 v[36:39], a[232:235], a[112:115], v[36:39]
v_cvt_pk_bf16_f32 v254, v28, v29
v_cvt_pk_bf16_f32 v255, v30, v31
v_mfma_f32_16x16x32_bf16 v[36:39], a[236:239], a[116:119], v[36:39]
ds_read_b128 a[228:231], v4 offset:27648
s_waitcnt lgkmcnt(4)
v_mfma_f32_16x16x32_bf16 v[40:43], a[240:243], a[40:43], v[40:43]
buffer_store_dwordx4 v[240:243], v172, s[8:11], 0 offen sc1
v_mfma_f32_16x16x32_bf16 v[40:43], a[244:247], a[44:47], v[40:43]
ds_read_b128 a[232:235], v4 offset:20480
v_mfma_f32_16x16x32_bf16 v[44:47], a[240:243], a[112:115], v[44:47]
v_mfma_f32_16x16x32_bf16 v[44:47], a[244:247], a[116:119], v[44:47]
ds_read_b128 a[236:239], v4 offset:28672
s_waitcnt lgkmcnt(4)
v_mfma_f32_16x16x32_bf16 v[48:51], a[216:219], a[40:43], v[48:51]
buffer_store_dwordx4 v[244:247], v173, s[8:11], 0 offen sc1
v_mfma_f32_16x16x32_bf16 v[48:51], a[220:223], a[44:47], v[48:51]
ds_read_b128 a[240:243], v4 offset:21504
v_mfma_f32_16x16x32_bf16 v[52:55], a[216:219], a[112:115], v[52:55]
v_mfma_f32_16x16x32_bf16 v[52:55], a[220:223], a[116:119], v[52:55]
ds_read_b128 a[244:247], v4 offset:29696
s_waitcnt lgkmcnt(4)
v_mfma_f32_16x16x32_bf16 v[56:59], a[224:227], a[40:43], v[56:59]
buffer_store_dwordx4 v[248:251], v174, s[8:11], 0 offen sc1
v_mfma_f32_16x16x32_bf16 v[56:59], a[228:231], a[44:47], v[56:59]
ds_read_b128 a[216:219], v4 offset:22528
v_mfma_f32_16x16x32_bf16 v[60:63], a[224:227], a[112:115], v[60:63]
v_mfma_f32_16x16x32_bf16 v[60:63], a[228:231], a[116:119], v[60:63]
ds_read_b128 a[220:223], v4 offset:30720
s_waitcnt lgkmcnt(4)
v_mfma_f32_16x16x32_bf16 v[64:67], a[232:235], a[40:43], v[64:67]
buffer_store_dwordx4 v[252:255], v175, s[8:11], 0 offen sc1
v_mfma_f32_16x16x32_bf16 v[64:67], a[236:239], a[44:47], v[64:67]
ds_read_b128 a[224:227], v4 offset:23552
v_mfma_f32_16x16x32_bf16 v[68:71], a[232:235], a[112:115], v[68:71]
v_mfma_f32_16x16x32_bf16 v[68:71], a[236:239], a[116:119], v[68:71]
ds_read_b128 a[228:231], v4 offset:31744
s_waitcnt lgkmcnt(4)
v_mfma_f32_16x16x32_bf16 v[72:75], a[40:43], a[240:243], v[72:75]
v_mfma_f32_16x16x32_bf16 v[72:75], a[44:47], a[244:247], v[72:75]
ds_read_b128 a[232:235], v7 offset:16384
v_mfma_f32_16x16x32_bf16 v[76:79], a[112:115], a[240:243], v[76:79]
v_mfma_f32_16x16x32_bf16 v[76:79], a[116:119], a[244:247], v[76:79]
ds_read_b128 a[236:239], v7 offset:24576
s_waitcnt lgkmcnt(4)
v_mfma_f32_16x16x32_bf16 v[80:83], a[40:43], a[216:219], v[80:83]
v_mfma_f32_16x16x32_bf16 v[80:83], a[44:47], a[220:223], v[80:83]
ds_read_b128 a[240:243], v10 offset:16384
v_mfma_f32_16x16x32_bf16 v[84:87], a[112:115], a[216:219], v[84:87]
v_mfma_f32_16x16x32_bf16 v[84:87], a[116:119], a[220:223], v[84:87]
ds_read_b128 a[244:247], v10 offset:24576
s_waitcnt lgkmcnt(4)
v_mfma_f32_16x16x32_bf16 v[88:91], a[40:43], a[224:227], v[88:91]
v_mfma_f32_16x16x32_bf16 v[88:91], a[44:47], a[228:231], v[88:91]
ds_read_b128 a[216:219], v4 offset:32768
v_mfma_f32_16x16x32_bf16 v[92:95], a[112:115], a[224:227], v[92:95]
v_mfma_f32_16x16x32_bf16 v[92:95], a[116:119], a[228:231], v[92:95]
ds_read_b128 a[220:223], v4 offset:40960
s_waitcnt lgkmcnt(4)
v_mfma_f32_16x16x32_bf16 v[96:99], a[232:235], a[184:187], v[96:99]
ds_read_b128 a[224:227], v4 offset:33792
v_mfma_f32_16x16x32_bf16 v[96:99], a[236:239], a[188:191], v[96:99]
ds_read_b128 a[228:231], v4 offset:41984
s_waitcnt lgkmcnt(4)
v_mfma_f32_16x16x32_bf16 v[100:103], a[184:187], a[240:243], v[100:103]
ds_read_b128 a[232:235], v4 offset:34816
v_mfma_f32_16x16x32_bf16 v[100:103], a[188:191], a[244:247], v[100:103]
ds_read_b128 a[236:239], v4 offset:43008
s_waitcnt vmcnt(32)
s_waitcnt lgkmcnt(4)
v_mfma_f32_16x16x32_bf16 v[32:35], a[216:219], a[48:51], v[32:35]
v_mfma_f32_16x16x32_bf16 v[32:35], a[220:223], a[52:55], v[32:35]
ds_read_b128 a[240:243], v4 offset:35840
v_mfma_f32_16x16x32_bf16 v[36:39], a[216:219], a[120:123], v[36:39]
v_mfma_f32_16x16x32_bf16 v[36:39], a[220:223], a[124:127], v[36:39]
ds_read_b128 a[244:247], v4 offset:44032
s_waitcnt lgkmcnt(4)
v_mfma_f32_16x16x32_bf16 v[40:43], a[224:227], a[48:51], v[40:43]
v_mfma_f32_16x16x32_bf16 v[40:43], a[228:231], a[52:55], v[40:43]
ds_read_b128 a[216:219], v4 offset:36864
v_mfma_f32_16x16x32_bf16 v[44:47], a[224:227], a[120:123], v[44:47]
v_mfma_f32_16x16x32_bf16 v[44:47], a[228:231], a[124:127], v[44:47]
ds_read_b128 a[220:223], v4 offset:45056
s_waitcnt lgkmcnt(4)
v_mfma_f32_16x16x32_bf16 v[48:51], a[232:235], a[48:51], v[48:51]
v_mfma_f32_16x16x32_bf16 v[48:51], a[236:239], a[52:55], v[48:51]
ds_read_b128 a[224:227], v4 offset:37888
v_mfma_f32_16x16x32_bf16 v[52:55], a[232:235], a[120:123], v[52:55]
v_mfma_f32_16x16x32_bf16 v[52:55], a[236:239], a[124:127], v[52:55]
ds_read_b128 a[228:231], v4 offset:46080
s_waitcnt lgkmcnt(4)
v_mfma_f32_16x16x32_bf16 v[56:59], a[240:243], a[48:51], v[56:59]
v_mfma_f32_16x16x32_bf16 v[56:59], a[244:247], a[52:55], v[56:59]
ds_read_b128 a[232:235], v4 offset:38912
v_mfma_f32_16x16x32_bf16 v[60:63], a[240:243], a[120:123], v[60:63]
v_mfma_f32_16x16x32_bf16 v[60:63], a[244:247], a[124:127], v[60:63]
ds_read_b128 a[236:239], v4 offset:47104
s_waitcnt lgkmcnt(4)
v_mfma_f32_16x16x32_bf16 v[64:67], a[216:219], a[48:51], v[64:67]
v_mfma_f32_16x16x32_bf16 v[64:67], a[220:223], a[52:55], v[64:67]
ds_read_b128 a[240:243], v4 offset:39936
v_mfma_f32_16x16x32_bf16 v[68:71], a[216:219], a[120:123], v[68:71]
v_mfma_f32_16x16x32_bf16 v[68:71], a[220:223], a[124:127], v[68:71]
ds_read_b128 a[244:247], v4 offset:48128
s_waitcnt lgkmcnt(4)
v_mfma_f32_16x16x32_bf16 v[72:75], a[48:51], a[224:227], v[72:75]
v_mfma_f32_16x16x32_bf16 v[72:75], a[52:55], a[228:231], v[72:75]
ds_read_b128 a[216:219], v7 offset:32768
v_mfma_f32_16x16x32_bf16 v[76:79], a[120:123], a[224:227], v[76:79]
v_mfma_f32_16x16x32_bf16 v[76:79], a[124:127], a[228:231], v[76:79]
ds_read_b128 a[220:223], v7 offset:40960
s_waitcnt lgkmcnt(4)
v_mfma_f32_16x16x32_bf16 v[80:83], a[48:51], a[232:235], v[80:83]
v_mfma_f32_16x16x32_bf16 v[80:83], a[52:55], a[236:239], v[80:83]
ds_read_b128 a[224:227], v10 offset:32768
v_mfma_f32_16x16x32_bf16 v[84:87], a[120:123], a[232:235], v[84:87]
v_mfma_f32_16x16x32_bf16 v[84:87], a[124:127], a[236:239], v[84:87]
ds_read_b128 a[228:231], v10 offset:40960
s_waitcnt lgkmcnt(4)
v_mfma_f32_16x16x32_bf16 v[88:91], a[48:51], a[240:243], v[88:91]
v_mfma_f32_16x16x32_bf16 v[88:91], a[52:55], a[244:247], v[88:91]
ds_read_b128 a[232:235], v4 offset:49152
v_mfma_f32_16x16x32_bf16 v[92:95], a[120:123], a[240:243], v[92:95]
v_mfma_f32_16x16x32_bf16 v[92:95], a[124:127], a[244:247], v[92:95]
ds_read_b128 a[236:239], v4 offset:57344
s_waitcnt lgkmcnt(4)
v_mfma_f32_16x16x32_bf16 v[96:99], a[216:219], a[192:195], v[96:99]
ds_read_b128 a[240:243], v4 offset:50176
v_mfma_f32_16x16x32_bf16 v[96:99], a[220:223], a[196:199], v[96:99]
ds_read_b128 a[244:247], v4 offset:58368
s_waitcnt lgkmcnt(4)
v_mfma_f32_16x16x32_bf16 v[100:103], a[192:195], a[224:227], v[100:103]
ds_read_b128 a[216:219], v4 offset:51200
v_mfma_f32_16x16x32_bf16 v[100:103], a[196:199], a[228:231], v[100:103]
ds_read_b128 a[220:223], v4 offset:59392
s_waitcnt vmcnt(26)
s_waitcnt lgkmcnt(4)
v_mfma_f32_16x16x32_bf16 v[32:35], a[232:235], a[56:59], v[32:35]
v_mfma_f32_16x16x32_bf16 v[32:35], a[236:239], a[60:63], v[32:35]
ds_read_b128 a[224:227], v4 offset:52224
v_mfma_f32_16x16x32_bf16 v[36:39], a[232:235], a[128:131], v[36:39]
v_mfma_f32_16x16x32_bf16 v[36:39], a[236:239], a[132:135], v[36:39]
ds_read_b128 a[228:231], v4 offset:60416
s_waitcnt lgkmcnt(4)
v_mfma_f32_16x16x32_bf16 v[40:43], a[240:243], a[56:59], v[40:43]
v_mfma_f32_16x16x32_bf16 v[40:43], a[244:247], a[60:63], v[40:43]
ds_read_b128 a[232:235], v4 offset:53248
v_mfma_f32_16x16x32_bf16 v[44:47], a[240:243], a[128:131], v[44:47]
v_mfma_f32_16x16x32_bf16 v[44:47], a[244:247], a[132:135], v[44:47]
ds_read_b128 a[236:239], v4 offset:61440
s_waitcnt lgkmcnt(4)
v_mfma_f32_16x16x32_bf16 v[48:51], a[216:219], a[56:59], v[48:51]
v_mfma_f32_16x16x32_bf16 v[48:51], a[220:223], a[60:63], v[48:51]
ds_read_b128 a[240:243], v4 offset:54272
v_mfma_f32_16x16x32_bf16 v[52:55], a[216:219], a[128:131], v[52:55]
v_mfma_f32_16x16x32_bf16 v[52:55], a[220:223], a[132:135], v[52:55]
ds_read_b128 a[244:247], v4 offset:62464
s_waitcnt lgkmcnt(4)
v_mfma_f32_16x16x32_bf16 v[56:59], a[224:227], a[56:59], v[56:59]
v_mfma_f32_16x16x32_bf16 v[56:59], a[228:231], a[60:63], v[56:59]
ds_read_b128 a[216:219], v4 offset:55296
v_mfma_f32_16x16x32_bf16 v[60:63], a[224:227], a[128:131], v[60:63]
v_mfma_f32_16x16x32_bf16 v[60:63], a[228:231], a[132:135], v[60:63]
ds_read_b128 a[220:223], v4 offset:63488
s_waitcnt lgkmcnt(4)
v_mfma_f32_16x16x32_bf16 v[64:67], a[232:235], a[56:59], v[64:67]
v_mfma_f32_16x16x32_bf16 v[64:67], a[236:239], a[60:63], v[64:67]
ds_read_b128 a[224:227], v4 offset:56320
v_mfma_f32_16x16x32_bf16 v[68:71], a[232:235], a[128:131], v[68:71]
v_mfma_f32_16x16x32_bf16 v[68:71], a[236:239], a[132:135], v[68:71]
ds_read_b128 a[228:231], v4 offset:64512
s_waitcnt lgkmcnt(4)
v_mfma_f32_16x16x32_bf16 v[72:75], a[56:59], a[240:243], v[72:75]
v_mfma_f32_16x16x32_bf16 v[72:75], a[60:63], a[244:247], v[72:75]
ds_read_b128 a[232:235], v7 offset:49152
v_mfma_f32_16x16x32_bf16 v[76:79], a[128:131], a[240:243], v[76:79]
v_mfma_f32_16x16x32_bf16 v[76:79], a[132:135], a[244:247], v[76:79]
ds_read_b128 a[236:239], v7 offset:57344
s_waitcnt lgkmcnt(4)
v_mfma_f32_16x16x32_bf16 v[80:83], a[56:59], a[216:219], v[80:83]
v_mfma_f32_16x16x32_bf16 v[80:83], a[60:63], a[220:223], v[80:83]
ds_read_b128 a[240:243], v10 offset:49152
v_mfma_f32_16x16x32_bf16 v[84:87], a[128:131], a[216:219], v[84:87]
v_mfma_f32_16x16x32_bf16 v[84:87], a[132:135], a[220:223], v[84:87]
ds_read_b128 a[244:247], v10 offset:57344
s_waitcnt lgkmcnt(4)
v_mfma_f32_16x16x32_bf16 v[88:91], a[56:59], a[224:227], v[88:91]
v_mfma_f32_16x16x32_bf16 v[88:91], a[60:63], a[228:231], v[88:91]
ds_read_b128 a[216:219], v5 offset:0
v_mfma_f32_16x16x32_bf16 v[92:95], a[128:131], a[224:227], v[92:95]
v_mfma_f32_16x16x32_bf16 v[92:95], a[132:135], a[228:231], v[92:95]
ds_read_b128 a[220:223], v5 offset:8192
s_waitcnt lgkmcnt(4)
v_mfma_f32_16x16x32_bf16 v[96:99], a[232:235], a[200:203], v[96:99]
ds_read_b128 a[224:227], v5 offset:1024
v_mfma_f32_16x16x32_bf16 v[96:99], a[236:239], a[204:207], v[96:99]
ds_read_b128 a[228:231], v5 offset:9216
s_waitcnt lgkmcnt(4)
v_mfma_f32_16x16x32_bf16 v[100:103], a[200:203], a[240:243], v[100:103]
ds_read_b128 a[232:235], v5 offset:2048
v_mfma_f32_16x16x32_bf16 v[100:103], a[204:207], a[244:247], v[100:103]
ds_read_b128 a[236:239], v5 offset:10240
s_waitcnt vmcnt(20)
s_waitcnt lgkmcnt(4)
v_mfma_f32_16x16x32_bf16 v[32:35], a[216:219], a[64:67], v[32:35]
v_mfma_f32_16x16x32_bf16 v[32:35], a[220:223], a[68:71], v[32:35]
ds_read_b128 a[240:243], v5 offset:3072
v_mfma_f32_16x16x32_bf16 v[36:39], a[216:219], a[136:139], v[36:39]
v_mfma_f32_16x16x32_bf16 v[36:39], a[220:223], a[140:143], v[36:39]
ds_read_b128 a[244:247], v5 offset:11264
s_waitcnt lgkmcnt(4)
v_mfma_f32_16x16x32_bf16 v[40:43], a[224:227], a[64:67], v[40:43]
v_mfma_f32_16x16x32_bf16 v[40:43], a[228:231], a[68:71], v[40:43]
ds_read_b128 a[216:219], v5 offset:4096
v_mfma_f32_16x16x32_bf16 v[44:47], a[224:227], a[136:139], v[44:47]
v_mfma_f32_16x16x32_bf16 v[44:47], a[228:231], a[140:143], v[44:47]
ds_read_b128 a[220:223], v5 offset:12288
s_waitcnt lgkmcnt(4)
v_mfma_f32_16x16x32_bf16 v[48:51], a[232:235], a[64:67], v[48:51]
v_mfma_f32_16x16x32_bf16 v[48:51], a[236:239], a[68:71], v[48:51]
ds_read_b128 a[224:227], v5 offset:5120
v_mfma_f32_16x16x32_bf16 v[52:55], a[232:235], a[136:139], v[52:55]
v_mfma_f32_16x16x32_bf16 v[52:55], a[236:239], a[140:143], v[52:55]
ds_read_b128 a[228:231], v5 offset:13312
s_waitcnt lgkmcnt(4)
v_mfma_f32_16x16x32_bf16 v[56:59], a[240:243], a[64:67], v[56:59]
v_mfma_f32_16x16x32_bf16 v[56:59], a[244:247], a[68:71], v[56:59]
ds_read_b128 a[232:235], v5 offset:6144
v_mfma_f32_16x16x32_bf16 v[60:63], a[240:243], a[136:139], v[60:63]
v_mfma_f32_16x16x32_bf16 v[60:63], a[244:247], a[140:143], v[60:63]
ds_read_b128 a[236:239], v5 offset:14336
s_waitcnt lgkmcnt(4)
v_mfma_f32_16x16x32_bf16 v[64:67], a[216:219], a[64:67], v[64:67]
v_mfma_f32_16x16x32_bf16 v[64:67], a[220:223], a[68:71], v[64:67]
ds_read_b128 a[240:243], v5 offset:7168
v_mfma_f32_16x16x32_bf16 v[68:71], a[216:219], a[136:139], v[68:71]
v_mfma_f32_16x16x32_bf16 v[68:71], a[220:223], a[140:143], v[68:71]
ds_read_b128 a[244:247], v5 offset:15360
s_waitcnt lgkmcnt(4)
v_mfma_f32_16x16x32_bf16 v[72:75], a[64:67], a[224:227], v[72:75]
v_mfma_f32_16x16x32_bf16 v[72:75], a[68:71], a[228:231], v[72:75]
ds_read_b128 a[216:219], v8 offset:0
v_mfma_f32_16x16x32_bf16 v[76:79], a[136:139], a[224:227], v[76:79]
v_mfma_f32_16x16x32_bf16 v[76:79], a[140:143], a[228:231], v[76:79]
ds_read_b128 a[220:223], v8 offset:8192
s_waitcnt lgkmcnt(4)
v_mfma_f32_16x16x32_bf16 v[80:83], a[64:67], a[232:235], v[80:83]
v_mfma_f32_16x16x32_bf16 v[80:83], a[68:71], a[236:239], v[80:83]
ds_read_b128 a[224:227], v11 offset:0
v_mfma_f32_16x16x32_bf16 v[84:87], a[136:139], a[232:235], v[84:87]
v_mfma_f32_16x16x32_bf16 v[84:87], a[140:143], a[236:239], v[84:87]
ds_read_b128 a[228:231], v11 offset:8192
s_waitcnt lgkmcnt(4)
v_mfma_f32_16x16x32_bf16 v[88:91], a[64:67], a[240:243], v[88:91]
v_mfma_f32_16x16x32_bf16 v[88:91], a[68:71], a[244:247], v[88:91]
v_mfma_f32_16x16x32_bf16 v[92:95], a[136:139], a[240:243], v[92:95]
v_mfma_f32_16x16x32_bf16 v[92:95], a[140:143], a[244:247], v[92:95]
s_waitcnt lgkmcnt(2)
v_mfma_f32_16x16x32_bf16 v[96:99], a[216:219], a[208:211], v[96:99]
v_mfma_f32_16x16x32_bf16 v[96:99], a[220:223], a[212:215], v[96:99]
s_waitcnt lgkmcnt(0)
v_mfma_f32_16x16x32_bf16 v[100:103], a[208:211], a[224:227], v[100:103]
v_mfma_f32_16x16x32_bf16 v[100:103], a[212:215], a[228:231], v[100:103]
L_att:
v_cvt_pk_bf16_f32 v116, v52, v53
v_cvt_pk_bf16_f32 v117, v54, v55
v_cvt_pk_bf16_f32 v120, v60, v61
v_cvt_pk_bf16_f32 v121, v62, v63
v_cvt_pk_bf16_f32 v160, v68, v69
v_cvt_pk_bf16_f32 v161, v70, v71
v_cvt_pk_bf16_f32 v126, v76, v77
v_cvt_pk_bf16_f32 v127, v78, v79
v_cvt_pk_bf16_f32 v132, v84, v85
v_cvt_pk_bf16_f32 v133, v86, v87
v_cvt_pk_bf16_f32 v138, v92, v93
v_cvt_pk_bf16_f32 v139, v94, v95
v_cvt_pk_bf16_f32 v156, v96, v97
v_cvt_pk_bf16_f32 v157, v98, v99
v_cvt_pk_bf16_f32 v158, v100, v101
v_cvt_pk_bf16_f32 v159, v102, v103
v_lshlrev_b32 v14, 3, v1
s_mul_i32 s31, s4, 3072
s_add_u32 s32, s31, 147456
v_add_u32 v15, s32, v14
s_lshl_b32 s33, s29, 9
s_add_u32 s33, s33, 147456
v_add_u32 v16, s33, v14
s_cmp_eq_u32 s4, 3
s_cbranch_scc1 L_a1_noxch
ds_write_b64 v16, v[156:157]
ds_write_b64 v16, v[158:159] offset:1536
ds_write_b64 v15, v[116:117] offset:3072
ds_write_b64 v15, v[120:121] offset:3584
ds_write_b64 v15, v[160:161] offset:4096
ds_write_b64 v15, v[126:127] offset:4608
ds_write_b64 v15, v[132:133] offset:5120
ds_write_b64 v15, v[138:139] offset:5632
L_a1_noxch:
v_cvt_pk_bf16_f32 v110, v48, v49
v_cvt_pk_bf16_f32 v111, v50, v51
v_cvt_pk_bf16_f32 v114, v56, v57
v_cvt_pk_bf16_f32 v115, v58, v59
v_cvt_pk_bf16_f32 v124, v72, v73
v_cvt_pk_bf16_f32 v125, v74, v75
v_cvt_pk_bf16_f32 v130, v80, v81
v_cvt_pk_bf16_f32 v131, v82, v83
v_cvt_pk_bf16_f32 v136, v88, v89
v_cvt_pk_bf16_f32 v137, v90, v91
v_cvt_pk_bf16_f32 v140, v32, v33
v_cvt_pk_bf16_f32 v141, v34, v35
v_cvt_pk_bf16_f32 v146, v40, v41
v_cvt_pk_bf16_f32 v147, v42, v43
v_cvt_pk_bf16_f32 v142, v64, v65
v_cvt_pk_bf16_f32 v145, v66, v67
v_mov_b32 v143, 0
v_mov_b32 v144, 0
v_mov_b32 v112, 0
v_mov_b32 v113, 0
s_nop 0
v_permlane16_swap_b32 v142, v112
v_permlane16_swap_b32 v145, v113
v_cvt_pk_bf16_f32 v148, v36, v37
v_cvt_pk_bf16_f32 v149, v38, v39
v_cvt_pk_bf16_f32 v154, v44, v45
v_cvt_pk_bf16_f32 v155, v46, v47
v_cvt_pk_bf16_f32 v150, v68, v69
v_cvt_pk_bf16_f32 v153, v70, v71
v_mov_b32 v151, 0
v_mov_b32 v152, 0
v_mov_b32 v118, 0
v_mov_b32 v119, 0
s_nop 0
v_permlane16_swap_b32 v150, v118
v_permlane16_swap_b32 v153, v119
v_add_u32 v17, 16, v12
v_add_u32 v18, 32, v12
v_cmp_gt_u32 vcc, 16, v1
s_nop 1
v_cndmask_b32 v17, v18, v17, vcc
v_lshlrev_b32 v17, 3, v17
v_add_u32 v17, s32, v17
s_waitcnt lgkmcnt(0)
s_barrier
s_and_b32 s37, s6, 7
s_mul_i32 s37, s37, 92160
s_mul_i32 s38, s4, 23552
s_add_u32 s37, s37, s38
s_add_u32 s37, s37, 6557696
ds_read_b64 v[104:105], v15
ds_read_b64 v[108:109], v15 offset:512
ds_read_b64 v[106:107], v17 offset:1024
ds_read_b64 v[122:123], v15 offset:1536
ds_read_b64 v[128:129], v15 offset:2048
ds_read_b64 v[134:135], v15 offset:2560
v_mfma_f32_16x16x32_bf16 v[32:35], v[110:113], v[148:151], 0
v_mfma_f32_16x16x32_bf16 v[36:39], v[116:119], v[148:151], 0
v_mfma_f32_16x16x32_bf16 v[40:43], v[112:115], v[152:155], 0
v_mfma_f32_16x16x32_bf16 v[44:47], v[118:121], v[152:155], 0
s_waitcnt lgkmcnt(0)
v_mfma_f32_16x16x32_bf16 v[48:51], v[104:107], v[140:143], 0
v_mfma_f32_16x16x32_bf16 v[52:55], v[110:113], v[140:143], 0
v_mfma_f32_16x16x32_bf16 v[56:59], v[106:109], v[144:147], 0
v_mfma_f32_16x16x32_bf16 v[60:63], v[112:115], v[144:147], 0
v_mov_b32 v18, 0xff61b1e6
s_mov_b32 s34, 0x3eae1a93
v_cndmask_b32 v32, v18, v32, s[44:45]
v_cndmask_b32 v40, v18, v40, s[44:45]
s_nop 0
v_cndmask_b32 v48, v18, v48, s[60:61]
s_nop 0
v_cndmask_b32 v56, v18, v56, s[60:61]
v_cndmask_b32 v33, v18, v33, s[46:47]
v_cndmask_b32 v41, v18, v41, s[46:47]
v_cndmask_b32 v49, v18, v49, s[62:63]
v_cndmask_b32 v57, v18, v57, s[62:63]
v_cndmask_b32 v34, v18, v34, s[48:49]
v_cndmask_b32 v42, v18, v42, s[48:49]
v_cndmask_b32 v50, v18, v50, s[64:65]
v_cndmask_b32 v58, v18, v58, s[64:65]
v_cndmask_b32 v35, v18, v35, s[50:51]
v_cndmask_b32 v43, v18, v43, s[50:51]
v_cndmask_b32 v51, v18, v51, s[66:67]
v_cndmask_b32 v59, v18, v59, s[66:67]
v_cndmask_b32 v36, v18, v36, s[52:53]
v_cndmask_b32 v44, v18, v44, s[52:53]
v_cndmask_b32 v52, v18, v52, s[52:53]
v_cndmask_b32 v60, v18, v60, s[52:53]
v_cndmask_b32 v37, v18, v37, s[54:55]
v_cndmask_b32 v45, v18, v45, s[54:55]
v_cndmask_b32 v53, v18, v53, s[54:55]
v_cndmask_b32 v61, v18, v61, s[54:55]
v_cndmask_b32 v38, v18, v38, s[56:57]
v_cndmask_b32 v46, v18, v46, s[56:57]
v_cndmask_b32 v54, v18, v54, s[56:57]
v_cndmask_b32 v62, v18, v62, s[56:57]
v_cndmask_b32 v39, v18, v39, s[58:59]
v_cndmask_b32 v47, v18, v47, s[58:59]
v_cndmask_b32 v55, v18, v55, s[58:59]
v_cndmask_b32 v63, v18, v63, s[58:59]
v_max3_f32 v20, v32, v33, v34
v_max3_f32 v21, v40, v41, v42
v_max3_f32 v22, v48, v49, v50
v_max3_f32 v23, v56, v57, v58
v_max3_f32 v20, v20, v35, v36
v_max3_f32 v21, v21, v43, v44
v_max3_f32 v22, v22, v51, v52
v_max3_f32 v23, v23, v59, v60
v_max3_f32 v20, v20, v37, v38
v_max3_f32 v21, v21, v45, v46
v_max3_f32 v22, v22, v53, v54
v_max3_f32 v23, v23, v61, v62
v_max_f32 v20, v20, v39
v_max_f32 v21, v21, v47
v_max_f32 v22, v22, v55
v_max_f32 v23, v23, v63
v_mov_b32 v24, v20
v_mov_b32 v25, v21
v_mov_b32 v26, v22
v_mov_b32 v27, v23
v_permlane16_swap_b32 v20, v24
v_permlane16_swap_b32 v21, v25
v_permlane16_swap_b32 v22, v26
v_permlane16_swap_b32 v23, v27
v_max_f32 v20, v20, v24
v_max_f32 v21, v21, v25
v_max_f32 v22, v22, v26
v_max_f32 v23, v23, v27
v_mov_b32 v24, v20
v_mov_b32 v25, v21
v_mov_b32 v26, v22
v_mov_b32 v27, v23
v_permlane32_swap_b32 v20, v24
v_permlane32_swap_b32 v21, v25
v_permlane32_swap_b32 v22, v26
v_permlane32_swap_b32 v23, v27
v_max_f32 v20, v20, v24
v_max_f32 v21, v21, v25
v_max_f32 v22, v22, v26
v_max_f32 v23, v23, v27
v_mul_f32 v20, s34, v20
v_mul_f32 v21, s34, v21
v_mul_f32 v22, s34, v22
v_mul_f32 v23, s34, v23
v_fma_f32 v32, v32, s34, -v20
v_fma_f32 v40, v40, s34, -v21
v_fma_f32 v48, v48, s34, -v22
v_fma_f32 v56, v56, s34, -v23
v_exp_f32 v32, v32
v_exp_f32 v40, v40
v_exp_f32 v48, v48
v_exp_f32 v56, v56
v_fma_f32 v33, v33, s34, -v20
v_fma_f32 v41, v41, s34, -v21
v_fma_f32 v49, v49, s34, -v22
v_fma_f32 v57, v57, s34, -v23
v_exp_f32 v33, v33
v_exp_f32 v41, v41
v_exp_f32 v49, v49
v_exp_f32 v57, v57
v_fma_f32 v34, v34, s34, -v20
v_fma_f32 v42, v42, s34, -v21
v_fma_f32 v50, v50, s34, -v22
v_fma_f32 v58, v58, s34, -v23
v_exp_f32 v34, v34
v_exp_f32 v42, v42
v_exp_f32 v50, v50
v_exp_f32 v58, v58
v_fma_f32 v35, v35, s34, -v20
v_fma_f32 v43, v43, s34, -v21
v_fma_f32 v51, v51, s34, -v22
v_fma_f32 v59, v59, s34, -v23
v_exp_f32 v35, v35
v_exp_f32 v43, v43
v_exp_f32 v51, v51
v_exp_f32 v59, v59
v_fma_f32 v36, v36, s34, -v20
v_fma_f32 v44, v44, s34, -v21
v_fma_f32 v52, v52, s34, -v22
v_fma_f32 v60, v60, s34, -v23
v_exp_f32 v36, v36
v_exp_f32 v44, v44
v_exp_f32 v52, v52
v_exp_f32 v60, v60
v_fma_f32 v37, v37, s34, -v20
v_fma_f32 v45, v45, s34, -v21
v_fma_f32 v53, v53, s34, -v22
v_fma_f32 v61, v61, s34, -v23
v_exp_f32 v37, v37
v_exp_f32 v45, v45
v_exp_f32 v53, v53
v_exp_f32 v61, v61
v_fma_f32 v38, v38, s34, -v20
v_fma_f32 v46, v46, s34, -v21
v_fma_f32 v54, v54, s34, -v22
v_fma_f32 v62, v62, s34, -v23
v_exp_f32 v38, v38
v_exp_f32 v46, v46
v_exp_f32 v54, v54
v_exp_f32 v62, v62
v_fma_f32 v39, v39, s34, -v20
v_fma_f32 v47, v47, s34, -v21
v_fma_f32 v55, v55, s34, -v22
v_fma_f32 v63, v63, s34, -v23
v_exp_f32 v39, v39
v_exp_f32 v47, v47
v_exp_f32 v55, v55
v_exp_f32 v63, v63
v_add_f32 v28, v32, v33
v_add_f32 v29, v40, v41
v_add_f32 v30, v48, v49
v_add_f32 v31, v56, v57
v_add_f32 v28, v28, v34
v_add_f32 v29, v29, v42
v_add_f32 v30, v30, v50
v_add_f32 v31, v31, v58
v_add_f32 v28, v28, v35
v_add_f32 v29, v29, v43
v_add_f32 v30, v30, v51
v_add_f32 v31, v31, v59
v_add_f32 v28, v28, v36
v_add_f32 v29, v29, v44
v_add_f32 v30, v30, v52
v_add_f32 v31, v31, v60
v_add_f32 v28, v28, v37
v_add_f32 v29, v29, v45
v_add_f32 v30, v30, v53
v_add_f32 v31, v31, v61
v_add_f32 v28, v28, v38
v_add_f32 v29, v29, v46
v_add_f32 v30, v30, v54
v_add_f32 v31, v31, v62
v_add_f32 v28, v28, v39
v_add_f32 v29, v29, v47
v_add_f32 v30, v30, v55
v_add_f32 v31, v31, v63
v_mov_b32 v24, v28
v_mov_b32 v25, v29
v_mov_b32 v26, v30
v_mov_b32 v27, v31
v_permlane16_swap_b32 v28, v24
v_permlane16_swap_b32 v29, v25
v_permlane16_swap_b32 v30, v26
v_permlane16_swap_b32 v31, v27
v_add_f32 v28, v28, v24
v_add_f32 v29, v29, v25
v_add_f32 v30, v30, v26
v_add_f32 v31, v31, v27
v_mov_b32 v24, v28
v_mov_b32 v25, v29
v_mov_b32 v26, v30
v_mov_b32 v27, v31
v_permlane32_swap_b32 v28, v24
v_permlane32_swap_b32 v29, v25
v_permlane32_swap_b32 v30, v26
v_permlane32_swap_b32 v31, v27
v_add_f32 v28, v28, v24
v_add_f32 v29, v29, v25
v_add_f32 v30, v30, v26
v_add_f32 v31, v31, v27
v_rcp_f32 v28, v28
v_rcp_f32 v29, v29
v_rcp_f32 v30, v30
v_rcp_f32 v31, v31
v_mul_f32 v32, v32, v28
v_mul_f32 v40, v40, v29
v_mul_f32 v48, v48, v30
v_mul_f32 v56, v56, v31
v_mul_f32 v33, v33, v28
v_mul_f32 v41, v41, v29
v_mul_f32 v49, v49, v30
v_mul_f32 v57, v57, v31
v_mul_f32 v34, v34, v28
v_mul_f32 v42, v42, v29
v_mul_f32 v50, v50, v30
v_mul_f32 v58, v58, v31
v_mul_f32 v35, v35, v28
v_mul_f32 v43, v43, v29
v_mul_f32 v51, v51, v30
v_mul_f32 v59, v59, v31
v_mul_f32 v36, v36, v28
v_mul_f32 v44, v44, v29
v_mul_f32 v52, v52, v30
v_mul_f32 v60, v60, v31
v_mul_f32 v37, v37, v28
v_mul_f32 v45, v45, v29
v_mul_f32 v53, v53, v30
v_mul_f32 v61, v61, v31
v_mul_f32 v38, v38, v28
v_mul_f32 v46, v46, v29
v_mul_f32 v54, v54, v30
v_mul_f32 v62, v62, v31
v_mul_f32 v39, v39, v28
v_mul_f32 v47, v47, v29
v_mul_f32 v55, v55, v30
v_mul_f32 v63, v63, v31
v_cvt_pk_bf16_f32 v64, v32, v33
v_cvt_pk_bf16_f32 v65, v34, v35
v_cvt_pk_bf16_f32 v66, v36, v37
v_cvt_pk_bf16_f32 v67, v38, v39
v_cvt_pk_bf16_f32 v68, v40, v41
v_cvt_pk_bf16_f32 v69, v42, v43
v_cvt_pk_bf16_f32 v70, v44, v45
v_cvt_pk_bf16_f32 v71, v46, v47
v_cvt_pk_bf16_f32 v72, v48, v49
v_cvt_pk_bf16_f32 v73, v50, v51
v_cvt_pk_bf16_f32 v74, v52, v53
v_cvt_pk_bf16_f32 v75, v54, v55
v_cvt_pk_bf16_f32 v76, v56, v57
v_cvt_pk_bf16_f32 v77, v58, v59
v_cvt_pk_bf16_f32 v78, v60, v61
v_cvt_pk_bf16_f32 v79, v62, v63
v_mfma_f32_16x16x32_bf16 v[80:83], v[124:127], v[64:67], 0
v_mfma_f32_16x16x32_bf16 v[84:87], v[136:139], v[64:67], 0
v_mfma_f32_16x16x32_bf16 v[88:91], v[130:133], v[68:71], 0
v_mfma_f32_16x16x32_bf16 v[92:95], v[136:139], v[68:71], 0
v_mfma_f32_16x16x32_bf16 v[96:99], v[122:125], v[72:75], 0
v_mfma_f32_16x16x32_bf16 v[100:103], v[134:137], v[72:75], 0
v_mfma_f32_16x16x32_bf16 v[164:167], v[128:131], v[76:79], 0
v_mfma_f32_16x16x32_bf16 v[168:171], v[134:137], v[76:79], 0
v_lshlrev_b32 v14, 3, v12
v_mov_b32 v15, 2146435072
v_cmp_gt_u32 vcc, 16, v1
s_nop 1
v_cndmask_b32 v14, v15, v14, vcc
s_add_u32 s26, s24, s72
s_lshl_b32 s27, s21, 10
s_add_u32 s27, s27, s26
s_lshl_b32 s28, s21, 7
s_add_u32 s28, s28, 16384
s_add_u32 s28, s28, s26
s_add_u32 s30, s27, 18432
s_add_u32 s31, s28, 18432
v_cvt_pk_bf16_f32 v180, v80, v81
v_cvt_pk_bf16_f32 v181, v82, v83
v_cvt_pk_bf16_f32 v182, v88, v89
v_cvt_pk_bf16_f32 v183, v90, v91
v_cvt_pk_bf16_f32 v184, v84, v85
v_cvt_pk_bf16_f32 v185, v94, v95
buffer_store_dwordx4 v[180:183], v2, s[8:11], s30 offen sc1
buffer_store_dwordx2 v[184:185], v14, s[8:11], s31 offen sc1
v_cvt_pk_bf16_f32 v172, v96, v97
v_cvt_pk_bf16_f32 v173, v98, v99
v_cvt_pk_bf16_f32 v174, v164, v165
v_cvt_pk_bf16_f32 v175, v166, v167
v_cvt_pk_bf16_f32 v176, v100, v101
v_cvt_pk_bf16_f32 v177, v170, v171
buffer_store_dwordx4 v[172:175], v2, s[8:11], s27 offen sc1
buffer_store_dwordx2 v[176:177], v14, s[8:11], s28 offen sc1
s_lshl_b32 s26, s20, 4
s_add_u32 s26, s26, s21
s_lshl_b32 s14, s26, 7
s_add_u32 s14, s14, 393216
s_add_u32 s14, s14, s77
s_lshr_b32 s20, s6, 3
s_lshl_b32 s21, s5, 2
s_add_u32 s20, s20, s21
s_lshl_b32 s20, s20, 2
s_add_u32 s20, s20, s4
s_and_b32 s21, s6, 7
s_mul_i32 s24, s20, 18432
s_add_u32 s25, s24, s72
s_mul_i32 s26, s21, 2304
s_add_u32 s26, s26, s24
s_add_u32 s27, s26, s71
v_and_b32 v6, 15, v1
v_lshrrev_b32 v7, 4, v1
v_lshlrev_b32 v8, 4, v6
v_lshl_add_u32 v8, v7, 3, v8
v_add_u32 v8, 2048, v8
v_mov_b32 v9, 2146435072
v_cmp_gt_u32 vcc, 32, v1
s_nop 1
v_cndmask_b32 v4, v9, v8, vcc
v_add_u32 v5, 0x10000, v2
s_and_b32 s40, s5, 1
s_lshl_b32 s40, s40, 2
s_lshr_b32 s41, s6, 3
s_add_u32 s40, s40, s41
s_lshr_b32 s41, s5, 1
s_lshl_b32 s41, s41, 3
s_and_b32 s42, s6, 7
s_add_u32 s41, s41, s42
s_lshr_b32 s42, s41, 2
s_and_b32 s43, s41, 3
s_lshr_b32 s22, s20, 3
s_lshl_b32 s22, s22, 4
v_add_u32 v10, s22, v6
v_subrev_u32 v12, 16, v1
v_min_u32 v12, 26, v12
v_mul_u32_u24 v16, 57, v12
v_lshrrev_b32 v16, 9, v16
v_mad_u32_u24 v12, v16, 63, v12
s_mul_i32 s22, s42, 9
v_add_u32 v12, s22, v12
v_and_b32 v16, 7, v12
v_lshrrev_b32 v12, 3, v12
v_lshrrev_b32 v17, 2, v16
v_lshlrev_b32 v17, 3, v17
v_lshrrev_b32 v18, 2, v12
v_add_lshl_u32 v17, v17, v18, 4
v_and_b32 v16, 3, v16
v_lshl_add_u32 v17, v16, 2, v17
v_and_b32 v12, 3, v12
v_add_u32 v17, v17, v12
s_cmp_eq_u32 s7, 0
s_cselect_b32 s22, 16, 64
v_cmp_le_u32 vcc, s22, v1
s_nop 1
v_cndmask_b32 v10, v10, v17, vcc
v_lshlrev_b32 v10, 7, v10
s_add_u32 s22, s77, 393216
v_lshlrev_b32 v11, 3, v6
v_lshl_add_u32 v11, v7, 8, v11
v_mov_b32 v13, 2146435072
v_cmp_gt_u32 vcc, 16, v0
v_lshlrev_b32 v14, 3, v0
s_nop 0
v_cndmask_b32 v13, v13, v14, vcc
v_mov_b32 v14, s68
v_mov_b32 v15, s69
s_waitcnt vmcnt(0)
s_barrier
buffer_store_dwordx2 v[14:15], v13, s[8:11], s14 offen sc1
s_add_u32 m0, s38, 0
s_add_u32 s39, s37, 0
buffer_load_dwordx4 v2, s[8:11], s39 offen offset:0 sc1 lds
buffer_load_dwordx4 v2, s[8:11], s39 offen offset:1024 sc1 lds
buffer_load_dwordx4 v2, s[8:11], s39 offen offset:2048 sc1 lds
buffer_load_dwordx4 v2, s[8:11], s39 offen offset:3072 sc1 lds
s_add_u32 m0, s38, 4096
s_add_u32 s39, s37, 4096
buffer_load_dwordx4 v2, s[8:11], s39 offen offset:0 sc1 lds
buffer_load_dwordx4 v2, s[8:11], s39 offen offset:1024 sc1 lds
buffer_load_dwordx4 v2, s[8:11], s39 offen offset:2048 sc1 lds
buffer_load_dwordx4 v2, s[8:11], s39 offen offset:3072 sc1 lds
s_add_u32 m0, s38, 8192
s_add_u32 s39, s37, 8192
buffer_load_dwordx4 v2, s[8:11], s39 offen offset:0 sc1 lds
buffer_load_dwordx4 v2, s[8:11], s39 offen offset:1024 sc1 lds
buffer_load_dwordx4 v2, s[8:11], s39 offen offset:2048 sc1 lds
buffer_load_dwordx4 v2, s[8:11], s39 offen offset:3072 sc1 lds
s_add_u32 m0, s38, 12288
s_add_u32 s39, s37, 12288
buffer_load_dwordx4 v2, s[8:11], s39 offen offset:0 sc1 lds
buffer_load_dwordx4 v2, s[8:11], s39 offen offset:1024 sc1 lds
buffer_load_dwordx4 v2, s[8:11], s39 offen offset:2048 sc1 lds
buffer_load_dwordx4 v2, s[8:11], s39 offen offset:3072 sc1 lds
s_add_u32 m0, s38, 16384
s_add_u32 s39, s37, 16384
buffer_load_dwordx4 v2, s[8:11], s39 offen offset:0 sc1 lds
buffer_load_dwordx4 v2, s[8:11], s39 offen offset:1024 sc1 lds
buffer_load_dwordx4 v2, s[8:11], s39 offen offset:2048 sc1 lds
buffer_load_dwordx4 v2, s[8:11], s39 offen offset:3072 sc1 lds
s_add_u32 m0, s38, 20480
s_add_u32 s39, s37, 20480
buffer_load_dwordx4 v2, s[8:11], s39 offen offset:0 sc1 lds
buffer_load_dwordx4 v2, s[8:11], s39 offen offset:1024 sc1 lds
buffer_load_dwordx4 v2, s[8:11], s39 offen offset:2048 sc1 lds
s_mov_b32 s52, 0
L_poll2:
buffer_load_dwordx2 v[14:15], v10, s[8:11], s22 offen sc1
s_add_u32 s52, s52, 1
s_waitcnt vmcnt(0)
v_cmp_ne_u64 vcc, s[68:69], v[14:15]
s_cmp_ge_u32 s52, 1048576
s_cbranch_scc1 L_got2
s_and_b64 exec, exec, vcc
s_cbranch_execnz L_poll2
L_got2:
s_mov_b64 exec, -1
buffer_load_dwordx4 a[0:3], v2, s[8:11], s25 offen offset:0 sc1
buffer_load_dwordx4 a[4:7], v2, s[8:11], s25 offen offset:1024 sc1
buffer_load_dwordx4 a[8:11], v2, s[8:11], s25 offen offset:2048 sc1
buffer_load_dwordx4 a[12:15], v2, s[8:11], s25 offen offset:3072 sc1
s_add_u32 s25, s25, 4096
buffer_load_dwordx4 a[16:19], v2, s[8:11], s25 offen offset:0 sc1
buffer_load_dwordx4 a[20:23], v2, s[8:11], s25 offen offset:1024 sc1
buffer_load_dwordx4 a[24:27], v2, s[8:11], s25 offen offset:2048 sc1
buffer_load_dwordx4 a[28:31], v2, s[8:11], s25 offen offset:3072 sc1
s_add_u32 s25, s25, 4096
buffer_load_dwordx4 a[32:35], v2, s[8:11], s25 offen offset:0 sc1
buffer_load_dwordx4 a[36:39], v2, s[8:11], s25 offen offset:1024 sc1
buffer_load_dwordx4 a[40:43], v2, s[8:11], s25 offen offset:2048 sc1
buffer_load_dwordx4 a[44:47], v2, s[8:11], s25 offen offset:3072 sc1
s_barrier
ds_read_b128 a[216:219], v2 offset:0
ds_read_b128 a[220:223], v2 offset:5120
ds_read_b128 a[224:227], v2 offset:1024
ds_read_b128 a[228:231], v2 offset:6144
ds_read_b128 a[232:235], v2 offset:2048
ds_read_b128 a[236:239], v2 offset:7168
s_mul_i32 s22, s4, 6144
s_mul_i32 s23, s41, 497664
s_add_u32 s23, s23, s22
s_add_u32 s23, s23, 7303168
v_add_u32 v3, s23, v2
s_waitcnt vmcnt(10)
s_waitcnt lgkmcnt(4)
v_mfma_f32_16x16x32_bf16 v[32:35], a[216:219], a[0:3], 0
ds_read_b128 a[240:243], v2 offset:3072
v_mfma_f32_16x16x32_bf16 v[32:35], a[220:223], a[4:7], v[32:35]
ds_read_b128 a[244:247], v2 offset:8192
s_add_u32 s25, s25, 4096
buffer_load_dwordx4 a[48:51], v2, s[8:11], s25 offen offset:0 sc1
s_waitcnt lgkmcnt(4)
v_mfma_f32_16x16x32_bf16 v[36:39], a[224:227], a[0:3], 0
ds_read_b128 a[216:219], v2 offset:4096
v_mfma_f32_16x16x32_bf16 v[36:39], a[228:231], a[4:7], v[36:39]
ds_read_b128 a[220:223], v2 offset:9216
s_waitcnt lgkmcnt(4)
v_mfma_f32_16x16x32_bf16 v[40:43], a[232:235], a[0:3], 0
ds_read_b128 a[224:227], v2 offset:10240
v_mfma_f32_16x16x32_bf16 v[40:43], a[236:239], a[4:7], v[40:43]
ds_read_b128 a[228:231], v2 offset:15360
buffer_load_dwordx4 a[52:55], v2, s[8:11], s25 offen offset:1024 sc1
s_waitcnt lgkmcnt(4)
v_mfma_f32_16x16x32_bf16 v[44:47], a[240:243], a[0:3], 0
ds_read_b128 a[232:235], v2 offset:11264
v_mfma_f32_16x16x32_bf16 v[44:47], a[244:247], a[4:7], v[44:47]
ds_read_b128 a[236:239], v2 offset:16384
s_waitcnt lgkmcnt(4)
v_mfma_f32_16x16x32_bf16 v[48:51], a[216:219], a[0:3], 0
ds_read_b128 a[240:243], v2 offset:12288
v_mfma_f32_16x16x32_bf16 v[48:51], a[220:223], a[4:7], v[48:51]
ds_read_b128 a[244:247], v2 offset:17408
buffer_load_dwordx4 a[56:59], v2, s[8:11], s25 offen offset:2048 sc1
s_waitcnt vmcnt(11)
s_waitcnt lgkmcnt(4)
v_mfma_f32_16x16x32_bf16 v[32:35], a[224:227], a[8:11], v[32:35]
ds_read_b128 a[216:219], v2 offset:13312
v_mfma_f32_16x16x32_bf16 v[32:35], a[228:231], a[12:15], v[32:35]
ds_read_b128 a[220:223], v2 offset:18432
s_waitcnt lgkmcnt(4)
v_mfma_f32_16x16x32_bf16 v[36:39], a[232:235], a[8:11], v[36:39]
ds_read_b128 a[224:227], v2 offset:14336
v_mfma_f32_16x16x32_bf16 v[36:39], a[236:239], a[12:15], v[36:39]
ds_read_b128 a[228:231], v2 offset:19456
buffer_load_dwordx4 a[60:63], v2, s[8:11], s25 offen offset:3072 sc1
s_waitcnt lgkmcnt(4)
v_mfma_f32_16x16x32_bf16 v[40:43], a[240:243], a[8:11], v[40:43]
ds_read_b128 a[232:235], v2 offset:20480
v_mfma_f32_16x16x32_bf16 v[40:43], a[244:247], a[12:15], v[40:43]
ds_read_b128 a[236:239], v2 offset:25600
s_waitcnt lgkmcnt(4)
v_mfma_f32_16x16x32_bf16 v[44:47], a[216:219], a[8:11], v[44:47]
ds_read_b128 a[240:243], v2 offset:21504
v_mfma_f32_16x16x32_bf16 v[44:47], a[220:223], a[12:15], v[44:47]
ds_read_b128 a[244:247], v2 offset:26624
s_add_u32 s25, s25, 4096
buffer_load_dwordx2 a[64:65], v11, s[8:11], s25 offen offset:0 sc1
buffer_load_dwordx2 a[66:67], v11, s[8:11], s25 offen offset:128 sc1
s_waitcnt lgkmcnt(4)
v_mfma_f32_16x16x32_bf16 v[48:51], a[224:227], a[8:11], v[48:51]
ds_read_b128 a[216:219], v2 offset:22528
v_mfma_f32_16x16x32_bf16 v[48:51], a[228:231], a[12:15], v[48:51]
ds_read_b128 a[220:223], v2 offset:27648
s_waitcnt vmcnt(12)
s_waitcnt lgkmcnt(4)
v_mfma_f32_16x16x32_bf16 v[32:35], a[232:235], a[16:19], v[32:35]
ds_read_b128 a[224:227], v2 offset:23552
v_mfma_f32_16x16x32_bf16 v[32:35], a[236:239], a[20:23], v[32:35]
ds_read_b128 a[228:231], v2 offset:28672
buffer_load_dwordx2 a[68:69], v11, s[8:11], s25 offen offset:1024 sc1
buffer_load_dwordx2 a[70:71], v11, s[8:11], s25 offen offset:1152 sc1
s_waitcnt lgkmcnt(4)
v_mfma_f32_16x16x32_bf16 v[36:39], a[240:243], a[16:19], v[36:39]
ds_read_b128 a[232:235], v2 offset:24576
v_mfma_f32_16x16x32_bf16 v[36:39], a[244:247], a[20:23], v[36:39]
ds_read_b128 a[236:239], v2 offset:29696
s_waitcnt lgkmcnt(4)
v_mfma_f32_16x16x32_bf16 v[40:43], a[216:219], a[16:19], v[40:43]
ds_read_b128 a[240:243], v2 offset:30720
v_mfma_f32_16x16x32_bf16 v[40:43], a[220:223], a[20:23], v[40:43]
ds_read_b128 a[244:247], v2 offset:35840
buffer_load_dwordx4 v[56:59], v2, s[8:11], s27 offen sc1
s_waitcnt lgkmcnt(4)
v_mfma_f32_16x16x32_bf16 v[44:47], a[224:227], a[16:19], v[44:47]
ds_read_b128 a[216:219], v2 offset:31744
v_mfma_f32_16x16x32_bf16 v[44:47], a[228:231], a[20:23], v[44:47]
ds_read_b128 a[220:223], v2 offset:36864
s_waitcnt lgkmcnt(4)
v_mfma_f32_16x16x32_bf16 v[48:51], a[232:235], a[16:19], v[48:51]
ds_read_b128 a[224:227], v2 offset:32768
v_mfma_f32_16x16x32_bf16 v[48:51], a[236:239], a[20:23], v[48:51]
ds_read_b128 a[228:231], v2 offset:37888
buffer_load_dwordx4 v[60:63], v2, s[8:11], s27 offen offset:1024 sc1
s_waitcnt vmcnt(14)
s_waitcnt lgkmcnt(4)
v_mfma_f32_16x16x32_bf16 v[32:35], a[240:243], a[24:27], v[32:35]
ds_read_b128 a[232:235], v2 offset:33792
v_mfma_f32_16x16x32_bf16 v[32:35], a[244:247], a[28:31], v[32:35]
ds_read_b128 a[236:239], v2 offset:38912
s_waitcnt lgkmcnt(4)
v_mfma_f32_16x16x32_bf16 v[36:39], a[216:219], a[24:27], v[36:39]
ds_read_b128 a[240:243], v2 offset:34816
v_mfma_f32_16x16x32_bf16 v[36:39], a[220:223], a[28:31], v[36:39]
ds_read_b128 a[244:247], v2 offset:39936
buffer_load_dwordx2 v[64:65], v4, s[8:11], s27 offen sc1
s_waitcnt lgkmcnt(4)
v_mfma_f32_16x16x32_bf16 v[40:43], a[224:227], a[24:27], v[40:43]
ds_read_b128 a[216:219], v2 offset:40960
v_mfma_f32_16x16x32_bf16 v[40:43], a[228:231], a[28:31], v[40:43]
ds_read_b128 a[220:223], v2 offset:46080
s_waitcnt lgkmcnt(4)
v_mfma_f32_16x16x32_bf16 v[44:47], a[232:235], a[24:27], v[44:47]
ds_read_b128 a[224:227], v2 offset:41984
v_mfma_f32_16x16x32_bf16 v[44:47], a[236:239], a[28:31], v[44:47]
ds_read_b128 a[228:231], v2 offset:47104
s_add_u32 m0, s22, 98304
s_nop 0
buffer_load_dwordx4 v3, s[8:11], 0 offen offset:0 sc1 lds
s_waitcnt lgkmcnt(4)
v_mfma_f32_16x16x32_bf16 v[48:51], a[240:243], a[24:27], v[48:51]
ds_read_b128 a[232:235], v2 offset:43008
v_mfma_f32_16x16x32_bf16 v[48:51], a[244:247], a[28:31], v[48:51]
ds_read_b128 a[236:239], v2 offset:48128
s_waitcnt vmcnt(14)
s_waitcnt lgkmcnt(4)
v_mfma_f32_16x16x32_bf16 v[32:35], a[216:219], a[32:35], v[32:35]
ds_read_b128 a[240:243], v2 offset:44032
v_mfma_f32_16x16x32_bf16 v[32:35], a[220:223], a[36:39], v[32:35]
ds_read_b128 a[244:247], v2 offset:49152
buffer_load_dwordx4 v3, s[8:11], 0 offen offset:1024 sc1 lds
s_waitcnt lgkmcnt(4)
v_mfma_f32_16x16x32_bf16 v[36:39], a[224:227], a[32:35], v[36:39]
ds_read_b128 a[216:219], v2 offset:45056
v_mfma_f32_16x16x32_bf16 v[36:39], a[228:231], a[36:39], v[36:39]
ds_read_b128 a[220:223], v2 offset:50176
s_waitcnt lgkmcnt(4)
v_mfma_f32_16x16x32_bf16 v[40:43], a[232:235], a[32:35], v[40:43]
ds_read_b128 a[224:227], v2 offset:51200
v_mfma_f32_16x16x32_bf16 v[40:43], a[236:239], a[36:39], v[40:43]
ds_read_b128 a[228:231], v2 offset:56320
buffer_load_dwordx4 v3, s[8:11], 0 offen offset:2048 sc1 lds
s_waitcnt lgkmcnt(4)
v_mfma_f32_16x16x32_bf16 v[44:47], a[240:243], a[32:35], v[44:47]
ds_read_b128 a[232:235], v2 offset:52224
v_mfma_f32_16x16x32_bf16 v[44:47], a[244:247], a[36:39], v[44:47]
ds_read_b128 a[236:239], v2 offset:57344
s_waitcnt lgkmcnt(4)
v_mfma_f32_16x16x32_bf16 v[48:51], a[216:219], a[32:35], v[48:51]
ds_read_b128 a[240:243], v2 offset:53248
v_mfma_f32_16x16x32_bf16 v[48:51], a[220:223], a[36:39], v[48:51]
ds_read_b128 a[244:247], v2 offset:58368
buffer_load_dwordx4 v3, s[8:11], 0 offen offset:3072 sc1 lds
s_waitcnt vmcnt(15)
s_waitcnt lgkmcnt(4)
v_mfma_f32_16x16x32_bf16 v[32:35], a[224:227], a[40:43], v[32:35]
ds_read_b128 a[216:219], v2 offset:54272
v_mfma_f32_16x16x32_bf16 v[32:35], a[228:231], a[44:47], v[32:35]
ds_read_b128 a[220:223], v2 offset:59392
s_waitcnt lgkmcnt(4)
v_mfma_f32_16x16x32_bf16 v[36:39], a[232:235], a[40:43], v[36:39]
ds_read_b128 a[224:227], v2 offset:55296
v_mfma_f32_16x16x32_bf16 v[36:39], a[236:239], a[44:47], v[36:39]
ds_read_b128 a[228:231], v2 offset:60416
s_add_u32 m0, s22, 102400
v_add_u32 v3, 4096, v3
buffer_load_dwordx4 v3, s[8:11], 0 offen offset:0 sc1 lds
s_waitcnt lgkmcnt(4)
v_mfma_f32_16x16x32_bf16 v[40:43], a[240:243], a[40:43], v[40:43]
ds_read_b128 a[232:235], v2 offset:61440
v_mfma_f32_16x16x32_bf16 v[40:43], a[244:247], a[44:47], v[40:43]
ds_read_b128 a[236:239], v5 offset:1024
s_waitcnt lgkmcnt(4)
v_mfma_f32_16x16x32_bf16 v[44:47], a[216:219], a[40:43], v[44:47]
ds_read_b128 a[240:243], v2 offset:62464
v_mfma_f32_16x16x32_bf16 v[44:47], a[220:223], a[44:47], v[44:47]
ds_read_b128 a[244:247], v5 offset:2048
buffer_load_dwordx4 v3, s[8:11], 0 offen offset:1024 sc1 lds
s_waitcnt lgkmcnt(4)
v_mfma_f32_16x16x32_bf16 v[48:51], a[224:227], a[40:43], v[48:51]
ds_read_b128 a[216:219], v2 offset:63488
v_mfma_f32_16x16x32_bf16 v[48:51], a[228:231], a[44:47], v[48:51]
ds_read_b128 a[220:223], v5 offset:3072
s_waitcnt vmcnt(15)
s_waitcnt lgkmcnt(4)
v_mfma_f32_16x16x32_bf16 v[32:35], a[232:235], a[48:51], v[32:35]
ds_read_b128 a[224:227], v2 offset:64512
v_mfma_f32_16x16x32_bf16 v[32:35], a[236:239], a[52:55], v[32:35]
ds_read_b128 a[228:231], v5 offset:4096
s_add_u32 m0, s22, 122880
v_add_u32 v3, 20480, v3
buffer_load_dwordx4 v3, s[8:11], 0 offen offset:0 sc1 lds
s_waitcnt lgkmcnt(4)
v_mfma_f32_16x16x32_bf16 v[36:39], a[240:243], a[48:51], v[36:39]
ds_read_b128 a[232:235], v5 offset:0
v_mfma_f32_16x16x32_bf16 v[36:39], a[244:247], a[52:55], v[36:39]
ds_read_b128 a[236:239], v5 offset:5120
s_waitcnt lgkmcnt(4)
v_mfma_f32_16x16x32_bf16 v[40:43], a[216:219], a[48:51], v[40:43]
ds_read_b128 a[240:243], v5 offset:6144
v_mfma_f32_16x16x32_bf16 v[40:43], a[220:223], a[52:55], v[40:43]
ds_read_b128 a[244:247], v5 offset:11264
buffer_load_dwordx4 v3, s[8:11], 0 offen offset:1024 sc1 lds
s_waitcnt lgkmcnt(4)
v_mfma_f32_16x16x32_bf16 v[44:47], a[224:227], a[48:51], v[44:47]
ds_read_b128 a[216:219], v5 offset:7168
v_mfma_f32_16x16x32_bf16 v[44:47], a[228:231], a[52:55], v[44:47]
ds_read_b128 a[220:223], v5 offset:12288
s_waitcnt lgkmcnt(4)
v_mfma_f32_16x16x32_bf16 v[48:51], a[232:235], a[48:51], v[48:51]
ds_read_b128 a[224:227], v5 offset:8192
v_mfma_f32_16x16x32_bf16 v[48:51], a[236:239], a[52:55], v[48:51]
ds_read_b128 a[228:231], v5 offset:13312
buffer_load_dwordx4 v3, s[8:11], 0 offen offset:2048 sc1 lds
s_waitcnt vmcnt(16)
s_waitcnt lgkmcnt(4)
v_mfma_f32_16x16x32_bf16 v[32:35], a[240:243], a[56:59], v[32:35]
ds_read_b128 a[232:235], v5 offset:9216
v_mfma_f32_16x16x32_bf16 v[32:35], a[244:247], a[60:63], v[32:35]
ds_read_b128 a[236:239], v5 offset:14336
s_waitcnt lgkmcnt(4)
v_mfma_f32_16x16x32_bf16 v[36:39], a[216:219], a[56:59], v[36:39]
ds_read_b128 a[240:243], v5 offset:10240
v_mfma_f32_16x16x32_bf16 v[36:39], a[220:223], a[60:63], v[36:39]
ds_read_b128 a[244:247], v5 offset:15360
buffer_load_dwordx4 v3, s[8:11], 0 offen offset:3072 sc1 lds
s_waitcnt lgkmcnt(4)
v_mfma_f32_16x16x32_bf16 v[40:43], a[224:227], a[56:59], v[40:43]
ds_read_b128 a[216:219], v5 offset:16384
v_mfma_f32_16x16x32_bf16 v[40:43], a[228:231], a[60:63], v[40:43]
ds_read_b128 a[220:223], v5 offset:21504
s_waitcnt lgkmcnt(4)
v_mfma_f32_16x16x32_bf16 v[44:47], a[232:235], a[56:59], v[44:47]
ds_read_b128 a[224:227], v5 offset:17408
v_mfma_f32_16x16x32_bf16 v[44:47], a[236:239], a[60:63], v[44:47]
ds_read_b128 a[228:231], v5 offset:22528
s_add_u32 m0, s22, 126976
v_add_u32 v3, 4096, v3
buffer_load_dwordx4 v3, s[8:11], 0 offen offset:0 sc1 lds
s_waitcnt lgkmcnt(4)
v_mfma_f32_16x16x32_bf16 v[48:51], a[240:243], a[56:59], v[48:51]
ds_read_b128 a[232:235], v5 offset:18432
v_mfma_f32_16x16x32_bf16 v[48:51], a[244:247], a[60:63], v[48:51]
ds_read_b128 a[236:239], v5 offset:23552
s_waitcnt vmcnt(14)
s_waitcnt lgkmcnt(4)
v_mfma_f32_16x16x32_bf16 v[32:35], a[216:219], a[64:67], v[32:35]
ds_read_b128 a[240:243], v5 offset:19456
v_mfma_f32_16x16x32_bf16 v[32:35], a[220:223], a[68:71], v[32:35]
ds_read_b128 a[244:247], v5 offset:24576
buffer_load_dwordx4 v3, s[8:11], 0 offen offset:1024 sc1 lds
s_waitcnt lgkmcnt(4)
v_mfma_f32_16x16x32_bf16 v[36:39], a[224:227], a[64:67], v[36:39]
ds_read_b128 a[216:219], v5 offset:20480
v_mfma_f32_16x16x32_bf16 v[36:39], a[228:231], a[68:71], v[36:39]
ds_read_b128 a[220:223], v5 offset:25600
s_waitcnt lgkmcnt(4)
v_mfma_f32_16x16x32_bf16 v[40:43], a[232:235], a[64:67], v[40:43]
v_mfma_f32_16x16x32_bf16 v[40:43], a[236:239], a[68:71], v[40:43]
s_waitcnt lgkmcnt(2)
v_mfma_f32_16x16x32_bf16 v[44:47], a[240:243], a[64:67], v[44:47]
v_mfma_f32_16x16x32_bf16 v[44:47], a[244:247], a[68:71], v[44:47]
s_waitcnt lgkmcnt(0)
v_mfma_f32_16x16x32_bf16 v[48:51], a[216:219], a[64:67], v[48:51]
v_mfma_f32_16x16x32_bf16 v[48:51], a[220:223], a[68:71], v[48:51]
s_waitcnt vmcnt(12)
v_lshlrev_b32 v68, 16, v56
v_and_b32 v69, 0xffff0000, v56
v_add_f32 v32, v32, v68
v_add_f32 v33, v33, v69
v_lshlrev_b32 v70, 16, v57
v_and_b32 v71, 0xffff0000, v57
v_add_f32 v34, v34, v70
v_add_f32 v35, v35, v71
v_lshlrev_b32 v72, 16, v58
v_and_b32 v73, 0xffff0000, v58
v_add_f32 v36, v36, v72
v_add_f32 v37, v37, v73
v_lshlrev_b32 v74, 16, v59
v_and_b32 v75, 0xffff0000, v59
v_add_f32 v38, v38, v74
v_add_f32 v39, v39, v75
v_lshlrev_b32 v68, 16, v60
v_and_b32 v69, 0xffff0000, v60
v_add_f32 v40, v40, v68
v_add_f32 v41, v41, v69
v_lshlrev_b32 v70, 16, v61
v_and_b32 v71, 0xffff0000, v61
v_add_f32 v42, v42, v70
v_add_f32 v43, v43, v71
v_lshlrev_b32 v72, 16, v62
v_and_b32 v73, 0xffff0000, v62
v_add_f32 v44, v44, v72
v_add_f32 v45, v45, v73
v_lshlrev_b32 v74, 16, v63
v_and_b32 v75, 0xffff0000, v63
v_add_f32 v46, v46, v74
v_add_f32 v47, v47, v75
v_lshlrev_b32 v68, 16, v64
v_and_b32 v69, 0xffff0000, v64
v_add_f32 v48, v48, v68
v_add_f32 v49, v49, v69
v_lshlrev_b32 v70, 16, v65
v_and_b32 v71, 0xffff0000, v65
v_add_f32 v50, v50, v70
v_add_f32 v51, v51, v71
v_cvt_pk_bf16_f32 v80, v32, v33
v_cvt_pk_bf16_f32 v81, v34, v35
v_cvt_pk_bf16_f32 v82, v36, v37
v_cvt_pk_bf16_f32 v83, v38, v39
v_cvt_pk_bf16_f32 v84, v40, v41
v_cvt_pk_bf16_f32 v85, v42, v43
v_cvt_pk_bf16_f32 v86, v44, v45
v_cvt_pk_bf16_f32 v87, v46, v47
v_cvt_pk_bf16_f32 v88, v48, v49
v_cvt_pk_bf16_f32 v89, v50, v51
s_add_u32 s27, s26, s73
buffer_store_dwordx4 v[80:83], v2, s[8:11], s27 offen sc1
buffer_store_dwordx4 v[84:87], v2, s[8:11], s27 offen offset:1024 sc1
buffer_store_dwordx2 v[88:89], v4, s[8:11], s27 offen sc1
v_add_f32 v10, v32, v33
v_mul_f32 v11, v32, v32
v_mul_f32 v13, v33, v33
v_mov_b32 v12, 0
v_add_f32 v10, v10, v34
v_add_f32 v12, v12, v35
v_fmac_f32 v11, v34, v34
v_fmac_f32 v13, v35, v35
v_add_f32 v10, v10, v36
v_add_f32 v12, v12, v37
v_fmac_f32 v11, v36, v36
v_fmac_f32 v13, v37, v37
v_add_f32 v10, v10, v38
v_add_f32 v12, v12, v39
v_fmac_f32 v11, v38, v38
v_fmac_f32 v13, v39, v39
v_add_f32 v10, v10, v40
v_add_f32 v12, v12, v41
v_fmac_f32 v11, v40, v40
v_fmac_f32 v13, v41, v41
v_add_f32 v10, v10, v42
v_add_f32 v12, v12, v43
v_fmac_f32 v11, v42, v42
v_fmac_f32 v13, v43, v43
v_add_f32 v10, v10, v44
v_add_f32 v12, v12, v45
v_fmac_f32 v11, v44, v44
v_fmac_f32 v13, v45, v45
v_add_f32 v10, v10, v46
v_add_f32 v12, v12, v47
v_fmac_f32 v11, v46, v46
v_fmac_f32 v13, v47, v47
v_add_f32 v10, v10, v48
v_add_f32 v12, v12, v49
v_fmac_f32 v11, v48, v48
v_fmac_f32 v13, v49, v49
v_add_f32 v10, v10, v50
v_add_f32 v12, v12, v51
v_fmac_f32 v11, v50, v50
v_fmac_f32 v13, v51, v51
v_add_f32 v10, v10, v12
v_add_f32 v11, v11, v13
v_mov_b32 v12, v10
v_mov_b32 v13, v11
s_nop 0
v_permlane16_swap_b32 v10, v12
v_permlane16_swap_b32 v11, v13
v_add_f32 v10, v10, v12
v_add_f32 v11, v11, v13
v_mov_b32 v12, v10
v_mov_b32 v13, v11
s_nop 0
v_permlane32_swap_b32 v10, v12
v_permlane32_swap_b32 v11, v13
v_add_f32 v10, v10, v12
v_add_f32 v11, v11, v13
v_lshlrev_b32 v8, 3, v6
v_cmp_gt_u32 vcc, 16, v1
s_nop 1
v_cndmask_b32 v8, v9, v8, vcc
s_lshl_b32 s27, s20, 10
s_lshl_b32 s28, s21, 7
s_add_u32 s27, s27, s28
s_add_u32 s27, s27, s74
buffer_store_dwordx2 v[10:11], v8, s[8:11], s27 offen sc1
s_lshr_b32 s27, s20, 2
s_lshl_b32 s27, s27, 3
s_add_u32 s27, s27, s21
s_lshl_b32 s14, s27, 7
s_add_u32 s14, s14, 524288
s_add_u32 s14, s14, s77
s_lshl_b32 s44, s40, 4
s_lshl_b32 s45, s4, 2
s_add_u32 s44, s44, s45
s_mul_i32 s46, s44, 18432
s_add_u32 s20, s46, s73
v_add_u32 v4, 18432, v2
v_add_u32 v5, 36864, v2
v_add_u32 v6, 55296, v2
v_lshlrev_b32 v248, 3, v1
v_add_u32 v249, 18432, v248
v_add_u32 v250, 36864, v248
v_add_u32 v251, 55296, v248
v_and_b32 v13, 15, v1
v_lshrrev_b32 v14, 4, v1
v_add_u32 v7, 0x10000, v2
v_add_u32 v8, 0x20000, v2
v_and_b32 v9, 1, v14
v_mul_u32_u24 v9, 18432, v9
v_lshrrev_b32 v15, 1, v14
v_lshlrev_b32 v15, 8, v15
v_lshl_add_u32 v15, v13, 4, v15
v_add_u32 v9, v9, v15
v_and_b32 v11, 3, v1
v_lshlrev_b32 v11, 7, v11
s_lshl_b32 s49, s43, 7
v_mov_b32 v10, 2146435072
v_lshl_add_u32 v15, v1, 3, s49
v_cmp_gt_u32 vcc, 16, v1
s_nop 1
v_cndmask_b32 v10, v10, v15, vcc
s_lshl_b32 s49, s40, 3
s_add_u32 s49, s49, s42
s_lshl_b32 s50, s49, 2
s_add_u32 s50, s50, s4
s_lshl_b32 s50, s50, 9
s_add_u32 s34, s50, s77
s_add_u32 s34, s34, 0
s_lshl_b32 s49, s49, 4
s_add_u32 s49, s49, s45
s_mul_i32 s49, s49, 18432
s_add_u32 s49, s49, s75
s_add_u32 s50, s43, 0
s_and_b32 s50, s50, 3
s_mul_i32 s50, s50, 9
s_add_u32 s50, s50, 1
s_lshr_b32 s50, s50, 1
s_lshl_b32 s50, s50, 10
s_add_u32 s24, s49, s50
s_add_u32 s50, s43, 1
s_and_b32 s50, s50, 3
s_mul_i32 s50, s50, 9
s_add_u32 s50, s50, 1
s_lshr_b32 s50, s50, 1
s_lshl_b32 s50, s50, 10
s_add_u32 s25, s49, s50
s_add_u32 s50, s43, 2
s_and_b32 s50, s50, 3
s_mul_i32 s50, s50, 9
s_add_u32 s50, s50, 1
s_lshr_b32 s50, s50, 1
s_lshl_b32 s50, s50, 10
s_add_u32 s26, s49, s50
s_add_u32 s50, s43, 3
s_and_b32 s50, s50, 3
s_mul_i32 s50, s50, 9
s_add_u32 s50, s50, 1
s_lshr_b32 s50, s50, 1
s_lshl_b32 s50, s50, 10
s_add_u32 s27, s49, s50
s_add_u32 s28, s49, 4096
s_add_u32 s29, s49, 13312
s_cmp_ge_u32 s43, 2
s_cselect_b32 s50, s29, s28
s_and_b32 s51, s43, 1
s_lshl_b32 s51, s51, 9
s_add_u32 s30, s50, s51
s_mul_i32 s50, s42, 2359296
s_add_u32 s50, s50, s46
s_add_u32 s50, s50, s76
s_lshl_b32 s51, s43, 12
s_add_u32 s31, s50, s51
s_lshl_b32 s51, s43, 9
s_add_u32 s50, s50, s51
s_add_u32 s32, s50, 16384
s_add_u32 s33, s32, 36864
s_add_u32 s36, s31, 0
s_add_u32 s37, s31, 18432
s_add_u32 s38, s31, 36864
s_add_u32 s39, s31, 55296
v_lshlrev_b32 v252, 4, v13
v_lshl_add_u32 v252, v14, 9, v252
s_lshl_b32 s35, s40, 5
s_add_u32 s35, s35, s41
s_lshl_b32 s35, s35, 7
s_add_u32 s35, s35, s77
s_add_u32 s35, s35, 655360
v_lshlrev_b32 v17, 3, v13
v_lshl_add_u32 v17, v14, 8, v17
s_lshl_b32 s47, s44, 10
s_add_u32 s47, s47, s74
s_lshl_b32 s49, s44, 8
s_add_u32 s49, s49, s77
s_add_u32 s49, s49, 524288
v_and_b32 v16, 7, v1
v_lshlrev_b32 v16, 7, v16
v_mov_b32 v13, 2146435072
v_cmp_gt_u32 vcc, 16, v0
v_lshlrev_b32 v14, 3, v0
s_nop 0
v_cndmask_b32 v13, v13, v14, vcc
v_mov_b32 v14, s68
v_mov_b32 v15, s69
s_waitcnt vmcnt(0)
s_barrier
buffer_store_dwordx2 v[14:15], v13, s[8:11], s14 offen sc1
s_add_u32 m0, s22, 0
v_add_u32 v3, 20480, v3
buffer_load_dwordx4 v3, s[8:11], 0 offen offset:0 sc1 lds
buffer_load_dwordx4 v3, s[8:11], 0 offen offset:1024 sc1 lds
buffer_load_dwordx4 v3, s[8:11], 0 offen offset:2048 sc1 lds
buffer_load_dwordx4 v3, s[8:11], 0 offen offset:3072 sc1 lds
s_add_u32 m0, s22, 4096
v_add_u32 v3, 4096, v3
buffer_load_dwordx4 v3, s[8:11], 0 offen offset:0 sc1 lds
buffer_load_dwordx4 v3, s[8:11], 0 offen offset:1024 sc1 lds
s_add_u32 m0, s22, 24576
v_add_u32 v3, 20480, v3
buffer_load_dwordx4 v3, s[8:11], 0 offen offset:0 sc1 lds
buffer_load_dwordx4 v3, s[8:11], 0 offen offset:1024 sc1 lds
buffer_load_dwordx4 v3, s[8:11], 0 offen offset:2048 sc1 lds
buffer_load_dwordx4 v3, s[8:11], 0 offen offset:3072 sc1 lds
s_add_u32 m0, s22, 28672
v_add_u32 v3, 4096, v3
buffer_load_dwordx4 v3, s[8:11], 0 offen offset:0 sc1 lds
buffer_load_dwordx4 v3, s[8:11], 0 offen offset:1024 sc1 lds
ds_read_b128 v[48:51], v7 offset:32768
ds_read_b128 v[52:55], v7 offset:33792
ds_read_b128 v[56:59], v7 offset:34816
ds_read_b128 v[60:63], v7 offset:35840
ds_read_b128 v[64:67], v7 offset:36864
ds_read_b128 v[68:71], v7 offset:37888
s_mov_b32 s52, 0
L_poll3:
buffer_load_dwordx2 v[14:15], v16, s[8:11], s49 offen sc1
s_add_u32 s52, s52, 1
s_waitcnt vmcnt(0)
v_cmp_ne_u64 vcc, s[68:69], v[14:15]
s_cmp_ge_u32 s52, 1048576
s_cbranch_scc1 L_got3
s_and_b64 exec, exec, vcc
s_cbranch_execnz L_poll3
L_got3:
s_mov_b64 exec, -1
s_add_u32 s48, s20, 0
buffer_load_dwordx4 a[0:3], v2, s[8:11], s48 offen offset:0 sc1
buffer_load_dwordx4 a[4:7], v4, s[8:11], s48 offen offset:0 sc1
buffer_load_dwordx4 a[8:11], v5, s[8:11], s48 offen offset:0 sc1
buffer_load_dwordx4 a[12:15], v6, s[8:11], s48 offen offset:0 sc1
buffer_load_dwordx4 a[16:19], v2, s[8:11], s48 offen offset:1024 sc1
buffer_load_dwordx4 a[20:23], v4, s[8:11], s48 offen offset:1024 sc1
buffer_load_dwordx4 a[24:27], v5, s[8:11], s48 offen offset:1024 sc1
buffer_load_dwordx4 a[28:31], v6, s[8:11], s48 offen offset:1024 sc1
buffer_load_dwordx2 v[144:145], v17, s[8:11], s47 offen offset:0 sc1
buffer_load_dwordx2 v[146:147], v17, s[8:11], s47 offen offset:128 sc1
buffer_load_dwordx2 v[148:149], v17, s[8:11], s47 offen offset:1024 sc1
buffer_load_dwordx2 v[150:151], v17, s[8:11], s47 offen offset:1152 sc1
buffer_load_dwordx2 v[152:153], v17, s[8:11], s47 offen offset:2048 sc1
buffer_load_dwordx2 v[154:155], v17, s[8:11], s47 offen offset:2176 sc1
buffer_load_dwordx2 v[156:157], v17, s[8:11], s47 offen offset:3072 sc1
buffer_load_dwordx2 v[158:159], v17, s[8:11], s47 offen offset:3200 sc1
buffer_load_dwordx4 a[32:35], v2, s[8:11], s48 offen offset:2048 sc1
buffer_load_dwordx4 a[36:39], v4, s[8:11], s48 offen offset:2048 sc1
buffer_load_dwordx4 a[40:43], v5, s[8:11], s48 offen offset:2048 sc1
buffer_load_dwordx4 a[44:47], v6, s[8:11], s48 offen offset:2048 sc1
buffer_load_dwordx4 a[48:51], v2, s[8:11], s48 offen offset:3072 sc1
buffer_load_dwordx4 a[52:55], v4, s[8:11], s48 offen offset:3072 sc1
buffer_load_dwordx4 a[56:59], v5, s[8:11], s48 offen offset:3072 sc1
buffer_load_dwordx4 a[60:63], v6, s[8:11], s48 offen offset:3072 sc1
s_add_u32 s48, s20, 4096
buffer_load_dwordx4 a[64:67], v2, s[8:11], s48 offen offset:0 sc1
buffer_load_dwordx4 a[68:71], v4, s[8:11], s48 offen offset:0 sc1
buffer_load_dwordx4 a[72:75], v5, s[8:11], s48 offen offset:0 sc1
buffer_load_dwordx4 a[76:79], v6, s[8:11], s48 offen offset:0 sc1
s_waitcnt vmcnt(20)
s_waitcnt lgkmcnt(4)
v_mfma_f32_16x16x32_bf16 v[80:83], v[48:51], a[0:3], 0
buffer_load_dwordx4 a[80:83], v2, s[8:11], s48 offen offset:1024 sc1
v_mfma_f32_16x16x32_bf16 v[80:83], v[52:55], a[16:19], v[80:83]
v_mfma_f32_16x16x32_bf16 v[84:87], v[48:51], a[4:7], 0
ds_read_b128 v[72:75], v7 offset:38912
v_mfma_f32_16x16x32_bf16 v[84:87], v[52:55], a[20:23], v[84:87]
v_mfma_f32_16x16x32_bf16 v[88:91], v[48:51], a[8:11], 0
buffer_load_dwordx4 a[84:87], v4, s[8:11], s48 offen offset:1024 sc1
v_mfma_f32_16x16x32_bf16 v[88:91], v[52:55], a[24:27], v[88:91]
ds_read_b128 v[76:79], v7 offset:39936
v_mfma_f32_16x16x32_bf16 v[92:95], v[48:51], a[12:15], 0
v_mfma_f32_16x16x32_bf16 v[92:95], v[52:55], a[28:31], v[92:95]
s_waitcnt lgkmcnt(4)
v_mfma_f32_16x16x32_bf16 v[96:99], v[56:59], a[0:3], 0
buffer_load_dwordx4 a[88:91], v5, s[8:11], s48 offen offset:1024 sc1
v_mfma_f32_16x16x32_bf16 v[96:99], v[60:63], a[16:19], v[96:99]
v_mfma_f32_16x16x32_bf16 v[100:103], v[56:59], a[4:7], 0
ds_read_b128 v[48:51], v7 offset:40960
v_mfma_f32_16x16x32_bf16 v[100:103], v[60:63], a[20:23], v[100:103]
v_mfma_f32_16x16x32_bf16 v[104:107], v[56:59], a[8:11], 0
buffer_load_dwordx4 a[92:95], v6, s[8:11], s48 offen offset:1024 sc1
v_mfma_f32_16x16x32_bf16 v[104:107], v[60:63], a[24:27], v[104:107]
ds_read_b128 v[52:55], v7 offset:41984
v_mfma_f32_16x16x32_bf16 v[108:111], v[56:59], a[12:15], 0
v_mfma_f32_16x16x32_bf16 v[108:111], v[60:63], a[28:31], v[108:111]
s_waitcnt lgkmcnt(4)
v_mfma_f32_16x16x32_bf16 v[112:115], v[64:67], a[0:3], 0
buffer_load_dwordx4 a[96:99], v2, s[8:11], s48 offen offset:2048 sc1
v_mfma_f32_16x16x32_bf16 v[112:115], v[68:71], a[16:19], v[112:115]
v_mfma_f32_16x16x32_bf16 v[116:119], v[64:67], a[4:7], 0
ds_read_b128 v[56:59], v7 offset:43008
v_mfma_f32_16x16x32_bf16 v[116:119], v[68:71], a[20:23], v[116:119]
v_mfma_f32_16x16x32_bf16 v[120:123], v[64:67], a[8:11], 0
buffer_load_dwordx4 a[100:103], v4, s[8:11], s48 offen offset:2048 sc1
v_mfma_f32_16x16x32_bf16 v[120:123], v[68:71], a[24:27], v[120:123]
ds_read_b128 v[60:63], v7 offset:44032
v_mfma_f32_16x16x32_bf16 v[124:127], v[64:67], a[12:15], 0
v_mfma_f32_16x16x32_bf16 v[124:127], v[68:71], a[28:31], v[124:127]
s_waitcnt lgkmcnt(4)
v_mfma_f32_16x16x32_bf16 v[128:131], v[72:75], a[0:3], 0
buffer_load_dwordx4 a[104:107], v5, s[8:11], s48 offen offset:2048 sc1
v_mfma_f32_16x16x32_bf16 v[128:131], v[76:79], a[16:19], v[128:131]
v_mfma_f32_16x16x32_bf16 v[132:135], v[72:75], a[4:7], 0
ds_read_b128 v[64:67], v7 offset:45056
v_mfma_f32_16x16x32_bf16 v[132:135], v[76:79], a[20:23], v[132:135]
v_mfma_f32_16x16x32_bf16 v[136:139], v[72:75], a[8:11], 0
buffer_load_dwordx4 a[108:111], v6, s[8:11], s48 offen offset:2048 sc1
v_mfma_f32_16x16x32_bf16 v[136:139], v[76:79], a[24:27], v[136:139]
ds_read_b128 v[68:71], v7 offset:46080
v_mfma_f32_16x16x32_bf16 v[140:143], v[72:75], a[12:15], 0
v_mfma_f32_16x16x32_bf16 v[140:143], v[76:79], a[28:31], v[140:143]
s_waitcnt vmcnt(12)
s_waitcnt lgkmcnt(4)
v_mfma_f32_16x16x32_bf16 v[80:83], v[48:51], a[32:35], v[80:83]
buffer_load_dwordx4 a[112:115], v2, s[8:11], s48 offen offset:3072 sc1
v_mfma_f32_16x16x32_bf16 v[80:83], v[52:55], a[48:51], v[80:83]
v_mfma_f32_16x16x32_bf16 v[84:87], v[48:51], a[36:39], v[84:87]
ds_read_b128 v[72:75], v7 offset:47104
v_mfma_f32_16x16x32_bf16 v[84:87], v[52:55], a[52:55], v[84:87]
v_mfma_f32_16x16x32_bf16 v[88:91], v[48:51], a[40:43], v[88:91]
buffer_load_dwordx4 a[116:119], v4, s[8:11], s48 offen offset:3072 sc1
v_mfma_f32_16x16x32_bf16 v[88:91], v[52:55], a[56:59], v[88:91]
ds_read_b128 v[76:79], v7 offset:48128
v_mfma_f32_16x16x32_bf16 v[92:95], v[48:51], a[44:47], v[92:95]
v_mfma_f32_16x16x32_bf16 v[92:95], v[52:55], a[60:63], v[92:95]
s_waitcnt lgkmcnt(4)
v_mfma_f32_16x16x32_bf16 v[96:99], v[56:59], a[32:35], v[96:99]
buffer_load_dwordx4 a[120:123], v5, s[8:11], s48 offen offset:3072 sc1
v_mfma_f32_16x16x32_bf16 v[96:99], v[60:63], a[48:51], v[96:99]
v_mfma_f32_16x16x32_bf16 v[100:103], v[56:59], a[36:39], v[100:103]
ds_read_b128 v[48:51], v7 offset:49152
v_mfma_f32_16x16x32_bf16 v[100:103], v[60:63], a[52:55], v[100:103]
v_mfma_f32_16x16x32_bf16 v[104:107], v[56:59], a[40:43], v[104:107]
buffer_load_dwordx4 a[124:127], v6, s[8:11], s48 offen offset:3072 sc1
v_mfma_f32_16x16x32_bf16 v[104:107], v[60:63], a[56:59], v[104:107]
ds_read_b128 v[52:55], v7 offset:50176
s_add_u32 s48, s20, 8192
v_mfma_f32_16x16x32_bf16 v[108:111], v[56:59], a[44:47], v[108:111]
v_mfma_f32_16x16x32_bf16 v[108:111], v[60:63], a[60:63], v[108:111]
s_waitcnt lgkmcnt(4)
v_mfma_f32_16x16x32_bf16 v[112:115], v[64:67], a[32:35], v[112:115]
buffer_load_dwordx4 a[128:131], v2, s[8:11], s48 offen offset:0 sc1
v_mfma_f32_16x16x32_bf16 v[112:115], v[68:71], a[48:51], v[112:115]
v_mfma_f32_16x16x32_bf16 v[116:119], v[64:67], a[36:39], v[116:119]
ds_read_b128 v[56:59], v7 offset:51200
v_mfma_f32_16x16x32_bf16 v[116:119], v[68:71], a[52:55], v[116:119]
v_mfma_f32_16x16x32_bf16 v[120:123], v[64:67], a[40:43], v[120:123]
buffer_load_dwordx4 a[132:135], v4, s[8:11], s48 offen offset:0 sc1
v_mfma_f32_16x16x32_bf16 v[120:123], v[68:71], a[56:59], v[120:123]
ds_read_b128 v[60:63], v7 offset:52224
v_mfma_f32_16x16x32_bf16 v[124:127], v[64:67], a[44:47], v[124:127]
v_mfma_f32_16x16x32_bf16 v[124:127], v[68:71], a[60:63], v[124:127]
s_waitcnt lgkmcnt(4)
v_mfma_f32_16x16x32_bf16 v[128:131], v[72:75], a[32:35], v[128:131]
buffer_load_dwordx4 a[136:139], v5, s[8:11], s48 offen offset:0 sc1
v_mfma_f32_16x16x32_bf16 v[128:131], v[76:79], a[48:51], v[128:131]
v_mfma_f32_16x16x32_bf16 v[132:135], v[72:75], a[36:39], v[132:135]
ds_read_b128 v[64:67], v7 offset:53248
v_mfma_f32_16x16x32_bf16 v[132:135], v[76:79], a[52:55], v[132:135]
v_mfma_f32_16x16x32_bf16 v[136:139], v[72:75], a[40:43], v[136:139]
buffer_load_dwordx4 a[140:143], v6, s[8:11], s48 offen offset:0 sc1
v_mfma_f32_16x16x32_bf16 v[136:139], v[76:79], a[56:59], v[136:139]
ds_read_b128 v[68:71], v7 offset:54272
v_mfma_f32_16x16x32_bf16 v[140:143], v[72:75], a[44:47], v[140:143]
v_mfma_f32_16x16x32_bf16 v[140:143], v[76:79], a[60:63], v[140:143]
s_waitcnt vmcnt(12)
s_waitcnt lgkmcnt(4)
v_mfma_f32_16x16x32_bf16 v[80:83], v[48:51], a[64:67], v[80:83]
buffer_load_dwordx4 a[144:147], v2, s[8:11], s48 offen offset:1024 sc1
v_mfma_f32_16x16x32_bf16 v[80:83], v[52:55], a[80:83], v[80:83]
v_mfma_f32_16x16x32_bf16 v[84:87], v[48:51], a[68:71], v[84:87]
ds_read_b128 v[72:75], v7 offset:55296
v_mfma_f32_16x16x32_bf16 v[84:87], v[52:55], a[84:87], v[84:87]
v_add_f32 v144, v144, v146
v_add_f32 v145, v145, v147
v_mfma_f32_16x16x32_bf16 v[88:91], v[48:51], a[72:75], v[88:91]
buffer_load_dwordx4 a[148:151], v4, s[8:11], s48 offen offset:1024 sc1
v_mfma_f32_16x16x32_bf16 v[88:91], v[52:55], a[88:91], v[88:91]
ds_read_b128 v[76:79], v7 offset:56320
v_add_f32 v148, v148, v150
v_mfma_f32_16x16x32_bf16 v[92:95], v[48:51], a[76:79], v[92:95]
v_add_f32 v149, v149, v151
v_add_f32 v152, v152, v154
v_mfma_f32_16x16x32_bf16 v[92:95], v[52:55], a[92:95], v[92:95]
v_add_f32 v153, v153, v155
s_waitcnt lgkmcnt(4)
v_mfma_f32_16x16x32_bf16 v[96:99], v[56:59], a[64:67], v[96:99]
buffer_load_dwordx4 a[152:155], v5, s[8:11], s48 offen offset:1024 sc1
v_mfma_f32_16x16x32_bf16 v[96:99], v[60:63], a[80:83], v[96:99]
s_barrier
v_mfma_f32_16x16x32_bf16 v[100:103], v[56:59], a[68:71], v[100:103]
ds_read_b128 v[48:51], v7 offset:57344
v_add_f32 v156, v156, v158
v_mfma_f32_16x16x32_bf16 v[100:103], v[60:63], a[84:87], v[100:103]
v_add_f32 v157, v157, v159
v_mov_b32 v160, v144
v_mfma_f32_16x16x32_bf16 v[104:107], v[56:59], a[72:75], v[104:107]
buffer_load_dwordx4 a[156:159], v6, s[8:11], s48 offen offset:1024 sc1
v_mfma_f32_16x16x32_bf16 v[104:107], v[60:63], a[88:91], v[104:107]
ds_read_b128 v[52:55], v7 offset:58368
v_mov_b32 v161, v145
v_mfma_f32_16x16x32_bf16 v[108:111], v[56:59], a[76:79], v[108:111]
v_mov_b32 v162, v148
v_mov_b32 v163, v149
v_mfma_f32_16x16x32_bf16 v[108:111], v[60:63], a[92:95], v[108:111]
v_mov_b32 v164, v152
s_waitcnt lgkmcnt(4)
v_mfma_f32_16x16x32_bf16 v[112:115], v[64:67], a[64:67], v[112:115]
buffer_load_dwordx4 a[160:163], v2, s[8:11], s48 offen offset:2048 sc1
v_mfma_f32_16x16x32_bf16 v[112:115], v[68:71], a[80:83], v[112:115]
v_mov_b32 v165, v153
v_mov_b32 v166, v156
v_mfma_f32_16x16x32_bf16 v[116:119], v[64:67], a[68:71], v[116:119]
ds_read_b128 v[56:59], v7 offset:59392
v_mov_b32 v167, v157
v_mfma_f32_16x16x32_bf16 v[116:119], v[68:71], a[84:87], v[116:119]
v_permlane16_swap_b32 v144, v160
v_permlane16_swap_b32 v145, v161
v_mfma_f32_16x16x32_bf16 v[120:123], v[64:67], a[72:75], v[120:123]
buffer_load_dwordx4 a[164:167], v4, s[8:11], s48 offen offset:2048 sc1
v_mfma_f32_16x16x32_bf16 v[120:123], v[68:71], a[88:91], v[120:123]
ds_read_b128 v[60:63], v7 offset:60416
v_permlane16_swap_b32 v148, v162
v_mfma_f32_16x16x32_bf16 v[124:127], v[64:67], a[76:79], v[124:127]
v_permlane16_swap_b32 v149, v163
v_permlane16_swap_b32 v152, v164
v_mfma_f32_16x16x32_bf16 v[124:127], v[68:71], a[92:95], v[124:127]
v_permlane16_swap_b32 v153, v165
s_waitcnt lgkmcnt(4)
v_mfma_f32_16x16x32_bf16 v[128:131], v[72:75], a[64:67], v[128:131]
buffer_load_dwordx4 a[168:171], v5, s[8:11], s48 offen offset:2048 sc1
v_mfma_f32_16x16x32_bf16 v[128:131], v[76:79], a[80:83], v[128:131]
v_permlane16_swap_b32 v156, v166
v_permlane16_swap_b32 v157, v167
v_mfma_f32_16x16x32_bf16 v[132:135], v[72:75], a[68:71], v[132:135]
ds_read_b128 v[64:67], v7 offset:61440
v_add_f32 v144, v144, v160
v_mfma_f32_16x16x32_bf16 v[132:135], v[76:79], a[84:87], v[132:135]
v_add_f32 v145, v145, v161
v_add_f32 v148, v148, v162
v_mfma_f32_16x16x32_bf16 v[136:139], v[72:75], a[72:75], v[136:139]
buffer_load_dwordx4 a[172:175], v6, s[8:11], s48 offen offset:2048 sc1
v_mfma_f32_16x16x32_bf16 v[136:139], v[76:79], a[88:91], v[136:139]
ds_read_b128 v[68:71], v7 offset:62464
v_add_f32 v149, v149, v163
v_mfma_f32_16x16x32_bf16 v[140:143], v[72:75], a[76:79], v[140:143]
v_add_f32 v152, v152, v164
v_add_f32 v153, v153, v165
v_mfma_f32_16x16x32_bf16 v[140:143], v[76:79], a[92:95], v[140:143]
v_add_f32 v156, v156, v166
s_waitcnt vmcnt(12)
s_waitcnt lgkmcnt(4)
v_mfma_f32_16x16x32_bf16 v[80:83], v[48:51], a[96:99], v[80:83]
buffer_load_dwordx4 a[176:179], v2, s[8:11], s48 offen offset:3072 sc1
v_mfma_f32_16x16x32_bf16 v[80:83], v[52:55], a[112:115], v[80:83]
v_add_f32 v157, v157, v167
v_mov_b32 v160, v144
v_mfma_f32_16x16x32_bf16 v[84:87], v[48:51], a[100:103], v[84:87]
ds_read_b128 v[72:75], v7 offset:63488
v_mov_b32 v161, v145
v_mfma_f32_16x16x32_bf16 v[84:87], v[52:55], a[116:119], v[84:87]
v_mov_b32 v162, v148
v_mov_b32 v163, v149
v_mfma_f32_16x16x32_bf16 v[88:91], v[48:51], a[104:107], v[88:91]
buffer_load_dwordx4 a[180:183], v4, s[8:11], s48 offen offset:3072 sc1
v_mfma_f32_16x16x32_bf16 v[88:91], v[52:55], a[120:123], v[88:91]
ds_read_b128 v[76:79], v7 offset:64512
v_mov_b32 v164, v152
v_mfma_f32_16x16x32_bf16 v[92:95], v[48:51], a[108:111], v[92:95]
v_mov_b32 v165, v153
v_mov_b32 v166, v156
v_mfma_f32_16x16x32_bf16 v[92:95], v[52:55], a[124:127], v[92:95]
v_mov_b32 v167, v157
s_waitcnt lgkmcnt(4)
v_mfma_f32_16x16x32_bf16 v[96:99], v[56:59], a[96:99], v[96:99]
buffer_load_dwordx4 a[184:187], v5, s[8:11], s48 offen offset:3072 sc1
v_mfma_f32_16x16x32_bf16 v[96:99], v[60:63], a[112:115], v[96:99]
v_permlane32_swap_b32 v144, v160
v_permlane32_swap_b32 v145, v161
v_mfma_f32_16x16x32_bf16 v[100:103], v[56:59], a[100:103], v[100:103]
ds_read_b128 v[48:51], v8 offset:0
v_permlane32_swap_b32 v148, v162
v_mfma_f32_16x16x32_bf16 v[100:103], v[60:63], a[116:119], v[100:103]
v_permlane32_swap_b32 v149, v163
v_permlane32_swap_b32 v152, v164
v_mfma_f32_16x16x32_bf16 v[104:107], v[56:59], a[104:107], v[104:107]
buffer_load_dwordx4 a[188:191], v6, s[8:11], s48 offen offset:3072 sc1
v_mfma_f32_16x16x32_bf16 v[104:107], v[60:63], a[120:123], v[104:107]
ds_read_b128 v[52:55], v8 offset:1024
s_add_u32 s48, s20, 12288
v_mfma_f32_16x16x32_bf16 v[108:111], v[56:59], a[108:111], v[108:111]
v_permlane32_swap_b32 v153, v165
v_permlane32_swap_b32 v156, v166
v_mfma_f32_16x16x32_bf16 v[108:111], v[60:63], a[124:127], v[108:111]
v_permlane32_swap_b32 v157, v167
s_waitcnt lgkmcnt(4)
v_mfma_f32_16x16x32_bf16 v[112:115], v[64:67], a[96:99], v[112:115]
buffer_load_dwordx4 a[192:195], v2, s[8:11], s48 offen offset:0 sc1
v_mfma_f32_16x16x32_bf16 v[112:115], v[68:71], a[112:115], v[112:115]
v_add_f32 v144, v144, v160
v_add_f32 v145, v145, v161
v_mfma_f32_16x16x32_bf16 v[116:119], v[64:67], a[100:103], v[116:119]
ds_read_b128 v[56:59], v8 offset:2048
v_add_f32 v148, v148, v162
v_mfma_f32_16x16x32_bf16 v[116:119], v[68:71], a[116:119], v[116:119]
v_add_f32 v149, v149, v163
v_add_f32 v152, v152, v164
v_mfma_f32_16x16x32_bf16 v[120:123], v[64:67], a[104:107], v[120:123]
buffer_load_dwordx4 a[196:199], v4, s[8:11], s48 offen offset:0 sc1
v_mfma_f32_16x16x32_bf16 v[120:123], v[68:71], a[120:123], v[120:123]
ds_read_b128 v[60:63], v8 offset:3072
v_add_f32 v153, v153, v165
v_mfma_f32_16x16x32_bf16 v[124:127], v[64:67], a[108:111], v[124:127]
v_add_f32 v156, v156, v166
v_add_f32 v157, v157, v167
v_mfma_f32_16x16x32_bf16 v[124:127], v[68:71], a[124:127], v[124:127]
v_mul_f32 v144, 0x3ae38e39, v144
s_waitcnt lgkmcnt(4)
v_mfma_f32_16x16x32_bf16 v[128:131], v[72:75], a[96:99], v[128:131]
buffer_load_dwordx4 a[200:203], v5, s[8:11], s48 offen offset:0 sc1
v_mfma_f32_16x16x32_bf16 v[128:131], v[76:79], a[112:115], v[128:131]
v_mul_f32 v148, 0x3ae38e39, v148
v_mul_f32 v152, 0x3ae38e39, v152
v_mfma_f32_16x16x32_bf16 v[132:135], v[72:75], a[100:103], v[132:135]
ds_read_b128 v[64:67], v8 offset:4096
v_mul_f32 v156, 0x3ae38e39, v156
v_mfma_f32_16x16x32_bf16 v[132:135], v[76:79], a[116:119], v[132:135]
v_mul_f32 v145, 0x3ae38e39, v145
v_mul_f32 v149, 0x3ae38e39, v149
v_mfma_f32_16x16x32_bf16 v[136:139], v[72:75], a[104:107], v[136:139]
buffer_load_dwordx4 a[204:207], v6, s[8:11], s48 offen offset:0 sc1
v_mfma_f32_16x16x32_bf16 v[136:139], v[76:79], a[120:123], v[136:139]
ds_read_b128 v[68:71], v8 offset:5120
v_mul_f32 v153, 0x3ae38e39, v153
v_mfma_f32_16x16x32_bf16 v[140:143], v[72:75], a[108:111], v[140:143]
v_mul_f32 v157, 0x3ae38e39, v157
v_fma_f32 v145, -v144, v144, v145
v_mfma_f32_16x16x32_bf16 v[140:143], v[76:79], a[124:127], v[140:143]
v_fma_f32 v149, -v148, v148, v149
s_waitcnt vmcnt(12)
s_waitcnt lgkmcnt(4)
v_mfma_f32_16x16x32_bf16 v[80:83], v[48:51], a[128:131], v[80:83]
buffer_load_dwordx4 a[208:211], v2, s[8:11], s48 offen offset:1024 sc1
v_mfma_f32_16x16x32_bf16 v[80:83], v[52:55], a[144:147], v[80:83]
v_fma_f32 v153, -v152, v152, v153
v_fma_f32 v157, -v156, v156, v157
v_mfma_f32_16x16x32_bf16 v[84:87], v[48:51], a[132:135], v[84:87]
ds_read_b128 v[72:75], v8 offset:6144
v_max_f32 v145, 0, v145
v_mfma_f32_16x16x32_bf16 v[84:87], v[52:55], a[148:151], v[84:87]
v_max_f32 v149, 0, v149
v_max_f32 v153, 0, v153
v_mfma_f32_16x16x32_bf16 v[88:91], v[48:51], a[136:139], v[88:91]
buffer_load_dwordx4 a[212:215], v4, s[8:11], s48 offen offset:1024 sc1
v_mfma_f32_16x16x32_bf16 v[88:91], v[52:55], a[152:155], v[88:91]
ds_read_b128 v[76:79], v8 offset:7168
v_max_f32 v157, 0, v157
v_mfma_f32_16x16x32_bf16 v[92:95], v[48:51], a[140:143], v[92:95]
v_add_f32 v234, 0x3727c5ac, v145
v_add_f32 v238, 0x3727c5ac, v149
v_mfma_f32_16x16x32_bf16 v[92:95], v[52:55], a[156:159], v[92:95]
v_add_f32 v242, 0x3727c5ac, v153
s_waitcnt lgkmcnt(4)
v_mfma_f32_16x16x32_bf16 v[96:99], v[56:59], a[128:131], v[96:99]
buffer_load_dwordx4 a[216:219], v5, s[8:11], s48 offen offset:1024 sc1
v_mfma_f32_16x16x32_bf16 v[96:99], v[60:63], a[144:147], v[96:99]
v_add_f32 v246, 0x3727c5ac, v157
v_mfma_f32_16x16x32_bf16 v[100:103], v[56:59], a[132:135], v[100:103]
ds_read_b128 v[48:51], v8 offset:8192
v_mfma_f32_16x16x32_bf16 v[100:103], v[60:63], a[148:151], v[100:103]
v_rsq_f32 v144, v234
v_mfma_f32_16x16x32_bf16 v[104:107], v[56:59], a[136:139], v[104:107]
buffer_load_dwordx4 a[220:223], v6, s[8:11], s48 offen offset:1024 sc1
v_mfma_f32_16x16x32_bf16 v[104:107], v[60:63], a[152:155], v[104:107]
ds_read_b128 v[52:55], v8 offset:9216
v_mul_f32 v232, 0xc0135761, v144
v_mfma_f32_16x16x32_bf16 v[108:111], v[56:59], a[140:143], v[108:111]
v_rsq_f32 v148, v238
v_mfma_f32_16x16x32_bf16 v[108:111], v[60:63], a[156:159], v[108:111]
v_mul_f32 v236, 0xc0135761, v148
s_waitcnt lgkmcnt(4)
v_mfma_f32_16x16x32_bf16 v[112:115], v[64:67], a[128:131], v[112:115]
buffer_load_dwordx4 a[224:227], v2, s[8:11], s48 offen offset:2048 sc1
v_mfma_f32_16x16x32_bf16 v[112:115], v[68:71], a[144:147], v[112:115]
v_rsq_f32 v152, v242
v_mfma_f32_16x16x32_bf16 v[116:119], v[64:67], a[132:135], v[116:119]
ds_read_b128 v[56:59], v8 offset:10240
v_mul_f32 v240, 0xc0135761, v152
v_mfma_f32_16x16x32_bf16 v[116:119], v[68:71], a[148:151], v[116:119]
v_rsq_f32 v156, v246
v_mfma_f32_16x16x32_bf16 v[120:123], v[64:67], a[136:139], v[120:123]
buffer_load_dwordx4 a[228:231], v4, s[8:11], s48 offen offset:2048 sc1
v_mfma_f32_16x16x32_bf16 v[120:123], v[68:71], a[152:155], v[120:123]
ds_read_b128 v[60:63], v8 offset:11264
v_mul_f32 v244, 0xc0135761, v156
v_mfma_f32_16x16x32_bf16 v[124:127], v[64:67], a[140:143], v[124:127]
v_mul_f32 v145, v144, v144
v_mul_f32 v149, v148, v148
v_mfma_f32_16x16x32_bf16 v[124:127], v[68:71], a[156:159], v[124:127]
v_mul_f32 v153, v152, v152
s_waitcnt lgkmcnt(4)
v_mfma_f32_16x16x32_bf16 v[128:131], v[72:75], a[128:131], v[128:131]
buffer_load_dwordx4 a[232:235], v5, s[8:11], s48 offen offset:2048 sc1
v_mfma_f32_16x16x32_bf16 v[128:131], v[76:79], a[144:147], v[128:131]
v_mul_f32 v157, v156, v156
v_mul_f32 v145, v145, v144
v_mfma_f32_16x16x32_bf16 v[132:135], v[72:75], a[132:135], v[132:135]
ds_read_b128 v[64:67], v8 offset:12288
v_mul_f32 v149, v149, v148
v_mfma_f32_16x16x32_bf16 v[132:135], v[76:79], a[148:151], v[132:135]
v_mul_f32 v153, v153, v152
v_mul_f32 v157, v157, v156
v_mfma_f32_16x16x32_bf16 v[136:139], v[72:75], a[136:139], v[136:139]
buffer_load_dwordx4 a[236:239], v6, s[8:11], s48 offen offset:2048 sc1
v_mfma_f32_16x16x32_bf16 v[136:139], v[76:79], a[152:155], v[136:139]
ds_read_b128 v[68:71], v8 offset:13312
v_mul_f32 v233, 0xbdd2d3e8, v145
v_mfma_f32_16x16x32_bf16 v[140:143], v[72:75], a[140:143], v[140:143]
v_mul_f32 v237, 0xbdd2d3e8, v149
v_mul_f32 v241, 0xbdd2d3e8, v153
v_mfma_f32_16x16x32_bf16 v[140:143], v[76:79], a[156:159], v[140:143]
v_mul_f32 v245, 0xbdd2d3e8, v157
s_waitcnt vmcnt(12)
s_waitcnt lgkmcnt(4)
v_mfma_f32_16x16x32_bf16 v[80:83], v[48:51], a[160:163], v[80:83]
buffer_load_dwordx4 a[240:243], v2, s[8:11], s48 offen offset:3072 sc1
v_mfma_f32_16x16x32_bf16 v[80:83], v[52:55], a[176:179], v[80:83]
v_mfma_f32_16x16x32_bf16 v[84:87], v[48:51], a[164:167], v[84:87]
ds_read_b128 v[72:75], v8 offset:14336
v_mfma_f32_16x16x32_bf16 v[84:87], v[52:55], a[180:183], v[84:87]
v_mfma_f32_16x16x32_bf16 v[88:91], v[48:51], a[168:171], v[88:91]
buffer_load_dwordx4 a[244:247], v4, s[8:11], s48 offen offset:3072 sc1
v_mfma_f32_16x16x32_bf16 v[88:91], v[52:55], a[184:187], v[88:91]
ds_read_b128 v[76:79], v8 offset:15360
v_mfma_f32_16x16x32_bf16 v[92:95], v[48:51], a[172:175], v[92:95]
v_mfma_f32_16x16x32_bf16 v[92:95], v[52:55], a[188:191], v[92:95]
s_waitcnt lgkmcnt(4)
v_mfma_f32_16x16x32_bf16 v[96:99], v[56:59], a[160:163], v[96:99]
buffer_load_dwordx4 a[248:251], v5, s[8:11], s48 offen offset:3072 sc1
v_mfma_f32_16x16x32_bf16 v[96:99], v[60:63], a[176:179], v[96:99]
s_barrier
v_mfma_f32_16x16x32_bf16 v[100:103], v[56:59], a[164:167], v[100:103]
ds_read_b128 v[48:51], v2 offset:0
v_mfma_f32_16x16x32_bf16 v[100:103], v[60:63], a[180:183], v[100:103]
v_mfma_f32_16x16x32_bf16 v[104:107], v[56:59], a[168:171], v[104:107]
buffer_load_dwordx4 a[252:255], v6, s[8:11], s48 offen offset:3072 sc1
v_mfma_f32_16x16x32_bf16 v[104:107], v[60:63], a[184:187], v[104:107]
ds_read_b128 v[52:55], v2 offset:1024
s_add_u32 s48, s20, 16384
v_mfma_f32_16x16x32_bf16 v[108:111], v[56:59], a[172:175], v[108:111]
v_mfma_f32_16x16x32_bf16 v[108:111], v[60:63], a[188:191], v[108:111]
s_waitcnt lgkmcnt(4)
v_mfma_f32_16x16x32_bf16 v[112:115], v[64:67], a[160:163], v[112:115]
buffer_load_dwordx4 v[16:19], v2, s[8:11], s48 offen offset:0 sc1
v_mfma_f32_16x16x32_bf16 v[112:115], v[68:71], a[176:179], v[112:115]
v_mfma_f32_16x16x32_bf16 v[116:119], v[64:67], a[164:167], v[116:119]
ds_read_b128 v[56:59], v2 offset:2048
v_mfma_f32_16x16x32_bf16 v[116:119], v[68:71], a[180:183], v[116:119]
v_mfma_f32_16x16x32_bf16 v[120:123], v[64:67], a[168:171], v[120:123]
buffer_load_dwordx4 v[20:23], v4, s[8:11], s48 offen offset:0 sc1
v_mfma_f32_16x16x32_bf16 v[120:123], v[68:71], a[184:187], v[120:123]
ds_read_b128 v[60:63], v2 offset:3072
v_mfma_f32_16x16x32_bf16 v[124:127], v[64:67], a[172:175], v[124:127]
v_mfma_f32_16x16x32_bf16 v[124:127], v[68:71], a[188:191], v[124:127]
s_waitcnt lgkmcnt(4)
v_mfma_f32_16x16x32_bf16 v[128:131], v[72:75], a[160:163], v[128:131]
buffer_load_dwordx4 v[24:27], v5, s[8:11], s48 offen offset:0 sc1
v_mfma_f32_16x16x32_bf16 v[128:131], v[76:79], a[176:179], v[128:131]
v_mfma_f32_16x16x32_bf16 v[132:135], v[72:75], a[164:167], v[132:135]
ds_read_b128 v[64:67], v2 offset:4096
v_mfma_f32_16x16x32_bf16 v[132:135], v[76:79], a[180:183], v[132:135]
v_mfma_f32_16x16x32_bf16 v[136:139], v[72:75], a[168:171], v[136:139]
buffer_load_dwordx4 v[28:31], v6, s[8:11], s48 offen offset:0 sc1
v_mfma_f32_16x16x32_bf16 v[136:139], v[76:79], a[184:187], v[136:139]
ds_read_b128 v[68:71], v2 offset:5120
v_mfma_f32_16x16x32_bf16 v[140:143], v[72:75], a[172:175], v[140:143]
v_mfma_f32_16x16x32_bf16 v[140:143], v[76:79], a[188:191], v[140:143]
s_waitcnt vmcnt(12)
s_waitcnt lgkmcnt(4)
v_mfma_f32_16x16x32_bf16 v[80:83], v[48:51], a[192:195], v[80:83]
buffer_load_dwordx4 v[32:35], v2, s[8:11], s48 offen offset:1024 sc1
v_mfma_f32_16x16x32_bf16 v[80:83], v[52:55], a[208:211], v[80:83]
v_mfma_f32_16x16x32_bf16 v[84:87], v[48:51], a[196:199], v[84:87]
ds_read_b128 v[72:75], v2 offset:6144
v_mfma_f32_16x16x32_bf16 v[84:87], v[52:55], a[212:215], v[84:87]
v_mfma_f32_16x16x32_bf16 v[88:91], v[48:51], a[200:203], v[88:91]
buffer_load_dwordx4 v[36:39], v4, s[8:11], s48 offen offset:1024 sc1
v_mfma_f32_16x16x32_bf16 v[88:91], v[52:55], a[216:219], v[88:91]
ds_read_b128 v[76:79], v2 offset:7168
v_mfma_f32_16x16x32_bf16 v[92:95], v[48:51], a[204:207], v[92:95]
v_mfma_f32_16x16x32_bf16 v[92:95], v[52:55], a[220:223], v[92:95]
s_waitcnt lgkmcnt(4)
v_mfma_f32_16x16x32_bf16 v[96:99], v[56:59], a[192:195], v[96:99]
buffer_load_dwordx4 v[40:43], v5, s[8:11], s48 offen offset:1024 sc1
v_mfma_f32_16x16x32_bf16 v[96:99], v[60:63], a[208:211], v[96:99]
v_mfma_f32_16x16x32_bf16 v[100:103], v[56:59], a[196:199], v[100:103]
ds_read_b128 v[48:51], v2 offset:8192
v_mfma_f32_16x16x32_bf16 v[100:103], v[60:63], a[212:215], v[100:103]
v_mfma_f32_16x16x32_bf16 v[104:107], v[56:59], a[200:203], v[104:107]
buffer_load_dwordx4 v[44:47], v6, s[8:11], s48 offen offset:1024 sc1
v_mfma_f32_16x16x32_bf16 v[104:107], v[60:63], a[216:219], v[104:107]
ds_read_b128 v[52:55], v2 offset:9216
s_add_u32 m0, s22, 49152
v_mfma_f32_16x16x32_bf16 v[108:111], v[56:59], a[204:207], v[108:111]
v_add_u32 v3, 20480, v3
v_mfma_f32_16x16x32_bf16 v[108:111], v[60:63], a[220:223], v[108:111]
s_waitcnt lgkmcnt(4)
v_mfma_f32_16x16x32_bf16 v[112:115], v[64:67], a[192:195], v[112:115]
buffer_load_dwordx4 v3, s[8:11], 0 offen offset:0 sc1 lds
v_mfma_f32_16x16x32_bf16 v[112:115], v[68:71], a[208:211], v[112:115]
v_mfma_f32_16x16x32_bf16 v[116:119], v[64:67], a[196:199], v[116:119]
ds_read_b128 v[56:59], v2 offset:10240
v_mfma_f32_16x16x32_bf16 v[116:119], v[68:71], a[212:215], v[116:119]
v_mfma_f32_16x16x32_bf16 v[120:123], v[64:67], a[200:203], v[120:123]
buffer_load_dwordx4 v3, s[8:11], 0 offen offset:1024 sc1 lds
v_mfma_f32_16x16x32_bf16 v[120:123], v[68:71], a[216:219], v[120:123]
ds_read_b128 v[60:63], v2 offset:11264
v_mfma_f32_16x16x32_bf16 v[124:127], v[64:67], a[204:207], v[124:127]
v_mfma_f32_16x16x32_bf16 v[124:127], v[68:71], a[220:223], v[124:127]
s_waitcnt lgkmcnt(4)
v_mfma_f32_16x16x32_bf16 v[128:131], v[72:75], a[192:195], v[128:131]
buffer_load_dwordx4 v3, s[8:11], 0 offen offset:2048 sc1 lds
v_mfma_f32_16x16x32_bf16 v[128:131], v[76:79], a[208:211], v[128:131]
v_mfma_f32_16x16x32_bf16 v[132:135], v[72:75], a[196:199], v[132:135]
ds_read_b128 v[64:67], v2 offset:12288
v_mfma_f32_16x16x32_bf16 v[132:135], v[76:79], a[212:215], v[132:135]
v_mfma_f32_16x16x32_bf16 v[136:139], v[72:75], a[200:203], v[136:139]
buffer_load_dwordx4 v3, s[8:11], 0 offen offset:3072 sc1 lds
v_mfma_f32_16x16x32_bf16 v[136:139], v[76:79], a[216:219], v[136:139]
ds_read_b128 v[68:71], v2 offset:13312
s_add_u32 m0, s22, 53248
v_mfma_f32_16x16x32_bf16 v[140:143], v[72:75], a[204:207], v[140:143]
v_add_u32 v3, 4096, v3
v_mfma_f32_16x16x32_bf16 v[140:143], v[76:79], a[220:223], v[140:143]
s_waitcnt vmcnt(12)
s_waitcnt lgkmcnt(4)
v_mfma_f32_16x16x32_bf16 v[80:83], v[48:51], a[224:227], v[80:83]
buffer_load_dwordx4 v3, s[8:11], 0 offen offset:0 sc1 lds
v_mfma_f32_16x16x32_bf16 v[80:83], v[52:55], a[240:243], v[80:83]
v_mfma_f32_16x16x32_bf16 v[84:87], v[48:51], a[228:231], v[84:87]
ds_read_b128 v[72:75], v2 offset:14336
v_mfma_f32_16x16x32_bf16 v[84:87], v[52:55], a[244:247], v[84:87]
v_mfma_f32_16x16x32_bf16 v[88:91], v[48:51], a[232:235], v[88:91]
buffer_load_dwordx4 v3, s[8:11], 0 offen offset:1024 sc1 lds
v_mfma_f32_16x16x32_bf16 v[88:91], v[52:55], a[248:251], v[88:91]
ds_read_b128 v[76:79], v2 offset:15360
s_add_u32 m0, s22, 73728
v_mfma_f32_16x16x32_bf16 v[92:95], v[48:51], a[236:239], v[92:95]
v_add_u32 v3, 20480, v3
v_mfma_f32_16x16x32_bf16 v[92:95], v[52:55], a[252:255], v[92:95]
s_waitcnt lgkmcnt(4)
v_mfma_f32_16x16x32_bf16 v[96:99], v[56:59], a[224:227], v[96:99]
buffer_load_dwordx4 v3, s[8:11], 0 offen offset:0 sc1 lds
v_mfma_f32_16x16x32_bf16 v[96:99], v[60:63], a[240:243], v[96:99]
v_mfma_f32_16x16x32_bf16 v[100:103], v[56:59], a[228:231], v[100:103]
ds_read_b128 v[48:51], v2 offset:16384
v_mfma_f32_16x16x32_bf16 v[100:103], v[60:63], a[244:247], v[100:103]
v_mfma_f32_16x16x32_bf16 v[104:107], v[56:59], a[232:235], v[104:107]
buffer_load_dwordx4 v3, s[8:11], 0 offen offset:1024 sc1 lds
v_mfma_f32_16x16x32_bf16 v[104:107], v[60:63], a[248:251], v[104:107]
ds_read_b128 v[52:55], v2 offset:17408
v_mfma_f32_16x16x32_bf16 v[108:111], v[56:59], a[236:239], v[108:111]
v_mfma_f32_16x16x32_bf16 v[108:111], v[60:63], a[252:255], v[108:111]
s_waitcnt lgkmcnt(4)
v_mfma_f32_16x16x32_bf16 v[112:115], v[64:67], a[224:227], v[112:115]
buffer_load_dwordx4 v3, s[8:11], 0 offen offset:2048 sc1 lds
v_mfma_f32_16x16x32_bf16 v[112:115], v[68:71], a[240:243], v[112:115]
v_mfma_f32_16x16x32_bf16 v[116:119], v[64:67], a[228:231], v[116:119]
ds_read_b128 v[56:59], v2 offset:18432
v_mfma_f32_16x16x32_bf16 v[116:119], v[68:71], a[244:247], v[116:119]
v_mfma_f32_16x16x32_bf16 v[120:123], v[64:67], a[232:235], v[120:123]
buffer_load_dwordx4 v3, s[8:11], 0 offen offset:3072 sc1 lds
v_mfma_f32_16x16x32_bf16 v[120:123], v[68:71], a[248:251], v[120:123]
ds_read_b128 v[60:63], v2 offset:19456
s_add_u32 m0, s22, 77824
v_mfma_f32_16x16x32_bf16 v[124:127], v[64:67], a[236:239], v[124:127]
v_add_u32 v3, 4096, v3
v_mfma_f32_16x16x32_bf16 v[124:127], v[68:71], a[252:255], v[124:127]
s_waitcnt lgkmcnt(4)
v_mfma_f32_16x16x32_bf16 v[128:131], v[72:75], a[224:227], v[128:131]
buffer_load_dwordx4 v3, s[8:11], 0 offen offset:0 sc1 lds
v_mfma_f32_16x16x32_bf16 v[128:131], v[76:79], a[240:243], v[128:131]
v_mfma_f32_16x16x32_bf16 v[132:135], v[72:75], a[228:231], v[132:135]
ds_read_b128 v[64:67], v2 offset:20480
v_mfma_f32_16x16x32_bf16 v[132:135], v[76:79], a[244:247], v[132:135]
v_mfma_f32_16x16x32_bf16 v[136:139], v[72:75], a[232:235], v[136:139]
buffer_load_dwordx4 v3, s[8:11], 0 offen offset:1024 sc1 lds
v_mfma_f32_16x16x32_bf16 v[136:139], v[76:79], a[248:251], v[136:139]
ds_read_b128 v[68:71], v2 offset:21504
s_add_u32 m0, s22, 98304
v_mfma_f32_16x16x32_bf16 v[140:143], v[72:75], a[236:239], v[140:143]
v_add_u32 v3, 20480, v3
v_mfma_f32_16x16x32_bf16 v[140:143], v[76:79], a[252:255], v[140:143]
s_waitcnt vmcnt(12)
s_waitcnt lgkmcnt(4)
v_mfma_f32_16x16x32_bf16 v[80:83], v[48:51], v[16:19], v[80:83]
buffer_load_dwordx4 v3, s[8:11], 0 offen offset:0 sc1 lds
v_mfma_f32_16x16x32_bf16 v[80:83], v[52:55], v[32:35], v[80:83]
v_mfma_f32_16x16x32_bf16 v[84:87], v[48:51], v[20:23], v[84:87]
ds_read_b128 v[72:75], v2 offset:22528
v_mfma_f32_16x16x32_bf16 v[84:87], v[52:55], v[36:39], v[84:87]
v_mfma_f32_16x16x32_bf16 v[88:91], v[48:51], v[24:27], v[88:91]
buffer_load_dwordx4 v3, s[8:11], 0 offen offset:1024 sc1 lds
v_mfma_f32_16x16x32_bf16 v[88:91], v[52:55], v[40:43], v[88:91]
ds_read_b128 v[76:79], v2 offset:23552
v_mfma_f32_16x16x32_bf16 v[92:95], v[48:51], v[28:31], v[92:95]
v_mfma_f32_16x16x32_bf16 v[92:95], v[52:55], v[44:47], v[92:95]
s_waitcnt lgkmcnt(4)
v_mfma_f32_16x16x32_bf16 v[96:99], v[56:59], v[16:19], v[96:99]
buffer_load_dwordx4 v3, s[8:11], 0 offen offset:2048 sc1 lds
v_mfma_f32_16x16x32_bf16 v[96:99], v[60:63], v[32:35], v[96:99]
s_barrier
v_mfma_f32_16x16x32_bf16 v[100:103], v[56:59], v[20:23], v[100:103]
ds_read_b128 v[48:51], v2 offset:24576
v_mfma_f32_16x16x32_bf16 v[100:103], v[60:63], v[36:39], v[100:103]
v_mfma_f32_16x16x32_bf16 v[104:107], v[56:59], v[24:27], v[104:107]
buffer_load_dwordx4 v3, s[8:11], 0 offen offset:3072 sc1 lds
v_mfma_f32_16x16x32_bf16 v[104:107], v[60:63], v[40:43], v[104:107]
ds_read_b128 v[52:55], v2 offset:25600
s_add_u32 m0, s22, 102400
v_mfma_f32_16x16x32_bf16 v[108:111], v[56:59], v[28:31], v[108:111]
v_add_u32 v3, 4096, v3
v_mfma_f32_16x16x32_bf16 v[108:111], v[60:63], v[44:47], v[108:111]
s_waitcnt lgkmcnt(4)
v_mfma_f32_16x16x32_bf16 v[112:115], v[64:67], v[16:19], v[112:115]
buffer_load_dwordx4 v3, s[8:11], 0 offen offset:0 sc1 lds
v_mfma_f32_16x16x32_bf16 v[112:115], v[68:71], v[32:35], v[112:115]
v_mfma_f32_16x16x32_bf16 v[116:119], v[64:67], v[20:23], v[116:119]
ds_read_b128 v[56:59], v2 offset:26624
v_mfma_f32_16x16x32_bf16 v[116:119], v[68:71], v[36:39], v[116:119]
v_mfma_f32_16x16x32_bf16 v[120:123], v[64:67], v[24:27], v[120:123]
buffer_load_dwordx4 v3, s[8:11], 0 offen offset:1024 sc1 lds
v_mfma_f32_16x16x32_bf16 v[120:123], v[68:71], v[40:43], v[120:123]
ds_read_b128 v[60:63], v2 offset:27648
s_add_u32 m0, s22, 122880
v_mfma_f32_16x16x32_bf16 v[124:127], v[64:67], v[28:31], v[124:127]
v_add_u32 v3, 20480, v3
v_mfma_f32_16x16x32_bf16 v[124:127], v[68:71], v[44:47], v[124:127]
s_waitcnt lgkmcnt(4)
v_mfma_f32_16x16x32_bf16 v[128:131], v[72:75], v[16:19], v[128:131]
v_mfma_f32_16x16x32_bf16 v[128:131], v[76:79], v[32:35], v[128:131]
buffer_load_dwordx4 v3, s[8:11], 0 offen offset:0 sc1 lds
v_mfma_f32_16x16x32_bf16 v[132:135], v[72:75], v[20:23], v[132:135]
ds_read_b128 v[64:67], v2 offset:28672
v_mfma_f32_16x16x32_bf16 v[132:135], v[76:79], v[36:39], v[132:135]
v_mfma_f32_16x16x32_bf16 v[136:139], v[72:75], v[24:27], v[136:139]
v_mfma_f32_16x16x32_bf16 v[136:139], v[76:79], v[40:43], v[136:139]
ds_read_b128 v[68:71], v2 offset:29696
v_mfma_f32_16x16x32_bf16 v[140:143], v[72:75], v[28:31], v[140:143]
buffer_load_dwordx4 v3, s[8:11], 0 offen offset:1024 sc1 lds
v_mfma_f32_16x16x32_bf16 v[140:143], v[76:79], v[44:47], v[140:143]
s_waitcnt lgkmcnt(4)
v_mfma_f32_16x16x32_bf16 v[176:179], v[48:51], a[0:3], 0
v_mfma_f32_16x16x32_bf16 v[176:179], v[52:55], a[16:19], v[176:179]
v_mfma_f32_16x16x32_bf16 v[180:183], v[48:51], a[4:7], 0
ds_read_b128 v[72:75], v2 offset:30720
v_mfma_f32_16x16x32_bf16 v[180:183], v[52:55], a[20:23], v[180:183]
buffer_load_dwordx4 v3, s[8:11], 0 offen offset:2048 sc1 lds
v_mfma_f32_16x16x32_bf16 v[184:187], v[48:51], a[8:11], 0
v_mul_f32 v208, v80, v80
v_mul_f32 v210, v81, v81
v_mfma_f32_16x16x32_bf16 v[184:187], v[52:55], a[24:27], v[184:187]
ds_read_b128 v[76:79], v2 offset:31744
v_fma_f32 v208, v208, v233, v232
v_mfma_f32_16x16x32_bf16 v[188:191], v[48:51], a[12:15], 0
v_fma_f32 v210, v210, v233, v232
v_mul_f32 v208, v208, v80
v_mfma_f32_16x16x32_bf16 v[188:191], v[52:55], a[28:31], v[188:191]
v_mul_f32 v210, v210, v81
s_waitcnt lgkmcnt(4)
v_mfma_f32_16x16x32_bf16 v[192:195], v[56:59], a[0:3], 0
buffer_load_dwordx4 v3, s[8:11], 0 offen offset:3072 sc1 lds
v_mfma_f32_16x16x32_bf16 v[192:195], v[60:63], a[16:19], v[192:195]
s_add_u32 m0, s22, 126976
v_add_u32 v3, 4096, v3
v_mfma_f32_16x16x32_bf16 v[196:199], v[56:59], a[4:7], 0
ds_read_b128 v[48:51], v2 offset:32768
v_mul_f32 v209, v80, v96
v_mfma_f32_16x16x32_bf16 v[196:199], v[60:63], a[20:23], v[196:199]
v_exp_f32 v208, v208
v_mfma_f32_16x16x32_bf16 v[200:203], v[56:59], a[8:11], 0
v_exp_f32 v210, v210
v_mfma_f32_16x16x32_bf16 v[200:203], v[60:63], a[24:27], v[200:203]
ds_read_b128 v[52:55], v2 offset:33792
v_mul_f32 v211, v81, v97
v_mfma_f32_16x16x32_bf16 v[204:207], v[56:59], a[12:15], 0
buffer_load_dwordx4 v3, s[8:11], 0 offen offset:0 sc1 lds
v_mfma_f32_16x16x32_bf16 v[204:207], v[60:63], a[28:31], v[204:207]
v_fma_f32 v208, v208, v234, v234
s_waitcnt lgkmcnt(4)
v_mfma_f32_16x16x32_bf16 v[176:179], v[64:67], a[32:35], v[176:179]
v_fma_f32 v210, v210, v234, v234
v_mul_f32 v212, v82, v82
v_mfma_f32_16x16x32_bf16 v[176:179], v[68:71], a[48:51], v[176:179]
v_rcp_f32 v208, v208
v_mfma_f32_16x16x32_bf16 v[180:183], v[64:67], a[36:39], v[180:183]
ds_read_b128 v[56:59], v2 offset:34816
v_mul_f32 v209, v209, v208
v_mfma_f32_16x16x32_bf16 v[180:183], v[68:71], a[52:55], v[180:183]
buffer_load_dwordx4 v3, s[8:11], 0 offen offset:1024 sc1 lds
v_mfma_f32_16x16x32_bf16 v[184:187], v[64:67], a[40:43], v[184:187]
v_rcp_f32 v210, v210
v_mfma_f32_16x16x32_bf16 v[184:187], v[68:71], a[56:59], v[184:187]
ds_read_b128 v[60:63], v2 offset:35840
v_mul_f32 v211, v211, v210
v_mfma_f32_16x16x32_bf16 v[188:191], v[64:67], a[44:47], v[188:191]
v_cvt_pk_bf16_f32 v224, v209, v211
v_mul_f32 v214, v83, v83
v_mfma_f32_16x16x32_bf16 v[188:191], v[68:71], a[60:63], v[188:191]
v_fma_f32 v212, v212, v233, v232
s_waitcnt lgkmcnt(4)
v_mfma_f32_16x16x32_bf16 v[192:195], v[72:75], a[32:35], v[192:195]
v_fma_f32 v214, v214, v233, v232
v_mul_f32 v212, v212, v82
v_mfma_f32_16x16x32_bf16 v[192:195], v[76:79], a[48:51], v[192:195]
v_mul_f32 v214, v214, v83
v_mul_f32 v213, v82, v98
v_mfma_f32_16x16x32_bf16 v[196:199], v[72:75], a[36:39], v[196:199]
ds_read_b128 v[64:67], v2 offset:36864
v_mul_f32 v215, v83, v99
v_mfma_f32_16x16x32_bf16 v[196:199], v[76:79], a[52:55], v[196:199]
v_exp_f32 v212, v212
v_mfma_f32_16x16x32_bf16 v[200:203], v[72:75], a[40:43], v[200:203]
v_exp_f32 v214, v214
v_mfma_f32_16x16x32_bf16 v[200:203], v[76:79], a[56:59], v[200:203]
ds_read_b128 v[68:71], v2 offset:37888
v_fma_f32 v212, v212, v234, v234
v_mfma_f32_16x16x32_bf16 v[204:207], v[72:75], a[44:47], v[204:207]
v_fma_f32 v214, v214, v234, v234
v_mul_f32 v208, v84, v84
v_mfma_f32_16x16x32_bf16 v[204:207], v[76:79], a[60:63], v[204:207]
v_mul_f32 v210, v85, v85
s_waitcnt lgkmcnt(4)
v_mfma_f32_16x16x32_bf16 v[176:179], v[48:51], a[64:67], v[176:179]
v_rcp_f32 v212, v212
v_mfma_f32_16x16x32_bf16 v[176:179], v[52:55], a[80:83], v[176:179]
v_rcp_f32 v214, v214
v_mfma_f32_16x16x32_bf16 v[180:183], v[48:51], a[68:71], v[180:183]
ds_read_b128 v[72:75], v2 offset:38912
v_mul_f32 v213, v213, v212
v_mfma_f32_16x16x32_bf16 v[180:183], v[52:55], a[84:87], v[180:183]
v_mul_f32 v215, v215, v214
v_cvt_pk_bf16_f32 v225, v213, v215
v_mfma_f32_16x16x32_bf16 v[184:187], v[48:51], a[72:75], v[184:187]
buffer_store_dwordx2 v[224:225], v248, s[8:11], s30 offen sc1
v_mfma_f32_16x16x32_bf16 v[184:187], v[52:55], a[88:91], v[184:187]
ds_read_b128 v[76:79], v2 offset:39936
v_fma_f32 v208, v208, v237, v236
v_mfma_f32_16x16x32_bf16 v[188:191], v[48:51], a[76:79], v[188:191]
v_fma_f32 v210, v210, v237, v236
v_mul_f32 v208, v208, v84
v_mfma_f32_16x16x32_bf16 v[188:191], v[52:55], a[92:95], v[188:191]
v_mul_f32 v210, v210, v85
s_waitcnt lgkmcnt(4)
v_mfma_f32_16x16x32_bf16 v[192:195], v[56:59], a[64:67], v[192:195]
v_exp_f32 v208, v208
v_mfma_f32_16x16x32_bf16 v[192:195], v[60:63], a[80:83], v[192:195]
v_exp_f32 v210, v210
v_mfma_f32_16x16x32_bf16 v[196:199], v[56:59], a[68:71], v[196:199]
ds_read_b128 v[48:51], v2 offset:40960
v_mul_f32 v209, v84, v100
v_mfma_f32_16x16x32_bf16 v[196:199], v[60:63], a[84:87], v[196:199]
v_mul_f32 v211, v85, v101
v_fma_f32 v208, v208, v238, v238
v_mfma_f32_16x16x32_bf16 v[200:203], v[56:59], a[72:75], v[200:203]
v_fma_f32 v210, v210, v238, v238
v_mul_f32 v212, v86, v86
v_mfma_f32_16x16x32_bf16 v[200:203], v[60:63], a[88:91], v[200:203]
ds_read_b128 v[52:55], v2 offset:41984
v_mul_f32 v214, v87, v87
v_mfma_f32_16x16x32_bf16 v[204:207], v[56:59], a[76:79], v[204:207]
v_rcp_f32 v208, v208
v_mfma_f32_16x16x32_bf16 v[204:207], v[60:63], a[92:95], v[204:207]
v_mul_f32 v209, v209, v208
s_waitcnt lgkmcnt(4)
v_mfma_f32_16x16x32_bf16 v[176:179], v[64:67], a[96:99], v[176:179]
v_rcp_f32 v210, v210
v_mfma_f32_16x16x32_bf16 v[176:179], v[68:71], a[112:115], v[176:179]
v_mul_f32 v211, v211, v210
v_cvt_pk_bf16_f32 v226, v209, v211
v_mfma_f32_16x16x32_bf16 v[180:183], v[64:67], a[100:103], v[180:183]
ds_read_b128 v[56:59], v2 offset:43008
v_fma_f32 v212, v212, v237, v236
v_mfma_f32_16x16x32_bf16 v[180:183], v[68:71], a[116:119], v[180:183]
v_fma_f32 v214, v214, v237, v236
v_mul_f32 v212, v212, v86
v_mfma_f32_16x16x32_bf16 v[184:187], v[64:67], a[104:107], v[184:187]
v_mul_f32 v214, v214, v87
v_mul_f32 v213, v86, v102
v_mfma_f32_16x16x32_bf16 v[184:187], v[68:71], a[120:123], v[184:187]
ds_read_b128 v[60:63], v2 offset:44032
v_mul_f32 v215, v87, v103
v_mfma_f32_16x16x32_bf16 v[188:191], v[64:67], a[108:111], v[188:191]
v_exp_f32 v212, v212
v_mfma_f32_16x16x32_bf16 v[188:191], v[68:71], a[124:127], v[188:191]
v_fma_f32 v212, v212, v238, v238
s_waitcnt lgkmcnt(4)
v_mfma_f32_16x16x32_bf16 v[192:195], v[72:75], a[96:99], v[192:195]
v_exp_f32 v214, v214
v_mfma_f32_16x16x32_bf16 v[192:195], v[76:79], a[112:115], v[192:195]
v_fma_f32 v214, v214, v238, v238
v_mul_f32 v208, v88, v88
v_mfma_f32_16x16x32_bf16 v[196:199], v[72:75], a[100:103], v[196:199]
ds_read_b128 v[64:67], v2 offset:45056
v_mul_f32 v210, v89, v89
v_mfma_f32_16x16x32_bf16 v[196:199], v[76:79], a[116:119], v[196:199]
v_rcp_f32 v212, v212
v_mfma_f32_16x16x32_bf16 v[200:203], v[72:75], a[104:107], v[200:203]
v_rcp_f32 v214, v214
v_mfma_f32_16x16x32_bf16 v[200:203], v[76:79], a[120:123], v[200:203]
ds_read_b128 v[68:71], v2 offset:46080
v_mul_f32 v213, v213, v212
v_mfma_f32_16x16x32_bf16 v[204:207], v[72:75], a[108:111], v[204:207]
v_mul_f32 v215, v215, v214
v_cvt_pk_bf16_f32 v227, v213, v215
v_mfma_f32_16x16x32_bf16 v[204:207], v[76:79], a[124:127], v[204:207]
v_fma_f32 v208, v208, v241, v240
s_waitcnt lgkmcnt(4)
v_mfma_f32_16x16x32_bf16 v[176:179], v[48:51], a[128:131], v[176:179]
buffer_store_dwordx2 v[226:227], v249, s[8:11], s30 offen sc1
v_mfma_f32_16x16x32_bf16 v[176:179], v[52:55], a[144:147], v[176:179]
v_fma_f32 v210, v210, v241, v240
v_mul_f32 v208, v208, v88
v_mfma_f32_16x16x32_bf16 v[180:183], v[48:51], a[132:135], v[180:183]
ds_read_b128 v[72:75], v2 offset:47104
v_mul_f32 v210, v210, v89
v_mfma_f32_16x16x32_bf16 v[180:183], v[52:55], a[148:151], v[180:183]
v_exp_f32 v208, v208
v_mfma_f32_16x16x32_bf16 v[184:187], v[48:51], a[136:139], v[184:187]
v_exp_f32 v210, v210
v_mfma_f32_16x16x32_bf16 v[184:187], v[52:55], a[152:155], v[184:187]
ds_read_b128 v[76:79], v2 offset:48128
v_mul_f32 v209, v88, v104
v_mfma_f32_16x16x32_bf16 v[188:191], v[48:51], a[140:143], v[188:191]
v_mul_f32 v211, v89, v105
v_fma_f32 v208, v208, v242, v242
v_mfma_f32_16x16x32_bf16 v[188:191], v[52:55], a[156:159], v[188:191]
v_fma_f32 v210, v210, v242, v242
s_waitcnt lgkmcnt(4)
v_mfma_f32_16x16x32_bf16 v[192:195], v[56:59], a[128:131], v[192:195]
s_waitcnt vmcnt(20)
v_mul_f32 v212, v90, v90
v_mfma_f32_16x16x32_bf16 v[192:195], v[60:63], a[144:147], v[192:195]
s_barrier
v_mfma_f32_16x16x32_bf16 v[196:199], v[56:59], a[132:135], v[196:199]
ds_read_b128 v[48:51], v2 offset:49152
s_add_u32 m0, s22, 0
v_mfma_f32_16x16x32_bf16 v[196:199], v[60:63], a[148:151], v[196:199]
v_add_u32 v3, 20480, v3
buffer_load_dwordx4 v3, s[8:11], 0 offen offset:0 sc1 lds
v_mfma_f32_16x16x32_bf16 v[200:203], v[56:59], a[136:139], v[200:203]
v_rcp_f32 v208, v208
v_mfma_f32_16x16x32_bf16 v[200:203], v[60:63], a[152:155], v[200:203]
ds_read_b128 v[52:55], v2 offset:50176
v_mul_f32 v209, v209, v208
v_mfma_f32_16x16x32_bf16 v[204:207], v[56:59], a[140:143], v[204:207]
v_rcp_f32 v210, v210
v_mfma_f32_16x16x32_bf16 v[204:207], v[60:63], a[156:159], v[204:207]
v_mul_f32 v211, v211, v210
s_waitcnt lgkmcnt(4)
v_mfma_f32_16x16x32_bf16 v[176:179], v[64:67], a[160:163], v[176:179]
buffer_load_dwordx4 v3, s[8:11], 0 offen offset:1024 sc1 lds
v_mfma_f32_16x16x32_bf16 v[176:179], v[68:71], a[176:179], v[176:179]
v_cvt_pk_bf16_f32 v228, v209, v211
v_mul_f32 v214, v91, v91
v_mfma_f32_16x16x32_bf16 v[180:183], v[64:67], a[164:167], v[180:183]
ds_read_b128 v[56:59], v2 offset:51200
v_fma_f32 v212, v212, v241, v240
v_mfma_f32_16x16x32_bf16 v[180:183], v[68:71], a[180:183], v[180:183]
v_fma_f32 v214, v214, v241, v240
v_mul_f32 v212, v212, v90
v_mfma_f32_16x16x32_bf16 v[184:187], v[64:67], a[168:171], v[184:187]
v_mul_f32 v214, v214, v91
v_mul_f32 v213, v90, v106
v_mfma_f32_16x16x32_bf16 v[184:187], v[68:71], a[184:187], v[184:187]
ds_read_b128 v[60:63], v2 offset:52224
v_mul_f32 v215, v91, v107
v_mfma_f32_16x16x32_bf16 v[188:191], v[64:67], a[172:175], v[188:191]
buffer_load_dwordx4 v3, s[8:11], 0 offen offset:2048 sc1 lds
v_mfma_f32_16x16x32_bf16 v[188:191], v[68:71], a[188:191], v[188:191]
v_mul_f32 v208, v92, v92
s_waitcnt lgkmcnt(4)
v_mfma_f32_16x16x32_bf16 v[192:195], v[72:75], a[160:163], v[192:195]
v_exp_f32 v212, v212
v_mfma_f32_16x16x32_bf16 v[192:195], v[76:79], a[176:179], v[192:195]
v_exp_f32 v214, v214
v_mfma_f32_16x16x32_bf16 v[196:199], v[72:75], a[164:167], v[196:199]
ds_read_b128 v[64:67], v2 offset:53248
v_fma_f32 v212, v212, v242, v242
v_mfma_f32_16x16x32_bf16 v[196:199], v[76:79], a[180:183], v[196:199]
buffer_load_dwordx4 v3, s[8:11], 0 offen offset:3072 sc1 lds
v_mfma_f32_16x16x32_bf16 v[200:203], v[72:75], a[168:171], v[200:203]
s_add_u32 m0, s22, 4096
v_add_u32 v3, 4096, v3
v_mfma_f32_16x16x32_bf16 v[200:203], v[76:79], a[184:187], v[200:203]
ds_read_b128 v[68:71], v2 offset:54272
v_fma_f32 v214, v214, v242, v242
v_mfma_f32_16x16x32_bf16 v[204:207], v[72:75], a[172:175], v[204:207]
v_rcp_f32 v212, v212
v_mfma_f32_16x16x32_bf16 v[204:207], v[76:79], a[188:191], v[204:207]
v_mul_f32 v213, v213, v212
s_waitcnt lgkmcnt(4)
v_mfma_f32_16x16x32_bf16 v[176:179], v[48:51], a[192:195], v[176:179]
buffer_load_dwordx4 v3, s[8:11], 0 offen offset:0 sc1 lds
v_mfma_f32_16x16x32_bf16 v[176:179], v[52:55], a[208:211], v[176:179]
v_rcp_f32 v214, v214
v_mfma_f32_16x16x32_bf16 v[180:183], v[48:51], a[196:199], v[180:183]
ds_read_b128 v[72:75], v2 offset:55296
v_mul_f32 v215, v215, v214
v_mfma_f32_16x16x32_bf16 v[180:183], v[52:55], a[212:215], v[180:183]
v_cvt_pk_bf16_f32 v229, v213, v215
v_mul_f32 v210, v93, v93
v_mfma_f32_16x16x32_bf16 v[184:187], v[48:51], a[200:203], v[184:187]
buffer_store_dwordx2 v[228:229], v250, s[8:11], s30 offen sc1
v_mfma_f32_16x16x32_bf16 v[184:187], v[52:55], a[216:219], v[184:187]
ds_read_b128 v[76:79], v2 offset:56320
v_fma_f32 v208, v208, v245, v244
v_mfma_f32_16x16x32_bf16 v[188:191], v[48:51], a[204:207], v[188:191]
v_fma_f32 v210, v210, v245, v244
v_mul_f32 v208, v208, v92
v_mfma_f32_16x16x32_bf16 v[188:191], v[52:55], a[220:223], v[188:191]
v_mul_f32 v210, v210, v93
s_waitcnt lgkmcnt(4)
v_mfma_f32_16x16x32_bf16 v[192:195], v[56:59], a[192:195], v[192:195]
v_exp_f32 v208, v208
v_mfma_f32_16x16x32_bf16 v[192:195], v[60:63], a[208:211], v[192:195]
buffer_load_dwordx4 v3, s[8:11], 0 offen offset:1024 sc1 lds
v_mfma_f32_16x16x32_bf16 v[196:199], v[56:59], a[196:199], v[196:199]
ds_read_b128 v[48:51], v2 offset:57344
v_mul_f32 v209, v92, v108
v_mfma_f32_16x16x32_bf16 v[196:199], v[60:63], a[212:215], v[196:199]
v_exp_f32 v210, v210
v_mfma_f32_16x16x32_bf16 v[200:203], v[56:59], a[200:203], v[200:203]
v_mul_f32 v211, v93, v109
v_fma_f32 v208, v208, v246, v246
v_mfma_f32_16x16x32_bf16 v[200:203], v[60:63], a[216:219], v[200:203]
ds_read_b128 v[52:55], v2 offset:58368
v_fma_f32 v210, v210, v246, v246
v_mfma_f32_16x16x32_bf16 v[204:207], v[56:59], a[204:207], v[204:207]
v_rcp_f32 v208, v208
v_mfma_f32_16x16x32_bf16 v[204:207], v[60:63], a[220:223], v[204:207]
v_mul_f32 v209, v209, v208
s_waitcnt lgkmcnt(4)
v_mfma_f32_16x16x32_bf16 v[176:179], v[64:67], a[224:227], v[176:179]
v_rcp_f32 v210, v210
v_mfma_f32_16x16x32_bf16 v[176:179], v[68:71], a[240:243], v[176:179]
v_mul_f32 v211, v211, v210
v_cvt_pk_bf16_f32 v230, v209, v211
v_mfma_f32_16x16x32_bf16 v[180:183], v[64:67], a[228:231], v[180:183]
ds_read_b128 v[56:59], v2 offset:59392
v_mul_f32 v212, v94, v94
v_mfma_f32_16x16x32_bf16 v[180:183], v[68:71], a[244:247], v[180:183]
v_mul_f32 v214, v95, v95
v_fma_f32 v212, v212, v245, v244
v_mfma_f32_16x16x32_bf16 v[184:187], v[64:67], a[232:235], v[184:187]
v_fma_f32 v214, v214, v245, v244
v_mul_f32 v212, v212, v94
v_mfma_f32_16x16x32_bf16 v[184:187], v[68:71], a[248:251], v[184:187]
ds_read_b128 v[60:63], v2 offset:60416
v_mul_f32 v214, v214, v95
v_mfma_f32_16x16x32_bf16 v[188:191], v[64:67], a[236:239], v[188:191]
v_exp_f32 v212, v212
v_mfma_f32_16x16x32_bf16 v[188:191], v[68:71], a[252:255], v[188:191]
v_mul_f32 v213, v94, v110
s_waitcnt lgkmcnt(4)
v_mfma_f32_16x16x32_bf16 v[192:195], v[72:75], a[224:227], v[192:195]
v_exp_f32 v214, v214
v_mfma_f32_16x16x32_bf16 v[192:195], v[76:79], a[240:243], v[192:195]
v_mul_f32 v215, v95, v111
v_fma_f32 v212, v212, v246, v246
v_mfma_f32_16x16x32_bf16 v[196:199], v[72:75], a[228:231], v[196:199]
ds_read_b128 v[64:67], v2 offset:61440
v_fma_f32 v214, v214, v246, v246
v_mfma_f32_16x16x32_bf16 v[196:199], v[76:79], a[244:247], v[196:199]
v_rcp_f32 v212, v212
v_mfma_f32_16x16x32_bf16 v[200:203], v[72:75], a[232:235], v[200:203]
v_rcp_f32 v214, v214
v_mfma_f32_16x16x32_bf16 v[200:203], v[76:79], a[248:251], v[200:203]
ds_read_b128 v[68:71], v2 offset:62464
v_mul_f32 v213, v213, v212
v_mfma_f32_16x16x32_bf16 v[204:207], v[72:75], a[236:239], v[204:207]
v_mul_f32 v215, v215, v214
v_cvt_pk_bf16_f32 v231, v213, v215
v_mfma_f32_16x16x32_bf16 v[204:207], v[76:79], a[252:255], v[204:207]
v_mul_f32 v208, v112, v112
s_waitcnt lgkmcnt(4)
v_mfma_f32_16x16x32_bf16 v[176:179], v[48:51], v[16:19], v[176:179]
buffer_store_dwordx2 v[230:231], v251, s[8:11], s30 offen sc1
v_mfma_f32_16x16x32_bf16 v[176:179], v[52:55], v[32:35], v[176:179]
v_mul_f32 v210, v113, v113
v_fma_f32 v208, v208, v233, v232
v_mfma_f32_16x16x32_bf16 v[180:183], v[48:51], v[20:23], v[180:183]
ds_read_b128 v[72:75], v2 offset:63488
v_fma_f32 v210, v210, v233, v232
v_mfma_f32_16x16x32_bf16 v[180:183], v[52:55], v[36:39], v[180:183]
v_mul_f32 v208, v208, v112
v_mul_f32 v210, v210, v113
v_mfma_f32_16x16x32_bf16 v[184:187], v[48:51], v[24:27], v[184:187]
v_exp_f32 v208, v208
v_mfma_f32_16x16x32_bf16 v[184:187], v[52:55], v[40:43], v[184:187]
ds_read_b128 v[76:79], v2 offset:64512
v_mul_f32 v209, v112, v128
v_mfma_f32_16x16x32_bf16 v[188:191], v[48:51], v[28:31], v[188:191]
v_exp_f32 v210, v210
v_mfma_f32_16x16x32_bf16 v[188:191], v[52:55], v[44:47], v[188:191]
v_mul_f32 v211, v113, v129
s_waitcnt lgkmcnt(4)
v_mfma_f32_16x16x32_bf16 v[192:195], v[56:59], v[16:19], v[192:195]
v_fma_f32 v208, v208, v234, v234
v_fma_f32 v210, v210, v234, v234
v_mfma_f32_16x16x32_bf16 v[192:195], v[60:63], v[32:35], v[192:195]
v_rcp_f32 v208, v208
v_mfma_f32_16x16x32_bf16 v[196:199], v[56:59], v[20:23], v[196:199]
ds_read_b128 v[48:51], v7 offset:0
v_mul_f32 v209, v209, v208
v_mfma_f32_16x16x32_bf16 v[196:199], v[60:63], v[36:39], v[196:199]
v_rcp_f32 v210, v210
v_mfma_f32_16x16x32_bf16 v[200:203], v[56:59], v[24:27], v[200:203]
v_mul_f32 v211, v211, v210
v_cvt_pk_bf16_f32 v144, v209, v211
v_mfma_f32_16x16x32_bf16 v[200:203], v[60:63], v[40:43], v[200:203]
ds_read_b128 v[52:55], v7 offset:1024
v_mul_f32 v212, v114, v114
v_mfma_f32_16x16x32_bf16 v[204:207], v[56:59], v[28:31], v[204:207]
v_mul_f32 v214, v115, v115
v_fma_f32 v212, v212, v233, v232
v_mfma_f32_16x16x32_bf16 v[204:207], v[60:63], v[44:47], v[204:207]
v_fma_f32 v214, v214, v233, v232
s_waitcnt lgkmcnt(4)
v_mfma_f32_16x16x32_bf16 v[80:83], v[64:67], a[0:3], 0
v_mul_f32 v212, v212, v114
v_mul_f32 v214, v214, v115
v_mfma_f32_16x16x32_bf16 v[80:83], v[68:71], a[16:19], v[80:83]
v_exp_f32 v212, v212
v_mfma_f32_16x16x32_bf16 v[84:87], v[64:67], a[4:7], 0
ds_read_b128 v[56:59], v7 offset:2048
v_mul_f32 v213, v114, v130
v_mfma_f32_16x16x32_bf16 v[84:87], v[68:71], a[20:23], v[84:87]
v_exp_f32 v214, v214
v_mfma_f32_16x16x32_bf16 v[88:91], v[64:67], a[8:11], 0
v_mul_f32 v215, v115, v131
v_fma_f32 v212, v212, v234, v234
v_mfma_f32_16x16x32_bf16 v[88:91], v[68:71], a[24:27], v[88:91]
ds_read_b128 v[60:63], v7 offset:3072
v_fma_f32 v214, v214, v234, v234
v_mfma_f32_16x16x32_bf16 v[92:95], v[64:67], a[12:15], 0
v_rcp_f32 v212, v212
v_mfma_f32_16x16x32_bf16 v[92:95], v[68:71], a[28:31], v[92:95]
v_mul_f32 v213, v213, v212
s_waitcnt lgkmcnt(4)
v_mfma_f32_16x16x32_bf16 v[96:99], v[72:75], a[0:3], 0
v_rcp_f32 v214, v214
v_mfma_f32_16x16x32_bf16 v[96:99], v[76:79], a[16:19], v[96:99]
v_mul_f32 v215, v215, v214
v_cvt_pk_bf16_f32 v145, v213, v215
v_mfma_f32_16x16x32_bf16 v[100:103], v[72:75], a[4:7], 0
ds_read_b128 v[64:67], v7 offset:4096
v_mul_f32 v208, v116, v116
v_mfma_f32_16x16x32_bf16 v[100:103], v[76:79], a[20:23], v[100:103]
v_mul_f32 v210, v117, v117
v_fma_f32 v208, v208, v237, v236
v_mfma_f32_16x16x32_bf16 v[104:107], v[72:75], a[8:11], 0
v_fma_f32 v210, v210, v237, v236
v_mul_f32 v208, v208, v116
v_mfma_f32_16x16x32_bf16 v[104:107], v[76:79], a[24:27], v[104:107]
ds_read_b128 v[68:71], v7 offset:5120
v_mul_f32 v210, v210, v117
v_mfma_f32_16x16x32_bf16 v[108:111], v[72:75], a[12:15], 0
v_exp_f32 v208, v208
v_mfma_f32_16x16x32_bf16 v[108:111], v[76:79], a[28:31], v[108:111]
v_mul_f32 v209, v116, v132
s_waitcnt lgkmcnt(4)
v_mfma_f32_16x16x32_bf16 v[80:83], v[48:51], a[32:35], v[80:83]
v_exp_f32 v210, v210
v_mfma_f32_16x16x32_bf16 v[80:83], v[52:55], a[48:51], v[80:83]
v_mul_f32 v211, v117, v133
v_fma_f32 v208, v208, v238, v238
v_mfma_f32_16x16x32_bf16 v[84:87], v[48:51], a[36:39], v[84:87]
ds_read_b128 v[72:75], v7 offset:6144
v_fma_f32 v210, v210, v238, v238
v_mfma_f32_16x16x32_bf16 v[84:87], v[52:55], a[52:55], v[84:87]
v_rcp_f32 v208, v208
v_mfma_f32_16x16x32_bf16 v[88:91], v[48:51], a[40:43], v[88:91]
v_rcp_f32 v210, v210
v_mfma_f32_16x16x32_bf16 v[88:91], v[52:55], a[56:59], v[88:91]
ds_read_b128 v[76:79], v7 offset:7168
v_mul_f32 v209, v209, v208
v_mfma_f32_16x16x32_bf16 v[92:95], v[48:51], a[44:47], v[92:95]
v_mul_f32 v211, v211, v210
v_cvt_pk_bf16_f32 v148, v209, v211
v_mfma_f32_16x16x32_bf16 v[92:95], v[52:55], a[60:63], v[92:95]
v_mul_f32 v212, v118, v118
s_waitcnt lgkmcnt(4)
v_mfma_f32_16x16x32_bf16 v[96:99], v[56:59], a[32:35], v[96:99]
s_waitcnt vmcnt(22)
v_mul_f32 v214, v119, v119
v_mfma_f32_16x16x32_bf16 v[96:99], v[60:63], a[48:51], v[96:99]
s_barrier
v_mfma_f32_16x16x32_bf16 v[100:103], v[56:59], a[36:39], v[100:103]
ds_read_b128 v[48:51], v7 offset:8192
s_add_u32 m0, s22, 24576
v_mfma_f32_16x16x32_bf16 v[100:103], v[60:63], a[52:55], v[100:103]
v_add_u32 v3, 20480, v3
buffer_load_dwordx4 v3, s[8:11], 0 offen offset:0 sc1 lds
v_mfma_f32_16x16x32_bf16 v[104:107], v[56:59], a[40:43], v[104:107]
v_fma_f32 v212, v212, v237, v236
v_fma_f32 v214, v214, v237, v236
v_mfma_f32_16x16x32_bf16 v[104:107], v[60:63], a[56:59], v[104:107]
ds_read_b128 v[52:55], v7 offset:9216
v_mul_f32 v212, v212, v118
v_mfma_f32_16x16x32_bf16 v[108:111], v[56:59], a[44:47], v[108:111]
v_mul_f32 v214, v214, v119
v_mul_f32 v213, v118, v134
v_mfma_f32_16x16x32_bf16 v[108:111], v[60:63], a[60:63], v[108:111]
v_mul_f32 v215, v119, v135
s_waitcnt lgkmcnt(4)
v_mfma_f32_16x16x32_bf16 v[80:83], v[64:67], a[64:67], v[80:83]
buffer_load_dwordx4 v3, s[8:11], 0 offen offset:1024 sc1 lds
v_mfma_f32_16x16x32_bf16 v[80:83], v[68:71], a[80:83], v[80:83]
v_exp_f32 v212, v212
v_mfma_f32_16x16x32_bf16 v[84:87], v[64:67], a[68:71], v[84:87]
ds_read_b128 v[56:59], v7 offset:10240
v_fma_f32 v212, v212, v238, v238
v_mfma_f32_16x16x32_bf16 v[84:87], v[68:71], a[84:87], v[84:87]
v_exp_f32 v214, v214
v_mfma_f32_16x16x32_bf16 v[88:91], v[64:67], a[72:75], v[88:91]
v_fma_f32 v214, v214, v238, v238
v_mul_f32 v208, v120, v120
v_mfma_f32_16x16x32_bf16 v[88:91], v[68:71], a[88:91], v[88:91]
ds_read_b128 v[60:63], v7 offset:11264
v_mul_f32 v210, v121, v121
v_mfma_f32_16x16x32_bf16 v[92:95], v[64:67], a[76:79], v[92:95]
buffer_load_dwordx4 v3, s[8:11], 0 offen offset:2048 sc1 lds
v_mfma_f32_16x16x32_bf16 v[92:95], v[68:71], a[92:95], v[92:95]
v_fma_f32 v208, v208, v241, v240
s_waitcnt lgkmcnt(4)
v_mfma_f32_16x16x32_bf16 v[96:99], v[72:75], a[64:67], v[96:99]
v_rcp_f32 v212, v212
v_mfma_f32_16x16x32_bf16 v[96:99], v[76:79], a[80:83], v[96:99]
v_rcp_f32 v214, v214
v_mfma_f32_16x16x32_bf16 v[100:103], v[72:75], a[68:71], v[100:103]
ds_read_b128 v[64:67], v7 offset:12288
v_mul_f32 v213, v213, v212
v_mfma_f32_16x16x32_bf16 v[100:103], v[76:79], a[84:87], v[100:103]
buffer_load_dwordx4 v3, s[8:11], 0 offen offset:3072 sc1 lds
v_mfma_f32_16x16x32_bf16 v[104:107], v[72:75], a[72:75], v[104:107]
s_add_u32 m0, s22, 28672
v_add_u32 v3, 4096, v3
v_mfma_f32_16x16x32_bf16 v[104:107], v[76:79], a[88:91], v[104:107]
ds_read_b128 v[68:71], v7 offset:13312
v_mul_f32 v215, v215, v214
v_mfma_f32_16x16x32_bf16 v[108:111], v[72:75], a[76:79], v[108:111]
v_cvt_pk_bf16_f32 v149, v213, v215
v_fma_f32 v210, v210, v241, v240
v_mfma_f32_16x16x32_bf16 v[108:111], v[76:79], a[92:95], v[108:111]
v_mul_f32 v208, v208, v120
s_waitcnt lgkmcnt(4)
v_mfma_f32_16x16x32_bf16 v[80:83], v[48:51], a[96:99], v[80:83]
buffer_load_dwordx4 v3, s[8:11], 0 offen offset:0 sc1 lds
v_mfma_f32_16x16x32_bf16 v[80:83], v[52:55], a[112:115], v[80:83]
v_mul_f32 v210, v210, v121
v_mul_f32 v209, v120, v136
v_mfma_f32_16x16x32_bf16 v[84:87], v[48:51], a[100:103], v[84:87]
ds_read_b128 v[72:75], v7 offset:14336
v_mul_f32 v211, v121, v137
v_mfma_f32_16x16x32_bf16 v[84:87], v[52:55], a[116:119], v[84:87]
v_exp_f32 v208, v208
v_mfma_f32_16x16x32_bf16 v[88:91], v[48:51], a[104:107], v[88:91]
v_exp_f32 v210, v210
v_mfma_f32_16x16x32_bf16 v[88:91], v[52:55], a[120:123], v[88:91]
ds_read_b128 v[76:79], v7 offset:15360
v_fma_f32 v208, v208, v242, v242
v_mfma_f32_16x16x32_bf16 v[92:95], v[48:51], a[108:111], v[92:95]
buffer_load_dwordx4 v3, s[8:11], 0 offen offset:1024 sc1 lds
v_mfma_f32_16x16x32_bf16 v[92:95], v[52:55], a[124:127], v[92:95]
v_fma_f32 v210, v210, v242, v242
s_waitcnt lgkmcnt(4)
v_mfma_f32_16x16x32_bf16 v[96:99], v[56:59], a[96:99], v[96:99]
v_rcp_f32 v208, v208
v_mfma_f32_16x16x32_bf16 v[96:99], v[60:63], a[112:115], v[96:99]
v_rcp_f32 v210, v210
v_mfma_f32_16x16x32_bf16 v[100:103], v[56:59], a[100:103], v[100:103]
ds_read_b128 v[48:51], v7 offset:16384
v_mul_f32 v209, v209, v208
v_mfma_f32_16x16x32_bf16 v[100:103], v[60:63], a[116:119], v[100:103]
v_mul_f32 v211, v211, v210
v_cvt_pk_bf16_f32 v152, v209, v211
v_mfma_f32_16x16x32_bf16 v[104:107], v[56:59], a[104:107], v[104:107]
v_mul_f32 v212, v122, v122
v_mul_f32 v214, v123, v123
v_mfma_f32_16x16x32_bf16 v[104:107], v[60:63], a[120:123], v[104:107]
ds_read_b128 v[52:55], v7 offset:17408
v_fma_f32 v212, v212, v241, v240
v_mfma_f32_16x16x32_bf16 v[108:111], v[56:59], a[108:111], v[108:111]
v_fma_f32 v214, v214, v241, v240
v_mul_f32 v212, v212, v122
v_mfma_f32_16x16x32_bf16 v[108:111], v[60:63], a[124:127], v[108:111]
v_mul_f32 v214, v214, v123
s_waitcnt lgkmcnt(4)
v_mfma_f32_16x16x32_bf16 v[80:83], v[64:67], a[128:131], v[80:83]
v_exp_f32 v212, v212
v_mfma_f32_16x16x32_bf16 v[80:83], v[68:71], a[144:147], v[80:83]
v_exp_f32 v214, v214
v_mfma_f32_16x16x32_bf16 v[84:87], v[64:67], a[132:135], v[84:87]
ds_read_b128 v[56:59], v7 offset:18432
v_mul_f32 v213, v122, v138
v_mfma_f32_16x16x32_bf16 v[84:87], v[68:71], a[148:151], v[84:87]
v_mul_f32 v215, v123, v139
v_fma_f32 v212, v212, v242, v242
v_mfma_f32_16x16x32_bf16 v[88:91], v[64:67], a[136:139], v[88:91]
v_fma_f32 v214, v214, v242, v242
v_mul_f32 v208, v124, v124
v_mfma_f32_16x16x32_bf16 v[88:91], v[68:71], a[152:155], v[88:91]
ds_read_b128 v[60:63], v7 offset:19456
v_mul_f32 v210, v125, v125
v_mfma_f32_16x16x32_bf16 v[92:95], v[64:67], a[140:143], v[92:95]
v_rcp_f32 v212, v212
v_mfma_f32_16x16x32_bf16 v[92:95], v[68:71], a[156:159], v[92:95]
v_mul_f32 v213, v213, v212
s_waitcnt lgkmcnt(4)
v_mfma_f32_16x16x32_bf16 v[96:99], v[72:75], a[128:131], v[96:99]
v_rcp_f32 v214, v214
v_mfma_f32_16x16x32_bf16 v[96:99], v[76:79], a[144:147], v[96:99]
v_mul_f32 v215, v215, v214
v_cvt_pk_bf16_f32 v153, v213, v215
v_mfma_f32_16x16x32_bf16 v[100:103], v[72:75], a[132:135], v[100:103]
ds_read_b128 v[64:67], v7 offset:20480
v_fma_f32 v208, v208, v245, v244
v_mfma_f32_16x16x32_bf16 v[100:103], v[76:79], a[148:151], v[100:103]
v_fma_f32 v210, v210, v245, v244
v_mul_f32 v208, v208, v124
v_mfma_f32_16x16x32_bf16 v[104:107], v[72:75], a[136:139], v[104:107]
v_mul_f32 v210, v210, v125
v_mul_f32 v209, v124, v140
v_mfma_f32_16x16x32_bf16 v[104:107], v[76:79], a[152:155], v[104:107]
ds_read_b128 v[68:71], v7 offset:21504
v_mul_f32 v211, v125, v141
v_mfma_f32_16x16x32_bf16 v[108:111], v[72:75], a[140:143], v[108:111]
v_exp_f32 v208, v208
v_mfma_f32_16x16x32_bf16 v[108:111], v[76:79], a[156:159], v[108:111]
v_fma_f32 v208, v208, v246, v246
s_waitcnt lgkmcnt(4)
v_mfma_f32_16x16x32_bf16 v[80:83], v[48:51], a[160:163], v[80:83]
v_exp_f32 v210, v210
v_mfma_f32_16x16x32_bf16 v[80:83], v[52:55], a[176:179], v[80:83]
v_fma_f32 v210, v210, v246, v246
v_mul_f32 v212, v126, v126
v_mfma_f32_16x16x32_bf16 v[84:87], v[48:51], a[164:167], v[84:87]
ds_read_b128 v[72:75], v7 offset:22528
v_mul_f32 v214, v127, v127
v_mfma_f32_16x16x32_bf16 v[84:87], v[52:55], a[180:183], v[84:87]
v_rcp_f32 v208, v208
v_mfma_f32_16x16x32_bf16 v[88:91], v[48:51], a[168:171], v[88:91]
v_rcp_f32 v210, v210
v_mfma_f32_16x16x32_bf16 v[88:91], v[52:55], a[184:187], v[88:91]
ds_read_b128 v[76:79], v7 offset:23552
v_mul_f32 v209, v209, v208
v_mfma_f32_16x16x32_bf16 v[92:95], v[48:51], a[172:175], v[92:95]
v_mul_f32 v211, v211, v210
v_cvt_pk_bf16_f32 v156, v209, v211
v_mfma_f32_16x16x32_bf16 v[92:95], v[52:55], a[188:191], v[92:95]
v_fma_f32 v212, v212, v245, v244
s_waitcnt lgkmcnt(4)
v_mfma_f32_16x16x32_bf16 v[96:99], v[56:59], a[160:163], v[96:99]
v_fma_f32 v214, v214, v245, v244
v_mul_f32 v212, v212, v126
v_mfma_f32_16x16x32_bf16 v[96:99], v[60:63], a[176:179], v[96:99]
v_mul_f32 v214, v214, v127
v_mul_f32 v213, v126, v142
v_mfma_f32_16x16x32_bf16 v[100:103], v[56:59], a[164:167], v[100:103]
ds_read_b128 v[48:51], v7 offset:24576
v_mul_f32 v215, v127, v143
v_mfma_f32_16x16x32_bf16 v[100:103], v[60:63], a[180:183], v[100:103]
v_exp_f32 v212, v212
v_mfma_f32_16x16x32_bf16 v[104:107], v[56:59], a[168:171], v[104:107]
v_exp_f32 v214, v214
v_mfma_f32_16x16x32_bf16 v[104:107], v[60:63], a[184:187], v[104:107]
ds_read_b128 v[52:55], v7 offset:25600
v_fma_f32 v212, v212, v246, v246
v_mfma_f32_16x16x32_bf16 v[108:111], v[56:59], a[172:175], v[108:111]
v_fma_f32 v214, v214, v246, v246
v_mul_f32 v216, v176, v176
v_mfma_f32_16x16x32_bf16 v[108:111], v[60:63], a[188:191], v[108:111]
v_mul_f32 v218, v177, v177
s_waitcnt lgkmcnt(4)
v_mfma_f32_16x16x32_bf16 v[80:83], v[64:67], a[192:195], v[80:83]
v_rcp_f32 v212, v212
v_mfma_f32_16x16x32_bf16 v[80:83], v[68:71], a[208:211], v[80:83]
v_rcp_f32 v214, v214
v_mfma_f32_16x16x32_bf16 v[84:87], v[64:67], a[196:199], v[84:87]
ds_read_b128 v[56:59], v7 offset:26624
v_mul_f32 v213, v213, v212
v_mfma_f32_16x16x32_bf16 v[84:87], v[68:71], a[212:215], v[84:87]
v_mul_f32 v215, v215, v214
v_cvt_pk_bf16_f32 v157, v213, v215
v_mfma_f32_16x16x32_bf16 v[88:91], v[64:67], a[200:203], v[88:91]
v_fma_f32 v216, v216, v233, v232
v_fma_f32 v218, v218, v233, v232
v_mfma_f32_16x16x32_bf16 v[88:91], v[68:71], a[216:219], v[88:91]
ds_read_b128 v[60:63], v7 offset:27648
v_mul_f32 v216, v216, v176
v_mfma_f32_16x16x32_bf16 v[92:95], v[64:67], a[204:207], v[92:95]
v_mul_f32 v218, v218, v177
v_mul_f32 v217, v176, v192
v_mfma_f32_16x16x32_bf16 v[92:95], v[68:71], a[220:223], v[92:95]
v_mul_f32 v219, v177, v193
s_waitcnt lgkmcnt(4)
v_mfma_f32_16x16x32_bf16 v[96:99], v[72:75], a[192:195], v[96:99]
v_exp_f32 v216, v216
v_mfma_f32_16x16x32_bf16 v[96:99], v[76:79], a[208:211], v[96:99]
v_exp_f32 v218, v218
v_mfma_f32_16x16x32_bf16 v[100:103], v[72:75], a[196:199], v[100:103]
ds_read_b128 v[64:67], v7 offset:28672
v_fma_f32 v216, v216, v234, v234
v_mfma_f32_16x16x32_bf16 v[100:103], v[76:79], a[212:215], v[100:103]
v_fma_f32 v218, v218, v234, v234
v_mul_f32 v220, v178, v178
v_mfma_f32_16x16x32_bf16 v[104:107], v[72:75], a[200:203], v[104:107]
v_rcp_f32 v216, v216
v_mfma_f32_16x16x32_bf16 v[104:107], v[76:79], a[216:219], v[104:107]
ds_read_b128 v[68:71], v7 offset:29696
v_mul_f32 v217, v217, v216
v_mfma_f32_16x16x32_bf16 v[108:111], v[72:75], a[204:207], v[108:111]
v_rcp_f32 v218, v218
v_mfma_f32_16x16x32_bf16 v[108:111], v[76:79], a[220:223], v[108:111]
v_mul_f32 v219, v219, v218
s_waitcnt lgkmcnt(4)
v_mfma_f32_16x16x32_bf16 v[80:83], v[48:51], a[224:227], v[80:83]
v_cvt_pk_bf16_f32 v146, v217, v219
v_mul_f32 v222, v179, v179
v_mfma_f32_16x16x32_bf16 v[80:83], v[52:55], a[240:243], v[80:83]
v_fma_f32 v220, v220, v233, v232
v_fma_f32 v222, v222, v233, v232
v_mfma_f32_16x16x32_bf16 v[84:87], v[48:51], a[228:231], v[84:87]
ds_read_b128 v[72:75], v7 offset:30720
v_mul_f32 v220, v220, v178
v_mfma_f32_16x16x32_bf16 v[84:87], v[52:55], a[244:247], v[84:87]
v_mul_f32 v222, v222, v179
v_mul_f32 v221, v178, v194
v_mfma_f32_16x16x32_bf16 v[88:91], v[48:51], a[232:235], v[88:91]
v_exp_f32 v220, v220
v_mfma_f32_16x16x32_bf16 v[88:91], v[52:55], a[248:251], v[88:91]
ds_read_b128 v[76:79], v7 offset:31744
v_mul_f32 v223, v179, v195
v_mfma_f32_16x16x32_bf16 v[92:95], v[48:51], a[236:239], v[92:95]
v_exp_f32 v222, v222
v_mfma_f32_16x16x32_bf16 v[92:95], v[52:55], a[252:255], v[92:95]
v_fma_f32 v220, v220, v234, v234
s_waitcnt lgkmcnt(4)
v_mfma_f32_16x16x32_bf16 v[96:99], v[56:59], a[224:227], v[96:99]
s_waitcnt vmcnt(22)
v_fma_f32 v222, v222, v234, v234
v_mfma_f32_16x16x32_bf16 v[96:99], v[60:63], a[240:243], v[96:99]
s_barrier
v_mfma_f32_16x16x32_bf16 v[100:103], v[56:59], a[228:231], v[100:103]
ds_read_b128 v[48:51], v7 offset:32768
s_add_u32 m0, s22, 49152
v_mfma_f32_16x16x32_bf16 v[100:103], v[60:63], a[244:247], v[100:103]
v_add_u32 v3, 20480, v3
buffer_load_dwordx4 v3, s[8:11], 0 offen offset:0 sc1 lds
v_mfma_f32_16x16x32_bf16 v[104:107], v[56:59], a[232:235], v[104:107]
v_rcp_f32 v220, v220
v_mfma_f32_16x16x32_bf16 v[104:107], v[60:63], a[248:251], v[104:107]
ds_read_b128 v[52:55], v7 offset:33792
v_mul_f32 v221, v221, v220
v_mfma_f32_16x16x32_bf16 v[108:111], v[56:59], a[236:239], v[108:111]
v_rcp_f32 v222, v222
v_mfma_f32_16x16x32_bf16 v[108:111], v[60:63], a[252:255], v[108:111]
v_mul_f32 v223, v223, v222
s_waitcnt lgkmcnt(4)
v_mfma_f32_16x16x32_bf16 v[80:83], v[64:67], v[16:19], v[80:83]
buffer_load_dwordx4 v3, s[8:11], 0 offen offset:1024 sc1 lds
v_mfma_f32_16x16x32_bf16 v[80:83], v[68:71], v[32:35], v[80:83]
v_cvt_pk_bf16_f32 v147, v221, v223
v_mul_f32 v216, v180, v180
v_mfma_f32_16x16x32_bf16 v[84:87], v[64:67], v[20:23], v[84:87]
ds_read_b128 v[56:59], v7 offset:34816
v_mul_f32 v218, v181, v181
v_mfma_f32_16x16x32_bf16 v[84:87], v[68:71], v[36:39], v[84:87]
buffer_store_dwordx4 v[144:147], v2, s[8:11], s24 offen offset:0 sc1
v_mfma_f32_16x16x32_bf16 v[88:91], v[64:67], v[24:27], v[88:91]
v_fma_f32 v216, v216, v237, v236
v_fma_f32 v218, v218, v237, v236
v_mfma_f32_16x16x32_bf16 v[88:91], v[68:71], v[40:43], v[88:91]
ds_read_b128 v[60:63], v7 offset:35840
v_mul_f32 v216, v216, v180
v_mfma_f32_16x16x32_bf16 v[92:95], v[64:67], v[28:31], v[92:95]
v_mul_f32 v218, v218, v181
v_mul_f32 v217, v180, v196
v_mfma_f32_16x16x32_bf16 v[92:95], v[68:71], v[44:47], v[92:95]
v_mul_f32 v219, v181, v197
s_waitcnt lgkmcnt(4)
v_mfma_f32_16x16x32_bf16 v[96:99], v[72:75], v[16:19], v[96:99]
buffer_load_dwordx4 v3, s[8:11], 0 offen offset:2048 sc1 lds
v_mfma_f32_16x16x32_bf16 v[96:99], v[76:79], v[32:35], v[96:99]
v_exp_f32 v216, v216
v_mfma_f32_16x16x32_bf16 v[100:103], v[72:75], v[20:23], v[100:103]
ds_read_b128 v[64:67], v7 offset:36864
v_fma_f32 v216, v216, v238, v238
v_mfma_f32_16x16x32_bf16 v[100:103], v[76:79], v[36:39], v[100:103]
v_exp_f32 v218, v218
v_mfma_f32_16x16x32_bf16 v[104:107], v[72:75], v[24:27], v[104:107]
v_fma_f32 v218, v218, v238, v238
v_mul_f32 v220, v182, v182
v_mfma_f32_16x16x32_bf16 v[104:107], v[76:79], v[40:43], v[104:107]
ds_read_b128 v[68:71], v7 offset:37888
v_mul_f32 v222, v183, v183
v_mfma_f32_16x16x32_bf16 v[108:111], v[72:75], v[28:31], v[108:111]
buffer_load_dwordx4 v3, s[8:11], 0 offen offset:3072 sc1 lds
v_mfma_f32_16x16x32_bf16 v[108:111], v[76:79], v[44:47], v[108:111]
s_add_u32 m0, s22, 53248
s_waitcnt lgkmcnt(4)
v_mfma_f32_16x16x32_bf16 v[112:115], v[48:51], a[0:3], 0
v_add_u32 v3, 4096, v3
v_fma_f32 v220, v220, v237, v236
v_mfma_f32_16x16x32_bf16 v[112:115], v[52:55], a[16:19], v[112:115]
v_rcp_f32 v216, v216
v_mfma_f32_16x16x32_bf16 v[116:119], v[48:51], a[4:7], 0
ds_read_b128 v[72:75], v7 offset:38912
v_mul_f32 v217, v217, v216
v_mfma_f32_16x16x32_bf16 v[116:119], v[52:55], a[20:23], v[116:119]
buffer_load_dwordx4 v3, s[8:11], 0 offen offset:0 sc1 lds
v_mfma_f32_16x16x32_bf16 v[120:123], v[48:51], a[8:11], 0
v_mul_f32 v208, v80, v80
v_mul_f32 v210, v81, v81
v_mfma_f32_16x16x32_bf16 v[120:123], v[52:55], a[24:27], v[120:123]
ds_read_b128 v[76:79], v7 offset:39936
v_fma_f32 v208, v208, v233, v232
v_mfma_f32_16x16x32_bf16 v[124:127], v[48:51], a[12:15], 0
v_fma_f32 v210, v210, v233, v232
v_mul_f32 v208, v208, v80
v_mfma_f32_16x16x32_bf16 v[124:127], v[52:55], a[28:31], v[124:127]
v_mul_f32 v210, v210, v81
s_waitcnt lgkmcnt(4)
v_mfma_f32_16x16x32_bf16 v[128:131], v[56:59], a[0:3], 0
buffer_load_dwordx4 v3, s[8:11], 0 offen offset:1024 sc1 lds
v_mfma_f32_16x16x32_bf16 v[128:131], v[60:63], a[16:19], v[128:131]
v_exp_f32 v208, v208
v_mfma_f32_16x16x32_bf16 v[132:135], v[56:59], a[4:7], 0
ds_read_b128 v[48:51], v7 offset:40960
v_mul_f32 v209, v80, v96
v_mfma_f32_16x16x32_bf16 v[132:135], v[60:63], a[20:23], v[132:135]
v_exp_f32 v210, v210
v_mfma_f32_16x16x32_bf16 v[136:139], v[56:59], a[8:11], 0
v_mul_f32 v211, v81, v97
v_fma_f32 v208, v208, v234, v234
v_mfma_f32_16x16x32_bf16 v[136:139], v[60:63], a[24:27], v[136:139]
ds_read_b128 v[52:55], v7 offset:41984
v_fma_f32 v210, v210, v234, v234
v_mfma_f32_16x16x32_bf16 v[140:143], v[56:59], a[12:15], 0
v_rcp_f32 v208, v208
v_mfma_f32_16x16x32_bf16 v[140:143], v[60:63], a[28:31], v[140:143]
v_mul_f32 v209, v209, v208
s_waitcnt lgkmcnt(4)
v_mfma_f32_16x16x32_bf16 v[112:115], v[64:67], a[32:35], v[112:115]
v_rcp_f32 v210, v210
v_mfma_f32_16x16x32_bf16 v[112:115], v[68:71], a[48:51], v[112:115]
v_mul_f32 v211, v211, v210
v_cvt_pk_bf16_f32 v160, v209, v211
v_mfma_f32_16x16x32_bf16 v[116:119], v[64:67], a[36:39], v[116:119]
ds_read_b128 v[56:59], v7 offset:43008
v_mul_f32 v212, v82, v82
v_mfma_f32_16x16x32_bf16 v[116:119], v[68:71], a[52:55], v[116:119]
v_mul_f32 v214, v83, v83
v_fma_f32 v212, v212, v233, v232
v_mfma_f32_16x16x32_bf16 v[120:123], v[64:67], a[40:43], v[120:123]
v_fma_f32 v214, v214, v233, v232
v_mul_f32 v212, v212, v82
v_mfma_f32_16x16x32_bf16 v[120:123], v[68:71], a[56:59], v[120:123]
ds_read_b128 v[60:63], v7 offset:44032
v_mul_f32 v214, v214, v83
v_mfma_f32_16x16x32_bf16 v[124:127], v[64:67], a[44:47], v[124:127]
v_exp_f32 v212, v212
v_mfma_f32_16x16x32_bf16 v[124:127], v[68:71], a[60:63], v[124:127]
v_mul_f32 v213, v82, v98
s_waitcnt lgkmcnt(4)
v_mfma_f32_16x16x32_bf16 v[128:131], v[72:75], a[32:35], v[128:131]
v_exp_f32 v214, v214
v_mfma_f32_16x16x32_bf16 v[128:131], v[76:79], a[48:51], v[128:131]
v_mul_f32 v215, v83, v99
v_fma_f32 v212, v212, v234, v234
v_mfma_f32_16x16x32_bf16 v[132:135], v[72:75], a[36:39], v[132:135]
ds_read_b128 v[64:67], v7 offset:45056
v_fma_f32 v214, v214, v234, v234
v_mfma_f32_16x16x32_bf16 v[132:135], v[76:79], a[52:55], v[132:135]
v_rcp_f32 v212, v212
v_mfma_f32_16x16x32_bf16 v[136:139], v[72:75], a[40:43], v[136:139]
v_rcp_f32 v214, v214
v_mfma_f32_16x16x32_bf16 v[136:139], v[76:79], a[56:59], v[136:139]
ds_read_b128 v[68:71], v7 offset:46080
v_mul_f32 v213, v213, v212
v_mfma_f32_16x16x32_bf16 v[140:143], v[72:75], a[44:47], v[140:143]
v_mul_f32 v215, v215, v214
v_cvt_pk_bf16_f32 v161, v213, v215
v_mfma_f32_16x16x32_bf16 v[140:143], v[76:79], a[60:63], v[140:143]
v_mul_f32 v208, v84, v84
s_waitcnt lgkmcnt(4)
v_mfma_f32_16x16x32_bf16 v[112:115], v[48:51], a[64:67], v[112:115]
v_mul_f32 v210, v85, v85
v_fma_f32 v208, v208, v237, v236
v_mfma_f32_16x16x32_bf16 v[112:115], v[52:55], a[80:83], v[112:115]
v_fma_f32 v210, v210, v237, v236
v_mul_f32 v208, v208, v84
v_mfma_f32_16x16x32_bf16 v[116:119], v[48:51], a[68:71], v[116:119]
ds_read_b128 v[72:75], v7 offset:47104
v_mul_f32 v210, v210, v85
v_mfma_f32_16x16x32_bf16 v[116:119], v[52:55], a[84:87], v[116:119]
v_exp_f32 v208, v208
v_mfma_f32_16x16x32_bf16 v[120:123], v[48:51], a[72:75], v[120:123]
v_exp_f32 v210, v210
v_mfma_f32_16x16x32_bf16 v[120:123], v[52:55], a[88:91], v[120:123]
ds_read_b128 v[76:79], v7 offset:48128
v_mul_f32 v209, v84, v100
v_mfma_f32_16x16x32_bf16 v[124:127], v[48:51], a[76:79], v[124:127]
v_mul_f32 v211, v85, v101
v_fma_f32 v208, v208, v238, v238
v_mfma_f32_16x16x32_bf16 v[124:127], v[52:55], a[92:95], v[124:127]
v_fma_f32 v210, v210, v238, v238
s_waitcnt lgkmcnt(4)
v_mfma_f32_16x16x32_bf16 v[128:131], v[56:59], a[64:67], v[128:131]
v_rcp_f32 v208, v208
v_mfma_f32_16x16x32_bf16 v[128:131], v[60:63], a[80:83], v[128:131]
v_rcp_f32 v210, v210
v_mfma_f32_16x16x32_bf16 v[132:135], v[56:59], a[68:71], v[132:135]
ds_read_b128 v[48:51], v7 offset:49152
v_mul_f32 v209, v209, v208
v_mfma_f32_16x16x32_bf16 v[132:135], v[60:63], a[84:87], v[132:135]
v_mul_f32 v211, v211, v210
v_cvt_pk_bf16_f32 v164, v209, v211
v_mfma_f32_16x16x32_bf16 v[136:139], v[56:59], a[72:75], v[136:139]
v_mul_f32 v212, v86, v86
v_mul_f32 v214, v87, v87
v_mfma_f32_16x16x32_bf16 v[136:139], v[60:63], a[88:91], v[136:139]
ds_read_b128 v[52:55], v7 offset:50176
v_fma_f32 v212, v212, v237, v236
v_mfma_f32_16x16x32_bf16 v[140:143], v[56:59], a[76:79], v[140:143]
v_fma_f32 v214, v214, v237, v236
v_mul_f32 v212, v212, v86
v_mfma_f32_16x16x32_bf16 v[140:143], v[60:63], a[92:95], v[140:143]
v_mul_f32 v214, v214, v87
s_waitcnt lgkmcnt(4)
v_mfma_f32_16x16x32_bf16 v[112:115], v[64:67], a[96:99], v[112:115]
v_exp_f32 v212, v212
v_mfma_f32_16x16x32_bf16 v[112:115], v[68:71], a[112:115], v[112:115]
v_exp_f32 v214, v214
v_mfma_f32_16x16x32_bf16 v[116:119], v[64:67], a[100:103], v[116:119]
ds_read_b128 v[56:59], v7 offset:51200
v_mul_f32 v213, v86, v102
v_mfma_f32_16x16x32_bf16 v[116:119], v[68:71], a[116:119], v[116:119]
v_mul_f32 v215, v87, v103
v_fma_f32 v212, v212, v238, v238
v_mfma_f32_16x16x32_bf16 v[120:123], v[64:67], a[104:107], v[120:123]
v_fma_f32 v214, v214, v238, v238
v_mul_f32 v208, v88, v88
v_mfma_f32_16x16x32_bf16 v[120:123], v[68:71], a[120:123], v[120:123]
ds_read_b128 v[60:63], v7 offset:52224
v_mul_f32 v210, v89, v89
v_mfma_f32_16x16x32_bf16 v[124:127], v[64:67], a[108:111], v[124:127]
v_rcp_f32 v212, v212
v_mfma_f32_16x16x32_bf16 v[124:127], v[68:71], a[124:127], v[124:127]
v_mul_f32 v213, v213, v212
s_waitcnt lgkmcnt(4)
v_mfma_f32_16x16x32_bf16 v[128:131], v[72:75], a[96:99], v[128:131]
v_rcp_f32 v214, v214
v_mfma_f32_16x16x32_bf16 v[128:131], v[76:79], a[112:115], v[128:131]
v_mul_f32 v215, v215, v214
v_cvt_pk_bf16_f32 v165, v213, v215
v_mfma_f32_16x16x32_bf16 v[132:135], v[72:75], a[100:103], v[132:135]
ds_read_b128 v[64:67], v7 offset:53248
v_fma_f32 v208, v208, v241, v240
v_mfma_f32_16x16x32_bf16 v[132:135], v[76:79], a[116:119], v[132:135]
v_fma_f32 v210, v210, v241, v240
v_mul_f32 v208, v208, v88
v_mfma_f32_16x16x32_bf16 v[136:139], v[72:75], a[104:107], v[136:139]
v_mul_f32 v210, v210, v89
v_mul_f32 v209, v88, v104
v_mfma_f32_16x16x32_bf16 v[136:139], v[76:79], a[120:123], v[136:139]
ds_read_b128 v[68:71], v7 offset:54272
v_mul_f32 v211, v89, v105
v_mfma_f32_16x16x32_bf16 v[140:143], v[72:75], a[108:111], v[140:143]
v_exp_f32 v208, v208
v_mfma_f32_16x16x32_bf16 v[140:143], v[76:79], a[124:127], v[140:143]
v_fma_f32 v208, v208, v242, v242
s_waitcnt lgkmcnt(4)
v_mfma_f32_16x16x32_bf16 v[112:115], v[48:51], a[128:131], v[112:115]
v_exp_f32 v210, v210
v_mfma_f32_16x16x32_bf16 v[112:115], v[52:55], a[144:147], v[112:115]
v_fma_f32 v210, v210, v242, v242
v_mul_f32 v212, v90, v90
v_mfma_f32_16x16x32_bf16 v[116:119], v[48:51], a[132:135], v[116:119]
ds_read_b128 v[72:75], v7 offset:55296
v_mul_f32 v214, v91, v91
v_mfma_f32_16x16x32_bf16 v[116:119], v[52:55], a[148:151], v[116:119]
v_rcp_f32 v208, v208
v_mfma_f32_16x16x32_bf16 v[120:123], v[48:51], a[136:139], v[120:123]
v_rcp_f32 v210, v210
v_mfma_f32_16x16x32_bf16 v[120:123], v[52:55], a[152:155], v[120:123]
ds_read_b128 v[76:79], v7 offset:56320
v_mul_f32 v209, v209, v208
v_mfma_f32_16x16x32_bf16 v[124:127], v[48:51], a[140:143], v[124:127]
v_mul_f32 v211, v211, v210
v_cvt_pk_bf16_f32 v168, v209, v211
v_mfma_f32_16x16x32_bf16 v[124:127], v[52:55], a[156:159], v[124:127]
v_fma_f32 v212, v212, v241, v240
s_waitcnt lgkmcnt(4)
v_mfma_f32_16x16x32_bf16 v[128:131], v[56:59], a[128:131], v[128:131]
s_waitcnt vmcnt(23)
v_fma_f32 v214, v214, v241, v240
v_mfma_f32_16x16x32_bf16 v[128:131], v[60:63], a[144:147], v[128:131]
s_barrier
v_mfma_f32_16x16x32_bf16 v[132:135], v[56:59], a[132:135], v[132:135]
ds_read_b128 v[48:51], v7 offset:57344
s_add_u32 m0, s22, 73728
v_mfma_f32_16x16x32_bf16 v[132:135], v[60:63], a[148:151], v[132:135]
v_add_u32 v3, 20480, v3
buffer_load_dwordx4 v3, s[8:11], 0 offen offset:0 sc1 lds
v_mfma_f32_16x16x32_bf16 v[136:139], v[56:59], a[136:139], v[136:139]
v_mul_f32 v212, v212, v90
v_mul_f32 v214, v214, v91
v_mfma_f32_16x16x32_bf16 v[136:139], v[60:63], a[152:155], v[136:139]
ds_read_b128 v[52:55], v7 offset:58368
v_mul_f32 v213, v90, v106
v_mfma_f32_16x16x32_bf16 v[140:143], v[56:59], a[140:143], v[140:143]
v_exp_f32 v212, v212
v_mfma_f32_16x16x32_bf16 v[140:143], v[60:63], a[156:159], v[140:143]
v_mul_f32 v215, v91, v107
s_waitcnt lgkmcnt(4)
v_mfma_f32_16x16x32_bf16 v[112:115], v[64:67], a[160:163], v[112:115]
buffer_load_dwordx4 v3, s[8:11], 0 offen offset:1024 sc1 lds
v_mfma_f32_16x16x32_bf16 v[112:115], v[68:71], a[176:179], v[112:115]
v_exp_f32 v214, v214
v_mfma_f32_16x16x32_bf16 v[116:119], v[64:67], a[164:167], v[116:119]
ds_read_b128 v[56:59], v7 offset:59392
v_fma_f32 v212, v212, v242, v242
v_mfma_f32_16x16x32_bf16 v[116:119], v[68:71], a[180:183], v[116:119]
v_fma_f32 v214, v214, v242, v242
v_mul_f32 v208, v92, v92
v_mfma_f32_16x16x32_bf16 v[120:123], v[64:67], a[168:171], v[120:123]
v_rcp_f32 v212, v212
v_mfma_f32_16x16x32_bf16 v[120:123], v[68:71], a[184:187], v[120:123]
ds_read_b128 v[60:63], v7 offset:60416
v_mul_f32 v213, v213, v212
v_mfma_f32_16x16x32_bf16 v[124:127], v[64:67], a[172:175], v[124:127]
buffer_load_dwordx4 v3, s[8:11], 0 offen offset:2048 sc1 lds
v_mfma_f32_16x16x32_bf16 v[124:127], v[68:71], a[188:191], v[124:127]
v_mul_f32 v210, v93, v93
s_waitcnt lgkmcnt(4)
v_mfma_f32_16x16x32_bf16 v[128:131], v[72:75], a[160:163], v[128:131]
v_rcp_f32 v214, v214
v_mfma_f32_16x16x32_bf16 v[128:131], v[76:79], a[176:179], v[128:131]
v_mul_f32 v215, v215, v214
v_cvt_pk_bf16_f32 v169, v213, v215
v_mfma_f32_16x16x32_bf16 v[132:135], v[72:75], a[164:167], v[132:135]
ds_read_b128 v[64:67], v7 offset:61440
v_fma_f32 v208, v208, v245, v244
v_mfma_f32_16x16x32_bf16 v[132:135], v[76:79], a[180:183], v[132:135]
buffer_load_dwordx4 v3, s[8:11], 0 offen offset:3072 sc1 lds
v_mfma_f32_16x16x32_bf16 v[136:139], v[72:75], a[168:171], v[136:139]
s_add_u32 m0, s22, 77824
v_add_u32 v3, 4096, v3
v_mfma_f32_16x16x32_bf16 v[136:139], v[76:79], a[184:187], v[136:139]
ds_read_b128 v[68:71], v7 offset:62464
v_fma_f32 v210, v210, v245, v244
v_mfma_f32_16x16x32_bf16 v[140:143], v[72:75], a[172:175], v[140:143]
v_mul_f32 v208, v208, v92
v_mul_f32 v210, v210, v93
v_mfma_f32_16x16x32_bf16 v[140:143], v[76:79], a[188:191], v[140:143]
v_mul_f32 v209, v92, v108
s_waitcnt lgkmcnt(4)
v_mfma_f32_16x16x32_bf16 v[112:115], v[48:51], a[192:195], v[112:115]
buffer_load_dwordx4 v3, s[8:11], 0 offen offset:0 sc1 lds
v_mfma_f32_16x16x32_bf16 v[112:115], v[52:55], a[208:211], v[112:115]
v_exp_f32 v208, v208
v_mfma_f32_16x16x32_bf16 v[116:119], v[48:51], a[196:199], v[116:119]
ds_read_b128 v[72:75], v7 offset:63488
v_mul_f32 v211, v93, v109
v_mfma_f32_16x16x32_bf16 v[116:119], v[52:55], a[212:215], v[116:119]
v_exp_f32 v210, v210
v_mfma_f32_16x16x32_bf16 v[120:123], v[48:51], a[200:203], v[120:123]
v_fma_f32 v208, v208, v246, v246
v_fma_f32 v210, v210, v246, v246
v_mfma_f32_16x16x32_bf16 v[120:123], v[52:55], a[216:219], v[120:123]
ds_read_b128 v[76:79], v7 offset:64512
v_mul_f32 v212, v94, v94
v_mfma_f32_16x16x32_bf16 v[124:127], v[48:51], a[204:207], v[124:127]
buffer_load_dwordx4 v3, s[8:11], 0 offen offset:1024 sc1 lds
v_mfma_f32_16x16x32_bf16 v[124:127], v[52:55], a[220:223], v[124:127]
v_mul_f32 v214, v95, v95
s_waitcnt lgkmcnt(4)
v_mfma_f32_16x16x32_bf16 v[128:131], v[56:59], a[192:195], v[128:131]
v_rcp_f32 v208, v208
v_mfma_f32_16x16x32_bf16 v[128:131], v[60:63], a[208:211], v[128:131]
v_rcp_f32 v210, v210
v_mfma_f32_16x16x32_bf16 v[132:135], v[56:59], a[196:199], v[132:135]
ds_read_b128 v[48:51], v8 offset:0
v_mul_f32 v209, v209, v208
v_mfma_f32_16x16x32_bf16 v[132:135], v[60:63], a[212:215], v[132:135]
v_mul_f32 v211, v211, v210
v_cvt_pk_bf16_f32 v172, v209, v211
v_mfma_f32_16x16x32_bf16 v[136:139], v[56:59], a[200:203], v[136:139]
v_fma_f32 v212, v212, v245, v244
v_fma_f32 v214, v214, v245, v244
v_mfma_f32_16x16x32_bf16 v[136:139], v[60:63], a[216:219], v[136:139]
ds_read_b128 v[52:55], v8 offset:1024
v_mul_f32 v212, v212, v94
v_mfma_f32_16x16x32_bf16 v[140:143], v[56:59], a[204:207], v[140:143]
v_mul_f32 v214, v214, v95
v_mul_f32 v213, v94, v110
v_mfma_f32_16x16x32_bf16 v[140:143], v[60:63], a[220:223], v[140:143]
v_mul_f32 v215, v95, v111
s_waitcnt lgkmcnt(4)
v_mfma_f32_16x16x32_bf16 v[112:115], v[64:67], a[224:227], v[112:115]
v_exp_f32 v212, v212
v_mfma_f32_16x16x32_bf16 v[112:115], v[68:71], a[240:243], v[112:115]
v_exp_f32 v214, v214
v_mfma_f32_16x16x32_bf16 v[116:119], v[64:67], a[228:231], v[116:119]
ds_read_b128 v[56:59], v8 offset:2048
v_fma_f32 v212, v212, v246, v246
v_mfma_f32_16x16x32_bf16 v[116:119], v[68:71], a[244:247], v[116:119]
v_fma_f32 v214, v214, v246, v246
v_fma_f32 v222, v222, v237, v236
v_mfma_f32_16x16x32_bf16 v[120:123], v[64:67], a[232:235], v[120:123]
v_rcp_f32 v212, v212
v_mfma_f32_16x16x32_bf16 v[120:123], v[68:71], a[248:251], v[120:123]
ds_read_b128 v[60:63], v8 offset:3072
v_mul_f32 v213, v213, v212
v_mfma_f32_16x16x32_bf16 v[124:127], v[64:67], a[236:239], v[124:127]
v_rcp_f32 v214, v214
v_mfma_f32_16x16x32_bf16 v[124:127], v[68:71], a[252:255], v[124:127]
v_mul_f32 v215, v215, v214
s_waitcnt lgkmcnt(4)
v_mfma_f32_16x16x32_bf16 v[128:131], v[72:75], a[224:227], v[128:131]
v_cvt_pk_bf16_f32 v173, v213, v215
v_mul_f32 v220, v220, v182
v_mfma_f32_16x16x32_bf16 v[128:131], v[76:79], a[240:243], v[128:131]
v_rcp_f32 v218, v218
v_mfma_f32_16x16x32_bf16 v[132:135], v[72:75], a[228:231], v[132:135]
ds_read_b128 v[64:67], v8 offset:4096
v_mul_f32 v219, v219, v218
v_mfma_f32_16x16x32_bf16 v[132:135], v[76:79], a[244:247], v[132:135]
v_cvt_pk_bf16_f32 v150, v217, v219
v_mul_f32 v222, v222, v183
v_mfma_f32_16x16x32_bf16 v[136:139], v[72:75], a[232:235], v[136:139]
v_exp_f32 v220, v220
v_mfma_f32_16x16x32_bf16 v[136:139], v[76:79], a[248:251], v[136:139]
ds_read_b128 v[68:71], v8 offset:5120
v_mul_f32 v221, v182, v198
v_mfma_f32_16x16x32_bf16 v[140:143], v[72:75], a[236:239], v[140:143]
v_exp_f32 v222, v222
v_mfma_f32_16x16x32_bf16 v[140:143], v[76:79], a[252:255], v[140:143]
v_mul_f32 v223, v183, v199
s_waitcnt lgkmcnt(4)
v_mfma_f32_16x16x32_bf16 v[112:115], v[48:51], v[16:19], v[112:115]
v_fma_f32 v220, v220, v238, v238
v_fma_f32 v222, v222, v238, v238
v_mfma_f32_16x16x32_bf16 v[112:115], v[52:55], v[32:35], v[112:115]
v_rcp_f32 v220, v220
v_mfma_f32_16x16x32_bf16 v[116:119], v[48:51], v[20:23], v[116:119]
ds_read_b128 v[72:75], v8 offset:6144
v_mul_f32 v221, v221, v220
v_mfma_f32_16x16x32_bf16 v[116:119], v[52:55], v[36:39], v[116:119]
v_rcp_f32 v222, v222
v_mfma_f32_16x16x32_bf16 v[120:123], v[48:51], v[24:27], v[120:123]
v_mul_f32 v223, v223, v222
v_cvt_pk_bf16_f32 v151, v221, v223
v_mfma_f32_16x16x32_bf16 v[120:123], v[52:55], v[40:43], v[120:123]
ds_read_b128 v[76:79], v8 offset:7168
v_mul_f32 v216, v184, v184
v_mfma_f32_16x16x32_bf16 v[124:127], v[48:51], v[28:31], v[124:127]
buffer_store_dwordx4 v[148:151], v4, s[8:11], s24 offen offset:0 sc1
v_mfma_f32_16x16x32_bf16 v[124:127], v[52:55], v[44:47], v[124:127]
v_mul_f32 v218, v185, v185
s_waitcnt lgkmcnt(4)
v_mfma_f32_16x16x32_bf16 v[128:131], v[56:59], v[16:19], v[128:131]
v_fma_f32 v216, v216, v241, v240
v_fma_f32 v218, v218, v241, v240
v_mfma_f32_16x16x32_bf16 v[128:131], v[60:63], v[32:35], v[128:131]
v_mul_f32 v216, v216, v184
v_mul_f32 v218, v218, v185
v_mfma_f32_16x16x32_bf16 v[132:135], v[56:59], v[20:23], v[132:135]
ds_read_b128 v[48:51], v8 offset:8192
v_mul_f32 v217, v184, v200
v_mfma_f32_16x16x32_bf16 v[132:135], v[60:63], v[36:39], v[132:135]
v_exp_f32 v216, v216
v_mfma_f32_16x16x32_bf16 v[136:139], v[56:59], v[24:27], v[136:139]
v_exp_f32 v218, v218
v_mfma_f32_16x16x32_bf16 v[136:139], v[60:63], v[40:43], v[136:139]
ds_read_b128 v[52:55], v8 offset:9216
v_mul_f32 v219, v185, v201
v_mfma_f32_16x16x32_bf16 v[140:143], v[56:59], v[28:31], v[140:143]
v_fma_f32 v216, v216, v242, v242
v_fma_f32 v218, v218, v242, v242
v_mfma_f32_16x16x32_bf16 v[140:143], v[60:63], v[44:47], v[140:143]
v_mul_f32 v220, v186, v186
s_waitcnt lgkmcnt(4)
v_mfma_f32_16x16x32_bf16 v[80:83], v[64:67], a[0:3], 0
v_rcp_f32 v216, v216
v_mfma_f32_16x16x32_bf16 v[80:83], v[68:71], a[16:19], v[80:83]
v_rcp_f32 v218, v218
v_mfma_f32_16x16x32_bf16 v[84:87], v[64:67], a[4:7], 0
ds_read_b128 v[56:59], v8 offset:10240
v_mul_f32 v217, v217, v216
v_mfma_f32_16x16x32_bf16 v[84:87], v[68:71], a[20:23], v[84:87]
v_mul_f32 v208, v112, v112
v_mul_f32 v210, v113, v113
v_mfma_f32_16x16x32_bf16 v[88:91], v[64:67], a[8:11], 0
v_fma_f32 v208, v208, v233, v232
v_fma_f32 v210, v210, v233, v232
v_mfma_f32_16x16x32_bf16 v[88:91], v[68:71], a[24:27], v[88:91]
ds_read_b128 v[60:63], v8 offset:11264
v_mul_f32 v208, v208, v112
v_mfma_f32_16x16x32_bf16 v[92:95], v[64:67], a[12:15], 0
v_mul_f32 v210, v210, v113
v_mul_f32 v209, v112, v128
v_mfma_f32_16x16x32_bf16 v[92:95], v[68:71], a[28:31], v[92:95]
v_mul_f32 v211, v113, v129
s_waitcnt lgkmcnt(4)
v_mfma_f32_16x16x32_bf16 v[96:99], v[72:75], a[0:3], 0
v_exp_f32 v208, v208
v_mfma_f32_16x16x32_bf16 v[96:99], v[76:79], a[16:19], v[96:99]
v_exp_f32 v210, v210
v_mfma_f32_16x16x32_bf16 v[100:103], v[72:75], a[4:7], 0
ds_read_b128 v[64:67], v8 offset:12288
v_fma_f32 v208, v208, v234, v234
v_mfma_f32_16x16x32_bf16 v[100:103], v[76:79], a[20:23], v[100:103]
v_fma_f32 v210, v210, v234, v234
v_mul_f32 v212, v114, v114
v_mfma_f32_16x16x32_bf16 v[104:107], v[72:75], a[8:11], 0
v_rcp_f32 v208, v208
v_mfma_f32_16x16x32_bf16 v[104:107], v[76:79], a[24:27], v[104:107]
ds_read_b128 v[68:71], v8 offset:13312
v_mul_f32 v209, v209, v208
v_mfma_f32_16x16x32_bf16 v[108:111], v[72:75], a[12:15], 0
v_rcp_f32 v210, v210
v_mfma_f32_16x16x32_bf16 v[108:111], v[76:79], a[28:31], v[108:111]
v_mul_f32 v211, v211, v210
s_waitcnt lgkmcnt(4)
v_mfma_f32_16x16x32_bf16 v[80:83], v[48:51], a[32:35], v[80:83]
v_cvt_pk_bf16_f32 v162, v209, v211
v_mul_f32 v214, v115, v115
v_mfma_f32_16x16x32_bf16 v[80:83], v[52:55], a[48:51], v[80:83]
v_fma_f32 v212, v212, v233, v232
v_fma_f32 v214, v214, v233, v232
v_mfma_f32_16x16x32_bf16 v[84:87], v[48:51], a[36:39], v[84:87]
ds_read_b128 v[72:75], v8 offset:14336
v_mul_f32 v212, v212, v114
v_mfma_f32_16x16x32_bf16 v[84:87], v[52:55], a[52:55], v[84:87]
v_mul_f32 v214, v214, v115
v_mul_f32 v213, v114, v130
v_mfma_f32_16x16x32_bf16 v[88:91], v[48:51], a[40:43], v[88:91]
v_exp_f32 v212, v212
v_mfma_f32_16x16x32_bf16 v[88:91], v[52:55], a[56:59], v[88:91]
ds_read_b128 v[76:79], v8 offset:15360
v_mul_f32 v215, v115, v131
v_mfma_f32_16x16x32_bf16 v[92:95], v[48:51], a[44:47], v[92:95]
v_exp_f32 v214, v214
v_mfma_f32_16x16x32_bf16 v[92:95], v[52:55], a[60:63], v[92:95]
v_fma_f32 v212, v212, v234, v234
s_waitcnt lgkmcnt(4)
v_mfma_f32_16x16x32_bf16 v[96:99], v[56:59], a[32:35], v[96:99]
s_waitcnt vmcnt(21)
v_fma_f32 v214, v214, v234, v234
v_mfma_f32_16x16x32_bf16 v[96:99], v[60:63], a[48:51], v[96:99]
s_barrier
v_mfma_f32_16x16x32_bf16 v[100:103], v[56:59], a[36:39], v[100:103]
ds_read_b128 v[48:51], v2 offset:0
s_add_u32 m0, s22, 98304
v_mfma_f32_16x16x32_bf16 v[100:103], v[60:63], a[52:55], v[100:103]
v_add_u32 v3, 20480, v3
buffer_load_dwordx4 v3, s[8:11], 0 offen offset:0 sc1 lds
v_mfma_f32_16x16x32_bf16 v[104:107], v[56:59], a[40:43], v[104:107]
v_rcp_f32 v212, v212
v_mfma_f32_16x16x32_bf16 v[104:107], v[60:63], a[56:59], v[104:107]
ds_read_b128 v[52:55], v2 offset:1024
v_mul_f32 v213, v213, v212
v_mfma_f32_16x16x32_bf16 v[108:111], v[56:59], a[44:47], v[108:111]
v_rcp_f32 v214, v214
v_mfma_f32_16x16x32_bf16 v[108:111], v[60:63], a[60:63], v[108:111]
v_mul_f32 v215, v215, v214
s_waitcnt lgkmcnt(4)
v_mfma_f32_16x16x32_bf16 v[80:83], v[64:67], a[64:67], v[80:83]
buffer_load_dwordx4 v3, s[8:11], 0 offen offset:1024 sc1 lds
v_mfma_f32_16x16x32_bf16 v[80:83], v[68:71], a[80:83], v[80:83]
v_cvt_pk_bf16_f32 v163, v213, v215
v_mul_f32 v208, v116, v116
v_mfma_f32_16x16x32_bf16 v[84:87], v[64:67], a[68:71], v[84:87]
ds_read_b128 v[56:59], v2 offset:2048
v_mul_f32 v210, v117, v117
v_mfma_f32_16x16x32_bf16 v[84:87], v[68:71], a[84:87], v[84:87]
buffer_store_dwordx4 v[160:163], v2, s[8:11], s24 offen offset:1024 sc1
v_mfma_f32_16x16x32_bf16 v[88:91], v[64:67], a[72:75], v[88:91]
v_fma_f32 v208, v208, v237, v236
v_fma_f32 v210, v210, v237, v236
v_mfma_f32_16x16x32_bf16 v[88:91], v[68:71], a[88:91], v[88:91]
ds_read_b128 v[60:63], v2 offset:3072
v_mul_f32 v208, v208, v116
v_mfma_f32_16x16x32_bf16 v[92:95], v[64:67], a[76:79], v[92:95]
v_mul_f32 v210, v210, v117
v_mul_f32 v209, v116, v132
v_mfma_f32_16x16x32_bf16 v[92:95], v[68:71], a[92:95], v[92:95]
v_mul_f32 v211, v117, v133
s_waitcnt lgkmcnt(4)
v_mfma_f32_16x16x32_bf16 v[96:99], v[72:75], a[64:67], v[96:99]
buffer_load_dwordx4 v3, s[8:11], 0 offen offset:2048 sc1 lds
v_mfma_f32_16x16x32_bf16 v[96:99], v[76:79], a[80:83], v[96:99]
v_exp_f32 v208, v208
v_mfma_f32_16x16x32_bf16 v[100:103], v[72:75], a[68:71], v[100:103]
ds_read_b128 v[64:67], v2 offset:4096
v_fma_f32 v208, v208, v238, v238
v_mfma_f32_16x16x32_bf16 v[100:103], v[76:79], a[84:87], v[100:103]
v_exp_f32 v210, v210
v_mfma_f32_16x16x32_bf16 v[104:107], v[72:75], a[72:75], v[104:107]
v_fma_f32 v210, v210, v238, v238
v_mul_f32 v212, v118, v118
v_mfma_f32_16x16x32_bf16 v[104:107], v[76:79], a[88:91], v[104:107]
ds_read_b128 v[68:71], v2 offset:5120
v_mul_f32 v214, v119, v119
v_mfma_f32_16x16x32_bf16 v[108:111], v[72:75], a[76:79], v[108:111]
buffer_load_dwordx4 v3, s[8:11], 0 offen offset:3072 sc1 lds
v_mfma_f32_16x16x32_bf16 v[108:111], v[76:79], a[92:95], v[108:111]
s_add_u32 m0, s22, 102400
s_waitcnt lgkmcnt(4)
v_mfma_f32_16x16x32_bf16 v[80:83], v[48:51], a[96:99], v[80:83]
v_add_u32 v3, 4096, v3
v_fma_f32 v212, v212, v237, v236
v_mfma_f32_16x16x32_bf16 v[80:83], v[52:55], a[112:115], v[80:83]
v_rcp_f32 v208, v208
v_mfma_f32_16x16x32_bf16 v[84:87], v[48:51], a[100:103], v[84:87]
ds_read_b128 v[72:75], v2 offset:6144
v_mul_f32 v209, v209, v208
v_mfma_f32_16x16x32_bf16 v[84:87], v[52:55], a[116:119], v[84:87]
buffer_load_dwordx4 v3, s[8:11], 0 offen offset:0 sc1 lds
v_mfma_f32_16x16x32_bf16 v[88:91], v[48:51], a[104:107], v[88:91]
v_rcp_f32 v210, v210
v_mfma_f32_16x16x32_bf16 v[88:91], v[52:55], a[120:123], v[88:91]
ds_read_b128 v[76:79], v2 offset:7168
v_mul_f32 v211, v211, v210
v_mfma_f32_16x16x32_bf16 v[92:95], v[48:51], a[108:111], v[92:95]
v_cvt_pk_bf16_f32 v166, v209, v211
v_fma_f32 v214, v214, v237, v236
v_mfma_f32_16x16x32_bf16 v[92:95], v[52:55], a[124:127], v[92:95]
v_mul_f32 v212, v212, v118
s_waitcnt lgkmcnt(4)
v_mfma_f32_16x16x32_bf16 v[96:99], v[56:59], a[96:99], v[96:99]
buffer_load_dwordx4 v3, s[8:11], 0 offen offset:1024 sc1 lds
v_mfma_f32_16x16x32_bf16 v[96:99], v[60:63], a[112:115], v[96:99]
v_mul_f32 v214, v214, v119
v_mul_f32 v213, v118, v134
v_mfma_f32_16x16x32_bf16 v[100:103], v[56:59], a[100:103], v[100:103]
ds_read_b128 v[48:51], v2 offset:8192
v_mul_f32 v215, v119, v135
v_mfma_f32_16x16x32_bf16 v[100:103], v[60:63], a[116:119], v[100:103]
v_exp_f32 v212, v212
v_mfma_f32_16x16x32_bf16 v[104:107], v[56:59], a[104:107], v[104:107]
v_exp_f32 v214, v214
v_mfma_f32_16x16x32_bf16 v[104:107], v[60:63], a[120:123], v[104:107]
ds_read_b128 v[52:55], v2 offset:9216
v_fma_f32 v212, v212, v238, v238
v_mfma_f32_16x16x32_bf16 v[108:111], v[56:59], a[108:111], v[108:111]
v_fma_f32 v214, v214, v238, v238
v_mul_f32 v208, v120, v120
v_mfma_f32_16x16x32_bf16 v[108:111], v[60:63], a[124:127], v[108:111]
v_mul_f32 v210, v121, v121
s_waitcnt lgkmcnt(4)
v_mfma_f32_16x16x32_bf16 v[80:83], v[64:67], a[128:131], v[80:83]
v_rcp_f32 v212, v212
v_mfma_f32_16x16x32_bf16 v[80:83], v[68:71], a[144:147], v[80:83]
v_rcp_f32 v214, v214
v_mfma_f32_16x16x32_bf16 v[84:87], v[64:67], a[132:135], v[84:87]
ds_read_b128 v[56:59], v2 offset:10240
v_mul_f32 v213, v213, v212
v_mfma_f32_16x16x32_bf16 v[84:87], v[68:71], a[148:151], v[84:87]
v_mul_f32 v215, v215, v214
v_cvt_pk_bf16_f32 v167, v213, v215
v_mfma_f32_16x16x32_bf16 v[88:91], v[64:67], a[136:139], v[88:91]
buffer_store_dwordx4 v[164:167], v4, s[8:11], s24 offen offset:1024 sc1
v_mfma_f32_16x16x32_bf16 v[88:91], v[68:71], a[152:155], v[88:91]
ds_read_b128 v[60:63], v2 offset:11264
v_fma_f32 v208, v208, v241, v240
v_mfma_f32_16x16x32_bf16 v[92:95], v[64:67], a[140:143], v[92:95]
v_fma_f32 v210, v210, v241, v240
v_mul_f32 v208, v208, v120
v_mfma_f32_16x16x32_bf16 v[92:95], v[68:71], a[156:159], v[92:95]
v_mul_f32 v210, v210, v121
s_waitcnt lgkmcnt(4)
v_mfma_f32_16x16x32_bf16 v[96:99], v[72:75], a[128:131], v[96:99]
v_exp_f32 v208, v208
v_mfma_f32_16x16x32_bf16 v[96:99], v[76:79], a[144:147], v[96:99]
v_exp_f32 v210, v210
v_mfma_f32_16x16x32_bf16 v[100:103], v[72:75], a[132:135], v[100:103]
ds_read_b128 v[64:67], v2 offset:12288
v_mul_f32 v209, v120, v136
v_mfma_f32_16x16x32_bf16 v[100:103], v[76:79], a[148:151], v[100:103]
v_mul_f32 v211, v121, v137
v_fma_f32 v208, v208, v242, v242
v_mfma_f32_16x16x32_bf16 v[104:107], v[72:75], a[136:139], v[104:107]
v_fma_f32 v210, v210, v242, v242
v_mul_f32 v212, v122, v122
v_mfma_f32_16x16x32_bf16 v[104:107], v[76:79], a[152:155], v[104:107]
ds_read_b128 v[68:71], v2 offset:13312
v_mul_f32 v214, v123, v123
v_mfma_f32_16x16x32_bf16 v[108:111], v[72:75], a[140:143], v[108:111]
v_rcp_f32 v208, v208
v_mfma_f32_16x16x32_bf16 v[108:111], v[76:79], a[156:159], v[108:111]
v_mul_f32 v209, v209, v208
s_waitcnt lgkmcnt(4)
v_mfma_f32_16x16x32_bf16 v[80:83], v[48:51], a[160:163], v[80:83]
v_rcp_f32 v210, v210
v_mfma_f32_16x16x32_bf16 v[80:83], v[52:55], a[176:179], v[80:83]
v_mul_f32 v211, v211, v210
v_cvt_pk_bf16_f32 v170, v209, v211
v_mfma_f32_16x16x32_bf16 v[84:87], v[48:51], a[164:167], v[84:87]
ds_read_b128 v[72:75], v2 offset:14336
v_fma_f32 v212, v212, v241, v240
v_mfma_f32_16x16x32_bf16 v[84:87], v[52:55], a[180:183], v[84:87]
v_fma_f32 v214, v214, v241, v240
v_mul_f32 v212, v212, v122
v_mfma_f32_16x16x32_bf16 v[88:91], v[48:51], a[168:171], v[88:91]
v_mul_f32 v214, v214, v123
v_mul_f32 v213, v122, v138
v_mfma_f32_16x16x32_bf16 v[88:91], v[52:55], a[184:187], v[88:91]
ds_read_b128 v[76:79], v2 offset:15360
v_mul_f32 v215, v123, v139
v_mfma_f32_16x16x32_bf16 v[92:95], v[48:51], a[172:175], v[92:95]
v_exp_f32 v212, v212
v_mfma_f32_16x16x32_bf16 v[92:95], v[52:55], a[188:191], v[92:95]
v_fma_f32 v212, v212, v242, v242
s_waitcnt lgkmcnt(4)
v_mfma_f32_16x16x32_bf16 v[96:99], v[56:59], a[160:163], v[96:99]
v_exp_f32 v214, v214
v_mfma_f32_16x16x32_bf16 v[96:99], v[60:63], a[176:179], v[96:99]
v_fma_f32 v214, v214, v242, v242
v_mul_f32 v208, v124, v124
v_mfma_f32_16x16x32_bf16 v[100:103], v[56:59], a[164:167], v[100:103]
ds_read_b128 v[48:51], v2 offset:16384
v_mul_f32 v210, v125, v125
v_mfma_f32_16x16x32_bf16 v[100:103], v[60:63], a[180:183], v[100:103]
v_rcp_f32 v212, v212
v_mfma_f32_16x16x32_bf16 v[104:107], v[56:59], a[168:171], v[104:107]
v_rcp_f32 v214, v214
v_mfma_f32_16x16x32_bf16 v[104:107], v[60:63], a[184:187], v[104:107]
ds_read_b128 v[52:55], v2 offset:17408
v_mul_f32 v213, v213, v212
v_mfma_f32_16x16x32_bf16 v[108:111], v[56:59], a[172:175], v[108:111]
v_mul_f32 v215, v215, v214
v_cvt_pk_bf16_f32 v171, v213, v215
v_mfma_f32_16x16x32_bf16 v[108:111], v[60:63], a[188:191], v[108:111]
v_fma_f32 v208, v208, v245, v244
s_waitcnt lgkmcnt(4)
v_mfma_f32_16x16x32_bf16 v[80:83], v[64:67], a[192:195], v[80:83]
buffer_store_dwordx4 v[168:171], v5, s[8:11], s24 offen offset:1024 sc1
v_mfma_f32_16x16x32_bf16 v[80:83], v[68:71], a[208:211], v[80:83]
v_fma_f32 v210, v210, v245, v244
v_mul_f32 v208, v208, v124
v_mfma_f32_16x16x32_bf16 v[84:87], v[64:67], a[196:199], v[84:87]
ds_read_b128 v[56:59], v2 offset:18432
v_mul_f32 v210, v210, v125
v_mfma_f32_16x16x32_bf16 v[84:87], v[68:71], a[212:215], v[84:87]
v_exp_f32 v208, v208
v_mfma_f32_16x16x32_bf16 v[88:91], v[64:67], a[200:203], v[88:91]
v_exp_f32 v210, v210
v_mfma_f32_16x16x32_bf16 v[88:91], v[68:71], a[216:219], v[88:91]
ds_read_b128 v[60:63], v2 offset:19456
v_mul_f32 v209, v124, v140
v_mfma_f32_16x16x32_bf16 v[92:95], v[64:67], a[204:207], v[92:95]
v_mul_f32 v211, v125, v141
v_fma_f32 v208, v208, v246, v246
v_mfma_f32_16x16x32_bf16 v[92:95], v[68:71], a[220:223], v[92:95]
v_fma_f32 v210, v210, v246, v246
s_waitcnt lgkmcnt(4)
v_mfma_f32_16x16x32_bf16 v[96:99], v[72:75], a[192:195], v[96:99]
v_rcp_f32 v208, v208
v_mfma_f32_16x16x32_bf16 v[96:99], v[76:79], a[208:211], v[96:99]
v_rcp_f32 v210, v210
v_mfma_f32_16x16x32_bf16 v[100:103], v[72:75], a[196:199], v[100:103]
ds_read_b128 v[64:67], v2 offset:20480
v_mul_f32 v209, v209, v208
v_mfma_f32_16x16x32_bf16 v[100:103], v[76:79], a[212:215], v[100:103]
v_mul_f32 v211, v211, v210
v_cvt_pk_bf16_f32 v174, v209, v211
v_mfma_f32_16x16x32_bf16 v[104:107], v[72:75], a[200:203], v[104:107]
v_mul_f32 v212, v126, v126
v_mul_f32 v214, v127, v127
v_mfma_f32_16x16x32_bf16 v[104:107], v[76:79], a[216:219], v[104:107]
ds_read_b128 v[68:71], v2 offset:21504
v_fma_f32 v212, v212, v245, v244
v_mfma_f32_16x16x32_bf16 v[108:111], v[72:75], a[204:207], v[108:111]
v_fma_f32 v214, v214, v245, v244
v_mul_f32 v212, v212, v126
v_mfma_f32_16x16x32_bf16 v[108:111], v[76:79], a[220:223], v[108:111]
v_mul_f32 v214, v214, v127
s_waitcnt lgkmcnt(4)
v_mfma_f32_16x16x32_bf16 v[80:83], v[48:51], a[224:227], v[80:83]
v_exp_f32 v212, v212
v_mfma_f32_16x16x32_bf16 v[80:83], v[52:55], a[240:243], v[80:83]
v_exp_f32 v214, v214
v_mfma_f32_16x16x32_bf16 v[84:87], v[48:51], a[228:231], v[84:87]
ds_read_b128 v[72:75], v2 offset:22528
v_mul_f32 v213, v126, v142
v_mfma_f32_16x16x32_bf16 v[84:87], v[52:55], a[244:247], v[84:87]
v_mul_f32 v215, v127, v143
v_fma_f32 v212, v212, v246, v246
v_mfma_f32_16x16x32_bf16 v[88:91], v[48:51], a[232:235], v[88:91]
v_fma_f32 v214, v214, v246, v246
v_mul_f32 v219, v219, v218
v_mfma_f32_16x16x32_bf16 v[88:91], v[52:55], a[248:251], v[88:91]
ds_read_b128 v[76:79], v2 offset:23552
v_cvt_pk_bf16_f32 v154, v217, v219
v_mfma_f32_16x16x32_bf16 v[92:95], v[48:51], a[236:239], v[92:95]
v_rcp_f32 v212, v212
v_mfma_f32_16x16x32_bf16 v[92:95], v[52:55], a[252:255], v[92:95]
v_mul_f32 v213, v213, v212
s_waitcnt lgkmcnt(4)
v_mfma_f32_16x16x32_bf16 v[96:99], v[56:59], a[224:227], v[96:99]
s_waitcnt vmcnt(23)
v_mul_f32 v222, v187, v187
v_mfma_f32_16x16x32_bf16 v[96:99], v[60:63], a[240:243], v[96:99]
s_barrier
v_mfma_f32_16x16x32_bf16 v[100:103], v[56:59], a[228:231], v[100:103]
ds_read_b128 v[48:51], v2 offset:24576
s_add_u32 m0, s22, 122880
v_mfma_f32_16x16x32_bf16 v[100:103], v[60:63], a[244:247], v[100:103]
v_add_u32 v3, 20480, v3
buffer_load_dwordx4 v3, s[8:11], 0 offen offset:0 sc1 lds
v_mfma_f32_16x16x32_bf16 v[104:107], v[56:59], a[232:235], v[104:107]
v_rcp_f32 v214, v214
v_mfma_f32_16x16x32_bf16 v[104:107], v[60:63], a[248:251], v[104:107]
ds_read_b128 v[52:55], v2 offset:25600
v_mul_f32 v215, v215, v214
v_mfma_f32_16x16x32_bf16 v[108:111], v[56:59], a[236:239], v[108:111]
v_cvt_pk_bf16_f32 v175, v213, v215
v_fma_f32 v220, v220, v241, v240
v_mfma_f32_16x16x32_bf16 v[108:111], v[60:63], a[252:255], v[108:111]
v_fma_f32 v222, v222, v241, v240
s_waitcnt lgkmcnt(4)
v_mfma_f32_16x16x32_bf16 v[80:83], v[64:67], v[16:19], v[80:83]
buffer_load_dwordx4 v3, s[8:11], 0 offen offset:1024 sc1 lds
v_mfma_f32_16x16x32_bf16 v[80:83], v[68:71], v[32:35], v[80:83]
v_mul_f32 v220, v220, v186
v_mul_f32 v222, v222, v187
v_mfma_f32_16x16x32_bf16 v[84:87], v[64:67], v[20:23], v[84:87]
ds_read_b128 v[56:59], v2 offset:26624
v_mul_f32 v221, v186, v202
v_mfma_f32_16x16x32_bf16 v[84:87], v[68:71], v[36:39], v[84:87]
buffer_store_dwordx4 v[172:175], v6, s[8:11], s24 offen offset:1024 sc1
v_mfma_f32_16x16x32_bf16 v[88:91], v[64:67], v[24:27], v[88:91]
v_exp_f32 v220, v220
v_mfma_f32_16x16x32_bf16 v[88:91], v[68:71], v[40:43], v[88:91]
ds_read_b128 v[60:63], v2 offset:27648
v_mul_f32 v223, v187, v203
v_mfma_f32_16x16x32_bf16 v[92:95], v[64:67], v[28:31], v[92:95]
v_exp_f32 v222, v222
v_mfma_f32_16x16x32_bf16 v[92:95], v[68:71], v[44:47], v[92:95]
v_fma_f32 v220, v220, v242, v242
s_waitcnt lgkmcnt(4)
v_mfma_f32_16x16x32_bf16 v[96:99], v[72:75], v[16:19], v[96:99]
buffer_load_dwordx4 v3, s[8:11], 0 offen offset:2048 sc1 lds
v_mfma_f32_16x16x32_bf16 v[96:99], v[76:79], v[32:35], v[96:99]
v_fma_f32 v222, v222, v242, v242
v_mul_f32 v216, v188, v188
v_mfma_f32_16x16x32_bf16 v[100:103], v[72:75], v[20:23], v[100:103]
ds_read_b128 v[64:67], v2 offset:28672
v_mul_f32 v218, v189, v189
v_mfma_f32_16x16x32_bf16 v[100:103], v[76:79], v[36:39], v[100:103]
v_rcp_f32 v220, v220
v_mfma_f32_16x16x32_bf16 v[104:107], v[72:75], v[24:27], v[104:107]
v_rcp_f32 v222, v222
v_mfma_f32_16x16x32_bf16 v[104:107], v[76:79], v[40:43], v[104:107]
ds_read_b128 v[68:71], v2 offset:29696
v_mul_f32 v221, v221, v220
v_mfma_f32_16x16x32_bf16 v[108:111], v[72:75], v[28:31], v[108:111]
buffer_load_dwordx4 v3, s[8:11], 0 offen offset:3072 sc1 lds
v_mfma_f32_16x16x32_bf16 v[108:111], v[76:79], v[44:47], v[108:111]
s_add_u32 m0, s22, 126976
s_waitcnt lgkmcnt(4)
v_mfma_f32_16x16x32_bf16 v[112:115], v[48:51], a[0:3], 0
v_add_u32 v3, 4096, v3
v_mul_f32 v223, v223, v222
v_mfma_f32_16x16x32_bf16 v[112:115], v[52:55], a[16:19], v[112:115]
v_cvt_pk_bf16_f32 v155, v221, v223
v_fma_f32 v216, v216, v245, v244
v_mfma_f32_16x16x32_bf16 v[116:119], v[48:51], a[4:7], 0
ds_read_b128 v[72:75], v2 offset:30720
v_fma_f32 v218, v218, v245, v244
v_mfma_f32_16x16x32_bf16 v[116:119], v[52:55], a[20:23], v[116:119]
buffer_load_dwordx4 v3, s[8:11], 0 offen offset:0 sc1 lds
v_mfma_f32_16x16x32_bf16 v[120:123], v[48:51], a[8:11], 0
v_mul_f32 v216, v216, v188
v_mul_f32 v218, v218, v189
v_mfma_f32_16x16x32_bf16 v[120:123], v[52:55], a[24:27], v[120:123]
ds_read_b128 v[76:79], v2 offset:31744
v_mul_f32 v217, v188, v204
v_mfma_f32_16x16x32_bf16 v[124:127], v[48:51], a[12:15], 0
buffer_store_dwordx4 v[152:155], v5, s[8:11], s24 offen offset:0 sc1
v_mfma_f32_16x16x32_bf16 v[124:127], v[52:55], a[28:31], v[124:127]
v_mul_f32 v219, v189, v205
s_waitcnt lgkmcnt(4)
v_mfma_f32_16x16x32_bf16 v[128:131], v[56:59], a[0:3], 0
v_exp_f32 v216, v216
v_mfma_f32_16x16x32_bf16 v[128:131], v[60:63], a[16:19], v[128:131]
v_exp_f32 v218, v218
v_mfma_f32_16x16x32_bf16 v[132:135], v[56:59], a[4:7], 0
ds_read_b128 v[48:51], v2 offset:32768
v_fma_f32 v216, v216, v246, v246
v_mfma_f32_16x16x32_bf16 v[132:135], v[60:63], a[20:23], v[132:135]
buffer_load_dwordx4 v3, s[8:11], 0 offen offset:1024 sc1 lds
v_mfma_f32_16x16x32_bf16 v[136:139], v[56:59], a[8:11], 0
v_fma_f32 v218, v218, v246, v246
v_mul_f32 v220, v190, v190
v_mfma_f32_16x16x32_bf16 v[136:139], v[60:63], a[24:27], v[136:139]
ds_read_b128 v[52:55], v2 offset:33792
v_mul_f32 v222, v191, v191
v_mfma_f32_16x16x32_bf16 v[140:143], v[56:59], a[12:15], 0
v_rcp_f32 v216, v216
v_mfma_f32_16x16x32_bf16 v[140:143], v[60:63], a[28:31], v[140:143]
v_mul_f32 v217, v217, v216
s_waitcnt lgkmcnt(4)
v_mfma_f32_16x16x32_bf16 v[112:115], v[64:67], a[32:35], v[112:115]
v_rcp_f32 v218, v218
v_mfma_f32_16x16x32_bf16 v[112:115], v[68:71], a[48:51], v[112:115]
v_mul_f32 v219, v219, v218
v_cvt_pk_bf16_f32 v158, v217, v219
v_mfma_f32_16x16x32_bf16 v[116:119], v[64:67], a[36:39], v[116:119]
ds_read_b128 v[56:59], v2 offset:34816
v_fma_f32 v220, v220, v245, v244
v_mfma_f32_16x16x32_bf16 v[116:119], v[68:71], a[52:55], v[116:119]
v_fma_f32 v222, v222, v245, v244
v_mul_f32 v220, v220, v190
v_mfma_f32_16x16x32_bf16 v[120:123], v[64:67], a[40:43], v[120:123]
v_mul_f32 v222, v222, v191
v_mul_f32 v221, v190, v206
v_mfma_f32_16x16x32_bf16 v[120:123], v[68:71], a[56:59], v[120:123]
ds_read_b128 v[60:63], v2 offset:35840
v_mul_f32 v223, v191, v207
v_mfma_f32_16x16x32_bf16 v[124:127], v[64:67], a[44:47], v[124:127]
v_exp_f32 v220, v220
v_mfma_f32_16x16x32_bf16 v[124:127], v[68:71], a[60:63], v[124:127]
v_fma_f32 v220, v220, v246, v246
s_waitcnt lgkmcnt(4)
v_mfma_f32_16x16x32_bf16 v[128:131], v[72:75], a[32:35], v[128:131]
v_exp_f32 v222, v222
v_mfma_f32_16x16x32_bf16 v[128:131], v[76:79], a[48:51], v[128:131]
v_fma_f32 v222, v222, v246, v246
v_mfma_f32_16x16x32_bf16 v[132:135], v[72:75], a[36:39], v[132:135]
ds_read_b128 v[64:67], v2 offset:36864
v_mfma_f32_16x16x32_bf16 v[132:135], v[76:79], a[52:55], v[132:135]
v_rcp_f32 v220, v220
v_mfma_f32_16x16x32_bf16 v[136:139], v[72:75], a[40:43], v[136:139]
v_rcp_f32 v222, v222
v_mfma_f32_16x16x32_bf16 v[136:139], v[76:79], a[56:59], v[136:139]
ds_read_b128 v[68:71], v2 offset:37888
v_mul_f32 v221, v221, v220
v_mfma_f32_16x16x32_bf16 v[140:143], v[72:75], a[44:47], v[140:143]
v_mul_f32 v223, v223, v222
v_cvt_pk_bf16_f32 v159, v221, v223
v_mfma_f32_16x16x32_bf16 v[140:143], v[76:79], a[60:63], v[140:143]
s_waitcnt lgkmcnt(4)
v_mfma_f32_16x16x32_bf16 v[112:115], v[48:51], a[64:67], v[112:115]
buffer_store_dwordx4 v[156:159], v6, s[8:11], s24 offen offset:0 sc1
v_mfma_f32_16x16x32_bf16 v[112:115], v[52:55], a[80:83], v[112:115]
v_mul_f32 v208, v80, v80
v_mul_f32 v210, v81, v81
v_mfma_f32_16x16x32_bf16 v[116:119], v[48:51], a[68:71], v[116:119]
ds_read_b128 v[72:75], v2 offset:38912
v_fma_f32 v208, v208, v233, v232
v_mfma_f32_16x16x32_bf16 v[116:119], v[52:55], a[84:87], v[116:119]
v_fma_f32 v210, v210, v233, v232
v_mul_f32 v208, v208, v80
v_mfma_f32_16x16x32_bf16 v[120:123], v[48:51], a[72:75], v[120:123]
v_mul_f32 v210, v210, v81
v_mul_f32 v209, v80, v96
v_mfma_f32_16x16x32_bf16 v[120:123], v[52:55], a[88:91], v[120:123]
ds_read_b128 v[76:79], v2 offset:39936
v_mul_f32 v211, v81, v97
v_mfma_f32_16x16x32_bf16 v[124:127], v[48:51], a[76:79], v[124:127]
v_exp_f32 v208, v208
v_mfma_f32_16x16x32_bf16 v[124:127], v[52:55], a[92:95], v[124:127]
v_fma_f32 v208, v208, v234, v234
s_waitcnt lgkmcnt(4)
v_mfma_f32_16x16x32_bf16 v[128:131], v[56:59], a[64:67], v[128:131]
v_exp_f32 v210, v210
v_mfma_f32_16x16x32_bf16 v[128:131], v[60:63], a[80:83], v[128:131]
v_fma_f32 v210, v210, v234, v234
v_mul_f32 v212, v82, v82
v_mfma_f32_16x16x32_bf16 v[132:135], v[56:59], a[68:71], v[132:135]
ds_read_b128 v[48:51], v2 offset:40960
v_mul_f32 v214, v83, v83
v_mfma_f32_16x16x32_bf16 v[132:135], v[60:63], a[84:87], v[132:135]
v_rcp_f32 v208, v208
v_mfma_f32_16x16x32_bf16 v[136:139], v[56:59], a[72:75], v[136:139]
v_rcp_f32 v210, v210
v_mfma_f32_16x16x32_bf16 v[136:139], v[60:63], a[88:91], v[136:139]
ds_read_b128 v[52:55], v2 offset:41984
v_mul_f32 v209, v209, v208
v_mfma_f32_16x16x32_bf16 v[140:143], v[56:59], a[76:79], v[140:143]
v_mul_f32 v211, v211, v210
v_cvt_pk_bf16_f32 v176, v209, v211
v_mfma_f32_16x16x32_bf16 v[140:143], v[60:63], a[92:95], v[140:143]
v_fma_f32 v212, v212, v233, v232
s_waitcnt lgkmcnt(4)
v_mfma_f32_16x16x32_bf16 v[112:115], v[64:67], a[96:99], v[112:115]
v_fma_f32 v214, v214, v233, v232
v_mul_f32 v212, v212, v82
v_mfma_f32_16x16x32_bf16 v[112:115], v[68:71], a[112:115], v[112:115]
v_mul_f32 v214, v214, v83
v_mul_f32 v213, v82, v98
v_mfma_f32_16x16x32_bf16 v[116:119], v[64:67], a[100:103], v[116:119]
ds_read_b128 v[56:59], v2 offset:43008
v_mul_f32 v215, v83, v99
v_mfma_f32_16x16x32_bf16 v[116:119], v[68:71], a[116:119], v[116:119]
v_exp_f32 v212, v212
v_mfma_f32_16x16x32_bf16 v[120:123], v[64:67], a[104:107], v[120:123]
v_exp_f32 v214, v214
v_mfma_f32_16x16x32_bf16 v[120:123], v[68:71], a[120:123], v[120:123]
ds_read_b128 v[60:63], v2 offset:44032
v_fma_f32 v212, v212, v234, v234
v_mfma_f32_16x16x32_bf16 v[124:127], v[64:67], a[108:111], v[124:127]
v_fma_f32 v214, v214, v234, v234
v_mul_f32 v208, v84, v84
v_mfma_f32_16x16x32_bf16 v[124:127], v[68:71], a[124:127], v[124:127]
v_mul_f32 v210, v85, v85
s_waitcnt lgkmcnt(4)
v_mfma_f32_16x16x32_bf16 v[128:131], v[72:75], a[96:99], v[128:131]
v_rcp_f32 v212, v212
v_mfma_f32_16x16x32_bf16 v[128:131], v[76:79], a[112:115], v[128:131]
v_rcp_f32 v214, v214
v_mfma_f32_16x16x32_bf16 v[132:135], v[72:75], a[100:103], v[132:135]
ds_read_b128 v[64:67], v2 offset:45056
v_mul_f32 v213, v213, v212
v_mfma_f32_16x16x32_bf16 v[132:135], v[76:79], a[116:119], v[132:135]
v_mul_f32 v215, v215, v214
v_cvt_pk_bf16_f32 v177, v213, v215
v_mfma_f32_16x16x32_bf16 v[136:139], v[72:75], a[104:107], v[136:139]
v_fma_f32 v208, v208, v237, v236
v_fma_f32 v210, v210, v237, v236
v_mfma_f32_16x16x32_bf16 v[136:139], v[76:79], a[120:123], v[136:139]
ds_read_b128 v[68:71], v2 offset:46080
v_mul_f32 v208, v208, v84
v_mfma_f32_16x16x32_bf16 v[140:143], v[72:75], a[108:111], v[140:143]
v_mul_f32 v210, v210, v85
v_mul_f32 v209, v84, v100
v_mfma_f32_16x16x32_bf16 v[140:143], v[76:79], a[124:127], v[140:143]
v_mul_f32 v211, v85, v101
s_waitcnt lgkmcnt(4)
v_mfma_f32_16x16x32_bf16 v[112:115], v[48:51], a[128:131], v[112:115]
v_exp_f32 v208, v208
v_mfma_f32_16x16x32_bf16 v[112:115], v[52:55], a[144:147], v[112:115]
v_exp_f32 v210, v210
v_mfma_f32_16x16x32_bf16 v[116:119], v[48:51], a[132:135], v[116:119]
ds_read_b128 v[72:75], v2 offset:47104
v_fma_f32 v208, v208, v238, v238
v_mfma_f32_16x16x32_bf16 v[116:119], v[52:55], a[148:151], v[116:119]
v_fma_f32 v210, v210, v238, v238
v_mul_f32 v212, v86, v86
v_mfma_f32_16x16x32_bf16 v[120:123], v[48:51], a[136:139], v[120:123]
v_rcp_f32 v208, v208
v_mfma_f32_16x16x32_bf16 v[120:123], v[52:55], a[152:155], v[120:123]
ds_read_b128 v[76:79], v2 offset:48128
v_mul_f32 v209, v209, v208
v_mfma_f32_16x16x32_bf16 v[124:127], v[48:51], a[140:143], v[124:127]
v_rcp_f32 v210, v210
v_mfma_f32_16x16x32_bf16 v[124:127], v[52:55], a[156:159], v[124:127]
v_mul_f32 v211, v211, v210
s_waitcnt lgkmcnt(4)
v_mfma_f32_16x16x32_bf16 v[128:131], v[56:59], a[128:131], v[128:131]
s_waitcnt vmcnt(25)
v_cvt_pk_bf16_f32 v180, v209, v211
v_mfma_f32_16x16x32_bf16 v[128:131], v[60:63], a[144:147], v[128:131]
s_barrier
v_mfma_f32_16x16x32_bf16 v[132:135], v[56:59], a[132:135], v[132:135]
ds_read_b128 v[48:51], v2 offset:49152
s_add_u32 m0, s22, 0
v_mfma_f32_16x16x32_bf16 v[132:135], v[60:63], a[148:151], v[132:135]
v_add_u32 v3, 20480, v3
buffer_load_dwordx4 v3, s[8:11], 0 offen offset:0 sc1 lds
v_mfma_f32_16x16x32_bf16 v[136:139], v[56:59], a[136:139], v[136:139]
v_mul_f32 v214, v87, v87
v_fma_f32 v212, v212, v237, v236
v_mfma_f32_16x16x32_bf16 v[136:139], v[60:63], a[152:155], v[136:139]
ds_read_b128 v[52:55], v2 offset:50176
v_fma_f32 v214, v214, v237, v236
v_mfma_f32_16x16x32_bf16 v[140:143], v[56:59], a[140:143], v[140:143]
v_mul_f32 v212, v212, v86
v_mul_f32 v214, v214, v87
v_mfma_f32_16x16x32_bf16 v[140:143], v[60:63], a[156:159], v[140:143]
v_mul_f32 v213, v86, v102
s_waitcnt lgkmcnt(4)
v_mfma_f32_16x16x32_bf16 v[112:115], v[64:67], a[160:163], v[112:115]
buffer_load_dwordx4 v3, s[8:11], 0 offen offset:1024 sc1 lds
v_mfma_f32_16x16x32_bf16 v[112:115], v[68:71], a[176:179], v[112:115]
v_exp_f32 v212, v212
v_mfma_f32_16x16x32_bf16 v[116:119], v[64:67], a[164:167], v[116:119]
ds_read_b128 v[56:59], v2 offset:51200
v_mul_f32 v215, v87, v103
v_mfma_f32_16x16x32_bf16 v[116:119], v[68:71], a[180:183], v[116:119]
v_exp_f32 v214, v214
v_mfma_f32_16x16x32_bf16 v[120:123], v[64:67], a[168:171], v[120:123]
v_fma_f32 v212, v212, v238, v238
v_fma_f32 v214, v214, v238, v238
v_mfma_f32_16x16x32_bf16 v[120:123], v[68:71], a[184:187], v[120:123]
ds_read_b128 v[60:63], v2 offset:52224
v_mul_f32 v208, v88, v88
v_mfma_f32_16x16x32_bf16 v[124:127], v[64:67], a[172:175], v[124:127]
buffer_load_dwordx4 v3, s[8:11], 0 offen offset:2048 sc1 lds
v_mfma_f32_16x16x32_bf16 v[124:127], v[68:71], a[188:191], v[124:127]
v_mul_f32 v210, v89, v89
s_waitcnt lgkmcnt(4)
v_mfma_f32_16x16x32_bf16 v[128:131], v[72:75], a[160:163], v[128:131]
v_rcp_f32 v212, v212
v_mfma_f32_16x16x32_bf16 v[128:131], v[76:79], a[176:179], v[128:131]
v_rcp_f32 v214, v214
v_mfma_f32_16x16x32_bf16 v[132:135], v[72:75], a[164:167], v[132:135]
ds_read_b128 v[64:67], v2 offset:53248
v_mul_f32 v213, v213, v212
v_mfma_f32_16x16x32_bf16 v[132:135], v[76:79], a[180:183], v[132:135]
buffer_load_dwordx4 v3, s[8:11], 0 offen offset:3072 sc1 lds
v_mfma_f32_16x16x32_bf16 v[136:139], v[72:75], a[168:171], v[136:139]
s_add_u32 m0, s22, 4096
v_add_u32 v3, 4096, v3
v_mfma_f32_16x16x32_bf16 v[136:139], v[76:79], a[184:187], v[136:139]
ds_read_b128 v[68:71], v2 offset:54272
v_mul_f32 v215, v215, v214
v_mfma_f32_16x16x32_bf16 v[140:143], v[72:75], a[172:175], v[140:143]
v_cvt_pk_bf16_f32 v181, v213, v215
v_fma_f32 v208, v208, v241, v240
v_mfma_f32_16x16x32_bf16 v[140:143], v[76:79], a[188:191], v[140:143]
v_fma_f32 v210, v210, v241, v240
s_waitcnt lgkmcnt(4)
v_mfma_f32_16x16x32_bf16 v[112:115], v[48:51], a[192:195], v[112:115]
buffer_load_dwordx4 v3, s[8:11], 0 offen offset:0 sc1 lds
v_mfma_f32_16x16x32_bf16 v[112:115], v[52:55], a[208:211], v[112:115]
v_mul_f32 v208, v208, v88
v_mul_f32 v210, v210, v89
v_mfma_f32_16x16x32_bf16 v[116:119], v[48:51], a[196:199], v[116:119]
ds_read_b128 v[72:75], v2 offset:55296
v_mul_f32 v209, v88, v104
v_mfma_f32_16x16x32_bf16 v[116:119], v[52:55], a[212:215], v[116:119]
v_exp_f32 v208, v208
v_mfma_f32_16x16x32_bf16 v[120:123], v[48:51], a[200:203], v[120:123]
v_exp_f32 v210, v210
v_mfma_f32_16x16x32_bf16 v[120:123], v[52:55], a[216:219], v[120:123]
ds_read_b128 v[76:79], v2 offset:56320
v_mul_f32 v211, v89, v105
v_mfma_f32_16x16x32_bf16 v[124:127], v[48:51], a[204:207], v[124:127]
buffer_load_dwordx4 v3, s[8:11], 0 offen offset:1024 sc1 lds
v_mfma_f32_16x16x32_bf16 v[124:127], v[52:55], a[220:223], v[124:127]
v_fma_f32 v208, v208, v242, v242
s_waitcnt lgkmcnt(4)
v_mfma_f32_16x16x32_bf16 v[128:131], v[56:59], a[192:195], v[128:131]
v_mov_b32 v12, s68
v_mov_b32 v13, s69
v_mfma_f32_16x16x32_bf16 v[128:131], v[60:63], a[208:211], v[128:131]
s_add_u32 s53, s34, 0
s_waitcnt vmcnt(6)
v_fma_f32 v210, v210, v242, v242
v_mfma_f32_16x16x32_bf16 v[132:135], v[56:59], a[196:199], v[132:135]
ds_read_b128 v[48:51], v2 offset:57344
v_rcp_f32 v208, v208
v_mfma_f32_16x16x32_bf16 v[132:135], v[60:63], a[212:215], v[132:135]
buffer_store_dwordx2 v[12:13], v10, s[8:11], s53 offen sc1
v_rcp_f32 v210, v210
v_mfma_f32_16x16x32_bf16 v[136:139], v[56:59], a[200:203], v[136:139]
v_mul_f32 v209, v209, v208
v_mul_f32 v211, v211, v210
v_mfma_f32_16x16x32_bf16 v[136:139], v[60:63], a[216:219], v[136:139]
ds_read_b128 v[52:55], v2 offset:58368
v_cvt_pk_bf16_f32 v184, v209, v211
v_mfma_f32_16x16x32_bf16 v[140:143], v[56:59], a[204:207], v[140:143]
v_mul_f32 v212, v90, v90
v_mul_f32 v214, v91, v91
v_mfma_f32_16x16x32_bf16 v[140:143], v[60:63], a[220:223], v[140:143]
v_fma_f32 v212, v212, v241, v240
s_waitcnt lgkmcnt(4)
v_mfma_f32_16x16x32_bf16 v[112:115], v[64:67], a[224:227], v[112:115]
v_fma_f32 v214, v214, v241, v240
v_mul_f32 v212, v212, v90
v_mfma_f32_16x16x32_bf16 v[112:115], v[68:71], a[240:243], v[112:115]
v_mul_f32 v214, v214, v91
v_exp_f32 v212, v212
v_mfma_f32_16x16x32_bf16 v[116:119], v[64:67], a[228:231], v[116:119]
ds_read_b128 v[56:59], v2 offset:59392
v_exp_f32 v214, v214
v_mfma_f32_16x16x32_bf16 v[116:119], v[68:71], a[244:247], v[116:119]
v_mul_f32 v213, v90, v106
v_mul_f32 v215, v91, v107
v_mfma_f32_16x16x32_bf16 v[120:123], v[64:67], a[232:235], v[120:123]
v_fma_f32 v212, v212, v242, v242
v_fma_f32 v214, v214, v242, v242
v_mfma_f32_16x16x32_bf16 v[120:123], v[68:71], a[248:251], v[120:123]
ds_read_b128 v[60:63], v2 offset:60416
v_rcp_f32 v212, v212
v_mfma_f32_16x16x32_bf16 v[124:127], v[64:67], a[236:239], v[124:127]
v_rcp_f32 v214, v214
v_mfma_f32_16x16x32_bf16 v[124:127], v[68:71], a[252:255], v[124:127]
v_mul_f32 v213, v213, v212
s_waitcnt lgkmcnt(4)
v_mfma_f32_16x16x32_bf16 v[128:131], v[72:75], a[224:227], v[128:131]
v_mul_f32 v215, v215, v214
v_cvt_pk_bf16_f32 v185, v213, v215
v_mfma_f32_16x16x32_bf16 v[128:131], v[76:79], a[240:243], v[128:131]
v_mul_f32 v208, v92, v92
v_mul_f32 v210, v93, v93
v_mfma_f32_16x16x32_bf16 v[132:135], v[72:75], a[228:231], v[132:135]
ds_read_b128 v[64:67], v2 offset:61440
v_fma_f32 v208, v208, v245, v244
v_mfma_f32_16x16x32_bf16 v[132:135], v[76:79], a[244:247], v[132:135]
v_fma_f32 v210, v210, v245, v244
v_mul_f32 v208, v208, v92
v_mfma_f32_16x16x32_bf16 v[136:139], v[72:75], a[232:235], v[136:139]
v_mul_f32 v210, v210, v93
v_exp_f32 v208, v208
v_mfma_f32_16x16x32_bf16 v[136:139], v[76:79], a[248:251], v[136:139]
ds_read_b128 v[68:71], v2 offset:62464
v_exp_f32 v210, v210
v_mfma_f32_16x16x32_bf16 v[140:143], v[72:75], a[236:239], v[140:143]
v_mul_f32 v209, v92, v108
v_mul_f32 v211, v93, v109
v_mfma_f32_16x16x32_bf16 v[140:143], v[76:79], a[252:255], v[140:143]
v_fma_f32 v208, v208, v246, v246
s_waitcnt lgkmcnt(4)
v_mfma_f32_16x16x32_bf16 v[112:115], v[48:51], v[16:19], v[112:115]
v_fma_f32 v210, v210, v246, v246
v_rcp_f32 v208, v208
v_mfma_f32_16x16x32_bf16 v[112:115], v[52:55], v[32:35], v[112:115]
v_rcp_f32 v210, v210
v_mfma_f32_16x16x32_bf16 v[116:119], v[48:51], v[20:23], v[116:119]
ds_read_b128 v[72:75], v2 offset:63488
v_mul_f32 v209, v209, v208
v_mfma_f32_16x16x32_bf16 v[116:119], v[52:55], v[36:39], v[116:119]
v_mul_f32 v211, v211, v210
v_cvt_pk_bf16_f32 v188, v209, v211
v_mfma_f32_16x16x32_bf16 v[120:123], v[48:51], v[24:27], v[120:123]
v_mul_f32 v212, v94, v94
v_mul_f32 v214, v95, v95
v_mfma_f32_16x16x32_bf16 v[120:123], v[52:55], v[40:43], v[120:123]
ds_read_b128 v[76:79], v2 offset:64512
v_fma_f32 v212, v212, v245, v244
v_mfma_f32_16x16x32_bf16 v[124:127], v[48:51], v[28:31], v[124:127]
v_fma_f32 v214, v214, v245, v244
v_mul_f32 v212, v212, v94
v_mfma_f32_16x16x32_bf16 v[124:127], v[52:55], v[44:47], v[124:127]
v_mul_f32 v214, v214, v95
s_waitcnt lgkmcnt(4)
v_mfma_f32_16x16x32_bf16 v[128:131], v[56:59], v[16:19], v[128:131]
v_exp_f32 v212, v212
v_mfma_f32_16x16x32_bf16 v[128:131], v[60:63], v[32:35], v[128:131]
v_exp_f32 v214, v214
v_mfma_f32_16x16x32_bf16 v[132:135], v[56:59], v[20:23], v[132:135]
ds_read_b128 v[48:51], v7 offset:0
v_mul_f32 v213, v94, v110
v_mfma_f32_16x16x32_bf16 v[132:135], v[60:63], v[36:39], v[132:135]
v_mul_f32 v215, v95, v111
v_fma_f32 v212, v212, v246, v246
v_mfma_f32_16x16x32_bf16 v[136:139], v[56:59], v[24:27], v[136:139]
v_fma_f32 v214, v214, v246, v246
v_rcp_f32 v212, v212
v_mfma_f32_16x16x32_bf16 v[136:139], v[60:63], v[40:43], v[136:139]
ds_read_b128 v[52:55], v7 offset:1024
v_rcp_f32 v214, v214
v_mfma_f32_16x16x32_bf16 v[140:143], v[56:59], v[28:31], v[140:143]
v_mul_f32 v213, v213, v212
v_mul_f32 v215, v215, v214
v_mfma_f32_16x16x32_bf16 v[140:143], v[60:63], v[44:47], v[140:143]
v_cvt_pk_bf16_f32 v189, v213, v215
s_waitcnt lgkmcnt(4)
v_mfma_f32_16x16x32_bf16 v[80:83], v[64:67], a[0:3], 0
v_mfma_f32_16x16x32_bf16 v[80:83], v[68:71], a[16:19], v[80:83]
v_mfma_f32_16x16x32_bf16 v[84:87], v[64:67], a[4:7], 0
ds_read_b128 v[56:59], v7 offset:2048
v_mfma_f32_16x16x32_bf16 v[84:87], v[68:71], a[20:23], v[84:87]
v_mul_f32 v208, v112, v112
v_mul_f32 v210, v113, v113
v_mfma_f32_16x16x32_bf16 v[88:91], v[64:67], a[8:11], 0
v_fma_f32 v208, v208, v233, v232
v_fma_f32 v210, v210, v233, v232
v_mfma_f32_16x16x32_bf16 v[88:91], v[68:71], a[24:27], v[88:91]
ds_read_b128 v[60:63], v7 offset:3072
v_mul_f32 v208, v208, v112
v_mfma_f32_16x16x32_bf16 v[92:95], v[64:67], a[12:15], 0
v_mul_f32 v210, v210, v113
v_mul_f32 v209, v112, v128
v_mfma_f32_16x16x32_bf16 v[92:95], v[68:71], a[28:31], v[92:95]
v_mul_f32 v211, v113, v129
s_waitcnt lgkmcnt(4)
v_mfma_f32_16x16x32_bf16 v[96:99], v[72:75], a[0:3], 0
v_exp_f32 v208, v208
v_mfma_f32_16x16x32_bf16 v[96:99], v[76:79], a[16:19], v[96:99]
v_exp_f32 v210, v210
v_mfma_f32_16x16x32_bf16 v[100:103], v[72:75], a[4:7], 0
ds_read_b128 v[64:67], v7 offset:4096
v_fma_f32 v208, v208, v234, v234
v_mfma_f32_16x16x32_bf16 v[100:103], v[76:79], a[20:23], v[100:103]
v_fma_f32 v210, v210, v234, v234
v_mul_f32 v212, v114, v114
v_mfma_f32_16x16x32_bf16 v[104:107], v[72:75], a[8:11], 0
v_rcp_f32 v208, v208
v_mfma_f32_16x16x32_bf16 v[104:107], v[76:79], a[24:27], v[104:107]
ds_read_b128 v[68:71], v7 offset:5120
v_mul_f32 v209, v209, v208
v_mfma_f32_16x16x32_bf16 v[108:111], v[72:75], a[12:15], 0
v_rcp_f32 v210, v210
v_mfma_f32_16x16x32_bf16 v[108:111], v[76:79], a[28:31], v[108:111]
v_mul_f32 v211, v211, v210
s_waitcnt lgkmcnt(4)
v_mfma_f32_16x16x32_bf16 v[80:83], v[48:51], a[32:35], v[80:83]
v_cvt_pk_bf16_f32 v178, v209, v211
v_mul_f32 v214, v115, v115
v_mfma_f32_16x16x32_bf16 v[80:83], v[52:55], a[48:51], v[80:83]
v_fma_f32 v212, v212, v233, v232
v_fma_f32 v214, v214, v233, v232
v_mfma_f32_16x16x32_bf16 v[84:87], v[48:51], a[36:39], v[84:87]
ds_read_b128 v[72:75], v7 offset:6144
v_mul_f32 v212, v212, v114
v_mfma_f32_16x16x32_bf16 v[84:87], v[52:55], a[52:55], v[84:87]
v_mul_f32 v214, v214, v115
v_mul_f32 v213, v114, v130
v_mfma_f32_16x16x32_bf16 v[88:91], v[48:51], a[40:43], v[88:91]
v_exp_f32 v212, v212
v_mfma_f32_16x16x32_bf16 v[88:91], v[52:55], a[56:59], v[88:91]
ds_read_b128 v[76:79], v7 offset:7168
v_mul_f32 v215, v115, v131
v_mfma_f32_16x16x32_bf16 v[92:95], v[48:51], a[44:47], v[92:95]
v_exp_f32 v214, v214
v_mfma_f32_16x16x32_bf16 v[92:95], v[52:55], a[60:63], v[92:95]
v_fma_f32 v212, v212, v234, v234
s_waitcnt lgkmcnt(4)
v_mfma_f32_16x16x32_bf16 v[96:99], v[56:59], a[32:35], v[96:99]
s_waitcnt vmcnt(26)
v_fma_f32 v214, v214, v234, v234
v_mfma_f32_16x16x32_bf16 v[96:99], v[60:63], a[48:51], v[96:99]
s_barrier
v_mfma_f32_16x16x32_bf16 v[100:103], v[56:59], a[36:39], v[100:103]
ds_read_b128 v[48:51], v7 offset:8192
s_add_u32 m0, s22, 24576
v_mfma_f32_16x16x32_bf16 v[100:103], v[60:63], a[52:55], v[100:103]
v_add_u32 v3, 20480, v3
buffer_load_dwordx4 v3, s[8:11], 0 offen offset:0 sc1 lds
v_mfma_f32_16x16x32_bf16 v[104:107], v[56:59], a[40:43], v[104:107]
v_rcp_f32 v212, v212
v_mfma_f32_16x16x32_bf16 v[104:107], v[60:63], a[56:59], v[104:107]
ds_read_b128 v[52:55], v7 offset:9216
v_mul_f32 v213, v213, v212
v_mfma_f32_16x16x32_bf16 v[108:111], v[56:59], a[44:47], v[108:111]
v_rcp_f32 v214, v214
v_mfma_f32_16x16x32_bf16 v[108:111], v[60:63], a[60:63], v[108:111]
v_mul_f32 v215, v215, v214
s_waitcnt lgkmcnt(4)
v_mfma_f32_16x16x32_bf16 v[80:83], v[64:67], a[64:67], v[80:83]
buffer_load_dwordx4 v3, s[8:11], 0 offen offset:1024 sc1 lds
v_mfma_f32_16x16x32_bf16 v[80:83], v[68:71], a[80:83], v[80:83]
v_cvt_pk_bf16_f32 v179, v213, v215
v_mul_f32 v208, v116, v116
v_mfma_f32_16x16x32_bf16 v[84:87], v[64:67], a[68:71], v[84:87]
ds_read_b128 v[56:59], v7 offset:10240
v_mul_f32 v210, v117, v117
v_mfma_f32_16x16x32_bf16 v[84:87], v[68:71], a[84:87], v[84:87]
buffer_store_dwordx4 v[176:179], v2, s[8:11], s24 offen offset:2048 sc1
v_mfma_f32_16x16x32_bf16 v[88:91], v[64:67], a[72:75], v[88:91]
v_fma_f32 v208, v208, v237, v236
v_fma_f32 v210, v210, v237, v236
v_mfma_f32_16x16x32_bf16 v[88:91], v[68:71], a[88:91], v[88:91]
ds_read_b128 v[60:63], v7 offset:11264
v_mul_f32 v208, v208, v116
v_mfma_f32_16x16x32_bf16 v[92:95], v[64:67], a[76:79], v[92:95]
v_mul_f32 v210, v210, v117
v_mul_f32 v209, v116, v132
v_mfma_f32_16x16x32_bf16 v[92:95], v[68:71], a[92:95], v[92:95]
v_mul_f32 v211, v117, v133
s_waitcnt lgkmcnt(4)
v_mfma_f32_16x16x32_bf16 v[96:99], v[72:75], a[64:67], v[96:99]
buffer_load_dwordx4 v3, s[8:11], 0 offen offset:2048 sc1 lds
v_mfma_f32_16x16x32_bf16 v[96:99], v[76:79], a[80:83], v[96:99]
v_exp_f32 v208, v208
v_mfma_f32_16x16x32_bf16 v[100:103], v[72:75], a[68:71], v[100:103]
ds_read_b128 v[64:67], v7 offset:12288
v_fma_f32 v208, v208, v238, v238
v_mfma_f32_16x16x32_bf16 v[100:103], v[76:79], a[84:87], v[100:103]
v_exp_f32 v210, v210
v_mfma_f32_16x16x32_bf16 v[104:107], v[72:75], a[72:75], v[104:107]
v_fma_f32 v210, v210, v238, v238
v_mul_f32 v212, v118, v118
v_mfma_f32_16x16x32_bf16 v[104:107], v[76:79], a[88:91], v[104:107]
ds_read_b128 v[68:71], v7 offset:13312
v_mul_f32 v214, v119, v119
v_mfma_f32_16x16x32_bf16 v[108:111], v[72:75], a[76:79], v[108:111]
buffer_load_dwordx4 v3, s[8:11], 0 offen offset:3072 sc1 lds
v_mfma_f32_16x16x32_bf16 v[108:111], v[76:79], a[92:95], v[108:111]
s_add_u32 m0, s22, 28672
s_waitcnt lgkmcnt(4)
v_mfma_f32_16x16x32_bf16 v[80:83], v[48:51], a[96:99], v[80:83]
s_add_u32 s23, s34, 0
v_fma_f32 v212, v212, v237, v236
v_mfma_f32_16x16x32_bf16 v[80:83], v[52:55], a[112:115], v[80:83]
v_rcp_f32 v208, v208
v_mfma_f32_16x16x32_bf16 v[84:87], v[48:51], a[100:103], v[84:87]
ds_read_b128 v[72:75], v7 offset:14336
v_mul_f32 v209, v209, v208
v_mfma_f32_16x16x32_bf16 v[84:87], v[52:55], a[116:119], v[84:87]
buffer_load_dwordx2 v[14:15], v11, s[8:11], s23 offen sc1
v_mfma_f32_16x16x32_bf16 v[88:91], v[48:51], a[104:107], v[88:91]
v_add_u32 v3, 4096, v3
v_fma_f32 v214, v214, v237, v236
v_mfma_f32_16x16x32_bf16 v[88:91], v[52:55], a[120:123], v[88:91]
ds_read_b128 v[76:79], v7 offset:15360
v_mul_f32 v212, v212, v118
v_mfma_f32_16x16x32_bf16 v[92:95], v[48:51], a[108:111], v[92:95]
v_rcp_f32 v210, v210
v_mfma_f32_16x16x32_bf16 v[92:95], v[52:55], a[124:127], v[92:95]
v_mul_f32 v211, v211, v210
s_waitcnt lgkmcnt(4)
v_mfma_f32_16x16x32_bf16 v[96:99], v[56:59], a[96:99], v[96:99]
buffer_load_dwordx4 v3, s[8:11], 0 offen offset:0 sc1 lds
v_mfma_f32_16x16x32_bf16 v[96:99], v[60:63], a[112:115], v[96:99]
v_cvt_pk_bf16_f32 v182, v209, v211
v_mul_f32 v214, v214, v119
v_mfma_f32_16x16x32_bf16 v[100:103], v[56:59], a[100:103], v[100:103]
ds_read_b128 v[48:51], v7 offset:16384
v_mul_f32 v213, v118, v134
v_mfma_f32_16x16x32_bf16 v[100:103], v[60:63], a[116:119], v[100:103]
v_exp_f32 v212, v212
v_mfma_f32_16x16x32_bf16 v[104:107], v[56:59], a[104:107], v[104:107]
v_exp_f32 v214, v214
v_mfma_f32_16x16x32_bf16 v[104:107], v[60:63], a[120:123], v[104:107]
ds_read_b128 v[52:55], v7 offset:17408
v_mul_f32 v215, v119, v135
v_mfma_f32_16x16x32_bf16 v[108:111], v[56:59], a[108:111], v[108:111]
buffer_load_dwordx4 v3, s[8:11], 0 offen offset:1024 sc1 lds
v_mfma_f32_16x16x32_bf16 v[108:111], v[60:63], a[124:127], v[108:111]
v_fma_f32 v212, v212, v238, v238
s_waitcnt lgkmcnt(4)
v_mfma_f32_16x16x32_bf16 v[80:83], v[64:67], a[128:131], v[80:83]
v_fma_f32 v214, v214, v238, v238
v_mul_f32 v208, v120, v120
v_mfma_f32_16x16x32_bf16 v[80:83], v[68:71], a[144:147], v[80:83]
v_rcp_f32 v212, v212
v_mfma_f32_16x16x32_bf16 v[84:87], v[64:67], a[132:135], v[84:87]
ds_read_b128 v[56:59], v7 offset:18432
v_mul_f32 v213, v213, v212
v_mfma_f32_16x16x32_bf16 v[84:87], v[68:71], a[148:151], v[84:87]
v_rcp_f32 v214, v214
v_mfma_f32_16x16x32_bf16 v[88:91], v[64:67], a[136:139], v[88:91]
v_mul_f32 v215, v215, v214
v_cvt_pk_bf16_f32 v183, v213, v215
v_mfma_f32_16x16x32_bf16 v[88:91], v[68:71], a[152:155], v[88:91]
ds_read_b128 v[60:63], v7 offset:19456
v_mul_f32 v210, v121, v121
v_mfma_f32_16x16x32_bf16 v[92:95], v[64:67], a[140:143], v[92:95]
buffer_store_dwordx4 v[180:183], v4, s[8:11], s24 offen offset:2048 sc1
v_mfma_f32_16x16x32_bf16 v[92:95], v[68:71], a[156:159], v[92:95]
v_fma_f32 v208, v208, v241, v240
s_waitcnt lgkmcnt(4)
v_mfma_f32_16x16x32_bf16 v[96:99], v[72:75], a[128:131], v[96:99]
v_fma_f32 v210, v210, v241, v240
v_mul_f32 v208, v208, v120
v_mfma_f32_16x16x32_bf16 v[96:99], v[76:79], a[144:147], v[96:99]
v_mul_f32 v210, v210, v121
v_mul_f32 v209, v120, v136
v_mfma_f32_16x16x32_bf16 v[100:103], v[72:75], a[132:135], v[100:103]
ds_read_b128 v[64:67], v7 offset:20480
v_mul_f32 v211, v121, v137
v_mfma_f32_16x16x32_bf16 v[100:103], v[76:79], a[148:151], v[100:103]
v_exp_f32 v208, v208
v_mfma_f32_16x16x32_bf16 v[104:107], v[72:75], a[136:139], v[104:107]
v_exp_f32 v210, v210
v_mfma_f32_16x16x32_bf16 v[104:107], v[76:79], a[152:155], v[104:107]
ds_read_b128 v[68:71], v7 offset:21504
v_fma_f32 v208, v208, v242, v242
v_mfma_f32_16x16x32_bf16 v[108:111], v[72:75], a[140:143], v[108:111]
v_fma_f32 v210, v210, v242, v242
v_mul_f32 v212, v122, v122
v_mfma_f32_16x16x32_bf16 v[108:111], v[76:79], a[156:159], v[108:111]
v_mul_f32 v214, v123, v123
s_waitcnt lgkmcnt(4)
v_mfma_f32_16x16x32_bf16 v[80:83], v[48:51], a[160:163], v[80:83]
v_rcp_f32 v208, v208
v_mfma_f32_16x16x32_bf16 v[80:83], v[52:55], a[176:179], v[80:83]
v_rcp_f32 v210, v210
v_mfma_f32_16x16x32_bf16 v[84:87], v[48:51], a[164:167], v[84:87]
ds_read_b128 v[72:75], v7 offset:22528
v_mul_f32 v209, v209, v208
v_mfma_f32_16x16x32_bf16 v[84:87], v[52:55], a[180:183], v[84:87]
v_mul_f32 v211, v211, v210
v_cvt_pk_bf16_f32 v186, v209, v211
v_mfma_f32_16x16x32_bf16 v[88:91], v[48:51], a[168:171], v[88:91]
v_fma_f32 v212, v212, v241, v240
v_fma_f32 v214, v214, v241, v240
v_mfma_f32_16x16x32_bf16 v[88:91], v[52:55], a[184:187], v[88:91]
ds_read_b128 v[76:79], v7 offset:23552
v_mul_f32 v212, v212, v122
v_mfma_f32_16x16x32_bf16 v[92:95], v[48:51], a[172:175], v[92:95]
v_mul_f32 v214, v214, v123
v_mul_f32 v213, v122, v138
v_mfma_f32_16x16x32_bf16 v[92:95], v[52:55], a[188:191], v[92:95]
v_mul_f32 v215, v123, v139
s_waitcnt lgkmcnt(4)
v_mfma_f32_16x16x32_bf16 v[96:99], v[56:59], a[160:163], v[96:99]
v_exp_f32 v212, v212
v_mfma_f32_16x16x32_bf16 v[96:99], v[60:63], a[176:179], v[96:99]
v_exp_f32 v214, v214
v_mfma_f32_16x16x32_bf16 v[100:103], v[56:59], a[164:167], v[100:103]
ds_read_b128 v[48:51], v7 offset:24576
v_fma_f32 v212, v212, v242, v242
v_mfma_f32_16x16x32_bf16 v[100:103], v[60:63], a[180:183], v[100:103]
v_fma_f32 v214, v214, v242, v242
v_mul_f32 v208, v124, v124
v_mfma_f32_16x16x32_bf16 v[104:107], v[56:59], a[168:171], v[104:107]
v_rcp_f32 v212, v212
v_mfma_f32_16x16x32_bf16 v[104:107], v[60:63], a[184:187], v[104:107]
ds_read_b128 v[52:55], v7 offset:25600
v_mfma_f32_16x16x32_bf16 v[108:111], v[56:59], a[172:175], v[108:111]
v_rcp_f32 v214, v214
v_mfma_f32_16x16x32_bf16 v[108:111], v[60:63], a[188:191], v[108:111]
s_waitcnt lgkmcnt(4)
v_mfma_f32_16x16x32_bf16 v[80:83], v[64:67], a[192:195], v[80:83]
v_mul_f32 v213, v213, v212
v_mul_f32 v215, v215, v214
v_mfma_f32_16x16x32_bf16 v[80:83], v[68:71], a[208:211], v[80:83]
v_cvt_pk_bf16_f32 v187, v213, v215
v_mul_f32 v210, v125, v125
v_mfma_f32_16x16x32_bf16 v[84:87], v[64:67], a[196:199], v[84:87]
ds_read_b128 v[56:59], v7 offset:26624
v_mfma_f32_16x16x32_bf16 v[84:87], v[68:71], a[212:215], v[84:87]
buffer_store_dwordx4 v[184:187], v5, s[8:11], s24 offen offset:2048 sc1
v_mfma_f32_16x16x32_bf16 v[88:91], v[64:67], a[200:203], v[88:91]
v_mfma_f32_16x16x32_bf16 v[88:91], v[68:71], a[216:219], v[88:91]
ds_read_b128 v[60:63], v7 offset:27648
v_fma_f32 v208, v208, v245, v244
v_mfma_f32_16x16x32_bf16 v[92:95], v[64:67], a[204:207], v[92:95]
v_fma_f32 v210, v210, v245, v244
v_mul_f32 v208, v208, v124
v_mfma_f32_16x16x32_bf16 v[92:95], v[68:71], a[220:223], v[92:95]
v_mul_f32 v210, v210, v125
s_waitcnt lgkmcnt(4)
v_mfma_f32_16x16x32_bf16 v[96:99], v[72:75], a[192:195], v[96:99]
v_exp_f32 v208, v208
v_mfma_f32_16x16x32_bf16 v[96:99], v[76:79], a[208:211], v[96:99]
v_mfma_f32_16x16x32_bf16 v[100:103], v[72:75], a[196:199], v[100:103]
ds_read_b128 v[64:67], v7 offset:28672
v_mul_f32 v209, v124, v140
v_mfma_f32_16x16x32_bf16 v[100:103], v[76:79], a[212:215], v[100:103]
v_exp_f32 v210, v210
v_mfma_f32_16x16x32_bf16 v[104:107], v[72:75], a[200:203], v[104:107]
v_mfma_f32_16x16x32_bf16 v[104:107], v[76:79], a[216:219], v[104:107]
ds_read_b128 v[68:71], v7 offset:29696
v_mul_f32 v211, v125, v141
v_mfma_f32_16x16x32_bf16 v[108:111], v[72:75], a[204:207], v[108:111]
v_fma_f32 v208, v208, v246, v246
v_fma_f32 v210, v210, v246, v246
v_mfma_f32_16x16x32_bf16 v[108:111], v[76:79], a[220:223], v[108:111]
v_mul_f32 v212, v126, v126
s_waitcnt lgkmcnt(4)
v_mfma_f32_16x16x32_bf16 v[80:83], v[48:51], a[224:227], v[80:83]
v_rcp_f32 v208, v208
v_mfma_f32_16x16x32_bf16 v[80:83], v[52:55], a[240:243], v[80:83]
v_mfma_f32_16x16x32_bf16 v[84:87], v[48:51], a[228:231], v[84:87]
ds_read_b128 v[72:75], v7 offset:30720
v_mul_f32 v209, v209, v208
v_mfma_f32_16x16x32_bf16 v[84:87], v[52:55], a[244:247], v[84:87]
v_rcp_f32 v210, v210
v_mfma_f32_16x16x32_bf16 v[88:91], v[48:51], a[232:235], v[88:91]
v_mul_f32 v211, v211, v210
v_cvt_pk_bf16_f32 v190, v209, v211
v_mfma_f32_16x16x32_bf16 v[88:91], v[52:55], a[248:251], v[88:91]
ds_read_b128 v[76:79], v7 offset:31744
v_mfma_f32_16x16x32_bf16 v[92:95], v[48:51], a[236:239], v[92:95]
v_mul_f32 v214, v127, v127
v_fma_f32 v212, v212, v245, v244
v_mfma_f32_16x16x32_bf16 v[92:95], v[52:55], a[252:255], v[92:95]
s_waitcnt lgkmcnt(4)
v_mfma_f32_16x16x32_bf16 v[96:99], v[56:59], a[224:227], v[96:99]
s_waitcnt vmcnt(28)
v_fma_f32 v214, v214, v245, v244
v_mfma_f32_16x16x32_bf16 v[96:99], v[60:63], a[240:243], v[96:99]
s_barrier
v_mfma_f32_16x16x32_bf16 v[100:103], v[56:59], a[228:231], v[100:103]
ds_read_b128 v[48:51], v7 offset:32768
s_add_u32 m0, s22, 49152
v_mfma_f32_16x16x32_bf16 v[100:103], v[60:63], a[244:247], v[100:103]
v_add_u32 v3, 20480, v3
buffer_load_dwordx4 v3, s[8:11], 0 offen offset:0 sc1 lds
v_mfma_f32_16x16x32_bf16 v[104:107], v[56:59], a[232:235], v[104:107]
v_mul_f32 v212, v212, v126
v_mul_f32 v214, v214, v127
v_mfma_f32_16x16x32_bf16 v[104:107], v[60:63], a[248:251], v[104:107]
ds_read_b128 v[52:55], v7 offset:33792
v_mul_f32 v213, v126, v142
v_mfma_f32_16x16x32_bf16 v[108:111], v[56:59], a[236:239], v[108:111]
v_exp_f32 v212, v212
v_mfma_f32_16x16x32_bf16 v[108:111], v[60:63], a[252:255], v[108:111]
v_mul_f32 v215, v127, v143
s_waitcnt lgkmcnt(4)
v_mfma_f32_16x16x32_bf16 v[80:83], v[64:67], v[16:19], v[80:83]
buffer_load_dwordx4 v3, s[8:11], 0 offen offset:1024 sc1 lds
v_mfma_f32_16x16x32_bf16 v[80:83], v[68:71], v[32:35], v[80:83]
v_exp_f32 v214, v214
v_mfma_f32_16x16x32_bf16 v[84:87], v[64:67], v[20:23], v[84:87]
ds_read_b128 v[56:59], v7 offset:34816
v_fma_f32 v212, v212, v246, v246
v_mfma_f32_16x16x32_bf16 v[84:87], v[68:71], v[36:39], v[84:87]
v_fma_f32 v214, v214, v246, v246
v_mfma_f32_16x16x32_bf16 v[88:91], v[64:67], v[24:27], v[88:91]
v_rcp_f32 v212, v212
v_mfma_f32_16x16x32_bf16 v[88:91], v[68:71], v[40:43], v[88:91]
ds_read_b128 v[60:63], v7 offset:35840
v_mul_f32 v213, v213, v212
v_mfma_f32_16x16x32_bf16 v[92:95], v[64:67], v[28:31], v[92:95]
buffer_load_dwordx4 v3, s[8:11], 0 offen offset:2048 sc1 lds
v_mfma_f32_16x16x32_bf16 v[92:95], v[68:71], v[44:47], v[92:95]
s_waitcnt lgkmcnt(4)
v_mfma_f32_16x16x32_bf16 v[96:99], v[72:75], v[16:19], v[96:99]
s_waitcnt vmcnt(7)
v_cmp_eq_u64 vcc, s[68:69], v[14:15]
s_nop 0
s_cmp_eq_u64 vcc, exec
s_cbranch_scc0 L_f_slow1
L_f_back1:
v_mfma_f32_16x16x32_bf16 v[96:99], v[76:79], v[32:35], v[96:99]
v_rcp_f32 v214, v214
v_mfma_f32_16x16x32_bf16 v[100:103], v[72:75], v[20:23], v[100:103]
ds_read_b128 v[64:67], v7 offset:36864
v_mul_f32 v215, v215, v214
v_mfma_f32_16x16x32_bf16 v[100:103], v[76:79], v[36:39], v[100:103]
buffer_load_dwordx4 v3, s[8:11], 0 offen offset:3072 sc1 lds
v_mfma_f32_16x16x32_bf16 v[104:107], v[72:75], v[24:27], v[104:107]
s_add_u32 m0, s22, 53248
v_add_u32 v3, 4096, v3
v_mfma_f32_16x16x32_bf16 v[104:107], v[76:79], v[40:43], v[104:107]
ds_read_b128 v[68:71], v7 offset:37888
v_cvt_pk_bf16_f32 v191, v213, v215
v_mfma_f32_16x16x32_bf16 v[108:111], v[72:75], v[28:31], v[108:111]
buffer_store_dwordx4 v[188:191], v6, s[8:11], s24 offen offset:2048 sc1
v_mfma_f32_16x16x32_bf16 v[108:111], v[76:79], v[44:47], v[108:111]
s_waitcnt lgkmcnt(4)
v_mfma_f32_16x16x32_bf16 v[112:115], v[48:51], a[0:3], 0
v_mfma_f32_16x16x32_bf16 v[112:115], v[52:55], a[16:19], v[112:115]
v_mfma_f32_16x16x32_bf16 v[116:119], v[48:51], a[4:7], 0
ds_read_b128 v[72:75], v7 offset:38912
v_mfma_f32_16x16x32_bf16 v[116:119], v[52:55], a[20:23], v[116:119]
buffer_load_dwordx4 v3, s[8:11], 0 offen offset:0 sc1 lds
v_mfma_f32_16x16x32_bf16 v[120:123], v[48:51], a[8:11], 0
v_mul_f32 v208, v80, v80
v_mul_f32 v210, v81, v81
v_mfma_f32_16x16x32_bf16 v[120:123], v[52:55], a[24:27], v[120:123]
ds_read_b128 v[76:79], v7 offset:39936
v_fma_f32 v208, v208, v233, v232
v_mfma_f32_16x16x32_bf16 v[124:127], v[48:51], a[12:15], 0
v_fma_f32 v210, v210, v233, v232
v_mul_f32 v208, v208, v80
v_mfma_f32_16x16x32_bf16 v[124:127], v[52:55], a[28:31], v[124:127]
v_mul_f32 v210, v210, v81
s_waitcnt lgkmcnt(4)
v_mfma_f32_16x16x32_bf16 v[128:131], v[56:59], a[0:3], 0
buffer_load_dwordx4 v3, s[8:11], 0 offen offset:1024 sc1 lds
v_mfma_f32_16x16x32_bf16 v[128:131], v[60:63], a[16:19], v[128:131]
v_exp_f32 v208, v208
v_mfma_f32_16x16x32_bf16 v[132:135], v[56:59], a[4:7], 0
ds_read_b128 v[48:51], v7 offset:40960
v_mul_f32 v209, v80, v96
v_mfma_f32_16x16x32_bf16 v[132:135], v[60:63], a[20:23], v[132:135]
v_exp_f32 v210, v210
v_mfma_f32_16x16x32_bf16 v[136:139], v[56:59], a[8:11], 0
v_mul_f32 v211, v81, v97
v_fma_f32 v208, v208, v234, v234
v_mfma_f32_16x16x32_bf16 v[136:139], v[60:63], a[24:27], v[136:139]
ds_read_b128 v[52:55], v7 offset:41984
v_fma_f32 v210, v210, v234, v234
v_mfma_f32_16x16x32_bf16 v[140:143], v[56:59], a[12:15], 0
v_rcp_f32 v208, v208
v_mfma_f32_16x16x32_bf16 v[140:143], v[60:63], a[28:31], v[140:143]
v_mul_f32 v209, v209, v208
s_waitcnt lgkmcnt(4)
v_mfma_f32_16x16x32_bf16 v[112:115], v[64:67], a[32:35], v[112:115]
buffer_load_dwordx4 a[0:3], v2, s[8:11], s25 offen offset:0 sc1
v_mfma_f32_16x16x32_bf16 v[112:115], v[68:71], a[48:51], v[112:115]
v_rcp_f32 v210, v210
v_mfma_f32_16x16x32_bf16 v[116:119], v[64:67], a[36:39], v[116:119]
ds_read_b128 v[56:59], v7 offset:43008
v_mul_f32 v211, v211, v210
v_mfma_f32_16x16x32_bf16 v[116:119], v[68:71], a[52:55], v[116:119]
v_cvt_pk_bf16_f32 v192, v209, v211
v_mul_f32 v212, v82, v82
v_mfma_f32_16x16x32_bf16 v[120:123], v[64:67], a[40:43], v[120:123]
v_mul_f32 v214, v83, v83
v_fma_f32 v212, v212, v233, v232
v_mfma_f32_16x16x32_bf16 v[120:123], v[68:71], a[56:59], v[120:123]
ds_read_b128 v[60:63], v7 offset:44032
v_fma_f32 v214, v214, v233, v232
v_mfma_f32_16x16x32_bf16 v[124:127], v[64:67], a[44:47], v[124:127]
buffer_load_dwordx4 a[4:7], v4, s[8:11], s25 offen offset:0 sc1
v_mfma_f32_16x16x32_bf16 v[124:127], v[68:71], a[60:63], v[124:127]
v_mul_f32 v212, v212, v82
s_waitcnt lgkmcnt(4)
v_mfma_f32_16x16x32_bf16 v[128:131], v[72:75], a[32:35], v[128:131]
v_mul_f32 v214, v214, v83
v_mul_f32 v213, v82, v98
v_mfma_f32_16x16x32_bf16 v[128:131], v[76:79], a[48:51], v[128:131]
v_exp_f32 v212, v212
v_mfma_f32_16x16x32_bf16 v[132:135], v[72:75], a[36:39], v[132:135]
ds_read_b128 v[64:67], v7 offset:45056
v_mul_f32 v215, v83, v99
v_mfma_f32_16x16x32_bf16 v[132:135], v[76:79], a[52:55], v[132:135]
buffer_load_dwordx4 a[8:11], v5, s[8:11], s25 offen offset:0 sc1
v_mfma_f32_16x16x32_bf16 v[136:139], v[72:75], a[40:43], v[136:139]
v_exp_f32 v214, v214
v_mfma_f32_16x16x32_bf16 v[136:139], v[76:79], a[56:59], v[136:139]
ds_read_b128 v[68:71], v7 offset:46080
v_fma_f32 v212, v212, v234, v234
v_mfma_f32_16x16x32_bf16 v[140:143], v[72:75], a[44:47], v[140:143]
v_fma_f32 v214, v214, v234, v234
v_mul_f32 v208, v84, v84
v_mfma_f32_16x16x32_bf16 v[140:143], v[76:79], a[60:63], v[140:143]
v_mul_f32 v210, v85, v85
s_waitcnt lgkmcnt(4)
v_mfma_f32_16x16x32_bf16 v[112:115], v[48:51], a[64:67], v[112:115]
buffer_load_dwordx4 a[12:15], v6, s[8:11], s25 offen offset:0 sc1
v_mfma_f32_16x16x32_bf16 v[112:115], v[52:55], a[80:83], v[112:115]
v_rcp_f32 v212, v212
v_mfma_f32_16x16x32_bf16 v[116:119], v[48:51], a[68:71], v[116:119]
ds_read_b128 v[72:75], v7 offset:47104
v_mul_f32 v213, v213, v212
v_mfma_f32_16x16x32_bf16 v[116:119], v[52:55], a[84:87], v[116:119]
v_rcp_f32 v214, v214
v_mfma_f32_16x16x32_bf16 v[120:123], v[48:51], a[72:75], v[120:123]
v_mul_f32 v215, v215, v214
v_cvt_pk_bf16_f32 v193, v213, v215
v_mfma_f32_16x16x32_bf16 v[120:123], v[52:55], a[88:91], v[120:123]
ds_read_b128 v[76:79], v7 offset:48128
v_fma_f32 v208, v208, v237, v236
v_mfma_f32_16x16x32_bf16 v[124:127], v[48:51], a[76:79], v[124:127]
buffer_load_dwordx4 a[16:19], v2, s[8:11], s26 offen offset:0 sc1
v_mfma_f32_16x16x32_bf16 v[124:127], v[52:55], a[92:95], v[124:127]
v_fma_f32 v210, v210, v237, v236
s_waitcnt lgkmcnt(4)
v_mfma_f32_16x16x32_bf16 v[128:131], v[56:59], a[64:67], v[128:131]
v_mul_f32 v208, v208, v84
v_mul_f32 v210, v210, v85
v_mfma_f32_16x16x32_bf16 v[128:131], v[60:63], a[80:83], v[128:131]
v_exp_f32 v208, v208
v_mfma_f32_16x16x32_bf16 v[132:135], v[56:59], a[68:71], v[132:135]
ds_read_b128 v[48:51], v7 offset:49152
v_mul_f32 v209, v84, v100
v_mfma_f32_16x16x32_bf16 v[132:135], v[60:63], a[84:87], v[132:135]
buffer_load_dwordx4 a[20:23], v4, s[8:11], s26 offen offset:0 sc1
v_mfma_f32_16x16x32_bf16 v[136:139], v[56:59], a[72:75], v[136:139]
v_exp_f32 v210, v210
v_mfma_f32_16x16x32_bf16 v[136:139], v[60:63], a[88:91], v[136:139]
ds_read_b128 v[52:55], v7 offset:50176
v_mul_f32 v211, v85, v101
v_mfma_f32_16x16x32_bf16 v[140:143], v[56:59], a[76:79], v[140:143]
v_fma_f32 v208, v208, v238, v238
v_fma_f32 v210, v210, v238, v238
v_mfma_f32_16x16x32_bf16 v[140:143], v[60:63], a[92:95], v[140:143]
v_mul_f32 v212, v86, v86
s_waitcnt lgkmcnt(4)
v_mfma_f32_16x16x32_bf16 v[112:115], v[64:67], a[96:99], v[112:115]
v_mov_b32 v12, s68
v_mov_b32 v13, s69
v_mfma_f32_16x16x32_bf16 v[112:115], v[68:71], a[112:115], v[112:115]
s_add_u32 s53, s34, 131072
s_waitcnt vmcnt(8)
buffer_store_dwordx2 v[12:13], v10, s[8:11], s53 offen sc1
v_mfma_f32_16x16x32_bf16 v[116:119], v[64:67], a[100:103], v[116:119]
ds_read_b128 v[56:59], v7 offset:51200
v_mul_f32 v214, v87, v87
v_mfma_f32_16x16x32_bf16 v[116:119], v[68:71], a[116:119], v[116:119]
v_rcp_f32 v208, v208
v_mfma_f32_16x16x32_bf16 v[120:123], v[64:67], a[104:107], v[120:123]
v_rcp_f32 v210, v210
v_mfma_f32_16x16x32_bf16 v[120:123], v[68:71], a[120:123], v[120:123]
ds_read_b128 v[60:63], v7 offset:52224
v_mul_f32 v209, v209, v208
v_mfma_f32_16x16x32_bf16 v[124:127], v[64:67], a[108:111], v[124:127]
buffer_load_dwordx4 a[24:27], v5, s[8:11], s26 offen offset:0 sc1
v_mfma_f32_16x16x32_bf16 v[124:127], v[68:71], a[124:127], v[124:127]
v_mul_f32 v211, v211, v210
s_waitcnt lgkmcnt(4)
v_mfma_f32_16x16x32_bf16 v[128:131], v[72:75], a[96:99], v[128:131]
v_cvt_pk_bf16_f32 v196, v209, v211
v_fma_f32 v212, v212, v237, v236
v_mfma_f32_16x16x32_bf16 v[128:131], v[76:79], a[112:115], v[128:131]
v_fma_f32 v214, v214, v237, v236
v_mul_f32 v212, v212, v86
v_mfma_f32_16x16x32_bf16 v[132:135], v[72:75], a[100:103], v[132:135]
ds_read_b128 v[64:67], v7 offset:53248
v_mul_f32 v214, v214, v87
v_mfma_f32_16x16x32_bf16 v[132:135], v[76:79], a[116:119], v[132:135]
buffer_load_dwordx4 a[28:31], v6, s[8:11], s26 offen offset:0 sc1
v_mfma_f32_16x16x32_bf16 v[136:139], v[72:75], a[104:107], v[136:139]
v_exp_f32 v212, v212
v_mfma_f32_16x16x32_bf16 v[136:139], v[76:79], a[120:123], v[136:139]
ds_read_b128 v[68:71], v7 offset:54272
v_mul_f32 v213, v86, v102
v_mfma_f32_16x16x32_bf16 v[140:143], v[72:75], a[108:111], v[140:143]
v_exp_f32 v214, v214
v_mfma_f32_16x16x32_bf16 v[140:143], v[76:79], a[124:127], v[140:143]
v_mul_f32 v215, v87, v103
s_waitcnt lgkmcnt(4)
v_mfma_f32_16x16x32_bf16 v[112:115], v[48:51], a[128:131], v[112:115]
buffer_load_dwordx4 a[32:35], v2, s[8:11], s27 offen offset:0 sc1
v_mfma_f32_16x16x32_bf16 v[112:115], v[52:55], a[144:147], v[112:115]
v_fma_f32 v212, v212, v238, v238
v_fma_f32 v214, v214, v238, v238
v_mfma_f32_16x16x32_bf16 v[116:119], v[48:51], a[132:135], v[116:119]
ds_read_b128 v[72:75], v7 offset:55296
v_mul_f32 v208, v88, v88
v_mfma_f32_16x16x32_bf16 v[116:119], v[52:55], a[148:151], v[116:119]
v_rcp_f32 v212, v212
v_mfma_f32_16x16x32_bf16 v[120:123], v[48:51], a[136:139], v[120:123]
v_rcp_f32 v214, v214
v_mfma_f32_16x16x32_bf16 v[120:123], v[52:55], a[152:155], v[120:123]
ds_read_b128 v[76:79], v7 offset:56320
v_mul_f32 v213, v213, v212
v_mfma_f32_16x16x32_bf16 v[124:127], v[48:51], a[140:143], v[124:127]
buffer_load_dwordx4 a[36:39], v4, s[8:11], s27 offen offset:0 sc1
v_mfma_f32_16x16x32_bf16 v[124:127], v[52:55], a[156:159], v[124:127]
v_mul_f32 v215, v215, v214
s_waitcnt lgkmcnt(4)
v_mfma_f32_16x16x32_bf16 v[128:131], v[56:59], a[128:131], v[128:131]
s_waitcnt vmcnt(36)
v_cvt_pk_bf16_f32 v197, v213, v215
v_mfma_f32_16x16x32_bf16 v[128:131], v[60:63], a[144:147], v[128:131]
s_barrier
v_mfma_f32_16x16x32_bf16 v[132:135], v[56:59], a[132:135], v[132:135]
ds_read_b128 v[48:51], v7 offset:57344
v_mul_f32 v210, v89, v89
v_mfma_f32_16x16x32_bf16 v[132:135], v[60:63], a[148:151], v[132:135]
buffer_load_dwordx4 a[40:43], v5, s[8:11], s27 offen offset:0 sc1
v_mfma_f32_16x16x32_bf16 v[136:139], v[56:59], a[136:139], v[136:139]
v_fma_f32 v208, v208, v241, v240
v_fma_f32 v210, v210, v241, v240
v_mfma_f32_16x16x32_bf16 v[136:139], v[60:63], a[152:155], v[136:139]
ds_read_b128 v[52:55], v7 offset:58368
v_mul_f32 v208, v208, v88
v_mfma_f32_16x16x32_bf16 v[140:143], v[56:59], a[140:143], v[140:143]
v_mul_f32 v210, v210, v89
v_mul_f32 v209, v88, v104
v_mfma_f32_16x16x32_bf16 v[140:143], v[60:63], a[156:159], v[140:143]
v_mul_f32 v211, v89, v105
s_waitcnt lgkmcnt(4)
v_mfma_f32_16x16x32_bf16 v[112:115], v[64:67], a[160:163], v[112:115]
buffer_load_dwordx4 a[44:47], v6, s[8:11], s27 offen offset:0 sc1
v_mfma_f32_16x16x32_bf16 v[112:115], v[68:71], a[176:179], v[112:115]
v_exp_f32 v208, v208
v_mfma_f32_16x16x32_bf16 v[116:119], v[64:67], a[164:167], v[116:119]
ds_read_b128 v[56:59], v7 offset:59392
v_fma_f32 v208, v208, v242, v242
v_mfma_f32_16x16x32_bf16 v[116:119], v[68:71], a[180:183], v[116:119]
v_exp_f32 v210, v210
v_mfma_f32_16x16x32_bf16 v[120:123], v[64:67], a[168:171], v[120:123]
v_fma_f32 v210, v210, v242, v242
v_mul_f32 v212, v90, v90
v_mfma_f32_16x16x32_bf16 v[120:123], v[68:71], a[184:187], v[120:123]
ds_read_b128 v[60:63], v7 offset:60416
v_mul_f32 v214, v91, v91
v_mfma_f32_16x16x32_bf16 v[124:127], v[64:67], a[172:175], v[124:127]
buffer_load_dwordx4 a[48:51], v2, s[8:11], s25 offen offset:1024 sc1
v_mfma_f32_16x16x32_bf16 v[124:127], v[68:71], a[188:191], v[124:127]
v_fma_f32 v212, v212, v241, v240
s_waitcnt lgkmcnt(4)
v_mfma_f32_16x16x32_bf16 v[128:131], v[72:75], a[160:163], v[128:131]
v_rcp_f32 v208, v208
v_mfma_f32_16x16x32_bf16 v[128:131], v[76:79], a[176:179], v[128:131]
v_rcp_f32 v210, v210
v_mfma_f32_16x16x32_bf16 v[132:135], v[72:75], a[164:167], v[132:135]
ds_read_b128 v[64:67], v7 offset:61440
v_mul_f32 v209, v209, v208
v_mfma_f32_16x16x32_bf16 v[132:135], v[76:79], a[180:183], v[132:135]
buffer_load_dwordx4 a[52:55], v4, s[8:11], s25 offen offset:1024 sc1
v_mfma_f32_16x16x32_bf16 v[136:139], v[72:75], a[168:171], v[136:139]
v_mul_f32 v211, v211, v210
v_cvt_pk_bf16_f32 v200, v209, v211
v_mfma_f32_16x16x32_bf16 v[136:139], v[76:79], a[184:187], v[136:139]
ds_read_b128 v[68:71], v7 offset:62464
v_fma_f32 v214, v214, v241, v240
v_mfma_f32_16x16x32_bf16 v[140:143], v[72:75], a[172:175], v[140:143]
v_mul_f32 v212, v212, v90
v_mul_f32 v214, v214, v91
v_mfma_f32_16x16x32_bf16 v[140:143], v[76:79], a[188:191], v[140:143]
v_mul_f32 v213, v90, v106
s_waitcnt lgkmcnt(4)
v_mfma_f32_16x16x32_bf16 v[112:115], v[48:51], a[192:195], v[112:115]
buffer_load_dwordx4 a[56:59], v5, s[8:11], s25 offen offset:1024 sc1
v_mfma_f32_16x16x32_bf16 v[112:115], v[52:55], a[208:211], v[112:115]
v_exp_f32 v212, v212
v_mfma_f32_16x16x32_bf16 v[116:119], v[48:51], a[196:199], v[116:119]
ds_read_b128 v[72:75], v7 offset:63488
v_mul_f32 v215, v91, v107
v_mfma_f32_16x16x32_bf16 v[116:119], v[52:55], a[212:215], v[116:119]
v_exp_f32 v214, v214
v_mfma_f32_16x16x32_bf16 v[120:123], v[48:51], a[200:203], v[120:123]
v_fma_f32 v212, v212, v242, v242
v_fma_f32 v214, v214, v242, v242
v_mfma_f32_16x16x32_bf16 v[120:123], v[52:55], a[216:219], v[120:123]
ds_read_b128 v[76:79], v7 offset:64512
v_mul_f32 v208, v92, v92
v_mfma_f32_16x16x32_bf16 v[124:127], v[48:51], a[204:207], v[124:127]
buffer_load_dwordx4 a[60:63], v6, s[8:11], s25 offen offset:1024 sc1
v_mfma_f32_16x16x32_bf16 v[124:127], v[52:55], a[220:223], v[124:127]
v_mul_f32 v210, v93, v93
s_waitcnt lgkmcnt(4)
v_mfma_f32_16x16x32_bf16 v[128:131], v[56:59], a[192:195], v[128:131]
v_rcp_f32 v212, v212
v_mfma_f32_16x16x32_bf16 v[128:131], v[60:63], a[208:211], v[128:131]
v_rcp_f32 v214, v214
v_mfma_f32_16x16x32_bf16 v[132:135], v[56:59], a[196:199], v[132:135]
ds_read_b128 v[48:51], v8 offset:0
v_mul_f32 v213, v213, v212
v_mfma_f32_16x16x32_bf16 v[132:135], v[60:63], a[212:215], v[132:135]
buffer_load_dwordx4 a[64:67], v2, s[8:11], s26 offen offset:1024 sc1
v_mfma_f32_16x16x32_bf16 v[136:139], v[56:59], a[200:203], v[136:139]
v_mul_f32 v215, v215, v214
v_cvt_pk_bf16_f32 v201, v213, v215
v_mfma_f32_16x16x32_bf16 v[136:139], v[60:63], a[216:219], v[136:139]
ds_read_b128 v[52:55], v8 offset:1024
v_fma_f32 v208, v208, v245, v244
v_mfma_f32_16x16x32_bf16 v[140:143], v[56:59], a[204:207], v[140:143]
v_fma_f32 v210, v210, v245, v244
v_mul_f32 v208, v208, v92
v_mfma_f32_16x16x32_bf16 v[140:143], v[60:63], a[220:223], v[140:143]
v_mul_f32 v210, v210, v93
s_waitcnt lgkmcnt(4)
v_mfma_f32_16x16x32_bf16 v[112:115], v[64:67], a[224:227], v[112:115]
buffer_load_dwordx4 a[68:71], v4, s[8:11], s26 offen offset:1024 sc1
v_mfma_f32_16x16x32_bf16 v[112:115], v[68:71], a[240:243], v[112:115]
v_exp_f32 v208, v208
v_mfma_f32_16x16x32_bf16 v[116:119], v[64:67], a[228:231], v[116:119]
ds_read_b128 v[56:59], v8 offset:2048
v_mul_f32 v209, v92, v108
v_mfma_f32_16x16x32_bf16 v[116:119], v[68:71], a[244:247], v[116:119]
v_exp_f32 v210, v210
v_mfma_f32_16x16x32_bf16 v[120:123], v[64:67], a[232:235], v[120:123]
v_mul_f32 v211, v93, v109
v_fma_f32 v208, v208, v246, v246
v_mfma_f32_16x16x32_bf16 v[120:123], v[68:71], a[248:251], v[120:123]
ds_read_b128 v[60:63], v8 offset:3072
v_fma_f32 v210, v210, v246, v246
v_mfma_f32_16x16x32_bf16 v[124:127], v[64:67], a[236:239], v[124:127]
buffer_load_dwordx4 a[72:75], v5, s[8:11], s26 offen offset:1024 sc1
v_mfma_f32_16x16x32_bf16 v[124:127], v[68:71], a[252:255], v[124:127]
v_mul_f32 v212, v94, v94
s_waitcnt lgkmcnt(4)
v_mfma_f32_16x16x32_bf16 v[128:131], v[72:75], a[224:227], v[128:131]
v_rcp_f32 v208, v208
v_mfma_f32_16x16x32_bf16 v[128:131], v[76:79], a[240:243], v[128:131]
v_rcp_f32 v210, v210
v_mfma_f32_16x16x32_bf16 v[132:135], v[72:75], a[228:231], v[132:135]
ds_read_b128 v[64:67], v8 offset:4096
v_mul_f32 v209, v209, v208
v_mfma_f32_16x16x32_bf16 v[132:135], v[76:79], a[244:247], v[132:135]
buffer_load_dwordx4 a[76:79], v6, s[8:11], s26 offen offset:1024 sc1
v_mfma_f32_16x16x32_bf16 v[136:139], v[72:75], a[232:235], v[136:139]
v_mul_f32 v211, v211, v210
v_cvt_pk_bf16_f32 v204, v209, v211
v_mfma_f32_16x16x32_bf16 v[136:139], v[76:79], a[248:251], v[136:139]
ds_read_b128 v[68:71], v8 offset:5120
v_mul_f32 v214, v95, v95
v_mfma_f32_16x16x32_bf16 v[140:143], v[72:75], a[236:239], v[140:143]
v_fma_f32 v212, v212, v245, v244
v_fma_f32 v214, v214, v245, v244
v_mfma_f32_16x16x32_bf16 v[140:143], v[76:79], a[252:255], v[140:143]
v_mul_f32 v212, v212, v94
s_waitcnt lgkmcnt(4)
v_mfma_f32_16x16x32_bf16 v[112:115], v[48:51], v[16:19], v[112:115]
s_add_u32 s23, s34, 131072
v_mul_f32 v214, v214, v95
v_mfma_f32_16x16x32_bf16 v[112:115], v[52:55], v[32:35], v[112:115]
buffer_load_dwordx2 v[14:15], v11, s[8:11], s23 offen sc1
v_mfma_f32_16x16x32_bf16 v[116:119], v[48:51], v[20:23], v[116:119]
ds_read_b128 v[72:75], v8 offset:6144
v_mul_f32 v213, v94, v110
v_mfma_f32_16x16x32_bf16 v[116:119], v[52:55], v[36:39], v[116:119]
v_exp_f32 v212, v212
v_mfma_f32_16x16x32_bf16 v[120:123], v[48:51], v[24:27], v[120:123]
v_exp_f32 v214, v214
v_mfma_f32_16x16x32_bf16 v[120:123], v[52:55], v[40:43], v[120:123]
ds_read_b128 v[76:79], v8 offset:7168
v_mul_f32 v215, v95, v111
v_mfma_f32_16x16x32_bf16 v[124:127], v[48:51], v[28:31], v[124:127]
buffer_load_dwordx4 a[80:83], v2, s[8:11], s27 offen offset:1024 sc1
v_mfma_f32_16x16x32_bf16 v[124:127], v[52:55], v[44:47], v[124:127]
v_fma_f32 v212, v212, v246, v246
s_waitcnt lgkmcnt(4)
v_mfma_f32_16x16x32_bf16 v[128:131], v[56:59], v[16:19], v[128:131]
v_fma_f32 v214, v214, v246, v246
v_mfma_f32_16x16x32_bf16 v[128:131], v[60:63], v[32:35], v[128:131]
v_rcp_f32 v212, v212
v_mfma_f32_16x16x32_bf16 v[132:135], v[56:59], v[20:23], v[132:135]
ds_read_b128 v[48:51], v8 offset:8192
v_mul_f32 v213, v213, v212
v_mfma_f32_16x16x32_bf16 v[132:135], v[60:63], v[36:39], v[132:135]
buffer_load_dwordx4 a[84:87], v4, s[8:11], s27 offen offset:1024 sc1
v_mfma_f32_16x16x32_bf16 v[136:139], v[56:59], v[24:27], v[136:139]
v_rcp_f32 v214, v214
v_mfma_f32_16x16x32_bf16 v[136:139], v[60:63], v[40:43], v[136:139]
ds_read_b128 v[52:55], v8 offset:9216
v_mul_f32 v215, v215, v214
v_mfma_f32_16x16x32_bf16 v[140:143], v[56:59], v[28:31], v[140:143]
v_cvt_pk_bf16_f32 v205, v213, v215
v_mfma_f32_16x16x32_bf16 v[140:143], v[60:63], v[44:47], v[140:143]
s_waitcnt lgkmcnt(4)
v_mfma_f32_16x16x32_bf16 a[112:115], v[64:67], v[144:147], 0
v_mfma_f32_16x16x32_bf16 a[112:115], v[68:71], v[160:163], a[112:115]
v_mfma_f32_16x16x32_bf16 a[116:119], v[64:67], v[148:151], 0
ds_read_b128 v[56:59], v8 offset:10240
v_mfma_f32_16x16x32_bf16 a[116:119], v[68:71], v[164:167], a[116:119]
v_mul_f32 v208, v112, v112
v_mul_f32 v210, v113, v113
v_mfma_f32_16x16x32_bf16 a[120:123], v[64:67], v[152:155], 0
v_fma_f32 v208, v208, v233, v232
v_fma_f32 v210, v210, v233, v232
v_mfma_f32_16x16x32_bf16 a[120:123], v[68:71], v[168:171], a[120:123]
ds_read_b128 v[60:63], v8 offset:11264
v_mul_f32 v208, v208, v112
v_mfma_f32_16x16x32_bf16 a[124:127], v[64:67], v[156:159], 0
v_mul_f32 v210, v210, v113
v_mul_f32 v209, v112, v128
v_mfma_f32_16x16x32_bf16 a[124:127], v[68:71], v[172:175], a[124:127]
v_mul_f32 v211, v113, v129
s_waitcnt lgkmcnt(4)
v_mfma_f32_16x16x32_bf16 a[128:131], v[72:75], v[144:147], 0
v_exp_f32 v208, v208
v_mfma_f32_16x16x32_bf16 a[128:131], v[76:79], v[160:163], a[128:131]
v_exp_f32 v210, v210
v_mfma_f32_16x16x32_bf16 a[132:135], v[72:75], v[148:151], 0
ds_read_b128 v[64:67], v8 offset:12288
v_fma_f32 v208, v208, v234, v234
v_mfma_f32_16x16x32_bf16 a[132:135], v[76:79], v[164:167], a[132:135]
v_fma_f32 v210, v210, v234, v234
v_mul_f32 v212, v114, v114
v_mfma_f32_16x16x32_bf16 a[136:139], v[72:75], v[152:155], 0
v_rcp_f32 v208, v208
v_mfma_f32_16x16x32_bf16 a[136:139], v[76:79], v[168:171], a[136:139]
ds_read_b128 v[68:71], v8 offset:13312
v_mul_f32 v209, v209, v208
v_mfma_f32_16x16x32_bf16 a[140:143], v[72:75], v[156:159], 0
v_rcp_f32 v210, v210
v_mfma_f32_16x16x32_bf16 a[140:143], v[76:79], v[172:175], a[140:143]
v_mul_f32 v211, v211, v210
s_waitcnt lgkmcnt(4)
v_mfma_f32_16x16x32_bf16 a[144:147], v[48:51], v[144:147], 0
v_cvt_pk_bf16_f32 v194, v209, v211
v_mul_f32 v214, v115, v115
v_mfma_f32_16x16x32_bf16 a[144:147], v[52:55], v[160:163], a[144:147]
v_fma_f32 v212, v212, v233, v232
v_fma_f32 v214, v214, v233, v232
v_mfma_f32_16x16x32_bf16 a[148:151], v[48:51], v[148:151], 0
ds_read_b128 v[72:75], v8 offset:14336
v_mul_f32 v212, v212, v114
v_mfma_f32_16x16x32_bf16 a[148:151], v[52:55], v[164:167], a[148:151]
v_mul_f32 v214, v214, v115
v_mul_f32 v213, v114, v130
v_mfma_f32_16x16x32_bf16 a[152:155], v[48:51], v[152:155], 0
v_exp_f32 v212, v212
v_mfma_f32_16x16x32_bf16 a[152:155], v[52:55], v[168:171], a[152:155]
ds_read_b128 v[76:79], v8 offset:15360
v_mul_f32 v215, v115, v131
v_mfma_f32_16x16x32_bf16 a[156:159], v[48:51], v[156:159], 0
v_exp_f32 v214, v214
v_mfma_f32_16x16x32_bf16 a[156:159], v[52:55], v[172:175], a[156:159]
v_fma_f32 v212, v212, v234, v234
s_waitcnt lgkmcnt(4)
v_mfma_f32_16x16x32_bf16 a[160:163], v[56:59], v[144:147], 0
s_waitcnt vmcnt(42)
v_fma_f32 v214, v214, v234, v234
v_mfma_f32_16x16x32_bf16 a[160:163], v[60:63], v[160:163], a[160:163]
s_barrier
v_mfma_f32_16x16x32_bf16 a[164:167], v[56:59], v[148:151], 0
ds_read_b128 v[48:51], v2 offset:0
v_mul_f32 v208, v116, v116
v_mfma_f32_16x16x32_bf16 a[164:167], v[60:63], v[164:167], a[164:167]
v_rcp_f32 v212, v212
v_mfma_f32_16x16x32_bf16 a[168:171], v[56:59], v[152:155], 0
v_rcp_f32 v214, v214
v_mfma_f32_16x16x32_bf16 a[168:171], v[60:63], v[168:171], a[168:171]
ds_read_b128 v[52:55], v2 offset:1024
v_mul_f32 v213, v213, v212
v_mfma_f32_16x16x32_bf16 a[172:175], v[56:59], v[156:159], 0
v_mul_f32 v215, v215, v214
v_cvt_pk_bf16_f32 v195, v213, v215
v_mfma_f32_16x16x32_bf16 a[172:175], v[60:63], v[172:175], a[172:175]
v_mul_f32 v210, v117, v117
s_waitcnt lgkmcnt(4)
v_mfma_f32_16x16x32_bf16 a[176:179], v[64:67], v[144:147], 0
buffer_store_dwordx4 v[192:195], v2, s[8:11], s24 offen offset:3072 sc1
v_mfma_f32_16x16x32_bf16 a[176:179], v[68:71], v[160:163], a[176:179]
v_fma_f32 v208, v208, v237, v236
v_fma_f32 v210, v210, v237, v236
v_mfma_f32_16x16x32_bf16 a[180:183], v[64:67], v[148:151], 0
ds_read_b128 v[56:59], v2 offset:2048
v_mul_f32 v208, v208, v116
v_mfma_f32_16x16x32_bf16 a[180:183], v[68:71], v[164:167], a[180:183]
v_mul_f32 v210, v210, v117
v_mul_f32 v209, v116, v132
v_mfma_f32_16x16x32_bf16 a[184:187], v[64:67], v[152:155], 0
v_exp_f32 v208, v208
v_mfma_f32_16x16x32_bf16 a[184:187], v[68:71], v[168:171], a[184:187]
ds_read_b128 v[60:63], v2 offset:3072
v_mul_f32 v211, v117, v133
v_mfma_f32_16x16x32_bf16 a[188:191], v[64:67], v[156:159], 0
v_exp_f32 v210, v210
v_mfma_f32_16x16x32_bf16 a[188:191], v[68:71], v[172:175], a[188:191]
v_fma_f32 v208, v208, v238, v238
s_waitcnt lgkmcnt(4)
v_mfma_f32_16x16x32_bf16 a[192:195], v[72:75], v[144:147], 0
v_fma_f32 v210, v210, v238, v238
v_rcp_f32 v208, v208
v_mfma_f32_16x16x32_bf16 a[192:195], v[76:79], v[160:163], a[192:195]
v_rcp_f32 v210, v210
v_mfma_f32_16x16x32_bf16 a[196:199], v[72:75], v[148:151], 0
ds_read_b128 v[64:67], v2 offset:4096
v_mul_f32 v209, v209, v208
v_mfma_f32_16x16x32_bf16 a[196:199], v[76:79], v[164:167], a[196:199]
v_mul_f32 v211, v211, v210
v_cvt_pk_bf16_f32 v198, v209, v211
v_mfma_f32_16x16x32_bf16 a[200:203], v[72:75], v[152:155], 0
v_mul_f32 v212, v118, v118
v_mul_f32 v214, v119, v119
v_mfma_f32_16x16x32_bf16 a[200:203], v[76:79], v[168:171], a[200:203]
ds_read_b128 v[68:71], v2 offset:5120
v_fma_f32 v212, v212, v237, v236
v_mfma_f32_16x16x32_bf16 a[204:207], v[72:75], v[156:159], 0
v_fma_f32 v214, v214, v237, v236
v_mul_f32 v212, v212, v118
v_mfma_f32_16x16x32_bf16 a[204:207], v[76:79], v[172:175], a[204:207]
v_mul_f32 v214, v214, v119
s_waitcnt lgkmcnt(4)
v_mfma_f32_16x16x32_bf16 a[208:211], v[48:51], v[144:147], 0
v_exp_f32 v212, v212
v_mfma_f32_16x16x32_bf16 a[208:211], v[52:55], v[160:163], a[208:211]
v_exp_f32 v214, v214
v_mfma_f32_16x16x32_bf16 a[212:215], v[48:51], v[148:151], 0
ds_read_b128 v[72:75], v2 offset:6144
v_mul_f32 v213, v118, v134
v_mfma_f32_16x16x32_bf16 a[212:215], v[52:55], v[164:167], a[212:215]
v_mul_f32 v215, v119, v135
v_fma_f32 v212, v212, v238, v238
v_mfma_f32_16x16x32_bf16 a[216:219], v[48:51], v[152:155], 0
v_fma_f32 v214, v214, v238, v238
v_rcp_f32 v212, v212
v_mfma_f32_16x16x32_bf16 a[216:219], v[52:55], v[168:171], a[216:219]
ds_read_b128 v[76:79], v2 offset:7168
v_rcp_f32 v214, v214
v_mfma_f32_16x16x32_bf16 a[220:223], v[48:51], v[156:159], 0
v_mul_f32 v213, v213, v212
v_mul_f32 v215, v215, v214
v_mfma_f32_16x16x32_bf16 a[220:223], v[52:55], v[172:175], a[220:223]
v_cvt_pk_bf16_f32 v199, v213, v215
s_waitcnt lgkmcnt(4)
v_mfma_f32_16x16x32_bf16 a[224:227], v[56:59], v[144:147], 0
buffer_store_dwordx4 v[196:199], v4, s[8:11], s24 offen offset:3072 sc1
v_mfma_f32_16x16x32_bf16 a[224:227], v[60:63], v[160:163], a[224:227]
v_mul_f32 v208, v120, v120
v_mul_f32 v210, v121, v121
v_mfma_f32_16x16x32_bf16 a[228:231], v[56:59], v[148:151], 0
ds_read_b128 v[48:51], v2 offset:8192
v_fma_f32 v208, v208, v241, v240
v_mfma_f32_16x16x32_bf16 a[228:231], v[60:63], v[164:167], a[228:231]
v_fma_f32 v210, v210, v241, v240
v_mul_f32 v208, v208, v120
v_mfma_f32_16x16x32_bf16 a[232:235], v[56:59], v[152:155], 0
v_mul_f32 v210, v210, v121
v_exp_f32 v208, v208
v_mfma_f32_16x16x32_bf16 a[232:235], v[60:63], v[168:171], a[232:235]
ds_read_b128 v[52:55], v2 offset:9216
v_exp_f32 v210, v210
v_mfma_f32_16x16x32_bf16 a[236:239], v[56:59], v[156:159], 0
v_mul_f32 v209, v120, v136
v_mul_f32 v211, v121, v137
v_mfma_f32_16x16x32_bf16 a[236:239], v[60:63], v[172:175], a[236:239]
v_fma_f32 v208, v208, v242, v242
s_waitcnt vmcnt(22)
s_waitcnt lgkmcnt(4)
v_mfma_f32_16x16x32_bf16 a[112:115], v[64:67], v[176:179], a[112:115]
v_fma_f32 v210, v210, v242, v242
v_rcp_f32 v208, v208
v_mfma_f32_16x16x32_bf16 a[112:115], v[68:71], a[0:3], a[112:115]
v_rcp_f32 v210, v210
v_mfma_f32_16x16x32_bf16 a[116:119], v[64:67], v[180:183], a[116:119]
ds_read_b128 v[56:59], v2 offset:10240
v_mul_f32 v209, v209, v208
v_mfma_f32_16x16x32_bf16 a[116:119], v[68:71], a[4:7], a[116:119]
v_mul_f32 v211, v211, v210
v_cvt_pk_bf16_f32 v202, v209, v211
v_mfma_f32_16x16x32_bf16 a[120:123], v[64:67], v[184:187], a[120:123]
v_mul_f32 v212, v122, v122
v_mul_f32 v214, v123, v123
v_mfma_f32_16x16x32_bf16 a[120:123], v[68:71], a[8:11], a[120:123]
ds_read_b128 v[60:63], v2 offset:11264
v_fma_f32 v212, v212, v241, v240
v_mfma_f32_16x16x32_bf16 a[124:127], v[64:67], v[188:191], a[124:127]
v_fma_f32 v214, v214, v241, v240
v_mul_f32 v212, v212, v122
v_mfma_f32_16x16x32_bf16 a[124:127], v[68:71], a[12:15], a[124:127]
v_mul_f32 v214, v214, v123
s_waitcnt lgkmcnt(4)
v_mfma_f32_16x16x32_bf16 a[128:131], v[72:75], v[176:179], a[128:131]
s_waitcnt vmcnt(4)
v_cmp_eq_u64 vcc, s[68:69], v[14:15]
s_nop 0
s_cmp_eq_u64 vcc, exec
s_cbranch_scc0 L_f_slow2
L_f_back2:
v_exp_f32 v212, v212
v_mfma_f32_16x16x32_bf16 a[128:131], v[76:79], a[0:3], a[128:131]
v_exp_f32 v214, v214
v_mfma_f32_16x16x32_bf16 a[132:135], v[72:75], v[180:183], a[132:135]
ds_read_b128 v[64:67], v2 offset:12288
v_mul_f32 v213, v122, v138
v_mfma_f32_16x16x32_bf16 a[132:135], v[76:79], a[4:7], a[132:135]
v_mul_f32 v215, v123, v139
v_fma_f32 v212, v212, v242, v242
v_mfma_f32_16x16x32_bf16 a[136:139], v[72:75], v[184:187], a[136:139]
v_fma_f32 v214, v214, v242, v242
v_rcp_f32 v212, v212
v_mfma_f32_16x16x32_bf16 a[136:139], v[76:79], a[8:11], a[136:139]
ds_read_b128 v[68:71], v2 offset:13312
v_rcp_f32 v214, v214
v_mfma_f32_16x16x32_bf16 a[140:143], v[72:75], v[188:191], a[140:143]
v_mul_f32 v213, v213, v212
v_mul_f32 v215, v215, v214
v_mfma_f32_16x16x32_bf16 a[140:143], v[76:79], a[12:15], a[140:143]
v_cvt_pk_bf16_f32 v203, v213, v215
s_waitcnt lgkmcnt(4)
v_mfma_f32_16x16x32_bf16 a[144:147], v[48:51], v[176:179], a[144:147]
buffer_store_dwordx4 v[200:203], v5, s[8:11], s24 offen offset:3072 sc1
v_mfma_f32_16x16x32_bf16 a[144:147], v[52:55], a[0:3], a[144:147]
v_mul_f32 v208, v124, v124
v_mul_f32 v210, v125, v125
v_mfma_f32_16x16x32_bf16 a[148:151], v[48:51], v[180:183], a[148:151]
ds_read_b128 v[72:75], v2 offset:14336
v_fma_f32 v208, v208, v245, v244
v_mfma_f32_16x16x32_bf16 a[148:151], v[52:55], a[4:7], a[148:151]
v_fma_f32 v210, v210, v245, v244
v_mul_f32 v208, v208, v124
v_mfma_f32_16x16x32_bf16 a[152:155], v[48:51], v[184:187], a[152:155]
v_mul_f32 v210, v210, v125
v_exp_f32 v208, v208
v_mfma_f32_16x16x32_bf16 a[152:155], v[52:55], a[8:11], a[152:155]
ds_read_b128 v[76:79], v2 offset:15360
v_exp_f32 v210, v210
v_mfma_f32_16x16x32_bf16 a[156:159], v[48:51], v[188:191], a[156:159]
v_mul_f32 v209, v124, v140
v_mul_f32 v211, v125, v141
v_mfma_f32_16x16x32_bf16 a[156:159], v[52:55], a[12:15], a[156:159]
v_fma_f32 v208, v208, v246, v246
s_waitcnt lgkmcnt(4)
v_mfma_f32_16x16x32_bf16 a[160:163], v[56:59], v[176:179], a[160:163]
v_fma_f32 v210, v210, v246, v246
v_rcp_f32 v208, v208
v_mfma_f32_16x16x32_bf16 a[160:163], v[60:63], a[0:3], a[160:163]
v_rcp_f32 v210, v210
v_mfma_f32_16x16x32_bf16 a[164:167], v[56:59], v[180:183], a[164:167]
ds_read_b128 v[48:51], v2 offset:16384
v_mul_f32 v209, v209, v208
v_mfma_f32_16x16x32_bf16 a[164:167], v[60:63], a[4:7], a[164:167]
v_mul_f32 v211, v211, v210
v_cvt_pk_bf16_f32 v206, v209, v211
v_mfma_f32_16x16x32_bf16 a[168:171], v[56:59], v[184:187], a[168:171]
v_mul_f32 v212, v126, v126
v_mul_f32 v214, v127, v127
v_mfma_f32_16x16x32_bf16 a[168:171], v[60:63], a[8:11], a[168:171]
ds_read_b128 v[52:55], v2 offset:17408
v_fma_f32 v212, v212, v245, v244
v_mfma_f32_16x16x32_bf16 a[172:175], v[56:59], v[188:191], a[172:175]
v_fma_f32 v214, v214, v245, v244
v_mul_f32 v212, v212, v126
v_mfma_f32_16x16x32_bf16 a[172:175], v[60:63], a[12:15], a[172:175]
v_mul_f32 v214, v214, v127
s_waitcnt lgkmcnt(4)
v_mfma_f32_16x16x32_bf16 a[176:179], v[64:67], v[176:179], a[176:179]
v_exp_f32 v212, v212
v_mfma_f32_16x16x32_bf16 a[176:179], v[68:71], a[0:3], a[176:179]
v_exp_f32 v214, v214
v_mfma_f32_16x16x32_bf16 a[180:183], v[64:67], v[180:183], a[180:183]
ds_read_b128 v[56:59], v2 offset:18432
v_mul_f32 v213, v126, v142
v_mfma_f32_16x16x32_bf16 a[180:183], v[68:71], a[4:7], a[180:183]
v_mul_f32 v215, v127, v143
v_fma_f32 v212, v212, v246, v246
v_mfma_f32_16x16x32_bf16 a[184:187], v[64:67], v[184:187], a[184:187]
v_fma_f32 v214, v214, v246, v246
v_rcp_f32 v212, v212
v_mfma_f32_16x16x32_bf16 a[184:187], v[68:71], a[8:11], a[184:187]
ds_read_b128 v[60:63], v2 offset:19456
v_rcp_f32 v214, v214
v_mfma_f32_16x16x32_bf16 a[188:191], v[64:67], v[188:191], a[188:191]
v_mul_f32 v213, v213, v212
v_mul_f32 v215, v215, v214
v_mfma_f32_16x16x32_bf16 a[188:191], v[68:71], a[12:15], a[188:191]
v_cvt_pk_bf16_f32 v207, v213, v215
buffer_store_dwordx4 v[204:207], v6, s[8:11], s24 offen offset:3072 sc1
s_waitcnt lgkmcnt(4)
v_mfma_f32_16x16x32_bf16 a[192:195], v[72:75], v[176:179], a[192:195]
buffer_load_dwordx4 a[88:91], v5, s[8:11], s27 offen offset:1024 sc1
v_mfma_f32_16x16x32_bf16 a[192:195], v[76:79], a[0:3], a[192:195]
v_mfma_f32_16x16x32_bf16 a[196:199], v[72:75], v[180:183], a[196:199]
ds_read_b128 v[64:67], v2 offset:20480
v_mfma_f32_16x16x32_bf16 a[196:199], v[76:79], a[4:7], a[196:199]
v_mfma_f32_16x16x32_bf16 a[200:203], v[72:75], v[184:187], a[200:203]
v_mfma_f32_16x16x32_bf16 a[200:203], v[76:79], a[8:11], a[200:203]
ds_read_b128 v[68:71], v2 offset:21504
v_mfma_f32_16x16x32_bf16 a[204:207], v[72:75], v[188:191], a[204:207]
buffer_load_dwordx4 a[92:95], v6, s[8:11], s27 offen offset:1024 sc1
v_mfma_f32_16x16x32_bf16 a[204:207], v[76:79], a[12:15], a[204:207]
s_waitcnt lgkmcnt(4)
v_mfma_f32_16x16x32_bf16 a[208:211], v[48:51], v[176:179], a[208:211]
v_mfma_f32_16x16x32_bf16 a[208:211], v[52:55], a[0:3], a[208:211]
v_mfma_f32_16x16x32_bf16 a[212:215], v[48:51], v[180:183], a[212:215]
ds_read_b128 v[72:75], v2 offset:22528
v_mfma_f32_16x16x32_bf16 a[212:215], v[52:55], a[4:7], a[212:215]
buffer_load_dwordx2 a[96:97], v248, s[8:11], s28 offen offset:0 sc1
v_mfma_f32_16x16x32_bf16 a[216:219], v[48:51], v[184:187], a[216:219]
v_mfma_f32_16x16x32_bf16 a[216:219], v[52:55], a[8:11], a[216:219]
ds_read_b128 v[76:79], v2 offset:23552
v_mfma_f32_16x16x32_bf16 a[220:223], v[48:51], v[188:191], a[220:223]
v_mfma_f32_16x16x32_bf16 a[220:223], v[52:55], a[12:15], a[220:223]
s_waitcnt lgkmcnt(4)
v_mfma_f32_16x16x32_bf16 a[224:227], v[56:59], v[176:179], a[224:227]
s_waitcnt vmcnt(40)
v_mfma_f32_16x16x32_bf16 a[224:227], v[60:63], a[0:3], a[224:227]
s_barrier
v_mfma_f32_16x16x32_bf16 a[228:231], v[56:59], v[180:183], a[228:231]
ds_read_b128 v[48:51], v2 offset:24576
buffer_load_dwordx2 a[98:99], v248, s[8:11], s28 offen offset:512 sc1
v_mfma_f32_16x16x32_bf16 a[228:231], v[60:63], a[4:7], a[228:231]
v_mfma_f32_16x16x32_bf16 a[232:235], v[56:59], v[184:187], a[232:235]
v_mfma_f32_16x16x32_bf16 a[232:235], v[60:63], a[8:11], a[232:235]
ds_read_b128 v[52:55], v2 offset:25600
v_mfma_f32_16x16x32_bf16 a[236:239], v[56:59], v[188:191], a[236:239]
v_mfma_f32_16x16x32_bf16 a[236:239], v[60:63], a[12:15], a[236:239]
s_waitcnt vmcnt(19)
s_waitcnt lgkmcnt(4)
v_mfma_f32_16x16x32_bf16 a[112:115], v[64:67], a[16:19], a[112:115]
buffer_load_dwordx2 a[100:101], v249, s[8:11], s28 offen offset:0 sc1
v_mfma_f32_16x16x32_bf16 a[112:115], v[68:71], a[32:35], a[112:115]
v_mfma_f32_16x16x32_bf16 a[116:119], v[64:67], a[20:23], a[116:119]
ds_read_b128 v[56:59], v2 offset:26624
v_mfma_f32_16x16x32_bf16 a[116:119], v[68:71], a[36:39], a[116:119]
v_mfma_f32_16x16x32_bf16 a[120:123], v[64:67], a[24:27], a[120:123]
v_mfma_f32_16x16x32_bf16 a[120:123], v[68:71], a[40:43], a[120:123]
ds_read_b128 v[60:63], v2 offset:27648
v_mfma_f32_16x16x32_bf16 a[124:127], v[64:67], a[28:31], a[124:127]
buffer_load_dwordx2 a[102:103], v249, s[8:11], s28 offen offset:512 sc1
v_mfma_f32_16x16x32_bf16 a[124:127], v[68:71], a[44:47], a[124:127]
s_waitcnt lgkmcnt(4)
v_mfma_f32_16x16x32_bf16 a[128:131], v[72:75], a[16:19], a[128:131]
v_mfma_f32_16x16x32_bf16 a[128:131], v[76:79], a[32:35], a[128:131]
v_mfma_f32_16x16x32_bf16 a[132:135], v[72:75], a[20:23], a[132:135]
ds_read_b128 v[64:67], v2 offset:28672
v_mfma_f32_16x16x32_bf16 a[132:135], v[76:79], a[36:39], a[132:135]
buffer_load_dwordx2 a[104:105], v250, s[8:11], s28 offen offset:0 sc1
v_mfma_f32_16x16x32_bf16 a[136:139], v[72:75], a[24:27], a[136:139]
v_mfma_f32_16x16x32_bf16 a[136:139], v[76:79], a[40:43], a[136:139]
ds_read_b128 v[68:71], v2 offset:29696
v_mfma_f32_16x16x32_bf16 a[140:143], v[72:75], a[28:31], a[140:143]
v_mfma_f32_16x16x32_bf16 a[140:143], v[76:79], a[44:47], a[140:143]
s_waitcnt lgkmcnt(4)
v_mfma_f32_16x16x32_bf16 a[144:147], v[48:51], a[16:19], a[144:147]
buffer_load_dwordx2 a[106:107], v250, s[8:11], s28 offen offset:512 sc1
v_mfma_f32_16x16x32_bf16 a[144:147], v[52:55], a[32:35], a[144:147]
v_mfma_f32_16x16x32_bf16 a[148:151], v[48:51], a[20:23], a[148:151]
ds_read_b128 v[72:75], v2 offset:30720
v_mfma_f32_16x16x32_bf16 a[148:151], v[52:55], a[36:39], a[148:151]
v_mfma_f32_16x16x32_bf16 a[152:155], v[48:51], a[24:27], a[152:155]
buffer_load_dwordx2 a[108:109], v251, s[8:11], s28 offen offset:0 sc1
v_mfma_f32_16x16x32_bf16 a[152:155], v[52:55], a[40:43], a[152:155]
ds_read_b128 v[76:79], v2 offset:31744
v_mfma_f32_16x16x32_bf16 a[156:159], v[48:51], a[28:31], a[156:159]
v_mfma_f32_16x16x32_bf16 a[156:159], v[52:55], a[44:47], a[156:159]
s_waitcnt lgkmcnt(4)
v_mfma_f32_16x16x32_bf16 a[160:163], v[56:59], a[16:19], a[160:163]
buffer_load_dwordx2 a[110:111], v251, s[8:11], s28 offen offset:512 sc1
v_mfma_f32_16x16x32_bf16 a[160:163], v[60:63], a[32:35], a[160:163]
s_add_u32 m0, s22, 73728
v_add_u32 v3, 20480, v3
v_mfma_f32_16x16x32_bf16 a[164:167], v[56:59], a[20:23], a[164:167]
ds_read_b128 v[48:51], v2 offset:32768
v_mfma_f32_16x16x32_bf16 a[164:167], v[60:63], a[36:39], a[164:167]
v_mfma_f32_16x16x32_bf16 a[168:171], v[56:59], a[24:27], a[168:171]
v_mfma_f32_16x16x32_bf16 a[168:171], v[60:63], a[40:43], a[168:171]
ds_read_b128 v[52:55], v2 offset:33792
v_mfma_f32_16x16x32_bf16 a[172:175], v[56:59], a[28:31], a[172:175]
buffer_load_dwordx4 v3, s[8:11], 0 offen offset:0 sc1 lds
v_mfma_f32_16x16x32_bf16 a[172:175], v[60:63], a[44:47], a[172:175]
s_waitcnt lgkmcnt(4)
v_mfma_f32_16x16x32_bf16 a[176:179], v[64:67], a[16:19], a[176:179]
v_mov_b32 v12, s68
v_mov_b32 v13, s69
v_mfma_f32_16x16x32_bf16 a[176:179], v[68:71], a[32:35], a[176:179]
s_add_u32 s53, s34, 262144
s_waitcnt vmcnt(11)
v_mfma_f32_16x16x32_bf16 a[180:183], v[64:67], a[20:23], a[180:183]
ds_read_b128 v[56:59], v2 offset:34816
v_mfma_f32_16x16x32_bf16 a[180:183], v[68:71], a[36:39], a[180:183]
buffer_store_dwordx2 v[12:13], v10, s[8:11], s53 offen sc1
v_mfma_f32_16x16x32_bf16 a[184:187], v[64:67], a[24:27], a[184:187]
v_mfma_f32_16x16x32_bf16 a[184:187], v[68:71], a[40:43], a[184:187]
ds_read_b128 v[60:63], v2 offset:35840
v_mfma_f32_16x16x32_bf16 a[188:191], v[64:67], a[28:31], a[188:191]
v_mfma_f32_16x16x32_bf16 a[188:191], v[68:71], a[44:47], a[188:191]
s_waitcnt lgkmcnt(4)
v_mfma_f32_16x16x32_bf16 a[192:195], v[72:75], a[16:19], a[192:195]
buffer_load_dwordx4 v3, s[8:11], 0 offen offset:1024 sc1 lds
v_mfma_f32_16x16x32_bf16 a[192:195], v[76:79], a[32:35], a[192:195]
v_mfma_f32_16x16x32_bf16 a[196:199], v[72:75], a[20:23], a[196:199]
ds_read_b128 v[64:67], v2 offset:36864
v_mfma_f32_16x16x32_bf16 a[196:199], v[76:79], a[36:39], a[196:199]
v_mfma_f32_16x16x32_bf16 a[200:203], v[72:75], a[24:27], a[200:203]
v_mfma_f32_16x16x32_bf16 a[200:203], v[76:79], a[40:43], a[200:203]
ds_read_b128 v[68:71], v2 offset:37888
v_mfma_f32_16x16x32_bf16 a[204:207], v[72:75], a[28:31], a[204:207]
buffer_load_dwordx4 v3, s[8:11], 0 offen offset:2048 sc1 lds
v_mfma_f32_16x16x32_bf16 a[204:207], v[76:79], a[44:47], a[204:207]
s_waitcnt lgkmcnt(4)
v_mfma_f32_16x16x32_bf16 a[208:211], v[48:51], a[16:19], a[208:211]
v_mfma_f32_16x16x32_bf16 a[208:211], v[52:55], a[32:35], a[208:211]
v_mfma_f32_16x16x32_bf16 a[212:215], v[48:51], a[20:23], a[212:215]
ds_read_b128 v[72:75], v2 offset:38912
v_mfma_f32_16x16x32_bf16 a[212:215], v[52:55], a[36:39], a[212:215]
buffer_load_dwordx4 v3, s[8:11], 0 offen offset:3072 sc1 lds
v_mfma_f32_16x16x32_bf16 a[216:219], v[48:51], a[24:27], a[216:219]
s_add_u32 m0, s22, 77824
v_add_u32 v3, 4096, v3
v_mfma_f32_16x16x32_bf16 a[216:219], v[52:55], a[40:43], a[216:219]
ds_read_b128 v[76:79], v2 offset:39936
v_mfma_f32_16x16x32_bf16 a[220:223], v[48:51], a[28:31], a[220:223]
v_mfma_f32_16x16x32_bf16 a[220:223], v[52:55], a[44:47], a[220:223]
s_waitcnt lgkmcnt(4)
v_mfma_f32_16x16x32_bf16 a[224:227], v[56:59], a[16:19], a[224:227]
buffer_load_dwordx4 v3, s[8:11], 0 offen offset:0 sc1 lds
v_mfma_f32_16x16x32_bf16 a[224:227], v[60:63], a[32:35], a[224:227]
v_mfma_f32_16x16x32_bf16 a[228:231], v[56:59], a[20:23], a[228:231]
ds_read_b128 v[48:51], v2 offset:40960
v_mfma_f32_16x16x32_bf16 a[228:231], v[60:63], a[36:39], a[228:231]
v_mfma_f32_16x16x32_bf16 a[232:235], v[56:59], a[24:27], a[232:235]
v_mfma_f32_16x16x32_bf16 a[232:235], v[60:63], a[40:43], a[232:235]
ds_read_b128 v[52:55], v2 offset:41984
v_mfma_f32_16x16x32_bf16 a[236:239], v[56:59], a[28:31], a[236:239]
buffer_load_dwordx4 v3, s[8:11], 0 offen offset:1024 sc1 lds
v_mfma_f32_16x16x32_bf16 a[236:239], v[60:63], a[44:47], a[236:239]
s_waitcnt vmcnt(24)
s_waitcnt lgkmcnt(4)
v_mfma_f32_16x16x32_bf16 a[112:115], v[64:67], a[48:51], a[112:115]
v_mfma_f32_16x16x32_bf16 a[112:115], v[68:71], a[64:67], a[112:115]
v_mfma_f32_16x16x32_bf16 a[116:119], v[64:67], a[52:55], a[116:119]
ds_read_b128 v[56:59], v2 offset:43008
v_mfma_f32_16x16x32_bf16 a[116:119], v[68:71], a[68:71], a[116:119]
buffer_load_dwordx2 v[16:17], v248, s[8:11], s29 offen offset:0 sc1
v_mfma_f32_16x16x32_bf16 a[120:123], v[64:67], a[56:59], a[120:123]
v_mfma_f32_16x16x32_bf16 a[120:123], v[68:71], a[72:75], a[120:123]
ds_read_b128 v[60:63], v2 offset:44032
v_mfma_f32_16x16x32_bf16 a[124:127], v[64:67], a[60:63], a[124:127]
v_mfma_f32_16x16x32_bf16 a[124:127], v[68:71], a[76:79], a[124:127]
s_waitcnt lgkmcnt(4)
v_mfma_f32_16x16x32_bf16 a[128:131], v[72:75], a[48:51], a[128:131]
buffer_load_dwordx2 v[18:19], v248, s[8:11], s29 offen offset:512 sc1
v_mfma_f32_16x16x32_bf16 a[128:131], v[76:79], a[64:67], a[128:131]
v_mfma_f32_16x16x32_bf16 a[132:135], v[72:75], a[52:55], a[132:135]
ds_read_b128 v[64:67], v2 offset:45056
v_mfma_f32_16x16x32_bf16 a[132:135], v[76:79], a[68:71], a[132:135]
v_mfma_f32_16x16x32_bf16 a[136:139], v[72:75], a[56:59], a[136:139]
v_mfma_f32_16x16x32_bf16 a[136:139], v[76:79], a[72:75], a[136:139]
ds_read_b128 v[68:71], v2 offset:46080
v_mfma_f32_16x16x32_bf16 a[140:143], v[72:75], a[60:63], a[140:143]
buffer_load_dwordx2 v[20:21], v249, s[8:11], s29 offen offset:0 sc1
v_mfma_f32_16x16x32_bf16 a[140:143], v[76:79], a[76:79], a[140:143]
s_waitcnt lgkmcnt(4)
v_mfma_f32_16x16x32_bf16 a[144:147], v[48:51], a[48:51], a[144:147]
s_add_u32 s23, s34, 262144
v_mfma_f32_16x16x32_bf16 a[144:147], v[52:55], a[64:67], a[144:147]
v_mfma_f32_16x16x32_bf16 a[148:151], v[48:51], a[52:55], a[148:151]
ds_read_b128 v[72:75], v2 offset:47104
v_mfma_f32_16x16x32_bf16 a[148:151], v[52:55], a[68:71], a[148:151]
buffer_load_dwordx2 v[14:15], v11, s[8:11], s23 offen sc1
v_mfma_f32_16x16x32_bf16 a[152:155], v[48:51], a[56:59], a[152:155]
v_mfma_f32_16x16x32_bf16 a[152:155], v[52:55], a[72:75], a[152:155]
ds_read_b128 v[76:79], v2 offset:48128
v_mfma_f32_16x16x32_bf16 a[156:159], v[48:51], a[60:63], a[156:159]
v_mfma_f32_16x16x32_bf16 a[156:159], v[52:55], a[76:79], a[156:159]
s_waitcnt lgkmcnt(4)
v_mfma_f32_16x16x32_bf16 a[160:163], v[56:59], a[48:51], a[160:163]
s_waitcnt vmcnt(49)
v_mfma_f32_16x16x32_bf16 a[160:163], v[60:63], a[64:67], a[160:163]
s_barrier
v_mfma_f32_16x16x32_bf16 a[164:167], v[56:59], a[52:55], a[164:167]
ds_read_b128 v[48:51], v2 offset:49152
buffer_load_dwordx2 v[22:23], v249, s[8:11], s29 offen offset:512 sc1
v_mfma_f32_16x16x32_bf16 a[164:167], v[60:63], a[68:71], a[164:167]
v_mfma_f32_16x16x32_bf16 a[168:171], v[56:59], a[56:59], a[168:171]
v_mfma_f32_16x16x32_bf16 a[168:171], v[60:63], a[72:75], a[168:171]
ds_read_b128 v[52:55], v2 offset:50176
v_mfma_f32_16x16x32_bf16 a[172:175], v[56:59], a[60:63], a[172:175]
buffer_load_dwordx2 v[24:25], v250, s[8:11], s29 offen offset:0 sc1
v_mfma_f32_16x16x32_bf16 a[172:175], v[60:63], a[76:79], a[172:175]
s_waitcnt lgkmcnt(4)
v_mfma_f32_16x16x32_bf16 a[176:179], v[64:67], a[48:51], a[176:179]
v_mfma_f32_16x16x32_bf16 a[176:179], v[68:71], a[64:67], a[176:179]
v_mfma_f32_16x16x32_bf16 a[180:183], v[64:67], a[52:55], a[180:183]
ds_read_b128 v[56:59], v2 offset:51200
v_mfma_f32_16x16x32_bf16 a[180:183], v[68:71], a[68:71], a[180:183]
buffer_load_dwordx2 v[26:27], v250, s[8:11], s29 offen offset:512 sc1
v_mfma_f32_16x16x32_bf16 a[184:187], v[64:67], a[56:59], a[184:187]
v_mfma_f32_16x16x32_bf16 a[184:187], v[68:71], a[72:75], a[184:187]
ds_read_b128 v[60:63], v2 offset:52224
v_mfma_f32_16x16x32_bf16 a[188:191], v[64:67], a[60:63], a[188:191]
v_mfma_f32_16x16x32_bf16 a[188:191], v[68:71], a[76:79], a[188:191]
s_waitcnt lgkmcnt(4)
v_mfma_f32_16x16x32_bf16 a[192:195], v[72:75], a[48:51], a[192:195]
buffer_load_dwordx2 v[28:29], v251, s[8:11], s29 offen offset:0 sc1
v_mfma_f32_16x16x32_bf16 a[192:195], v[76:79], a[64:67], a[192:195]
v_mfma_f32_16x16x32_bf16 a[196:199], v[72:75], a[52:55], a[196:199]
ds_read_b128 v[64:67], v2 offset:53248
v_mfma_f32_16x16x32_bf16 a[196:199], v[76:79], a[68:71], a[196:199]
v_mfma_f32_16x16x32_bf16 a[200:203], v[72:75], a[56:59], a[200:203]
buffer_load_dwordx2 v[30:31], v251, s[8:11], s29 offen offset:512 sc1
v_mfma_f32_16x16x32_bf16 a[200:203], v[76:79], a[72:75], a[200:203]
ds_read_b128 v[68:71], v2 offset:54272
v_mfma_f32_16x16x32_bf16 a[204:207], v[72:75], a[60:63], a[204:207]
v_mfma_f32_16x16x32_bf16 a[204:207], v[76:79], a[76:79], a[204:207]
s_waitcnt lgkmcnt(4)
v_mfma_f32_16x16x32_bf16 a[208:211], v[48:51], a[48:51], a[208:211]
buffer_load_dwordx4 v[32:35], v2, s[8:11], s25 offen offset:2048 sc1
v_mfma_f32_16x16x32_bf16 a[208:211], v[52:55], a[64:67], a[208:211]
v_mfma_f32_16x16x32_bf16 a[212:215], v[48:51], a[52:55], a[212:215]
ds_read_b128 v[72:75], v2 offset:55296
v_mfma_f32_16x16x32_bf16 a[212:215], v[52:55], a[68:71], a[212:215]
v_mfma_f32_16x16x32_bf16 a[216:219], v[48:51], a[56:59], a[216:219]
buffer_load_dwordx4 v[36:39], v4, s[8:11], s25 offen offset:2048 sc1
v_mfma_f32_16x16x32_bf16 a[216:219], v[52:55], a[72:75], a[216:219]
ds_read_b128 v[76:79], v2 offset:56320
v_mfma_f32_16x16x32_bf16 a[220:223], v[48:51], a[60:63], a[220:223]
v_mfma_f32_16x16x32_bf16 a[220:223], v[52:55], a[76:79], a[220:223]
s_waitcnt lgkmcnt(4)
v_mfma_f32_16x16x32_bf16 a[224:227], v[56:59], a[48:51], a[224:227]
buffer_load_dwordx4 v[40:43], v5, s[8:11], s25 offen offset:2048 sc1
v_mfma_f32_16x16x32_bf16 a[224:227], v[60:63], a[64:67], a[224:227]
v_mfma_f32_16x16x32_bf16 a[228:231], v[56:59], a[52:55], a[228:231]
ds_read_b128 v[48:51], v2 offset:57344
v_mfma_f32_16x16x32_bf16 a[228:231], v[60:63], a[68:71], a[228:231]
v_mfma_f32_16x16x32_bf16 a[232:235], v[56:59], a[56:59], a[232:235]
buffer_load_dwordx4 v[44:47], v6, s[8:11], s25 offen offset:2048 sc1
v_mfma_f32_16x16x32_bf16 a[232:235], v[60:63], a[72:75], a[232:235]
ds_read_b128 v[52:55], v2 offset:58368
v_mfma_f32_16x16x32_bf16 a[236:239], v[56:59], a[60:63], a[236:239]
v_mfma_f32_16x16x32_bf16 a[236:239], v[60:63], a[76:79], a[236:239]
s_waitcnt vmcnt(20)
s_waitcnt lgkmcnt(4)
v_mfma_f32_16x16x32_bf16 a[112:115], v[64:67], a[80:83], a[112:115]
buffer_load_dwordx4 v[80:83], v2, s[8:11], s26 offen offset:2048 sc1
v_mfma_f32_16x16x32_bf16 a[112:115], v[68:71], a[96:99], a[112:115]
v_mfma_f32_16x16x32_bf16 a[116:119], v[64:67], a[84:87], a[116:119]
ds_read_b128 v[56:59], v2 offset:59392
v_mfma_f32_16x16x32_bf16 a[116:119], v[68:71], a[100:103], a[116:119]
v_mfma_f32_16x16x32_bf16 a[120:123], v[64:67], a[88:91], a[120:123]
buffer_load_dwordx4 v[84:87], v4, s[8:11], s26 offen offset:2048 sc1
v_mfma_f32_16x16x32_bf16 a[120:123], v[68:71], a[104:107], a[120:123]
ds_read_b128 v[60:63], v2 offset:60416
v_mfma_f32_16x16x32_bf16 a[124:127], v[64:67], a[92:95], a[124:127]
v_mfma_f32_16x16x32_bf16 a[124:127], v[68:71], a[108:111], a[124:127]
s_waitcnt lgkmcnt(4)
v_mfma_f32_16x16x32_bf16 a[128:131], v[72:75], a[80:83], a[128:131]
buffer_load_dwordx4 v[88:91], v5, s[8:11], s26 offen offset:2048 sc1
v_mfma_f32_16x16x32_bf16 a[128:131], v[76:79], a[96:99], a[128:131]
v_mfma_f32_16x16x32_bf16 a[132:135], v[72:75], a[84:87], a[132:135]
ds_read_b128 v[64:67], v2 offset:61440
v_mfma_f32_16x16x32_bf16 a[132:135], v[76:79], a[100:103], a[132:135]
v_mfma_f32_16x16x32_bf16 a[136:139], v[72:75], a[88:91], a[136:139]
buffer_load_dwordx4 v[92:95], v6, s[8:11], s26 offen offset:2048 sc1
v_mfma_f32_16x16x32_bf16 a[136:139], v[76:79], a[104:107], a[136:139]
ds_read_b128 v[68:71], v2 offset:62464
s_waitcnt vmcnt(13)
v_cmp_eq_u64 vcc, s[68:69], v[14:15]
s_nop 0
s_cmp_eq_u64 vcc, exec
s_cbranch_scc0 L_f_slow3
L_f_back3:
v_mfma_f32_16x16x32_bf16 a[140:143], v[72:75], a[92:95], a[140:143]
v_mfma_f32_16x16x32_bf16 a[140:143], v[76:79], a[108:111], a[140:143]
s_waitcnt lgkmcnt(4)
v_mfma_f32_16x16x32_bf16 a[144:147], v[48:51], a[80:83], a[144:147]
buffer_load_dwordx4 v[96:99], v2, s[8:11], s27 offen offset:2048 sc1
v_mfma_f32_16x16x32_bf16 a[144:147], v[52:55], a[96:99], a[144:147]
v_mfma_f32_16x16x32_bf16 a[148:151], v[48:51], a[84:87], a[148:151]
ds_read_b128 v[72:75], v2 offset:63488
v_mfma_f32_16x16x32_bf16 a[148:151], v[52:55], a[100:103], a[148:151]
v_mfma_f32_16x16x32_bf16 a[152:155], v[48:51], a[88:91], a[152:155]
buffer_load_dwordx4 v[100:103], v4, s[8:11], s27 offen offset:2048 sc1
v_mfma_f32_16x16x32_bf16 a[152:155], v[52:55], a[104:107], a[152:155]
ds_read_b128 v[76:79], v2 offset:64512
v_mfma_f32_16x16x32_bf16 a[156:159], v[48:51], a[92:95], a[156:159]
v_mfma_f32_16x16x32_bf16 a[156:159], v[52:55], a[108:111], a[156:159]
s_waitcnt lgkmcnt(4)
v_mfma_f32_16x16x32_bf16 a[160:163], v[56:59], a[80:83], a[160:163]
buffer_load_dwordx4 v[104:107], v5, s[8:11], s27 offen offset:2048 sc1
v_mfma_f32_16x16x32_bf16 a[160:163], v[60:63], a[96:99], a[160:163]
v_mfma_f32_16x16x32_bf16 a[164:167], v[56:59], a[84:87], a[164:167]
ds_read_b128 v[48:51], v7 offset:0
v_mfma_f32_16x16x32_bf16 a[164:167], v[60:63], a[100:103], a[164:167]
v_mfma_f32_16x16x32_bf16 a[168:171], v[56:59], a[88:91], a[168:171]
buffer_load_dwordx4 v[108:111], v6, s[8:11], s27 offen offset:2048 sc1
v_mfma_f32_16x16x32_bf16 a[168:171], v[60:63], a[104:107], a[168:171]
ds_read_b128 v[52:55], v7 offset:1024
v_mfma_f32_16x16x32_bf16 a[172:175], v[56:59], a[92:95], a[172:175]
v_mfma_f32_16x16x32_bf16 a[172:175], v[60:63], a[108:111], a[172:175]
s_waitcnt lgkmcnt(4)
v_mfma_f32_16x16x32_bf16 a[176:179], v[64:67], a[80:83], a[176:179]
buffer_load_dwordx4 v[112:115], v2, s[8:11], s25 offen offset:3072 sc1
v_mfma_f32_16x16x32_bf16 a[176:179], v[68:71], a[96:99], a[176:179]
v_mfma_f32_16x16x32_bf16 a[180:183], v[64:67], a[84:87], a[180:183]
ds_read_b128 v[56:59], v7 offset:2048
v_mfma_f32_16x16x32_bf16 a[180:183], v[68:71], a[100:103], a[180:183]
v_mfma_f32_16x16x32_bf16 a[184:187], v[64:67], a[88:91], a[184:187]
buffer_load_dwordx4 v[116:119], v4, s[8:11], s25 offen offset:3072 sc1
v_mfma_f32_16x16x32_bf16 a[184:187], v[68:71], a[104:107], a[184:187]
ds_read_b128 v[60:63], v7 offset:3072
v_mfma_f32_16x16x32_bf16 a[188:191], v[64:67], a[92:95], a[188:191]
v_mfma_f32_16x16x32_bf16 a[188:191], v[68:71], a[108:111], a[188:191]
s_waitcnt lgkmcnt(4)
v_mfma_f32_16x16x32_bf16 a[192:195], v[72:75], a[80:83], a[192:195]
buffer_load_dwordx4 v[120:123], v5, s[8:11], s25 offen offset:3072 sc1
v_mfma_f32_16x16x32_bf16 a[192:195], v[76:79], a[96:99], a[192:195]
v_mfma_f32_16x16x32_bf16 a[196:199], v[72:75], a[84:87], a[196:199]
ds_read_b128 v[64:67], v7 offset:4096
v_mfma_f32_16x16x32_bf16 a[196:199], v[76:79], a[100:103], a[196:199]
v_mfma_f32_16x16x32_bf16 a[200:203], v[72:75], a[88:91], a[200:203]
buffer_load_dwordx4 v[124:127], v6, s[8:11], s25 offen offset:3072 sc1
v_mfma_f32_16x16x32_bf16 a[200:203], v[76:79], a[104:107], a[200:203]
ds_read_b128 v[68:71], v7 offset:5120
v_mfma_f32_16x16x32_bf16 a[204:207], v[72:75], a[92:95], a[204:207]
v_mfma_f32_16x16x32_bf16 a[204:207], v[76:79], a[108:111], a[204:207]
s_waitcnt lgkmcnt(4)
v_mfma_f32_16x16x32_bf16 a[208:211], v[48:51], a[80:83], a[208:211]
buffer_load_dwordx4 v[128:131], v2, s[8:11], s26 offen offset:3072 sc1
v_mfma_f32_16x16x32_bf16 a[208:211], v[52:55], a[96:99], a[208:211]
v_mfma_f32_16x16x32_bf16 a[212:215], v[48:51], a[84:87], a[212:215]
ds_read_b128 v[72:75], v7 offset:6144
v_mfma_f32_16x16x32_bf16 a[212:215], v[52:55], a[100:103], a[212:215]
v_mfma_f32_16x16x32_bf16 a[216:219], v[48:51], a[88:91], a[216:219]
buffer_load_dwordx4 v[132:135], v4, s[8:11], s26 offen offset:3072 sc1
v_mfma_f32_16x16x32_bf16 a[216:219], v[52:55], a[104:107], a[216:219]
ds_read_b128 v[76:79], v7 offset:7168
v_mfma_f32_16x16x32_bf16 a[220:223], v[48:51], a[92:95], a[220:223]
v_mfma_f32_16x16x32_bf16 a[220:223], v[52:55], a[108:111], a[220:223]
s_waitcnt lgkmcnt(4)
v_mfma_f32_16x16x32_bf16 a[224:227], v[56:59], a[80:83], a[224:227]
s_waitcnt vmcnt(27)
v_mfma_f32_16x16x32_bf16 a[224:227], v[60:63], a[96:99], a[224:227]
s_barrier
v_mfma_f32_16x16x32_bf16 a[228:231], v[56:59], a[84:87], a[228:231]
ds_read_b128 v[48:51], v7 offset:8192
buffer_load_dwordx4 v[136:139], v5, s[8:11], s26 offen offset:3072 sc1
v_mfma_f32_16x16x32_bf16 a[228:231], v[60:63], a[100:103], a[228:231]
v_mfma_f32_16x16x32_bf16 a[232:235], v[56:59], a[88:91], a[232:235]
v_mfma_f32_16x16x32_bf16 a[232:235], v[60:63], a[104:107], a[232:235]
ds_read_b128 v[52:55], v7 offset:9216
v_mfma_f32_16x16x32_bf16 a[236:239], v[56:59], a[92:95], a[236:239]
buffer_load_dwordx4 v[140:143], v6, s[8:11], s26 offen offset:3072 sc1
v_mfma_f32_16x16x32_bf16 a[236:239], v[60:63], a[108:111], a[236:239]
s_waitcnt vmcnt(20)
s_waitcnt lgkmcnt(4)
v_mfma_f32_16x16x32_bf16 a[112:115], v[64:67], v[16:19], a[112:115]
v_mfma_f32_16x16x32_bf16 a[112:115], v[68:71], v[192:195], a[112:115]
v_mfma_f32_16x16x32_bf16 a[116:119], v[64:67], v[20:23], a[116:119]
ds_read_b128 v[56:59], v7 offset:10240
v_mfma_f32_16x16x32_bf16 a[116:119], v[68:71], v[196:199], a[116:119]
buffer_load_dwordx4 v[232:235], v2, s[8:11], s27 offen offset:3072 sc1
v_mfma_f32_16x16x32_bf16 a[120:123], v[64:67], v[24:27], a[120:123]
v_mfma_f32_16x16x32_bf16 a[120:123], v[68:71], v[200:203], a[120:123]
ds_read_b128 v[60:63], v7 offset:11264
v_mfma_f32_16x16x32_bf16 a[124:127], v[64:67], v[28:31], a[124:127]
v_mfma_f32_16x16x32_bf16 a[124:127], v[68:71], v[204:207], a[124:127]
s_waitcnt lgkmcnt(4)
v_mfma_f32_16x16x32_bf16 a[128:131], v[72:75], v[16:19], a[128:131]
buffer_load_dwordx4 v[236:239], v4, s[8:11], s27 offen offset:3072 sc1
v_mfma_f32_16x16x32_bf16 a[128:131], v[76:79], v[192:195], a[128:131]
v_mfma_f32_16x16x32_bf16 a[132:135], v[72:75], v[20:23], a[132:135]
ds_read_b128 v[64:67], v7 offset:12288
v_mfma_f32_16x16x32_bf16 a[132:135], v[76:79], v[196:199], a[132:135]
v_mfma_f32_16x16x32_bf16 a[136:139], v[72:75], v[24:27], a[136:139]
buffer_load_dwordx4 v[240:243], v5, s[8:11], s27 offen offset:3072 sc1
v_mfma_f32_16x16x32_bf16 a[136:139], v[76:79], v[200:203], a[136:139]
ds_read_b128 v[68:71], v7 offset:13312
v_mfma_f32_16x16x32_bf16 a[140:143], v[72:75], v[28:31], a[140:143]
v_mfma_f32_16x16x32_bf16 a[140:143], v[76:79], v[204:207], a[140:143]
s_waitcnt lgkmcnt(4)
v_mfma_f32_16x16x32_bf16 a[144:147], v[48:51], v[16:19], a[144:147]
buffer_load_dwordx4 v[244:247], v6, s[8:11], s27 offen offset:3072 sc1
v_mfma_f32_16x16x32_bf16 a[144:147], v[52:55], v[192:195], a[144:147]
s_add_u32 m0, s22, 98304
v_add_u32 v3, 20480, v3
v_mfma_f32_16x16x32_bf16 a[148:151], v[48:51], v[20:23], a[148:151]
ds_read_b128 v[72:75], v7 offset:14336
v_mfma_f32_16x16x32_bf16 a[148:151], v[52:55], v[196:199], a[148:151]
v_mfma_f32_16x16x32_bf16 a[152:155], v[48:51], v[24:27], a[152:155]
buffer_load_dwordx4 v3, s[8:11], 0 offen offset:0 sc1 lds
v_mfma_f32_16x16x32_bf16 a[152:155], v[52:55], v[200:203], a[152:155]
ds_read_b128 v[76:79], v7 offset:15360
v_mfma_f32_16x16x32_bf16 a[156:159], v[48:51], v[28:31], a[156:159]
v_mfma_f32_16x16x32_bf16 a[156:159], v[52:55], v[204:207], a[156:159]
s_waitcnt lgkmcnt(4)
v_mfma_f32_16x16x32_bf16 a[160:163], v[56:59], v[16:19], a[160:163]
buffer_load_dwordx4 v3, s[8:11], 0 offen offset:1024 sc1 lds
v_mfma_f32_16x16x32_bf16 a[160:163], v[60:63], v[192:195], a[160:163]
v_mfma_f32_16x16x32_bf16 a[164:167], v[56:59], v[20:23], a[164:167]
ds_read_b128 v[48:51], v7 offset:16384
v_mfma_f32_16x16x32_bf16 a[164:167], v[60:63], v[196:199], a[164:167]
v_mfma_f32_16x16x32_bf16 a[168:171], v[56:59], v[24:27], a[168:171]
buffer_load_dwordx4 v3, s[8:11], 0 offen offset:2048 sc1 lds
v_mfma_f32_16x16x32_bf16 a[168:171], v[60:63], v[200:203], a[168:171]
ds_read_b128 v[52:55], v7 offset:17408
v_mfma_f32_16x16x32_bf16 a[172:175], v[56:59], v[28:31], a[172:175]
v_mfma_f32_16x16x32_bf16 a[172:175], v[60:63], v[204:207], a[172:175]
s_waitcnt vmcnt(19)
s_waitcnt lgkmcnt(4)
v_mfma_f32_16x16x32_bf16 a[112:115], v[64:67], v[32:35], a[112:115]
buffer_load_dwordx4 v3, s[8:11], 0 offen offset:3072 sc1 lds
v_mfma_f32_16x16x32_bf16 a[112:115], v[68:71], v[80:83], a[112:115]
s_add_u32 m0, s22, 102400
v_add_u32 v3, 4096, v3
v_mfma_f32_16x16x32_bf16 a[116:119], v[64:67], v[36:39], a[116:119]
ds_read_b128 v[56:59], v7 offset:18432
v_mfma_f32_16x16x32_bf16 a[116:119], v[68:71], v[84:87], a[116:119]
v_mfma_f32_16x16x32_bf16 a[120:123], v[64:67], v[40:43], a[120:123]
buffer_load_dwordx4 v3, s[8:11], 0 offen offset:0 sc1 lds
v_mfma_f32_16x16x32_bf16 a[120:123], v[68:71], v[88:91], a[120:123]
ds_read_b128 v[60:63], v7 offset:19456
v_mfma_f32_16x16x32_bf16 a[124:127], v[64:67], v[44:47], a[124:127]
v_mfma_f32_16x16x32_bf16 a[124:127], v[68:71], v[92:95], a[124:127]
s_waitcnt lgkmcnt(4)
v_mfma_f32_16x16x32_bf16 a[128:131], v[72:75], v[32:35], a[128:131]
buffer_load_dwordx4 v3, s[8:11], 0 offen offset:1024 sc1 lds
v_mfma_f32_16x16x32_bf16 a[128:131], v[76:79], v[80:83], a[128:131]
s_add_u32 m0, s22, 122880
v_add_u32 v3, 20480, v3
v_mfma_f32_16x16x32_bf16 a[132:135], v[72:75], v[36:39], a[132:135]
ds_read_b128 v[64:67], v7 offset:20480
v_mfma_f32_16x16x32_bf16 a[132:135], v[76:79], v[84:87], a[132:135]
v_mfma_f32_16x16x32_bf16 a[136:139], v[72:75], v[40:43], a[136:139]
v_mfma_f32_16x16x32_bf16 a[136:139], v[76:79], v[88:91], a[136:139]
ds_read_b128 v[68:71], v7 offset:21504
v_mfma_f32_16x16x32_bf16 a[140:143], v[72:75], v[44:47], a[140:143]
buffer_load_dwordx4 v3, s[8:11], 0 offen offset:0 sc1 lds
v_mfma_f32_16x16x32_bf16 a[140:143], v[76:79], v[92:95], a[140:143]
s_waitcnt lgkmcnt(4)
v_mfma_f32_16x16x32_bf16 a[144:147], v[48:51], v[32:35], a[144:147]
v_mfma_f32_16x16x32_bf16 a[144:147], v[52:55], v[80:83], a[144:147]
v_mfma_f32_16x16x32_bf16 a[148:151], v[48:51], v[36:39], a[148:151]
ds_read_b128 v[72:75], v7 offset:22528
v_mfma_f32_16x16x32_bf16 a[148:151], v[52:55], v[84:87], a[148:151]
buffer_load_dwordx4 v3, s[8:11], 0 offen offset:1024 sc1 lds
v_mfma_f32_16x16x32_bf16 a[152:155], v[48:51], v[40:43], a[152:155]
v_mfma_f32_16x16x32_bf16 a[152:155], v[52:55], v[88:91], a[152:155]
ds_read_b128 v[76:79], v7 offset:23552
v_mfma_f32_16x16x32_bf16 a[156:159], v[48:51], v[44:47], a[156:159]
v_mfma_f32_16x16x32_bf16 a[156:159], v[52:55], v[92:95], a[156:159]
s_waitcnt lgkmcnt(4)
v_mfma_f32_16x16x32_bf16 a[160:163], v[56:59], v[32:35], a[160:163]
buffer_load_dwordx4 v3, s[8:11], 0 offen offset:2048 sc1 lds
v_mfma_f32_16x16x32_bf16 a[160:163], v[60:63], v[80:83], a[160:163]
v_mfma_f32_16x16x32_bf16 a[164:167], v[56:59], v[36:39], a[164:167]
ds_read_b128 v[48:51], v7 offset:24576
v_mfma_f32_16x16x32_bf16 a[164:167], v[60:63], v[84:87], a[164:167]
v_mfma_f32_16x16x32_bf16 a[168:171], v[56:59], v[40:43], a[168:171]
v_mfma_f32_16x16x32_bf16 a[168:171], v[60:63], v[88:91], a[168:171]
ds_read_b128 v[52:55], v7 offset:25600
v_mfma_f32_16x16x32_bf16 a[172:175], v[56:59], v[44:47], a[172:175]
buffer_load_dwordx4 v3, s[8:11], 0 offen offset:3072 sc1 lds
v_mfma_f32_16x16x32_bf16 a[172:175], v[60:63], v[92:95], a[172:175]
s_add_u32 m0, s22, 126976
s_waitcnt vmcnt(18)
s_waitcnt lgkmcnt(4)
v_mfma_f32_16x16x32_bf16 a[112:115], v[64:67], v[96:99], a[112:115]
v_add_u32 v3, 4096, v3
v_mfma_f32_16x16x32_bf16 a[112:115], v[68:71], v[112:115], a[112:115]
v_mfma_f32_16x16x32_bf16 a[116:119], v[64:67], v[100:103], a[116:119]
ds_read_b128 v[56:59], v7 offset:26624
v_mfma_f32_16x16x32_bf16 a[116:119], v[68:71], v[116:119], a[116:119]
buffer_load_dwordx4 v3, s[8:11], 0 offen offset:0 sc1 lds
v_mfma_f32_16x16x32_bf16 a[120:123], v[64:67], v[104:107], a[120:123]
v_mfma_f32_16x16x32_bf16 a[120:123], v[68:71], v[120:123], a[120:123]
ds_read_b128 v[60:63], v7 offset:27648
v_mfma_f32_16x16x32_bf16 a[124:127], v[64:67], v[108:111], a[124:127]
v_mfma_f32_16x16x32_bf16 a[124:127], v[68:71], v[124:127], a[124:127]
s_waitcnt vmcnt(11)
s_waitcnt lgkmcnt(4)
v_mfma_f32_16x16x32_bf16 a[112:115], v[72:75], v[128:131], a[112:115]
buffer_load_dwordx4 v3, s[8:11], 0 offen offset:1024 sc1 lds
v_mfma_f32_16x16x32_bf16 a[112:115], v[76:79], v[232:235], a[112:115]
s_lshl_b32 s21, s4, 11
s_add_u32 m0, s21, 0
v_mfma_f32_16x16x32_bf16 a[116:119], v[72:75], v[132:135], a[116:119]
ds_read_b128 v[64:67], v7 offset:28672
s_sub_u32 s21, s21, s22
v_mfma_f32_16x16x32_bf16 a[116:119], v[76:79], v[236:239], a[116:119]
s_add_u32 s21, s21, 20480
v_add_u32 v3, s21, v3
v_mfma_f32_16x16x32_bf16 a[120:123], v[72:75], v[136:139], a[120:123]
v_mfma_f32_16x16x32_bf16 a[120:123], v[76:79], v[240:243], a[120:123]
ds_read_b128 v[68:71], v7 offset:29696
v_mfma_f32_16x16x32_bf16 a[124:127], v[72:75], v[140:143], a[124:127]
buffer_load_dwordx4 v3, s[8:11], 0 offen offset:0 sc1 lds
v_mfma_f32_16x16x32_bf16 a[124:127], v[76:79], v[244:247], a[124:127]
s_waitcnt lgkmcnt(4)
v_mfma_f32_16x16x32_bf16 a[128:131], v[48:51], v[96:99], a[128:131]
v_mfma_f32_16x16x32_bf16 a[128:131], v[52:55], v[112:115], a[128:131]
v_mfma_f32_16x16x32_bf16 a[132:135], v[48:51], v[100:103], a[132:135]
ds_read_b128 v[72:75], v7 offset:30720
v_mfma_f32_16x16x32_bf16 a[132:135], v[52:55], v[116:119], a[132:135]
buffer_load_dwordx4 v3, s[8:11], 0 offen offset:1024 sc1 lds
v_mfma_f32_16x16x32_bf16 a[136:139], v[48:51], v[104:107], a[136:139]
v_mfma_f32_16x16x32_bf16 a[136:139], v[52:55], v[120:123], a[136:139]
ds_read_b128 v[76:79], v7 offset:31744
v_mfma_f32_16x16x32_bf16 a[140:143], v[48:51], v[108:111], a[140:143]
v_mfma_f32_16x16x32_bf16 a[140:143], v[52:55], v[124:127], a[140:143]
s_waitcnt lgkmcnt(4)
v_mfma_f32_16x16x32_bf16 a[128:131], v[56:59], v[128:131], a[128:131]
s_waitcnt vmcnt(8)
v_mfma_f32_16x16x32_bf16 a[128:131], v[60:63], v[232:235], a[128:131]
s_barrier
v_mfma_f32_16x16x32_bf16 a[132:135], v[56:59], v[132:135], a[132:135]
ds_read_b128 v[48:51], v7 offset:32768
v_mfma_f32_16x16x32_bf16 a[132:135], v[60:63], v[236:239], a[132:135]
v_mfma_f32_16x16x32_bf16 a[136:139], v[56:59], v[136:139], a[136:139]
v_mfma_f32_16x16x32_bf16 a[136:139], v[60:63], v[240:243], a[136:139]
ds_read_b128 v[52:55], v7 offset:33792
v_mfma_f32_16x16x32_bf16 a[140:143], v[56:59], v[140:143], a[140:143]
v_mfma_f32_16x16x32_bf16 a[140:143], v[60:63], v[244:247], a[140:143]
s_waitcnt lgkmcnt(4)
v_mfma_f32_16x16x32_bf16 a[144:147], v[64:67], v[96:99], a[144:147]
v_mfma_f32_16x16x32_bf16 a[144:147], v[68:71], v[112:115], a[144:147]
v_mfma_f32_16x16x32_bf16 a[148:151], v[64:67], v[100:103], a[148:151]
ds_read_b128 v[56:59], v7 offset:34816
v_mfma_f32_16x16x32_bf16 a[148:151], v[68:71], v[116:119], a[148:151]
v_mfma_f32_16x16x32_bf16 a[152:155], v[64:67], v[104:107], a[152:155]
v_mfma_f32_16x16x32_bf16 a[152:155], v[68:71], v[120:123], a[152:155]
ds_read_b128 v[60:63], v7 offset:35840
v_mfma_f32_16x16x32_bf16 a[156:159], v[64:67], v[108:111], a[156:159]
v_mfma_f32_16x16x32_bf16 a[156:159], v[68:71], v[124:127], a[156:159]
s_waitcnt lgkmcnt(4)
v_mfma_f32_16x16x32_bf16 a[144:147], v[72:75], v[128:131], a[144:147]
v_mfma_f32_16x16x32_bf16 a[144:147], v[76:79], v[232:235], a[144:147]
v_mfma_f32_16x16x32_bf16 a[148:151], v[72:75], v[132:135], a[148:151]
ds_read_b128 v[64:67], v7 offset:36864
v_mfma_f32_16x16x32_bf16 a[148:151], v[76:79], v[236:239], a[148:151]
v_mfma_f32_16x16x32_bf16 a[152:155], v[72:75], v[136:139], a[152:155]
v_mfma_f32_16x16x32_bf16 a[152:155], v[76:79], v[240:243], a[152:155]
ds_read_b128 v[68:71], v7 offset:37888
v_mfma_f32_16x16x32_bf16 a[156:159], v[72:75], v[140:143], a[156:159]
v_mfma_f32_16x16x32_bf16 a[156:159], v[76:79], v[244:247], a[156:159]
s_waitcnt lgkmcnt(4)
v_mfma_f32_16x16x32_bf16 a[160:163], v[48:51], v[96:99], a[160:163]
v_mfma_f32_16x16x32_bf16 a[160:163], v[52:55], v[112:115], a[160:163]
v_mfma_f32_16x16x32_bf16 a[164:167], v[48:51], v[100:103], a[164:167]
ds_read_b128 v[72:75], v7 offset:38912
v_mfma_f32_16x16x32_bf16 a[164:167], v[52:55], v[116:119], a[164:167]
v_mfma_f32_16x16x32_bf16 a[168:171], v[48:51], v[104:107], a[168:171]
v_mfma_f32_16x16x32_bf16 a[168:171], v[52:55], v[120:123], a[168:171]
ds_read_b128 v[76:79], v7 offset:39936
v_mfma_f32_16x16x32_bf16 a[172:175], v[48:51], v[108:111], a[172:175]
v_mfma_f32_16x16x32_bf16 a[172:175], v[52:55], v[124:127], a[172:175]
s_waitcnt lgkmcnt(4)
v_mfma_f32_16x16x32_bf16 a[160:163], v[56:59], v[128:131], a[160:163]
v_mfma_f32_16x16x32_bf16 a[160:163], v[60:63], v[232:235], a[160:163]
v_mfma_f32_16x16x32_bf16 a[164:167], v[56:59], v[132:135], a[164:167]
ds_read_b128 v[48:51], v7 offset:40960
v_mfma_f32_16x16x32_bf16 a[164:167], v[60:63], v[236:239], a[164:167]
v_mfma_f32_16x16x32_bf16 a[168:171], v[56:59], v[136:139], a[168:171]
v_mfma_f32_16x16x32_bf16 a[168:171], v[60:63], v[240:243], a[168:171]
ds_read_b128 v[52:55], v7 offset:41984
v_mfma_f32_16x16x32_bf16 a[172:175], v[56:59], v[140:143], a[172:175]
v_mfma_f32_16x16x32_bf16 a[172:175], v[60:63], v[244:247], a[172:175]
s_waitcnt lgkmcnt(4)
v_mfma_f32_16x16x32_bf16 a[176:179], v[64:67], v[16:19], a[176:179]
v_mfma_f32_16x16x32_bf16 a[176:179], v[68:71], v[192:195], a[176:179]
v_mfma_f32_16x16x32_bf16 a[180:183], v[64:67], v[20:23], a[180:183]
ds_read_b128 v[56:59], v7 offset:43008
v_mfma_f32_16x16x32_bf16 a[180:183], v[68:71], v[196:199], a[180:183]
v_accvgpr_read_b32 v208, a112
v_accvgpr_read_b32 v209, a128
v_mfma_f32_16x16x32_bf16 a[184:187], v[64:67], v[24:27], a[184:187]
v_accvgpr_read_b32 v210, a144
v_accvgpr_read_b32 v211, a160
v_mfma_f32_16x16x32_bf16 a[184:187], v[68:71], v[200:203], a[184:187]
ds_read_b128 v[60:63], v7 offset:44032
v_accvgpr_read_b32 v212, a113
v_mfma_f32_16x16x32_bf16 a[188:191], v[64:67], v[28:31], a[188:191]
v_accvgpr_read_b32 v213, a129
v_accvgpr_read_b32 v214, a145
v_mfma_f32_16x16x32_bf16 a[188:191], v[68:71], v[204:207], a[188:191]
v_accvgpr_read_b32 v215, a161
s_waitcnt lgkmcnt(4)
v_mfma_f32_16x16x32_bf16 a[192:195], v[72:75], v[16:19], a[192:195]
v_cvt_pk_bf16_f32 v224, v208, v209
v_cvt_pk_bf16_f32 v225, v210, v211
v_mfma_f32_16x16x32_bf16 a[192:195], v[76:79], v[192:195], a[192:195]
v_cvt_pk_bf16_f32 v226, v212, v213
v_cvt_pk_bf16_f32 v227, v214, v215
v_mfma_f32_16x16x32_bf16 a[196:199], v[72:75], v[20:23], a[196:199]
ds_read_b128 v[64:67], v7 offset:45056
v_accvgpr_read_b32 v216, a114
v_mfma_f32_16x16x32_bf16 a[196:199], v[76:79], v[196:199], a[196:199]
buffer_store_dwordx4 v[224:227], v252, s[8:11], s36 offen offset:0 sc1
v_mfma_f32_16x16x32_bf16 a[200:203], v[72:75], v[24:27], a[200:203]
v_accvgpr_read_b32 v217, a130
v_accvgpr_read_b32 v218, a146
v_mfma_f32_16x16x32_bf16 a[200:203], v[76:79], v[200:203], a[200:203]
ds_read_b128 v[68:71], v7 offset:46080
v_accvgpr_read_b32 v219, a162
v_mfma_f32_16x16x32_bf16 a[204:207], v[72:75], v[28:31], a[204:207]
v_accvgpr_read_b32 v220, a115
v_accvgpr_read_b32 v221, a131
v_mfma_f32_16x16x32_bf16 a[204:207], v[76:79], v[204:207], a[204:207]
v_accvgpr_read_b32 v222, a147
s_waitcnt lgkmcnt(4)
v_mfma_f32_16x16x32_bf16 a[208:211], v[48:51], v[16:19], a[208:211]
v_accvgpr_read_b32 v223, a163
v_cvt_pk_bf16_f32 v228, v216, v217
v_mfma_f32_16x16x32_bf16 a[208:211], v[52:55], v[192:195], a[208:211]
v_cvt_pk_bf16_f32 v229, v218, v219
v_cvt_pk_bf16_f32 v230, v220, v221
v_mfma_f32_16x16x32_bf16 a[212:215], v[48:51], v[20:23], a[212:215]
ds_read_b128 v[72:75], v7 offset:47104
v_cvt_pk_bf16_f32 v231, v222, v223
v_mfma_f32_16x16x32_bf16 a[212:215], v[52:55], v[196:199], a[212:215]
buffer_store_dwordx4 v[228:231], v252, s[8:11], s36 offen offset:256 sc1
v_mfma_f32_16x16x32_bf16 a[216:219], v[48:51], v[24:27], a[216:219]
v_accvgpr_read_b32 v208, a116
v_accvgpr_read_b32 v209, a132
v_mfma_f32_16x16x32_bf16 a[216:219], v[52:55], v[200:203], a[216:219]
ds_read_b128 v[76:79], v7 offset:48128
v_accvgpr_read_b32 v210, a148
v_mfma_f32_16x16x32_bf16 a[220:223], v[48:51], v[28:31], a[220:223]
v_accvgpr_read_b32 v211, a164
v_accvgpr_read_b32 v212, a117
v_mfma_f32_16x16x32_bf16 a[220:223], v[52:55], v[204:207], a[220:223]
v_accvgpr_read_b32 v213, a133
s_waitcnt lgkmcnt(4)
v_mfma_f32_16x16x32_bf16 a[224:227], v[56:59], v[16:19], a[224:227]
v_accvgpr_read_b32 v214, a149
v_accvgpr_read_b32 v215, a165
v_mfma_f32_16x16x32_bf16 a[224:227], v[60:63], v[192:195], a[224:227]
v_cvt_pk_bf16_f32 v224, v208, v209
v_cvt_pk_bf16_f32 v225, v210, v211
v_mfma_f32_16x16x32_bf16 a[228:231], v[56:59], v[20:23], a[228:231]
ds_read_b128 v[48:51], v7 offset:49152
v_cvt_pk_bf16_f32 v226, v212, v213
v_mfma_f32_16x16x32_bf16 a[228:231], v[60:63], v[196:199], a[228:231]
v_cvt_pk_bf16_f32 v227, v214, v215
v_accvgpr_read_b32 v216, a118
v_mfma_f32_16x16x32_bf16 a[232:235], v[56:59], v[24:27], a[232:235]
buffer_store_dwordx4 v[224:227], v252, s[8:11], s37 offen offset:0 sc1
v_mfma_f32_16x16x32_bf16 a[232:235], v[60:63], v[200:203], a[232:235]
ds_read_b128 v[52:55], v7 offset:50176
v_accvgpr_read_b32 v217, a134
v_mfma_f32_16x16x32_bf16 a[236:239], v[56:59], v[28:31], a[236:239]
v_accvgpr_read_b32 v218, a150
v_accvgpr_read_b32 v219, a166
v_mfma_f32_16x16x32_bf16 a[236:239], v[60:63], v[204:207], a[236:239]
v_accvgpr_read_b32 v220, a119
s_waitcnt lgkmcnt(4)
v_mfma_f32_16x16x32_bf16 a[176:179], v[64:67], v[32:35], a[176:179]
v_accvgpr_read_b32 v221, a135
v_accvgpr_read_b32 v222, a151
v_mfma_f32_16x16x32_bf16 a[176:179], v[68:71], v[80:83], a[176:179]
v_accvgpr_read_b32 v223, a167
v_cvt_pk_bf16_f32 v228, v216, v217
v_mfma_f32_16x16x32_bf16 a[180:183], v[64:67], v[36:39], a[180:183]
ds_read_b128 v[56:59], v7 offset:51200
v_cvt_pk_bf16_f32 v229, v218, v219
v_mfma_f32_16x16x32_bf16 a[180:183], v[68:71], v[84:87], a[180:183]
v_cvt_pk_bf16_f32 v230, v220, v221
v_cvt_pk_bf16_f32 v231, v222, v223
v_mfma_f32_16x16x32_bf16 a[184:187], v[64:67], v[40:43], a[184:187]
buffer_store_dwordx4 v[228:231], v252, s[8:11], s37 offen offset:256 sc1
v_mfma_f32_16x16x32_bf16 a[184:187], v[68:71], v[88:91], a[184:187]
ds_read_b128 v[60:63], v7 offset:52224
v_accvgpr_read_b32 v208, a120
v_mfma_f32_16x16x32_bf16 a[188:191], v[64:67], v[44:47], a[188:191]
v_accvgpr_read_b32 v209, a136
v_accvgpr_read_b32 v210, a152
v_mfma_f32_16x16x32_bf16 a[188:191], v[68:71], v[92:95], a[188:191]
v_accvgpr_read_b32 v211, a168
s_waitcnt lgkmcnt(4)
v_mfma_f32_16x16x32_bf16 a[192:195], v[72:75], v[32:35], a[192:195]
v_accvgpr_read_b32 v212, a121
v_accvgpr_read_b32 v213, a137
v_mfma_f32_16x16x32_bf16 a[192:195], v[76:79], v[80:83], a[192:195]
v_accvgpr_read_b32 v214, a153
v_accvgpr_read_b32 v215, a169
v_mfma_f32_16x16x32_bf16 a[196:199], v[72:75], v[36:39], a[196:199]
ds_read_b128 v[64:67], v7 offset:53248
v_cvt_pk_bf16_f32 v224, v208, v209
v_mfma_f32_16x16x32_bf16 a[196:199], v[76:79], v[84:87], a[196:199]
v_cvt_pk_bf16_f32 v225, v210, v211
v_cvt_pk_bf16_f32 v226, v212, v213
v_mfma_f32_16x16x32_bf16 a[200:203], v[72:75], v[40:43], a[200:203]
v_cvt_pk_bf16_f32 v227, v214, v215
v_accvgpr_read_b32 v216, a122
v_mfma_f32_16x16x32_bf16 a[200:203], v[76:79], v[88:91], a[200:203]
ds_read_b128 v[68:71], v7 offset:54272
v_accvgpr_read_b32 v217, a138
v_mfma_f32_16x16x32_bf16 a[204:207], v[72:75], v[44:47], a[204:207]
buffer_store_dwordx4 v[224:227], v252, s[8:11], s38 offen offset:0 sc1
v_mfma_f32_16x16x32_bf16 a[204:207], v[76:79], v[92:95], a[204:207]
v_accvgpr_read_b32 v218, a154
s_waitcnt lgkmcnt(4)
v_mfma_f32_16x16x32_bf16 a[208:211], v[48:51], v[32:35], a[208:211]
v_accvgpr_read_b32 v219, a170
v_accvgpr_read_b32 v220, a123
v_mfma_f32_16x16x32_bf16 a[208:211], v[52:55], v[80:83], a[208:211]
v_accvgpr_read_b32 v221, a139
v_accvgpr_read_b32 v222, a155
v_mfma_f32_16x16x32_bf16 a[212:215], v[48:51], v[36:39], a[212:215]
ds_read_b128 v[72:75], v7 offset:55296
v_accvgpr_read_b32 v223, a171
v_mfma_f32_16x16x32_bf16 a[212:215], v[52:55], v[84:87], a[212:215]
v_cvt_pk_bf16_f32 v228, v216, v217
v_cvt_pk_bf16_f32 v229, v218, v219
v_mfma_f32_16x16x32_bf16 a[216:219], v[48:51], v[40:43], a[216:219]
v_cvt_pk_bf16_f32 v230, v220, v221
v_cvt_pk_bf16_f32 v231, v222, v223
v_mfma_f32_16x16x32_bf16 a[216:219], v[52:55], v[88:91], a[216:219]
ds_read_b128 v[76:79], v7 offset:56320
v_accvgpr_read_b32 v208, a124
v_mfma_f32_16x16x32_bf16 a[220:223], v[48:51], v[44:47], a[220:223]
buffer_store_dwordx4 v[228:231], v252, s[8:11], s38 offen offset:256 sc1
v_mfma_f32_16x16x32_bf16 a[220:223], v[52:55], v[92:95], a[220:223]
v_accvgpr_read_b32 v209, a140
s_waitcnt lgkmcnt(4)
v_mfma_f32_16x16x32_bf16 a[224:227], v[56:59], v[32:35], a[224:227]
s_waitcnt vmcnt(8)
v_accvgpr_read_b32 v210, a156
v_mfma_f32_16x16x32_bf16 a[224:227], v[60:63], v[80:83], a[224:227]
s_barrier
v_mfma_f32_16x16x32_bf16 a[228:231], v[56:59], v[36:39], a[228:231]
ds_read_b128 v[48:51], v7 offset:57344
v_accvgpr_read_b32 v211, a172
v_mfma_f32_16x16x32_bf16 a[228:231], v[60:63], v[84:87], a[228:231]
v_accvgpr_read_b32 v212, a125
v_accvgpr_read_b32 v213, a141
v_mfma_f32_16x16x32_bf16 a[232:235], v[56:59], v[40:43], a[232:235]
v_accvgpr_read_b32 v214, a157
v_accvgpr_read_b32 v215, a173
v_mfma_f32_16x16x32_bf16 a[232:235], v[60:63], v[88:91], a[232:235]
ds_read_b128 v[52:55], v7 offset:58368
v_cvt_pk_bf16_f32 v224, v208, v209
v_mfma_f32_16x16x32_bf16 a[236:239], v[56:59], v[44:47], a[236:239]
v_cvt_pk_bf16_f32 v225, v210, v211
v_cvt_pk_bf16_f32 v226, v212, v213
v_mfma_f32_16x16x32_bf16 a[236:239], v[60:63], v[92:95], a[236:239]
v_cvt_pk_bf16_f32 v227, v214, v215
s_waitcnt lgkmcnt(4)
v_mfma_f32_16x16x32_bf16 a[176:179], v[64:67], v[96:99], a[176:179]
buffer_store_dwordx4 v[224:227], v252, s[8:11], s39 offen offset:0 sc1
v_mfma_f32_16x16x32_bf16 a[176:179], v[68:71], v[112:115], a[176:179]
v_accvgpr_read_b32 v216, a126
v_accvgpr_read_b32 v217, a142
v_mfma_f32_16x16x32_bf16 a[180:183], v[64:67], v[100:103], a[180:183]
ds_read_b128 v[56:59], v7 offset:59392
v_accvgpr_read_b32 v218, a158
v_mfma_f32_16x16x32_bf16 a[180:183], v[68:71], v[116:119], a[180:183]
v_accvgpr_read_b32 v219, a174
v_accvgpr_read_b32 v220, a127
v_mfma_f32_16x16x32_bf16 a[184:187], v[64:67], v[104:107], a[184:187]
v_accvgpr_read_b32 v221, a143
v_accvgpr_read_b32 v222, a159
v_mfma_f32_16x16x32_bf16 a[184:187], v[68:71], v[120:123], a[184:187]
ds_read_b128 v[60:63], v7 offset:60416
v_accvgpr_read_b32 v223, a175
v_mfma_f32_16x16x32_bf16 a[188:191], v[64:67], v[108:111], a[188:191]
v_cvt_pk_bf16_f32 v228, v216, v217
v_cvt_pk_bf16_f32 v229, v218, v219
v_mfma_f32_16x16x32_bf16 a[188:191], v[68:71], v[124:127], a[188:191]
v_cvt_pk_bf16_f32 v230, v220, v221
s_waitcnt lgkmcnt(4)
v_mfma_f32_16x16x32_bf16 a[176:179], v[72:75], v[128:131], a[176:179]
v_cvt_pk_bf16_f32 v231, v222, v223
v_mfma_f32_16x16x32_bf16 a[176:179], v[76:79], v[232:235], a[176:179]
buffer_store_dwordx4 v[228:231], v252, s[8:11], s39 offen offset:256 sc1
v_mfma_f32_16x16x32_bf16 a[180:183], v[72:75], v[132:135], a[180:183]
ds_read_b128 v[64:67], v7 offset:61440
v_mfma_f32_16x16x32_bf16 a[180:183], v[76:79], v[236:239], a[180:183]
v_mfma_f32_16x16x32_bf16 a[184:187], v[72:75], v[136:139], a[184:187]
v_mfma_f32_16x16x32_bf16 a[184:187], v[76:79], v[240:243], a[184:187]
ds_read_b128 v[68:71], v7 offset:62464
v_mfma_f32_16x16x32_bf16 a[188:191], v[72:75], v[140:143], a[188:191]
v_mfma_f32_16x16x32_bf16 a[188:191], v[76:79], v[244:247], a[188:191]
s_waitcnt lgkmcnt(4)
v_mfma_f32_16x16x32_bf16 a[192:195], v[48:51], v[96:99], a[192:195]
v_mfma_f32_16x16x32_bf16 a[192:195], v[52:55], v[112:115], a[192:195]
v_mfma_f32_16x16x32_bf16 a[196:199], v[48:51], v[100:103], a[196:199]
ds_read_b128 v[72:75], v7 offset:63488
v_mfma_f32_16x16x32_bf16 a[196:199], v[52:55], v[116:119], a[196:199]
v_mfma_f32_16x16x32_bf16 a[200:203], v[48:51], v[104:107], a[200:203]
v_mfma_f32_16x16x32_bf16 a[200:203], v[52:55], v[120:123], a[200:203]
ds_read_b128 v[76:79], v7 offset:64512
v_mfma_f32_16x16x32_bf16 a[204:207], v[48:51], v[108:111], a[204:207]
v_mfma_f32_16x16x32_bf16 a[204:207], v[52:55], v[124:127], a[204:207]
s_waitcnt lgkmcnt(4)
v_mfma_f32_16x16x32_bf16 a[192:195], v[56:59], v[128:131], a[192:195]
v_mfma_f32_16x16x32_bf16 a[192:195], v[60:63], v[232:235], a[192:195]
v_mfma_f32_16x16x32_bf16 a[196:199], v[56:59], v[132:135], a[196:199]
ds_read_b128 v[48:51], v8 offset:0
v_mfma_f32_16x16x32_bf16 a[196:199], v[60:63], v[236:239], a[196:199]
v_mfma_f32_16x16x32_bf16 a[200:203], v[56:59], v[136:139], a[200:203]
v_mfma_f32_16x16x32_bf16 a[200:203], v[60:63], v[240:243], a[200:203]
ds_read_b128 v[52:55], v8 offset:1024
v_mfma_f32_16x16x32_bf16 a[204:207], v[56:59], v[140:143], a[204:207]
v_mfma_f32_16x16x32_bf16 a[204:207], v[60:63], v[244:247], a[204:207]
s_waitcnt lgkmcnt(4)
v_mfma_f32_16x16x32_bf16 a[208:211], v[64:67], v[96:99], a[208:211]
v_mfma_f32_16x16x32_bf16 a[208:211], v[68:71], v[112:115], a[208:211]
v_mfma_f32_16x16x32_bf16 a[212:215], v[64:67], v[100:103], a[212:215]
ds_read_b128 v[56:59], v8 offset:2048
v_mfma_f32_16x16x32_bf16 a[212:215], v[68:71], v[116:119], a[212:215]
v_mfma_f32_16x16x32_bf16 a[216:219], v[64:67], v[104:107], a[216:219]
v_mfma_f32_16x16x32_bf16 a[216:219], v[68:71], v[120:123], a[216:219]
ds_read_b128 v[60:63], v8 offset:3072
v_mfma_f32_16x16x32_bf16 a[220:223], v[64:67], v[108:111], a[220:223]
v_mfma_f32_16x16x32_bf16 a[220:223], v[68:71], v[124:127], a[220:223]
s_waitcnt lgkmcnt(4)
v_mfma_f32_16x16x32_bf16 a[208:211], v[72:75], v[128:131], a[208:211]
v_mfma_f32_16x16x32_bf16 a[208:211], v[76:79], v[232:235], a[208:211]
v_mfma_f32_16x16x32_bf16 a[212:215], v[72:75], v[132:135], a[212:215]
ds_read_b128 v[64:67], v8 offset:4096
v_mfma_f32_16x16x32_bf16 a[212:215], v[76:79], v[236:239], a[212:215]
v_mfma_f32_16x16x32_bf16 a[216:219], v[72:75], v[136:139], a[216:219]
v_mfma_f32_16x16x32_bf16 a[216:219], v[76:79], v[240:243], a[216:219]
ds_read_b128 v[68:71], v8 offset:5120
v_mfma_f32_16x16x32_bf16 a[220:223], v[72:75], v[140:143], a[220:223]
v_mfma_f32_16x16x32_bf16 a[220:223], v[76:79], v[244:247], a[220:223]
s_waitcnt lgkmcnt(4)
v_mfma_f32_16x16x32_bf16 a[224:227], v[48:51], v[96:99], a[224:227]
v_mfma_f32_16x16x32_bf16 a[224:227], v[52:55], v[112:115], a[224:227]
v_mfma_f32_16x16x32_bf16 a[228:231], v[48:51], v[100:103], a[228:231]
ds_read_b128 v[72:75], v8 offset:6144
v_mfma_f32_16x16x32_bf16 a[228:231], v[52:55], v[116:119], a[228:231]
v_mfma_f32_16x16x32_bf16 a[232:235], v[48:51], v[104:107], a[232:235]
v_mfma_f32_16x16x32_bf16 a[232:235], v[52:55], v[120:123], a[232:235]
ds_read_b128 v[76:79], v8 offset:7168
v_mfma_f32_16x16x32_bf16 a[236:239], v[48:51], v[108:111], a[236:239]
v_mfma_f32_16x16x32_bf16 a[236:239], v[52:55], v[124:127], a[236:239]
s_waitcnt lgkmcnt(4)
v_mfma_f32_16x16x32_bf16 a[224:227], v[56:59], v[128:131], a[224:227]
v_mfma_f32_16x16x32_bf16 a[224:227], v[60:63], v[232:235], a[224:227]
v_mfma_f32_16x16x32_bf16 a[228:231], v[56:59], v[132:135], a[228:231]
ds_read_b128 v[48:51], v8 offset:8192
v_mfma_f32_16x16x32_bf16 a[228:231], v[60:63], v[236:239], a[228:231]
v_mfma_f32_16x16x32_bf16 a[232:235], v[56:59], v[136:139], a[232:235]
v_mfma_f32_16x16x32_bf16 a[232:235], v[60:63], v[240:243], a[232:235]
ds_read_b128 v[52:55], v8 offset:9216
v_mfma_f32_16x16x32_bf16 a[236:239], v[56:59], v[140:143], a[236:239]
v_mfma_f32_16x16x32_bf16 a[236:239], v[60:63], v[244:247], a[236:239]
s_waitcnt lgkmcnt(4)
v_mfma_f32_16x16x32_bf16 a[240:243], v[64:67], v[144:147], 0
v_mfma_f32_16x16x32_bf16 a[240:243], v[68:71], v[160:163], a[240:243]
v_mfma_f32_16x16x32_bf16 a[244:247], v[64:67], v[148:151], 0
ds_read_b128 v[56:59], v8 offset:10240
v_mfma_f32_16x16x32_bf16 a[244:247], v[68:71], v[164:167], a[244:247]
v_accvgpr_read_b32 v208, a176
v_accvgpr_read_b32 v209, a192
v_mfma_f32_16x16x32_bf16 a[248:251], v[64:67], v[152:155], 0
v_accvgpr_read_b32 v210, a208
v_accvgpr_read_b32 v211, a224
v_mfma_f32_16x16x32_bf16 a[248:251], v[68:71], v[168:171], a[248:251]
ds_read_b128 v[60:63], v8 offset:11264
v_accvgpr_read_b32 v212, a177
v_mfma_f32_16x16x32_bf16 a[252:255], v[64:67], v[156:159], 0
v_accvgpr_read_b32 v213, a193
v_accvgpr_read_b32 v214, a209
v_mfma_f32_16x16x32_bf16 a[252:255], v[68:71], v[172:175], a[252:255]
v_accvgpr_read_b32 v215, a225
s_waitcnt lgkmcnt(4)
v_mfma_f32_16x16x32_bf16 a[240:243], v[72:75], v[176:179], a[240:243]
v_cvt_pk_bf16_f32 v224, v208, v209
v_cvt_pk_bf16_f32 v225, v210, v211
v_mfma_f32_16x16x32_bf16 a[240:243], v[76:79], a[0:3], a[240:243]
v_cvt_pk_bf16_f32 v226, v212, v213
v_cvt_pk_bf16_f32 v227, v214, v215
v_mfma_f32_16x16x32_bf16 a[244:247], v[72:75], v[180:183], a[244:247]
ds_read_b128 v[64:67], v8 offset:12288
v_accvgpr_read_b32 v216, a178
v_mfma_f32_16x16x32_bf16 a[244:247], v[76:79], a[4:7], a[244:247]
buffer_store_dwordx4 v[224:227], v252, s[8:11], s36 offen offset:2048 sc1
v_mfma_f32_16x16x32_bf16 a[248:251], v[72:75], v[184:187], a[248:251]
v_accvgpr_read_b32 v217, a194
v_accvgpr_read_b32 v218, a210
v_mfma_f32_16x16x32_bf16 a[248:251], v[76:79], a[8:11], a[248:251]
ds_read_b128 v[68:71], v8 offset:13312
v_accvgpr_read_b32 v219, a226
v_mfma_f32_16x16x32_bf16 a[252:255], v[72:75], v[188:191], a[252:255]
v_accvgpr_read_b32 v220, a179
v_accvgpr_read_b32 v221, a195
v_mfma_f32_16x16x32_bf16 a[252:255], v[76:79], a[12:15], a[252:255]
v_accvgpr_read_b32 v222, a211
s_waitcnt lgkmcnt(4)
v_mfma_f32_16x16x32_bf16 a[240:243], v[48:51], a[16:19], a[240:243]
v_accvgpr_read_b32 v223, a227
v_cvt_pk_bf16_f32 v228, v216, v217
v_mfma_f32_16x16x32_bf16 a[240:243], v[52:55], a[32:35], a[240:243]
v_cvt_pk_bf16_f32 v229, v218, v219
v_cvt_pk_bf16_f32 v230, v220, v221
v_mfma_f32_16x16x32_bf16 a[244:247], v[48:51], a[20:23], a[244:247]
ds_read_b128 v[72:75], v8 offset:14336
v_cvt_pk_bf16_f32 v231, v222, v223
v_mfma_f32_16x16x32_bf16 a[244:247], v[52:55], a[36:39], a[244:247]
buffer_store_dwordx4 v[228:231], v252, s[8:11], s36 offen offset:2304 sc1
v_mfma_f32_16x16x32_bf16 a[248:251], v[48:51], a[24:27], a[248:251]
v_accvgpr_read_b32 v208, a180
v_accvgpr_read_b32 v209, a196
v_mfma_f32_16x16x32_bf16 a[248:251], v[52:55], a[40:43], a[248:251]
ds_read_b128 v[76:79], v8 offset:15360
v_accvgpr_read_b32 v210, a212
v_mfma_f32_16x16x32_bf16 a[252:255], v[48:51], a[28:31], a[252:255]
v_accvgpr_read_b32 v211, a228
v_accvgpr_read_b32 v212, a181
v_mfma_f32_16x16x32_bf16 a[252:255], v[52:55], a[44:47], a[252:255]
v_accvgpr_read_b32 v213, a197
s_waitcnt lgkmcnt(4)
v_mfma_f32_16x16x32_bf16 a[240:243], v[56:59], a[48:51], a[240:243]
s_waitcnt vmcnt(2)
v_mov_b32 v12, s68
v_mfma_f32_16x16x32_bf16 a[240:243], v[60:63], a[64:67], a[240:243]
s_barrier
v_mfma_f32_16x16x32_bf16 a[244:247], v[56:59], a[52:55], a[244:247]
ds_read_b128 v[48:51], v2 offset:0
v_mov_b32 v13, s69
v_mfma_f32_16x16x32_bf16 a[244:247], v[60:63], a[68:71], a[244:247]
s_add_u32 s53, s35, 262144
s_cmp_eq_u32 s4, 0
v_mfma_f32_16x16x32_bf16 a[248:251], v[56:59], a[56:59], a[248:251]
s_cselect_b32 s53, s53, 2146435072
s_lshl_b32 s23, s43, 7
v_mfma_f32_16x16x32_bf16 a[248:251], v[60:63], a[72:75], a[248:251]
ds_read_b128 v[52:55], v2 offset:1024
s_sub_u32 s53, s53, s23
v_mfma_f32_16x16x32_bf16 a[252:255], v[56:59], a[60:63], a[252:255]
buffer_store_dwordx2 v[12:13], v10, s[8:11], s53 offen sc1
v_mfma_f32_16x16x32_bf16 a[252:255], v[60:63], a[76:79], a[252:255]
v_accvgpr_read_b32 v214, a213
s_waitcnt lgkmcnt(4)
v_mfma_f32_16x16x32_bf16 a[240:243], v[64:67], a[80:83], a[240:243]
v_accvgpr_read_b32 v215, a229
v_cvt_pk_bf16_f32 v224, v208, v209
v_mfma_f32_16x16x32_bf16 a[240:243], v[68:71], a[96:99], a[240:243]
v_cvt_pk_bf16_f32 v225, v210, v211
v_cvt_pk_bf16_f32 v226, v212, v213
v_mfma_f32_16x16x32_bf16 a[244:247], v[64:67], a[84:87], a[244:247]
ds_read_b128 v[56:59], v2 offset:2048
v_cvt_pk_bf16_f32 v227, v214, v215
v_mfma_f32_16x16x32_bf16 a[244:247], v[68:71], a[100:103], a[244:247]
buffer_store_dwordx4 v[224:227], v252, s[8:11], s37 offen offset:2048 sc1
v_mfma_f32_16x16x32_bf16 a[248:251], v[64:67], a[88:91], a[248:251]
v_accvgpr_read_b32 v216, a182
v_accvgpr_read_b32 v217, a198
v_mfma_f32_16x16x32_bf16 a[248:251], v[68:71], a[104:107], a[248:251]
ds_read_b128 v[60:63], v2 offset:3072
v_accvgpr_read_b32 v218, a214
v_mfma_f32_16x16x32_bf16 a[252:255], v[64:67], a[92:95], a[252:255]
v_accvgpr_read_b32 v219, a230
v_accvgpr_read_b32 v220, a183
v_mfma_f32_16x16x32_bf16 a[252:255], v[68:71], a[108:111], a[252:255]
v_accvgpr_read_b32 v221, a199
s_waitcnt lgkmcnt(4)
v_mfma_f32_16x16x32_bf16 a[240:243], v[72:75], v[16:19], a[240:243]
v_accvgpr_read_b32 v222, a215
v_accvgpr_read_b32 v223, a231
v_mfma_f32_16x16x32_bf16 a[240:243], v[76:79], v[192:195], a[240:243]
v_cvt_pk_bf16_f32 v228, v216, v217
v_cvt_pk_bf16_f32 v229, v218, v219
v_mfma_f32_16x16x32_bf16 a[244:247], v[72:75], v[20:23], a[244:247]
ds_read_b128 v[64:67], v2 offset:4096
v_cvt_pk_bf16_f32 v230, v220, v221
v_mfma_f32_16x16x32_bf16 a[244:247], v[76:79], v[196:199], a[244:247]
v_cvt_pk_bf16_f32 v231, v222, v223
v_accvgpr_read_b32 v208, a184
v_mfma_f32_16x16x32_bf16 a[248:251], v[72:75], v[24:27], a[248:251]
buffer_store_dwordx4 v[228:231], v252, s[8:11], s37 offen offset:2304 sc1
v_mfma_f32_16x16x32_bf16 a[248:251], v[76:79], v[200:203], a[248:251]
ds_read_b128 v[68:71], v2 offset:5120
v_accvgpr_read_b32 v209, a200
v_mfma_f32_16x16x32_bf16 a[252:255], v[72:75], v[28:31], a[252:255]
v_accvgpr_read_b32 v210, a216
v_accvgpr_read_b32 v211, a232
v_mfma_f32_16x16x32_bf16 a[252:255], v[76:79], v[204:207], a[252:255]
v_accvgpr_read_b32 v212, a185
s_waitcnt lgkmcnt(4)
v_mfma_f32_16x16x32_bf16 a[240:243], v[48:51], v[32:35], a[240:243]
v_accvgpr_read_b32 v213, a201
v_accvgpr_read_b32 v214, a217
v_mfma_f32_16x16x32_bf16 a[240:243], v[52:55], v[80:83], a[240:243]
v_accvgpr_read_b32 v215, a233
v_cvt_pk_bf16_f32 v224, v208, v209
v_mfma_f32_16x16x32_bf16 a[244:247], v[48:51], v[36:39], a[244:247]
v_cvt_pk_bf16_f32 v225, v210, v211
v_cvt_pk_bf16_f32 v226, v212, v213
v_mfma_f32_16x16x32_bf16 a[244:247], v[52:55], v[84:87], a[244:247]
v_cvt_pk_bf16_f32 v227, v214, v215
v_accvgpr_read_b32 v216, a186
v_mfma_f32_16x16x32_bf16 a[248:251], v[48:51], v[40:43], a[248:251]
buffer_store_dwordx4 v[224:227], v252, s[8:11], s38 offen offset:2048 sc1
v_mfma_f32_16x16x32_bf16 a[248:251], v[52:55], v[88:91], a[248:251]
v_accvgpr_read_b32 v217, a202
v_accvgpr_read_b32 v218, a218
v_mfma_f32_16x16x32_bf16 a[252:255], v[48:51], v[44:47], a[252:255]
v_accvgpr_read_b32 v219, a234
v_accvgpr_read_b32 v220, a187
v_mfma_f32_16x16x32_bf16 a[252:255], v[52:55], v[92:95], a[252:255]
v_accvgpr_read_b32 v221, a203
s_waitcnt lgkmcnt(2)
v_mfma_f32_16x16x32_bf16 a[240:243], v[56:59], v[96:99], a[240:243]
v_accvgpr_read_b32 v222, a219
v_accvgpr_read_b32 v223, a235
v_mfma_f32_16x16x32_bf16 a[240:243], v[60:63], v[112:115], a[240:243]
v_cvt_pk_bf16_f32 v228, v216, v217
v_cvt_pk_bf16_f32 v229, v218, v219
v_mfma_f32_16x16x32_bf16 a[244:247], v[56:59], v[100:103], a[244:247]
v_cvt_pk_bf16_f32 v230, v220, v221
v_cvt_pk_bf16_f32 v231, v222, v223
v_mfma_f32_16x16x32_bf16 a[244:247], v[60:63], v[116:119], a[244:247]
buffer_store_dwordx4 v[228:231], v252, s[8:11], s38 offen offset:2304 sc1
v_mfma_f32_16x16x32_bf16 a[248:251], v[56:59], v[104:107], a[248:251]
v_accvgpr_read_b32 v208, a188
v_accvgpr_read_b32 v209, a204
v_mfma_f32_16x16x32_bf16 a[248:251], v[60:63], v[120:123], a[248:251]
v_accvgpr_read_b32 v210, a220
v_accvgpr_read_b32 v211, a236
v_mfma_f32_16x16x32_bf16 a[252:255], v[56:59], v[108:111], a[252:255]
v_accvgpr_read_b32 v212, a189
v_accvgpr_read_b32 v213, a205
v_mfma_f32_16x16x32_bf16 a[252:255], v[60:63], v[124:127], a[252:255]
v_accvgpr_read_b32 v214, a221
s_waitcnt lgkmcnt(0)
v_mfma_f32_16x16x32_bf16 a[240:243], v[64:67], v[128:131], a[240:243]
v_accvgpr_read_b32 v215, a237
v_cvt_pk_bf16_f32 v224, v208, v209
v_mfma_f32_16x16x32_bf16 a[240:243], v[68:71], v[232:235], a[240:243]
v_cvt_pk_bf16_f32 v225, v210, v211
v_cvt_pk_bf16_f32 v226, v212, v213
v_mfma_f32_16x16x32_bf16 a[244:247], v[64:67], v[132:135], a[244:247]
v_cvt_pk_bf16_f32 v227, v214, v215
v_accvgpr_read_b32 v216, a190
v_mfma_f32_16x16x32_bf16 a[244:247], v[68:71], v[236:239], a[244:247]
buffer_store_dwordx4 v[224:227], v252, s[8:11], s39 offen offset:2048 sc1
v_mfma_f32_16x16x32_bf16 a[248:251], v[64:67], v[136:139], a[248:251]
v_accvgpr_read_b32 v217, a206
v_accvgpr_read_b32 v218, a222
v_mfma_f32_16x16x32_bf16 a[248:251], v[68:71], v[240:243], a[248:251]
v_accvgpr_read_b32 v219, a238
v_accvgpr_read_b32 v220, a191
v_mfma_f32_16x16x32_bf16 a[252:255], v[64:67], v[140:143], a[252:255]
v_accvgpr_read_b32 v221, a207
v_accvgpr_read_b32 v222, a223
v_mfma_f32_16x16x32_bf16 a[252:255], v[68:71], v[244:247], a[252:255]
v_accvgpr_read_b32 v223, a239
v_cvt_pk_bf16_f32 v228, v216, v217
v_cvt_pk_bf16_f32 v229, v218, v219
v_cvt_pk_bf16_f32 v230, v220, v221
v_cvt_pk_bf16_f32 v231, v222, v223
buffer_store_dwordx4 v[228:231], v252, s[8:11], s39 offen offset:2304 sc1
v_accvgpr_read_b32 v208, a240
v_accvgpr_read_b32 v209, a241
v_accvgpr_read_b32 v210, a242
v_accvgpr_read_b32 v211, a243
v_accvgpr_read_b32 v212, a244
v_accvgpr_read_b32 v213, a245
v_accvgpr_read_b32 v214, a246
v_accvgpr_read_b32 v215, a247
v_cvt_pk_bf16_f32 v224, v208, v209
v_cvt_pk_bf16_f32 v225, v210, v211
v_cvt_pk_bf16_f32 v226, v212, v213
v_cvt_pk_bf16_f32 v227, v214, v215
s_nop 0
v_permlane16_swap_b32 v224, v226
v_permlane16_swap_b32 v225, v227
buffer_store_dwordx4 v[224:227], v9, s[8:11], s32 offen sc1
v_accvgpr_read_b32 v216, a248
v_accvgpr_read_b32 v217, a249
v_accvgpr_read_b32 v218, a250
v_accvgpr_read_b32 v219, a251
v_accvgpr_read_b32 v220, a252
v_accvgpr_read_b32 v221, a253
v_accvgpr_read_b32 v222, a254
v_accvgpr_read_b32 v223, a255
v_cvt_pk_bf16_f32 v228, v216, v217
v_cvt_pk_bf16_f32 v229, v218, v219
v_cvt_pk_bf16_f32 v230, v220, v221
v_cvt_pk_bf16_f32 v231, v222, v223
s_nop 0
v_permlane16_swap_b32 v228, v230
v_permlane16_swap_b32 v229, v231
buffer_store_dwordx4 v[228:231], v9, s[8:11], s33 offen sc1
s_mov_b32 s14, s35
s_cmp_eq_u32 s7, 1
s_cbranch_scc1 L_last
s_cmp_eq_u32 s4, 3
s_cbranch_scc1 L_r_side
v_and_b32 v6, 7, v1
v_lshrrev_b32 v7, 3, v1
s_and_b32 s23, s6, 1
s_lshl_b32 s23, s23, 3
v_add_u32 v8, s23, v6
v_lshlrev_b32 v8, 4, v8
v_lshl_add_u32 v4, v7, 8, v8
s_lshl_b32 s24, s5, 4
s_lshr_b32 s25, s6, 1
s_add_u32 s24, s24, s25
s_mul_i32 s20, s24, 18432
s_lshl_b32 s22, s4, 2
s_lshr_b32 s23, 1056, s22
s_and_b32 s23, s23, 15
s_lshl_b32 s24, s23, 11
s_add_u32 s28, s20, s24
s_lshr_b32 s23, 790, s22
s_and_b32 s23, s23, 15
s_lshl_b32 s24, s23, 11
s_add_u32 s29, s20, s24
s_lshr_b32 s23, 2165, s22
s_and_b32 s23, s23, 15
s_lshl_b32 s24, s23, 11
s_add_u32 s30, s20, s24
s_lshl_b32 s26, s5, 12
s_add_u32 s27, s26, 917504
s_add_u32 s26, s26, 655360
v_and_b32 v6, 31, v1
v_lshlrev_b32 v6, 7, v6
buffer_load_dwordx2 v[10:11], v6, s[8:11], s27 offen sc1
v_mov_b32 v13, 2146435072
v_cmp_gt_u32 vcc, 16, v0
v_lshlrev_b32 v14, 3, v0
s_nop 0
v_cndmask_b32 v13, v13, v14, vcc
v_mov_b32 v14, s68
v_mov_b32 v15, s69
s_waitcnt vmcnt(0)
s_barrier
buffer_store_dwordx2 v[14:15], v13, s[8:11], s14 offen sc1
s_add_u32 s24, s28, 37416960
buffer_load_dwordx4 v[16:19], v4, s[8:11], s24 offen sc1
s_add_u32 s25, s29, 37416960
buffer_load_dwordx4 v[20:23], v4, s[8:11], s25 offen sc1
s_add_u32 s24, s30, 37416960
buffer_load_dwordx4 v[24:27], v4, s[8:11], s24 offen sc1
v_cmp_eq_u64 vcc, s[68:69], v[10:11]
s_nop 0
s_cmp_eq_u64 vcc, exec
s_cbranch_scc0 L_re_slow4
L_re_back4:
s_add_u32 s25, s28, 80146432
buffer_load_dwordx4 v[28:31], v4, s[8:11], s25 offen sc1
s_add_u32 s24, s28, 82505728
buffer_load_dwordx4 v[40:43], v4, s[8:11], s24 offen sc1
s_add_u32 s25, s28, 84865024
buffer_load_dwordx4 v[52:55], v4, s[8:11], s25 offen sc1
s_add_u32 s24, s28, 87224320
buffer_load_dwordx4 v[64:67], v4, s[8:11], s24 offen sc1
s_add_u32 s25, s28, 89583616
buffer_load_dwordx4 v[76:79], v4, s[8:11], s25 offen sc1
s_add_u32 s24, s28, 91942912
buffer_load_dwordx4 v[88:91], v4, s[8:11], s24 offen sc1
s_add_u32 s25, s28, 94302208
buffer_load_dwordx4 v[100:103], v4, s[8:11], s25 offen sc1
s_add_u32 s24, s28, 96661504
buffer_load_dwordx4 v[112:115], v4, s[8:11], s24 offen sc1
s_mov_b32 s52, 0
L_poll6:
buffer_load_dwordx2 v[14:15], v6, s[8:11], s26 offen sc1
s_add_u32 s52, s52, 1
s_waitcnt vmcnt(0)
v_cmp_ne_u64 vcc, s[68:69], v[14:15]
s_cmp_ge_u32 s52, 1048576
s_cbranch_scc1 L_got6
s_and_b64 exec, exec, vcc
s_cbranch_execnz L_poll6
L_got6:
s_mov_b64 exec, -1
s_add_u32 s24, s29, 80146432
buffer_load_dwordx4 v[32:35], v4, s[8:11], s24 offen sc1
s_add_u32 s25, s30, 80146432
buffer_load_dwordx4 v[36:39], v4, s[8:11], s25 offen sc1
s_add_u32 s25, s29, 82505728
buffer_load_dwordx4 v[44:47], v4, s[8:11], s25 offen sc1
s_add_u32 s24, s30, 82505728
buffer_load_dwordx4 v[48:51], v4, s[8:11], s24 offen sc1
s_add_u32 s24, s29, 84865024
buffer_load_dwordx4 v[56:59], v4, s[8:11], s24 offen sc1
s_add_u32 s25, s30, 84865024
buffer_load_dwordx4 v[60:63], v4, s[8:11], s25 offen sc1
s_add_u32 s25, s29, 87224320
buffer_load_dwordx4 v[68:71], v4, s[8:11], s25 offen sc1
s_add_u32 s24, s30, 87224320
buffer_load_dwordx4 v[72:75], v4, s[8:11], s24 offen sc1
s_add_u32 s24, s29, 89583616
buffer_load_dwordx4 v[80:83], v4, s[8:11], s24 offen sc1
s_add_u32 s25, s30, 89583616
buffer_load_dwordx4 v[84:87], v4, s[8:11], s25 offen sc1
s_add_u32 s25, s29, 91942912
buffer_load_dwordx4 v[92:95], v4, s[8:11], s25 offen sc1
s_add_u32 s24, s30, 91942912
buffer_load_dwordx4 v[96:99], v4, s[8:11], s24 offen sc1
s_add_u32 s24, s29, 94302208
buffer_load_dwordx4 v[104:107], v4, s[8:11], s24 offen sc1
s_add_u32 s25, s30, 94302208
buffer_load_dwordx4 v[108:111], v4, s[8:11], s25 offen sc1
s_add_u32 s25, s29, 96661504
buffer_load_dwordx4 v[116:119], v4, s[8:11], s25 offen sc1
s_add_u32 s24, s30, 96661504
buffer_load_dwordx4 v[120:123], v4, s[8:11], s24 offen sc1
s_waitcnt vmcnt(26)
v_lshlrev_b32 v128, 16, v16
v_and_b32 v129, 0xffff0000, v16
v_lshlrev_b32 v130, 16, v17
v_and_b32 v131, 0xffff0000, v17
v_lshlrev_b32 v132, 16, v18
v_and_b32 v133, 0xffff0000, v18
v_lshlrev_b32 v134, 16, v19
v_and_b32 v135, 0xffff0000, v19
s_waitcnt vmcnt(25)
v_lshlrev_b32 v136, 16, v20
v_and_b32 v137, 0xffff0000, v20
v_lshlrev_b32 v138, 16, v21
v_and_b32 v139, 0xffff0000, v21
v_lshlrev_b32 v140, 16, v22
v_and_b32 v141, 0xffff0000, v22
v_lshlrev_b32 v142, 16, v23
v_and_b32 v143, 0xffff0000, v23
s_waitcnt vmcnt(24)
v_lshlrev_b32 v144, 16, v24
v_and_b32 v145, 0xffff0000, v24
v_lshlrev_b32 v146, 16, v25
v_and_b32 v147, 0xffff0000, v25
v_lshlrev_b32 v148, 16, v26
v_and_b32 v149, 0xffff0000, v26
v_lshlrev_b32 v150, 16, v27
v_and_b32 v151, 0xffff0000, v27
s_waitcnt vmcnt(23)
v_lshlrev_b32 v6, 16, v28
v_and_b32 v7, 0xffff0000, v28
v_add_f32 v128, v128, v6
v_add_f32 v129, v129, v7
v_lshlrev_b32 v8, 16, v29
v_and_b32 v9, 0xffff0000, v29
v_add_f32 v130, v130, v8
v_add_f32 v131, v131, v9
v_lshlrev_b32 v6, 16, v30
v_and_b32 v7, 0xffff0000, v30
v_add_f32 v132, v132, v6
v_add_f32 v133, v133, v7
v_lshlrev_b32 v8, 16, v31
v_and_b32 v9, 0xffff0000, v31
v_add_f32 v134, v134, v8
v_add_f32 v135, v135, v9
s_waitcnt vmcnt(22)
v_lshlrev_b32 v6, 16, v40
v_and_b32 v7, 0xffff0000, v40
v_add_f32 v128, v128, v6
v_add_f32 v129, v129, v7
v_lshlrev_b32 v8, 16, v41
v_and_b32 v9, 0xffff0000, v41
v_add_f32 v130, v130, v8
v_add_f32 v131, v131, v9
v_lshlrev_b32 v6, 16, v42
v_and_b32 v7, 0xffff0000, v42
v_add_f32 v132, v132, v6
v_add_f32 v133, v133, v7
v_lshlrev_b32 v8, 16, v43
v_and_b32 v9, 0xffff0000, v43
v_add_f32 v134, v134, v8
v_add_f32 v135, v135, v9
s_waitcnt vmcnt(21)
v_lshlrev_b32 v6, 16, v52
v_and_b32 v7, 0xffff0000, v52
v_add_f32 v128, v128, v6
v_add_f32 v129, v129, v7
v_lshlrev_b32 v8, 16, v53
v_and_b32 v9, 0xffff0000, v53
v_add_f32 v130, v130, v8
v_add_f32 v131, v131, v9
v_lshlrev_b32 v6, 16, v54
v_and_b32 v7, 0xffff0000, v54
v_add_f32 v132, v132, v6
v_add_f32 v133, v133, v7
v_lshlrev_b32 v8, 16, v55
v_and_b32 v9, 0xffff0000, v55
v_add_f32 v134, v134, v8
v_add_f32 v135, v135, v9
s_waitcnt vmcnt(20)
v_lshlrev_b32 v6, 16, v64
v_and_b32 v7, 0xffff0000, v64
v_add_f32 v128, v128, v6
v_add_f32 v129, v129, v7
v_lshlrev_b32 v8, 16, v65
v_and_b32 v9, 0xffff0000, v65
v_add_f32 v130, v130, v8
v_add_f32 v131, v131, v9
v_lshlrev_b32 v6, 16, v66
v_and_b32 v7, 0xffff0000, v66
v_add_f32 v132, v132, v6
v_add_f32 v133, v133, v7
v_lshlrev_b32 v8, 16, v67
v_and_b32 v9, 0xffff0000, v67
v_add_f32 v134, v134, v8
v_add_f32 v135, v135, v9
s_waitcnt vmcnt(19)
v_lshlrev_b32 v6, 16, v76
v_and_b32 v7, 0xffff0000, v76
v_add_f32 v128, v128, v6
v_add_f32 v129, v129, v7
v_lshlrev_b32 v8, 16, v77
v_and_b32 v9, 0xffff0000, v77
v_add_f32 v130, v130, v8
v_add_f32 v131, v131, v9
v_lshlrev_b32 v6, 16, v78
v_and_b32 v7, 0xffff0000, v78
v_add_f32 v132, v132, v6
v_add_f32 v133, v133, v7
v_lshlrev_b32 v8, 16, v79
v_and_b32 v9, 0xffff0000, v79
v_add_f32 v134, v134, v8
v_add_f32 v135, v135, v9
s_waitcnt vmcnt(18)
v_lshlrev_b32 v6, 16, v88
v_and_b32 v7, 0xffff0000, v88
v_add_f32 v128, v128, v6
v_add_f32 v129, v129, v7
v_lshlrev_b32 v8, 16, v89
v_and_b32 v9, 0xffff0000, v89
v_add_f32 v130, v130, v8
v_add_f32 v131, v131, v9
v_lshlrev_b32 v6, 16, v90
v_and_b32 v7, 0xffff0000, v90
v_add_f32 v132, v132, v6
v_add_f32 v133, v133, v7
v_lshlrev_b32 v8, 16, v91
v_and_b32 v9, 0xffff0000, v91
v_add_f32 v134, v134, v8
v_add_f32 v135, v135, v9
s_waitcnt vmcnt(17)
v_lshlrev_b32 v6, 16, v100
v_and_b32 v7, 0xffff0000, v100
v_add_f32 v128, v128, v6
v_add_f32 v129, v129, v7
v_lshlrev_b32 v8, 16, v101
v_and_b32 v9, 0xffff0000, v101
v_add_f32 v130, v130, v8
v_add_f32 v131, v131, v9
v_lshlrev_b32 v6, 16, v102
v_and_b32 v7, 0xffff0000, v102
v_add_f32 v132, v132, v6
v_add_f32 v133, v133, v7
v_lshlrev_b32 v8, 16, v103
v_and_b32 v9, 0xffff0000, v103
v_add_f32 v134, v134, v8
v_add_f32 v135, v135, v9
s_waitcnt vmcnt(16)
v_lshlrev_b32 v6, 16, v112
v_and_b32 v7, 0xffff0000, v112
v_add_f32 v128, v128, v6
v_add_f32 v129, v129, v7
v_lshlrev_b32 v8, 16, v113
v_and_b32 v9, 0xffff0000, v113
v_add_f32 v130, v130, v8
v_add_f32 v131, v131, v9
v_lshlrev_b32 v6, 16, v114
v_and_b32 v7, 0xffff0000, v114
v_add_f32 v132, v132, v6
v_add_f32 v133, v133, v7
v_lshlrev_b32 v8, 16, v115
v_and_b32 v9, 0xffff0000, v115
v_add_f32 v134, v134, v8
v_add_f32 v135, v135, v9
s_waitcnt vmcnt(15)
v_lshlrev_b32 v6, 16, v32
v_and_b32 v7, 0xffff0000, v32
v_add_f32 v136, v136, v6
v_add_f32 v137, v137, v7
v_lshlrev_b32 v8, 16, v33
v_and_b32 v9, 0xffff0000, v33
v_add_f32 v138, v138, v8
v_add_f32 v139, v139, v9
v_lshlrev_b32 v6, 16, v34
v_and_b32 v7, 0xffff0000, v34
v_add_f32 v140, v140, v6
v_add_f32 v141, v141, v7
v_lshlrev_b32 v8, 16, v35
v_and_b32 v9, 0xffff0000, v35
v_add_f32 v142, v142, v8
v_add_f32 v143, v143, v9
s_waitcnt vmcnt(14)
v_lshlrev_b32 v6, 16, v36
v_and_b32 v7, 0xffff0000, v36
v_add_f32 v144, v144, v6
v_add_f32 v145, v145, v7
v_lshlrev_b32 v8, 16, v37
v_and_b32 v9, 0xffff0000, v37
v_add_f32 v146, v146, v8
v_add_f32 v147, v147, v9
v_lshlrev_b32 v6, 16, v38
v_and_b32 v7, 0xffff0000, v38
v_add_f32 v148, v148, v6
v_add_f32 v149, v149, v7
v_lshlrev_b32 v8, 16, v39
v_and_b32 v9, 0xffff0000, v39
v_add_f32 v150, v150, v8
v_add_f32 v151, v151, v9
s_waitcnt vmcnt(13)
v_lshlrev_b32 v6, 16, v44
v_and_b32 v7, 0xffff0000, v44
v_add_f32 v136, v136, v6
v_add_f32 v137, v137, v7
v_lshlrev_b32 v8, 16, v45
v_and_b32 v9, 0xffff0000, v45
v_add_f32 v138, v138, v8
v_add_f32 v139, v139, v9
v_lshlrev_b32 v6, 16, v46
v_and_b32 v7, 0xffff0000, v46
v_add_f32 v140, v140, v6
v_add_f32 v141, v141, v7
v_lshlrev_b32 v8, 16, v47
v_and_b32 v9, 0xffff0000, v47
v_add_f32 v142, v142, v8
v_add_f32 v143, v143, v9
s_waitcnt vmcnt(12)
v_lshlrev_b32 v6, 16, v48
v_and_b32 v7, 0xffff0000, v48
v_add_f32 v144, v144, v6
v_add_f32 v145, v145, v7
v_lshlrev_b32 v8, 16, v49
v_and_b32 v9, 0xffff0000, v49
v_add_f32 v146, v146, v8
v_add_f32 v147, v147, v9
v_lshlrev_b32 v6, 16, v50
v_and_b32 v7, 0xffff0000, v50
v_add_f32 v148, v148, v6
v_add_f32 v149, v149, v7
v_lshlrev_b32 v8, 16, v51
v_and_b32 v9, 0xffff0000, v51
v_add_f32 v150, v150, v8
v_add_f32 v151, v151, v9
s_waitcnt vmcnt(11)
v_lshlrev_b32 v6, 16, v56
v_and_b32 v7, 0xffff0000, v56
v_add_f32 v136, v136, v6
v_add_f32 v137, v137, v7
v_lshlrev_b32 v8, 16, v57
v_and_b32 v9, 0xffff0000, v57
v_add_f32 v138, v138, v8
v_add_f32 v139, v139, v9
v_lshlrev_b32 v6, 16, v58
v_and_b32 v7, 0xffff0000, v58
v_add_f32 v140, v140, v6
v_add_f32 v141, v141, v7
v_lshlrev_b32 v8, 16, v59
v_and_b32 v9, 0xffff0000, v59
v_add_f32 v142, v142, v8
v_add_f32 v143, v143, v9
s_waitcnt vmcnt(10)
v_lshlrev_b32 v6, 16, v60
v_and_b32 v7, 0xffff0000, v60
v_add_f32 v144, v144, v6
v_add_f32 v145, v145, v7
v_lshlrev_b32 v8, 16, v61
v_and_b32 v9, 0xffff0000, v61
v_add_f32 v146, v146, v8
v_add_f32 v147, v147, v9
v_lshlrev_b32 v6, 16, v62
v_and_b32 v7, 0xffff0000, v62
v_add_f32 v148, v148, v6
v_add_f32 v149, v149, v7
v_lshlrev_b32 v8, 16, v63
v_and_b32 v9, 0xffff0000, v63
v_add_f32 v150, v150, v8
v_add_f32 v151, v151, v9
s_waitcnt vmcnt(9)
v_lshlrev_b32 v6, 16, v68
v_and_b32 v7, 0xffff0000, v68
v_add_f32 v136, v136, v6
v_add_f32 v137, v137, v7
v_lshlrev_b32 v8, 16, v69
v_and_b32 v9, 0xffff0000, v69
v_add_f32 v138, v138, v8
v_add_f32 v139, v139, v9
v_lshlrev_b32 v6, 16, v70
v_and_b32 v7, 0xffff0000, v70
v_add_f32 v140, v140, v6
v_add_f32 v141, v141, v7
v_lshlrev_b32 v8, 16, v71
v_and_b32 v9, 0xffff0000, v71
v_add_f32 v142, v142, v8
v_add_f32 v143, v143, v9
s_waitcnt vmcnt(8)
v_lshlrev_b32 v6, 16, v72
v_and_b32 v7, 0xffff0000, v72
v_add_f32 v144, v144, v6
v_add_f32 v145, v145, v7
v_lshlrev_b32 v8, 16, v73
v_and_b32 v9, 0xffff0000, v73
v_add_f32 v146, v146, v8
v_add_f32 v147, v147, v9
v_lshlrev_b32 v6, 16, v74
v_and_b32 v7, 0xffff0000, v74
v_add_f32 v148, v148, v6
v_add_f32 v149, v149, v7
v_lshlrev_b32 v8, 16, v75
v_and_b32 v9, 0xffff0000, v75
v_add_f32 v150, v150, v8
v_add_f32 v151, v151, v9
s_waitcnt vmcnt(7)
v_lshlrev_b32 v6, 16, v80
v_and_b32 v7, 0xffff0000, v80
v_add_f32 v136, v136, v6
v_add_f32 v137, v137, v7
v_lshlrev_b32 v8, 16, v81
v_and_b32 v9, 0xffff0000, v81
v_add_f32 v138, v138, v8
v_add_f32 v139, v139, v9
v_lshlrev_b32 v6, 16, v82
v_and_b32 v7, 0xffff0000, v82
v_add_f32 v140, v140, v6
v_add_f32 v141, v141, v7
v_lshlrev_b32 v8, 16, v83
v_and_b32 v9, 0xffff0000, v83
v_add_f32 v142, v142, v8
v_add_f32 v143, v143, v9
s_waitcnt vmcnt(6)
v_lshlrev_b32 v6, 16, v84
v_and_b32 v7, 0xffff0000, v84
v_add_f32 v144, v144, v6
v_add_f32 v145, v145, v7
v_lshlrev_b32 v8, 16, v85
v_and_b32 v9, 0xffff0000, v85
v_add_f32 v146, v146, v8
v_add_f32 v147, v147, v9
v_lshlrev_b32 v6, 16, v86
v_and_b32 v7, 0xffff0000, v86
v_add_f32 v148, v148, v6
v_add_f32 v149, v149, v7
v_lshlrev_b32 v8, 16, v87
v_and_b32 v9, 0xffff0000, v87
v_add_f32 v150, v150, v8
v_add_f32 v151, v151, v9
s_waitcnt vmcnt(5)
v_lshlrev_b32 v6, 16, v92
v_and_b32 v7, 0xffff0000, v92
v_add_f32 v136, v136, v6
v_add_f32 v137, v137, v7
v_lshlrev_b32 v8, 16, v93
v_and_b32 v9, 0xffff0000, v93
v_add_f32 v138, v138, v8
v_add_f32 v139, v139, v9
v_lshlrev_b32 v6, 16, v94
v_and_b32 v7, 0xffff0000, v94
v_add_f32 v140, v140, v6
v_add_f32 v141, v141, v7
v_lshlrev_b32 v8, 16, v95
v_and_b32 v9, 0xffff0000, v95
v_add_f32 v142, v142, v8
v_add_f32 v143, v143, v9
s_waitcnt vmcnt(4)
v_lshlrev_b32 v6, 16, v96
v_and_b32 v7, 0xffff0000, v96
v_add_f32 v144, v144, v6
v_add_f32 v145, v145, v7
v_lshlrev_b32 v8, 16, v97
v_and_b32 v9, 0xffff0000, v97
v_add_f32 v146, v146, v8
v_add_f32 v147, v147, v9
v_lshlrev_b32 v6, 16, v98
v_and_b32 v7, 0xffff0000, v98
v_add_f32 v148, v148, v6
v_add_f32 v149, v149, v7
v_lshlrev_b32 v8, 16, v99
v_and_b32 v9, 0xffff0000, v99
v_add_f32 v150, v150, v8
v_add_f32 v151, v151, v9
s_waitcnt vmcnt(3)
v_lshlrev_b32 v6, 16, v104
v_and_b32 v7, 0xffff0000, v104
v_add_f32 v136, v136, v6
v_add_f32 v137, v137, v7
v_lshlrev_b32 v8, 16, v105
v_and_b32 v9, 0xffff0000, v105
v_add_f32 v138, v138, v8
v_add_f32 v139, v139, v9
v_lshlrev_b32 v6, 16, v106
v_and_b32 v7, 0xffff0000, v106
v_add_f32 v140, v140, v6
v_add_f32 v141, v141, v7
v_lshlrev_b32 v8, 16, v107
v_and_b32 v9, 0xffff0000, v107
v_add_f32 v142, v142, v8
v_add_f32 v143, v143, v9
s_waitcnt vmcnt(2)
v_lshlrev_b32 v6, 16, v108
v_and_b32 v7, 0xffff0000, v108
v_add_f32 v144, v144, v6
v_add_f32 v145, v145, v7
v_lshlrev_b32 v8, 16, v109
v_and_b32 v9, 0xffff0000, v109
v_add_f32 v146, v146, v8
v_add_f32 v147, v147, v9
v_lshlrev_b32 v6, 16, v110
v_and_b32 v7, 0xffff0000, v110
v_add_f32 v148, v148, v6
v_add_f32 v149, v149, v7
v_lshlrev_b32 v8, 16, v111
v_and_b32 v9, 0xffff0000, v111
v_add_f32 v150, v150, v8
v_add_f32 v151, v151, v9
s_waitcnt vmcnt(1)
v_lshlrev_b32 v6, 16, v116
v_and_b32 v7, 0xffff0000, v116
v_add_f32 v136, v136, v6
v_add_f32 v137, v137, v7
v_lshlrev_b32 v8, 16, v117
v_and_b32 v9, 0xffff0000, v117
v_add_f32 v138, v138, v8
v_add_f32 v139, v139, v9
v_lshlrev_b32 v6, 16, v118
v_and_b32 v7, 0xffff0000, v118
v_add_f32 v140, v140, v6
v_add_f32 v141, v141, v7
v_lshlrev_b32 v8, 16, v119
v_and_b32 v9, 0xffff0000, v119
v_add_f32 v142, v142, v8
v_add_f32 v143, v143, v9
s_waitcnt vmcnt(0)
v_lshlrev_b32 v6, 16, v120
v_and_b32 v7, 0xffff0000, v120
v_add_f32 v144, v144, v6
v_add_f32 v145, v145, v7
v_lshlrev_b32 v8, 16, v121
v_and_b32 v9, 0xffff0000, v121
v_add_f32 v146, v146, v8
v_add_f32 v147, v147, v9
v_lshlrev_b32 v6, 16, v122
v_and_b32 v7, 0xffff0000, v122
v_add_f32 v148, v148, v6
v_add_f32 v149, v149, v7
v_lshlrev_b32 v8, 16, v123
v_and_b32 v9, 0xffff0000, v123
v_add_f32 v150, v150, v8
v_add_f32 v151, v151, v9
v_cvt_pk_bf16_f32 v152, v128, v129
v_cvt_pk_bf16_f32 v153, v130, v131
v_cvt_pk_bf16_f32 v154, v132, v133
v_cvt_pk_bf16_f32 v155, v134, v135
v_cvt_pk_bf16_f32 v156, v136, v137
v_cvt_pk_bf16_f32 v157, v138, v139
v_cvt_pk_bf16_f32 v158, v140, v141
v_cvt_pk_bf16_f32 v159, v142, v143
v_cvt_pk_bf16_f32 v160, v144, v145
v_cvt_pk_bf16_f32 v161, v146, v147
v_cvt_pk_bf16_f32 v162, v148, v149
v_cvt_pk_bf16_f32 v163, v150, v151
v_add_f32 v6, v128, v129
v_mul_f32 v7, v128, v128
v_mul_f32 v9, v129, v129
v_mov_b32 v8, 0
v_add_f32 v6, v6, v130
v_add_f32 v8, v8, v131
v_fmac_f32 v7, v130, v130
v_fmac_f32 v9, v131, v131
v_add_f32 v6, v6, v132
v_add_f32 v8, v8, v133
v_fmac_f32 v7, v132, v132
v_fmac_f32 v9, v133, v133
v_add_f32 v6, v6, v134
v_add_f32 v8, v8, v135
v_fmac_f32 v7, v134, v134
v_fmac_f32 v9, v135, v135
v_add_f32 v6, v6, v136
v_add_f32 v8, v8, v137
v_fmac_f32 v7, v136, v136
v_fmac_f32 v9, v137, v137
v_add_f32 v6, v6, v138
v_add_f32 v8, v8, v139
v_fmac_f32 v7, v138, v138
v_fmac_f32 v9, v139, v139
v_add_f32 v6, v6, v140
v_add_f32 v8, v8, v141
v_fmac_f32 v7, v140, v140
v_fmac_f32 v9, v141, v141
v_add_f32 v6, v6, v142
v_add_f32 v8, v8, v143
v_fmac_f32 v7, v142, v142
v_fmac_f32 v9, v143, v143
v_add_f32 v6, v6, v144
v_add_f32 v8, v8, v145
v_fmac_f32 v7, v144, v144
v_fmac_f32 v9, v145, v145
v_add_f32 v6, v6, v146
v_add_f32 v8, v8, v147
v_fmac_f32 v7, v146, v146
v_fmac_f32 v9, v147, v147
v_add_f32 v6, v6, v148
v_add_f32 v8, v8, v149
v_fmac_f32 v7, v148, v148
v_fmac_f32 v9, v149, v149
v_add_f32 v6, v6, v150
v_add_f32 v8, v8, v151
v_fmac_f32 v7, v150, v150
v_fmac_f32 v9, v151, v151
v_add_f32 v6, v6, v8
v_add_f32 v7, v7, v9
s_nop 0
v_add_f32_dpp v6, v6, v6 row_ror:8 row_mask:0xf bank_mask:0xf
v_add_f32_dpp v7, v7, v7 row_ror:8 row_mask:0xf bank_mask:0xf
v_mov_b32 v8, v6
v_mov_b32 v9, v7
s_nop 0
v_permlane16_swap_b32 v6, v8
v_permlane16_swap_b32 v7, v9
v_add_f32 v6, v6, v8
v_add_f32 v7, v7, v9
v_mov_b32 v8, v6
v_mov_b32 v9, v7
s_nop 0
v_permlane32_swap_b32 v6, v8
v_permlane32_swap_b32 v7, v9
v_add_f32 v6, v6, v8
v_add_f32 v7, v7, v9
v_and_b32 v10, 7, v1
v_lshlrev_b32 v10, 3, v10
v_add_u32 v10, 147456, v10
s_lshl_b32 s24, s4, 6
v_add_u32 v11, s24, v10
ds_write_b64 v11, v[6:7]
s_add_u32 s24, s28, 30339072
buffer_store_dwordx4 v[152:155], v4, s[8:11], s24 offen sc1
s_add_u32 s25, s29, 30339072
buffer_store_dwordx4 v[156:159], v4, s[8:11], s25 offen sc1
s_add_u32 s24, s30, 30339072
buffer_store_dwordx4 v[160:163], v4, s[8:11], s24 offen sc1
s_waitcnt lgkmcnt(0)
s_barrier
ds_read_b64 v[6:7], v10
ds_read_b64 v[8:9], v10 offset:64
ds_read_b64 v[12:13], v10 offset:128
s_waitcnt lgkmcnt(0)
v_add_f32 v6, v6, v8
v_add_f32 v7, v7, v9
v_add_f32 v6, v6, v12
v_add_f32 v7, v7, v13
v_mul_f32 v6, 0x3ae38e39, v6
v_mul_f32 v7, 0x3ae38e39, v7
v_fma_f32 v7, -v6, v6, v7
v_max_f32 v7, 0, v7
v_add_f32 v7, 0x3727c5ac, v7
v_rsq_f32 v7, v7
s_nop 0
v_mul_f32 v6, v6, v7
v_fma_f32 v128, v128, v7, -v6
v_fma_f32 v129, v129, v7, -v6
v_fma_f32 v130, v130, v7, -v6
v_fma_f32 v131, v131, v7, -v6
v_fma_f32 v132, v132, v7, -v6
v_fma_f32 v133, v133, v7, -v6
v_fma_f32 v134, v134, v7, -v6
v_fma_f32 v135, v135, v7, -v6
v_cvt_pk_bf16_f32 v168, v128, v129
v_cvt_pk_bf16_f32 v169, v130, v131
v_cvt_pk_bf16_f32 v170, v132, v133
v_cvt_pk_bf16_f32 v171, v134, v135
s_add_u32 s24, s28, 25620480
buffer_store_dwordx4 v[168:171], v4, s[8:11], s24 offen sc1
v_fma_f32 v136, v136, v7, -v6
v_fma_f32 v137, v137, v7, -v6
v_fma_f32 v138, v138, v7, -v6
v_fma_f32 v139, v139, v7, -v6
v_fma_f32 v140, v140, v7, -v6
v_fma_f32 v141, v141, v7, -v6
v_fma_f32 v142, v142, v7, -v6
v_fma_f32 v143, v143, v7, -v6
v_cvt_pk_bf16_f32 v172, v136, v137
v_cvt_pk_bf16_f32 v173, v138, v139
v_cvt_pk_bf16_f32 v174, v140, v141
v_cvt_pk_bf16_f32 v175, v142, v143
s_add_u32 s25, s29, 25620480
buffer_store_dwordx4 v[172:175], v4, s[8:11], s25 offen sc1
v_fma_f32 v144, v144, v7, -v6
v_fma_f32 v145, v145, v7, -v6
v_fma_f32 v146, v146, v7, -v6
v_fma_f32 v147, v147, v7, -v6
v_fma_f32 v148, v148, v7, -v6
v_fma_f32 v149, v149, v7, -v6
v_fma_f32 v150, v150, v7, -v6
v_fma_f32 v151, v151, v7, -v6
v_cvt_pk_bf16_f32 v176, v144, v145
v_cvt_pk_bf16_f32 v177, v146, v147
v_cvt_pk_bf16_f32 v178, v148, v149
v_cvt_pk_bf16_f32 v179, v150, v151
s_add_u32 s24, s30, 25620480
buffer_store_dwordx4 v[176:179], v4, s[8:11], s24 offen sc1
s_lshl_b32 s24, s5, 5
s_add_u32 s24, s24, s6
s_lshl_b32 s14, s24, 7
s_add_u32 s14, s14, 1835008
s_branch L_r_done
L_r_side:
v_mov_b32 v13, 2146435072
v_cmp_gt_u32 vcc, 16, v0
v_lshlrev_b32 v14, 3, v0
s_nop 0
v_cndmask_b32 v13, v13, v14, vcc
v_mov_b32 v14, s68
v_mov_b32 v15, s69
s_waitcnt vmcnt(0)
s_barrier
buffer_store_dwordx2 v[14:15], v13, s[8:11], s14 offen sc1
s_lshr_b32 s20, s5, 2
s_lshl_b32 s20, s20, 3
s_lshr_b32 s21, s6, 2
s_add_u32 s20, s20, s21
s_and_b32 s21, s5, 3
s_lshl_b32 s21, s21, 2
s_and_b32 s22, s6, 3
s_add_u32 s21, s21, s22
s_mul_i32 s32, s21, 147456
s_add_u32 s32, s32, 4198400
s_mul_i32 s33, s4, 0
s_add_u32 s32, s32, s33
s_add_u32 m0, s33, 0
s_add_u32 s40, s32, 0
buffer_load_dwordx4 v2, s[8:11], s40 offen offset:0 sc1 lds
buffer_load_dwordx4 v2, s[8:11], s40 offen offset:1024 sc1 lds
buffer_load_dwordx4 v2, s[8:11], s40 offen offset:2048 sc1 lds
buffer_load_dwordx4 v2, s[8:11], s40 offen offset:3072 sc1 lds
s_add_u32 m0, s33, 4096
s_add_u32 s40, s32, 4096
buffer_load_dwordx4 v2, s[8:11], s40 offen offset:0 sc1 lds
buffer_load_dwordx4 v2, s[8:11], s40 offen offset:1024 sc1 lds
buffer_load_dwordx4 v2, s[8:11], s40 offen offset:2048 sc1 lds
buffer_load_dwordx4 v2, s[8:11], s40 offen offset:3072 sc1 lds
s_add_u32 m0, s33, 8192
s_add_u32 s40, s32, 8192
buffer_load_dwordx4 v2, s[8:11], s40 offen offset:0 sc1 lds
buffer_load_dwordx4 v2, s[8:11], s40 offen offset:1024 sc1 lds
buffer_load_dwordx4 v2, s[8:11], s40 offen offset:2048 sc1 lds
buffer_load_dwordx4 v2, s[8:11], s40 offen offset:3072 sc1 lds
s_add_u32 m0, s33, 12288
s_add_u32 s40, s32, 12288
buffer_load_dwordx4 v2, s[8:11], s40 offen offset:0 sc1 lds
buffer_load_dwordx4 v2, s[8:11], s40 offen offset:1024 sc1 lds
buffer_load_dwordx4 v2, s[8:11], s40 offen offset:2048 sc1 lds
buffer_load_dwordx4 v2, s[8:11], s40 offen offset:3072 sc1 lds
s_add_u32 m0, s33, 16384
s_add_u32 s40, s32, 16384
buffer_load_dwordx4 v2, s[8:11], s40 offen offset:0 sc1 lds
buffer_load_dwordx4 v2, s[8:11], s40 offen offset:1024 sc1 lds
buffer_load_dwordx4 v2, s[8:11], s40 offen offset:2048 sc1 lds
buffer_load_dwordx4 v2, s[8:11], s40 offen offset:3072 sc1 lds
s_add_u32 m0, s33, 20480
s_add_u32 s40, s32, 20480
buffer_load_dwordx4 v2, s[8:11], s40 offen offset:0 sc1 lds
buffer_load_dwordx4 v2, s[8:11], s40 offen offset:1024 sc1 lds
buffer_load_dwordx4 v2, s[8:11], s40 offen offset:2048 sc1 lds
buffer_load_dwordx4 v2, s[8:11], s40 offen offset:3072 sc1 lds
s_add_u32 m0, s33, 24576
s_add_u32 s40, s32, 24576
buffer_load_dwordx4 v2, s[8:11], s40 offen offset:0 sc1 lds
buffer_load_dwordx4 v2, s[8:11], s40 offen offset:1024 sc1 lds
buffer_load_dwordx4 v2, s[8:11], s40 offen offset:2048 sc1 lds
buffer_load_dwordx4 v2, s[8:11], s40 offen offset:3072 sc1 lds
s_add_u32 m0, s33, 28672
s_add_u32 s40, s32, 28672
buffer_load_dwordx4 v2, s[8:11], s40 offen offset:0 sc1 lds
buffer_load_dwordx4 v2, s[8:11], s40 offen offset:1024 sc1 lds
buffer_load_dwordx4 v2, s[8:11], s40 offen offset:2048 sc1 lds
buffer_load_dwordx4 v2, s[8:11], s40 offen offset:3072 sc1 lds
s_add_u32 m0, s33, 32768
s_add_u32 s40, s32, 32768
buffer_load_dwordx4 v2, s[8:11], s40 offen offset:0 sc1 lds
buffer_load_dwordx4 v2, s[8:11], s40 offen offset:1024 sc1 lds
buffer_load_dwordx4 v2, s[8:11], s40 offen offset:2048 sc1 lds
buffer_load_dwordx4 v2, s[8:11], s40 offen offset:3072 sc1 lds
s_add_u32 m0, s33, 36864
s_add_u32 s40, s32, 36864
buffer_load_dwordx4 v2, s[8:11], s40 offen offset:0 sc1 lds
buffer_load_dwordx4 v2, s[8:11], s40 offen offset:1024 sc1 lds
buffer_load_dwordx4 v2, s[8:11], s40 offen offset:2048 sc1 lds
buffer_load_dwordx4 v2, s[8:11], s40 offen offset:3072 sc1 lds
s_add_u32 m0, s33, 40960
s_add_u32 s40, s32, 40960
buffer_load_dwordx4 v2, s[8:11], s40 offen offset:0 sc1 lds
buffer_load_dwordx4 v2, s[8:11], s40 offen offset:1024 sc1 lds
buffer_load_dwordx4 v2, s[8:11], s40 offen offset:2048 sc1 lds
buffer_load_dwordx4 v2, s[8:11], s40 offen offset:3072 sc1 lds
s_add_u32 m0, s33, 45056
s_add_u32 s40, s32, 45056
buffer_load_dwordx4 v2, s[8:11], s40 offen offset:0 sc1 lds
buffer_load_dwordx4 v2, s[8:11], s40 offen offset:1024 sc1 lds
buffer_load_dwordx4 v2, s[8:11], s40 offen offset:2048 sc1 lds
buffer_load_dwordx4 v2, s[8:11], s40 offen offset:3072 sc1 lds
s_add_u32 m0, s33, 49152
s_add_u32 s40, s32, 49152
buffer_load_dwordx4 v2, s[8:11], s40 offen offset:0 sc1 lds
buffer_load_dwordx4 v2, s[8:11], s40 offen offset:1024 sc1 lds
buffer_load_dwordx4 v2, s[8:11], s40 offen offset:2048 sc1 lds
buffer_load_dwordx4 v2, s[8:11], s40 offen offset:3072 sc1 lds
s_add_u32 m0, s33, 53248
s_add_u32 s40, s32, 53248
buffer_load_dwordx4 v2, s[8:11], s40 offen offset:0 sc1 lds
buffer_load_dwordx4 v2, s[8:11], s40 offen offset:1024 sc1 lds
buffer_load_dwordx4 v2, s[8:11], s40 offen offset:2048 sc1 lds
buffer_load_dwordx4 v2, s[8:11], s40 offen offset:3072 sc1 lds
s_add_u32 m0, s33, 57344
s_add_u32 s40, s32, 57344
buffer_load_dwordx4 v2, s[8:11], s40 offen offset:0 sc1 lds
buffer_load_dwordx4 v2, s[8:11], s40 offen offset:1024 sc1 lds
buffer_load_dwordx4 v2, s[8:11], s40 offen offset:2048 sc1 lds
buffer_load_dwordx4 v2, s[8:11], s40 offen offset:3072 sc1 lds
s_add_u32 m0, s33, 61440
s_add_u32 s40, s32, 61440
buffer_load_dwordx4 v2, s[8:11], s40 offen offset:0 sc1 lds
buffer_load_dwordx4 v2, s[8:11], s40 offen offset:1024 sc1 lds
buffer_load_dwordx4 v2, s[8:11], s40 offen offset:2048 sc1 lds
buffer_load_dwordx4 v2, s[8:11], s40 offen offset:3072 sc1 lds
s_add_u32 m0, s33, 65536
s_add_u32 s40, s32, 65536
buffer_load_dwordx4 v2, s[8:11], s40 offen offset:0 sc1 lds
buffer_load_dwordx4 v2, s[8:11], s40 offen offset:1024 sc1 lds
buffer_load_dwordx4 v2, s[8:11], s40 offen offset:2048 sc1 lds
buffer_load_dwordx4 v2, s[8:11], s40 offen offset:3072 sc1 lds
s_add_u32 m0, s33, 69632
s_add_u32 s40, s32, 69632
buffer_load_dwordx4 v2, s[8:11], s40 offen offset:0 sc1 lds
buffer_load_dwordx4 v2, s[8:11], s40 offen offset:1024 sc1 lds
buffer_load_dwordx4 v2, s[8:11], s40 offen offset:2048 sc1 lds
buffer_load_dwordx4 v2, s[8:11], s40 offen offset:3072 sc1 lds
s_add_u32 m0, s33, 73728
s_add_u32 s40, s32, 73728
buffer_load_dwordx4 v2, s[8:11], s40 offen offset:0 sc1 lds
buffer_load_dwordx4 v2, s[8:11], s40 offen offset:1024 sc1 lds
buffer_load_dwordx4 v2, s[8:11], s40 offen offset:2048 sc1 lds
buffer_load_dwordx4 v2, s[8:11], s40 offen offset:3072 sc1 lds
s_add_u32 m0, s33, 77824
s_add_u32 s40, s32, 77824
buffer_load_dwordx4 v2, s[8:11], s40 offen offset:0 sc1 lds
buffer_load_dwordx4 v2, s[8:11], s40 offen offset:1024 sc1 lds
buffer_load_dwordx4 v2, s[8:11], s40 offen offset:2048 sc1 lds
buffer_load_dwordx4 v2, s[8:11], s40 offen offset:3072 sc1 lds
s_add_u32 m0, s33, 81920
s_add_u32 s40, s32, 81920
buffer_load_dwordx4 v2, s[8:11], s40 offen offset:0 sc1 lds
buffer_load_dwordx4 v2, s[8:11], s40 offen offset:1024 sc1 lds
buffer_load_dwordx4 v2, s[8:11], s40 offen offset:2048 sc1 lds
buffer_load_dwordx4 v2, s[8:11], s40 offen offset:3072 sc1 lds
s_add_u32 m0, s33, 86016
s_add_u32 s40, s32, 86016
buffer_load_dwordx4 v2, s[8:11], s40 offen offset:0 sc1 lds
buffer_load_dwordx4 v2, s[8:11], s40 offen offset:1024 sc1 lds
buffer_load_dwordx4 v2, s[8:11], s40 offen offset:2048 sc1 lds
buffer_load_dwordx4 v2, s[8:11], s40 offen offset:3072 sc1 lds
s_add_u32 m0, s33, 90112
s_add_u32 s40, s32, 90112
buffer_load_dwordx4 v2, s[8:11], s40 offen offset:0 sc1 lds
buffer_load_dwordx4 v2, s[8:11], s40 offen offset:1024 sc1 lds
buffer_load_dwordx4 v2, s[8:11], s40 offen offset:2048 sc1 lds
buffer_load_dwordx4 v2, s[8:11], s40 offen offset:3072 sc1 lds
s_add_u32 m0, s33, 94208
s_add_u32 s40, s32, 94208
buffer_load_dwordx4 v2, s[8:11], s40 offen offset:0 sc1 lds
buffer_load_dwordx4 v2, s[8:11], s40 offen offset:1024 sc1 lds
buffer_load_dwordx4 v2, s[8:11], s40 offen offset:2048 sc1 lds
buffer_load_dwordx4 v2, s[8:11], s40 offen offset:3072 sc1 lds
s_add_u32 m0, s33, 98304
s_add_u32 s40, s32, 98304
buffer_load_dwordx4 v2, s[8:11], s40 offen offset:0 sc1 lds
buffer_load_dwordx4 v2, s[8:11], s40 offen offset:1024 sc1 lds
buffer_load_dwordx4 v2, s[8:11], s40 offen offset:2048 sc1 lds
buffer_load_dwordx4 v2, s[8:11], s40 offen offset:3072 sc1 lds
s_add_u32 m0, s33, 102400
s_add_u32 s40, s32, 102400
buffer_load_dwordx4 v2, s[8:11], s40 offen offset:0 sc1 lds
buffer_load_dwordx4 v2, s[8:11], s40 offen offset:1024 sc1 lds
buffer_load_dwordx4 v2, s[8:11], s40 offen offset:2048 sc1 lds
buffer_load_dwordx4 v2, s[8:11], s40 offen offset:3072 sc1 lds
s_add_u32 m0, s33, 106496
s_add_u32 s40, s32, 106496
buffer_load_dwordx4 v2, s[8:11], s40 offen offset:0 sc1 lds
buffer_load_dwordx4 v2, s[8:11], s40 offen offset:1024 sc1 lds
buffer_load_dwordx4 v2, s[8:11], s40 offen offset:2048 sc1 lds
buffer_load_dwordx4 v2, s[8:11], s40 offen offset:3072 sc1 lds
s_add_u32 m0, s33, 110592
s_add_u32 s40, s32, 110592
buffer_load_dwordx4 v2, s[8:11], s40 offen offset:0 sc1 lds
buffer_load_dwordx4 v2, s[8:11], s40 offen offset:1024 sc1 lds
buffer_load_dwordx4 v2, s[8:11], s40 offen offset:2048 sc1 lds
buffer_load_dwordx4 v2, s[8:11], s40 offen offset:3072 sc1 lds
s_add_u32 m0, s33, 114688
s_add_u32 s40, s32, 114688
buffer_load_dwordx4 v2, s[8:11], s40 offen offset:0 sc1 lds
buffer_load_dwordx4 v2, s[8:11], s40 offen offset:1024 sc1 lds
buffer_load_dwordx4 v2, s[8:11], s40 offen offset:2048 sc1 lds
buffer_load_dwordx4 v2, s[8:11], s40 offen offset:3072 sc1 lds
s_add_u32 m0, s33, 118784
s_add_u32 s40, s32, 118784
buffer_load_dwordx4 v2, s[8:11], s40 offen offset:0 sc1 lds
buffer_load_dwordx4 v2, s[8:11], s40 offen offset:1024 sc1 lds
buffer_load_dwordx4 v2, s[8:11], s40 offen offset:2048 sc1 lds
buffer_load_dwordx4 v2, s[8:11], s40 offen offset:3072 sc1 lds
s_add_u32 m0, s33, 122880
s_add_u32 s40, s32, 122880
buffer_load_dwordx4 v2, s[8:11], s40 offen offset:0 sc1 lds
buffer_load_dwordx4 v2, s[8:11], s40 offen offset:1024 sc1 lds
buffer_load_dwordx4 v2, s[8:11], s40 offen offset:2048 sc1 lds
buffer_load_dwordx4 v2, s[8:11], s40 offen offset:3072 sc1 lds
s_add_u32 m0, s33, 126976
s_add_u32 s40, s32, 126976
buffer_load_dwordx4 v2, s[8:11], s40 offen offset:0 sc1 lds
buffer_load_dwordx4 v2, s[8:11], s40 offen offset:1024 sc1 lds
buffer_load_dwordx4 v2, s[8:11], s40 offen offset:2048 sc1 lds
buffer_load_dwordx4 v2, s[8:11], s40 offen offset:3072 sc1 lds
s_add_u32 m0, s33, 131072
s_add_u32 s40, s32, 131072
buffer_load_dwordx4 v2, s[8:11], s40 offen offset:0 sc1 lds
buffer_load_dwordx4 v2, s[8:11], s40 offen offset:1024 sc1 lds
buffer_load_dwordx4 v2, s[8:11], s40 offen offset:2048 sc1 lds
buffer_load_dwordx4 v2, s[8:11], s40 offen offset:3072 sc1 lds
s_add_u32 m0, s33, 135168
s_add_u32 s40, s32, 135168
buffer_load_dwordx4 v2, s[8:11], s40 offen offset:0 sc1 lds
buffer_load_dwordx4 v2, s[8:11], s40 offen offset:1024 sc1 lds
buffer_load_dwordx4 v2, s[8:11], s40 offen offset:2048 sc1 lds
buffer_load_dwordx4 v2, s[8:11], s40 offen offset:3072 sc1 lds
s_add_u32 m0, s33, 139264
s_add_u32 s40, s32, 139264
buffer_load_dwordx4 v2, s[8:11], s40 offen offset:0 sc1 lds
buffer_load_dwordx4 v2, s[8:11], s40 offen offset:1024 sc1 lds
buffer_load_dwordx4 v2, s[8:11], s40 offen offset:2048 sc1 lds
buffer_load_dwordx4 v2, s[8:11], s40 offen offset:3072 sc1 lds
s_add_u32 m0, s33, 143360
s_add_u32 s40, s32, 143360
buffer_load_dwordx4 v2, s[8:11], s40 offen offset:0 sc1 lds
buffer_load_dwordx4 v2, s[8:11], s40 offen offset:1024 sc1 lds
buffer_load_dwordx4 v2, s[8:11], s40 offen offset:2048 sc1 lds
buffer_load_dwordx4 v2, s[8:11], s40 offen offset:3072 sc1 lds
s_barrier
L_r_done:
s_mov_b32 s70, 25620480
s_mov_b32 s71, 30339072
s_mov_b32 s72, 35057664
s_mov_b32 s73, 39776256
s_mov_b32 s74, 42266624
s_mov_b32 s75, 61272064
s_mov_b32 s76, 99020800
s_mov_b32 s77, 1048576
s_mov_b32 s7, 1
s_lshr_b32 s20, s5, 2
s_lshl_b32 s20, s20, 3
s_lshr_b32 s21, s6, 2
s_add_u32 s20, s20, s21
s_and_b32 s21, s5, 3
s_lshl_b32 s21, s21, 2
s_and_b32 s22, s6, 3
s_add_u32 s21, s21, s22
s_lshl_b32 s24, s20, 3
s_sub_u32 s25, s24, 1
s_max_i32 s35, s25, 0
s_mul_i32 s25, s35, 18432
s_lshl_b32 s26, s4, 1
s_add_u32 s36, s24, s26
s_mul_i32 s24, s36, 18432
s_add_u32 s26, s24, s70
s_add_u32 s27, s26, 18432
s_add_u32 s28, s25, s70
v_add_u32 v4, 0x10000, v2
v_add_u32 v5, 0x20000, v2
s_cmp_eq_u32 s4, 3
s_cselect_b32 s29, 0, s4
s_cselect_b32 s31, 16, 9
s_lshl_b32 s30, s29, 10
v_and_b32 v12, 15, v1
v_mov_b32 v13, 2146435072
v_cmp_le_u32 vcc, s31, v12
s_nop 1
v_cndmask_b32 v3, v13, v2, vcc
s_add_u32 s31, s30, 2048
v_add_u32 v6, s31, v2
v_add_u32 v7, s31, v4
v_add_u32 v8, s31, v5
s_add_u32 s31, s30, 5120
v_add_u32 v9, s31, v2
v_add_u32 v10, s31, v4
v_add_u32 v11, s31, v5
s_lshl_b32 s22, s36, 1
s_lshl_b32 s23, s35, 1
s_add_u32 s23, s23, 1
v_and_b32 v16, 3, v1
v_add_u32 v16, s22, v16
v_mov_b32 v17, s23
v_cmp_eq_u32 vcc, 4, v1
s_nop 1
v_cndmask_b32 v16, v16, v17, vcc
v_lshlrev_b32 v16, 7, v16
s_add_u32 s22, s77, 786432
v_mov_b32 v13, 2146435072
v_cmp_gt_u32 vcc, 16, v0
v_lshlrev_b32 v14, 3, v0
s_nop 0
v_cndmask_b32 v13, v13, v14, vcc
v_mov_b32 v14, s68
v_mov_b32 v15, s69
s_waitcnt vmcnt(0)
s_barrier
buffer_store_dwordx2 v[14:15], v13, s[8:11], s14 offen sc1
s_mov_b32 s52, 0
L_poll7:
buffer_load_dwordx2 v[14:15], v16, s[8:11], s22 offen sc1
s_add_u32 s52, s52, 1
s_waitcnt vmcnt(0)
v_cmp_ne_u64 vcc, s[68:69], v[14:15]
s_cmp_ge_u32 s52, 1048576
s_cbranch_scc1 L_got7
s_and_b64 exec, exec, vcc
s_cbranch_execnz L_poll7
L_got7:
s_mov_b64 exec, -1
buffer_load_dwordx4 a[0:3], v2, s[8:11], s26 offen offset:0 sc1
buffer_load_dwordx4 a[72:75], v2, s[8:11], s27 offen offset:0 sc1
buffer_load_dwordx4 a[144:147], v3, s[8:11], s28 offen offset:0 sc1
buffer_load_dwordx4 a[4:7], v2, s[8:11], s26 offen offset:1024 sc1
buffer_load_dwordx4 a[76:79], v2, s[8:11], s27 offen offset:1024 sc1
buffer_load_dwordx4 a[148:151], v3, s[8:11], s28 offen offset:1024 sc1
buffer_load_dwordx4 a[8:11], v2, s[8:11], s26 offen offset:2048 sc1
buffer_load_dwordx4 a[80:83], v2, s[8:11], s27 offen offset:2048 sc1
buffer_load_dwordx4 a[152:155], v3, s[8:11], s28 offen offset:2048 sc1
buffer_load_dwordx4 a[12:15], v2, s[8:11], s26 offen offset:3072 sc1
buffer_load_dwordx4 a[84:87], v2, s[8:11], s27 offen offset:3072 sc1
buffer_load_dwordx4 a[156:159], v3, s[8:11], s28 offen offset:3072 sc1
s_add_u32 s26, s26, 4096
s_add_u32 s27, s27, 4096
s_add_u32 s28, s28, 4096
buffer_load_dwordx4 a[16:19], v2, s[8:11], s26 offen offset:0 sc1
buffer_load_dwordx4 a[88:91], v2, s[8:11], s27 offen offset:0 sc1
buffer_load_dwordx4 a[160:163], v3, s[8:11], s28 offen offset:0 sc1
buffer_load_dwordx4 a[20:23], v2, s[8:11], s26 offen offset:1024 sc1
buffer_load_dwordx4 a[92:95], v2, s[8:11], s27 offen offset:1024 sc1
buffer_load_dwordx4 a[164:167], v3, s[8:11], s28 offen offset:1024 sc1
buffer_load_dwordx4 a[24:27], v2, s[8:11], s26 offen offset:2048 sc1
buffer_load_dwordx4 a[96:99], v2, s[8:11], s27 offen offset:2048 sc1
buffer_load_dwordx4 a[168:171], v3, s[8:11], s28 offen offset:2048 sc1
buffer_load_dwordx4 a[28:31], v2, s[8:11], s26 offen offset:3072 sc1
buffer_load_dwordx4 a[100:103], v2, s[8:11], s27 offen offset:3072 sc1
buffer_load_dwordx4 a[172:175], v3, s[8:11], s28 offen offset:3072 sc1
v_lshrrev_b32 v13, 4, v1
v_lshlrev_b32 v14, 2, v13
v_sub_u32 v14, v12, v14
v_subrev_u32 v15, 0, v14
v_cmp_gt_u32 s[52:53], 8, v15
v_cmp_gt_i32 s[44:45], -8, v15
v_subrev_u32 v15, 1, v14
v_cmp_gt_u32 s[54:55], 8, v15
v_cmp_gt_i32 s[46:47], -8, v15
v_subrev_u32 v15, 2, v14
v_cmp_gt_u32 s[56:57], 8, v15
v_cmp_gt_i32 s[48:49], -8, v15
v_subrev_u32 v15, 3, v14
v_cmp_gt_u32 s[58:59], 8, v15
v_cmp_gt_i32 s[50:51], -8, v15
s_and_b32 s31, s20, 7
s_or_b32 s31, s31, s4
s_cmp_eq_u32 s31, 0
s_cselect_b64 s[60:61], 0, s[44:45]
s_cselect_b64 s[62:63], 0, s[46:47]
s_cselect_b64 s[64:65], 0, s[48:49]
s_cselect_b64 s[66:67], 0, s[50:51]
ds_read_b128 a[216:219], v2 offset:0
ds_read_b128 a[220:223], v2 offset:8192
ds_read_b128 a[224:227], v2 offset:1024
ds_read_b128 a[228:231], v2 offset:9216
ds_read_b128 a[232:235], v2 offset:2048
ds_read_b128 a[236:239], v2 offset:10240
s_waitcnt vmcnt(18)
s_waitcnt lgkmcnt(4)
v_mfma_f32_16x16x32_bf16 v[32:35], a[216:219], a[0:3], 0
s_add_u32 s26, s26, 4096
s_add_u32 s27, s27, 4096
s_add_u32 s28, s28, 4096
buffer_load_dwordx4 a[32:35], v2, s[8:11], s26 offen offset:0 sc1
v_mfma_f32_16x16x32_bf16 v[32:35], a[220:223], a[4:7], v[32:35]
ds_read_b128 a[240:243], v2 offset:3072
v_mfma_f32_16x16x32_bf16 v[36:39], a[216:219], a[72:75], 0
v_mfma_f32_16x16x32_bf16 v[36:39], a[220:223], a[76:79], v[36:39]
ds_read_b128 a[244:247], v2 offset:11264
s_waitcnt lgkmcnt(4)
v_mfma_f32_16x16x32_bf16 v[40:43], a[224:227], a[0:3], 0
buffer_load_dwordx4 a[104:107], v2, s[8:11], s27 offen offset:0 sc1
v_mfma_f32_16x16x32_bf16 v[40:43], a[228:231], a[4:7], v[40:43]
ds_read_b128 a[216:219], v2 offset:4096
v_mfma_f32_16x16x32_bf16 v[44:47], a[224:227], a[72:75], 0
v_mfma_f32_16x16x32_bf16 v[44:47], a[228:231], a[76:79], v[44:47]
ds_read_b128 a[220:223], v2 offset:12288
s_waitcnt lgkmcnt(4)
v_mfma_f32_16x16x32_bf16 v[48:51], a[232:235], a[0:3], 0
buffer_load_dwordx4 a[176:179], v3, s[8:11], s28 offen offset:0 sc1
v_mfma_f32_16x16x32_bf16 v[48:51], a[236:239], a[4:7], v[48:51]
ds_read_b128 a[224:227], v2 offset:5120
v_mfma_f32_16x16x32_bf16 v[52:55], a[232:235], a[72:75], 0
v_mfma_f32_16x16x32_bf16 v[52:55], a[236:239], a[76:79], v[52:55]
ds_read_b128 a[228:231], v2 offset:13312
s_waitcnt lgkmcnt(4)
v_mfma_f32_16x16x32_bf16 v[56:59], a[240:243], a[0:3], 0
buffer_load_dwordx4 a[36:39], v2, s[8:11], s26 offen offset:1024 sc1
v_mfma_f32_16x16x32_bf16 v[56:59], a[244:247], a[4:7], v[56:59]
ds_read_b128 a[232:235], v2 offset:6144
v_mfma_f32_16x16x32_bf16 v[60:63], a[240:243], a[72:75], 0
v_mfma_f32_16x16x32_bf16 v[60:63], a[244:247], a[76:79], v[60:63]
ds_read_b128 a[236:239], v2 offset:14336
s_waitcnt lgkmcnt(4)
v_mfma_f32_16x16x32_bf16 v[64:67], a[216:219], a[0:3], 0
buffer_load_dwordx4 a[108:111], v2, s[8:11], s27 offen offset:1024 sc1
v_mfma_f32_16x16x32_bf16 v[64:67], a[220:223], a[4:7], v[64:67]
ds_read_b128 a[240:243], v2 offset:7168
v_mfma_f32_16x16x32_bf16 v[68:71], a[216:219], a[72:75], 0
v_mfma_f32_16x16x32_bf16 v[68:71], a[220:223], a[76:79], v[68:71]
ds_read_b128 a[244:247], v2 offset:15360
s_waitcnt lgkmcnt(4)
v_mfma_f32_16x16x32_bf16 v[72:75], a[0:3], a[224:227], 0
buffer_load_dwordx4 a[180:183], v3, s[8:11], s28 offen offset:1024 sc1
v_mfma_f32_16x16x32_bf16 v[72:75], a[4:7], a[228:231], v[72:75]
ds_read_b128 a[216:219], v6 offset:0
v_mfma_f32_16x16x32_bf16 v[76:79], a[72:75], a[224:227], 0
v_mfma_f32_16x16x32_bf16 v[76:79], a[76:79], a[228:231], v[76:79]
ds_read_b128 a[220:223], v6 offset:8192
s_waitcnt lgkmcnt(4)
v_mfma_f32_16x16x32_bf16 v[80:83], a[0:3], a[232:235], 0
buffer_load_dwordx4 a[40:43], v2, s[8:11], s26 offen offset:2048 sc1
v_mfma_f32_16x16x32_bf16 v[80:83], a[4:7], a[236:239], v[80:83]
ds_read_b128 a[224:227], v9 offset:0
v_mfma_f32_16x16x32_bf16 v[84:87], a[72:75], a[232:235], 0
v_mfma_f32_16x16x32_bf16 v[84:87], a[76:79], a[236:239], v[84:87]
ds_read_b128 a[228:231], v9 offset:8192
s_waitcnt lgkmcnt(4)
v_mfma_f32_16x16x32_bf16 v[88:91], a[0:3], a[240:243], 0
buffer_load_dwordx4 a[112:115], v2, s[8:11], s27 offen offset:2048 sc1
v_mfma_f32_16x16x32_bf16 v[88:91], a[4:7], a[244:247], v[88:91]
ds_read_b128 a[232:235], v2 offset:16384
v_mfma_f32_16x16x32_bf16 v[92:95], a[72:75], a[240:243], 0
v_mfma_f32_16x16x32_bf16 v[92:95], a[76:79], a[244:247], v[92:95]
ds_read_b128 a[236:239], v2 offset:24576
s_waitcnt lgkmcnt(4)
v_mfma_f32_16x16x32_bf16 v[96:99], a[216:219], a[144:147], 0
ds_read_b128 a[240:243], v2 offset:17408
buffer_load_dwordx4 a[184:187], v3, s[8:11], s28 offen offset:2048 sc1
v_mfma_f32_16x16x32_bf16 v[96:99], a[220:223], a[148:151], v[96:99]
ds_read_b128 a[244:247], v2 offset:25600
s_waitcnt lgkmcnt(4)
v_mfma_f32_16x16x32_bf16 v[100:103], a[144:147], a[224:227], 0
ds_read_b128 a[216:219], v2 offset:18432
v_mfma_f32_16x16x32_bf16 v[100:103], a[148:151], a[228:231], v[100:103]
ds_read_b128 a[220:223], v2 offset:26624
s_waitcnt vmcnt(21)
s_waitcnt lgkmcnt(4)
v_mfma_f32_16x16x32_bf16 v[32:35], a[232:235], a[8:11], v[32:35]
buffer_load_dwordx4 a[44:47], v2, s[8:11], s26 offen offset:3072 sc1
v_mfma_f32_16x16x32_bf16 v[32:35], a[236:239], a[12:15], v[32:35]
ds_read_b128 a[224:227], v2 offset:19456
v_mfma_f32_16x16x32_bf16 v[36:39], a[232:235], a[80:83], v[36:39]
v_mfma_f32_16x16x32_bf16 v[36:39], a[236:239], a[84:87], v[36:39]
ds_read_b128 a[228:231], v2 offset:27648
s_waitcnt lgkmcnt(4)
v_mfma_f32_16x16x32_bf16 v[40:43], a[240:243], a[8:11], v[40:43]
buffer_load_dwordx4 a[116:119], v2, s[8:11], s27 offen offset:3072 sc1
v_mfma_f32_16x16x32_bf16 v[40:43], a[244:247], a[12:15], v[40:43]
ds_read_b128 a[232:235], v2 offset:20480
v_mfma_f32_16x16x32_bf16 v[44:47], a[240:243], a[80:83], v[44:47]
v_mfma_f32_16x16x32_bf16 v[44:47], a[244:247], a[84:87], v[44:47]
ds_read_b128 a[236:239], v2 offset:28672
s_waitcnt lgkmcnt(4)
v_mfma_f32_16x16x32_bf16 v[48:51], a[216:219], a[8:11], v[48:51]
buffer_load_dwordx4 a[188:191], v3, s[8:11], s28 offen offset:3072 sc1
v_mfma_f32_16x16x32_bf16 v[48:51], a[220:223], a[12:15], v[48:51]
ds_read_b128 a[240:243], v2 offset:21504
v_mfma_f32_16x16x32_bf16 v[52:55], a[216:219], a[80:83], v[52:55]
v_mfma_f32_16x16x32_bf16 v[52:55], a[220:223], a[84:87], v[52:55]
ds_read_b128 a[244:247], v2 offset:29696
s_waitcnt lgkmcnt(4)
v_mfma_f32_16x16x32_bf16 v[56:59], a[224:227], a[8:11], v[56:59]
s_add_u32 s26, s26, 4096
s_add_u32 s27, s27, 4096
s_add_u32 s28, s28, 4096
buffer_load_dwordx4 a[48:51], v2, s[8:11], s26 offen offset:0 sc1
v_mfma_f32_16x16x32_bf16 v[56:59], a[228:231], a[12:15], v[56:59]
ds_read_b128 a[216:219], v2 offset:22528
v_mfma_f32_16x16x32_bf16 v[60:63], a[224:227], a[80:83], v[60:63]
v_mfma_f32_16x16x32_bf16 v[60:63], a[228:231], a[84:87], v[60:63]
ds_read_b128 a[220:223], v2 offset:30720
s_waitcnt lgkmcnt(4)
v_mfma_f32_16x16x32_bf16 v[64:67], a[232:235], a[8:11], v[64:67]
buffer_load_dwordx4 a[120:123], v2, s[8:11], s27 offen offset:0 sc1
v_mfma_f32_16x16x32_bf16 v[64:67], a[236:239], a[12:15], v[64:67]
ds_read_b128 a[224:227], v2 offset:23552
v_mfma_f32_16x16x32_bf16 v[68:71], a[232:235], a[80:83], v[68:71]
v_mfma_f32_16x16x32_bf16 v[68:71], a[236:239], a[84:87], v[68:71]
ds_read_b128 a[228:231], v2 offset:31744
s_waitcnt lgkmcnt(4)
v_mfma_f32_16x16x32_bf16 v[72:75], a[8:11], a[240:243], v[72:75]
buffer_load_dwordx4 a[192:195], v3, s[8:11], s28 offen offset:0 sc1
v_mfma_f32_16x16x32_bf16 v[72:75], a[12:15], a[244:247], v[72:75]
ds_read_b128 a[232:235], v6 offset:16384
v_mfma_f32_16x16x32_bf16 v[76:79], a[80:83], a[240:243], v[76:79]
v_mfma_f32_16x16x32_bf16 v[76:79], a[84:87], a[244:247], v[76:79]
ds_read_b128 a[236:239], v6 offset:24576
s_waitcnt lgkmcnt(4)
v_mfma_f32_16x16x32_bf16 v[80:83], a[8:11], a[216:219], v[80:83]
buffer_load_dwordx4 a[52:55], v2, s[8:11], s26 offen offset:1024 sc1
v_mfma_f32_16x16x32_bf16 v[80:83], a[12:15], a[220:223], v[80:83]
ds_read_b128 a[240:243], v9 offset:16384
v_mfma_f32_16x16x32_bf16 v[84:87], a[80:83], a[216:219], v[84:87]
v_mfma_f32_16x16x32_bf16 v[84:87], a[84:87], a[220:223], v[84:87]
ds_read_b128 a[244:247], v9 offset:24576
s_waitcnt lgkmcnt(4)
v_mfma_f32_16x16x32_bf16 v[88:91], a[8:11], a[224:227], v[88:91]
buffer_load_dwordx4 a[124:127], v2, s[8:11], s27 offen offset:1024 sc1
v_mfma_f32_16x16x32_bf16 v[88:91], a[12:15], a[228:231], v[88:91]
ds_read_b128 a[216:219], v2 offset:32768
v_mfma_f32_16x16x32_bf16 v[92:95], a[80:83], a[224:227], v[92:95]
v_mfma_f32_16x16x32_bf16 v[92:95], a[84:87], a[228:231], v[92:95]
ds_read_b128 a[220:223], v2 offset:40960
s_waitcnt lgkmcnt(4)
v_mfma_f32_16x16x32_bf16 v[96:99], a[232:235], a[152:155], v[96:99]
ds_read_b128 a[224:227], v2 offset:33792
buffer_load_dwordx4 a[196:199], v3, s[8:11], s28 offen offset:1024 sc1
v_mfma_f32_16x16x32_bf16 v[96:99], a[236:239], a[156:159], v[96:99]
ds_read_b128 a[228:231], v2 offset:41984
s_waitcnt lgkmcnt(4)
v_mfma_f32_16x16x32_bf16 v[100:103], a[152:155], a[240:243], v[100:103]
ds_read_b128 a[232:235], v2 offset:34816
v_mfma_f32_16x16x32_bf16 v[100:103], a[156:159], a[244:247], v[100:103]
ds_read_b128 a[236:239], v2 offset:43008
s_waitcnt vmcnt(24)
s_waitcnt lgkmcnt(4)
v_mfma_f32_16x16x32_bf16 v[32:35], a[216:219], a[16:19], v[32:35]
buffer_load_dwordx4 a[56:59], v2, s[8:11], s26 offen offset:2048 sc1
v_mfma_f32_16x16x32_bf16 v[32:35], a[220:223], a[20:23], v[32:35]
ds_read_b128 a[240:243], v2 offset:35840
v_mfma_f32_16x16x32_bf16 v[36:39], a[216:219], a[88:91], v[36:39]
v_mfma_f32_16x16x32_bf16 v[36:39], a[220:223], a[92:95], v[36:39]
ds_read_b128 a[244:247], v2 offset:44032
s_waitcnt lgkmcnt(4)
v_mfma_f32_16x16x32_bf16 v[40:43], a[224:227], a[16:19], v[40:43]
buffer_load_dwordx4 a[128:131], v2, s[8:11], s27 offen offset:2048 sc1
v_mfma_f32_16x16x32_bf16 v[40:43], a[228:231], a[20:23], v[40:43]
ds_read_b128 a[216:219], v2 offset:36864
v_mfma_f32_16x16x32_bf16 v[44:47], a[224:227], a[88:91], v[44:47]
v_mfma_f32_16x16x32_bf16 v[44:47], a[228:231], a[92:95], v[44:47]
ds_read_b128 a[220:223], v2 offset:45056
s_waitcnt lgkmcnt(4)
v_mfma_f32_16x16x32_bf16 v[48:51], a[232:235], a[16:19], v[48:51]
buffer_load_dwordx4 a[200:203], v3, s[8:11], s28 offen offset:2048 sc1
v_mfma_f32_16x16x32_bf16 v[48:51], a[236:239], a[20:23], v[48:51]
ds_read_b128 a[224:227], v2 offset:37888
v_mfma_f32_16x16x32_bf16 v[52:55], a[232:235], a[88:91], v[52:55]
v_mfma_f32_16x16x32_bf16 v[52:55], a[236:239], a[92:95], v[52:55]
ds_read_b128 a[228:231], v2 offset:46080
s_waitcnt lgkmcnt(4)
v_mfma_f32_16x16x32_bf16 v[56:59], a[240:243], a[16:19], v[56:59]
buffer_load_dwordx4 a[60:63], v2, s[8:11], s26 offen offset:3072 sc1
v_mfma_f32_16x16x32_bf16 v[56:59], a[244:247], a[20:23], v[56:59]
ds_read_b128 a[232:235], v2 offset:38912
v_mfma_f32_16x16x32_bf16 v[60:63], a[240:243], a[88:91], v[60:63]
v_mfma_f32_16x16x32_bf16 v[60:63], a[244:247], a[92:95], v[60:63]
ds_read_b128 a[236:239], v2 offset:47104
s_waitcnt lgkmcnt(4)
v_mfma_f32_16x16x32_bf16 v[64:67], a[216:219], a[16:19], v[64:67]
buffer_load_dwordx4 a[132:135], v2, s[8:11], s27 offen offset:3072 sc1
v_mfma_f32_16x16x32_bf16 v[64:67], a[220:223], a[20:23], v[64:67]
ds_read_b128 a[240:243], v2 offset:39936
v_mfma_f32_16x16x32_bf16 v[68:71], a[216:219], a[88:91], v[68:71]
v_mfma_f32_16x16x32_bf16 v[68:71], a[220:223], a[92:95], v[68:71]
ds_read_b128 a[244:247], v2 offset:48128
s_waitcnt lgkmcnt(4)
v_mfma_f32_16x16x32_bf16 v[72:75], a[16:19], a[224:227], v[72:75]
buffer_load_dwordx4 a[204:207], v3, s[8:11], s28 offen offset:3072 sc1
v_mfma_f32_16x16x32_bf16 v[72:75], a[20:23], a[228:231], v[72:75]
ds_read_b128 a[216:219], v6 offset:32768
v_mfma_f32_16x16x32_bf16 v[76:79], a[88:91], a[224:227], v[76:79]
v_mfma_f32_16x16x32_bf16 v[76:79], a[92:95], a[228:231], v[76:79]
ds_read_b128 a[220:223], v6 offset:40960
s_waitcnt lgkmcnt(4)
v_mfma_f32_16x16x32_bf16 v[80:83], a[16:19], a[232:235], v[80:83]
s_add_u32 s26, s26, 4096
s_add_u32 s27, s27, 4096
s_add_u32 s28, s28, 4096
buffer_load_dwordx4 a[64:67], v2, s[8:11], s26 offen offset:0 sc1
v_mfma_f32_16x16x32_bf16 v[80:83], a[20:23], a[236:239], v[80:83]
ds_read_b128 a[224:227], v9 offset:32768
v_mfma_f32_16x16x32_bf16 v[84:87], a[88:91], a[232:235], v[84:87]
v_mfma_f32_16x16x32_bf16 v[84:87], a[92:95], a[236:239], v[84:87]
ds_read_b128 a[228:231], v9 offset:40960
s_waitcnt lgkmcnt(4)
v_mfma_f32_16x16x32_bf16 v[88:91], a[16:19], a[240:243], v[88:91]
buffer_load_dwordx4 a[136:139], v2, s[8:11], s27 offen offset:0 sc1
v_mfma_f32_16x16x32_bf16 v[88:91], a[20:23], a[244:247], v[88:91]
ds_read_b128 a[232:235], v2 offset:49152
v_mfma_f32_16x16x32_bf16 v[92:95], a[88:91], a[240:243], v[92:95]
v_mfma_f32_16x16x32_bf16 v[92:95], a[92:95], a[244:247], v[92:95]
ds_read_b128 a[236:239], v2 offset:57344
s_waitcnt lgkmcnt(4)
v_mfma_f32_16x16x32_bf16 v[96:99], a[216:219], a[160:163], v[96:99]
ds_read_b128 a[240:243], v2 offset:50176
buffer_load_dwordx4 a[208:211], v3, s[8:11], s28 offen offset:0 sc1
v_mfma_f32_16x16x32_bf16 v[96:99], a[220:223], a[164:167], v[96:99]
ds_read_b128 a[244:247], v2 offset:58368
s_waitcnt lgkmcnt(4)
v_mfma_f32_16x16x32_bf16 v[100:103], a[160:163], a[224:227], v[100:103]
ds_read_b128 a[216:219], v2 offset:51200
v_mfma_f32_16x16x32_bf16 v[100:103], a[164:167], a[228:231], v[100:103]
ds_read_b128 a[220:223], v2 offset:59392
s_waitcnt vmcnt(27)
s_waitcnt lgkmcnt(4)
v_mfma_f32_16x16x32_bf16 v[32:35], a[232:235], a[24:27], v[32:35]
buffer_load_dwordx4 a[68:71], v2, s[8:11], s26 offen offset:1024 sc1
v_mfma_f32_16x16x32_bf16 v[32:35], a[236:239], a[28:31], v[32:35]
ds_read_b128 a[224:227], v2 offset:52224
v_mfma_f32_16x16x32_bf16 v[36:39], a[232:235], a[96:99], v[36:39]
v_mfma_f32_16x16x32_bf16 v[36:39], a[236:239], a[100:103], v[36:39]
ds_read_b128 a[228:231], v2 offset:60416
s_waitcnt lgkmcnt(4)
v_mfma_f32_16x16x32_bf16 v[40:43], a[240:243], a[24:27], v[40:43]
buffer_load_dwordx4 a[140:143], v2, s[8:11], s27 offen offset:1024 sc1
v_mfma_f32_16x16x32_bf16 v[40:43], a[244:247], a[28:31], v[40:43]
ds_read_b128 a[232:235], v2 offset:53248
v_mfma_f32_16x16x32_bf16 v[44:47], a[240:243], a[96:99], v[44:47]
v_mfma_f32_16x16x32_bf16 v[44:47], a[244:247], a[100:103], v[44:47]
ds_read_b128 a[236:239], v2 offset:61440
s_waitcnt lgkmcnt(4)
v_mfma_f32_16x16x32_bf16 v[48:51], a[216:219], a[24:27], v[48:51]
buffer_load_dwordx4 a[212:215], v3, s[8:11], s28 offen offset:1024 sc1
v_mfma_f32_16x16x32_bf16 v[48:51], a[220:223], a[28:31], v[48:51]
ds_read_b128 a[240:243], v2 offset:54272
v_mfma_f32_16x16x32_bf16 v[52:55], a[216:219], a[96:99], v[52:55]
v_mfma_f32_16x16x32_bf16 v[52:55], a[220:223], a[100:103], v[52:55]
ds_read_b128 a[244:247], v2 offset:62464
s_waitcnt lgkmcnt(4)
v_mfma_f32_16x16x32_bf16 v[56:59], a[224:227], a[24:27], v[56:59]
v_mfma_f32_16x16x32_bf16 v[56:59], a[228:231], a[28:31], v[56:59]
ds_read_b128 a[216:219], v2 offset:55296
v_mfma_f32_16x16x32_bf16 v[60:63], a[224:227], a[96:99], v[60:63]
v_mfma_f32_16x16x32_bf16 v[60:63], a[228:231], a[100:103], v[60:63]
ds_read_b128 a[220:223], v2 offset:63488
s_waitcnt lgkmcnt(4)
v_mfma_f32_16x16x32_bf16 v[64:67], a[232:235], a[24:27], v[64:67]
v_mfma_f32_16x16x32_bf16 v[64:67], a[236:239], a[28:31], v[64:67]
ds_read_b128 a[224:227], v2 offset:56320
v_mfma_f32_16x16x32_bf16 v[68:71], a[232:235], a[96:99], v[68:71]
v_mfma_f32_16x16x32_bf16 v[68:71], a[236:239], a[100:103], v[68:71]
ds_read_b128 a[228:231], v2 offset:64512
s_waitcnt lgkmcnt(4)
v_mfma_f32_16x16x32_bf16 v[72:75], a[24:27], a[240:243], v[72:75]
v_mfma_f32_16x16x32_bf16 v[72:75], a[28:31], a[244:247], v[72:75]
ds_read_b128 a[232:235], v6 offset:49152
v_mfma_f32_16x16x32_bf16 v[76:79], a[96:99], a[240:243], v[76:79]
v_mfma_f32_16x16x32_bf16 v[76:79], a[100:103], a[244:247], v[76:79]
ds_read_b128 a[236:239], v6 offset:57344
s_waitcnt lgkmcnt(4)
v_mfma_f32_16x16x32_bf16 v[80:83], a[24:27], a[216:219], v[80:83]
v_mfma_f32_16x16x32_bf16 v[80:83], a[28:31], a[220:223], v[80:83]
ds_read_b128 a[240:243], v9 offset:49152
v_mfma_f32_16x16x32_bf16 v[84:87], a[96:99], a[216:219], v[84:87]
v_mfma_f32_16x16x32_bf16 v[84:87], a[100:103], a[220:223], v[84:87]
ds_read_b128 a[244:247], v9 offset:57344
s_waitcnt lgkmcnt(4)
v_mfma_f32_16x16x32_bf16 v[88:91], a[24:27], a[224:227], v[88:91]
v_mfma_f32_16x16x32_bf16 v[88:91], a[28:31], a[228:231], v[88:91]
ds_read_b128 a[216:219], v4 offset:0
v_mfma_f32_16x16x32_bf16 v[92:95], a[96:99], a[224:227], v[92:95]
v_mfma_f32_16x16x32_bf16 v[92:95], a[100:103], a[228:231], v[92:95]
ds_read_b128 a[220:223], v4 offset:8192
s_waitcnt lgkmcnt(4)
v_mfma_f32_16x16x32_bf16 v[96:99], a[232:235], a[168:171], v[96:99]
ds_read_b128 a[224:227], v4 offset:1024
v_mfma_f32_16x16x32_bf16 v[96:99], a[236:239], a[172:175], v[96:99]
ds_read_b128 a[228:231], v4 offset:9216
s_waitcnt lgkmcnt(4)
v_mfma_f32_16x16x32_bf16 v[100:103], a[168:171], a[240:243], v[100:103]
ds_read_b128 a[232:235], v4 offset:2048
v_mfma_f32_16x16x32_bf16 v[100:103], a[172:175], a[244:247], v[100:103]
ds_read_b128 a[236:239], v4 offset:10240
s_waitcnt vmcnt(24)
s_waitcnt lgkmcnt(4)
v_mfma_f32_16x16x32_bf16 v[32:35], a[216:219], a[32:35], v[32:35]
v_mfma_f32_16x16x32_bf16 v[32:35], a[220:223], a[36:39], v[32:35]
ds_read_b128 a[240:243], v4 offset:3072
v_mfma_f32_16x16x32_bf16 v[36:39], a[216:219], a[104:107], v[36:39]
v_mfma_f32_16x16x32_bf16 v[36:39], a[220:223], a[108:111], v[36:39]
ds_read_b128 a[244:247], v4 offset:11264
s_waitcnt lgkmcnt(4)
v_mfma_f32_16x16x32_bf16 v[40:43], a[224:227], a[32:35], v[40:43]
v_mfma_f32_16x16x32_bf16 v[40:43], a[228:231], a[36:39], v[40:43]
ds_read_b128 a[216:219], v4 offset:4096
v_mfma_f32_16x16x32_bf16 v[44:47], a[224:227], a[104:107], v[44:47]
v_mfma_f32_16x16x32_bf16 v[44:47], a[228:231], a[108:111], v[44:47]
ds_read_b128 a[220:223], v4 offset:12288
s_waitcnt lgkmcnt(4)
v_mfma_f32_16x16x32_bf16 v[48:51], a[232:235], a[32:35], v[48:51]
v_mfma_f32_16x16x32_bf16 v[48:51], a[236:239], a[36:39], v[48:51]
ds_read_b128 a[224:227], v4 offset:5120
v_mfma_f32_16x16x32_bf16 v[52:55], a[232:235], a[104:107], v[52:55]
v_mfma_f32_16x16x32_bf16 v[52:55], a[236:239], a[108:111], v[52:55]
ds_read_b128 a[228:231], v4 offset:13312
s_waitcnt lgkmcnt(4)
v_mfma_f32_16x16x32_bf16 v[56:59], a[240:243], a[32:35], v[56:59]
v_mfma_f32_16x16x32_bf16 v[56:59], a[244:247], a[36:39], v[56:59]
ds_read_b128 a[232:235], v4 offset:6144
v_mfma_f32_16x16x32_bf16 v[60:63], a[240:243], a[104:107], v[60:63]
v_mfma_f32_16x16x32_bf16 v[60:63], a[244:247], a[108:111], v[60:63]
ds_read_b128 a[236:239], v4 offset:14336
s_waitcnt lgkmcnt(4)
v_mfma_f32_16x16x32_bf16 v[64:67], a[216:219], a[32:35], v[64:67]
v_mfma_f32_16x16x32_bf16 v[64:67], a[220:223], a[36:39], v[64:67]
ds_read_b128 a[240:243], v4 offset:7168
v_mfma_f32_16x16x32_bf16 v[68:71], a[216:219], a[104:107], v[68:71]
v_mfma_f32_16x16x32_bf16 v[68:71], a[220:223], a[108:111], v[68:71]
ds_read_b128 a[244:247], v4 offset:15360
s_waitcnt lgkmcnt(4)
v_mfma_f32_16x16x32_bf16 v[72:75], a[32:35], a[224:227], v[72:75]
v_mfma_f32_16x16x32_bf16 v[72:75], a[36:39], a[228:231], v[72:75]
ds_read_b128 a[216:219], v7 offset:0
v_mfma_f32_16x16x32_bf16 v[76:79], a[104:107], a[224:227], v[76:79]
v_mfma_f32_16x16x32_bf16 v[76:79], a[108:111], a[228:231], v[76:79]
ds_read_b128 a[220:223], v7 offset:8192
s_waitcnt lgkmcnt(4)
v_mfma_f32_16x16x32_bf16 v[80:83], a[32:35], a[232:235], v[80:83]
v_mfma_f32_16x16x32_bf16 v[80:83], a[36:39], a[236:239], v[80:83]
ds_read_b128 a[224:227], v10 offset:0
v_mfma_f32_16x16x32_bf16 v[84:87], a[104:107], a[232:235], v[84:87]
v_mfma_f32_16x16x32_bf16 v[84:87], a[108:111], a[236:239], v[84:87]
ds_read_b128 a[228:231], v10 offset:8192
s_waitcnt lgkmcnt(4)
v_mfma_f32_16x16x32_bf16 v[88:91], a[32:35], a[240:243], v[88:91]
v_mfma_f32_16x16x32_bf16 v[88:91], a[36:39], a[244:247], v[88:91]
ds_read_b128 a[232:235], v4 offset:16384
v_mfma_f32_16x16x32_bf16 v[92:95], a[104:107], a[240:243], v[92:95]
v_mfma_f32_16x16x32_bf16 v[92:95], a[108:111], a[244:247], v[92:95]
ds_read_b128 a[236:239], v4 offset:24576
s_waitcnt lgkmcnt(4)
v_mfma_f32_16x16x32_bf16 v[96:99], a[216:219], a[176:179], v[96:99]
ds_read_b128 a[240:243], v4 offset:17408
v_mfma_f32_16x16x32_bf16 v[96:99], a[220:223], a[180:183], v[96:99]
ds_read_b128 a[244:247], v4 offset:25600
s_waitcnt lgkmcnt(4)
v_mfma_f32_16x16x32_bf16 v[100:103], a[176:179], a[224:227], v[100:103]
ds_read_b128 a[216:219], v4 offset:18432
v_mfma_f32_16x16x32_bf16 v[100:103], a[180:183], a[228:231], v[100:103]
ds_read_b128 a[220:223], v4 offset:26624
s_waitcnt vmcnt(18)
s_waitcnt lgkmcnt(4)
v_mfma_f32_16x16x32_bf16 v[32:35], a[232:235], a[40:43], v[32:35]
v_mfma_f32_16x16x32_bf16 v[32:35], a[236:239], a[44:47], v[32:35]
ds_read_b128 a[224:227], v4 offset:19456
v_mfma_f32_16x16x32_bf16 v[36:39], a[232:235], a[112:115], v[36:39]
v_mfma_f32_16x16x32_bf16 v[36:39], a[236:239], a[116:119], v[36:39]
ds_read_b128 a[228:231], v4 offset:27648
s_waitcnt lgkmcnt(4)
v_mfma_f32_16x16x32_bf16 v[40:43], a[240:243], a[40:43], v[40:43]
v_mfma_f32_16x16x32_bf16 v[40:43], a[244:247], a[44:47], v[40:43]
ds_read_b128 a[232:235], v4 offset:20480
v_mfma_f32_16x16x32_bf16 v[44:47], a[240:243], a[112:115], v[44:47]
v_mfma_f32_16x16x32_bf16 v[44:47], a[244:247], a[116:119], v[44:47]
ds_read_b128 a[236:239], v4 offset:28672
s_waitcnt lgkmcnt(4)
v_mfma_f32_16x16x32_bf16 v[48:51], a[216:219], a[40:43], v[48:51]
v_mfma_f32_16x16x32_bf16 v[48:51], a[220:223], a[44:47], v[48:51]
ds_read_b128 a[240:243], v4 offset:21504
v_mfma_f32_16x16x32_bf16 v[52:55], a[216:219], a[112:115], v[52:55]
v_mfma_f32_16x16x32_bf16 v[52:55], a[220:223], a[116:119], v[52:55]
ds_read_b128 a[244:247], v4 offset:29696
s_waitcnt lgkmcnt(4)
v_mfma_f32_16x16x32_bf16 v[56:59], a[224:227], a[40:43], v[56:59]
v_mfma_f32_16x16x32_bf16 v[56:59], a[228:231], a[44:47], v[56:59]
ds_read_b128 a[216:219], v4 offset:22528
v_mfma_f32_16x16x32_bf16 v[60:63], a[224:227], a[112:115], v[60:63]
v_mfma_f32_16x16x32_bf16 v[60:63], a[228:231], a[116:119], v[60:63]
ds_read_b128 a[220:223], v4 offset:30720
s_waitcnt lgkmcnt(4)
v_mfma_f32_16x16x32_bf16 v[64:67], a[232:235], a[40:43], v[64:67]
v_mfma_f32_16x16x32_bf16 v[64:67], a[236:239], a[44:47], v[64:67]
ds_read_b128 a[224:227], v4 offset:23552
v_mfma_f32_16x16x32_bf16 v[68:71], a[232:235], a[112:115], v[68:71]
v_mfma_f32_16x16x32_bf16 v[68:71], a[236:239], a[116:119], v[68:71]
ds_read_b128 a[228:231], v4 offset:31744
s_waitcnt lgkmcnt(4)
v_mfma_f32_16x16x32_bf16 v[72:75], a[40:43], a[240:243], v[72:75]
v_mfma_f32_16x16x32_bf16 v[72:75], a[44:47], a[244:247], v[72:75]
ds_read_b128 a[232:235], v7 offset:16384
v_mfma_f32_16x16x32_bf16 v[76:79], a[112:115], a[240:243], v[76:79]
v_mfma_f32_16x16x32_bf16 v[76:79], a[116:119], a[244:247], v[76:79]
ds_read_b128 a[236:239], v7 offset:24576
s_waitcnt lgkmcnt(4)
v_mfma_f32_16x16x32_bf16 v[80:83], a[40:43], a[216:219], v[80:83]
v_mfma_f32_16x16x32_bf16 v[80:83], a[44:47], a[220:223], v[80:83]
ds_read_b128 a[240:243], v10 offset:16384
v_mfma_f32_16x16x32_bf16 v[84:87], a[112:115], a[216:219], v[84:87]
v_mfma_f32_16x16x32_bf16 v[84:87], a[116:119], a[220:223], v[84:87]
ds_read_b128 a[244:247], v10 offset:24576
s_waitcnt lgkmcnt(4)
v_mfma_f32_16x16x32_bf16 v[88:91], a[40:43], a[224:227], v[88:91]
v_mfma_f32_16x16x32_bf16 v[88:91], a[44:47], a[228:231], v[88:91]
ds_read_b128 a[216:219], v4 offset:32768
v_mfma_f32_16x16x32_bf16 v[92:95], a[112:115], a[224:227], v[92:95]
v_mfma_f32_16x16x32_bf16 v[92:95], a[116:119], a[228:231], v[92:95]
ds_read_b128 a[220:223], v4 offset:40960
s_waitcnt lgkmcnt(4)
v_mfma_f32_16x16x32_bf16 v[96:99], a[232:235], a[184:187], v[96:99]
ds_read_b128 a[224:227], v4 offset:33792
v_mfma_f32_16x16x32_bf16 v[96:99], a[236:239], a[188:191], v[96:99]
ds_read_b128 a[228:231], v4 offset:41984
s_waitcnt lgkmcnt(4)
v_mfma_f32_16x16x32_bf16 v[100:103], a[184:187], a[240:243], v[100:103]
ds_read_b128 a[232:235], v4 offset:34816
v_mfma_f32_16x16x32_bf16 v[100:103], a[188:191], a[244:247], v[100:103]
ds_read_b128 a[236:239], v4 offset:43008
s_waitcnt vmcnt(12)
s_waitcnt lgkmcnt(4)
v_mfma_f32_16x16x32_bf16 v[32:35], a[216:219], a[48:51], v[32:35]
v_mfma_f32_16x16x32_bf16 v[32:35], a[220:223], a[52:55], v[32:35]
ds_read_b128 a[240:243], v4 offset:35840
v_mfma_f32_16x16x32_bf16 v[36:39], a[216:219], a[120:123], v[36:39]
v_mfma_f32_16x16x32_bf16 v[36:39], a[220:223], a[124:127], v[36:39]
ds_read_b128 a[244:247], v4 offset:44032
s_waitcnt lgkmcnt(4)
v_mfma_f32_16x16x32_bf16 v[40:43], a[224:227], a[48:51], v[40:43]
v_mfma_f32_16x16x32_bf16 v[40:43], a[228:231], a[52:55], v[40:43]
ds_read_b128 a[216:219], v4 offset:36864
v_mfma_f32_16x16x32_bf16 v[44:47], a[224:227], a[120:123], v[44:47]
v_mfma_f32_16x16x32_bf16 v[44:47], a[228:231], a[124:127], v[44:47]
ds_read_b128 a[220:223], v4 offset:45056
s_waitcnt lgkmcnt(4)
v_mfma_f32_16x16x32_bf16 v[48:51], a[232:235], a[48:51], v[48:51]
v_mfma_f32_16x16x32_bf16 v[48:51], a[236:239], a[52:55], v[48:51]
ds_read_b128 a[224:227], v4 offset:37888
v_mfma_f32_16x16x32_bf16 v[52:55], a[232:235], a[120:123], v[52:55]
v_mfma_f32_16x16x32_bf16 v[52:55], a[236:239], a[124:127], v[52:55]
ds_read_b128 a[228:231], v4 offset:46080
s_waitcnt lgkmcnt(4)
v_mfma_f32_16x16x32_bf16 v[56:59], a[240:243], a[48:51], v[56:59]
v_mfma_f32_16x16x32_bf16 v[56:59], a[244:247], a[52:55], v[56:59]
ds_read_b128 a[232:235], v4 offset:38912
v_mfma_f32_16x16x32_bf16 v[60:63], a[240:243], a[120:123], v[60:63]
v_mfma_f32_16x16x32_bf16 v[60:63], a[244:247], a[124:127], v[60:63]
ds_read_b128 a[236:239], v4 offset:47104
s_waitcnt lgkmcnt(4)
v_mfma_f32_16x16x32_bf16 v[64:67], a[216:219], a[48:51], v[64:67]
v_mfma_f32_16x16x32_bf16 v[64:67], a[220:223], a[52:55], v[64:67]
ds_read_b128 a[240:243], v4 offset:39936
v_mfma_f32_16x16x32_bf16 v[68:71], a[216:219], a[120:123], v[68:71]
v_mfma_f32_16x16x32_bf16 v[68:71], a[220:223], a[124:127], v[68:71]
ds_read_b128 a[244:247], v4 offset:48128
s_waitcnt lgkmcnt(4)
v_mfma_f32_16x16x32_bf16 v[72:75], a[48:51], a[224:227], v[72:75]
v_mfma_f32_16x16x32_bf16 v[72:75], a[52:55], a[228:231], v[72:75]
ds_read_b128 a[216:219], v7 offset:32768
v_mfma_f32_16x16x32_bf16 v[76:79], a[120:123], a[224:227], v[76:79]
v_mfma_f32_16x16x32_bf16 v[76:79], a[124:127], a[228:231], v[76:79]
ds_read_b128 a[220:223], v7 offset:40960
s_waitcnt lgkmcnt(4)
v_mfma_f32_16x16x32_bf16 v[80:83], a[48:51], a[232:235], v[80:83]
v_mfma_f32_16x16x32_bf16 v[80:83], a[52:55], a[236:239], v[80:83]
ds_read_b128 a[224:227], v10 offset:32768
v_mfma_f32_16x16x32_bf16 v[84:87], a[120:123], a[232:235], v[84:87]
v_mfma_f32_16x16x32_bf16 v[84:87], a[124:127], a[236:239], v[84:87]
ds_read_b128 a[228:231], v10 offset:40960
s_waitcnt lgkmcnt(4)
v_mfma_f32_16x16x32_bf16 v[88:91], a[48:51], a[240:243], v[88:91]
v_mfma_f32_16x16x32_bf16 v[88:91], a[52:55], a[244:247], v[88:91]
ds_read_b128 a[232:235], v4 offset:49152
v_mfma_f32_16x16x32_bf16 v[92:95], a[120:123], a[240:243], v[92:95]
v_mfma_f32_16x16x32_bf16 v[92:95], a[124:127], a[244:247], v[92:95]
ds_read_b128 a[236:239], v4 offset:57344
s_waitcnt lgkmcnt(4)
v_mfma_f32_16x16x32_bf16 v[96:99], a[216:219], a[192:195], v[96:99]
ds_read_b128 a[240:243], v4 offset:50176
v_mfma_f32_16x16x32_bf16 v[96:99], a[220:223], a[196:199], v[96:99]
ds_read_b128 a[244:247], v4 offset:58368
s_waitcnt lgkmcnt(4)
v_mfma_f32_16x16x32_bf16 v[100:103], a[192:195], a[224:227], v[100:103]
ds_read_b128 a[216:219], v4 offset:51200
v_mfma_f32_16x16x32_bf16 v[100:103], a[196:199], a[228:231], v[100:103]
ds_read_b128 a[220:223], v4 offset:59392
s_waitcnt vmcnt(6)
s_waitcnt lgkmcnt(4)
v_mfma_f32_16x16x32_bf16 v[32:35], a[232:235], a[56:59], v[32:35]
v_mfma_f32_16x16x32_bf16 v[32:35], a[236:239], a[60:63], v[32:35]
ds_read_b128 a[224:227], v4 offset:52224
v_mfma_f32_16x16x32_bf16 v[36:39], a[232:235], a[128:131], v[36:39]
v_mfma_f32_16x16x32_bf16 v[36:39], a[236:239], a[132:135], v[36:39]
ds_read_b128 a[228:231], v4 offset:60416
s_waitcnt lgkmcnt(4)
v_mfma_f32_16x16x32_bf16 v[40:43], a[240:243], a[56:59], v[40:43]
v_mfma_f32_16x16x32_bf16 v[40:43], a[244:247], a[60:63], v[40:43]
ds_read_b128 a[232:235], v4 offset:53248
v_mfma_f32_16x16x32_bf16 v[44:47], a[240:243], a[128:131], v[44:47]
v_mfma_f32_16x16x32_bf16 v[44:47], a[244:247], a[132:135], v[44:47]
ds_read_b128 a[236:239], v4 offset:61440
s_waitcnt lgkmcnt(4)
v_mfma_f32_16x16x32_bf16 v[48:51], a[216:219], a[56:59], v[48:51]
v_mfma_f32_16x16x32_bf16 v[48:51], a[220:223], a[60:63], v[48:51]
ds_read_b128 a[240:243], v4 offset:54272
v_mfma_f32_16x16x32_bf16 v[52:55], a[216:219], a[128:131], v[52:55]
v_mfma_f32_16x16x32_bf16 v[52:55], a[220:223], a[132:135], v[52:55]
ds_read_b128 a[244:247], v4 offset:62464
s_waitcnt lgkmcnt(4)
v_mfma_f32_16x16x32_bf16 v[56:59], a[224:227], a[56:59], v[56:59]
v_mfma_f32_16x16x32_bf16 v[56:59], a[228:231], a[60:63], v[56:59]
ds_read_b128 a[216:219], v4 offset:55296
v_mfma_f32_16x16x32_bf16 v[60:63], a[224:227], a[128:131], v[60:63]
v_mfma_f32_16x16x32_bf16 v[60:63], a[228:231], a[132:135], v[60:63]
ds_read_b128 a[220:223], v4 offset:63488
s_waitcnt lgkmcnt(4)
v_mfma_f32_16x16x32_bf16 v[64:67], a[232:235], a[56:59], v[64:67]
v_mfma_f32_16x16x32_bf16 v[64:67], a[236:239], a[60:63], v[64:67]
ds_read_b128 a[224:227], v4 offset:56320
v_mfma_f32_16x16x32_bf16 v[68:71], a[232:235], a[128:131], v[68:71]
v_mfma_f32_16x16x32_bf16 v[68:71], a[236:239], a[132:135], v[68:71]
ds_read_b128 a[228:231], v4 offset:64512
s_waitcnt lgkmcnt(4)
v_mfma_f32_16x16x32_bf16 v[72:75], a[56:59], a[240:243], v[72:75]
v_mfma_f32_16x16x32_bf16 v[72:75], a[60:63], a[244:247], v[72:75]
ds_read_b128 a[232:235], v7 offset:49152
v_mfma_f32_16x16x32_bf16 v[76:79], a[128:131], a[240:243], v[76:79]
v_mfma_f32_16x16x32_bf16 v[76:79], a[132:135], a[244:247], v[76:79]
ds_read_b128 a[236:239], v7 offset:57344
s_waitcnt lgkmcnt(4)
v_mfma_f32_16x16x32_bf16 v[80:83], a[56:59], a[216:219], v[80:83]
v_mfma_f32_16x16x32_bf16 v[80:83], a[60:63], a[220:223], v[80:83]
ds_read_b128 a[240:243], v10 offset:49152
v_mfma_f32_16x16x32_bf16 v[84:87], a[128:131], a[216:219], v[84:87]
v_mfma_f32_16x16x32_bf16 v[84:87], a[132:135], a[220:223], v[84:87]
ds_read_b128 a[244:247], v10 offset:57344
s_waitcnt lgkmcnt(4)
v_mfma_f32_16x16x32_bf16 v[88:91], a[56:59], a[224:227], v[88:91]
v_mfma_f32_16x16x32_bf16 v[88:91], a[60:63], a[228:231], v[88:91]
ds_read_b128 a[216:219], v5 offset:0
v_mfma_f32_16x16x32_bf16 v[92:95], a[128:131], a[224:227], v[92:95]
v_mfma_f32_16x16x32_bf16 v[92:95], a[132:135], a[228:231], v[92:95]
ds_read_b128 a[220:223], v5 offset:8192
s_waitcnt lgkmcnt(4)
v_mfma_f32_16x16x32_bf16 v[96:99], a[232:235], a[200:203], v[96:99]
ds_read_b128 a[224:227], v5 offset:1024
v_mfma_f32_16x16x32_bf16 v[96:99], a[236:239], a[204:207], v[96:99]
ds_read_b128 a[228:231], v5 offset:9216
s_waitcnt lgkmcnt(4)
v_mfma_f32_16x16x32_bf16 v[100:103], a[200:203], a[240:243], v[100:103]
ds_read_b128 a[232:235], v5 offset:2048
v_mfma_f32_16x16x32_bf16 v[100:103], a[204:207], a[244:247], v[100:103]
ds_read_b128 a[236:239], v5 offset:10240
s_waitcnt vmcnt(0)
s_waitcnt lgkmcnt(4)
v_mfma_f32_16x16x32_bf16 v[32:35], a[216:219], a[64:67], v[32:35]
v_mfma_f32_16x16x32_bf16 v[32:35], a[220:223], a[68:71], v[32:35]
ds_read_b128 a[240:243], v5 offset:3072
v_mfma_f32_16x16x32_bf16 v[36:39], a[216:219], a[136:139], v[36:39]
v_mfma_f32_16x16x32_bf16 v[36:39], a[220:223], a[140:143], v[36:39]
ds_read_b128 a[244:247], v5 offset:11264
s_waitcnt lgkmcnt(4)
v_mfma_f32_16x16x32_bf16 v[40:43], a[224:227], a[64:67], v[40:43]
v_mfma_f32_16x16x32_bf16 v[40:43], a[228:231], a[68:71], v[40:43]
ds_read_b128 a[216:219], v5 offset:4096
v_mfma_f32_16x16x32_bf16 v[44:47], a[224:227], a[136:139], v[44:47]
v_mfma_f32_16x16x32_bf16 v[44:47], a[228:231], a[140:143], v[44:47]
ds_read_b128 a[220:223], v5 offset:12288
s_waitcnt lgkmcnt(4)
v_mfma_f32_16x16x32_bf16 v[48:51], a[232:235], a[64:67], v[48:51]
v_mfma_f32_16x16x32_bf16 v[48:51], a[236:239], a[68:71], v[48:51]
ds_read_b128 a[224:227], v5 offset:5120
v_mfma_f32_16x16x32_bf16 v[52:55], a[232:235], a[136:139], v[52:55]
v_mfma_f32_16x16x32_bf16 v[52:55], a[236:239], a[140:143], v[52:55]
ds_read_b128 a[228:231], v5 offset:13312
s_waitcnt lgkmcnt(4)
v_mfma_f32_16x16x32_bf16 v[56:59], a[240:243], a[64:67], v[56:59]
v_mfma_f32_16x16x32_bf16 v[56:59], a[244:247], a[68:71], v[56:59]
ds_read_b128 a[232:235], v5 offset:6144
v_mfma_f32_16x16x32_bf16 v[60:63], a[240:243], a[136:139], v[60:63]
v_mfma_f32_16x16x32_bf16 v[60:63], a[244:247], a[140:143], v[60:63]
ds_read_b128 a[236:239], v5 offset:14336
s_waitcnt lgkmcnt(4)
v_mfma_f32_16x16x32_bf16 v[64:67], a[216:219], a[64:67], v[64:67]
v_mfma_f32_16x16x32_bf16 v[64:67], a[220:223], a[68:71], v[64:67]
ds_read_b128 a[240:243], v5 offset:7168
v_mfma_f32_16x16x32_bf16 v[68:71], a[216:219], a[136:139], v[68:71]
v_mfma_f32_16x16x32_bf16 v[68:71], a[220:223], a[140:143], v[68:71]
ds_read_b128 a[244:247], v5 offset:15360
s_waitcnt lgkmcnt(4)
v_mfma_f32_16x16x32_bf16 v[72:75], a[64:67], a[224:227], v[72:75]
v_mfma_f32_16x16x32_bf16 v[72:75], a[68:71], a[228:231], v[72:75]
ds_read_b128 a[216:219], v8 offset:0
v_mfma_f32_16x16x32_bf16 v[76:79], a[136:139], a[224:227], v[76:79]
v_mfma_f32_16x16x32_bf16 v[76:79], a[140:143], a[228:231], v[76:79]
ds_read_b128 a[220:223], v8 offset:8192
s_waitcnt lgkmcnt(4)
v_mfma_f32_16x16x32_bf16 v[80:83], a[64:67], a[232:235], v[80:83]
v_mfma_f32_16x16x32_bf16 v[80:83], a[68:71], a[236:239], v[80:83]
ds_read_b128 a[224:227], v11 offset:0
v_mfma_f32_16x16x32_bf16 v[84:87], a[136:139], a[232:235], v[84:87]
v_mfma_f32_16x16x32_bf16 v[84:87], a[140:143], a[236:239], v[84:87]
ds_read_b128 a[228:231], v11 offset:8192
s_waitcnt lgkmcnt(4)
v_mfma_f32_16x16x32_bf16 v[88:91], a[64:67], a[240:243], v[88:91]
v_mfma_f32_16x16x32_bf16 v[88:91], a[68:71], a[244:247], v[88:91]
v_mfma_f32_16x16x32_bf16 v[92:95], a[136:139], a[240:243], v[92:95]
v_mfma_f32_16x16x32_bf16 v[92:95], a[140:143], a[244:247], v[92:95]
s_waitcnt lgkmcnt(2)
v_mfma_f32_16x16x32_bf16 v[96:99], a[216:219], a[208:211], v[96:99]
v_mfma_f32_16x16x32_bf16 v[96:99], a[220:223], a[212:215], v[96:99]
s_waitcnt lgkmcnt(0)
v_mfma_f32_16x16x32_bf16 v[100:103], a[208:211], a[224:227], v[100:103]
v_mfma_f32_16x16x32_bf16 v[100:103], a[212:215], a[228:231], v[100:103]
s_branch L_att
L_last:
s_cmp_eq_u32 s4, 3
s_cbranch_scc1 L_epoch
v_and_b32 v6, 7, v1
v_lshrrev_b32 v7, 3, v1
s_and_b32 s23, s6, 1
s_lshl_b32 s23, s23, 3
v_add_u32 v8, s23, v6
v_lshlrev_b32 v8, 4, v8
v_lshl_add_u32 v4, v7, 8, v8
s_lshl_b32 s24, s5, 4
s_lshr_b32 s25, s6, 1
s_add_u32 s24, s24, s25
s_mul_i32 s20, s24, 18432
s_lshl_b32 s24, s5, 8
s_lshl_b32 s25, s6, 3
s_add_u32 s24, s24, s25
s_and_b32 s25, s24, 1023
s_lshl_b32 s25, s25, 1
s_lshr_b32 s24, s24, 10
s_add_u32 s24, s24, s25
s_mul_i32 s21, s24, 1152
v_mul_u32_u24 v8, 2304, v6
v_lshl_add_u32 v5, v7, 4, v8
s_load_dwordx2 s[12:13], s[0:1], 56
s_waitcnt lgkmcnt(0)
s_mov_b32 s16, s12
s_and_b32 s17, s13, 0xffff
s_mov_b32 s18, 2359296
s_mov_b32 s19, 0x20000
s_lshl_b32 s22, s4, 2
s_lshr_b32 s23, 1056, s22
s_and_b32 s23, s23, 15
s_lshl_b32 s24, s23, 11
s_add_u32 s28, s20, s24
s_lshl_b32 s24, s23, 7
s_add_u32 s31, s21, s24
s_lshr_b32 s23, 790, s22
s_and_b32 s23, s23, 15
s_lshl_b32 s24, s23, 11
s_add_u32 s29, s20, s24
s_lshl_b32 s24, s23, 7
s_add_u32 s32, s21, s24
s_lshr_b32 s23, 2165, s22
s_and_b32 s23, s23, 15
s_lshl_b32 s24, s23, 11
s_add_u32 s30, s20, s24
s_lshl_b32 s24, s23, 7
s_add_u32 s33, s21, s24
s_lshl_b32 s26, s5, 12
s_add_u32 s27, s26, 1966080
s_add_u32 s26, s26, 1703936
v_and_b32 v6, 31, v1
v_lshlrev_b32 v6, 7, v6
buffer_load_dwordx2 v[10:11], v6, s[8:11], s27 offen sc1
v_mov_b32 v13, 2146435072
v_cmp_gt_u32 vcc, 16, v0
v_lshlrev_b32 v14, 3, v0
s_nop 0
v_cndmask_b32 v13, v13, v14, vcc
v_mov_b32 v14, s68
v_mov_b32 v15, s69
s_waitcnt vmcnt(0)
s_barrier
buffer_store_dwordx2 v[14:15], v13, s[8:11], s14 offen sc1
s_add_u32 s24, s28, 39776256
buffer_load_dwordx4 v[16:19], v4, s[8:11], s24 offen sc1
s_add_u32 s25, s29, 39776256
buffer_load_dwordx4 v[20:23], v4, s[8:11], s25 offen sc1
s_add_u32 s24, s30, 39776256
buffer_load_dwordx4 v[24:27], v4, s[8:11], s24 offen sc1
v_cmp_eq_u64 vcc, s[68:69], v[10:11]
s_nop 0
s_cmp_eq_u64 vcc, exec
s_cbranch_scc0 L_re_slow8
L_re_back8:
s_add_u32 s25, s28, 99020800
buffer_load_dwordx4 v[28:31], v4, s[8:11], s25 offen sc1
s_add_u32 s24, s28, 101380096
buffer_load_dwordx4 v[40:43], v4, s[8:11], s24 offen sc1
s_add_u32 s25, s28, 103739392
buffer_load_dwordx4 v[52:55], v4, s[8:11], s25 offen sc1
s_add_u32 s24, s28, 106098688
buffer_load_dwordx4 v[64:67], v4, s[8:11], s24 offen sc1
s_add_u32 s25, s28, 108457984
buffer_load_dwordx4 v[76:79], v4, s[8:11], s25 offen sc1
s_add_u32 s24, s28, 110817280
buffer_load_dwordx4 v[88:91], v4, s[8:11], s24 offen sc1
s_add_u32 s25, s28, 113176576
buffer_load_dwordx4 v[100:103], v4, s[8:11], s25 offen sc1
s_add_u32 s24, s28, 115535872
buffer_load_dwordx4 v[112:115], v4, s[8:11], s24 offen sc1
s_mov_b32 s52, 0
L_poll10:
buffer_load_dwordx2 v[14:15], v6, s[8:11], s26 offen sc1
s_add_u32 s52, s52, 1
s_waitcnt vmcnt(0)
v_cmp_ne_u64 vcc, s[68:69], v[14:15]
s_cmp_ge_u32 s52, 1048576
s_cbranch_scc1 L_got10
s_and_b64 exec, exec, vcc
s_cbranch_execnz L_poll10
L_got10:
s_mov_b64 exec, -1
s_add_u32 s24, s29, 99020800
buffer_load_dwordx4 v[32:35], v4, s[8:11], s24 offen sc1
s_add_u32 s25, s30, 99020800
buffer_load_dwordx4 v[36:39], v4, s[8:11], s25 offen sc1
s_add_u32 s25, s29, 101380096
buffer_load_dwordx4 v[44:47], v4, s[8:11], s25 offen sc1
s_add_u32 s24, s30, 101380096
buffer_load_dwordx4 v[48:51], v4, s[8:11], s24 offen sc1
s_add_u32 s24, s29, 103739392
buffer_load_dwordx4 v[56:59], v4, s[8:11], s24 offen sc1
s_add_u32 s25, s30, 103739392
buffer_load_dwordx4 v[60:63], v4, s[8:11], s25 offen sc1
s_add_u32 s25, s29, 106098688
buffer_load_dwordx4 v[68:71], v4, s[8:11], s25 offen sc1
s_add_u32 s24, s30, 106098688
buffer_load_dwordx4 v[72:75], v4, s[8:11], s24 offen sc1
s_add_u32 s24, s29, 108457984
buffer_load_dwordx4 v[80:83], v4, s[8:11], s24 offen sc1
s_add_u32 s25, s30, 108457984
buffer_load_dwordx4 v[84:87], v4, s[8:11], s25 offen sc1
s_add_u32 s25, s29, 110817280
buffer_load_dwordx4 v[92:95], v4, s[8:11], s25 offen sc1
s_add_u32 s24, s30, 110817280
buffer_load_dwordx4 v[96:99], v4, s[8:11], s24 offen sc1
s_add_u32 s24, s29, 113176576
buffer_load_dwordx4 v[104:107], v4, s[8:11], s24 offen sc1
s_add_u32 s25, s30, 113176576
buffer_load_dwordx4 v[108:111], v4, s[8:11], s25 offen sc1
s_add_u32 s25, s29, 115535872
buffer_load_dwordx4 v[116:119], v4, s[8:11], s25 offen sc1
s_add_u32 s24, s30, 115535872
buffer_load_dwordx4 v[120:123], v4, s[8:11], s24 offen sc1
s_waitcnt vmcnt(26)
v_lshlrev_b32 v128, 16, v16
v_and_b32 v129, 0xffff0000, v16
v_lshlrev_b32 v130, 16, v17
v_and_b32 v131, 0xffff0000, v17
v_lshlrev_b32 v132, 16, v18
v_and_b32 v133, 0xffff0000, v18
v_lshlrev_b32 v134, 16, v19
v_and_b32 v135, 0xffff0000, v19
s_waitcnt vmcnt(25)
v_lshlrev_b32 v136, 16, v20
v_and_b32 v137, 0xffff0000, v20
v_lshlrev_b32 v138, 16, v21
v_and_b32 v139, 0xffff0000, v21
v_lshlrev_b32 v140, 16, v22
v_and_b32 v141, 0xffff0000, v22
v_lshlrev_b32 v142, 16, v23
v_and_b32 v143, 0xffff0000, v23
s_waitcnt vmcnt(24)
v_lshlrev_b32 v144, 16, v24
v_and_b32 v145, 0xffff0000, v24
v_lshlrev_b32 v146, 16, v25
v_and_b32 v147, 0xffff0000, v25
v_lshlrev_b32 v148, 16, v26
v_and_b32 v149, 0xffff0000, v26
v_lshlrev_b32 v150, 16, v27
v_and_b32 v151, 0xffff0000, v27
s_waitcnt vmcnt(23)
v_lshlrev_b32 v6, 16, v28
v_and_b32 v7, 0xffff0000, v28
v_add_f32 v128, v128, v6
v_add_f32 v129, v129, v7
v_lshlrev_b32 v8, 16, v29
v_and_b32 v9, 0xffff0000, v29
v_add_f32 v130, v130, v8
v_add_f32 v131, v131, v9
v_lshlrev_b32 v6, 16, v30
v_and_b32 v7, 0xffff0000, v30
v_add_f32 v132, v132, v6
v_add_f32 v133, v133, v7
v_lshlrev_b32 v8, 16, v31
v_and_b32 v9, 0xffff0000, v31
v_add_f32 v134, v134, v8
v_add_f32 v135, v135, v9
s_waitcnt vmcnt(22)
v_lshlrev_b32 v6, 16, v40
v_and_b32 v7, 0xffff0000, v40
v_add_f32 v128, v128, v6
v_add_f32 v129, v129, v7
v_lshlrev_b32 v8, 16, v41
v_and_b32 v9, 0xffff0000, v41
v_add_f32 v130, v130, v8
v_add_f32 v131, v131, v9
v_lshlrev_b32 v6, 16, v42
v_and_b32 v7, 0xffff0000, v42
v_add_f32 v132, v132, v6
v_add_f32 v133, v133, v7
v_lshlrev_b32 v8, 16, v43
v_and_b32 v9, 0xffff0000, v43
v_add_f32 v134, v134, v8
v_add_f32 v135, v135, v9
s_waitcnt vmcnt(21)
v_lshlrev_b32 v6, 16, v52
v_and_b32 v7, 0xffff0000, v52
v_add_f32 v128, v128, v6
v_add_f32 v129, v129, v7
v_lshlrev_b32 v8, 16, v53
v_and_b32 v9, 0xffff0000, v53
v_add_f32 v130, v130, v8
v_add_f32 v131, v131, v9
v_lshlrev_b32 v6, 16, v54
v_and_b32 v7, 0xffff0000, v54
v_add_f32 v132, v132, v6
v_add_f32 v133, v133, v7
v_lshlrev_b32 v8, 16, v55
v_and_b32 v9, 0xffff0000, v55
v_add_f32 v134, v134, v8
v_add_f32 v135, v135, v9
s_waitcnt vmcnt(20)
v_lshlrev_b32 v6, 16, v64
v_and_b32 v7, 0xffff0000, v64
v_add_f32 v128, v128, v6
v_add_f32 v129, v129, v7
v_lshlrev_b32 v8, 16, v65
v_and_b32 v9, 0xffff0000, v65
v_add_f32 v130, v130, v8
v_add_f32 v131, v131, v9
v_lshlrev_b32 v6, 16, v66
v_and_b32 v7, 0xffff0000, v66
v_add_f32 v132, v132, v6
v_add_f32 v133, v133, v7
v_lshlrev_b32 v8, 16, v67
v_and_b32 v9, 0xffff0000, v67
v_add_f32 v134, v134, v8
v_add_f32 v135, v135, v9
s_waitcnt vmcnt(19)
v_lshlrev_b32 v6, 16, v76
v_and_b32 v7, 0xffff0000, v76
v_add_f32 v128, v128, v6
v_add_f32 v129, v129, v7
v_lshlrev_b32 v8, 16, v77
v_and_b32 v9, 0xffff0000, v77
v_add_f32 v130, v130, v8
v_add_f32 v131, v131, v9
v_lshlrev_b32 v6, 16, v78
v_and_b32 v7, 0xffff0000, v78
v_add_f32 v132, v132, v6
v_add_f32 v133, v133, v7
v_lshlrev_b32 v8, 16, v79
v_and_b32 v9, 0xffff0000, v79
v_add_f32 v134, v134, v8
v_add_f32 v135, v135, v9
s_waitcnt vmcnt(18)
v_lshlrev_b32 v6, 16, v88
v_and_b32 v7, 0xffff0000, v88
v_add_f32 v128, v128, v6
v_add_f32 v129, v129, v7
v_lshlrev_b32 v8, 16, v89
v_and_b32 v9, 0xffff0000, v89
v_add_f32 v130, v130, v8
v_add_f32 v131, v131, v9
v_lshlrev_b32 v6, 16, v90
v_and_b32 v7, 0xffff0000, v90
v_add_f32 v132, v132, v6
v_add_f32 v133, v133, v7
v_lshlrev_b32 v8, 16, v91
v_and_b32 v9, 0xffff0000, v91
v_add_f32 v134, v134, v8
v_add_f32 v135, v135, v9
s_waitcnt vmcnt(17)
v_lshlrev_b32 v6, 16, v100
v_and_b32 v7, 0xffff0000, v100
v_add_f32 v128, v128, v6
v_add_f32 v129, v129, v7
v_lshlrev_b32 v8, 16, v101
v_and_b32 v9, 0xffff0000, v101
v_add_f32 v130, v130, v8
v_add_f32 v131, v131, v9
v_lshlrev_b32 v6, 16, v102
v_and_b32 v7, 0xffff0000, v102
v_add_f32 v132, v132, v6
v_add_f32 v133, v133, v7
v_lshlrev_b32 v8, 16, v103
v_and_b32 v9, 0xffff0000, v103
v_add_f32 v134, v134, v8
v_add_f32 v135, v135, v9
s_waitcnt vmcnt(16)
v_lshlrev_b32 v6, 16, v112
v_and_b32 v7, 0xffff0000, v112
v_add_f32 v128, v128, v6
v_add_f32 v129, v129, v7
v_lshlrev_b32 v8, 16, v113
v_and_b32 v9, 0xffff0000, v113
v_add_f32 v130, v130, v8
v_add_f32 v131, v131, v9
v_lshlrev_b32 v6, 16, v114
v_and_b32 v7, 0xffff0000, v114
v_add_f32 v132, v132, v6
v_add_f32 v133, v133, v7
v_lshlrev_b32 v8, 16, v115
v_and_b32 v9, 0xffff0000, v115
v_add_f32 v134, v134, v8
v_add_f32 v135, v135, v9
s_waitcnt vmcnt(15)
v_lshlrev_b32 v6, 16, v32
v_and_b32 v7, 0xffff0000, v32
v_add_f32 v136, v136, v6
v_add_f32 v137, v137, v7
v_lshlrev_b32 v8, 16, v33
v_and_b32 v9, 0xffff0000, v33
v_add_f32 v138, v138, v8
v_add_f32 v139, v139, v9
v_lshlrev_b32 v6, 16, v34
v_and_b32 v7, 0xffff0000, v34
v_add_f32 v140, v140, v6
v_add_f32 v141, v141, v7
v_lshlrev_b32 v8, 16, v35
v_and_b32 v9, 0xffff0000, v35
v_add_f32 v142, v142, v8
v_add_f32 v143, v143, v9
s_waitcnt vmcnt(14)
v_lshlrev_b32 v6, 16, v36
v_and_b32 v7, 0xffff0000, v36
v_add_f32 v144, v144, v6
v_add_f32 v145, v145, v7
v_lshlrev_b32 v8, 16, v37
v_and_b32 v9, 0xffff0000, v37
v_add_f32 v146, v146, v8
v_add_f32 v147, v147, v9
v_lshlrev_b32 v6, 16, v38
v_and_b32 v7, 0xffff0000, v38
v_add_f32 v148, v148, v6
v_add_f32 v149, v149, v7
v_lshlrev_b32 v8, 16, v39
v_and_b32 v9, 0xffff0000, v39
v_add_f32 v150, v150, v8
v_add_f32 v151, v151, v9
s_waitcnt vmcnt(13)
v_lshlrev_b32 v6, 16, v44
v_and_b32 v7, 0xffff0000, v44
v_add_f32 v136, v136, v6
v_add_f32 v137, v137, v7
v_lshlrev_b32 v8, 16, v45
v_and_b32 v9, 0xffff0000, v45
v_add_f32 v138, v138, v8
v_add_f32 v139, v139, v9
v_lshlrev_b32 v6, 16, v46
v_and_b32 v7, 0xffff0000, v46
v_add_f32 v140, v140, v6
v_add_f32 v141, v141, v7
v_lshlrev_b32 v8, 16, v47
v_and_b32 v9, 0xffff0000, v47
v_add_f32 v142, v142, v8
v_add_f32 v143, v143, v9
s_waitcnt vmcnt(12)
v_lshlrev_b32 v6, 16, v48
v_and_b32 v7, 0xffff0000, v48
v_add_f32 v144, v144, v6
v_add_f32 v145, v145, v7
v_lshlrev_b32 v8, 16, v49
v_and_b32 v9, 0xffff0000, v49
v_add_f32 v146, v146, v8
v_add_f32 v147, v147, v9
v_lshlrev_b32 v6, 16, v50
v_and_b32 v7, 0xffff0000, v50
v_add_f32 v148, v148, v6
v_add_f32 v149, v149, v7
v_lshlrev_b32 v8, 16, v51
v_and_b32 v9, 0xffff0000, v51
v_add_f32 v150, v150, v8
v_add_f32 v151, v151, v9
s_waitcnt vmcnt(11)
v_lshlrev_b32 v6, 16, v56
v_and_b32 v7, 0xffff0000, v56
v_add_f32 v136, v136, v6
v_add_f32 v137, v137, v7
v_lshlrev_b32 v8, 16, v57
v_and_b32 v9, 0xffff0000, v57
v_add_f32 v138, v138, v8
v_add_f32 v139, v139, v9
v_lshlrev_b32 v6, 16, v58
v_and_b32 v7, 0xffff0000, v58
v_add_f32 v140, v140, v6
v_add_f32 v141, v141, v7
v_lshlrev_b32 v8, 16, v59
v_and_b32 v9, 0xffff0000, v59
v_add_f32 v142, v142, v8
v_add_f32 v143, v143, v9
s_waitcnt vmcnt(10)
v_lshlrev_b32 v6, 16, v60
v_and_b32 v7, 0xffff0000, v60
v_add_f32 v144, v144, v6
v_add_f32 v145, v145, v7
v_lshlrev_b32 v8, 16, v61
v_and_b32 v9, 0xffff0000, v61
v_add_f32 v146, v146, v8
v_add_f32 v147, v147, v9
v_lshlrev_b32 v6, 16, v62
v_and_b32 v7, 0xffff0000, v62
v_add_f32 v148, v148, v6
v_add_f32 v149, v149, v7
v_lshlrev_b32 v8, 16, v63
v_and_b32 v9, 0xffff0000, v63
v_add_f32 v150, v150, v8
v_add_f32 v151, v151, v9
s_waitcnt vmcnt(9)
v_lshlrev_b32 v6, 16, v68
v_and_b32 v7, 0xffff0000, v68
v_add_f32 v136, v136, v6
v_add_f32 v137, v137, v7
v_lshlrev_b32 v8, 16, v69
v_and_b32 v9, 0xffff0000, v69
v_add_f32 v138, v138, v8
v_add_f32 v139, v139, v9
v_lshlrev_b32 v6, 16, v70
v_and_b32 v7, 0xffff0000, v70
v_add_f32 v140, v140, v6
v_add_f32 v141, v141, v7
v_lshlrev_b32 v8, 16, v71
v_and_b32 v9, 0xffff0000, v71
v_add_f32 v142, v142, v8
v_add_f32 v143, v143, v9
s_waitcnt vmcnt(8)
v_lshlrev_b32 v6, 16, v72
v_and_b32 v7, 0xffff0000, v72
v_add_f32 v144, v144, v6
v_add_f32 v145, v145, v7
v_lshlrev_b32 v8, 16, v73
v_and_b32 v9, 0xffff0000, v73
v_add_f32 v146, v146, v8
v_add_f32 v147, v147, v9
v_lshlrev_b32 v6, 16, v74
v_and_b32 v7, 0xffff0000, v74
v_add_f32 v148, v148, v6
v_add_f32 v149, v149, v7
v_lshlrev_b32 v8, 16, v75
v_and_b32 v9, 0xffff0000, v75
v_add_f32 v150, v150, v8
v_add_f32 v151, v151, v9
s_waitcnt vmcnt(7)
v_lshlrev_b32 v6, 16, v80
v_and_b32 v7, 0xffff0000, v80
v_add_f32 v136, v136, v6
v_add_f32 v137, v137, v7
v_lshlrev_b32 v8, 16, v81
v_and_b32 v9, 0xffff0000, v81
v_add_f32 v138, v138, v8
v_add_f32 v139, v139, v9
v_lshlrev_b32 v6, 16, v82
v_and_b32 v7, 0xffff0000, v82
v_add_f32 v140, v140, v6
v_add_f32 v141, v141, v7
v_lshlrev_b32 v8, 16, v83
v_and_b32 v9, 0xffff0000, v83
v_add_f32 v142, v142, v8
v_add_f32 v143, v143, v9
s_waitcnt vmcnt(6)
v_lshlrev_b32 v6, 16, v84
v_and_b32 v7, 0xffff0000, v84
v_add_f32 v144, v144, v6
v_add_f32 v145, v145, v7
v_lshlrev_b32 v8, 16, v85
v_and_b32 v9, 0xffff0000, v85
v_add_f32 v146, v146, v8
v_add_f32 v147, v147, v9
v_lshlrev_b32 v6, 16, v86
v_and_b32 v7, 0xffff0000, v86
v_add_f32 v148, v148, v6
v_add_f32 v149, v149, v7
v_lshlrev_b32 v8, 16, v87
v_and_b32 v9, 0xffff0000, v87
v_add_f32 v150, v150, v8
v_add_f32 v151, v151, v9
s_waitcnt vmcnt(5)
v_lshlrev_b32 v6, 16, v92
v_and_b32 v7, 0xffff0000, v92
v_add_f32 v136, v136, v6
v_add_f32 v137, v137, v7
v_lshlrev_b32 v8, 16, v93
v_and_b32 v9, 0xffff0000, v93
v_add_f32 v138, v138, v8
v_add_f32 v139, v139, v9
v_lshlrev_b32 v6, 16, v94
v_and_b32 v7, 0xffff0000, v94
v_add_f32 v140, v140, v6
v_add_f32 v141, v141, v7
v_lshlrev_b32 v8, 16, v95
v_and_b32 v9, 0xffff0000, v95
v_add_f32 v142, v142, v8
v_add_f32 v143, v143, v9
s_waitcnt vmcnt(4)
v_lshlrev_b32 v6, 16, v96
v_and_b32 v7, 0xffff0000, v96
v_add_f32 v144, v144, v6
v_add_f32 v145, v145, v7
v_lshlrev_b32 v8, 16, v97
v_and_b32 v9, 0xffff0000, v97
v_add_f32 v146, v146, v8
v_add_f32 v147, v147, v9
v_lshlrev_b32 v6, 16, v98
v_and_b32 v7, 0xffff0000, v98
v_add_f32 v148, v148, v6
v_add_f32 v149, v149, v7
v_lshlrev_b32 v8, 16, v99
v_and_b32 v9, 0xffff0000, v99
v_add_f32 v150, v150, v8
v_add_f32 v151, v151, v9
s_waitcnt vmcnt(3)
v_lshlrev_b32 v6, 16, v104
v_and_b32 v7, 0xffff0000, v104
v_add_f32 v136, v136, v6
v_add_f32 v137, v137, v7
v_lshlrev_b32 v8, 16, v105
v_and_b32 v9, 0xffff0000, v105
v_add_f32 v138, v138, v8
v_add_f32 v139, v139, v9
v_lshlrev_b32 v6, 16, v106
v_and_b32 v7, 0xffff0000, v106
v_add_f32 v140, v140, v6
v_add_f32 v141, v141, v7
v_lshlrev_b32 v8, 16, v107
v_and_b32 v9, 0xffff0000, v107
v_add_f32 v142, v142, v8
v_add_f32 v143, v143, v9
s_waitcnt vmcnt(2)
v_lshlrev_b32 v6, 16, v108
v_and_b32 v7, 0xffff0000, v108
v_add_f32 v144, v144, v6
v_add_f32 v145, v145, v7
v_lshlrev_b32 v8, 16, v109
v_and_b32 v9, 0xffff0000, v109
v_add_f32 v146, v146, v8
v_add_f32 v147, v147, v9
v_lshlrev_b32 v6, 16, v110
v_and_b32 v7, 0xffff0000, v110
v_add_f32 v148, v148, v6
v_add_f32 v149, v149, v7
v_lshlrev_b32 v8, 16, v111
v_and_b32 v9, 0xffff0000, v111
v_add_f32 v150, v150, v8
v_add_f32 v151, v151, v9
s_waitcnt vmcnt(1)
v_lshlrev_b32 v6, 16, v116
v_and_b32 v7, 0xffff0000, v116
v_add_f32 v136, v136, v6
v_add_f32 v137, v137, v7
v_lshlrev_b32 v8, 16, v117
v_and_b32 v9, 0xffff0000, v117
v_add_f32 v138, v138, v8
v_add_f32 v139, v139, v9
v_lshlrev_b32 v6, 16, v118
v_and_b32 v7, 0xffff0000, v118
v_add_f32 v140, v140, v6
v_add_f32 v141, v141, v7
v_lshlrev_b32 v8, 16, v119
v_and_b32 v9, 0xffff0000, v119
v_add_f32 v142, v142, v8
v_add_f32 v143, v143, v9
s_waitcnt vmcnt(0)
v_lshlrev_b32 v6, 16, v120
v_and_b32 v7, 0xffff0000, v120
v_add_f32 v144, v144, v6
v_add_f32 v145, v145, v7
v_lshlrev_b32 v8, 16, v121
v_and_b32 v9, 0xffff0000, v121
v_add_f32 v146, v146, v8
v_add_f32 v147, v147, v9
v_lshlrev_b32 v6, 16, v122
v_and_b32 v7, 0xffff0000, v122
v_add_f32 v148, v148, v6
v_add_f32 v149, v149, v7
v_lshlrev_b32 v8, 16, v123
v_and_b32 v9, 0xffff0000, v123
v_add_f32 v150, v150, v8
v_add_f32 v151, v151, v9
v_cvt_pk_bf16_f32 v152, v128, v129
v_cvt_pk_bf16_f32 v153, v130, v131
v_cvt_pk_bf16_f32 v154, v132, v133
v_cvt_pk_bf16_f32 v155, v134, v135
v_cvt_pk_bf16_f32 v156, v136, v137
v_cvt_pk_bf16_f32 v157, v138, v139
v_cvt_pk_bf16_f32 v158, v140, v141
v_cvt_pk_bf16_f32 v159, v142, v143
v_cvt_pk_bf16_f32 v160, v144, v145
v_cvt_pk_bf16_f32 v161, v146, v147
v_cvt_pk_bf16_f32 v162, v148, v149
v_cvt_pk_bf16_f32 v163, v150, v151
buffer_store_dwordx4 v[152:155], v5, s[16:19], s31 offen
buffer_store_dwordx4 v[156:159], v5, s[16:19], s32 offen
buffer_store_dwordx4 v[160:163], v5, s[16:19], s33 offen
L_end:
s_endpgm
L_f_slow1:
s_mov_b32 s52, 0
L_f_spin1:
buffer_load_dwordx2 v[14:15], v11, s[8:11], s23 offen sc1
s_add_u32 s52, s52, 1
s_waitcnt vmcnt(0)
v_cmp_eq_u64 vcc, s[68:69], v[14:15]
s_cmp_gt_u32 s52, 1048576
s_cbranch_scc1 L_f_back1
s_cmp_eq_u64 vcc, exec
s_cbranch_scc0 L_f_spin1
s_branch L_f_back1
L_f_slow2:
s_mov_b32 s52, 0
L_f_spin2:
buffer_load_dwordx2 v[14:15], v11, s[8:11], s23 offen sc1
s_add_u32 s52, s52, 1
s_waitcnt vmcnt(0)
v_cmp_eq_u64 vcc, s[68:69], v[14:15]
s_cmp_gt_u32 s52, 1048576
s_cbranch_scc1 L_f_back2
s_cmp_eq_u64 vcc, exec
s_cbranch_scc0 L_f_spin2
s_branch L_f_back2
L_f_slow3:
s_mov_b32 s52, 0
L_f_spin3:
buffer_load_dwordx2 v[14:15], v11, s[8:11], s23 offen sc1
s_add_u32 s52, s52, 1
s_waitcnt vmcnt(0)
v_cmp_eq_u64 vcc, s[68:69], v[14:15]
s_cmp_gt_u32 s52, 1048576
s_cbranch_scc1 L_f_back3
s_cmp_eq_u64 vcc, exec
s_cbranch_scc0 L_f_spin3
s_branch L_f_back3
L_re_slow4:
s_mov_b32 s52, 0
L_poll5:
buffer_load_dwordx2 v[14:15], v6, s[8:11], s27 offen sc1
s_add_u32 s52, s52, 1
s_waitcnt vmcnt(0)
v_cmp_ne_u64 vcc, s[68:69], v[14:15]
s_cmp_ge_u32 s52, 1048576
s_cbranch_scc1 L_got5
s_and_b64 exec, exec, vcc
s_cbranch_execnz L_poll5
L_got5:
s_mov_b64 exec, -1
s_branch L_re_back4
L_re_slow8:
s_mov_b32 s52, 0
L_poll9:
buffer_load_dwordx2 v[14:15], v6, s[8:11], s27 offen sc1
s_add_u32 s52, s52, 1
s_waitcnt vmcnt(0)
v_cmp_ne_u64 vcc, s[68:69], v[14:15]
s_cmp_ge_u32 s52, 1048576
s_cbranch_scc1 L_got9
s_and_b64 exec, exec, vcc
s_cbranch_execnz L_poll9
L_got9:
s_mov_b64 exec, -1
s_branch L_re_back8
L_epoch:
v_mov_b32 v13, 2146435072
v_cmp_gt_u32 vcc, 16, v0
v_lshlrev_b32 v14, 3, v0
s_nop 0
v_cndmask_b32 v13, v13, v14, vcc
v_mov_b32 v14, s68
v_mov_b32 v15, s69
s_waitcnt vmcnt(0)
s_barrier
buffer_store_dwordx2 v[14:15], v13, s[8:11], s14 offen sc1
s_cmp_lg_u32 s2, 0
s_cbranch_scc1 L_end
s_load_dwordx2 s[12:13], s[0:1], 64
s_waitcnt lgkmcnt(0)
s_mov_b32 s44, s12
s_and_b32 s45, s13, 0xffff
s_mov_b32 s46, 256
s_mov_b32 s47, 0x20000
v_mov_b32 v3, 0
s_mov_b32 s52, 0
L_ep:
buffer_load_dword v4, v3, s[44:47], 0 offen sc1
s_add_u32 s52, s52, 1
s_waitcnt vmcnt(0)
v_readfirstlane_b32 s40, v4
s_cmp_ge_u32 s52, 0x100000
s_cbranch_scc1 L_end
s_cmp_lt_u32 s40, 256
s_cbranch_scc1 L_ep
s_mov_b32 s40, 4194304
v_mov_b32 v13, 2146435072
v_cmp_gt_u32 vcc, 16, v1
v_lshlrev_b32 v14, 3, v1
s_nop 0
v_cndmask_b32 v13, v13, v14, vcc
v_mov_b32 v14, s68
v_mov_b32 v15, s69
buffer_store_dwordx2 v[14:15], v13, s[8:11], s40 offen sc1
s_branch L_end
L_code_end:
s_endpgm
.section .rodata,"a"
.p2align 6
.amdhsa_kernel interleave_layers__sliding_local_dilated__glu_gated_geglu__prompt_kernel
  .amdhsa_next_free_vgpr 512
  .amdhsa_next_free_sgpr 102
  .amdhsa_accum_offset 256
  .amdhsa_group_segment_fixed_size 0
  .amdhsa_kernarg_size 80
  .amdhsa_user_sgpr_count 2
  .amdhsa_user_sgpr_kernarg_segment_ptr 1
  .amdhsa_system_sgpr_workgroup_id_x 1
.end_amdhsa_kernel
```

```asm
; @launch grid=(256,1,1) block=(256,1,1) lds=160768
.amdgcn_target "amdgcn-amd-amdhsa--gfx950"
.text
.p2align 8
.globl interleave_layers__sliding_local_dilated__glu_gated_geglu__prompt_kernel
.type interleave_layers__sliding_local_dilated__glu_gated_geglu__prompt_kernel,@function
interleave_layers__sliding_local_dilated__glu_gated_geglu__prompt_kernel:
s_cmp_ge_u32 s2, 256
s_cbranch_scc1 L_end
s_getpc_b64 s[40:41]
L_warm_pc:
s_lshr_b32 s42, s2, 3
s_lshl_b32 s42, s42, 11
v_lshlrev_b32 v10, 3, v0
v_add_u32 v10, s42, v10
v_min_u32 v10, L_code_end - L_warm_pc - 8, v10
v_mov_b32 v11, s41
v_add_co_u32 v10, vcc, s40, v10
s_nop 1
v_addc_co_u32 v11, vcc, 0, v11, vcc
global_load_dwordx2 a[0:1], v[10:11], off
v_add_co_u32 v10, vcc, 0x10000, v10
s_nop 1
v_addc_co_u32 v11, vcc, 0, v11, vcc
s_add_u32 s42, s42, 67584
s_cmp_le_u32 s42, L_code_end - L_warm_pc - 8
s_cbranch_scc0 L_warm_done
global_load_dwordx2 a[2:3], v[10:11], off
L_warm_done:
s_load_dwordx4 s[56:59], s[0:1], 0
s_load_dwordx2 s[60:61], s[0:1], 16
s_load_dwordx4 s[64:67], s[0:1], 32
s_load_dwordx2 s[62:63], s[0:1], 48
s_load_dwordx2 s[12:13], s[0:1], 72
v_and_b32 v1, 63, v0
v_lshrrev_b32 v3, 6, v0
v_lshlrev_b32 v2, 4, v1
v_readfirstlane_b32 s4, v3
s_and_b32 s5, s2, 7
s_lshr_b32 s6, s2, 3
s_waitcnt lgkmcnt(0)
s_mov_b32 s8, s12
s_and_b32 s9, s13, 0xffff
s_mov_b32 s10, 268435456
s_mov_b32 s11, 0x20000
s_mov_b32 s16, s56
s_and_b32 s17, s57, 0xffff
s_mov_b32 s18, 2359296
s_mov_b32 s19, 0x20000
v_mov_b32 v3, 4194304
buffer_load_dwordx2 v[14:15], v3, s[8:11], 0 offen sc1
v_and_b32 v6, 7, v1
v_lshrrev_b32 v7, 3, v1
s_and_b32 s23, s6, 1
s_lshl_b32 s23, s23, 3
v_add_u32 v8, s23, v6
v_lshlrev_b32 v8, 4, v8
v_lshl_add_u32 v4, v7, 8, v8
s_lshl_b32 s24, s5, 4
s_lshr_b32 s25, s6, 1
s_add_u32 s24, s24, s25
s_mul_i32 s20, s24, 18432
s_lshl_b32 s24, s5, 8
s_lshl_b32 s25, s6, 3
s_add_u32 s24, s24, s25
s_and_b32 s25, s24, 1023
s_lshl_b32 s25, s25, 1
s_lshr_b32 s24, s24, 10
s_add_u32 s24, s24, s25
s_mul_i32 s21, s24, 1152
v_mul_u32_u24 v8, 2304, v6
v_lshl_add_u32 v5, v7, 4, v8
s_lshl_b32 s22, s4, 2
s_lshr_b32 s23, 1056, s22
s_and_b32 s23, s23, 15
s_lshl_b32 s24, s23, 11
s_add_u32 s28, s20, s24
s_lshl_b32 s24, s23, 7
s_add_u32 s31, s21, s24
s_lshr_b32 s23, 790, s22
s_and_b32 s23, s23, 15
s_lshl_b32 s24, s23, 11
s_add_u32 s29, s20, s24
s_lshl_b32 s24, s23, 7
s_add_u32 s32, s21, s24
s_lshr_b32 s23, 2165, s22
s_and_b32 s23, s23, 15
s_lshl_b32 s24, s23, 11
s_add_u32 s30, s20, s24
s_lshl_b32 s24, s23, 7
s_add_u32 s33, s21, s24
s_cmp_eq_u32 s4, 3
s_cselect_b64 vcc, -1, 0
v_mov_b32 v8, 2146435072
v_cndmask_b32 v4, v4, v8, vcc
v_cndmask_b32 v5, v5, v8, vcc
buffer_load_dwordx4 v[16:19], v5, s[16:19], s31 offen nt
buffer_load_dwordx4 v[20:23], v5, s[16:19], s32 offen nt
buffer_load_dwordx4 v[24:27], v5, s[16:19], s33 offen nt
s_lshl_b32 s40, s6, 2
s_add_u32 s40, s40, s4
v_and_b32 v6, 15, v1
v_lshrrev_b32 v7, 4, v1
v_lshrrev_b32 v8, 2, v6
v_mov_b32 v12, 2146435072
s_cmp_ge_u32 s40, 84
s_cbranch_scc1 L_g_o
s_mov_b32 s44, s58
s_and_b32 s45, s59, 0xffff
s_mov_b32 s46, 1990656
s_mov_b32 s47, 0x20000
s_cmp_ge_u32 s40, 42
s_cselect_b32 s41, 1, 0
s_mul_i32 s42, s41, 42
s_sub_u32 s40, s40, s42
s_mul_i32 s40, s40, 3
s_lshl_b32 s42, s5, 1
s_add_u32 s41, s41, s42
s_mul_i32 s38, s41, 129024
s_lshl_b32 s42, s40, 10
s_add_u32 s38, s38, s42
s_add_u32 s38, s38, 4198400
s_mul_i32 s41, s41, 36
v_and_b32 v9, 1, v6
v_bfe_u32 v10, v6, 1, 1
v_mul_u32_u24 v10, 18, v10
v_add_u32 v9, v9, v10
v_mul_u32_u24 v10, 576, v8
v_add_u32 v9, v9, v10
v_mul_u32_u24 v10, 27648, v7
s_add_u32 s43, s40, 0
s_mul_i32 s42, s43, 9363
s_lshr_b32 s42, s42, 16
s_mul_i32 s35, s42, 7
s_sub_u32 s43, s43, s35
s_mul_i32 s42, s42, 110592
s_mov_b32 s35, 0
s_cmp_eq_u32 s43, 1
s_cselect_b32 s35, 18, s35
s_cmp_eq_u32 s43, 2
s_cselect_b32 s35, 576, s35
s_cmp_eq_u32 s43, 3
s_cselect_b32 s35, 594, s35
s_cmp_eq_u32 s43, 4
s_cselect_b32 s35, 16, s35
s_cmp_eq_u32 s43, 5
s_cselect_b32 s35, 1152, s35
s_cmp_eq_u32 s43, 6
s_cselect_b32 s35, 1170, s35
s_add_u32 s35, s35, s41
s_cmp_eq_u32 s43, 4
s_cselect_b32 s36, 12, 16
s_cselect_b64 vcc, -1, 0
v_cndmask_b32 v11, v6, v9, vcc
v_add_u32 v11, s35, v11
v_lshl_add_u32 v11, v11, 1, v10
v_cmp_gt_u32 vcc, s36, v6
s_nop 1
v_cndmask_b32 v11, v12, v11, vcc
buffer_load_ushort v52, v11, s[44:47], s42 offen
s_add_u32 s42, s42, 3456
buffer_load_ushort v53, v11, s[44:47], s42 offen
s_add_u32 s42, s42, 3456
buffer_load_ushort v54, v11, s[44:47], s42 offen
s_add_u32 s42, s42, 3456
buffer_load_ushort v55, v11, s[44:47], s42 offen
s_add_u32 s42, s42, 3456
buffer_load_ushort v56, v11, s[44:47], s42 offen
s_add_u32 s42, s42, 3456
buffer_load_ushort v57, v11, s[44:47], s42 offen
s_add_u32 s42, s42, 3456
buffer_load_ushort v58, v11, s[44:47], s42 offen
s_add_u32 s42, s42, 3456
buffer_load_ushort v59, v11, s[44:47], s42 offen
s_add_u32 s43, s40, 1
s_mul_i32 s42, s43, 9363
s_lshr_b32 s42, s42, 16
s_mul_i32 s35, s42, 7
s_sub_u32 s43, s43, s35
s_mul_i32 s42, s42, 110592
s_mov_b32 s35, 0
s_cmp_eq_u32 s43, 1
s_cselect_b32 s35, 18, s35
s_cmp_eq_u32 s43, 2
s_cselect_b32 s35, 576, s35
s_cmp_eq_u32 s43, 3
s_cselect_b32 s35, 594, s35
s_cmp_eq_u32 s43, 4
s_cselect_b32 s35, 16, s35
s_cmp_eq_u32 s43, 5
s_cselect_b32 s35, 1152, s35
s_cmp_eq_u32 s43, 6
s_cselect_b32 s35, 1170, s35
s_add_u32 s35, s35, s41
s_cmp_eq_u32 s43, 4
s_cselect_b32 s36, 12, 16
s_cselect_b64 vcc, -1, 0
v_cndmask_b32 v11, v6, v9, vcc
v_add_u32 v11, s35, v11
v_lshl_add_u32 v11, v11, 1, v10
v_cmp_gt_u32 vcc, s36, v6
s_nop 1
v_cndmask_b32 v11, v12, v11, vcc
buffer_load_ushort v60, v11, s[44:47], s42 offen
s_add_u32 s42, s42, 3456
buffer_load_ushort v61, v11, s[44:47], s42 offen
s_add_u32 s42, s42, 3456
buffer_load_ushort v62, v11, s[44:47], s42 offen
s_add_u32 s42, s42, 3456
buffer_load_ushort v63, v11, s[44:47], s42 offen
s_add_u32 s42, s42, 3456
buffer_load_ushort v64, v11, s[44:47], s42 offen
s_add_u32 s42, s42, 3456
buffer_load_ushort v65, v11, s[44:47], s42 offen
s_add_u32 s42, s42, 3456
buffer_load_ushort v66, v11, s[44:47], s42 offen
s_add_u32 s42, s42, 3456
buffer_load_ushort v67, v11, s[44:47], s42 offen
s_add_u32 s43, s40, 2
s_mul_i32 s42, s43, 9363
s_lshr_b32 s42, s42, 16
s_mul_i32 s35, s42, 7
s_sub_u32 s43, s43, s35
s_mul_i32 s42, s42, 110592
s_mov_b32 s35, 0
s_cmp_eq_u32 s43, 1
s_cselect_b32 s35, 18, s35
s_cmp_eq_u32 s43, 2
s_cselect_b32 s35, 576, s35
s_cmp_eq_u32 s43, 3
s_cselect_b32 s35, 594, s35
s_cmp_eq_u32 s43, 4
s_cselect_b32 s35, 16, s35
s_cmp_eq_u32 s43, 5
s_cselect_b32 s35, 1152, s35
s_cmp_eq_u32 s43, 6
s_cselect_b32 s35, 1170, s35
s_add_u32 s35, s35, s41
s_cmp_eq_u32 s43, 4
s_cselect_b32 s36, 12, 16
s_cselect_b64 vcc, -1, 0
v_cndmask_b32 v11, v6, v9, vcc
v_add_u32 v11, s35, v11
v_lshl_add_u32 v11, v11, 1, v10
v_cmp_gt_u32 vcc, s36, v6
s_nop 1
v_cndmask_b32 v11, v12, v11, vcc
buffer_load_ushort v68, v11, s[44:47], s42 offen
s_add_u32 s42, s42, 3456
buffer_load_ushort v69, v11, s[44:47], s42 offen
s_add_u32 s42, s42, 3456
buffer_load_ushort v70, v11, s[44:47], s42 offen
s_add_u32 s42, s42, 3456
buffer_load_ushort v71, v11, s[44:47], s42 offen
s_add_u32 s42, s42, 3456
buffer_load_ushort v72, v11, s[44:47], s42 offen
s_add_u32 s42, s42, 3456
buffer_load_ushort v73, v11, s[44:47], s42 offen
s_add_u32 s42, s42, 3456
buffer_load_ushort v74, v11, s[44:47], s42 offen
s_add_u32 s42, s42, 3456
buffer_load_ushort v75, v11, s[44:47], s42 offen
s_branch L_g_done
L_g_o:
s_mov_b32 s44, s60
s_and_b32 s45, s61, 0xffff
s_mov_b32 s46, 663552
s_mov_b32 s47, 0x20000
s_sub_u32 s40, s40, 84
s_mul_i32 s40, s40, 3
s_mul_i32 s38, s5, 92160
s_lshl_b32 s42, s40, 10
s_add_u32 s38, s38, s42
s_add_u32 s38, s38, 6266880
s_cmp_ge_u32 s40, 90
s_cselect_b32 s38, 2146435072, s38
s_mul_i32 s41, s5, 72
v_and_b32 v9, 3, v6
v_lshl_add_u32 v9, v8, 3, v9
s_add_u32 s42, s40, 0
s_mul_i32 s43, s42, 13108
s_lshr_b32 s43, s43, 16
s_mul_i32 s35, s43, 5
s_sub_u32 s42, s42, s35
s_lshr_b32 s35, s42, 1
s_lshl_b32 s35, s35, 5
s_and_b32 s36, s42, 1
s_lshl_b32 s36, s36, 2
s_add_u32 s35, s35, s36
s_add_u32 s35, s35, s41
s_cmp_eq_u32 s42, 4
s_cselect_b64 vcc, -1, 0
s_cselect_b32 s36, 8, 16
v_cndmask_b32 v11, v9, v6, vcc
v_add_u32 v11, s35, v11
s_mul_i32 s35, s43, 41472
s_sub_u32 s37, s43, 16
s_mul_i32 s37, s37, 331776
s_cmp_lt_u32 s43, 16
s_cselect_b32 s35, s35, s37
s_cselect_b32 s37, 4, 72
s_cselect_b32 s34, 0, 1
s_mul_i32 s37, s37, 1152
v_mul_lo_u32 v10, s37, v7
v_lshl_add_u32 v11, v11, 1, v10
v_cmp_gt_u32 vcc, s36, v6
s_nop 1
v_cndmask_b32 v11, v12, v11, vcc
s_mul_i32 s42, s34, 18432
s_add_u32 s42, s42, 0
s_add_u32 s42, s42, s35
buffer_load_ushort v52, v11, s[44:47], s42 offen
s_mul_i32 s42, s34, 18432
s_add_u32 s42, s42, 1152
s_add_u32 s42, s42, s35
buffer_load_ushort v53, v11, s[44:47], s42 offen
s_mul_i32 s42, s34, 36864
s_add_u32 s42, s42, 2304
s_add_u32 s42, s42, s35
buffer_load_ushort v54, v11, s[44:47], s42 offen
s_mul_i32 s42, s34, 36864
s_add_u32 s42, s42, 3456
s_add_u32 s42, s42, s35
buffer_load_ushort v55, v11, s[44:47], s42 offen
s_mul_i32 s42, s34, 39168
s_add_u32 s42, s42, 20736
s_add_u32 s42, s42, s35
buffer_load_ushort v56, v11, s[44:47], s42 offen
s_mul_i32 s42, s34, 39168
s_add_u32 s42, s42, 21888
s_add_u32 s42, s42, s35
buffer_load_ushort v57, v11, s[44:47], s42 offen
s_mul_i32 s42, s34, 57600
s_add_u32 s42, s42, 23040
s_add_u32 s42, s42, s35
buffer_load_ushort v58, v11, s[44:47], s42 offen
s_mul_i32 s42, s34, 57600
s_add_u32 s42, s42, 24192
s_add_u32 s42, s42, s35
buffer_load_ushort v59, v11, s[44:47], s42 offen
s_add_u32 s42, s40, 1
s_mul_i32 s43, s42, 13108
s_lshr_b32 s43, s43, 16
s_mul_i32 s35, s43, 5
s_sub_u32 s42, s42, s35
s_lshr_b32 s35, s42, 1
s_lshl_b32 s35, s35, 5
s_and_b32 s36, s42, 1
s_lshl_b32 s36, s36, 2
s_add_u32 s35, s35, s36
s_add_u32 s35, s35, s41
s_cmp_eq_u32 s42, 4
s_cselect_b64 vcc, -1, 0
s_cselect_b32 s36, 8, 16
v_cndmask_b32 v11, v9, v6, vcc
v_add_u32 v11, s35, v11
s_mul_i32 s35, s43, 41472
s_sub_u32 s37, s43, 16
s_mul_i32 s37, s37, 331776
s_cmp_lt_u32 s43, 16
s_cselect_b32 s35, s35, s37
s_cselect_b32 s37, 4, 72
s_cselect_b32 s34, 0, 1
s_mul_i32 s37, s37, 1152
v_mul_lo_u32 v10, s37, v7
v_lshl_add_u32 v11, v11, 1, v10
v_cmp_gt_u32 vcc, s36, v6
s_nop 1
v_cndmask_b32 v11, v12, v11, vcc
s_mul_i32 s42, s34, 18432
s_add_u32 s42, s42, 0
s_add_u32 s42, s42, s35
buffer_load_ushort v60, v11, s[44:47], s42 offen
s_mul_i32 s42, s34, 18432
s_add_u32 s42, s42, 1152
s_add_u32 s42, s42, s35
buffer_load_ushort v61, v11, s[44:47], s42 offen
s_mul_i32 s42, s34, 36864
s_add_u32 s42, s42, 2304
s_add_u32 s42, s42, s35
buffer_load_ushort v62, v11, s[44:47], s42 offen
s_mul_i32 s42, s34, 36864
s_add_u32 s42, s42, 3456
s_add_u32 s42, s42, s35
buffer_load_ushort v63, v11, s[44:47], s42 offen
s_mul_i32 s42, s34, 39168
s_add_u32 s42, s42, 20736
s_add_u32 s42, s42, s35
buffer_load_ushort v64, v11, s[44:47], s42 offen
s_mul_i32 s42, s34, 39168
s_add_u32 s42, s42, 21888
s_add_u32 s42, s42, s35
buffer_load_ushort v65, v11, s[44:47], s42 offen
s_mul_i32 s42, s34, 57600
s_add_u32 s42, s42, 23040
s_add_u32 s42, s42, s35
buffer_load_ushort v66, v11, s[44:47], s42 offen
s_mul_i32 s42, s34, 57600
s_add_u32 s42, s42, 24192
s_add_u32 s42, s42, s35
buffer_load_ushort v67, v11, s[44:47], s42 offen
s_add_u32 s42, s40, 2
s_mul_i32 s43, s42, 13108
s_lshr_b32 s43, s43, 16
s_mul_i32 s35, s43, 5
s_sub_u32 s42, s42, s35
s_lshr_b32 s35, s42, 1
s_lshl_b32 s35, s35, 5
s_and_b32 s36, s42, 1
s_lshl_b32 s36, s36, 2
s_add_u32 s35, s35, s36
s_add_u32 s35, s35, s41
s_cmp_eq_u32 s42, 4
s_cselect_b64 vcc, -1, 0
s_cselect_b32 s36, 8, 16
v_cndmask_b32 v11, v9, v6, vcc
v_add_u32 v11, s35, v11
s_mul_i32 s35, s43, 41472
s_sub_u32 s37, s43, 16
s_mul_i32 s37, s37, 331776
s_cmp_lt_u32 s43, 16
s_cselect_b32 s35, s35, s37
s_cselect_b32 s37, 4, 72
s_cselect_b32 s34, 0, 1
s_mul_i32 s37, s37, 1152
v_mul_lo_u32 v10, s37, v7
v_lshl_add_u32 v11, v11, 1, v10
v_cmp_gt_u32 vcc, s36, v6
s_nop 1
v_cndmask_b32 v11, v12, v11, vcc
s_mul_i32 s42, s34, 18432
s_add_u32 s42, s42, 0
s_add_u32 s42, s42, s35
buffer_load_ushort v68, v11, s[44:47], s42 offen
s_mul_i32 s42, s34, 18432
s_add_u32 s42, s42, 1152
s_add_u32 s42, s42, s35
buffer_load_ushort v69, v11, s[44:47], s42 offen
s_mul_i32 s42, s34, 36864
s_add_u32 s42, s42, 2304
s_add_u32 s42, s42, s35
buffer_load_ushort v70, v11, s[44:47], s42 offen
s_mul_i32 s42, s34, 36864
s_add_u32 s42, s42, 3456
s_add_u32 s42, s42, s35
buffer_load_ushort v71, v11, s[44:47], s42 offen
s_mul_i32 s42, s34, 39168
s_add_u32 s42, s42, 20736
s_add_u32 s42, s42, s35
buffer_load_ushort v72, v11, s[44:47], s42 offen
s_mul_i32 s42, s34, 39168
s_add_u32 s42, s42, 21888
s_add_u32 s42, s42, s35
buffer_load_ushort v73, v11, s[44:47], s42 offen
s_mul_i32 s42, s34, 57600
s_add_u32 s42, s42, 23040
s_add_u32 s42, s42, s35
buffer_load_ushort v74, v11, s[44:47], s42 offen
s_mul_i32 s42, s34, 57600
s_add_u32 s42, s42, 24192
s_add_u32 s42, s42, s35
buffer_load_ushort v75, v11, s[44:47], s42 offen
L_g_done:
s_cmp_ge_u32 s2, 144
s_cbranch_scc1 L_l1_d
s_mul_i32 s40, s2, 911
s_lshr_b32 s40, s40, 16
s_mul_i32 s41, s40, 72
s_sub_u32 s41, s2, s41
s_cmp_eq_u32 s40, 0
s_cselect_b64 s[12:13], s[64:65], s[66:67]
s_mov_b32 s48, s12
s_and_b32 s49, s13, 0xffff
s_mov_b32 s50, 5308416
s_mov_b32 s51, 0x20000
s_lshl_b32 s42, s41, 7
v_lshlrev_b32 v9, 3, v6
v_mul_u32_u24 v10, 73728, v7
v_add3_u32 v254, v9, v10, s42
s_bitcmp1_b32 s4, 0
s_cselect_b64 vcc, -1, 0
v_cndmask_b32 v255, v254, v12, vcc
s_mul_i32 s43, s4, 9
s_add_u32 s43, s43, 1
s_lshr_b32 s43, s43, 1
s_mul_i32 s53, s43, 294912
buffer_load_dwordx2 v[76:77], v254, s[48:51], s53 offen nt
s_add_u32 s53, s53, 9216
buffer_load_dwordx2 v[78:79], v254, s[48:51], s53 offen nt
s_add_u32 s53, s53, 9216
buffer_load_dwordx2 v[80:81], v254, s[48:51], s53 offen nt
s_add_u32 s53, s53, 9216
buffer_load_dwordx2 v[82:83], v254, s[48:51], s53 offen nt
s_add_u32 s53, s53, 9216
buffer_load_dwordx2 v[84:85], v254, s[48:51], s53 offen nt
s_add_u32 s53, s53, 9216
buffer_load_dwordx2 v[86:87], v254, s[48:51], s53 offen nt
s_add_u32 s53, s53, 9216
buffer_load_dwordx2 v[88:89], v254, s[48:51], s53 offen nt
s_add_u32 s53, s53, 9216
buffer_load_dwordx2 v[90:91], v254, s[48:51], s53 offen nt
s_add_u32 s53, s53, 230400
buffer_load_dwordx2 v[92:93], v254, s[48:51], s53 offen nt
s_add_u32 s53, s53, 9216
s_mul_i32 s42, s41, 7282
s_lshr_b32 s42, s42, 16
s_mul_i32 s35, s42, 9
s_sub_u32 s41, s41, s35
s_lshl_b32 s41, s41, 2
s_lshl_b32 s42, s42, 2
s_lshl_b32 s40, s40, 11
s_add_u32 s40, s40, 7012352
s_mov_b32 s35, 497664
v_and_b32 v6, 3, v1
v_add_u32 v6, s41, v6
v_mul_u32_u24 v7, 57, v6
v_lshrrev_b32 v7, 9, v7
v_mul_u32_u24 v8, 9, v7
v_sub_u32 v6, v6, v8
v_add_u32 v8, 1, v6
v_cmp_eq_u32 vcc, 9, v8
s_nop 1
v_cndmask_b32 v8, v8, 0, vcc
v_and_b32 v9, 1, v7
v_cmp_eq_u32 vcc, 0, v9
s_nop 1
v_cndmask_b32 v6, v6, v8, vcc
v_add_u32 v7, s42, v7
v_mul_lo_u32 v7, v7, s35
v_add_u32 v7, s40, v7
v_lshrrev_b32 v8, 2, v1
v_add_u32 v8, s43, v8
v_and_b32 v9, 1, v8
v_lshl_add_u32 v7, v9, 10, v7
v_lshrrev_b32 v9, 1, v8
v_lshlrev_b32 v9, 12, v9
v_add_u32 v7, v7, v9
v_lshl_add_u32 v9, v6, 12, v9
v_mul_u32_u24 v10, 36864, v6
v_cmp_gt_u32 vcc, 2, v6
s_nop 1
v_cndmask_b32 v9, v10, v9, vcc
v_add_u32 v7, v7, v9
v_cmp_gt_u32 vcc, 18, v8
s_nop 1
v_cndmask_b32 v7, v12, v7, vcc
s_bitcmp1_b32 s4, 0
s_cselect_b32 s41, 16, 20
v_cmp_gt_u32 vcc, s41, v1
s_nop 1
v_cndmask_b32 v7, v12, v7, vcc
s_nop 0
v_readlane_b32 s40, v7, 0
v_readlane_b32 s41, v7, 1
v_readlane_b32 s42, v7, 2
v_readlane_b32 s43, v7, 3
v_add_u32 v156, s40, v2
v_add_u32 v157, s41, v2
v_add_u32 v158, s42, v2
v_add_u32 v159, s43, v2
v_readlane_b32 s40, v7, 4
v_readlane_b32 s41, v7, 5
v_readlane_b32 s42, v7, 6
v_readlane_b32 s43, v7, 7
v_add_u32 v160, s40, v2
v_add_u32 v161, s41, v2
v_add_u32 v162, s42, v2
v_add_u32 v163, s43, v2
v_readlane_b32 s40, v7, 8
v_readlane_b32 s41, v7, 9
v_readlane_b32 s42, v7, 10
v_readlane_b32 s43, v7, 11
v_add_u32 v164, s40, v2
v_add_u32 v165, s41, v2
v_add_u32 v166, s42, v2
v_add_u32 v167, s43, v2
v_readlane_b32 s40, v7, 12
v_readlane_b32 s41, v7, 13
v_readlane_b32 s42, v7, 14
v_readlane_b32 s43, v7, 15
v_add_u32 v168, s40, v2
v_add_u32 v169, s41, v2
v_add_u32 v170, s42, v2
v_add_u32 v171, s43, v2
v_readlane_b32 s40, v7, 16
v_readlane_b32 s41, v7, 17
v_readlane_b32 s42, v7, 18
v_readlane_b32 s43, v7, 19
v_add_u32 v172, s40, v2
v_add_u32 v173, s41, v2
v_add_u32 v174, s42, v2
v_add_u32 v175, s43, v2
s_waitcnt vmcnt(33)
s_branch L_l1_e
L_l1_d:
s_cmp_ge_u32 s2, 216
s_cbranch_scc1 L_l1_n
s_mov_b32 s48, s62
s_and_b32 s49, s63, 0xffff
s_mov_b32 s50, 5308416
s_mov_b32 s51, 0x20000
s_sub_u32 s40, s2, 144
s_mul_i32 s53, s40, 73728
s_lshl_b32 s41, s4, 8
s_lshl_b32 s42, s4, 5
v_mul_u32_u24 v10, 18432, v7
v_lshl_add_u32 v9, v6, 3, v10
v_add_u32 v254, s41, v9
v_lshl_add_u32 v9, v6, 1, v10
v_add_u32 v255, s42, v9
s_add_u32 s43, s53, 0
buffer_load_dwordx2 v[76:77], v254, s[48:51], s43 offen offset:0 nt
buffer_load_dwordx2 v[92:93], v254, s[48:51], s43 offen offset:128 nt
buffer_load_ushort v108, v255, s[48:51], s43 offen offset:1024 nt
s_add_u32 s43, s53, 4608
buffer_load_dwordx2 v[78:79], v254, s[48:51], s43 offen offset:0 nt
buffer_load_dwordx2 v[94:95], v254, s[48:51], s43 offen offset:128 nt
buffer_load_ushort v109, v255, s[48:51], s43 offen offset:1024 nt
s_add_u32 s43, s53, 9216
buffer_load_dwordx2 v[80:81], v254, s[48:51], s43 offen offset:0 nt
buffer_load_dwordx2 v[96:97], v254, s[48:51], s43 offen offset:128 nt
buffer_load_ushort v110, v255, s[48:51], s43 offen offset:1024 nt
s_mul_i32 s41, s40, 7282
s_lshr_b32 s41, s41, 16
s_mul_i32 s42, s41, 9
s_sub_u32 s40, s40, s42
s_lshl_b32 s40, s40, 1
s_lshl_b32 s41, s41, 2
s_add_u32 s41, s41, s4
s_mul_i32 s41, s41, 497664
s_add_u32 s41, s41, 7344128
v_cmp_lt_u32 vcc, 8, v1
s_nop 1
v_cndmask_b32 v6, 0, 1, vcc
v_mul_u32_u24 v7, 9, v6
v_sub_u32 v7, v1, v7
v_add_u32 v6, s40, v6
v_mov_b32 v8, 0
v_cmp_lt_u32 vcc, 4, v6
s_nop 1
v_addc_co_u32 v8, vcc, 0, v8, vcc
v_cmp_lt_u32 vcc, 8, v6
s_nop 1
v_addc_co_u32 v8, vcc, 0, v8, vcc
v_cmp_lt_u32 vcc, 13, v6
s_nop 1
v_addc_co_u32 v8, vcc, 0, v8, vcc
v_mul_u32_u24 v9, 9, v8
v_add_u32 v9, 1, v9
v_lshrrev_b32 v9, 1, v9
v_sub_u32 v9, v6, v9
v_subrev_u32 v8, s4, v8
v_and_b32 v8, 3, v8
v_mul_u32_u24 v10, 3, v9
v_add3_u32 v10, v10, v8, 2
v_add_u32 v11, 3, v10
v_cmp_lt_u32 vcc, 1, v9
s_nop 1
v_cndmask_b32 v10, v10, v11, vcc
v_cmp_eq_u32 vcc, 3, v9
s_nop 1
v_cndmask_b32 v9, v9, 11, vcc
v_cmp_eq_u32 vcc, 0, v8
s_nop 1
v_cndmask_b32 v10, v10, v9, vcc
v_cmp_eq_u32 vcc, 4, v6
s_nop 1
v_cndmask_b32 v10, v10, 9, vcc
v_cmp_eq_u32 vcc, 13, v6
s_nop 1
v_cndmask_b32 v10, v10, 10, vcc
v_and_b32 v6, 30, v10
v_and_b32 v8, 1, v10
v_lshl_add_u32 v8, v7, 1, v8
v_lshl_add_u32 v9, v6, 3, v8
v_lshrrev_b32 v11, 2, v7
v_mul_u32_u24 v13, 24, v11
v_lshl_add_u32 v6, v6, 2, v8
v_add3_u32 v6, v6, v13, 40
v_cmp_gt_u32 vcc, 10, v10
s_nop 1
v_cndmask_b32 v9, v6, v9, vcc
v_lshl_add_u32 v6, v7, 2, v10
v_lshl_add_u32 v6, v11, 4, v6
v_add_u32 v6, 82, v6
v_cmp_gt_u32 vcc, 14, v10
s_nop 1
v_cndmask_b32 v9, v6, v9, vcc
v_add_u32 v6, 144, v10
v_add_u32 v11, 96, v10
v_cmp_gt_u32 vcc, 0, v10
s_nop 1
v_cndmask_b32 v6, v6, v11, vcc
v_cmp_eq_u32 vcc, 8, v7
s_nop 1
v_cndmask_b32 v9, v9, v6, vcc
v_lshlrev_b32 v9, 10, v9
v_add_u32 v9, s41, v9
v_cmp_gt_u32 vcc, 18, v1
s_nop 1
v_cndmask_b32 v9, v12, v9, vcc
s_nop 0
v_readlane_b32 s40, v9, 0
v_readlane_b32 s41, v9, 1
v_readlane_b32 s42, v9, 2
v_readlane_b32 s43, v9, 3
v_add_u32 v156, s40, v2
v_add_u32 v157, s41, v2
v_add_u32 v158, s42, v2
v_add_u32 v159, s43, v2
v_readlane_b32 s40, v9, 4
v_readlane_b32 s41, v9, 5
v_readlane_b32 s42, v9, 6
v_readlane_b32 s43, v9, 7
v_add_u32 v160, s40, v2
v_add_u32 v161, s41, v2
v_add_u32 v162, s42, v2
v_add_u32 v163, s43, v2
v_readlane_b32 s40, v9, 8
v_readlane_b32 s41, v9, 9
v_readlane_b32 s42, v9, 10
v_readlane_b32 s43, v9, 11
v_add_u32 v164, s40, v2
v_add_u32 v165, s41, v2
v_add_u32 v166, s42, v2
v_add_u32 v167, s43, v2
v_readlane_b32 s40, v9, 12
v_readlane_b32 s41, v9, 13
v_readlane_b32 s42, v9, 14
v_readlane_b32 s43, v9, 15
v_add_u32 v168, s40, v2
v_add_u32 v169, s41, v2
v_add_u32 v170, s42, v2
v_add_u32 v171, s43, v2
v_readlane_b32 s40, v9, 16
v_readlane_b32 s41, v9, 17
v_readlane_b32 s42, v9, 18
v_readlane_b32 s43, v9, 19
v_add_u32 v172, s40, v2
v_add_u32 v173, s41, v2
v_add_u32 v174, s42, v2
v_add_u32 v175, s43, v2
s_waitcnt vmcnt(33)
s_branch L_l1_e
L_l1_n:
v_mov_b32 v156, v12
v_mov_b32 v157, v12
v_mov_b32 v158, v12
v_mov_b32 v159, v12
v_mov_b32 v160, v12
v_mov_b32 v161, v12
v_mov_b32 v162, v12
v_mov_b32 v163, v12
v_mov_b32 v164, v12
v_mov_b32 v165, v12
v_mov_b32 v166, v12
v_mov_b32 v167, v12
v_mov_b32 v168, v12
v_mov_b32 v169, v12
v_mov_b32 v170, v12
v_mov_b32 v171, v12
v_mov_b32 v172, v12
v_mov_b32 v173, v12
v_mov_b32 v174, v12
v_mov_b32 v175, v12
s_waitcnt vmcnt(24)
L_l1_e:
v_readfirstlane_b32 s40, v14
v_readfirstlane_b32 s41, v15
s_add_u32 s68, s40, 1
s_addc_u32 s69, s41, 0
v_lshlrev_b32 v28, 16, v16
v_and_b32 v29, 0xffff0000, v16
v_lshlrev_b32 v30, 16, v17
v_and_b32 v31, 0xffff0000, v17
v_lshlrev_b32 v32, 16, v18
v_and_b32 v33, 0xffff0000, v18
v_lshlrev_b32 v34, 16, v19
v_and_b32 v35, 0xffff0000, v19
v_lshlrev_b32 v36, 16, v20
v_and_b32 v37, 0xffff0000, v20
v_lshlrev_b32 v38, 16, v21
v_and_b32 v39, 0xffff0000, v21
v_lshlrev_b32 v40, 16, v22
v_and_b32 v41, 0xffff0000, v22
v_lshlrev_b32 v42, 16, v23
v_and_b32 v43, 0xffff0000, v23
v_lshlrev_b32 v44, 16, v24
v_and_b32 v45, 0xffff0000, v24
v_lshlrev_b32 v46, 16, v25
v_and_b32 v47, 0xffff0000, v25
v_lshlrev_b32 v48, 16, v26
v_and_b32 v49, 0xffff0000, v26
v_lshlrev_b32 v50, 16, v27
v_and_b32 v51, 0xffff0000, v27
v_add_f32 v6, v28, v29
v_mul_f32 v7, v28, v28
v_mul_f32 v9, v29, v29
v_mov_b32 v8, 0
v_add_f32 v6, v6, v30
v_add_f32 v8, v8, v31
v_fmac_f32 v7, v30, v30
v_fmac_f32 v9, v31, v31
v_add_f32 v6, v6, v32
v_add_f32 v8, v8, v33
v_fmac_f32 v7, v32, v32
v_fmac_f32 v9, v33, v33
v_add_f32 v6, v6, v34
v_add_f32 v8, v8, v35
v_fmac_f32 v7, v34, v34
v_fmac_f32 v9, v35, v35
v_add_f32 v6, v6, v36
v_add_f32 v8, v8, v37
v_fmac_f32 v7, v36, v36
v_fmac_f32 v9, v37, v37
v_add_f32 v6, v6, v38
v_add_f32 v8, v8, v39
v_fmac_f32 v7, v38, v38
v_fmac_f32 v9, v39, v39
v_add_f32 v6, v6, v40
v_add_f32 v8, v8, v41
v_fmac_f32 v7, v40, v40
v_fmac_f32 v9, v41, v41
v_add_f32 v6, v6, v42
v_add_f32 v8, v8, v43
v_fmac_f32 v7, v42, v42
v_fmac_f32 v9, v43, v43
v_add_f32 v6, v6, v44
v_add_f32 v8, v8, v45
v_fmac_f32 v7, v44, v44
v_fmac_f32 v9, v45, v45
v_add_f32 v6, v6, v46
v_add_f32 v8, v8, v47
v_fmac_f32 v7, v46, v46
v_fmac_f32 v9, v47, v47
v_add_f32 v6, v6, v48
v_add_f32 v8, v8, v49
v_fmac_f32 v7, v48, v48
v_fmac_f32 v9, v49, v49
v_add_f32 v6, v6, v50
v_add_f32 v8, v8, v51
v_fmac_f32 v7, v50, v50
v_fmac_f32 v9, v51, v51
v_add_f32 v6, v6, v8
v_add_f32 v7, v7, v9
s_nop 0
v_add_f32_dpp v6, v6, v6 row_ror:8 row_mask:0xf bank_mask:0xf
v_add_f32_dpp v7, v7, v7 row_ror:8 row_mask:0xf bank_mask:0xf
v_mov_b32 v8, v6
v_mov_b32 v9, v7
s_nop 0
v_permlane16_swap_b32 v6, v8
v_permlane16_swap_b32 v7, v9
v_add_f32 v6, v6, v8
v_add_f32 v7, v7, v9
v_mov_b32 v8, v6
v_mov_b32 v9, v7
s_nop 0
v_permlane32_swap_b32 v6, v8
v_permlane32_swap_b32 v7, v9
v_add_f32 v6, v6, v8
v_add_f32 v7, v7, v9
v_and_b32 v10, 7, v1
v_lshlrev_b32 v10, 3, v10
v_add_u32 v10, 147456, v10
s_lshl_b32 s24, s4, 6
v_add_u32 v11, s24, v10
ds_write_b64 v11, v[6:7]
s_add_u32 s24, s28, 27688960
buffer_store_dwordx4 v[16:19], v4, s[8:11], s24 offen sc1
s_add_u32 s25, s29, 27688960
buffer_store_dwordx4 v[20:23], v4, s[8:11], s25 offen sc1
s_add_u32 s24, s30, 27688960
buffer_store_dwordx4 v[24:27], v4, s[8:11], s24 offen sc1
s_waitcnt lgkmcnt(0)
s_barrier
ds_read_b64 v[6:7], v10
ds_read_b64 v[8:9], v10 offset:64
ds_read_b64 v[12:13], v10 offset:128
s_waitcnt lgkmcnt(0)
v_add_f32 v6, v6, v8
v_add_f32 v7, v7, v9
v_add_f32 v6, v6, v12
v_add_f32 v7, v7, v13
v_mul_f32 v6, 0x3ae38e39, v6
v_mul_f32 v7, 0x3ae38e39, v7
v_fma_f32 v7, -v6, v6, v7
v_max_f32 v7, 0, v7
v_add_f32 v7, 0x3727c5ac, v7
v_rsq_f32 v7, v7
s_nop 0
v_mul_f32 v6, v6, v7
v_fma_f32 v28, v28, v7, -v6
v_fma_f32 v29, v29, v7, -v6
v_fma_f32 v30, v30, v7, -v6
v_fma_f32 v31, v31, v7, -v6
v_fma_f32 v32, v32, v7, -v6
v_fma_f32 v33, v33, v7, -v6
v_fma_f32 v34, v34, v7, -v6
v_fma_f32 v35, v35, v7, -v6
v_cvt_pk_bf16_f32 v16, v28, v29
v_cvt_pk_bf16_f32 v17, v30, v31
v_cvt_pk_bf16_f32 v18, v32, v33
v_cvt_pk_bf16_f32 v19, v34, v35
s_add_u32 s24, s28, 22970368
buffer_store_dwordx4 v[16:19], v4, s[8:11], s24 offen sc1
v_fma_f32 v36, v36, v7, -v6
v_fma_f32 v37, v37, v7, -v6
v_fma_f32 v38, v38, v7, -v6
v_fma_f32 v39, v39, v7, -v6
v_fma_f32 v40, v40, v7, -v6
v_fma_f32 v41, v41, v7, -v6
v_fma_f32 v42, v42, v7, -v6
v_fma_f32 v43, v43, v7, -v6
v_cvt_pk_bf16_f32 v20, v36, v37
v_cvt_pk_bf16_f32 v21, v38, v39
v_cvt_pk_bf16_f32 v22, v40, v41
v_cvt_pk_bf16_f32 v23, v42, v43
s_add_u32 s25, s29, 22970368
buffer_store_dwordx4 v[20:23], v4, s[8:11], s25 offen sc1
v_fma_f32 v44, v44, v7, -v6
v_fma_f32 v45, v45, v7, -v6
v_fma_f32 v46, v46, v7, -v6
v_fma_f32 v47, v47, v7, -v6
v_fma_f32 v48, v48, v7, -v6
v_fma_f32 v49, v49, v7, -v6
v_fma_f32 v50, v50, v7, -v6
v_fma_f32 v51, v51, v7, -v6
v_cvt_pk_bf16_f32 v24, v44, v45
v_cvt_pk_bf16_f32 v25, v46, v47
v_cvt_pk_bf16_f32 v26, v48, v49
v_cvt_pk_bf16_f32 v27, v50, v51
s_add_u32 s24, s30, 22970368
buffer_store_dwordx4 v[24:27], v4, s[8:11], s24 offen sc1
s_lshl_b32 s24, s5, 5
s_add_u32 s24, s24, s6
s_lshl_b32 s14, s24, 7
s_add_u32 s14, s14, 786432
s_waitcnt vmcnt(6)
v_lshl_or_b32 v52, v53, 16, v52
v_lshl_or_b32 v53, v55, 16, v54
v_lshl_or_b32 v54, v57, 16, v56
v_lshl_or_b32 v55, v59, 16, v58
buffer_store_dwordx4 v[52:55], v2, s[8:11], s38 offen offset:0 sc1
v_lshl_or_b32 v60, v61, 16, v60
v_lshl_or_b32 v61, v63, 16, v62
v_lshl_or_b32 v62, v65, 16, v64
v_lshl_or_b32 v63, v67, 16, v66
buffer_store_dwordx4 v[60:63], v2, s[8:11], s38 offen offset:1024 sc1
v_lshl_or_b32 v68, v69, 16, v68
v_lshl_or_b32 v69, v71, 16, v70
v_lshl_or_b32 v70, v73, 16, v72
v_lshl_or_b32 v71, v75, 16, v74
buffer_store_dwordx4 v[68:71], v2, s[8:11], s38 offen offset:2048 sc1
v_mov_b32 v13, 2146435072
v_cmp_gt_u32 vcc, 16, v0
v_lshlrev_b32 v14, 3, v0
s_nop 0
v_cndmask_b32 v13, v13, v14, vcc
v_mov_b32 v14, s68
v_mov_b32 v15, s69
s_waitcnt vmcnt(0)
s_barrier
buffer_store_dwordx2 v[14:15], v13, s[8:11], s14 offen sc1
s_cmp_ge_u32 s2, 144
s_cbranch_scc1 L_l2_d
buffer_load_dwordx2 v[94:95], v254, s[48:51], s53 offen nt
s_add_u32 s53, s53, 9216
buffer_load_dwordx2 v[96:97], v254, s[48:51], s53 offen nt
s_add_u32 s53, s53, 9216
buffer_load_dwordx2 v[98:99], v254, s[48:51], s53 offen nt
s_add_u32 s53, s53, 9216
buffer_load_dwordx2 v[100:101], v254, s[48:51], s53 offen nt
s_add_u32 s53, s53, 9216
buffer_load_dwordx2 v[102:103], v254, s[48:51], s53 offen nt
s_add_u32 s53, s53, 9216
buffer_load_dwordx2 v[104:105], v254, s[48:51], s53 offen nt
s_add_u32 s53, s53, 9216
buffer_load_dwordx2 v[106:107], v254, s[48:51], s53 offen nt
s_add_u32 s53, s53, 230400
buffer_load_dwordx2 v[108:109], v254, s[48:51], s53 offen nt
s_add_u32 s53, s53, 9216
buffer_load_dwordx2 v[110:111], v254, s[48:51], s53 offen nt
s_add_u32 s53, s53, 9216
buffer_load_dwordx2 v[112:113], v254, s[48:51], s53 offen nt
s_add_u32 s53, s53, 9216
buffer_load_dwordx2 v[114:115], v254, s[48:51], s53 offen nt
s_add_u32 s53, s53, 9216
buffer_load_dwordx2 v[116:117], v254, s[48:51], s53 offen nt
s_add_u32 s53, s53, 9216
buffer_load_dwordx2 v[118:119], v254, s[48:51], s53 offen nt
s_add_u32 s53, s53, 9216
buffer_load_dwordx2 v[120:121], v254, s[48:51], s53 offen nt
s_add_u32 s53, s53, 9216
buffer_load_dwordx2 v[122:123], v254, s[48:51], s53 offen nt
s_add_u32 s53, s53, 230400
buffer_load_dwordx2 v[124:125], v254, s[48:51], s53 offen nt
s_add_u32 s53, s53, 9216
buffer_load_dwordx2 v[126:127], v254, s[48:51], s53 offen nt
s_add_u32 s53, s53, 9216
buffer_load_dwordx2 v[128:129], v254, s[48:51], s53 offen nt
s_add_u32 s53, s53, 9216
buffer_load_dwordx2 v[130:131], v254, s[48:51], s53 offen nt
s_add_u32 s53, s53, 9216
buffer_load_dwordx2 v[132:133], v254, s[48:51], s53 offen nt
s_add_u32 s53, s53, 9216
buffer_load_dwordx2 v[134:135], v254, s[48:51], s53 offen nt
s_add_u32 s53, s53, 9216
buffer_load_dwordx2 v[136:137], v254, s[48:51], s53 offen nt
s_add_u32 s53, s53, 9216
buffer_load_dwordx2 v[138:139], v254, s[48:51], s53 offen nt
s_add_u32 s53, s53, 230400
buffer_load_dwordx2 v[140:141], v255, s[48:51], s53 offen nt
s_add_u32 s53, s53, 9216
buffer_load_dwordx2 v[142:143], v255, s[48:51], s53 offen nt
s_add_u32 s53, s53, 9216
buffer_load_dwordx2 v[144:145], v255, s[48:51], s53 offen nt
s_add_u32 s53, s53, 9216
buffer_load_dwordx2 v[146:147], v255, s[48:51], s53 offen nt
s_add_u32 s53, s53, 9216
buffer_load_dwordx2 v[148:149], v255, s[48:51], s53 offen nt
s_add_u32 s53, s53, 9216
buffer_load_dwordx2 v[150:151], v255, s[48:51], s53 offen nt
s_add_u32 s53, s53, 9216
buffer_load_dwordx2 v[152:153], v255, s[48:51], s53 offen nt
s_add_u32 s53, s53, 9216
buffer_load_dwordx2 v[154:155], v255, s[48:51], s53 offen nt
s_add_u32 s53, s53, 230400
s_branch L_l2_e
L_l2_d:
s_cmp_ge_u32 s2, 216
s_cbranch_scc1 L_l2_n
s_add_u32 s43, s53, 13824
buffer_load_dwordx2 v[82:83], v254, s[48:51], s43 offen offset:0 nt
buffer_load_dwordx2 v[98:99], v254, s[48:51], s43 offen offset:128 nt
buffer_load_ushort v111, v255, s[48:51], s43 offen offset:1024 nt
s_add_u32 s43, s53, 1152
buffer_load_dwordx2 v[84:85], v254, s[48:51], s43 offen offset:0 nt
buffer_load_dwordx2 v[100:101], v254, s[48:51], s43 offen offset:128 nt
buffer_load_ushort v112, v255, s[48:51], s43 offen offset:1024 nt
s_add_u32 s43, s53, 5760
buffer_load_dwordx2 v[86:87], v254, s[48:51], s43 offen offset:0 nt
buffer_load_dwordx2 v[102:103], v254, s[48:51], s43 offen offset:128 nt
buffer_load_ushort v113, v255, s[48:51], s43 offen offset:1024 nt
s_add_u32 s43, s53, 10368
buffer_load_dwordx2 v[88:89], v254, s[48:51], s43 offen offset:0 nt
buffer_load_dwordx2 v[104:105], v254, s[48:51], s43 offen offset:128 nt
buffer_load_ushort v114, v255, s[48:51], s43 offen offset:1024 nt
s_add_u32 s43, s53, 14976
buffer_load_dwordx2 v[90:91], v254, s[48:51], s43 offen offset:0 nt
buffer_load_dwordx2 v[106:107], v254, s[48:51], s43 offen offset:128 nt
buffer_load_ushort v115, v255, s[48:51], s43 offen offset:1024 nt
s_add_u32 s43, s53, 2304
buffer_load_dwordx2 v[116:117], v254, s[48:51], s43 offen offset:0 nt
buffer_load_dwordx2 v[132:133], v254, s[48:51], s43 offen offset:128 nt
buffer_load_ushort v148, v255, s[48:51], s43 offen offset:1024 nt
s_add_u32 s43, s53, 6912
buffer_load_dwordx2 v[118:119], v254, s[48:51], s43 offen offset:0 nt
buffer_load_dwordx2 v[134:135], v254, s[48:51], s43 offen offset:128 nt
buffer_load_ushort v149, v255, s[48:51], s43 offen offset:1024 nt
s_add_u32 s43, s53, 11520
buffer_load_dwordx2 v[120:121], v254, s[48:51], s43 offen offset:0 nt
buffer_load_dwordx2 v[136:137], v254, s[48:51], s43 offen offset:128 nt
buffer_load_ushort v150, v255, s[48:51], s43 offen offset:1024 nt
s_add_u32 s43, s53, 16128
buffer_load_dwordx2 v[122:123], v254, s[48:51], s43 offen offset:0 nt
buffer_load_dwordx2 v[138:139], v254, s[48:51], s43 offen offset:128 nt
buffer_load_ushort v151, v255, s[48:51], s43 offen offset:1024 nt
s_add_u32 s43, s53, 3456
buffer_load_dwordx2 v[124:125], v254, s[48:51], s43 offen offset:0 nt
buffer_load_dwordx2 v[140:141], v254, s[48:51], s43 offen offset:128 nt
buffer_load_ushort v152, v255, s[48:51], s43 offen offset:1024 nt
s_add_u32 s43, s53, 8064
buffer_load_dwordx2 v[126:127], v254, s[48:51], s43 offen offset:0 nt
buffer_load_dwordx2 v[142:143], v254, s[48:51], s43 offen offset:128 nt
buffer_load_ushort v153, v255, s[48:51], s43 offen offset:1024 nt
s_add_u32 s43, s53, 12672
buffer_load_dwordx2 v[128:129], v254, s[48:51], s43 offen offset:0 nt
buffer_load_dwordx2 v[144:145], v254, s[48:51], s43 offen offset:128 nt
buffer_load_ushort v154, v255, s[48:51], s43 offen offset:1024 nt
s_add_u32 s43, s53, 17280
buffer_load_dwordx2 v[130:131], v254, s[48:51], s43 offen offset:0 nt
buffer_load_dwordx2 v[146:147], v254, s[48:51], s43 offen offset:128 nt
buffer_load_ushort v155, v255, s[48:51], s43 offen offset:1024 nt
L_l2_n:
L_l2_e:
s_mov_b32 s70, 22970368
s_mov_b32 s71, 27688960
s_mov_b32 s72, 32407552
s_mov_b32 s73, 37126144
s_mov_b32 s74, 41844736
s_mov_b32 s75, 42106880
s_mov_b32 s76, 79855616
s_mov_b32 s77, 0
s_mov_b32 s7, 0
s_lshr_b32 s20, s5, 2
s_lshl_b32 s20, s20, 3
s_lshr_b32 s21, s6, 2
s_add_u32 s20, s20, s21
s_and_b32 s21, s5, 3
s_lshl_b32 s21, s21, 2
s_and_b32 s22, s6, 3
s_add_u32 s21, s21, s22
s_lshl_b32 s24, s20, 3
s_sub_u32 s25, s24, 1
s_max_i32 s35, s25, 0
s_mul_i32 s25, s35, 18432
s_lshl_b32 s26, s4, 1
s_add_u32 s36, s24, s26
s_mul_i32 s24, s36, 18432
s_add_u32 s26, s24, s70
s_add_u32 s27, s26, 18432
s_add_u32 s28, s25, s70
v_add_u32 v4, 0x10000, v2
v_add_u32 v5, 0x20000, v2
s_cmp_eq_u32 s4, 3
s_cselect_b32 s29, 0, s4
s_cselect_b32 s31, 16, 9
s_lshl_b32 s30, s29, 10
v_and_b32 v12, 15, v1
v_mov_b32 v13, 2146435072
v_cmp_le_u32 vcc, s31, v12
s_nop 1
v_cndmask_b32 v3, v13, v2, vcc
s_add_u32 s31, s30, 2048
v_add_u32 v6, s31, v2
v_add_u32 v7, s31, v4
v_add_u32 v8, s31, v5
s_and_b32 s30, s30, 1024
s_add_u32 s31, s30, 5120
v_add_u32 v9, s31, v2
v_add_u32 v10, s31, v4
v_add_u32 v11, s31, v5
s_lshl_b32 s22, s36, 1
s_lshl_b32 s23, s35, 1
s_add_u32 s23, s23, 1
v_and_b32 v16, 3, v1
v_add_u32 v16, s22, v16
v_mov_b32 v17, s23
v_cmp_eq_u32 vcc, 4, v1
s_nop 1
v_cndmask_b32 v16, v16, v17, vcc
s_lshr_b32 s22, s21, 1
s_lshl_b32 s22, s22, 5
s_and_b32 s23, s21, 1
s_mul_i32 s23, s23, 10
s_add_u32 s22, s22, s23
s_sub_u32 s22, s22, 8
v_add_u32 v17, s22, v1
v_subrev_u32 v14, 8, v1
v_cmp_gt_u32 vcc, 11, v14
s_nop 1
v_cndmask_b32 v16, v16, v17, vcc
s_and_b32 s22, s6, 7
s_lshl_b32 s22, s22, 5
v_add_u32 v17, s22, v1
v_subrev_u32 v14, 21, v1
v_cmp_gt_u32 vcc, 8, v14
s_nop 1
v_cndmask_b32 v16, v16, v17, vcc
v_lshlrev_b32 v16, 7, v16
s_add_u32 s22, s77, 786432
s_mov_b32 s52, 0
L_poll1:
buffer_load_dwordx2 v[14:15], v16, s[8:11], s22 offen sc1
s_add_u32 s52, s52, 1
s_waitcnt vmcnt(0)
v_cmp_ne_u64 vcc, s[68:69], v[14:15]
s_cmp_ge_u32 s52, 1048576
s_cbranch_scc1 L_got1
s_and_b64 exec, exec, vcc
s_cbranch_execnz L_poll1
L_got1:
s_mov_b64 exec, -1
s_lshr_b32 s20, s5, 2
s_lshl_b32 s20, s20, 3
s_lshr_b32 s21, s6, 2
s_add_u32 s20, s20, s21
s_and_b32 s21, s5, 3
s_lshl_b32 s21, s21, 2
s_and_b32 s22, s6, 3
s_add_u32 s21, s21, s22
s_mul_i32 s32, s21, 129024
s_add_u32 s32, s32, 4198400
s_mul_i32 s33, s4, 32768
s_add_u32 s32, s32, s33
s_mov_b32 s34, 0x05040100
s_mov_b32 s37, s35
s_mov_b32 s35, 0x07060302
s_mov_b32 s38, 0x00003f80
s_mov_b32 s39, 0x3f800000
v_mov_b32 v20, 0
v_mov_b32 v21, 0
v_mov_b32 v22, 0
v_mov_b32 v23, 0
s_cmp_ge_u32 s2, 144
s_cbranch_scc1 L_tr_d
v_mov_b32 v68, 0x3f803f80
v_mov_b32 v69, 0x3f803f80
s_add_u32 m0, s33, 0
s_add_u32 s40, s32, 0
buffer_load_dwordx4 v2, s[8:11], s40 offen offset:0 sc1 lds
v_mov_b32 v70, 0x3f803f80
v_mov_b32 v71, 0x3f803f80
v_perm_b32 v176, v78, v76, s34
v_perm_b32 v177, v82, v80, s34
v_perm_b32 v178, v86, v84, s34
v_perm_b32 v179, v90, v88, s34
buffer_load_dwordx4 v2, s[8:11], s40 offen offset:1024 sc1 lds
v_perm_b32 v180, v78, v76, s35
v_perm_b32 v181, v82, v80, s35
v_perm_b32 v182, v86, v84, s35
v_perm_b32 v183, v90, v88, s35
v_perm_b32 v184, v79, v77, s34
v_perm_b32 v185, v83, v81, s34
buffer_load_dwordx4 v2, s[8:11], s40 offen offset:2048 sc1 lds
v_perm_b32 v186, v87, v85, s34
v_perm_b32 v187, v91, v89, s34
v_perm_b32 v188, v79, v77, s35
v_perm_b32 v189, v83, v81, s35
v_perm_b32 v190, v87, v85, s35
v_perm_b32 v191, v91, v89, s35
buffer_load_dwordx4 v2, s[8:11], s40 offen offset:3072 sc1 lds
v_perm_b32 v192, v94, v92, s34
v_perm_b32 v193, v98, v96, s34
v_perm_b32 v194, v102, v100, s34
v_perm_b32 v195, v106, v104, s34
v_perm_b32 v196, v94, v92, s35
v_perm_b32 v197, v98, v96, s35
s_add_u32 m0, s33, 4096
s_add_u32 s40, s32, 4096
buffer_load_dwordx4 v2, s[8:11], s40 offen offset:0 sc1 lds
v_perm_b32 v198, v102, v100, s35
v_perm_b32 v199, v106, v104, s35
v_perm_b32 v200, v95, v93, s34
v_perm_b32 v201, v99, v97, s34
v_perm_b32 v202, v103, v101, s34
v_perm_b32 v203, v107, v105, s34
buffer_load_dwordx4 v2, s[8:11], s40 offen offset:1024 sc1 lds
v_perm_b32 v204, v95, v93, s35
v_perm_b32 v205, v99, v97, s35
v_perm_b32 v206, v103, v101, s35
v_perm_b32 v207, v107, v105, s35
v_perm_b32 v208, v110, v108, s34
v_perm_b32 v209, v114, v112, s34
buffer_load_dwordx4 v2, s[8:11], s40 offen offset:2048 sc1 lds
v_perm_b32 v210, v118, v116, s34
v_perm_b32 v211, v122, v120, s34
v_perm_b32 v212, v110, v108, s35
v_perm_b32 v213, v114, v112, s35
v_perm_b32 v214, v118, v116, s35
v_perm_b32 v215, v122, v120, s35
buffer_load_dwordx4 v2, s[8:11], s40 offen offset:3072 sc1 lds
v_perm_b32 v216, v111, v109, s34
v_perm_b32 v217, v115, v113, s34
v_perm_b32 v218, v119, v117, s34
v_perm_b32 v219, v123, v121, s34
v_perm_b32 v220, v111, v109, s35
v_perm_b32 v221, v115, v113, s35
s_add_u32 m0, s33, 8192
s_add_u32 s40, s32, 8192
buffer_load_dwordx4 v2, s[8:11], s40 offen offset:0 sc1 lds
v_perm_b32 v222, v119, v117, s35
v_perm_b32 v223, v123, v121, s35
v_perm_b32 v224, v126, v124, s34
v_perm_b32 v225, v130, v128, s34
v_perm_b32 v226, v134, v132, s34
v_perm_b32 v227, v138, v136, s34
buffer_load_dwordx4 v2, s[8:11], s40 offen offset:1024 sc1 lds
v_perm_b32 v228, v126, v124, s35
v_perm_b32 v229, v130, v128, s35
v_perm_b32 v230, v134, v132, s35
v_perm_b32 v231, v138, v136, s35
v_perm_b32 v232, v127, v125, s34
v_perm_b32 v233, v131, v129, s34
buffer_load_dwordx4 v2, s[8:11], s40 offen offset:2048 sc1 lds
v_perm_b32 v234, v135, v133, s34
v_perm_b32 v235, v139, v137, s34
v_perm_b32 v236, v127, v125, s35
v_perm_b32 v237, v131, v129, s35
v_perm_b32 v238, v135, v133, s35
v_perm_b32 v239, v139, v137, s35
buffer_load_dwordx4 v2, s[8:11], s40 offen offset:3072 sc1 lds
v_perm_b32 v240, v142, v140, s34
v_perm_b32 v241, v146, v144, s34
v_perm_b32 v242, v150, v148, s34
v_perm_b32 v243, v154, v152, s34
v_perm_b32 v244, v142, v140, s35
v_perm_b32 v245, v146, v144, s35
s_add_u32 m0, s33, 12288
s_add_u32 s40, s32, 12288
buffer_load_dwordx4 v2, s[8:11], s40 offen offset:0 sc1 lds
v_perm_b32 v246, v150, v148, s35
v_perm_b32 v247, v154, v152, s35
v_perm_b32 v248, v143, v141, s34
v_perm_b32 v249, v147, v145, s34
v_perm_b32 v250, v151, v149, s34
v_perm_b32 v251, v155, v153, s34
buffer_load_dwordx4 v2, s[8:11], s40 offen offset:1024 sc1 lds
v_perm_b32 v252, v143, v141, s35
v_perm_b32 v253, v147, v145, s35
v_perm_b32 v254, v151, v149, s35
v_perm_b32 v255, v155, v153, s35
v_mfma_f32_16x16x32_bf16 v[52:55], v[68:71], v[176:179], 0
v_mfma_f32_16x16x32_bf16 v[56:59], v[68:71], v[180:183], 0
buffer_load_dwordx4 v2, s[8:11], s40 offen offset:2048 sc1 lds
v_mfma_f32_16x16x32_bf16 v[60:63], v[68:71], v[184:187], 0
v_mfma_f32_16x16x32_bf16 v[64:67], v[68:71], v[188:191], 0
v_mfma_f32_16x16x32_bf16 v[52:55], v[68:71], v[192:195], v[52:55]
v_mfma_f32_16x16x32_bf16 v[56:59], v[68:71], v[196:199], v[56:59]
v_mfma_f32_16x16x32_bf16 v[60:63], v[68:71], v[200:203], v[60:63]
v_mfma_f32_16x16x32_bf16 v[64:67], v[68:71], v[204:207], v[64:67]
buffer_load_dwordx4 v2, s[8:11], s40 offen offset:3072 sc1 lds
v_mfma_f32_16x16x32_bf16 v[52:55], v[68:71], v[208:211], v[52:55]
v_mfma_f32_16x16x32_bf16 v[56:59], v[68:71], v[212:215], v[56:59]
v_mfma_f32_16x16x32_bf16 v[60:63], v[68:71], v[216:219], v[60:63]
v_mfma_f32_16x16x32_bf16 v[64:67], v[68:71], v[220:223], v[64:67]
v_mfma_f32_16x16x32_bf16 v[52:55], v[68:71], v[224:227], v[52:55]
v_mfma_f32_16x16x32_bf16 v[56:59], v[68:71], v[228:231], v[56:59]
s_add_u32 m0, s33, 16384
s_add_u32 s40, s32, 16384
buffer_load_dwordx4 v2, s[8:11], s40 offen offset:0 sc1 lds
v_mfma_f32_16x16x32_bf16 v[60:63], v[68:71], v[232:235], v[60:63]
v_mfma_f32_16x16x32_bf16 v[64:67], v[68:71], v[236:239], v[64:67]
v_mfma_f32_16x16x32_bf16 v[52:55], v[68:71], v[240:243], v[52:55]
v_mfma_f32_16x16x32_bf16 v[56:59], v[68:71], v[244:247], v[56:59]
v_mfma_f32_16x16x32_bf16 v[60:63], v[68:71], v[248:251], v[60:63]
v_mfma_f32_16x16x32_bf16 v[64:67], v[68:71], v[252:255], v[64:67]
buffer_load_dwordx4 v2, s[8:11], s40 offen offset:1024 sc1 lds
v_and_b32 v72, 15, v1
v_lshlrev_b32 v72, 4, v72
v_add_u32 v72, 159744, v72
s_lshl_b32 s44, s4, 2
v_add_u32 v73, s44, v72
ds_write_b32 v73, v52 offset:0
buffer_load_dwordx4 v2, s[8:11], s40 offen offset:2048 sc1 lds
ds_write_b32 v73, v56 offset:256
ds_write_b32 v73, v60 offset:512
ds_write_b32 v73, v64 offset:768
s_waitcnt lgkmcnt(0)
s_barrier
ds_read_b128 v[52:55], v72 offset:0
buffer_load_dwordx4 v2, s[8:11], s40 offen offset:3072 sc1 lds
ds_read_b128 v[56:59], v72 offset:256
ds_read_b128 v[60:63], v72 offset:512
ds_read_b128 v[64:67], v72 offset:768
s_waitcnt lgkmcnt(0)
v_add_f32 v52, v52, v53
v_add_f32 v54, v54, v55
s_add_u32 m0, s33, 20480
s_add_u32 s40, s32, 20480
buffer_load_dwordx4 v2, s[8:11], s40 offen offset:0 sc1 lds
v_add_f32 v56, v56, v57
v_add_f32 v58, v58, v59
v_add_f32 v60, v60, v61
v_add_f32 v62, v62, v63
v_add_f32 v64, v64, v65
v_add_f32 v66, v66, v67
buffer_load_dwordx4 v2, s[8:11], s40 offen offset:1024 sc1 lds
v_add_f32 v52, v52, v54
v_add_f32 v56, v56, v58
v_add_f32 v60, v60, v62
v_add_f32 v64, v64, v66
v_mul_f32 v20, 0xbae38e39, v52
v_mul_f32 v21, 0xbae38e39, v56
buffer_load_dwordx4 v2, s[8:11], s40 offen offset:2048 sc1 lds
v_mul_f32 v22, 0xbae38e39, v60
v_mul_f32 v23, 0xbae38e39, v64
v_dot2_f32_bf16 v24, v176, s38, v20
v_dot2_f32_bf16 v25, v176, s39, v20
v_dot2_f32_bf16 v26, v177, s38, v20
v_dot2_f32_bf16 v27, v177, s39, v20
buffer_load_dwordx4 v2, s[8:11], s40 offen offset:3072 sc1 lds
v_dot2_f32_bf16 v28, v178, s38, v20
v_dot2_f32_bf16 v29, v178, s39, v20
v_dot2_f32_bf16 v30, v179, s38, v20
v_dot2_f32_bf16 v31, v179, s39, v20
v_cvt_pk_bf16_f32 v176, v24, v25
v_cvt_pk_bf16_f32 v177, v26, v27
s_add_u32 m0, s33, 24576
s_add_u32 s40, s32, 24576
buffer_load_dwordx4 v2, s[8:11], s40 offen offset:0 sc1 lds
v_cvt_pk_bf16_f32 v178, v28, v29
v_cvt_pk_bf16_f32 v179, v30, v31
v_dot2_f32_bf16 v24, v180, s38, v21
v_dot2_f32_bf16 v25, v180, s39, v21
v_dot2_f32_bf16 v26, v181, s38, v21
v_dot2_f32_bf16 v27, v181, s39, v21
buffer_load_dwordx4 v2, s[8:11], s40 offen offset:1024 sc1 lds
v_dot2_f32_bf16 v28, v182, s38, v21
v_dot2_f32_bf16 v29, v182, s39, v21
v_dot2_f32_bf16 v30, v183, s38, v21
v_dot2_f32_bf16 v31, v183, s39, v21
v_cvt_pk_bf16_f32 v180, v24, v25
v_cvt_pk_bf16_f32 v181, v26, v27
buffer_load_dwordx4 v2, s[8:11], s40 offen offset:2048 sc1 lds
v_cvt_pk_bf16_f32 v182, v28, v29
v_cvt_pk_bf16_f32 v183, v30, v31
v_dot2_f32_bf16 v24, v184, s38, v22
v_dot2_f32_bf16 v25, v184, s39, v22
v_dot2_f32_bf16 v26, v185, s38, v22
v_dot2_f32_bf16 v27, v185, s39, v22
buffer_load_dwordx4 v2, s[8:11], s40 offen offset:3072 sc1 lds
v_dot2_f32_bf16 v28, v186, s38, v22
v_dot2_f32_bf16 v29, v186, s39, v22
v_dot2_f32_bf16 v30, v187, s38, v22
v_dot2_f32_bf16 v31, v187, s39, v22
v_cvt_pk_bf16_f32 v184, v24, v25
v_cvt_pk_bf16_f32 v185, v26, v27
s_add_u32 m0, s33, 28672
s_add_u32 s40, s32, 28672
buffer_load_dwordx4 v2, s[8:11], s40 offen offset:0 sc1 lds
v_cvt_pk_bf16_f32 v186, v28, v29
v_cvt_pk_bf16_f32 v187, v30, v31
v_dot2_f32_bf16 v24, v188, s38, v23
v_dot2_f32_bf16 v25, v188, s39, v23
v_dot2_f32_bf16 v26, v189, s38, v23
v_dot2_f32_bf16 v27, v189, s39, v23
buffer_load_dwordx4 v2, s[8:11], s40 offen offset:1024 sc1 lds
v_dot2_f32_bf16 v28, v190, s38, v23
v_dot2_f32_bf16 v29, v190, s39, v23
v_dot2_f32_bf16 v30, v191, s38, v23
v_dot2_f32_bf16 v31, v191, s39, v23
v_cvt_pk_bf16_f32 v188, v24, v25
v_cvt_pk_bf16_f32 v189, v26, v27
buffer_load_dwordx4 v2, s[8:11], s40 offen offset:2048 sc1 lds
v_cvt_pk_bf16_f32 v190, v28, v29
v_cvt_pk_bf16_f32 v191, v30, v31
v_dot2_f32_bf16 v24, v192, s38, v20
v_dot2_f32_bf16 v25, v192, s39, v20
v_dot2_f32_bf16 v26, v193, s38, v20
v_dot2_f32_bf16 v27, v193, s39, v20
buffer_load_dwordx4 v2, s[8:11], s40 offen offset:3072 sc1 lds
v_dot2_f32_bf16 v28, v194, s38, v20
v_dot2_f32_bf16 v29, v194, s39, v20
v_dot2_f32_bf16 v30, v195, s38, v20
v_dot2_f32_bf16 v31, v195, s39, v20
v_cvt_pk_bf16_f32 v192, v24, v25
v_cvt_pk_bf16_f32 v193, v26, v27
v_cvt_pk_bf16_f32 v194, v28, v29
v_cvt_pk_bf16_f32 v195, v30, v31
v_dot2_f32_bf16 v24, v196, s38, v21
v_dot2_f32_bf16 v25, v196, s39, v21
v_dot2_f32_bf16 v26, v197, s38, v21
v_dot2_f32_bf16 v27, v197, s39, v21
v_dot2_f32_bf16 v28, v198, s38, v21
v_dot2_f32_bf16 v29, v198, s39, v21
v_dot2_f32_bf16 v30, v199, s38, v21
v_dot2_f32_bf16 v31, v199, s39, v21
v_cvt_pk_bf16_f32 v196, v24, v25
v_cvt_pk_bf16_f32 v197, v26, v27
v_cvt_pk_bf16_f32 v198, v28, v29
v_cvt_pk_bf16_f32 v199, v30, v31
v_dot2_f32_bf16 v24, v200, s38, v22
v_dot2_f32_bf16 v25, v200, s39, v22
v_dot2_f32_bf16 v26, v201, s38, v22
v_dot2_f32_bf16 v27, v201, s39, v22
v_dot2_f32_bf16 v28, v202, s38, v22
v_dot2_f32_bf16 v29, v202, s39, v22
v_dot2_f32_bf16 v30, v203, s38, v22
v_dot2_f32_bf16 v31, v203, s39, v22
v_cvt_pk_bf16_f32 v200, v24, v25
v_cvt_pk_bf16_f32 v201, v26, v27
v_cvt_pk_bf16_f32 v202, v28, v29
v_cvt_pk_bf16_f32 v203, v30, v31
v_dot2_f32_bf16 v24, v204, s38, v23
v_dot2_f32_bf16 v25, v204, s39, v23
v_dot2_f32_bf16 v26, v205, s38, v23
v_dot2_f32_bf16 v27, v205, s39, v23
v_dot2_f32_bf16 v28, v206, s38, v23
v_dot2_f32_bf16 v29, v206, s39, v23
v_dot2_f32_bf16 v30, v207, s38, v23
v_dot2_f32_bf16 v31, v207, s39, v23
v_cvt_pk_bf16_f32 v204, v24, v25
v_cvt_pk_bf16_f32 v205, v26, v27
v_cvt_pk_bf16_f32 v206, v28, v29
v_cvt_pk_bf16_f32 v207, v30, v31
s_branch L_tr_e
L_tr_d:
s_cmp_ge_u32 s2, 216
s_cbranch_scc1 L_tr_n
v_perm_b32 v176, v78, v76, s34
v_perm_b32 v177, v82, v80, s34
s_add_u32 m0, s33, 0
s_add_u32 s40, s32, 0
buffer_load_dwordx4 v2, s[8:11], s40 offen offset:0 sc1 lds
v_perm_b32 v178, v86, v84, s34
v_perm_b32 v179, v90, v88, s34
buffer_load_dwordx4 v2, s[8:11], s40 offen offset:1024 sc1 lds
v_perm_b32 v180, v78, v76, s35
v_perm_b32 v181, v82, v80, s35
buffer_load_dwordx4 v2, s[8:11], s40 offen offset:2048 sc1 lds
v_perm_b32 v182, v86, v84, s35
v_perm_b32 v183, v90, v88, s35
buffer_load_dwordx4 v2, s[8:11], s40 offen offset:3072 sc1 lds
v_perm_b32 v184, v79, v77, s34
v_perm_b32 v185, v83, v81, s34
s_add_u32 m0, s33, 4096
s_add_u32 s40, s32, 4096
buffer_load_dwordx4 v2, s[8:11], s40 offen offset:0 sc1 lds
v_perm_b32 v186, v87, v85, s34
v_perm_b32 v187, v91, v89, s34
buffer_load_dwordx4 v2, s[8:11], s40 offen offset:1024 sc1 lds
v_perm_b32 v188, v79, v77, s35
v_perm_b32 v189, v83, v81, s35
buffer_load_dwordx4 v2, s[8:11], s40 offen offset:2048 sc1 lds
v_perm_b32 v190, v87, v85, s35
v_perm_b32 v191, v91, v89, s35
buffer_load_dwordx4 v2, s[8:11], s40 offen offset:3072 sc1 lds
v_perm_b32 v192, v94, v92, s34
v_perm_b32 v193, v98, v96, s34
s_add_u32 m0, s33, 8192
s_add_u32 s40, s32, 8192
buffer_load_dwordx4 v2, s[8:11], s40 offen offset:0 sc1 lds
v_perm_b32 v194, v102, v100, s34
v_perm_b32 v195, v106, v104, s34
buffer_load_dwordx4 v2, s[8:11], s40 offen offset:1024 sc1 lds
v_perm_b32 v196, v94, v92, s35
v_perm_b32 v197, v98, v96, s35
buffer_load_dwordx4 v2, s[8:11], s40 offen offset:2048 sc1 lds
v_perm_b32 v198, v102, v100, s35
v_perm_b32 v199, v106, v104, s35
buffer_load_dwordx4 v2, s[8:11], s40 offen offset:3072 sc1 lds
v_perm_b32 v200, v95, v93, s34
v_perm_b32 v201, v99, v97, s34
s_add_u32 m0, s33, 12288
s_add_u32 s40, s32, 12288
buffer_load_dwordx4 v2, s[8:11], s40 offen offset:0 sc1 lds
v_perm_b32 v202, v103, v101, s34
v_perm_b32 v203, v107, v105, s34
buffer_load_dwordx4 v2, s[8:11], s40 offen offset:1024 sc1 lds
v_perm_b32 v204, v95, v93, s35
v_perm_b32 v205, v99, v97, s35
buffer_load_dwordx4 v2, s[8:11], s40 offen offset:2048 sc1 lds
v_perm_b32 v206, v103, v101, s35
v_perm_b32 v207, v107, v105, s35
buffer_load_dwordx4 v2, s[8:11], s40 offen offset:3072 sc1 lds
v_lshl_or_b32 v208, v109, 16, v108
v_lshl_or_b32 v209, v111, 16, v110
s_add_u32 m0, s33, 16384
s_add_u32 s40, s32, 16384
buffer_load_dwordx4 v2, s[8:11], s40 offen offset:0 sc1 lds
v_lshl_or_b32 v210, v113, 16, v112
v_lshl_or_b32 v211, v115, 16, v114
buffer_load_dwordx4 v2, s[8:11], s40 offen offset:1024 sc1 lds
v_perm_b32 v212, v118, v116, s34
v_perm_b32 v213, v122, v120, s34
buffer_load_dwordx4 v2, s[8:11], s40 offen offset:2048 sc1 lds
v_perm_b32 v214, v126, v124, s34
v_perm_b32 v215, v130, v128, s34
buffer_load_dwordx4 v2, s[8:11], s40 offen offset:3072 sc1 lds
v_perm_b32 v216, v118, v116, s35
v_perm_b32 v217, v122, v120, s35
s_add_u32 m0, s33, 20480
s_add_u32 s40, s32, 20480
buffer_load_dwordx4 v2, s[8:11], s40 offen offset:0 sc1 lds
v_perm_b32 v218, v126, v124, s35
v_perm_b32 v219, v130, v128, s35
buffer_load_dwordx4 v2, s[8:11], s40 offen offset:1024 sc1 lds
v_perm_b32 v220, v119, v117, s34
v_perm_b32 v221, v123, v121, s34
buffer_load_dwordx4 v2, s[8:11], s40 offen offset:2048 sc1 lds
v_perm_b32 v222, v127, v125, s34
v_perm_b32 v223, v131, v129, s34
buffer_load_dwordx4 v2, s[8:11], s40 offen offset:3072 sc1 lds
v_perm_b32 v224, v119, v117, s35
v_perm_b32 v225, v123, v121, s35
s_add_u32 m0, s33, 24576
s_add_u32 s40, s32, 24576
buffer_load_dwordx4 v2, s[8:11], s40 offen offset:0 sc1 lds
v_perm_b32 v226, v127, v125, s35
v_perm_b32 v227, v131, v129, s35
buffer_load_dwordx4 v2, s[8:11], s40 offen offset:1024 sc1 lds
v_perm_b32 v228, v134, v132, s34
v_perm_b32 v229, v138, v136, s34
buffer_load_dwordx4 v2, s[8:11], s40 offen offset:2048 sc1 lds
v_perm_b32 v230, v142, v140, s34
v_perm_b32 v231, v146, v144, s34
buffer_load_dwordx4 v2, s[8:11], s40 offen offset:3072 sc1 lds
v_perm_b32 v232, v134, v132, s35
v_perm_b32 v233, v138, v136, s35
s_add_u32 m0, s33, 28672
s_add_u32 s40, s32, 28672
buffer_load_dwordx4 v2, s[8:11], s40 offen offset:0 sc1 lds
v_perm_b32 v234, v142, v140, s35
v_perm_b32 v235, v146, v144, s35
buffer_load_dwordx4 v2, s[8:11], s40 offen offset:1024 sc1 lds
v_perm_b32 v236, v135, v133, s34
v_perm_b32 v237, v139, v137, s34
buffer_load_dwordx4 v2, s[8:11], s40 offen offset:2048 sc1 lds
v_perm_b32 v238, v143, v141, s34
v_perm_b32 v239, v147, v145, s34
buffer_load_dwordx4 v2, s[8:11], s40 offen offset:3072 sc1 lds
v_perm_b32 v240, v135, v133, s35
v_perm_b32 v241, v139, v137, s35
v_perm_b32 v242, v143, v141, s35
v_perm_b32 v243, v147, v145, s35
v_lshl_or_b32 v244, v149, 16, v148
v_lshl_or_b32 v245, v151, 16, v150
v_lshl_or_b32 v246, v153, 16, v152
v_lshl_or_b32 v247, v155, 16, v154
s_branch L_tr_e
L_tr_n:
s_add_u32 m0, s33, 0
s_add_u32 s40, s32, 0
buffer_load_dwordx4 v2, s[8:11], s40 offen offset:0 sc1 lds
buffer_load_dwordx4 v2, s[8:11], s40 offen offset:1024 sc1 lds
buffer_load_dwordx4 v2, s[8:11], s40 offen offset:2048 sc1 lds
buffer_load_dwordx4 v2, s[8:11], s40 offen offset:3072 sc1 lds
s_add_u32 m0, s33, 4096
s_add_u32 s40, s32, 4096
buffer_load_dwordx4 v2, s[8:11], s40 offen offset:0 sc1 lds
buffer_load_dwordx4 v2, s[8:11], s40 offen offset:1024 sc1 lds
buffer_load_dwordx4 v2, s[8:11], s40 offen offset:2048 sc1 lds
buffer_load_dwordx4 v2, s[8:11], s40 offen offset:3072 sc1 lds
s_add_u32 m0, s33, 8192
s_add_u32 s40, s32, 8192
buffer_load_dwordx4 v2, s[8:11], s40 offen offset:0 sc1 lds
buffer_load_dwordx4 v2, s[8:11], s40 offen offset:1024 sc1 lds
buffer_load_dwordx4 v2, s[8:11], s40 offen offset:2048 sc1 lds
buffer_load_dwordx4 v2, s[8:11], s40 offen offset:3072 sc1 lds
s_add_u32 m0, s33, 12288
s_add_u32 s40, s32, 12288
buffer_load_dwordx4 v2, s[8:11], s40 offen offset:0 sc1 lds
buffer_load_dwordx4 v2, s[8:11], s40 offen offset:1024 sc1 lds
buffer_load_dwordx4 v2, s[8:11], s40 offen offset:2048 sc1 lds
buffer_load_dwordx4 v2, s[8:11], s40 offen offset:3072 sc1 lds
s_add_u32 m0, s33, 16384
s_add_u32 s40, s32, 16384
buffer_load_dwordx4 v2, s[8:11], s40 offen offset:0 sc1 lds
buffer_load_dwordx4 v2, s[8:11], s40 offen offset:1024 sc1 lds
buffer_load_dwordx4 v2, s[8:11], s40 offen offset:2048 sc1 lds
buffer_load_dwordx4 v2, s[8:11], s40 offen offset:3072 sc1 lds
s_add_u32 m0, s33, 20480
s_add_u32 s40, s32, 20480
buffer_load_dwordx4 v2, s[8:11], s40 offen offset:0 sc1 lds
buffer_load_dwordx4 v2, s[8:11], s40 offen offset:1024 sc1 lds
buffer_load_dwordx4 v2, s[8:11], s40 offen offset:2048 sc1 lds
buffer_load_dwordx4 v2, s[8:11], s40 offen offset:3072 sc1 lds
s_add_u32 m0, s33, 24576
s_add_u32 s40, s32, 24576
buffer_load_dwordx4 v2, s[8:11], s40 offen offset:0 sc1 lds
buffer_load_dwordx4 v2, s[8:11], s40 offen offset:1024 sc1 lds
buffer_load_dwordx4 v2, s[8:11], s40 offen offset:2048 sc1 lds
buffer_load_dwordx4 v2, s[8:11], s40 offen offset:3072 sc1 lds
s_add_u32 m0, s33, 28672
s_add_u32 s40, s32, 28672
buffer_load_dwordx4 v2, s[8:11], s40 offen offset:0 sc1 lds
buffer_load_dwordx4 v2, s[8:11], s40 offen offset:1024 sc1 lds
buffer_load_dwordx4 v2, s[8:11], s40 offen offset:2048 sc1 lds
buffer_load_dwordx4 v2, s[8:11], s40 offen offset:3072 sc1 lds
L_tr_e:
s_mov_b32 s35, s37
buffer_load_dwordx4 a[0:3], v2, s[8:11], s26 offen offset:0 sc1
buffer_load_dwordx4 a[72:75], v2, s[8:11], s27 offen offset:0 sc1
buffer_load_dwordx4 a[144:147], v3, s[8:11], s28 offen offset:0 sc1
buffer_load_dwordx4 a[4:7], v2, s[8:11], s26 offen offset:1024 sc1
buffer_load_dwordx4 a[76:79], v2, s[8:11], s27 offen offset:1024 sc1
buffer_load_dwordx4 a[148:151], v3, s[8:11], s28 offen offset:1024 sc1
buffer_load_dwordx4 a[8:11], v2, s[8:11], s26 offen offset:2048 sc1
buffer_load_dwordx4 a[80:83], v2, s[8:11], s27 offen offset:2048 sc1
buffer_load_dwordx4 a[152:155], v3, s[8:11], s28 offen offset:2048 sc1
buffer_load_dwordx4 a[12:15], v2, s[8:11], s26 offen offset:3072 sc1
buffer_load_dwordx4 a[84:87], v2, s[8:11], s27 offen offset:3072 sc1
buffer_load_dwordx4 a[156:159], v3, s[8:11], s28 offen offset:3072 sc1
s_add_u32 s26, s26, 4096
s_add_u32 s27, s27, 4096
s_add_u32 s28, s28, 4096
buffer_load_dwordx4 a[16:19], v2, s[8:11], s26 offen offset:0 sc1
buffer_load_dwordx4 a[88:91], v2, s[8:11], s27 offen offset:0 sc1
buffer_load_dwordx4 a[160:163], v3, s[8:11], s28 offen offset:0 sc1
buffer_load_dwordx4 a[20:23], v2, s[8:11], s26 offen offset:1024 sc1
buffer_load_dwordx4 a[92:95], v2, s[8:11], s27 offen offset:1024 sc1
buffer_load_dwordx4 a[164:167], v3, s[8:11], s28 offen offset:1024 sc1
buffer_load_dwordx4 a[24:27], v2, s[8:11], s26 offen offset:2048 sc1
buffer_load_dwordx4 a[96:99], v2, s[8:11], s27 offen offset:2048 sc1
buffer_load_dwordx4 a[168:171], v3, s[8:11], s28 offen offset:2048 sc1
buffer_load_dwordx4 a[28:31], v2, s[8:11], s26 offen offset:3072 sc1
buffer_load_dwordx4 a[100:103], v2, s[8:11], s27 offen offset:3072 sc1
buffer_load_dwordx4 a[172:175], v3, s[8:11], s28 offen offset:3072 sc1
v_lshrrev_b32 v13, 4, v1
v_lshlrev_b32 v14, 2, v13
v_sub_u32 v14, v12, v14
v_subrev_u32 v15, 0, v14
v_cmp_gt_u32 s[52:53], 8, v15
v_cmp_gt_i32 s[44:45], -8, v15
v_subrev_u32 v15, 1, v14
v_cmp_gt_u32 s[54:55], 8, v15
v_cmp_gt_i32 s[46:47], -8, v15
v_subrev_u32 v15, 2, v14
v_cmp_gt_u32 s[56:57], 8, v15
v_cmp_gt_i32 s[48:49], -8, v15
v_subrev_u32 v15, 3, v14
v_cmp_gt_u32 s[58:59], 8, v15
v_cmp_gt_i32 s[50:51], -8, v15
s_and_b32 s31, s20, 7
s_or_b32 s31, s31, s4
s_cmp_eq_u32 s31, 0
s_cselect_b64 s[60:61], 0, s[44:45]
s_cselect_b64 s[62:63], 0, s[46:47]
s_cselect_b64 s[64:65], 0, s[48:49]
s_cselect_b64 s[66:67], 0, s[50:51]
s_waitcnt vmcnt(24)
s_barrier
ds_read_b128 a[216:219], v2 offset:0
ds_read_b128 a[220:223], v2 offset:7168
ds_read_b128 a[224:227], v2 offset:1024
ds_read_b128 a[228:231], v2 offset:8192
ds_read_b128 a[232:235], v2 offset:2048
ds_read_b128 a[236:239], v2 offset:9216
s_waitcnt vmcnt(18)
s_waitcnt lgkmcnt(4)
v_mfma_f32_16x16x32_bf16 v[32:35], a[216:219], a[0:3], 0
s_add_u32 s26, s26, 4096
s_add_u32 s27, s27, 4096
s_add_u32 s28, s28, 4096
buffer_load_dwordx4 a[32:35], v2, s[8:11], s26 offen offset:0 sc1
v_mfma_f32_16x16x32_bf16 v[32:35], a[220:223], a[4:7], v[32:35]
ds_read_b128 a[240:243], v2 offset:3072
v_dot2_f32_bf16 v24, v208, s38, v20
v_mfma_f32_16x16x32_bf16 v[36:39], a[216:219], a[72:75], 0
v_dot2_f32_bf16 v25, v208, s39, v20
v_dot2_f32_bf16 v26, v209, s38, v20
v_mfma_f32_16x16x32_bf16 v[36:39], a[220:223], a[76:79], v[36:39]
ds_read_b128 a[244:247], v2 offset:10240
s_waitcnt lgkmcnt(4)
v_mfma_f32_16x16x32_bf16 v[40:43], a[224:227], a[0:3], 0
buffer_load_dwordx4 a[104:107], v2, s[8:11], s27 offen offset:0 sc1
v_mfma_f32_16x16x32_bf16 v[40:43], a[228:231], a[4:7], v[40:43]
ds_read_b128 a[216:219], v2 offset:4096
v_dot2_f32_bf16 v27, v209, s39, v20
v_mfma_f32_16x16x32_bf16 v[44:47], a[224:227], a[72:75], 0
v_dot2_f32_bf16 v28, v210, s38, v20
v_dot2_f32_bf16 v29, v210, s39, v20
v_mfma_f32_16x16x32_bf16 v[44:47], a[228:231], a[76:79], v[44:47]
ds_read_b128 a[220:223], v2 offset:11264
s_waitcnt lgkmcnt(4)
v_mfma_f32_16x16x32_bf16 v[48:51], a[232:235], a[0:3], 0
buffer_load_dwordx4 a[176:179], v3, s[8:11], s28 offen offset:0 sc1
v_mfma_f32_16x16x32_bf16 v[48:51], a[236:239], a[4:7], v[48:51]
ds_read_b128 a[224:227], v2 offset:5120
v_dot2_f32_bf16 v30, v211, s38, v20
v_mfma_f32_16x16x32_bf16 v[52:55], a[232:235], a[72:75], 0
v_dot2_f32_bf16 v31, v211, s39, v20
v_cvt_pk_bf16_f32 v208, v24, v25
v_mfma_f32_16x16x32_bf16 v[52:55], a[236:239], a[76:79], v[52:55]
ds_read_b128 a[228:231], v2 offset:12288
s_waitcnt lgkmcnt(4)
v_mfma_f32_16x16x32_bf16 v[56:59], a[240:243], a[0:3], 0
buffer_load_dwordx4 a[36:39], v2, s[8:11], s26 offen offset:1024 sc1
v_mfma_f32_16x16x32_bf16 v[56:59], a[244:247], a[4:7], v[56:59]
ds_read_b128 a[232:235], v2 offset:6144
v_cvt_pk_bf16_f32 v209, v26, v27
v_mfma_f32_16x16x32_bf16 v[60:63], a[240:243], a[72:75], 0
v_cvt_pk_bf16_f32 v210, v28, v29
v_cvt_pk_bf16_f32 v211, v30, v31
v_mfma_f32_16x16x32_bf16 v[60:63], a[244:247], a[76:79], v[60:63]
ds_read_b128 a[236:239], v2 offset:13312
s_waitcnt lgkmcnt(4)
v_mfma_f32_16x16x32_bf16 v[64:67], a[216:219], a[0:3], 0
buffer_load_dwordx4 a[108:111], v2, s[8:11], s27 offen offset:1024 sc1
v_mfma_f32_16x16x32_bf16 v[64:67], a[220:223], a[4:7], v[64:67]
ds_read_b128 a[240:243], v6 offset:0
v_dot2_f32_bf16 v24, v212, s38, v21
v_mfma_f32_16x16x32_bf16 v[68:71], a[216:219], a[72:75], 0
v_dot2_f32_bf16 v25, v212, s39, v21
v_dot2_f32_bf16 v26, v213, s38, v21
v_mfma_f32_16x16x32_bf16 v[68:71], a[220:223], a[76:79], v[68:71]
ds_read_b128 a[244:247], v6 offset:7168
s_waitcnt lgkmcnt(4)
v_mfma_f32_16x16x32_bf16 v[72:75], a[0:3], a[224:227], 0
buffer_load_dwordx4 a[180:183], v3, s[8:11], s28 offen offset:1024 sc1
v_mfma_f32_16x16x32_bf16 v[72:75], a[4:7], a[228:231], v[72:75]
ds_read_b128 a[216:219], v9 offset:0
v_dot2_f32_bf16 v27, v213, s39, v21
v_mfma_f32_16x16x32_bf16 v[76:79], a[72:75], a[224:227], 0
v_dot2_f32_bf16 v28, v214, s38, v21
v_dot2_f32_bf16 v29, v214, s39, v21
v_mfma_f32_16x16x32_bf16 v[76:79], a[76:79], a[228:231], v[76:79]
ds_read_b128 a[220:223], v9 offset:7168
s_waitcnt lgkmcnt(4)
v_mfma_f32_16x16x32_bf16 v[80:83], a[0:3], a[232:235], 0
buffer_load_dwordx4 a[40:43], v2, s[8:11], s26 offen offset:2048 sc1
v_mfma_f32_16x16x32_bf16 v[80:83], a[4:7], a[236:239], v[80:83]
ds_read_b128 a[224:227], v2 offset:14336
v_dot2_f32_bf16 v30, v215, s38, v21
v_mfma_f32_16x16x32_bf16 v[84:87], a[72:75], a[232:235], 0
v_dot2_f32_bf16 v31, v215, s39, v21
v_cvt_pk_bf16_f32 v212, v24, v25
v_mfma_f32_16x16x32_bf16 v[84:87], a[76:79], a[236:239], v[84:87]
ds_read_b128 a[228:231], v2 offset:21504
s_waitcnt lgkmcnt(4)
v_mfma_f32_16x16x32_bf16 v[88:91], a[240:243], a[144:147], 0
ds_read_b128 a[232:235], v2 offset:15360
buffer_load_dwordx4 a[112:115], v2, s[8:11], s27 offen offset:2048 sc1
v_mfma_f32_16x16x32_bf16 v[88:91], a[244:247], a[148:151], v[88:91]
ds_read_b128 a[236:239], v2 offset:22528
s_waitcnt lgkmcnt(4)
v_mfma_f32_16x16x32_bf16 v[92:95], a[144:147], a[216:219], 0
ds_read_b128 a[240:243], v2 offset:16384
v_cvt_pk_bf16_f32 v213, v26, v27
v_mfma_f32_16x16x32_bf16 v[92:95], a[148:151], a[220:223], v[92:95]
ds_read_b128 a[244:247], v2 offset:23552
s_waitcnt vmcnt(20)
s_waitcnt lgkmcnt(4)
v_mfma_f32_16x16x32_bf16 v[32:35], a[224:227], a[8:11], v[32:35]
buffer_load_dwordx4 a[184:187], v3, s[8:11], s28 offen offset:2048 sc1
v_mfma_f32_16x16x32_bf16 v[32:35], a[228:231], a[12:15], v[32:35]
ds_read_b128 a[216:219], v2 offset:17408
v_cvt_pk_bf16_f32 v214, v28, v29
v_mfma_f32_16x16x32_bf16 v[36:39], a[224:227], a[80:83], v[36:39]
v_cvt_pk_bf16_f32 v215, v30, v31
v_dot2_f32_bf16 v24, v216, s38, v22
v_mfma_f32_16x16x32_bf16 v[36:39], a[228:231], a[84:87], v[36:39]
ds_read_b128 a[220:223], v2 offset:24576
s_waitcnt lgkmcnt(4)
v_mfma_f32_16x16x32_bf16 v[40:43], a[232:235], a[8:11], v[40:43]
buffer_load_dwordx4 a[44:47], v2, s[8:11], s26 offen offset:3072 sc1
v_mfma_f32_16x16x32_bf16 v[40:43], a[236:239], a[12:15], v[40:43]
ds_read_b128 a[224:227], v2 offset:18432
v_dot2_f32_bf16 v25, v216, s39, v22
v_mfma_f32_16x16x32_bf16 v[44:47], a[232:235], a[80:83], v[44:47]
v_dot2_f32_bf16 v26, v217, s38, v22
v_dot2_f32_bf16 v27, v217, s39, v22
v_mfma_f32_16x16x32_bf16 v[44:47], a[236:239], a[84:87], v[44:47]
ds_read_b128 a[228:231], v2 offset:25600
s_waitcnt lgkmcnt(4)
v_mfma_f32_16x16x32_bf16 v[48:51], a[240:243], a[8:11], v[48:51]
buffer_load_dwordx4 a[116:119], v2, s[8:11], s27 offen offset:3072 sc1
v_mfma_f32_16x16x32_bf16 v[48:51], a[244:247], a[12:15], v[48:51]
ds_read_b128 a[232:235], v2 offset:19456
v_dot2_f32_bf16 v28, v218, s38, v22
v_mfma_f32_16x16x32_bf16 v[52:55], a[240:243], a[80:83], v[52:55]
v_dot2_f32_bf16 v29, v218, s39, v22
v_dot2_f32_bf16 v30, v219, s38, v22
v_mfma_f32_16x16x32_bf16 v[52:55], a[244:247], a[84:87], v[52:55]
ds_read_b128 a[236:239], v2 offset:26624
s_waitcnt lgkmcnt(4)
v_mfma_f32_16x16x32_bf16 v[56:59], a[216:219], a[8:11], v[56:59]
buffer_load_dwordx4 a[188:191], v3, s[8:11], s28 offen offset:3072 sc1
v_mfma_f32_16x16x32_bf16 v[56:59], a[220:223], a[12:15], v[56:59]
ds_read_b128 a[240:243], v2 offset:20480
v_dot2_f32_bf16 v31, v219, s39, v22
v_mfma_f32_16x16x32_bf16 v[60:63], a[216:219], a[80:83], v[60:63]
v_cvt_pk_bf16_f32 v216, v24, v25
v_cvt_pk_bf16_f32 v217, v26, v27
v_mfma_f32_16x16x32_bf16 v[60:63], a[220:223], a[84:87], v[60:63]
ds_read_b128 a[244:247], v2 offset:27648
s_waitcnt lgkmcnt(4)
v_mfma_f32_16x16x32_bf16 v[64:67], a[224:227], a[8:11], v[64:67]
s_add_u32 s26, s26, 4096
s_add_u32 s27, s27, 4096
s_add_u32 s28, s28, 4096
buffer_load_dwordx4 a[48:51], v2, s[8:11], s26 offen offset:0 sc1
v_mfma_f32_16x16x32_bf16 v[64:67], a[228:231], a[12:15], v[64:67]
ds_read_b128 a[216:219], v6 offset:14336
v_cvt_pk_bf16_f32 v218, v28, v29
v_mfma_f32_16x16x32_bf16 v[68:71], a[224:227], a[80:83], v[68:71]
v_cvt_pk_bf16_f32 v219, v30, v31
v_dot2_f32_bf16 v24, v220, s38, v23
v_mfma_f32_16x16x32_bf16 v[68:71], a[228:231], a[84:87], v[68:71]
ds_read_b128 a[220:223], v6 offset:21504
s_waitcnt lgkmcnt(4)
v_mfma_f32_16x16x32_bf16 v[72:75], a[8:11], a[232:235], v[72:75]
buffer_load_dwordx4 a[120:123], v2, s[8:11], s27 offen offset:0 sc1
v_mfma_f32_16x16x32_bf16 v[72:75], a[12:15], a[236:239], v[72:75]
ds_read_b128 a[224:227], v9 offset:14336
v_dot2_f32_bf16 v25, v220, s39, v23
v_mfma_f32_16x16x32_bf16 v[76:79], a[80:83], a[232:235], v[76:79]
v_dot2_f32_bf16 v26, v221, s38, v23
v_dot2_f32_bf16 v27, v221, s39, v23
v_mfma_f32_16x16x32_bf16 v[76:79], a[84:87], a[236:239], v[76:79]
ds_read_b128 a[228:231], v9 offset:21504
s_waitcnt lgkmcnt(4)
v_mfma_f32_16x16x32_bf16 v[80:83], a[8:11], a[240:243], v[80:83]
buffer_load_dwordx4 a[192:195], v3, s[8:11], s28 offen offset:0 sc1
v_mfma_f32_16x16x32_bf16 v[80:83], a[12:15], a[244:247], v[80:83]
ds_read_b128 a[232:235], v2 offset:28672
v_dot2_f32_bf16 v28, v222, s38, v23
v_mfma_f32_16x16x32_bf16 v[84:87], a[80:83], a[240:243], v[84:87]
v_dot2_f32_bf16 v29, v222, s39, v23
v_dot2_f32_bf16 v30, v223, s38, v23
v_mfma_f32_16x16x32_bf16 v[84:87], a[84:87], a[244:247], v[84:87]
ds_read_b128 a[236:239], v2 offset:35840
s_waitcnt lgkmcnt(4)
v_mfma_f32_16x16x32_bf16 v[88:91], a[216:219], a[152:155], v[88:91]
ds_read_b128 a[240:243], v2 offset:29696
buffer_load_dwordx4 a[52:55], v2, s[8:11], s26 offen offset:1024 sc1
v_mfma_f32_16x16x32_bf16 v[88:91], a[220:223], a[156:159], v[88:91]
ds_read_b128 a[244:247], v2 offset:36864
s_waitcnt lgkmcnt(4)
v_mfma_f32_16x16x32_bf16 v[92:95], a[152:155], a[224:227], v[92:95]
ds_read_b128 a[216:219], v2 offset:30720
v_dot2_f32_bf16 v31, v223, s39, v23
v_mfma_f32_16x16x32_bf16 v[92:95], a[156:159], a[228:231], v[92:95]
ds_read_b128 a[220:223], v2 offset:37888
s_waitcnt vmcnt(22)
s_waitcnt lgkmcnt(4)
v_mfma_f32_16x16x32_bf16 v[32:35], a[232:235], a[16:19], v[32:35]
buffer_load_dwordx4 a[124:127], v2, s[8:11], s27 offen offset:1024 sc1
v_mfma_f32_16x16x32_bf16 v[32:35], a[236:239], a[20:23], v[32:35]
ds_read_b128 a[224:227], v2 offset:31744
v_cvt_pk_bf16_f32 v220, v24, v25
v_mfma_f32_16x16x32_bf16 v[36:39], a[232:235], a[88:91], v[36:39]
v_cvt_pk_bf16_f32 v221, v26, v27
v_cvt_pk_bf16_f32 v222, v28, v29
v_mfma_f32_16x16x32_bf16 v[36:39], a[236:239], a[92:95], v[36:39]
ds_read_b128 a[228:231], v2 offset:38912
s_waitcnt lgkmcnt(4)
v_mfma_f32_16x16x32_bf16 v[40:43], a[240:243], a[16:19], v[40:43]
buffer_load_dwordx4 a[196:199], v3, s[8:11], s28 offen offset:1024 sc1
v_mfma_f32_16x16x32_bf16 v[40:43], a[244:247], a[20:23], v[40:43]
ds_read_b128 a[232:235], v2 offset:32768
v_cvt_pk_bf16_f32 v223, v30, v31
v_mfma_f32_16x16x32_bf16 v[44:47], a[240:243], a[88:91], v[44:47]
v_dot2_f32_bf16 v24, v224, s38, v20
v_dot2_f32_bf16 v25, v224, s39, v20
v_mfma_f32_16x16x32_bf16 v[44:47], a[244:247], a[92:95], v[44:47]
ds_read_b128 a[236:239], v2 offset:39936
s_waitcnt lgkmcnt(4)
v_mfma_f32_16x16x32_bf16 v[48:51], a[216:219], a[16:19], v[48:51]
buffer_load_dwordx4 a[56:59], v2, s[8:11], s26 offen offset:2048 sc1
v_mfma_f32_16x16x32_bf16 v[48:51], a[220:223], a[20:23], v[48:51]
ds_read_b128 a[240:243], v2 offset:33792
v_dot2_f32_bf16 v26, v225, s38, v20
v_mfma_f32_16x16x32_bf16 v[52:55], a[216:219], a[88:91], v[52:55]
v_dot2_f32_bf16 v27, v225, s39, v20
v_dot2_f32_bf16 v28, v226, s38, v20
v_mfma_f32_16x16x32_bf16 v[52:55], a[220:223], a[92:95], v[52:55]
ds_read_b128 a[244:247], v2 offset:40960
s_waitcnt lgkmcnt(4)
v_mfma_f32_16x16x32_bf16 v[56:59], a[224:227], a[16:19], v[56:59]
buffer_load_dwordx4 a[128:131], v2, s[8:11], s27 offen offset:2048 sc1
v_mfma_f32_16x16x32_bf16 v[56:59], a[228:231], a[20:23], v[56:59]
ds_read_b128 a[216:219], v2 offset:34816
v_dot2_f32_bf16 v29, v226, s39, v20
v_mfma_f32_16x16x32_bf16 v[60:63], a[224:227], a[88:91], v[60:63]
v_dot2_f32_bf16 v30, v227, s38, v20
v_dot2_f32_bf16 v31, v227, s39, v20
v_mfma_f32_16x16x32_bf16 v[60:63], a[228:231], a[92:95], v[60:63]
ds_read_b128 a[220:223], v2 offset:41984
s_waitcnt lgkmcnt(4)
v_mfma_f32_16x16x32_bf16 v[64:67], a[232:235], a[16:19], v[64:67]
buffer_load_dwordx4 a[200:203], v3, s[8:11], s28 offen offset:2048 sc1
v_mfma_f32_16x16x32_bf16 v[64:67], a[236:239], a[20:23], v[64:67]
ds_read_b128 a[224:227], v6 offset:28672
v_cvt_pk_bf16_f32 v224, v24, v25
v_mfma_f32_16x16x32_bf16 v[68:71], a[232:235], a[88:91], v[68:71]
v_cvt_pk_bf16_f32 v225, v26, v27
v_cvt_pk_bf16_f32 v226, v28, v29
v_mfma_f32_16x16x32_bf16 v[68:71], a[236:239], a[92:95], v[68:71]
ds_read_b128 a[228:231], v6 offset:35840
s_waitcnt lgkmcnt(4)
v_mfma_f32_16x16x32_bf16 v[72:75], a[16:19], a[240:243], v[72:75]
buffer_load_dwordx4 a[60:63], v2, s[8:11], s26 offen offset:3072 sc1
v_mfma_f32_16x16x32_bf16 v[72:75], a[20:23], a[244:247], v[72:75]
ds_read_b128 a[232:235], v9 offset:28672
v_cvt_pk_bf16_f32 v227, v30, v31
v_mfma_f32_16x16x32_bf16 v[76:79], a[88:91], a[240:243], v[76:79]
v_dot2_f32_bf16 v24, v228, s38, v21
v_dot2_f32_bf16 v25, v228, s39, v21
v_mfma_f32_16x16x32_bf16 v[76:79], a[92:95], a[244:247], v[76:79]
ds_read_b128 a[236:239], v9 offset:35840
s_waitcnt lgkmcnt(4)
v_mfma_f32_16x16x32_bf16 v[80:83], a[16:19], a[216:219], v[80:83]
buffer_load_dwordx4 a[132:135], v2, s[8:11], s27 offen offset:3072 sc1
v_mfma_f32_16x16x32_bf16 v[80:83], a[20:23], a[220:223], v[80:83]
ds_read_b128 a[240:243], v2 offset:43008
v_dot2_f32_bf16 v26, v229, s38, v21
v_mfma_f32_16x16x32_bf16 v[84:87], a[88:91], a[216:219], v[84:87]
v_dot2_f32_bf16 v27, v229, s39, v21
v_dot2_f32_bf16 v28, v230, s38, v21
v_mfma_f32_16x16x32_bf16 v[84:87], a[92:95], a[220:223], v[84:87]
ds_read_b128 a[244:247], v2 offset:50176
s_waitcnt lgkmcnt(4)
v_mfma_f32_16x16x32_bf16 v[88:91], a[224:227], a[160:163], v[88:91]
ds_read_b128 a[216:219], v2 offset:44032
buffer_load_dwordx4 a[204:207], v3, s[8:11], s28 offen offset:3072 sc1
v_mfma_f32_16x16x32_bf16 v[88:91], a[228:231], a[164:167], v[88:91]
ds_read_b128 a[220:223], v2 offset:51200
s_waitcnt lgkmcnt(4)
v_mfma_f32_16x16x32_bf16 v[92:95], a[160:163], a[232:235], v[92:95]
ds_read_b128 a[224:227], v2 offset:45056
v_dot2_f32_bf16 v29, v230, s39, v21
v_mfma_f32_16x16x32_bf16 v[92:95], a[164:167], a[236:239], v[92:95]
ds_read_b128 a[228:231], v2 offset:52224
s_waitcnt vmcnt(24)
s_waitcnt lgkmcnt(4)
v_mfma_f32_16x16x32_bf16 v[32:35], a[240:243], a[24:27], v[32:35]
s_add_u32 s26, s26, 4096
s_add_u32 s27, s27, 4096
s_add_u32 s28, s28, 4096
buffer_load_dwordx4 a[64:67], v2, s[8:11], s26 offen offset:0 sc1
v_mfma_f32_16x16x32_bf16 v[32:35], a[244:247], a[28:31], v[32:35]
ds_read_b128 a[232:235], v2 offset:46080
v_dot2_f32_bf16 v30, v231, s38, v21
v_mfma_f32_16x16x32_bf16 v[36:39], a[240:243], a[96:99], v[36:39]
v_dot2_f32_bf16 v31, v231, s39, v21
v_cvt_pk_bf16_f32 v228, v24, v25
v_mfma_f32_16x16x32_bf16 v[36:39], a[244:247], a[100:103], v[36:39]
ds_read_b128 a[236:239], v2 offset:53248
s_waitcnt lgkmcnt(4)
v_mfma_f32_16x16x32_bf16 v[40:43], a[216:219], a[24:27], v[40:43]
buffer_load_dwordx4 a[136:139], v2, s[8:11], s27 offen offset:0 sc1
v_mfma_f32_16x16x32_bf16 v[40:43], a[220:223], a[28:31], v[40:43]
ds_read_b128 a[240:243], v2 offset:47104
v_cvt_pk_bf16_f32 v229, v26, v27
v_mfma_f32_16x16x32_bf16 v[44:47], a[216:219], a[96:99], v[44:47]
v_cvt_pk_bf16_f32 v230, v28, v29
v_cvt_pk_bf16_f32 v231, v30, v31
v_mfma_f32_16x16x32_bf16 v[44:47], a[220:223], a[100:103], v[44:47]
ds_read_b128 a[244:247], v2 offset:54272
s_waitcnt lgkmcnt(4)
v_mfma_f32_16x16x32_bf16 v[48:51], a[224:227], a[24:27], v[48:51]
buffer_load_dwordx4 a[208:211], v3, s[8:11], s28 offen offset:0 sc1
v_mfma_f32_16x16x32_bf16 v[48:51], a[228:231], a[28:31], v[48:51]
ds_read_b128 a[216:219], v2 offset:48128
v_dot2_f32_bf16 v24, v232, s38, v22
v_mfma_f32_16x16x32_bf16 v[52:55], a[224:227], a[96:99], v[52:55]
v_dot2_f32_bf16 v25, v232, s39, v22
v_dot2_f32_bf16 v26, v233, s38, v22
v_mfma_f32_16x16x32_bf16 v[52:55], a[228:231], a[100:103], v[52:55]
ds_read_b128 a[220:223], v2 offset:55296
s_waitcnt lgkmcnt(4)
v_mfma_f32_16x16x32_bf16 v[56:59], a[232:235], a[24:27], v[56:59]
buffer_load_dwordx4 a[68:71], v2, s[8:11], s26 offen offset:1024 sc1
v_mfma_f32_16x16x32_bf16 v[56:59], a[236:239], a[28:31], v[56:59]
ds_read_b128 a[224:227], v2 offset:49152
v_dot2_f32_bf16 v27, v233, s39, v22
v_mfma_f32_16x16x32_bf16 v[60:63], a[232:235], a[96:99], v[60:63]
v_dot2_f32_bf16 v28, v234, s38, v22
v_dot2_f32_bf16 v29, v234, s39, v22
v_mfma_f32_16x16x32_bf16 v[60:63], a[236:239], a[100:103], v[60:63]
ds_read_b128 a[228:231], v2 offset:56320
s_waitcnt lgkmcnt(4)
v_mfma_f32_16x16x32_bf16 v[64:67], a[240:243], a[24:27], v[64:67]
buffer_load_dwordx4 a[140:143], v2, s[8:11], s27 offen offset:1024 sc1
v_mfma_f32_16x16x32_bf16 v[64:67], a[244:247], a[28:31], v[64:67]
ds_read_b128 a[232:235], v6 offset:43008
v_dot2_f32_bf16 v30, v235, s38, v22
v_mfma_f32_16x16x32_bf16 v[68:71], a[240:243], a[96:99], v[68:71]
v_dot2_f32_bf16 v31, v235, s39, v22
v_cvt_pk_bf16_f32 v232, v24, v25
v_mfma_f32_16x16x32_bf16 v[68:71], a[244:247], a[100:103], v[68:71]
ds_read_b128 a[236:239], v6 offset:50176
s_waitcnt lgkmcnt(4)
v_mfma_f32_16x16x32_bf16 v[72:75], a[24:27], a[216:219], v[72:75]
buffer_load_dwordx4 a[212:215], v3, s[8:11], s28 offen offset:1024 sc1
v_mfma_f32_16x16x32_bf16 v[72:75], a[28:31], a[220:223], v[72:75]
ds_read_b128 a[240:243], v9 offset:43008
v_cvt_pk_bf16_f32 v233, v26, v27
v_mfma_f32_16x16x32_bf16 v[76:79], a[96:99], a[216:219], v[76:79]
v_cvt_pk_bf16_f32 v234, v28, v29
v_cvt_pk_bf16_f32 v235, v30, v31
v_mfma_f32_16x16x32_bf16 v[76:79], a[100:103], a[220:223], v[76:79]
ds_read_b128 a[244:247], v9 offset:50176
s_waitcnt lgkmcnt(4)
v_mfma_f32_16x16x32_bf16 v[80:83], a[24:27], a[224:227], v[80:83]
buffer_store_dwordx4 v[176:179], v156, s[8:11], 0 offen sc1
v_dot2_f32_bf16 v24, v236, s38, v23
v_mfma_f32_16x16x32_bf16 v[80:83], a[28:31], a[228:231], v[80:83]
ds_read_b128 a[216:219], v2 offset:57344
v_dot2_f32_bf16 v25, v236, s39, v23
v_mfma_f32_16x16x32_bf16 v[84:87], a[96:99], a[224:227], v[84:87]
v_dot2_f32_bf16 v26, v237, s38, v23
v_dot2_f32_bf16 v27, v237, s39, v23
v_mfma_f32_16x16x32_bf16 v[84:87], a[100:103], a[228:231], v[84:87]
ds_read_b128 a[220:223], v2 offset:64512
s_waitcnt lgkmcnt(4)
v_mfma_f32_16x16x32_bf16 v[88:91], a[232:235], a[168:171], v[88:91]
ds_read_b128 a[224:227], v2 offset:58368
buffer_store_dwordx4 v[180:183], v157, s[8:11], 0 offen sc1
v_dot2_f32_bf16 v28, v238, s38, v23
v_mfma_f32_16x16x32_bf16 v[88:91], a[236:239], a[172:175], v[88:91]
ds_read_b128 a[228:231], v4 offset:0
s_waitcnt lgkmcnt(4)
v_mfma_f32_16x16x32_bf16 v[92:95], a[168:171], a[240:243], v[92:95]
ds_read_b128 a[232:235], v2 offset:59392
v_dot2_f32_bf16 v29, v238, s39, v23
v_mfma_f32_16x16x32_bf16 v[92:95], a[172:175], a[244:247], v[92:95]
ds_read_b128 a[236:239], v4 offset:1024
s_waitcnt vmcnt(26)
s_waitcnt lgkmcnt(4)
v_mfma_f32_16x16x32_bf16 v[32:35], a[216:219], a[32:35], v[32:35]
buffer_store_dwordx4 v[184:187], v158, s[8:11], 0 offen sc1
v_dot2_f32_bf16 v30, v239, s38, v23
v_mfma_f32_16x16x32_bf16 v[32:35], a[220:223], a[36:39], v[32:35]
ds_read_b128 a[240:243], v2 offset:60416
v_dot2_f32_bf16 v31, v239, s39, v23
v_mfma_f32_16x16x32_bf16 v[36:39], a[216:219], a[104:107], v[36:39]
v_cvt_pk_bf16_f32 v236, v24, v25
v_cvt_pk_bf16_f32 v237, v26, v27
v_mfma_f32_16x16x32_bf16 v[36:39], a[220:223], a[108:111], v[36:39]
ds_read_b128 a[244:247], v4 offset:2048
s_waitcnt lgkmcnt(4)
v_mfma_f32_16x16x32_bf16 v[40:43], a[224:227], a[32:35], v[40:43]
buffer_store_dwordx4 v[188:191], v159, s[8:11], 0 offen sc1
v_cvt_pk_bf16_f32 v238, v28, v29
v_mfma_f32_16x16x32_bf16 v[40:43], a[228:231], a[36:39], v[40:43]
ds_read_b128 a[216:219], v2 offset:61440
v_cvt_pk_bf16_f32 v239, v30, v31
v_mfma_f32_16x16x32_bf16 v[44:47], a[224:227], a[104:107], v[44:47]
v_dot2_f32_bf16 v24, v240, s38, v20
v_dot2_f32_bf16 v25, v240, s39, v20
v_mfma_f32_16x16x32_bf16 v[44:47], a[228:231], a[108:111], v[44:47]
ds_read_b128 a[220:223], v4 offset:3072
s_waitcnt lgkmcnt(4)
v_mfma_f32_16x16x32_bf16 v[48:51], a[232:235], a[32:35], v[48:51]
buffer_store_dwordx4 v[192:195], v160, s[8:11], 0 offen sc1
v_dot2_f32_bf16 v26, v241, s38, v20
v_mfma_f32_16x16x32_bf16 v[48:51], a[236:239], a[36:39], v[48:51]
ds_read_b128 a[224:227], v2 offset:62464
v_dot2_f32_bf16 v27, v241, s39, v20
v_mfma_f32_16x16x32_bf16 v[52:55], a[232:235], a[104:107], v[52:55]
v_dot2_f32_bf16 v28, v242, s38, v20
v_dot2_f32_bf16 v29, v242, s39, v20
v_mfma_f32_16x16x32_bf16 v[52:55], a[236:239], a[108:111], v[52:55]
ds_read_b128 a[228:231], v4 offset:4096
s_waitcnt lgkmcnt(4)
v_mfma_f32_16x16x32_bf16 v[56:59], a[240:243], a[32:35], v[56:59]
buffer_store_dwordx4 v[196:199], v161, s[8:11], 0 offen sc1
v_dot2_f32_bf16 v30, v243, s38, v20
v_mfma_f32_16x16x32_bf16 v[56:59], a[244:247], a[36:39], v[56:59]
ds_read_b128 a[232:235], v2 offset:63488
v_dot2_f32_bf16 v31, v243, s39, v20
v_mfma_f32_16x16x32_bf16 v[60:63], a[240:243], a[104:107], v[60:63]
v_cvt_pk_bf16_f32 v240, v24, v25
v_cvt_pk_bf16_f32 v241, v26, v27
v_mfma_f32_16x16x32_bf16 v[60:63], a[244:247], a[108:111], v[60:63]
ds_read_b128 a[236:239], v4 offset:5120
s_waitcnt lgkmcnt(4)
v_mfma_f32_16x16x32_bf16 v[64:67], a[216:219], a[32:35], v[64:67]
buffer_store_dwordx4 v[200:203], v162, s[8:11], 0 offen sc1
v_cvt_pk_bf16_f32 v242, v28, v29
v_mfma_f32_16x16x32_bf16 v[64:67], a[220:223], a[36:39], v[64:67]
ds_read_b128 a[240:243], v6 offset:57344
v_cvt_pk_bf16_f32 v243, v30, v31
v_mfma_f32_16x16x32_bf16 v[68:71], a[216:219], a[104:107], v[68:71]
v_dot2_f32_bf16 v24, v244, s38, v21
v_dot2_f32_bf16 v25, v244, s39, v21
v_mfma_f32_16x16x32_bf16 v[68:71], a[220:223], a[108:111], v[68:71]
ds_read_b128 a[244:247], v6 offset:64512
s_waitcnt lgkmcnt(4)
v_mfma_f32_16x16x32_bf16 v[72:75], a[32:35], a[224:227], v[72:75]
buffer_store_dwordx4 v[204:207], v163, s[8:11], 0 offen sc1
v_dot2_f32_bf16 v26, v245, s38, v21
v_mfma_f32_16x16x32_bf16 v[72:75], a[36:39], a[228:231], v[72:75]
ds_read_b128 a[216:219], v9 offset:57344
v_dot2_f32_bf16 v27, v245, s39, v21
v_mfma_f32_16x16x32_bf16 v[76:79], a[104:107], a[224:227], v[76:79]
v_dot2_f32_bf16 v28, v246, s38, v21
v_dot2_f32_bf16 v29, v246, s39, v21
v_mfma_f32_16x16x32_bf16 v[76:79], a[108:111], a[228:231], v[76:79]
ds_read_b128 a[220:223], v9 offset:64512
s_waitcnt lgkmcnt(4)
v_mfma_f32_16x16x32_bf16 v[80:83], a[32:35], a[232:235], v[80:83]
buffer_store_dwordx4 v[208:211], v164, s[8:11], 0 offen sc1
v_dot2_f32_bf16 v30, v247, s38, v21
v_mfma_f32_16x16x32_bf16 v[80:83], a[36:39], a[236:239], v[80:83]
ds_read_b128 a[224:227], v4 offset:6144
v_dot2_f32_bf16 v31, v247, s39, v21
v_mfma_f32_16x16x32_bf16 v[84:87], a[104:107], a[232:235], v[84:87]
v_cvt_pk_bf16_f32 v244, v24, v25
v_cvt_pk_bf16_f32 v245, v26, v27
v_mfma_f32_16x16x32_bf16 v[84:87], a[108:111], a[236:239], v[84:87]
ds_read_b128 a[228:231], v4 offset:13312
s_waitcnt lgkmcnt(4)
v_mfma_f32_16x16x32_bf16 v[88:91], a[240:243], a[176:179], v[88:91]
ds_read_b128 a[232:235], v4 offset:7168
buffer_store_dwordx4 v[212:215], v165, s[8:11], 0 offen sc1
v_cvt_pk_bf16_f32 v246, v28, v29
v_mfma_f32_16x16x32_bf16 v[88:91], a[244:247], a[180:183], v[88:91]
ds_read_b128 a[236:239], v4 offset:14336
s_waitcnt lgkmcnt(4)
v_mfma_f32_16x16x32_bf16 v[92:95], a[176:179], a[216:219], v[92:95]
ds_read_b128 a[240:243], v4 offset:8192
v_cvt_pk_bf16_f32 v247, v30, v31
v_mfma_f32_16x16x32_bf16 v[92:95], a[180:183], a[220:223], v[92:95]
ds_read_b128 a[244:247], v4 offset:15360
s_waitcnt vmcnt(28)
s_waitcnt lgkmcnt(4)
v_mfma_f32_16x16x32_bf16 v[32:35], a[224:227], a[40:43], v[32:35]
buffer_store_dwordx4 v[216:219], v166, s[8:11], 0 offen sc1
v_dot2_f32_bf16 v24, v248, s38, v22
v_mfma_f32_16x16x32_bf16 v[32:35], a[228:231], a[44:47], v[32:35]
ds_read_b128 a[216:219], v4 offset:9216
v_dot2_f32_bf16 v25, v248, s39, v22
v_mfma_f32_16x16x32_bf16 v[36:39], a[224:227], a[112:115], v[36:39]
v_dot2_f32_bf16 v26, v249, s38, v22
v_dot2_f32_bf16 v27, v249, s39, v22
v_mfma_f32_16x16x32_bf16 v[36:39], a[228:231], a[116:119], v[36:39]
ds_read_b128 a[220:223], v4 offset:16384
s_waitcnt lgkmcnt(4)
v_mfma_f32_16x16x32_bf16 v[40:43], a[232:235], a[40:43], v[40:43]
buffer_store_dwordx4 v[220:223], v167, s[8:11], 0 offen sc1
v_dot2_f32_bf16 v28, v250, s38, v22
v_mfma_f32_16x16x32_bf16 v[40:43], a[236:239], a[44:47], v[40:43]
ds_read_b128 a[224:227], v4 offset:10240
v_dot2_f32_bf16 v29, v250, s39, v22
v_mfma_f32_16x16x32_bf16 v[44:47], a[232:235], a[112:115], v[44:47]
v_dot2_f32_bf16 v30, v251, s38, v22
v_dot2_f32_bf16 v31, v251, s39, v22
v_mfma_f32_16x16x32_bf16 v[44:47], a[236:239], a[116:119], v[44:47]
ds_read_b128 a[228:231], v4 offset:17408
s_waitcnt lgkmcnt(4)
v_mfma_f32_16x16x32_bf16 v[48:51], a[240:243], a[40:43], v[48:51]
buffer_store_dwordx4 v[224:227], v168, s[8:11], 0 offen sc1
v_cvt_pk_bf16_f32 v248, v24, v25
v_mfma_f32_16x16x32_bf16 v[48:51], a[244:247], a[44:47], v[48:51]
ds_read_b128 a[232:235], v4 offset:11264
v_cvt_pk_bf16_f32 v249, v26, v27
v_mfma_f32_16x16x32_bf16 v[52:55], a[240:243], a[112:115], v[52:55]
v_cvt_pk_bf16_f32 v250, v28, v29
v_cvt_pk_bf16_f32 v251, v30, v31
v_mfma_f32_16x16x32_bf16 v[52:55], a[244:247], a[116:119], v[52:55]
ds_read_b128 a[236:239], v4 offset:18432
s_waitcnt lgkmcnt(4)
v_mfma_f32_16x16x32_bf16 v[56:59], a[216:219], a[40:43], v[56:59]
buffer_store_dwordx4 v[228:231], v169, s[8:11], 0 offen sc1
v_dot2_f32_bf16 v24, v252, s38, v23
v_mfma_f32_16x16x32_bf16 v[56:59], a[220:223], a[44:47], v[56:59]
ds_read_b128 a[240:243], v4 offset:12288
v_dot2_f32_bf16 v25, v252, s39, v23
v_mfma_f32_16x16x32_bf16 v[60:63], a[216:219], a[112:115], v[60:63]
v_dot2_f32_bf16 v26, v253, s38, v23
v_dot2_f32_bf16 v27, v253, s39, v23
v_mfma_f32_16x16x32_bf16 v[60:63], a[220:223], a[116:119], v[60:63]
ds_read_b128 a[244:247], v4 offset:19456
s_waitcnt lgkmcnt(4)
v_mfma_f32_16x16x32_bf16 v[64:67], a[224:227], a[40:43], v[64:67]
buffer_store_dwordx4 v[232:235], v170, s[8:11], 0 offen sc1
v_dot2_f32_bf16 v28, v254, s38, v23
v_mfma_f32_16x16x32_bf16 v[64:67], a[228:231], a[44:47], v[64:67]
ds_read_b128 a[216:219], v7 offset:6144
v_dot2_f32_bf16 v29, v254, s39, v23
v_mfma_f32_16x16x32_bf16 v[68:71], a[224:227], a[112:115], v[68:71]
v_dot2_f32_bf16 v30, v255, s38, v23
v_dot2_f32_bf16 v31, v255, s39, v23
v_mfma_f32_16x16x32_bf16 v[68:71], a[228:231], a[116:119], v[68:71]
ds_read_b128 a[220:223], v7 offset:13312
s_waitcnt lgkmcnt(4)
v_mfma_f32_16x16x32_bf16 v[72:75], a[40:43], a[232:235], v[72:75]
buffer_store_dwordx4 v[236:239], v171, s[8:11], 0 offen sc1
v_cvt_pk_bf16_f32 v252, v24, v25
v_mfma_f32_16x16x32_bf16 v[72:75], a[44:47], a[236:239], v[72:75]
ds_read_b128 a[224:227], v10 offset:6144
v_cvt_pk_bf16_f32 v253, v26, v27
v_mfma_f32_16x16x32_bf16 v[76:79], a[112:115], a[232:235], v[76:79]
v_cvt_pk_bf16_f32 v254, v28, v29
v_cvt_pk_bf16_f32 v255, v30, v31
v_mfma_f32_16x16x32_bf16 v[76:79], a[116:119], a[236:239], v[76:79]
ds_read_b128 a[228:231], v10 offset:13312
s_waitcnt lgkmcnt(4)
v_mfma_f32_16x16x32_bf16 v[80:83], a[40:43], a[240:243], v[80:83]
buffer_store_dwordx4 v[240:243], v172, s[8:11], 0 offen sc1
v_lshlrev_b32 v14, 3, v1
v_mfma_f32_16x16x32_bf16 v[80:83], a[44:47], a[244:247], v[80:83]
ds_read_b128 a[232:235], v4 offset:20480
s_mul_i32 s31, s4, 3072
v_mfma_f32_16x16x32_bf16 v[84:87], a[112:115], a[240:243], v[84:87]
s_add_u32 s41, s31, 147456
v_add_u32 v15, s41, v14
v_mfma_f32_16x16x32_bf16 v[84:87], a[116:119], a[244:247], v[84:87]
ds_read_b128 a[236:239], v4 offset:27648
s_waitcnt lgkmcnt(4)
v_mfma_f32_16x16x32_bf16 v[88:91], a[216:219], a[184:187], v[88:91]
ds_read_b128 a[240:243], v4 offset:21504
buffer_store_dwordx4 v[244:247], v173, s[8:11], 0 offen sc1
s_lshl_b32 s42, s29, 9
v_mfma_f32_16x16x32_bf16 v[88:91], a[220:223], a[188:191], v[88:91]
ds_read_b128 a[244:247], v4 offset:28672
s_waitcnt lgkmcnt(4)
v_mfma_f32_16x16x32_bf16 v[92:95], a[184:187], a[224:227], v[92:95]
ds_read_b128 a[216:219], v4 offset:22528
s_add_u32 s42, s42, 147456
v_mfma_f32_16x16x32_bf16 v[92:95], a[188:191], a[228:231], v[92:95]
ds_read_b128 a[220:223], v4 offset:29696
s_waitcnt vmcnt(30)
s_waitcnt lgkmcnt(4)
v_mfma_f32_16x16x32_bf16 v[32:35], a[232:235], a[48:51], v[32:35]
buffer_store_dwordx4 v[248:251], v174, s[8:11], 0 offen sc1
v_add_u32 v16, s42, v14
v_mfma_f32_16x16x32_bf16 v[32:35], a[236:239], a[52:55], v[32:35]
ds_read_b128 a[224:227], v4 offset:23552
s_and_b32 s42, s42, 512
v_mfma_f32_16x16x32_bf16 v[36:39], a[232:235], a[120:123], v[36:39]
s_add_u32 s42, s42, 147456
v_add_u32 v19, s42, v14
v_mfma_f32_16x16x32_bf16 v[36:39], a[236:239], a[124:127], v[36:39]
ds_read_b128 a[228:231], v4 offset:30720
s_waitcnt lgkmcnt(4)
v_mfma_f32_16x16x32_bf16 v[40:43], a[240:243], a[48:51], v[40:43]
buffer_store_dwordx4 v[252:255], v175, s[8:11], 0 offen sc1
v_add_u32 v18, 150016, v14
v_mfma_f32_16x16x32_bf16 v[40:43], a[244:247], a[52:55], v[40:43]
ds_read_b128 a[232:235], v4 offset:24576
v_mov_b32 v96, 0
v_mfma_f32_16x16x32_bf16 v[44:47], a[240:243], a[120:123], v[44:47]
v_mov_b32 v97, 0
v_mov_b32 v100, 0
v_mfma_f32_16x16x32_bf16 v[44:47], a[244:247], a[124:127], v[44:47]
ds_read_b128 a[236:239], v4 offset:31744
s_waitcnt lgkmcnt(4)
v_mfma_f32_16x16x32_bf16 v[48:51], a[216:219], a[48:51], v[48:51]
v_mov_b32 v101, 0
v_and_b32 v13, 1, v1
v_mfma_f32_16x16x32_bf16 v[48:51], a[220:223], a[52:55], v[48:51]
ds_read_b128 a[240:243], v4 offset:25600
v_lshlrev_b32 v13, 4, v13
v_mfma_f32_16x16x32_bf16 v[52:55], a[216:219], a[120:123], v[52:55]
v_mov_b32 v102, 0x3f80
v_lshlrev_b32 v13, v13, v102
v_mfma_f32_16x16x32_bf16 v[52:55], a[220:223], a[124:127], v[52:55]
ds_read_b128 a[244:247], v4 offset:32768
s_waitcnt lgkmcnt(4)
v_mfma_f32_16x16x32_bf16 v[56:59], a[224:227], a[48:51], v[56:59]
v_lshrrev_b32 v102, 1, v1
v_cmp_eq_u32 vcc, 16, v102
v_mfma_f32_16x16x32_bf16 v[56:59], a[228:231], a[52:55], v[56:59]
ds_read_b128 a[216:219], v4 offset:26624
v_cndmask_b32 v98, 0, v13, vcc
v_mfma_f32_16x16x32_bf16 v[60:63], a[224:227], a[120:123], v[60:63]
v_cmp_eq_u32 vcc, 17, v102
s_nop 1
v_cndmask_b32 v99, 0, v13, vcc
v_mfma_f32_16x16x32_bf16 v[60:63], a[228:231], a[124:127], v[60:63]
ds_read_b128 a[220:223], v4 offset:33792
s_waitcnt lgkmcnt(4)
v_mfma_f32_16x16x32_bf16 v[64:67], a[232:235], a[48:51], v[64:67]
v_add_u32 v17, 16, v12
v_cmp_gt_u32 vcc, 16, v1
v_mfma_f32_16x16x32_bf16 v[64:67], a[236:239], a[52:55], v[64:67]
ds_read_b128 a[224:227], v7 offset:20480
v_add_u32 v14, 48, v12
v_mfma_f32_16x16x32_bf16 v[68:71], a[232:235], a[120:123], v[68:71]
s_mov_b32 s34, 0x3eae1a93
v_cndmask_b32 v17, v14, v17, vcc
v_mfma_f32_16x16x32_bf16 v[68:71], a[236:239], a[124:127], v[68:71]
ds_read_b128 a[228:231], v7 offset:27648
s_waitcnt lgkmcnt(4)
v_mfma_f32_16x16x32_bf16 v[72:75], a[48:51], a[240:243], v[72:75]
v_lshlrev_b32 v17, 3, v17
v_add_u32 v17, s41, v17
v_mfma_f32_16x16x32_bf16 v[72:75], a[52:55], a[244:247], v[72:75]
ds_read_b128 a[232:235], v10 offset:20480
v_mfma_f32_16x16x32_bf16 v[76:79], a[120:123], a[240:243], v[76:79]
v_mfma_f32_16x16x32_bf16 v[76:79], a[124:127], a[244:247], v[76:79]
ds_read_b128 a[236:239], v10 offset:27648
s_waitcnt lgkmcnt(4)
v_mfma_f32_16x16x32_bf16 v[80:83], a[48:51], a[216:219], v[80:83]
v_mfma_f32_16x16x32_bf16 v[80:83], a[52:55], a[220:223], v[80:83]
ds_read_b128 a[240:243], v4 offset:34816
v_mfma_f32_16x16x32_bf16 v[84:87], a[120:123], a[216:219], v[84:87]
v_mfma_f32_16x16x32_bf16 v[84:87], a[124:127], a[220:223], v[84:87]
ds_read_b128 a[244:247], v4 offset:41984
s_waitcnt lgkmcnt(4)
v_mfma_f32_16x16x32_bf16 v[88:91], a[224:227], a[192:195], v[88:91]
ds_read_b128 a[216:219], v4 offset:35840
v_mfma_f32_16x16x32_bf16 v[88:91], a[228:231], a[196:199], v[88:91]
ds_read_b128 a[220:223], v4 offset:43008
s_waitcnt lgkmcnt(4)
v_mfma_f32_16x16x32_bf16 v[92:95], a[192:195], a[232:235], v[92:95]
ds_read_b128 a[224:227], v4 offset:36864
v_mfma_f32_16x16x32_bf16 v[92:95], a[196:199], a[236:239], v[92:95]
ds_read_b128 a[228:231], v4 offset:44032
s_waitcnt vmcnt(26)
s_waitcnt lgkmcnt(4)
v_mfma_f32_16x16x32_bf16 v[32:35], a[240:243], a[56:59], v[32:35]
v_mfma_f32_16x16x32_bf16 v[32:35], a[244:247], a[60:63], v[32:35]
ds_read_b128 a[232:235], v4 offset:37888
v_mfma_f32_16x16x32_bf16 v[36:39], a[240:243], a[128:131], v[36:39]
v_mfma_f32_16x16x32_bf16 v[36:39], a[244:247], a[132:135], v[36:39]
ds_read_b128 a[236:239], v4 offset:45056
s_waitcnt lgkmcnt(4)
v_mfma_f32_16x16x32_bf16 v[40:43], a[216:219], a[56:59], v[40:43]
v_mfma_f32_16x16x32_bf16 v[40:43], a[220:223], a[60:63], v[40:43]
ds_read_b128 a[240:243], v4 offset:38912
v_mfma_f32_16x16x32_bf16 v[44:47], a[216:219], a[128:131], v[44:47]
v_mfma_f32_16x16x32_bf16 v[44:47], a[220:223], a[132:135], v[44:47]
ds_read_b128 a[244:247], v4 offset:46080
s_waitcnt lgkmcnt(4)
v_mfma_f32_16x16x32_bf16 v[48:51], a[224:227], a[56:59], v[48:51]
v_mfma_f32_16x16x32_bf16 v[48:51], a[228:231], a[60:63], v[48:51]
ds_read_b128 a[216:219], v4 offset:39936
v_mfma_f32_16x16x32_bf16 v[52:55], a[224:227], a[128:131], v[52:55]
v_mfma_f32_16x16x32_bf16 v[52:55], a[228:231], a[132:135], v[52:55]
ds_read_b128 a[220:223], v4 offset:47104
s_waitcnt lgkmcnt(4)
v_mfma_f32_16x16x32_bf16 v[56:59], a[232:235], a[56:59], v[56:59]
v_mfma_f32_16x16x32_bf16 v[56:59], a[236:239], a[60:63], v[56:59]
ds_read_b128 a[224:227], v4 offset:40960
v_mfma_f32_16x16x32_bf16 v[60:63], a[232:235], a[128:131], v[60:63]
v_mfma_f32_16x16x32_bf16 v[60:63], a[236:239], a[132:135], v[60:63]
ds_read_b128 a[228:231], v4 offset:48128
s_waitcnt lgkmcnt(4)
v_mfma_f32_16x16x32_bf16 v[64:67], a[240:243], a[56:59], v[64:67]
v_mfma_f32_16x16x32_bf16 v[64:67], a[244:247], a[60:63], v[64:67]
ds_read_b128 a[232:235], v7 offset:34816
v_mfma_f32_16x16x32_bf16 v[68:71], a[240:243], a[128:131], v[68:71]
v_mfma_f32_16x16x32_bf16 v[68:71], a[244:247], a[132:135], v[68:71]
ds_read_b128 a[236:239], v7 offset:41984
s_waitcnt lgkmcnt(4)
v_mfma_f32_16x16x32_bf16 v[72:75], a[56:59], a[216:219], v[72:75]
v_mfma_f32_16x16x32_bf16 v[72:75], a[60:63], a[220:223], v[72:75]
ds_read_b128 a[240:243], v10 offset:34816
v_mfma_f32_16x16x32_bf16 v[76:79], a[128:131], a[216:219], v[76:79]
v_mfma_f32_16x16x32_bf16 v[76:79], a[132:135], a[220:223], v[76:79]
ds_read_b128 a[244:247], v10 offset:41984
s_waitcnt lgkmcnt(4)
v_mfma_f32_16x16x32_bf16 v[80:83], a[56:59], a[224:227], v[80:83]
v_mfma_f32_16x16x32_bf16 v[80:83], a[60:63], a[228:231], v[80:83]
ds_read_b128 a[216:219], v4 offset:49152
v_mfma_f32_16x16x32_bf16 v[84:87], a[128:131], a[224:227], v[84:87]
v_mfma_f32_16x16x32_bf16 v[84:87], a[132:135], a[228:231], v[84:87]
ds_read_b128 a[220:223], v4 offset:56320
s_waitcnt lgkmcnt(4)
v_mfma_f32_16x16x32_bf16 v[88:91], a[232:235], a[200:203], v[88:91]
ds_read_b128 a[224:227], v4 offset:50176
v_mfma_f32_16x16x32_bf16 v[88:91], a[236:239], a[204:207], v[88:91]
ds_read_b128 a[228:231], v4 offset:57344
s_waitcnt lgkmcnt(4)
v_mfma_f32_16x16x32_bf16 v[92:95], a[200:203], a[240:243], v[92:95]
ds_read_b128 a[232:235], v4 offset:51200
v_mfma_f32_16x16x32_bf16 v[92:95], a[204:207], a[244:247], v[92:95]
ds_read_b128 a[236:239], v4 offset:58368
s_waitcnt vmcnt(20)
s_waitcnt lgkmcnt(4)
v_mfma_f32_16x16x32_bf16 v[32:35], a[216:219], a[64:67], v[32:35]
v_mfma_f32_16x16x32_bf16 v[32:35], a[220:223], a[68:71], v[32:35]
ds_read_b128 a[240:243], v4 offset:52224
v_mfma_f32_16x16x32_bf16 v[36:39], a[216:219], a[136:139], v[36:39]
v_mfma_f32_16x16x32_bf16 v[36:39], a[220:223], a[140:143], v[36:39]
ds_read_b128 a[244:247], v4 offset:59392
s_waitcnt lgkmcnt(4)
v_mfma_f32_16x16x32_bf16 v[40:43], a[224:227], a[64:67], v[40:43]
v_mfma_f32_16x16x32_bf16 v[40:43], a[228:231], a[68:71], v[40:43]
ds_read_b128 a[216:219], v4 offset:53248
v_mfma_f32_16x16x32_bf16 v[44:47], a[224:227], a[136:139], v[44:47]
v_mfma_f32_16x16x32_bf16 v[44:47], a[228:231], a[140:143], v[44:47]
ds_read_b128 a[220:223], v4 offset:60416
s_waitcnt lgkmcnt(4)
v_mfma_f32_16x16x32_bf16 v[48:51], a[232:235], a[64:67], v[48:51]
v_mfma_f32_16x16x32_bf16 v[48:51], a[236:239], a[68:71], v[48:51]
ds_read_b128 a[224:227], v4 offset:54272
v_mfma_f32_16x16x32_bf16 v[52:55], a[232:235], a[136:139], v[52:55]
v_mfma_f32_16x16x32_bf16 v[52:55], a[236:239], a[140:143], v[52:55]
ds_read_b128 a[228:231], v4 offset:61440
s_waitcnt lgkmcnt(4)
v_mfma_f32_16x16x32_bf16 v[56:59], a[240:243], a[64:67], v[56:59]
v_mfma_f32_16x16x32_bf16 v[56:59], a[244:247], a[68:71], v[56:59]
ds_read_b128 a[232:235], v4 offset:55296
v_mfma_f32_16x16x32_bf16 v[60:63], a[240:243], a[136:139], v[60:63]
v_mfma_f32_16x16x32_bf16 v[60:63], a[244:247], a[140:143], v[60:63]
ds_read_b128 a[236:239], v4 offset:62464
s_waitcnt lgkmcnt(4)
v_mfma_f32_16x16x32_bf16 v[64:67], a[216:219], a[64:67], v[64:67]
v_mfma_f32_16x16x32_bf16 v[64:67], a[220:223], a[68:71], v[64:67]
ds_read_b128 a[240:243], v7 offset:49152
v_mfma_f32_16x16x32_bf16 v[68:71], a[216:219], a[136:139], v[68:71]
v_mfma_f32_16x16x32_bf16 v[68:71], a[220:223], a[140:143], v[68:71]
ds_read_b128 a[244:247], v7 offset:56320
s_waitcnt lgkmcnt(4)
v_mfma_f32_16x16x32_bf16 v[72:75], a[64:67], a[224:227], v[72:75]
v_mfma_f32_16x16x32_bf16 v[72:75], a[68:71], a[228:231], v[72:75]
ds_read_b128 a[216:219], v10 offset:49152
v_mfma_f32_16x16x32_bf16 v[76:79], a[136:139], a[224:227], v[76:79]
v_mfma_f32_16x16x32_bf16 v[76:79], a[140:143], a[228:231], v[76:79]
ds_read_b128 a[220:223], v10 offset:56320
s_waitcnt lgkmcnt(4)
v_mfma_f32_16x16x32_bf16 v[80:83], a[64:67], a[232:235], v[80:83]
v_mfma_f32_16x16x32_bf16 v[80:83], a[68:71], a[236:239], v[80:83]
v_mfma_f32_16x16x32_bf16 v[84:87], a[136:139], a[232:235], v[84:87]
v_mfma_f32_16x16x32_bf16 v[84:87], a[140:143], a[236:239], v[84:87]
s_waitcnt lgkmcnt(2)
v_mfma_f32_16x16x32_bf16 v[88:91], a[240:243], a[208:211], v[88:91]
v_mfma_f32_16x16x32_bf16 v[88:91], a[244:247], a[212:215], v[88:91]
s_waitcnt lgkmcnt(0)
v_mfma_f32_16x16x32_bf16 v[92:95], a[208:211], a[216:219], v[92:95]
v_mfma_f32_16x16x32_bf16 v[92:95], a[212:215], a[220:223], v[92:95]
v_mov_b32 v103, 0xff61b1e6
v_mov_b32 v102, 0xffff
v_cndmask_b32 v172, v103, 0, s[44:45]
v_cndmask_b32 v173, v103, 0, s[46:47]
v_cndmask_b32 v174, v103, 0, s[48:49]
v_cndmask_b32 v175, v103, 0, s[50:51]
v_cndmask_b32 v184, 0, v102, s[44:45]
v_cndmask_b32 v13, 0, v102, s[46:47]
v_lshl_or_b32 v184, v13, 16, v184
v_cndmask_b32 v185, 0, v102, s[48:49]
v_cndmask_b32 v13, 0, v102, s[50:51]
v_lshl_or_b32 v185, v13, 16, v185
v_cndmask_b32 v176, v103, 0, s[52:53]
v_cndmask_b32 v177, v103, 0, s[54:55]
v_cndmask_b32 v178, v103, 0, s[56:57]
v_cndmask_b32 v179, v103, 0, s[58:59]
v_cndmask_b32 v186, 0, v102, s[52:53]
v_cndmask_b32 v13, 0, v102, s[54:55]
v_lshl_or_b32 v186, v13, 16, v186
v_cndmask_b32 v187, 0, v102, s[56:57]
v_cndmask_b32 v13, 0, v102, s[58:59]
v_lshl_or_b32 v187, v13, 16, v187
v_cndmask_b32 v180, v103, 0, s[60:61]
v_cndmask_b32 v181, v103, 0, s[62:63]
v_cndmask_b32 v182, v103, 0, s[64:65]
v_cndmask_b32 v183, v103, 0, s[66:67]
v_cndmask_b32 v188, 0, v102, s[60:61]
v_cndmask_b32 v13, 0, v102, s[62:63]
v_lshl_or_b32 v188, v13, 16, v188
v_cndmask_b32 v189, 0, v102, s[64:65]
v_cndmask_b32 v13, 0, v102, s[66:67]
v_lshl_or_b32 v189, v13, 16, v189
L_att:
v_cvt_pk_bf16_f32 v160, v64, v65
v_cvt_pk_bf16_f32 v161, v66, v67
v_cvt_pk_bf16_f32 v162, v68, v69
v_cvt_pk_bf16_f32 v163, v70, v71
v_cvt_pk_bf16_f32 v156, v88, v89
v_cvt_pk_bf16_f32 v157, v90, v91
v_cvt_pk_bf16_f32 v158, v92, v93
v_cvt_pk_bf16_f32 v159, v94, v95
v_mfma_f32_16x16x32_bf16 v[164:167], v[160:163], v[96:99], 0
s_nop 0
v_mfma_f32_16x16x32_bf16 v[168:171], v[156:159], v[98:101], 0
v_mfma_f32_16x16x32_bf16 v[88:91], v[160:163], v[98:101], 0
v_cvt_pk_bf16_f32 v116, v52, v53
v_cvt_pk_bf16_f32 v117, v54, v55
v_cvt_pk_bf16_f32 v120, v60, v61
v_cvt_pk_bf16_f32 v121, v62, v63
v_cvt_pk_bf16_f32 v126, v76, v77
v_cvt_pk_bf16_f32 v127, v78, v79
v_cvt_pk_bf16_f32 v132, v84, v85
v_cvt_pk_bf16_f32 v133, v86, v87
v_cvt_pk_bf16_f32 v138, v164, v165
v_cvt_pk_bf16_f32 v139, v166, v167
v_cvt_pk_bf16_f32 v164, v168, v169
v_cvt_pk_bf16_f32 v165, v170, v171
s_cmp_eq_u32 s4, 3
s_cbranch_scc1 L_a1_noxch
ds_write_b64 v16, v[156:157]
ds_write_b64 v15, v[116:117] offset:3072
ds_write_b64 v15, v[120:121] offset:3584
ds_write_b64 v15, v[162:163] offset:4096
ds_write_b64 v15, v[126:127] offset:4608
ds_write_b64 v15, v[132:133] offset:5120
ds_write_b64 v15, v[138:139] offset:5632
s_cmp_eq_u32 s4, 2
s_cbranch_scc1 L_a1_left
ds_write_b64 v19, v[158:159] offset:1536
s_branch L_a1_noxch
L_a1_left:
ds_write_b64 v18, v[164:165]
L_a1_noxch:
v_cvt_pk_bf16_f32 v136, v88, v89
v_cvt_pk_bf16_f32 v137, v90, v91
v_cvt_pk_bf16_f32 v110, v48, v49
v_cvt_pk_bf16_f32 v111, v50, v51
v_cvt_pk_bf16_f32 v114, v56, v57
v_cvt_pk_bf16_f32 v115, v58, v59
v_cvt_pk_bf16_f32 v124, v72, v73
v_cvt_pk_bf16_f32 v125, v74, v75
v_cvt_pk_bf16_f32 v130, v80, v81
v_cvt_pk_bf16_f32 v131, v82, v83
v_cvt_pk_bf16_f32 v140, v32, v33
v_cvt_pk_bf16_f32 v141, v34, v35
v_cvt_pk_bf16_f32 v146, v40, v41
v_cvt_pk_bf16_f32 v147, v42, v43
v_mov_b32 v142, v160
v_mov_b32 v145, v161
v_mov_b32 v143, 0
v_mov_b32 v144, 0
v_mov_b32 v112, 0
v_mov_b32 v113, 0
s_nop 0
v_permlane16_swap_b32 v142, v112
v_permlane16_swap_b32 v145, v113
v_cvt_pk_bf16_f32 v148, v36, v37
v_cvt_pk_bf16_f32 v149, v38, v39
v_cvt_pk_bf16_f32 v154, v44, v45
v_cvt_pk_bf16_f32 v155, v46, v47
v_mov_b32 v150, v162
v_mov_b32 v153, v163
v_mov_b32 v151, 0
v_mov_b32 v152, 0
v_mov_b32 v118, 0
v_mov_b32 v119, 0
s_nop 0
v_permlane16_swap_b32 v150, v118
v_permlane16_swap_b32 v153, v119
s_waitcnt lgkmcnt(0)
s_barrier
s_and_b32 s37, s6, 7
s_mul_i32 s37, s37, 92160
s_mul_i32 s38, s4, 23552
s_add_u32 s37, s37, s38
s_add_u32 s37, s37, 6266880
ds_read_b64 v[104:105], v15
ds_read_b64 v[108:109], v15 offset:512
ds_read_b64 v[106:107], v17 offset:1024
ds_read_b64 v[122:123], v15 offset:1536
ds_read_b64 v[128:129], v15 offset:2048
ds_read_b64 v[134:135], v15 offset:2560
v_mfma_f32_16x16x32_bf16 v[32:35], v[110:113], v[148:151], v[172:175]
v_mfma_f32_16x16x32_bf16 v[36:39], v[116:119], v[148:151], v[176:179]
v_mfma_f32_16x16x32_bf16 v[40:43], v[112:115], v[152:155], v[172:175]
v_mfma_f32_16x16x32_bf16 v[44:47], v[118:121], v[152:155], v[176:179]
s_waitcnt lgkmcnt(3)
v_mfma_f32_16x16x32_bf16 v[48:51], v[104:107], v[140:143], v[180:183]
v_mfma_f32_16x16x32_bf16 v[52:55], v[110:113], v[140:143], v[176:179]
v_mfma_f32_16x16x32_bf16 v[56:59], v[106:109], v[144:147], v[180:183]
v_mfma_f32_16x16x32_bf16 v[60:63], v[112:115], v[144:147], v[176:179]
s_nop 0
v_max_f32 v32, v32, v36
v_max_f32 v33, v33, v37
v_max_f32 v34, v34, v38
v_max_f32 v35, v35, v39
v_max_f32 v40, v40, v44
v_max_f32 v41, v41, v45
v_max_f32 v42, v42, v46
v_max_f32 v43, v43, v47
v_max_f32 v48, v48, v52
v_max_f32 v49, v49, v53
v_max_f32 v50, v50, v54
v_max_f32 v51, v51, v55
v_max_f32 v56, v56, v60
v_max_f32 v57, v57, v61
v_max_f32 v58, v58, v62
v_max_f32 v59, v59, v63
v_max3_f32 v20, v32, v33, v34
v_max3_f32 v21, v40, v41, v42
v_max3_f32 v22, v48, v49, v50
v_max3_f32 v23, v56, v57, v58
v_max_f32 v20, v20, v35
v_max_f32 v21, v21, v43
v_max_f32 v22, v22, v51
v_max_f32 v23, v23, v59
v_mov_b32 v24, v20
v_mov_b32 v25, v21
v_mov_b32 v26, v22
v_mov_b32 v27, v23
v_permlane16_swap_b32 v20, v24
v_permlane16_swap_b32 v21, v25
v_permlane16_swap_b32 v22, v26
v_permlane16_swap_b32 v23, v27
v_max_f32 v20, v20, v24
v_max_f32 v21, v21, v25
v_max_f32 v22, v22, v26
v_max_f32 v23, v23, v27
v_mov_b32 v24, v20
v_mov_b32 v25, v21
v_mov_b32 v26, v22
v_mov_b32 v27, v23
v_permlane32_swap_b32 v20, v24
v_permlane32_swap_b32 v21, v25
v_permlane32_swap_b32 v22, v26
v_permlane32_swap_b32 v23, v27
v_max_f32 v20, v20, v24
v_max_f32 v21, v21, v25
v_max_f32 v22, v22, v26
v_max_f32 v23, v23, v27
v_mul_f32 v20, s34, v20
v_mul_f32 v21, s34, v21
v_mul_f32 v22, s34, v22
v_mul_f32 v23, s34, v23
v_fma_f32 v32, v32, s34, -v20
v_fma_f32 v40, v40, s34, -v21
v_fma_f32 v48, v48, s34, -v22
v_fma_f32 v56, v56, s34, -v23
v_exp_f32 v32, v32
v_exp_f32 v40, v40
v_exp_f32 v48, v48
v_exp_f32 v56, v56
v_fma_f32 v33, v33, s34, -v20
v_fma_f32 v41, v41, s34, -v21
v_fma_f32 v49, v49, s34, -v22
v_fma_f32 v57, v57, s34, -v23
v_exp_f32 v33, v33
v_exp_f32 v41, v41
v_exp_f32 v49, v49
v_exp_f32 v57, v57
v_fma_f32 v34, v34, s34, -v20
v_fma_f32 v42, v42, s34, -v21
v_fma_f32 v50, v50, s34, -v22
v_fma_f32 v58, v58, s34, -v23
v_exp_f32 v34, v34
v_exp_f32 v42, v42
v_exp_f32 v50, v50
v_exp_f32 v58, v58
v_fma_f32 v35, v35, s34, -v20
v_fma_f32 v43, v43, s34, -v21
v_fma_f32 v51, v51, s34, -v22
v_fma_f32 v59, v59, s34, -v23
v_exp_f32 v35, v35
v_exp_f32 v43, v43
v_exp_f32 v51, v51
v_exp_f32 v59, v59
v_add_f32 v28, v32, v33
v_add_f32 v29, v40, v41
v_add_f32 v30, v48, v49
v_add_f32 v31, v56, v57
v_add_f32 v28, v28, v34
v_add_f32 v29, v29, v42
v_add_f32 v30, v30, v50
v_add_f32 v31, v31, v58
v_add_f32 v28, v28, v35
v_add_f32 v29, v29, v43
v_add_f32 v30, v30, v51
v_add_f32 v31, v31, v59
v_mov_b32 v24, v28
v_mov_b32 v25, v29
v_mov_b32 v26, v30
v_mov_b32 v27, v31
v_permlane16_swap_b32 v28, v24
v_permlane16_swap_b32 v29, v25
v_permlane16_swap_b32 v30, v26
v_permlane16_swap_b32 v31, v27
v_add_f32 v28, v28, v24
v_add_f32 v29, v29, v25
v_add_f32 v30, v30, v26
v_add_f32 v31, v31, v27
v_mov_b32 v24, v28
v_mov_b32 v25, v29
v_mov_b32 v26, v30
v_mov_b32 v27, v31
v_permlane32_swap_b32 v28, v24
v_permlane32_swap_b32 v29, v25
v_permlane32_swap_b32 v30, v26
v_permlane32_swap_b32 v31, v27
v_add_f32 v28, v28, v24
v_add_f32 v29, v29, v25
v_add_f32 v30, v30, v26
v_add_f32 v31, v31, v27
v_rcp_f32 v28, v28
v_rcp_f32 v29, v29
v_rcp_f32 v30, v30
v_rcp_f32 v31, v31
v_mul_f32 v32, v32, v28
v_mul_f32 v40, v40, v29
v_mul_f32 v48, v48, v30
v_mul_f32 v56, v56, v31
v_mul_f32 v33, v33, v28
v_mul_f32 v41, v41, v29
v_mul_f32 v49, v49, v30
v_mul_f32 v57, v57, v31
v_mul_f32 v34, v34, v28
v_mul_f32 v42, v42, v29
v_mul_f32 v50, v50, v30
v_mul_f32 v58, v58, v31
v_mul_f32 v35, v35, v28
v_mul_f32 v43, v43, v29
v_mul_f32 v51, v51, v30
v_mul_f32 v59, v59, v31
v_cvt_pk_bf16_f32 v36, v32, v33
v_cvt_pk_bf16_f32 v37, v34, v35
v_cvt_pk_bf16_f32 v44, v40, v41
v_cvt_pk_bf16_f32 v45, v42, v43
v_cvt_pk_bf16_f32 v52, v48, v49
v_cvt_pk_bf16_f32 v53, v50, v51
v_cvt_pk_bf16_f32 v60, v56, v57
v_cvt_pk_bf16_f32 v61, v58, v59
v_and_b32 v64, v184, v36
v_and_b32 v66, v186, v36
v_and_b32 v65, v185, v37
v_and_b32 v67, v187, v37
v_and_b32 v68, v184, v44
v_and_b32 v70, v186, v44
v_and_b32 v69, v185, v45
v_and_b32 v71, v187, v45
v_and_b32 v72, v188, v52
v_and_b32 v74, v186, v52
v_and_b32 v73, v189, v53
v_and_b32 v75, v187, v53
v_and_b32 v76, v188, v60
v_and_b32 v78, v186, v60
v_and_b32 v77, v189, v61
v_and_b32 v79, v187, v61
s_waitcnt lgkmcnt(0)
v_mfma_f32_16x16x32_bf16 v[80:83], v[124:127], v[64:67], 0
v_mfma_f32_16x16x32_bf16 v[84:87], v[136:139], v[64:67], 0
v_mfma_f32_16x16x32_bf16 v[88:91], v[130:133], v[68:71], 0
v_mfma_f32_16x16x32_bf16 v[92:95], v[136:139], v[68:71], 0
v_mfma_f32_16x16x32_bf16 v[96:99], v[122:125], v[72:75], 0
v_mfma_f32_16x16x32_bf16 v[100:103], v[134:137], v[72:75], 0
v_mfma_f32_16x16x32_bf16 v[164:167], v[128:131], v[76:79], 0
v_mfma_f32_16x16x32_bf16 v[168:171], v[134:137], v[76:79], 0
v_lshlrev_b32 v14, 3, v12
v_mov_b32 v15, 2146435072
v_cmp_gt_u32 vcc, 16, v1
s_nop 1
v_cndmask_b32 v14, v15, v14, vcc
s_add_u32 s26, s24, s72
s_lshl_b32 s27, s21, 10
s_add_u32 s27, s27, s26
s_lshl_b32 s28, s21, 7
s_add_u32 s28, s28, 16384
s_add_u32 s28, s28, s26
s_add_u32 s30, s27, 18432
s_add_u32 s31, s28, 18432
v_cvt_pk_bf16_f32 v40, v80, v81
v_cvt_pk_bf16_f32 v41, v82, v83
v_cvt_pk_bf16_f32 v42, v88, v89
v_cvt_pk_bf16_f32 v43, v90, v91
v_cvt_pk_bf16_f32 v44, v84, v85
v_cvt_pk_bf16_f32 v45, v94, v95
buffer_store_dwordx4 v[40:43], v2, s[8:11], s30 offen sc1
buffer_store_dwordx2 v[44:45], v14, s[8:11], s31 offen sc1
v_cvt_pk_bf16_f32 v32, v96, v97
v_cvt_pk_bf16_f32 v33, v98, v99
v_cvt_pk_bf16_f32 v34, v164, v165
v_cvt_pk_bf16_f32 v35, v166, v167
v_cvt_pk_bf16_f32 v36, v100, v101
v_cvt_pk_bf16_f32 v37, v170, v171
buffer_store_dwordx4 v[32:35], v2, s[8:11], s27 offen sc1
buffer_store_dwordx2 v[36:37], v14, s[8:11], s28 offen sc1
s_lshl_b32 s26, s20, 4
s_add_u32 s26, s26, s21
s_lshl_b32 s14, s26, 7
s_add_u32 s14, s14, 393216
s_add_u32 s14, s14, s77
s_lshr_b32 s20, s6, 3
s_lshl_b32 s21, s5, 2
s_add_u32 s20, s20, s21
s_lshl_b32 s20, s20, 2
s_add_u32 s20, s20, s4
s_and_b32 s21, s6, 7
s_mul_i32 s24, s20, 18432
s_add_u32 s25, s24, s72
s_mul_i32 s26, s21, 2304
s_add_u32 s26, s26, s24
s_add_u32 s27, s26, s71
v_and_b32 v6, 15, v1
v_lshrrev_b32 v7, 4, v1
v_lshlrev_b32 v8, 4, v6
v_lshl_add_u32 v8, v7, 3, v8
v_add_u32 v8, 2048, v8
v_mov_b32 v9, 2146435072
v_cmp_gt_u32 vcc, 32, v1
s_nop 1
v_cndmask_b32 v4, v9, v8, vcc
v_add_u32 v5, 0x10000, v2
s_and_b32 s40, s5, 1
s_lshl_b32 s40, s40, 2
s_lshr_b32 s41, s6, 3
s_add_u32 s40, s40, s41
s_lshr_b32 s41, s5, 1
s_lshl_b32 s41, s41, 3
s_and_b32 s42, s6, 7
s_add_u32 s41, s41, s42
s_lshr_b32 s42, s41, 2
s_and_b32 s43, s41, 3
s_lshr_b32 s22, s20, 3
s_lshl_b32 s22, s22, 4
v_add_u32 v10, s22, v6
v_subrev_u32 v12, 16, v1
v_min_u32 v12, 26, v12
v_mul_u32_u24 v16, 57, v12
v_lshrrev_b32 v16, 9, v16
v_mad_u32_u24 v12, v16, 63, v12
s_mul_i32 s22, s42, 9
v_add_u32 v12, s22, v12
v_and_b32 v16, 7, v12
v_lshrrev_b32 v12, 3, v12
v_lshrrev_b32 v17, 2, v16
v_lshlrev_b32 v17, 3, v17
v_lshrrev_b32 v18, 2, v12
v_add_lshl_u32 v17, v17, v18, 4
v_and_b32 v16, 3, v16
v_lshl_add_u32 v17, v16, 2, v17
v_and_b32 v12, 3, v12
v_add_u32 v17, v17, v12
s_cmp_eq_u32 s7, 0
s_cselect_b32 s22, 16, 64
v_cmp_le_u32 vcc, s22, v1
s_nop 1
v_cndmask_b32 v10, v10, v17, vcc
v_lshlrev_b32 v10, 7, v10
s_add_u32 s22, s77, 393216
v_lshlrev_b32 v11, 3, v6
v_lshl_add_u32 v11, v7, 8, v11
v_mov_b32 v13, 2146435072
v_cmp_gt_u32 vcc, 16, v0
v_lshlrev_b32 v14, 3, v0
s_nop 0
v_cndmask_b32 v13, v13, v14, vcc
v_mov_b32 v14, s68
v_mov_b32 v15, s69
s_waitcnt vmcnt(0)
s_barrier
buffer_store_dwordx2 v[14:15], v13, s[8:11], s14 offen sc1
s_add_u32 m0, s38, 0
s_add_u32 s39, s37, 0
buffer_load_dwordx4 v2, s[8:11], s39 offen offset:0 sc1 lds
buffer_load_dwordx4 v2, s[8:11], s39 offen offset:1024 sc1 lds
buffer_load_dwordx4 v2, s[8:11], s39 offen offset:2048 sc1 lds
buffer_load_dwordx4 v2, s[8:11], s39 offen offset:3072 sc1 lds
s_add_u32 m0, s38, 4096
s_add_u32 s39, s37, 4096
buffer_load_dwordx4 v2, s[8:11], s39 offen offset:0 sc1 lds
buffer_load_dwordx4 v2, s[8:11], s39 offen offset:1024 sc1 lds
buffer_load_dwordx4 v2, s[8:11], s39 offen offset:2048 sc1 lds
buffer_load_dwordx4 v2, s[8:11], s39 offen offset:3072 sc1 lds
s_add_u32 m0, s38, 8192
s_add_u32 s39, s37, 8192
buffer_load_dwordx4 v2, s[8:11], s39 offen offset:0 sc1 lds
buffer_load_dwordx4 v2, s[8:11], s39 offen offset:1024 sc1 lds
buffer_load_dwordx4 v2, s[8:11], s39 offen offset:2048 sc1 lds
buffer_load_dwordx4 v2, s[8:11], s39 offen offset:3072 sc1 lds
s_add_u32 m0, s38, 12288
s_add_u32 s39, s37, 12288
buffer_load_dwordx4 v2, s[8:11], s39 offen offset:0 sc1 lds
buffer_load_dwordx4 v2, s[8:11], s39 offen offset:1024 sc1 lds
buffer_load_dwordx4 v2, s[8:11], s39 offen offset:2048 sc1 lds
buffer_load_dwordx4 v2, s[8:11], s39 offen offset:3072 sc1 lds
s_add_u32 m0, s38, 16384
s_add_u32 s39, s37, 16384
buffer_load_dwordx4 v2, s[8:11], s39 offen offset:0 sc1 lds
buffer_load_dwordx4 v2, s[8:11], s39 offen offset:1024 sc1 lds
buffer_load_dwordx4 v2, s[8:11], s39 offen offset:2048 sc1 lds
buffer_load_dwordx4 v2, s[8:11], s39 offen offset:3072 sc1 lds
s_add_u32 m0, s38, 20480
s_add_u32 s39, s37, 20480
buffer_load_dwordx4 v2, s[8:11], s39 offen offset:0 sc1 lds
buffer_load_dwordx4 v2, s[8:11], s39 offen offset:1024 sc1 lds
buffer_load_dwordx4 v2, s[8:11], s39 offen offset:2048 sc1 lds
s_mov_b32 s52, 0
L_poll2:
buffer_load_dwordx2 v[14:15], v10, s[8:11], s22 offen sc1
s_add_u32 s52, s52, 1
s_waitcnt vmcnt(0)
v_cmp_ne_u64 vcc, s[68:69], v[14:15]
s_cmp_ge_u32 s52, 1048576
s_cbranch_scc1 L_got2
s_and_b64 exec, exec, vcc
s_cbranch_execnz L_poll2
L_got2:
s_mov_b64 exec, -1
buffer_load_dwordx4 a[0:3], v2, s[8:11], s25 offen offset:0 sc1
buffer_load_dwordx4 a[4:7], v2, s[8:11], s25 offen offset:1024 sc1
buffer_load_dwordx4 a[8:11], v2, s[8:11], s25 offen offset:2048 sc1
buffer_load_dwordx4 a[12:15], v2, s[8:11], s25 offen offset:3072 sc1
s_add_u32 s25, s25, 4096
buffer_load_dwordx4 a[16:19], v2, s[8:11], s25 offen offset:0 sc1
buffer_load_dwordx4 a[20:23], v2, s[8:11], s25 offen offset:1024 sc1
buffer_load_dwordx4 a[24:27], v2, s[8:11], s25 offen offset:2048 sc1
buffer_load_dwordx4 a[28:31], v2, s[8:11], s25 offen offset:3072 sc1
s_add_u32 s25, s25, 4096
buffer_load_dwordx4 a[32:35], v2, s[8:11], s25 offen offset:0 sc1
buffer_load_dwordx4 a[36:39], v2, s[8:11], s25 offen offset:1024 sc1
buffer_load_dwordx4 a[40:43], v2, s[8:11], s25 offen offset:2048 sc1
buffer_load_dwordx4 a[44:47], v2, s[8:11], s25 offen offset:3072 sc1
s_barrier
ds_read_b128 a[216:219], v2 offset:0
ds_read_b128 a[220:223], v2 offset:5120
ds_read_b128 a[224:227], v2 offset:1024
ds_read_b128 a[228:231], v2 offset:6144
ds_read_b128 a[232:235], v2 offset:2048
ds_read_b128 a[236:239], v2 offset:7168
s_mul_i32 s22, s4, 6144
s_mul_i32 s23, s41, 497664
s_add_u32 s23, s23, s22
s_add_u32 s23, s23, 7012352
v_add_u32 v3, s23, v2
s_waitcnt vmcnt(10)
s_waitcnt lgkmcnt(4)
v_mfma_f32_16x16x32_bf16 v[32:35], a[216:219], a[0:3], 0
ds_read_b128 a[240:243], v2 offset:3072
v_mfma_f32_16x16x32_bf16 v[32:35], a[220:223], a[4:7], v[32:35]
ds_read_b128 a[244:247], v2 offset:8192
s_add_u32 s25, s25, 4096
buffer_load_dwordx4 a[48:51], v2, s[8:11], s25 offen offset:0 sc1
s_waitcnt lgkmcnt(4)
v_mfma_f32_16x16x32_bf16 v[36:39], a[224:227], a[0:3], 0
ds_read_b128 a[216:219], v2 offset:4096
v_mfma_f32_16x16x32_bf16 v[36:39], a[228:231], a[4:7], v[36:39]
ds_read_b128 a[220:223], v2 offset:9216
s_waitcnt lgkmcnt(4)
v_mfma_f32_16x16x32_bf16 v[40:43], a[232:235], a[0:3], 0
ds_read_b128 a[224:227], v2 offset:10240
v_mfma_f32_16x16x32_bf16 v[40:43], a[236:239], a[4:7], v[40:43]
ds_read_b128 a[228:231], v2 offset:15360
buffer_load_dwordx4 a[52:55], v2, s[8:11], s25 offen offset:1024 sc1
s_waitcnt lgkmcnt(4)
v_mfma_f32_16x16x32_bf16 v[44:47], a[240:243], a[0:3], 0
ds_read_b128 a[232:235], v2 offset:11264
v_mfma_f32_16x16x32_bf16 v[44:47], a[244:247], a[4:7], v[44:47]
ds_read_b128 a[236:239], v2 offset:16384
s_waitcnt lgkmcnt(4)
v_mfma_f32_16x16x32_bf16 v[48:51], a[216:219], a[0:3], 0
ds_read_b128 a[240:243], v2 offset:12288
v_mfma_f32_16x16x32_bf16 v[48:51], a[220:223], a[4:7], v[48:51]
ds_read_b128 a[244:247], v2 offset:17408
buffer_load_dwordx4 a[56:59], v2, s[8:11], s25 offen offset:2048 sc1
s_waitcnt vmcnt(11)
s_waitcnt lgkmcnt(4)
v_mfma_f32_16x16x32_bf16 v[32:35], a[224:227], a[8:11], v[32:35]
ds_read_b128 a[216:219], v2 offset:13312
v_mfma_f32_16x16x32_bf16 v[32:35], a[228:231], a[12:15], v[32:35]
ds_read_b128 a[220:223], v2 offset:18432
s_waitcnt lgkmcnt(4)
v_mfma_f32_16x16x32_bf16 v[36:39], a[232:235], a[8:11], v[36:39]
ds_read_b128 a[224:227], v2 offset:14336
v_mfma_f32_16x16x32_bf16 v[36:39], a[236:239], a[12:15], v[36:39]
ds_read_b128 a[228:231], v2 offset:19456
buffer_load_dwordx4 a[60:63], v2, s[8:11], s25 offen offset:3072 sc1
s_waitcnt lgkmcnt(4)
v_mfma_f32_16x16x32_bf16 v[40:43], a[240:243], a[8:11], v[40:43]
ds_read_b128 a[232:235], v2 offset:20480
v_mfma_f32_16x16x32_bf16 v[40:43], a[244:247], a[12:15], v[40:43]
ds_read_b128 a[236:239], v2 offset:25600
s_waitcnt lgkmcnt(4)
v_mfma_f32_16x16x32_bf16 v[44:47], a[216:219], a[8:11], v[44:47]
ds_read_b128 a[240:243], v2 offset:21504
v_mfma_f32_16x16x32_bf16 v[44:47], a[220:223], a[12:15], v[44:47]
ds_read_b128 a[244:247], v2 offset:26624
s_add_u32 s25, s25, 4096
buffer_load_dwordx2 a[64:65], v11, s[8:11], s25 offen offset:0 sc1
buffer_load_dwordx2 a[66:67], v11, s[8:11], s25 offen offset:128 sc1
s_waitcnt lgkmcnt(4)
v_mfma_f32_16x16x32_bf16 v[48:51], a[224:227], a[8:11], v[48:51]
ds_read_b128 a[216:219], v2 offset:22528
v_mfma_f32_16x16x32_bf16 v[48:51], a[228:231], a[12:15], v[48:51]
ds_read_b128 a[220:223], v2 offset:27648
s_waitcnt vmcnt(12)
s_waitcnt lgkmcnt(4)
v_mfma_f32_16x16x32_bf16 v[32:35], a[232:235], a[16:19], v[32:35]
ds_read_b128 a[224:227], v2 offset:23552
v_mfma_f32_16x16x32_bf16 v[32:35], a[236:239], a[20:23], v[32:35]
ds_read_b128 a[228:231], v2 offset:28672
buffer_load_dwordx2 a[68:69], v11, s[8:11], s25 offen offset:1024 sc1
buffer_load_dwordx2 a[70:71], v11, s[8:11], s25 offen offset:1152 sc1
s_waitcnt lgkmcnt(4)
v_mfma_f32_16x16x32_bf16 v[36:39], a[240:243], a[16:19], v[36:39]
ds_read_b128 a[232:235], v2 offset:24576
v_mfma_f32_16x16x32_bf16 v[36:39], a[244:247], a[20:23], v[36:39]
ds_read_b128 a[236:239], v2 offset:29696
s_waitcnt lgkmcnt(4)
v_mfma_f32_16x16x32_bf16 v[40:43], a[216:219], a[16:19], v[40:43]
ds_read_b128 a[240:243], v2 offset:30720
v_mfma_f32_16x16x32_bf16 v[40:43], a[220:223], a[20:23], v[40:43]
ds_read_b128 a[244:247], v2 offset:35840
buffer_load_dwordx4 v[56:59], v2, s[8:11], s27 offen sc1
s_waitcnt lgkmcnt(4)
v_mfma_f32_16x16x32_bf16 v[44:47], a[224:227], a[16:19], v[44:47]
ds_read_b128 a[216:219], v2 offset:31744
v_mfma_f32_16x16x32_bf16 v[44:47], a[228:231], a[20:23], v[44:47]
ds_read_b128 a[220:223], v2 offset:36864
s_waitcnt lgkmcnt(4)
v_mfma_f32_16x16x32_bf16 v[48:51], a[232:235], a[16:19], v[48:51]
ds_read_b128 a[224:227], v2 offset:32768
v_mfma_f32_16x16x32_bf16 v[48:51], a[236:239], a[20:23], v[48:51]
ds_read_b128 a[228:231], v2 offset:37888
buffer_load_dwordx4 v[60:63], v2, s[8:11], s27 offen offset:1024 sc1
s_waitcnt vmcnt(14)
s_waitcnt lgkmcnt(4)
v_mfma_f32_16x16x32_bf16 v[32:35], a[240:243], a[24:27], v[32:35]
ds_read_b128 a[232:235], v2 offset:33792
v_mfma_f32_16x16x32_bf16 v[32:35], a[244:247], a[28:31], v[32:35]
ds_read_b128 a[236:239], v2 offset:38912
s_waitcnt lgkmcnt(4)
v_mfma_f32_16x16x32_bf16 v[36:39], a[216:219], a[24:27], v[36:39]
ds_read_b128 a[240:243], v2 offset:34816
v_mfma_f32_16x16x32_bf16 v[36:39], a[220:223], a[28:31], v[36:39]
ds_read_b128 a[244:247], v2 offset:39936
buffer_load_dwordx2 v[64:65], v4, s[8:11], s27 offen sc1
s_waitcnt lgkmcnt(4)
v_mfma_f32_16x16x32_bf16 v[40:43], a[224:227], a[24:27], v[40:43]
ds_read_b128 a[216:219], v2 offset:40960
v_mfma_f32_16x16x32_bf16 v[40:43], a[228:231], a[28:31], v[40:43]
ds_read_b128 a[220:223], v2 offset:46080
s_waitcnt lgkmcnt(4)
v_mfma_f32_16x16x32_bf16 v[44:47], a[232:235], a[24:27], v[44:47]
ds_read_b128 a[224:227], v2 offset:41984
v_mfma_f32_16x16x32_bf16 v[44:47], a[236:239], a[28:31], v[44:47]
ds_read_b128 a[228:231], v2 offset:47104
s_add_u32 m0, s22, 98304
s_nop 0
buffer_load_dwordx4 v3, s[8:11], 0 offen offset:0 sc1 lds
s_waitcnt lgkmcnt(4)
v_mfma_f32_16x16x32_bf16 v[48:51], a[240:243], a[24:27], v[48:51]
ds_read_b128 a[232:235], v2 offset:43008
v_mfma_f32_16x16x32_bf16 v[48:51], a[244:247], a[28:31], v[48:51]
ds_read_b128 a[236:239], v2 offset:48128
s_waitcnt vmcnt(14)
s_waitcnt lgkmcnt(4)
v_mfma_f32_16x16x32_bf16 v[32:35], a[216:219], a[32:35], v[32:35]
ds_read_b128 a[240:243], v2 offset:44032
v_mfma_f32_16x16x32_bf16 v[32:35], a[220:223], a[36:39], v[32:35]
ds_read_b128 a[244:247], v2 offset:49152
buffer_load_dwordx4 v3, s[8:11], 0 offen offset:1024 sc1 lds
s_waitcnt lgkmcnt(4)
v_mfma_f32_16x16x32_bf16 v[36:39], a[224:227], a[32:35], v[36:39]
ds_read_b128 a[216:219], v2 offset:45056
v_mfma_f32_16x16x32_bf16 v[36:39], a[228:231], a[36:39], v[36:39]
ds_read_b128 a[220:223], v2 offset:50176
s_waitcnt lgkmcnt(4)
v_mfma_f32_16x16x32_bf16 v[40:43], a[232:235], a[32:35], v[40:43]
ds_read_b128 a[224:227], v2 offset:51200
v_mfma_f32_16x16x32_bf16 v[40:43], a[236:239], a[36:39], v[40:43]
ds_read_b128 a[228:231], v2 offset:56320
buffer_load_dwordx4 v3, s[8:11], 0 offen offset:2048 sc1 lds
s_waitcnt lgkmcnt(4)
v_mfma_f32_16x16x32_bf16 v[44:47], a[240:243], a[32:35], v[44:47]
ds_read_b128 a[232:235], v2 offset:52224
v_mfma_f32_16x16x32_bf16 v[44:47], a[244:247], a[36:39], v[44:47]
ds_read_b128 a[236:239], v2 offset:57344
s_waitcnt lgkmcnt(4)
v_mfma_f32_16x16x32_bf16 v[48:51], a[216:219], a[32:35], v[48:51]
ds_read_b128 a[240:243], v2 offset:53248
v_mfma_f32_16x16x32_bf16 v[48:51], a[220:223], a[36:39], v[48:51]
ds_read_b128 a[244:247], v2 offset:58368
buffer_load_dwordx4 v3, s[8:11], 0 offen offset:3072 sc1 lds
s_waitcnt vmcnt(15)
s_waitcnt lgkmcnt(4)
v_mfma_f32_16x16x32_bf16 v[32:35], a[224:227], a[40:43], v[32:35]
ds_read_b128 a[216:219], v2 offset:54272
v_mfma_f32_16x16x32_bf16 v[32:35], a[228:231], a[44:47], v[32:35]
ds_read_b128 a[220:223], v2 offset:59392
s_waitcnt lgkmcnt(4)
v_mfma_f32_16x16x32_bf16 v[36:39], a[232:235], a[40:43], v[36:39]
ds_read_b128 a[224:227], v2 offset:55296
v_mfma_f32_16x16x32_bf16 v[36:39], a[236:239], a[44:47], v[36:39]
ds_read_b128 a[228:231], v2 offset:60416
s_add_u32 m0, s22, 102400
v_add_u32 v3, 4096, v3
buffer_load_dwordx4 v3, s[8:11], 0 offen offset:0 sc1 lds
s_waitcnt lgkmcnt(4)
v_mfma_f32_16x16x32_bf16 v[40:43], a[240:243], a[40:43], v[40:43]
ds_read_b128 a[232:235], v2 offset:61440
v_mfma_f32_16x16x32_bf16 v[40:43], a[244:247], a[44:47], v[40:43]
ds_read_b128 a[236:239], v5 offset:1024
s_waitcnt lgkmcnt(4)
v_mfma_f32_16x16x32_bf16 v[44:47], a[216:219], a[40:43], v[44:47]
ds_read_b128 a[240:243], v2 offset:62464
v_mfma_f32_16x16x32_bf16 v[44:47], a[220:223], a[44:47], v[44:47]
ds_read_b128 a[244:247], v5 offset:2048
buffer_load_dwordx4 v3, s[8:11], 0 offen offset:1024 sc1 lds
s_waitcnt lgkmcnt(4)
v_mfma_f32_16x16x32_bf16 v[48:51], a[224:227], a[40:43], v[48:51]
ds_read_b128 a[216:219], v2 offset:63488
v_mfma_f32_16x16x32_bf16 v[48:51], a[228:231], a[44:47], v[48:51]
ds_read_b128 a[220:223], v5 offset:3072
s_waitcnt vmcnt(15)
s_waitcnt lgkmcnt(4)
v_mfma_f32_16x16x32_bf16 v[32:35], a[232:235], a[48:51], v[32:35]
ds_read_b128 a[224:227], v2 offset:64512
v_mfma_f32_16x16x32_bf16 v[32:35], a[236:239], a[52:55], v[32:35]
ds_read_b128 a[228:231], v5 offset:4096
s_add_u32 m0, s22, 122880
v_add_u32 v3, 20480, v3
buffer_load_dwordx4 v3, s[8:11], 0 offen offset:0 sc1 lds
s_waitcnt lgkmcnt(4)
v_mfma_f32_16x16x32_bf16 v[36:39], a[240:243], a[48:51], v[36:39]
ds_read_b128 a[232:235], v5 offset:0
v_mfma_f32_16x16x32_bf16 v[36:39], a[244:247], a[52:55], v[36:39]
ds_read_b128 a[236:239], v5 offset:5120
s_waitcnt lgkmcnt(4)
v_mfma_f32_16x16x32_bf16 v[40:43], a[216:219], a[48:51], v[40:43]
ds_read_b128 a[240:243], v5 offset:6144
v_mfma_f32_16x16x32_bf16 v[40:43], a[220:223], a[52:55], v[40:43]
ds_read_b128 a[244:247], v5 offset:11264
buffer_load_dwordx4 v3, s[8:11], 0 offen offset:1024 sc1 lds
s_waitcnt lgkmcnt(4)
v_mfma_f32_16x16x32_bf16 v[44:47], a[224:227], a[48:51], v[44:47]
ds_read_b128 a[216:219], v5 offset:7168
v_mfma_f32_16x16x32_bf16 v[44:47], a[228:231], a[52:55], v[44:47]
ds_read_b128 a[220:223], v5 offset:12288
s_waitcnt lgkmcnt(4)
v_mfma_f32_16x16x32_bf16 v[48:51], a[232:235], a[48:51], v[48:51]
ds_read_b128 a[224:227], v5 offset:8192
v_mfma_f32_16x16x32_bf16 v[48:51], a[236:239], a[52:55], v[48:51]
ds_read_b128 a[228:231], v5 offset:13312
buffer_load_dwordx4 v3, s[8:11], 0 offen offset:2048 sc1 lds
s_waitcnt vmcnt(16)
s_waitcnt lgkmcnt(4)
v_mfma_f32_16x16x32_bf16 v[32:35], a[240:243], a[56:59], v[32:35]
ds_read_b128 a[232:235], v5 offset:9216
v_mfma_f32_16x16x32_bf16 v[32:35], a[244:247], a[60:63], v[32:35]
ds_read_b128 a[236:239], v5 offset:14336
s_waitcnt lgkmcnt(4)
v_mfma_f32_16x16x32_bf16 v[36:39], a[216:219], a[56:59], v[36:39]
ds_read_b128 a[240:243], v5 offset:10240
v_mfma_f32_16x16x32_bf16 v[36:39], a[220:223], a[60:63], v[36:39]
ds_read_b128 a[244:247], v5 offset:15360
buffer_load_dwordx4 v3, s[8:11], 0 offen offset:3072 sc1 lds
s_waitcnt lgkmcnt(4)
v_mfma_f32_16x16x32_bf16 v[40:43], a[224:227], a[56:59], v[40:43]
ds_read_b128 a[216:219], v5 offset:16384
v_mfma_f32_16x16x32_bf16 v[40:43], a[228:231], a[60:63], v[40:43]
ds_read_b128 a[220:223], v5 offset:21504
s_waitcnt lgkmcnt(4)
v_mfma_f32_16x16x32_bf16 v[44:47], a[232:235], a[56:59], v[44:47]
ds_read_b128 a[224:227], v5 offset:17408
v_mfma_f32_16x16x32_bf16 v[44:47], a[236:239], a[60:63], v[44:47]
ds_read_b128 a[228:231], v5 offset:22528
s_add_u32 m0, s22, 126976
v_add_u32 v3, 4096, v3
buffer_load_dwordx4 v3, s[8:11], 0 offen offset:0 sc1 lds
s_waitcnt lgkmcnt(4)
v_mfma_f32_16x16x32_bf16 v[48:51], a[240:243], a[56:59], v[48:51]
ds_read_b128 a[232:235], v5 offset:18432
v_mfma_f32_16x16x32_bf16 v[48:51], a[244:247], a[60:63], v[48:51]
ds_read_b128 a[236:239], v5 offset:23552
s_waitcnt vmcnt(14)
s_waitcnt lgkmcnt(4)
v_mfma_f32_16x16x32_bf16 v[32:35], a[216:219], a[64:67], v[32:35]
ds_read_b128 a[240:243], v5 offset:19456
v_mfma_f32_16x16x32_bf16 v[32:35], a[220:223], a[68:71], v[32:35]
ds_read_b128 a[244:247], v5 offset:24576
buffer_load_dwordx4 v3, s[8:11], 0 offen offset:1024 sc1 lds
s_waitcnt lgkmcnt(4)
v_mfma_f32_16x16x32_bf16 v[36:39], a[224:227], a[64:67], v[36:39]
ds_read_b128 a[216:219], v5 offset:20480
v_mfma_f32_16x16x32_bf16 v[36:39], a[228:231], a[68:71], v[36:39]
ds_read_b128 a[220:223], v5 offset:25600
s_waitcnt lgkmcnt(4)
v_mfma_f32_16x16x32_bf16 v[40:43], a[232:235], a[64:67], v[40:43]
v_mfma_f32_16x16x32_bf16 v[40:43], a[236:239], a[68:71], v[40:43]
s_waitcnt lgkmcnt(2)
v_mfma_f32_16x16x32_bf16 v[44:47], a[240:243], a[64:67], v[44:47]
v_mfma_f32_16x16x32_bf16 v[44:47], a[244:247], a[68:71], v[44:47]
s_waitcnt lgkmcnt(0)
v_mfma_f32_16x16x32_bf16 v[48:51], a[216:219], a[64:67], v[48:51]
v_mfma_f32_16x16x32_bf16 v[48:51], a[220:223], a[68:71], v[48:51]
s_waitcnt vmcnt(12)
v_lshlrev_b32 v68, 16, v56
v_and_b32 v69, 0xffff0000, v56
v_add_f32 v32, v32, v68
v_add_f32 v33, v33, v69
v_lshlrev_b32 v70, 16, v57
v_and_b32 v71, 0xffff0000, v57
v_add_f32 v34, v34, v70
v_add_f32 v35, v35, v71
v_lshlrev_b32 v72, 16, v58
v_and_b32 v73, 0xffff0000, v58
v_add_f32 v36, v36, v72
v_add_f32 v37, v37, v73
v_lshlrev_b32 v74, 16, v59
v_and_b32 v75, 0xffff0000, v59
v_add_f32 v38, v38, v74
v_add_f32 v39, v39, v75
v_lshlrev_b32 v68, 16, v60
v_and_b32 v69, 0xffff0000, v60
v_add_f32 v40, v40, v68
v_add_f32 v41, v41, v69
v_lshlrev_b32 v70, 16, v61
v_and_b32 v71, 0xffff0000, v61
v_add_f32 v42, v42, v70
v_add_f32 v43, v43, v71
v_lshlrev_b32 v72, 16, v62
v_and_b32 v73, 0xffff0000, v62
v_add_f32 v44, v44, v72
v_add_f32 v45, v45, v73
v_lshlrev_b32 v74, 16, v63
v_and_b32 v75, 0xffff0000, v63
v_add_f32 v46, v46, v74
v_add_f32 v47, v47, v75
v_lshlrev_b32 v68, 16, v64
v_and_b32 v69, 0xffff0000, v64
v_add_f32 v48, v48, v68
v_add_f32 v49, v49, v69
v_lshlrev_b32 v70, 16, v65
v_and_b32 v71, 0xffff0000, v65
v_add_f32 v50, v50, v70
v_add_f32 v51, v51, v71
v_cvt_pk_bf16_f32 v80, v32, v33
v_cvt_pk_bf16_f32 v81, v34, v35
v_cvt_pk_bf16_f32 v82, v36, v37
v_cvt_pk_bf16_f32 v83, v38, v39
v_cvt_pk_bf16_f32 v84, v40, v41
v_cvt_pk_bf16_f32 v85, v42, v43
v_cvt_pk_bf16_f32 v86, v44, v45
v_cvt_pk_bf16_f32 v87, v46, v47
v_cvt_pk_bf16_f32 v88, v48, v49
v_cvt_pk_bf16_f32 v89, v50, v51
s_add_u32 s27, s26, s73
buffer_store_dwordx4 v[80:83], v2, s[8:11], s27 offen sc1
buffer_store_dwordx4 v[84:87], v2, s[8:11], s27 offen offset:1024 sc1
buffer_store_dwordx2 v[88:89], v4, s[8:11], s27 offen sc1
v_add_f32 v10, v32, v33
v_mul_f32 v11, v32, v32
v_mul_f32 v13, v33, v33
v_mov_b32 v12, 0
v_add_f32 v10, v10, v34
v_add_f32 v12, v12, v35
v_fmac_f32 v11, v34, v34
v_fmac_f32 v13, v35, v35
v_add_f32 v10, v10, v36
v_add_f32 v12, v12, v37
v_fmac_f32 v11, v36, v36
v_fmac_f32 v13, v37, v37
v_add_f32 v10, v10, v38
v_add_f32 v12, v12, v39
v_fmac_f32 v11, v38, v38
v_fmac_f32 v13, v39, v39
v_add_f32 v10, v10, v40
v_add_f32 v12, v12, v41
v_fmac_f32 v11, v40, v40
v_fmac_f32 v13, v41, v41
v_add_f32 v10, v10, v42
v_add_f32 v12, v12, v43
v_fmac_f32 v11, v42, v42
v_fmac_f32 v13, v43, v43
v_add_f32 v10, v10, v44
v_add_f32 v12, v12, v45
v_fmac_f32 v11, v44, v44
v_fmac_f32 v13, v45, v45
v_add_f32 v10, v10, v46
v_add_f32 v12, v12, v47
v_fmac_f32 v11, v46, v46
v_fmac_f32 v13, v47, v47
v_add_f32 v10, v10, v48
v_add_f32 v12, v12, v49
v_fmac_f32 v11, v48, v48
v_fmac_f32 v13, v49, v49
v_add_f32 v10, v10, v50
v_add_f32 v12, v12, v51
v_fmac_f32 v11, v50, v50
v_fmac_f32 v13, v51, v51
v_add_f32 v10, v10, v12
v_add_f32 v11, v11, v13
v_mov_b32 v12, v10
v_mov_b32 v13, v11
s_nop 0
v_permlane16_swap_b32 v10, v12
v_permlane16_swap_b32 v11, v13
v_add_f32 v10, v10, v12
v_add_f32 v11, v11, v13
v_mov_b32 v12, v10
v_mov_b32 v13, v11
s_nop 0
v_permlane32_swap_b32 v10, v12
v_permlane32_swap_b32 v11, v13
v_add_f32 v10, v10, v12
v_add_f32 v11, v11, v13
v_lshlrev_b32 v8, 3, v6
v_cmp_gt_u32 vcc, 16, v1
s_nop 1
v_cndmask_b32 v8, v9, v8, vcc
s_lshl_b32 s27, s20, 10
s_lshl_b32 s28, s21, 7
s_add_u32 s27, s27, s28
s_add_u32 s27, s27, s74
buffer_store_dwordx2 v[10:11], v8, s[8:11], s27 offen sc1
s_lshr_b32 s27, s20, 2
s_lshl_b32 s27, s27, 3
s_add_u32 s27, s27, s21
s_lshl_b32 s14, s27, 7
s_add_u32 s14, s14, 524288
s_add_u32 s14, s14, s77
s_lshl_b32 s44, s40, 4
s_lshl_b32 s45, s4, 2
s_add_u32 s44, s44, s45
s_mul_i32 s46, s44, 18432
s_add_u32 s20, s46, s73
v_add_u32 v4, 18432, v2
v_add_u32 v5, 36864, v2
v_add_u32 v6, 55296, v2
v_lshlrev_b32 v248, 3, v1
v_add_u32 v249, 18432, v248
v_add_u32 v250, 36864, v248
v_add_u32 v251, 55296, v248
v_and_b32 v13, 15, v1
v_lshrrev_b32 v14, 4, v1
v_add_u32 v7, 0x10000, v2
v_add_u32 v8, 0x20000, v2
v_and_b32 v9, 1, v14
v_mul_u32_u24 v9, 18432, v9
v_lshrrev_b32 v15, 1, v14
v_lshlrev_b32 v15, 8, v15
v_lshl_add_u32 v15, v13, 4, v15
v_add_u32 v9, v9, v15
v_and_b32 v11, 3, v1
v_lshlrev_b32 v11, 7, v11
s_lshl_b32 s49, s43, 7
v_mov_b32 v10, 2146435072
v_lshl_add_u32 v15, v1, 3, s49
v_cmp_gt_u32 vcc, 16, v1
s_nop 1
v_cndmask_b32 v10, v10, v15, vcc
s_lshl_b32 s49, s40, 3
s_add_u32 s49, s49, s42
s_lshl_b32 s50, s49, 2
s_add_u32 s50, s50, s4
s_lshl_b32 s50, s50, 9
s_add_u32 s34, s50, s77
s_add_u32 s34, s34, 0
s_lshl_b32 s49, s49, 4
s_add_u32 s49, s49, s45
s_mul_i32 s49, s49, 18432
s_add_u32 s49, s49, s75
s_add_u32 s50, s43, 0
s_and_b32 s50, s50, 3
s_mul_i32 s50, s50, 9
s_add_u32 s50, s50, 1
s_lshr_b32 s50, s50, 1
s_lshl_b32 s50, s50, 10
s_add_u32 s24, s49, s50
s_add_u32 s50, s43, 1
s_and_b32 s50, s50, 3
s_mul_i32 s50, s50, 9
s_add_u32 s50, s50, 1
s_lshr_b32 s50, s50, 1
s_lshl_b32 s50, s50, 10
s_add_u32 s25, s49, s50
s_add_u32 s50, s43, 2
s_and_b32 s50, s50, 3
s_mul_i32 s50, s50, 9
s_add_u32 s50, s50, 1
s_lshr_b32 s50, s50, 1
s_lshl_b32 s50, s50, 10
s_add_u32 s26, s49, s50
s_add_u32 s50, s43, 3
s_and_b32 s50, s50, 3
s_mul_i32 s50, s50, 9
s_add_u32 s50, s50, 1
s_lshr_b32 s50, s50, 1
s_lshl_b32 s50, s50, 10
s_add_u32 s27, s49, s50
s_add_u32 s28, s49, 4096
s_add_u32 s29, s49, 13312
s_cmp_ge_u32 s43, 2
s_cselect_b32 s50, s29, s28
s_and_b32 s51, s43, 1
s_lshl_b32 s51, s51, 9
s_add_u32 s30, s50, s51
s_mul_i32 s50, s42, 2359296
s_add_u32 s50, s50, s46
s_add_u32 s50, s50, s76
s_lshl_b32 s51, s43, 12
s_add_u32 s31, s50, s51
s_lshl_b32 s51, s43, 9
s_add_u32 s50, s50, s51
s_add_u32 s32, s50, 16384
s_add_u32 s33, s32, 36864
s_add_u32 s36, s31, 0
s_add_u32 s37, s31, 18432
s_add_u32 s38, s31, 36864
s_add_u32 s39, s31, 55296
v_lshlrev_b32 v252, 4, v13
v_lshl_add_u32 v252, v14, 9, v252
s_lshl_b32 s35, s40, 5
s_add_u32 s35, s35, s41
s_lshl_b32 s35, s35, 7
s_add_u32 s35, s35, s77
s_add_u32 s35, s35, 655360
v_lshlrev_b32 v17, 3, v13
v_lshl_add_u32 v17, v14, 8, v17
s_lshl_b32 s47, s44, 10
s_add_u32 s47, s47, s74
s_lshl_b32 s49, s44, 8
s_add_u32 s49, s49, s77
s_add_u32 s49, s49, 524288
v_and_b32 v16, 7, v1
v_lshlrev_b32 v16, 7, v16
v_mov_b32 v13, 2146435072
v_cmp_gt_u32 vcc, 16, v0
v_lshlrev_b32 v14, 3, v0
s_nop 0
v_cndmask_b32 v13, v13, v14, vcc
v_mov_b32 v14, s68
v_mov_b32 v15, s69
s_waitcnt vmcnt(0)
s_barrier
buffer_store_dwordx2 v[14:15], v13, s[8:11], s14 offen sc1
s_add_u32 m0, s22, 0
v_add_u32 v3, 20480, v3
buffer_load_dwordx4 v3, s[8:11], 0 offen offset:0 sc1 lds
buffer_load_dwordx4 v3, s[8:11], 0 offen offset:1024 sc1 lds
buffer_load_dwordx4 v3, s[8:11], 0 offen offset:2048 sc1 lds
buffer_load_dwordx4 v3, s[8:11], 0 offen offset:3072 sc1 lds
s_add_u32 m0, s22, 4096
v_add_u32 v3, 4096, v3
buffer_load_dwordx4 v3, s[8:11], 0 offen offset:0 sc1 lds
buffer_load_dwordx4 v3, s[8:11], 0 offen offset:1024 sc1 lds
s_add_u32 m0, s22, 24576
v_add_u32 v3, 20480, v3
buffer_load_dwordx4 v3, s[8:11], 0 offen offset:0 sc1 lds
buffer_load_dwordx4 v3, s[8:11], 0 offen offset:1024 sc1 lds
buffer_load_dwordx4 v3, s[8:11], 0 offen offset:2048 sc1 lds
buffer_load_dwordx4 v3, s[8:11], 0 offen offset:3072 sc1 lds
s_add_u32 m0, s22, 28672
v_add_u32 v3, 4096, v3
buffer_load_dwordx4 v3, s[8:11], 0 offen offset:0 sc1 lds
buffer_load_dwordx4 v3, s[8:11], 0 offen offset:1024 sc1 lds
ds_read_b128 v[48:51], v7 offset:32768
ds_read_b128 v[52:55], v7 offset:33792
ds_read_b128 v[56:59], v7 offset:34816
ds_read_b128 v[60:63], v7 offset:35840
ds_read_b128 v[64:67], v7 offset:36864
ds_read_b128 v[68:71], v7 offset:37888
s_mov_b32 s52, 0
L_poll3:
buffer_load_dwordx2 v[14:15], v16, s[8:11], s49 offen sc1
s_add_u32 s52, s52, 1
s_waitcnt vmcnt(0)
v_cmp_ne_u64 vcc, s[68:69], v[14:15]
s_cmp_ge_u32 s52, 1048576
s_cbranch_scc1 L_got3
s_and_b64 exec, exec, vcc
s_cbranch_execnz L_poll3
L_got3:
s_mov_b64 exec, -1
s_add_u32 s48, s20, 0
buffer_load_dwordx4 a[0:3], v2, s[8:11], s48 offen offset:0 sc1
buffer_load_dwordx4 a[4:7], v4, s[8:11], s48 offen offset:0 sc1
buffer_load_dwordx4 a[8:11], v5, s[8:11], s48 offen offset:0 sc1
buffer_load_dwordx4 a[12:15], v6, s[8:11], s48 offen offset:0 sc1
buffer_load_dwordx4 a[16:19], v2, s[8:11], s48 offen offset:1024 sc1
buffer_load_dwordx4 a[20:23], v4, s[8:11], s48 offen offset:1024 sc1
buffer_load_dwordx4 a[24:27], v5, s[8:11], s48 offen offset:1024 sc1
buffer_load_dwordx4 a[28:31], v6, s[8:11], s48 offen offset:1024 sc1
buffer_load_dwordx2 v[144:145], v17, s[8:11], s47 offen offset:0 sc1
buffer_load_dwordx2 v[146:147], v17, s[8:11], s47 offen offset:128 sc1
buffer_load_dwordx2 v[148:149], v17, s[8:11], s47 offen offset:1024 sc1
buffer_load_dwordx2 v[150:151], v17, s[8:11], s47 offen offset:1152 sc1
buffer_load_dwordx2 v[152:153], v17, s[8:11], s47 offen offset:2048 sc1
buffer_load_dwordx2 v[154:155], v17, s[8:11], s47 offen offset:2176 sc1
buffer_load_dwordx2 v[156:157], v17, s[8:11], s47 offen offset:3072 sc1
buffer_load_dwordx2 v[158:159], v17, s[8:11], s47 offen offset:3200 sc1
buffer_load_dwordx4 a[32:35], v2, s[8:11], s48 offen offset:2048 sc1
buffer_load_dwordx4 a[36:39], v4, s[8:11], s48 offen offset:2048 sc1
buffer_load_dwordx4 a[40:43], v5, s[8:11], s48 offen offset:2048 sc1
buffer_load_dwordx4 a[44:47], v6, s[8:11], s48 offen offset:2048 sc1
buffer_load_dwordx4 a[48:51], v2, s[8:11], s48 offen offset:3072 sc1
buffer_load_dwordx4 a[52:55], v4, s[8:11], s48 offen offset:3072 sc1
buffer_load_dwordx4 a[56:59], v5, s[8:11], s48 offen offset:3072 sc1
buffer_load_dwordx4 a[60:63], v6, s[8:11], s48 offen offset:3072 sc1
s_add_u32 s48, s20, 4096
buffer_load_dwordx4 a[64:67], v2, s[8:11], s48 offen offset:0 sc1
buffer_load_dwordx4 a[68:71], v4, s[8:11], s48 offen offset:0 sc1
buffer_load_dwordx4 a[72:75], v5, s[8:11], s48 offen offset:0 sc1
buffer_load_dwordx4 a[76:79], v6, s[8:11], s48 offen offset:0 sc1
s_waitcnt vmcnt(20)
s_waitcnt lgkmcnt(4)
v_mfma_f32_16x16x32_bf16 v[80:83], v[48:51], a[0:3], 0
buffer_load_dwordx4 a[80:83], v2, s[8:11], s48 offen offset:1024 sc1
v_mfma_f32_16x16x32_bf16 v[80:83], v[52:55], a[16:19], v[80:83]
v_mfma_f32_16x16x32_bf16 v[84:87], v[48:51], a[4:7], 0
ds_read_b128 v[72:75], v7 offset:38912
v_mfma_f32_16x16x32_bf16 v[84:87], v[52:55], a[20:23], v[84:87]
v_mfma_f32_16x16x32_bf16 v[88:91], v[48:51], a[8:11], 0
buffer_load_dwordx4 a[84:87], v4, s[8:11], s48 offen offset:1024 sc1
v_mfma_f32_16x16x32_bf16 v[88:91], v[52:55], a[24:27], v[88:91]
ds_read_b128 v[76:79], v7 offset:39936
v_mfma_f32_16x16x32_bf16 v[92:95], v[48:51], a[12:15], 0
v_mfma_f32_16x16x32_bf16 v[92:95], v[52:55], a[28:31], v[92:95]
s_waitcnt lgkmcnt(4)
v_mfma_f32_16x16x32_bf16 v[96:99], v[56:59], a[0:3], 0
buffer_load_dwordx4 a[88:91], v5, s[8:11], s48 offen offset:1024 sc1
v_mfma_f32_16x16x32_bf16 v[96:99], v[60:63], a[16:19], v[96:99]
v_mfma_f32_16x16x32_bf16 v[100:103], v[56:59], a[4:7], 0
ds_read_b128 v[48:51], v7 offset:40960
v_mfma_f32_16x16x32_bf16 v[100:103], v[60:63], a[20:23], v[100:103]
v_mfma_f32_16x16x32_bf16 v[104:107], v[56:59], a[8:11], 0
buffer_load_dwordx4 a[92:95], v6, s[8:11], s48 offen offset:1024 sc1
v_mfma_f32_16x16x32_bf16 v[104:107], v[60:63], a[24:27], v[104:107]
ds_read_b128 v[52:55], v7 offset:41984
v_mfma_f32_16x16x32_bf16 v[108:111], v[56:59], a[12:15], 0
v_mfma_f32_16x16x32_bf16 v[108:111], v[60:63], a[28:31], v[108:111]
s_waitcnt lgkmcnt(4)
v_mfma_f32_16x16x32_bf16 v[112:115], v[64:67], a[0:3], 0
buffer_load_dwordx4 a[96:99], v2, s[8:11], s48 offen offset:2048 sc1
v_mfma_f32_16x16x32_bf16 v[112:115], v[68:71], a[16:19], v[112:115]
v_mfma_f32_16x16x32_bf16 v[116:119], v[64:67], a[4:7], 0
ds_read_b128 v[56:59], v7 offset:43008
v_mfma_f32_16x16x32_bf16 v[116:119], v[68:71], a[20:23], v[116:119]
v_mfma_f32_16x16x32_bf16 v[120:123], v[64:67], a[8:11], 0
buffer_load_dwordx4 a[100:103], v4, s[8:11], s48 offen offset:2048 sc1
v_mfma_f32_16x16x32_bf16 v[120:123], v[68:71], a[24:27], v[120:123]
ds_read_b128 v[60:63], v7 offset:44032
v_mfma_f32_16x16x32_bf16 v[124:127], v[64:67], a[12:15], 0
v_mfma_f32_16x16x32_bf16 v[124:127], v[68:71], a[28:31], v[124:127]
s_waitcnt lgkmcnt(4)
v_mfma_f32_16x16x32_bf16 v[128:131], v[72:75], a[0:3], 0
buffer_load_dwordx4 a[104:107], v5, s[8:11], s48 offen offset:2048 sc1
v_mfma_f32_16x16x32_bf16 v[128:131], v[76:79], a[16:19], v[128:131]
v_mfma_f32_16x16x32_bf16 v[132:135], v[72:75], a[4:7], 0
ds_read_b128 v[64:67], v7 offset:45056
v_mfma_f32_16x16x32_bf16 v[132:135], v[76:79], a[20:23], v[132:135]
v_mfma_f32_16x16x32_bf16 v[136:139], v[72:75], a[8:11], 0
buffer_load_dwordx4 a[108:111], v6, s[8:11], s48 offen offset:2048 sc1
v_mfma_f32_16x16x32_bf16 v[136:139], v[76:79], a[24:27], v[136:139]
ds_read_b128 v[68:71], v7 offset:46080
v_mfma_f32_16x16x32_bf16 v[140:143], v[72:75], a[12:15], 0
v_mfma_f32_16x16x32_bf16 v[140:143], v[76:79], a[28:31], v[140:143]
s_waitcnt vmcnt(12)
s_waitcnt lgkmcnt(4)
v_mfma_f32_16x16x32_bf16 v[80:83], v[48:51], a[32:35], v[80:83]
buffer_load_dwordx4 a[112:115], v2, s[8:11], s48 offen offset:3072 sc1
v_mfma_f32_16x16x32_bf16 v[80:83], v[52:55], a[48:51], v[80:83]
v_mfma_f32_16x16x32_bf16 v[84:87], v[48:51], a[36:39], v[84:87]
ds_read_b128 v[72:75], v7 offset:47104
v_mfma_f32_16x16x32_bf16 v[84:87], v[52:55], a[52:55], v[84:87]
v_mfma_f32_16x16x32_bf16 v[88:91], v[48:51], a[40:43], v[88:91]
buffer_load_dwordx4 a[116:119], v4, s[8:11], s48 offen offset:3072 sc1
v_mfma_f32_16x16x32_bf16 v[88:91], v[52:55], a[56:59], v[88:91]
ds_read_b128 v[76:79], v7 offset:48128
v_mfma_f32_16x16x32_bf16 v[92:95], v[48:51], a[44:47], v[92:95]
v_mfma_f32_16x16x32_bf16 v[92:95], v[52:55], a[60:63], v[92:95]
s_waitcnt lgkmcnt(4)
v_mfma_f32_16x16x32_bf16 v[96:99], v[56:59], a[32:35], v[96:99]
buffer_load_dwordx4 a[120:123], v5, s[8:11], s48 offen offset:3072 sc1
v_mfma_f32_16x16x32_bf16 v[96:99], v[60:63], a[48:51], v[96:99]
v_mfma_f32_16x16x32_bf16 v[100:103], v[56:59], a[36:39], v[100:103]
ds_read_b128 v[48:51], v7 offset:49152
v_mfma_f32_16x16x32_bf16 v[100:103], v[60:63], a[52:55], v[100:103]
v_mfma_f32_16x16x32_bf16 v[104:107], v[56:59], a[40:43], v[104:107]
buffer_load_dwordx4 a[124:127], v6, s[8:11], s48 offen offset:3072 sc1
v_mfma_f32_16x16x32_bf16 v[104:107], v[60:63], a[56:59], v[104:107]
ds_read_b128 v[52:55], v7 offset:50176
s_add_u32 s48, s20, 8192
v_mfma_f32_16x16x32_bf16 v[108:111], v[56:59], a[44:47], v[108:111]
v_mfma_f32_16x16x32_bf16 v[108:111], v[60:63], a[60:63], v[108:111]
s_waitcnt lgkmcnt(4)
v_mfma_f32_16x16x32_bf16 v[112:115], v[64:67], a[32:35], v[112:115]
buffer_load_dwordx4 a[128:131], v2, s[8:11], s48 offen offset:0 sc1
v_mfma_f32_16x16x32_bf16 v[112:115], v[68:71], a[48:51], v[112:115]
v_mfma_f32_16x16x32_bf16 v[116:119], v[64:67], a[36:39], v[116:119]
ds_read_b128 v[56:59], v7 offset:51200
v_mfma_f32_16x16x32_bf16 v[116:119], v[68:71], a[52:55], v[116:119]
v_mfma_f32_16x16x32_bf16 v[120:123], v[64:67], a[40:43], v[120:123]
buffer_load_dwordx4 a[132:135], v4, s[8:11], s48 offen offset:0 sc1
v_mfma_f32_16x16x32_bf16 v[120:123], v[68:71], a[56:59], v[120:123]
ds_read_b128 v[60:63], v7 offset:52224
v_mfma_f32_16x16x32_bf16 v[124:127], v[64:67], a[44:47], v[124:127]
v_mfma_f32_16x16x32_bf16 v[124:127], v[68:71], a[60:63], v[124:127]
s_waitcnt lgkmcnt(4)
v_mfma_f32_16x16x32_bf16 v[128:131], v[72:75], a[32:35], v[128:131]
buffer_load_dwordx4 a[136:139], v5, s[8:11], s48 offen offset:0 sc1
v_mfma_f32_16x16x32_bf16 v[128:131], v[76:79], a[48:51], v[128:131]
v_mfma_f32_16x16x32_bf16 v[132:135], v[72:75], a[36:39], v[132:135]
ds_read_b128 v[64:67], v7 offset:53248
v_mfma_f32_16x16x32_bf16 v[132:135], v[76:79], a[52:55], v[132:135]
v_mfma_f32_16x16x32_bf16 v[136:139], v[72:75], a[40:43], v[136:139]
buffer_load_dwordx4 a[140:143], v6, s[8:11], s48 offen offset:0 sc1
v_mfma_f32_16x16x32_bf16 v[136:139], v[76:79], a[56:59], v[136:139]
ds_read_b128 v[68:71], v7 offset:54272
v_mfma_f32_16x16x32_bf16 v[140:143], v[72:75], a[44:47], v[140:143]
v_mfma_f32_16x16x32_bf16 v[140:143], v[76:79], a[60:63], v[140:143]
s_waitcnt vmcnt(12)
s_waitcnt lgkmcnt(4)
v_mfma_f32_16x16x32_bf16 v[80:83], v[48:51], a[64:67], v[80:83]
buffer_load_dwordx4 a[144:147], v2, s[8:11], s48 offen offset:1024 sc1
v_mfma_f32_16x16x32_bf16 v[80:83], v[52:55], a[80:83], v[80:83]
v_mfma_f32_16x16x32_bf16 v[84:87], v[48:51], a[68:71], v[84:87]
ds_read_b128 v[72:75], v7 offset:55296
v_mfma_f32_16x16x32_bf16 v[84:87], v[52:55], a[84:87], v[84:87]
v_add_f32 v144, v144, v146
v_add_f32 v145, v145, v147
v_mfma_f32_16x16x32_bf16 v[88:91], v[48:51], a[72:75], v[88:91]
buffer_load_dwordx4 a[148:151], v4, s[8:11], s48 offen offset:1024 sc1
v_mfma_f32_16x16x32_bf16 v[88:91], v[52:55], a[88:91], v[88:91]
ds_read_b128 v[76:79], v7 offset:56320
v_add_f32 v148, v148, v150
v_mfma_f32_16x16x32_bf16 v[92:95], v[48:51], a[76:79], v[92:95]
v_add_f32 v149, v149, v151
v_add_f32 v152, v152, v154
v_mfma_f32_16x16x32_bf16 v[92:95], v[52:55], a[92:95], v[92:95]
v_add_f32 v153, v153, v155
s_waitcnt lgkmcnt(4)
v_mfma_f32_16x16x32_bf16 v[96:99], v[56:59], a[64:67], v[96:99]
buffer_load_dwordx4 a[152:155], v5, s[8:11], s48 offen offset:1024 sc1
v_mfma_f32_16x16x32_bf16 v[96:99], v[60:63], a[80:83], v[96:99]
s_barrier
v_mfma_f32_16x16x32_bf16 v[100:103], v[56:59], a[68:71], v[100:103]
ds_read_b128 v[48:51], v7 offset:57344
v_add_f32 v156, v156, v158
v_mfma_f32_16x16x32_bf16 v[100:103], v[60:63], a[84:87], v[100:103]
v_add_f32 v157, v157, v159
v_mov_b32 v160, v144
v_mfma_f32_16x16x32_bf16 v[104:107], v[56:59], a[72:75], v[104:107]
buffer_load_dwordx4 a[156:159], v6, s[8:11], s48 offen offset:1024 sc1
v_mfma_f32_16x16x32_bf16 v[104:107], v[60:63], a[88:91], v[104:107]
ds_read_b128 v[52:55], v7 offset:58368
v_mov_b32 v161, v145
v_mfma_f32_16x16x32_bf16 v[108:111], v[56:59], a[76:79], v[108:111]
v_mov_b32 v162, v148
v_mov_b32 v163, v149
v_mfma_f32_16x16x32_bf16 v[108:111], v[60:63], a[92:95], v[108:111]
v_mov_b32 v164, v152
s_waitcnt lgkmcnt(4)
v_mfma_f32_16x16x32_bf16 v[112:115], v[64:67], a[64:67], v[112:115]
buffer_load_dwordx4 a[160:163], v2, s[8:11], s48 offen offset:2048 sc1
v_mfma_f32_16x16x32_bf16 v[112:115], v[68:71], a[80:83], v[112:115]
v_mov_b32 v165, v153
v_mov_b32 v166, v156
v_mfma_f32_16x16x32_bf16 v[116:119], v[64:67], a[68:71], v[116:119]
ds_read_b128 v[56:59], v7 offset:59392
v_mov_b32 v167, v157
v_mfma_f32_16x16x32_bf16 v[116:119], v[68:71], a[84:87], v[116:119]
v_permlane16_swap_b32 v144, v160
v_permlane16_swap_b32 v145, v161
v_mfma_f32_16x16x32_bf16 v[120:123], v[64:67], a[72:75], v[120:123]
buffer_load_dwordx4 a[164:167], v4, s[8:11], s48 offen offset:2048 sc1
v_mfma_f32_16x16x32_bf16 v[120:123], v[68:71], a[88:91], v[120:123]
ds_read_b128 v[60:63], v7 offset:60416
v_permlane16_swap_b32 v148, v162
v_mfma_f32_16x16x32_bf16 v[124:127], v[64:67], a[76:79], v[124:127]
v_permlane16_swap_b32 v149, v163
v_permlane16_swap_b32 v152, v164
v_mfma_f32_16x16x32_bf16 v[124:127], v[68:71], a[92:95], v[124:127]
v_permlane16_swap_b32 v153, v165
s_waitcnt lgkmcnt(4)
v_mfma_f32_16x16x32_bf16 v[128:131], v[72:75], a[64:67], v[128:131]
buffer_load_dwordx4 a[168:171], v5, s[8:11], s48 offen offset:2048 sc1
v_mfma_f32_16x16x32_bf16 v[128:131], v[76:79], a[80:83], v[128:131]
v_permlane16_swap_b32 v156, v166
v_permlane16_swap_b32 v157, v167
v_mfma_f32_16x16x32_bf16 v[132:135], v[72:75], a[68:71], v[132:135]
ds_read_b128 v[64:67], v7 offset:61440
v_add_f32 v144, v144, v160
v_mfma_f32_16x16x32_bf16 v[132:135], v[76:79], a[84:87], v[132:135]
v_add_f32 v145, v145, v161
v_add_f32 v148, v148, v162
v_mfma_f32_16x16x32_bf16 v[136:139], v[72:75], a[72:75], v[136:139]
buffer_load_dwordx4 a[172:175], v6, s[8:11], s48 offen offset:2048 sc1
v_mfma_f32_16x16x32_bf16 v[136:139], v[76:79], a[88:91], v[136:139]
ds_read_b128 v[68:71], v7 offset:62464
v_add_f32 v149, v149, v163
v_mfma_f32_16x16x32_bf16 v[140:143], v[72:75], a[76:79], v[140:143]
v_add_f32 v152, v152, v164
v_add_f32 v153, v153, v165
v_mfma_f32_16x16x32_bf16 v[140:143], v[76:79], a[92:95], v[140:143]
v_add_f32 v156, v156, v166
s_waitcnt vmcnt(12)
s_waitcnt lgkmcnt(4)
v_mfma_f32_16x16x32_bf16 v[80:83], v[48:51], a[96:99], v[80:83]
buffer_load_dwordx4 a[176:179], v2, s[8:11], s48 offen offset:3072 sc1
v_mfma_f32_16x16x32_bf16 v[80:83], v[52:55], a[112:115], v[80:83]
v_add_f32 v157, v157, v167
v_mov_b32 v160, v144
v_mfma_f32_16x16x32_bf16 v[84:87], v[48:51], a[100:103], v[84:87]
ds_read_b128 v[72:75], v7 offset:63488
v_mov_b32 v161, v145
v_mfma_f32_16x16x32_bf16 v[84:87], v[52:55], a[116:119], v[84:87]
v_mov_b32 v162, v148
v_mov_b32 v163, v149
v_mfma_f32_16x16x32_bf16 v[88:91], v[48:51], a[104:107], v[88:91]
buffer_load_dwordx4 a[180:183], v4, s[8:11], s48 offen offset:3072 sc1
v_mfma_f32_16x16x32_bf16 v[88:91], v[52:55], a[120:123], v[88:91]
ds_read_b128 v[76:79], v7 offset:64512
v_mov_b32 v164, v152
v_mfma_f32_16x16x32_bf16 v[92:95], v[48:51], a[108:111], v[92:95]
v_mov_b32 v165, v153
v_mov_b32 v166, v156
v_mfma_f32_16x16x32_bf16 v[92:95], v[52:55], a[124:127], v[92:95]
v_mov_b32 v167, v157
s_waitcnt lgkmcnt(4)
v_mfma_f32_16x16x32_bf16 v[96:99], v[56:59], a[96:99], v[96:99]
buffer_load_dwordx4 a[184:187], v5, s[8:11], s48 offen offset:3072 sc1
v_mfma_f32_16x16x32_bf16 v[96:99], v[60:63], a[112:115], v[96:99]
v_permlane32_swap_b32 v144, v160
v_permlane32_swap_b32 v145, v161
v_mfma_f32_16x16x32_bf16 v[100:103], v[56:59], a[100:103], v[100:103]
ds_read_b128 v[48:51], v8 offset:0
v_permlane32_swap_b32 v148, v162
v_mfma_f32_16x16x32_bf16 v[100:103], v[60:63], a[116:119], v[100:103]
v_permlane32_swap_b32 v149, v163
v_permlane32_swap_b32 v152, v164
v_mfma_f32_16x16x32_bf16 v[104:107], v[56:59], a[104:107], v[104:107]
buffer_load_dwordx4 a[188:191], v6, s[8:11], s48 offen offset:3072 sc1
v_mfma_f32_16x16x32_bf16 v[104:107], v[60:63], a[120:123], v[104:107]
ds_read_b128 v[52:55], v8 offset:1024
s_add_u32 s48, s20, 12288
v_mfma_f32_16x16x32_bf16 v[108:111], v[56:59], a[108:111], v[108:111]
v_permlane32_swap_b32 v153, v165
v_permlane32_swap_b32 v156, v166
v_mfma_f32_16x16x32_bf16 v[108:111], v[60:63], a[124:127], v[108:111]
v_permlane32_swap_b32 v157, v167
s_waitcnt lgkmcnt(4)
v_mfma_f32_16x16x32_bf16 v[112:115], v[64:67], a[96:99], v[112:115]
buffer_load_dwordx4 a[192:195], v2, s[8:11], s48 offen offset:0 sc1
v_mfma_f32_16x16x32_bf16 v[112:115], v[68:71], a[112:115], v[112:115]
v_add_f32 v144, v144, v160
v_add_f32 v145, v145, v161
v_mfma_f32_16x16x32_bf16 v[116:119], v[64:67], a[100:103], v[116:119]
ds_read_b128 v[56:59], v8 offset:2048
v_add_f32 v148, v148, v162
v_mfma_f32_16x16x32_bf16 v[116:119], v[68:71], a[116:119], v[116:119]
v_add_f32 v149, v149, v163
v_add_f32 v152, v152, v164
v_mfma_f32_16x16x32_bf16 v[120:123], v[64:67], a[104:107], v[120:123]
buffer_load_dwordx4 a[196:199], v4, s[8:11], s48 offen offset:0 sc1
v_mfma_f32_16x16x32_bf16 v[120:123], v[68:71], a[120:123], v[120:123]
ds_read_b128 v[60:63], v8 offset:3072
v_add_f32 v153, v153, v165
v_mfma_f32_16x16x32_bf16 v[124:127], v[64:67], a[108:111], v[124:127]
v_add_f32 v156, v156, v166
v_add_f32 v157, v157, v167
v_mfma_f32_16x16x32_bf16 v[124:127], v[68:71], a[124:127], v[124:127]
v_mul_f32 v144, 0x3ae38e39, v144
s_waitcnt lgkmcnt(4)
v_mfma_f32_16x16x32_bf16 v[128:131], v[72:75], a[96:99], v[128:131]
buffer_load_dwordx4 a[200:203], v5, s[8:11], s48 offen offset:0 sc1
v_mfma_f32_16x16x32_bf16 v[128:131], v[76:79], a[112:115], v[128:131]
v_mul_f32 v148, 0x3ae38e39, v148
v_mul_f32 v152, 0x3ae38e39, v152
v_mfma_f32_16x16x32_bf16 v[132:135], v[72:75], a[100:103], v[132:135]
ds_read_b128 v[64:67], v8 offset:4096
v_mul_f32 v156, 0x3ae38e39, v156
v_mfma_f32_16x16x32_bf16 v[132:135], v[76:79], a[116:119], v[132:135]
v_mul_f32 v145, 0x3ae38e39, v145
v_mul_f32 v149, 0x3ae38e39, v149
v_mfma_f32_16x16x32_bf16 v[136:139], v[72:75], a[104:107], v[136:139]
buffer_load_dwordx4 a[204:207], v6, s[8:11], s48 offen offset:0 sc1
v_mfma_f32_16x16x32_bf16 v[136:139], v[76:79], a[120:123], v[136:139]
ds_read_b128 v[68:71], v8 offset:5120
v_mul_f32 v153, 0x3ae38e39, v153
v_mfma_f32_16x16x32_bf16 v[140:143], v[72:75], a[108:111], v[140:143]
v_mul_f32 v157, 0x3ae38e39, v157
v_fma_f32 v145, -v144, v144, v145
v_mfma_f32_16x16x32_bf16 v[140:143], v[76:79], a[124:127], v[140:143]
v_fma_f32 v149, -v148, v148, v149
s_waitcnt vmcnt(12)
s_waitcnt lgkmcnt(4)
v_mfma_f32_16x16x32_bf16 v[80:83], v[48:51], a[128:131], v[80:83]
buffer_load_dwordx4 a[208:211], v2, s[8:11], s48 offen offset:1024 sc1
v_mfma_f32_16x16x32_bf16 v[80:83], v[52:55], a[144:147], v[80:83]
v_fma_f32 v153, -v152, v152, v153
v_fma_f32 v157, -v156, v156, v157
v_mfma_f32_16x16x32_bf16 v[84:87], v[48:51], a[132:135], v[84:87]
ds_read_b128 v[72:75], v8 offset:6144
v_max_f32 v145, 0, v145
v_mfma_f32_16x16x32_bf16 v[84:87], v[52:55], a[148:151], v[84:87]
v_max_f32 v149, 0, v149
v_max_f32 v153, 0, v153
v_mfma_f32_16x16x32_bf16 v[88:91], v[48:51], a[136:139], v[88:91]
buffer_load_dwordx4 a[212:215], v4, s[8:11], s48 offen offset:1024 sc1
v_mfma_f32_16x16x32_bf16 v[88:91], v[52:55], a[152:155], v[88:91]
ds_read_b128 v[76:79], v8 offset:7168
v_max_f32 v157, 0, v157
v_mfma_f32_16x16x32_bf16 v[92:95], v[48:51], a[140:143], v[92:95]
v_add_f32 v234, 0x3727c5ac, v145
v_add_f32 v238, 0x3727c5ac, v149
v_mfma_f32_16x16x32_bf16 v[92:95], v[52:55], a[156:159], v[92:95]
v_add_f32 v242, 0x3727c5ac, v153
s_waitcnt lgkmcnt(4)
v_mfma_f32_16x16x32_bf16 v[96:99], v[56:59], a[128:131], v[96:99]
buffer_load_dwordx4 a[216:219], v5, s[8:11], s48 offen offset:1024 sc1
v_mfma_f32_16x16x32_bf16 v[96:99], v[60:63], a[144:147], v[96:99]
v_add_f32 v246, 0x3727c5ac, v157
v_mfma_f32_16x16x32_bf16 v[100:103], v[56:59], a[132:135], v[100:103]
ds_read_b128 v[48:51], v8 offset:8192
v_mfma_f32_16x16x32_bf16 v[100:103], v[60:63], a[148:151], v[100:103]
v_rsq_f32 v144, v234
v_mfma_f32_16x16x32_bf16 v[104:107], v[56:59], a[136:139], v[104:107]
buffer_load_dwordx4 a[220:223], v6, s[8:11], s48 offen offset:1024 sc1
v_mfma_f32_16x16x32_bf16 v[104:107], v[60:63], a[152:155], v[104:107]
ds_read_b128 v[52:55], v8 offset:9216
v_mul_f32 v232, 0xc0135761, v144
v_mfma_f32_16x16x32_bf16 v[108:111], v[56:59], a[140:143], v[108:111]
v_rsq_f32 v148, v238
v_mfma_f32_16x16x32_bf16 v[108:111], v[60:63], a[156:159], v[108:111]
v_mul_f32 v236, 0xc0135761, v148
s_waitcnt lgkmcnt(4)
v_mfma_f32_16x16x32_bf16 v[112:115], v[64:67], a[128:131], v[112:115]
buffer_load_dwordx4 a[224:227], v2, s[8:11], s48 offen offset:2048 sc1
v_mfma_f32_16x16x32_bf16 v[112:115], v[68:71], a[144:147], v[112:115]
v_rsq_f32 v152, v242
v_mfma_f32_16x16x32_bf16 v[116:119], v[64:67], a[132:135], v[116:119]
ds_read_b128 v[56:59], v8 offset:10240
v_mul_f32 v240, 0xc0135761, v152
v_mfma_f32_16x16x32_bf16 v[116:119], v[68:71], a[148:151], v[116:119]
v_rsq_f32 v156, v246
v_mfma_f32_16x16x32_bf16 v[120:123], v[64:67], a[136:139], v[120:123]
buffer_load_dwordx4 a[228:231], v4, s[8:11], s48 offen offset:2048 sc1
v_mfma_f32_16x16x32_bf16 v[120:123], v[68:71], a[152:155], v[120:123]
ds_read_b128 v[60:63], v8 offset:11264
v_mul_f32 v244, 0xc0135761, v156
v_mfma_f32_16x16x32_bf16 v[124:127], v[64:67], a[140:143], v[124:127]
v_mul_f32 v145, v144, v144
v_mul_f32 v149, v148, v148
v_mfma_f32_16x16x32_bf16 v[124:127], v[68:71], a[156:159], v[124:127]
v_mul_f32 v153, v152, v152
s_waitcnt lgkmcnt(4)
v_mfma_f32_16x16x32_bf16 v[128:131], v[72:75], a[128:131], v[128:131]
buffer_load_dwordx4 a[232:235], v5, s[8:11], s48 offen offset:2048 sc1
v_mfma_f32_16x16x32_bf16 v[128:131], v[76:79], a[144:147], v[128:131]
v_mul_f32 v157, v156, v156
v_mul_f32 v145, v145, v144
v_mfma_f32_16x16x32_bf16 v[132:135], v[72:75], a[132:135], v[132:135]
ds_read_b128 v[64:67], v8 offset:12288
v_mul_f32 v149, v149, v148
v_mfma_f32_16x16x32_bf16 v[132:135], v[76:79], a[148:151], v[132:135]
v_mul_f32 v153, v153, v152
v_mul_f32 v157, v157, v156
v_mfma_f32_16x16x32_bf16 v[136:139], v[72:75], a[136:139], v[136:139]
buffer_load_dwordx4 a[236:239], v6, s[8:11], s48 offen offset:2048 sc1
v_mfma_f32_16x16x32_bf16 v[136:139], v[76:79], a[152:155], v[136:139]
ds_read_b128 v[68:71], v8 offset:13312
v_mul_f32 v233, 0xbdd2d3e8, v145
v_mfma_f32_16x16x32_bf16 v[140:143], v[72:75], a[140:143], v[140:143]
v_mul_f32 v237, 0xbdd2d3e8, v149
v_mul_f32 v241, 0xbdd2d3e8, v153
v_mfma_f32_16x16x32_bf16 v[140:143], v[76:79], a[156:159], v[140:143]
v_mul_f32 v245, 0xbdd2d3e8, v157
s_waitcnt vmcnt(12)
s_waitcnt lgkmcnt(4)
v_mfma_f32_16x16x32_bf16 v[80:83], v[48:51], a[160:163], v[80:83]
buffer_load_dwordx4 a[240:243], v2, s[8:11], s48 offen offset:3072 sc1
v_mfma_f32_16x16x32_bf16 v[80:83], v[52:55], a[176:179], v[80:83]
v_mfma_f32_16x16x32_bf16 v[84:87], v[48:51], a[164:167], v[84:87]
ds_read_b128 v[72:75], v8 offset:14336
v_mfma_f32_16x16x32_bf16 v[84:87], v[52:55], a[180:183], v[84:87]
v_mfma_f32_16x16x32_bf16 v[88:91], v[48:51], a[168:171], v[88:91]
buffer_load_dwordx4 a[244:247], v4, s[8:11], s48 offen offset:3072 sc1
v_mfma_f32_16x16x32_bf16 v[88:91], v[52:55], a[184:187], v[88:91]
ds_read_b128 v[76:79], v8 offset:15360
v_mfma_f32_16x16x32_bf16 v[92:95], v[48:51], a[172:175], v[92:95]
v_mfma_f32_16x16x32_bf16 v[92:95], v[52:55], a[188:191], v[92:95]
s_waitcnt lgkmcnt(4)
v_mfma_f32_16x16x32_bf16 v[96:99], v[56:59], a[160:163], v[96:99]
buffer_load_dwordx4 a[248:251], v5, s[8:11], s48 offen offset:3072 sc1
v_mfma_f32_16x16x32_bf16 v[96:99], v[60:63], a[176:179], v[96:99]
s_barrier
v_mfma_f32_16x16x32_bf16 v[100:103], v[56:59], a[164:167], v[100:103]
ds_read_b128 v[48:51], v2 offset:0
v_mfma_f32_16x16x32_bf16 v[100:103], v[60:63], a[180:183], v[100:103]
v_mfma_f32_16x16x32_bf16 v[104:107], v[56:59], a[168:171], v[104:107]
buffer_load_dwordx4 a[252:255], v6, s[8:11], s48 offen offset:3072 sc1
v_mfma_f32_16x16x32_bf16 v[104:107], v[60:63], a[184:187], v[104:107]
ds_read_b128 v[52:55], v2 offset:1024
s_add_u32 s48, s20, 16384
v_mfma_f32_16x16x32_bf16 v[108:111], v[56:59], a[172:175], v[108:111]
v_mfma_f32_16x16x32_bf16 v[108:111], v[60:63], a[188:191], v[108:111]
s_waitcnt lgkmcnt(4)
v_mfma_f32_16x16x32_bf16 v[112:115], v[64:67], a[160:163], v[112:115]
buffer_load_dwordx4 v[16:19], v2, s[8:11], s48 offen offset:0 sc1
v_mfma_f32_16x16x32_bf16 v[112:115], v[68:71], a[176:179], v[112:115]
v_mfma_f32_16x16x32_bf16 v[116:119], v[64:67], a[164:167], v[116:119]
ds_read_b128 v[56:59], v2 offset:2048
v_mfma_f32_16x16x32_bf16 v[116:119], v[68:71], a[180:183], v[116:119]
v_mfma_f32_16x16x32_bf16 v[120:123], v[64:67], a[168:171], v[120:123]
buffer_load_dwordx4 v[20:23], v4, s[8:11], s48 offen offset:0 sc1
v_mfma_f32_16x16x32_bf16 v[120:123], v[68:71], a[184:187], v[120:123]
ds_read_b128 v[60:63], v2 offset:3072
v_mfma_f32_16x16x32_bf16 v[124:127], v[64:67], a[172:175], v[124:127]
v_mfma_f32_16x16x32_bf16 v[124:127], v[68:71], a[188:191], v[124:127]
s_waitcnt lgkmcnt(4)
v_mfma_f32_16x16x32_bf16 v[128:131], v[72:75], a[160:163], v[128:131]
buffer_load_dwordx4 v[24:27], v5, s[8:11], s48 offen offset:0 sc1
v_mfma_f32_16x16x32_bf16 v[128:131], v[76:79], a[176:179], v[128:131]
v_mfma_f32_16x16x32_bf16 v[132:135], v[72:75], a[164:167], v[132:135]
ds_read_b128 v[64:67], v2 offset:4096
v_mfma_f32_16x16x32_bf16 v[132:135], v[76:79], a[180:183], v[132:135]
v_mfma_f32_16x16x32_bf16 v[136:139], v[72:75], a[168:171], v[136:139]
buffer_load_dwordx4 v[28:31], v6, s[8:11], s48 offen offset:0 sc1
v_mfma_f32_16x16x32_bf16 v[136:139], v[76:79], a[184:187], v[136:139]
ds_read_b128 v[68:71], v2 offset:5120
v_mfma_f32_16x16x32_bf16 v[140:143], v[72:75], a[172:175], v[140:143]
v_mfma_f32_16x16x32_bf16 v[140:143], v[76:79], a[188:191], v[140:143]
s_waitcnt vmcnt(12)
s_waitcnt lgkmcnt(4)
v_mfma_f32_16x16x32_bf16 v[80:83], v[48:51], a[192:195], v[80:83]
buffer_load_dwordx4 v[32:35], v2, s[8:11], s48 offen offset:1024 sc1
v_mfma_f32_16x16x32_bf16 v[80:83], v[52:55], a[208:211], v[80:83]
v_mfma_f32_16x16x32_bf16 v[84:87], v[48:51], a[196:199], v[84:87]
ds_read_b128 v[72:75], v2 offset:6144
v_mfma_f32_16x16x32_bf16 v[84:87], v[52:55], a[212:215], v[84:87]
v_mfma_f32_16x16x32_bf16 v[88:91], v[48:51], a[200:203], v[88:91]
buffer_load_dwordx4 v[36:39], v4, s[8:11], s48 offen offset:1024 sc1
v_mfma_f32_16x16x32_bf16 v[88:91], v[52:55], a[216:219], v[88:91]
ds_read_b128 v[76:79], v2 offset:7168
v_mfma_f32_16x16x32_bf16 v[92:95], v[48:51], a[204:207], v[92:95]
v_mfma_f32_16x16x32_bf16 v[92:95], v[52:55], a[220:223], v[92:95]
s_waitcnt lgkmcnt(4)
v_mfma_f32_16x16x32_bf16 v[96:99], v[56:59], a[192:195], v[96:99]
buffer_load_dwordx4 v[40:43], v5, s[8:11], s48 offen offset:1024 sc1
v_mfma_f32_16x16x32_bf16 v[96:99], v[60:63], a[208:211], v[96:99]
v_mfma_f32_16x16x32_bf16 v[100:103], v[56:59], a[196:199], v[100:103]
ds_read_b128 v[48:51], v2 offset:8192
v_mfma_f32_16x16x32_bf16 v[100:103], v[60:63], a[212:215], v[100:103]
v_mfma_f32_16x16x32_bf16 v[104:107], v[56:59], a[200:203], v[104:107]
buffer_load_dwordx4 v[44:47], v6, s[8:11], s48 offen offset:1024 sc1
v_mfma_f32_16x16x32_bf16 v[104:107], v[60:63], a[216:219], v[104:107]
ds_read_b128 v[52:55], v2 offset:9216
s_add_u32 m0, s22, 49152
v_mfma_f32_16x16x32_bf16 v[108:111], v[56:59], a[204:207], v[108:111]
v_add_u32 v3, 20480, v3
v_mfma_f32_16x16x32_bf16 v[108:111], v[60:63], a[220:223], v[108:111]
s_waitcnt lgkmcnt(4)
v_mfma_f32_16x16x32_bf16 v[112:115], v[64:67], a[192:195], v[112:115]
buffer_load_dwordx4 v3, s[8:11], 0 offen offset:0 sc1 lds
v_mfma_f32_16x16x32_bf16 v[112:115], v[68:71], a[208:211], v[112:115]
v_mfma_f32_16x16x32_bf16 v[116:119], v[64:67], a[196:199], v[116:119]
ds_read_b128 v[56:59], v2 offset:10240
v_mfma_f32_16x16x32_bf16 v[116:119], v[68:71], a[212:215], v[116:119]
v_mfma_f32_16x16x32_bf16 v[120:123], v[64:67], a[200:203], v[120:123]
buffer_load_dwordx4 v3, s[8:11], 0 offen offset:1024 sc1 lds
v_mfma_f32_16x16x32_bf16 v[120:123], v[68:71], a[216:219], v[120:123]
ds_read_b128 v[60:63], v2 offset:11264
v_mfma_f32_16x16x32_bf16 v[124:127], v[64:67], a[204:207], v[124:127]
v_mfma_f32_16x16x32_bf16 v[124:127], v[68:71], a[220:223], v[124:127]
s_waitcnt lgkmcnt(4)
v_mfma_f32_16x16x32_bf16 v[128:131], v[72:75], a[192:195], v[128:131]
buffer_load_dwordx4 v3, s[8:11], 0 offen offset:2048 sc1 lds
v_mfma_f32_16x16x32_bf16 v[128:131], v[76:79], a[208:211], v[128:131]
v_mfma_f32_16x16x32_bf16 v[132:135], v[72:75], a[196:199], v[132:135]
ds_read_b128 v[64:67], v2 offset:12288
v_mfma_f32_16x16x32_bf16 v[132:135], v[76:79], a[212:215], v[132:135]
v_mfma_f32_16x16x32_bf16 v[136:139], v[72:75], a[200:203], v[136:139]
buffer_load_dwordx4 v3, s[8:11], 0 offen offset:3072 sc1 lds
v_mfma_f32_16x16x32_bf16 v[136:139], v[76:79], a[216:219], v[136:139]
ds_read_b128 v[68:71], v2 offset:13312
s_add_u32 m0, s22, 53248
v_mfma_f32_16x16x32_bf16 v[140:143], v[72:75], a[204:207], v[140:143]
v_add_u32 v3, 4096, v3
v_mfma_f32_16x16x32_bf16 v[140:143], v[76:79], a[220:223], v[140:143]
s_waitcnt vmcnt(12)
s_waitcnt lgkmcnt(4)
v_mfma_f32_16x16x32_bf16 v[80:83], v[48:51], a[224:227], v[80:83]
buffer_load_dwordx4 v3, s[8:11], 0 offen offset:0 sc1 lds
v_mfma_f32_16x16x32_bf16 v[80:83], v[52:55], a[240:243], v[80:83]
v_mfma_f32_16x16x32_bf16 v[84:87], v[48:51], a[228:231], v[84:87]
ds_read_b128 v[72:75], v2 offset:14336
v_mfma_f32_16x16x32_bf16 v[84:87], v[52:55], a[244:247], v[84:87]
v_mfma_f32_16x16x32_bf16 v[88:91], v[48:51], a[232:235], v[88:91]
buffer_load_dwordx4 v3, s[8:11], 0 offen offset:1024 sc1 lds
v_mfma_f32_16x16x32_bf16 v[88:91], v[52:55], a[248:251], v[88:91]
ds_read_b128 v[76:79], v2 offset:15360
s_add_u32 m0, s22, 73728
v_mfma_f32_16x16x32_bf16 v[92:95], v[48:51], a[236:239], v[92:95]
v_add_u32 v3, 20480, v3
v_mfma_f32_16x16x32_bf16 v[92:95], v[52:55], a[252:255], v[92:95]
s_waitcnt lgkmcnt(4)
v_mfma_f32_16x16x32_bf16 v[96:99], v[56:59], a[224:227], v[96:99]
buffer_load_dwordx4 v3, s[8:11], 0 offen offset:0 sc1 lds
v_mfma_f32_16x16x32_bf16 v[96:99], v[60:63], a[240:243], v[96:99]
v_mfma_f32_16x16x32_bf16 v[100:103], v[56:59], a[228:231], v[100:103]
ds_read_b128 v[48:51], v2 offset:16384
v_mfma_f32_16x16x32_bf16 v[100:103], v[60:63], a[244:247], v[100:103]
v_mfma_f32_16x16x32_bf16 v[104:107], v[56:59], a[232:235], v[104:107]
buffer_load_dwordx4 v3, s[8:11], 0 offen offset:1024 sc1 lds
v_mfma_f32_16x16x32_bf16 v[104:107], v[60:63], a[248:251], v[104:107]
ds_read_b128 v[52:55], v2 offset:17408
v_mfma_f32_16x16x32_bf16 v[108:111], v[56:59], a[236:239], v[108:111]
v_mfma_f32_16x16x32_bf16 v[108:111], v[60:63], a[252:255], v[108:111]
s_waitcnt lgkmcnt(4)
v_mfma_f32_16x16x32_bf16 v[112:115], v[64:67], a[224:227], v[112:115]
buffer_load_dwordx4 v3, s[8:11], 0 offen offset:2048 sc1 lds
v_mfma_f32_16x16x32_bf16 v[112:115], v[68:71], a[240:243], v[112:115]
v_mfma_f32_16x16x32_bf16 v[116:119], v[64:67], a[228:231], v[116:119]
ds_read_b128 v[56:59], v2 offset:18432
v_mfma_f32_16x16x32_bf16 v[116:119], v[68:71], a[244:247], v[116:119]
v_mfma_f32_16x16x32_bf16 v[120:123], v[64:67], a[232:235], v[120:123]
buffer_load_dwordx4 v3, s[8:11], 0 offen offset:3072 sc1 lds
v_mfma_f32_16x16x32_bf16 v[120:123], v[68:71], a[248:251], v[120:123]
ds_read_b128 v[60:63], v2 offset:19456
s_add_u32 m0, s22, 77824
v_mfma_f32_16x16x32_bf16 v[124:127], v[64:67], a[236:239], v[124:127]
v_add_u32 v3, 4096, v3
v_mfma_f32_16x16x32_bf16 v[124:127], v[68:71], a[252:255], v[124:127]
s_waitcnt lgkmcnt(4)
v_mfma_f32_16x16x32_bf16 v[128:131], v[72:75], a[224:227], v[128:131]
buffer_load_dwordx4 v3, s[8:11], 0 offen offset:0 sc1 lds
v_mfma_f32_16x16x32_bf16 v[128:131], v[76:79], a[240:243], v[128:131]
v_mfma_f32_16x16x32_bf16 v[132:135], v[72:75], a[228:231], v[132:135]
ds_read_b128 v[64:67], v2 offset:20480
v_mfma_f32_16x16x32_bf16 v[132:135], v[76:79], a[244:247], v[132:135]
v_mfma_f32_16x16x32_bf16 v[136:139], v[72:75], a[232:235], v[136:139]
buffer_load_dwordx4 v3, s[8:11], 0 offen offset:1024 sc1 lds
v_mfma_f32_16x16x32_bf16 v[136:139], v[76:79], a[248:251], v[136:139]
ds_read_b128 v[68:71], v2 offset:21504
s_add_u32 m0, s22, 98304
v_mfma_f32_16x16x32_bf16 v[140:143], v[72:75], a[236:239], v[140:143]
v_add_u32 v3, 20480, v3
v_mfma_f32_16x16x32_bf16 v[140:143], v[76:79], a[252:255], v[140:143]
s_waitcnt vmcnt(12)
s_waitcnt lgkmcnt(4)
v_mfma_f32_16x16x32_bf16 v[80:83], v[48:51], v[16:19], v[80:83]
buffer_load_dwordx4 v3, s[8:11], 0 offen offset:0 sc1 lds
v_mfma_f32_16x16x32_bf16 v[80:83], v[52:55], v[32:35], v[80:83]
v_mfma_f32_16x16x32_bf16 v[84:87], v[48:51], v[20:23], v[84:87]
ds_read_b128 v[72:75], v2 offset:22528
v_mfma_f32_16x16x32_bf16 v[84:87], v[52:55], v[36:39], v[84:87]
v_mfma_f32_16x16x32_bf16 v[88:91], v[48:51], v[24:27], v[88:91]
buffer_load_dwordx4 v3, s[8:11], 0 offen offset:1024 sc1 lds
v_mfma_f32_16x16x32_bf16 v[88:91], v[52:55], v[40:43], v[88:91]
ds_read_b128 v[76:79], v2 offset:23552
v_mfma_f32_16x16x32_bf16 v[92:95], v[48:51], v[28:31], v[92:95]
v_mfma_f32_16x16x32_bf16 v[92:95], v[52:55], v[44:47], v[92:95]
s_waitcnt lgkmcnt(4)
v_mfma_f32_16x16x32_bf16 v[96:99], v[56:59], v[16:19], v[96:99]
buffer_load_dwordx4 v3, s[8:11], 0 offen offset:2048 sc1 lds
v_mfma_f32_16x16x32_bf16 v[96:99], v[60:63], v[32:35], v[96:99]
s_barrier
v_mfma_f32_16x16x32_bf16 v[100:103], v[56:59], v[20:23], v[100:103]
ds_read_b128 v[48:51], v2 offset:24576
v_mfma_f32_16x16x32_bf16 v[100:103], v[60:63], v[36:39], v[100:103]
v_mfma_f32_16x16x32_bf16 v[104:107], v[56:59], v[24:27], v[104:107]
buffer_load_dwordx4 v3, s[8:11], 0 offen offset:3072 sc1 lds
v_mfma_f32_16x16x32_bf16 v[104:107], v[60:63], v[40:43], v[104:107]
ds_read_b128 v[52:55], v2 offset:25600
s_add_u32 m0, s22, 102400
v_mfma_f32_16x16x32_bf16 v[108:111], v[56:59], v[28:31], v[108:111]
v_add_u32 v3, 4096, v3
v_mfma_f32_16x16x32_bf16 v[108:111], v[60:63], v[44:47], v[108:111]
s_waitcnt lgkmcnt(4)
v_mfma_f32_16x16x32_bf16 v[112:115], v[64:67], v[16:19], v[112:115]
buffer_load_dwordx4 v3, s[8:11], 0 offen offset:0 sc1 lds
v_mfma_f32_16x16x32_bf16 v[112:115], v[68:71], v[32:35], v[112:115]
v_mfma_f32_16x16x32_bf16 v[116:119], v[64:67], v[20:23], v[116:119]
ds_read_b128 v[56:59], v2 offset:26624
v_mfma_f32_16x16x32_bf16 v[116:119], v[68:71], v[36:39], v[116:119]
v_mfma_f32_16x16x32_bf16 v[120:123], v[64:67], v[24:27], v[120:123]
buffer_load_dwordx4 v3, s[8:11], 0 offen offset:1024 sc1 lds
v_mfma_f32_16x16x32_bf16 v[120:123], v[68:71], v[40:43], v[120:123]
ds_read_b128 v[60:63], v2 offset:27648
s_add_u32 m0, s22, 122880
v_mfma_f32_16x16x32_bf16 v[124:127], v[64:67], v[28:31], v[124:127]
v_add_u32 v3, 20480, v3
v_mfma_f32_16x16x32_bf16 v[124:127], v[68:71], v[44:47], v[124:127]
s_waitcnt lgkmcnt(4)
v_mfma_f32_16x16x32_bf16 v[128:131], v[72:75], v[16:19], v[128:131]
v_mfma_f32_16x16x32_bf16 v[128:131], v[76:79], v[32:35], v[128:131]
buffer_load_dwordx4 v3, s[8:11], 0 offen offset:0 sc1 lds
v_mfma_f32_16x16x32_bf16 v[132:135], v[72:75], v[20:23], v[132:135]
ds_read_b128 v[64:67], v2 offset:28672
v_mfma_f32_16x16x32_bf16 v[132:135], v[76:79], v[36:39], v[132:135]
v_mfma_f32_16x16x32_bf16 v[136:139], v[72:75], v[24:27], v[136:139]
v_mfma_f32_16x16x32_bf16 v[136:139], v[76:79], v[40:43], v[136:139]
ds_read_b128 v[68:71], v2 offset:29696
v_mfma_f32_16x16x32_bf16 v[140:143], v[72:75], v[28:31], v[140:143]
buffer_load_dwordx4 v3, s[8:11], 0 offen offset:1024 sc1 lds
v_mfma_f32_16x16x32_bf16 v[140:143], v[76:79], v[44:47], v[140:143]
s_waitcnt lgkmcnt(4)
v_mfma_f32_16x16x32_bf16 v[176:179], v[48:51], a[0:3], 0
v_mfma_f32_16x16x32_bf16 v[176:179], v[52:55], a[16:19], v[176:179]
v_mfma_f32_16x16x32_bf16 v[180:183], v[48:51], a[4:7], 0
ds_read_b128 v[72:75], v2 offset:30720
v_mfma_f32_16x16x32_bf16 v[180:183], v[52:55], a[20:23], v[180:183]
buffer_load_dwordx4 v3, s[8:11], 0 offen offset:2048 sc1 lds
v_mfma_f32_16x16x32_bf16 v[184:187], v[48:51], a[8:11], 0
v_mul_f32 v208, v80, v80
v_mul_f32 v210, v81, v81
v_mfma_f32_16x16x32_bf16 v[184:187], v[52:55], a[24:27], v[184:187]
ds_read_b128 v[76:79], v2 offset:31744
v_fma_f32 v208, v208, v233, v232
v_mfma_f32_16x16x32_bf16 v[188:191], v[48:51], a[12:15], 0
v_fma_f32 v210, v210, v233, v232
v_mul_f32 v208, v208, v80
v_mfma_f32_16x16x32_bf16 v[188:191], v[52:55], a[28:31], v[188:191]
v_mul_f32 v210, v210, v81
s_waitcnt lgkmcnt(4)
v_mfma_f32_16x16x32_bf16 v[192:195], v[56:59], a[0:3], 0
buffer_load_dwordx4 v3, s[8:11], 0 offen offset:3072 sc1 lds
v_mfma_f32_16x16x32_bf16 v[192:195], v[60:63], a[16:19], v[192:195]
s_add_u32 m0, s22, 126976
v_add_u32 v3, 4096, v3
v_mfma_f32_16x16x32_bf16 v[196:199], v[56:59], a[4:7], 0
ds_read_b128 v[48:51], v2 offset:32768
v_mul_f32 v209, v80, v96
v_mfma_f32_16x16x32_bf16 v[196:199], v[60:63], a[20:23], v[196:199]
v_exp_f32 v208, v208
v_mfma_f32_16x16x32_bf16 v[200:203], v[56:59], a[8:11], 0
v_exp_f32 v210, v210
v_mfma_f32_16x16x32_bf16 v[200:203], v[60:63], a[24:27], v[200:203]
ds_read_b128 v[52:55], v2 offset:33792
v_mul_f32 v211, v81, v97
v_mfma_f32_16x16x32_bf16 v[204:207], v[56:59], a[12:15], 0
buffer_load_dwordx4 v3, s[8:11], 0 offen offset:0 sc1 lds
v_mfma_f32_16x16x32_bf16 v[204:207], v[60:63], a[28:31], v[204:207]
v_fma_f32 v208, v208, v234, v234
s_waitcnt lgkmcnt(4)
v_mfma_f32_16x16x32_bf16 v[176:179], v[64:67], a[32:35], v[176:179]
v_fma_f32 v210, v210, v234, v234
v_mul_f32 v212, v82, v82
v_mfma_f32_16x16x32_bf16 v[176:179], v[68:71], a[48:51], v[176:179]
v_rcp_f32 v208, v208
v_mfma_f32_16x16x32_bf16 v[180:183], v[64:67], a[36:39], v[180:183]
ds_read_b128 v[56:59], v2 offset:34816
v_mul_f32 v209, v209, v208
v_mfma_f32_16x16x32_bf16 v[180:183], v[68:71], a[52:55], v[180:183]
buffer_load_dwordx4 v3, s[8:11], 0 offen offset:1024 sc1 lds
v_mfma_f32_16x16x32_bf16 v[184:187], v[64:67], a[40:43], v[184:187]
v_rcp_f32 v210, v210
v_mfma_f32_16x16x32_bf16 v[184:187], v[68:71], a[56:59], v[184:187]
ds_read_b128 v[60:63], v2 offset:35840
v_mul_f32 v211, v211, v210
v_mfma_f32_16x16x32_bf16 v[188:191], v[64:67], a[44:47], v[188:191]
v_cvt_pk_bf16_f32 v224, v209, v211
v_mul_f32 v214, v83, v83
v_mfma_f32_16x16x32_bf16 v[188:191], v[68:71], a[60:63], v[188:191]
v_fma_f32 v212, v212, v233, v232
s_waitcnt lgkmcnt(4)
v_mfma_f32_16x16x32_bf16 v[192:195], v[72:75], a[32:35], v[192:195]
v_fma_f32 v214, v214, v233, v232
v_mul_f32 v212, v212, v82
v_mfma_f32_16x16x32_bf16 v[192:195], v[76:79], a[48:51], v[192:195]
v_mul_f32 v214, v214, v83
v_mul_f32 v213, v82, v98
v_mfma_f32_16x16x32_bf16 v[196:199], v[72:75], a[36:39], v[196:199]
ds_read_b128 v[64:67], v2 offset:36864
v_mul_f32 v215, v83, v99
v_mfma_f32_16x16x32_bf16 v[196:199], v[76:79], a[52:55], v[196:199]
v_exp_f32 v212, v212
v_mfma_f32_16x16x32_bf16 v[200:203], v[72:75], a[40:43], v[200:203]
v_exp_f32 v214, v214
v_mfma_f32_16x16x32_bf16 v[200:203], v[76:79], a[56:59], v[200:203]
ds_read_b128 v[68:71], v2 offset:37888
v_fma_f32 v212, v212, v234, v234
v_mfma_f32_16x16x32_bf16 v[204:207], v[72:75], a[44:47], v[204:207]
v_fma_f32 v214, v214, v234, v234
v_mul_f32 v208, v84, v84
v_mfma_f32_16x16x32_bf16 v[204:207], v[76:79], a[60:63], v[204:207]
v_mul_f32 v210, v85, v85
s_waitcnt lgkmcnt(4)
v_mfma_f32_16x16x32_bf16 v[176:179], v[48:51], a[64:67], v[176:179]
v_rcp_f32 v212, v212
v_mfma_f32_16x16x32_bf16 v[176:179], v[52:55], a[80:83], v[176:179]
v_rcp_f32 v214, v214
v_mfma_f32_16x16x32_bf16 v[180:183], v[48:51], a[68:71], v[180:183]
ds_read_b128 v[72:75], v2 offset:38912
v_mul_f32 v213, v213, v212
v_mfma_f32_16x16x32_bf16 v[180:183], v[52:55], a[84:87], v[180:183]
v_mul_f32 v215, v215, v214
v_cvt_pk_bf16_f32 v225, v213, v215
v_mfma_f32_16x16x32_bf16 v[184:187], v[48:51], a[72:75], v[184:187]
buffer_store_dwordx2 v[224:225], v248, s[8:11], s30 offen sc1
v_mfma_f32_16x16x32_bf16 v[184:187], v[52:55], a[88:91], v[184:187]
ds_read_b128 v[76:79], v2 offset:39936
v_fma_f32 v208, v208, v237, v236
v_mfma_f32_16x16x32_bf16 v[188:191], v[48:51], a[76:79], v[188:191]
v_fma_f32 v210, v210, v237, v236
v_mul_f32 v208, v208, v84
v_mfma_f32_16x16x32_bf16 v[188:191], v[52:55], a[92:95], v[188:191]
v_mul_f32 v210, v210, v85
s_waitcnt lgkmcnt(4)
v_mfma_f32_16x16x32_bf16 v[192:195], v[56:59], a[64:67], v[192:195]
v_exp_f32 v208, v208
v_mfma_f32_16x16x32_bf16 v[192:195], v[60:63], a[80:83], v[192:195]
v_exp_f32 v210, v210
v_mfma_f32_16x16x32_bf16 v[196:199], v[56:59], a[68:71], v[196:199]
ds_read_b128 v[48:51], v2 offset:40960
v_mul_f32 v209, v84, v100
v_mfma_f32_16x16x32_bf16 v[196:199], v[60:63], a[84:87], v[196:199]
v_mul_f32 v211, v85, v101
v_fma_f32 v208, v208, v238, v238
v_mfma_f32_16x16x32_bf16 v[200:203], v[56:59], a[72:75], v[200:203]
v_fma_f32 v210, v210, v238, v238
v_mul_f32 v212, v86, v86
v_mfma_f32_16x16x32_bf16 v[200:203], v[60:63], a[88:91], v[200:203]
ds_read_b128 v[52:55], v2 offset:41984
v_mul_f32 v214, v87, v87
v_mfma_f32_16x16x32_bf16 v[204:207], v[56:59], a[76:79], v[204:207]
v_rcp_f32 v208, v208
v_mfma_f32_16x16x32_bf16 v[204:207], v[60:63], a[92:95], v[204:207]
v_mul_f32 v209, v209, v208
s_waitcnt lgkmcnt(4)
v_mfma_f32_16x16x32_bf16 v[176:179], v[64:67], a[96:99], v[176:179]
v_rcp_f32 v210, v210
v_mfma_f32_16x16x32_bf16 v[176:179], v[68:71], a[112:115], v[176:179]
v_mul_f32 v211, v211, v210
v_cvt_pk_bf16_f32 v226, v209, v211
v_mfma_f32_16x16x32_bf16 v[180:183], v[64:67], a[100:103], v[180:183]
ds_read_b128 v[56:59], v2 offset:43008
v_fma_f32 v212, v212, v237, v236
v_mfma_f32_16x16x32_bf16 v[180:183], v[68:71], a[116:119], v[180:183]
v_fma_f32 v214, v214, v237, v236
v_mul_f32 v212, v212, v86
v_mfma_f32_16x16x32_bf16 v[184:187], v[64:67], a[104:107], v[184:187]
v_mul_f32 v214, v214, v87
v_mul_f32 v213, v86, v102
v_mfma_f32_16x16x32_bf16 v[184:187], v[68:71], a[120:123], v[184:187]
ds_read_b128 v[60:63], v2 offset:44032
v_mul_f32 v215, v87, v103
v_mfma_f32_16x16x32_bf16 v[188:191], v[64:67], a[108:111], v[188:191]
v_exp_f32 v212, v212
v_mfma_f32_16x16x32_bf16 v[188:191], v[68:71], a[124:127], v[188:191]
v_fma_f32 v212, v212, v238, v238
s_waitcnt lgkmcnt(4)
v_mfma_f32_16x16x32_bf16 v[192:195], v[72:75], a[96:99], v[192:195]
v_exp_f32 v214, v214
v_mfma_f32_16x16x32_bf16 v[192:195], v[76:79], a[112:115], v[192:195]
v_fma_f32 v214, v214, v238, v238
v_mul_f32 v208, v88, v88
v_mfma_f32_16x16x32_bf16 v[196:199], v[72:75], a[100:103], v[196:199]
ds_read_b128 v[64:67], v2 offset:45056
v_mul_f32 v210, v89, v89
v_mfma_f32_16x16x32_bf16 v[196:199], v[76:79], a[116:119], v[196:199]
v_rcp_f32 v212, v212
v_mfma_f32_16x16x32_bf16 v[200:203], v[72:75], a[104:107], v[200:203]
v_rcp_f32 v214, v214
v_mfma_f32_16x16x32_bf16 v[200:203], v[76:79], a[120:123], v[200:203]
ds_read_b128 v[68:71], v2 offset:46080
v_mul_f32 v213, v213, v212
v_mfma_f32_16x16x32_bf16 v[204:207], v[72:75], a[108:111], v[204:207]
v_mul_f32 v215, v215, v214
v_cvt_pk_bf16_f32 v227, v213, v215
v_mfma_f32_16x16x32_bf16 v[204:207], v[76:79], a[124:127], v[204:207]
v_fma_f32 v208, v208, v241, v240
s_waitcnt lgkmcnt(4)
v_mfma_f32_16x16x32_bf16 v[176:179], v[48:51], a[128:131], v[176:179]
buffer_store_dwordx2 v[226:227], v249, s[8:11], s30 offen sc1
v_mfma_f32_16x16x32_bf16 v[176:179], v[52:55], a[144:147], v[176:179]
v_fma_f32 v210, v210, v241, v240
v_mul_f32 v208, v208, v88
v_mfma_f32_16x16x32_bf16 v[180:183], v[48:51], a[132:135], v[180:183]
ds_read_b128 v[72:75], v2 offset:47104
v_mul_f32 v210, v210, v89
v_mfma_f32_16x16x32_bf16 v[180:183], v[52:55], a[148:151], v[180:183]
v_exp_f32 v208, v208
v_mfma_f32_16x16x32_bf16 v[184:187], v[48:51], a[136:139], v[184:187]
v_exp_f32 v210, v210
v_mfma_f32_16x16x32_bf16 v[184:187], v[52:55], a[152:155], v[184:187]
ds_read_b128 v[76:79], v2 offset:48128
v_mul_f32 v209, v88, v104
v_mfma_f32_16x16x32_bf16 v[188:191], v[48:51], a[140:143], v[188:191]
v_mul_f32 v211, v89, v105
v_fma_f32 v208, v208, v242, v242
v_mfma_f32_16x16x32_bf16 v[188:191], v[52:55], a[156:159], v[188:191]
v_fma_f32 v210, v210, v242, v242
s_waitcnt lgkmcnt(4)
v_mfma_f32_16x16x32_bf16 v[192:195], v[56:59], a[128:131], v[192:195]
s_waitcnt vmcnt(20)
v_mul_f32 v212, v90, v90
v_mfma_f32_16x16x32_bf16 v[192:195], v[60:63], a[144:147], v[192:195]
s_barrier
v_mfma_f32_16x16x32_bf16 v[196:199], v[56:59], a[132:135], v[196:199]
ds_read_b128 v[48:51], v2 offset:49152
s_add_u32 m0, s22, 0
v_mfma_f32_16x16x32_bf16 v[196:199], v[60:63], a[148:151], v[196:199]
v_add_u32 v3, 20480, v3
buffer_load_dwordx4 v3, s[8:11], 0 offen offset:0 sc1 lds
v_mfma_f32_16x16x32_bf16 v[200:203], v[56:59], a[136:139], v[200:203]
v_rcp_f32 v208, v208
v_mfma_f32_16x16x32_bf16 v[200:203], v[60:63], a[152:155], v[200:203]
ds_read_b128 v[52:55], v2 offset:50176
v_mul_f32 v209, v209, v208
v_mfma_f32_16x16x32_bf16 v[204:207], v[56:59], a[140:143], v[204:207]
v_rcp_f32 v210, v210
v_mfma_f32_16x16x32_bf16 v[204:207], v[60:63], a[156:159], v[204:207]
v_mul_f32 v211, v211, v210
s_waitcnt lgkmcnt(4)
v_mfma_f32_16x16x32_bf16 v[176:179], v[64:67], a[160:163], v[176:179]
buffer_load_dwordx4 v3, s[8:11], 0 offen offset:1024 sc1 lds
v_mfma_f32_16x16x32_bf16 v[176:179], v[68:71], a[176:179], v[176:179]
v_cvt_pk_bf16_f32 v228, v209, v211
v_mul_f32 v214, v91, v91
v_mfma_f32_16x16x32_bf16 v[180:183], v[64:67], a[164:167], v[180:183]
ds_read_b128 v[56:59], v2 offset:51200
v_fma_f32 v212, v212, v241, v240
v_mfma_f32_16x16x32_bf16 v[180:183], v[68:71], a[180:183], v[180:183]
v_fma_f32 v214, v214, v241, v240
v_mul_f32 v212, v212, v90
v_mfma_f32_16x16x32_bf16 v[184:187], v[64:67], a[168:171], v[184:187]
v_mul_f32 v214, v214, v91
v_mul_f32 v213, v90, v106
v_mfma_f32_16x16x32_bf16 v[184:187], v[68:71], a[184:187], v[184:187]
ds_read_b128 v[60:63], v2 offset:52224
v_mul_f32 v215, v91, v107
v_mfma_f32_16x16x32_bf16 v[188:191], v[64:67], a[172:175], v[188:191]
buffer_load_dwordx4 v3, s[8:11], 0 offen offset:2048 sc1 lds
v_mfma_f32_16x16x32_bf16 v[188:191], v[68:71], a[188:191], v[188:191]
v_mul_f32 v208, v92, v92
s_waitcnt lgkmcnt(4)
v_mfma_f32_16x16x32_bf16 v[192:195], v[72:75], a[160:163], v[192:195]
v_exp_f32 v212, v212
v_mfma_f32_16x16x32_bf16 v[192:195], v[76:79], a[176:179], v[192:195]
v_exp_f32 v214, v214
v_mfma_f32_16x16x32_bf16 v[196:199], v[72:75], a[164:167], v[196:199]
ds_read_b128 v[64:67], v2 offset:53248
v_fma_f32 v212, v212, v242, v242
v_mfma_f32_16x16x32_bf16 v[196:199], v[76:79], a[180:183], v[196:199]
buffer_load_dwordx4 v3, s[8:11], 0 offen offset:3072 sc1 lds
v_mfma_f32_16x16x32_bf16 v[200:203], v[72:75], a[168:171], v[200:203]
s_add_u32 m0, s22, 4096
v_add_u32 v3, 4096, v3
v_mfma_f32_16x16x32_bf16 v[200:203], v[76:79], a[184:187], v[200:203]
ds_read_b128 v[68:71], v2 offset:54272
v_fma_f32 v214, v214, v242, v242
v_mfma_f32_16x16x32_bf16 v[204:207], v[72:75], a[172:175], v[204:207]
v_rcp_f32 v212, v212
v_mfma_f32_16x16x32_bf16 v[204:207], v[76:79], a[188:191], v[204:207]
v_mul_f32 v213, v213, v212
s_waitcnt lgkmcnt(4)
v_mfma_f32_16x16x32_bf16 v[176:179], v[48:51], a[192:195], v[176:179]
buffer_load_dwordx4 v3, s[8:11], 0 offen offset:0 sc1 lds
v_mfma_f32_16x16x32_bf16 v[176:179], v[52:55], a[208:211], v[176:179]
v_rcp_f32 v214, v214
v_mfma_f32_16x16x32_bf16 v[180:183], v[48:51], a[196:199], v[180:183]
ds_read_b128 v[72:75], v2 offset:55296
v_mul_f32 v215, v215, v214
v_mfma_f32_16x16x32_bf16 v[180:183], v[52:55], a[212:215], v[180:183]
v_cvt_pk_bf16_f32 v229, v213, v215
v_mul_f32 v210, v93, v93
v_mfma_f32_16x16x32_bf16 v[184:187], v[48:51], a[200:203], v[184:187]
buffer_store_dwordx2 v[228:229], v250, s[8:11], s30 offen sc1
v_mfma_f32_16x16x32_bf16 v[184:187], v[52:55], a[216:219], v[184:187]
ds_read_b128 v[76:79], v2 offset:56320
v_fma_f32 v208, v208, v245, v244
v_mfma_f32_16x16x32_bf16 v[188:191], v[48:51], a[204:207], v[188:191]
v_fma_f32 v210, v210, v245, v244
v_mul_f32 v208, v208, v92
v_mfma_f32_16x16x32_bf16 v[188:191], v[52:55], a[220:223], v[188:191]
v_mul_f32 v210, v210, v93
s_waitcnt lgkmcnt(4)
v_mfma_f32_16x16x32_bf16 v[192:195], v[56:59], a[192:195], v[192:195]
v_exp_f32 v208, v208
v_mfma_f32_16x16x32_bf16 v[192:195], v[60:63], a[208:211], v[192:195]
buffer_load_dwordx4 v3, s[8:11], 0 offen offset:1024 sc1 lds
v_mfma_f32_16x16x32_bf16 v[196:199], v[56:59], a[196:199], v[196:199]
ds_read_b128 v[48:51], v2 offset:57344
v_mul_f32 v209, v92, v108
v_mfma_f32_16x16x32_bf16 v[196:199], v[60:63], a[212:215], v[196:199]
v_exp_f32 v210, v210
v_mfma_f32_16x16x32_bf16 v[200:203], v[56:59], a[200:203], v[200:203]
v_mul_f32 v211, v93, v109
v_fma_f32 v208, v208, v246, v246
v_mfma_f32_16x16x32_bf16 v[200:203], v[60:63], a[216:219], v[200:203]
ds_read_b128 v[52:55], v2 offset:58368
v_fma_f32 v210, v210, v246, v246
v_mfma_f32_16x16x32_bf16 v[204:207], v[56:59], a[204:207], v[204:207]
v_rcp_f32 v208, v208
v_mfma_f32_16x16x32_bf16 v[204:207], v[60:63], a[220:223], v[204:207]
v_mul_f32 v209, v209, v208
s_waitcnt lgkmcnt(4)
v_mfma_f32_16x16x32_bf16 v[176:179], v[64:67], a[224:227], v[176:179]
v_rcp_f32 v210, v210
v_mfma_f32_16x16x32_bf16 v[176:179], v[68:71], a[240:243], v[176:179]
v_mul_f32 v211, v211, v210
v_cvt_pk_bf16_f32 v230, v209, v211
v_mfma_f32_16x16x32_bf16 v[180:183], v[64:67], a[228:231], v[180:183]
ds_read_b128 v[56:59], v2 offset:59392
v_mul_f32 v212, v94, v94
v_mfma_f32_16x16x32_bf16 v[180:183], v[68:71], a[244:247], v[180:183]
v_mul_f32 v214, v95, v95
v_fma_f32 v212, v212, v245, v244
v_mfma_f32_16x16x32_bf16 v[184:187], v[64:67], a[232:235], v[184:187]
v_fma_f32 v214, v214, v245, v244
v_mul_f32 v212, v212, v94
v_mfma_f32_16x16x32_bf16 v[184:187], v[68:71], a[248:251], v[184:187]
ds_read_b128 v[60:63], v2 offset:60416
v_mul_f32 v214, v214, v95
v_mfma_f32_16x16x32_bf16 v[188:191], v[64:67], a[236:239], v[188:191]
v_exp_f32 v212, v212
v_mfma_f32_16x16x32_bf16 v[188:191], v[68:71], a[252:255], v[188:191]
v_mul_f32 v213, v94, v110
s_waitcnt lgkmcnt(4)
v_mfma_f32_16x16x32_bf16 v[192:195], v[72:75], a[224:227], v[192:195]
v_exp_f32 v214, v214
v_mfma_f32_16x16x32_bf16 v[192:195], v[76:79], a[240:243], v[192:195]
v_mul_f32 v215, v95, v111
v_fma_f32 v212, v212, v246, v246
v_mfma_f32_16x16x32_bf16 v[196:199], v[72:75], a[228:231], v[196:199]
ds_read_b128 v[64:67], v2 offset:61440
v_fma_f32 v214, v214, v246, v246
v_mfma_f32_16x16x32_bf16 v[196:199], v[76:79], a[244:247], v[196:199]
v_rcp_f32 v212, v212
v_mfma_f32_16x16x32_bf16 v[200:203], v[72:75], a[232:235], v[200:203]
v_rcp_f32 v214, v214
v_mfma_f32_16x16x32_bf16 v[200:203], v[76:79], a[248:251], v[200:203]
ds_read_b128 v[68:71], v2 offset:62464
v_mul_f32 v213, v213, v212
v_mfma_f32_16x16x32_bf16 v[204:207], v[72:75], a[236:239], v[204:207]
v_mul_f32 v215, v215, v214
v_cvt_pk_bf16_f32 v231, v213, v215
v_mfma_f32_16x16x32_bf16 v[204:207], v[76:79], a[252:255], v[204:207]
v_mul_f32 v208, v112, v112
s_waitcnt lgkmcnt(4)
v_mfma_f32_16x16x32_bf16 v[176:179], v[48:51], v[16:19], v[176:179]
buffer_store_dwordx2 v[230:231], v251, s[8:11], s30 offen sc1
v_mfma_f32_16x16x32_bf16 v[176:179], v[52:55], v[32:35], v[176:179]
v_mul_f32 v210, v113, v113
v_fma_f32 v208, v208, v233, v232
v_mfma_f32_16x16x32_bf16 v[180:183], v[48:51], v[20:23], v[180:183]
ds_read_b128 v[72:75], v2 offset:63488
v_fma_f32 v210, v210, v233, v232
v_mfma_f32_16x16x32_bf16 v[180:183], v[52:55], v[36:39], v[180:183]
v_mul_f32 v208, v208, v112
v_mul_f32 v210, v210, v113
v_mfma_f32_16x16x32_bf16 v[184:187], v[48:51], v[24:27], v[184:187]
v_exp_f32 v208, v208
v_mfma_f32_16x16x32_bf16 v[184:187], v[52:55], v[40:43], v[184:187]
ds_read_b128 v[76:79], v2 offset:64512
v_mul_f32 v209, v112, v128
v_mfma_f32_16x16x32_bf16 v[188:191], v[48:51], v[28:31], v[188:191]
v_exp_f32 v210, v210
v_mfma_f32_16x16x32_bf16 v[188:191], v[52:55], v[44:47], v[188:191]
v_mul_f32 v211, v113, v129
s_waitcnt lgkmcnt(4)
v_mfma_f32_16x16x32_bf16 v[192:195], v[56:59], v[16:19], v[192:195]
v_fma_f32 v208, v208, v234, v234
v_fma_f32 v210, v210, v234, v234
v_mfma_f32_16x16x32_bf16 v[192:195], v[60:63], v[32:35], v[192:195]
v_rcp_f32 v208, v208
v_mfma_f32_16x16x32_bf16 v[196:199], v[56:59], v[20:23], v[196:199]
ds_read_b128 v[48:51], v7 offset:0
v_mul_f32 v209, v209, v208
v_mfma_f32_16x16x32_bf16 v[196:199], v[60:63], v[36:39], v[196:199]
v_rcp_f32 v210, v210
v_mfma_f32_16x16x32_bf16 v[200:203], v[56:59], v[24:27], v[200:203]
v_mul_f32 v211, v211, v210
v_cvt_pk_bf16_f32 v144, v209, v211
v_mfma_f32_16x16x32_bf16 v[200:203], v[60:63], v[40:43], v[200:203]
ds_read_b128 v[52:55], v7 offset:1024
v_mul_f32 v212, v114, v114
v_mfma_f32_16x16x32_bf16 v[204:207], v[56:59], v[28:31], v[204:207]
v_mul_f32 v214, v115, v115
v_fma_f32 v212, v212, v233, v232
v_mfma_f32_16x16x32_bf16 v[204:207], v[60:63], v[44:47], v[204:207]
v_fma_f32 v214, v214, v233, v232
s_waitcnt lgkmcnt(4)
v_mfma_f32_16x16x32_bf16 v[80:83], v[64:67], a[0:3], 0
v_mul_f32 v212, v212, v114
v_mul_f32 v214, v214, v115
v_mfma_f32_16x16x32_bf16 v[80:83], v[68:71], a[16:19], v[80:83]
v_exp_f32 v212, v212
v_mfma_f32_16x16x32_bf16 v[84:87], v[64:67], a[4:7], 0
ds_read_b128 v[56:59], v7 offset:2048
v_mul_f32 v213, v114, v130
v_mfma_f32_16x16x32_bf16 v[84:87], v[68:71], a[20:23], v[84:87]
v_exp_f32 v214, v214
v_mfma_f32_16x16x32_bf16 v[88:91], v[64:67], a[8:11], 0
v_mul_f32 v215, v115, v131
v_fma_f32 v212, v212, v234, v234
v_mfma_f32_16x16x32_bf16 v[88:91], v[68:71], a[24:27], v[88:91]
ds_read_b128 v[60:63], v7 offset:3072
v_fma_f32 v214, v214, v234, v234
v_mfma_f32_16x16x32_bf16 v[92:95], v[64:67], a[12:15], 0
v_rcp_f32 v212, v212
v_mfma_f32_16x16x32_bf16 v[92:95], v[68:71], a[28:31], v[92:95]
v_mul_f32 v213, v213, v212
s_waitcnt lgkmcnt(4)
v_mfma_f32_16x16x32_bf16 v[96:99], v[72:75], a[0:3], 0
v_rcp_f32 v214, v214
v_mfma_f32_16x16x32_bf16 v[96:99], v[76:79], a[16:19], v[96:99]
v_mul_f32 v215, v215, v214
v_cvt_pk_bf16_f32 v145, v213, v215
v_mfma_f32_16x16x32_bf16 v[100:103], v[72:75], a[4:7], 0
ds_read_b128 v[64:67], v7 offset:4096
v_mul_f32 v208, v116, v116
v_mfma_f32_16x16x32_bf16 v[100:103], v[76:79], a[20:23], v[100:103]
v_mul_f32 v210, v117, v117
v_fma_f32 v208, v208, v237, v236
v_mfma_f32_16x16x32_bf16 v[104:107], v[72:75], a[8:11], 0
v_fma_f32 v210, v210, v237, v236
v_mul_f32 v208, v208, v116
v_mfma_f32_16x16x32_bf16 v[104:107], v[76:79], a[24:27], v[104:107]
ds_read_b128 v[68:71], v7 offset:5120
v_mul_f32 v210, v210, v117
v_mfma_f32_16x16x32_bf16 v[108:111], v[72:75], a[12:15], 0
v_exp_f32 v208, v208
v_mfma_f32_16x16x32_bf16 v[108:111], v[76:79], a[28:31], v[108:111]
v_mul_f32 v209, v116, v132
s_waitcnt lgkmcnt(4)
v_mfma_f32_16x16x32_bf16 v[80:83], v[48:51], a[32:35], v[80:83]
v_exp_f32 v210, v210
v_mfma_f32_16x16x32_bf16 v[80:83], v[52:55], a[48:51], v[80:83]
v_mul_f32 v211, v117, v133
v_fma_f32 v208, v208, v238, v238
v_mfma_f32_16x16x32_bf16 v[84:87], v[48:51], a[36:39], v[84:87]
ds_read_b128 v[72:75], v7 offset:6144
v_fma_f32 v210, v210, v238, v238
v_mfma_f32_16x16x32_bf16 v[84:87], v[52:55], a[52:55], v[84:87]
v_rcp_f32 v208, v208
v_mfma_f32_16x16x32_bf16 v[88:91], v[48:51], a[40:43], v[88:91]
v_rcp_f32 v210, v210
v_mfma_f32_16x16x32_bf16 v[88:91], v[52:55], a[56:59], v[88:91]
ds_read_b128 v[76:79], v7 offset:7168
v_mul_f32 v209, v209, v208
v_mfma_f32_16x16x32_bf16 v[92:95], v[48:51], a[44:47], v[92:95]
v_mul_f32 v211, v211, v210
v_cvt_pk_bf16_f32 v148, v209, v211
v_mfma_f32_16x16x32_bf16 v[92:95], v[52:55], a[60:63], v[92:95]
v_mul_f32 v212, v118, v118
s_waitcnt lgkmcnt(4)
v_mfma_f32_16x16x32_bf16 v[96:99], v[56:59], a[32:35], v[96:99]
s_waitcnt vmcnt(22)
v_mul_f32 v214, v119, v119
v_mfma_f32_16x16x32_bf16 v[96:99], v[60:63], a[48:51], v[96:99]
s_barrier
v_mfma_f32_16x16x32_bf16 v[100:103], v[56:59], a[36:39], v[100:103]
ds_read_b128 v[48:51], v7 offset:8192
s_add_u32 m0, s22, 24576
v_mfma_f32_16x16x32_bf16 v[100:103], v[60:63], a[52:55], v[100:103]
v_add_u32 v3, 20480, v3
buffer_load_dwordx4 v3, s[8:11], 0 offen offset:0 sc1 lds
v_mfma_f32_16x16x32_bf16 v[104:107], v[56:59], a[40:43], v[104:107]
v_fma_f32 v212, v212, v237, v236
v_fma_f32 v214, v214, v237, v236
v_mfma_f32_16x16x32_bf16 v[104:107], v[60:63], a[56:59], v[104:107]
ds_read_b128 v[52:55], v7 offset:9216
v_mul_f32 v212, v212, v118
v_mfma_f32_16x16x32_bf16 v[108:111], v[56:59], a[44:47], v[108:111]
v_mul_f32 v214, v214, v119
v_mul_f32 v213, v118, v134
v_mfma_f32_16x16x32_bf16 v[108:111], v[60:63], a[60:63], v[108:111]
v_mul_f32 v215, v119, v135
s_waitcnt lgkmcnt(4)
v_mfma_f32_16x16x32_bf16 v[80:83], v[64:67], a[64:67], v[80:83]
buffer_load_dwordx4 v3, s[8:11], 0 offen offset:1024 sc1 lds
v_mfma_f32_16x16x32_bf16 v[80:83], v[68:71], a[80:83], v[80:83]
v_exp_f32 v212, v212
v_mfma_f32_16x16x32_bf16 v[84:87], v[64:67], a[68:71], v[84:87]
ds_read_b128 v[56:59], v7 offset:10240
v_fma_f32 v212, v212, v238, v238
v_mfma_f32_16x16x32_bf16 v[84:87], v[68:71], a[84:87], v[84:87]
v_exp_f32 v214, v214
v_mfma_f32_16x16x32_bf16 v[88:91], v[64:67], a[72:75], v[88:91]
v_fma_f32 v214, v214, v238, v238
v_mul_f32 v208, v120, v120
v_mfma_f32_16x16x32_bf16 v[88:91], v[68:71], a[88:91], v[88:91]
ds_read_b128 v[60:63], v7 offset:11264
v_mul_f32 v210, v121, v121
v_mfma_f32_16x16x32_bf16 v[92:95], v[64:67], a[76:79], v[92:95]
buffer_load_dwordx4 v3, s[8:11], 0 offen offset:2048 sc1 lds
v_mfma_f32_16x16x32_bf16 v[92:95], v[68:71], a[92:95], v[92:95]
v_fma_f32 v208, v208, v241, v240
s_waitcnt lgkmcnt(4)
v_mfma_f32_16x16x32_bf16 v[96:99], v[72:75], a[64:67], v[96:99]
v_rcp_f32 v212, v212
v_mfma_f32_16x16x32_bf16 v[96:99], v[76:79], a[80:83], v[96:99]
v_rcp_f32 v214, v214
v_mfma_f32_16x16x32_bf16 v[100:103], v[72:75], a[68:71], v[100:103]
ds_read_b128 v[64:67], v7 offset:12288
v_mul_f32 v213, v213, v212
v_mfma_f32_16x16x32_bf16 v[100:103], v[76:79], a[84:87], v[100:103]
buffer_load_dwordx4 v3, s[8:11], 0 offen offset:3072 sc1 lds
v_mfma_f32_16x16x32_bf16 v[104:107], v[72:75], a[72:75], v[104:107]
s_add_u32 m0, s22, 28672
v_add_u32 v3, 4096, v3
v_mfma_f32_16x16x32_bf16 v[104:107], v[76:79], a[88:91], v[104:107]
ds_read_b128 v[68:71], v7 offset:13312
v_mul_f32 v215, v215, v214
v_mfma_f32_16x16x32_bf16 v[108:111], v[72:75], a[76:79], v[108:111]
v_cvt_pk_bf16_f32 v149, v213, v215
v_fma_f32 v210, v210, v241, v240
v_mfma_f32_16x16x32_bf16 v[108:111], v[76:79], a[92:95], v[108:111]
v_mul_f32 v208, v208, v120
s_waitcnt lgkmcnt(4)
v_mfma_f32_16x16x32_bf16 v[80:83], v[48:51], a[96:99], v[80:83]
buffer_load_dwordx4 v3, s[8:11], 0 offen offset:0 sc1 lds
v_mfma_f32_16x16x32_bf16 v[80:83], v[52:55], a[112:115], v[80:83]
v_mul_f32 v210, v210, v121
v_mul_f32 v209, v120, v136
v_mfma_f32_16x16x32_bf16 v[84:87], v[48:51], a[100:103], v[84:87]
ds_read_b128 v[72:75], v7 offset:14336
v_mul_f32 v211, v121, v137
v_mfma_f32_16x16x32_bf16 v[84:87], v[52:55], a[116:119], v[84:87]
v_exp_f32 v208, v208
v_mfma_f32_16x16x32_bf16 v[88:91], v[48:51], a[104:107], v[88:91]
v_exp_f32 v210, v210
v_mfma_f32_16x16x32_bf16 v[88:91], v[52:55], a[120:123], v[88:91]
ds_read_b128 v[76:79], v7 offset:15360
v_fma_f32 v208, v208, v242, v242
v_mfma_f32_16x16x32_bf16 v[92:95], v[48:51], a[108:111], v[92:95]
buffer_load_dwordx4 v3, s[8:11], 0 offen offset:1024 sc1 lds
v_mfma_f32_16x16x32_bf16 v[92:95], v[52:55], a[124:127], v[92:95]
v_fma_f32 v210, v210, v242, v242
s_waitcnt lgkmcnt(4)
v_mfma_f32_16x16x32_bf16 v[96:99], v[56:59], a[96:99], v[96:99]
v_rcp_f32 v208, v208
v_mfma_f32_16x16x32_bf16 v[96:99], v[60:63], a[112:115], v[96:99]
v_rcp_f32 v210, v210
v_mfma_f32_16x16x32_bf16 v[100:103], v[56:59], a[100:103], v[100:103]
ds_read_b128 v[48:51], v7 offset:16384
v_mul_f32 v209, v209, v208
v_mfma_f32_16x16x32_bf16 v[100:103], v[60:63], a[116:119], v[100:103]
v_mul_f32 v211, v211, v210
v_cvt_pk_bf16_f32 v152, v209, v211
v_mfma_f32_16x16x32_bf16 v[104:107], v[56:59], a[104:107], v[104:107]
v_mul_f32 v212, v122, v122
v_mul_f32 v214, v123, v123
v_mfma_f32_16x16x32_bf16 v[104:107], v[60:63], a[120:123], v[104:107]
ds_read_b128 v[52:55], v7 offset:17408
v_fma_f32 v212, v212, v241, v240
v_mfma_f32_16x16x32_bf16 v[108:111], v[56:59], a[108:111], v[108:111]
v_fma_f32 v214, v214, v241, v240
v_mul_f32 v212, v212, v122
v_mfma_f32_16x16x32_bf16 v[108:111], v[60:63], a[124:127], v[108:111]
v_mul_f32 v214, v214, v123
s_waitcnt lgkmcnt(4)
v_mfma_f32_16x16x32_bf16 v[80:83], v[64:67], a[128:131], v[80:83]
v_exp_f32 v212, v212
v_mfma_f32_16x16x32_bf16 v[80:83], v[68:71], a[144:147], v[80:83]
v_exp_f32 v214, v214
v_mfma_f32_16x16x32_bf16 v[84:87], v[64:67], a[132:135], v[84:87]
ds_read_b128 v[56:59], v7 offset:18432
v_mul_f32 v213, v122, v138
v_mfma_f32_16x16x32_bf16 v[84:87], v[68:71], a[148:151], v[84:87]
v_mul_f32 v215, v123, v139
v_fma_f32 v212, v212, v242, v242
v_mfma_f32_16x16x32_bf16 v[88:91], v[64:67], a[136:139], v[88:91]
v_fma_f32 v214, v214, v242, v242
v_mul_f32 v208, v124, v124
v_mfma_f32_16x16x32_bf16 v[88:91], v[68:71], a[152:155], v[88:91]
ds_read_b128 v[60:63], v7 offset:19456
v_mul_f32 v210, v125, v125
v_mfma_f32_16x16x32_bf16 v[92:95], v[64:67], a[140:143], v[92:95]
v_rcp_f32 v212, v212
v_mfma_f32_16x16x32_bf16 v[92:95], v[68:71], a[156:159], v[92:95]
v_mul_f32 v213, v213, v212
s_waitcnt lgkmcnt(4)
v_mfma_f32_16x16x32_bf16 v[96:99], v[72:75], a[128:131], v[96:99]
v_rcp_f32 v214, v214
v_mfma_f32_16x16x32_bf16 v[96:99], v[76:79], a[144:147], v[96:99]
v_mul_f32 v215, v215, v214
v_cvt_pk_bf16_f32 v153, v213, v215
v_mfma_f32_16x16x32_bf16 v[100:103], v[72:75], a[132:135], v[100:103]
ds_read_b128 v[64:67], v7 offset:20480
v_fma_f32 v208, v208, v245, v244
v_mfma_f32_16x16x32_bf16 v[100:103], v[76:79], a[148:151], v[100:103]
v_fma_f32 v210, v210, v245, v244
v_mul_f32 v208, v208, v124
v_mfma_f32_16x16x32_bf16 v[104:107], v[72:75], a[136:139], v[104:107]
v_mul_f32 v210, v210, v125
v_mul_f32 v209, v124, v140
v_mfma_f32_16x16x32_bf16 v[104:107], v[76:79], a[152:155], v[104:107]
ds_read_b128 v[68:71], v7 offset:21504
v_mul_f32 v211, v125, v141
v_mfma_f32_16x16x32_bf16 v[108:111], v[72:75], a[140:143], v[108:111]
v_exp_f32 v208, v208
v_mfma_f32_16x16x32_bf16 v[108:111], v[76:79], a[156:159], v[108:111]
v_fma_f32 v208, v208, v246, v246
s_waitcnt lgkmcnt(4)
v_mfma_f32_16x16x32_bf16 v[80:83], v[48:51], a[160:163], v[80:83]
v_exp_f32 v210, v210
v_mfma_f32_16x16x32_bf16 v[80:83], v[52:55], a[176:179], v[80:83]
v_fma_f32 v210, v210, v246, v246
v_mul_f32 v212, v126, v126
v_mfma_f32_16x16x32_bf16 v[84:87], v[48:51], a[164:167], v[84:87]
ds_read_b128 v[72:75], v7 offset:22528
v_mul_f32 v214, v127, v127
v_mfma_f32_16x16x32_bf16 v[84:87], v[52:55], a[180:183], v[84:87]
v_rcp_f32 v208, v208
v_mfma_f32_16x16x32_bf16 v[88:91], v[48:51], a[168:171], v[88:91]
v_rcp_f32 v210, v210
v_mfma_f32_16x16x32_bf16 v[88:91], v[52:55], a[184:187], v[88:91]
ds_read_b128 v[76:79], v7 offset:23552
v_mul_f32 v209, v209, v208
v_mfma_f32_16x16x32_bf16 v[92:95], v[48:51], a[172:175], v[92:95]
v_mul_f32 v211, v211, v210
v_cvt_pk_bf16_f32 v156, v209, v211
v_mfma_f32_16x16x32_bf16 v[92:95], v[52:55], a[188:191], v[92:95]
v_fma_f32 v212, v212, v245, v244
s_waitcnt lgkmcnt(4)
v_mfma_f32_16x16x32_bf16 v[96:99], v[56:59], a[160:163], v[96:99]
v_fma_f32 v214, v214, v245, v244
v_mul_f32 v212, v212, v126
v_mfma_f32_16x16x32_bf16 v[96:99], v[60:63], a[176:179], v[96:99]
v_mul_f32 v214, v214, v127
v_mul_f32 v213, v126, v142
v_mfma_f32_16x16x32_bf16 v[100:103], v[56:59], a[164:167], v[100:103]
ds_read_b128 v[48:51], v7 offset:24576
v_mul_f32 v215, v127, v143
v_mfma_f32_16x16x32_bf16 v[100:103], v[60:63], a[180:183], v[100:103]
v_exp_f32 v212, v212
v_mfma_f32_16x16x32_bf16 v[104:107], v[56:59], a[168:171], v[104:107]
v_exp_f32 v214, v214
v_mfma_f32_16x16x32_bf16 v[104:107], v[60:63], a[184:187], v[104:107]
ds_read_b128 v[52:55], v7 offset:25600
v_fma_f32 v212, v212, v246, v246
v_mfma_f32_16x16x32_bf16 v[108:111], v[56:59], a[172:175], v[108:111]
v_fma_f32 v214, v214, v246, v246
v_mul_f32 v216, v176, v176
v_mfma_f32_16x16x32_bf16 v[108:111], v[60:63], a[188:191], v[108:111]
v_mul_f32 v218, v177, v177
s_waitcnt lgkmcnt(4)
v_mfma_f32_16x16x32_bf16 v[80:83], v[64:67], a[192:195], v[80:83]
v_rcp_f32 v212, v212
v_mfma_f32_16x16x32_bf16 v[80:83], v[68:71], a[208:211], v[80:83]
v_rcp_f32 v214, v214
v_mfma_f32_16x16x32_bf16 v[84:87], v[64:67], a[196:199], v[84:87]
ds_read_b128 v[56:59], v7 offset:26624
v_mul_f32 v213, v213, v212
v_mfma_f32_16x16x32_bf16 v[84:87], v[68:71], a[212:215], v[84:87]
v_mul_f32 v215, v215, v214
v_cvt_pk_bf16_f32 v157, v213, v215
v_mfma_f32_16x16x32_bf16 v[88:91], v[64:67], a[200:203], v[88:91]
v_fma_f32 v216, v216, v233, v232
v_fma_f32 v218, v218, v233, v232
v_mfma_f32_16x16x32_bf16 v[88:91], v[68:71], a[216:219], v[88:91]
ds_read_b128 v[60:63], v7 offset:27648
v_mul_f32 v216, v216, v176
v_mfma_f32_16x16x32_bf16 v[92:95], v[64:67], a[204:207], v[92:95]
v_mul_f32 v218, v218, v177
v_mul_f32 v217, v176, v192
v_mfma_f32_16x16x32_bf16 v[92:95], v[68:71], a[220:223], v[92:95]
v_mul_f32 v219, v177, v193
s_waitcnt lgkmcnt(4)
v_mfma_f32_16x16x32_bf16 v[96:99], v[72:75], a[192:195], v[96:99]
v_exp_f32 v216, v216
v_mfma_f32_16x16x32_bf16 v[96:99], v[76:79], a[208:211], v[96:99]
v_exp_f32 v218, v218
v_mfma_f32_16x16x32_bf16 v[100:103], v[72:75], a[196:199], v[100:103]
ds_read_b128 v[64:67], v7 offset:28672
v_fma_f32 v216, v216, v234, v234
v_mfma_f32_16x16x32_bf16 v[100:103], v[76:79], a[212:215], v[100:103]
v_fma_f32 v218, v218, v234, v234
v_mul_f32 v220, v178, v178
v_mfma_f32_16x16x32_bf16 v[104:107], v[72:75], a[200:203], v[104:107]
v_rcp_f32 v216, v216
v_mfma_f32_16x16x32_bf16 v[104:107], v[76:79], a[216:219], v[104:107]
ds_read_b128 v[68:71], v7 offset:29696
v_mul_f32 v217, v217, v216
v_mfma_f32_16x16x32_bf16 v[108:111], v[72:75], a[204:207], v[108:111]
v_rcp_f32 v218, v218
v_mfma_f32_16x16x32_bf16 v[108:111], v[76:79], a[220:223], v[108:111]
v_mul_f32 v219, v219, v218
s_waitcnt lgkmcnt(4)
v_mfma_f32_16x16x32_bf16 v[80:83], v[48:51], a[224:227], v[80:83]
v_cvt_pk_bf16_f32 v146, v217, v219
v_mul_f32 v222, v179, v179
v_mfma_f32_16x16x32_bf16 v[80:83], v[52:55], a[240:243], v[80:83]
v_fma_f32 v220, v220, v233, v232
v_fma_f32 v222, v222, v233, v232
v_mfma_f32_16x16x32_bf16 v[84:87], v[48:51], a[228:231], v[84:87]
ds_read_b128 v[72:75], v7 offset:30720
v_mul_f32 v220, v220, v178
v_mfma_f32_16x16x32_bf16 v[84:87], v[52:55], a[244:247], v[84:87]
v_mul_f32 v222, v222, v179
v_mul_f32 v221, v178, v194
v_mfma_f32_16x16x32_bf16 v[88:91], v[48:51], a[232:235], v[88:91]
v_exp_f32 v220, v220
v_mfma_f32_16x16x32_bf16 v[88:91], v[52:55], a[248:251], v[88:91]
ds_read_b128 v[76:79], v7 offset:31744
v_mul_f32 v223, v179, v195
v_mfma_f32_16x16x32_bf16 v[92:95], v[48:51], a[236:239], v[92:95]
v_exp_f32 v222, v222
v_mfma_f32_16x16x32_bf16 v[92:95], v[52:55], a[252:255], v[92:95]
v_fma_f32 v220, v220, v234, v234
s_waitcnt lgkmcnt(4)
v_mfma_f32_16x16x32_bf16 v[96:99], v[56:59], a[224:227], v[96:99]
s_waitcnt vmcnt(22)
v_fma_f32 v222, v222, v234, v234
v_mfma_f32_16x16x32_bf16 v[96:99], v[60:63], a[240:243], v[96:99]
s_barrier
v_mfma_f32_16x16x32_bf16 v[100:103], v[56:59], a[228:231], v[100:103]
ds_read_b128 v[48:51], v7 offset:32768
s_add_u32 m0, s22, 49152
v_mfma_f32_16x16x32_bf16 v[100:103], v[60:63], a[244:247], v[100:103]
v_add_u32 v3, 20480, v3
buffer_load_dwordx4 v3, s[8:11], 0 offen offset:0 sc1 lds
v_mfma_f32_16x16x32_bf16 v[104:107], v[56:59], a[232:235], v[104:107]
v_rcp_f32 v220, v220
v_mfma_f32_16x16x32_bf16 v[104:107], v[60:63], a[248:251], v[104:107]
ds_read_b128 v[52:55], v7 offset:33792
v_mul_f32 v221, v221, v220
v_mfma_f32_16x16x32_bf16 v[108:111], v[56:59], a[236:239], v[108:111]
v_rcp_f32 v222, v222
v_mfma_f32_16x16x32_bf16 v[108:111], v[60:63], a[252:255], v[108:111]
v_mul_f32 v223, v223, v222
s_waitcnt lgkmcnt(4)
v_mfma_f32_16x16x32_bf16 v[80:83], v[64:67], v[16:19], v[80:83]
buffer_load_dwordx4 v3, s[8:11], 0 offen offset:1024 sc1 lds
v_mfma_f32_16x16x32_bf16 v[80:83], v[68:71], v[32:35], v[80:83]
v_cvt_pk_bf16_f32 v147, v221, v223
v_mul_f32 v216, v180, v180
v_mfma_f32_16x16x32_bf16 v[84:87], v[64:67], v[20:23], v[84:87]
ds_read_b128 v[56:59], v7 offset:34816
v_mul_f32 v218, v181, v181
v_mfma_f32_16x16x32_bf16 v[84:87], v[68:71], v[36:39], v[84:87]
buffer_store_dwordx4 v[144:147], v2, s[8:11], s24 offen offset:0 sc1
v_mfma_f32_16x16x32_bf16 v[88:91], v[64:67], v[24:27], v[88:91]
v_fma_f32 v216, v216, v237, v236
v_fma_f32 v218, v218, v237, v236
v_mfma_f32_16x16x32_bf16 v[88:91], v[68:71], v[40:43], v[88:91]
ds_read_b128 v[60:63], v7 offset:35840
v_mul_f32 v216, v216, v180
v_mfma_f32_16x16x32_bf16 v[92:95], v[64:67], v[28:31], v[92:95]
v_mul_f32 v218, v218, v181
v_mul_f32 v217, v180, v196
v_mfma_f32_16x16x32_bf16 v[92:95], v[68:71], v[44:47], v[92:95]
v_mul_f32 v219, v181, v197
s_waitcnt lgkmcnt(4)
v_mfma_f32_16x16x32_bf16 v[96:99], v[72:75], v[16:19], v[96:99]
buffer_load_dwordx4 v3, s[8:11], 0 offen offset:2048 sc1 lds
v_mfma_f32_16x16x32_bf16 v[96:99], v[76:79], v[32:35], v[96:99]
v_exp_f32 v216, v216
v_mfma_f32_16x16x32_bf16 v[100:103], v[72:75], v[20:23], v[100:103]
ds_read_b128 v[64:67], v7 offset:36864
v_fma_f32 v216, v216, v238, v238
v_mfma_f32_16x16x32_bf16 v[100:103], v[76:79], v[36:39], v[100:103]
v_exp_f32 v218, v218
v_mfma_f32_16x16x32_bf16 v[104:107], v[72:75], v[24:27], v[104:107]
v_fma_f32 v218, v218, v238, v238
v_mul_f32 v220, v182, v182
v_mfma_f32_16x16x32_bf16 v[104:107], v[76:79], v[40:43], v[104:107]
ds_read_b128 v[68:71], v7 offset:37888
v_mul_f32 v222, v183, v183
v_mfma_f32_16x16x32_bf16 v[108:111], v[72:75], v[28:31], v[108:111]
buffer_load_dwordx4 v3, s[8:11], 0 offen offset:3072 sc1 lds
v_mfma_f32_16x16x32_bf16 v[108:111], v[76:79], v[44:47], v[108:111]
s_add_u32 m0, s22, 53248
s_waitcnt lgkmcnt(4)
v_mfma_f32_16x16x32_bf16 v[112:115], v[48:51], a[0:3], 0
v_add_u32 v3, 4096, v3
v_fma_f32 v220, v220, v237, v236
v_mfma_f32_16x16x32_bf16 v[112:115], v[52:55], a[16:19], v[112:115]
v_rcp_f32 v216, v216
v_mfma_f32_16x16x32_bf16 v[116:119], v[48:51], a[4:7], 0
ds_read_b128 v[72:75], v7 offset:38912
v_mul_f32 v217, v217, v216
v_mfma_f32_16x16x32_bf16 v[116:119], v[52:55], a[20:23], v[116:119]
buffer_load_dwordx4 v3, s[8:11], 0 offen offset:0 sc1 lds
v_mfma_f32_16x16x32_bf16 v[120:123], v[48:51], a[8:11], 0
v_mul_f32 v208, v80, v80
v_mul_f32 v210, v81, v81
v_mfma_f32_16x16x32_bf16 v[120:123], v[52:55], a[24:27], v[120:123]
ds_read_b128 v[76:79], v7 offset:39936
v_fma_f32 v208, v208, v233, v232
v_mfma_f32_16x16x32_bf16 v[124:127], v[48:51], a[12:15], 0
v_fma_f32 v210, v210, v233, v232
v_mul_f32 v208, v208, v80
v_mfma_f32_16x16x32_bf16 v[124:127], v[52:55], a[28:31], v[124:127]
v_mul_f32 v210, v210, v81
s_waitcnt lgkmcnt(4)
v_mfma_f32_16x16x32_bf16 v[128:131], v[56:59], a[0:3], 0
buffer_load_dwordx4 v3, s[8:11], 0 offen offset:1024 sc1 lds
v_mfma_f32_16x16x32_bf16 v[128:131], v[60:63], a[16:19], v[128:131]
v_exp_f32 v208, v208
v_mfma_f32_16x16x32_bf16 v[132:135], v[56:59], a[4:7], 0
ds_read_b128 v[48:51], v7 offset:40960
v_mul_f32 v209, v80, v96
v_mfma_f32_16x16x32_bf16 v[132:135], v[60:63], a[20:23], v[132:135]
v_exp_f32 v210, v210
v_mfma_f32_16x16x32_bf16 v[136:139], v[56:59], a[8:11], 0
v_mul_f32 v211, v81, v97
v_fma_f32 v208, v208, v234, v234
v_mfma_f32_16x16x32_bf16 v[136:139], v[60:63], a[24:27], v[136:139]
ds_read_b128 v[52:55], v7 offset:41984
v_fma_f32 v210, v210, v234, v234
v_mfma_f32_16x16x32_bf16 v[140:143], v[56:59], a[12:15], 0
v_rcp_f32 v208, v208
v_mfma_f32_16x16x32_bf16 v[140:143], v[60:63], a[28:31], v[140:143]
v_mul_f32 v209, v209, v208
s_waitcnt lgkmcnt(4)
v_mfma_f32_16x16x32_bf16 v[112:115], v[64:67], a[32:35], v[112:115]
v_rcp_f32 v210, v210
v_mfma_f32_16x16x32_bf16 v[112:115], v[68:71], a[48:51], v[112:115]
v_mul_f32 v211, v211, v210
v_cvt_pk_bf16_f32 v160, v209, v211
v_mfma_f32_16x16x32_bf16 v[116:119], v[64:67], a[36:39], v[116:119]
ds_read_b128 v[56:59], v7 offset:43008
v_mul_f32 v212, v82, v82
v_mfma_f32_16x16x32_bf16 v[116:119], v[68:71], a[52:55], v[116:119]
v_mul_f32 v214, v83, v83
v_fma_f32 v212, v212, v233, v232
v_mfma_f32_16x16x32_bf16 v[120:123], v[64:67], a[40:43], v[120:123]
v_fma_f32 v214, v214, v233, v232
v_mul_f32 v212, v212, v82
v_mfma_f32_16x16x32_bf16 v[120:123], v[68:71], a[56:59], v[120:123]
ds_read_b128 v[60:63], v7 offset:44032
v_mul_f32 v214, v214, v83
v_mfma_f32_16x16x32_bf16 v[124:127], v[64:67], a[44:47], v[124:127]
v_exp_f32 v212, v212
v_mfma_f32_16x16x32_bf16 v[124:127], v[68:71], a[60:63], v[124:127]
v_mul_f32 v213, v82, v98
s_waitcnt lgkmcnt(4)
v_mfma_f32_16x16x32_bf16 v[128:131], v[72:75], a[32:35], v[128:131]
v_exp_f32 v214, v214
v_mfma_f32_16x16x32_bf16 v[128:131], v[76:79], a[48:51], v[128:131]
v_mul_f32 v215, v83, v99
v_fma_f32 v212, v212, v234, v234
v_mfma_f32_16x16x32_bf16 v[132:135], v[72:75], a[36:39], v[132:135]
ds_read_b128 v[64:67], v7 offset:45056
v_fma_f32 v214, v214, v234, v234
v_mfma_f32_16x16x32_bf16 v[132:135], v[76:79], a[52:55], v[132:135]
v_rcp_f32 v212, v212
v_mfma_f32_16x16x32_bf16 v[136:139], v[72:75], a[40:43], v[136:139]
v_rcp_f32 v214, v214
v_mfma_f32_16x16x32_bf16 v[136:139], v[76:79], a[56:59], v[136:139]
ds_read_b128 v[68:71], v7 offset:46080
v_mul_f32 v213, v213, v212
v_mfma_f32_16x16x32_bf16 v[140:143], v[72:75], a[44:47], v[140:143]
v_mul_f32 v215, v215, v214
v_cvt_pk_bf16_f32 v161, v213, v215
v_mfma_f32_16x16x32_bf16 v[140:143], v[76:79], a[60:63], v[140:143]
v_mul_f32 v208, v84, v84
s_waitcnt lgkmcnt(4)
v_mfma_f32_16x16x32_bf16 v[112:115], v[48:51], a[64:67], v[112:115]
v_mul_f32 v210, v85, v85
v_fma_f32 v208, v208, v237, v236
v_mfma_f32_16x16x32_bf16 v[112:115], v[52:55], a[80:83], v[112:115]
v_fma_f32 v210, v210, v237, v236
v_mul_f32 v208, v208, v84
v_mfma_f32_16x16x32_bf16 v[116:119], v[48:51], a[68:71], v[116:119]
ds_read_b128 v[72:75], v7 offset:47104
v_mul_f32 v210, v210, v85
v_mfma_f32_16x16x32_bf16 v[116:119], v[52:55], a[84:87], v[116:119]
v_exp_f32 v208, v208
v_mfma_f32_16x16x32_bf16 v[120:123], v[48:51], a[72:75], v[120:123]
v_exp_f32 v210, v210
v_mfma_f32_16x16x32_bf16 v[120:123], v[52:55], a[88:91], v[120:123]
ds_read_b128 v[76:79], v7 offset:48128
v_mul_f32 v209, v84, v100
v_mfma_f32_16x16x32_bf16 v[124:127], v[48:51], a[76:79], v[124:127]
v_mul_f32 v211, v85, v101
v_fma_f32 v208, v208, v238, v238
v_mfma_f32_16x16x32_bf16 v[124:127], v[52:55], a[92:95], v[124:127]
v_fma_f32 v210, v210, v238, v238
s_waitcnt lgkmcnt(4)
v_mfma_f32_16x16x32_bf16 v[128:131], v[56:59], a[64:67], v[128:131]
v_rcp_f32 v208, v208
v_mfma_f32_16x16x32_bf16 v[128:131], v[60:63], a[80:83], v[128:131]
v_rcp_f32 v210, v210
v_mfma_f32_16x16x32_bf16 v[132:135], v[56:59], a[68:71], v[132:135]
ds_read_b128 v[48:51], v7 offset:49152
v_mul_f32 v209, v209, v208
v_mfma_f32_16x16x32_bf16 v[132:135], v[60:63], a[84:87], v[132:135]
v_mul_f32 v211, v211, v210
v_cvt_pk_bf16_f32 v164, v209, v211
v_mfma_f32_16x16x32_bf16 v[136:139], v[56:59], a[72:75], v[136:139]
v_mul_f32 v212, v86, v86
v_mul_f32 v214, v87, v87
v_mfma_f32_16x16x32_bf16 v[136:139], v[60:63], a[88:91], v[136:139]
ds_read_b128 v[52:55], v7 offset:50176
v_fma_f32 v212, v212, v237, v236
v_mfma_f32_16x16x32_bf16 v[140:143], v[56:59], a[76:79], v[140:143]
v_fma_f32 v214, v214, v237, v236
v_mul_f32 v212, v212, v86
v_mfma_f32_16x16x32_bf16 v[140:143], v[60:63], a[92:95], v[140:143]
v_mul_f32 v214, v214, v87
s_waitcnt lgkmcnt(4)
v_mfma_f32_16x16x32_bf16 v[112:115], v[64:67], a[96:99], v[112:115]
v_exp_f32 v212, v212
v_mfma_f32_16x16x32_bf16 v[112:115], v[68:71], a[112:115], v[112:115]
v_exp_f32 v214, v214
v_mfma_f32_16x16x32_bf16 v[116:119], v[64:67], a[100:103], v[116:119]
ds_read_b128 v[56:59], v7 offset:51200
v_mul_f32 v213, v86, v102
v_mfma_f32_16x16x32_bf16 v[116:119], v[68:71], a[116:119], v[116:119]
v_mul_f32 v215, v87, v103
v_fma_f32 v212, v212, v238, v238
v_mfma_f32_16x16x32_bf16 v[120:123], v[64:67], a[104:107], v[120:123]
v_fma_f32 v214, v214, v238, v238
v_mul_f32 v208, v88, v88
v_mfma_f32_16x16x32_bf16 v[120:123], v[68:71], a[120:123], v[120:123]
ds_read_b128 v[60:63], v7 offset:52224
v_mul_f32 v210, v89, v89
v_mfma_f32_16x16x32_bf16 v[124:127], v[64:67], a[108:111], v[124:127]
v_rcp_f32 v212, v212
v_mfma_f32_16x16x32_bf16 v[124:127], v[68:71], a[124:127], v[124:127]
v_mul_f32 v213, v213, v212
s_waitcnt lgkmcnt(4)
v_mfma_f32_16x16x32_bf16 v[128:131], v[72:75], a[96:99], v[128:131]
v_rcp_f32 v214, v214
v_mfma_f32_16x16x32_bf16 v[128:131], v[76:79], a[112:115], v[128:131]
v_mul_f32 v215, v215, v214
v_cvt_pk_bf16_f32 v165, v213, v215
v_mfma_f32_16x16x32_bf16 v[132:135], v[72:75], a[100:103], v[132:135]
ds_read_b128 v[64:67], v7 offset:53248
v_fma_f32 v208, v208, v241, v240
v_mfma_f32_16x16x32_bf16 v[132:135], v[76:79], a[116:119], v[132:135]
v_fma_f32 v210, v210, v241, v240
v_mul_f32 v208, v208, v88
v_mfma_f32_16x16x32_bf16 v[136:139], v[72:75], a[104:107], v[136:139]
v_mul_f32 v210, v210, v89
v_mul_f32 v209, v88, v104
v_mfma_f32_16x16x32_bf16 v[136:139], v[76:79], a[120:123], v[136:139]
ds_read_b128 v[68:71], v7 offset:54272
v_mul_f32 v211, v89, v105
v_mfma_f32_16x16x32_bf16 v[140:143], v[72:75], a[108:111], v[140:143]
v_exp_f32 v208, v208
v_mfma_f32_16x16x32_bf16 v[140:143], v[76:79], a[124:127], v[140:143]
v_fma_f32 v208, v208, v242, v242
s_waitcnt lgkmcnt(4)
v_mfma_f32_16x16x32_bf16 v[112:115], v[48:51], a[128:131], v[112:115]
v_exp_f32 v210, v210
v_mfma_f32_16x16x32_bf16 v[112:115], v[52:55], a[144:147], v[112:115]
v_fma_f32 v210, v210, v242, v242
v_mul_f32 v212, v90, v90
v_mfma_f32_16x16x32_bf16 v[116:119], v[48:51], a[132:135], v[116:119]
ds_read_b128 v[72:75], v7 offset:55296
v_mul_f32 v214, v91, v91
v_mfma_f32_16x16x32_bf16 v[116:119], v[52:55], a[148:151], v[116:119]
v_rcp_f32 v208, v208
v_mfma_f32_16x16x32_bf16 v[120:123], v[48:51], a[136:139], v[120:123]
v_rcp_f32 v210, v210
v_mfma_f32_16x16x32_bf16 v[120:123], v[52:55], a[152:155], v[120:123]
ds_read_b128 v[76:79], v7 offset:56320
v_mul_f32 v209, v209, v208
v_mfma_f32_16x16x32_bf16 v[124:127], v[48:51], a[140:143], v[124:127]
v_mul_f32 v211, v211, v210
v_cvt_pk_bf16_f32 v168, v209, v211
v_mfma_f32_16x16x32_bf16 v[124:127], v[52:55], a[156:159], v[124:127]
v_fma_f32 v212, v212, v241, v240
s_waitcnt lgkmcnt(4)
v_mfma_f32_16x16x32_bf16 v[128:131], v[56:59], a[128:131], v[128:131]
s_waitcnt vmcnt(23)
v_fma_f32 v214, v214, v241, v240
v_mfma_f32_16x16x32_bf16 v[128:131], v[60:63], a[144:147], v[128:131]
s_barrier
v_mfma_f32_16x16x32_bf16 v[132:135], v[56:59], a[132:135], v[132:135]
ds_read_b128 v[48:51], v7 offset:57344
s_add_u32 m0, s22, 73728
v_mfma_f32_16x16x32_bf16 v[132:135], v[60:63], a[148:151], v[132:135]
v_add_u32 v3, 20480, v3
buffer_load_dwordx4 v3, s[8:11], 0 offen offset:0 sc1 lds
v_mfma_f32_16x16x32_bf16 v[136:139], v[56:59], a[136:139], v[136:139]
v_mul_f32 v212, v212, v90
v_mul_f32 v214, v214, v91
v_mfma_f32_16x16x32_bf16 v[136:139], v[60:63], a[152:155], v[136:139]
ds_read_b128 v[52:55], v7 offset:58368
v_mul_f32 v213, v90, v106
v_mfma_f32_16x16x32_bf16 v[140:143], v[56:59], a[140:143], v[140:143]
v_exp_f32 v212, v212
v_mfma_f32_16x16x32_bf16 v[140:143], v[60:63], a[156:159], v[140:143]
v_mul_f32 v215, v91, v107
s_waitcnt lgkmcnt(4)
v_mfma_f32_16x16x32_bf16 v[112:115], v[64:67], a[160:163], v[112:115]
buffer_load_dwordx4 v3, s[8:11], 0 offen offset:1024 sc1 lds
v_mfma_f32_16x16x32_bf16 v[112:115], v[68:71], a[176:179], v[112:115]
v_exp_f32 v214, v214
v_mfma_f32_16x16x32_bf16 v[116:119], v[64:67], a[164:167], v[116:119]
ds_read_b128 v[56:59], v7 offset:59392
v_fma_f32 v212, v212, v242, v242
v_mfma_f32_16x16x32_bf16 v[116:119], v[68:71], a[180:183], v[116:119]
v_fma_f32 v214, v214, v242, v242
v_mul_f32 v208, v92, v92
v_mfma_f32_16x16x32_bf16 v[120:123], v[64:67], a[168:171], v[120:123]
v_rcp_f32 v212, v212
v_mfma_f32_16x16x32_bf16 v[120:123], v[68:71], a[184:187], v[120:123]
ds_read_b128 v[60:63], v7 offset:60416
v_mul_f32 v213, v213, v212
v_mfma_f32_16x16x32_bf16 v[124:127], v[64:67], a[172:175], v[124:127]
buffer_load_dwordx4 v3, s[8:11], 0 offen offset:2048 sc1 lds
v_mfma_f32_16x16x32_bf16 v[124:127], v[68:71], a[188:191], v[124:127]
v_mul_f32 v210, v93, v93
s_waitcnt lgkmcnt(4)
v_mfma_f32_16x16x32_bf16 v[128:131], v[72:75], a[160:163], v[128:131]
v_rcp_f32 v214, v214
v_mfma_f32_16x16x32_bf16 v[128:131], v[76:79], a[176:179], v[128:131]
v_mul_f32 v215, v215, v214
v_cvt_pk_bf16_f32 v169, v213, v215
v_mfma_f32_16x16x32_bf16 v[132:135], v[72:75], a[164:167], v[132:135]
ds_read_b128 v[64:67], v7 offset:61440
v_fma_f32 v208, v208, v245, v244
v_mfma_f32_16x16x32_bf16 v[132:135], v[76:79], a[180:183], v[132:135]
buffer_load_dwordx4 v3, s[8:11], 0 offen offset:3072 sc1 lds
v_mfma_f32_16x16x32_bf16 v[136:139], v[72:75], a[168:171], v[136:139]
s_add_u32 m0, s22, 77824
v_add_u32 v3, 4096, v3
v_mfma_f32_16x16x32_bf16 v[136:139], v[76:79], a[184:187], v[136:139]
ds_read_b128 v[68:71], v7 offset:62464
v_fma_f32 v210, v210, v245, v244
v_mfma_f32_16x16x32_bf16 v[140:143], v[72:75], a[172:175], v[140:143]
v_mul_f32 v208, v208, v92
v_mul_f32 v210, v210, v93
v_mfma_f32_16x16x32_bf16 v[140:143], v[76:79], a[188:191], v[140:143]
v_mul_f32 v209, v92, v108
s_waitcnt lgkmcnt(4)
v_mfma_f32_16x16x32_bf16 v[112:115], v[48:51], a[192:195], v[112:115]
buffer_load_dwordx4 v3, s[8:11], 0 offen offset:0 sc1 lds
v_mfma_f32_16x16x32_bf16 v[112:115], v[52:55], a[208:211], v[112:115]
v_exp_f32 v208, v208
v_mfma_f32_16x16x32_bf16 v[116:119], v[48:51], a[196:199], v[116:119]
ds_read_b128 v[72:75], v7 offset:63488
v_mul_f32 v211, v93, v109
v_mfma_f32_16x16x32_bf16 v[116:119], v[52:55], a[212:215], v[116:119]
v_exp_f32 v210, v210
v_mfma_f32_16x16x32_bf16 v[120:123], v[48:51], a[200:203], v[120:123]
v_fma_f32 v208, v208, v246, v246
v_fma_f32 v210, v210, v246, v246
v_mfma_f32_16x16x32_bf16 v[120:123], v[52:55], a[216:219], v[120:123]
ds_read_b128 v[76:79], v7 offset:64512
v_mul_f32 v212, v94, v94
v_mfma_f32_16x16x32_bf16 v[124:127], v[48:51], a[204:207], v[124:127]
buffer_load_dwordx4 v3, s[8:11], 0 offen offset:1024 sc1 lds
v_mfma_f32_16x16x32_bf16 v[124:127], v[52:55], a[220:223], v[124:127]
v_mul_f32 v214, v95, v95
s_waitcnt lgkmcnt(4)
v_mfma_f32_16x16x32_bf16 v[128:131], v[56:59], a[192:195], v[128:131]
v_rcp_f32 v208, v208
v_mfma_f32_16x16x32_bf16 v[128:131], v[60:63], a[208:211], v[128:131]
v_rcp_f32 v210, v210
v_mfma_f32_16x16x32_bf16 v[132:135], v[56:59], a[196:199], v[132:135]
ds_read_b128 v[48:51], v8 offset:0
v_mul_f32 v209, v209, v208
v_mfma_f32_16x16x32_bf16 v[132:135], v[60:63], a[212:215], v[132:135]
v_mul_f32 v211, v211, v210
v_cvt_pk_bf16_f32 v172, v209, v211
v_mfma_f32_16x16x32_bf16 v[136:139], v[56:59], a[200:203], v[136:139]
v_fma_f32 v212, v212, v245, v244
v_fma_f32 v214, v214, v245, v244
v_mfma_f32_16x16x32_bf16 v[136:139], v[60:63], a[216:219], v[136:139]
ds_read_b128 v[52:55], v8 offset:1024
v_mul_f32 v212, v212, v94
v_mfma_f32_16x16x32_bf16 v[140:143], v[56:59], a[204:207], v[140:143]
v_mul_f32 v214, v214, v95
v_mul_f32 v213, v94, v110
v_mfma_f32_16x16x32_bf16 v[140:143], v[60:63], a[220:223], v[140:143]
v_mul_f32 v215, v95, v111
s_waitcnt lgkmcnt(4)
v_mfma_f32_16x16x32_bf16 v[112:115], v[64:67], a[224:227], v[112:115]
v_exp_f32 v212, v212
v_mfma_f32_16x16x32_bf16 v[112:115], v[68:71], a[240:243], v[112:115]
v_exp_f32 v214, v214
v_mfma_f32_16x16x32_bf16 v[116:119], v[64:67], a[228:231], v[116:119]
ds_read_b128 v[56:59], v8 offset:2048
v_fma_f32 v212, v212, v246, v246
v_mfma_f32_16x16x32_bf16 v[116:119], v[68:71], a[244:247], v[116:119]
v_fma_f32 v214, v214, v246, v246
v_fma_f32 v222, v222, v237, v236
v_mfma_f32_16x16x32_bf16 v[120:123], v[64:67], a[232:235], v[120:123]
v_rcp_f32 v212, v212
v_mfma_f32_16x16x32_bf16 v[120:123], v[68:71], a[248:251], v[120:123]
ds_read_b128 v[60:63], v8 offset:3072
v_mul_f32 v213, v213, v212
v_mfma_f32_16x16x32_bf16 v[124:127], v[64:67], a[236:239], v[124:127]
v_rcp_f32 v214, v214
v_mfma_f32_16x16x32_bf16 v[124:127], v[68:71], a[252:255], v[124:127]
v_mul_f32 v215, v215, v214
s_waitcnt lgkmcnt(4)
v_mfma_f32_16x16x32_bf16 v[128:131], v[72:75], a[224:227], v[128:131]
v_cvt_pk_bf16_f32 v173, v213, v215
v_mul_f32 v220, v220, v182
v_mfma_f32_16x16x32_bf16 v[128:131], v[76:79], a[240:243], v[128:131]
v_rcp_f32 v218, v218
v_mfma_f32_16x16x32_bf16 v[132:135], v[72:75], a[228:231], v[132:135]
ds_read_b128 v[64:67], v8 offset:4096
v_mul_f32 v219, v219, v218
v_mfma_f32_16x16x32_bf16 v[132:135], v[76:79], a[244:247], v[132:135]
v_cvt_pk_bf16_f32 v150, v217, v219
v_mul_f32 v222, v222, v183
v_mfma_f32_16x16x32_bf16 v[136:139], v[72:75], a[232:235], v[136:139]
v_exp_f32 v220, v220
v_mfma_f32_16x16x32_bf16 v[136:139], v[76:79], a[248:251], v[136:139]
ds_read_b128 v[68:71], v8 offset:5120
v_mul_f32 v221, v182, v198
v_mfma_f32_16x16x32_bf16 v[140:143], v[72:75], a[236:239], v[140:143]
v_exp_f32 v222, v222
v_mfma_f32_16x16x32_bf16 v[140:143], v[76:79], a[252:255], v[140:143]
v_mul_f32 v223, v183, v199
s_waitcnt lgkmcnt(4)
v_mfma_f32_16x16x32_bf16 v[112:115], v[48:51], v[16:19], v[112:115]
v_fma_f32 v220, v220, v238, v238
v_fma_f32 v222, v222, v238, v238
v_mfma_f32_16x16x32_bf16 v[112:115], v[52:55], v[32:35], v[112:115]
v_rcp_f32 v220, v220
v_mfma_f32_16x16x32_bf16 v[116:119], v[48:51], v[20:23], v[116:119]
ds_read_b128 v[72:75], v8 offset:6144
v_mul_f32 v221, v221, v220
v_mfma_f32_16x16x32_bf16 v[116:119], v[52:55], v[36:39], v[116:119]
v_rcp_f32 v222, v222
v_mfma_f32_16x16x32_bf16 v[120:123], v[48:51], v[24:27], v[120:123]
v_mul_f32 v223, v223, v222
v_cvt_pk_bf16_f32 v151, v221, v223
v_mfma_f32_16x16x32_bf16 v[120:123], v[52:55], v[40:43], v[120:123]
ds_read_b128 v[76:79], v8 offset:7168
v_mul_f32 v216, v184, v184
v_mfma_f32_16x16x32_bf16 v[124:127], v[48:51], v[28:31], v[124:127]
buffer_store_dwordx4 v[148:151], v4, s[8:11], s24 offen offset:0 sc1
v_mfma_f32_16x16x32_bf16 v[124:127], v[52:55], v[44:47], v[124:127]
v_mul_f32 v218, v185, v185
s_waitcnt lgkmcnt(4)
v_mfma_f32_16x16x32_bf16 v[128:131], v[56:59], v[16:19], v[128:131]
v_fma_f32 v216, v216, v241, v240
v_fma_f32 v218, v218, v241, v240
v_mfma_f32_16x16x32_bf16 v[128:131], v[60:63], v[32:35], v[128:131]
v_mul_f32 v216, v216, v184
v_mul_f32 v218, v218, v185
v_mfma_f32_16x16x32_bf16 v[132:135], v[56:59], v[20:23], v[132:135]
ds_read_b128 v[48:51], v8 offset:8192
v_mul_f32 v217, v184, v200
v_mfma_f32_16x16x32_bf16 v[132:135], v[60:63], v[36:39], v[132:135]
v_exp_f32 v216, v216
v_mfma_f32_16x16x32_bf16 v[136:139], v[56:59], v[24:27], v[136:139]
v_exp_f32 v218, v218
v_mfma_f32_16x16x32_bf16 v[136:139], v[60:63], v[40:43], v[136:139]
ds_read_b128 v[52:55], v8 offset:9216
v_mul_f32 v219, v185, v201
v_mfma_f32_16x16x32_bf16 v[140:143], v[56:59], v[28:31], v[140:143]
v_fma_f32 v216, v216, v242, v242
v_fma_f32 v218, v218, v242, v242
v_mfma_f32_16x16x32_bf16 v[140:143], v[60:63], v[44:47], v[140:143]
v_mul_f32 v220, v186, v186
s_waitcnt lgkmcnt(4)
v_mfma_f32_16x16x32_bf16 v[80:83], v[64:67], a[0:3], 0
v_rcp_f32 v216, v216
v_mfma_f32_16x16x32_bf16 v[80:83], v[68:71], a[16:19], v[80:83]
v_rcp_f32 v218, v218
v_mfma_f32_16x16x32_bf16 v[84:87], v[64:67], a[4:7], 0
ds_read_b128 v[56:59], v8 offset:10240
v_mul_f32 v217, v217, v216
v_mfma_f32_16x16x32_bf16 v[84:87], v[68:71], a[20:23], v[84:87]
v_mul_f32 v208, v112, v112
v_mul_f32 v210, v113, v113
v_mfma_f32_16x16x32_bf16 v[88:91], v[64:67], a[8:11], 0
v_fma_f32 v208, v208, v233, v232
v_fma_f32 v210, v210, v233, v232
v_mfma_f32_16x16x32_bf16 v[88:91], v[68:71], a[24:27], v[88:91]
ds_read_b128 v[60:63], v8 offset:11264
v_mul_f32 v208, v208, v112
v_mfma_f32_16x16x32_bf16 v[92:95], v[64:67], a[12:15], 0
v_mul_f32 v210, v210, v113
v_mul_f32 v209, v112, v128
v_mfma_f32_16x16x32_bf16 v[92:95], v[68:71], a[28:31], v[92:95]
v_mul_f32 v211, v113, v129
s_waitcnt lgkmcnt(4)
v_mfma_f32_16x16x32_bf16 v[96:99], v[72:75], a[0:3], 0
v_exp_f32 v208, v208
v_mfma_f32_16x16x32_bf16 v[96:99], v[76:79], a[16:19], v[96:99]
v_exp_f32 v210, v210
v_mfma_f32_16x16x32_bf16 v[100:103], v[72:75], a[4:7], 0
ds_read_b128 v[64:67], v8 offset:12288
v_fma_f32 v208, v208, v234, v234
v_mfma_f32_16x16x32_bf16 v[100:103], v[76:79], a[20:23], v[100:103]
v_fma_f32 v210, v210, v234, v234
v_mul_f32 v212, v114, v114
v_mfma_f32_16x16x32_bf16 v[104:107], v[72:75], a[8:11], 0
v_rcp_f32 v208, v208
v_mfma_f32_16x16x32_bf16 v[104:107], v[76:79], a[24:27], v[104:107]
ds_read_b128 v[68:71], v8 offset:13312
v_mul_f32 v209, v209, v208
v_mfma_f32_16x16x32_bf16 v[108:111], v[72:75], a[12:15], 0
v_rcp_f32 v210, v210
v_mfma_f32_16x16x32_bf16 v[108:111], v[76:79], a[28:31], v[108:111]
v_mul_f32 v211, v211, v210
s_waitcnt lgkmcnt(4)
v_mfma_f32_16x16x32_bf16 v[80:83], v[48:51], a[32:35], v[80:83]
v_cvt_pk_bf16_f32 v162, v209, v211
v_mul_f32 v214, v115, v115
v_mfma_f32_16x16x32_bf16 v[80:83], v[52:55], a[48:51], v[80:83]
v_fma_f32 v212, v212, v233, v232
v_fma_f32 v214, v214, v233, v232
v_mfma_f32_16x16x32_bf16 v[84:87], v[48:51], a[36:39], v[84:87]
ds_read_b128 v[72:75], v8 offset:14336
v_mul_f32 v212, v212, v114
v_mfma_f32_16x16x32_bf16 v[84:87], v[52:55], a[52:55], v[84:87]
v_mul_f32 v214, v214, v115
v_mul_f32 v213, v114, v130
v_mfma_f32_16x16x32_bf16 v[88:91], v[48:51], a[40:43], v[88:91]
v_exp_f32 v212, v212
v_mfma_f32_16x16x32_bf16 v[88:91], v[52:55], a[56:59], v[88:91]
ds_read_b128 v[76:79], v8 offset:15360
v_mul_f32 v215, v115, v131
v_mfma_f32_16x16x32_bf16 v[92:95], v[48:51], a[44:47], v[92:95]
v_exp_f32 v214, v214
v_mfma_f32_16x16x32_bf16 v[92:95], v[52:55], a[60:63], v[92:95]
v_fma_f32 v212, v212, v234, v234
s_waitcnt lgkmcnt(4)
v_mfma_f32_16x16x32_bf16 v[96:99], v[56:59], a[32:35], v[96:99]
s_waitcnt vmcnt(21)
v_fma_f32 v214, v214, v234, v234
v_mfma_f32_16x16x32_bf16 v[96:99], v[60:63], a[48:51], v[96:99]
s_barrier
v_mfma_f32_16x16x32_bf16 v[100:103], v[56:59], a[36:39], v[100:103]
ds_read_b128 v[48:51], v2 offset:0
s_add_u32 m0, s22, 98304
v_mfma_f32_16x16x32_bf16 v[100:103], v[60:63], a[52:55], v[100:103]
v_add_u32 v3, 20480, v3
buffer_load_dwordx4 v3, s[8:11], 0 offen offset:0 sc1 lds
v_mfma_f32_16x16x32_bf16 v[104:107], v[56:59], a[40:43], v[104:107]
v_rcp_f32 v212, v212
v_mfma_f32_16x16x32_bf16 v[104:107], v[60:63], a[56:59], v[104:107]
ds_read_b128 v[52:55], v2 offset:1024
v_mul_f32 v213, v213, v212
v_mfma_f32_16x16x32_bf16 v[108:111], v[56:59], a[44:47], v[108:111]
v_rcp_f32 v214, v214
v_mfma_f32_16x16x32_bf16 v[108:111], v[60:63], a[60:63], v[108:111]
v_mul_f32 v215, v215, v214
s_waitcnt lgkmcnt(4)
v_mfma_f32_16x16x32_bf16 v[80:83], v[64:67], a[64:67], v[80:83]
buffer_load_dwordx4 v3, s[8:11], 0 offen offset:1024 sc1 lds
v_mfma_f32_16x16x32_bf16 v[80:83], v[68:71], a[80:83], v[80:83]
v_cvt_pk_bf16_f32 v163, v213, v215
v_mul_f32 v208, v116, v116
v_mfma_f32_16x16x32_bf16 v[84:87], v[64:67], a[68:71], v[84:87]
ds_read_b128 v[56:59], v2 offset:2048
v_mul_f32 v210, v117, v117
v_mfma_f32_16x16x32_bf16 v[84:87], v[68:71], a[84:87], v[84:87]
buffer_store_dwordx4 v[160:163], v2, s[8:11], s24 offen offset:1024 sc1
v_mfma_f32_16x16x32_bf16 v[88:91], v[64:67], a[72:75], v[88:91]
v_fma_f32 v208, v208, v237, v236
v_fma_f32 v210, v210, v237, v236
v_mfma_f32_16x16x32_bf16 v[88:91], v[68:71], a[88:91], v[88:91]
ds_read_b128 v[60:63], v2 offset:3072
v_mul_f32 v208, v208, v116
v_mfma_f32_16x16x32_bf16 v[92:95], v[64:67], a[76:79], v[92:95]
v_mul_f32 v210, v210, v117
v_mul_f32 v209, v116, v132
v_mfma_f32_16x16x32_bf16 v[92:95], v[68:71], a[92:95], v[92:95]
v_mul_f32 v211, v117, v133
s_waitcnt lgkmcnt(4)
v_mfma_f32_16x16x32_bf16 v[96:99], v[72:75], a[64:67], v[96:99]
buffer_load_dwordx4 v3, s[8:11], 0 offen offset:2048 sc1 lds
v_mfma_f32_16x16x32_bf16 v[96:99], v[76:79], a[80:83], v[96:99]
v_exp_f32 v208, v208
v_mfma_f32_16x16x32_bf16 v[100:103], v[72:75], a[68:71], v[100:103]
ds_read_b128 v[64:67], v2 offset:4096
v_fma_f32 v208, v208, v238, v238
v_mfma_f32_16x16x32_bf16 v[100:103], v[76:79], a[84:87], v[100:103]
v_exp_f32 v210, v210
v_mfma_f32_16x16x32_bf16 v[104:107], v[72:75], a[72:75], v[104:107]
v_fma_f32 v210, v210, v238, v238
v_mul_f32 v212, v118, v118
v_mfma_f32_16x16x32_bf16 v[104:107], v[76:79], a[88:91], v[104:107]
ds_read_b128 v[68:71], v2 offset:5120
v_mul_f32 v214, v119, v119
v_mfma_f32_16x16x32_bf16 v[108:111], v[72:75], a[76:79], v[108:111]
buffer_load_dwordx4 v3, s[8:11], 0 offen offset:3072 sc1 lds
v_mfma_f32_16x16x32_bf16 v[108:111], v[76:79], a[92:95], v[108:111]
s_add_u32 m0, s22, 102400
s_waitcnt lgkmcnt(4)
v_mfma_f32_16x16x32_bf16 v[80:83], v[48:51], a[96:99], v[80:83]
v_add_u32 v3, 4096, v3
v_fma_f32 v212, v212, v237, v236
v_mfma_f32_16x16x32_bf16 v[80:83], v[52:55], a[112:115], v[80:83]
v_rcp_f32 v208, v208
v_mfma_f32_16x16x32_bf16 v[84:87], v[48:51], a[100:103], v[84:87]
ds_read_b128 v[72:75], v2 offset:6144
v_mul_f32 v209, v209, v208
v_mfma_f32_16x16x32_bf16 v[84:87], v[52:55], a[116:119], v[84:87]
buffer_load_dwordx4 v3, s[8:11], 0 offen offset:0 sc1 lds
v_mfma_f32_16x16x32_bf16 v[88:91], v[48:51], a[104:107], v[88:91]
v_rcp_f32 v210, v210
v_mfma_f32_16x16x32_bf16 v[88:91], v[52:55], a[120:123], v[88:91]
ds_read_b128 v[76:79], v2 offset:7168
v_mul_f32 v211, v211, v210
v_mfma_f32_16x16x32_bf16 v[92:95], v[48:51], a[108:111], v[92:95]
v_cvt_pk_bf16_f32 v166, v209, v211
v_fma_f32 v214, v214, v237, v236
v_mfma_f32_16x16x32_bf16 v[92:95], v[52:55], a[124:127], v[92:95]
v_mul_f32 v212, v212, v118
s_waitcnt lgkmcnt(4)
v_mfma_f32_16x16x32_bf16 v[96:99], v[56:59], a[96:99], v[96:99]
buffer_load_dwordx4 v3, s[8:11], 0 offen offset:1024 sc1 lds
v_mfma_f32_16x16x32_bf16 v[96:99], v[60:63], a[112:115], v[96:99]
v_mul_f32 v214, v214, v119
v_mul_f32 v213, v118, v134
v_mfma_f32_16x16x32_bf16 v[100:103], v[56:59], a[100:103], v[100:103]
ds_read_b128 v[48:51], v2 offset:8192
v_mul_f32 v215, v119, v135
v_mfma_f32_16x16x32_bf16 v[100:103], v[60:63], a[116:119], v[100:103]
v_exp_f32 v212, v212
v_mfma_f32_16x16x32_bf16 v[104:107], v[56:59], a[104:107], v[104:107]
v_exp_f32 v214, v214
v_mfma_f32_16x16x32_bf16 v[104:107], v[60:63], a[120:123], v[104:107]
ds_read_b128 v[52:55], v2 offset:9216
v_fma_f32 v212, v212, v238, v238
v_mfma_f32_16x16x32_bf16 v[108:111], v[56:59], a[108:111], v[108:111]
v_fma_f32 v214, v214, v238, v238
v_mul_f32 v208, v120, v120
v_mfma_f32_16x16x32_bf16 v[108:111], v[60:63], a[124:127], v[108:111]
v_mul_f32 v210, v121, v121
s_waitcnt lgkmcnt(4)
v_mfma_f32_16x16x32_bf16 v[80:83], v[64:67], a[128:131], v[80:83]
v_rcp_f32 v212, v212
v_mfma_f32_16x16x32_bf16 v[80:83], v[68:71], a[144:147], v[80:83]
v_rcp_f32 v214, v214
v_mfma_f32_16x16x32_bf16 v[84:87], v[64:67], a[132:135], v[84:87]
ds_read_b128 v[56:59], v2 offset:10240
v_mul_f32 v213, v213, v212
v_mfma_f32_16x16x32_bf16 v[84:87], v[68:71], a[148:151], v[84:87]
v_mul_f32 v215, v215, v214
v_cvt_pk_bf16_f32 v167, v213, v215
v_mfma_f32_16x16x32_bf16 v[88:91], v[64:67], a[136:139], v[88:91]
buffer_store_dwordx4 v[164:167], v4, s[8:11], s24 offen offset:1024 sc1
v_mfma_f32_16x16x32_bf16 v[88:91], v[68:71], a[152:155], v[88:91]
ds_read_b128 v[60:63], v2 offset:11264
v_fma_f32 v208, v208, v241, v240
v_mfma_f32_16x16x32_bf16 v[92:95], v[64:67], a[140:143], v[92:95]
v_fma_f32 v210, v210, v241, v240
v_mul_f32 v208, v208, v120
v_mfma_f32_16x16x32_bf16 v[92:95], v[68:71], a[156:159], v[92:95]
v_mul_f32 v210, v210, v121
s_waitcnt lgkmcnt(4)
v_mfma_f32_16x16x32_bf16 v[96:99], v[72:75], a[128:131], v[96:99]
v_exp_f32 v208, v208
v_mfma_f32_16x16x32_bf16 v[96:99], v[76:79], a[144:147], v[96:99]
v_exp_f32 v210, v210
v_mfma_f32_16x16x32_bf16 v[100:103], v[72:75], a[132:135], v[100:103]
ds_read_b128 v[64:67], v2 offset:12288
v_mul_f32 v209, v120, v136
v_mfma_f32_16x16x32_bf16 v[100:103], v[76:79], a[148:151], v[100:103]
v_mul_f32 v211, v121, v137
v_fma_f32 v208, v208, v242, v242
v_mfma_f32_16x16x32_bf16 v[104:107], v[72:75], a[136:139], v[104:107]
v_fma_f32 v210, v210, v242, v242
v_mul_f32 v212, v122, v122
v_mfma_f32_16x16x32_bf16 v[104:107], v[76:79], a[152:155], v[104:107]
ds_read_b128 v[68:71], v2 offset:13312
v_mul_f32 v214, v123, v123
v_mfma_f32_16x16x32_bf16 v[108:111], v[72:75], a[140:143], v[108:111]
v_rcp_f32 v208, v208
v_mfma_f32_16x16x32_bf16 v[108:111], v[76:79], a[156:159], v[108:111]
v_mul_f32 v209, v209, v208
s_waitcnt lgkmcnt(4)
v_mfma_f32_16x16x32_bf16 v[80:83], v[48:51], a[160:163], v[80:83]
v_rcp_f32 v210, v210
v_mfma_f32_16x16x32_bf16 v[80:83], v[52:55], a[176:179], v[80:83]
v_mul_f32 v211, v211, v210
v_cvt_pk_bf16_f32 v170, v209, v211
v_mfma_f32_16x16x32_bf16 v[84:87], v[48:51], a[164:167], v[84:87]
ds_read_b128 v[72:75], v2 offset:14336
v_fma_f32 v212, v212, v241, v240
v_mfma_f32_16x16x32_bf16 v[84:87], v[52:55], a[180:183], v[84:87]
v_fma_f32 v214, v214, v241, v240
v_mul_f32 v212, v212, v122
v_mfma_f32_16x16x32_bf16 v[88:91], v[48:51], a[168:171], v[88:91]
v_mul_f32 v214, v214, v123
v_mul_f32 v213, v122, v138
v_mfma_f32_16x16x32_bf16 v[88:91], v[52:55], a[184:187], v[88:91]
ds_read_b128 v[76:79], v2 offset:15360
v_mul_f32 v215, v123, v139
v_mfma_f32_16x16x32_bf16 v[92:95], v[48:51], a[172:175], v[92:95]
v_exp_f32 v212, v212
v_mfma_f32_16x16x32_bf16 v[92:95], v[52:55], a[188:191], v[92:95]
v_fma_f32 v212, v212, v242, v242
s_waitcnt lgkmcnt(4)
v_mfma_f32_16x16x32_bf16 v[96:99], v[56:59], a[160:163], v[96:99]
v_exp_f32 v214, v214
v_mfma_f32_16x16x32_bf16 v[96:99], v[60:63], a[176:179], v[96:99]
v_fma_f32 v214, v214, v242, v242
v_mul_f32 v208, v124, v124
v_mfma_f32_16x16x32_bf16 v[100:103], v[56:59], a[164:167], v[100:103]
ds_read_b128 v[48:51], v2 offset:16384
v_mul_f32 v210, v125, v125
v_mfma_f32_16x16x32_bf16 v[100:103], v[60:63], a[180:183], v[100:103]
v_rcp_f32 v212, v212
v_mfma_f32_16x16x32_bf16 v[104:107], v[56:59], a[168:171], v[104:107]
v_rcp_f32 v214, v214
v_mfma_f32_16x16x32_bf16 v[104:107], v[60:63], a[184:187], v[104:107]
ds_read_b128 v[52:55], v2 offset:17408
v_mul_f32 v213, v213, v212
v_mfma_f32_16x16x32_bf16 v[108:111], v[56:59], a[172:175], v[108:111]
v_mul_f32 v215, v215, v214
v_cvt_pk_bf16_f32 v171, v213, v215
v_mfma_f32_16x16x32_bf16 v[108:111], v[60:63], a[188:191], v[108:111]
v_fma_f32 v208, v208, v245, v244
s_waitcnt lgkmcnt(4)
v_mfma_f32_16x16x32_bf16 v[80:83], v[64:67], a[192:195], v[80:83]
buffer_store_dwordx4 v[168:171], v5, s[8:11], s24 offen offset:1024 sc1
v_mfma_f32_16x16x32_bf16 v[80:83], v[68:71], a[208:211], v[80:83]
v_fma_f32 v210, v210, v245, v244
v_mul_f32 v208, v208, v124
v_mfma_f32_16x16x32_bf16 v[84:87], v[64:67], a[196:199], v[84:87]
ds_read_b128 v[56:59], v2 offset:18432
v_mul_f32 v210, v210, v125
v_mfma_f32_16x16x32_bf16 v[84:87], v[68:71], a[212:215], v[84:87]
v_exp_f32 v208, v208
v_mfma_f32_16x16x32_bf16 v[88:91], v[64:67], a[200:203], v[88:91]
v_exp_f32 v210, v210
v_mfma_f32_16x16x32_bf16 v[88:91], v[68:71], a[216:219], v[88:91]
ds_read_b128 v[60:63], v2 offset:19456
v_mul_f32 v209, v124, v140
v_mfma_f32_16x16x32_bf16 v[92:95], v[64:67], a[204:207], v[92:95]
v_mul_f32 v211, v125, v141
v_fma_f32 v208, v208, v246, v246
v_mfma_f32_16x16x32_bf16 v[92:95], v[68:71], a[220:223], v[92:95]
v_fma_f32 v210, v210, v246, v246
s_waitcnt lgkmcnt(4)
v_mfma_f32_16x16x32_bf16 v[96:99], v[72:75], a[192:195], v[96:99]
v_rcp_f32 v208, v208
v_mfma_f32_16x16x32_bf16 v[96:99], v[76:79], a[208:211], v[96:99]
v_rcp_f32 v210, v210
v_mfma_f32_16x16x32_bf16 v[100:103], v[72:75], a[196:199], v[100:103]
ds_read_b128 v[64:67], v2 offset:20480
v_mul_f32 v209, v209, v208
v_mfma_f32_16x16x32_bf16 v[100:103], v[76:79], a[212:215], v[100:103]
v_mul_f32 v211, v211, v210
v_cvt_pk_bf16_f32 v174, v209, v211
v_mfma_f32_16x16x32_bf16 v[104:107], v[72:75], a[200:203], v[104:107]
v_mul_f32 v212, v126, v126
v_mul_f32 v214, v127, v127
v_mfma_f32_16x16x32_bf16 v[104:107], v[76:79], a[216:219], v[104:107]
ds_read_b128 v[68:71], v2 offset:21504
v_fma_f32 v212, v212, v245, v244
v_mfma_f32_16x16x32_bf16 v[108:111], v[72:75], a[204:207], v[108:111]
v_fma_f32 v214, v214, v245, v244
v_mul_f32 v212, v212, v126
v_mfma_f32_16x16x32_bf16 v[108:111], v[76:79], a[220:223], v[108:111]
v_mul_f32 v214, v214, v127
s_waitcnt lgkmcnt(4)
v_mfma_f32_16x16x32_bf16 v[80:83], v[48:51], a[224:227], v[80:83]
v_exp_f32 v212, v212
v_mfma_f32_16x16x32_bf16 v[80:83], v[52:55], a[240:243], v[80:83]
v_exp_f32 v214, v214
v_mfma_f32_16x16x32_bf16 v[84:87], v[48:51], a[228:231], v[84:87]
ds_read_b128 v[72:75], v2 offset:22528
v_mul_f32 v213, v126, v142
v_mfma_f32_16x16x32_bf16 v[84:87], v[52:55], a[244:247], v[84:87]
v_mul_f32 v215, v127, v143
v_fma_f32 v212, v212, v246, v246
v_mfma_f32_16x16x32_bf16 v[88:91], v[48:51], a[232:235], v[88:91]
v_fma_f32 v214, v214, v246, v246
v_mul_f32 v219, v219, v218
v_mfma_f32_16x16x32_bf16 v[88:91], v[52:55], a[248:251], v[88:91]
ds_read_b128 v[76:79], v2 offset:23552
v_cvt_pk_bf16_f32 v154, v217, v219
v_mfma_f32_16x16x32_bf16 v[92:95], v[48:51], a[236:239], v[92:95]
v_rcp_f32 v212, v212
v_mfma_f32_16x16x32_bf16 v[92:95], v[52:55], a[252:255], v[92:95]
v_mul_f32 v213, v213, v212
s_waitcnt lgkmcnt(4)
v_mfma_f32_16x16x32_bf16 v[96:99], v[56:59], a[224:227], v[96:99]
s_waitcnt vmcnt(23)
v_mul_f32 v222, v187, v187
v_mfma_f32_16x16x32_bf16 v[96:99], v[60:63], a[240:243], v[96:99]
s_barrier
v_mfma_f32_16x16x32_bf16 v[100:103], v[56:59], a[228:231], v[100:103]
ds_read_b128 v[48:51], v2 offset:24576
s_add_u32 m0, s22, 122880
v_mfma_f32_16x16x32_bf16 v[100:103], v[60:63], a[244:247], v[100:103]
v_add_u32 v3, 20480, v3
buffer_load_dwordx4 v3, s[8:11], 0 offen offset:0 sc1 lds
v_mfma_f32_16x16x32_bf16 v[104:107], v[56:59], a[232:235], v[104:107]
v_rcp_f32 v214, v214
v_mfma_f32_16x16x32_bf16 v[104:107], v[60:63], a[248:251], v[104:107]
ds_read_b128 v[52:55], v2 offset:25600
v_mul_f32 v215, v215, v214
v_mfma_f32_16x16x32_bf16 v[108:111], v[56:59], a[236:239], v[108:111]
v_cvt_pk_bf16_f32 v175, v213, v215
v_fma_f32 v220, v220, v241, v240
v_mfma_f32_16x16x32_bf16 v[108:111], v[60:63], a[252:255], v[108:111]
v_fma_f32 v222, v222, v241, v240
s_waitcnt lgkmcnt(4)
v_mfma_f32_16x16x32_bf16 v[80:83], v[64:67], v[16:19], v[80:83]
buffer_load_dwordx4 v3, s[8:11], 0 offen offset:1024 sc1 lds
v_mfma_f32_16x16x32_bf16 v[80:83], v[68:71], v[32:35], v[80:83]
v_mul_f32 v220, v220, v186
v_mul_f32 v222, v222, v187
v_mfma_f32_16x16x32_bf16 v[84:87], v[64:67], v[20:23], v[84:87]
ds_read_b128 v[56:59], v2 offset:26624
v_mul_f32 v221, v186, v202
v_mfma_f32_16x16x32_bf16 v[84:87], v[68:71], v[36:39], v[84:87]
buffer_store_dwordx4 v[172:175], v6, s[8:11], s24 offen offset:1024 sc1
v_mfma_f32_16x16x32_bf16 v[88:91], v[64:67], v[24:27], v[88:91]
v_exp_f32 v220, v220
v_mfma_f32_16x16x32_bf16 v[88:91], v[68:71], v[40:43], v[88:91]
ds_read_b128 v[60:63], v2 offset:27648
v_mul_f32 v223, v187, v203
v_mfma_f32_16x16x32_bf16 v[92:95], v[64:67], v[28:31], v[92:95]
v_exp_f32 v222, v222
v_mfma_f32_16x16x32_bf16 v[92:95], v[68:71], v[44:47], v[92:95]
v_fma_f32 v220, v220, v242, v242
s_waitcnt lgkmcnt(4)
v_mfma_f32_16x16x32_bf16 v[96:99], v[72:75], v[16:19], v[96:99]
buffer_load_dwordx4 v3, s[8:11], 0 offen offset:2048 sc1 lds
v_mfma_f32_16x16x32_bf16 v[96:99], v[76:79], v[32:35], v[96:99]
v_fma_f32 v222, v222, v242, v242
v_mul_f32 v216, v188, v188
v_mfma_f32_16x16x32_bf16 v[100:103], v[72:75], v[20:23], v[100:103]
ds_read_b128 v[64:67], v2 offset:28672
v_mul_f32 v218, v189, v189
v_mfma_f32_16x16x32_bf16 v[100:103], v[76:79], v[36:39], v[100:103]
v_rcp_f32 v220, v220
v_mfma_f32_16x16x32_bf16 v[104:107], v[72:75], v[24:27], v[104:107]
v_rcp_f32 v222, v222
v_mfma_f32_16x16x32_bf16 v[104:107], v[76:79], v[40:43], v[104:107]
ds_read_b128 v[68:71], v2 offset:29696
v_mul_f32 v221, v221, v220
v_mfma_f32_16x16x32_bf16 v[108:111], v[72:75], v[28:31], v[108:111]
buffer_load_dwordx4 v3, s[8:11], 0 offen offset:3072 sc1 lds
v_mfma_f32_16x16x32_bf16 v[108:111], v[76:79], v[44:47], v[108:111]
s_add_u32 m0, s22, 126976
s_waitcnt lgkmcnt(4)
v_mfma_f32_16x16x32_bf16 v[112:115], v[48:51], a[0:3], 0
v_add_u32 v3, 4096, v3
v_mul_f32 v223, v223, v222
v_mfma_f32_16x16x32_bf16 v[112:115], v[52:55], a[16:19], v[112:115]
v_cvt_pk_bf16_f32 v155, v221, v223
v_fma_f32 v216, v216, v245, v244
v_mfma_f32_16x16x32_bf16 v[116:119], v[48:51], a[4:7], 0
ds_read_b128 v[72:75], v2 offset:30720
v_fma_f32 v218, v218, v245, v244
v_mfma_f32_16x16x32_bf16 v[116:119], v[52:55], a[20:23], v[116:119]
buffer_load_dwordx4 v3, s[8:11], 0 offen offset:0 sc1 lds
v_mfma_f32_16x16x32_bf16 v[120:123], v[48:51], a[8:11], 0
v_mul_f32 v216, v216, v188
v_mul_f32 v218, v218, v189
v_mfma_f32_16x16x32_bf16 v[120:123], v[52:55], a[24:27], v[120:123]
ds_read_b128 v[76:79], v2 offset:31744
v_mul_f32 v217, v188, v204
v_mfma_f32_16x16x32_bf16 v[124:127], v[48:51], a[12:15], 0
buffer_store_dwordx4 v[152:155], v5, s[8:11], s24 offen offset:0 sc1
v_mfma_f32_16x16x32_bf16 v[124:127], v[52:55], a[28:31], v[124:127]
v_mul_f32 v219, v189, v205
s_waitcnt lgkmcnt(4)
v_mfma_f32_16x16x32_bf16 v[128:131], v[56:59], a[0:3], 0
v_exp_f32 v216, v216
v_mfma_f32_16x16x32_bf16 v[128:131], v[60:63], a[16:19], v[128:131]
v_exp_f32 v218, v218
v_mfma_f32_16x16x32_bf16 v[132:135], v[56:59], a[4:7], 0
ds_read_b128 v[48:51], v2 offset:32768
v_fma_f32 v216, v216, v246, v246
v_mfma_f32_16x16x32_bf16 v[132:135], v[60:63], a[20:23], v[132:135]
buffer_load_dwordx4 v3, s[8:11], 0 offen offset:1024 sc1 lds
v_mfma_f32_16x16x32_bf16 v[136:139], v[56:59], a[8:11], 0
v_fma_f32 v218, v218, v246, v246
v_mul_f32 v220, v190, v190
v_mfma_f32_16x16x32_bf16 v[136:139], v[60:63], a[24:27], v[136:139]
ds_read_b128 v[52:55], v2 offset:33792
v_mul_f32 v222, v191, v191
v_mfma_f32_16x16x32_bf16 v[140:143], v[56:59], a[12:15], 0
v_rcp_f32 v216, v216
v_mfma_f32_16x16x32_bf16 v[140:143], v[60:63], a[28:31], v[140:143]
v_mul_f32 v217, v217, v216
s_waitcnt lgkmcnt(4)
v_mfma_f32_16x16x32_bf16 v[112:115], v[64:67], a[32:35], v[112:115]
v_rcp_f32 v218, v218
v_mfma_f32_16x16x32_bf16 v[112:115], v[68:71], a[48:51], v[112:115]
v_mul_f32 v219, v219, v218
v_cvt_pk_bf16_f32 v158, v217, v219
v_mfma_f32_16x16x32_bf16 v[116:119], v[64:67], a[36:39], v[116:119]
ds_read_b128 v[56:59], v2 offset:34816
v_fma_f32 v220, v220, v245, v244
v_mfma_f32_16x16x32_bf16 v[116:119], v[68:71], a[52:55], v[116:119]
v_fma_f32 v222, v222, v245, v244
v_mul_f32 v220, v220, v190
v_mfma_f32_16x16x32_bf16 v[120:123], v[64:67], a[40:43], v[120:123]
v_mul_f32 v222, v222, v191
v_mul_f32 v221, v190, v206
v_mfma_f32_16x16x32_bf16 v[120:123], v[68:71], a[56:59], v[120:123]
ds_read_b128 v[60:63], v2 offset:35840
v_mul_f32 v223, v191, v207
v_mfma_f32_16x16x32_bf16 v[124:127], v[64:67], a[44:47], v[124:127]
v_exp_f32 v220, v220
v_mfma_f32_16x16x32_bf16 v[124:127], v[68:71], a[60:63], v[124:127]
v_fma_f32 v220, v220, v246, v246
s_waitcnt lgkmcnt(4)
v_mfma_f32_16x16x32_bf16 v[128:131], v[72:75], a[32:35], v[128:131]
v_exp_f32 v222, v222
v_mfma_f32_16x16x32_bf16 v[128:131], v[76:79], a[48:51], v[128:131]
v_fma_f32 v222, v222, v246, v246
v_mfma_f32_16x16x32_bf16 v[132:135], v[72:75], a[36:39], v[132:135]
ds_read_b128 v[64:67], v2 offset:36864
v_mfma_f32_16x16x32_bf16 v[132:135], v[76:79], a[52:55], v[132:135]
v_rcp_f32 v220, v220
v_mfma_f32_16x16x32_bf16 v[136:139], v[72:75], a[40:43], v[136:139]
v_rcp_f32 v222, v222
v_mfma_f32_16x16x32_bf16 v[136:139], v[76:79], a[56:59], v[136:139]
ds_read_b128 v[68:71], v2 offset:37888
v_mul_f32 v221, v221, v220
v_mfma_f32_16x16x32_bf16 v[140:143], v[72:75], a[44:47], v[140:143]
v_mul_f32 v223, v223, v222
v_cvt_pk_bf16_f32 v159, v221, v223
v_mfma_f32_16x16x32_bf16 v[140:143], v[76:79], a[60:63], v[140:143]
s_waitcnt lgkmcnt(4)
v_mfma_f32_16x16x32_bf16 v[112:115], v[48:51], a[64:67], v[112:115]
buffer_store_dwordx4 v[156:159], v6, s[8:11], s24 offen offset:0 sc1
v_mfma_f32_16x16x32_bf16 v[112:115], v[52:55], a[80:83], v[112:115]
v_mul_f32 v208, v80, v80
v_mul_f32 v210, v81, v81
v_mfma_f32_16x16x32_bf16 v[116:119], v[48:51], a[68:71], v[116:119]
ds_read_b128 v[72:75], v2 offset:38912
v_fma_f32 v208, v208, v233, v232
v_mfma_f32_16x16x32_bf16 v[116:119], v[52:55], a[84:87], v[116:119]
v_fma_f32 v210, v210, v233, v232
v_mul_f32 v208, v208, v80
v_mfma_f32_16x16x32_bf16 v[120:123], v[48:51], a[72:75], v[120:123]
v_mul_f32 v210, v210, v81
v_mul_f32 v209, v80, v96
v_mfma_f32_16x16x32_bf16 v[120:123], v[52:55], a[88:91], v[120:123]
ds_read_b128 v[76:79], v2 offset:39936
v_mul_f32 v211, v81, v97
v_mfma_f32_16x16x32_bf16 v[124:127], v[48:51], a[76:79], v[124:127]
v_exp_f32 v208, v208
v_mfma_f32_16x16x32_bf16 v[124:127], v[52:55], a[92:95], v[124:127]
v_fma_f32 v208, v208, v234, v234
s_waitcnt lgkmcnt(4)
v_mfma_f32_16x16x32_bf16 v[128:131], v[56:59], a[64:67], v[128:131]
v_exp_f32 v210, v210
v_mfma_f32_16x16x32_bf16 v[128:131], v[60:63], a[80:83], v[128:131]
v_fma_f32 v210, v210, v234, v234
v_mul_f32 v212, v82, v82
v_mfma_f32_16x16x32_bf16 v[132:135], v[56:59], a[68:71], v[132:135]
ds_read_b128 v[48:51], v2 offset:40960
v_mul_f32 v214, v83, v83
v_mfma_f32_16x16x32_bf16 v[132:135], v[60:63], a[84:87], v[132:135]
v_rcp_f32 v208, v208
v_mfma_f32_16x16x32_bf16 v[136:139], v[56:59], a[72:75], v[136:139]
v_rcp_f32 v210, v210
v_mfma_f32_16x16x32_bf16 v[136:139], v[60:63], a[88:91], v[136:139]
ds_read_b128 v[52:55], v2 offset:41984
v_mul_f32 v209, v209, v208
v_mfma_f32_16x16x32_bf16 v[140:143], v[56:59], a[76:79], v[140:143]
v_mul_f32 v211, v211, v210
v_cvt_pk_bf16_f32 v176, v209, v211
v_mfma_f32_16x16x32_bf16 v[140:143], v[60:63], a[92:95], v[140:143]
v_fma_f32 v212, v212, v233, v232
s_waitcnt lgkmcnt(4)
v_mfma_f32_16x16x32_bf16 v[112:115], v[64:67], a[96:99], v[112:115]
v_fma_f32 v214, v214, v233, v232
v_mul_f32 v212, v212, v82
v_mfma_f32_16x16x32_bf16 v[112:115], v[68:71], a[112:115], v[112:115]
v_mul_f32 v214, v214, v83
v_mul_f32 v213, v82, v98
v_mfma_f32_16x16x32_bf16 v[116:119], v[64:67], a[100:103], v[116:119]
ds_read_b128 v[56:59], v2 offset:43008
v_mul_f32 v215, v83, v99
v_mfma_f32_16x16x32_bf16 v[116:119], v[68:71], a[116:119], v[116:119]
v_exp_f32 v212, v212
v_mfma_f32_16x16x32_bf16 v[120:123], v[64:67], a[104:107], v[120:123]
v_exp_f32 v214, v214
v_mfma_f32_16x16x32_bf16 v[120:123], v[68:71], a[120:123], v[120:123]
ds_read_b128 v[60:63], v2 offset:44032
v_fma_f32 v212, v212, v234, v234
v_mfma_f32_16x16x32_bf16 v[124:127], v[64:67], a[108:111], v[124:127]
v_fma_f32 v214, v214, v234, v234
v_mul_f32 v208, v84, v84
v_mfma_f32_16x16x32_bf16 v[124:127], v[68:71], a[124:127], v[124:127]
v_mul_f32 v210, v85, v85
s_waitcnt lgkmcnt(4)
v_mfma_f32_16x16x32_bf16 v[128:131], v[72:75], a[96:99], v[128:131]
v_rcp_f32 v212, v212
v_mfma_f32_16x16x32_bf16 v[128:131], v[76:79], a[112:115], v[128:131]
v_rcp_f32 v214, v214
v_mfma_f32_16x16x32_bf16 v[132:135], v[72:75], a[100:103], v[132:135]
ds_read_b128 v[64:67], v2 offset:45056
v_mul_f32 v213, v213, v212
v_mfma_f32_16x16x32_bf16 v[132:135], v[76:79], a[116:119], v[132:135]
v_mul_f32 v215, v215, v214
v_cvt_pk_bf16_f32 v177, v213, v215
v_mfma_f32_16x16x32_bf16 v[136:139], v[72:75], a[104:107], v[136:139]
v_fma_f32 v208, v208, v237, v236
v_fma_f32 v210, v210, v237, v236
v_mfma_f32_16x16x32_bf16 v[136:139], v[76:79], a[120:123], v[136:139]
ds_read_b128 v[68:71], v2 offset:46080
v_mul_f32 v208, v208, v84
v_mfma_f32_16x16x32_bf16 v[140:143], v[72:75], a[108:111], v[140:143]
v_mul_f32 v210, v210, v85
v_mul_f32 v209, v84, v100
v_mfma_f32_16x16x32_bf16 v[140:143], v[76:79], a[124:127], v[140:143]
v_mul_f32 v211, v85, v101
s_waitcnt lgkmcnt(4)
v_mfma_f32_16x16x32_bf16 v[112:115], v[48:51], a[128:131], v[112:115]
v_exp_f32 v208, v208
v_mfma_f32_16x16x32_bf16 v[112:115], v[52:55], a[144:147], v[112:115]
v_exp_f32 v210, v210
v_mfma_f32_16x16x32_bf16 v[116:119], v[48:51], a[132:135], v[116:119]
ds_read_b128 v[72:75], v2 offset:47104
v_fma_f32 v208, v208, v238, v238
v_mfma_f32_16x16x32_bf16 v[116:119], v[52:55], a[148:151], v[116:119]
v_fma_f32 v210, v210, v238, v238
v_mul_f32 v212, v86, v86
v_mfma_f32_16x16x32_bf16 v[120:123], v[48:51], a[136:139], v[120:123]
v_rcp_f32 v208, v208
v_mfma_f32_16x16x32_bf16 v[120:123], v[52:55], a[152:155], v[120:123]
ds_read_b128 v[76:79], v2 offset:48128
v_mul_f32 v209, v209, v208
v_mfma_f32_16x16x32_bf16 v[124:127], v[48:51], a[140:143], v[124:127]
v_rcp_f32 v210, v210
v_mfma_f32_16x16x32_bf16 v[124:127], v[52:55], a[156:159], v[124:127]
v_mul_f32 v211, v211, v210
s_waitcnt lgkmcnt(4)
v_mfma_f32_16x16x32_bf16 v[128:131], v[56:59], a[128:131], v[128:131]
s_waitcnt vmcnt(25)
v_cvt_pk_bf16_f32 v180, v209, v211
v_mfma_f32_16x16x32_bf16 v[128:131], v[60:63], a[144:147], v[128:131]
s_barrier
v_mfma_f32_16x16x32_bf16 v[132:135], v[56:59], a[132:135], v[132:135]
ds_read_b128 v[48:51], v2 offset:49152
s_add_u32 m0, s22, 0
v_mfma_f32_16x16x32_bf16 v[132:135], v[60:63], a[148:151], v[132:135]
v_add_u32 v3, 20480, v3
buffer_load_dwordx4 v3, s[8:11], 0 offen offset:0 sc1 lds
v_mfma_f32_16x16x32_bf16 v[136:139], v[56:59], a[136:139], v[136:139]
v_mul_f32 v214, v87, v87
v_fma_f32 v212, v212, v237, v236
v_mfma_f32_16x16x32_bf16 v[136:139], v[60:63], a[152:155], v[136:139]
ds_read_b128 v[52:55], v2 offset:50176
v_fma_f32 v214, v214, v237, v236
v_mfma_f32_16x16x32_bf16 v[140:143], v[56:59], a[140:143], v[140:143]
v_mul_f32 v212, v212, v86
v_mul_f32 v214, v214, v87
v_mfma_f32_16x16x32_bf16 v[140:143], v[60:63], a[156:159], v[140:143]
v_mul_f32 v213, v86, v102
s_waitcnt lgkmcnt(4)
v_mfma_f32_16x16x32_bf16 v[112:115], v[64:67], a[160:163], v[112:115]
buffer_load_dwordx4 v3, s[8:11], 0 offen offset:1024 sc1 lds
v_mfma_f32_16x16x32_bf16 v[112:115], v[68:71], a[176:179], v[112:115]
v_exp_f32 v212, v212
v_mfma_f32_16x16x32_bf16 v[116:119], v[64:67], a[164:167], v[116:119]
ds_read_b128 v[56:59], v2 offset:51200
v_mul_f32 v215, v87, v103
v_mfma_f32_16x16x32_bf16 v[116:119], v[68:71], a[180:183], v[116:119]
v_exp_f32 v214, v214
v_mfma_f32_16x16x32_bf16 v[120:123], v[64:67], a[168:171], v[120:123]
v_fma_f32 v212, v212, v238, v238
v_fma_f32 v214, v214, v238, v238
v_mfma_f32_16x16x32_bf16 v[120:123], v[68:71], a[184:187], v[120:123]
ds_read_b128 v[60:63], v2 offset:52224
v_mul_f32 v208, v88, v88
v_mfma_f32_16x16x32_bf16 v[124:127], v[64:67], a[172:175], v[124:127]
buffer_load_dwordx4 v3, s[8:11], 0 offen offset:2048 sc1 lds
v_mfma_f32_16x16x32_bf16 v[124:127], v[68:71], a[188:191], v[124:127]
v_mul_f32 v210, v89, v89
s_waitcnt lgkmcnt(4)
v_mfma_f32_16x16x32_bf16 v[128:131], v[72:75], a[160:163], v[128:131]
v_rcp_f32 v212, v212
v_mfma_f32_16x16x32_bf16 v[128:131], v[76:79], a[176:179], v[128:131]
v_rcp_f32 v214, v214
v_mfma_f32_16x16x32_bf16 v[132:135], v[72:75], a[164:167], v[132:135]
ds_read_b128 v[64:67], v2 offset:53248
v_mul_f32 v213, v213, v212
v_mfma_f32_16x16x32_bf16 v[132:135], v[76:79], a[180:183], v[132:135]
buffer_load_dwordx4 v3, s[8:11], 0 offen offset:3072 sc1 lds
v_mfma_f32_16x16x32_bf16 v[136:139], v[72:75], a[168:171], v[136:139]
s_add_u32 m0, s22, 4096
v_add_u32 v3, 4096, v3
v_mfma_f32_16x16x32_bf16 v[136:139], v[76:79], a[184:187], v[136:139]
ds_read_b128 v[68:71], v2 offset:54272
v_mul_f32 v215, v215, v214
v_mfma_f32_16x16x32_bf16 v[140:143], v[72:75], a[172:175], v[140:143]
v_cvt_pk_bf16_f32 v181, v213, v215
v_fma_f32 v208, v208, v241, v240
v_mfma_f32_16x16x32_bf16 v[140:143], v[76:79], a[188:191], v[140:143]
v_fma_f32 v210, v210, v241, v240
s_waitcnt lgkmcnt(4)
v_mfma_f32_16x16x32_bf16 v[112:115], v[48:51], a[192:195], v[112:115]
buffer_load_dwordx4 v3, s[8:11], 0 offen offset:0 sc1 lds
v_mfma_f32_16x16x32_bf16 v[112:115], v[52:55], a[208:211], v[112:115]
v_mul_f32 v208, v208, v88
v_mul_f32 v210, v210, v89
v_mfma_f32_16x16x32_bf16 v[116:119], v[48:51], a[196:199], v[116:119]
ds_read_b128 v[72:75], v2 offset:55296
v_mul_f32 v209, v88, v104
v_mfma_f32_16x16x32_bf16 v[116:119], v[52:55], a[212:215], v[116:119]
v_exp_f32 v208, v208
v_mfma_f32_16x16x32_bf16 v[120:123], v[48:51], a[200:203], v[120:123]
v_exp_f32 v210, v210
v_mfma_f32_16x16x32_bf16 v[120:123], v[52:55], a[216:219], v[120:123]
ds_read_b128 v[76:79], v2 offset:56320
v_mul_f32 v211, v89, v105
v_mfma_f32_16x16x32_bf16 v[124:127], v[48:51], a[204:207], v[124:127]
buffer_load_dwordx4 v3, s[8:11], 0 offen offset:1024 sc1 lds
v_mfma_f32_16x16x32_bf16 v[124:127], v[52:55], a[220:223], v[124:127]
v_fma_f32 v208, v208, v242, v242
s_waitcnt lgkmcnt(4)
v_mfma_f32_16x16x32_bf16 v[128:131], v[56:59], a[192:195], v[128:131]
v_mov_b32 v12, s68
v_mov_b32 v13, s69
v_mfma_f32_16x16x32_bf16 v[128:131], v[60:63], a[208:211], v[128:131]
s_add_u32 s53, s34, 0
s_waitcnt vmcnt(6)
v_fma_f32 v210, v210, v242, v242
v_mfma_f32_16x16x32_bf16 v[132:135], v[56:59], a[196:199], v[132:135]
ds_read_b128 v[48:51], v2 offset:57344
v_rcp_f32 v208, v208
v_mfma_f32_16x16x32_bf16 v[132:135], v[60:63], a[212:215], v[132:135]
buffer_store_dwordx2 v[12:13], v10, s[8:11], s53 offen sc1
v_rcp_f32 v210, v210
v_mfma_f32_16x16x32_bf16 v[136:139], v[56:59], a[200:203], v[136:139]
v_mul_f32 v209, v209, v208
v_mul_f32 v211, v211, v210
v_mfma_f32_16x16x32_bf16 v[136:139], v[60:63], a[216:219], v[136:139]
ds_read_b128 v[52:55], v2 offset:58368
v_cvt_pk_bf16_f32 v184, v209, v211
v_mfma_f32_16x16x32_bf16 v[140:143], v[56:59], a[204:207], v[140:143]
v_mul_f32 v212, v90, v90
v_mul_f32 v214, v91, v91
v_mfma_f32_16x16x32_bf16 v[140:143], v[60:63], a[220:223], v[140:143]
v_fma_f32 v212, v212, v241, v240
s_waitcnt lgkmcnt(4)
v_mfma_f32_16x16x32_bf16 v[112:115], v[64:67], a[224:227], v[112:115]
v_fma_f32 v214, v214, v241, v240
v_mul_f32 v212, v212, v90
v_mfma_f32_16x16x32_bf16 v[112:115], v[68:71], a[240:243], v[112:115]
v_mul_f32 v214, v214, v91
v_exp_f32 v212, v212
v_mfma_f32_16x16x32_bf16 v[116:119], v[64:67], a[228:231], v[116:119]
ds_read_b128 v[56:59], v2 offset:59392
v_exp_f32 v214, v214
v_mfma_f32_16x16x32_bf16 v[116:119], v[68:71], a[244:247], v[116:119]
v_mul_f32 v213, v90, v106
v_mul_f32 v215, v91, v107
v_mfma_f32_16x16x32_bf16 v[120:123], v[64:67], a[232:235], v[120:123]
v_fma_f32 v212, v212, v242, v242
v_fma_f32 v214, v214, v242, v242
v_mfma_f32_16x16x32_bf16 v[120:123], v[68:71], a[248:251], v[120:123]
ds_read_b128 v[60:63], v2 offset:60416
v_rcp_f32 v212, v212
v_mfma_f32_16x16x32_bf16 v[124:127], v[64:67], a[236:239], v[124:127]
v_rcp_f32 v214, v214
v_mfma_f32_16x16x32_bf16 v[124:127], v[68:71], a[252:255], v[124:127]
v_mul_f32 v213, v213, v212
s_waitcnt lgkmcnt(4)
v_mfma_f32_16x16x32_bf16 v[128:131], v[72:75], a[224:227], v[128:131]
v_mul_f32 v215, v215, v214
v_cvt_pk_bf16_f32 v185, v213, v215
v_mfma_f32_16x16x32_bf16 v[128:131], v[76:79], a[240:243], v[128:131]
v_mul_f32 v208, v92, v92
v_mul_f32 v210, v93, v93
v_mfma_f32_16x16x32_bf16 v[132:135], v[72:75], a[228:231], v[132:135]
ds_read_b128 v[64:67], v2 offset:61440
v_fma_f32 v208, v208, v245, v244
v_mfma_f32_16x16x32_bf16 v[132:135], v[76:79], a[244:247], v[132:135]
v_fma_f32 v210, v210, v245, v244
v_mul_f32 v208, v208, v92
v_mfma_f32_16x16x32_bf16 v[136:139], v[72:75], a[232:235], v[136:139]
v_mul_f32 v210, v210, v93
v_exp_f32 v208, v208
v_mfma_f32_16x16x32_bf16 v[136:139], v[76:79], a[248:251], v[136:139]
ds_read_b128 v[68:71], v2 offset:62464
v_exp_f32 v210, v210
v_mfma_f32_16x16x32_bf16 v[140:143], v[72:75], a[236:239], v[140:143]
v_mul_f32 v209, v92, v108
v_mul_f32 v211, v93, v109
v_mfma_f32_16x16x32_bf16 v[140:143], v[76:79], a[252:255], v[140:143]
v_fma_f32 v208, v208, v246, v246
s_waitcnt lgkmcnt(4)
v_mfma_f32_16x16x32_bf16 v[112:115], v[48:51], v[16:19], v[112:115]
v_fma_f32 v210, v210, v246, v246
v_rcp_f32 v208, v208
v_mfma_f32_16x16x32_bf16 v[112:115], v[52:55], v[32:35], v[112:115]
v_rcp_f32 v210, v210
v_mfma_f32_16x16x32_bf16 v[116:119], v[48:51], v[20:23], v[116:119]
ds_read_b128 v[72:75], v2 offset:63488
v_mul_f32 v209, v209, v208
v_mfma_f32_16x16x32_bf16 v[116:119], v[52:55], v[36:39], v[116:119]
v_mul_f32 v211, v211, v210
v_cvt_pk_bf16_f32 v188, v209, v211
v_mfma_f32_16x16x32_bf16 v[120:123], v[48:51], v[24:27], v[120:123]
v_mul_f32 v212, v94, v94
v_mul_f32 v214, v95, v95
v_mfma_f32_16x16x32_bf16 v[120:123], v[52:55], v[40:43], v[120:123]
ds_read_b128 v[76:79], v2 offset:64512
v_fma_f32 v212, v212, v245, v244
v_mfma_f32_16x16x32_bf16 v[124:127], v[48:51], v[28:31], v[124:127]
v_fma_f32 v214, v214, v245, v244
v_mul_f32 v212, v212, v94
v_mfma_f32_16x16x32_bf16 v[124:127], v[52:55], v[44:47], v[124:127]
v_mul_f32 v214, v214, v95
s_waitcnt lgkmcnt(4)
v_mfma_f32_16x16x32_bf16 v[128:131], v[56:59], v[16:19], v[128:131]
v_exp_f32 v212, v212
v_mfma_f32_16x16x32_bf16 v[128:131], v[60:63], v[32:35], v[128:131]
v_exp_f32 v214, v214
v_mfma_f32_16x16x32_bf16 v[132:135], v[56:59], v[20:23], v[132:135]
ds_read_b128 v[48:51], v7 offset:0
v_mul_f32 v213, v94, v110
v_mfma_f32_16x16x32_bf16 v[132:135], v[60:63], v[36:39], v[132:135]
v_mul_f32 v215, v95, v111
v_fma_f32 v212, v212, v246, v246
v_mfma_f32_16x16x32_bf16 v[136:139], v[56:59], v[24:27], v[136:139]
v_fma_f32 v214, v214, v246, v246
v_rcp_f32 v212, v212
v_mfma_f32_16x16x32_bf16 v[136:139], v[60:63], v[40:43], v[136:139]
ds_read_b128 v[52:55], v7 offset:1024
v_rcp_f32 v214, v214
v_mfma_f32_16x16x32_bf16 v[140:143], v[56:59], v[28:31], v[140:143]
v_mul_f32 v213, v213, v212
v_mul_f32 v215, v215, v214
v_mfma_f32_16x16x32_bf16 v[140:143], v[60:63], v[44:47], v[140:143]
v_cvt_pk_bf16_f32 v189, v213, v215
s_waitcnt lgkmcnt(4)
v_mfma_f32_16x16x32_bf16 v[80:83], v[64:67], a[0:3], 0
v_mfma_f32_16x16x32_bf16 v[80:83], v[68:71], a[16:19], v[80:83]
v_mfma_f32_16x16x32_bf16 v[84:87], v[64:67], a[4:7], 0
ds_read_b128 v[56:59], v7 offset:2048
v_mfma_f32_16x16x32_bf16 v[84:87], v[68:71], a[20:23], v[84:87]
v_mul_f32 v208, v112, v112
v_mul_f32 v210, v113, v113
v_mfma_f32_16x16x32_bf16 v[88:91], v[64:67], a[8:11], 0
v_fma_f32 v208, v208, v233, v232
v_fma_f32 v210, v210, v233, v232
v_mfma_f32_16x16x32_bf16 v[88:91], v[68:71], a[24:27], v[88:91]
ds_read_b128 v[60:63], v7 offset:3072
v_mul_f32 v208, v208, v112
v_mfma_f32_16x16x32_bf16 v[92:95], v[64:67], a[12:15], 0
v_mul_f32 v210, v210, v113
v_mul_f32 v209, v112, v128
v_mfma_f32_16x16x32_bf16 v[92:95], v[68:71], a[28:31], v[92:95]
v_mul_f32 v211, v113, v129
s_waitcnt lgkmcnt(4)
v_mfma_f32_16x16x32_bf16 v[96:99], v[72:75], a[0:3], 0
v_exp_f32 v208, v208
v_mfma_f32_16x16x32_bf16 v[96:99], v[76:79], a[16:19], v[96:99]
v_exp_f32 v210, v210
v_mfma_f32_16x16x32_bf16 v[100:103], v[72:75], a[4:7], 0
ds_read_b128 v[64:67], v7 offset:4096
v_fma_f32 v208, v208, v234, v234
v_mfma_f32_16x16x32_bf16 v[100:103], v[76:79], a[20:23], v[100:103]
v_fma_f32 v210, v210, v234, v234
v_mul_f32 v212, v114, v114
v_mfma_f32_16x16x32_bf16 v[104:107], v[72:75], a[8:11], 0
v_rcp_f32 v208, v208
v_mfma_f32_16x16x32_bf16 v[104:107], v[76:79], a[24:27], v[104:107]
ds_read_b128 v[68:71], v7 offset:5120
v_mul_f32 v209, v209, v208
v_mfma_f32_16x16x32_bf16 v[108:111], v[72:75], a[12:15], 0
v_rcp_f32 v210, v210
v_mfma_f32_16x16x32_bf16 v[108:111], v[76:79], a[28:31], v[108:111]
v_mul_f32 v211, v211, v210
s_waitcnt lgkmcnt(4)
v_mfma_f32_16x16x32_bf16 v[80:83], v[48:51], a[32:35], v[80:83]
v_cvt_pk_bf16_f32 v178, v209, v211
v_mul_f32 v214, v115, v115
v_mfma_f32_16x16x32_bf16 v[80:83], v[52:55], a[48:51], v[80:83]
v_fma_f32 v212, v212, v233, v232
v_fma_f32 v214, v214, v233, v232
v_mfma_f32_16x16x32_bf16 v[84:87], v[48:51], a[36:39], v[84:87]
ds_read_b128 v[72:75], v7 offset:6144
v_mul_f32 v212, v212, v114
v_mfma_f32_16x16x32_bf16 v[84:87], v[52:55], a[52:55], v[84:87]
v_mul_f32 v214, v214, v115
v_mul_f32 v213, v114, v130
v_mfma_f32_16x16x32_bf16 v[88:91], v[48:51], a[40:43], v[88:91]
v_exp_f32 v212, v212
v_mfma_f32_16x16x32_bf16 v[88:91], v[52:55], a[56:59], v[88:91]
ds_read_b128 v[76:79], v7 offset:7168
v_mul_f32 v215, v115, v131
v_mfma_f32_16x16x32_bf16 v[92:95], v[48:51], a[44:47], v[92:95]
v_exp_f32 v214, v214
v_mfma_f32_16x16x32_bf16 v[92:95], v[52:55], a[60:63], v[92:95]
v_fma_f32 v212, v212, v234, v234
s_waitcnt lgkmcnt(4)
v_mfma_f32_16x16x32_bf16 v[96:99], v[56:59], a[32:35], v[96:99]
s_waitcnt vmcnt(26)
v_fma_f32 v214, v214, v234, v234
v_mfma_f32_16x16x32_bf16 v[96:99], v[60:63], a[48:51], v[96:99]
s_barrier
v_mfma_f32_16x16x32_bf16 v[100:103], v[56:59], a[36:39], v[100:103]
ds_read_b128 v[48:51], v7 offset:8192
s_add_u32 m0, s22, 24576
v_mfma_f32_16x16x32_bf16 v[100:103], v[60:63], a[52:55], v[100:103]
v_add_u32 v3, 20480, v3
buffer_load_dwordx4 v3, s[8:11], 0 offen offset:0 sc1 lds
v_mfma_f32_16x16x32_bf16 v[104:107], v[56:59], a[40:43], v[104:107]
v_rcp_f32 v212, v212
v_mfma_f32_16x16x32_bf16 v[104:107], v[60:63], a[56:59], v[104:107]
ds_read_b128 v[52:55], v7 offset:9216
v_mul_f32 v213, v213, v212
v_mfma_f32_16x16x32_bf16 v[108:111], v[56:59], a[44:47], v[108:111]
v_rcp_f32 v214, v214
v_mfma_f32_16x16x32_bf16 v[108:111], v[60:63], a[60:63], v[108:111]
v_mul_f32 v215, v215, v214
s_waitcnt lgkmcnt(4)
v_mfma_f32_16x16x32_bf16 v[80:83], v[64:67], a[64:67], v[80:83]
buffer_load_dwordx4 v3, s[8:11], 0 offen offset:1024 sc1 lds
v_mfma_f32_16x16x32_bf16 v[80:83], v[68:71], a[80:83], v[80:83]
v_cvt_pk_bf16_f32 v179, v213, v215
v_mul_f32 v208, v116, v116
v_mfma_f32_16x16x32_bf16 v[84:87], v[64:67], a[68:71], v[84:87]
ds_read_b128 v[56:59], v7 offset:10240
v_mul_f32 v210, v117, v117
v_mfma_f32_16x16x32_bf16 v[84:87], v[68:71], a[84:87], v[84:87]
buffer_store_dwordx4 v[176:179], v2, s[8:11], s24 offen offset:2048 sc1
v_mfma_f32_16x16x32_bf16 v[88:91], v[64:67], a[72:75], v[88:91]
v_fma_f32 v208, v208, v237, v236
v_fma_f32 v210, v210, v237, v236
v_mfma_f32_16x16x32_bf16 v[88:91], v[68:71], a[88:91], v[88:91]
ds_read_b128 v[60:63], v7 offset:11264
v_mul_f32 v208, v208, v116
v_mfma_f32_16x16x32_bf16 v[92:95], v[64:67], a[76:79], v[92:95]
v_mul_f32 v210, v210, v117
v_mul_f32 v209, v116, v132
v_mfma_f32_16x16x32_bf16 v[92:95], v[68:71], a[92:95], v[92:95]
v_mul_f32 v211, v117, v133
s_waitcnt lgkmcnt(4)
v_mfma_f32_16x16x32_bf16 v[96:99], v[72:75], a[64:67], v[96:99]
buffer_load_dwordx4 v3, s[8:11], 0 offen offset:2048 sc1 lds
v_mfma_f32_16x16x32_bf16 v[96:99], v[76:79], a[80:83], v[96:99]
v_exp_f32 v208, v208
v_mfma_f32_16x16x32_bf16 v[100:103], v[72:75], a[68:71], v[100:103]
ds_read_b128 v[64:67], v7 offset:12288
v_fma_f32 v208, v208, v238, v238
v_mfma_f32_16x16x32_bf16 v[100:103], v[76:79], a[84:87], v[100:103]
v_exp_f32 v210, v210
v_mfma_f32_16x16x32_bf16 v[104:107], v[72:75], a[72:75], v[104:107]
v_fma_f32 v210, v210, v238, v238
v_mul_f32 v212, v118, v118
v_mfma_f32_16x16x32_bf16 v[104:107], v[76:79], a[88:91], v[104:107]
ds_read_b128 v[68:71], v7 offset:13312
v_mul_f32 v214, v119, v119
v_mfma_f32_16x16x32_bf16 v[108:111], v[72:75], a[76:79], v[108:111]
buffer_load_dwordx4 v3, s[8:11], 0 offen offset:3072 sc1 lds
v_mfma_f32_16x16x32_bf16 v[108:111], v[76:79], a[92:95], v[108:111]
s_add_u32 m0, s22, 28672
s_waitcnt lgkmcnt(4)
v_mfma_f32_16x16x32_bf16 v[80:83], v[48:51], a[96:99], v[80:83]
s_add_u32 s23, s34, 0
v_fma_f32 v212, v212, v237, v236
v_mfma_f32_16x16x32_bf16 v[80:83], v[52:55], a[112:115], v[80:83]
v_rcp_f32 v208, v208
v_mfma_f32_16x16x32_bf16 v[84:87], v[48:51], a[100:103], v[84:87]
ds_read_b128 v[72:75], v7 offset:14336
v_mul_f32 v209, v209, v208
v_mfma_f32_16x16x32_bf16 v[84:87], v[52:55], a[116:119], v[84:87]
buffer_load_dwordx2 v[14:15], v11, s[8:11], s23 offen sc1
v_mfma_f32_16x16x32_bf16 v[88:91], v[48:51], a[104:107], v[88:91]
v_add_u32 v3, 4096, v3
v_fma_f32 v214, v214, v237, v236
v_mfma_f32_16x16x32_bf16 v[88:91], v[52:55], a[120:123], v[88:91]
ds_read_b128 v[76:79], v7 offset:15360
v_mul_f32 v212, v212, v118
v_mfma_f32_16x16x32_bf16 v[92:95], v[48:51], a[108:111], v[92:95]
v_rcp_f32 v210, v210
v_mfma_f32_16x16x32_bf16 v[92:95], v[52:55], a[124:127], v[92:95]
v_mul_f32 v211, v211, v210
s_waitcnt lgkmcnt(4)
v_mfma_f32_16x16x32_bf16 v[96:99], v[56:59], a[96:99], v[96:99]
buffer_load_dwordx4 v3, s[8:11], 0 offen offset:0 sc1 lds
v_mfma_f32_16x16x32_bf16 v[96:99], v[60:63], a[112:115], v[96:99]
v_cvt_pk_bf16_f32 v182, v209, v211
v_mul_f32 v214, v214, v119
v_mfma_f32_16x16x32_bf16 v[100:103], v[56:59], a[100:103], v[100:103]
ds_read_b128 v[48:51], v7 offset:16384
v_mul_f32 v213, v118, v134
v_mfma_f32_16x16x32_bf16 v[100:103], v[60:63], a[116:119], v[100:103]
v_exp_f32 v212, v212
v_mfma_f32_16x16x32_bf16 v[104:107], v[56:59], a[104:107], v[104:107]
v_exp_f32 v214, v214
v_mfma_f32_16x16x32_bf16 v[104:107], v[60:63], a[120:123], v[104:107]
ds_read_b128 v[52:55], v7 offset:17408
v_mul_f32 v215, v119, v135
v_mfma_f32_16x16x32_bf16 v[108:111], v[56:59], a[108:111], v[108:111]
buffer_load_dwordx4 v3, s[8:11], 0 offen offset:1024 sc1 lds
v_mfma_f32_16x16x32_bf16 v[108:111], v[60:63], a[124:127], v[108:111]
v_fma_f32 v212, v212, v238, v238
s_waitcnt lgkmcnt(4)
v_mfma_f32_16x16x32_bf16 v[80:83], v[64:67], a[128:131], v[80:83]
v_fma_f32 v214, v214, v238, v238
v_mul_f32 v208, v120, v120
v_mfma_f32_16x16x32_bf16 v[80:83], v[68:71], a[144:147], v[80:83]
v_rcp_f32 v212, v212
v_mfma_f32_16x16x32_bf16 v[84:87], v[64:67], a[132:135], v[84:87]
ds_read_b128 v[56:59], v7 offset:18432
v_mul_f32 v213, v213, v212
v_mfma_f32_16x16x32_bf16 v[84:87], v[68:71], a[148:151], v[84:87]
v_rcp_f32 v214, v214
v_mfma_f32_16x16x32_bf16 v[88:91], v[64:67], a[136:139], v[88:91]
v_mul_f32 v215, v215, v214
v_cvt_pk_bf16_f32 v183, v213, v215
v_mfma_f32_16x16x32_bf16 v[88:91], v[68:71], a[152:155], v[88:91]
ds_read_b128 v[60:63], v7 offset:19456
v_mul_f32 v210, v121, v121
v_mfma_f32_16x16x32_bf16 v[92:95], v[64:67], a[140:143], v[92:95]
buffer_store_dwordx4 v[180:183], v4, s[8:11], s24 offen offset:2048 sc1
v_mfma_f32_16x16x32_bf16 v[92:95], v[68:71], a[156:159], v[92:95]
v_fma_f32 v208, v208, v241, v240
s_waitcnt lgkmcnt(4)
v_mfma_f32_16x16x32_bf16 v[96:99], v[72:75], a[128:131], v[96:99]
v_fma_f32 v210, v210, v241, v240
v_mul_f32 v208, v208, v120
v_mfma_f32_16x16x32_bf16 v[96:99], v[76:79], a[144:147], v[96:99]
v_mul_f32 v210, v210, v121
v_mul_f32 v209, v120, v136
v_mfma_f32_16x16x32_bf16 v[100:103], v[72:75], a[132:135], v[100:103]
ds_read_b128 v[64:67], v7 offset:20480
v_mul_f32 v211, v121, v137
v_mfma_f32_16x16x32_bf16 v[100:103], v[76:79], a[148:151], v[100:103]
v_exp_f32 v208, v208
v_mfma_f32_16x16x32_bf16 v[104:107], v[72:75], a[136:139], v[104:107]
v_exp_f32 v210, v210
v_mfma_f32_16x16x32_bf16 v[104:107], v[76:79], a[152:155], v[104:107]
ds_read_b128 v[68:71], v7 offset:21504
v_fma_f32 v208, v208, v242, v242
v_mfma_f32_16x16x32_bf16 v[108:111], v[72:75], a[140:143], v[108:111]
v_fma_f32 v210, v210, v242, v242
v_mul_f32 v212, v122, v122
v_mfma_f32_16x16x32_bf16 v[108:111], v[76:79], a[156:159], v[108:111]
v_mul_f32 v214, v123, v123
s_waitcnt lgkmcnt(4)
v_mfma_f32_16x16x32_bf16 v[80:83], v[48:51], a[160:163], v[80:83]
v_rcp_f32 v208, v208
v_mfma_f32_16x16x32_bf16 v[80:83], v[52:55], a[176:179], v[80:83]
v_rcp_f32 v210, v210
v_mfma_f32_16x16x32_bf16 v[84:87], v[48:51], a[164:167], v[84:87]
ds_read_b128 v[72:75], v7 offset:22528
v_mul_f32 v209, v209, v208
v_mfma_f32_16x16x32_bf16 v[84:87], v[52:55], a[180:183], v[84:87]
v_mul_f32 v211, v211, v210
v_cvt_pk_bf16_f32 v186, v209, v211
v_mfma_f32_16x16x32_bf16 v[88:91], v[48:51], a[168:171], v[88:91]
v_fma_f32 v212, v212, v241, v240
v_fma_f32 v214, v214, v241, v240
v_mfma_f32_16x16x32_bf16 v[88:91], v[52:55], a[184:187], v[88:91]
ds_read_b128 v[76:79], v7 offset:23552
v_mul_f32 v212, v212, v122
v_mfma_f32_16x16x32_bf16 v[92:95], v[48:51], a[172:175], v[92:95]
v_mul_f32 v214, v214, v123
v_mul_f32 v213, v122, v138
v_mfma_f32_16x16x32_bf16 v[92:95], v[52:55], a[188:191], v[92:95]
v_mul_f32 v215, v123, v139
s_waitcnt lgkmcnt(4)
v_mfma_f32_16x16x32_bf16 v[96:99], v[56:59], a[160:163], v[96:99]
v_exp_f32 v212, v212
v_mfma_f32_16x16x32_bf16 v[96:99], v[60:63], a[176:179], v[96:99]
v_exp_f32 v214, v214
v_mfma_f32_16x16x32_bf16 v[100:103], v[56:59], a[164:167], v[100:103]
ds_read_b128 v[48:51], v7 offset:24576
v_fma_f32 v212, v212, v242, v242
v_mfma_f32_16x16x32_bf16 v[100:103], v[60:63], a[180:183], v[100:103]
v_fma_f32 v214, v214, v242, v242
v_mul_f32 v208, v124, v124
v_mfma_f32_16x16x32_bf16 v[104:107], v[56:59], a[168:171], v[104:107]
v_rcp_f32 v212, v212
v_mfma_f32_16x16x32_bf16 v[104:107], v[60:63], a[184:187], v[104:107]
ds_read_b128 v[52:55], v7 offset:25600
v_mfma_f32_16x16x32_bf16 v[108:111], v[56:59], a[172:175], v[108:111]
v_rcp_f32 v214, v214
v_mfma_f32_16x16x32_bf16 v[108:111], v[60:63], a[188:191], v[108:111]
s_waitcnt lgkmcnt(4)
v_mfma_f32_16x16x32_bf16 v[80:83], v[64:67], a[192:195], v[80:83]
v_mul_f32 v213, v213, v212
v_mul_f32 v215, v215, v214
v_mfma_f32_16x16x32_bf16 v[80:83], v[68:71], a[208:211], v[80:83]
v_cvt_pk_bf16_f32 v187, v213, v215
v_mul_f32 v210, v125, v125
v_mfma_f32_16x16x32_bf16 v[84:87], v[64:67], a[196:199], v[84:87]
ds_read_b128 v[56:59], v7 offset:26624
v_mfma_f32_16x16x32_bf16 v[84:87], v[68:71], a[212:215], v[84:87]
buffer_store_dwordx4 v[184:187], v5, s[8:11], s24 offen offset:2048 sc1
v_mfma_f32_16x16x32_bf16 v[88:91], v[64:67], a[200:203], v[88:91]
v_mfma_f32_16x16x32_bf16 v[88:91], v[68:71], a[216:219], v[88:91]
ds_read_b128 v[60:63], v7 offset:27648
v_fma_f32 v208, v208, v245, v244
v_mfma_f32_16x16x32_bf16 v[92:95], v[64:67], a[204:207], v[92:95]
v_fma_f32 v210, v210, v245, v244
v_mul_f32 v208, v208, v124
v_mfma_f32_16x16x32_bf16 v[92:95], v[68:71], a[220:223], v[92:95]
v_mul_f32 v210, v210, v125
s_waitcnt lgkmcnt(4)
v_mfma_f32_16x16x32_bf16 v[96:99], v[72:75], a[192:195], v[96:99]
v_exp_f32 v208, v208
v_mfma_f32_16x16x32_bf16 v[96:99], v[76:79], a[208:211], v[96:99]
v_mfma_f32_16x16x32_bf16 v[100:103], v[72:75], a[196:199], v[100:103]
ds_read_b128 v[64:67], v7 offset:28672
v_mul_f32 v209, v124, v140
v_mfma_f32_16x16x32_bf16 v[100:103], v[76:79], a[212:215], v[100:103]
v_exp_f32 v210, v210
v_mfma_f32_16x16x32_bf16 v[104:107], v[72:75], a[200:203], v[104:107]
v_mfma_f32_16x16x32_bf16 v[104:107], v[76:79], a[216:219], v[104:107]
ds_read_b128 v[68:71], v7 offset:29696
v_mul_f32 v211, v125, v141
v_mfma_f32_16x16x32_bf16 v[108:111], v[72:75], a[204:207], v[108:111]
v_fma_f32 v208, v208, v246, v246
v_fma_f32 v210, v210, v246, v246
v_mfma_f32_16x16x32_bf16 v[108:111], v[76:79], a[220:223], v[108:111]
v_mul_f32 v212, v126, v126
s_waitcnt lgkmcnt(4)
v_mfma_f32_16x16x32_bf16 v[80:83], v[48:51], a[224:227], v[80:83]
v_rcp_f32 v208, v208
v_mfma_f32_16x16x32_bf16 v[80:83], v[52:55], a[240:243], v[80:83]
v_mfma_f32_16x16x32_bf16 v[84:87], v[48:51], a[228:231], v[84:87]
ds_read_b128 v[72:75], v7 offset:30720
v_mul_f32 v209, v209, v208
v_mfma_f32_16x16x32_bf16 v[84:87], v[52:55], a[244:247], v[84:87]
v_rcp_f32 v210, v210
v_mfma_f32_16x16x32_bf16 v[88:91], v[48:51], a[232:235], v[88:91]
v_mul_f32 v211, v211, v210
v_cvt_pk_bf16_f32 v190, v209, v211
v_mfma_f32_16x16x32_bf16 v[88:91], v[52:55], a[248:251], v[88:91]
ds_read_b128 v[76:79], v7 offset:31744
v_mfma_f32_16x16x32_bf16 v[92:95], v[48:51], a[236:239], v[92:95]
v_mul_f32 v214, v127, v127
v_fma_f32 v212, v212, v245, v244
v_mfma_f32_16x16x32_bf16 v[92:95], v[52:55], a[252:255], v[92:95]
s_waitcnt lgkmcnt(4)
v_mfma_f32_16x16x32_bf16 v[96:99], v[56:59], a[224:227], v[96:99]
s_waitcnt vmcnt(28)
v_fma_f32 v214, v214, v245, v244
v_mfma_f32_16x16x32_bf16 v[96:99], v[60:63], a[240:243], v[96:99]
s_barrier
v_mfma_f32_16x16x32_bf16 v[100:103], v[56:59], a[228:231], v[100:103]
ds_read_b128 v[48:51], v7 offset:32768
s_add_u32 m0, s22, 49152
v_mfma_f32_16x16x32_bf16 v[100:103], v[60:63], a[244:247], v[100:103]
v_add_u32 v3, 20480, v3
buffer_load_dwordx4 v3, s[8:11], 0 offen offset:0 sc1 lds
v_mfma_f32_16x16x32_bf16 v[104:107], v[56:59], a[232:235], v[104:107]
v_mul_f32 v212, v212, v126
v_mul_f32 v214, v214, v127
v_mfma_f32_16x16x32_bf16 v[104:107], v[60:63], a[248:251], v[104:107]
ds_read_b128 v[52:55], v7 offset:33792
v_mul_f32 v213, v126, v142
v_mfma_f32_16x16x32_bf16 v[108:111], v[56:59], a[236:239], v[108:111]
v_exp_f32 v212, v212
v_mfma_f32_16x16x32_bf16 v[108:111], v[60:63], a[252:255], v[108:111]
v_mul_f32 v215, v127, v143
s_waitcnt lgkmcnt(4)
v_mfma_f32_16x16x32_bf16 v[80:83], v[64:67], v[16:19], v[80:83]
buffer_load_dwordx4 v3, s[8:11], 0 offen offset:1024 sc1 lds
v_mfma_f32_16x16x32_bf16 v[80:83], v[68:71], v[32:35], v[80:83]
v_exp_f32 v214, v214
v_mfma_f32_16x16x32_bf16 v[84:87], v[64:67], v[20:23], v[84:87]
ds_read_b128 v[56:59], v7 offset:34816
v_fma_f32 v212, v212, v246, v246
v_mfma_f32_16x16x32_bf16 v[84:87], v[68:71], v[36:39], v[84:87]
v_fma_f32 v214, v214, v246, v246
v_mfma_f32_16x16x32_bf16 v[88:91], v[64:67], v[24:27], v[88:91]
v_rcp_f32 v212, v212
v_mfma_f32_16x16x32_bf16 v[88:91], v[68:71], v[40:43], v[88:91]
ds_read_b128 v[60:63], v7 offset:35840
v_mul_f32 v213, v213, v212
v_mfma_f32_16x16x32_bf16 v[92:95], v[64:67], v[28:31], v[92:95]
buffer_load_dwordx4 v3, s[8:11], 0 offen offset:2048 sc1 lds
v_mfma_f32_16x16x32_bf16 v[92:95], v[68:71], v[44:47], v[92:95]
s_waitcnt lgkmcnt(4)
v_mfma_f32_16x16x32_bf16 v[96:99], v[72:75], v[16:19], v[96:99]
s_waitcnt vmcnt(7)
v_cmp_eq_u64 vcc, s[68:69], v[14:15]
s_nop 0
s_cmp_eq_u64 vcc, exec
s_cbranch_scc0 L_f_slow1
L_f_back1:
v_mfma_f32_16x16x32_bf16 v[96:99], v[76:79], v[32:35], v[96:99]
v_rcp_f32 v214, v214
v_mfma_f32_16x16x32_bf16 v[100:103], v[72:75], v[20:23], v[100:103]
ds_read_b128 v[64:67], v7 offset:36864
v_mul_f32 v215, v215, v214
v_mfma_f32_16x16x32_bf16 v[100:103], v[76:79], v[36:39], v[100:103]
buffer_load_dwordx4 v3, s[8:11], 0 offen offset:3072 sc1 lds
v_mfma_f32_16x16x32_bf16 v[104:107], v[72:75], v[24:27], v[104:107]
s_add_u32 m0, s22, 53248
v_add_u32 v3, 4096, v3
v_mfma_f32_16x16x32_bf16 v[104:107], v[76:79], v[40:43], v[104:107]
ds_read_b128 v[68:71], v7 offset:37888
v_cvt_pk_bf16_f32 v191, v213, v215
v_mfma_f32_16x16x32_bf16 v[108:111], v[72:75], v[28:31], v[108:111]
buffer_store_dwordx4 v[188:191], v6, s[8:11], s24 offen offset:2048 sc1
v_mfma_f32_16x16x32_bf16 v[108:111], v[76:79], v[44:47], v[108:111]
s_waitcnt lgkmcnt(4)
v_mfma_f32_16x16x32_bf16 v[112:115], v[48:51], a[0:3], 0
v_mfma_f32_16x16x32_bf16 v[112:115], v[52:55], a[16:19], v[112:115]
v_mfma_f32_16x16x32_bf16 v[116:119], v[48:51], a[4:7], 0
ds_read_b128 v[72:75], v7 offset:38912
v_mfma_f32_16x16x32_bf16 v[116:119], v[52:55], a[20:23], v[116:119]
buffer_load_dwordx4 v3, s[8:11], 0 offen offset:0 sc1 lds
v_mfma_f32_16x16x32_bf16 v[120:123], v[48:51], a[8:11], 0
v_mul_f32 v208, v80, v80
v_mul_f32 v210, v81, v81
v_mfma_f32_16x16x32_bf16 v[120:123], v[52:55], a[24:27], v[120:123]
ds_read_b128 v[76:79], v7 offset:39936
v_fma_f32 v208, v208, v233, v232
v_mfma_f32_16x16x32_bf16 v[124:127], v[48:51], a[12:15], 0
v_fma_f32 v210, v210, v233, v232
v_mul_f32 v208, v208, v80
v_mfma_f32_16x16x32_bf16 v[124:127], v[52:55], a[28:31], v[124:127]
v_mul_f32 v210, v210, v81
s_waitcnt lgkmcnt(4)
v_mfma_f32_16x16x32_bf16 v[128:131], v[56:59], a[0:3], 0
buffer_load_dwordx4 v3, s[8:11], 0 offen offset:1024 sc1 lds
v_mfma_f32_16x16x32_bf16 v[128:131], v[60:63], a[16:19], v[128:131]
v_exp_f32 v208, v208
v_mfma_f32_16x16x32_bf16 v[132:135], v[56:59], a[4:7], 0
ds_read_b128 v[48:51], v7 offset:40960
v_mul_f32 v209, v80, v96
v_mfma_f32_16x16x32_bf16 v[132:135], v[60:63], a[20:23], v[132:135]
v_exp_f32 v210, v210
v_mfma_f32_16x16x32_bf16 v[136:139], v[56:59], a[8:11], 0
v_mul_f32 v211, v81, v97
v_fma_f32 v208, v208, v234, v234
v_mfma_f32_16x16x32_bf16 v[136:139], v[60:63], a[24:27], v[136:139]
ds_read_b128 v[52:55], v7 offset:41984
v_fma_f32 v210, v210, v234, v234
v_mfma_f32_16x16x32_bf16 v[140:143], v[56:59], a[12:15], 0
v_rcp_f32 v208, v208
v_mfma_f32_16x16x32_bf16 v[140:143], v[60:63], a[28:31], v[140:143]
v_mul_f32 v209, v209, v208
s_waitcnt lgkmcnt(4)
v_mfma_f32_16x16x32_bf16 v[112:115], v[64:67], a[32:35], v[112:115]
buffer_load_dwordx4 a[0:3], v2, s[8:11], s25 offen offset:0 sc1
v_mfma_f32_16x16x32_bf16 v[112:115], v[68:71], a[48:51], v[112:115]
v_rcp_f32 v210, v210
v_mfma_f32_16x16x32_bf16 v[116:119], v[64:67], a[36:39], v[116:119]
ds_read_b128 v[56:59], v7 offset:43008
v_mul_f32 v211, v211, v210
v_mfma_f32_16x16x32_bf16 v[116:119], v[68:71], a[52:55], v[116:119]
v_cvt_pk_bf16_f32 v192, v209, v211
v_mul_f32 v212, v82, v82
v_mfma_f32_16x16x32_bf16 v[120:123], v[64:67], a[40:43], v[120:123]
v_mul_f32 v214, v83, v83
v_fma_f32 v212, v212, v233, v232
v_mfma_f32_16x16x32_bf16 v[120:123], v[68:71], a[56:59], v[120:123]
ds_read_b128 v[60:63], v7 offset:44032
v_fma_f32 v214, v214, v233, v232
v_mfma_f32_16x16x32_bf16 v[124:127], v[64:67], a[44:47], v[124:127]
buffer_load_dwordx4 a[4:7], v4, s[8:11], s25 offen offset:0 sc1
v_mfma_f32_16x16x32_bf16 v[124:127], v[68:71], a[60:63], v[124:127]
v_mul_f32 v212, v212, v82
s_waitcnt lgkmcnt(4)
v_mfma_f32_16x16x32_bf16 v[128:131], v[72:75], a[32:35], v[128:131]
v_mul_f32 v214, v214, v83
v_mul_f32 v213, v82, v98
v_mfma_f32_16x16x32_bf16 v[128:131], v[76:79], a[48:51], v[128:131]
v_exp_f32 v212, v212
v_mfma_f32_16x16x32_bf16 v[132:135], v[72:75], a[36:39], v[132:135]
ds_read_b128 v[64:67], v7 offset:45056
v_mul_f32 v215, v83, v99
v_mfma_f32_16x16x32_bf16 v[132:135], v[76:79], a[52:55], v[132:135]
buffer_load_dwordx4 a[8:11], v5, s[8:11], s25 offen offset:0 sc1
v_mfma_f32_16x16x32_bf16 v[136:139], v[72:75], a[40:43], v[136:139]
v_exp_f32 v214, v214
v_mfma_f32_16x16x32_bf16 v[136:139], v[76:79], a[56:59], v[136:139]
ds_read_b128 v[68:71], v7 offset:46080
v_fma_f32 v212, v212, v234, v234
v_mfma_f32_16x16x32_bf16 v[140:143], v[72:75], a[44:47], v[140:143]
v_fma_f32 v214, v214, v234, v234
v_mul_f32 v208, v84, v84
v_mfma_f32_16x16x32_bf16 v[140:143], v[76:79], a[60:63], v[140:143]
v_mul_f32 v210, v85, v85
s_waitcnt lgkmcnt(4)
v_mfma_f32_16x16x32_bf16 v[112:115], v[48:51], a[64:67], v[112:115]
buffer_load_dwordx4 a[12:15], v6, s[8:11], s25 offen offset:0 sc1
v_mfma_f32_16x16x32_bf16 v[112:115], v[52:55], a[80:83], v[112:115]
v_rcp_f32 v212, v212
v_mfma_f32_16x16x32_bf16 v[116:119], v[48:51], a[68:71], v[116:119]
ds_read_b128 v[72:75], v7 offset:47104
v_mul_f32 v213, v213, v212
v_mfma_f32_16x16x32_bf16 v[116:119], v[52:55], a[84:87], v[116:119]
v_rcp_f32 v214, v214
v_mfma_f32_16x16x32_bf16 v[120:123], v[48:51], a[72:75], v[120:123]
v_mul_f32 v215, v215, v214
v_cvt_pk_bf16_f32 v193, v213, v215
v_mfma_f32_16x16x32_bf16 v[120:123], v[52:55], a[88:91], v[120:123]
ds_read_b128 v[76:79], v7 offset:48128
v_fma_f32 v208, v208, v237, v236
v_mfma_f32_16x16x32_bf16 v[124:127], v[48:51], a[76:79], v[124:127]
buffer_load_dwordx4 a[16:19], v2, s[8:11], s26 offen offset:0 sc1
v_mfma_f32_16x16x32_bf16 v[124:127], v[52:55], a[92:95], v[124:127]
v_fma_f32 v210, v210, v237, v236
s_waitcnt lgkmcnt(4)
v_mfma_f32_16x16x32_bf16 v[128:131], v[56:59], a[64:67], v[128:131]
v_mul_f32 v208, v208, v84
v_mul_f32 v210, v210, v85
v_mfma_f32_16x16x32_bf16 v[128:131], v[60:63], a[80:83], v[128:131]
v_exp_f32 v208, v208
v_mfma_f32_16x16x32_bf16 v[132:135], v[56:59], a[68:71], v[132:135]
ds_read_b128 v[48:51], v7 offset:49152
v_mul_f32 v209, v84, v100
v_mfma_f32_16x16x32_bf16 v[132:135], v[60:63], a[84:87], v[132:135]
buffer_load_dwordx4 a[20:23], v4, s[8:11], s26 offen offset:0 sc1
v_mfma_f32_16x16x32_bf16 v[136:139], v[56:59], a[72:75], v[136:139]
v_exp_f32 v210, v210
v_mfma_f32_16x16x32_bf16 v[136:139], v[60:63], a[88:91], v[136:139]
ds_read_b128 v[52:55], v7 offset:50176
v_mul_f32 v211, v85, v101
v_mfma_f32_16x16x32_bf16 v[140:143], v[56:59], a[76:79], v[140:143]
v_fma_f32 v208, v208, v238, v238
v_fma_f32 v210, v210, v238, v238
v_mfma_f32_16x16x32_bf16 v[140:143], v[60:63], a[92:95], v[140:143]
v_mul_f32 v212, v86, v86
s_waitcnt lgkmcnt(4)
v_mfma_f32_16x16x32_bf16 v[112:115], v[64:67], a[96:99], v[112:115]
v_mov_b32 v12, s68
v_mov_b32 v13, s69
v_mfma_f32_16x16x32_bf16 v[112:115], v[68:71], a[112:115], v[112:115]
s_add_u32 s53, s34, 131072
s_waitcnt vmcnt(8)
buffer_store_dwordx2 v[12:13], v10, s[8:11], s53 offen sc1
v_mfma_f32_16x16x32_bf16 v[116:119], v[64:67], a[100:103], v[116:119]
ds_read_b128 v[56:59], v7 offset:51200
v_mul_f32 v214, v87, v87
v_mfma_f32_16x16x32_bf16 v[116:119], v[68:71], a[116:119], v[116:119]
v_rcp_f32 v208, v208
v_mfma_f32_16x16x32_bf16 v[120:123], v[64:67], a[104:107], v[120:123]
v_rcp_f32 v210, v210
v_mfma_f32_16x16x32_bf16 v[120:123], v[68:71], a[120:123], v[120:123]
ds_read_b128 v[60:63], v7 offset:52224
v_mul_f32 v209, v209, v208
v_mfma_f32_16x16x32_bf16 v[124:127], v[64:67], a[108:111], v[124:127]
buffer_load_dwordx4 a[24:27], v5, s[8:11], s26 offen offset:0 sc1
v_mfma_f32_16x16x32_bf16 v[124:127], v[68:71], a[124:127], v[124:127]
v_mul_f32 v211, v211, v210
s_waitcnt lgkmcnt(4)
v_mfma_f32_16x16x32_bf16 v[128:131], v[72:75], a[96:99], v[128:131]
v_cvt_pk_bf16_f32 v196, v209, v211
v_fma_f32 v212, v212, v237, v236
v_mfma_f32_16x16x32_bf16 v[128:131], v[76:79], a[112:115], v[128:131]
v_fma_f32 v214, v214, v237, v236
v_mul_f32 v212, v212, v86
v_mfma_f32_16x16x32_bf16 v[132:135], v[72:75], a[100:103], v[132:135]
ds_read_b128 v[64:67], v7 offset:53248
v_mul_f32 v214, v214, v87
v_mfma_f32_16x16x32_bf16 v[132:135], v[76:79], a[116:119], v[132:135]
buffer_load_dwordx4 a[28:31], v6, s[8:11], s26 offen offset:0 sc1
v_mfma_f32_16x16x32_bf16 v[136:139], v[72:75], a[104:107], v[136:139]
v_exp_f32 v212, v212
v_mfma_f32_16x16x32_bf16 v[136:139], v[76:79], a[120:123], v[136:139]
ds_read_b128 v[68:71], v7 offset:54272
v_mul_f32 v213, v86, v102
v_mfma_f32_16x16x32_bf16 v[140:143], v[72:75], a[108:111], v[140:143]
v_exp_f32 v214, v214
v_mfma_f32_16x16x32_bf16 v[140:143], v[76:79], a[124:127], v[140:143]
v_mul_f32 v215, v87, v103
s_waitcnt lgkmcnt(4)
v_mfma_f32_16x16x32_bf16 v[112:115], v[48:51], a[128:131], v[112:115]
buffer_load_dwordx4 a[32:35], v2, s[8:11], s27 offen offset:0 sc1
v_mfma_f32_16x16x32_bf16 v[112:115], v[52:55], a[144:147], v[112:115]
v_fma_f32 v212, v212, v238, v238
v_fma_f32 v214, v214, v238, v238
v_mfma_f32_16x16x32_bf16 v[116:119], v[48:51], a[132:135], v[116:119]
ds_read_b128 v[72:75], v7 offset:55296
v_mul_f32 v208, v88, v88
v_mfma_f32_16x16x32_bf16 v[116:119], v[52:55], a[148:151], v[116:119]
v_rcp_f32 v212, v212
v_mfma_f32_16x16x32_bf16 v[120:123], v[48:51], a[136:139], v[120:123]
v_rcp_f32 v214, v214
v_mfma_f32_16x16x32_bf16 v[120:123], v[52:55], a[152:155], v[120:123]
ds_read_b128 v[76:79], v7 offset:56320
v_mul_f32 v213, v213, v212
v_mfma_f32_16x16x32_bf16 v[124:127], v[48:51], a[140:143], v[124:127]
buffer_load_dwordx4 a[36:39], v4, s[8:11], s27 offen offset:0 sc1
v_mfma_f32_16x16x32_bf16 v[124:127], v[52:55], a[156:159], v[124:127]
v_mul_f32 v215, v215, v214
s_waitcnt lgkmcnt(4)
v_mfma_f32_16x16x32_bf16 v[128:131], v[56:59], a[128:131], v[128:131]
s_waitcnt vmcnt(36)
v_cvt_pk_bf16_f32 v197, v213, v215
v_mfma_f32_16x16x32_bf16 v[128:131], v[60:63], a[144:147], v[128:131]
s_barrier
v_mfma_f32_16x16x32_bf16 v[132:135], v[56:59], a[132:135], v[132:135]
ds_read_b128 v[48:51], v7 offset:57344
v_mul_f32 v210, v89, v89
v_mfma_f32_16x16x32_bf16 v[132:135], v[60:63], a[148:151], v[132:135]
buffer_load_dwordx4 a[40:43], v5, s[8:11], s27 offen offset:0 sc1
v_mfma_f32_16x16x32_bf16 v[136:139], v[56:59], a[136:139], v[136:139]
v_fma_f32 v208, v208, v241, v240
v_fma_f32 v210, v210, v241, v240
v_mfma_f32_16x16x32_bf16 v[136:139], v[60:63], a[152:155], v[136:139]
ds_read_b128 v[52:55], v7 offset:58368
v_mul_f32 v208, v208, v88
v_mfma_f32_16x16x32_bf16 v[140:143], v[56:59], a[140:143], v[140:143]
v_mul_f32 v210, v210, v89
v_mul_f32 v209, v88, v104
v_mfma_f32_16x16x32_bf16 v[140:143], v[60:63], a[156:159], v[140:143]
v_mul_f32 v211, v89, v105
s_waitcnt lgkmcnt(4)
v_mfma_f32_16x16x32_bf16 v[112:115], v[64:67], a[160:163], v[112:115]
buffer_load_dwordx4 a[44:47], v6, s[8:11], s27 offen offset:0 sc1
v_mfma_f32_16x16x32_bf16 v[112:115], v[68:71], a[176:179], v[112:115]
v_exp_f32 v208, v208
v_mfma_f32_16x16x32_bf16 v[116:119], v[64:67], a[164:167], v[116:119]
ds_read_b128 v[56:59], v7 offset:59392
v_fma_f32 v208, v208, v242, v242
v_mfma_f32_16x16x32_bf16 v[116:119], v[68:71], a[180:183], v[116:119]
v_exp_f32 v210, v210
v_mfma_f32_16x16x32_bf16 v[120:123], v[64:67], a[168:171], v[120:123]
v_fma_f32 v210, v210, v242, v242
v_mul_f32 v212, v90, v90
v_mfma_f32_16x16x32_bf16 v[120:123], v[68:71], a[184:187], v[120:123]
ds_read_b128 v[60:63], v7 offset:60416
v_mul_f32 v214, v91, v91
v_mfma_f32_16x16x32_bf16 v[124:127], v[64:67], a[172:175], v[124:127]
buffer_load_dwordx4 a[48:51], v2, s[8:11], s25 offen offset:1024 sc1
v_mfma_f32_16x16x32_bf16 v[124:127], v[68:71], a[188:191], v[124:127]
v_fma_f32 v212, v212, v241, v240
s_waitcnt lgkmcnt(4)
v_mfma_f32_16x16x32_bf16 v[128:131], v[72:75], a[160:163], v[128:131]
v_rcp_f32 v208, v208
v_mfma_f32_16x16x32_bf16 v[128:131], v[76:79], a[176:179], v[128:131]
v_rcp_f32 v210, v210
v_mfma_f32_16x16x32_bf16 v[132:135], v[72:75], a[164:167], v[132:135]
ds_read_b128 v[64:67], v7 offset:61440
v_mul_f32 v209, v209, v208
v_mfma_f32_16x16x32_bf16 v[132:135], v[76:79], a[180:183], v[132:135]
buffer_load_dwordx4 a[52:55], v4, s[8:11], s25 offen offset:1024 sc1
v_mfma_f32_16x16x32_bf16 v[136:139], v[72:75], a[168:171], v[136:139]
v_mul_f32 v211, v211, v210
v_cvt_pk_bf16_f32 v200, v209, v211
v_mfma_f32_16x16x32_bf16 v[136:139], v[76:79], a[184:187], v[136:139]
ds_read_b128 v[68:71], v7 offset:62464
v_fma_f32 v214, v214, v241, v240
v_mfma_f32_16x16x32_bf16 v[140:143], v[72:75], a[172:175], v[140:143]
v_mul_f32 v212, v212, v90
v_mul_f32 v214, v214, v91
v_mfma_f32_16x16x32_bf16 v[140:143], v[76:79], a[188:191], v[140:143]
v_mul_f32 v213, v90, v106
s_waitcnt lgkmcnt(4)
v_mfma_f32_16x16x32_bf16 v[112:115], v[48:51], a[192:195], v[112:115]
buffer_load_dwordx4 a[56:59], v5, s[8:11], s25 offen offset:1024 sc1
v_mfma_f32_16x16x32_bf16 v[112:115], v[52:55], a[208:211], v[112:115]
v_exp_f32 v212, v212
v_mfma_f32_16x16x32_bf16 v[116:119], v[48:51], a[196:199], v[116:119]
ds_read_b128 v[72:75], v7 offset:63488
v_mul_f32 v215, v91, v107
v_mfma_f32_16x16x32_bf16 v[116:119], v[52:55], a[212:215], v[116:119]
v_exp_f32 v214, v214
v_mfma_f32_16x16x32_bf16 v[120:123], v[48:51], a[200:203], v[120:123]
v_fma_f32 v212, v212, v242, v242
v_fma_f32 v214, v214, v242, v242
v_mfma_f32_16x16x32_bf16 v[120:123], v[52:55], a[216:219], v[120:123]
ds_read_b128 v[76:79], v7 offset:64512
v_mul_f32 v208, v92, v92
v_mfma_f32_16x16x32_bf16 v[124:127], v[48:51], a[204:207], v[124:127]
buffer_load_dwordx4 a[60:63], v6, s[8:11], s25 offen offset:1024 sc1
v_mfma_f32_16x16x32_bf16 v[124:127], v[52:55], a[220:223], v[124:127]
v_mul_f32 v210, v93, v93
s_waitcnt lgkmcnt(4)
v_mfma_f32_16x16x32_bf16 v[128:131], v[56:59], a[192:195], v[128:131]
v_rcp_f32 v212, v212
v_mfma_f32_16x16x32_bf16 v[128:131], v[60:63], a[208:211], v[128:131]
v_rcp_f32 v214, v214
v_mfma_f32_16x16x32_bf16 v[132:135], v[56:59], a[196:199], v[132:135]
ds_read_b128 v[48:51], v8 offset:0
v_mul_f32 v213, v213, v212
v_mfma_f32_16x16x32_bf16 v[132:135], v[60:63], a[212:215], v[132:135]
buffer_load_dwordx4 a[64:67], v2, s[8:11], s26 offen offset:1024 sc1
v_mfma_f32_16x16x32_bf16 v[136:139], v[56:59], a[200:203], v[136:139]
v_mul_f32 v215, v215, v214
v_cvt_pk_bf16_f32 v201, v213, v215
v_mfma_f32_16x16x32_bf16 v[136:139], v[60:63], a[216:219], v[136:139]
ds_read_b128 v[52:55], v8 offset:1024
v_fma_f32 v208, v208, v245, v244
v_mfma_f32_16x16x32_bf16 v[140:143], v[56:59], a[204:207], v[140:143]
v_fma_f32 v210, v210, v245, v244
v_mul_f32 v208, v208, v92
v_mfma_f32_16x16x32_bf16 v[140:143], v[60:63], a[220:223], v[140:143]
v_mul_f32 v210, v210, v93
s_waitcnt lgkmcnt(4)
v_mfma_f32_16x16x32_bf16 v[112:115], v[64:67], a[224:227], v[112:115]
buffer_load_dwordx4 a[68:71], v4, s[8:11], s26 offen offset:1024 sc1
v_mfma_f32_16x16x32_bf16 v[112:115], v[68:71], a[240:243], v[112:115]
v_exp_f32 v208, v208
v_mfma_f32_16x16x32_bf16 v[116:119], v[64:67], a[228:231], v[116:119]
ds_read_b128 v[56:59], v8 offset:2048
v_mul_f32 v209, v92, v108
v_mfma_f32_16x16x32_bf16 v[116:119], v[68:71], a[244:247], v[116:119]
v_exp_f32 v210, v210
v_mfma_f32_16x16x32_bf16 v[120:123], v[64:67], a[232:235], v[120:123]
v_mul_f32 v211, v93, v109
v_fma_f32 v208, v208, v246, v246
v_mfma_f32_16x16x32_bf16 v[120:123], v[68:71], a[248:251], v[120:123]
ds_read_b128 v[60:63], v8 offset:3072
v_fma_f32 v210, v210, v246, v246
v_mfma_f32_16x16x32_bf16 v[124:127], v[64:67], a[236:239], v[124:127]
buffer_load_dwordx4 a[72:75], v5, s[8:11], s26 offen offset:1024 sc1
v_mfma_f32_16x16x32_bf16 v[124:127], v[68:71], a[252:255], v[124:127]
v_mul_f32 v212, v94, v94
s_waitcnt lgkmcnt(4)
v_mfma_f32_16x16x32_bf16 v[128:131], v[72:75], a[224:227], v[128:131]
v_rcp_f32 v208, v208
v_mfma_f32_16x16x32_bf16 v[128:131], v[76:79], a[240:243], v[128:131]
v_rcp_f32 v210, v210
v_mfma_f32_16x16x32_bf16 v[132:135], v[72:75], a[228:231], v[132:135]
ds_read_b128 v[64:67], v8 offset:4096
v_mul_f32 v209, v209, v208
v_mfma_f32_16x16x32_bf16 v[132:135], v[76:79], a[244:247], v[132:135]
buffer_load_dwordx4 a[76:79], v6, s[8:11], s26 offen offset:1024 sc1
v_mfma_f32_16x16x32_bf16 v[136:139], v[72:75], a[232:235], v[136:139]
v_mul_f32 v211, v211, v210
v_cvt_pk_bf16_f32 v204, v209, v211
v_mfma_f32_16x16x32_bf16 v[136:139], v[76:79], a[248:251], v[136:139]
ds_read_b128 v[68:71], v8 offset:5120
v_mul_f32 v214, v95, v95
v_mfma_f32_16x16x32_bf16 v[140:143], v[72:75], a[236:239], v[140:143]
v_fma_f32 v212, v212, v245, v244
v_fma_f32 v214, v214, v245, v244
v_mfma_f32_16x16x32_bf16 v[140:143], v[76:79], a[252:255], v[140:143]
v_mul_f32 v212, v212, v94
s_waitcnt lgkmcnt(4)
v_mfma_f32_16x16x32_bf16 v[112:115], v[48:51], v[16:19], v[112:115]
s_add_u32 s23, s34, 131072
v_mul_f32 v214, v214, v95
v_mfma_f32_16x16x32_bf16 v[112:115], v[52:55], v[32:35], v[112:115]
buffer_load_dwordx2 v[14:15], v11, s[8:11], s23 offen sc1
v_mfma_f32_16x16x32_bf16 v[116:119], v[48:51], v[20:23], v[116:119]
ds_read_b128 v[72:75], v8 offset:6144
v_mul_f32 v213, v94, v110
v_mfma_f32_16x16x32_bf16 v[116:119], v[52:55], v[36:39], v[116:119]
v_exp_f32 v212, v212
v_mfma_f32_16x16x32_bf16 v[120:123], v[48:51], v[24:27], v[120:123]
v_exp_f32 v214, v214
v_mfma_f32_16x16x32_bf16 v[120:123], v[52:55], v[40:43], v[120:123]
ds_read_b128 v[76:79], v8 offset:7168
v_mul_f32 v215, v95, v111
v_mfma_f32_16x16x32_bf16 v[124:127], v[48:51], v[28:31], v[124:127]
buffer_load_dwordx4 a[80:83], v2, s[8:11], s27 offen offset:1024 sc1
v_mfma_f32_16x16x32_bf16 v[124:127], v[52:55], v[44:47], v[124:127]
v_fma_f32 v212, v212, v246, v246
s_waitcnt lgkmcnt(4)
v_mfma_f32_16x16x32_bf16 v[128:131], v[56:59], v[16:19], v[128:131]
v_fma_f32 v214, v214, v246, v246
v_mfma_f32_16x16x32_bf16 v[128:131], v[60:63], v[32:35], v[128:131]
v_rcp_f32 v212, v212
v_mfma_f32_16x16x32_bf16 v[132:135], v[56:59], v[20:23], v[132:135]
ds_read_b128 v[48:51], v8 offset:8192
v_mul_f32 v213, v213, v212
v_mfma_f32_16x16x32_bf16 v[132:135], v[60:63], v[36:39], v[132:135]
buffer_load_dwordx4 a[84:87], v4, s[8:11], s27 offen offset:1024 sc1
v_mfma_f32_16x16x32_bf16 v[136:139], v[56:59], v[24:27], v[136:139]
v_rcp_f32 v214, v214
v_mfma_f32_16x16x32_bf16 v[136:139], v[60:63], v[40:43], v[136:139]
ds_read_b128 v[52:55], v8 offset:9216
v_mul_f32 v215, v215, v214
v_mfma_f32_16x16x32_bf16 v[140:143], v[56:59], v[28:31], v[140:143]
v_cvt_pk_bf16_f32 v205, v213, v215
v_mfma_f32_16x16x32_bf16 v[140:143], v[60:63], v[44:47], v[140:143]
s_waitcnt lgkmcnt(4)
v_mfma_f32_16x16x32_bf16 a[112:115], v[64:67], v[144:147], 0
v_mfma_f32_16x16x32_bf16 a[112:115], v[68:71], v[160:163], a[112:115]
v_mfma_f32_16x16x32_bf16 a[116:119], v[64:67], v[148:151], 0
ds_read_b128 v[56:59], v8 offset:10240
v_mfma_f32_16x16x32_bf16 a[116:119], v[68:71], v[164:167], a[116:119]
v_mul_f32 v208, v112, v112
v_mul_f32 v210, v113, v113
v_mfma_f32_16x16x32_bf16 a[120:123], v[64:67], v[152:155], 0
v_fma_f32 v208, v208, v233, v232
v_fma_f32 v210, v210, v233, v232
v_mfma_f32_16x16x32_bf16 a[120:123], v[68:71], v[168:171], a[120:123]
ds_read_b128 v[60:63], v8 offset:11264
v_mul_f32 v208, v208, v112
v_mfma_f32_16x16x32_bf16 a[124:127], v[64:67], v[156:159], 0
v_mul_f32 v210, v210, v113
v_mul_f32 v209, v112, v128
v_mfma_f32_16x16x32_bf16 a[124:127], v[68:71], v[172:175], a[124:127]
v_mul_f32 v211, v113, v129
s_waitcnt lgkmcnt(4)
v_mfma_f32_16x16x32_bf16 a[128:131], v[72:75], v[144:147], 0
v_exp_f32 v208, v208
v_mfma_f32_16x16x32_bf16 a[128:131], v[76:79], v[160:163], a[128:131]
v_exp_f32 v210, v210
v_mfma_f32_16x16x32_bf16 a[132:135], v[72:75], v[148:151], 0
ds_read_b128 v[64:67], v8 offset:12288
v_fma_f32 v208, v208, v234, v234
v_mfma_f32_16x16x32_bf16 a[132:135], v[76:79], v[164:167], a[132:135]
v_fma_f32 v210, v210, v234, v234
v_mul_f32 v212, v114, v114
v_mfma_f32_16x16x32_bf16 a[136:139], v[72:75], v[152:155], 0
v_rcp_f32 v208, v208
v_mfma_f32_16x16x32_bf16 a[136:139], v[76:79], v[168:171], a[136:139]
ds_read_b128 v[68:71], v8 offset:13312
v_mul_f32 v209, v209, v208
v_mfma_f32_16x16x32_bf16 a[140:143], v[72:75], v[156:159], 0
v_rcp_f32 v210, v210
v_mfma_f32_16x16x32_bf16 a[140:143], v[76:79], v[172:175], a[140:143]
v_mul_f32 v211, v211, v210
s_waitcnt lgkmcnt(4)
v_mfma_f32_16x16x32_bf16 a[144:147], v[48:51], v[144:147], 0
v_cvt_pk_bf16_f32 v194, v209, v211
v_mul_f32 v214, v115, v115
v_mfma_f32_16x16x32_bf16 a[144:147], v[52:55], v[160:163], a[144:147]
v_fma_f32 v212, v212, v233, v232
v_fma_f32 v214, v214, v233, v232
v_mfma_f32_16x16x32_bf16 a[148:151], v[48:51], v[148:151], 0
ds_read_b128 v[72:75], v8 offset:14336
v_mul_f32 v212, v212, v114
v_mfma_f32_16x16x32_bf16 a[148:151], v[52:55], v[164:167], a[148:151]
v_mul_f32 v214, v214, v115
v_mul_f32 v213, v114, v130
v_mfma_f32_16x16x32_bf16 a[152:155], v[48:51], v[152:155], 0
v_exp_f32 v212, v212
v_mfma_f32_16x16x32_bf16 a[152:155], v[52:55], v[168:171], a[152:155]
ds_read_b128 v[76:79], v8 offset:15360
v_mul_f32 v215, v115, v131
v_mfma_f32_16x16x32_bf16 a[156:159], v[48:51], v[156:159], 0
v_exp_f32 v214, v214
v_mfma_f32_16x16x32_bf16 a[156:159], v[52:55], v[172:175], a[156:159]
v_fma_f32 v212, v212, v234, v234
s_waitcnt lgkmcnt(4)
v_mfma_f32_16x16x32_bf16 a[160:163], v[56:59], v[144:147], 0
s_waitcnt vmcnt(42)
v_fma_f32 v214, v214, v234, v234
v_mfma_f32_16x16x32_bf16 a[160:163], v[60:63], v[160:163], a[160:163]
s_barrier
v_mfma_f32_16x16x32_bf16 a[164:167], v[56:59], v[148:151], 0
ds_read_b128 v[48:51], v2 offset:0
v_mul_f32 v208, v116, v116
v_mfma_f32_16x16x32_bf16 a[164:167], v[60:63], v[164:167], a[164:167]
v_rcp_f32 v212, v212
v_mfma_f32_16x16x32_bf16 a[168:171], v[56:59], v[152:155], 0
v_rcp_f32 v214, v214
v_mfma_f32_16x16x32_bf16 a[168:171], v[60:63], v[168:171], a[168:171]
ds_read_b128 v[52:55], v2 offset:1024
v_mul_f32 v213, v213, v212
v_mfma_f32_16x16x32_bf16 a[172:175], v[56:59], v[156:159], 0
v_mul_f32 v215, v215, v214
v_cvt_pk_bf16_f32 v195, v213, v215
v_mfma_f32_16x16x32_bf16 a[172:175], v[60:63], v[172:175], a[172:175]
v_mul_f32 v210, v117, v117
s_waitcnt lgkmcnt(4)
v_mfma_f32_16x16x32_bf16 a[176:179], v[64:67], v[144:147], 0
buffer_store_dwordx4 v[192:195], v2, s[8:11], s24 offen offset:3072 sc1
v_mfma_f32_16x16x32_bf16 a[176:179], v[68:71], v[160:163], a[176:179]
v_fma_f32 v208, v208, v237, v236
v_fma_f32 v210, v210, v237, v236
v_mfma_f32_16x16x32_bf16 a[180:183], v[64:67], v[148:151], 0
ds_read_b128 v[56:59], v2 offset:2048
v_mul_f32 v208, v208, v116
v_mfma_f32_16x16x32_bf16 a[180:183], v[68:71], v[164:167], a[180:183]
v_mul_f32 v210, v210, v117
v_mul_f32 v209, v116, v132
v_mfma_f32_16x16x32_bf16 a[184:187], v[64:67], v[152:155], 0
v_exp_f32 v208, v208
v_mfma_f32_16x16x32_bf16 a[184:187], v[68:71], v[168:171], a[184:187]
ds_read_b128 v[60:63], v2 offset:3072
v_mul_f32 v211, v117, v133
v_mfma_f32_16x16x32_bf16 a[188:191], v[64:67], v[156:159], 0
v_exp_f32 v210, v210
v_mfma_f32_16x16x32_bf16 a[188:191], v[68:71], v[172:175], a[188:191]
v_fma_f32 v208, v208, v238, v238
s_waitcnt lgkmcnt(4)
v_mfma_f32_16x16x32_bf16 a[192:195], v[72:75], v[144:147], 0
v_fma_f32 v210, v210, v238, v238
v_rcp_f32 v208, v208
v_mfma_f32_16x16x32_bf16 a[192:195], v[76:79], v[160:163], a[192:195]
v_rcp_f32 v210, v210
v_mfma_f32_16x16x32_bf16 a[196:199], v[72:75], v[148:151], 0
ds_read_b128 v[64:67], v2 offset:4096
v_mul_f32 v209, v209, v208
v_mfma_f32_16x16x32_bf16 a[196:199], v[76:79], v[164:167], a[196:199]
v_mul_f32 v211, v211, v210
v_cvt_pk_bf16_f32 v198, v209, v211
v_mfma_f32_16x16x32_bf16 a[200:203], v[72:75], v[152:155], 0
v_mul_f32 v212, v118, v118
v_mul_f32 v214, v119, v119
v_mfma_f32_16x16x32_bf16 a[200:203], v[76:79], v[168:171], a[200:203]
ds_read_b128 v[68:71], v2 offset:5120
v_fma_f32 v212, v212, v237, v236
v_mfma_f32_16x16x32_bf16 a[204:207], v[72:75], v[156:159], 0
v_fma_f32 v214, v214, v237, v236
v_mul_f32 v212, v212, v118
v_mfma_f32_16x16x32_bf16 a[204:207], v[76:79], v[172:175], a[204:207]
v_mul_f32 v214, v214, v119
s_waitcnt lgkmcnt(4)
v_mfma_f32_16x16x32_bf16 a[208:211], v[48:51], v[144:147], 0
v_exp_f32 v212, v212
v_mfma_f32_16x16x32_bf16 a[208:211], v[52:55], v[160:163], a[208:211]
v_exp_f32 v214, v214
v_mfma_f32_16x16x32_bf16 a[212:215], v[48:51], v[148:151], 0
ds_read_b128 v[72:75], v2 offset:6144
v_mul_f32 v213, v118, v134
v_mfma_f32_16x16x32_bf16 a[212:215], v[52:55], v[164:167], a[212:215]
v_mul_f32 v215, v119, v135
v_fma_f32 v212, v212, v238, v238
v_mfma_f32_16x16x32_bf16 a[216:219], v[48:51], v[152:155], 0
v_fma_f32 v214, v214, v238, v238
v_rcp_f32 v212, v212
v_mfma_f32_16x16x32_bf16 a[216:219], v[52:55], v[168:171], a[216:219]
ds_read_b128 v[76:79], v2 offset:7168
v_rcp_f32 v214, v214
v_mfma_f32_16x16x32_bf16 a[220:223], v[48:51], v[156:159], 0
v_mul_f32 v213, v213, v212
v_mul_f32 v215, v215, v214
v_mfma_f32_16x16x32_bf16 a[220:223], v[52:55], v[172:175], a[220:223]
v_cvt_pk_bf16_f32 v199, v213, v215
s_waitcnt lgkmcnt(4)
v_mfma_f32_16x16x32_bf16 a[224:227], v[56:59], v[144:147], 0
buffer_store_dwordx4 v[196:199], v4, s[8:11], s24 offen offset:3072 sc1
v_mfma_f32_16x16x32_bf16 a[224:227], v[60:63], v[160:163], a[224:227]
v_mul_f32 v208, v120, v120
v_mul_f32 v210, v121, v121
v_mfma_f32_16x16x32_bf16 a[228:231], v[56:59], v[148:151], 0
ds_read_b128 v[48:51], v2 offset:8192
v_fma_f32 v208, v208, v241, v240
v_mfma_f32_16x16x32_bf16 a[228:231], v[60:63], v[164:167], a[228:231]
v_fma_f32 v210, v210, v241, v240
v_mul_f32 v208, v208, v120
v_mfma_f32_16x16x32_bf16 a[232:235], v[56:59], v[152:155], 0
v_mul_f32 v210, v210, v121
v_exp_f32 v208, v208
v_mfma_f32_16x16x32_bf16 a[232:235], v[60:63], v[168:171], a[232:235]
ds_read_b128 v[52:55], v2 offset:9216
v_exp_f32 v210, v210
v_mfma_f32_16x16x32_bf16 a[236:239], v[56:59], v[156:159], 0
v_mul_f32 v209, v120, v136
v_mul_f32 v211, v121, v137
v_mfma_f32_16x16x32_bf16 a[236:239], v[60:63], v[172:175], a[236:239]
v_fma_f32 v208, v208, v242, v242
s_waitcnt vmcnt(22)
s_waitcnt lgkmcnt(4)
v_mfma_f32_16x16x32_bf16 a[112:115], v[64:67], v[176:179], a[112:115]
v_fma_f32 v210, v210, v242, v242
v_rcp_f32 v208, v208
v_mfma_f32_16x16x32_bf16 a[112:115], v[68:71], a[0:3], a[112:115]
v_rcp_f32 v210, v210
v_mfma_f32_16x16x32_bf16 a[116:119], v[64:67], v[180:183], a[116:119]
ds_read_b128 v[56:59], v2 offset:10240
v_mul_f32 v209, v209, v208
v_mfma_f32_16x16x32_bf16 a[116:119], v[68:71], a[4:7], a[116:119]
v_mul_f32 v211, v211, v210
v_cvt_pk_bf16_f32 v202, v209, v211
v_mfma_f32_16x16x32_bf16 a[120:123], v[64:67], v[184:187], a[120:123]
v_mul_f32 v212, v122, v122
v_mul_f32 v214, v123, v123
v_mfma_f32_16x16x32_bf16 a[120:123], v[68:71], a[8:11], a[120:123]
ds_read_b128 v[60:63], v2 offset:11264
v_fma_f32 v212, v212, v241, v240
v_mfma_f32_16x16x32_bf16 a[124:127], v[64:67], v[188:191], a[124:127]
v_fma_f32 v214, v214, v241, v240
v_mul_f32 v212, v212, v122
v_mfma_f32_16x16x32_bf16 a[124:127], v[68:71], a[12:15], a[124:127]
v_mul_f32 v214, v214, v123
s_waitcnt lgkmcnt(4)
v_mfma_f32_16x16x32_bf16 a[128:131], v[72:75], v[176:179], a[128:131]
s_waitcnt vmcnt(4)
v_cmp_eq_u64 vcc, s[68:69], v[14:15]
s_nop 0
s_cmp_eq_u64 vcc, exec
s_cbranch_scc0 L_f_slow2
L_f_back2:
v_exp_f32 v212, v212
v_mfma_f32_16x16x32_bf16 a[128:131], v[76:79], a[0:3], a[128:131]
v_exp_f32 v214, v214
v_mfma_f32_16x16x32_bf16 a[132:135], v[72:75], v[180:183], a[132:135]
ds_read_b128 v[64:67], v2 offset:12288
v_mul_f32 v213, v122, v138
v_mfma_f32_16x16x32_bf16 a[132:135], v[76:79], a[4:7], a[132:135]
v_mul_f32 v215, v123, v139
v_fma_f32 v212, v212, v242, v242
v_mfma_f32_16x16x32_bf16 a[136:139], v[72:75], v[184:187], a[136:139]
v_fma_f32 v214, v214, v242, v242
v_rcp_f32 v212, v212
v_mfma_f32_16x16x32_bf16 a[136:139], v[76:79], a[8:11], a[136:139]
ds_read_b128 v[68:71], v2 offset:13312
v_rcp_f32 v214, v214
v_mfma_f32_16x16x32_bf16 a[140:143], v[72:75], v[188:191], a[140:143]
v_mul_f32 v213, v213, v212
v_mul_f32 v215, v215, v214
v_mfma_f32_16x16x32_bf16 a[140:143], v[76:79], a[12:15], a[140:143]
v_cvt_pk_bf16_f32 v203, v213, v215
s_waitcnt lgkmcnt(4)
v_mfma_f32_16x16x32_bf16 a[144:147], v[48:51], v[176:179], a[144:147]
buffer_store_dwordx4 v[200:203], v5, s[8:11], s24 offen offset:3072 sc1
v_mfma_f32_16x16x32_bf16 a[144:147], v[52:55], a[0:3], a[144:147]
v_mul_f32 v208, v124, v124
v_mul_f32 v210, v125, v125
v_mfma_f32_16x16x32_bf16 a[148:151], v[48:51], v[180:183], a[148:151]
ds_read_b128 v[72:75], v2 offset:14336
v_fma_f32 v208, v208, v245, v244
v_mfma_f32_16x16x32_bf16 a[148:151], v[52:55], a[4:7], a[148:151]
v_fma_f32 v210, v210, v245, v244
v_mul_f32 v208, v208, v124
v_mfma_f32_16x16x32_bf16 a[152:155], v[48:51], v[184:187], a[152:155]
v_mul_f32 v210, v210, v125
v_exp_f32 v208, v208
v_mfma_f32_16x16x32_bf16 a[152:155], v[52:55], a[8:11], a[152:155]
ds_read_b128 v[76:79], v2 offset:15360
v_exp_f32 v210, v210
v_mfma_f32_16x16x32_bf16 a[156:159], v[48:51], v[188:191], a[156:159]
v_mul_f32 v209, v124, v140
v_mul_f32 v211, v125, v141
v_mfma_f32_16x16x32_bf16 a[156:159], v[52:55], a[12:15], a[156:159]
v_fma_f32 v208, v208, v246, v246
s_waitcnt lgkmcnt(4)
v_mfma_f32_16x16x32_bf16 a[160:163], v[56:59], v[176:179], a[160:163]
v_fma_f32 v210, v210, v246, v246
v_rcp_f32 v208, v208
v_mfma_f32_16x16x32_bf16 a[160:163], v[60:63], a[0:3], a[160:163]
v_rcp_f32 v210, v210
v_mfma_f32_16x16x32_bf16 a[164:167], v[56:59], v[180:183], a[164:167]
ds_read_b128 v[48:51], v2 offset:16384
v_mul_f32 v209, v209, v208
v_mfma_f32_16x16x32_bf16 a[164:167], v[60:63], a[4:7], a[164:167]
v_mul_f32 v211, v211, v210
v_cvt_pk_bf16_f32 v206, v209, v211
v_mfma_f32_16x16x32_bf16 a[168:171], v[56:59], v[184:187], a[168:171]
v_mul_f32 v212, v126, v126
v_mul_f32 v214, v127, v127
v_mfma_f32_16x16x32_bf16 a[168:171], v[60:63], a[8:11], a[168:171]
ds_read_b128 v[52:55], v2 offset:17408
v_fma_f32 v212, v212, v245, v244
v_mfma_f32_16x16x32_bf16 a[172:175], v[56:59], v[188:191], a[172:175]
v_fma_f32 v214, v214, v245, v244
v_mul_f32 v212, v212, v126
v_mfma_f32_16x16x32_bf16 a[172:175], v[60:63], a[12:15], a[172:175]
v_mul_f32 v214, v214, v127
s_waitcnt lgkmcnt(4)
v_mfma_f32_16x16x32_bf16 a[176:179], v[64:67], v[176:179], a[176:179]
v_exp_f32 v212, v212
v_mfma_f32_16x16x32_bf16 a[176:179], v[68:71], a[0:3], a[176:179]
v_exp_f32 v214, v214
v_mfma_f32_16x16x32_bf16 a[180:183], v[64:67], v[180:183], a[180:183]
ds_read_b128 v[56:59], v2 offset:18432
v_mul_f32 v213, v126, v142
v_mfma_f32_16x16x32_bf16 a[180:183], v[68:71], a[4:7], a[180:183]
v_mul_f32 v215, v127, v143
v_fma_f32 v212, v212, v246, v246
v_mfma_f32_16x16x32_bf16 a[184:187], v[64:67], v[184:187], a[184:187]
v_fma_f32 v214, v214, v246, v246
v_rcp_f32 v212, v212
v_mfma_f32_16x16x32_bf16 a[184:187], v[68:71], a[8:11], a[184:187]
ds_read_b128 v[60:63], v2 offset:19456
v_rcp_f32 v214, v214
v_mfma_f32_16x16x32_bf16 a[188:191], v[64:67], v[188:191], a[188:191]
v_mul_f32 v213, v213, v212
v_mul_f32 v215, v215, v214
v_mfma_f32_16x16x32_bf16 a[188:191], v[68:71], a[12:15], a[188:191]
v_cvt_pk_bf16_f32 v207, v213, v215
buffer_store_dwordx4 v[204:207], v6, s[8:11], s24 offen offset:3072 sc1
s_waitcnt lgkmcnt(4)
v_mfma_f32_16x16x32_bf16 a[192:195], v[72:75], v[176:179], a[192:195]
buffer_load_dwordx4 a[88:91], v5, s[8:11], s27 offen offset:1024 sc1
v_mfma_f32_16x16x32_bf16 a[192:195], v[76:79], a[0:3], a[192:195]
v_mfma_f32_16x16x32_bf16 a[196:199], v[72:75], v[180:183], a[196:199]
ds_read_b128 v[64:67], v2 offset:20480
v_mfma_f32_16x16x32_bf16 a[196:199], v[76:79], a[4:7], a[196:199]
v_mfma_f32_16x16x32_bf16 a[200:203], v[72:75], v[184:187], a[200:203]
v_mfma_f32_16x16x32_bf16 a[200:203], v[76:79], a[8:11], a[200:203]
ds_read_b128 v[68:71], v2 offset:21504
v_mfma_f32_16x16x32_bf16 a[204:207], v[72:75], v[188:191], a[204:207]
buffer_load_dwordx4 a[92:95], v6, s[8:11], s27 offen offset:1024 sc1
v_mfma_f32_16x16x32_bf16 a[204:207], v[76:79], a[12:15], a[204:207]
s_waitcnt lgkmcnt(4)
v_mfma_f32_16x16x32_bf16 a[208:211], v[48:51], v[176:179], a[208:211]
v_mfma_f32_16x16x32_bf16 a[208:211], v[52:55], a[0:3], a[208:211]
v_mfma_f32_16x16x32_bf16 a[212:215], v[48:51], v[180:183], a[212:215]
ds_read_b128 v[72:75], v2 offset:22528
v_mfma_f32_16x16x32_bf16 a[212:215], v[52:55], a[4:7], a[212:215]
buffer_load_dwordx2 a[96:97], v248, s[8:11], s28 offen offset:0 sc1
v_mfma_f32_16x16x32_bf16 a[216:219], v[48:51], v[184:187], a[216:219]
v_mfma_f32_16x16x32_bf16 a[216:219], v[52:55], a[8:11], a[216:219]
ds_read_b128 v[76:79], v2 offset:23552
v_mfma_f32_16x16x32_bf16 a[220:223], v[48:51], v[188:191], a[220:223]
v_mfma_f32_16x16x32_bf16 a[220:223], v[52:55], a[12:15], a[220:223]
s_waitcnt lgkmcnt(4)
v_mfma_f32_16x16x32_bf16 a[224:227], v[56:59], v[176:179], a[224:227]
s_waitcnt vmcnt(40)
v_mfma_f32_16x16x32_bf16 a[224:227], v[60:63], a[0:3], a[224:227]
s_barrier
v_mfma_f32_16x16x32_bf16 a[228:231], v[56:59], v[180:183], a[228:231]
ds_read_b128 v[48:51], v2 offset:24576
buffer_load_dwordx2 a[98:99], v248, s[8:11], s28 offen offset:512 sc1
v_mfma_f32_16x16x32_bf16 a[228:231], v[60:63], a[4:7], a[228:231]
v_mfma_f32_16x16x32_bf16 a[232:235], v[56:59], v[184:187], a[232:235]
v_mfma_f32_16x16x32_bf16 a[232:235], v[60:63], a[8:11], a[232:235]
ds_read_b128 v[52:55], v2 offset:25600
v_mfma_f32_16x16x32_bf16 a[236:239], v[56:59], v[188:191], a[236:239]
v_mfma_f32_16x16x32_bf16 a[236:239], v[60:63], a[12:15], a[236:239]
s_waitcnt vmcnt(19)
s_waitcnt lgkmcnt(4)
v_mfma_f32_16x16x32_bf16 a[112:115], v[64:67], a[16:19], a[112:115]
buffer_load_dwordx2 a[100:101], v249, s[8:11], s28 offen offset:0 sc1
v_mfma_f32_16x16x32_bf16 a[112:115], v[68:71], a[32:35], a[112:115]
v_mfma_f32_16x16x32_bf16 a[116:119], v[64:67], a[20:23], a[116:119]
ds_read_b128 v[56:59], v2 offset:26624
v_mfma_f32_16x16x32_bf16 a[116:119], v[68:71], a[36:39], a[116:119]
v_mfma_f32_16x16x32_bf16 a[120:123], v[64:67], a[24:27], a[120:123]
v_mfma_f32_16x16x32_bf16 a[120:123], v[68:71], a[40:43], a[120:123]
ds_read_b128 v[60:63], v2 offset:27648
v_mfma_f32_16x16x32_bf16 a[124:127], v[64:67], a[28:31], a[124:127]
buffer_load_dwordx2 a[102:103], v249, s[8:11], s28 offen offset:512 sc1
v_mfma_f32_16x16x32_bf16 a[124:127], v[68:71], a[44:47], a[124:127]
s_waitcnt lgkmcnt(4)
v_mfma_f32_16x16x32_bf16 a[128:131], v[72:75], a[16:19], a[128:131]
v_mfma_f32_16x16x32_bf16 a[128:131], v[76:79], a[32:35], a[128:131]
v_mfma_f32_16x16x32_bf16 a[132:135], v[72:75], a[20:23], a[132:135]
ds_read_b128 v[64:67], v2 offset:28672
v_mfma_f32_16x16x32_bf16 a[132:135], v[76:79], a[36:39], a[132:135]
buffer_load_dwordx2 a[104:105], v250, s[8:11], s28 offen offset:0 sc1
v_mfma_f32_16x16x32_bf16 a[136:139], v[72:75], a[24:27], a[136:139]
v_mfma_f32_16x16x32_bf16 a[136:139], v[76:79], a[40:43], a[136:139]
ds_read_b128 v[68:71], v2 offset:29696
v_mfma_f32_16x16x32_bf16 a[140:143], v[72:75], a[28:31], a[140:143]
v_mfma_f32_16x16x32_bf16 a[140:143], v[76:79], a[44:47], a[140:143]
s_waitcnt lgkmcnt(4)
v_mfma_f32_16x16x32_bf16 a[144:147], v[48:51], a[16:19], a[144:147]
buffer_load_dwordx2 a[106:107], v250, s[8:11], s28 offen offset:512 sc1
v_mfma_f32_16x16x32_bf16 a[144:147], v[52:55], a[32:35], a[144:147]
v_mfma_f32_16x16x32_bf16 a[148:151], v[48:51], a[20:23], a[148:151]
ds_read_b128 v[72:75], v2 offset:30720
v_mfma_f32_16x16x32_bf16 a[148:151], v[52:55], a[36:39], a[148:151]
v_mfma_f32_16x16x32_bf16 a[152:155], v[48:51], a[24:27], a[152:155]
buffer_load_dwordx2 a[108:109], v251, s[8:11], s28 offen offset:0 sc1
v_mfma_f32_16x16x32_bf16 a[152:155], v[52:55], a[40:43], a[152:155]
ds_read_b128 v[76:79], v2 offset:31744
v_mfma_f32_16x16x32_bf16 a[156:159], v[48:51], a[28:31], a[156:159]
v_mfma_f32_16x16x32_bf16 a[156:159], v[52:55], a[44:47], a[156:159]
s_waitcnt lgkmcnt(4)
v_mfma_f32_16x16x32_bf16 a[160:163], v[56:59], a[16:19], a[160:163]
buffer_load_dwordx2 a[110:111], v251, s[8:11], s28 offen offset:512 sc1
v_mfma_f32_16x16x32_bf16 a[160:163], v[60:63], a[32:35], a[160:163]
s_add_u32 m0, s22, 73728
v_add_u32 v3, 20480, v3
v_mfma_f32_16x16x32_bf16 a[164:167], v[56:59], a[20:23], a[164:167]
ds_read_b128 v[48:51], v2 offset:32768
v_mfma_f32_16x16x32_bf16 a[164:167], v[60:63], a[36:39], a[164:167]
v_mfma_f32_16x16x32_bf16 a[168:171], v[56:59], a[24:27], a[168:171]
v_mfma_f32_16x16x32_bf16 a[168:171], v[60:63], a[40:43], a[168:171]
ds_read_b128 v[52:55], v2 offset:33792
v_mfma_f32_16x16x32_bf16 a[172:175], v[56:59], a[28:31], a[172:175]
buffer_load_dwordx4 v3, s[8:11], 0 offen offset:0 sc1 lds
v_mfma_f32_16x16x32_bf16 a[172:175], v[60:63], a[44:47], a[172:175]
s_waitcnt lgkmcnt(4)
v_mfma_f32_16x16x32_bf16 a[176:179], v[64:67], a[16:19], a[176:179]
v_mov_b32 v12, s68
v_mov_b32 v13, s69
v_mfma_f32_16x16x32_bf16 a[176:179], v[68:71], a[32:35], a[176:179]
s_add_u32 s53, s34, 262144
s_waitcnt vmcnt(11)
v_mfma_f32_16x16x32_bf16 a[180:183], v[64:67], a[20:23], a[180:183]
ds_read_b128 v[56:59], v2 offset:34816
v_mfma_f32_16x16x32_bf16 a[180:183], v[68:71], a[36:39], a[180:183]
buffer_store_dwordx2 v[12:13], v10, s[8:11], s53 offen sc1
v_mfma_f32_16x16x32_bf16 a[184:187], v[64:67], a[24:27], a[184:187]
v_mfma_f32_16x16x32_bf16 a[184:187], v[68:71], a[40:43], a[184:187]
ds_read_b128 v[60:63], v2 offset:35840
v_mfma_f32_16x16x32_bf16 a[188:191], v[64:67], a[28:31], a[188:191]
v_mfma_f32_16x16x32_bf16 a[188:191], v[68:71], a[44:47], a[188:191]
s_waitcnt lgkmcnt(4)
v_mfma_f32_16x16x32_bf16 a[192:195], v[72:75], a[16:19], a[192:195]
buffer_load_dwordx4 v3, s[8:11], 0 offen offset:1024 sc1 lds
v_mfma_f32_16x16x32_bf16 a[192:195], v[76:79], a[32:35], a[192:195]
v_mfma_f32_16x16x32_bf16 a[196:199], v[72:75], a[20:23], a[196:199]
ds_read_b128 v[64:67], v2 offset:36864
v_mfma_f32_16x16x32_bf16 a[196:199], v[76:79], a[36:39], a[196:199]
v_mfma_f32_16x16x32_bf16 a[200:203], v[72:75], a[24:27], a[200:203]
v_mfma_f32_16x16x32_bf16 a[200:203], v[76:79], a[40:43], a[200:203]
ds_read_b128 v[68:71], v2 offset:37888
v_mfma_f32_16x16x32_bf16 a[204:207], v[72:75], a[28:31], a[204:207]
buffer_load_dwordx4 v3, s[8:11], 0 offen offset:2048 sc1 lds
v_mfma_f32_16x16x32_bf16 a[204:207], v[76:79], a[44:47], a[204:207]
s_waitcnt lgkmcnt(4)
v_mfma_f32_16x16x32_bf16 a[208:211], v[48:51], a[16:19], a[208:211]
v_mfma_f32_16x16x32_bf16 a[208:211], v[52:55], a[32:35], a[208:211]
v_mfma_f32_16x16x32_bf16 a[212:215], v[48:51], a[20:23], a[212:215]
ds_read_b128 v[72:75], v2 offset:38912
v_mfma_f32_16x16x32_bf16 a[212:215], v[52:55], a[36:39], a[212:215]
buffer_load_dwordx4 v3, s[8:11], 0 offen offset:3072 sc1 lds
v_mfma_f32_16x16x32_bf16 a[216:219], v[48:51], a[24:27], a[216:219]
s_add_u32 m0, s22, 77824
v_add_u32 v3, 4096, v3
v_mfma_f32_16x16x32_bf16 a[216:219], v[52:55], a[40:43], a[216:219]
ds_read_b128 v[76:79], v2 offset:39936
v_mfma_f32_16x16x32_bf16 a[220:223], v[48:51], a[28:31], a[220:223]
v_mfma_f32_16x16x32_bf16 a[220:223], v[52:55], a[44:47], a[220:223]
s_waitcnt lgkmcnt(4)
v_mfma_f32_16x16x32_bf16 a[224:227], v[56:59], a[16:19], a[224:227]
buffer_load_dwordx4 v3, s[8:11], 0 offen offset:0 sc1 lds
v_mfma_f32_16x16x32_bf16 a[224:227], v[60:63], a[32:35], a[224:227]
v_mfma_f32_16x16x32_bf16 a[228:231], v[56:59], a[20:23], a[228:231]
ds_read_b128 v[48:51], v2 offset:40960
v_mfma_f32_16x16x32_bf16 a[228:231], v[60:63], a[36:39], a[228:231]
v_mfma_f32_16x16x32_bf16 a[232:235], v[56:59], a[24:27], a[232:235]
v_mfma_f32_16x16x32_bf16 a[232:235], v[60:63], a[40:43], a[232:235]
ds_read_b128 v[52:55], v2 offset:41984
v_mfma_f32_16x16x32_bf16 a[236:239], v[56:59], a[28:31], a[236:239]
buffer_load_dwordx4 v3, s[8:11], 0 offen offset:1024 sc1 lds
v_mfma_f32_16x16x32_bf16 a[236:239], v[60:63], a[44:47], a[236:239]
s_waitcnt vmcnt(24)
s_waitcnt lgkmcnt(4)
v_mfma_f32_16x16x32_bf16 a[112:115], v[64:67], a[48:51], a[112:115]
v_mfma_f32_16x16x32_bf16 a[112:115], v[68:71], a[64:67], a[112:115]
v_mfma_f32_16x16x32_bf16 a[116:119], v[64:67], a[52:55], a[116:119]
ds_read_b128 v[56:59], v2 offset:43008
v_mfma_f32_16x16x32_bf16 a[116:119], v[68:71], a[68:71], a[116:119]
buffer_load_dwordx2 v[16:17], v248, s[8:11], s29 offen offset:0 sc1
v_mfma_f32_16x16x32_bf16 a[120:123], v[64:67], a[56:59], a[120:123]
v_mfma_f32_16x16x32_bf16 a[120:123], v[68:71], a[72:75], a[120:123]
ds_read_b128 v[60:63], v2 offset:44032
v_mfma_f32_16x16x32_bf16 a[124:127], v[64:67], a[60:63], a[124:127]
v_mfma_f32_16x16x32_bf16 a[124:127], v[68:71], a[76:79], a[124:127]
s_waitcnt lgkmcnt(4)
v_mfma_f32_16x16x32_bf16 a[128:131], v[72:75], a[48:51], a[128:131]
buffer_load_dwordx2 v[18:19], v248, s[8:11], s29 offen offset:512 sc1
v_mfma_f32_16x16x32_bf16 a[128:131], v[76:79], a[64:67], a[128:131]
v_mfma_f32_16x16x32_bf16 a[132:135], v[72:75], a[52:55], a[132:135]
ds_read_b128 v[64:67], v2 offset:45056
v_mfma_f32_16x16x32_bf16 a[132:135], v[76:79], a[68:71], a[132:135]
v_mfma_f32_16x16x32_bf16 a[136:139], v[72:75], a[56:59], a[136:139]
v_mfma_f32_16x16x32_bf16 a[136:139], v[76:79], a[72:75], a[136:139]
ds_read_b128 v[68:71], v2 offset:46080
v_mfma_f32_16x16x32_bf16 a[140:143], v[72:75], a[60:63], a[140:143]
buffer_load_dwordx2 v[20:21], v249, s[8:11], s29 offen offset:0 sc1
v_mfma_f32_16x16x32_bf16 a[140:143], v[76:79], a[76:79], a[140:143]
s_waitcnt lgkmcnt(4)
v_mfma_f32_16x16x32_bf16 a[144:147], v[48:51], a[48:51], a[144:147]
s_add_u32 s23, s34, 262144
v_mfma_f32_16x16x32_bf16 a[144:147], v[52:55], a[64:67], a[144:147]
v_mfma_f32_16x16x32_bf16 a[148:151], v[48:51], a[52:55], a[148:151]
ds_read_b128 v[72:75], v2 offset:47104
v_mfma_f32_16x16x32_bf16 a[148:151], v[52:55], a[68:71], a[148:151]
buffer_load_dwordx2 v[14:15], v11, s[8:11], s23 offen sc1
v_mfma_f32_16x16x32_bf16 a[152:155], v[48:51], a[56:59], a[152:155]
v_mfma_f32_16x16x32_bf16 a[152:155], v[52:55], a[72:75], a[152:155]
ds_read_b128 v[76:79], v2 offset:48128
v_mfma_f32_16x16x32_bf16 a[156:159], v[48:51], a[60:63], a[156:159]
v_mfma_f32_16x16x32_bf16 a[156:159], v[52:55], a[76:79], a[156:159]
s_waitcnt lgkmcnt(4)
v_mfma_f32_16x16x32_bf16 a[160:163], v[56:59], a[48:51], a[160:163]
s_waitcnt vmcnt(49)
v_mfma_f32_16x16x32_bf16 a[160:163], v[60:63], a[64:67], a[160:163]
s_barrier
v_mfma_f32_16x16x32_bf16 a[164:167], v[56:59], a[52:55], a[164:167]
ds_read_b128 v[48:51], v2 offset:49152
buffer_load_dwordx2 v[22:23], v249, s[8:11], s29 offen offset:512 sc1
v_mfma_f32_16x16x32_bf16 a[164:167], v[60:63], a[68:71], a[164:167]
v_mfma_f32_16x16x32_bf16 a[168:171], v[56:59], a[56:59], a[168:171]
v_mfma_f32_16x16x32_bf16 a[168:171], v[60:63], a[72:75], a[168:171]
ds_read_b128 v[52:55], v2 offset:50176
v_mfma_f32_16x16x32_bf16 a[172:175], v[56:59], a[60:63], a[172:175]
buffer_load_dwordx2 v[24:25], v250, s[8:11], s29 offen offset:0 sc1
v_mfma_f32_16x16x32_bf16 a[172:175], v[60:63], a[76:79], a[172:175]
s_waitcnt lgkmcnt(4)
v_mfma_f32_16x16x32_bf16 a[176:179], v[64:67], a[48:51], a[176:179]
v_mfma_f32_16x16x32_bf16 a[176:179], v[68:71], a[64:67], a[176:179]
v_mfma_f32_16x16x32_bf16 a[180:183], v[64:67], a[52:55], a[180:183]
ds_read_b128 v[56:59], v2 offset:51200
v_mfma_f32_16x16x32_bf16 a[180:183], v[68:71], a[68:71], a[180:183]
buffer_load_dwordx2 v[26:27], v250, s[8:11], s29 offen offset:512 sc1
v_mfma_f32_16x16x32_bf16 a[184:187], v[64:67], a[56:59], a[184:187]
v_mfma_f32_16x16x32_bf16 a[184:187], v[68:71], a[72:75], a[184:187]
ds_read_b128 v[60:63], v2 offset:52224
v_mfma_f32_16x16x32_bf16 a[188:191], v[64:67], a[60:63], a[188:191]
v_mfma_f32_16x16x32_bf16 a[188:191], v[68:71], a[76:79], a[188:191]
s_waitcnt lgkmcnt(4)
v_mfma_f32_16x16x32_bf16 a[192:195], v[72:75], a[48:51], a[192:195]
buffer_load_dwordx2 v[28:29], v251, s[8:11], s29 offen offset:0 sc1
v_mfma_f32_16x16x32_bf16 a[192:195], v[76:79], a[64:67], a[192:195]
v_mfma_f32_16x16x32_bf16 a[196:199], v[72:75], a[52:55], a[196:199]
ds_read_b128 v[64:67], v2 offset:53248
v_mfma_f32_16x16x32_bf16 a[196:199], v[76:79], a[68:71], a[196:199]
v_mfma_f32_16x16x32_bf16 a[200:203], v[72:75], a[56:59], a[200:203]
buffer_load_dwordx2 v[30:31], v251, s[8:11], s29 offen offset:512 sc1
v_mfma_f32_16x16x32_bf16 a[200:203], v[76:79], a[72:75], a[200:203]
ds_read_b128 v[68:71], v2 offset:54272
v_mfma_f32_16x16x32_bf16 a[204:207], v[72:75], a[60:63], a[204:207]
v_mfma_f32_16x16x32_bf16 a[204:207], v[76:79], a[76:79], a[204:207]
s_waitcnt lgkmcnt(4)
v_mfma_f32_16x16x32_bf16 a[208:211], v[48:51], a[48:51], a[208:211]
buffer_load_dwordx4 v[32:35], v2, s[8:11], s25 offen offset:2048 sc1
v_mfma_f32_16x16x32_bf16 a[208:211], v[52:55], a[64:67], a[208:211]
v_mfma_f32_16x16x32_bf16 a[212:215], v[48:51], a[52:55], a[212:215]
ds_read_b128 v[72:75], v2 offset:55296
v_mfma_f32_16x16x32_bf16 a[212:215], v[52:55], a[68:71], a[212:215]
v_mfma_f32_16x16x32_bf16 a[216:219], v[48:51], a[56:59], a[216:219]
buffer_load_dwordx4 v[36:39], v4, s[8:11], s25 offen offset:2048 sc1
v_mfma_f32_16x16x32_bf16 a[216:219], v[52:55], a[72:75], a[216:219]
ds_read_b128 v[76:79], v2 offset:56320
v_mfma_f32_16x16x32_bf16 a[220:223], v[48:51], a[60:63], a[220:223]
v_mfma_f32_16x16x32_bf16 a[220:223], v[52:55], a[76:79], a[220:223]
s_waitcnt lgkmcnt(4)
v_mfma_f32_16x16x32_bf16 a[224:227], v[56:59], a[48:51], a[224:227]
buffer_load_dwordx4 v[40:43], v5, s[8:11], s25 offen offset:2048 sc1
v_mfma_f32_16x16x32_bf16 a[224:227], v[60:63], a[64:67], a[224:227]
v_mfma_f32_16x16x32_bf16 a[228:231], v[56:59], a[52:55], a[228:231]
ds_read_b128 v[48:51], v2 offset:57344
v_mfma_f32_16x16x32_bf16 a[228:231], v[60:63], a[68:71], a[228:231]
v_mfma_f32_16x16x32_bf16 a[232:235], v[56:59], a[56:59], a[232:235]
buffer_load_dwordx4 v[44:47], v6, s[8:11], s25 offen offset:2048 sc1
v_mfma_f32_16x16x32_bf16 a[232:235], v[60:63], a[72:75], a[232:235]
ds_read_b128 v[52:55], v2 offset:58368
v_mfma_f32_16x16x32_bf16 a[236:239], v[56:59], a[60:63], a[236:239]
v_mfma_f32_16x16x32_bf16 a[236:239], v[60:63], a[76:79], a[236:239]
s_waitcnt vmcnt(20)
s_waitcnt lgkmcnt(4)
v_mfma_f32_16x16x32_bf16 a[112:115], v[64:67], a[80:83], a[112:115]
buffer_load_dwordx4 v[80:83], v2, s[8:11], s26 offen offset:2048 sc1
v_mfma_f32_16x16x32_bf16 a[112:115], v[68:71], a[96:99], a[112:115]
v_mfma_f32_16x16x32_bf16 a[116:119], v[64:67], a[84:87], a[116:119]
ds_read_b128 v[56:59], v2 offset:59392
v_mfma_f32_16x16x32_bf16 a[116:119], v[68:71], a[100:103], a[116:119]
v_mfma_f32_16x16x32_bf16 a[120:123], v[64:67], a[88:91], a[120:123]
buffer_load_dwordx4 v[84:87], v4, s[8:11], s26 offen offset:2048 sc1
v_mfma_f32_16x16x32_bf16 a[120:123], v[68:71], a[104:107], a[120:123]
ds_read_b128 v[60:63], v2 offset:60416
v_mfma_f32_16x16x32_bf16 a[124:127], v[64:67], a[92:95], a[124:127]
v_mfma_f32_16x16x32_bf16 a[124:127], v[68:71], a[108:111], a[124:127]
s_waitcnt lgkmcnt(4)
v_mfma_f32_16x16x32_bf16 a[128:131], v[72:75], a[80:83], a[128:131]
buffer_load_dwordx4 v[88:91], v5, s[8:11], s26 offen offset:2048 sc1
v_mfma_f32_16x16x32_bf16 a[128:131], v[76:79], a[96:99], a[128:131]
v_mfma_f32_16x16x32_bf16 a[132:135], v[72:75], a[84:87], a[132:135]
ds_read_b128 v[64:67], v2 offset:61440
v_mfma_f32_16x16x32_bf16 a[132:135], v[76:79], a[100:103], a[132:135]
v_mfma_f32_16x16x32_bf16 a[136:139], v[72:75], a[88:91], a[136:139]
buffer_load_dwordx4 v[92:95], v6, s[8:11], s26 offen offset:2048 sc1
v_mfma_f32_16x16x32_bf16 a[136:139], v[76:79], a[104:107], a[136:139]
ds_read_b128 v[68:71], v2 offset:62464
s_waitcnt vmcnt(13)
v_cmp_eq_u64 vcc, s[68:69], v[14:15]
s_nop 0
s_cmp_eq_u64 vcc, exec
s_cbranch_scc0 L_f_slow3
L_f_back3:
v_mfma_f32_16x16x32_bf16 a[140:143], v[72:75], a[92:95], a[140:143]
v_mfma_f32_16x16x32_bf16 a[140:143], v[76:79], a[108:111], a[140:143]
s_waitcnt lgkmcnt(4)
v_mfma_f32_16x16x32_bf16 a[144:147], v[48:51], a[80:83], a[144:147]
buffer_load_dwordx4 v[96:99], v2, s[8:11], s27 offen offset:2048 sc1
v_mfma_f32_16x16x32_bf16 a[144:147], v[52:55], a[96:99], a[144:147]
v_mfma_f32_16x16x32_bf16 a[148:151], v[48:51], a[84:87], a[148:151]
ds_read_b128 v[72:75], v2 offset:63488
v_mfma_f32_16x16x32_bf16 a[148:151], v[52:55], a[100:103], a[148:151]
v_mfma_f32_16x16x32_bf16 a[152:155], v[48:51], a[88:91], a[152:155]
buffer_load_dwordx4 v[100:103], v4, s[8:11], s27 offen offset:2048 sc1
v_mfma_f32_16x16x32_bf16 a[152:155], v[52:55], a[104:107], a[152:155]
ds_read_b128 v[76:79], v2 offset:64512
v_mfma_f32_16x16x32_bf16 a[156:159], v[48:51], a[92:95], a[156:159]
v_mfma_f32_16x16x32_bf16 a[156:159], v[52:55], a[108:111], a[156:159]
s_waitcnt lgkmcnt(4)
v_mfma_f32_16x16x32_bf16 a[160:163], v[56:59], a[80:83], a[160:163]
buffer_load_dwordx4 v[104:107], v5, s[8:11], s27 offen offset:2048 sc1
v_mfma_f32_16x16x32_bf16 a[160:163], v[60:63], a[96:99], a[160:163]
v_mfma_f32_16x16x32_bf16 a[164:167], v[56:59], a[84:87], a[164:167]
ds_read_b128 v[48:51], v7 offset:0
v_mfma_f32_16x16x32_bf16 a[164:167], v[60:63], a[100:103], a[164:167]
v_mfma_f32_16x16x32_bf16 a[168:171], v[56:59], a[88:91], a[168:171]
buffer_load_dwordx4 v[108:111], v6, s[8:11], s27 offen offset:2048 sc1
v_mfma_f32_16x16x32_bf16 a[168:171], v[60:63], a[104:107], a[168:171]
ds_read_b128 v[52:55], v7 offset:1024
v_mfma_f32_16x16x32_bf16 a[172:175], v[56:59], a[92:95], a[172:175]
v_mfma_f32_16x16x32_bf16 a[172:175], v[60:63], a[108:111], a[172:175]
s_waitcnt lgkmcnt(4)
v_mfma_f32_16x16x32_bf16 a[176:179], v[64:67], a[80:83], a[176:179]
buffer_load_dwordx4 v[112:115], v2, s[8:11], s25 offen offset:3072 sc1
v_mfma_f32_16x16x32_bf16 a[176:179], v[68:71], a[96:99], a[176:179]
v_mfma_f32_16x16x32_bf16 a[180:183], v[64:67], a[84:87], a[180:183]
ds_read_b128 v[56:59], v7 offset:2048
v_mfma_f32_16x16x32_bf16 a[180:183], v[68:71], a[100:103], a[180:183]
v_mfma_f32_16x16x32_bf16 a[184:187], v[64:67], a[88:91], a[184:187]
buffer_load_dwordx4 v[116:119], v4, s[8:11], s25 offen offset:3072 sc1
v_mfma_f32_16x16x32_bf16 a[184:187], v[68:71], a[104:107], a[184:187]
ds_read_b128 v[60:63], v7 offset:3072
v_mfma_f32_16x16x32_bf16 a[188:191], v[64:67], a[92:95], a[188:191]
v_mfma_f32_16x16x32_bf16 a[188:191], v[68:71], a[108:111], a[188:191]
s_waitcnt lgkmcnt(4)
v_mfma_f32_16x16x32_bf16 a[192:195], v[72:75], a[80:83], a[192:195]
buffer_load_dwordx4 v[120:123], v5, s[8:11], s25 offen offset:3072 sc1
v_mfma_f32_16x16x32_bf16 a[192:195], v[76:79], a[96:99], a[192:195]
v_mfma_f32_16x16x32_bf16 a[196:199], v[72:75], a[84:87], a[196:199]
ds_read_b128 v[64:67], v7 offset:4096
v_mfma_f32_16x16x32_bf16 a[196:199], v[76:79], a[100:103], a[196:199]
v_mfma_f32_16x16x32_bf16 a[200:203], v[72:75], a[88:91], a[200:203]
buffer_load_dwordx4 v[124:127], v6, s[8:11], s25 offen offset:3072 sc1
v_mfma_f32_16x16x32_bf16 a[200:203], v[76:79], a[104:107], a[200:203]
ds_read_b128 v[68:71], v7 offset:5120
v_mfma_f32_16x16x32_bf16 a[204:207], v[72:75], a[92:95], a[204:207]
v_mfma_f32_16x16x32_bf16 a[204:207], v[76:79], a[108:111], a[204:207]
s_waitcnt lgkmcnt(4)
v_mfma_f32_16x16x32_bf16 a[208:211], v[48:51], a[80:83], a[208:211]
buffer_load_dwordx4 v[128:131], v2, s[8:11], s26 offen offset:3072 sc1
v_mfma_f32_16x16x32_bf16 a[208:211], v[52:55], a[96:99], a[208:211]
v_mfma_f32_16x16x32_bf16 a[212:215], v[48:51], a[84:87], a[212:215]
ds_read_b128 v[72:75], v7 offset:6144
v_mfma_f32_16x16x32_bf16 a[212:215], v[52:55], a[100:103], a[212:215]
v_mfma_f32_16x16x32_bf16 a[216:219], v[48:51], a[88:91], a[216:219]
buffer_load_dwordx4 v[132:135], v4, s[8:11], s26 offen offset:3072 sc1
v_mfma_f32_16x16x32_bf16 a[216:219], v[52:55], a[104:107], a[216:219]
ds_read_b128 v[76:79], v7 offset:7168
v_mfma_f32_16x16x32_bf16 a[220:223], v[48:51], a[92:95], a[220:223]
v_mfma_f32_16x16x32_bf16 a[220:223], v[52:55], a[108:111], a[220:223]
s_waitcnt lgkmcnt(4)
v_mfma_f32_16x16x32_bf16 a[224:227], v[56:59], a[80:83], a[224:227]
s_waitcnt vmcnt(27)
v_mfma_f32_16x16x32_bf16 a[224:227], v[60:63], a[96:99], a[224:227]
s_barrier
v_mfma_f32_16x16x32_bf16 a[228:231], v[56:59], a[84:87], a[228:231]
ds_read_b128 v[48:51], v7 offset:8192
buffer_load_dwordx4 v[136:139], v5, s[8:11], s26 offen offset:3072 sc1
v_mfma_f32_16x16x32_bf16 a[228:231], v[60:63], a[100:103], a[228:231]
v_mfma_f32_16x16x32_bf16 a[232:235], v[56:59], a[88:91], a[232:235]
v_mfma_f32_16x16x32_bf16 a[232:235], v[60:63], a[104:107], a[232:235]
ds_read_b128 v[52:55], v7 offset:9216
v_mfma_f32_16x16x32_bf16 a[236:239], v[56:59], a[92:95], a[236:239]
buffer_load_dwordx4 v[140:143], v6, s[8:11], s26 offen offset:3072 sc1
v_mfma_f32_16x16x32_bf16 a[236:239], v[60:63], a[108:111], a[236:239]
s_waitcnt vmcnt(20)
s_waitcnt lgkmcnt(4)
v_mfma_f32_16x16x32_bf16 a[112:115], v[64:67], v[16:19], a[112:115]
v_mfma_f32_16x16x32_bf16 a[112:115], v[68:71], v[192:195], a[112:115]
v_mfma_f32_16x16x32_bf16 a[116:119], v[64:67], v[20:23], a[116:119]
ds_read_b128 v[56:59], v7 offset:10240
v_mfma_f32_16x16x32_bf16 a[116:119], v[68:71], v[196:199], a[116:119]
buffer_load_dwordx4 v[232:235], v2, s[8:11], s27 offen offset:3072 sc1
v_mfma_f32_16x16x32_bf16 a[120:123], v[64:67], v[24:27], a[120:123]
v_mfma_f32_16x16x32_bf16 a[120:123], v[68:71], v[200:203], a[120:123]
ds_read_b128 v[60:63], v7 offset:11264
v_mfma_f32_16x16x32_bf16 a[124:127], v[64:67], v[28:31], a[124:127]
v_mfma_f32_16x16x32_bf16 a[124:127], v[68:71], v[204:207], a[124:127]
s_waitcnt lgkmcnt(4)
v_mfma_f32_16x16x32_bf16 a[128:131], v[72:75], v[16:19], a[128:131]
buffer_load_dwordx4 v[236:239], v4, s[8:11], s27 offen offset:3072 sc1
v_mfma_f32_16x16x32_bf16 a[128:131], v[76:79], v[192:195], a[128:131]
v_mfma_f32_16x16x32_bf16 a[132:135], v[72:75], v[20:23], a[132:135]
ds_read_b128 v[64:67], v7 offset:12288
v_mfma_f32_16x16x32_bf16 a[132:135], v[76:79], v[196:199], a[132:135]
v_mfma_f32_16x16x32_bf16 a[136:139], v[72:75], v[24:27], a[136:139]
buffer_load_dwordx4 v[240:243], v5, s[8:11], s27 offen offset:3072 sc1
v_mfma_f32_16x16x32_bf16 a[136:139], v[76:79], v[200:203], a[136:139]
ds_read_b128 v[68:71], v7 offset:13312
v_mfma_f32_16x16x32_bf16 a[140:143], v[72:75], v[28:31], a[140:143]
v_mfma_f32_16x16x32_bf16 a[140:143], v[76:79], v[204:207], a[140:143]
s_waitcnt lgkmcnt(4)
v_mfma_f32_16x16x32_bf16 a[144:147], v[48:51], v[16:19], a[144:147]
buffer_load_dwordx4 v[244:247], v6, s[8:11], s27 offen offset:3072 sc1
v_mfma_f32_16x16x32_bf16 a[144:147], v[52:55], v[192:195], a[144:147]
s_add_u32 m0, s22, 98304
v_add_u32 v3, 20480, v3
v_mfma_f32_16x16x32_bf16 a[148:151], v[48:51], v[20:23], a[148:151]
ds_read_b128 v[72:75], v7 offset:14336
v_mfma_f32_16x16x32_bf16 a[148:151], v[52:55], v[196:199], a[148:151]
v_mfma_f32_16x16x32_bf16 a[152:155], v[48:51], v[24:27], a[152:155]
buffer_load_dwordx4 v3, s[8:11], 0 offen offset:0 sc1 lds
v_mfma_f32_16x16x32_bf16 a[152:155], v[52:55], v[200:203], a[152:155]
ds_read_b128 v[76:79], v7 offset:15360
v_mfma_f32_16x16x32_bf16 a[156:159], v[48:51], v[28:31], a[156:159]
v_mfma_f32_16x16x32_bf16 a[156:159], v[52:55], v[204:207], a[156:159]
s_waitcnt lgkmcnt(4)
v_mfma_f32_16x16x32_bf16 a[160:163], v[56:59], v[16:19], a[160:163]
buffer_load_dwordx4 v3, s[8:11], 0 offen offset:1024 sc1 lds
v_mfma_f32_16x16x32_bf16 a[160:163], v[60:63], v[192:195], a[160:163]
v_mfma_f32_16x16x32_bf16 a[164:167], v[56:59], v[20:23], a[164:167]
ds_read_b128 v[48:51], v7 offset:16384
v_mfma_f32_16x16x32_bf16 a[164:167], v[60:63], v[196:199], a[164:167]
v_mfma_f32_16x16x32_bf16 a[168:171], v[56:59], v[24:27], a[168:171]
buffer_load_dwordx4 v3, s[8:11], 0 offen offset:2048 sc1 lds
v_mfma_f32_16x16x32_bf16 a[168:171], v[60:63], v[200:203], a[168:171]
ds_read_b128 v[52:55], v7 offset:17408
v_mfma_f32_16x16x32_bf16 a[172:175], v[56:59], v[28:31], a[172:175]
v_mfma_f32_16x16x32_bf16 a[172:175], v[60:63], v[204:207], a[172:175]
s_waitcnt vmcnt(19)
s_waitcnt lgkmcnt(4)
v_mfma_f32_16x16x32_bf16 a[112:115], v[64:67], v[32:35], a[112:115]
buffer_load_dwordx4 v3, s[8:11], 0 offen offset:3072 sc1 lds
v_mfma_f32_16x16x32_bf16 a[112:115], v[68:71], v[80:83], a[112:115]
s_add_u32 m0, s22, 102400
v_add_u32 v3, 4096, v3
v_mfma_f32_16x16x32_bf16 a[116:119], v[64:67], v[36:39], a[116:119]
ds_read_b128 v[56:59], v7 offset:18432
v_mfma_f32_16x16x32_bf16 a[116:119], v[68:71], v[84:87], a[116:119]
v_mfma_f32_16x16x32_bf16 a[120:123], v[64:67], v[40:43], a[120:123]
buffer_load_dwordx4 v3, s[8:11], 0 offen offset:0 sc1 lds
v_mfma_f32_16x16x32_bf16 a[120:123], v[68:71], v[88:91], a[120:123]
ds_read_b128 v[60:63], v7 offset:19456
v_mfma_f32_16x16x32_bf16 a[124:127], v[64:67], v[44:47], a[124:127]
v_mfma_f32_16x16x32_bf16 a[124:127], v[68:71], v[92:95], a[124:127]
s_waitcnt lgkmcnt(4)
v_mfma_f32_16x16x32_bf16 a[128:131], v[72:75], v[32:35], a[128:131]
buffer_load_dwordx4 v3, s[8:11], 0 offen offset:1024 sc1 lds
v_mfma_f32_16x16x32_bf16 a[128:131], v[76:79], v[80:83], a[128:131]
s_add_u32 m0, s22, 122880
v_add_u32 v3, 20480, v3
v_mfma_f32_16x16x32_bf16 a[132:135], v[72:75], v[36:39], a[132:135]
ds_read_b128 v[64:67], v7 offset:20480
v_mfma_f32_16x16x32_bf16 a[132:135], v[76:79], v[84:87], a[132:135]
v_mfma_f32_16x16x32_bf16 a[136:139], v[72:75], v[40:43], a[136:139]
v_mfma_f32_16x16x32_bf16 a[136:139], v[76:79], v[88:91], a[136:139]
ds_read_b128 v[68:71], v7 offset:21504
v_mfma_f32_16x16x32_bf16 a[140:143], v[72:75], v[44:47], a[140:143]
buffer_load_dwordx4 v3, s[8:11], 0 offen offset:0 sc1 lds
v_mfma_f32_16x16x32_bf16 a[140:143], v[76:79], v[92:95], a[140:143]
s_waitcnt lgkmcnt(4)
v_mfma_f32_16x16x32_bf16 a[144:147], v[48:51], v[32:35], a[144:147]
v_mfma_f32_16x16x32_bf16 a[144:147], v[52:55], v[80:83], a[144:147]
v_mfma_f32_16x16x32_bf16 a[148:151], v[48:51], v[36:39], a[148:151]
ds_read_b128 v[72:75], v7 offset:22528
v_mfma_f32_16x16x32_bf16 a[148:151], v[52:55], v[84:87], a[148:151]
buffer_load_dwordx4 v3, s[8:11], 0 offen offset:1024 sc1 lds
v_mfma_f32_16x16x32_bf16 a[152:155], v[48:51], v[40:43], a[152:155]
v_mfma_f32_16x16x32_bf16 a[152:155], v[52:55], v[88:91], a[152:155]
ds_read_b128 v[76:79], v7 offset:23552
v_mfma_f32_16x16x32_bf16 a[156:159], v[48:51], v[44:47], a[156:159]
v_mfma_f32_16x16x32_bf16 a[156:159], v[52:55], v[92:95], a[156:159]
s_waitcnt lgkmcnt(4)
v_mfma_f32_16x16x32_bf16 a[160:163], v[56:59], v[32:35], a[160:163]
buffer_load_dwordx4 v3, s[8:11], 0 offen offset:2048 sc1 lds
v_mfma_f32_16x16x32_bf16 a[160:163], v[60:63], v[80:83], a[160:163]
v_mfma_f32_16x16x32_bf16 a[164:167], v[56:59], v[36:39], a[164:167]
ds_read_b128 v[48:51], v7 offset:24576
v_mfma_f32_16x16x32_bf16 a[164:167], v[60:63], v[84:87], a[164:167]
v_mfma_f32_16x16x32_bf16 a[168:171], v[56:59], v[40:43], a[168:171]
v_mfma_f32_16x16x32_bf16 a[168:171], v[60:63], v[88:91], a[168:171]
ds_read_b128 v[52:55], v7 offset:25600
v_mfma_f32_16x16x32_bf16 a[172:175], v[56:59], v[44:47], a[172:175]
buffer_load_dwordx4 v3, s[8:11], 0 offen offset:3072 sc1 lds
v_mfma_f32_16x16x32_bf16 a[172:175], v[60:63], v[92:95], a[172:175]
s_add_u32 m0, s22, 126976
s_waitcnt vmcnt(18)
s_waitcnt lgkmcnt(4)
v_mfma_f32_16x16x32_bf16 a[112:115], v[64:67], v[96:99], a[112:115]
v_add_u32 v3, 4096, v3
v_mfma_f32_16x16x32_bf16 a[112:115], v[68:71], v[112:115], a[112:115]
v_mfma_f32_16x16x32_bf16 a[116:119], v[64:67], v[100:103], a[116:119]
ds_read_b128 v[56:59], v7 offset:26624
v_mfma_f32_16x16x32_bf16 a[116:119], v[68:71], v[116:119], a[116:119]
buffer_load_dwordx4 v3, s[8:11], 0 offen offset:0 sc1 lds
v_mfma_f32_16x16x32_bf16 a[120:123], v[64:67], v[104:107], a[120:123]
v_mfma_f32_16x16x32_bf16 a[120:123], v[68:71], v[120:123], a[120:123]
ds_read_b128 v[60:63], v7 offset:27648
v_mfma_f32_16x16x32_bf16 a[124:127], v[64:67], v[108:111], a[124:127]
v_mfma_f32_16x16x32_bf16 a[124:127], v[68:71], v[124:127], a[124:127]
s_waitcnt vmcnt(11)
s_waitcnt lgkmcnt(4)
v_mfma_f32_16x16x32_bf16 a[112:115], v[72:75], v[128:131], a[112:115]
buffer_load_dwordx4 v3, s[8:11], 0 offen offset:1024 sc1 lds
v_mfma_f32_16x16x32_bf16 a[112:115], v[76:79], v[232:235], a[112:115]
s_lshl_b32 s21, s4, 11
s_add_u32 m0, s21, 0
v_mfma_f32_16x16x32_bf16 a[116:119], v[72:75], v[132:135], a[116:119]
ds_read_b128 v[64:67], v7 offset:28672
s_sub_u32 s21, s21, s22
v_mfma_f32_16x16x32_bf16 a[116:119], v[76:79], v[236:239], a[116:119]
s_add_u32 s21, s21, 20480
v_add_u32 v3, s21, v3
v_mfma_f32_16x16x32_bf16 a[120:123], v[72:75], v[136:139], a[120:123]
v_mfma_f32_16x16x32_bf16 a[120:123], v[76:79], v[240:243], a[120:123]
ds_read_b128 v[68:71], v7 offset:29696
v_mfma_f32_16x16x32_bf16 a[124:127], v[72:75], v[140:143], a[124:127]
buffer_load_dwordx4 v3, s[8:11], 0 offen offset:0 sc1 lds
v_mfma_f32_16x16x32_bf16 a[124:127], v[76:79], v[244:247], a[124:127]
s_waitcnt lgkmcnt(4)
v_mfma_f32_16x16x32_bf16 a[128:131], v[48:51], v[96:99], a[128:131]
v_mfma_f32_16x16x32_bf16 a[128:131], v[52:55], v[112:115], a[128:131]
v_mfma_f32_16x16x32_bf16 a[132:135], v[48:51], v[100:103], a[132:135]
ds_read_b128 v[72:75], v7 offset:30720
v_mfma_f32_16x16x32_bf16 a[132:135], v[52:55], v[116:119], a[132:135]
buffer_load_dwordx4 v3, s[8:11], 0 offen offset:1024 sc1 lds
v_mfma_f32_16x16x32_bf16 a[136:139], v[48:51], v[104:107], a[136:139]
v_mfma_f32_16x16x32_bf16 a[136:139], v[52:55], v[120:123], a[136:139]
ds_read_b128 v[76:79], v7 offset:31744
v_mfma_f32_16x16x32_bf16 a[140:143], v[48:51], v[108:111], a[140:143]
v_mfma_f32_16x16x32_bf16 a[140:143], v[52:55], v[124:127], a[140:143]
s_waitcnt lgkmcnt(4)
v_mfma_f32_16x16x32_bf16 a[128:131], v[56:59], v[128:131], a[128:131]
s_waitcnt vmcnt(8)
v_mfma_f32_16x16x32_bf16 a[128:131], v[60:63], v[232:235], a[128:131]
s_barrier
v_mfma_f32_16x16x32_bf16 a[132:135], v[56:59], v[132:135], a[132:135]
ds_read_b128 v[48:51], v7 offset:32768
v_mfma_f32_16x16x32_bf16 a[132:135], v[60:63], v[236:239], a[132:135]
v_mfma_f32_16x16x32_bf16 a[136:139], v[56:59], v[136:139], a[136:139]
v_mfma_f32_16x16x32_bf16 a[136:139], v[60:63], v[240:243], a[136:139]
ds_read_b128 v[52:55], v7 offset:33792
v_mfma_f32_16x16x32_bf16 a[140:143], v[56:59], v[140:143], a[140:143]
v_mfma_f32_16x16x32_bf16 a[140:143], v[60:63], v[244:247], a[140:143]
s_waitcnt lgkmcnt(4)
v_mfma_f32_16x16x32_bf16 a[144:147], v[64:67], v[96:99], a[144:147]
v_mfma_f32_16x16x32_bf16 a[144:147], v[68:71], v[112:115], a[144:147]
v_mfma_f32_16x16x32_bf16 a[148:151], v[64:67], v[100:103], a[148:151]
ds_read_b128 v[56:59], v7 offset:34816
v_mfma_f32_16x16x32_bf16 a[148:151], v[68:71], v[116:119], a[148:151]
v_mfma_f32_16x16x32_bf16 a[152:155], v[64:67], v[104:107], a[152:155]
v_mfma_f32_16x16x32_bf16 a[152:155], v[68:71], v[120:123], a[152:155]
ds_read_b128 v[60:63], v7 offset:35840
v_mfma_f32_16x16x32_bf16 a[156:159], v[64:67], v[108:111], a[156:159]
v_mfma_f32_16x16x32_bf16 a[156:159], v[68:71], v[124:127], a[156:159]
s_waitcnt lgkmcnt(4)
v_mfma_f32_16x16x32_bf16 a[144:147], v[72:75], v[128:131], a[144:147]
v_mfma_f32_16x16x32_bf16 a[144:147], v[76:79], v[232:235], a[144:147]
v_mfma_f32_16x16x32_bf16 a[148:151], v[72:75], v[132:135], a[148:151]
ds_read_b128 v[64:67], v7 offset:36864
v_mfma_f32_16x16x32_bf16 a[148:151], v[76:79], v[236:239], a[148:151]
v_mfma_f32_16x16x32_bf16 a[152:155], v[72:75], v[136:139], a[152:155]
v_mfma_f32_16x16x32_bf16 a[152:155], v[76:79], v[240:243], a[152:155]
ds_read_b128 v[68:71], v7 offset:37888
v_mfma_f32_16x16x32_bf16 a[156:159], v[72:75], v[140:143], a[156:159]
v_mfma_f32_16x16x32_bf16 a[156:159], v[76:79], v[244:247], a[156:159]
s_waitcnt lgkmcnt(4)
v_mfma_f32_16x16x32_bf16 a[160:163], v[48:51], v[96:99], a[160:163]
v_mfma_f32_16x16x32_bf16 a[160:163], v[52:55], v[112:115], a[160:163]
v_mfma_f32_16x16x32_bf16 a[164:167], v[48:51], v[100:103], a[164:167]
ds_read_b128 v[72:75], v7 offset:38912
v_mfma_f32_16x16x32_bf16 a[164:167], v[52:55], v[116:119], a[164:167]
v_mfma_f32_16x16x32_bf16 a[168:171], v[48:51], v[104:107], a[168:171]
v_mfma_f32_16x16x32_bf16 a[168:171], v[52:55], v[120:123], a[168:171]
ds_read_b128 v[76:79], v7 offset:39936
v_mfma_f32_16x16x32_bf16 a[172:175], v[48:51], v[108:111], a[172:175]
v_mfma_f32_16x16x32_bf16 a[172:175], v[52:55], v[124:127], a[172:175]
s_waitcnt lgkmcnt(4)
v_mfma_f32_16x16x32_bf16 a[160:163], v[56:59], v[128:131], a[160:163]
v_mfma_f32_16x16x32_bf16 a[160:163], v[60:63], v[232:235], a[160:163]
v_mfma_f32_16x16x32_bf16 a[164:167], v[56:59], v[132:135], a[164:167]
ds_read_b128 v[48:51], v7 offset:40960
v_mfma_f32_16x16x32_bf16 a[164:167], v[60:63], v[236:239], a[164:167]
v_mfma_f32_16x16x32_bf16 a[168:171], v[56:59], v[136:139], a[168:171]
v_mfma_f32_16x16x32_bf16 a[168:171], v[60:63], v[240:243], a[168:171]
ds_read_b128 v[52:55], v7 offset:41984
v_mfma_f32_16x16x32_bf16 a[172:175], v[56:59], v[140:143], a[172:175]
v_mfma_f32_16x16x32_bf16 a[172:175], v[60:63], v[244:247], a[172:175]
s_waitcnt lgkmcnt(4)
v_mfma_f32_16x16x32_bf16 a[176:179], v[64:67], v[16:19], a[176:179]
v_mfma_f32_16x16x32_bf16 a[176:179], v[68:71], v[192:195], a[176:179]
v_mfma_f32_16x16x32_bf16 a[180:183], v[64:67], v[20:23], a[180:183]
ds_read_b128 v[56:59], v7 offset:43008
v_mfma_f32_16x16x32_bf16 a[180:183], v[68:71], v[196:199], a[180:183]
v_accvgpr_read_b32 v208, a112
v_accvgpr_read_b32 v209, a128
v_mfma_f32_16x16x32_bf16 a[184:187], v[64:67], v[24:27], a[184:187]
v_accvgpr_read_b32 v210, a144
v_accvgpr_read_b32 v211, a160
v_mfma_f32_16x16x32_bf16 a[184:187], v[68:71], v[200:203], a[184:187]
ds_read_b128 v[60:63], v7 offset:44032
v_accvgpr_read_b32 v212, a113
v_mfma_f32_16x16x32_bf16 a[188:191], v[64:67], v[28:31], a[188:191]
v_accvgpr_read_b32 v213, a129
v_accvgpr_read_b32 v214, a145
v_mfma_f32_16x16x32_bf16 a[188:191], v[68:71], v[204:207], a[188:191]
v_accvgpr_read_b32 v215, a161
s_waitcnt lgkmcnt(4)
v_mfma_f32_16x16x32_bf16 a[192:195], v[72:75], v[16:19], a[192:195]
v_cvt_pk_bf16_f32 v224, v208, v209
v_cvt_pk_bf16_f32 v225, v210, v211
v_mfma_f32_16x16x32_bf16 a[192:195], v[76:79], v[192:195], a[192:195]
v_cvt_pk_bf16_f32 v226, v212, v213
v_cvt_pk_bf16_f32 v227, v214, v215
v_mfma_f32_16x16x32_bf16 a[196:199], v[72:75], v[20:23], a[196:199]
ds_read_b128 v[64:67], v7 offset:45056
v_accvgpr_read_b32 v216, a114
v_mfma_f32_16x16x32_bf16 a[196:199], v[76:79], v[196:199], a[196:199]
buffer_store_dwordx4 v[224:227], v252, s[8:11], s36 offen offset:0 sc1
v_mfma_f32_16x16x32_bf16 a[200:203], v[72:75], v[24:27], a[200:203]
v_accvgpr_read_b32 v217, a130
v_accvgpr_read_b32 v218, a146
v_mfma_f32_16x16x32_bf16 a[200:203], v[76:79], v[200:203], a[200:203]
ds_read_b128 v[68:71], v7 offset:46080
v_accvgpr_read_b32 v219, a162
v_mfma_f32_16x16x32_bf16 a[204:207], v[72:75], v[28:31], a[204:207]
v_accvgpr_read_b32 v220, a115
v_accvgpr_read_b32 v221, a131
v_mfma_f32_16x16x32_bf16 a[204:207], v[76:79], v[204:207], a[204:207]
v_accvgpr_read_b32 v222, a147
s_waitcnt lgkmcnt(4)
v_mfma_f32_16x16x32_bf16 a[208:211], v[48:51], v[16:19], a[208:211]
v_accvgpr_read_b32 v223, a163
v_cvt_pk_bf16_f32 v228, v216, v217
v_mfma_f32_16x16x32_bf16 a[208:211], v[52:55], v[192:195], a[208:211]
v_cvt_pk_bf16_f32 v229, v218, v219
v_cvt_pk_bf16_f32 v230, v220, v221
v_mfma_f32_16x16x32_bf16 a[212:215], v[48:51], v[20:23], a[212:215]
ds_read_b128 v[72:75], v7 offset:47104
v_cvt_pk_bf16_f32 v231, v222, v223
v_mfma_f32_16x16x32_bf16 a[212:215], v[52:55], v[196:199], a[212:215]
buffer_store_dwordx4 v[228:231], v252, s[8:11], s36 offen offset:256 sc1
v_mfma_f32_16x16x32_bf16 a[216:219], v[48:51], v[24:27], a[216:219]
v_accvgpr_read_b32 v208, a116
v_accvgpr_read_b32 v209, a132
v_mfma_f32_16x16x32_bf16 a[216:219], v[52:55], v[200:203], a[216:219]
ds_read_b128 v[76:79], v7 offset:48128
v_accvgpr_read_b32 v210, a148
v_mfma_f32_16x16x32_bf16 a[220:223], v[48:51], v[28:31], a[220:223]
v_accvgpr_read_b32 v211, a164
v_accvgpr_read_b32 v212, a117
v_mfma_f32_16x16x32_bf16 a[220:223], v[52:55], v[204:207], a[220:223]
v_accvgpr_read_b32 v213, a133
s_waitcnt lgkmcnt(4)
v_mfma_f32_16x16x32_bf16 a[224:227], v[56:59], v[16:19], a[224:227]
v_accvgpr_read_b32 v214, a149
v_accvgpr_read_b32 v215, a165
v_mfma_f32_16x16x32_bf16 a[224:227], v[60:63], v[192:195], a[224:227]
v_cvt_pk_bf16_f32 v224, v208, v209
v_cvt_pk_bf16_f32 v225, v210, v211
v_mfma_f32_16x16x32_bf16 a[228:231], v[56:59], v[20:23], a[228:231]
ds_read_b128 v[48:51], v7 offset:49152
v_cvt_pk_bf16_f32 v226, v212, v213
v_mfma_f32_16x16x32_bf16 a[228:231], v[60:63], v[196:199], a[228:231]
v_cvt_pk_bf16_f32 v227, v214, v215
v_accvgpr_read_b32 v216, a118
v_mfma_f32_16x16x32_bf16 a[232:235], v[56:59], v[24:27], a[232:235]
buffer_store_dwordx4 v[224:227], v252, s[8:11], s37 offen offset:0 sc1
v_mfma_f32_16x16x32_bf16 a[232:235], v[60:63], v[200:203], a[232:235]
ds_read_b128 v[52:55], v7 offset:50176
v_accvgpr_read_b32 v217, a134
v_mfma_f32_16x16x32_bf16 a[236:239], v[56:59], v[28:31], a[236:239]
v_accvgpr_read_b32 v218, a150
v_accvgpr_read_b32 v219, a166
v_mfma_f32_16x16x32_bf16 a[236:239], v[60:63], v[204:207], a[236:239]
v_accvgpr_read_b32 v220, a119
s_waitcnt lgkmcnt(4)
v_mfma_f32_16x16x32_bf16 a[176:179], v[64:67], v[32:35], a[176:179]
v_accvgpr_read_b32 v221, a135
v_accvgpr_read_b32 v222, a151
v_mfma_f32_16x16x32_bf16 a[176:179], v[68:71], v[80:83], a[176:179]
v_accvgpr_read_b32 v223, a167
v_cvt_pk_bf16_f32 v228, v216, v217
v_mfma_f32_16x16x32_bf16 a[180:183], v[64:67], v[36:39], a[180:183]
ds_read_b128 v[56:59], v7 offset:51200
v_cvt_pk_bf16_f32 v229, v218, v219
v_mfma_f32_16x16x32_bf16 a[180:183], v[68:71], v[84:87], a[180:183]
v_cvt_pk_bf16_f32 v230, v220, v221
v_cvt_pk_bf16_f32 v231, v222, v223
v_mfma_f32_16x16x32_bf16 a[184:187], v[64:67], v[40:43], a[184:187]
buffer_store_dwordx4 v[228:231], v252, s[8:11], s37 offen offset:256 sc1
v_mfma_f32_16x16x32_bf16 a[184:187], v[68:71], v[88:91], a[184:187]
ds_read_b128 v[60:63], v7 offset:52224
v_accvgpr_read_b32 v208, a120
v_mfma_f32_16x16x32_bf16 a[188:191], v[64:67], v[44:47], a[188:191]
v_accvgpr_read_b32 v209, a136
v_accvgpr_read_b32 v210, a152
v_mfma_f32_16x16x32_bf16 a[188:191], v[68:71], v[92:95], a[188:191]
v_accvgpr_read_b32 v211, a168
s_waitcnt lgkmcnt(4)
v_mfma_f32_16x16x32_bf16 a[192:195], v[72:75], v[32:35], a[192:195]
v_accvgpr_read_b32 v212, a121
v_accvgpr_read_b32 v213, a137
v_mfma_f32_16x16x32_bf16 a[192:195], v[76:79], v[80:83], a[192:195]
v_accvgpr_read_b32 v214, a153
v_accvgpr_read_b32 v215, a169
v_mfma_f32_16x16x32_bf16 a[196:199], v[72:75], v[36:39], a[196:199]
ds_read_b128 v[64:67], v7 offset:53248
v_cvt_pk_bf16_f32 v224, v208, v209
v_mfma_f32_16x16x32_bf16 a[196:199], v[76:79], v[84:87], a[196:199]
v_cvt_pk_bf16_f32 v225, v210, v211
v_cvt_pk_bf16_f32 v226, v212, v213
v_mfma_f32_16x16x32_bf16 a[200:203], v[72:75], v[40:43], a[200:203]
v_cvt_pk_bf16_f32 v227, v214, v215
v_accvgpr_read_b32 v216, a122
v_mfma_f32_16x16x32_bf16 a[200:203], v[76:79], v[88:91], a[200:203]
ds_read_b128 v[68:71], v7 offset:54272
v_accvgpr_read_b32 v217, a138
v_mfma_f32_16x16x32_bf16 a[204:207], v[72:75], v[44:47], a[204:207]
buffer_store_dwordx4 v[224:227], v252, s[8:11], s38 offen offset:0 sc1
v_mfma_f32_16x16x32_bf16 a[204:207], v[76:79], v[92:95], a[204:207]
v_accvgpr_read_b32 v218, a154
s_waitcnt lgkmcnt(4)
v_mfma_f32_16x16x32_bf16 a[208:211], v[48:51], v[32:35], a[208:211]
v_accvgpr_read_b32 v219, a170
v_accvgpr_read_b32 v220, a123
v_mfma_f32_16x16x32_bf16 a[208:211], v[52:55], v[80:83], a[208:211]
v_accvgpr_read_b32 v221, a139
v_accvgpr_read_b32 v222, a155
v_mfma_f32_16x16x32_bf16 a[212:215], v[48:51], v[36:39], a[212:215]
ds_read_b128 v[72:75], v7 offset:55296
v_accvgpr_read_b32 v223, a171
v_mfma_f32_16x16x32_bf16 a[212:215], v[52:55], v[84:87], a[212:215]
v_cvt_pk_bf16_f32 v228, v216, v217
v_cvt_pk_bf16_f32 v229, v218, v219
v_mfma_f32_16x16x32_bf16 a[216:219], v[48:51], v[40:43], a[216:219]
v_cvt_pk_bf16_f32 v230, v220, v221
v_cvt_pk_bf16_f32 v231, v222, v223
v_mfma_f32_16x16x32_bf16 a[216:219], v[52:55], v[88:91], a[216:219]
ds_read_b128 v[76:79], v7 offset:56320
v_accvgpr_read_b32 v208, a124
v_mfma_f32_16x16x32_bf16 a[220:223], v[48:51], v[44:47], a[220:223]
buffer_store_dwordx4 v[228:231], v252, s[8:11], s38 offen offset:256 sc1
v_mfma_f32_16x16x32_bf16 a[220:223], v[52:55], v[92:95], a[220:223]
v_accvgpr_read_b32 v209, a140
s_waitcnt lgkmcnt(4)
v_mfma_f32_16x16x32_bf16 a[224:227], v[56:59], v[32:35], a[224:227]
s_waitcnt vmcnt(8)
v_accvgpr_read_b32 v210, a156
v_mfma_f32_16x16x32_bf16 a[224:227], v[60:63], v[80:83], a[224:227]
s_barrier
v_mfma_f32_16x16x32_bf16 a[228:231], v[56:59], v[36:39], a[228:231]
ds_read_b128 v[48:51], v7 offset:57344
v_accvgpr_read_b32 v211, a172
v_mfma_f32_16x16x32_bf16 a[228:231], v[60:63], v[84:87], a[228:231]
v_accvgpr_read_b32 v212, a125
v_accvgpr_read_b32 v213, a141
v_mfma_f32_16x16x32_bf16 a[232:235], v[56:59], v[40:43], a[232:235]
v_accvgpr_read_b32 v214, a157
v_accvgpr_read_b32 v215, a173
v_mfma_f32_16x16x32_bf16 a[232:235], v[60:63], v[88:91], a[232:235]
ds_read_b128 v[52:55], v7 offset:58368
v_cvt_pk_bf16_f32 v224, v208, v209
v_mfma_f32_16x16x32_bf16 a[236:239], v[56:59], v[44:47], a[236:239]
v_cvt_pk_bf16_f32 v225, v210, v211
v_cvt_pk_bf16_f32 v226, v212, v213
v_mfma_f32_16x16x32_bf16 a[236:239], v[60:63], v[92:95], a[236:239]
v_cvt_pk_bf16_f32 v227, v214, v215
s_waitcnt lgkmcnt(4)
v_mfma_f32_16x16x32_bf16 a[176:179], v[64:67], v[96:99], a[176:179]
buffer_store_dwordx4 v[224:227], v252, s[8:11], s39 offen offset:0 sc1
v_mfma_f32_16x16x32_bf16 a[176:179], v[68:71], v[112:115], a[176:179]
v_accvgpr_read_b32 v216, a126
v_accvgpr_read_b32 v217, a142
v_mfma_f32_16x16x32_bf16 a[180:183], v[64:67], v[100:103], a[180:183]
ds_read_b128 v[56:59], v7 offset:59392
v_accvgpr_read_b32 v218, a158
v_mfma_f32_16x16x32_bf16 a[180:183], v[68:71], v[116:119], a[180:183]
v_accvgpr_read_b32 v219, a174
v_accvgpr_read_b32 v220, a127
v_mfma_f32_16x16x32_bf16 a[184:187], v[64:67], v[104:107], a[184:187]
v_accvgpr_read_b32 v221, a143
v_accvgpr_read_b32 v222, a159
v_mfma_f32_16x16x32_bf16 a[184:187], v[68:71], v[120:123], a[184:187]
ds_read_b128 v[60:63], v7 offset:60416
v_accvgpr_read_b32 v223, a175
v_mfma_f32_16x16x32_bf16 a[188:191], v[64:67], v[108:111], a[188:191]
v_cvt_pk_bf16_f32 v228, v216, v217
v_cvt_pk_bf16_f32 v229, v218, v219
v_mfma_f32_16x16x32_bf16 a[188:191], v[68:71], v[124:127], a[188:191]
v_cvt_pk_bf16_f32 v230, v220, v221
s_waitcnt lgkmcnt(4)
v_mfma_f32_16x16x32_bf16 a[176:179], v[72:75], v[128:131], a[176:179]
v_cvt_pk_bf16_f32 v231, v222, v223
v_mfma_f32_16x16x32_bf16 a[176:179], v[76:79], v[232:235], a[176:179]
buffer_store_dwordx4 v[228:231], v252, s[8:11], s39 offen offset:256 sc1
v_mfma_f32_16x16x32_bf16 a[180:183], v[72:75], v[132:135], a[180:183]
ds_read_b128 v[64:67], v7 offset:61440
v_mfma_f32_16x16x32_bf16 a[180:183], v[76:79], v[236:239], a[180:183]
v_mfma_f32_16x16x32_bf16 a[184:187], v[72:75], v[136:139], a[184:187]
v_mfma_f32_16x16x32_bf16 a[184:187], v[76:79], v[240:243], a[184:187]
ds_read_b128 v[68:71], v7 offset:62464
v_mfma_f32_16x16x32_bf16 a[188:191], v[72:75], v[140:143], a[188:191]
v_mfma_f32_16x16x32_bf16 a[188:191], v[76:79], v[244:247], a[188:191]
s_waitcnt lgkmcnt(4)
v_mfma_f32_16x16x32_bf16 a[192:195], v[48:51], v[96:99], a[192:195]
v_mfma_f32_16x16x32_bf16 a[192:195], v[52:55], v[112:115], a[192:195]
v_mfma_f32_16x16x32_bf16 a[196:199], v[48:51], v[100:103], a[196:199]
ds_read_b128 v[72:75], v7 offset:63488
v_mfma_f32_16x16x32_bf16 a[196:199], v[52:55], v[116:119], a[196:199]
v_mfma_f32_16x16x32_bf16 a[200:203], v[48:51], v[104:107], a[200:203]
v_mfma_f32_16x16x32_bf16 a[200:203], v[52:55], v[120:123], a[200:203]
ds_read_b128 v[76:79], v7 offset:64512
v_mfma_f32_16x16x32_bf16 a[204:207], v[48:51], v[108:111], a[204:207]
v_mfma_f32_16x16x32_bf16 a[204:207], v[52:55], v[124:127], a[204:207]
s_waitcnt lgkmcnt(4)
v_mfma_f32_16x16x32_bf16 a[192:195], v[56:59], v[128:131], a[192:195]
v_mfma_f32_16x16x32_bf16 a[192:195], v[60:63], v[232:235], a[192:195]
v_mfma_f32_16x16x32_bf16 a[196:199], v[56:59], v[132:135], a[196:199]
ds_read_b128 v[48:51], v8 offset:0
v_mfma_f32_16x16x32_bf16 a[196:199], v[60:63], v[236:239], a[196:199]
v_mfma_f32_16x16x32_bf16 a[200:203], v[56:59], v[136:139], a[200:203]
v_mfma_f32_16x16x32_bf16 a[200:203], v[60:63], v[240:243], a[200:203]
ds_read_b128 v[52:55], v8 offset:1024
v_mfma_f32_16x16x32_bf16 a[204:207], v[56:59], v[140:143], a[204:207]
v_mfma_f32_16x16x32_bf16 a[204:207], v[60:63], v[244:247], a[204:207]
s_waitcnt lgkmcnt(4)
v_mfma_f32_16x16x32_bf16 a[208:211], v[64:67], v[96:99], a[208:211]
v_mfma_f32_16x16x32_bf16 a[208:211], v[68:71], v[112:115], a[208:211]
v_mfma_f32_16x16x32_bf16 a[212:215], v[64:67], v[100:103], a[212:215]
ds_read_b128 v[56:59], v8 offset:2048
v_mfma_f32_16x16x32_bf16 a[212:215], v[68:71], v[116:119], a[212:215]
v_mfma_f32_16x16x32_bf16 a[216:219], v[64:67], v[104:107], a[216:219]
v_mfma_f32_16x16x32_bf16 a[216:219], v[68:71], v[120:123], a[216:219]
ds_read_b128 v[60:63], v8 offset:3072
v_mfma_f32_16x16x32_bf16 a[220:223], v[64:67], v[108:111], a[220:223]
v_mfma_f32_16x16x32_bf16 a[220:223], v[68:71], v[124:127], a[220:223]
s_waitcnt lgkmcnt(4)
v_mfma_f32_16x16x32_bf16 a[208:211], v[72:75], v[128:131], a[208:211]
v_mfma_f32_16x16x32_bf16 a[208:211], v[76:79], v[232:235], a[208:211]
v_mfma_f32_16x16x32_bf16 a[212:215], v[72:75], v[132:135], a[212:215]
ds_read_b128 v[64:67], v8 offset:4096
v_mfma_f32_16x16x32_bf16 a[212:215], v[76:79], v[236:239], a[212:215]
v_mfma_f32_16x16x32_bf16 a[216:219], v[72:75], v[136:139], a[216:219]
v_mfma_f32_16x16x32_bf16 a[216:219], v[76:79], v[240:243], a[216:219]
ds_read_b128 v[68:71], v8 offset:5120
v_mfma_f32_16x16x32_bf16 a[220:223], v[72:75], v[140:143], a[220:223]
v_mfma_f32_16x16x32_bf16 a[220:223], v[76:79], v[244:247], a[220:223]
s_waitcnt lgkmcnt(4)
v_mfma_f32_16x16x32_bf16 a[224:227], v[48:51], v[96:99], a[224:227]
v_mfma_f32_16x16x32_bf16 a[224:227], v[52:55], v[112:115], a[224:227]
v_mfma_f32_16x16x32_bf16 a[228:231], v[48:51], v[100:103], a[228:231]
ds_read_b128 v[72:75], v8 offset:6144
v_mfma_f32_16x16x32_bf16 a[228:231], v[52:55], v[116:119], a[228:231]
v_mfma_f32_16x16x32_bf16 a[232:235], v[48:51], v[104:107], a[232:235]
v_mfma_f32_16x16x32_bf16 a[232:235], v[52:55], v[120:123], a[232:235]
ds_read_b128 v[76:79], v8 offset:7168
v_mfma_f32_16x16x32_bf16 a[236:239], v[48:51], v[108:111], a[236:239]
v_mfma_f32_16x16x32_bf16 a[236:239], v[52:55], v[124:127], a[236:239]
s_waitcnt lgkmcnt(4)
v_mfma_f32_16x16x32_bf16 a[224:227], v[56:59], v[128:131], a[224:227]
v_mfma_f32_16x16x32_bf16 a[224:227], v[60:63], v[232:235], a[224:227]
v_mfma_f32_16x16x32_bf16 a[228:231], v[56:59], v[132:135], a[228:231]
ds_read_b128 v[48:51], v8 offset:8192
v_mfma_f32_16x16x32_bf16 a[228:231], v[60:63], v[236:239], a[228:231]
v_mfma_f32_16x16x32_bf16 a[232:235], v[56:59], v[136:139], a[232:235]
v_mfma_f32_16x16x32_bf16 a[232:235], v[60:63], v[240:243], a[232:235]
ds_read_b128 v[52:55], v8 offset:9216
v_mfma_f32_16x16x32_bf16 a[236:239], v[56:59], v[140:143], a[236:239]
v_mfma_f32_16x16x32_bf16 a[236:239], v[60:63], v[244:247], a[236:239]
s_waitcnt lgkmcnt(4)
v_mfma_f32_16x16x32_bf16 a[240:243], v[64:67], v[144:147], 0
v_mfma_f32_16x16x32_bf16 a[240:243], v[68:71], v[160:163], a[240:243]
v_mfma_f32_16x16x32_bf16 a[244:247], v[64:67], v[148:151], 0
ds_read_b128 v[56:59], v8 offset:10240
v_mfma_f32_16x16x32_bf16 a[244:247], v[68:71], v[164:167], a[244:247]
v_accvgpr_read_b32 v208, a176
v_accvgpr_read_b32 v209, a192
v_mfma_f32_16x16x32_bf16 a[248:251], v[64:67], v[152:155], 0
v_accvgpr_read_b32 v210, a208
v_accvgpr_read_b32 v211, a224
v_mfma_f32_16x16x32_bf16 a[248:251], v[68:71], v[168:171], a[248:251]
ds_read_b128 v[60:63], v8 offset:11264
v_accvgpr_read_b32 v212, a177
v_mfma_f32_16x16x32_bf16 a[252:255], v[64:67], v[156:159], 0
v_accvgpr_read_b32 v213, a193
v_accvgpr_read_b32 v214, a209
v_mfma_f32_16x16x32_bf16 a[252:255], v[68:71], v[172:175], a[252:255]
v_accvgpr_read_b32 v215, a225
s_waitcnt lgkmcnt(4)
v_mfma_f32_16x16x32_bf16 a[240:243], v[72:75], v[176:179], a[240:243]
v_cvt_pk_bf16_f32 v224, v208, v209
v_cvt_pk_bf16_f32 v225, v210, v211
v_mfma_f32_16x16x32_bf16 a[240:243], v[76:79], a[0:3], a[240:243]
v_cvt_pk_bf16_f32 v226, v212, v213
v_cvt_pk_bf16_f32 v227, v214, v215
v_mfma_f32_16x16x32_bf16 a[244:247], v[72:75], v[180:183], a[244:247]
ds_read_b128 v[64:67], v8 offset:12288
v_accvgpr_read_b32 v216, a178
v_mfma_f32_16x16x32_bf16 a[244:247], v[76:79], a[4:7], a[244:247]
buffer_store_dwordx4 v[224:227], v252, s[8:11], s36 offen offset:2048 sc1
v_mfma_f32_16x16x32_bf16 a[248:251], v[72:75], v[184:187], a[248:251]
v_accvgpr_read_b32 v217, a194
v_accvgpr_read_b32 v218, a210
v_mfma_f32_16x16x32_bf16 a[248:251], v[76:79], a[8:11], a[248:251]
ds_read_b128 v[68:71], v8 offset:13312
v_accvgpr_read_b32 v219, a226
v_mfma_f32_16x16x32_bf16 a[252:255], v[72:75], v[188:191], a[252:255]
v_accvgpr_read_b32 v220, a179
v_accvgpr_read_b32 v221, a195
v_mfma_f32_16x16x32_bf16 a[252:255], v[76:79], a[12:15], a[252:255]
v_accvgpr_read_b32 v222, a211
s_waitcnt lgkmcnt(4)
v_mfma_f32_16x16x32_bf16 a[240:243], v[48:51], a[16:19], a[240:243]
v_accvgpr_read_b32 v223, a227
v_cvt_pk_bf16_f32 v228, v216, v217
v_mfma_f32_16x16x32_bf16 a[240:243], v[52:55], a[32:35], a[240:243]
v_cvt_pk_bf16_f32 v229, v218, v219
v_cvt_pk_bf16_f32 v230, v220, v221
v_mfma_f32_16x16x32_bf16 a[244:247], v[48:51], a[20:23], a[244:247]
ds_read_b128 v[72:75], v8 offset:14336
v_cvt_pk_bf16_f32 v231, v222, v223
v_mfma_f32_16x16x32_bf16 a[244:247], v[52:55], a[36:39], a[244:247]
buffer_store_dwordx4 v[228:231], v252, s[8:11], s36 offen offset:2304 sc1
v_mfma_f32_16x16x32_bf16 a[248:251], v[48:51], a[24:27], a[248:251]
v_accvgpr_read_b32 v208, a180
v_accvgpr_read_b32 v209, a196
v_mfma_f32_16x16x32_bf16 a[248:251], v[52:55], a[40:43], a[248:251]
ds_read_b128 v[76:79], v8 offset:15360
v_accvgpr_read_b32 v210, a212
v_mfma_f32_16x16x32_bf16 a[252:255], v[48:51], a[28:31], a[252:255]
v_accvgpr_read_b32 v211, a228
v_accvgpr_read_b32 v212, a181
v_mfma_f32_16x16x32_bf16 a[252:255], v[52:55], a[44:47], a[252:255]
v_accvgpr_read_b32 v213, a197
s_waitcnt lgkmcnt(4)
v_mfma_f32_16x16x32_bf16 a[240:243], v[56:59], a[48:51], a[240:243]
s_waitcnt vmcnt(2)
v_mov_b32 v12, s68
v_mfma_f32_16x16x32_bf16 a[240:243], v[60:63], a[64:67], a[240:243]
s_barrier
v_mfma_f32_16x16x32_bf16 a[244:247], v[56:59], a[52:55], a[244:247]
ds_read_b128 v[48:51], v2 offset:0
v_mov_b32 v13, s69
v_mfma_f32_16x16x32_bf16 a[244:247], v[60:63], a[68:71], a[244:247]
s_add_u32 s53, s35, 262144
s_cmp_eq_u32 s4, 0
v_mfma_f32_16x16x32_bf16 a[248:251], v[56:59], a[56:59], a[248:251]
s_cselect_b32 s53, s53, 2146435072
s_lshl_b32 s23, s43, 7
v_mfma_f32_16x16x32_bf16 a[248:251], v[60:63], a[72:75], a[248:251]
ds_read_b128 v[52:55], v2 offset:1024
s_sub_u32 s53, s53, s23
v_mfma_f32_16x16x32_bf16 a[252:255], v[56:59], a[60:63], a[252:255]
buffer_store_dwordx2 v[12:13], v10, s[8:11], s53 offen sc1
v_mfma_f32_16x16x32_bf16 a[252:255], v[60:63], a[76:79], a[252:255]
v_accvgpr_read_b32 v214, a213
s_waitcnt lgkmcnt(4)
v_mfma_f32_16x16x32_bf16 a[240:243], v[64:67], a[80:83], a[240:243]
v_accvgpr_read_b32 v215, a229
v_cvt_pk_bf16_f32 v224, v208, v209
v_mfma_f32_16x16x32_bf16 a[240:243], v[68:71], a[96:99], a[240:243]
v_cvt_pk_bf16_f32 v225, v210, v211
v_cvt_pk_bf16_f32 v226, v212, v213
v_mfma_f32_16x16x32_bf16 a[244:247], v[64:67], a[84:87], a[244:247]
ds_read_b128 v[56:59], v2 offset:2048
v_cvt_pk_bf16_f32 v227, v214, v215
v_mfma_f32_16x16x32_bf16 a[244:247], v[68:71], a[100:103], a[244:247]
buffer_store_dwordx4 v[224:227], v252, s[8:11], s37 offen offset:2048 sc1
v_mfma_f32_16x16x32_bf16 a[248:251], v[64:67], a[88:91], a[248:251]
v_accvgpr_read_b32 v216, a182
v_accvgpr_read_b32 v217, a198
v_mfma_f32_16x16x32_bf16 a[248:251], v[68:71], a[104:107], a[248:251]
ds_read_b128 v[60:63], v2 offset:3072
v_accvgpr_read_b32 v218, a214
v_mfma_f32_16x16x32_bf16 a[252:255], v[64:67], a[92:95], a[252:255]
v_accvgpr_read_b32 v219, a230
v_accvgpr_read_b32 v220, a183
v_mfma_f32_16x16x32_bf16 a[252:255], v[68:71], a[108:111], a[252:255]
v_accvgpr_read_b32 v221, a199
s_waitcnt lgkmcnt(4)
v_mfma_f32_16x16x32_bf16 a[240:243], v[72:75], v[16:19], a[240:243]
v_accvgpr_read_b32 v222, a215
v_accvgpr_read_b32 v223, a231
v_mfma_f32_16x16x32_bf16 a[240:243], v[76:79], v[192:195], a[240:243]
v_cvt_pk_bf16_f32 v228, v216, v217
v_cvt_pk_bf16_f32 v229, v218, v219
v_mfma_f32_16x16x32_bf16 a[244:247], v[72:75], v[20:23], a[244:247]
ds_read_b128 v[64:67], v2 offset:4096
v_cvt_pk_bf16_f32 v230, v220, v221
v_mfma_f32_16x16x32_bf16 a[244:247], v[76:79], v[196:199], a[244:247]
v_cvt_pk_bf16_f32 v231, v222, v223
v_accvgpr_read_b32 v208, a184
v_mfma_f32_16x16x32_bf16 a[248:251], v[72:75], v[24:27], a[248:251]
buffer_store_dwordx4 v[228:231], v252, s[8:11], s37 offen offset:2304 sc1
v_mfma_f32_16x16x32_bf16 a[248:251], v[76:79], v[200:203], a[248:251]
ds_read_b128 v[68:71], v2 offset:5120
v_accvgpr_read_b32 v209, a200
v_mfma_f32_16x16x32_bf16 a[252:255], v[72:75], v[28:31], a[252:255]
v_accvgpr_read_b32 v210, a216
v_accvgpr_read_b32 v211, a232
v_mfma_f32_16x16x32_bf16 a[252:255], v[76:79], v[204:207], a[252:255]
v_accvgpr_read_b32 v212, a185
s_waitcnt lgkmcnt(4)
v_mfma_f32_16x16x32_bf16 a[240:243], v[48:51], v[32:35], a[240:243]
v_accvgpr_read_b32 v213, a201
v_accvgpr_read_b32 v214, a217
v_mfma_f32_16x16x32_bf16 a[240:243], v[52:55], v[80:83], a[240:243]
v_accvgpr_read_b32 v215, a233
v_cvt_pk_bf16_f32 v224, v208, v209
v_mfma_f32_16x16x32_bf16 a[244:247], v[48:51], v[36:39], a[244:247]
v_cvt_pk_bf16_f32 v225, v210, v211
v_cvt_pk_bf16_f32 v226, v212, v213
v_mfma_f32_16x16x32_bf16 a[244:247], v[52:55], v[84:87], a[244:247]
v_cvt_pk_bf16_f32 v227, v214, v215
v_accvgpr_read_b32 v216, a186
v_mfma_f32_16x16x32_bf16 a[248:251], v[48:51], v[40:43], a[248:251]
buffer_store_dwordx4 v[224:227], v252, s[8:11], s38 offen offset:2048 sc1
v_mfma_f32_16x16x32_bf16 a[248:251], v[52:55], v[88:91], a[248:251]
v_accvgpr_read_b32 v217, a202
v_accvgpr_read_b32 v218, a218
v_mfma_f32_16x16x32_bf16 a[252:255], v[48:51], v[44:47], a[252:255]
v_accvgpr_read_b32 v219, a234
v_accvgpr_read_b32 v220, a187
v_mfma_f32_16x16x32_bf16 a[252:255], v[52:55], v[92:95], a[252:255]
v_accvgpr_read_b32 v221, a203
s_waitcnt lgkmcnt(2)
v_mfma_f32_16x16x32_bf16 a[240:243], v[56:59], v[96:99], a[240:243]
v_accvgpr_read_b32 v222, a219
v_accvgpr_read_b32 v223, a235
v_mfma_f32_16x16x32_bf16 a[240:243], v[60:63], v[112:115], a[240:243]
v_cvt_pk_bf16_f32 v228, v216, v217
v_cvt_pk_bf16_f32 v229, v218, v219
v_mfma_f32_16x16x32_bf16 a[244:247], v[56:59], v[100:103], a[244:247]
v_cvt_pk_bf16_f32 v230, v220, v221
v_cvt_pk_bf16_f32 v231, v222, v223
v_mfma_f32_16x16x32_bf16 a[244:247], v[60:63], v[116:119], a[244:247]
buffer_store_dwordx4 v[228:231], v252, s[8:11], s38 offen offset:2304 sc1
v_mfma_f32_16x16x32_bf16 a[248:251], v[56:59], v[104:107], a[248:251]
v_accvgpr_read_b32 v208, a188
v_accvgpr_read_b32 v209, a204
v_mfma_f32_16x16x32_bf16 a[248:251], v[60:63], v[120:123], a[248:251]
v_accvgpr_read_b32 v210, a220
v_accvgpr_read_b32 v211, a236
v_mfma_f32_16x16x32_bf16 a[252:255], v[56:59], v[108:111], a[252:255]
v_accvgpr_read_b32 v212, a189
v_accvgpr_read_b32 v213, a205
v_mfma_f32_16x16x32_bf16 a[252:255], v[60:63], v[124:127], a[252:255]
v_accvgpr_read_b32 v214, a221
s_waitcnt lgkmcnt(0)
v_mfma_f32_16x16x32_bf16 a[240:243], v[64:67], v[128:131], a[240:243]
v_accvgpr_read_b32 v215, a237
v_cvt_pk_bf16_f32 v224, v208, v209
v_mfma_f32_16x16x32_bf16 a[240:243], v[68:71], v[232:235], a[240:243]
v_cvt_pk_bf16_f32 v225, v210, v211
v_cvt_pk_bf16_f32 v226, v212, v213
v_mfma_f32_16x16x32_bf16 a[244:247], v[64:67], v[132:135], a[244:247]
v_cvt_pk_bf16_f32 v227, v214, v215
v_accvgpr_read_b32 v216, a190
v_mfma_f32_16x16x32_bf16 a[244:247], v[68:71], v[236:239], a[244:247]
buffer_store_dwordx4 v[224:227], v252, s[8:11], s39 offen offset:2048 sc1
v_mfma_f32_16x16x32_bf16 a[248:251], v[64:67], v[136:139], a[248:251]
v_accvgpr_read_b32 v217, a206
v_accvgpr_read_b32 v218, a222
v_mfma_f32_16x16x32_bf16 a[248:251], v[68:71], v[240:243], a[248:251]
v_accvgpr_read_b32 v219, a238
v_accvgpr_read_b32 v220, a191
v_mfma_f32_16x16x32_bf16 a[252:255], v[64:67], v[140:143], a[252:255]
v_accvgpr_read_b32 v221, a207
v_accvgpr_read_b32 v222, a223
v_mfma_f32_16x16x32_bf16 a[252:255], v[68:71], v[244:247], a[252:255]
v_accvgpr_read_b32 v223, a239
v_cvt_pk_bf16_f32 v228, v216, v217
v_cvt_pk_bf16_f32 v229, v218, v219
v_cvt_pk_bf16_f32 v230, v220, v221
v_cvt_pk_bf16_f32 v231, v222, v223
buffer_store_dwordx4 v[228:231], v252, s[8:11], s39 offen offset:2304 sc1
v_accvgpr_read_b32 v208, a240
v_accvgpr_read_b32 v209, a241
v_accvgpr_read_b32 v210, a242
v_accvgpr_read_b32 v211, a243
v_accvgpr_read_b32 v212, a244
v_accvgpr_read_b32 v213, a245
v_accvgpr_read_b32 v214, a246
v_accvgpr_read_b32 v215, a247
v_cvt_pk_bf16_f32 v224, v208, v209
v_cvt_pk_bf16_f32 v225, v210, v211
v_cvt_pk_bf16_f32 v226, v212, v213
v_cvt_pk_bf16_f32 v227, v214, v215
s_nop 0
v_permlane16_swap_b32 v224, v226
v_permlane16_swap_b32 v225, v227
buffer_store_dwordx4 v[224:227], v9, s[8:11], s32 offen sc1
v_accvgpr_read_b32 v216, a248
v_accvgpr_read_b32 v217, a249
v_accvgpr_read_b32 v218, a250
v_accvgpr_read_b32 v219, a251
v_accvgpr_read_b32 v220, a252
v_accvgpr_read_b32 v221, a253
v_accvgpr_read_b32 v222, a254
v_accvgpr_read_b32 v223, a255
v_cvt_pk_bf16_f32 v228, v216, v217
v_cvt_pk_bf16_f32 v229, v218, v219
v_cvt_pk_bf16_f32 v230, v220, v221
v_cvt_pk_bf16_f32 v231, v222, v223
s_nop 0
v_permlane16_swap_b32 v228, v230
v_permlane16_swap_b32 v229, v231
buffer_store_dwordx4 v[228:231], v9, s[8:11], s33 offen sc1
s_mov_b32 s14, s35
s_cmp_eq_u32 s7, 1
s_cbranch_scc1 L_last
s_cmp_eq_u32 s4, 3
s_cbranch_scc1 L_r_side
v_and_b32 v6, 7, v1
v_lshrrev_b32 v7, 3, v1
s_and_b32 s23, s6, 1
s_lshl_b32 s23, s23, 3
v_add_u32 v8, s23, v6
v_lshlrev_b32 v8, 4, v8
v_lshl_add_u32 v4, v7, 8, v8
s_lshl_b32 s24, s5, 4
s_lshr_b32 s25, s6, 1
s_add_u32 s24, s24, s25
s_mul_i32 s20, s24, 18432
s_lshl_b32 s22, s4, 2
s_lshr_b32 s23, 1056, s22
s_and_b32 s23, s23, 15
s_lshl_b32 s24, s23, 11
s_add_u32 s28, s20, s24
s_lshr_b32 s23, 790, s22
s_and_b32 s23, s23, 15
s_lshl_b32 s24, s23, 11
s_add_u32 s29, s20, s24
s_lshr_b32 s23, 2165, s22
s_and_b32 s23, s23, 15
s_lshl_b32 s24, s23, 11
s_add_u32 s30, s20, s24
s_lshl_b32 s26, s5, 12
s_add_u32 s27, s26, 917504
s_add_u32 s26, s26, 655360
v_and_b32 v6, 31, v1
v_lshlrev_b32 v6, 7, v6
buffer_load_dwordx2 v[10:11], v6, s[8:11], s27 offen sc1
v_mov_b32 v13, 2146435072
v_cmp_gt_u32 vcc, 16, v0
v_lshlrev_b32 v14, 3, v0
s_nop 0
v_cndmask_b32 v13, v13, v14, vcc
v_mov_b32 v14, s68
v_mov_b32 v15, s69
s_waitcnt vmcnt(0)
s_barrier
buffer_store_dwordx2 v[14:15], v13, s[8:11], s14 offen sc1
s_add_u32 s24, s28, 37126144
buffer_load_dwordx4 v[16:19], v4, s[8:11], s24 offen sc1
s_add_u32 s25, s29, 37126144
buffer_load_dwordx4 v[20:23], v4, s[8:11], s25 offen sc1
s_add_u32 s24, s30, 37126144
buffer_load_dwordx4 v[24:27], v4, s[8:11], s24 offen sc1
v_cmp_eq_u64 vcc, s[68:69], v[10:11]
s_nop 0
s_cmp_eq_u64 vcc, exec
s_cbranch_scc0 L_re_slow4
L_re_back4:
s_add_u32 s25, s28, 79855616
buffer_load_dwordx4 v[28:31], v4, s[8:11], s25 offen sc1
s_add_u32 s24, s28, 82214912
buffer_load_dwordx4 v[40:43], v4, s[8:11], s24 offen sc1
s_add_u32 s25, s28, 84574208
buffer_load_dwordx4 v[52:55], v4, s[8:11], s25 offen sc1
s_add_u32 s24, s28, 86933504
buffer_load_dwordx4 v[64:67], v4, s[8:11], s24 offen sc1
s_add_u32 s25, s28, 89292800
buffer_load_dwordx4 v[76:79], v4, s[8:11], s25 offen sc1
s_add_u32 s24, s28, 91652096
buffer_load_dwordx4 v[88:91], v4, s[8:11], s24 offen sc1
s_add_u32 s25, s28, 94011392
buffer_load_dwordx4 v[100:103], v4, s[8:11], s25 offen sc1
s_add_u32 s24, s28, 96370688
buffer_load_dwordx4 v[112:115], v4, s[8:11], s24 offen sc1
s_mov_b32 s52, 0
L_poll6:
buffer_load_dwordx2 v[14:15], v6, s[8:11], s26 offen sc1
s_add_u32 s52, s52, 1
s_waitcnt vmcnt(0)
v_cmp_ne_u64 vcc, s[68:69], v[14:15]
s_cmp_ge_u32 s52, 1048576
s_cbranch_scc1 L_got6
s_and_b64 exec, exec, vcc
s_cbranch_execnz L_poll6
L_got6:
s_mov_b64 exec, -1
s_add_u32 s24, s29, 79855616
buffer_load_dwordx4 v[32:35], v4, s[8:11], s24 offen sc1
s_add_u32 s25, s30, 79855616
buffer_load_dwordx4 v[36:39], v4, s[8:11], s25 offen sc1
s_add_u32 s25, s29, 82214912
buffer_load_dwordx4 v[44:47], v4, s[8:11], s25 offen sc1
s_add_u32 s24, s30, 82214912
buffer_load_dwordx4 v[48:51], v4, s[8:11], s24 offen sc1
s_add_u32 s24, s29, 84574208
buffer_load_dwordx4 v[56:59], v4, s[8:11], s24 offen sc1
s_add_u32 s25, s30, 84574208
buffer_load_dwordx4 v[60:63], v4, s[8:11], s25 offen sc1
s_add_u32 s25, s29, 86933504
buffer_load_dwordx4 v[68:71], v4, s[8:11], s25 offen sc1
s_add_u32 s24, s30, 86933504
buffer_load_dwordx4 v[72:75], v4, s[8:11], s24 offen sc1
s_add_u32 s24, s29, 89292800
buffer_load_dwordx4 v[80:83], v4, s[8:11], s24 offen sc1
s_add_u32 s25, s30, 89292800
buffer_load_dwordx4 v[84:87], v4, s[8:11], s25 offen sc1
s_add_u32 s25, s29, 91652096
buffer_load_dwordx4 v[92:95], v4, s[8:11], s25 offen sc1
s_add_u32 s24, s30, 91652096
buffer_load_dwordx4 v[96:99], v4, s[8:11], s24 offen sc1
s_add_u32 s24, s29, 94011392
buffer_load_dwordx4 v[104:107], v4, s[8:11], s24 offen sc1
s_add_u32 s25, s30, 94011392
buffer_load_dwordx4 v[108:111], v4, s[8:11], s25 offen sc1
s_add_u32 s25, s29, 96370688
buffer_load_dwordx4 v[116:119], v4, s[8:11], s25 offen sc1
s_add_u32 s24, s30, 96370688
buffer_load_dwordx4 v[120:123], v4, s[8:11], s24 offen sc1
s_waitcnt vmcnt(26)
v_lshlrev_b32 v128, 16, v16
v_and_b32 v129, 0xffff0000, v16
v_lshlrev_b32 v130, 16, v17
v_and_b32 v131, 0xffff0000, v17
v_lshlrev_b32 v132, 16, v18
v_and_b32 v133, 0xffff0000, v18
v_lshlrev_b32 v134, 16, v19
v_and_b32 v135, 0xffff0000, v19
s_waitcnt vmcnt(25)
v_lshlrev_b32 v136, 16, v20
v_and_b32 v137, 0xffff0000, v20
v_lshlrev_b32 v138, 16, v21
v_and_b32 v139, 0xffff0000, v21
v_lshlrev_b32 v140, 16, v22
v_and_b32 v141, 0xffff0000, v22
v_lshlrev_b32 v142, 16, v23
v_and_b32 v143, 0xffff0000, v23
s_waitcnt vmcnt(24)
v_lshlrev_b32 v144, 16, v24
v_and_b32 v145, 0xffff0000, v24
v_lshlrev_b32 v146, 16, v25
v_and_b32 v147, 0xffff0000, v25
v_lshlrev_b32 v148, 16, v26
v_and_b32 v149, 0xffff0000, v26
v_lshlrev_b32 v150, 16, v27
v_and_b32 v151, 0xffff0000, v27
s_waitcnt vmcnt(23)
v_lshlrev_b32 v6, 16, v28
v_and_b32 v7, 0xffff0000, v28
v_add_f32 v128, v128, v6
v_add_f32 v129, v129, v7
v_lshlrev_b32 v8, 16, v29
v_and_b32 v9, 0xffff0000, v29
v_add_f32 v130, v130, v8
v_add_f32 v131, v131, v9
v_lshlrev_b32 v6, 16, v30
v_and_b32 v7, 0xffff0000, v30
v_add_f32 v132, v132, v6
v_add_f32 v133, v133, v7
v_lshlrev_b32 v8, 16, v31
v_and_b32 v9, 0xffff0000, v31
v_add_f32 v134, v134, v8
v_add_f32 v135, v135, v9
s_waitcnt vmcnt(22)
v_lshlrev_b32 v6, 16, v40
v_and_b32 v7, 0xffff0000, v40
v_add_f32 v128, v128, v6
v_add_f32 v129, v129, v7
v_lshlrev_b32 v8, 16, v41
v_and_b32 v9, 0xffff0000, v41
v_add_f32 v130, v130, v8
v_add_f32 v131, v131, v9
v_lshlrev_b32 v6, 16, v42
v_and_b32 v7, 0xffff0000, v42
v_add_f32 v132, v132, v6
v_add_f32 v133, v133, v7
v_lshlrev_b32 v8, 16, v43
v_and_b32 v9, 0xffff0000, v43
v_add_f32 v134, v134, v8
v_add_f32 v135, v135, v9
s_waitcnt vmcnt(21)
v_lshlrev_b32 v6, 16, v52
v_and_b32 v7, 0xffff0000, v52
v_add_f32 v128, v128, v6
v_add_f32 v129, v129, v7
v_lshlrev_b32 v8, 16, v53
v_and_b32 v9, 0xffff0000, v53
v_add_f32 v130, v130, v8
v_add_f32 v131, v131, v9
v_lshlrev_b32 v6, 16, v54
v_and_b32 v7, 0xffff0000, v54
v_add_f32 v132, v132, v6
v_add_f32 v133, v133, v7
v_lshlrev_b32 v8, 16, v55
v_and_b32 v9, 0xffff0000, v55
v_add_f32 v134, v134, v8
v_add_f32 v135, v135, v9
s_waitcnt vmcnt(20)
v_lshlrev_b32 v6, 16, v64
v_and_b32 v7, 0xffff0000, v64
v_add_f32 v128, v128, v6
v_add_f32 v129, v129, v7
v_lshlrev_b32 v8, 16, v65
v_and_b32 v9, 0xffff0000, v65
v_add_f32 v130, v130, v8
v_add_f32 v131, v131, v9
v_lshlrev_b32 v6, 16, v66
v_and_b32 v7, 0xffff0000, v66
v_add_f32 v132, v132, v6
v_add_f32 v133, v133, v7
v_lshlrev_b32 v8, 16, v67
v_and_b32 v9, 0xffff0000, v67
v_add_f32 v134, v134, v8
v_add_f32 v135, v135, v9
s_waitcnt vmcnt(19)
v_lshlrev_b32 v6, 16, v76
v_and_b32 v7, 0xffff0000, v76
v_add_f32 v128, v128, v6
v_add_f32 v129, v129, v7
v_lshlrev_b32 v8, 16, v77
v_and_b32 v9, 0xffff0000, v77
v_add_f32 v130, v130, v8
v_add_f32 v131, v131, v9
v_lshlrev_b32 v6, 16, v78
v_and_b32 v7, 0xffff0000, v78
v_add_f32 v132, v132, v6
v_add_f32 v133, v133, v7
v_lshlrev_b32 v8, 16, v79
v_and_b32 v9, 0xffff0000, v79
v_add_f32 v134, v134, v8
v_add_f32 v135, v135, v9
s_waitcnt vmcnt(18)
v_lshlrev_b32 v6, 16, v88
v_and_b32 v7, 0xffff0000, v88
v_add_f32 v128, v128, v6
v_add_f32 v129, v129, v7
v_lshlrev_b32 v8, 16, v89
v_and_b32 v9, 0xffff0000, v89
v_add_f32 v130, v130, v8
v_add_f32 v131, v131, v9
v_lshlrev_b32 v6, 16, v90
v_and_b32 v7, 0xffff0000, v90
v_add_f32 v132, v132, v6
v_add_f32 v133, v133, v7
v_lshlrev_b32 v8, 16, v91
v_and_b32 v9, 0xffff0000, v91
v_add_f32 v134, v134, v8
v_add_f32 v135, v135, v9
s_waitcnt vmcnt(17)
v_lshlrev_b32 v6, 16, v100
v_and_b32 v7, 0xffff0000, v100
v_add_f32 v128, v128, v6
v_add_f32 v129, v129, v7
v_lshlrev_b32 v8, 16, v101
v_and_b32 v9, 0xffff0000, v101
v_add_f32 v130, v130, v8
v_add_f32 v131, v131, v9
v_lshlrev_b32 v6, 16, v102
v_and_b32 v7, 0xffff0000, v102
v_add_f32 v132, v132, v6
v_add_f32 v133, v133, v7
v_lshlrev_b32 v8, 16, v103
v_and_b32 v9, 0xffff0000, v103
v_add_f32 v134, v134, v8
v_add_f32 v135, v135, v9
s_waitcnt vmcnt(16)
v_lshlrev_b32 v6, 16, v112
v_and_b32 v7, 0xffff0000, v112
v_add_f32 v128, v128, v6
v_add_f32 v129, v129, v7
v_lshlrev_b32 v8, 16, v113
v_and_b32 v9, 0xffff0000, v113
v_add_f32 v130, v130, v8
v_add_f32 v131, v131, v9
v_lshlrev_b32 v6, 16, v114
v_and_b32 v7, 0xffff0000, v114
v_add_f32 v132, v132, v6
v_add_f32 v133, v133, v7
v_lshlrev_b32 v8, 16, v115
v_and_b32 v9, 0xffff0000, v115
v_add_f32 v134, v134, v8
v_add_f32 v135, v135, v9
s_waitcnt vmcnt(15)
v_lshlrev_b32 v6, 16, v32
v_and_b32 v7, 0xffff0000, v32
v_add_f32 v136, v136, v6
v_add_f32 v137, v137, v7
v_lshlrev_b32 v8, 16, v33
v_and_b32 v9, 0xffff0000, v33
v_add_f32 v138, v138, v8
v_add_f32 v139, v139, v9
v_lshlrev_b32 v6, 16, v34
v_and_b32 v7, 0xffff0000, v34
v_add_f32 v140, v140, v6
v_add_f32 v141, v141, v7
v_lshlrev_b32 v8, 16, v35
v_and_b32 v9, 0xffff0000, v35
v_add_f32 v142, v142, v8
v_add_f32 v143, v143, v9
s_waitcnt vmcnt(14)
v_lshlrev_b32 v6, 16, v36
v_and_b32 v7, 0xffff0000, v36
v_add_f32 v144, v144, v6
v_add_f32 v145, v145, v7
v_lshlrev_b32 v8, 16, v37
v_and_b32 v9, 0xffff0000, v37
v_add_f32 v146, v146, v8
v_add_f32 v147, v147, v9
v_lshlrev_b32 v6, 16, v38
v_and_b32 v7, 0xffff0000, v38
v_add_f32 v148, v148, v6
v_add_f32 v149, v149, v7
v_lshlrev_b32 v8, 16, v39
v_and_b32 v9, 0xffff0000, v39
v_add_f32 v150, v150, v8
v_add_f32 v151, v151, v9
s_waitcnt vmcnt(13)
v_lshlrev_b32 v6, 16, v44
v_and_b32 v7, 0xffff0000, v44
v_add_f32 v136, v136, v6
v_add_f32 v137, v137, v7
v_lshlrev_b32 v8, 16, v45
v_and_b32 v9, 0xffff0000, v45
v_add_f32 v138, v138, v8
v_add_f32 v139, v139, v9
v_lshlrev_b32 v6, 16, v46
v_and_b32 v7, 0xffff0000, v46
v_add_f32 v140, v140, v6
v_add_f32 v141, v141, v7
v_lshlrev_b32 v8, 16, v47
v_and_b32 v9, 0xffff0000, v47
v_add_f32 v142, v142, v8
v_add_f32 v143, v143, v9
s_waitcnt vmcnt(12)
v_lshlrev_b32 v6, 16, v48
v_and_b32 v7, 0xffff0000, v48
v_add_f32 v144, v144, v6
v_add_f32 v145, v145, v7
v_lshlrev_b32 v8, 16, v49
v_and_b32 v9, 0xffff0000, v49
v_add_f32 v146, v146, v8
v_add_f32 v147, v147, v9
v_lshlrev_b32 v6, 16, v50
v_and_b32 v7, 0xffff0000, v50
v_add_f32 v148, v148, v6
v_add_f32 v149, v149, v7
v_lshlrev_b32 v8, 16, v51
v_and_b32 v9, 0xffff0000, v51
v_add_f32 v150, v150, v8
v_add_f32 v151, v151, v9
s_waitcnt vmcnt(11)
v_lshlrev_b32 v6, 16, v56
v_and_b32 v7, 0xffff0000, v56
v_add_f32 v136, v136, v6
v_add_f32 v137, v137, v7
v_lshlrev_b32 v8, 16, v57
v_and_b32 v9, 0xffff0000, v57
v_add_f32 v138, v138, v8
v_add_f32 v139, v139, v9
v_lshlrev_b32 v6, 16, v58
v_and_b32 v7, 0xffff0000, v58
v_add_f32 v140, v140, v6
v_add_f32 v141, v141, v7
v_lshlrev_b32 v8, 16, v59
v_and_b32 v9, 0xffff0000, v59
v_add_f32 v142, v142, v8
v_add_f32 v143, v143, v9
s_waitcnt vmcnt(10)
v_lshlrev_b32 v6, 16, v60
v_and_b32 v7, 0xffff0000, v60
v_add_f32 v144, v144, v6
v_add_f32 v145, v145, v7
v_lshlrev_b32 v8, 16, v61
v_and_b32 v9, 0xffff0000, v61
v_add_f32 v146, v146, v8
v_add_f32 v147, v147, v9
v_lshlrev_b32 v6, 16, v62
v_and_b32 v7, 0xffff0000, v62
v_add_f32 v148, v148, v6
v_add_f32 v149, v149, v7
v_lshlrev_b32 v8, 16, v63
v_and_b32 v9, 0xffff0000, v63
v_add_f32 v150, v150, v8
v_add_f32 v151, v151, v9
s_waitcnt vmcnt(9)
v_lshlrev_b32 v6, 16, v68
v_and_b32 v7, 0xffff0000, v68
v_add_f32 v136, v136, v6
v_add_f32 v137, v137, v7
v_lshlrev_b32 v8, 16, v69
v_and_b32 v9, 0xffff0000, v69
v_add_f32 v138, v138, v8
v_add_f32 v139, v139, v9
v_lshlrev_b32 v6, 16, v70
v_and_b32 v7, 0xffff0000, v70
v_add_f32 v140, v140, v6
v_add_f32 v141, v141, v7
v_lshlrev_b32 v8, 16, v71
v_and_b32 v9, 0xffff0000, v71
v_add_f32 v142, v142, v8
v_add_f32 v143, v143, v9
s_waitcnt vmcnt(8)
v_lshlrev_b32 v6, 16, v72
v_and_b32 v7, 0xffff0000, v72
v_add_f32 v144, v144, v6
v_add_f32 v145, v145, v7
v_lshlrev_b32 v8, 16, v73
v_and_b32 v9, 0xffff0000, v73
v_add_f32 v146, v146, v8
v_add_f32 v147, v147, v9
v_lshlrev_b32 v6, 16, v74
v_and_b32 v7, 0xffff0000, v74
v_add_f32 v148, v148, v6
v_add_f32 v149, v149, v7
v_lshlrev_b32 v8, 16, v75
v_and_b32 v9, 0xffff0000, v75
v_add_f32 v150, v150, v8
v_add_f32 v151, v151, v9
s_waitcnt vmcnt(7)
v_lshlrev_b32 v6, 16, v80
v_and_b32 v7, 0xffff0000, v80
v_add_f32 v136, v136, v6
v_add_f32 v137, v137, v7
v_lshlrev_b32 v8, 16, v81
v_and_b32 v9, 0xffff0000, v81
v_add_f32 v138, v138, v8
v_add_f32 v139, v139, v9
v_lshlrev_b32 v6, 16, v82
v_and_b32 v7, 0xffff0000, v82
v_add_f32 v140, v140, v6
v_add_f32 v141, v141, v7
v_lshlrev_b32 v8, 16, v83
v_and_b32 v9, 0xffff0000, v83
v_add_f32 v142, v142, v8
v_add_f32 v143, v143, v9
s_waitcnt vmcnt(6)
v_lshlrev_b32 v6, 16, v84
v_and_b32 v7, 0xffff0000, v84
v_add_f32 v144, v144, v6
v_add_f32 v145, v145, v7
v_lshlrev_b32 v8, 16, v85
v_and_b32 v9, 0xffff0000, v85
v_add_f32 v146, v146, v8
v_add_f32 v147, v147, v9
v_lshlrev_b32 v6, 16, v86
v_and_b32 v7, 0xffff0000, v86
v_add_f32 v148, v148, v6
v_add_f32 v149, v149, v7
v_lshlrev_b32 v8, 16, v87
v_and_b32 v9, 0xffff0000, v87
v_add_f32 v150, v150, v8
v_add_f32 v151, v151, v9
s_waitcnt vmcnt(5)
v_lshlrev_b32 v6, 16, v92
v_and_b32 v7, 0xffff0000, v92
v_add_f32 v136, v136, v6
v_add_f32 v137, v137, v7
v_lshlrev_b32 v8, 16, v93
v_and_b32 v9, 0xffff0000, v93
v_add_f32 v138, v138, v8
v_add_f32 v139, v139, v9
v_lshlrev_b32 v6, 16, v94
v_and_b32 v7, 0xffff0000, v94
v_add_f32 v140, v140, v6
v_add_f32 v141, v141, v7
v_lshlrev_b32 v8, 16, v95
v_and_b32 v9, 0xffff0000, v95
v_add_f32 v142, v142, v8
v_add_f32 v143, v143, v9
s_waitcnt vmcnt(4)
v_lshlrev_b32 v6, 16, v96
v_and_b32 v7, 0xffff0000, v96
v_add_f32 v144, v144, v6
v_add_f32 v145, v145, v7
v_lshlrev_b32 v8, 16, v97
v_and_b32 v9, 0xffff0000, v97
v_add_f32 v146, v146, v8
v_add_f32 v147, v147, v9
v_lshlrev_b32 v6, 16, v98
v_and_b32 v7, 0xffff0000, v98
v_add_f32 v148, v148, v6
v_add_f32 v149, v149, v7
v_lshlrev_b32 v8, 16, v99
v_and_b32 v9, 0xffff0000, v99
v_add_f32 v150, v150, v8
v_add_f32 v151, v151, v9
s_waitcnt vmcnt(3)
v_lshlrev_b32 v6, 16, v104
v_and_b32 v7, 0xffff0000, v104
v_add_f32 v136, v136, v6
v_add_f32 v137, v137, v7
v_lshlrev_b32 v8, 16, v105
v_and_b32 v9, 0xffff0000, v105
v_add_f32 v138, v138, v8
v_add_f32 v139, v139, v9
v_lshlrev_b32 v6, 16, v106
v_and_b32 v7, 0xffff0000, v106
v_add_f32 v140, v140, v6
v_add_f32 v141, v141, v7
v_lshlrev_b32 v8, 16, v107
v_and_b32 v9, 0xffff0000, v107
v_add_f32 v142, v142, v8
v_add_f32 v143, v143, v9
s_waitcnt vmcnt(2)
v_lshlrev_b32 v6, 16, v108
v_and_b32 v7, 0xffff0000, v108
v_add_f32 v144, v144, v6
v_add_f32 v145, v145, v7
v_lshlrev_b32 v8, 16, v109
v_and_b32 v9, 0xffff0000, v109
v_add_f32 v146, v146, v8
v_add_f32 v147, v147, v9
v_lshlrev_b32 v6, 16, v110
v_and_b32 v7, 0xffff0000, v110
v_add_f32 v148, v148, v6
v_add_f32 v149, v149, v7
v_lshlrev_b32 v8, 16, v111
v_and_b32 v9, 0xffff0000, v111
v_add_f32 v150, v150, v8
v_add_f32 v151, v151, v9
s_waitcnt vmcnt(1)
v_lshlrev_b32 v6, 16, v116
v_and_b32 v7, 0xffff0000, v116
v_add_f32 v136, v136, v6
v_add_f32 v137, v137, v7
v_lshlrev_b32 v8, 16, v117
v_and_b32 v9, 0xffff0000, v117
v_add_f32 v138, v138, v8
v_add_f32 v139, v139, v9
v_lshlrev_b32 v6, 16, v118
v_and_b32 v7, 0xffff0000, v118
v_add_f32 v140, v140, v6
v_add_f32 v141, v141, v7
v_lshlrev_b32 v8, 16, v119
v_and_b32 v9, 0xffff0000, v119
v_add_f32 v142, v142, v8
v_add_f32 v143, v143, v9
s_waitcnt vmcnt(0)
v_lshlrev_b32 v6, 16, v120
v_and_b32 v7, 0xffff0000, v120
v_add_f32 v144, v144, v6
v_add_f32 v145, v145, v7
v_lshlrev_b32 v8, 16, v121
v_and_b32 v9, 0xffff0000, v121
v_add_f32 v146, v146, v8
v_add_f32 v147, v147, v9
v_lshlrev_b32 v6, 16, v122
v_and_b32 v7, 0xffff0000, v122
v_add_f32 v148, v148, v6
v_add_f32 v149, v149, v7
v_lshlrev_b32 v8, 16, v123
v_and_b32 v9, 0xffff0000, v123
v_add_f32 v150, v150, v8
v_add_f32 v151, v151, v9
v_cvt_pk_bf16_f32 v152, v128, v129
v_cvt_pk_bf16_f32 v153, v130, v131
v_cvt_pk_bf16_f32 v154, v132, v133
v_cvt_pk_bf16_f32 v155, v134, v135
v_cvt_pk_bf16_f32 v156, v136, v137
v_cvt_pk_bf16_f32 v157, v138, v139
v_cvt_pk_bf16_f32 v158, v140, v141
v_cvt_pk_bf16_f32 v159, v142, v143
v_cvt_pk_bf16_f32 v160, v144, v145
v_cvt_pk_bf16_f32 v161, v146, v147
v_cvt_pk_bf16_f32 v162, v148, v149
v_cvt_pk_bf16_f32 v163, v150, v151
v_add_f32 v6, v128, v129
v_mul_f32 v7, v128, v128
v_mul_f32 v9, v129, v129
v_mov_b32 v8, 0
v_add_f32 v6, v6, v130
v_add_f32 v8, v8, v131
v_fmac_f32 v7, v130, v130
v_fmac_f32 v9, v131, v131
v_add_f32 v6, v6, v132
v_add_f32 v8, v8, v133
v_fmac_f32 v7, v132, v132
v_fmac_f32 v9, v133, v133
v_add_f32 v6, v6, v134
v_add_f32 v8, v8, v135
v_fmac_f32 v7, v134, v134
v_fmac_f32 v9, v135, v135
v_add_f32 v6, v6, v136
v_add_f32 v8, v8, v137
v_fmac_f32 v7, v136, v136
v_fmac_f32 v9, v137, v137
v_add_f32 v6, v6, v138
v_add_f32 v8, v8, v139
v_fmac_f32 v7, v138, v138
v_fmac_f32 v9, v139, v139
v_add_f32 v6, v6, v140
v_add_f32 v8, v8, v141
v_fmac_f32 v7, v140, v140
v_fmac_f32 v9, v141, v141
v_add_f32 v6, v6, v142
v_add_f32 v8, v8, v143
v_fmac_f32 v7, v142, v142
v_fmac_f32 v9, v143, v143
v_add_f32 v6, v6, v144
v_add_f32 v8, v8, v145
v_fmac_f32 v7, v144, v144
v_fmac_f32 v9, v145, v145
v_add_f32 v6, v6, v146
v_add_f32 v8, v8, v147
v_fmac_f32 v7, v146, v146
v_fmac_f32 v9, v147, v147
v_add_f32 v6, v6, v148
v_add_f32 v8, v8, v149
v_fmac_f32 v7, v148, v148
v_fmac_f32 v9, v149, v149
v_add_f32 v6, v6, v150
v_add_f32 v8, v8, v151
v_fmac_f32 v7, v150, v150
v_fmac_f32 v9, v151, v151
v_add_f32 v6, v6, v8
v_add_f32 v7, v7, v9
s_nop 0
v_add_f32_dpp v6, v6, v6 row_ror:8 row_mask:0xf bank_mask:0xf
v_add_f32_dpp v7, v7, v7 row_ror:8 row_mask:0xf bank_mask:0xf
v_mov_b32 v8, v6
v_mov_b32 v9, v7
s_nop 0
v_permlane16_swap_b32 v6, v8
v_permlane16_swap_b32 v7, v9
v_add_f32 v6, v6, v8
v_add_f32 v7, v7, v9
v_mov_b32 v8, v6
v_mov_b32 v9, v7
s_nop 0
v_permlane32_swap_b32 v6, v8
v_permlane32_swap_b32 v7, v9
v_add_f32 v6, v6, v8
v_add_f32 v7, v7, v9
v_and_b32 v10, 7, v1
v_lshlrev_b32 v10, 3, v10
v_add_u32 v10, 147456, v10
s_lshl_b32 s24, s4, 6
v_add_u32 v11, s24, v10
ds_write_b64 v11, v[6:7]
s_add_u32 s24, s28, 30048256
buffer_store_dwordx4 v[152:155], v4, s[8:11], s24 offen sc1
s_add_u32 s25, s29, 30048256
buffer_store_dwordx4 v[156:159], v4, s[8:11], s25 offen sc1
s_add_u32 s24, s30, 30048256
buffer_store_dwordx4 v[160:163], v4, s[8:11], s24 offen sc1
s_waitcnt lgkmcnt(0)
s_barrier
ds_read_b64 v[6:7], v10
ds_read_b64 v[8:9], v10 offset:64
ds_read_b64 v[12:13], v10 offset:128
s_waitcnt lgkmcnt(0)
v_add_f32 v6, v6, v8
v_add_f32 v7, v7, v9
v_add_f32 v6, v6, v12
v_add_f32 v7, v7, v13
v_mul_f32 v6, 0x3ae38e39, v6
v_mul_f32 v7, 0x3ae38e39, v7
v_fma_f32 v7, -v6, v6, v7
v_max_f32 v7, 0, v7
v_add_f32 v7, 0x3727c5ac, v7
v_rsq_f32 v7, v7
s_nop 0
v_mul_f32 v6, v6, v7
v_fma_f32 v128, v128, v7, -v6
v_fma_f32 v129, v129, v7, -v6
v_fma_f32 v130, v130, v7, -v6
v_fma_f32 v131, v131, v7, -v6
v_fma_f32 v132, v132, v7, -v6
v_fma_f32 v133, v133, v7, -v6
v_fma_f32 v134, v134, v7, -v6
v_fma_f32 v135, v135, v7, -v6
v_cvt_pk_bf16_f32 v168, v128, v129
v_cvt_pk_bf16_f32 v169, v130, v131
v_cvt_pk_bf16_f32 v170, v132, v133
v_cvt_pk_bf16_f32 v171, v134, v135
s_add_u32 s24, s28, 25329664
buffer_store_dwordx4 v[168:171], v4, s[8:11], s24 offen sc1
v_fma_f32 v136, v136, v7, -v6
v_fma_f32 v137, v137, v7, -v6
v_fma_f32 v138, v138, v7, -v6
v_fma_f32 v139, v139, v7, -v6
v_fma_f32 v140, v140, v7, -v6
v_fma_f32 v141, v141, v7, -v6
v_fma_f32 v142, v142, v7, -v6
v_fma_f32 v143, v143, v7, -v6
v_cvt_pk_bf16_f32 v172, v136, v137
v_cvt_pk_bf16_f32 v173, v138, v139
v_cvt_pk_bf16_f32 v174, v140, v141
v_cvt_pk_bf16_f32 v175, v142, v143
s_add_u32 s25, s29, 25329664
buffer_store_dwordx4 v[172:175], v4, s[8:11], s25 offen sc1
v_fma_f32 v144, v144, v7, -v6
v_fma_f32 v145, v145, v7, -v6
v_fma_f32 v146, v146, v7, -v6
v_fma_f32 v147, v147, v7, -v6
v_fma_f32 v148, v148, v7, -v6
v_fma_f32 v149, v149, v7, -v6
v_fma_f32 v150, v150, v7, -v6
v_fma_f32 v151, v151, v7, -v6
v_cvt_pk_bf16_f32 v176, v144, v145
v_cvt_pk_bf16_f32 v177, v146, v147
v_cvt_pk_bf16_f32 v178, v148, v149
v_cvt_pk_bf16_f32 v179, v150, v151
s_add_u32 s24, s30, 25329664
buffer_store_dwordx4 v[176:179], v4, s[8:11], s24 offen sc1
s_lshl_b32 s24, s5, 5
s_add_u32 s24, s24, s6
s_lshl_b32 s14, s24, 7
s_add_u32 s14, s14, 1835008
s_branch L_r_done
L_r_side:
v_mov_b32 v13, 2146435072
v_cmp_gt_u32 vcc, 16, v0
v_lshlrev_b32 v14, 3, v0
s_nop 0
v_cndmask_b32 v13, v13, v14, vcc
v_mov_b32 v14, s68
v_mov_b32 v15, s69
s_waitcnt vmcnt(0)
s_barrier
buffer_store_dwordx2 v[14:15], v13, s[8:11], s14 offen sc1
s_lshr_b32 s20, s5, 2
s_lshl_b32 s20, s20, 3
s_lshr_b32 s21, s6, 2
s_add_u32 s20, s20, s21
s_and_b32 s21, s5, 3
s_lshl_b32 s21, s21, 2
s_and_b32 s22, s6, 3
s_add_u32 s21, s21, s22
s_mul_i32 s32, s21, 129024
s_add_u32 s32, s32, 4198400
s_mul_i32 s33, s4, 0
s_add_u32 s32, s32, s33
s_add_u32 m0, s33, 0
s_add_u32 s40, s32, 0
buffer_load_dwordx4 v2, s[8:11], s40 offen offset:0 sc1 lds
buffer_load_dwordx4 v2, s[8:11], s40 offen offset:1024 sc1 lds
buffer_load_dwordx4 v2, s[8:11], s40 offen offset:2048 sc1 lds
buffer_load_dwordx4 v2, s[8:11], s40 offen offset:3072 sc1 lds
s_add_u32 m0, s33, 4096
s_add_u32 s40, s32, 4096
buffer_load_dwordx4 v2, s[8:11], s40 offen offset:0 sc1 lds
buffer_load_dwordx4 v2, s[8:11], s40 offen offset:1024 sc1 lds
buffer_load_dwordx4 v2, s[8:11], s40 offen offset:2048 sc1 lds
buffer_load_dwordx4 v2, s[8:11], s40 offen offset:3072 sc1 lds
s_add_u32 m0, s33, 8192
s_add_u32 s40, s32, 8192
buffer_load_dwordx4 v2, s[8:11], s40 offen offset:0 sc1 lds
buffer_load_dwordx4 v2, s[8:11], s40 offen offset:1024 sc1 lds
buffer_load_dwordx4 v2, s[8:11], s40 offen offset:2048 sc1 lds
buffer_load_dwordx4 v2, s[8:11], s40 offen offset:3072 sc1 lds
s_add_u32 m0, s33, 12288
s_add_u32 s40, s32, 12288
buffer_load_dwordx4 v2, s[8:11], s40 offen offset:0 sc1 lds
buffer_load_dwordx4 v2, s[8:11], s40 offen offset:1024 sc1 lds
buffer_load_dwordx4 v2, s[8:11], s40 offen offset:2048 sc1 lds
buffer_load_dwordx4 v2, s[8:11], s40 offen offset:3072 sc1 lds
s_add_u32 m0, s33, 16384
s_add_u32 s40, s32, 16384
buffer_load_dwordx4 v2, s[8:11], s40 offen offset:0 sc1 lds
buffer_load_dwordx4 v2, s[8:11], s40 offen offset:1024 sc1 lds
buffer_load_dwordx4 v2, s[8:11], s40 offen offset:2048 sc1 lds
buffer_load_dwordx4 v2, s[8:11], s40 offen offset:3072 sc1 lds
s_add_u32 m0, s33, 20480
s_add_u32 s40, s32, 20480
buffer_load_dwordx4 v2, s[8:11], s40 offen offset:0 sc1 lds
buffer_load_dwordx4 v2, s[8:11], s40 offen offset:1024 sc1 lds
buffer_load_dwordx4 v2, s[8:11], s40 offen offset:2048 sc1 lds
buffer_load_dwordx4 v2, s[8:11], s40 offen offset:3072 sc1 lds
s_add_u32 m0, s33, 24576
s_add_u32 s40, s32, 24576
buffer_load_dwordx4 v2, s[8:11], s40 offen offset:0 sc1 lds
buffer_load_dwordx4 v2, s[8:11], s40 offen offset:1024 sc1 lds
buffer_load_dwordx4 v2, s[8:11], s40 offen offset:2048 sc1 lds
buffer_load_dwordx4 v2, s[8:11], s40 offen offset:3072 sc1 lds
s_add_u32 m0, s33, 28672
s_add_u32 s40, s32, 28672
buffer_load_dwordx4 v2, s[8:11], s40 offen offset:0 sc1 lds
buffer_load_dwordx4 v2, s[8:11], s40 offen offset:1024 sc1 lds
buffer_load_dwordx4 v2, s[8:11], s40 offen offset:2048 sc1 lds
buffer_load_dwordx4 v2, s[8:11], s40 offen offset:3072 sc1 lds
s_add_u32 m0, s33, 32768
s_add_u32 s40, s32, 32768
buffer_load_dwordx4 v2, s[8:11], s40 offen offset:0 sc1 lds
buffer_load_dwordx4 v2, s[8:11], s40 offen offset:1024 sc1 lds
buffer_load_dwordx4 v2, s[8:11], s40 offen offset:2048 sc1 lds
buffer_load_dwordx4 v2, s[8:11], s40 offen offset:3072 sc1 lds
s_add_u32 m0, s33, 36864
s_add_u32 s40, s32, 36864
buffer_load_dwordx4 v2, s[8:11], s40 offen offset:0 sc1 lds
buffer_load_dwordx4 v2, s[8:11], s40 offen offset:1024 sc1 lds
buffer_load_dwordx4 v2, s[8:11], s40 offen offset:2048 sc1 lds
buffer_load_dwordx4 v2, s[8:11], s40 offen offset:3072 sc1 lds
s_add_u32 m0, s33, 40960
s_add_u32 s40, s32, 40960
buffer_load_dwordx4 v2, s[8:11], s40 offen offset:0 sc1 lds
buffer_load_dwordx4 v2, s[8:11], s40 offen offset:1024 sc1 lds
buffer_load_dwordx4 v2, s[8:11], s40 offen offset:2048 sc1 lds
buffer_load_dwordx4 v2, s[8:11], s40 offen offset:3072 sc1 lds
s_add_u32 m0, s33, 45056
s_add_u32 s40, s32, 45056
buffer_load_dwordx4 v2, s[8:11], s40 offen offset:0 sc1 lds
buffer_load_dwordx4 v2, s[8:11], s40 offen offset:1024 sc1 lds
buffer_load_dwordx4 v2, s[8:11], s40 offen offset:2048 sc1 lds
buffer_load_dwordx4 v2, s[8:11], s40 offen offset:3072 sc1 lds
s_add_u32 m0, s33, 49152
s_add_u32 s40, s32, 49152
buffer_load_dwordx4 v2, s[8:11], s40 offen offset:0 sc1 lds
buffer_load_dwordx4 v2, s[8:11], s40 offen offset:1024 sc1 lds
buffer_load_dwordx4 v2, s[8:11], s40 offen offset:2048 sc1 lds
buffer_load_dwordx4 v2, s[8:11], s40 offen offset:3072 sc1 lds
s_add_u32 m0, s33, 53248
s_add_u32 s40, s32, 53248
buffer_load_dwordx4 v2, s[8:11], s40 offen offset:0 sc1 lds
buffer_load_dwordx4 v2, s[8:11], s40 offen offset:1024 sc1 lds
buffer_load_dwordx4 v2, s[8:11], s40 offen offset:2048 sc1 lds
buffer_load_dwordx4 v2, s[8:11], s40 offen offset:3072 sc1 lds
s_add_u32 m0, s33, 57344
s_add_u32 s40, s32, 57344
buffer_load_dwordx4 v2, s[8:11], s40 offen offset:0 sc1 lds
buffer_load_dwordx4 v2, s[8:11], s40 offen offset:1024 sc1 lds
buffer_load_dwordx4 v2, s[8:11], s40 offen offset:2048 sc1 lds
buffer_load_dwordx4 v2, s[8:11], s40 offen offset:3072 sc1 lds
s_add_u32 m0, s33, 61440
s_add_u32 s40, s32, 61440
buffer_load_dwordx4 v2, s[8:11], s40 offen offset:0 sc1 lds
buffer_load_dwordx4 v2, s[8:11], s40 offen offset:1024 sc1 lds
buffer_load_dwordx4 v2, s[8:11], s40 offen offset:2048 sc1 lds
buffer_load_dwordx4 v2, s[8:11], s40 offen offset:3072 sc1 lds
s_add_u32 m0, s33, 65536
s_add_u32 s40, s32, 65536
buffer_load_dwordx4 v2, s[8:11], s40 offen offset:0 sc1 lds
buffer_load_dwordx4 v2, s[8:11], s40 offen offset:1024 sc1 lds
buffer_load_dwordx4 v2, s[8:11], s40 offen offset:2048 sc1 lds
buffer_load_dwordx4 v2, s[8:11], s40 offen offset:3072 sc1 lds
s_add_u32 m0, s33, 69632
s_add_u32 s40, s32, 69632
buffer_load_dwordx4 v2, s[8:11], s40 offen offset:0 sc1 lds
buffer_load_dwordx4 v2, s[8:11], s40 offen offset:1024 sc1 lds
buffer_load_dwordx4 v2, s[8:11], s40 offen offset:2048 sc1 lds
buffer_load_dwordx4 v2, s[8:11], s40 offen offset:3072 sc1 lds
s_add_u32 m0, s33, 73728
s_add_u32 s40, s32, 73728
buffer_load_dwordx4 v2, s[8:11], s40 offen offset:0 sc1 lds
buffer_load_dwordx4 v2, s[8:11], s40 offen offset:1024 sc1 lds
buffer_load_dwordx4 v2, s[8:11], s40 offen offset:2048 sc1 lds
buffer_load_dwordx4 v2, s[8:11], s40 offen offset:3072 sc1 lds
s_add_u32 m0, s33, 77824
s_add_u32 s40, s32, 77824
buffer_load_dwordx4 v2, s[8:11], s40 offen offset:0 sc1 lds
buffer_load_dwordx4 v2, s[8:11], s40 offen offset:1024 sc1 lds
buffer_load_dwordx4 v2, s[8:11], s40 offen offset:2048 sc1 lds
buffer_load_dwordx4 v2, s[8:11], s40 offen offset:3072 sc1 lds
s_add_u32 m0, s33, 81920
s_add_u32 s40, s32, 81920
buffer_load_dwordx4 v2, s[8:11], s40 offen offset:0 sc1 lds
buffer_load_dwordx4 v2, s[8:11], s40 offen offset:1024 sc1 lds
buffer_load_dwordx4 v2, s[8:11], s40 offen offset:2048 sc1 lds
buffer_load_dwordx4 v2, s[8:11], s40 offen offset:3072 sc1 lds
s_add_u32 m0, s33, 86016
s_add_u32 s40, s32, 86016
buffer_load_dwordx4 v2, s[8:11], s40 offen offset:0 sc1 lds
buffer_load_dwordx4 v2, s[8:11], s40 offen offset:1024 sc1 lds
buffer_load_dwordx4 v2, s[8:11], s40 offen offset:2048 sc1 lds
buffer_load_dwordx4 v2, s[8:11], s40 offen offset:3072 sc1 lds
s_add_u32 m0, s33, 90112
s_add_u32 s40, s32, 90112
buffer_load_dwordx4 v2, s[8:11], s40 offen offset:0 sc1 lds
buffer_load_dwordx4 v2, s[8:11], s40 offen offset:1024 sc1 lds
buffer_load_dwordx4 v2, s[8:11], s40 offen offset:2048 sc1 lds
buffer_load_dwordx4 v2, s[8:11], s40 offen offset:3072 sc1 lds
s_add_u32 m0, s33, 94208
s_add_u32 s40, s32, 94208
buffer_load_dwordx4 v2, s[8:11], s40 offen offset:0 sc1 lds
buffer_load_dwordx4 v2, s[8:11], s40 offen offset:1024 sc1 lds
buffer_load_dwordx4 v2, s[8:11], s40 offen offset:2048 sc1 lds
buffer_load_dwordx4 v2, s[8:11], s40 offen offset:3072 sc1 lds
s_add_u32 m0, s33, 98304
s_add_u32 s40, s32, 98304
buffer_load_dwordx4 v2, s[8:11], s40 offen offset:0 sc1 lds
buffer_load_dwordx4 v2, s[8:11], s40 offen offset:1024 sc1 lds
buffer_load_dwordx4 v2, s[8:11], s40 offen offset:2048 sc1 lds
buffer_load_dwordx4 v2, s[8:11], s40 offen offset:3072 sc1 lds
s_add_u32 m0, s33, 102400
s_add_u32 s40, s32, 102400
buffer_load_dwordx4 v2, s[8:11], s40 offen offset:0 sc1 lds
buffer_load_dwordx4 v2, s[8:11], s40 offen offset:1024 sc1 lds
buffer_load_dwordx4 v2, s[8:11], s40 offen offset:2048 sc1 lds
buffer_load_dwordx4 v2, s[8:11], s40 offen offset:3072 sc1 lds
s_add_u32 m0, s33, 106496
s_add_u32 s40, s32, 106496
buffer_load_dwordx4 v2, s[8:11], s40 offen offset:0 sc1 lds
buffer_load_dwordx4 v2, s[8:11], s40 offen offset:1024 sc1 lds
buffer_load_dwordx4 v2, s[8:11], s40 offen offset:2048 sc1 lds
buffer_load_dwordx4 v2, s[8:11], s40 offen offset:3072 sc1 lds
s_add_u32 m0, s33, 110592
s_add_u32 s40, s32, 110592
buffer_load_dwordx4 v2, s[8:11], s40 offen offset:0 sc1 lds
buffer_load_dwordx4 v2, s[8:11], s40 offen offset:1024 sc1 lds
buffer_load_dwordx4 v2, s[8:11], s40 offen offset:2048 sc1 lds
buffer_load_dwordx4 v2, s[8:11], s40 offen offset:3072 sc1 lds
s_add_u32 m0, s33, 114688
s_add_u32 s40, s32, 114688
buffer_load_dwordx4 v2, s[8:11], s40 offen offset:0 sc1 lds
buffer_load_dwordx4 v2, s[8:11], s40 offen offset:1024 sc1 lds
buffer_load_dwordx4 v2, s[8:11], s40 offen offset:2048 sc1 lds
buffer_load_dwordx4 v2, s[8:11], s40 offen offset:3072 sc1 lds
s_add_u32 m0, s33, 118784
s_add_u32 s40, s32, 118784
buffer_load_dwordx4 v2, s[8:11], s40 offen offset:0 sc1 lds
buffer_load_dwordx4 v2, s[8:11], s40 offen offset:1024 sc1 lds
buffer_load_dwordx4 v2, s[8:11], s40 offen offset:2048 sc1 lds
buffer_load_dwordx4 v2, s[8:11], s40 offen offset:3072 sc1 lds
s_add_u32 m0, s33, 122880
s_add_u32 s40, s32, 122880
buffer_load_dwordx4 v2, s[8:11], s40 offen offset:0 sc1 lds
buffer_load_dwordx4 v2, s[8:11], s40 offen offset:1024 sc1 lds
buffer_load_dwordx4 v2, s[8:11], s40 offen offset:2048 sc1 lds
buffer_load_dwordx4 v2, s[8:11], s40 offen offset:3072 sc1 lds
s_add_u32 m0, s33, 126976
s_add_u32 s40, s32, 126976
buffer_load_dwordx4 v2, s[8:11], s40 offen offset:0 sc1 lds
buffer_load_dwordx4 v2, s[8:11], s40 offen offset:1024 sc1 lds
s_barrier
L_r_done:
s_mov_b32 s70, 25329664
s_mov_b32 s71, 30048256
s_mov_b32 s72, 34766848
s_mov_b32 s73, 39485440
s_mov_b32 s74, 41975808
s_mov_b32 s75, 60981248
s_mov_b32 s76, 98729984
s_mov_b32 s77, 1048576
s_mov_b32 s7, 1
s_lshr_b32 s20, s5, 2
s_lshl_b32 s20, s20, 3
s_lshr_b32 s21, s6, 2
s_add_u32 s20, s20, s21
s_and_b32 s21, s5, 3
s_lshl_b32 s21, s21, 2
s_and_b32 s22, s6, 3
s_add_u32 s21, s21, s22
s_lshl_b32 s24, s20, 3
s_sub_u32 s25, s24, 1
s_max_i32 s35, s25, 0
s_mul_i32 s25, s35, 18432
s_lshl_b32 s26, s4, 1
s_add_u32 s36, s24, s26
s_mul_i32 s24, s36, 18432
s_add_u32 s26, s24, s70
s_add_u32 s27, s26, 18432
s_add_u32 s28, s25, s70
v_add_u32 v4, 0x10000, v2
v_add_u32 v5, 0x20000, v2
s_cmp_eq_u32 s4, 3
s_cselect_b32 s29, 0, s4
s_cselect_b32 s31, 16, 9
s_lshl_b32 s30, s29, 10
v_and_b32 v12, 15, v1
v_mov_b32 v13, 2146435072
v_cmp_le_u32 vcc, s31, v12
s_nop 1
v_cndmask_b32 v3, v13, v2, vcc
s_add_u32 s31, s30, 2048
v_add_u32 v6, s31, v2
v_add_u32 v7, s31, v4
v_add_u32 v8, s31, v5
s_and_b32 s30, s30, 1024
s_add_u32 s31, s30, 5120
v_add_u32 v9, s31, v2
v_add_u32 v10, s31, v4
v_add_u32 v11, s31, v5
s_lshl_b32 s22, s36, 1
s_lshl_b32 s23, s35, 1
s_add_u32 s23, s23, 1
v_and_b32 v16, 3, v1
v_add_u32 v16, s22, v16
v_mov_b32 v17, s23
v_cmp_eq_u32 vcc, 4, v1
s_nop 1
v_cndmask_b32 v16, v16, v17, vcc
v_lshlrev_b32 v16, 7, v16
s_add_u32 s22, s77, 786432
v_mov_b32 v13, 2146435072
v_cmp_gt_u32 vcc, 16, v0
v_lshlrev_b32 v14, 3, v0
s_nop 0
v_cndmask_b32 v13, v13, v14, vcc
v_mov_b32 v14, s68
v_mov_b32 v15, s69
s_waitcnt vmcnt(0)
s_barrier
buffer_store_dwordx2 v[14:15], v13, s[8:11], s14 offen sc1
s_mov_b32 s52, 0
L_poll7:
buffer_load_dwordx2 v[14:15], v16, s[8:11], s22 offen sc1
s_add_u32 s52, s52, 1
s_waitcnt vmcnt(0)
v_cmp_ne_u64 vcc, s[68:69], v[14:15]
s_cmp_ge_u32 s52, 1048576
s_cbranch_scc1 L_got7
s_and_b64 exec, exec, vcc
s_cbranch_execnz L_poll7
L_got7:
s_mov_b64 exec, -1
buffer_load_dwordx4 a[0:3], v2, s[8:11], s26 offen offset:0 sc1
buffer_load_dwordx4 a[72:75], v2, s[8:11], s27 offen offset:0 sc1
buffer_load_dwordx4 a[144:147], v3, s[8:11], s28 offen offset:0 sc1
buffer_load_dwordx4 a[4:7], v2, s[8:11], s26 offen offset:1024 sc1
buffer_load_dwordx4 a[76:79], v2, s[8:11], s27 offen offset:1024 sc1
buffer_load_dwordx4 a[148:151], v3, s[8:11], s28 offen offset:1024 sc1
buffer_load_dwordx4 a[8:11], v2, s[8:11], s26 offen offset:2048 sc1
buffer_load_dwordx4 a[80:83], v2, s[8:11], s27 offen offset:2048 sc1
buffer_load_dwordx4 a[152:155], v3, s[8:11], s28 offen offset:2048 sc1
buffer_load_dwordx4 a[12:15], v2, s[8:11], s26 offen offset:3072 sc1
buffer_load_dwordx4 a[84:87], v2, s[8:11], s27 offen offset:3072 sc1
buffer_load_dwordx4 a[156:159], v3, s[8:11], s28 offen offset:3072 sc1
s_add_u32 s26, s26, 4096
s_add_u32 s27, s27, 4096
s_add_u32 s28, s28, 4096
buffer_load_dwordx4 a[16:19], v2, s[8:11], s26 offen offset:0 sc1
buffer_load_dwordx4 a[88:91], v2, s[8:11], s27 offen offset:0 sc1
buffer_load_dwordx4 a[160:163], v3, s[8:11], s28 offen offset:0 sc1
buffer_load_dwordx4 a[20:23], v2, s[8:11], s26 offen offset:1024 sc1
buffer_load_dwordx4 a[92:95], v2, s[8:11], s27 offen offset:1024 sc1
buffer_load_dwordx4 a[164:167], v3, s[8:11], s28 offen offset:1024 sc1
buffer_load_dwordx4 a[24:27], v2, s[8:11], s26 offen offset:2048 sc1
buffer_load_dwordx4 a[96:99], v2, s[8:11], s27 offen offset:2048 sc1
buffer_load_dwordx4 a[168:171], v3, s[8:11], s28 offen offset:2048 sc1
buffer_load_dwordx4 a[28:31], v2, s[8:11], s26 offen offset:3072 sc1
buffer_load_dwordx4 a[100:103], v2, s[8:11], s27 offen offset:3072 sc1
buffer_load_dwordx4 a[172:175], v3, s[8:11], s28 offen offset:3072 sc1
v_lshrrev_b32 v13, 4, v1
v_lshlrev_b32 v14, 2, v13
v_sub_u32 v14, v12, v14
v_subrev_u32 v15, 0, v14
v_cmp_gt_u32 s[52:53], 8, v15
v_cmp_gt_i32 s[44:45], -8, v15
v_subrev_u32 v15, 1, v14
v_cmp_gt_u32 s[54:55], 8, v15
v_cmp_gt_i32 s[46:47], -8, v15
v_subrev_u32 v15, 2, v14
v_cmp_gt_u32 s[56:57], 8, v15
v_cmp_gt_i32 s[48:49], -8, v15
v_subrev_u32 v15, 3, v14
v_cmp_gt_u32 s[58:59], 8, v15
v_cmp_gt_i32 s[50:51], -8, v15
s_and_b32 s31, s20, 7
s_or_b32 s31, s31, s4
s_cmp_eq_u32 s31, 0
s_cselect_b64 s[60:61], 0, s[44:45]
s_cselect_b64 s[62:63], 0, s[46:47]
s_cselect_b64 s[64:65], 0, s[48:49]
s_cselect_b64 s[66:67], 0, s[50:51]
ds_read_b128 a[216:219], v2 offset:0
ds_read_b128 a[220:223], v2 offset:7168
ds_read_b128 a[224:227], v2 offset:1024
ds_read_b128 a[228:231], v2 offset:8192
ds_read_b128 a[232:235], v2 offset:2048
ds_read_b128 a[236:239], v2 offset:9216
s_waitcnt vmcnt(18)
s_waitcnt lgkmcnt(4)
v_mfma_f32_16x16x32_bf16 v[32:35], a[216:219], a[0:3], 0
s_add_u32 s26, s26, 4096
s_add_u32 s27, s27, 4096
s_add_u32 s28, s28, 4096
buffer_load_dwordx4 a[32:35], v2, s[8:11], s26 offen offset:0 sc1
v_mfma_f32_16x16x32_bf16 v[32:35], a[220:223], a[4:7], v[32:35]
ds_read_b128 a[240:243], v2 offset:3072
v_lshlrev_b32 v14, 3, v1
v_mfma_f32_16x16x32_bf16 v[36:39], a[216:219], a[72:75], 0
s_mul_i32 s31, s4, 3072
s_add_u32 s41, s31, 147456
v_mfma_f32_16x16x32_bf16 v[36:39], a[220:223], a[76:79], v[36:39]
ds_read_b128 a[244:247], v2 offset:10240
s_waitcnt lgkmcnt(4)
v_mfma_f32_16x16x32_bf16 v[40:43], a[224:227], a[0:3], 0
buffer_load_dwordx4 a[104:107], v2, s[8:11], s27 offen offset:0 sc1
v_mfma_f32_16x16x32_bf16 v[40:43], a[228:231], a[4:7], v[40:43]
ds_read_b128 a[216:219], v2 offset:4096
v_add_u32 v15, s41, v14
v_mfma_f32_16x16x32_bf16 v[44:47], a[224:227], a[72:75], 0
s_lshl_b32 s42, s29, 9
s_add_u32 s42, s42, 147456
v_mfma_f32_16x16x32_bf16 v[44:47], a[228:231], a[76:79], v[44:47]
ds_read_b128 a[220:223], v2 offset:11264
s_waitcnt lgkmcnt(4)
v_mfma_f32_16x16x32_bf16 v[48:51], a[232:235], a[0:3], 0
buffer_load_dwordx4 a[176:179], v3, s[8:11], s28 offen offset:0 sc1
v_mfma_f32_16x16x32_bf16 v[48:51], a[236:239], a[4:7], v[48:51]
ds_read_b128 a[224:227], v2 offset:5120
v_add_u32 v16, s42, v14
v_mfma_f32_16x16x32_bf16 v[52:55], a[232:235], a[72:75], 0
s_and_b32 s42, s42, 512
s_add_u32 s42, s42, 147456
v_mfma_f32_16x16x32_bf16 v[52:55], a[236:239], a[76:79], v[52:55]
ds_read_b128 a[228:231], v2 offset:12288
s_waitcnt lgkmcnt(4)
v_mfma_f32_16x16x32_bf16 v[56:59], a[240:243], a[0:3], 0
buffer_load_dwordx4 a[36:39], v2, s[8:11], s26 offen offset:1024 sc1
v_mfma_f32_16x16x32_bf16 v[56:59], a[244:247], a[4:7], v[56:59]
ds_read_b128 a[232:235], v2 offset:6144
v_add_u32 v19, s42, v14
v_mfma_f32_16x16x32_bf16 v[60:63], a[240:243], a[72:75], 0
v_add_u32 v18, 150016, v14
v_mov_b32 v96, 0
v_mfma_f32_16x16x32_bf16 v[60:63], a[244:247], a[76:79], v[60:63]
ds_read_b128 a[236:239], v2 offset:13312
s_waitcnt lgkmcnt(4)
v_mfma_f32_16x16x32_bf16 v[64:67], a[216:219], a[0:3], 0
buffer_load_dwordx4 a[108:111], v2, s[8:11], s27 offen offset:1024 sc1
v_mfma_f32_16x16x32_bf16 v[64:67], a[220:223], a[4:7], v[64:67]
ds_read_b128 a[240:243], v6 offset:0
v_mov_b32 v97, 0
v_mfma_f32_16x16x32_bf16 v[68:71], a[216:219], a[72:75], 0
v_mov_b32 v100, 0
v_mov_b32 v101, 0
v_mfma_f32_16x16x32_bf16 v[68:71], a[220:223], a[76:79], v[68:71]
ds_read_b128 a[244:247], v6 offset:7168
s_waitcnt lgkmcnt(4)
v_mfma_f32_16x16x32_bf16 v[72:75], a[0:3], a[224:227], 0
buffer_load_dwordx4 a[180:183], v3, s[8:11], s28 offen offset:1024 sc1
v_mfma_f32_16x16x32_bf16 v[72:75], a[4:7], a[228:231], v[72:75]
ds_read_b128 a[216:219], v9 offset:0
v_and_b32 v13, 1, v1
v_mfma_f32_16x16x32_bf16 v[76:79], a[72:75], a[224:227], 0
v_lshlrev_b32 v13, 4, v13
v_mov_b32 v102, 0x3f80
v_mfma_f32_16x16x32_bf16 v[76:79], a[76:79], a[228:231], v[76:79]
ds_read_b128 a[220:223], v9 offset:7168
s_waitcnt lgkmcnt(4)
v_mfma_f32_16x16x32_bf16 v[80:83], a[0:3], a[232:235], 0
buffer_load_dwordx4 a[40:43], v2, s[8:11], s26 offen offset:2048 sc1
v_mfma_f32_16x16x32_bf16 v[80:83], a[4:7], a[236:239], v[80:83]
ds_read_b128 a[224:227], v2 offset:14336
v_lshlrev_b32 v13, v13, v102
v_mfma_f32_16x16x32_bf16 v[84:87], a[72:75], a[232:235], 0
v_lshrrev_b32 v102, 1, v1
v_cmp_eq_u32 vcc, 16, v102
v_mfma_f32_16x16x32_bf16 v[84:87], a[76:79], a[236:239], v[84:87]
ds_read_b128 a[228:231], v2 offset:21504
s_waitcnt lgkmcnt(4)
v_mfma_f32_16x16x32_bf16 v[88:91], a[240:243], a[144:147], 0
ds_read_b128 a[232:235], v2 offset:15360
buffer_load_dwordx4 a[112:115], v2, s[8:11], s27 offen offset:2048 sc1
v_mfma_f32_16x16x32_bf16 v[88:91], a[244:247], a[148:151], v[88:91]
ds_read_b128 a[236:239], v2 offset:22528
s_waitcnt lgkmcnt(4)
v_mfma_f32_16x16x32_bf16 v[92:95], a[144:147], a[216:219], 0
ds_read_b128 a[240:243], v2 offset:16384
v_cndmask_b32 v98, 0, v13, vcc
v_mfma_f32_16x16x32_bf16 v[92:95], a[148:151], a[220:223], v[92:95]
ds_read_b128 a[244:247], v2 offset:23552
s_waitcnt vmcnt(20)
s_waitcnt lgkmcnt(4)
v_mfma_f32_16x16x32_bf16 v[32:35], a[224:227], a[8:11], v[32:35]
buffer_load_dwordx4 a[184:187], v3, s[8:11], s28 offen offset:2048 sc1
v_mfma_f32_16x16x32_bf16 v[32:35], a[228:231], a[12:15], v[32:35]
ds_read_b128 a[216:219], v2 offset:17408
v_cmp_eq_u32 vcc, 17, v102
v_mfma_f32_16x16x32_bf16 v[36:39], a[224:227], a[80:83], v[36:39]
s_nop 0
v_cndmask_b32 v99, 0, v13, vcc
v_add_u32 v17, 16, v12
v_mfma_f32_16x16x32_bf16 v[36:39], a[228:231], a[84:87], v[36:39]
ds_read_b128 a[220:223], v2 offset:24576
s_waitcnt lgkmcnt(4)
v_mfma_f32_16x16x32_bf16 v[40:43], a[232:235], a[8:11], v[40:43]
buffer_load_dwordx4 a[44:47], v2, s[8:11], s26 offen offset:3072 sc1
v_mfma_f32_16x16x32_bf16 v[40:43], a[236:239], a[12:15], v[40:43]
ds_read_b128 a[224:227], v2 offset:18432
v_cmp_gt_u32 vcc, 16, v1
v_mfma_f32_16x16x32_bf16 v[44:47], a[232:235], a[80:83], v[44:47]
v_add_u32 v14, 48, v12
s_mov_b32 s34, 0x3eae1a93
v_mfma_f32_16x16x32_bf16 v[44:47], a[236:239], a[84:87], v[44:47]
ds_read_b128 a[228:231], v2 offset:25600
s_waitcnt lgkmcnt(4)
v_mfma_f32_16x16x32_bf16 v[48:51], a[240:243], a[8:11], v[48:51]
buffer_load_dwordx4 a[116:119], v2, s[8:11], s27 offen offset:3072 sc1
v_mfma_f32_16x16x32_bf16 v[48:51], a[244:247], a[12:15], v[48:51]
ds_read_b128 a[232:235], v2 offset:19456
v_cndmask_b32 v17, v14, v17, vcc
v_mfma_f32_16x16x32_bf16 v[52:55], a[240:243], a[80:83], v[52:55]
v_lshlrev_b32 v17, 3, v17
v_add_u32 v17, s41, v17
v_mfma_f32_16x16x32_bf16 v[52:55], a[244:247], a[84:87], v[52:55]
ds_read_b128 a[236:239], v2 offset:26624
s_waitcnt lgkmcnt(4)
v_mfma_f32_16x16x32_bf16 v[56:59], a[216:219], a[8:11], v[56:59]
buffer_load_dwordx4 a[188:191], v3, s[8:11], s28 offen offset:3072 sc1
v_mfma_f32_16x16x32_bf16 v[56:59], a[220:223], a[12:15], v[56:59]
ds_read_b128 a[240:243], v2 offset:20480
v_mov_b32 v103, 0xff61b1e6
v_mfma_f32_16x16x32_bf16 v[60:63], a[216:219], a[80:83], v[60:63]
v_mov_b32 v102, 0xffff
v_cndmask_b32 v172, v103, 0, s[44:45]
v_mfma_f32_16x16x32_bf16 v[60:63], a[220:223], a[84:87], v[60:63]
ds_read_b128 a[244:247], v2 offset:27648
s_waitcnt lgkmcnt(4)
v_mfma_f32_16x16x32_bf16 v[64:67], a[224:227], a[8:11], v[64:67]
s_add_u32 s26, s26, 4096
s_add_u32 s27, s27, 4096
s_add_u32 s28, s28, 4096
buffer_load_dwordx4 a[48:51], v2, s[8:11], s26 offen offset:0 sc1
v_mfma_f32_16x16x32_bf16 v[64:67], a[228:231], a[12:15], v[64:67]
ds_read_b128 a[216:219], v6 offset:14336
v_cndmask_b32 v173, v103, 0, s[46:47]
v_mfma_f32_16x16x32_bf16 v[68:71], a[224:227], a[80:83], v[68:71]
v_cndmask_b32 v174, v103, 0, s[48:49]
v_cndmask_b32 v175, v103, 0, s[50:51]
v_mfma_f32_16x16x32_bf16 v[68:71], a[228:231], a[84:87], v[68:71]
ds_read_b128 a[220:223], v6 offset:21504
s_waitcnt lgkmcnt(4)
v_mfma_f32_16x16x32_bf16 v[72:75], a[8:11], a[232:235], v[72:75]
buffer_load_dwordx4 a[120:123], v2, s[8:11], s27 offen offset:0 sc1
v_mfma_f32_16x16x32_bf16 v[72:75], a[12:15], a[236:239], v[72:75]
ds_read_b128 a[224:227], v9 offset:14336
v_cndmask_b32 v184, 0, v102, s[44:45]
v_mfma_f32_16x16x32_bf16 v[76:79], a[80:83], a[232:235], v[76:79]
v_cndmask_b32 v13, 0, v102, s[46:47]
v_lshl_or_b32 v184, v13, 16, v184
v_mfma_f32_16x16x32_bf16 v[76:79], a[84:87], a[236:239], v[76:79]
ds_read_b128 a[228:231], v9 offset:21504
s_waitcnt lgkmcnt(4)
v_mfma_f32_16x16x32_bf16 v[80:83], a[8:11], a[240:243], v[80:83]
buffer_load_dwordx4 a[192:195], v3, s[8:11], s28 offen offset:0 sc1
v_mfma_f32_16x16x32_bf16 v[80:83], a[12:15], a[244:247], v[80:83]
ds_read_b128 a[232:235], v2 offset:28672
v_cndmask_b32 v185, 0, v102, s[48:49]
v_mfma_f32_16x16x32_bf16 v[84:87], a[80:83], a[240:243], v[84:87]
v_cndmask_b32 v13, 0, v102, s[50:51]
v_lshl_or_b32 v185, v13, 16, v185
v_mfma_f32_16x16x32_bf16 v[84:87], a[84:87], a[244:247], v[84:87]
ds_read_b128 a[236:239], v2 offset:35840
s_waitcnt lgkmcnt(4)
v_mfma_f32_16x16x32_bf16 v[88:91], a[216:219], a[152:155], v[88:91]
ds_read_b128 a[240:243], v2 offset:29696
buffer_load_dwordx4 a[52:55], v2, s[8:11], s26 offen offset:1024 sc1
v_mfma_f32_16x16x32_bf16 v[88:91], a[220:223], a[156:159], v[88:91]
ds_read_b128 a[244:247], v2 offset:36864
s_waitcnt lgkmcnt(4)
v_mfma_f32_16x16x32_bf16 v[92:95], a[152:155], a[224:227], v[92:95]
ds_read_b128 a[216:219], v2 offset:30720
v_cndmask_b32 v176, v103, 0, s[52:53]
v_mfma_f32_16x16x32_bf16 v[92:95], a[156:159], a[228:231], v[92:95]
ds_read_b128 a[220:223], v2 offset:37888
s_waitcnt vmcnt(22)
s_waitcnt lgkmcnt(4)
v_mfma_f32_16x16x32_bf16 v[32:35], a[232:235], a[16:19], v[32:35]
buffer_load_dwordx4 a[124:127], v2, s[8:11], s27 offen offset:1024 sc1
v_mfma_f32_16x16x32_bf16 v[32:35], a[236:239], a[20:23], v[32:35]
ds_read_b128 a[224:227], v2 offset:31744
v_cndmask_b32 v177, v103, 0, s[54:55]
v_mfma_f32_16x16x32_bf16 v[36:39], a[232:235], a[88:91], v[36:39]
v_cndmask_b32 v178, v103, 0, s[56:57]
v_cndmask_b32 v179, v103, 0, s[58:59]
v_mfma_f32_16x16x32_bf16 v[36:39], a[236:239], a[92:95], v[36:39]
ds_read_b128 a[228:231], v2 offset:38912
s_waitcnt lgkmcnt(4)
v_mfma_f32_16x16x32_bf16 v[40:43], a[240:243], a[16:19], v[40:43]
buffer_load_dwordx4 a[196:199], v3, s[8:11], s28 offen offset:1024 sc1
v_mfma_f32_16x16x32_bf16 v[40:43], a[244:247], a[20:23], v[40:43]
ds_read_b128 a[232:235], v2 offset:32768
v_cndmask_b32 v186, 0, v102, s[52:53]
v_mfma_f32_16x16x32_bf16 v[44:47], a[240:243], a[88:91], v[44:47]
v_cndmask_b32 v13, 0, v102, s[54:55]
v_lshl_or_b32 v186, v13, 16, v186
v_mfma_f32_16x16x32_bf16 v[44:47], a[244:247], a[92:95], v[44:47]
ds_read_b128 a[236:239], v2 offset:39936
s_waitcnt lgkmcnt(4)
v_mfma_f32_16x16x32_bf16 v[48:51], a[216:219], a[16:19], v[48:51]
buffer_load_dwordx4 a[56:59], v2, s[8:11], s26 offen offset:2048 sc1
v_mfma_f32_16x16x32_bf16 v[48:51], a[220:223], a[20:23], v[48:51]
ds_read_b128 a[240:243], v2 offset:33792
v_cndmask_b32 v187, 0, v102, s[56:57]
v_mfma_f32_16x16x32_bf16 v[52:55], a[216:219], a[88:91], v[52:55]
v_cndmask_b32 v13, 0, v102, s[58:59]
v_lshl_or_b32 v187, v13, 16, v187
v_mfma_f32_16x16x32_bf16 v[52:55], a[220:223], a[92:95], v[52:55]
ds_read_b128 a[244:247], v2 offset:40960
s_waitcnt lgkmcnt(4)
v_mfma_f32_16x16x32_bf16 v[56:59], a[224:227], a[16:19], v[56:59]
buffer_load_dwordx4 a[128:131], v2, s[8:11], s27 offen offset:2048 sc1
v_mfma_f32_16x16x32_bf16 v[56:59], a[228:231], a[20:23], v[56:59]
ds_read_b128 a[216:219], v2 offset:34816
v_cndmask_b32 v180, v103, 0, s[60:61]
v_mfma_f32_16x16x32_bf16 v[60:63], a[224:227], a[88:91], v[60:63]
v_cndmask_b32 v181, v103, 0, s[62:63]
v_cndmask_b32 v182, v103, 0, s[64:65]
v_mfma_f32_16x16x32_bf16 v[60:63], a[228:231], a[92:95], v[60:63]
ds_read_b128 a[220:223], v2 offset:41984
s_waitcnt lgkmcnt(4)
v_mfma_f32_16x16x32_bf16 v[64:67], a[232:235], a[16:19], v[64:67]
buffer_load_dwordx4 a[200:203], v3, s[8:11], s28 offen offset:2048 sc1
v_mfma_f32_16x16x32_bf16 v[64:67], a[236:239], a[20:23], v[64:67]
ds_read_b128 a[224:227], v6 offset:28672
v_cndmask_b32 v183, v103, 0, s[66:67]
v_mfma_f32_16x16x32_bf16 v[68:71], a[232:235], a[88:91], v[68:71]
v_cndmask_b32 v188, 0, v102, s[60:61]
v_cndmask_b32 v13, 0, v102, s[62:63]
v_mfma_f32_16x16x32_bf16 v[68:71], a[236:239], a[92:95], v[68:71]
ds_read_b128 a[228:231], v6 offset:35840
s_waitcnt lgkmcnt(4)
v_mfma_f32_16x16x32_bf16 v[72:75], a[16:19], a[240:243], v[72:75]
buffer_load_dwordx4 a[60:63], v2, s[8:11], s26 offen offset:3072 sc1
v_mfma_f32_16x16x32_bf16 v[72:75], a[20:23], a[244:247], v[72:75]
ds_read_b128 a[232:235], v9 offset:28672
v_lshl_or_b32 v188, v13, 16, v188
v_mfma_f32_16x16x32_bf16 v[76:79], a[88:91], a[240:243], v[76:79]
v_cndmask_b32 v189, 0, v102, s[64:65]
v_cndmask_b32 v13, 0, v102, s[66:67]
v_mfma_f32_16x16x32_bf16 v[76:79], a[92:95], a[244:247], v[76:79]
ds_read_b128 a[236:239], v9 offset:35840
s_waitcnt lgkmcnt(4)
v_mfma_f32_16x16x32_bf16 v[80:83], a[16:19], a[216:219], v[80:83]
buffer_load_dwordx4 a[132:135], v2, s[8:11], s27 offen offset:3072 sc1
v_mfma_f32_16x16x32_bf16 v[80:83], a[20:23], a[220:223], v[80:83]
ds_read_b128 a[240:243], v2 offset:43008
v_lshl_or_b32 v189, v13, 16, v189
v_mfma_f32_16x16x32_bf16 v[84:87], a[88:91], a[216:219], v[84:87]
v_mfma_f32_16x16x32_bf16 v[84:87], a[92:95], a[220:223], v[84:87]
ds_read_b128 a[244:247], v2 offset:50176
s_waitcnt lgkmcnt(4)
v_mfma_f32_16x16x32_bf16 v[88:91], a[224:227], a[160:163], v[88:91]
ds_read_b128 a[216:219], v2 offset:44032
buffer_load_dwordx4 a[204:207], v3, s[8:11], s28 offen offset:3072 sc1
v_mfma_f32_16x16x32_bf16 v[88:91], a[228:231], a[164:167], v[88:91]
ds_read_b128 a[220:223], v2 offset:51200
s_waitcnt lgkmcnt(4)
v_mfma_f32_16x16x32_bf16 v[92:95], a[160:163], a[232:235], v[92:95]
ds_read_b128 a[224:227], v2 offset:45056
v_mfma_f32_16x16x32_bf16 v[92:95], a[164:167], a[236:239], v[92:95]
ds_read_b128 a[228:231], v2 offset:52224
s_waitcnt vmcnt(24)
s_waitcnt lgkmcnt(4)
v_mfma_f32_16x16x32_bf16 v[32:35], a[240:243], a[24:27], v[32:35]
s_add_u32 s26, s26, 4096
s_add_u32 s27, s27, 4096
s_add_u32 s28, s28, 4096
buffer_load_dwordx4 a[64:67], v2, s[8:11], s26 offen offset:0 sc1
v_mfma_f32_16x16x32_bf16 v[32:35], a[244:247], a[28:31], v[32:35]
ds_read_b128 a[232:235], v2 offset:46080
v_mfma_f32_16x16x32_bf16 v[36:39], a[240:243], a[96:99], v[36:39]
v_mfma_f32_16x16x32_bf16 v[36:39], a[244:247], a[100:103], v[36:39]
ds_read_b128 a[236:239], v2 offset:53248
s_waitcnt lgkmcnt(4)
v_mfma_f32_16x16x32_bf16 v[40:43], a[216:219], a[24:27], v[40:43]
buffer_load_dwordx4 a[136:139], v2, s[8:11], s27 offen offset:0 sc1
v_mfma_f32_16x16x32_bf16 v[40:43], a[220:223], a[28:31], v[40:43]
ds_read_b128 a[240:243], v2 offset:47104
v_mfma_f32_16x16x32_bf16 v[44:47], a[216:219], a[96:99], v[44:47]
v_mfma_f32_16x16x32_bf16 v[44:47], a[220:223], a[100:103], v[44:47]
ds_read_b128 a[244:247], v2 offset:54272
s_waitcnt lgkmcnt(4)
v_mfma_f32_16x16x32_bf16 v[48:51], a[224:227], a[24:27], v[48:51]
buffer_load_dwordx4 a[208:211], v3, s[8:11], s28 offen offset:0 sc1
v_mfma_f32_16x16x32_bf16 v[48:51], a[228:231], a[28:31], v[48:51]
ds_read_b128 a[216:219], v2 offset:48128
v_mfma_f32_16x16x32_bf16 v[52:55], a[224:227], a[96:99], v[52:55]
v_mfma_f32_16x16x32_bf16 v[52:55], a[228:231], a[100:103], v[52:55]
ds_read_b128 a[220:223], v2 offset:55296
s_waitcnt lgkmcnt(4)
v_mfma_f32_16x16x32_bf16 v[56:59], a[232:235], a[24:27], v[56:59]
buffer_load_dwordx4 a[68:71], v2, s[8:11], s26 offen offset:1024 sc1
v_mfma_f32_16x16x32_bf16 v[56:59], a[236:239], a[28:31], v[56:59]
ds_read_b128 a[224:227], v2 offset:49152
v_mfma_f32_16x16x32_bf16 v[60:63], a[232:235], a[96:99], v[60:63]
v_mfma_f32_16x16x32_bf16 v[60:63], a[236:239], a[100:103], v[60:63]
ds_read_b128 a[228:231], v2 offset:56320
s_waitcnt lgkmcnt(4)
v_mfma_f32_16x16x32_bf16 v[64:67], a[240:243], a[24:27], v[64:67]
buffer_load_dwordx4 a[140:143], v2, s[8:11], s27 offen offset:1024 sc1
v_mfma_f32_16x16x32_bf16 v[64:67], a[244:247], a[28:31], v[64:67]
ds_read_b128 a[232:235], v6 offset:43008
v_mfma_f32_16x16x32_bf16 v[68:71], a[240:243], a[96:99], v[68:71]
v_mfma_f32_16x16x32_bf16 v[68:71], a[244:247], a[100:103], v[68:71]
ds_read_b128 a[236:239], v6 offset:50176
s_waitcnt lgkmcnt(4)
v_mfma_f32_16x16x32_bf16 v[72:75], a[24:27], a[216:219], v[72:75]
buffer_load_dwordx4 a[212:215], v3, s[8:11], s28 offen offset:1024 sc1
v_mfma_f32_16x16x32_bf16 v[72:75], a[28:31], a[220:223], v[72:75]
ds_read_b128 a[240:243], v9 offset:43008
v_mfma_f32_16x16x32_bf16 v[76:79], a[96:99], a[216:219], v[76:79]
v_mfma_f32_16x16x32_bf16 v[76:79], a[100:103], a[220:223], v[76:79]
ds_read_b128 a[244:247], v9 offset:50176
s_waitcnt lgkmcnt(4)
v_mfma_f32_16x16x32_bf16 v[80:83], a[24:27], a[224:227], v[80:83]
v_mfma_f32_16x16x32_bf16 v[80:83], a[28:31], a[228:231], v[80:83]
ds_read_b128 a[216:219], v2 offset:57344
v_mfma_f32_16x16x32_bf16 v[84:87], a[96:99], a[224:227], v[84:87]
v_mfma_f32_16x16x32_bf16 v[84:87], a[100:103], a[228:231], v[84:87]
ds_read_b128 a[220:223], v2 offset:64512
s_waitcnt lgkmcnt(4)
v_mfma_f32_16x16x32_bf16 v[88:91], a[232:235], a[168:171], v[88:91]
ds_read_b128 a[224:227], v2 offset:58368
v_mfma_f32_16x16x32_bf16 v[88:91], a[236:239], a[172:175], v[88:91]
ds_read_b128 a[228:231], v4 offset:0
s_waitcnt lgkmcnt(4)
v_mfma_f32_16x16x32_bf16 v[92:95], a[168:171], a[240:243], v[92:95]
ds_read_b128 a[232:235], v2 offset:59392
v_mfma_f32_16x16x32_bf16 v[92:95], a[172:175], a[244:247], v[92:95]
ds_read_b128 a[236:239], v4 offset:1024
s_waitcnt vmcnt(24)
s_waitcnt lgkmcnt(4)
v_mfma_f32_16x16x32_bf16 v[32:35], a[216:219], a[32:35], v[32:35]
v_mfma_f32_16x16x32_bf16 v[32:35], a[220:223], a[36:39], v[32:35]
ds_read_b128 a[240:243], v2 offset:60416
v_mfma_f32_16x16x32_bf16 v[36:39], a[216:219], a[104:107], v[36:39]
v_mfma_f32_16x16x32_bf16 v[36:39], a[220:223], a[108:111], v[36:39]
ds_read_b128 a[244:247], v4 offset:2048
s_waitcnt lgkmcnt(4)
v_mfma_f32_16x16x32_bf16 v[40:43], a[224:227], a[32:35], v[40:43]
v_mfma_f32_16x16x32_bf16 v[40:43], a[228:231], a[36:39], v[40:43]
ds_read_b128 a[216:219], v2 offset:61440
v_mfma_f32_16x16x32_bf16 v[44:47], a[224:227], a[104:107], v[44:47]
v_mfma_f32_16x16x32_bf16 v[44:47], a[228:231], a[108:111], v[44:47]
ds_read_b128 a[220:223], v4 offset:3072
s_waitcnt lgkmcnt(4)
v_mfma_f32_16x16x32_bf16 v[48:51], a[232:235], a[32:35], v[48:51]
v_mfma_f32_16x16x32_bf16 v[48:51], a[236:239], a[36:39], v[48:51]
ds_read_b128 a[224:227], v2 offset:62464
v_mfma_f32_16x16x32_bf16 v[52:55], a[232:235], a[104:107], v[52:55]
v_mfma_f32_16x16x32_bf16 v[52:55], a[236:239], a[108:111], v[52:55]
ds_read_b128 a[228:231], v4 offset:4096
s_waitcnt lgkmcnt(4)
v_mfma_f32_16x16x32_bf16 v[56:59], a[240:243], a[32:35], v[56:59]
v_mfma_f32_16x16x32_bf16 v[56:59], a[244:247], a[36:39], v[56:59]
ds_read_b128 a[232:235], v2 offset:63488
v_mfma_f32_16x16x32_bf16 v[60:63], a[240:243], a[104:107], v[60:63]
v_mfma_f32_16x16x32_bf16 v[60:63], a[244:247], a[108:111], v[60:63]
ds_read_b128 a[236:239], v4 offset:5120
s_waitcnt lgkmcnt(4)
v_mfma_f32_16x16x32_bf16 v[64:67], a[216:219], a[32:35], v[64:67]
v_mfma_f32_16x16x32_bf16 v[64:67], a[220:223], a[36:39], v[64:67]
ds_read_b128 a[240:243], v6 offset:57344
v_mfma_f32_16x16x32_bf16 v[68:71], a[216:219], a[104:107], v[68:71]
v_mfma_f32_16x16x32_bf16 v[68:71], a[220:223], a[108:111], v[68:71]
ds_read_b128 a[244:247], v6 offset:64512
s_waitcnt lgkmcnt(4)
v_mfma_f32_16x16x32_bf16 v[72:75], a[32:35], a[224:227], v[72:75]
v_mfma_f32_16x16x32_bf16 v[72:75], a[36:39], a[228:231], v[72:75]
ds_read_b128 a[216:219], v9 offset:57344
v_mfma_f32_16x16x32_bf16 v[76:79], a[104:107], a[224:227], v[76:79]
v_mfma_f32_16x16x32_bf16 v[76:79], a[108:111], a[228:231], v[76:79]
ds_read_b128 a[220:223], v9 offset:64512
s_waitcnt lgkmcnt(4)
v_mfma_f32_16x16x32_bf16 v[80:83], a[32:35], a[232:235], v[80:83]
v_mfma_f32_16x16x32_bf16 v[80:83], a[36:39], a[236:239], v[80:83]
ds_read_b128 a[224:227], v4 offset:6144
v_mfma_f32_16x16x32_bf16 v[84:87], a[104:107], a[232:235], v[84:87]
v_mfma_f32_16x16x32_bf16 v[84:87], a[108:111], a[236:239], v[84:87]
ds_read_b128 a[228:231], v4 offset:13312
s_waitcnt lgkmcnt(4)
v_mfma_f32_16x16x32_bf16 v[88:91], a[240:243], a[176:179], v[88:91]
ds_read_b128 a[232:235], v4 offset:7168
v_mfma_f32_16x16x32_bf16 v[88:91], a[244:247], a[180:183], v[88:91]
ds_read_b128 a[236:239], v4 offset:14336
s_waitcnt lgkmcnt(4)
v_mfma_f32_16x16x32_bf16 v[92:95], a[176:179], a[216:219], v[92:95]
ds_read_b128 a[240:243], v4 offset:8192
v_mfma_f32_16x16x32_bf16 v[92:95], a[180:183], a[220:223], v[92:95]
ds_read_b128 a[244:247], v4 offset:15360
s_waitcnt vmcnt(18)
s_waitcnt lgkmcnt(4)
v_mfma_f32_16x16x32_bf16 v[32:35], a[224:227], a[40:43], v[32:35]
v_mfma_f32_16x16x32_bf16 v[32:35], a[228:231], a[44:47], v[32:35]
ds_read_b128 a[216:219], v4 offset:9216
v_mfma_f32_16x16x32_bf16 v[36:39], a[224:227], a[112:115], v[36:39]
v_mfma_f32_16x16x32_bf16 v[36:39], a[228:231], a[116:119], v[36:39]
ds_read_b128 a[220:223], v4 offset:16384
s_waitcnt lgkmcnt(4)
v_mfma_f32_16x16x32_bf16 v[40:43], a[232:235], a[40:43], v[40:43]
v_mfma_f32_16x16x32_bf16 v[40:43], a[236:239], a[44:47], v[40:43]
ds_read_b128 a[224:227], v4 offset:10240
v_mfma_f32_16x16x32_bf16 v[44:47], a[232:235], a[112:115], v[44:47]
v_mfma_f32_16x16x32_bf16 v[44:47], a[236:239], a[116:119], v[44:47]
ds_read_b128 a[228:231], v4 offset:17408
s_waitcnt lgkmcnt(4)
v_mfma_f32_16x16x32_bf16 v[48:51], a[240:243], a[40:43], v[48:51]
v_mfma_f32_16x16x32_bf16 v[48:51], a[244:247], a[44:47], v[48:51]
ds_read_b128 a[232:235], v4 offset:11264
v_mfma_f32_16x16x32_bf16 v[52:55], a[240:243], a[112:115], v[52:55]
v_mfma_f32_16x16x32_bf16 v[52:55], a[244:247], a[116:119], v[52:55]
ds_read_b128 a[236:239], v4 offset:18432
s_waitcnt lgkmcnt(4)
v_mfma_f32_16x16x32_bf16 v[56:59], a[216:219], a[40:43], v[56:59]
v_mfma_f32_16x16x32_bf16 v[56:59], a[220:223], a[44:47], v[56:59]
ds_read_b128 a[240:243], v4 offset:12288
v_mfma_f32_16x16x32_bf16 v[60:63], a[216:219], a[112:115], v[60:63]
v_mfma_f32_16x16x32_bf16 v[60:63], a[220:223], a[116:119], v[60:63]
ds_read_b128 a[244:247], v4 offset:19456
s_waitcnt lgkmcnt(4)
v_mfma_f32_16x16x32_bf16 v[64:67], a[224:227], a[40:43], v[64:67]
v_mfma_f32_16x16x32_bf16 v[64:67], a[228:231], a[44:47], v[64:67]
ds_read_b128 a[216:219], v7 offset:6144
v_mfma_f32_16x16x32_bf16 v[68:71], a[224:227], a[112:115], v[68:71]
v_mfma_f32_16x16x32_bf16 v[68:71], a[228:231], a[116:119], v[68:71]
ds_read_b128 a[220:223], v7 offset:13312
s_waitcnt lgkmcnt(4)
v_mfma_f32_16x16x32_bf16 v[72:75], a[40:43], a[232:235], v[72:75]
v_mfma_f32_16x16x32_bf16 v[72:75], a[44:47], a[236:239], v[72:75]
ds_read_b128 a[224:227], v10 offset:6144
v_mfma_f32_16x16x32_bf16 v[76:79], a[112:115], a[232:235], v[76:79]
v_mfma_f32_16x16x32_bf16 v[76:79], a[116:119], a[236:239], v[76:79]
ds_read_b128 a[228:231], v10 offset:13312
s_waitcnt lgkmcnt(4)
v_mfma_f32_16x16x32_bf16 v[80:83], a[40:43], a[240:243], v[80:83]
v_mfma_f32_16x16x32_bf16 v[80:83], a[44:47], a[244:247], v[80:83]
ds_read_b128 a[232:235], v4 offset:20480
v_mfma_f32_16x16x32_bf16 v[84:87], a[112:115], a[240:243], v[84:87]
v_mfma_f32_16x16x32_bf16 v[84:87], a[116:119], a[244:247], v[84:87]
ds_read_b128 a[236:239], v4 offset:27648
s_waitcnt lgkmcnt(4)
v_mfma_f32_16x16x32_bf16 v[88:91], a[216:219], a[184:187], v[88:91]
ds_read_b128 a[240:243], v4 offset:21504
v_mfma_f32_16x16x32_bf16 v[88:91], a[220:223], a[188:191], v[88:91]
ds_read_b128 a[244:247], v4 offset:28672
s_waitcnt lgkmcnt(4)
v_mfma_f32_16x16x32_bf16 v[92:95], a[184:187], a[224:227], v[92:95]
ds_read_b128 a[216:219], v4 offset:22528
v_mfma_f32_16x16x32_bf16 v[92:95], a[188:191], a[228:231], v[92:95]
ds_read_b128 a[220:223], v4 offset:29696
s_waitcnt vmcnt(12)
s_waitcnt lgkmcnt(4)
v_mfma_f32_16x16x32_bf16 v[32:35], a[232:235], a[48:51], v[32:35]
v_mfma_f32_16x16x32_bf16 v[32:35], a[236:239], a[52:55], v[32:35]
ds_read_b128 a[224:227], v4 offset:23552
v_mfma_f32_16x16x32_bf16 v[36:39], a[232:235], a[120:123], v[36:39]
v_mfma_f32_16x16x32_bf16 v[36:39], a[236:239], a[124:127], v[36:39]
ds_read_b128 a[228:231], v4 offset:30720
s_waitcnt lgkmcnt(4)
v_mfma_f32_16x16x32_bf16 v[40:43], a[240:243], a[48:51], v[40:43]
v_mfma_f32_16x16x32_bf16 v[40:43], a[244:247], a[52:55], v[40:43]
ds_read_b128 a[232:235], v4 offset:24576
v_mfma_f32_16x16x32_bf16 v[44:47], a[240:243], a[120:123], v[44:47]
v_mfma_f32_16x16x32_bf16 v[44:47], a[244:247], a[124:127], v[44:47]
ds_read_b128 a[236:239], v4 offset:31744
s_waitcnt lgkmcnt(4)
v_mfma_f32_16x16x32_bf16 v[48:51], a[216:219], a[48:51], v[48:51]
v_mfma_f32_16x16x32_bf16 v[48:51], a[220:223], a[52:55], v[48:51]
ds_read_b128 a[240:243], v4 offset:25600
v_mfma_f32_16x16x32_bf16 v[52:55], a[216:219], a[120:123], v[52:55]
v_mfma_f32_16x16x32_bf16 v[52:55], a[220:223], a[124:127], v[52:55]
ds_read_b128 a[244:247], v4 offset:32768
s_waitcnt lgkmcnt(4)
v_mfma_f32_16x16x32_bf16 v[56:59], a[224:227], a[48:51], v[56:59]
v_mfma_f32_16x16x32_bf16 v[56:59], a[228:231], a[52:55], v[56:59]
ds_read_b128 a[216:219], v4 offset:26624
v_mfma_f32_16x16x32_bf16 v[60:63], a[224:227], a[120:123], v[60:63]
v_mfma_f32_16x16x32_bf16 v[60:63], a[228:231], a[124:127], v[60:63]
ds_read_b128 a[220:223], v4 offset:33792
s_waitcnt lgkmcnt(4)
v_mfma_f32_16x16x32_bf16 v[64:67], a[232:235], a[48:51], v[64:67]
v_mfma_f32_16x16x32_bf16 v[64:67], a[236:239], a[52:55], v[64:67]
ds_read_b128 a[224:227], v7 offset:20480
v_mfma_f32_16x16x32_bf16 v[68:71], a[232:235], a[120:123], v[68:71]
v_mfma_f32_16x16x32_bf16 v[68:71], a[236:239], a[124:127], v[68:71]
ds_read_b128 a[228:231], v7 offset:27648
s_waitcnt lgkmcnt(4)
v_mfma_f32_16x16x32_bf16 v[72:75], a[48:51], a[240:243], v[72:75]
v_mfma_f32_16x16x32_bf16 v[72:75], a[52:55], a[244:247], v[72:75]
ds_read_b128 a[232:235], v10 offset:20480
v_mfma_f32_16x16x32_bf16 v[76:79], a[120:123], a[240:243], v[76:79]
v_mfma_f32_16x16x32_bf16 v[76:79], a[124:127], a[244:247], v[76:79]
ds_read_b128 a[236:239], v10 offset:27648
s_waitcnt lgkmcnt(4)
v_mfma_f32_16x16x32_bf16 v[80:83], a[48:51], a[216:219], v[80:83]
v_mfma_f32_16x16x32_bf16 v[80:83], a[52:55], a[220:223], v[80:83]
ds_read_b128 a[240:243], v4 offset:34816
v_mfma_f32_16x16x32_bf16 v[84:87], a[120:123], a[216:219], v[84:87]
v_mfma_f32_16x16x32_bf16 v[84:87], a[124:127], a[220:223], v[84:87]
ds_read_b128 a[244:247], v4 offset:41984
s_waitcnt lgkmcnt(4)
v_mfma_f32_16x16x32_bf16 v[88:91], a[224:227], a[192:195], v[88:91]
ds_read_b128 a[216:219], v4 offset:35840
v_mfma_f32_16x16x32_bf16 v[88:91], a[228:231], a[196:199], v[88:91]
ds_read_b128 a[220:223], v4 offset:43008
s_waitcnt lgkmcnt(4)
v_mfma_f32_16x16x32_bf16 v[92:95], a[192:195], a[232:235], v[92:95]
ds_read_b128 a[224:227], v4 offset:36864
v_mfma_f32_16x16x32_bf16 v[92:95], a[196:199], a[236:239], v[92:95]
ds_read_b128 a[228:231], v4 offset:44032
s_waitcnt vmcnt(6)
s_waitcnt lgkmcnt(4)
v_mfma_f32_16x16x32_bf16 v[32:35], a[240:243], a[56:59], v[32:35]
v_mfma_f32_16x16x32_bf16 v[32:35], a[244:247], a[60:63], v[32:35]
ds_read_b128 a[232:235], v4 offset:37888
v_mfma_f32_16x16x32_bf16 v[36:39], a[240:243], a[128:131], v[36:39]
v_mfma_f32_16x16x32_bf16 v[36:39], a[244:247], a[132:135], v[36:39]
ds_read_b128 a[236:239], v4 offset:45056
s_waitcnt lgkmcnt(4)
v_mfma_f32_16x16x32_bf16 v[40:43], a[216:219], a[56:59], v[40:43]
v_mfma_f32_16x16x32_bf16 v[40:43], a[220:223], a[60:63], v[40:43]
ds_read_b128 a[240:243], v4 offset:38912
v_mfma_f32_16x16x32_bf16 v[44:47], a[216:219], a[128:131], v[44:47]
v_mfma_f32_16x16x32_bf16 v[44:47], a[220:223], a[132:135], v[44:47]
ds_read_b128 a[244:247], v4 offset:46080
s_waitcnt lgkmcnt(4)
v_mfma_f32_16x16x32_bf16 v[48:51], a[224:227], a[56:59], v[48:51]
v_mfma_f32_16x16x32_bf16 v[48:51], a[228:231], a[60:63], v[48:51]
ds_read_b128 a[216:219], v4 offset:39936
v_mfma_f32_16x16x32_bf16 v[52:55], a[224:227], a[128:131], v[52:55]
v_mfma_f32_16x16x32_bf16 v[52:55], a[228:231], a[132:135], v[52:55]
ds_read_b128 a[220:223], v4 offset:47104
s_waitcnt lgkmcnt(4)
v_mfma_f32_16x16x32_bf16 v[56:59], a[232:235], a[56:59], v[56:59]
v_mfma_f32_16x16x32_bf16 v[56:59], a[236:239], a[60:63], v[56:59]
ds_read_b128 a[224:227], v4 offset:40960
v_mfma_f32_16x16x32_bf16 v[60:63], a[232:235], a[128:131], v[60:63]
v_mfma_f32_16x16x32_bf16 v[60:63], a[236:239], a[132:135], v[60:63]
ds_read_b128 a[228:231], v4 offset:48128
s_waitcnt lgkmcnt(4)
v_mfma_f32_16x16x32_bf16 v[64:67], a[240:243], a[56:59], v[64:67]
v_mfma_f32_16x16x32_bf16 v[64:67], a[244:247], a[60:63], v[64:67]
ds_read_b128 a[232:235], v7 offset:34816
v_mfma_f32_16x16x32_bf16 v[68:71], a[240:243], a[128:131], v[68:71]
v_mfma_f32_16x16x32_bf16 v[68:71], a[244:247], a[132:135], v[68:71]
ds_read_b128 a[236:239], v7 offset:41984
s_waitcnt lgkmcnt(4)
v_mfma_f32_16x16x32_bf16 v[72:75], a[56:59], a[216:219], v[72:75]
v_mfma_f32_16x16x32_bf16 v[72:75], a[60:63], a[220:223], v[72:75]
ds_read_b128 a[240:243], v10 offset:34816
v_mfma_f32_16x16x32_bf16 v[76:79], a[128:131], a[216:219], v[76:79]
v_mfma_f32_16x16x32_bf16 v[76:79], a[132:135], a[220:223], v[76:79]
ds_read_b128 a[244:247], v10 offset:41984
s_waitcnt lgkmcnt(4)
v_mfma_f32_16x16x32_bf16 v[80:83], a[56:59], a[224:227], v[80:83]
v_mfma_f32_16x16x32_bf16 v[80:83], a[60:63], a[228:231], v[80:83]
ds_read_b128 a[216:219], v4 offset:49152
v_mfma_f32_16x16x32_bf16 v[84:87], a[128:131], a[224:227], v[84:87]
v_mfma_f32_16x16x32_bf16 v[84:87], a[132:135], a[228:231], v[84:87]
ds_read_b128 a[220:223], v4 offset:56320
s_waitcnt lgkmcnt(4)
v_mfma_f32_16x16x32_bf16 v[88:91], a[232:235], a[200:203], v[88:91]
ds_read_b128 a[224:227], v4 offset:50176
v_mfma_f32_16x16x32_bf16 v[88:91], a[236:239], a[204:207], v[88:91]
ds_read_b128 a[228:231], v4 offset:57344
s_waitcnt lgkmcnt(4)
v_mfma_f32_16x16x32_bf16 v[92:95], a[200:203], a[240:243], v[92:95]
ds_read_b128 a[232:235], v4 offset:51200
v_mfma_f32_16x16x32_bf16 v[92:95], a[204:207], a[244:247], v[92:95]
ds_read_b128 a[236:239], v4 offset:58368
s_waitcnt vmcnt(0)
s_waitcnt lgkmcnt(4)
v_mfma_f32_16x16x32_bf16 v[32:35], a[216:219], a[64:67], v[32:35]
v_mfma_f32_16x16x32_bf16 v[32:35], a[220:223], a[68:71], v[32:35]
ds_read_b128 a[240:243], v4 offset:52224
v_mfma_f32_16x16x32_bf16 v[36:39], a[216:219], a[136:139], v[36:39]
v_mfma_f32_16x16x32_bf16 v[36:39], a[220:223], a[140:143], v[36:39]
ds_read_b128 a[244:247], v4 offset:59392
s_waitcnt lgkmcnt(4)
v_mfma_f32_16x16x32_bf16 v[40:43], a[224:227], a[64:67], v[40:43]
v_mfma_f32_16x16x32_bf16 v[40:43], a[228:231], a[68:71], v[40:43]
ds_read_b128 a[216:219], v4 offset:53248
v_mfma_f32_16x16x32_bf16 v[44:47], a[224:227], a[136:139], v[44:47]
v_mfma_f32_16x16x32_bf16 v[44:47], a[228:231], a[140:143], v[44:47]
ds_read_b128 a[220:223], v4 offset:60416
s_waitcnt lgkmcnt(4)
v_mfma_f32_16x16x32_bf16 v[48:51], a[232:235], a[64:67], v[48:51]
v_mfma_f32_16x16x32_bf16 v[48:51], a[236:239], a[68:71], v[48:51]
ds_read_b128 a[224:227], v4 offset:54272
v_mfma_f32_16x16x32_bf16 v[52:55], a[232:235], a[136:139], v[52:55]
v_mfma_f32_16x16x32_bf16 v[52:55], a[236:239], a[140:143], v[52:55]
ds_read_b128 a[228:231], v4 offset:61440
s_waitcnt lgkmcnt(4)
v_mfma_f32_16x16x32_bf16 v[56:59], a[240:243], a[64:67], v[56:59]
v_mfma_f32_16x16x32_bf16 v[56:59], a[244:247], a[68:71], v[56:59]
ds_read_b128 a[232:235], v4 offset:55296
v_mfma_f32_16x16x32_bf16 v[60:63], a[240:243], a[136:139], v[60:63]
v_mfma_f32_16x16x32_bf16 v[60:63], a[244:247], a[140:143], v[60:63]
ds_read_b128 a[236:239], v4 offset:62464
s_waitcnt lgkmcnt(4)
v_mfma_f32_16x16x32_bf16 v[64:67], a[216:219], a[64:67], v[64:67]
v_mfma_f32_16x16x32_bf16 v[64:67], a[220:223], a[68:71], v[64:67]
ds_read_b128 a[240:243], v7 offset:49152
v_mfma_f32_16x16x32_bf16 v[68:71], a[216:219], a[136:139], v[68:71]
v_mfma_f32_16x16x32_bf16 v[68:71], a[220:223], a[140:143], v[68:71]
ds_read_b128 a[244:247], v7 offset:56320
s_waitcnt lgkmcnt(4)
v_mfma_f32_16x16x32_bf16 v[72:75], a[64:67], a[224:227], v[72:75]
v_mfma_f32_16x16x32_bf16 v[72:75], a[68:71], a[228:231], v[72:75]
ds_read_b128 a[216:219], v10 offset:49152
v_mfma_f32_16x16x32_bf16 v[76:79], a[136:139], a[224:227], v[76:79]
v_mfma_f32_16x16x32_bf16 v[76:79], a[140:143], a[228:231], v[76:79]
ds_read_b128 a[220:223], v10 offset:56320
s_waitcnt lgkmcnt(4)
v_mfma_f32_16x16x32_bf16 v[80:83], a[64:67], a[232:235], v[80:83]
v_mfma_f32_16x16x32_bf16 v[80:83], a[68:71], a[236:239], v[80:83]
v_mfma_f32_16x16x32_bf16 v[84:87], a[136:139], a[232:235], v[84:87]
v_mfma_f32_16x16x32_bf16 v[84:87], a[140:143], a[236:239], v[84:87]
s_waitcnt lgkmcnt(2)
v_mfma_f32_16x16x32_bf16 v[88:91], a[240:243], a[208:211], v[88:91]
v_mfma_f32_16x16x32_bf16 v[88:91], a[244:247], a[212:215], v[88:91]
s_waitcnt lgkmcnt(0)
v_mfma_f32_16x16x32_bf16 v[92:95], a[208:211], a[216:219], v[92:95]
v_mfma_f32_16x16x32_bf16 v[92:95], a[212:215], a[220:223], v[92:95]
s_branch L_att
L_last:
s_cmp_eq_u32 s4, 3
s_cbranch_scc1 L_epoch
v_and_b32 v6, 7, v1
v_lshrrev_b32 v7, 3, v1
s_and_b32 s23, s6, 1
s_lshl_b32 s23, s23, 3
v_add_u32 v8, s23, v6
v_lshlrev_b32 v8, 4, v8
v_lshl_add_u32 v4, v7, 8, v8
s_lshl_b32 s24, s5, 4
s_lshr_b32 s25, s6, 1
s_add_u32 s24, s24, s25
s_mul_i32 s20, s24, 18432
s_lshl_b32 s24, s5, 8
s_lshl_b32 s25, s6, 3
s_add_u32 s24, s24, s25
s_and_b32 s25, s24, 1023
s_lshl_b32 s25, s25, 1
s_lshr_b32 s24, s24, 10
s_add_u32 s24, s24, s25
s_mul_i32 s21, s24, 1152
v_mul_u32_u24 v8, 2304, v6
v_lshl_add_u32 v5, v7, 4, v8
s_load_dwordx2 s[12:13], s[0:1], 56
s_waitcnt lgkmcnt(0)
s_mov_b32 s16, s12
s_and_b32 s17, s13, 0xffff
s_mov_b32 s18, 2359296
s_mov_b32 s19, 0x20000
s_lshl_b32 s22, s4, 2
s_lshr_b32 s23, 1056, s22
s_and_b32 s23, s23, 15
s_lshl_b32 s24, s23, 11
s_add_u32 s28, s20, s24
s_lshl_b32 s24, s23, 7
s_add_u32 s31, s21, s24
s_lshr_b32 s23, 790, s22
s_and_b32 s23, s23, 15
s_lshl_b32 s24, s23, 11
s_add_u32 s29, s20, s24
s_lshl_b32 s24, s23, 7
s_add_u32 s32, s21, s24
s_lshr_b32 s23, 2165, s22
s_and_b32 s23, s23, 15
s_lshl_b32 s24, s23, 11
s_add_u32 s30, s20, s24
s_lshl_b32 s24, s23, 7
s_add_u32 s33, s21, s24
s_lshl_b32 s26, s5, 12
s_add_u32 s27, s26, 1966080
s_add_u32 s26, s26, 1703936
v_and_b32 v6, 31, v1
v_lshlrev_b32 v6, 7, v6
buffer_load_dwordx2 v[10:11], v6, s[8:11], s27 offen sc1
v_mov_b32 v13, 2146435072
v_cmp_gt_u32 vcc, 16, v0
v_lshlrev_b32 v14, 3, v0
s_nop 0
v_cndmask_b32 v13, v13, v14, vcc
v_mov_b32 v14, s68
v_mov_b32 v15, s69
s_waitcnt vmcnt(0)
s_barrier
buffer_store_dwordx2 v[14:15], v13, s[8:11], s14 offen sc1
s_add_u32 s24, s28, 39485440
buffer_load_dwordx4 v[16:19], v4, s[8:11], s24 offen sc1
s_add_u32 s25, s29, 39485440
buffer_load_dwordx4 v[20:23], v4, s[8:11], s25 offen sc1
s_add_u32 s24, s30, 39485440
buffer_load_dwordx4 v[24:27], v4, s[8:11], s24 offen sc1
v_cmp_eq_u64 vcc, s[68:69], v[10:11]
s_nop 0
s_cmp_eq_u64 vcc, exec
s_cbranch_scc0 L_re_slow8
L_re_back8:
s_add_u32 s25, s28, 98729984
buffer_load_dwordx4 v[28:31], v4, s[8:11], s25 offen sc1
s_add_u32 s24, s28, 101089280
buffer_load_dwordx4 v[40:43], v4, s[8:11], s24 offen sc1
s_add_u32 s25, s28, 103448576
buffer_load_dwordx4 v[52:55], v4, s[8:11], s25 offen sc1
s_add_u32 s24, s28, 105807872
buffer_load_dwordx4 v[64:67], v4, s[8:11], s24 offen sc1
s_add_u32 s25, s28, 108167168
buffer_load_dwordx4 v[76:79], v4, s[8:11], s25 offen sc1
s_add_u32 s24, s28, 110526464
buffer_load_dwordx4 v[88:91], v4, s[8:11], s24 offen sc1
s_add_u32 s25, s28, 112885760
buffer_load_dwordx4 v[100:103], v4, s[8:11], s25 offen sc1
s_add_u32 s24, s28, 115245056
buffer_load_dwordx4 v[112:115], v4, s[8:11], s24 offen sc1
s_mov_b32 s52, 0
L_poll10:
buffer_load_dwordx2 v[14:15], v6, s[8:11], s26 offen sc1
s_add_u32 s52, s52, 1
s_waitcnt vmcnt(0)
v_cmp_ne_u64 vcc, s[68:69], v[14:15]
s_cmp_ge_u32 s52, 1048576
s_cbranch_scc1 L_got10
s_and_b64 exec, exec, vcc
s_cbranch_execnz L_poll10
L_got10:
s_mov_b64 exec, -1
s_add_u32 s24, s29, 98729984
buffer_load_dwordx4 v[32:35], v4, s[8:11], s24 offen sc1
s_add_u32 s25, s30, 98729984
buffer_load_dwordx4 v[36:39], v4, s[8:11], s25 offen sc1
s_add_u32 s25, s29, 101089280
buffer_load_dwordx4 v[44:47], v4, s[8:11], s25 offen sc1
s_add_u32 s24, s30, 101089280
buffer_load_dwordx4 v[48:51], v4, s[8:11], s24 offen sc1
s_add_u32 s24, s29, 103448576
buffer_load_dwordx4 v[56:59], v4, s[8:11], s24 offen sc1
s_add_u32 s25, s30, 103448576
buffer_load_dwordx4 v[60:63], v4, s[8:11], s25 offen sc1
s_add_u32 s25, s29, 105807872
buffer_load_dwordx4 v[68:71], v4, s[8:11], s25 offen sc1
s_add_u32 s24, s30, 105807872
buffer_load_dwordx4 v[72:75], v4, s[8:11], s24 offen sc1
s_add_u32 s24, s29, 108167168
buffer_load_dwordx4 v[80:83], v4, s[8:11], s24 offen sc1
s_add_u32 s25, s30, 108167168
buffer_load_dwordx4 v[84:87], v4, s[8:11], s25 offen sc1
s_add_u32 s25, s29, 110526464
buffer_load_dwordx4 v[92:95], v4, s[8:11], s25 offen sc1
s_add_u32 s24, s30, 110526464
buffer_load_dwordx4 v[96:99], v4, s[8:11], s24 offen sc1
s_add_u32 s24, s29, 112885760
buffer_load_dwordx4 v[104:107], v4, s[8:11], s24 offen sc1
s_add_u32 s25, s30, 112885760
buffer_load_dwordx4 v[108:111], v4, s[8:11], s25 offen sc1
s_add_u32 s25, s29, 115245056
buffer_load_dwordx4 v[116:119], v4, s[8:11], s25 offen sc1
s_add_u32 s24, s30, 115245056
buffer_load_dwordx4 v[120:123], v4, s[8:11], s24 offen sc1
s_waitcnt vmcnt(26)
v_lshlrev_b32 v128, 16, v16
v_and_b32 v129, 0xffff0000, v16
v_lshlrev_b32 v130, 16, v17
v_and_b32 v131, 0xffff0000, v17
v_lshlrev_b32 v132, 16, v18
v_and_b32 v133, 0xffff0000, v18
v_lshlrev_b32 v134, 16, v19
v_and_b32 v135, 0xffff0000, v19
s_waitcnt vmcnt(25)
v_lshlrev_b32 v136, 16, v20
v_and_b32 v137, 0xffff0000, v20
v_lshlrev_b32 v138, 16, v21
v_and_b32 v139, 0xffff0000, v21
v_lshlrev_b32 v140, 16, v22
v_and_b32 v141, 0xffff0000, v22
v_lshlrev_b32 v142, 16, v23
v_and_b32 v143, 0xffff0000, v23
s_waitcnt vmcnt(24)
v_lshlrev_b32 v144, 16, v24
v_and_b32 v145, 0xffff0000, v24
v_lshlrev_b32 v146, 16, v25
v_and_b32 v147, 0xffff0000, v25
v_lshlrev_b32 v148, 16, v26
v_and_b32 v149, 0xffff0000, v26
v_lshlrev_b32 v150, 16, v27
v_and_b32 v151, 0xffff0000, v27
s_waitcnt vmcnt(23)
v_lshlrev_b32 v6, 16, v28
v_and_b32 v7, 0xffff0000, v28
v_add_f32 v128, v128, v6
v_add_f32 v129, v129, v7
v_lshlrev_b32 v8, 16, v29
v_and_b32 v9, 0xffff0000, v29
v_add_f32 v130, v130, v8
v_add_f32 v131, v131, v9
v_lshlrev_b32 v6, 16, v30
v_and_b32 v7, 0xffff0000, v30
v_add_f32 v132, v132, v6
v_add_f32 v133, v133, v7
v_lshlrev_b32 v8, 16, v31
v_and_b32 v9, 0xffff0000, v31
v_add_f32 v134, v134, v8
v_add_f32 v135, v135, v9
s_waitcnt vmcnt(22)
v_lshlrev_b32 v6, 16, v40
v_and_b32 v7, 0xffff0000, v40
v_add_f32 v128, v128, v6
v_add_f32 v129, v129, v7
v_lshlrev_b32 v8, 16, v41
v_and_b32 v9, 0xffff0000, v41
v_add_f32 v130, v130, v8
v_add_f32 v131, v131, v9
v_lshlrev_b32 v6, 16, v42
v_and_b32 v7, 0xffff0000, v42
v_add_f32 v132, v132, v6
v_add_f32 v133, v133, v7
v_lshlrev_b32 v8, 16, v43
v_and_b32 v9, 0xffff0000, v43
v_add_f32 v134, v134, v8
v_add_f32 v135, v135, v9
s_waitcnt vmcnt(21)
v_lshlrev_b32 v6, 16, v52
v_and_b32 v7, 0xffff0000, v52
v_add_f32 v128, v128, v6
v_add_f32 v129, v129, v7
v_lshlrev_b32 v8, 16, v53
v_and_b32 v9, 0xffff0000, v53
v_add_f32 v130, v130, v8
v_add_f32 v131, v131, v9
v_lshlrev_b32 v6, 16, v54
v_and_b32 v7, 0xffff0000, v54
v_add_f32 v132, v132, v6
v_add_f32 v133, v133, v7
v_lshlrev_b32 v8, 16, v55
v_and_b32 v9, 0xffff0000, v55
v_add_f32 v134, v134, v8
v_add_f32 v135, v135, v9
s_waitcnt vmcnt(20)
v_lshlrev_b32 v6, 16, v64
v_and_b32 v7, 0xffff0000, v64
v_add_f32 v128, v128, v6
v_add_f32 v129, v129, v7
v_lshlrev_b32 v8, 16, v65
v_and_b32 v9, 0xffff0000, v65
v_add_f32 v130, v130, v8
v_add_f32 v131, v131, v9
v_lshlrev_b32 v6, 16, v66
v_and_b32 v7, 0xffff0000, v66
v_add_f32 v132, v132, v6
v_add_f32 v133, v133, v7
v_lshlrev_b32 v8, 16, v67
v_and_b32 v9, 0xffff0000, v67
v_add_f32 v134, v134, v8
v_add_f32 v135, v135, v9
s_waitcnt vmcnt(19)
v_lshlrev_b32 v6, 16, v76
v_and_b32 v7, 0xffff0000, v76
v_add_f32 v128, v128, v6
v_add_f32 v129, v129, v7
v_lshlrev_b32 v8, 16, v77
v_and_b32 v9, 0xffff0000, v77
v_add_f32 v130, v130, v8
v_add_f32 v131, v131, v9
v_lshlrev_b32 v6, 16, v78
v_and_b32 v7, 0xffff0000, v78
v_add_f32 v132, v132, v6
v_add_f32 v133, v133, v7
v_lshlrev_b32 v8, 16, v79
v_and_b32 v9, 0xffff0000, v79
v_add_f32 v134, v134, v8
v_add_f32 v135, v135, v9
s_waitcnt vmcnt(18)
v_lshlrev_b32 v6, 16, v88
v_and_b32 v7, 0xffff0000, v88
v_add_f32 v128, v128, v6
v_add_f32 v129, v129, v7
v_lshlrev_b32 v8, 16, v89
v_and_b32 v9, 0xffff0000, v89
v_add_f32 v130, v130, v8
v_add_f32 v131, v131, v9
v_lshlrev_b32 v6, 16, v90
v_and_b32 v7, 0xffff0000, v90
v_add_f32 v132, v132, v6
v_add_f32 v133, v133, v7
v_lshlrev_b32 v8, 16, v91
v_and_b32 v9, 0xffff0000, v91
v_add_f32 v134, v134, v8
v_add_f32 v135, v135, v9
s_waitcnt vmcnt(17)
v_lshlrev_b32 v6, 16, v100
v_and_b32 v7, 0xffff0000, v100
v_add_f32 v128, v128, v6
v_add_f32 v129, v129, v7
v_lshlrev_b32 v8, 16, v101
v_and_b32 v9, 0xffff0000, v101
v_add_f32 v130, v130, v8
v_add_f32 v131, v131, v9
v_lshlrev_b32 v6, 16, v102
v_and_b32 v7, 0xffff0000, v102
v_add_f32 v132, v132, v6
v_add_f32 v133, v133, v7
v_lshlrev_b32 v8, 16, v103
v_and_b32 v9, 0xffff0000, v103
v_add_f32 v134, v134, v8
v_add_f32 v135, v135, v9
s_waitcnt vmcnt(16)
v_lshlrev_b32 v6, 16, v112
v_and_b32 v7, 0xffff0000, v112
v_add_f32 v128, v128, v6
v_add_f32 v129, v129, v7
v_lshlrev_b32 v8, 16, v113
v_and_b32 v9, 0xffff0000, v113
v_add_f32 v130, v130, v8
v_add_f32 v131, v131, v9
v_lshlrev_b32 v6, 16, v114
v_and_b32 v7, 0xffff0000, v114
v_add_f32 v132, v132, v6
v_add_f32 v133, v133, v7
v_lshlrev_b32 v8, 16, v115
v_and_b32 v9, 0xffff0000, v115
v_add_f32 v134, v134, v8
v_add_f32 v135, v135, v9
s_waitcnt vmcnt(15)
v_lshlrev_b32 v6, 16, v32
v_and_b32 v7, 0xffff0000, v32
v_add_f32 v136, v136, v6
v_add_f32 v137, v137, v7
v_lshlrev_b32 v8, 16, v33
v_and_b32 v9, 0xffff0000, v33
v_add_f32 v138, v138, v8
v_add_f32 v139, v139, v9
v_lshlrev_b32 v6, 16, v34
v_and_b32 v7, 0xffff0000, v34
v_add_f32 v140, v140, v6
v_add_f32 v141, v141, v7
v_lshlrev_b32 v8, 16, v35
v_and_b32 v9, 0xffff0000, v35
v_add_f32 v142, v142, v8
v_add_f32 v143, v143, v9
s_waitcnt vmcnt(14)
v_lshlrev_b32 v6, 16, v36
v_and_b32 v7, 0xffff0000, v36
v_add_f32 v144, v144, v6
v_add_f32 v145, v145, v7
v_lshlrev_b32 v8, 16, v37
v_and_b32 v9, 0xffff0000, v37
v_add_f32 v146, v146, v8
v_add_f32 v147, v147, v9
v_lshlrev_b32 v6, 16, v38
v_and_b32 v7, 0xffff0000, v38
v_add_f32 v148, v148, v6
v_add_f32 v149, v149, v7
v_lshlrev_b32 v8, 16, v39
v_and_b32 v9, 0xffff0000, v39
v_add_f32 v150, v150, v8
v_add_f32 v151, v151, v9
s_waitcnt vmcnt(13)
v_lshlrev_b32 v6, 16, v44
v_and_b32 v7, 0xffff0000, v44
v_add_f32 v136, v136, v6
v_add_f32 v137, v137, v7
v_lshlrev_b32 v8, 16, v45
v_and_b32 v9, 0xffff0000, v45
v_add_f32 v138, v138, v8
v_add_f32 v139, v139, v9
v_lshlrev_b32 v6, 16, v46
v_and_b32 v7, 0xffff0000, v46
v_add_f32 v140, v140, v6
v_add_f32 v141, v141, v7
v_lshlrev_b32 v8, 16, v47
v_and_b32 v9, 0xffff0000, v47
v_add_f32 v142, v142, v8
v_add_f32 v143, v143, v9
s_waitcnt vmcnt(12)
v_lshlrev_b32 v6, 16, v48
v_and_b32 v7, 0xffff0000, v48
v_add_f32 v144, v144, v6
v_add_f32 v145, v145, v7
v_lshlrev_b32 v8, 16, v49
v_and_b32 v9, 0xffff0000, v49
v_add_f32 v146, v146, v8
v_add_f32 v147, v147, v9
v_lshlrev_b32 v6, 16, v50
v_and_b32 v7, 0xffff0000, v50
v_add_f32 v148, v148, v6
v_add_f32 v149, v149, v7
v_lshlrev_b32 v8, 16, v51
v_and_b32 v9, 0xffff0000, v51
v_add_f32 v150, v150, v8
v_add_f32 v151, v151, v9
s_waitcnt vmcnt(11)
v_lshlrev_b32 v6, 16, v56
v_and_b32 v7, 0xffff0000, v56
v_add_f32 v136, v136, v6
v_add_f32 v137, v137, v7
v_lshlrev_b32 v8, 16, v57
v_and_b32 v9, 0xffff0000, v57
v_add_f32 v138, v138, v8
v_add_f32 v139, v139, v9
v_lshlrev_b32 v6, 16, v58
v_and_b32 v7, 0xffff0000, v58
v_add_f32 v140, v140, v6
v_add_f32 v141, v141, v7
v_lshlrev_b32 v8, 16, v59
v_and_b32 v9, 0xffff0000, v59
v_add_f32 v142, v142, v8
v_add_f32 v143, v143, v9
s_waitcnt vmcnt(10)
v_lshlrev_b32 v6, 16, v60
v_and_b32 v7, 0xffff0000, v60
v_add_f32 v144, v144, v6
v_add_f32 v145, v145, v7
v_lshlrev_b32 v8, 16, v61
v_and_b32 v9, 0xffff0000, v61
v_add_f32 v146, v146, v8
v_add_f32 v147, v147, v9
v_lshlrev_b32 v6, 16, v62
v_and_b32 v7, 0xffff0000, v62
v_add_f32 v148, v148, v6
v_add_f32 v149, v149, v7
v_lshlrev_b32 v8, 16, v63
v_and_b32 v9, 0xffff0000, v63
v_add_f32 v150, v150, v8
v_add_f32 v151, v151, v9
s_waitcnt vmcnt(9)
v_lshlrev_b32 v6, 16, v68
v_and_b32 v7, 0xffff0000, v68
v_add_f32 v136, v136, v6
v_add_f32 v137, v137, v7
v_lshlrev_b32 v8, 16, v69
v_and_b32 v9, 0xffff0000, v69
v_add_f32 v138, v138, v8
v_add_f32 v139, v139, v9
v_lshlrev_b32 v6, 16, v70
v_and_b32 v7, 0xffff0000, v70
v_add_f32 v140, v140, v6
v_add_f32 v141, v141, v7
v_lshlrev_b32 v8, 16, v71
v_and_b32 v9, 0xffff0000, v71
v_add_f32 v142, v142, v8
v_add_f32 v143, v143, v9
s_waitcnt vmcnt(8)
v_lshlrev_b32 v6, 16, v72
v_and_b32 v7, 0xffff0000, v72
v_add_f32 v144, v144, v6
v_add_f32 v145, v145, v7
v_lshlrev_b32 v8, 16, v73
v_and_b32 v9, 0xffff0000, v73
v_add_f32 v146, v146, v8
v_add_f32 v147, v147, v9
v_lshlrev_b32 v6, 16, v74
v_and_b32 v7, 0xffff0000, v74
v_add_f32 v148, v148, v6
v_add_f32 v149, v149, v7
v_lshlrev_b32 v8, 16, v75
v_and_b32 v9, 0xffff0000, v75
v_add_f32 v150, v150, v8
v_add_f32 v151, v151, v9
s_waitcnt vmcnt(7)
v_lshlrev_b32 v6, 16, v80
v_and_b32 v7, 0xffff0000, v80
v_add_f32 v136, v136, v6
v_add_f32 v137, v137, v7
v_lshlrev_b32 v8, 16, v81
v_and_b32 v9, 0xffff0000, v81
v_add_f32 v138, v138, v8
v_add_f32 v139, v139, v9
v_lshlrev_b32 v6, 16, v82
v_and_b32 v7, 0xffff0000, v82
v_add_f32 v140, v140, v6
v_add_f32 v141, v141, v7
v_lshlrev_b32 v8, 16, v83
v_and_b32 v9, 0xffff0000, v83
v_add_f32 v142, v142, v8
v_add_f32 v143, v143, v9
s_waitcnt vmcnt(6)
v_lshlrev_b32 v6, 16, v84
v_and_b32 v7, 0xffff0000, v84
v_add_f32 v144, v144, v6
v_add_f32 v145, v145, v7
v_lshlrev_b32 v8, 16, v85
v_and_b32 v9, 0xffff0000, v85
v_add_f32 v146, v146, v8
v_add_f32 v147, v147, v9
v_lshlrev_b32 v6, 16, v86
v_and_b32 v7, 0xffff0000, v86
v_add_f32 v148, v148, v6
v_add_f32 v149, v149, v7
v_lshlrev_b32 v8, 16, v87
v_and_b32 v9, 0xffff0000, v87
v_add_f32 v150, v150, v8
v_add_f32 v151, v151, v9
s_waitcnt vmcnt(5)
v_lshlrev_b32 v6, 16, v92
v_and_b32 v7, 0xffff0000, v92
v_add_f32 v136, v136, v6
v_add_f32 v137, v137, v7
v_lshlrev_b32 v8, 16, v93
v_and_b32 v9, 0xffff0000, v93
v_add_f32 v138, v138, v8
v_add_f32 v139, v139, v9
v_lshlrev_b32 v6, 16, v94
v_and_b32 v7, 0xffff0000, v94
v_add_f32 v140, v140, v6
v_add_f32 v141, v141, v7
v_lshlrev_b32 v8, 16, v95
v_and_b32 v9, 0xffff0000, v95
v_add_f32 v142, v142, v8
v_add_f32 v143, v143, v9
s_waitcnt vmcnt(4)
v_lshlrev_b32 v6, 16, v96
v_and_b32 v7, 0xffff0000, v96
v_add_f32 v144, v144, v6
v_add_f32 v145, v145, v7
v_lshlrev_b32 v8, 16, v97
v_and_b32 v9, 0xffff0000, v97
v_add_f32 v146, v146, v8
v_add_f32 v147, v147, v9
v_lshlrev_b32 v6, 16, v98
v_and_b32 v7, 0xffff0000, v98
v_add_f32 v148, v148, v6
v_add_f32 v149, v149, v7
v_lshlrev_b32 v8, 16, v99
v_and_b32 v9, 0xffff0000, v99
v_add_f32 v150, v150, v8
v_add_f32 v151, v151, v9
s_waitcnt vmcnt(3)
v_lshlrev_b32 v6, 16, v104
v_and_b32 v7, 0xffff0000, v104
v_add_f32 v136, v136, v6
v_add_f32 v137, v137, v7
v_lshlrev_b32 v8, 16, v105
v_and_b32 v9, 0xffff0000, v105
v_add_f32 v138, v138, v8
v_add_f32 v139, v139, v9
v_lshlrev_b32 v6, 16, v106
v_and_b32 v7, 0xffff0000, v106
v_add_f32 v140, v140, v6
v_add_f32 v141, v141, v7
v_lshlrev_b32 v8, 16, v107
v_and_b32 v9, 0xffff0000, v107
v_add_f32 v142, v142, v8
v_add_f32 v143, v143, v9
s_waitcnt vmcnt(2)
v_lshlrev_b32 v6, 16, v108
v_and_b32 v7, 0xffff0000, v108
v_add_f32 v144, v144, v6
v_add_f32 v145, v145, v7
v_lshlrev_b32 v8, 16, v109
v_and_b32 v9, 0xffff0000, v109
v_add_f32 v146, v146, v8
v_add_f32 v147, v147, v9
v_lshlrev_b32 v6, 16, v110
v_and_b32 v7, 0xffff0000, v110
v_add_f32 v148, v148, v6
v_add_f32 v149, v149, v7
v_lshlrev_b32 v8, 16, v111
v_and_b32 v9, 0xffff0000, v111
v_add_f32 v150, v150, v8
v_add_f32 v151, v151, v9
s_waitcnt vmcnt(1)
v_lshlrev_b32 v6, 16, v116
v_and_b32 v7, 0xffff0000, v116
v_add_f32 v136, v136, v6
v_add_f32 v137, v137, v7
v_lshlrev_b32 v8, 16, v117
v_and_b32 v9, 0xffff0000, v117
v_add_f32 v138, v138, v8
v_add_f32 v139, v139, v9
v_lshlrev_b32 v6, 16, v118
v_and_b32 v7, 0xffff0000, v118
v_add_f32 v140, v140, v6
v_add_f32 v141, v141, v7
v_lshlrev_b32 v8, 16, v119
v_and_b32 v9, 0xffff0000, v119
v_add_f32 v142, v142, v8
v_add_f32 v143, v143, v9
s_waitcnt vmcnt(0)
v_lshlrev_b32 v6, 16, v120
v_and_b32 v7, 0xffff0000, v120
v_add_f32 v144, v144, v6
v_add_f32 v145, v145, v7
v_lshlrev_b32 v8, 16, v121
v_and_b32 v9, 0xffff0000, v121
v_add_f32 v146, v146, v8
v_add_f32 v147, v147, v9
v_lshlrev_b32 v6, 16, v122
v_and_b32 v7, 0xffff0000, v122
v_add_f32 v148, v148, v6
v_add_f32 v149, v149, v7
v_lshlrev_b32 v8, 16, v123
v_and_b32 v9, 0xffff0000, v123
v_add_f32 v150, v150, v8
v_add_f32 v151, v151, v9
v_cvt_pk_bf16_f32 v152, v128, v129
v_cvt_pk_bf16_f32 v153, v130, v131
v_cvt_pk_bf16_f32 v154, v132, v133
v_cvt_pk_bf16_f32 v155, v134, v135
v_cvt_pk_bf16_f32 v156, v136, v137
v_cvt_pk_bf16_f32 v157, v138, v139
v_cvt_pk_bf16_f32 v158, v140, v141
v_cvt_pk_bf16_f32 v159, v142, v143
v_cvt_pk_bf16_f32 v160, v144, v145
v_cvt_pk_bf16_f32 v161, v146, v147
v_cvt_pk_bf16_f32 v162, v148, v149
v_cvt_pk_bf16_f32 v163, v150, v151
buffer_store_dwordx4 v[152:155], v5, s[16:19], s31 offen
buffer_store_dwordx4 v[156:159], v5, s[16:19], s32 offen
buffer_store_dwordx4 v[160:163], v5, s[16:19], s33 offen
L_end:
s_endpgm
L_f_slow1:
s_mov_b32 s52, 0
L_f_spin1:
buffer_load_dwordx2 v[14:15], v11, s[8:11], s23 offen sc1
s_add_u32 s52, s52, 1
s_waitcnt vmcnt(0)
v_cmp_eq_u64 vcc, s[68:69], v[14:15]
s_cmp_gt_u32 s52, 1048576
s_cbranch_scc1 L_f_back1
s_cmp_eq_u64 vcc, exec
s_cbranch_scc0 L_f_spin1
s_branch L_f_back1
L_f_slow2:
s_mov_b32 s52, 0
L_f_spin2:
buffer_load_dwordx2 v[14:15], v11, s[8:11], s23 offen sc1
s_add_u32 s52, s52, 1
s_waitcnt vmcnt(0)
v_cmp_eq_u64 vcc, s[68:69], v[14:15]
s_cmp_gt_u32 s52, 1048576
s_cbranch_scc1 L_f_back2
s_cmp_eq_u64 vcc, exec
s_cbranch_scc0 L_f_spin2
s_branch L_f_back2
L_f_slow3:
s_mov_b32 s52, 0
L_f_spin3:
buffer_load_dwordx2 v[14:15], v11, s[8:11], s23 offen sc1
s_add_u32 s52, s52, 1
s_waitcnt vmcnt(0)
v_cmp_eq_u64 vcc, s[68:69], v[14:15]
s_cmp_gt_u32 s52, 1048576
s_cbranch_scc1 L_f_back3
s_cmp_eq_u64 vcc, exec
s_cbranch_scc0 L_f_spin3
s_branch L_f_back3
L_re_slow4:
s_mov_b32 s52, 0
L_poll5:
buffer_load_dwordx2 v[14:15], v6, s[8:11], s27 offen sc1
s_add_u32 s52, s52, 1
s_waitcnt vmcnt(0)
v_cmp_ne_u64 vcc, s[68:69], v[14:15]
s_cmp_ge_u32 s52, 1048576
s_cbranch_scc1 L_got5
s_and_b64 exec, exec, vcc
s_cbranch_execnz L_poll5
L_got5:
s_mov_b64 exec, -1
s_branch L_re_back4
L_re_slow8:
s_mov_b32 s52, 0
L_poll9:
buffer_load_dwordx2 v[14:15], v6, s[8:11], s27 offen sc1
s_add_u32 s52, s52, 1
s_waitcnt vmcnt(0)
v_cmp_ne_u64 vcc, s[68:69], v[14:15]
s_cmp_ge_u32 s52, 1048576
s_cbranch_scc1 L_got9
s_and_b64 exec, exec, vcc
s_cbranch_execnz L_poll9
L_got9:
s_mov_b64 exec, -1
s_branch L_re_back8
L_epoch:
v_mov_b32 v13, 2146435072
v_cmp_gt_u32 vcc, 16, v0
v_lshlrev_b32 v14, 3, v0
s_nop 0
v_cndmask_b32 v13, v13, v14, vcc
v_mov_b32 v14, s68
v_mov_b32 v15, s69
s_waitcnt vmcnt(0)
s_barrier
buffer_store_dwordx2 v[14:15], v13, s[8:11], s14 offen sc1
s_cmp_lg_u32 s2, 0
s_cbranch_scc1 L_end
v_lshlrev_b32 v4, 7, v1
s_mov_b32 s40, 786432
s_mov_b32 s52, 0
L_poll11:
buffer_load_dwordx2 v[14:15], v4, s[8:11], s40 offen sc1
s_add_u32 s52, s52, 1
s_waitcnt vmcnt(0)
v_cmp_ne_u64 vcc, s[68:69], v[14:15]
s_cmp_ge_u32 s52, 1048576
s_cbranch_scc1 L_got11
s_and_b64 exec, exec, vcc
s_cbranch_execnz L_poll11
L_got11:
s_mov_b64 exec, -1
s_mov_b32 s40, 794624
s_mov_b32 s52, 0
L_poll12:
buffer_load_dwordx2 v[14:15], v4, s[8:11], s40 offen sc1
s_add_u32 s52, s52, 1
s_waitcnt vmcnt(0)
v_cmp_ne_u64 vcc, s[68:69], v[14:15]
s_cmp_ge_u32 s52, 1048576
s_cbranch_scc1 L_got12
s_and_b64 exec, exec, vcc
s_cbranch_execnz L_poll12
L_got12:
s_mov_b64 exec, -1
s_mov_b32 s40, 802816
s_mov_b32 s52, 0
L_poll13:
buffer_load_dwordx2 v[14:15], v4, s[8:11], s40 offen sc1
s_add_u32 s52, s52, 1
s_waitcnt vmcnt(0)
v_cmp_ne_u64 vcc, s[68:69], v[14:15]
s_cmp_ge_u32 s52, 1048576
s_cbranch_scc1 L_got13
s_and_b64 exec, exec, vcc
s_cbranch_execnz L_poll13
L_got13:
s_mov_b64 exec, -1
s_mov_b32 s40, 811008
s_mov_b32 s52, 0
L_poll14:
buffer_load_dwordx2 v[14:15], v4, s[8:11], s40 offen sc1
s_add_u32 s52, s52, 1
s_waitcnt vmcnt(0)
v_cmp_ne_u64 vcc, s[68:69], v[14:15]
s_cmp_ge_u32 s52, 1048576
s_cbranch_scc1 L_got14
s_and_b64 exec, exec, vcc
s_cbranch_execnz L_poll14
L_got14:
s_mov_b64 exec, -1
s_mov_b32 s40, 4194304
v_mov_b32 v13, 2146435072
v_cmp_gt_u32 vcc, 16, v1
v_lshlrev_b32 v14, 3, v1
s_nop 0
v_cndmask_b32 v13, v13, v14, vcc
v_mov_b32 v14, s68
v_mov_b32 v15, s69
buffer_store_dwordx2 v[14:15], v13, s[8:11], s40 offen sc1
s_branch L_end
L_code_end:
s_endpgm
.section .rodata,"a"
.p2align 6
.amdhsa_kernel interleave_layers__sliding_local_dilated__glu_gated_geglu__prompt_kernel
  .amdhsa_next_free_vgpr 512
  .amdhsa_next_free_sgpr 102
  .amdhsa_accum_offset 256
  .amdhsa_group_segment_fixed_size 0
  .amdhsa_kernarg_size 80
  .amdhsa_user_sgpr_count 2
  .amdhsa_user_sgpr_kernarg_segment_ptr 1
  .amdhsa_system_sgpr_workgroup_id_x 1
.end_amdhsa_kernel
```

```asm
; @launch grid=(256,1,1) block=(256,1,1) lds=160768
.amdgcn_target "amdgcn-amd-amdhsa--gfx950"
.text
.p2align 8
.globl interleave_layers__sliding_local_dilated__glu_gated_geglu__prompt_kernel
.type interleave_layers__sliding_local_dilated__glu_gated_geglu__prompt_kernel,@function
interleave_layers__sliding_local_dilated__glu_gated_geglu__prompt_kernel:
s_cmp_ge_u32 s2, 256
s_cbranch_scc1 L_end
s_getpc_b64 s[40:41]
L_warm_pc:
s_lshr_b32 s42, s2, 3
s_lshl_b32 s42, s42, 11
v_lshlrev_b32 v10, 3, v0
v_add_u32 v10, s42, v10
v_min_u32 v10, L_code_end - L_warm_pc - 8, v10
v_mov_b32 v11, s41
v_add_co_u32 v10, vcc, s40, v10
s_nop 1
v_addc_co_u32 v11, vcc, 0, v11, vcc
global_load_dwordx2 a[0:1], v[10:11], off
v_add_co_u32 v10, vcc, 0x10000, v10
s_nop 1
v_addc_co_u32 v11, vcc, 0, v11, vcc
s_add_u32 s42, s42, 67584
s_cmp_le_u32 s42, L_code_end - L_warm_pc - 8
s_cbranch_scc0 L_warm_done
global_load_dwordx2 a[2:3], v[10:11], off
L_warm_done:
s_load_dwordx4 s[56:59], s[0:1], 0
s_load_dwordx2 s[60:61], s[0:1], 16
s_load_dwordx4 s[64:67], s[0:1], 32
s_load_dwordx2 s[62:63], s[0:1], 48
s_load_dwordx2 s[12:13], s[0:1], 72
v_and_b32 v1, 63, v0
v_lshrrev_b32 v3, 6, v0
v_lshlrev_b32 v2, 4, v1
v_readfirstlane_b32 s4, v3
s_and_b32 s5, s2, 7
s_lshr_b32 s6, s2, 3
s_waitcnt lgkmcnt(0)
s_mov_b32 s8, s12
s_and_b32 s9, s13, 0xffff
s_mov_b32 s10, 268435456
s_mov_b32 s11, 0x20000
s_mov_b32 s16, s56
s_and_b32 s17, s57, 0xffff
s_mov_b32 s18, 2359296
s_mov_b32 s19, 0x20000
v_mov_b32 v3, 4194304
buffer_load_dwordx2 v[14:15], v3, s[8:11], 0 offen sc1
v_and_b32 v6, 7, v1
v_lshrrev_b32 v7, 3, v1
s_and_b32 s23, s6, 1
s_lshl_b32 s23, s23, 3
v_add_u32 v8, s23, v6
v_lshlrev_b32 v8, 4, v8
v_lshl_add_u32 v4, v7, 8, v8
s_lshl_b32 s24, s5, 4
s_lshr_b32 s25, s6, 1
s_add_u32 s24, s24, s25
s_mul_i32 s20, s24, 18432
s_lshl_b32 s24, s5, 8
s_lshl_b32 s25, s6, 3
s_add_u32 s24, s24, s25
s_and_b32 s25, s24, 1023
s_lshl_b32 s25, s25, 1
s_lshr_b32 s24, s24, 10
s_add_u32 s24, s24, s25
s_mul_i32 s21, s24, 1152
v_mul_u32_u24 v8, 2304, v6
v_lshl_add_u32 v5, v7, 4, v8
s_lshl_b32 s22, s4, 2
s_lshr_b32 s23, 1056, s22
s_and_b32 s23, s23, 15
s_lshl_b32 s24, s23, 11
s_add_u32 s28, s20, s24
s_lshl_b32 s24, s23, 7
s_add_u32 s31, s21, s24
s_lshr_b32 s23, 790, s22
s_and_b32 s23, s23, 15
s_lshl_b32 s24, s23, 11
s_add_u32 s29, s20, s24
s_lshl_b32 s24, s23, 7
s_add_u32 s32, s21, s24
s_lshr_b32 s23, 2165, s22
s_and_b32 s23, s23, 15
s_lshl_b32 s24, s23, 11
s_add_u32 s30, s20, s24
s_lshl_b32 s24, s23, 7
s_add_u32 s33, s21, s24
s_cmp_eq_u32 s4, 3
s_cselect_b64 vcc, -1, 0
v_mov_b32 v8, 2146435072
v_cndmask_b32 v4, v4, v8, vcc
v_cndmask_b32 v5, v5, v8, vcc
buffer_load_dwordx4 v[16:19], v5, s[16:19], s31 offen nt
buffer_load_dwordx4 v[20:23], v5, s[16:19], s32 offen nt
buffer_load_dwordx4 v[24:27], v5, s[16:19], s33 offen nt
s_lshl_b32 s40, s6, 2
s_add_u32 s40, s40, s4
v_and_b32 v6, 15, v1
v_lshrrev_b32 v7, 4, v1
v_lshrrev_b32 v8, 2, v6
v_mov_b32 v12, 2146435072
s_cmp_ge_u32 s40, 84
s_cbranch_scc1 L_g_o
s_mov_b32 s44, s58
s_and_b32 s45, s59, 0xffff
s_mov_b32 s46, 1990656
s_mov_b32 s47, 0x20000
s_cmp_ge_u32 s40, 42
s_cselect_b32 s41, 1, 0
s_mul_i32 s42, s41, 42
s_sub_u32 s40, s40, s42
s_mul_i32 s40, s40, 3
s_lshl_b32 s42, s5, 1
s_add_u32 s41, s41, s42
s_mul_i32 s38, s41, 129024
s_lshl_b32 s42, s40, 10
s_add_u32 s38, s38, s42
s_add_u32 s38, s38, 4198400
s_mul_i32 s41, s41, 36
v_and_b32 v9, 1, v6
v_bfe_u32 v10, v6, 1, 1
v_mul_u32_u24 v10, 18, v10
v_add_u32 v9, v9, v10
v_mul_u32_u24 v10, 576, v8
v_add_u32 v9, v9, v10
v_mul_u32_u24 v10, 27648, v7
s_add_u32 s43, s40, 0
s_mul_i32 s42, s43, 9363
s_lshr_b32 s42, s42, 16
s_mul_i32 s35, s42, 7
s_sub_u32 s43, s43, s35
s_mul_i32 s42, s42, 110592
s_mov_b32 s35, 0
s_cmp_eq_u32 s43, 1
s_cselect_b32 s35, 18, s35
s_cmp_eq_u32 s43, 2
s_cselect_b32 s35, 576, s35
s_cmp_eq_u32 s43, 3
s_cselect_b32 s35, 594, s35
s_cmp_eq_u32 s43, 4
s_cselect_b32 s35, 16, s35
s_cmp_eq_u32 s43, 5
s_cselect_b32 s35, 1152, s35
s_cmp_eq_u32 s43, 6
s_cselect_b32 s35, 1170, s35
s_add_u32 s35, s35, s41
s_cmp_eq_u32 s43, 4
s_cselect_b32 s36, 12, 16
s_cselect_b64 vcc, -1, 0
v_cndmask_b32 v11, v6, v9, vcc
v_add_u32 v11, s35, v11
v_lshl_add_u32 v11, v11, 1, v10
v_cmp_gt_u32 vcc, s36, v6
s_nop 1
v_cndmask_b32 v11, v12, v11, vcc
buffer_load_ushort v52, v11, s[44:47], s42 offen
s_add_u32 s42, s42, 3456
buffer_load_ushort v53, v11, s[44:47], s42 offen
s_add_u32 s42, s42, 3456
buffer_load_ushort v54, v11, s[44:47], s42 offen
s_add_u32 s42, s42, 3456
buffer_load_ushort v55, v11, s[44:47], s42 offen
s_add_u32 s42, s42, 3456
buffer_load_ushort v56, v11, s[44:47], s42 offen
s_add_u32 s42, s42, 3456
buffer_load_ushort v57, v11, s[44:47], s42 offen
s_add_u32 s42, s42, 3456
buffer_load_ushort v58, v11, s[44:47], s42 offen
s_add_u32 s42, s42, 3456
buffer_load_ushort v59, v11, s[44:47], s42 offen
s_add_u32 s43, s40, 1
s_mul_i32 s42, s43, 9363
s_lshr_b32 s42, s42, 16
s_mul_i32 s35, s42, 7
s_sub_u32 s43, s43, s35
s_mul_i32 s42, s42, 110592
s_mov_b32 s35, 0
s_cmp_eq_u32 s43, 1
s_cselect_b32 s35, 18, s35
s_cmp_eq_u32 s43, 2
s_cselect_b32 s35, 576, s35
s_cmp_eq_u32 s43, 3
s_cselect_b32 s35, 594, s35
s_cmp_eq_u32 s43, 4
s_cselect_b32 s35, 16, s35
s_cmp_eq_u32 s43, 5
s_cselect_b32 s35, 1152, s35
s_cmp_eq_u32 s43, 6
s_cselect_b32 s35, 1170, s35
s_add_u32 s35, s35, s41
s_cmp_eq_u32 s43, 4
s_cselect_b32 s36, 12, 16
s_cselect_b64 vcc, -1, 0
v_cndmask_b32 v11, v6, v9, vcc
v_add_u32 v11, s35, v11
v_lshl_add_u32 v11, v11, 1, v10
v_cmp_gt_u32 vcc, s36, v6
s_nop 1
v_cndmask_b32 v11, v12, v11, vcc
buffer_load_ushort v60, v11, s[44:47], s42 offen
s_add_u32 s42, s42, 3456
buffer_load_ushort v61, v11, s[44:47], s42 offen
s_add_u32 s42, s42, 3456
buffer_load_ushort v62, v11, s[44:47], s42 offen
s_add_u32 s42, s42, 3456
buffer_load_ushort v63, v11, s[44:47], s42 offen
s_add_u32 s42, s42, 3456
buffer_load_ushort v64, v11, s[44:47], s42 offen
s_add_u32 s42, s42, 3456
buffer_load_ushort v65, v11, s[44:47], s42 offen
s_add_u32 s42, s42, 3456
buffer_load_ushort v66, v11, s[44:47], s42 offen
s_add_u32 s42, s42, 3456
buffer_load_ushort v67, v11, s[44:47], s42 offen
s_add_u32 s43, s40, 2
s_mul_i32 s42, s43, 9363
s_lshr_b32 s42, s42, 16
s_mul_i32 s35, s42, 7
s_sub_u32 s43, s43, s35
s_mul_i32 s42, s42, 110592
s_mov_b32 s35, 0
s_cmp_eq_u32 s43, 1
s_cselect_b32 s35, 18, s35
s_cmp_eq_u32 s43, 2
s_cselect_b32 s35, 576, s35
s_cmp_eq_u32 s43, 3
s_cselect_b32 s35, 594, s35
s_cmp_eq_u32 s43, 4
s_cselect_b32 s35, 16, s35
s_cmp_eq_u32 s43, 5
s_cselect_b32 s35, 1152, s35
s_cmp_eq_u32 s43, 6
s_cselect_b32 s35, 1170, s35
s_add_u32 s35, s35, s41
s_cmp_eq_u32 s43, 4
s_cselect_b32 s36, 12, 16
s_cselect_b64 vcc, -1, 0
v_cndmask_b32 v11, v6, v9, vcc
v_add_u32 v11, s35, v11
v_lshl_add_u32 v11, v11, 1, v10
v_cmp_gt_u32 vcc, s36, v6
s_nop 1
v_cndmask_b32 v11, v12, v11, vcc
buffer_load_ushort v68, v11, s[44:47], s42 offen
s_add_u32 s42, s42, 3456
buffer_load_ushort v69, v11, s[44:47], s42 offen
s_add_u32 s42, s42, 3456
buffer_load_ushort v70, v11, s[44:47], s42 offen
s_add_u32 s42, s42, 3456
buffer_load_ushort v71, v11, s[44:47], s42 offen
s_add_u32 s42, s42, 3456
buffer_load_ushort v72, v11, s[44:47], s42 offen
s_add_u32 s42, s42, 3456
buffer_load_ushort v73, v11, s[44:47], s42 offen
s_add_u32 s42, s42, 3456
buffer_load_ushort v74, v11, s[44:47], s42 offen
s_add_u32 s42, s42, 3456
buffer_load_ushort v75, v11, s[44:47], s42 offen
s_branch L_g_done
L_g_o:
s_mov_b32 s44, s60
s_and_b32 s45, s61, 0xffff
s_mov_b32 s46, 663552
s_mov_b32 s47, 0x20000
s_sub_u32 s40, s40, 84
s_mul_i32 s40, s40, 3
s_mul_i32 s38, s5, 92160
s_lshl_b32 s42, s40, 10
s_add_u32 s38, s38, s42
s_add_u32 s38, s38, 6266880
s_cmp_ge_u32 s40, 90
s_cselect_b32 s38, 2146435072, s38
s_mul_i32 s41, s5, 72
v_and_b32 v9, 3, v6
v_lshl_add_u32 v9, v8, 3, v9
s_add_u32 s42, s40, 0
s_mul_i32 s43, s42, 13108
s_lshr_b32 s43, s43, 16
s_mul_i32 s35, s43, 5
s_sub_u32 s42, s42, s35
s_lshr_b32 s35, s42, 1
s_lshl_b32 s35, s35, 5
s_and_b32 s36, s42, 1
s_lshl_b32 s36, s36, 2
s_add_u32 s35, s35, s36
s_add_u32 s35, s35, s41
s_cmp_eq_u32 s42, 4
s_cselect_b64 vcc, -1, 0
s_cselect_b32 s36, 8, 16
v_cndmask_b32 v11, v9, v6, vcc
v_add_u32 v11, s35, v11
s_mul_i32 s35, s43, 41472
s_sub_u32 s37, s43, 16
s_mul_i32 s37, s37, 331776
s_cmp_lt_u32 s43, 16
s_cselect_b32 s35, s35, s37
s_cselect_b32 s37, 4, 72
s_cselect_b32 s34, 0, 1
s_mul_i32 s37, s37, 1152
v_mul_lo_u32 v10, s37, v7
v_lshl_add_u32 v11, v11, 1, v10
v_cmp_gt_u32 vcc, s36, v6
s_nop 1
v_cndmask_b32 v11, v12, v11, vcc
s_mul_i32 s42, s34, 18432
s_add_u32 s42, s42, 0
s_add_u32 s42, s42, s35
buffer_load_ushort v52, v11, s[44:47], s42 offen
s_mul_i32 s42, s34, 18432
s_add_u32 s42, s42, 1152
s_add_u32 s42, s42, s35
buffer_load_ushort v53, v11, s[44:47], s42 offen
s_mul_i32 s42, s34, 36864
s_add_u32 s42, s42, 2304
s_add_u32 s42, s42, s35
buffer_load_ushort v54, v11, s[44:47], s42 offen
s_mul_i32 s42, s34, 36864
s_add_u32 s42, s42, 3456
s_add_u32 s42, s42, s35
buffer_load_ushort v55, v11, s[44:47], s42 offen
s_mul_i32 s42, s34, 39168
s_add_u32 s42, s42, 20736
s_add_u32 s42, s42, s35
buffer_load_ushort v56, v11, s[44:47], s42 offen
s_mul_i32 s42, s34, 39168
s_add_u32 s42, s42, 21888
s_add_u32 s42, s42, s35
buffer_load_ushort v57, v11, s[44:47], s42 offen
s_mul_i32 s42, s34, 57600
s_add_u32 s42, s42, 23040
s_add_u32 s42, s42, s35
buffer_load_ushort v58, v11, s[44:47], s42 offen
s_mul_i32 s42, s34, 57600
s_add_u32 s42, s42, 24192
s_add_u32 s42, s42, s35
buffer_load_ushort v59, v11, s[44:47], s42 offen
s_add_u32 s42, s40, 1
s_mul_i32 s43, s42, 13108
s_lshr_b32 s43, s43, 16
s_mul_i32 s35, s43, 5
s_sub_u32 s42, s42, s35
s_lshr_b32 s35, s42, 1
s_lshl_b32 s35, s35, 5
s_and_b32 s36, s42, 1
s_lshl_b32 s36, s36, 2
s_add_u32 s35, s35, s36
s_add_u32 s35, s35, s41
s_cmp_eq_u32 s42, 4
s_cselect_b64 vcc, -1, 0
s_cselect_b32 s36, 8, 16
v_cndmask_b32 v11, v9, v6, vcc
v_add_u32 v11, s35, v11
s_mul_i32 s35, s43, 41472
s_sub_u32 s37, s43, 16
s_mul_i32 s37, s37, 331776
s_cmp_lt_u32 s43, 16
s_cselect_b32 s35, s35, s37
s_cselect_b32 s37, 4, 72
s_cselect_b32 s34, 0, 1
s_mul_i32 s37, s37, 1152
v_mul_lo_u32 v10, s37, v7
v_lshl_add_u32 v11, v11, 1, v10
v_cmp_gt_u32 vcc, s36, v6
s_nop 1
v_cndmask_b32 v11, v12, v11, vcc
s_mul_i32 s42, s34, 18432
s_add_u32 s42, s42, 0
s_add_u32 s42, s42, s35
buffer_load_ushort v60, v11, s[44:47], s42 offen
s_mul_i32 s42, s34, 18432
s_add_u32 s42, s42, 1152
s_add_u32 s42, s42, s35
buffer_load_ushort v61, v11, s[44:47], s42 offen
s_mul_i32 s42, s34, 36864
s_add_u32 s42, s42, 2304
s_add_u32 s42, s42, s35
buffer_load_ushort v62, v11, s[44:47], s42 offen
s_mul_i32 s42, s34, 36864
s_add_u32 s42, s42, 3456
s_add_u32 s42, s42, s35
buffer_load_ushort v63, v11, s[44:47], s42 offen
s_mul_i32 s42, s34, 39168
s_add_u32 s42, s42, 20736
s_add_u32 s42, s42, s35
buffer_load_ushort v64, v11, s[44:47], s42 offen
s_mul_i32 s42, s34, 39168
s_add_u32 s42, s42, 21888
s_add_u32 s42, s42, s35
buffer_load_ushort v65, v11, s[44:47], s42 offen
s_mul_i32 s42, s34, 57600
s_add_u32 s42, s42, 23040
s_add_u32 s42, s42, s35
buffer_load_ushort v66, v11, s[44:47], s42 offen
s_mul_i32 s42, s34, 57600
s_add_u32 s42, s42, 24192
s_add_u32 s42, s42, s35
buffer_load_ushort v67, v11, s[44:47], s42 offen
s_add_u32 s42, s40, 2
s_mul_i32 s43, s42, 13108
s_lshr_b32 s43, s43, 16
s_mul_i32 s35, s43, 5
s_sub_u32 s42, s42, s35
s_lshr_b32 s35, s42, 1
s_lshl_b32 s35, s35, 5
s_and_b32 s36, s42, 1
s_lshl_b32 s36, s36, 2
s_add_u32 s35, s35, s36
s_add_u32 s35, s35, s41
s_cmp_eq_u32 s42, 4
s_cselect_b64 vcc, -1, 0
s_cselect_b32 s36, 8, 16
v_cndmask_b32 v11, v9, v6, vcc
v_add_u32 v11, s35, v11
s_mul_i32 s35, s43, 41472
s_sub_u32 s37, s43, 16
s_mul_i32 s37, s37, 331776
s_cmp_lt_u32 s43, 16
s_cselect_b32 s35, s35, s37
s_cselect_b32 s37, 4, 72
s_cselect_b32 s34, 0, 1
s_mul_i32 s37, s37, 1152
v_mul_lo_u32 v10, s37, v7
v_lshl_add_u32 v11, v11, 1, v10
v_cmp_gt_u32 vcc, s36, v6
s_nop 1
v_cndmask_b32 v11, v12, v11, vcc
s_mul_i32 s42, s34, 18432
s_add_u32 s42, s42, 0
s_add_u32 s42, s42, s35
buffer_load_ushort v68, v11, s[44:47], s42 offen
s_mul_i32 s42, s34, 18432
s_add_u32 s42, s42, 1152
s_add_u32 s42, s42, s35
buffer_load_ushort v69, v11, s[44:47], s42 offen
s_mul_i32 s42, s34, 36864
s_add_u32 s42, s42, 2304
s_add_u32 s42, s42, s35
buffer_load_ushort v70, v11, s[44:47], s42 offen
s_mul_i32 s42, s34, 36864
s_add_u32 s42, s42, 3456
s_add_u32 s42, s42, s35
buffer_load_ushort v71, v11, s[44:47], s42 offen
s_mul_i32 s42, s34, 39168
s_add_u32 s42, s42, 20736
s_add_u32 s42, s42, s35
buffer_load_ushort v72, v11, s[44:47], s42 offen
s_mul_i32 s42, s34, 39168
s_add_u32 s42, s42, 21888
s_add_u32 s42, s42, s35
buffer_load_ushort v73, v11, s[44:47], s42 offen
s_mul_i32 s42, s34, 57600
s_add_u32 s42, s42, 23040
s_add_u32 s42, s42, s35
buffer_load_ushort v74, v11, s[44:47], s42 offen
s_mul_i32 s42, s34, 57600
s_add_u32 s42, s42, 24192
s_add_u32 s42, s42, s35
buffer_load_ushort v75, v11, s[44:47], s42 offen
L_g_done:
s_cmp_ge_u32 s2, 144
s_cbranch_scc1 L_l1_d
s_mul_i32 s40, s2, 911
s_lshr_b32 s40, s40, 16
s_mul_i32 s41, s40, 72
s_sub_u32 s41, s2, s41
s_cmp_eq_u32 s40, 0
s_cselect_b64 s[12:13], s[64:65], s[66:67]
s_mov_b32 s48, s12
s_and_b32 s49, s13, 0xffff
s_mov_b32 s50, 5308416
s_mov_b32 s51, 0x20000
s_lshl_b32 s42, s41, 7
v_lshlrev_b32 v9, 3, v6
v_mul_u32_u24 v10, 73728, v7
v_add3_u32 v254, v9, v10, s42
s_bitcmp1_b32 s4, 0
s_cselect_b64 vcc, -1, 0
v_cndmask_b32 v255, v254, v12, vcc
s_mul_i32 s43, s4, 9
s_add_u32 s43, s43, 1
s_lshr_b32 s43, s43, 1
s_mul_i32 s53, s43, 294912
buffer_load_dwordx2 v[76:77], v254, s[48:51], s53 offen nt
s_add_u32 s53, s53, 9216
buffer_load_dwordx2 v[78:79], v254, s[48:51], s53 offen nt
s_add_u32 s53, s53, 9216
buffer_load_dwordx2 v[80:81], v254, s[48:51], s53 offen nt
s_add_u32 s53, s53, 9216
buffer_load_dwordx2 v[82:83], v254, s[48:51], s53 offen nt
s_add_u32 s53, s53, 9216
buffer_load_dwordx2 v[84:85], v254, s[48:51], s53 offen nt
s_add_u32 s53, s53, 9216
buffer_load_dwordx2 v[86:87], v254, s[48:51], s53 offen nt
s_add_u32 s53, s53, 9216
buffer_load_dwordx2 v[88:89], v254, s[48:51], s53 offen nt
s_add_u32 s53, s53, 9216
buffer_load_dwordx2 v[90:91], v254, s[48:51], s53 offen nt
s_add_u32 s53, s53, 230400
buffer_load_dwordx2 v[92:93], v254, s[48:51], s53 offen nt
s_add_u32 s53, s53, 9216
s_mul_i32 s42, s41, 7282
s_lshr_b32 s42, s42, 16
s_mul_i32 s35, s42, 9
s_sub_u32 s41, s41, s35
s_lshl_b32 s41, s41, 2
s_lshl_b32 s42, s42, 2
s_lshl_b32 s40, s40, 11
s_add_u32 s40, s40, 7012352
s_mov_b32 s35, 497664
v_and_b32 v6, 3, v1
v_add_u32 v6, s41, v6
v_mul_u32_u24 v7, 57, v6
v_lshrrev_b32 v7, 9, v7
v_mul_u32_u24 v8, 9, v7
v_sub_u32 v6, v6, v8
v_add_u32 v8, 1, v6
v_cmp_eq_u32 vcc, 9, v8
s_nop 1
v_cndmask_b32 v8, v8, 0, vcc
v_and_b32 v9, 1, v7
v_cmp_eq_u32 vcc, 0, v9
s_nop 1
v_cndmask_b32 v6, v6, v8, vcc
v_add_u32 v7, s42, v7
v_mul_lo_u32 v7, v7, s35
v_add_u32 v7, s40, v7
v_lshrrev_b32 v8, 2, v1
v_add_u32 v8, s43, v8
v_and_b32 v9, 1, v8
v_lshl_add_u32 v7, v9, 10, v7
v_lshrrev_b32 v9, 1, v8
v_lshlrev_b32 v9, 12, v9
v_add_u32 v7, v7, v9
v_lshl_add_u32 v9, v6, 12, v9
v_mul_u32_u24 v10, 36864, v6
v_cmp_gt_u32 vcc, 2, v6
s_nop 1
v_cndmask_b32 v9, v10, v9, vcc
v_add_u32 v7, v7, v9
v_cmp_gt_u32 vcc, 18, v8
s_nop 1
v_cndmask_b32 v7, v12, v7, vcc
s_bitcmp1_b32 s4, 0
s_cselect_b32 s41, 16, 20
v_cmp_gt_u32 vcc, s41, v1
s_nop 1
v_cndmask_b32 v7, v12, v7, vcc
s_nop 0
v_readlane_b32 s40, v7, 0
v_readlane_b32 s41, v7, 1
v_readlane_b32 s42, v7, 2
v_readlane_b32 s43, v7, 3
v_add_u32 v156, s40, v2
v_add_u32 v157, s41, v2
v_add_u32 v158, s42, v2
v_add_u32 v159, s43, v2
v_readlane_b32 s40, v7, 4
v_readlane_b32 s41, v7, 5
v_readlane_b32 s42, v7, 6
v_readlane_b32 s43, v7, 7
v_add_u32 v160, s40, v2
v_add_u32 v161, s41, v2
v_add_u32 v162, s42, v2
v_add_u32 v163, s43, v2
v_readlane_b32 s40, v7, 8
v_readlane_b32 s41, v7, 9
v_readlane_b32 s42, v7, 10
v_readlane_b32 s43, v7, 11
v_add_u32 v164, s40, v2
v_add_u32 v165, s41, v2
v_add_u32 v166, s42, v2
v_add_u32 v167, s43, v2
v_readlane_b32 s40, v7, 12
v_readlane_b32 s41, v7, 13
v_readlane_b32 s42, v7, 14
v_readlane_b32 s43, v7, 15
v_add_u32 v168, s40, v2
v_add_u32 v169, s41, v2
v_add_u32 v170, s42, v2
v_add_u32 v171, s43, v2
v_readlane_b32 s40, v7, 16
v_readlane_b32 s41, v7, 17
v_readlane_b32 s42, v7, 18
v_readlane_b32 s43, v7, 19
v_add_u32 v172, s40, v2
v_add_u32 v173, s41, v2
v_add_u32 v174, s42, v2
v_add_u32 v175, s43, v2
s_waitcnt vmcnt(33)
s_branch L_l1_e
L_l1_d:
s_cmp_ge_u32 s2, 216
s_cbranch_scc1 L_l1_n
s_mov_b32 s48, s62
s_and_b32 s49, s63, 0xffff
s_mov_b32 s50, 5308416
s_mov_b32 s51, 0x20000
s_sub_u32 s40, s2, 144
s_mul_i32 s53, s40, 73728
s_lshl_b32 s41, s4, 8
s_lshl_b32 s42, s4, 5
v_mul_u32_u24 v10, 18432, v7
v_lshl_add_u32 v9, v6, 3, v10
v_add_u32 v254, s41, v9
v_lshl_add_u32 v9, v6, 1, v10
v_add_u32 v255, s42, v9
s_add_u32 s43, s53, 0
buffer_load_dwordx2 v[76:77], v254, s[48:51], s43 offen offset:0 nt
buffer_load_dwordx2 v[92:93], v254, s[48:51], s43 offen offset:128 nt
buffer_load_ushort v108, v255, s[48:51], s43 offen offset:1024 nt
s_add_u32 s43, s53, 4608
buffer_load_dwordx2 v[78:79], v254, s[48:51], s43 offen offset:0 nt
buffer_load_dwordx2 v[94:95], v254, s[48:51], s43 offen offset:128 nt
buffer_load_ushort v109, v255, s[48:51], s43 offen offset:1024 nt
s_add_u32 s43, s53, 9216
buffer_load_dwordx2 v[80:81], v254, s[48:51], s43 offen offset:0 nt
buffer_load_dwordx2 v[96:97], v254, s[48:51], s43 offen offset:128 nt
buffer_load_ushort v110, v255, s[48:51], s43 offen offset:1024 nt
s_mul_i32 s41, s40, 7282
s_lshr_b32 s41, s41, 16
s_mul_i32 s42, s41, 9
s_sub_u32 s40, s40, s42
s_lshl_b32 s40, s40, 1
s_lshl_b32 s41, s41, 2
s_add_u32 s41, s41, s4
s_mul_i32 s41, s41, 497664
s_add_u32 s41, s41, 7344128
v_cmp_lt_u32 vcc, 8, v1
s_nop 1
v_cndmask_b32 v6, 0, 1, vcc
v_mul_u32_u24 v7, 9, v6
v_sub_u32 v7, v1, v7
v_add_u32 v6, s40, v6
v_mov_b32 v8, 0
v_cmp_lt_u32 vcc, 4, v6
s_nop 1
v_addc_co_u32 v8, vcc, 0, v8, vcc
v_cmp_lt_u32 vcc, 8, v6
s_nop 1
v_addc_co_u32 v8, vcc, 0, v8, vcc
v_cmp_lt_u32 vcc, 13, v6
s_nop 1
v_addc_co_u32 v8, vcc, 0, v8, vcc
v_mul_u32_u24 v9, 9, v8
v_add_u32 v9, 1, v9
v_lshrrev_b32 v9, 1, v9
v_sub_u32 v9, v6, v9
v_subrev_u32 v8, s4, v8
v_and_b32 v8, 3, v8
v_mul_u32_u24 v10, 3, v9
v_add3_u32 v10, v10, v8, 2
v_add_u32 v11, 3, v10
v_cmp_lt_u32 vcc, 1, v9
s_nop 1
v_cndmask_b32 v10, v10, v11, vcc
v_cmp_eq_u32 vcc, 3, v9
s_nop 1
v_cndmask_b32 v9, v9, 11, vcc
v_cmp_eq_u32 vcc, 0, v8
s_nop 1
v_cndmask_b32 v10, v10, v9, vcc
v_cmp_eq_u32 vcc, 4, v6
s_nop 1
v_cndmask_b32 v10, v10, 9, vcc
v_cmp_eq_u32 vcc, 13, v6
s_nop 1
v_cndmask_b32 v10, v10, 10, vcc
v_and_b32 v6, 30, v10
v_and_b32 v8, 1, v10
v_lshl_add_u32 v8, v7, 1, v8
v_lshl_add_u32 v9, v6, 3, v8
v_lshrrev_b32 v11, 2, v7
v_mul_u32_u24 v13, 24, v11
v_lshl_add_u32 v6, v6, 2, v8
v_add3_u32 v6, v6, v13, 40
v_cmp_gt_u32 vcc, 10, v10
s_nop 1
v_cndmask_b32 v9, v6, v9, vcc
v_lshl_add_u32 v6, v7, 2, v10
v_lshl_add_u32 v6, v11, 4, v6
v_add_u32 v6, 82, v6
v_cmp_gt_u32 vcc, 14, v10
s_nop 1
v_cndmask_b32 v9, v6, v9, vcc
v_add_u32 v6, 144, v10
v_add_u32 v11, 96, v10
v_cmp_gt_u32 vcc, 0, v10
s_nop 1
v_cndmask_b32 v6, v6, v11, vcc
v_cmp_eq_u32 vcc, 8, v7
s_nop 1
v_cndmask_b32 v9, v9, v6, vcc
v_lshlrev_b32 v9, 10, v9
v_add_u32 v9, s41, v9
v_cmp_gt_u32 vcc, 18, v1
s_nop 1
v_cndmask_b32 v9, v12, v9, vcc
s_nop 0
v_readlane_b32 s40, v9, 0
v_readlane_b32 s41, v9, 1
v_readlane_b32 s42, v9, 2
v_readlane_b32 s43, v9, 3
v_add_u32 v156, s40, v2
v_add_u32 v157, s41, v2
v_add_u32 v158, s42, v2
v_add_u32 v159, s43, v2
v_readlane_b32 s40, v9, 4
v_readlane_b32 s41, v9, 5
v_readlane_b32 s42, v9, 6
v_readlane_b32 s43, v9, 7
v_add_u32 v160, s40, v2
v_add_u32 v161, s41, v2
v_add_u32 v162, s42, v2
v_add_u32 v163, s43, v2
v_readlane_b32 s40, v9, 8
v_readlane_b32 s41, v9, 9
v_readlane_b32 s42, v9, 10
v_readlane_b32 s43, v9, 11
v_add_u32 v164, s40, v2
v_add_u32 v165, s41, v2
v_add_u32 v166, s42, v2
v_add_u32 v167, s43, v2
v_readlane_b32 s40, v9, 12
v_readlane_b32 s41, v9, 13
v_readlane_b32 s42, v9, 14
v_readlane_b32 s43, v9, 15
v_add_u32 v168, s40, v2
v_add_u32 v169, s41, v2
v_add_u32 v170, s42, v2
v_add_u32 v171, s43, v2
v_readlane_b32 s40, v9, 16
v_readlane_b32 s41, v9, 17
v_readlane_b32 s42, v9, 18
v_readlane_b32 s43, v9, 19
v_add_u32 v172, s40, v2
v_add_u32 v173, s41, v2
v_add_u32 v174, s42, v2
v_add_u32 v175, s43, v2
s_waitcnt vmcnt(33)
s_branch L_l1_e
L_l1_n:
v_mov_b32 v156, v12
v_mov_b32 v157, v12
v_mov_b32 v158, v12
v_mov_b32 v159, v12
v_mov_b32 v160, v12
v_mov_b32 v161, v12
v_mov_b32 v162, v12
v_mov_b32 v163, v12
v_mov_b32 v164, v12
v_mov_b32 v165, v12
v_mov_b32 v166, v12
v_mov_b32 v167, v12
v_mov_b32 v168, v12
v_mov_b32 v169, v12
v_mov_b32 v170, v12
v_mov_b32 v171, v12
v_mov_b32 v172, v12
v_mov_b32 v173, v12
v_mov_b32 v174, v12
v_mov_b32 v175, v12
s_waitcnt vmcnt(24)
L_l1_e:
v_readfirstlane_b32 s40, v14
v_readfirstlane_b32 s41, v15
s_add_u32 s68, s40, 1
s_addc_u32 s69, s41, 0
v_lshlrev_b32 v28, 16, v16
v_and_b32 v29, 0xffff0000, v16
v_lshlrev_b32 v30, 16, v17
v_and_b32 v31, 0xffff0000, v17
v_lshlrev_b32 v32, 16, v18
v_and_b32 v33, 0xffff0000, v18
v_lshlrev_b32 v34, 16, v19
v_and_b32 v35, 0xffff0000, v19
v_lshlrev_b32 v36, 16, v20
v_and_b32 v37, 0xffff0000, v20
v_lshlrev_b32 v38, 16, v21
v_and_b32 v39, 0xffff0000, v21
v_lshlrev_b32 v40, 16, v22
v_and_b32 v41, 0xffff0000, v22
v_lshlrev_b32 v42, 16, v23
v_and_b32 v43, 0xffff0000, v23
v_lshlrev_b32 v44, 16, v24
v_and_b32 v45, 0xffff0000, v24
v_lshlrev_b32 v46, 16, v25
v_and_b32 v47, 0xffff0000, v25
v_lshlrev_b32 v48, 16, v26
v_and_b32 v49, 0xffff0000, v26
v_lshlrev_b32 v50, 16, v27
v_and_b32 v51, 0xffff0000, v27
v_add_f32 v6, v28, v29
v_mul_f32 v7, v28, v28
v_mul_f32 v9, v29, v29
v_mov_b32 v8, 0
v_add_f32 v6, v6, v30
v_add_f32 v8, v8, v31
v_fmac_f32 v7, v30, v30
v_fmac_f32 v9, v31, v31
v_add_f32 v6, v6, v32
v_add_f32 v8, v8, v33
v_fmac_f32 v7, v32, v32
v_fmac_f32 v9, v33, v33
v_add_f32 v6, v6, v34
v_add_f32 v8, v8, v35
v_fmac_f32 v7, v34, v34
v_fmac_f32 v9, v35, v35
v_add_f32 v6, v6, v36
v_add_f32 v8, v8, v37
v_fmac_f32 v7, v36, v36
v_fmac_f32 v9, v37, v37
v_add_f32 v6, v6, v38
v_add_f32 v8, v8, v39
v_fmac_f32 v7, v38, v38
v_fmac_f32 v9, v39, v39
v_add_f32 v6, v6, v40
v_add_f32 v8, v8, v41
v_fmac_f32 v7, v40, v40
v_fmac_f32 v9, v41, v41
v_add_f32 v6, v6, v42
v_add_f32 v8, v8, v43
v_fmac_f32 v7, v42, v42
v_fmac_f32 v9, v43, v43
v_add_f32 v6, v6, v44
v_add_f32 v8, v8, v45
v_fmac_f32 v7, v44, v44
v_fmac_f32 v9, v45, v45
v_add_f32 v6, v6, v46
v_add_f32 v8, v8, v47
v_fmac_f32 v7, v46, v46
v_fmac_f32 v9, v47, v47
v_add_f32 v6, v6, v48
v_add_f32 v8, v8, v49
v_fmac_f32 v7, v48, v48
v_fmac_f32 v9, v49, v49
v_add_f32 v6, v6, v50
v_add_f32 v8, v8, v51
v_fmac_f32 v7, v50, v50
v_fmac_f32 v9, v51, v51
v_add_f32 v6, v6, v8
v_add_f32 v7, v7, v9
s_nop 0
v_add_f32_dpp v6, v6, v6 row_ror:8 row_mask:0xf bank_mask:0xf
v_add_f32_dpp v7, v7, v7 row_ror:8 row_mask:0xf bank_mask:0xf
v_mov_b32 v8, v6
v_mov_b32 v9, v7
s_nop 0
v_permlane16_swap_b32 v6, v8
v_permlane16_swap_b32 v7, v9
v_add_f32 v6, v6, v8
v_add_f32 v7, v7, v9
v_mov_b32 v8, v6
v_mov_b32 v9, v7
s_nop 0
v_permlane32_swap_b32 v6, v8
v_permlane32_swap_b32 v7, v9
v_add_f32 v6, v6, v8
v_add_f32 v7, v7, v9
v_and_b32 v10, 7, v1
v_lshlrev_b32 v10, 3, v10
v_add_u32 v10, 147456, v10
s_lshl_b32 s24, s4, 6
v_add_u32 v11, s24, v10
ds_write_b64 v11, v[6:7]
s_add_u32 s24, s28, 27688960
buffer_store_dwordx4 v[16:19], v4, s[8:11], s24 offen sc1
s_add_u32 s25, s29, 27688960
buffer_store_dwordx4 v[20:23], v4, s[8:11], s25 offen sc1
s_add_u32 s24, s30, 27688960
buffer_store_dwordx4 v[24:27], v4, s[8:11], s24 offen sc1
s_waitcnt lgkmcnt(0)
s_barrier
ds_read_b64 v[6:7], v10
ds_read_b64 v[8:9], v10 offset:64
ds_read_b64 v[12:13], v10 offset:128
s_waitcnt lgkmcnt(0)
v_add_f32 v6, v6, v8
v_add_f32 v7, v7, v9
v_add_f32 v6, v6, v12
v_add_f32 v7, v7, v13
v_mul_f32 v6, 0x3ae38e39, v6
v_mul_f32 v7, 0x3ae38e39, v7
v_fma_f32 v7, -v6, v6, v7
v_max_f32 v7, 0, v7
v_add_f32 v7, 0x3727c5ac, v7
v_rsq_f32 v7, v7
s_nop 0
v_mul_f32 v6, v6, v7
v_fma_f32 v28, v28, v7, -v6
v_fma_f32 v29, v29, v7, -v6
v_fma_f32 v30, v30, v7, -v6
v_fma_f32 v31, v31, v7, -v6
v_fma_f32 v32, v32, v7, -v6
v_fma_f32 v33, v33, v7, -v6
v_fma_f32 v34, v34, v7, -v6
v_fma_f32 v35, v35, v7, -v6
v_cvt_pk_bf16_f32 v16, v28, v29
v_cvt_pk_bf16_f32 v17, v30, v31
v_cvt_pk_bf16_f32 v18, v32, v33
v_cvt_pk_bf16_f32 v19, v34, v35
s_add_u32 s24, s28, 22970368
buffer_store_dwordx4 v[16:19], v4, s[8:11], s24 offen sc1
v_fma_f32 v36, v36, v7, -v6
v_fma_f32 v37, v37, v7, -v6
v_fma_f32 v38, v38, v7, -v6
v_fma_f32 v39, v39, v7, -v6
v_fma_f32 v40, v40, v7, -v6
v_fma_f32 v41, v41, v7, -v6
v_fma_f32 v42, v42, v7, -v6
v_fma_f32 v43, v43, v7, -v6
v_cvt_pk_bf16_f32 v20, v36, v37
v_cvt_pk_bf16_f32 v21, v38, v39
v_cvt_pk_bf16_f32 v22, v40, v41
v_cvt_pk_bf16_f32 v23, v42, v43
s_add_u32 s25, s29, 22970368
buffer_store_dwordx4 v[20:23], v4, s[8:11], s25 offen sc1
v_fma_f32 v44, v44, v7, -v6
v_fma_f32 v45, v45, v7, -v6
v_fma_f32 v46, v46, v7, -v6
v_fma_f32 v47, v47, v7, -v6
v_fma_f32 v48, v48, v7, -v6
v_fma_f32 v49, v49, v7, -v6
v_fma_f32 v50, v50, v7, -v6
v_fma_f32 v51, v51, v7, -v6
v_cvt_pk_bf16_f32 v24, v44, v45
v_cvt_pk_bf16_f32 v25, v46, v47
v_cvt_pk_bf16_f32 v26, v48, v49
v_cvt_pk_bf16_f32 v27, v50, v51
s_add_u32 s24, s30, 22970368
buffer_store_dwordx4 v[24:27], v4, s[8:11], s24 offen sc1
s_lshl_b32 s24, s5, 5
s_add_u32 s24, s24, s6
s_lshl_b32 s14, s24, 7
s_add_u32 s14, s14, 786432
s_waitcnt vmcnt(6)
v_lshl_or_b32 v52, v53, 16, v52
v_lshl_or_b32 v53, v55, 16, v54
v_lshl_or_b32 v54, v57, 16, v56
v_lshl_or_b32 v55, v59, 16, v58
buffer_store_dwordx4 v[52:55], v2, s[8:11], s38 offen offset:0 sc1
v_lshl_or_b32 v60, v61, 16, v60
v_lshl_or_b32 v61, v63, 16, v62
v_lshl_or_b32 v62, v65, 16, v64
v_lshl_or_b32 v63, v67, 16, v66
buffer_store_dwordx4 v[60:63], v2, s[8:11], s38 offen offset:1024 sc1
v_lshl_or_b32 v68, v69, 16, v68
v_lshl_or_b32 v69, v71, 16, v70
v_lshl_or_b32 v70, v73, 16, v72
v_lshl_or_b32 v71, v75, 16, v74
buffer_store_dwordx4 v[68:71], v2, s[8:11], s38 offen offset:2048 sc1
v_mov_b32 v13, 2146435072
v_cmp_gt_u32 vcc, 16, v0
v_lshlrev_b32 v14, 3, v0
s_nop 0
v_cndmask_b32 v13, v13, v14, vcc
v_mov_b32 v14, s68
v_mov_b32 v15, s69
s_waitcnt vmcnt(0)
s_barrier
buffer_store_dwordx2 v[14:15], v13, s[8:11], s14 offen sc1
s_cmp_ge_u32 s2, 144
s_cbranch_scc1 L_l2_d
buffer_load_dwordx2 v[94:95], v254, s[48:51], s53 offen nt
s_add_u32 s53, s53, 9216
buffer_load_dwordx2 v[96:97], v254, s[48:51], s53 offen nt
s_add_u32 s53, s53, 9216
buffer_load_dwordx2 v[98:99], v254, s[48:51], s53 offen nt
s_add_u32 s53, s53, 9216
buffer_load_dwordx2 v[100:101], v254, s[48:51], s53 offen nt
s_add_u32 s53, s53, 9216
buffer_load_dwordx2 v[102:103], v254, s[48:51], s53 offen nt
s_add_u32 s53, s53, 9216
buffer_load_dwordx2 v[104:105], v254, s[48:51], s53 offen nt
s_add_u32 s53, s53, 9216
buffer_load_dwordx2 v[106:107], v254, s[48:51], s53 offen nt
s_add_u32 s53, s53, 230400
buffer_load_dwordx2 v[108:109], v254, s[48:51], s53 offen nt
s_add_u32 s53, s53, 9216
buffer_load_dwordx2 v[110:111], v254, s[48:51], s53 offen nt
s_add_u32 s53, s53, 9216
buffer_load_dwordx2 v[112:113], v254, s[48:51], s53 offen nt
s_add_u32 s53, s53, 9216
buffer_load_dwordx2 v[114:115], v254, s[48:51], s53 offen nt
s_add_u32 s53, s53, 9216
buffer_load_dwordx2 v[116:117], v254, s[48:51], s53 offen nt
s_add_u32 s53, s53, 9216
buffer_load_dwordx2 v[118:119], v254, s[48:51], s53 offen nt
s_add_u32 s53, s53, 9216
buffer_load_dwordx2 v[120:121], v254, s[48:51], s53 offen nt
s_add_u32 s53, s53, 9216
buffer_load_dwordx2 v[122:123], v254, s[48:51], s53 offen nt
s_add_u32 s53, s53, 230400
buffer_load_dwordx2 v[124:125], v254, s[48:51], s53 offen nt
s_add_u32 s53, s53, 9216
buffer_load_dwordx2 v[126:127], v254, s[48:51], s53 offen nt
s_add_u32 s53, s53, 9216
buffer_load_dwordx2 v[128:129], v254, s[48:51], s53 offen nt
s_add_u32 s53, s53, 9216
buffer_load_dwordx2 v[130:131], v254, s[48:51], s53 offen nt
s_add_u32 s53, s53, 9216
buffer_load_dwordx2 v[132:133], v254, s[48:51], s53 offen nt
s_add_u32 s53, s53, 9216
buffer_load_dwordx2 v[134:135], v254, s[48:51], s53 offen nt
s_add_u32 s53, s53, 9216
buffer_load_dwordx2 v[136:137], v254, s[48:51], s53 offen nt
s_add_u32 s53, s53, 9216
buffer_load_dwordx2 v[138:139], v254, s[48:51], s53 offen nt
s_add_u32 s53, s53, 230400
buffer_load_dwordx2 v[140:141], v255, s[48:51], s53 offen nt
s_add_u32 s53, s53, 9216
buffer_load_dwordx2 v[142:143], v255, s[48:51], s53 offen nt
s_add_u32 s53, s53, 9216
buffer_load_dwordx2 v[144:145], v255, s[48:51], s53 offen nt
s_add_u32 s53, s53, 9216
buffer_load_dwordx2 v[146:147], v255, s[48:51], s53 offen nt
s_add_u32 s53, s53, 9216
buffer_load_dwordx2 v[148:149], v255, s[48:51], s53 offen nt
s_add_u32 s53, s53, 9216
buffer_load_dwordx2 v[150:151], v255, s[48:51], s53 offen nt
s_add_u32 s53, s53, 9216
buffer_load_dwordx2 v[152:153], v255, s[48:51], s53 offen nt
s_add_u32 s53, s53, 9216
buffer_load_dwordx2 v[154:155], v255, s[48:51], s53 offen nt
s_add_u32 s53, s53, 230400
s_branch L_l2_e
L_l2_d:
s_cmp_ge_u32 s2, 216
s_cbranch_scc1 L_l2_n
s_add_u32 s43, s53, 13824
buffer_load_dwordx2 v[82:83], v254, s[48:51], s43 offen offset:0 nt
buffer_load_dwordx2 v[98:99], v254, s[48:51], s43 offen offset:128 nt
buffer_load_ushort v111, v255, s[48:51], s43 offen offset:1024 nt
s_add_u32 s43, s53, 1152
buffer_load_dwordx2 v[84:85], v254, s[48:51], s43 offen offset:0 nt
buffer_load_dwordx2 v[100:101], v254, s[48:51], s43 offen offset:128 nt
buffer_load_ushort v112, v255, s[48:51], s43 offen offset:1024 nt
s_add_u32 s43, s53, 5760
buffer_load_dwordx2 v[86:87], v254, s[48:51], s43 offen offset:0 nt
buffer_load_dwordx2 v[102:103], v254, s[48:51], s43 offen offset:128 nt
buffer_load_ushort v113, v255, s[48:51], s43 offen offset:1024 nt
s_add_u32 s43, s53, 10368
buffer_load_dwordx2 v[88:89], v254, s[48:51], s43 offen offset:0 nt
buffer_load_dwordx2 v[104:105], v254, s[48:51], s43 offen offset:128 nt
buffer_load_ushort v114, v255, s[48:51], s43 offen offset:1024 nt
s_add_u32 s43, s53, 14976
buffer_load_dwordx2 v[90:91], v254, s[48:51], s43 offen offset:0 nt
buffer_load_dwordx2 v[106:107], v254, s[48:51], s43 offen offset:128 nt
buffer_load_ushort v115, v255, s[48:51], s43 offen offset:1024 nt
s_add_u32 s43, s53, 2304
buffer_load_dwordx2 v[116:117], v254, s[48:51], s43 offen offset:0 nt
buffer_load_dwordx2 v[132:133], v254, s[48:51], s43 offen offset:128 nt
buffer_load_ushort v148, v255, s[48:51], s43 offen offset:1024 nt
s_add_u32 s43, s53, 6912
buffer_load_dwordx2 v[118:119], v254, s[48:51], s43 offen offset:0 nt
buffer_load_dwordx2 v[134:135], v254, s[48:51], s43 offen offset:128 nt
buffer_load_ushort v149, v255, s[48:51], s43 offen offset:1024 nt
s_add_u32 s43, s53, 11520
buffer_load_dwordx2 v[120:121], v254, s[48:51], s43 offen offset:0 nt
buffer_load_dwordx2 v[136:137], v254, s[48:51], s43 offen offset:128 nt
buffer_load_ushort v150, v255, s[48:51], s43 offen offset:1024 nt
s_add_u32 s43, s53, 16128
buffer_load_dwordx2 v[122:123], v254, s[48:51], s43 offen offset:0 nt
buffer_load_dwordx2 v[138:139], v254, s[48:51], s43 offen offset:128 nt
buffer_load_ushort v151, v255, s[48:51], s43 offen offset:1024 nt
s_add_u32 s43, s53, 3456
buffer_load_dwordx2 v[124:125], v254, s[48:51], s43 offen offset:0 nt
buffer_load_dwordx2 v[140:141], v254, s[48:51], s43 offen offset:128 nt
buffer_load_ushort v152, v255, s[48:51], s43 offen offset:1024 nt
s_add_u32 s43, s53, 8064
buffer_load_dwordx2 v[126:127], v254, s[48:51], s43 offen offset:0 nt
buffer_load_dwordx2 v[142:143], v254, s[48:51], s43 offen offset:128 nt
buffer_load_ushort v153, v255, s[48:51], s43 offen offset:1024 nt
s_add_u32 s43, s53, 12672
buffer_load_dwordx2 v[128:129], v254, s[48:51], s43 offen offset:0 nt
buffer_load_dwordx2 v[144:145], v254, s[48:51], s43 offen offset:128 nt
buffer_load_ushort v154, v255, s[48:51], s43 offen offset:1024 nt
s_add_u32 s43, s53, 17280
buffer_load_dwordx2 v[130:131], v254, s[48:51], s43 offen offset:0 nt
buffer_load_dwordx2 v[146:147], v254, s[48:51], s43 offen offset:128 nt
buffer_load_ushort v155, v255, s[48:51], s43 offen offset:1024 nt
L_l2_n:
L_l2_e:
s_mov_b32 s15, 1
s_cmp_eq_u32 s4, 0
s_cbranch_scc1 L_hop0
s_cmp_eq_u32 s4, 1
s_cbranch_scc1 L_hop1
s_cmp_eq_u32 s4, 2
s_cbranch_scc1 L_hop2
s_cmp_eq_u32 s4, 3
s_cbranch_scc1 L_hop3
L_hop_done:
s_mov_b32 s15, 0
s_mov_b32 s70, 22970368
s_mov_b32 s71, 27688960
s_mov_b32 s72, 32407552
s_mov_b32 s73, 37126144
s_mov_b32 s74, 41844736
s_mov_b32 s75, 42106880
s_mov_b32 s76, 79855616
s_mov_b32 s77, 0
s_mov_b32 s7, 0
s_lshr_b32 s20, s5, 2
s_lshl_b32 s20, s20, 3
s_lshr_b32 s21, s6, 2
s_add_u32 s20, s20, s21
s_and_b32 s21, s5, 3
s_lshl_b32 s21, s21, 2
s_and_b32 s22, s6, 3
s_add_u32 s21, s21, s22
s_lshl_b32 s24, s20, 3
s_sub_u32 s25, s24, 1
s_max_i32 s35, s25, 0
s_mul_i32 s25, s35, 18432
s_lshl_b32 s26, s4, 1
s_add_u32 s36, s24, s26
s_mul_i32 s24, s36, 18432
s_add_u32 s26, s24, s70
s_add_u32 s27, s26, 18432
s_add_u32 s28, s25, s70
v_add_u32 v4, 0x10000, v2
v_add_u32 v5, 0x20000, v2
s_cmp_eq_u32 s4, 3
s_cselect_b32 s29, 0, s4
s_cselect_b32 s31, 16, 9
s_lshl_b32 s30, s29, 10
v_and_b32 v12, 15, v1
v_mov_b32 v13, 2146435072
v_cmp_le_u32 vcc, s31, v12
s_nop 1
v_cndmask_b32 v3, v13, v2, vcc
s_add_u32 s31, s30, 2048
v_add_u32 v6, s31, v2
v_add_u32 v7, s31, v4
v_add_u32 v8, s31, v5
s_and_b32 s30, s30, 1024
s_add_u32 s31, s30, 5120
v_add_u32 v9, s31, v2
v_add_u32 v10, s31, v4
v_add_u32 v11, s31, v5
s_lshl_b32 s22, s36, 1
s_lshl_b32 s23, s35, 1
s_add_u32 s23, s23, 1
v_and_b32 v16, 3, v1
v_add_u32 v16, s22, v16
v_mov_b32 v17, s23
v_cmp_eq_u32 vcc, 4, v1
s_nop 1
v_cndmask_b32 v16, v16, v17, vcc
s_lshr_b32 s22, s21, 1
s_lshl_b32 s22, s22, 5
s_and_b32 s23, s21, 1
s_mul_i32 s23, s23, 10
s_add_u32 s22, s22, s23
s_sub_u32 s22, s22, 8
v_add_u32 v17, s22, v1
v_subrev_u32 v14, 8, v1
v_cmp_gt_u32 vcc, 11, v14
s_nop 1
v_cndmask_b32 v16, v16, v17, vcc
s_and_b32 s22, s6, 7
s_lshl_b32 s22, s22, 5
v_add_u32 v17, s22, v1
v_subrev_u32 v14, 21, v1
v_cmp_gt_u32 vcc, 8, v14
s_nop 1
v_cndmask_b32 v16, v16, v17, vcc
v_lshlrev_b32 v16, 7, v16
s_add_u32 s22, s77, 786432
s_mov_b32 s52, 0
L_poll1:
buffer_load_dwordx2 v[14:15], v16, s[8:11], s22 offen sc1
s_add_u32 s52, s52, 1
s_waitcnt vmcnt(0)
v_cmp_ne_u64 vcc, s[68:69], v[14:15]
s_cmp_ge_u32 s52, 1048576
s_cbranch_scc1 L_got1
s_and_b64 exec, exec, vcc
s_cbranch_execnz L_poll1
L_got1:
s_mov_b64 exec, -1
s_lshr_b32 s20, s5, 2
s_lshl_b32 s20, s20, 3
s_lshr_b32 s21, s6, 2
s_add_u32 s20, s20, s21
s_and_b32 s21, s5, 3
s_lshl_b32 s21, s21, 2
s_and_b32 s22, s6, 3
s_add_u32 s21, s21, s22
s_mul_i32 s32, s21, 129024
s_add_u32 s32, s32, 4198400
s_mul_i32 s33, s4, 32768
s_add_u32 s32, s32, s33
s_mov_b32 s34, 0x05040100
s_mov_b32 s37, s35
s_mov_b32 s35, 0x07060302
s_mov_b32 s38, 0x00003f80
s_mov_b32 s39, 0x3f800000
v_mov_b32 v20, 0
v_mov_b32 v21, 0
v_mov_b32 v22, 0
v_mov_b32 v23, 0
s_cmp_ge_u32 s2, 144
s_cbranch_scc1 L_tr_d
v_mov_b32 v68, 0x3f803f80
v_mov_b32 v69, 0x3f803f80
s_add_u32 m0, s33, 0
s_add_u32 s40, s32, 0
buffer_load_dwordx4 v2, s[8:11], s40 offen offset:0 sc1 lds
v_mov_b32 v70, 0x3f803f80
v_mov_b32 v71, 0x3f803f80
v_perm_b32 v176, v78, v76, s34
v_perm_b32 v177, v82, v80, s34
v_perm_b32 v178, v86, v84, s34
v_perm_b32 v179, v90, v88, s34
buffer_load_dwordx4 v2, s[8:11], s40 offen offset:1024 sc1 lds
v_perm_b32 v180, v78, v76, s35
v_perm_b32 v181, v82, v80, s35
v_perm_b32 v182, v86, v84, s35
v_perm_b32 v183, v90, v88, s35
v_perm_b32 v184, v79, v77, s34
v_perm_b32 v185, v83, v81, s34
buffer_load_dwordx4 v2, s[8:11], s40 offen offset:2048 sc1 lds
v_perm_b32 v186, v87, v85, s34
v_perm_b32 v187, v91, v89, s34
v_perm_b32 v188, v79, v77, s35
v_perm_b32 v189, v83, v81, s35
v_perm_b32 v190, v87, v85, s35
v_perm_b32 v191, v91, v89, s35
buffer_load_dwordx4 v2, s[8:11], s40 offen offset:3072 sc1 lds
v_perm_b32 v192, v94, v92, s34
v_perm_b32 v193, v98, v96, s34
v_perm_b32 v194, v102, v100, s34
v_perm_b32 v195, v106, v104, s34
v_perm_b32 v196, v94, v92, s35
v_perm_b32 v197, v98, v96, s35
s_add_u32 m0, s33, 4096
s_add_u32 s40, s32, 4096
buffer_load_dwordx4 v2, s[8:11], s40 offen offset:0 sc1 lds
v_perm_b32 v198, v102, v100, s35
v_perm_b32 v199, v106, v104, s35
v_perm_b32 v200, v95, v93, s34
v_perm_b32 v201, v99, v97, s34
v_perm_b32 v202, v103, v101, s34
v_perm_b32 v203, v107, v105, s34
buffer_load_dwordx4 v2, s[8:11], s40 offen offset:1024 sc1 lds
v_perm_b32 v204, v95, v93, s35
v_perm_b32 v205, v99, v97, s35
v_perm_b32 v206, v103, v101, s35
v_perm_b32 v207, v107, v105, s35
v_perm_b32 v208, v110, v108, s34
v_perm_b32 v209, v114, v112, s34
buffer_load_dwordx4 v2, s[8:11], s40 offen offset:2048 sc1 lds
v_perm_b32 v210, v118, v116, s34
v_perm_b32 v211, v122, v120, s34
v_perm_b32 v212, v110, v108, s35
v_perm_b32 v213, v114, v112, s35
v_perm_b32 v214, v118, v116, s35
v_perm_b32 v215, v122, v120, s35
buffer_load_dwordx4 v2, s[8:11], s40 offen offset:3072 sc1 lds
v_perm_b32 v216, v111, v109, s34
v_perm_b32 v217, v115, v113, s34
v_perm_b32 v218, v119, v117, s34
v_perm_b32 v219, v123, v121, s34
v_perm_b32 v220, v111, v109, s35
v_perm_b32 v221, v115, v113, s35
s_add_u32 m0, s33, 8192
s_add_u32 s40, s32, 8192
buffer_load_dwordx4 v2, s[8:11], s40 offen offset:0 sc1 lds
v_perm_b32 v222, v119, v117, s35
v_perm_b32 v223, v123, v121, s35
v_perm_b32 v224, v126, v124, s34
v_perm_b32 v225, v130, v128, s34
v_perm_b32 v226, v134, v132, s34
v_perm_b32 v227, v138, v136, s34
buffer_load_dwordx4 v2, s[8:11], s40 offen offset:1024 sc1 lds
v_perm_b32 v228, v126, v124, s35
v_perm_b32 v229, v130, v128, s35
v_perm_b32 v230, v134, v132, s35
v_perm_b32 v231, v138, v136, s35
v_perm_b32 v232, v127, v125, s34
v_perm_b32 v233, v131, v129, s34
buffer_load_dwordx4 v2, s[8:11], s40 offen offset:2048 sc1 lds
v_perm_b32 v234, v135, v133, s34
v_perm_b32 v235, v139, v137, s34
v_perm_b32 v236, v127, v125, s35
v_perm_b32 v237, v131, v129, s35
v_perm_b32 v238, v135, v133, s35
v_perm_b32 v239, v139, v137, s35
buffer_load_dwordx4 v2, s[8:11], s40 offen offset:3072 sc1 lds
v_perm_b32 v240, v142, v140, s34
v_perm_b32 v241, v146, v144, s34
v_perm_b32 v242, v150, v148, s34
v_perm_b32 v243, v154, v152, s34
v_perm_b32 v244, v142, v140, s35
v_perm_b32 v245, v146, v144, s35
s_add_u32 m0, s33, 12288
s_add_u32 s40, s32, 12288
buffer_load_dwordx4 v2, s[8:11], s40 offen offset:0 sc1 lds
v_perm_b32 v246, v150, v148, s35
v_perm_b32 v247, v154, v152, s35
v_perm_b32 v248, v143, v141, s34
v_perm_b32 v249, v147, v145, s34
v_perm_b32 v250, v151, v149, s34
v_perm_b32 v251, v155, v153, s34
buffer_load_dwordx4 v2, s[8:11], s40 offen offset:1024 sc1 lds
v_perm_b32 v252, v143, v141, s35
v_perm_b32 v253, v147, v145, s35
v_perm_b32 v254, v151, v149, s35
v_perm_b32 v255, v155, v153, s35
v_mfma_f32_16x16x32_bf16 v[52:55], v[68:71], v[176:179], 0
v_mfma_f32_16x16x32_bf16 v[56:59], v[68:71], v[180:183], 0
buffer_load_dwordx4 v2, s[8:11], s40 offen offset:2048 sc1 lds
v_mfma_f32_16x16x32_bf16 v[60:63], v[68:71], v[184:187], 0
v_mfma_f32_16x16x32_bf16 v[64:67], v[68:71], v[188:191], 0
v_mfma_f32_16x16x32_bf16 v[52:55], v[68:71], v[192:195], v[52:55]
v_mfma_f32_16x16x32_bf16 v[56:59], v[68:71], v[196:199], v[56:59]
v_mfma_f32_16x16x32_bf16 v[60:63], v[68:71], v[200:203], v[60:63]
v_mfma_f32_16x16x32_bf16 v[64:67], v[68:71], v[204:207], v[64:67]
buffer_load_dwordx4 v2, s[8:11], s40 offen offset:3072 sc1 lds
v_mfma_f32_16x16x32_bf16 v[52:55], v[68:71], v[208:211], v[52:55]
v_mfma_f32_16x16x32_bf16 v[56:59], v[68:71], v[212:215], v[56:59]
v_mfma_f32_16x16x32_bf16 v[60:63], v[68:71], v[216:219], v[60:63]
v_mfma_f32_16x16x32_bf16 v[64:67], v[68:71], v[220:223], v[64:67]
v_mfma_f32_16x16x32_bf16 v[52:55], v[68:71], v[224:227], v[52:55]
v_mfma_f32_16x16x32_bf16 v[56:59], v[68:71], v[228:231], v[56:59]
s_add_u32 m0, s33, 16384
s_add_u32 s40, s32, 16384
buffer_load_dwordx4 v2, s[8:11], s40 offen offset:0 sc1 lds
v_mfma_f32_16x16x32_bf16 v[60:63], v[68:71], v[232:235], v[60:63]
v_mfma_f32_16x16x32_bf16 v[64:67], v[68:71], v[236:239], v[64:67]
v_mfma_f32_16x16x32_bf16 v[52:55], v[68:71], v[240:243], v[52:55]
v_mfma_f32_16x16x32_bf16 v[56:59], v[68:71], v[244:247], v[56:59]
v_mfma_f32_16x16x32_bf16 v[60:63], v[68:71], v[248:251], v[60:63]
v_mfma_f32_16x16x32_bf16 v[64:67], v[68:71], v[252:255], v[64:67]
buffer_load_dwordx4 v2, s[8:11], s40 offen offset:1024 sc1 lds
v_and_b32 v72, 15, v1
v_lshlrev_b32 v72, 4, v72
v_add_u32 v72, 159744, v72
s_lshl_b32 s44, s4, 2
v_add_u32 v73, s44, v72
ds_write_b32 v73, v52 offset:0
buffer_load_dwordx4 v2, s[8:11], s40 offen offset:2048 sc1 lds
ds_write_b32 v73, v56 offset:256
ds_write_b32 v73, v60 offset:512
ds_write_b32 v73, v64 offset:768
s_waitcnt lgkmcnt(0)
s_barrier
ds_read_b128 v[52:55], v72 offset:0
buffer_load_dwordx4 v2, s[8:11], s40 offen offset:3072 sc1 lds
ds_read_b128 v[56:59], v72 offset:256
ds_read_b128 v[60:63], v72 offset:512
ds_read_b128 v[64:67], v72 offset:768
s_waitcnt lgkmcnt(0)
v_add_f32 v52, v52, v53
v_add_f32 v54, v54, v55
s_add_u32 m0, s33, 20480
s_add_u32 s40, s32, 20480
buffer_load_dwordx4 v2, s[8:11], s40 offen offset:0 sc1 lds
v_add_f32 v56, v56, v57
v_add_f32 v58, v58, v59
v_add_f32 v60, v60, v61
v_add_f32 v62, v62, v63
v_add_f32 v64, v64, v65
v_add_f32 v66, v66, v67
buffer_load_dwordx4 v2, s[8:11], s40 offen offset:1024 sc1 lds
v_add_f32 v52, v52, v54
v_add_f32 v56, v56, v58
v_add_f32 v60, v60, v62
v_add_f32 v64, v64, v66
v_mul_f32 v20, 0xbae38e39, v52
v_mul_f32 v21, 0xbae38e39, v56
buffer_load_dwordx4 v2, s[8:11], s40 offen offset:2048 sc1 lds
v_mul_f32 v22, 0xbae38e39, v60
v_mul_f32 v23, 0xbae38e39, v64
v_dot2_f32_bf16 v24, v176, s38, v20
v_dot2_f32_bf16 v25, v176, s39, v20
v_dot2_f32_bf16 v26, v177, s38, v20
v_dot2_f32_bf16 v27, v177, s39, v20
buffer_load_dwordx4 v2, s[8:11], s40 offen offset:3072 sc1 lds
v_dot2_f32_bf16 v28, v178, s38, v20
v_dot2_f32_bf16 v29, v178, s39, v20
v_dot2_f32_bf16 v30, v179, s38, v20
v_dot2_f32_bf16 v31, v179, s39, v20
v_cvt_pk_bf16_f32 v176, v24, v25
v_cvt_pk_bf16_f32 v177, v26, v27
s_add_u32 m0, s33, 24576
s_add_u32 s40, s32, 24576
buffer_load_dwordx4 v2, s[8:11], s40 offen offset:0 sc1 lds
v_cvt_pk_bf16_f32 v178, v28, v29
v_cvt_pk_bf16_f32 v179, v30, v31
v_dot2_f32_bf16 v24, v180, s38, v21
v_dot2_f32_bf16 v25, v180, s39, v21
v_dot2_f32_bf16 v26, v181, s38, v21
v_dot2_f32_bf16 v27, v181, s39, v21
buffer_load_dwordx4 v2, s[8:11], s40 offen offset:1024 sc1 lds
v_dot2_f32_bf16 v28, v182, s38, v21
v_dot2_f32_bf16 v29, v182, s39, v21
v_dot2_f32_bf16 v30, v183, s38, v21
v_dot2_f32_bf16 v31, v183, s39, v21
v_cvt_pk_bf16_f32 v180, v24, v25
L_hop0:
s_cmp_eq_u32 s15, 1
s_cbranch_scc1 L_hop4
v_cvt_pk_bf16_f32 v181, v26, v27
buffer_load_dwordx4 v2, s[8:11], s40 offen offset:2048 sc1 lds
v_cvt_pk_bf16_f32 v182, v28, v29
v_cvt_pk_bf16_f32 v183, v30, v31
v_dot2_f32_bf16 v24, v184, s38, v22
v_dot2_f32_bf16 v25, v184, s39, v22
v_dot2_f32_bf16 v26, v185, s38, v22
v_dot2_f32_bf16 v27, v185, s39, v22
buffer_load_dwordx4 v2, s[8:11], s40 offen offset:3072 sc1 lds
v_dot2_f32_bf16 v28, v186, s38, v22
v_dot2_f32_bf16 v29, v186, s39, v22
v_dot2_f32_bf16 v30, v187, s38, v22
v_dot2_f32_bf16 v31, v187, s39, v22
v_cvt_pk_bf16_f32 v184, v24, v25
v_cvt_pk_bf16_f32 v185, v26, v27
s_add_u32 m0, s33, 28672
s_add_u32 s40, s32, 28672
buffer_load_dwordx4 v2, s[8:11], s40 offen offset:0 sc1 lds
v_cvt_pk_bf16_f32 v186, v28, v29
v_cvt_pk_bf16_f32 v187, v30, v31
v_dot2_f32_bf16 v24, v188, s38, v23
v_dot2_f32_bf16 v25, v188, s39, v23
v_dot2_f32_bf16 v26, v189, s38, v23
v_dot2_f32_bf16 v27, v189, s39, v23
buffer_load_dwordx4 v2, s[8:11], s40 offen offset:1024 sc1 lds
v_dot2_f32_bf16 v28, v190, s38, v23
v_dot2_f32_bf16 v29, v190, s39, v23
v_dot2_f32_bf16 v30, v191, s38, v23
v_dot2_f32_bf16 v31, v191, s39, v23
v_cvt_pk_bf16_f32 v188, v24, v25
v_cvt_pk_bf16_f32 v189, v26, v27
buffer_load_dwordx4 v2, s[8:11], s40 offen offset:2048 sc1 lds
v_cvt_pk_bf16_f32 v190, v28, v29
v_cvt_pk_bf16_f32 v191, v30, v31
v_dot2_f32_bf16 v24, v192, s38, v20
v_dot2_f32_bf16 v25, v192, s39, v20
v_dot2_f32_bf16 v26, v193, s38, v20
v_dot2_f32_bf16 v27, v193, s39, v20
buffer_load_dwordx4 v2, s[8:11], s40 offen offset:3072 sc1 lds
v_dot2_f32_bf16 v28, v194, s38, v20
v_dot2_f32_bf16 v29, v194, s39, v20
v_dot2_f32_bf16 v30, v195, s38, v20
v_dot2_f32_bf16 v31, v195, s39, v20
v_cvt_pk_bf16_f32 v192, v24, v25
v_cvt_pk_bf16_f32 v193, v26, v27
v_cvt_pk_bf16_f32 v194, v28, v29
v_cvt_pk_bf16_f32 v195, v30, v31
v_dot2_f32_bf16 v24, v196, s38, v21
v_dot2_f32_bf16 v25, v196, s39, v21
v_dot2_f32_bf16 v26, v197, s38, v21
v_dot2_f32_bf16 v27, v197, s39, v21
v_dot2_f32_bf16 v28, v198, s38, v21
v_dot2_f32_bf16 v29, v198, s39, v21
v_dot2_f32_bf16 v30, v199, s38, v21
v_dot2_f32_bf16 v31, v199, s39, v21
v_cvt_pk_bf16_f32 v196, v24, v25
v_cvt_pk_bf16_f32 v197, v26, v27
v_cvt_pk_bf16_f32 v198, v28, v29
v_cvt_pk_bf16_f32 v199, v30, v31
v_dot2_f32_bf16 v24, v200, s38, v22
v_dot2_f32_bf16 v25, v200, s39, v22
v_dot2_f32_bf16 v26, v201, s38, v22
v_dot2_f32_bf16 v27, v201, s39, v22
v_dot2_f32_bf16 v28, v202, s38, v22
v_dot2_f32_bf16 v29, v202, s39, v22
v_dot2_f32_bf16 v30, v203, s38, v22
v_dot2_f32_bf16 v31, v203, s39, v22
v_cvt_pk_bf16_f32 v200, v24, v25
v_cvt_pk_bf16_f32 v201, v26, v27
v_cvt_pk_bf16_f32 v202, v28, v29
v_cvt_pk_bf16_f32 v203, v30, v31
v_dot2_f32_bf16 v24, v204, s38, v23
v_dot2_f32_bf16 v25, v204, s39, v23
v_dot2_f32_bf16 v26, v205, s38, v23
v_dot2_f32_bf16 v27, v205, s39, v23
v_dot2_f32_bf16 v28, v206, s38, v23
v_dot2_f32_bf16 v29, v206, s39, v23
v_dot2_f32_bf16 v30, v207, s38, v23
v_dot2_f32_bf16 v31, v207, s39, v23
v_cvt_pk_bf16_f32 v204, v24, v25
v_cvt_pk_bf16_f32 v205, v26, v27
v_cvt_pk_bf16_f32 v206, v28, v29
v_cvt_pk_bf16_f32 v207, v30, v31
s_branch L_tr_e
L_tr_d:
s_cmp_ge_u32 s2, 216
s_cbranch_scc1 L_tr_n
v_perm_b32 v176, v78, v76, s34
v_perm_b32 v177, v82, v80, s34
s_add_u32 m0, s33, 0
s_add_u32 s40, s32, 0
buffer_load_dwordx4 v2, s[8:11], s40 offen offset:0 sc1 lds
v_perm_b32 v178, v86, v84, s34
v_perm_b32 v179, v90, v88, s34
buffer_load_dwordx4 v2, s[8:11], s40 offen offset:1024 sc1 lds
v_perm_b32 v180, v78, v76, s35
v_perm_b32 v181, v82, v80, s35
buffer_load_dwordx4 v2, s[8:11], s40 offen offset:2048 sc1 lds
v_perm_b32 v182, v86, v84, s35
v_perm_b32 v183, v90, v88, s35
buffer_load_dwordx4 v2, s[8:11], s40 offen offset:3072 sc1 lds
v_perm_b32 v184, v79, v77, s34
v_perm_b32 v185, v83, v81, s34
s_add_u32 m0, s33, 4096
s_add_u32 s40, s32, 4096
buffer_load_dwordx4 v2, s[8:11], s40 offen offset:0 sc1 lds
v_perm_b32 v186, v87, v85, s34
v_perm_b32 v187, v91, v89, s34
buffer_load_dwordx4 v2, s[8:11], s40 offen offset:1024 sc1 lds
v_perm_b32 v188, v79, v77, s35
v_perm_b32 v189, v83, v81, s35
buffer_load_dwordx4 v2, s[8:11], s40 offen offset:2048 sc1 lds
v_perm_b32 v190, v87, v85, s35
v_perm_b32 v191, v91, v89, s35
buffer_load_dwordx4 v2, s[8:11], s40 offen offset:3072 sc1 lds
v_perm_b32 v192, v94, v92, s34
v_perm_b32 v193, v98, v96, s34
s_add_u32 m0, s33, 8192
s_add_u32 s40, s32, 8192
buffer_load_dwordx4 v2, s[8:11], s40 offen offset:0 sc1 lds
v_perm_b32 v194, v102, v100, s34
v_perm_b32 v195, v106, v104, s34
buffer_load_dwordx4 v2, s[8:11], s40 offen offset:1024 sc1 lds
v_perm_b32 v196, v94, v92, s35
v_perm_b32 v197, v98, v96, s35
buffer_load_dwordx4 v2, s[8:11], s40 offen offset:2048 sc1 lds
v_perm_b32 v198, v102, v100, s35
v_perm_b32 v199, v106, v104, s35
buffer_load_dwordx4 v2, s[8:11], s40 offen offset:3072 sc1 lds
v_perm_b32 v200, v95, v93, s34
v_perm_b32 v201, v99, v97, s34
s_add_u32 m0, s33, 12288
s_add_u32 s40, s32, 12288
buffer_load_dwordx4 v2, s[8:11], s40 offen offset:0 sc1 lds
v_perm_b32 v202, v103, v101, s34
v_perm_b32 v203, v107, v105, s34
buffer_load_dwordx4 v2, s[8:11], s40 offen offset:1024 sc1 lds
v_perm_b32 v204, v95, v93, s35
v_perm_b32 v205, v99, v97, s35
buffer_load_dwordx4 v2, s[8:11], s40 offen offset:2048 sc1 lds
v_perm_b32 v206, v103, v101, s35
v_perm_b32 v207, v107, v105, s35
buffer_load_dwordx4 v2, s[8:11], s40 offen offset:3072 sc1 lds
v_lshl_or_b32 v208, v109, 16, v108
v_lshl_or_b32 v209, v111, 16, v110
s_add_u32 m0, s33, 16384
s_add_u32 s40, s32, 16384
buffer_load_dwordx4 v2, s[8:11], s40 offen offset:0 sc1 lds
v_lshl_or_b32 v210, v113, 16, v112
v_lshl_or_b32 v211, v115, 16, v114
buffer_load_dwordx4 v2, s[8:11], s40 offen offset:1024 sc1 lds
v_perm_b32 v212, v118, v116, s34
v_perm_b32 v213, v122, v120, s34
buffer_load_dwordx4 v2, s[8:11], s40 offen offset:2048 sc1 lds
v_perm_b32 v214, v126, v124, s34
v_perm_b32 v215, v130, v128, s34
buffer_load_dwordx4 v2, s[8:11], s40 offen offset:3072 sc1 lds
v_perm_b32 v216, v118, v116, s35
v_perm_b32 v217, v122, v120, s35
s_add_u32 m0, s33, 20480
s_add_u32 s40, s32, 20480
buffer_load_dwordx4 v2, s[8:11], s40 offen offset:0 sc1 lds
v_perm_b32 v218, v126, v124, s35
v_perm_b32 v219, v130, v128, s35
buffer_load_dwordx4 v2, s[8:11], s40 offen offset:1024 sc1 lds
v_perm_b32 v220, v119, v117, s34
v_perm_b32 v221, v123, v121, s34
buffer_load_dwordx4 v2, s[8:11], s40 offen offset:2048 sc1 lds
v_perm_b32 v222, v127, v125, s34
v_perm_b32 v223, v131, v129, s34
buffer_load_dwordx4 v2, s[8:11], s40 offen offset:3072 sc1 lds
v_perm_b32 v224, v119, v117, s35
v_perm_b32 v225, v123, v121, s35
s_add_u32 m0, s33, 24576
s_add_u32 s40, s32, 24576
buffer_load_dwordx4 v2, s[8:11], s40 offen offset:0 sc1 lds
v_perm_b32 v226, v127, v125, s35
v_perm_b32 v227, v131, v129, s35
buffer_load_dwordx4 v2, s[8:11], s40 offen offset:1024 sc1 lds
v_perm_b32 v228, v134, v132, s34
v_perm_b32 v229, v138, v136, s34
buffer_load_dwordx4 v2, s[8:11], s40 offen offset:2048 sc1 lds
v_perm_b32 v230, v142, v140, s34
v_perm_b32 v231, v146, v144, s34
buffer_load_dwordx4 v2, s[8:11], s40 offen offset:3072 sc1 lds
v_perm_b32 v232, v134, v132, s35
v_perm_b32 v233, v138, v136, s35
s_add_u32 m0, s33, 28672
s_add_u32 s40, s32, 28672
buffer_load_dwordx4 v2, s[8:11], s40 offen offset:0 sc1 lds
v_perm_b32 v234, v142, v140, s35
v_perm_b32 v235, v146, v144, s35
buffer_load_dwordx4 v2, s[8:11], s40 offen offset:1024 sc1 lds
v_perm_b32 v236, v135, v133, s34
v_perm_b32 v237, v139, v137, s34
buffer_load_dwordx4 v2, s[8:11], s40 offen offset:2048 sc1 lds
v_perm_b32 v238, v143, v141, s34
v_perm_b32 v239, v147, v145, s34
buffer_load_dwordx4 v2, s[8:11], s40 offen offset:3072 sc1 lds
v_perm_b32 v240, v135, v133, s35
v_perm_b32 v241, v139, v137, s35
v_perm_b32 v242, v143, v141, s35
v_perm_b32 v243, v147, v145, s35
v_lshl_or_b32 v244, v149, 16, v148
v_lshl_or_b32 v245, v151, 16, v150
v_lshl_or_b32 v246, v153, 16, v152
v_lshl_or_b32 v247, v155, 16, v154
s_branch L_tr_e
L_tr_n:
s_add_u32 m0, s33, 0
s_add_u32 s40, s32, 0
buffer_load_dwordx4 v2, s[8:11], s40 offen offset:0 sc1 lds
buffer_load_dwordx4 v2, s[8:11], s40 offen offset:1024 sc1 lds
buffer_load_dwordx4 v2, s[8:11], s40 offen offset:2048 sc1 lds
buffer_load_dwordx4 v2, s[8:11], s40 offen offset:3072 sc1 lds
s_add_u32 m0, s33, 4096
s_add_u32 s40, s32, 4096
buffer_load_dwordx4 v2, s[8:11], s40 offen offset:0 sc1 lds
buffer_load_dwordx4 v2, s[8:11], s40 offen offset:1024 sc1 lds
buffer_load_dwordx4 v2, s[8:11], s40 offen offset:2048 sc1 lds
buffer_load_dwordx4 v2, s[8:11], s40 offen offset:3072 sc1 lds
s_add_u32 m0, s33, 8192
s_add_u32 s40, s32, 8192
buffer_load_dwordx4 v2, s[8:11], s40 offen offset:0 sc1 lds
buffer_load_dwordx4 v2, s[8:11], s40 offen offset:1024 sc1 lds
buffer_load_dwordx4 v2, s[8:11], s40 offen offset:2048 sc1 lds
buffer_load_dwordx4 v2, s[8:11], s40 offen offset:3072 sc1 lds
s_add_u32 m0, s33, 12288
s_add_u32 s40, s32, 12288
buffer_load_dwordx4 v2, s[8:11], s40 offen offset:0 sc1 lds
buffer_load_dwordx4 v2, s[8:11], s40 offen offset:1024 sc1 lds
buffer_load_dwordx4 v2, s[8:11], s40 offen offset:2048 sc1 lds
buffer_load_dwordx4 v2, s[8:11], s40 offen offset:3072 sc1 lds
s_add_u32 m0, s33, 16384
s_add_u32 s40, s32, 16384
buffer_load_dwordx4 v2, s[8:11], s40 offen offset:0 sc1 lds
buffer_load_dwordx4 v2, s[8:11], s40 offen offset:1024 sc1 lds
buffer_load_dwordx4 v2, s[8:11], s40 offen offset:2048 sc1 lds
buffer_load_dwordx4 v2, s[8:11], s40 offen offset:3072 sc1 lds
s_add_u32 m0, s33, 20480
s_add_u32 s40, s32, 20480
buffer_load_dwordx4 v2, s[8:11], s40 offen offset:0 sc1 lds
buffer_load_dwordx4 v2, s[8:11], s40 offen offset:1024 sc1 lds
buffer_load_dwordx4 v2, s[8:11], s40 offen offset:2048 sc1 lds
buffer_load_dwordx4 v2, s[8:11], s40 offen offset:3072 sc1 lds
s_add_u32 m0, s33, 24576
s_add_u32 s40, s32, 24576
buffer_load_dwordx4 v2, s[8:11], s40 offen offset:0 sc1 lds
buffer_load_dwordx4 v2, s[8:11], s40 offen offset:1024 sc1 lds
buffer_load_dwordx4 v2, s[8:11], s40 offen offset:2048 sc1 lds
buffer_load_dwordx4 v2, s[8:11], s40 offen offset:3072 sc1 lds
s_add_u32 m0, s33, 28672
s_add_u32 s40, s32, 28672
buffer_load_dwordx4 v2, s[8:11], s40 offen offset:0 sc1 lds
buffer_load_dwordx4 v2, s[8:11], s40 offen offset:1024 sc1 lds
buffer_load_dwordx4 v2, s[8:11], s40 offen offset:2048 sc1 lds
buffer_load_dwordx4 v2, s[8:11], s40 offen offset:3072 sc1 lds
L_tr_e:
s_mov_b32 s35, s37
buffer_load_dwordx4 a[0:3], v2, s[8:11], s26 offen offset:0 sc1
buffer_load_dwordx4 a[72:75], v2, s[8:11], s27 offen offset:0 sc1
buffer_load_dwordx4 a[144:147], v3, s[8:11], s28 offen offset:0 sc1
buffer_load_dwordx4 a[4:7], v2, s[8:11], s26 offen offset:1024 sc1
buffer_load_dwordx4 a[76:79], v2, s[8:11], s27 offen offset:1024 sc1
buffer_load_dwordx4 a[148:151], v3, s[8:11], s28 offen offset:1024 sc1
buffer_load_dwordx4 a[8:11], v2, s[8:11], s26 offen offset:2048 sc1
buffer_load_dwordx4 a[80:83], v2, s[8:11], s27 offen offset:2048 sc1
buffer_load_dwordx4 a[152:155], v3, s[8:11], s28 offen offset:2048 sc1
buffer_load_dwordx4 a[12:15], v2, s[8:11], s26 offen offset:3072 sc1
buffer_load_dwordx4 a[84:87], v2, s[8:11], s27 offen offset:3072 sc1
buffer_load_dwordx4 a[156:159], v3, s[8:11], s28 offen offset:3072 sc1
s_add_u32 s26, s26, 4096
s_add_u32 s27, s27, 4096
s_add_u32 s28, s28, 4096
buffer_load_dwordx4 a[16:19], v2, s[8:11], s26 offen offset:0 sc1
buffer_load_dwordx4 a[88:91], v2, s[8:11], s27 offen offset:0 sc1
buffer_load_dwordx4 a[160:163], v3, s[8:11], s28 offen offset:0 sc1
buffer_load_dwordx4 a[20:23], v2, s[8:11], s26 offen offset:1024 sc1
buffer_load_dwordx4 a[92:95], v2, s[8:11], s27 offen offset:1024 sc1
buffer_load_dwordx4 a[164:167], v3, s[8:11], s28 offen offset:1024 sc1
buffer_load_dwordx4 a[24:27], v2, s[8:11], s26 offen offset:2048 sc1
buffer_load_dwordx4 a[96:99], v2, s[8:11], s27 offen offset:2048 sc1
buffer_load_dwordx4 a[168:171], v3, s[8:11], s28 offen offset:2048 sc1
buffer_load_dwordx4 a[28:31], v2, s[8:11], s26 offen offset:3072 sc1
buffer_load_dwordx4 a[100:103], v2, s[8:11], s27 offen offset:3072 sc1
buffer_load_dwordx4 a[172:175], v3, s[8:11], s28 offen offset:3072 sc1
v_lshrrev_b32 v13, 4, v1
v_lshlrev_b32 v14, 2, v13
v_sub_u32 v14, v12, v14
v_subrev_u32 v15, 0, v14
v_cmp_gt_u32 s[52:53], 8, v15
v_cmp_gt_i32 s[44:45], -8, v15
v_subrev_u32 v15, 1, v14
v_cmp_gt_u32 s[54:55], 8, v15
v_cmp_gt_i32 s[46:47], -8, v15
v_subrev_u32 v15, 2, v14
v_cmp_gt_u32 s[56:57], 8, v15
v_cmp_gt_i32 s[48:49], -8, v15
v_subrev_u32 v15, 3, v14
v_cmp_gt_u32 s[58:59], 8, v15
v_cmp_gt_i32 s[50:51], -8, v15
s_and_b32 s31, s20, 7
s_or_b32 s31, s31, s4
s_cmp_eq_u32 s31, 0
s_cselect_b64 s[60:61], 0, s[44:45]
s_cselect_b64 s[62:63], 0, s[46:47]
s_cselect_b64 s[64:65], 0, s[48:49]
s_cselect_b64 s[66:67], 0, s[50:51]
s_waitcnt vmcnt(24)
s_barrier
ds_read_b128 a[216:219], v2 offset:0
ds_read_b128 a[220:223], v2 offset:7168
ds_read_b128 a[224:227], v2 offset:1024
ds_read_b128 a[228:231], v2 offset:8192
ds_read_b128 a[232:235], v2 offset:2048
ds_read_b128 a[236:239], v2 offset:9216
s_waitcnt vmcnt(18)
s_waitcnt lgkmcnt(4)
v_mfma_f32_16x16x32_bf16 v[32:35], a[216:219], a[0:3], 0
s_add_u32 s26, s26, 4096
s_add_u32 s27, s27, 4096
s_add_u32 s28, s28, 4096
buffer_load_dwordx4 a[32:35], v2, s[8:11], s26 offen offset:0 sc1
v_mfma_f32_16x16x32_bf16 v[32:35], a[220:223], a[4:7], v[32:35]
ds_read_b128 a[240:243], v2 offset:3072
v_dot2_f32_bf16 v24, v208, s38, v20
v_mfma_f32_16x16x32_bf16 v[36:39], a[216:219], a[72:75], 0
v_dot2_f32_bf16 v25, v208, s39, v20
v_dot2_f32_bf16 v26, v209, s38, v20
v_mfma_f32_16x16x32_bf16 v[36:39], a[220:223], a[76:79], v[36:39]
ds_read_b128 a[244:247], v2 offset:10240
s_waitcnt lgkmcnt(4)
v_mfma_f32_16x16x32_bf16 v[40:43], a[224:227], a[0:3], 0
buffer_load_dwordx4 a[104:107], v2, s[8:11], s27 offen offset:0 sc1
v_mfma_f32_16x16x32_bf16 v[40:43], a[228:231], a[4:7], v[40:43]
ds_read_b128 a[216:219], v2 offset:4096
v_dot2_f32_bf16 v27, v209, s39, v20
v_mfma_f32_16x16x32_bf16 v[44:47], a[224:227], a[72:75], 0
v_dot2_f32_bf16 v28, v210, s38, v20
v_dot2_f32_bf16 v29, v210, s39, v20
v_mfma_f32_16x16x32_bf16 v[44:47], a[228:231], a[76:79], v[44:47]
ds_read_b128 a[220:223], v2 offset:11264
s_waitcnt lgkmcnt(4)
v_mfma_f32_16x16x32_bf16 v[48:51], a[232:235], a[0:3], 0
buffer_load_dwordx4 a[176:179], v3, s[8:11], s28 offen offset:0 sc1
v_mfma_f32_16x16x32_bf16 v[48:51], a[236:239], a[4:7], v[48:51]
ds_read_b128 a[224:227], v2 offset:5120
v_dot2_f32_bf16 v30, v211, s38, v20
v_mfma_f32_16x16x32_bf16 v[52:55], a[232:235], a[72:75], 0
v_dot2_f32_bf16 v31, v211, s39, v20
v_cvt_pk_bf16_f32 v208, v24, v25
v_mfma_f32_16x16x32_bf16 v[52:55], a[236:239], a[76:79], v[52:55]
ds_read_b128 a[228:231], v2 offset:12288
s_waitcnt lgkmcnt(4)
v_mfma_f32_16x16x32_bf16 v[56:59], a[240:243], a[0:3], 0
buffer_load_dwordx4 a[36:39], v2, s[8:11], s26 offen offset:1024 sc1
v_mfma_f32_16x16x32_bf16 v[56:59], a[244:247], a[4:7], v[56:59]
ds_read_b128 a[232:235], v2 offset:6144
v_cvt_pk_bf16_f32 v209, v26, v27
v_mfma_f32_16x16x32_bf16 v[60:63], a[240:243], a[72:75], 0
v_cvt_pk_bf16_f32 v210, v28, v29
v_cvt_pk_bf16_f32 v211, v30, v31
v_mfma_f32_16x16x32_bf16 v[60:63], a[244:247], a[76:79], v[60:63]
ds_read_b128 a[236:239], v2 offset:13312
s_waitcnt lgkmcnt(4)
v_mfma_f32_16x16x32_bf16 v[64:67], a[216:219], a[0:3], 0
buffer_load_dwordx4 a[108:111], v2, s[8:11], s27 offen offset:1024 sc1
v_mfma_f32_16x16x32_bf16 v[64:67], a[220:223], a[4:7], v[64:67]
ds_read_b128 a[240:243], v6 offset:0
v_dot2_f32_bf16 v24, v212, s38, v21
v_mfma_f32_16x16x32_bf16 v[68:71], a[216:219], a[72:75], 0
v_dot2_f32_bf16 v25, v212, s39, v21
v_dot2_f32_bf16 v26, v213, s38, v21
v_mfma_f32_16x16x32_bf16 v[68:71], a[220:223], a[76:79], v[68:71]
ds_read_b128 a[244:247], v6 offset:7168
s_waitcnt lgkmcnt(4)
v_mfma_f32_16x16x32_bf16 v[72:75], a[0:3], a[224:227], 0
buffer_load_dwordx4 a[180:183], v3, s[8:11], s28 offen offset:1024 sc1
v_mfma_f32_16x16x32_bf16 v[72:75], a[4:7], a[228:231], v[72:75]
ds_read_b128 a[216:219], v9 offset:0
v_dot2_f32_bf16 v27, v213, s39, v21
v_mfma_f32_16x16x32_bf16 v[76:79], a[72:75], a[224:227], 0
v_dot2_f32_bf16 v28, v214, s38, v21
v_dot2_f32_bf16 v29, v214, s39, v21
v_mfma_f32_16x16x32_bf16 v[76:79], a[76:79], a[228:231], v[76:79]
ds_read_b128 a[220:223], v9 offset:7168
s_waitcnt lgkmcnt(4)
v_mfma_f32_16x16x32_bf16 v[80:83], a[0:3], a[232:235], 0
buffer_load_dwordx4 a[40:43], v2, s[8:11], s26 offen offset:2048 sc1
v_mfma_f32_16x16x32_bf16 v[80:83], a[4:7], a[236:239], v[80:83]
ds_read_b128 a[224:227], v2 offset:14336
v_dot2_f32_bf16 v30, v215, s38, v21
v_mfma_f32_16x16x32_bf16 v[84:87], a[72:75], a[232:235], 0
v_dot2_f32_bf16 v31, v215, s39, v21
v_cvt_pk_bf16_f32 v212, v24, v25
v_mfma_f32_16x16x32_bf16 v[84:87], a[76:79], a[236:239], v[84:87]
ds_read_b128 a[228:231], v2 offset:21504
s_waitcnt lgkmcnt(4)
v_mfma_f32_16x16x32_bf16 v[88:91], a[240:243], a[144:147], 0
ds_read_b128 a[232:235], v2 offset:15360
buffer_load_dwordx4 a[112:115], v2, s[8:11], s27 offen offset:2048 sc1
v_mfma_f32_16x16x32_bf16 v[88:91], a[244:247], a[148:151], v[88:91]
ds_read_b128 a[236:239], v2 offset:22528
s_waitcnt lgkmcnt(4)
v_mfma_f32_16x16x32_bf16 v[92:95], a[144:147], a[216:219], 0
ds_read_b128 a[240:243], v2 offset:16384
v_cvt_pk_bf16_f32 v213, v26, v27
v_mfma_f32_16x16x32_bf16 v[92:95], a[148:151], a[220:223], v[92:95]
ds_read_b128 a[244:247], v2 offset:23552
s_waitcnt vmcnt(20)
s_waitcnt lgkmcnt(4)
v_mfma_f32_16x16x32_bf16 v[32:35], a[224:227], a[8:11], v[32:35]
buffer_load_dwordx4 a[184:187], v3, s[8:11], s28 offen offset:2048 sc1
v_mfma_f32_16x16x32_bf16 v[32:35], a[228:231], a[12:15], v[32:35]
ds_read_b128 a[216:219], v2 offset:17408
v_cvt_pk_bf16_f32 v214, v28, v29
v_mfma_f32_16x16x32_bf16 v[36:39], a[224:227], a[80:83], v[36:39]
v_cvt_pk_bf16_f32 v215, v30, v31
v_dot2_f32_bf16 v24, v216, s38, v22
v_mfma_f32_16x16x32_bf16 v[36:39], a[228:231], a[84:87], v[36:39]
ds_read_b128 a[220:223], v2 offset:24576
s_waitcnt lgkmcnt(4)
v_mfma_f32_16x16x32_bf16 v[40:43], a[232:235], a[8:11], v[40:43]
buffer_load_dwordx4 a[44:47], v2, s[8:11], s26 offen offset:3072 sc1
v_mfma_f32_16x16x32_bf16 v[40:43], a[236:239], a[12:15], v[40:43]
ds_read_b128 a[224:227], v2 offset:18432
v_dot2_f32_bf16 v25, v216, s39, v22
v_mfma_f32_16x16x32_bf16 v[44:47], a[232:235], a[80:83], v[44:47]
v_dot2_f32_bf16 v26, v217, s38, v22
v_dot2_f32_bf16 v27, v217, s39, v22
v_mfma_f32_16x16x32_bf16 v[44:47], a[236:239], a[84:87], v[44:47]
ds_read_b128 a[228:231], v2 offset:25600
s_waitcnt lgkmcnt(4)
v_mfma_f32_16x16x32_bf16 v[48:51], a[240:243], a[8:11], v[48:51]
buffer_load_dwordx4 a[116:119], v2, s[8:11], s27 offen offset:3072 sc1
v_mfma_f32_16x16x32_bf16 v[48:51], a[244:247], a[12:15], v[48:51]
ds_read_b128 a[232:235], v2 offset:19456
v_dot2_f32_bf16 v28, v218, s38, v22
v_mfma_f32_16x16x32_bf16 v[52:55], a[240:243], a[80:83], v[52:55]
v_dot2_f32_bf16 v29, v218, s39, v22
v_dot2_f32_bf16 v30, v219, s38, v22
v_mfma_f32_16x16x32_bf16 v[52:55], a[244:247], a[84:87], v[52:55]
ds_read_b128 a[236:239], v2 offset:26624
s_waitcnt lgkmcnt(4)
v_mfma_f32_16x16x32_bf16 v[56:59], a[216:219], a[8:11], v[56:59]
buffer_load_dwordx4 a[188:191], v3, s[8:11], s28 offen offset:3072 sc1
v_mfma_f32_16x16x32_bf16 v[56:59], a[220:223], a[12:15], v[56:59]
ds_read_b128 a[240:243], v2 offset:20480
v_dot2_f32_bf16 v31, v219, s39, v22
v_mfma_f32_16x16x32_bf16 v[60:63], a[216:219], a[80:83], v[60:63]
v_cvt_pk_bf16_f32 v216, v24, v25
v_cvt_pk_bf16_f32 v217, v26, v27
v_mfma_f32_16x16x32_bf16 v[60:63], a[220:223], a[84:87], v[60:63]
ds_read_b128 a[244:247], v2 offset:27648
s_waitcnt lgkmcnt(4)
v_mfma_f32_16x16x32_bf16 v[64:67], a[224:227], a[8:11], v[64:67]
s_add_u32 s26, s26, 4096
s_add_u32 s27, s27, 4096
s_add_u32 s28, s28, 4096
buffer_load_dwordx4 a[48:51], v2, s[8:11], s26 offen offset:0 sc1
v_mfma_f32_16x16x32_bf16 v[64:67], a[228:231], a[12:15], v[64:67]
ds_read_b128 a[216:219], v6 offset:14336
v_cvt_pk_bf16_f32 v218, v28, v29
v_mfma_f32_16x16x32_bf16 v[68:71], a[224:227], a[80:83], v[68:71]
v_cvt_pk_bf16_f32 v219, v30, v31
v_dot2_f32_bf16 v24, v220, s38, v23
v_mfma_f32_16x16x32_bf16 v[68:71], a[228:231], a[84:87], v[68:71]
ds_read_b128 a[220:223], v6 offset:21504
s_waitcnt lgkmcnt(4)
v_mfma_f32_16x16x32_bf16 v[72:75], a[8:11], a[232:235], v[72:75]
buffer_load_dwordx4 a[120:123], v2, s[8:11], s27 offen offset:0 sc1
v_mfma_f32_16x16x32_bf16 v[72:75], a[12:15], a[236:239], v[72:75]
ds_read_b128 a[224:227], v9 offset:14336
v_dot2_f32_bf16 v25, v220, s39, v23
v_mfma_f32_16x16x32_bf16 v[76:79], a[80:83], a[232:235], v[76:79]
v_dot2_f32_bf16 v26, v221, s38, v23
v_dot2_f32_bf16 v27, v221, s39, v23
v_mfma_f32_16x16x32_bf16 v[76:79], a[84:87], a[236:239], v[76:79]
ds_read_b128 a[228:231], v9 offset:21504
s_waitcnt lgkmcnt(4)
v_mfma_f32_16x16x32_bf16 v[80:83], a[8:11], a[240:243], v[80:83]
buffer_load_dwordx4 a[192:195], v3, s[8:11], s28 offen offset:0 sc1
v_mfma_f32_16x16x32_bf16 v[80:83], a[12:15], a[244:247], v[80:83]
ds_read_b128 a[232:235], v2 offset:28672
v_dot2_f32_bf16 v28, v222, s38, v23
v_mfma_f32_16x16x32_bf16 v[84:87], a[80:83], a[240:243], v[84:87]
v_dot2_f32_bf16 v29, v222, s39, v23
v_dot2_f32_bf16 v30, v223, s38, v23
v_mfma_f32_16x16x32_bf16 v[84:87], a[84:87], a[244:247], v[84:87]
ds_read_b128 a[236:239], v2 offset:35840
s_waitcnt lgkmcnt(4)
v_mfma_f32_16x16x32_bf16 v[88:91], a[216:219], a[152:155], v[88:91]
ds_read_b128 a[240:243], v2 offset:29696
buffer_load_dwordx4 a[52:55], v2, s[8:11], s26 offen offset:1024 sc1
v_mfma_f32_16x16x32_bf16 v[88:91], a[220:223], a[156:159], v[88:91]
ds_read_b128 a[244:247], v2 offset:36864
s_waitcnt lgkmcnt(4)
v_mfma_f32_16x16x32_bf16 v[92:95], a[152:155], a[224:227], v[92:95]
ds_read_b128 a[216:219], v2 offset:30720
v_dot2_f32_bf16 v31, v223, s39, v23
v_mfma_f32_16x16x32_bf16 v[92:95], a[156:159], a[228:231], v[92:95]
ds_read_b128 a[220:223], v2 offset:37888
s_waitcnt vmcnt(22)
s_waitcnt lgkmcnt(4)
v_mfma_f32_16x16x32_bf16 v[32:35], a[232:235], a[16:19], v[32:35]
buffer_load_dwordx4 a[124:127], v2, s[8:11], s27 offen offset:1024 sc1
v_mfma_f32_16x16x32_bf16 v[32:35], a[236:239], a[20:23], v[32:35]
ds_read_b128 a[224:227], v2 offset:31744
v_cvt_pk_bf16_f32 v220, v24, v25
v_mfma_f32_16x16x32_bf16 v[36:39], a[232:235], a[88:91], v[36:39]
v_cvt_pk_bf16_f32 v221, v26, v27
v_cvt_pk_bf16_f32 v222, v28, v29
v_mfma_f32_16x16x32_bf16 v[36:39], a[236:239], a[92:95], v[36:39]
ds_read_b128 a[228:231], v2 offset:38912
s_waitcnt lgkmcnt(4)
v_mfma_f32_16x16x32_bf16 v[40:43], a[240:243], a[16:19], v[40:43]
buffer_load_dwordx4 a[196:199], v3, s[8:11], s28 offen offset:1024 sc1
v_mfma_f32_16x16x32_bf16 v[40:43], a[244:247], a[20:23], v[40:43]
ds_read_b128 a[232:235], v2 offset:32768
v_cvt_pk_bf16_f32 v223, v30, v31
v_mfma_f32_16x16x32_bf16 v[44:47], a[240:243], a[88:91], v[44:47]
v_dot2_f32_bf16 v24, v224, s38, v20
v_dot2_f32_bf16 v25, v224, s39, v20
v_mfma_f32_16x16x32_bf16 v[44:47], a[244:247], a[92:95], v[44:47]
ds_read_b128 a[236:239], v2 offset:39936
s_waitcnt lgkmcnt(4)
v_mfma_f32_16x16x32_bf16 v[48:51], a[216:219], a[16:19], v[48:51]
buffer_load_dwordx4 a[56:59], v2, s[8:11], s26 offen offset:2048 sc1
v_mfma_f32_16x16x32_bf16 v[48:51], a[220:223], a[20:23], v[48:51]
ds_read_b128 a[240:243], v2 offset:33792
v_dot2_f32_bf16 v26, v225, s38, v20
v_mfma_f32_16x16x32_bf16 v[52:55], a[216:219], a[88:91], v[52:55]
v_dot2_f32_bf16 v27, v225, s39, v20
v_dot2_f32_bf16 v28, v226, s38, v20
v_mfma_f32_16x16x32_bf16 v[52:55], a[220:223], a[92:95], v[52:55]
ds_read_b128 a[244:247], v2 offset:40960
s_waitcnt lgkmcnt(4)
v_mfma_f32_16x16x32_bf16 v[56:59], a[224:227], a[16:19], v[56:59]
L_hop1:
s_cmp_eq_u32 s15, 1
s_cbranch_scc1 L_hop5
buffer_load_dwordx4 a[128:131], v2, s[8:11], s27 offen offset:2048 sc1
v_mfma_f32_16x16x32_bf16 v[56:59], a[228:231], a[20:23], v[56:59]
ds_read_b128 a[216:219], v2 offset:34816
v_dot2_f32_bf16 v29, v226, s39, v20
v_mfma_f32_16x16x32_bf16 v[60:63], a[224:227], a[88:91], v[60:63]
v_dot2_f32_bf16 v30, v227, s38, v20
v_dot2_f32_bf16 v31, v227, s39, v20
v_mfma_f32_16x16x32_bf16 v[60:63], a[228:231], a[92:95], v[60:63]
ds_read_b128 a[220:223], v2 offset:41984
s_waitcnt lgkmcnt(4)
v_mfma_f32_16x16x32_bf16 v[64:67], a[232:235], a[16:19], v[64:67]
buffer_load_dwordx4 a[200:203], v3, s[8:11], s28 offen offset:2048 sc1
v_mfma_f32_16x16x32_bf16 v[64:67], a[236:239], a[20:23], v[64:67]
ds_read_b128 a[224:227], v6 offset:28672
v_cvt_pk_bf16_f32 v224, v24, v25
v_mfma_f32_16x16x32_bf16 v[68:71], a[232:235], a[88:91], v[68:71]
v_cvt_pk_bf16_f32 v225, v26, v27
v_cvt_pk_bf16_f32 v226, v28, v29
v_mfma_f32_16x16x32_bf16 v[68:71], a[236:239], a[92:95], v[68:71]
ds_read_b128 a[228:231], v6 offset:35840
s_waitcnt lgkmcnt(4)
v_mfma_f32_16x16x32_bf16 v[72:75], a[16:19], a[240:243], v[72:75]
buffer_load_dwordx4 a[60:63], v2, s[8:11], s26 offen offset:3072 sc1
v_mfma_f32_16x16x32_bf16 v[72:75], a[20:23], a[244:247], v[72:75]
ds_read_b128 a[232:235], v9 offset:28672
v_cvt_pk_bf16_f32 v227, v30, v31
v_mfma_f32_16x16x32_bf16 v[76:79], a[88:91], a[240:243], v[76:79]
v_dot2_f32_bf16 v24, v228, s38, v21
v_dot2_f32_bf16 v25, v228, s39, v21
v_mfma_f32_16x16x32_bf16 v[76:79], a[92:95], a[244:247], v[76:79]
ds_read_b128 a[236:239], v9 offset:35840
s_waitcnt lgkmcnt(4)
v_mfma_f32_16x16x32_bf16 v[80:83], a[16:19], a[216:219], v[80:83]
buffer_load_dwordx4 a[132:135], v2, s[8:11], s27 offen offset:3072 sc1
v_mfma_f32_16x16x32_bf16 v[80:83], a[20:23], a[220:223], v[80:83]
ds_read_b128 a[240:243], v2 offset:43008
v_dot2_f32_bf16 v26, v229, s38, v21
v_mfma_f32_16x16x32_bf16 v[84:87], a[88:91], a[216:219], v[84:87]
v_dot2_f32_bf16 v27, v229, s39, v21
v_dot2_f32_bf16 v28, v230, s38, v21
v_mfma_f32_16x16x32_bf16 v[84:87], a[92:95], a[220:223], v[84:87]
ds_read_b128 a[244:247], v2 offset:50176
s_waitcnt lgkmcnt(4)
v_mfma_f32_16x16x32_bf16 v[88:91], a[224:227], a[160:163], v[88:91]
ds_read_b128 a[216:219], v2 offset:44032
buffer_load_dwordx4 a[204:207], v3, s[8:11], s28 offen offset:3072 sc1
v_mfma_f32_16x16x32_bf16 v[88:91], a[228:231], a[164:167], v[88:91]
ds_read_b128 a[220:223], v2 offset:51200
s_waitcnt lgkmcnt(4)
v_mfma_f32_16x16x32_bf16 v[92:95], a[160:163], a[232:235], v[92:95]
ds_read_b128 a[224:227], v2 offset:45056
v_dot2_f32_bf16 v29, v230, s39, v21
v_mfma_f32_16x16x32_bf16 v[92:95], a[164:167], a[236:239], v[92:95]
ds_read_b128 a[228:231], v2 offset:52224
s_waitcnt vmcnt(24)
s_waitcnt lgkmcnt(4)
v_mfma_f32_16x16x32_bf16 v[32:35], a[240:243], a[24:27], v[32:35]
s_add_u32 s26, s26, 4096
s_add_u32 s27, s27, 4096
s_add_u32 s28, s28, 4096
buffer_load_dwordx4 a[64:67], v2, s[8:11], s26 offen offset:0 sc1
v_mfma_f32_16x16x32_bf16 v[32:35], a[244:247], a[28:31], v[32:35]
ds_read_b128 a[232:235], v2 offset:46080
v_dot2_f32_bf16 v30, v231, s38, v21
v_mfma_f32_16x16x32_bf16 v[36:39], a[240:243], a[96:99], v[36:39]
v_dot2_f32_bf16 v31, v231, s39, v21
v_cvt_pk_bf16_f32 v228, v24, v25
v_mfma_f32_16x16x32_bf16 v[36:39], a[244:247], a[100:103], v[36:39]
ds_read_b128 a[236:239], v2 offset:53248
s_waitcnt lgkmcnt(4)
v_mfma_f32_16x16x32_bf16 v[40:43], a[216:219], a[24:27], v[40:43]
buffer_load_dwordx4 a[136:139], v2, s[8:11], s27 offen offset:0 sc1
v_mfma_f32_16x16x32_bf16 v[40:43], a[220:223], a[28:31], v[40:43]
ds_read_b128 a[240:243], v2 offset:47104
v_cvt_pk_bf16_f32 v229, v26, v27
v_mfma_f32_16x16x32_bf16 v[44:47], a[216:219], a[96:99], v[44:47]
v_cvt_pk_bf16_f32 v230, v28, v29
v_cvt_pk_bf16_f32 v231, v30, v31
v_mfma_f32_16x16x32_bf16 v[44:47], a[220:223], a[100:103], v[44:47]
ds_read_b128 a[244:247], v2 offset:54272
s_waitcnt lgkmcnt(4)
v_mfma_f32_16x16x32_bf16 v[48:51], a[224:227], a[24:27], v[48:51]
buffer_load_dwordx4 a[208:211], v3, s[8:11], s28 offen offset:0 sc1
v_mfma_f32_16x16x32_bf16 v[48:51], a[228:231], a[28:31], v[48:51]
ds_read_b128 a[216:219], v2 offset:48128
v_dot2_f32_bf16 v24, v232, s38, v22
v_mfma_f32_16x16x32_bf16 v[52:55], a[224:227], a[96:99], v[52:55]
v_dot2_f32_bf16 v25, v232, s39, v22
v_dot2_f32_bf16 v26, v233, s38, v22
v_mfma_f32_16x16x32_bf16 v[52:55], a[228:231], a[100:103], v[52:55]
ds_read_b128 a[220:223], v2 offset:55296
s_waitcnt lgkmcnt(4)
v_mfma_f32_16x16x32_bf16 v[56:59], a[232:235], a[24:27], v[56:59]
buffer_load_dwordx4 a[68:71], v2, s[8:11], s26 offen offset:1024 sc1
v_mfma_f32_16x16x32_bf16 v[56:59], a[236:239], a[28:31], v[56:59]
ds_read_b128 a[224:227], v2 offset:49152
v_dot2_f32_bf16 v27, v233, s39, v22
v_mfma_f32_16x16x32_bf16 v[60:63], a[232:235], a[96:99], v[60:63]
v_dot2_f32_bf16 v28, v234, s38, v22
v_dot2_f32_bf16 v29, v234, s39, v22
v_mfma_f32_16x16x32_bf16 v[60:63], a[236:239], a[100:103], v[60:63]
ds_read_b128 a[228:231], v2 offset:56320
s_waitcnt lgkmcnt(4)
v_mfma_f32_16x16x32_bf16 v[64:67], a[240:243], a[24:27], v[64:67]
buffer_load_dwordx4 a[140:143], v2, s[8:11], s27 offen offset:1024 sc1
v_mfma_f32_16x16x32_bf16 v[64:67], a[244:247], a[28:31], v[64:67]
ds_read_b128 a[232:235], v6 offset:43008
v_dot2_f32_bf16 v30, v235, s38, v22
v_mfma_f32_16x16x32_bf16 v[68:71], a[240:243], a[96:99], v[68:71]
v_dot2_f32_bf16 v31, v235, s39, v22
v_cvt_pk_bf16_f32 v232, v24, v25
v_mfma_f32_16x16x32_bf16 v[68:71], a[244:247], a[100:103], v[68:71]
ds_read_b128 a[236:239], v6 offset:50176
s_waitcnt lgkmcnt(4)
v_mfma_f32_16x16x32_bf16 v[72:75], a[24:27], a[216:219], v[72:75]
buffer_load_dwordx4 a[212:215], v3, s[8:11], s28 offen offset:1024 sc1
v_mfma_f32_16x16x32_bf16 v[72:75], a[28:31], a[220:223], v[72:75]
ds_read_b128 a[240:243], v9 offset:43008
v_cvt_pk_bf16_f32 v233, v26, v27
v_mfma_f32_16x16x32_bf16 v[76:79], a[96:99], a[216:219], v[76:79]
v_cvt_pk_bf16_f32 v234, v28, v29
v_cvt_pk_bf16_f32 v235, v30, v31
v_mfma_f32_16x16x32_bf16 v[76:79], a[100:103], a[220:223], v[76:79]
ds_read_b128 a[244:247], v9 offset:50176
s_waitcnt lgkmcnt(4)
v_mfma_f32_16x16x32_bf16 v[80:83], a[24:27], a[224:227], v[80:83]
buffer_store_dwordx4 v[176:179], v156, s[8:11], 0 offen sc1
v_dot2_f32_bf16 v24, v236, s38, v23
v_mfma_f32_16x16x32_bf16 v[80:83], a[28:31], a[228:231], v[80:83]
ds_read_b128 a[216:219], v2 offset:57344
v_dot2_f32_bf16 v25, v236, s39, v23
v_mfma_f32_16x16x32_bf16 v[84:87], a[96:99], a[224:227], v[84:87]
v_dot2_f32_bf16 v26, v237, s38, v23
v_dot2_f32_bf16 v27, v237, s39, v23
v_mfma_f32_16x16x32_bf16 v[84:87], a[100:103], a[228:231], v[84:87]
ds_read_b128 a[220:223], v2 offset:64512
s_waitcnt lgkmcnt(4)
v_mfma_f32_16x16x32_bf16 v[88:91], a[232:235], a[168:171], v[88:91]
ds_read_b128 a[224:227], v2 offset:58368
buffer_store_dwordx4 v[180:183], v157, s[8:11], 0 offen sc1
v_dot2_f32_bf16 v28, v238, s38, v23
v_mfma_f32_16x16x32_bf16 v[88:91], a[236:239], a[172:175], v[88:91]
ds_read_b128 a[228:231], v4 offset:0
s_waitcnt lgkmcnt(4)
v_mfma_f32_16x16x32_bf16 v[92:95], a[168:171], a[240:243], v[92:95]
ds_read_b128 a[232:235], v2 offset:59392
v_dot2_f32_bf16 v29, v238, s39, v23
v_mfma_f32_16x16x32_bf16 v[92:95], a[172:175], a[244:247], v[92:95]
ds_read_b128 a[236:239], v4 offset:1024
s_waitcnt vmcnt(26)
s_waitcnt lgkmcnt(4)
v_mfma_f32_16x16x32_bf16 v[32:35], a[216:219], a[32:35], v[32:35]
buffer_store_dwordx4 v[184:187], v158, s[8:11], 0 offen sc1
v_dot2_f32_bf16 v30, v239, s38, v23
v_mfma_f32_16x16x32_bf16 v[32:35], a[220:223], a[36:39], v[32:35]
ds_read_b128 a[240:243], v2 offset:60416
v_dot2_f32_bf16 v31, v239, s39, v23
v_mfma_f32_16x16x32_bf16 v[36:39], a[216:219], a[104:107], v[36:39]
v_cvt_pk_bf16_f32 v236, v24, v25
v_cvt_pk_bf16_f32 v237, v26, v27
v_mfma_f32_16x16x32_bf16 v[36:39], a[220:223], a[108:111], v[36:39]
ds_read_b128 a[244:247], v4 offset:2048
s_waitcnt lgkmcnt(4)
v_mfma_f32_16x16x32_bf16 v[40:43], a[224:227], a[32:35], v[40:43]
buffer_store_dwordx4 v[188:191], v159, s[8:11], 0 offen sc1
v_cvt_pk_bf16_f32 v238, v28, v29
v_mfma_f32_16x16x32_bf16 v[40:43], a[228:231], a[36:39], v[40:43]
ds_read_b128 a[216:219], v2 offset:61440
v_cvt_pk_bf16_f32 v239, v30, v31
v_mfma_f32_16x16x32_bf16 v[44:47], a[224:227], a[104:107], v[44:47]
v_dot2_f32_bf16 v24, v240, s38, v20
v_dot2_f32_bf16 v25, v240, s39, v20
v_mfma_f32_16x16x32_bf16 v[44:47], a[228:231], a[108:111], v[44:47]
ds_read_b128 a[220:223], v4 offset:3072
s_waitcnt lgkmcnt(4)
v_mfma_f32_16x16x32_bf16 v[48:51], a[232:235], a[32:35], v[48:51]
buffer_store_dwordx4 v[192:195], v160, s[8:11], 0 offen sc1
v_dot2_f32_bf16 v26, v241, s38, v20
v_mfma_f32_16x16x32_bf16 v[48:51], a[236:239], a[36:39], v[48:51]
ds_read_b128 a[224:227], v2 offset:62464
v_dot2_f32_bf16 v27, v241, s39, v20
v_mfma_f32_16x16x32_bf16 v[52:55], a[232:235], a[104:107], v[52:55]
v_dot2_f32_bf16 v28, v242, s38, v20
v_dot2_f32_bf16 v29, v242, s39, v20
v_mfma_f32_16x16x32_bf16 v[52:55], a[236:239], a[108:111], v[52:55]
ds_read_b128 a[228:231], v4 offset:4096
s_waitcnt lgkmcnt(4)
v_mfma_f32_16x16x32_bf16 v[56:59], a[240:243], a[32:35], v[56:59]
buffer_store_dwordx4 v[196:199], v161, s[8:11], 0 offen sc1
v_dot2_f32_bf16 v30, v243, s38, v20
v_mfma_f32_16x16x32_bf16 v[56:59], a[244:247], a[36:39], v[56:59]
ds_read_b128 a[232:235], v2 offset:63488
v_dot2_f32_bf16 v31, v243, s39, v20
v_mfma_f32_16x16x32_bf16 v[60:63], a[240:243], a[104:107], v[60:63]
v_cvt_pk_bf16_f32 v240, v24, v25
v_cvt_pk_bf16_f32 v241, v26, v27
v_mfma_f32_16x16x32_bf16 v[60:63], a[244:247], a[108:111], v[60:63]
ds_read_b128 a[236:239], v4 offset:5120
s_waitcnt lgkmcnt(4)
v_mfma_f32_16x16x32_bf16 v[64:67], a[216:219], a[32:35], v[64:67]
buffer_store_dwordx4 v[200:203], v162, s[8:11], 0 offen sc1
v_cvt_pk_bf16_f32 v242, v28, v29
v_mfma_f32_16x16x32_bf16 v[64:67], a[220:223], a[36:39], v[64:67]
ds_read_b128 a[240:243], v6 offset:57344
v_cvt_pk_bf16_f32 v243, v30, v31
v_mfma_f32_16x16x32_bf16 v[68:71], a[216:219], a[104:107], v[68:71]
v_dot2_f32_bf16 v24, v244, s38, v21
v_dot2_f32_bf16 v25, v244, s39, v21
v_mfma_f32_16x16x32_bf16 v[68:71], a[220:223], a[108:111], v[68:71]
ds_read_b128 a[244:247], v6 offset:64512
s_waitcnt lgkmcnt(4)
v_mfma_f32_16x16x32_bf16 v[72:75], a[32:35], a[224:227], v[72:75]
buffer_store_dwordx4 v[204:207], v163, s[8:11], 0 offen sc1
v_dot2_f32_bf16 v26, v245, s38, v21
v_mfma_f32_16x16x32_bf16 v[72:75], a[36:39], a[228:231], v[72:75]
ds_read_b128 a[216:219], v9 offset:57344
v_dot2_f32_bf16 v27, v245, s39, v21
v_mfma_f32_16x16x32_bf16 v[76:79], a[104:107], a[224:227], v[76:79]
v_dot2_f32_bf16 v28, v246, s38, v21
v_dot2_f32_bf16 v29, v246, s39, v21
v_mfma_f32_16x16x32_bf16 v[76:79], a[108:111], a[228:231], v[76:79]
ds_read_b128 a[220:223], v9 offset:64512
s_waitcnt lgkmcnt(4)
v_mfma_f32_16x16x32_bf16 v[80:83], a[32:35], a[232:235], v[80:83]
buffer_store_dwordx4 v[208:211], v164, s[8:11], 0 offen sc1
v_dot2_f32_bf16 v30, v247, s38, v21
v_mfma_f32_16x16x32_bf16 v[80:83], a[36:39], a[236:239], v[80:83]
ds_read_b128 a[224:227], v4 offset:6144
v_dot2_f32_bf16 v31, v247, s39, v21
v_mfma_f32_16x16x32_bf16 v[84:87], a[104:107], a[232:235], v[84:87]
v_cvt_pk_bf16_f32 v244, v24, v25
v_cvt_pk_bf16_f32 v245, v26, v27
v_mfma_f32_16x16x32_bf16 v[84:87], a[108:111], a[236:239], v[84:87]
ds_read_b128 a[228:231], v4 offset:13312
s_waitcnt lgkmcnt(4)
v_mfma_f32_16x16x32_bf16 v[88:91], a[240:243], a[176:179], v[88:91]
ds_read_b128 a[232:235], v4 offset:7168
buffer_store_dwordx4 v[212:215], v165, s[8:11], 0 offen sc1
v_cvt_pk_bf16_f32 v246, v28, v29
v_mfma_f32_16x16x32_bf16 v[88:91], a[244:247], a[180:183], v[88:91]
ds_read_b128 a[236:239], v4 offset:14336
s_waitcnt lgkmcnt(4)
v_mfma_f32_16x16x32_bf16 v[92:95], a[176:179], a[216:219], v[92:95]
ds_read_b128 a[240:243], v4 offset:8192
v_cvt_pk_bf16_f32 v247, v30, v31
v_mfma_f32_16x16x32_bf16 v[92:95], a[180:183], a[220:223], v[92:95]
ds_read_b128 a[244:247], v4 offset:15360
s_waitcnt vmcnt(28)
s_waitcnt lgkmcnt(4)
v_mfma_f32_16x16x32_bf16 v[32:35], a[224:227], a[40:43], v[32:35]
buffer_store_dwordx4 v[216:219], v166, s[8:11], 0 offen sc1
v_dot2_f32_bf16 v24, v248, s38, v22
v_mfma_f32_16x16x32_bf16 v[32:35], a[228:231], a[44:47], v[32:35]
ds_read_b128 a[216:219], v4 offset:9216
v_dot2_f32_bf16 v25, v248, s39, v22
v_mfma_f32_16x16x32_bf16 v[36:39], a[224:227], a[112:115], v[36:39]
v_dot2_f32_bf16 v26, v249, s38, v22
v_dot2_f32_bf16 v27, v249, s39, v22
v_mfma_f32_16x16x32_bf16 v[36:39], a[228:231], a[116:119], v[36:39]
ds_read_b128 a[220:223], v4 offset:16384
s_waitcnt lgkmcnt(4)
v_mfma_f32_16x16x32_bf16 v[40:43], a[232:235], a[40:43], v[40:43]
buffer_store_dwordx4 v[220:223], v167, s[8:11], 0 offen sc1
v_dot2_f32_bf16 v28, v250, s38, v22
v_mfma_f32_16x16x32_bf16 v[40:43], a[236:239], a[44:47], v[40:43]
ds_read_b128 a[224:227], v4 offset:10240
v_dot2_f32_bf16 v29, v250, s39, v22
v_mfma_f32_16x16x32_bf16 v[44:47], a[232:235], a[112:115], v[44:47]
v_dot2_f32_bf16 v30, v251, s38, v22
v_dot2_f32_bf16 v31, v251, s39, v22
v_mfma_f32_16x16x32_bf16 v[44:47], a[236:239], a[116:119], v[44:47]
ds_read_b128 a[228:231], v4 offset:17408
s_waitcnt lgkmcnt(4)
v_mfma_f32_16x16x32_bf16 v[48:51], a[240:243], a[40:43], v[48:51]
buffer_store_dwordx4 v[224:227], v168, s[8:11], 0 offen sc1
v_cvt_pk_bf16_f32 v248, v24, v25
v_mfma_f32_16x16x32_bf16 v[48:51], a[244:247], a[44:47], v[48:51]
ds_read_b128 a[232:235], v4 offset:11264
v_cvt_pk_bf16_f32 v249, v26, v27
v_mfma_f32_16x16x32_bf16 v[52:55], a[240:243], a[112:115], v[52:55]
v_cvt_pk_bf16_f32 v250, v28, v29
v_cvt_pk_bf16_f32 v251, v30, v31
v_mfma_f32_16x16x32_bf16 v[52:55], a[244:247], a[116:119], v[52:55]
ds_read_b128 a[236:239], v4 offset:18432
s_waitcnt lgkmcnt(4)
v_mfma_f32_16x16x32_bf16 v[56:59], a[216:219], a[40:43], v[56:59]
buffer_store_dwordx4 v[228:231], v169, s[8:11], 0 offen sc1
v_dot2_f32_bf16 v24, v252, s38, v23
v_mfma_f32_16x16x32_bf16 v[56:59], a[220:223], a[44:47], v[56:59]
ds_read_b128 a[240:243], v4 offset:12288
v_dot2_f32_bf16 v25, v252, s39, v23
v_mfma_f32_16x16x32_bf16 v[60:63], a[216:219], a[112:115], v[60:63]
v_dot2_f32_bf16 v26, v253, s38, v23
v_dot2_f32_bf16 v27, v253, s39, v23
v_mfma_f32_16x16x32_bf16 v[60:63], a[220:223], a[116:119], v[60:63]
ds_read_b128 a[244:247], v4 offset:19456
s_waitcnt lgkmcnt(4)
v_mfma_f32_16x16x32_bf16 v[64:67], a[224:227], a[40:43], v[64:67]
buffer_store_dwordx4 v[232:235], v170, s[8:11], 0 offen sc1
v_dot2_f32_bf16 v28, v254, s38, v23
v_mfma_f32_16x16x32_bf16 v[64:67], a[228:231], a[44:47], v[64:67]
ds_read_b128 a[216:219], v7 offset:6144
v_dot2_f32_bf16 v29, v254, s39, v23
v_mfma_f32_16x16x32_bf16 v[68:71], a[224:227], a[112:115], v[68:71]
v_dot2_f32_bf16 v30, v255, s38, v23
v_dot2_f32_bf16 v31, v255, s39, v23
v_mfma_f32_16x16x32_bf16 v[68:71], a[228:231], a[116:119], v[68:71]
ds_read_b128 a[220:223], v7 offset:13312
s_waitcnt lgkmcnt(4)
v_mfma_f32_16x16x32_bf16 v[72:75], a[40:43], a[232:235], v[72:75]
buffer_store_dwordx4 v[236:239], v171, s[8:11], 0 offen sc1
v_cvt_pk_bf16_f32 v252, v24, v25
v_mfma_f32_16x16x32_bf16 v[72:75], a[44:47], a[236:239], v[72:75]
ds_read_b128 a[224:227], v10 offset:6144
v_cvt_pk_bf16_f32 v253, v26, v27
v_mfma_f32_16x16x32_bf16 v[76:79], a[112:115], a[232:235], v[76:79]
v_cvt_pk_bf16_f32 v254, v28, v29
v_cvt_pk_bf16_f32 v255, v30, v31
v_mfma_f32_16x16x32_bf16 v[76:79], a[116:119], a[236:239], v[76:79]
ds_read_b128 a[228:231], v10 offset:13312
s_waitcnt lgkmcnt(4)
v_mfma_f32_16x16x32_bf16 v[80:83], a[40:43], a[240:243], v[80:83]
buffer_store_dwordx4 v[240:243], v172, s[8:11], 0 offen sc1
v_lshlrev_b32 v14, 3, v1
v_mfma_f32_16x16x32_bf16 v[80:83], a[44:47], a[244:247], v[80:83]
ds_read_b128 a[232:235], v4 offset:20480
s_mul_i32 s31, s4, 3072
v_mfma_f32_16x16x32_bf16 v[84:87], a[112:115], a[240:243], v[84:87]
s_add_u32 s41, s31, 147456
v_add_u32 v15, s41, v14
v_mfma_f32_16x16x32_bf16 v[84:87], a[116:119], a[244:247], v[84:87]
ds_read_b128 a[236:239], v4 offset:27648
s_waitcnt lgkmcnt(4)
v_mfma_f32_16x16x32_bf16 v[88:91], a[216:219], a[184:187], v[88:91]
ds_read_b128 a[240:243], v4 offset:21504
buffer_store_dwordx4 v[244:247], v173, s[8:11], 0 offen sc1
s_lshl_b32 s42, s29, 9
v_mfma_f32_16x16x32_bf16 v[88:91], a[220:223], a[188:191], v[88:91]
ds_read_b128 a[244:247], v4 offset:28672
s_waitcnt lgkmcnt(4)
v_mfma_f32_16x16x32_bf16 v[92:95], a[184:187], a[224:227], v[92:95]
ds_read_b128 a[216:219], v4 offset:22528
s_add_u32 s42, s42, 147456
v_mfma_f32_16x16x32_bf16 v[92:95], a[188:191], a[228:231], v[92:95]
ds_read_b128 a[220:223], v4 offset:29696
s_waitcnt vmcnt(30)
s_waitcnt lgkmcnt(4)
v_mfma_f32_16x16x32_bf16 v[32:35], a[232:235], a[48:51], v[32:35]
buffer_store_dwordx4 v[248:251], v174, s[8:11], 0 offen sc1
v_add_u32 v16, s42, v14
v_mfma_f32_16x16x32_bf16 v[32:35], a[236:239], a[52:55], v[32:35]
ds_read_b128 a[224:227], v4 offset:23552
s_and_b32 s42, s42, 512
v_mfma_f32_16x16x32_bf16 v[36:39], a[232:235], a[120:123], v[36:39]
s_add_u32 s42, s42, 147456
v_add_u32 v19, s42, v14
v_mfma_f32_16x16x32_bf16 v[36:39], a[236:239], a[124:127], v[36:39]
ds_read_b128 a[228:231], v4 offset:30720
s_waitcnt lgkmcnt(4)
v_mfma_f32_16x16x32_bf16 v[40:43], a[240:243], a[48:51], v[40:43]
buffer_store_dwordx4 v[252:255], v175, s[8:11], 0 offen sc1
v_add_u32 v18, 150016, v14
v_mfma_f32_16x16x32_bf16 v[40:43], a[244:247], a[52:55], v[40:43]
ds_read_b128 a[232:235], v4 offset:24576
v_mov_b32 v96, 0
v_mfma_f32_16x16x32_bf16 v[44:47], a[240:243], a[120:123], v[44:47]
v_mov_b32 v97, 0
v_mov_b32 v100, 0
v_mfma_f32_16x16x32_bf16 v[44:47], a[244:247], a[124:127], v[44:47]
ds_read_b128 a[236:239], v4 offset:31744
s_waitcnt lgkmcnt(4)
v_mfma_f32_16x16x32_bf16 v[48:51], a[216:219], a[48:51], v[48:51]
v_mov_b32 v101, 0
v_and_b32 v13, 1, v1
v_mfma_f32_16x16x32_bf16 v[48:51], a[220:223], a[52:55], v[48:51]
ds_read_b128 a[240:243], v4 offset:25600
v_lshlrev_b32 v13, 4, v13
v_mfma_f32_16x16x32_bf16 v[52:55], a[216:219], a[120:123], v[52:55]
v_mov_b32 v102, 0x3f80
v_lshlrev_b32 v13, v13, v102
v_mfma_f32_16x16x32_bf16 v[52:55], a[220:223], a[124:127], v[52:55]
ds_read_b128 a[244:247], v4 offset:32768
s_waitcnt lgkmcnt(4)
v_mfma_f32_16x16x32_bf16 v[56:59], a[224:227], a[48:51], v[56:59]
v_lshrrev_b32 v102, 1, v1
v_cmp_eq_u32 vcc, 16, v102
v_mfma_f32_16x16x32_bf16 v[56:59], a[228:231], a[52:55], v[56:59]
ds_read_b128 a[216:219], v4 offset:26624
v_cndmask_b32 v98, 0, v13, vcc
v_mfma_f32_16x16x32_bf16 v[60:63], a[224:227], a[120:123], v[60:63]
v_cmp_eq_u32 vcc, 17, v102
s_nop 1
v_cndmask_b32 v99, 0, v13, vcc
v_mfma_f32_16x16x32_bf16 v[60:63], a[228:231], a[124:127], v[60:63]
ds_read_b128 a[220:223], v4 offset:33792
s_waitcnt lgkmcnt(4)
v_mfma_f32_16x16x32_bf16 v[64:67], a[232:235], a[48:51], v[64:67]
v_add_u32 v17, 16, v12
v_cmp_gt_u32 vcc, 16, v1
v_mfma_f32_16x16x32_bf16 v[64:67], a[236:239], a[52:55], v[64:67]
ds_read_b128 a[224:227], v7 offset:20480
v_add_u32 v14, 48, v12
v_mfma_f32_16x16x32_bf16 v[68:71], a[232:235], a[120:123], v[68:71]
s_mov_b32 s34, 0x3eae1a93
v_cndmask_b32 v17, v14, v17, vcc
v_mfma_f32_16x16x32_bf16 v[68:71], a[236:239], a[124:127], v[68:71]
ds_read_b128 a[228:231], v7 offset:27648
s_waitcnt lgkmcnt(4)
v_mfma_f32_16x16x32_bf16 v[72:75], a[48:51], a[240:243], v[72:75]
v_lshlrev_b32 v17, 3, v17
v_add_u32 v17, s41, v17
v_mfma_f32_16x16x32_bf16 v[72:75], a[52:55], a[244:247], v[72:75]
ds_read_b128 a[232:235], v10 offset:20480
v_mfma_f32_16x16x32_bf16 v[76:79], a[120:123], a[240:243], v[76:79]
v_mfma_f32_16x16x32_bf16 v[76:79], a[124:127], a[244:247], v[76:79]
ds_read_b128 a[236:239], v10 offset:27648
s_waitcnt lgkmcnt(4)
v_mfma_f32_16x16x32_bf16 v[80:83], a[48:51], a[216:219], v[80:83]
v_mfma_f32_16x16x32_bf16 v[80:83], a[52:55], a[220:223], v[80:83]
ds_read_b128 a[240:243], v4 offset:34816
v_mfma_f32_16x16x32_bf16 v[84:87], a[120:123], a[216:219], v[84:87]
v_mfma_f32_16x16x32_bf16 v[84:87], a[124:127], a[220:223], v[84:87]
ds_read_b128 a[244:247], v4 offset:41984
s_waitcnt lgkmcnt(4)
v_mfma_f32_16x16x32_bf16 v[88:91], a[224:227], a[192:195], v[88:91]
ds_read_b128 a[216:219], v4 offset:35840
v_mfma_f32_16x16x32_bf16 v[88:91], a[228:231], a[196:199], v[88:91]
ds_read_b128 a[220:223], v4 offset:43008
s_waitcnt lgkmcnt(4)
v_mfma_f32_16x16x32_bf16 v[92:95], a[192:195], a[232:235], v[92:95]
ds_read_b128 a[224:227], v4 offset:36864
v_mfma_f32_16x16x32_bf16 v[92:95], a[196:199], a[236:239], v[92:95]
ds_read_b128 a[228:231], v4 offset:44032
s_waitcnt vmcnt(26)
s_waitcnt lgkmcnt(4)
v_mfma_f32_16x16x32_bf16 v[32:35], a[240:243], a[56:59], v[32:35]
v_mfma_f32_16x16x32_bf16 v[32:35], a[244:247], a[60:63], v[32:35]
ds_read_b128 a[232:235], v4 offset:37888
v_mfma_f32_16x16x32_bf16 v[36:39], a[240:243], a[128:131], v[36:39]
v_mfma_f32_16x16x32_bf16 v[36:39], a[244:247], a[132:135], v[36:39]
ds_read_b128 a[236:239], v4 offset:45056
s_waitcnt lgkmcnt(4)
v_mfma_f32_16x16x32_bf16 v[40:43], a[216:219], a[56:59], v[40:43]
v_mfma_f32_16x16x32_bf16 v[40:43], a[220:223], a[60:63], v[40:43]
ds_read_b128 a[240:243], v4 offset:38912
v_mfma_f32_16x16x32_bf16 v[44:47], a[216:219], a[128:131], v[44:47]
v_mfma_f32_16x16x32_bf16 v[44:47], a[220:223], a[132:135], v[44:47]
ds_read_b128 a[244:247], v4 offset:46080
s_waitcnt lgkmcnt(4)
v_mfma_f32_16x16x32_bf16 v[48:51], a[224:227], a[56:59], v[48:51]
v_mfma_f32_16x16x32_bf16 v[48:51], a[228:231], a[60:63], v[48:51]
ds_read_b128 a[216:219], v4 offset:39936
v_mfma_f32_16x16x32_bf16 v[52:55], a[224:227], a[128:131], v[52:55]
v_mfma_f32_16x16x32_bf16 v[52:55], a[228:231], a[132:135], v[52:55]
ds_read_b128 a[220:223], v4 offset:47104
s_waitcnt lgkmcnt(4)
v_mfma_f32_16x16x32_bf16 v[56:59], a[232:235], a[56:59], v[56:59]
v_mfma_f32_16x16x32_bf16 v[56:59], a[236:239], a[60:63], v[56:59]
ds_read_b128 a[224:227], v4 offset:40960
v_mfma_f32_16x16x32_bf16 v[60:63], a[232:235], a[128:131], v[60:63]
v_mfma_f32_16x16x32_bf16 v[60:63], a[236:239], a[132:135], v[60:63]
ds_read_b128 a[228:231], v4 offset:48128
s_waitcnt lgkmcnt(4)
v_mfma_f32_16x16x32_bf16 v[64:67], a[240:243], a[56:59], v[64:67]
v_mfma_f32_16x16x32_bf16 v[64:67], a[244:247], a[60:63], v[64:67]
ds_read_b128 a[232:235], v7 offset:34816
v_mfma_f32_16x16x32_bf16 v[68:71], a[240:243], a[128:131], v[68:71]
v_mfma_f32_16x16x32_bf16 v[68:71], a[244:247], a[132:135], v[68:71]
ds_read_b128 a[236:239], v7 offset:41984
s_waitcnt lgkmcnt(4)
v_mfma_f32_16x16x32_bf16 v[72:75], a[56:59], a[216:219], v[72:75]
v_mfma_f32_16x16x32_bf16 v[72:75], a[60:63], a[220:223], v[72:75]
ds_read_b128 a[240:243], v10 offset:34816
v_mfma_f32_16x16x32_bf16 v[76:79], a[128:131], a[216:219], v[76:79]
v_mfma_f32_16x16x32_bf16 v[76:79], a[132:135], a[220:223], v[76:79]
ds_read_b128 a[244:247], v10 offset:41984
s_waitcnt lgkmcnt(4)
v_mfma_f32_16x16x32_bf16 v[80:83], a[56:59], a[224:227], v[80:83]
v_mfma_f32_16x16x32_bf16 v[80:83], a[60:63], a[228:231], v[80:83]
ds_read_b128 a[216:219], v4 offset:49152
v_mfma_f32_16x16x32_bf16 v[84:87], a[128:131], a[224:227], v[84:87]
v_mfma_f32_16x16x32_bf16 v[84:87], a[132:135], a[228:231], v[84:87]
ds_read_b128 a[220:223], v4 offset:56320
s_waitcnt lgkmcnt(4)
v_mfma_f32_16x16x32_bf16 v[88:91], a[232:235], a[200:203], v[88:91]
ds_read_b128 a[224:227], v4 offset:50176
v_mfma_f32_16x16x32_bf16 v[88:91], a[236:239], a[204:207], v[88:91]
ds_read_b128 a[228:231], v4 offset:57344
s_waitcnt lgkmcnt(4)
v_mfma_f32_16x16x32_bf16 v[92:95], a[200:203], a[240:243], v[92:95]
ds_read_b128 a[232:235], v4 offset:51200
v_mfma_f32_16x16x32_bf16 v[92:95], a[204:207], a[244:247], v[92:95]
ds_read_b128 a[236:239], v4 offset:58368
s_waitcnt vmcnt(20)
s_waitcnt lgkmcnt(4)
v_mfma_f32_16x16x32_bf16 v[32:35], a[216:219], a[64:67], v[32:35]
v_mfma_f32_16x16x32_bf16 v[32:35], a[220:223], a[68:71], v[32:35]
ds_read_b128 a[240:243], v4 offset:52224
v_mfma_f32_16x16x32_bf16 v[36:39], a[216:219], a[136:139], v[36:39]
v_mfma_f32_16x16x32_bf16 v[36:39], a[220:223], a[140:143], v[36:39]
ds_read_b128 a[244:247], v4 offset:59392
s_waitcnt lgkmcnt(4)
v_mfma_f32_16x16x32_bf16 v[40:43], a[224:227], a[64:67], v[40:43]
v_mfma_f32_16x16x32_bf16 v[40:43], a[228:231], a[68:71], v[40:43]
ds_read_b128 a[216:219], v4 offset:53248
v_mfma_f32_16x16x32_bf16 v[44:47], a[224:227], a[136:139], v[44:47]
v_mfma_f32_16x16x32_bf16 v[44:47], a[228:231], a[140:143], v[44:47]
ds_read_b128 a[220:223], v4 offset:60416
s_waitcnt lgkmcnt(4)
v_mfma_f32_16x16x32_bf16 v[48:51], a[232:235], a[64:67], v[48:51]
v_mfma_f32_16x16x32_bf16 v[48:51], a[236:239], a[68:71], v[48:51]
ds_read_b128 a[224:227], v4 offset:54272
v_mfma_f32_16x16x32_bf16 v[52:55], a[232:235], a[136:139], v[52:55]
v_mfma_f32_16x16x32_bf16 v[52:55], a[236:239], a[140:143], v[52:55]
ds_read_b128 a[228:231], v4 offset:61440
s_waitcnt lgkmcnt(4)
v_mfma_f32_16x16x32_bf16 v[56:59], a[240:243], a[64:67], v[56:59]
v_mfma_f32_16x16x32_bf16 v[56:59], a[244:247], a[68:71], v[56:59]
ds_read_b128 a[232:235], v4 offset:55296
v_mfma_f32_16x16x32_bf16 v[60:63], a[240:243], a[136:139], v[60:63]
v_mfma_f32_16x16x32_bf16 v[60:63], a[244:247], a[140:143], v[60:63]
ds_read_b128 a[236:239], v4 offset:62464
s_waitcnt lgkmcnt(4)
v_mfma_f32_16x16x32_bf16 v[64:67], a[216:219], a[64:67], v[64:67]
v_mfma_f32_16x16x32_bf16 v[64:67], a[220:223], a[68:71], v[64:67]
ds_read_b128 a[240:243], v7 offset:49152
v_mfma_f32_16x16x32_bf16 v[68:71], a[216:219], a[136:139], v[68:71]
v_mfma_f32_16x16x32_bf16 v[68:71], a[220:223], a[140:143], v[68:71]
ds_read_b128 a[244:247], v7 offset:56320
s_waitcnt lgkmcnt(4)
v_mfma_f32_16x16x32_bf16 v[72:75], a[64:67], a[224:227], v[72:75]
v_mfma_f32_16x16x32_bf16 v[72:75], a[68:71], a[228:231], v[72:75]
ds_read_b128 a[216:219], v10 offset:49152
v_mfma_f32_16x16x32_bf16 v[76:79], a[136:139], a[224:227], v[76:79]
v_mfma_f32_16x16x32_bf16 v[76:79], a[140:143], a[228:231], v[76:79]
ds_read_b128 a[220:223], v10 offset:56320
s_waitcnt lgkmcnt(4)
v_mfma_f32_16x16x32_bf16 v[80:83], a[64:67], a[232:235], v[80:83]
v_mfma_f32_16x16x32_bf16 v[80:83], a[68:71], a[236:239], v[80:83]
v_mfma_f32_16x16x32_bf16 v[84:87], a[136:139], a[232:235], v[84:87]
v_mfma_f32_16x16x32_bf16 v[84:87], a[140:143], a[236:239], v[84:87]
s_waitcnt lgkmcnt(2)
v_mfma_f32_16x16x32_bf16 v[88:91], a[240:243], a[208:211], v[88:91]
v_mfma_f32_16x16x32_bf16 v[88:91], a[244:247], a[212:215], v[88:91]
s_waitcnt lgkmcnt(0)
v_mfma_f32_16x16x32_bf16 v[92:95], a[208:211], a[216:219], v[92:95]
v_mfma_f32_16x16x32_bf16 v[92:95], a[212:215], a[220:223], v[92:95]
v_mov_b32 v103, 0xff61b1e6
v_mov_b32 v102, 0xffff
v_cndmask_b32 v172, v103, 0, s[44:45]
v_cndmask_b32 v173, v103, 0, s[46:47]
v_cndmask_b32 v174, v103, 0, s[48:49]
v_cndmask_b32 v175, v103, 0, s[50:51]
v_cndmask_b32 v184, 0, v102, s[44:45]
v_cndmask_b32 v13, 0, v102, s[46:47]
v_lshl_or_b32 v184, v13, 16, v184
L_hop2:
s_cmp_eq_u32 s15, 1
s_cbranch_scc1 L_hop6
v_cndmask_b32 v185, 0, v102, s[48:49]
v_cndmask_b32 v13, 0, v102, s[50:51]
v_lshl_or_b32 v185, v13, 16, v185
v_cndmask_b32 v176, v103, 0, s[52:53]
v_cndmask_b32 v177, v103, 0, s[54:55]
v_cndmask_b32 v178, v103, 0, s[56:57]
v_cndmask_b32 v179, v103, 0, s[58:59]
v_cndmask_b32 v186, 0, v102, s[52:53]
v_cndmask_b32 v13, 0, v102, s[54:55]
v_lshl_or_b32 v186, v13, 16, v186
v_cndmask_b32 v187, 0, v102, s[56:57]
v_cndmask_b32 v13, 0, v102, s[58:59]
v_lshl_or_b32 v187, v13, 16, v187
v_cndmask_b32 v180, v103, 0, s[60:61]
v_cndmask_b32 v181, v103, 0, s[62:63]
v_cndmask_b32 v182, v103, 0, s[64:65]
v_cndmask_b32 v183, v103, 0, s[66:67]
v_cndmask_b32 v188, 0, v102, s[60:61]
v_cndmask_b32 v13, 0, v102, s[62:63]
v_lshl_or_b32 v188, v13, 16, v188
v_cndmask_b32 v189, 0, v102, s[64:65]
v_cndmask_b32 v13, 0, v102, s[66:67]
v_lshl_or_b32 v189, v13, 16, v189
L_att:
v_cvt_pk_bf16_f32 v160, v64, v65
v_cvt_pk_bf16_f32 v161, v66, v67
v_cvt_pk_bf16_f32 v162, v68, v69
v_cvt_pk_bf16_f32 v163, v70, v71
v_cvt_pk_bf16_f32 v156, v88, v89
v_cvt_pk_bf16_f32 v157, v90, v91
v_cvt_pk_bf16_f32 v158, v92, v93
v_cvt_pk_bf16_f32 v159, v94, v95
v_mfma_f32_16x16x32_bf16 v[164:167], v[160:163], v[96:99], 0
s_nop 0
v_mfma_f32_16x16x32_bf16 v[168:171], v[156:159], v[98:101], 0
v_mfma_f32_16x16x32_bf16 v[88:91], v[160:163], v[98:101], 0
v_cvt_pk_bf16_f32 v116, v52, v53
v_cvt_pk_bf16_f32 v117, v54, v55
v_cvt_pk_bf16_f32 v120, v60, v61
v_cvt_pk_bf16_f32 v121, v62, v63
v_cvt_pk_bf16_f32 v126, v76, v77
v_cvt_pk_bf16_f32 v127, v78, v79
v_cvt_pk_bf16_f32 v132, v84, v85
v_cvt_pk_bf16_f32 v133, v86, v87
v_cvt_pk_bf16_f32 v138, v164, v165
v_cvt_pk_bf16_f32 v139, v166, v167
v_cvt_pk_bf16_f32 v164, v168, v169
v_cvt_pk_bf16_f32 v165, v170, v171
s_cmp_eq_u32 s4, 3
s_cbranch_scc1 L_a1_noxch
ds_write_b64 v16, v[156:157]
ds_write_b64 v15, v[116:117] offset:3072
ds_write_b64 v15, v[120:121] offset:3584
ds_write_b64 v15, v[162:163] offset:4096
ds_write_b64 v15, v[126:127] offset:4608
ds_write_b64 v15, v[132:133] offset:5120
ds_write_b64 v15, v[138:139] offset:5632
s_cmp_eq_u32 s4, 2
s_cbranch_scc1 L_a1_left
ds_write_b64 v19, v[158:159] offset:1536
s_branch L_a1_noxch
L_a1_left:
ds_write_b64 v18, v[164:165]
L_a1_noxch:
v_cvt_pk_bf16_f32 v136, v88, v89
v_cvt_pk_bf16_f32 v137, v90, v91
v_cvt_pk_bf16_f32 v110, v48, v49
v_cvt_pk_bf16_f32 v111, v50, v51
v_cvt_pk_bf16_f32 v114, v56, v57
v_cvt_pk_bf16_f32 v115, v58, v59
v_cvt_pk_bf16_f32 v124, v72, v73
v_cvt_pk_bf16_f32 v125, v74, v75
v_cvt_pk_bf16_f32 v130, v80, v81
v_cvt_pk_bf16_f32 v131, v82, v83
v_cvt_pk_bf16_f32 v140, v32, v33
v_cvt_pk_bf16_f32 v141, v34, v35
v_cvt_pk_bf16_f32 v146, v40, v41
v_cvt_pk_bf16_f32 v147, v42, v43
v_mov_b32 v142, v160
v_mov_b32 v145, v161
v_mov_b32 v143, 0
v_mov_b32 v144, 0
v_mov_b32 v112, 0
v_mov_b32 v113, 0
s_nop 0
v_permlane16_swap_b32 v142, v112
v_permlane16_swap_b32 v145, v113
v_cvt_pk_bf16_f32 v148, v36, v37
v_cvt_pk_bf16_f32 v149, v38, v39
v_cvt_pk_bf16_f32 v154, v44, v45
v_cvt_pk_bf16_f32 v155, v46, v47
v_mov_b32 v150, v162
v_mov_b32 v153, v163
v_mov_b32 v151, 0
v_mov_b32 v152, 0
v_mov_b32 v118, 0
v_mov_b32 v119, 0
s_nop 0
v_permlane16_swap_b32 v150, v118
v_permlane16_swap_b32 v153, v119
s_waitcnt lgkmcnt(0)
s_barrier
s_and_b32 s37, s6, 7
s_mul_i32 s37, s37, 92160
s_mul_i32 s38, s4, 23552
s_add_u32 s37, s37, s38
s_add_u32 s37, s37, 6266880
ds_read_b64 v[104:105], v15
ds_read_b64 v[108:109], v15 offset:512
ds_read_b64 v[106:107], v17 offset:1024
ds_read_b64 v[122:123], v15 offset:1536
ds_read_b64 v[128:129], v15 offset:2048
ds_read_b64 v[134:135], v15 offset:2560
v_mfma_f32_16x16x32_bf16 v[32:35], v[110:113], v[148:151], v[172:175]
v_mfma_f32_16x16x32_bf16 v[36:39], v[116:119], v[148:151], v[176:179]
v_mfma_f32_16x16x32_bf16 v[40:43], v[112:115], v[152:155], v[172:175]
v_mfma_f32_16x16x32_bf16 v[44:47], v[118:121], v[152:155], v[176:179]
s_waitcnt lgkmcnt(3)
v_mfma_f32_16x16x32_bf16 v[48:51], v[104:107], v[140:143], v[180:183]
v_mfma_f32_16x16x32_bf16 v[52:55], v[110:113], v[140:143], v[176:179]
v_mfma_f32_16x16x32_bf16 v[56:59], v[106:109], v[144:147], v[180:183]
v_mfma_f32_16x16x32_bf16 v[60:63], v[112:115], v[144:147], v[176:179]
s_nop 0
v_max_f32 v32, v32, v36
v_max_f32 v33, v33, v37
v_max_f32 v34, v34, v38
v_max_f32 v35, v35, v39
v_max_f32 v40, v40, v44
v_max_f32 v41, v41, v45
v_max_f32 v42, v42, v46
v_max_f32 v43, v43, v47
v_max_f32 v48, v48, v52
v_max_f32 v49, v49, v53
v_max_f32 v50, v50, v54
v_max_f32 v51, v51, v55
v_max_f32 v56, v56, v60
v_max_f32 v57, v57, v61
v_max_f32 v58, v58, v62
v_max_f32 v59, v59, v63
v_max3_f32 v20, v32, v33, v34
v_max3_f32 v21, v40, v41, v42
v_max3_f32 v22, v48, v49, v50
v_max3_f32 v23, v56, v57, v58
v_max_f32 v20, v20, v35
v_max_f32 v21, v21, v43
v_max_f32 v22, v22, v51
v_max_f32 v23, v23, v59
v_mov_b32 v24, v20
v_mov_b32 v25, v21
v_mov_b32 v26, v22
v_mov_b32 v27, v23
v_permlane16_swap_b32 v20, v24
v_permlane16_swap_b32 v21, v25
v_permlane16_swap_b32 v22, v26
v_permlane16_swap_b32 v23, v27
v_max_f32 v20, v20, v24
v_max_f32 v21, v21, v25
v_max_f32 v22, v22, v26
v_max_f32 v23, v23, v27
v_mov_b32 v24, v20
v_mov_b32 v25, v21
v_mov_b32 v26, v22
v_mov_b32 v27, v23
v_permlane32_swap_b32 v20, v24
v_permlane32_swap_b32 v21, v25
v_permlane32_swap_b32 v22, v26
v_permlane32_swap_b32 v23, v27
v_max_f32 v20, v20, v24
v_max_f32 v21, v21, v25
v_max_f32 v22, v22, v26
v_max_f32 v23, v23, v27
v_mul_f32 v20, s34, v20
v_mul_f32 v21, s34, v21
v_mul_f32 v22, s34, v22
v_mul_f32 v23, s34, v23
v_fma_f32 v32, v32, s34, -v20
v_fma_f32 v40, v40, s34, -v21
v_fma_f32 v48, v48, s34, -v22
v_fma_f32 v56, v56, s34, -v23
v_exp_f32 v32, v32
v_exp_f32 v40, v40
v_exp_f32 v48, v48
v_exp_f32 v56, v56
v_fma_f32 v33, v33, s34, -v20
v_fma_f32 v41, v41, s34, -v21
v_fma_f32 v49, v49, s34, -v22
v_fma_f32 v57, v57, s34, -v23
v_exp_f32 v33, v33
v_exp_f32 v41, v41
v_exp_f32 v49, v49
v_exp_f32 v57, v57
v_fma_f32 v34, v34, s34, -v20
v_fma_f32 v42, v42, s34, -v21
v_fma_f32 v50, v50, s34, -v22
v_fma_f32 v58, v58, s34, -v23
v_exp_f32 v34, v34
v_exp_f32 v42, v42
v_exp_f32 v50, v50
v_exp_f32 v58, v58
v_fma_f32 v35, v35, s34, -v20
v_fma_f32 v43, v43, s34, -v21
v_fma_f32 v51, v51, s34, -v22
v_fma_f32 v59, v59, s34, -v23
v_exp_f32 v35, v35
v_exp_f32 v43, v43
v_exp_f32 v51, v51
v_exp_f32 v59, v59
v_add_f32 v28, v32, v33
v_add_f32 v29, v40, v41
v_add_f32 v30, v48, v49
v_add_f32 v31, v56, v57
v_add_f32 v28, v28, v34
v_add_f32 v29, v29, v42
v_add_f32 v30, v30, v50
v_add_f32 v31, v31, v58
v_add_f32 v28, v28, v35
v_add_f32 v29, v29, v43
v_add_f32 v30, v30, v51
v_add_f32 v31, v31, v59
v_mov_b32 v24, v28
v_mov_b32 v25, v29
v_mov_b32 v26, v30
v_mov_b32 v27, v31
v_permlane16_swap_b32 v28, v24
v_permlane16_swap_b32 v29, v25
v_permlane16_swap_b32 v30, v26
v_permlane16_swap_b32 v31, v27
v_add_f32 v28, v28, v24
v_add_f32 v29, v29, v25
v_add_f32 v30, v30, v26
v_add_f32 v31, v31, v27
v_mov_b32 v24, v28
v_mov_b32 v25, v29
v_mov_b32 v26, v30
v_mov_b32 v27, v31
v_permlane32_swap_b32 v28, v24
v_permlane32_swap_b32 v29, v25
v_permlane32_swap_b32 v30, v26
v_permlane32_swap_b32 v31, v27
v_add_f32 v28, v28, v24
v_add_f32 v29, v29, v25
v_add_f32 v30, v30, v26
v_add_f32 v31, v31, v27
v_rcp_f32 v28, v28
v_rcp_f32 v29, v29
v_rcp_f32 v30, v30
v_rcp_f32 v31, v31
v_mul_f32 v32, v32, v28
v_mul_f32 v40, v40, v29
v_mul_f32 v48, v48, v30
v_mul_f32 v56, v56, v31
v_mul_f32 v33, v33, v28
v_mul_f32 v41, v41, v29
v_mul_f32 v49, v49, v30
v_mul_f32 v57, v57, v31
v_mul_f32 v34, v34, v28
v_mul_f32 v42, v42, v29
v_mul_f32 v50, v50, v30
v_mul_f32 v58, v58, v31
v_mul_f32 v35, v35, v28
v_mul_f32 v43, v43, v29
v_mul_f32 v51, v51, v30
v_mul_f32 v59, v59, v31
v_cvt_pk_bf16_f32 v36, v32, v33
v_cvt_pk_bf16_f32 v37, v34, v35
v_cvt_pk_bf16_f32 v44, v40, v41
v_cvt_pk_bf16_f32 v45, v42, v43
v_cvt_pk_bf16_f32 v52, v48, v49
v_cvt_pk_bf16_f32 v53, v50, v51
v_cvt_pk_bf16_f32 v60, v56, v57
v_cvt_pk_bf16_f32 v61, v58, v59
v_and_b32 v64, v184, v36
v_and_b32 v66, v186, v36
v_and_b32 v65, v185, v37
v_and_b32 v67, v187, v37
v_and_b32 v68, v184, v44
v_and_b32 v70, v186, v44
v_and_b32 v69, v185, v45
v_and_b32 v71, v187, v45
v_and_b32 v72, v188, v52
v_and_b32 v74, v186, v52
v_and_b32 v73, v189, v53
v_and_b32 v75, v187, v53
v_and_b32 v76, v188, v60
v_and_b32 v78, v186, v60
v_and_b32 v77, v189, v61
v_and_b32 v79, v187, v61
s_waitcnt lgkmcnt(0)
v_mfma_f32_16x16x32_bf16 v[80:83], v[124:127], v[64:67], 0
v_mfma_f32_16x16x32_bf16 v[84:87], v[136:139], v[64:67], 0
v_mfma_f32_16x16x32_bf16 v[88:91], v[130:133], v[68:71], 0
v_mfma_f32_16x16x32_bf16 v[92:95], v[136:139], v[68:71], 0
v_mfma_f32_16x16x32_bf16 v[96:99], v[122:125], v[72:75], 0
v_mfma_f32_16x16x32_bf16 v[100:103], v[134:137], v[72:75], 0
v_mfma_f32_16x16x32_bf16 v[164:167], v[128:131], v[76:79], 0
v_mfma_f32_16x16x32_bf16 v[168:171], v[134:137], v[76:79], 0
v_lshlrev_b32 v14, 3, v12
v_mov_b32 v15, 2146435072
v_cmp_gt_u32 vcc, 16, v1
s_nop 1
v_cndmask_b32 v14, v15, v14, vcc
s_add_u32 s26, s24, s72
s_lshl_b32 s27, s21, 10
s_add_u32 s27, s27, s26
s_lshl_b32 s28, s21, 7
s_add_u32 s28, s28, 16384
s_add_u32 s28, s28, s26
s_add_u32 s30, s27, 18432
s_add_u32 s31, s28, 18432
v_cvt_pk_bf16_f32 v40, v80, v81
v_cvt_pk_bf16_f32 v41, v82, v83
v_cvt_pk_bf16_f32 v42, v88, v89
v_cvt_pk_bf16_f32 v43, v90, v91
v_cvt_pk_bf16_f32 v44, v84, v85
v_cvt_pk_bf16_f32 v45, v94, v95
buffer_store_dwordx4 v[40:43], v2, s[8:11], s30 offen sc1
buffer_store_dwordx2 v[44:45], v14, s[8:11], s31 offen sc1
v_cvt_pk_bf16_f32 v32, v96, v97
v_cvt_pk_bf16_f32 v33, v98, v99
v_cvt_pk_bf16_f32 v34, v164, v165
v_cvt_pk_bf16_f32 v35, v166, v167
v_cvt_pk_bf16_f32 v36, v100, v101
v_cvt_pk_bf16_f32 v37, v170, v171
buffer_store_dwordx4 v[32:35], v2, s[8:11], s27 offen sc1
buffer_store_dwordx2 v[36:37], v14, s[8:11], s28 offen sc1
s_lshl_b32 s26, s20, 4
s_add_u32 s26, s26, s21
s_lshl_b32 s14, s26, 7
s_add_u32 s14, s14, 393216
s_add_u32 s14, s14, s77
s_lshr_b32 s20, s6, 3
s_lshl_b32 s21, s5, 2
s_add_u32 s20, s20, s21
s_lshl_b32 s20, s20, 2
s_add_u32 s20, s20, s4
s_and_b32 s21, s6, 7
s_mul_i32 s24, s20, 18432
s_add_u32 s25, s24, s72
s_mul_i32 s26, s21, 2304
s_add_u32 s26, s26, s24
s_add_u32 s27, s26, s71
v_and_b32 v6, 15, v1
v_lshrrev_b32 v7, 4, v1
v_lshlrev_b32 v8, 4, v6
v_lshl_add_u32 v8, v7, 3, v8
v_add_u32 v8, 2048, v8
v_mov_b32 v9, 2146435072
v_cmp_gt_u32 vcc, 32, v1
s_nop 1
v_cndmask_b32 v4, v9, v8, vcc
v_add_u32 v5, 0x10000, v2
s_and_b32 s40, s5, 1
s_lshl_b32 s40, s40, 2
s_lshr_b32 s41, s6, 3
s_add_u32 s40, s40, s41
s_lshr_b32 s41, s5, 1
s_lshl_b32 s41, s41, 3
s_and_b32 s42, s6, 7
s_add_u32 s41, s41, s42
s_lshr_b32 s42, s41, 2
s_and_b32 s43, s41, 3
s_lshr_b32 s22, s20, 3
s_lshl_b32 s22, s22, 4
v_add_u32 v10, s22, v6
v_subrev_u32 v12, 16, v1
v_min_u32 v12, 26, v12
v_mul_u32_u24 v16, 57, v12
v_lshrrev_b32 v16, 9, v16
v_mad_u32_u24 v12, v16, 63, v12
s_mul_i32 s22, s42, 9
v_add_u32 v12, s22, v12
v_and_b32 v16, 7, v12
v_lshrrev_b32 v12, 3, v12
v_lshrrev_b32 v17, 2, v16
v_lshlrev_b32 v17, 3, v17
v_lshrrev_b32 v18, 2, v12
v_add_lshl_u32 v17, v17, v18, 4
v_and_b32 v16, 3, v16
v_lshl_add_u32 v17, v16, 2, v17
v_and_b32 v12, 3, v12
v_add_u32 v17, v17, v12
s_cmp_eq_u32 s7, 0
s_cselect_b32 s22, 16, 64
v_cmp_le_u32 vcc, s22, v1
s_nop 1
v_cndmask_b32 v10, v10, v17, vcc
v_lshlrev_b32 v10, 7, v10
s_add_u32 s22, s77, 393216
v_lshlrev_b32 v11, 3, v6
v_lshl_add_u32 v11, v7, 8, v11
v_mov_b32 v13, 2146435072
v_cmp_gt_u32 vcc, 16, v0
v_lshlrev_b32 v14, 3, v0
s_nop 0
v_cndmask_b32 v13, v13, v14, vcc
v_mov_b32 v14, s68
v_mov_b32 v15, s69
s_waitcnt vmcnt(0)
s_barrier
buffer_store_dwordx2 v[14:15], v13, s[8:11], s14 offen sc1
s_add_u32 m0, s38, 0
s_add_u32 s39, s37, 0
buffer_load_dwordx4 v2, s[8:11], s39 offen offset:0 sc1 lds
buffer_load_dwordx4 v2, s[8:11], s39 offen offset:1024 sc1 lds
buffer_load_dwordx4 v2, s[8:11], s39 offen offset:2048 sc1 lds
buffer_load_dwordx4 v2, s[8:11], s39 offen offset:3072 sc1 lds
s_add_u32 m0, s38, 4096
s_add_u32 s39, s37, 4096
buffer_load_dwordx4 v2, s[8:11], s39 offen offset:0 sc1 lds
buffer_load_dwordx4 v2, s[8:11], s39 offen offset:1024 sc1 lds
buffer_load_dwordx4 v2, s[8:11], s39 offen offset:2048 sc1 lds
buffer_load_dwordx4 v2, s[8:11], s39 offen offset:3072 sc1 lds
s_add_u32 m0, s38, 8192
s_add_u32 s39, s37, 8192
buffer_load_dwordx4 v2, s[8:11], s39 offen offset:0 sc1 lds
buffer_load_dwordx4 v2, s[8:11], s39 offen offset:1024 sc1 lds
buffer_load_dwordx4 v2, s[8:11], s39 offen offset:2048 sc1 lds
buffer_load_dwordx4 v2, s[8:11], s39 offen offset:3072 sc1 lds
s_add_u32 m0, s38, 12288
s_add_u32 s39, s37, 12288
buffer_load_dwordx4 v2, s[8:11], s39 offen offset:0 sc1 lds
buffer_load_dwordx4 v2, s[8:11], s39 offen offset:1024 sc1 lds
buffer_load_dwordx4 v2, s[8:11], s39 offen offset:2048 sc1 lds
buffer_load_dwordx4 v2, s[8:11], s39 offen offset:3072 sc1 lds
s_add_u32 m0, s38, 16384
s_add_u32 s39, s37, 16384
buffer_load_dwordx4 v2, s[8:11], s39 offen offset:0 sc1 lds
buffer_load_dwordx4 v2, s[8:11], s39 offen offset:1024 sc1 lds
buffer_load_dwordx4 v2, s[8:11], s39 offen offset:2048 sc1 lds
buffer_load_dwordx4 v2, s[8:11], s39 offen offset:3072 sc1 lds
s_add_u32 m0, s38, 20480
s_add_u32 s39, s37, 20480
buffer_load_dwordx4 v2, s[8:11], s39 offen offset:0 sc1 lds
buffer_load_dwordx4 v2, s[8:11], s39 offen offset:1024 sc1 lds
buffer_load_dwordx4 v2, s[8:11], s39 offen offset:2048 sc1 lds
s_mov_b32 s52, 0
L_poll2:
buffer_load_dwordx2 v[14:15], v10, s[8:11], s22 offen sc1
s_add_u32 s52, s52, 1
s_waitcnt vmcnt(0)
v_cmp_ne_u64 vcc, s[68:69], v[14:15]
s_cmp_ge_u32 s52, 1048576
s_cbranch_scc1 L_got2
s_and_b64 exec, exec, vcc
s_cbranch_execnz L_poll2
L_got2:
s_mov_b64 exec, -1
buffer_load_dwordx4 a[0:3], v2, s[8:11], s25 offen offset:0 sc1
buffer_load_dwordx4 a[4:7], v2, s[8:11], s25 offen offset:1024 sc1
buffer_load_dwordx4 a[8:11], v2, s[8:11], s25 offen offset:2048 sc1
buffer_load_dwordx4 a[12:15], v2, s[8:11], s25 offen offset:3072 sc1
s_add_u32 s25, s25, 4096
buffer_load_dwordx4 a[16:19], v2, s[8:11], s25 offen offset:0 sc1
buffer_load_dwordx4 a[20:23], v2, s[8:11], s25 offen offset:1024 sc1
buffer_load_dwordx4 a[24:27], v2, s[8:11], s25 offen offset:2048 sc1
buffer_load_dwordx4 a[28:31], v2, s[8:11], s25 offen offset:3072 sc1
s_add_u32 s25, s25, 4096
buffer_load_dwordx4 a[32:35], v2, s[8:11], s25 offen offset:0 sc1
buffer_load_dwordx4 a[36:39], v2, s[8:11], s25 offen offset:1024 sc1
buffer_load_dwordx4 a[40:43], v2, s[8:11], s25 offen offset:2048 sc1
buffer_load_dwordx4 a[44:47], v2, s[8:11], s25 offen offset:3072 sc1
s_barrier
ds_read_b128 a[216:219], v2 offset:0
ds_read_b128 a[220:223], v2 offset:5120
ds_read_b128 a[224:227], v2 offset:1024
ds_read_b128 a[228:231], v2 offset:6144
ds_read_b128 a[232:235], v2 offset:2048
ds_read_b128 a[236:239], v2 offset:7168
s_mul_i32 s22, s4, 6144
s_mul_i32 s23, s41, 497664
s_add_u32 s23, s23, s22
s_add_u32 s23, s23, 7012352
v_add_u32 v3, s23, v2
s_waitcnt vmcnt(10)
s_waitcnt lgkmcnt(4)
v_mfma_f32_16x16x32_bf16 v[32:35], a[216:219], a[0:3], 0
ds_read_b128 a[240:243], v2 offset:3072
v_mfma_f32_16x16x32_bf16 v[32:35], a[220:223], a[4:7], v[32:35]
ds_read_b128 a[244:247], v2 offset:8192
s_add_u32 s25, s25, 4096
buffer_load_dwordx4 a[48:51], v2, s[8:11], s25 offen offset:0 sc1
s_waitcnt lgkmcnt(4)
v_mfma_f32_16x16x32_bf16 v[36:39], a[224:227], a[0:3], 0
ds_read_b128 a[216:219], v2 offset:4096
v_mfma_f32_16x16x32_bf16 v[36:39], a[228:231], a[4:7], v[36:39]
ds_read_b128 a[220:223], v2 offset:9216
s_waitcnt lgkmcnt(4)
v_mfma_f32_16x16x32_bf16 v[40:43], a[232:235], a[0:3], 0
ds_read_b128 a[224:227], v2 offset:10240
v_mfma_f32_16x16x32_bf16 v[40:43], a[236:239], a[4:7], v[40:43]
ds_read_b128 a[228:231], v2 offset:15360
buffer_load_dwordx4 a[52:55], v2, s[8:11], s25 offen offset:1024 sc1
s_waitcnt lgkmcnt(4)
v_mfma_f32_16x16x32_bf16 v[44:47], a[240:243], a[0:3], 0
ds_read_b128 a[232:235], v2 offset:11264
v_mfma_f32_16x16x32_bf16 v[44:47], a[244:247], a[4:7], v[44:47]
ds_read_b128 a[236:239], v2 offset:16384
s_waitcnt lgkmcnt(4)
v_mfma_f32_16x16x32_bf16 v[48:51], a[216:219], a[0:3], 0
ds_read_b128 a[240:243], v2 offset:12288
v_mfma_f32_16x16x32_bf16 v[48:51], a[220:223], a[4:7], v[48:51]
ds_read_b128 a[244:247], v2 offset:17408
buffer_load_dwordx4 a[56:59], v2, s[8:11], s25 offen offset:2048 sc1
s_waitcnt vmcnt(11)
s_waitcnt lgkmcnt(4)
v_mfma_f32_16x16x32_bf16 v[32:35], a[224:227], a[8:11], v[32:35]
ds_read_b128 a[216:219], v2 offset:13312
v_mfma_f32_16x16x32_bf16 v[32:35], a[228:231], a[12:15], v[32:35]
ds_read_b128 a[220:223], v2 offset:18432
s_waitcnt lgkmcnt(4)
v_mfma_f32_16x16x32_bf16 v[36:39], a[232:235], a[8:11], v[36:39]
ds_read_b128 a[224:227], v2 offset:14336
v_mfma_f32_16x16x32_bf16 v[36:39], a[236:239], a[12:15], v[36:39]
ds_read_b128 a[228:231], v2 offset:19456
buffer_load_dwordx4 a[60:63], v2, s[8:11], s25 offen offset:3072 sc1
s_waitcnt lgkmcnt(4)
v_mfma_f32_16x16x32_bf16 v[40:43], a[240:243], a[8:11], v[40:43]
ds_read_b128 a[232:235], v2 offset:20480
v_mfma_f32_16x16x32_bf16 v[40:43], a[244:247], a[12:15], v[40:43]
ds_read_b128 a[236:239], v2 offset:25600
s_waitcnt lgkmcnt(4)
v_mfma_f32_16x16x32_bf16 v[44:47], a[216:219], a[8:11], v[44:47]
ds_read_b128 a[240:243], v2 offset:21504
v_mfma_f32_16x16x32_bf16 v[44:47], a[220:223], a[12:15], v[44:47]
ds_read_b128 a[244:247], v2 offset:26624
s_add_u32 s25, s25, 4096
buffer_load_dwordx2 a[64:65], v11, s[8:11], s25 offen offset:0 sc1
buffer_load_dwordx2 a[66:67], v11, s[8:11], s25 offen offset:128 sc1
s_waitcnt lgkmcnt(4)
v_mfma_f32_16x16x32_bf16 v[48:51], a[224:227], a[8:11], v[48:51]
ds_read_b128 a[216:219], v2 offset:22528
v_mfma_f32_16x16x32_bf16 v[48:51], a[228:231], a[12:15], v[48:51]
ds_read_b128 a[220:223], v2 offset:27648
s_waitcnt vmcnt(12)
s_waitcnt lgkmcnt(4)
v_mfma_f32_16x16x32_bf16 v[32:35], a[232:235], a[16:19], v[32:35]
ds_read_b128 a[224:227], v2 offset:23552
v_mfma_f32_16x16x32_bf16 v[32:35], a[236:239], a[20:23], v[32:35]
ds_read_b128 a[228:231], v2 offset:28672
buffer_load_dwordx2 a[68:69], v11, s[8:11], s25 offen offset:1024 sc1
buffer_load_dwordx2 a[70:71], v11, s[8:11], s25 offen offset:1152 sc1
s_waitcnt lgkmcnt(4)
v_mfma_f32_16x16x32_bf16 v[36:39], a[240:243], a[16:19], v[36:39]
ds_read_b128 a[232:235], v2 offset:24576
v_mfma_f32_16x16x32_bf16 v[36:39], a[244:247], a[20:23], v[36:39]
ds_read_b128 a[236:239], v2 offset:29696
s_waitcnt lgkmcnt(4)
v_mfma_f32_16x16x32_bf16 v[40:43], a[216:219], a[16:19], v[40:43]
ds_read_b128 a[240:243], v2 offset:30720
v_mfma_f32_16x16x32_bf16 v[40:43], a[220:223], a[20:23], v[40:43]
ds_read_b128 a[244:247], v2 offset:35840
buffer_load_dwordx4 v[56:59], v2, s[8:11], s27 offen sc1
s_waitcnt lgkmcnt(4)
v_mfma_f32_16x16x32_bf16 v[44:47], a[224:227], a[16:19], v[44:47]
ds_read_b128 a[216:219], v2 offset:31744
v_mfma_f32_16x16x32_bf16 v[44:47], a[228:231], a[20:23], v[44:47]
ds_read_b128 a[220:223], v2 offset:36864
s_waitcnt lgkmcnt(4)
v_mfma_f32_16x16x32_bf16 v[48:51], a[232:235], a[16:19], v[48:51]
ds_read_b128 a[224:227], v2 offset:32768
v_mfma_f32_16x16x32_bf16 v[48:51], a[236:239], a[20:23], v[48:51]
ds_read_b128 a[228:231], v2 offset:37888
buffer_load_dwordx4 v[60:63], v2, s[8:11], s27 offen offset:1024 sc1
s_waitcnt vmcnt(14)
s_waitcnt lgkmcnt(4)
v_mfma_f32_16x16x32_bf16 v[32:35], a[240:243], a[24:27], v[32:35]
ds_read_b128 a[232:235], v2 offset:33792
v_mfma_f32_16x16x32_bf16 v[32:35], a[244:247], a[28:31], v[32:35]
ds_read_b128 a[236:239], v2 offset:38912
s_waitcnt lgkmcnt(4)
v_mfma_f32_16x16x32_bf16 v[36:39], a[216:219], a[24:27], v[36:39]
ds_read_b128 a[240:243], v2 offset:34816
v_mfma_f32_16x16x32_bf16 v[36:39], a[220:223], a[28:31], v[36:39]
ds_read_b128 a[244:247], v2 offset:39936
buffer_load_dwordx2 v[64:65], v4, s[8:11], s27 offen sc1
s_waitcnt lgkmcnt(4)
v_mfma_f32_16x16x32_bf16 v[40:43], a[224:227], a[24:27], v[40:43]
ds_read_b128 a[216:219], v2 offset:40960
v_mfma_f32_16x16x32_bf16 v[40:43], a[228:231], a[28:31], v[40:43]
ds_read_b128 a[220:223], v2 offset:46080
s_waitcnt lgkmcnt(4)
v_mfma_f32_16x16x32_bf16 v[44:47], a[232:235], a[24:27], v[44:47]
ds_read_b128 a[224:227], v2 offset:41984
v_mfma_f32_16x16x32_bf16 v[44:47], a[236:239], a[28:31], v[44:47]
ds_read_b128 a[228:231], v2 offset:47104
s_add_u32 m0, s22, 98304
s_nop 0
buffer_load_dwordx4 v3, s[8:11], 0 offen offset:0 sc1 lds
s_waitcnt lgkmcnt(4)
v_mfma_f32_16x16x32_bf16 v[48:51], a[240:243], a[24:27], v[48:51]
ds_read_b128 a[232:235], v2 offset:43008
v_mfma_f32_16x16x32_bf16 v[48:51], a[244:247], a[28:31], v[48:51]
ds_read_b128 a[236:239], v2 offset:48128
s_waitcnt vmcnt(14)
s_waitcnt lgkmcnt(4)
v_mfma_f32_16x16x32_bf16 v[32:35], a[216:219], a[32:35], v[32:35]
ds_read_b128 a[240:243], v2 offset:44032
v_mfma_f32_16x16x32_bf16 v[32:35], a[220:223], a[36:39], v[32:35]
ds_read_b128 a[244:247], v2 offset:49152
buffer_load_dwordx4 v3, s[8:11], 0 offen offset:1024 sc1 lds
s_waitcnt lgkmcnt(4)
v_mfma_f32_16x16x32_bf16 v[36:39], a[224:227], a[32:35], v[36:39]
ds_read_b128 a[216:219], v2 offset:45056
v_mfma_f32_16x16x32_bf16 v[36:39], a[228:231], a[36:39], v[36:39]
ds_read_b128 a[220:223], v2 offset:50176
s_waitcnt lgkmcnt(4)
v_mfma_f32_16x16x32_bf16 v[40:43], a[232:235], a[32:35], v[40:43]
ds_read_b128 a[224:227], v2 offset:51200
v_mfma_f32_16x16x32_bf16 v[40:43], a[236:239], a[36:39], v[40:43]
ds_read_b128 a[228:231], v2 offset:56320
buffer_load_dwordx4 v3, s[8:11], 0 offen offset:2048 sc1 lds
s_waitcnt lgkmcnt(4)
v_mfma_f32_16x16x32_bf16 v[44:47], a[240:243], a[32:35], v[44:47]
ds_read_b128 a[232:235], v2 offset:52224
v_mfma_f32_16x16x32_bf16 v[44:47], a[244:247], a[36:39], v[44:47]
ds_read_b128 a[236:239], v2 offset:57344
s_waitcnt lgkmcnt(4)
v_mfma_f32_16x16x32_bf16 v[48:51], a[216:219], a[32:35], v[48:51]
ds_read_b128 a[240:243], v2 offset:53248
v_mfma_f32_16x16x32_bf16 v[48:51], a[220:223], a[36:39], v[48:51]
ds_read_b128 a[244:247], v2 offset:58368
buffer_load_dwordx4 v3, s[8:11], 0 offen offset:3072 sc1 lds
s_waitcnt vmcnt(15)
s_waitcnt lgkmcnt(4)
v_mfma_f32_16x16x32_bf16 v[32:35], a[224:227], a[40:43], v[32:35]
ds_read_b128 a[216:219], v2 offset:54272
v_mfma_f32_16x16x32_bf16 v[32:35], a[228:231], a[44:47], v[32:35]
ds_read_b128 a[220:223], v2 offset:59392
s_waitcnt lgkmcnt(4)
v_mfma_f32_16x16x32_bf16 v[36:39], a[232:235], a[40:43], v[36:39]
ds_read_b128 a[224:227], v2 offset:55296
v_mfma_f32_16x16x32_bf16 v[36:39], a[236:239], a[44:47], v[36:39]
ds_read_b128 a[228:231], v2 offset:60416
s_add_u32 m0, s22, 102400
v_add_u32 v3, 4096, v3
buffer_load_dwordx4 v3, s[8:11], 0 offen offset:0 sc1 lds
s_waitcnt lgkmcnt(4)
v_mfma_f32_16x16x32_bf16 v[40:43], a[240:243], a[40:43], v[40:43]
ds_read_b128 a[232:235], v2 offset:61440
v_mfma_f32_16x16x32_bf16 v[40:43], a[244:247], a[44:47], v[40:43]
ds_read_b128 a[236:239], v5 offset:1024
s_waitcnt lgkmcnt(4)
v_mfma_f32_16x16x32_bf16 v[44:47], a[216:219], a[40:43], v[44:47]
ds_read_b128 a[240:243], v2 offset:62464
v_mfma_f32_16x16x32_bf16 v[44:47], a[220:223], a[44:47], v[44:47]
ds_read_b128 a[244:247], v5 offset:2048
buffer_load_dwordx4 v3, s[8:11], 0 offen offset:1024 sc1 lds
s_waitcnt lgkmcnt(4)
v_mfma_f32_16x16x32_bf16 v[48:51], a[224:227], a[40:43], v[48:51]
ds_read_b128 a[216:219], v2 offset:63488
v_mfma_f32_16x16x32_bf16 v[48:51], a[228:231], a[44:47], v[48:51]
ds_read_b128 a[220:223], v5 offset:3072
s_waitcnt vmcnt(15)
s_waitcnt lgkmcnt(4)
v_mfma_f32_16x16x32_bf16 v[32:35], a[232:235], a[48:51], v[32:35]
ds_read_b128 a[224:227], v2 offset:64512
v_mfma_f32_16x16x32_bf16 v[32:35], a[236:239], a[52:55], v[32:35]
ds_read_b128 a[228:231], v5 offset:4096
s_add_u32 m0, s22, 122880
v_add_u32 v3, 20480, v3
L_hop3:
s_cmp_eq_u32 s15, 1
s_cbranch_scc1 L_hop7
buffer_load_dwordx4 v3, s[8:11], 0 offen offset:0 sc1 lds
s_waitcnt lgkmcnt(4)
v_mfma_f32_16x16x32_bf16 v[36:39], a[240:243], a[48:51], v[36:39]
ds_read_b128 a[232:235], v5 offset:0
v_mfma_f32_16x16x32_bf16 v[36:39], a[244:247], a[52:55], v[36:39]
ds_read_b128 a[236:239], v5 offset:5120
s_waitcnt lgkmcnt(4)
v_mfma_f32_16x16x32_bf16 v[40:43], a[216:219], a[48:51], v[40:43]
ds_read_b128 a[240:243], v5 offset:6144
v_mfma_f32_16x16x32_bf16 v[40:43], a[220:223], a[52:55], v[40:43]
ds_read_b128 a[244:247], v5 offset:11264
buffer_load_dwordx4 v3, s[8:11], 0 offen offset:1024 sc1 lds
s_waitcnt lgkmcnt(4)
v_mfma_f32_16x16x32_bf16 v[44:47], a[224:227], a[48:51], v[44:47]
ds_read_b128 a[216:219], v5 offset:7168
v_mfma_f32_16x16x32_bf16 v[44:47], a[228:231], a[52:55], v[44:47]
ds_read_b128 a[220:223], v5 offset:12288
s_waitcnt lgkmcnt(4)
v_mfma_f32_16x16x32_bf16 v[48:51], a[232:235], a[48:51], v[48:51]
ds_read_b128 a[224:227], v5 offset:8192
v_mfma_f32_16x16x32_bf16 v[48:51], a[236:239], a[52:55], v[48:51]
ds_read_b128 a[228:231], v5 offset:13312
buffer_load_dwordx4 v3, s[8:11], 0 offen offset:2048 sc1 lds
s_waitcnt vmcnt(16)
s_waitcnt lgkmcnt(4)
v_mfma_f32_16x16x32_bf16 v[32:35], a[240:243], a[56:59], v[32:35]
ds_read_b128 a[232:235], v5 offset:9216
v_mfma_f32_16x16x32_bf16 v[32:35], a[244:247], a[60:63], v[32:35]
ds_read_b128 a[236:239], v5 offset:14336
s_waitcnt lgkmcnt(4)
v_mfma_f32_16x16x32_bf16 v[36:39], a[216:219], a[56:59], v[36:39]
ds_read_b128 a[240:243], v5 offset:10240
v_mfma_f32_16x16x32_bf16 v[36:39], a[220:223], a[60:63], v[36:39]
ds_read_b128 a[244:247], v5 offset:15360
buffer_load_dwordx4 v3, s[8:11], 0 offen offset:3072 sc1 lds
s_waitcnt lgkmcnt(4)
v_mfma_f32_16x16x32_bf16 v[40:43], a[224:227], a[56:59], v[40:43]
ds_read_b128 a[216:219], v5 offset:16384
v_mfma_f32_16x16x32_bf16 v[40:43], a[228:231], a[60:63], v[40:43]
ds_read_b128 a[220:223], v5 offset:21504
s_waitcnt lgkmcnt(4)
v_mfma_f32_16x16x32_bf16 v[44:47], a[232:235], a[56:59], v[44:47]
ds_read_b128 a[224:227], v5 offset:17408
v_mfma_f32_16x16x32_bf16 v[44:47], a[236:239], a[60:63], v[44:47]
ds_read_b128 a[228:231], v5 offset:22528
s_add_u32 m0, s22, 126976
v_add_u32 v3, 4096, v3
buffer_load_dwordx4 v3, s[8:11], 0 offen offset:0 sc1 lds
s_waitcnt lgkmcnt(4)
v_mfma_f32_16x16x32_bf16 v[48:51], a[240:243], a[56:59], v[48:51]
ds_read_b128 a[232:235], v5 offset:18432
v_mfma_f32_16x16x32_bf16 v[48:51], a[244:247], a[60:63], v[48:51]
ds_read_b128 a[236:239], v5 offset:23552
s_waitcnt vmcnt(14)
s_waitcnt lgkmcnt(4)
v_mfma_f32_16x16x32_bf16 v[32:35], a[216:219], a[64:67], v[32:35]
ds_read_b128 a[240:243], v5 offset:19456
v_mfma_f32_16x16x32_bf16 v[32:35], a[220:223], a[68:71], v[32:35]
ds_read_b128 a[244:247], v5 offset:24576
buffer_load_dwordx4 v3, s[8:11], 0 offen offset:1024 sc1 lds
s_waitcnt lgkmcnt(4)
v_mfma_f32_16x16x32_bf16 v[36:39], a[224:227], a[64:67], v[36:39]
ds_read_b128 a[216:219], v5 offset:20480
v_mfma_f32_16x16x32_bf16 v[36:39], a[228:231], a[68:71], v[36:39]
ds_read_b128 a[220:223], v5 offset:25600
s_waitcnt lgkmcnt(4)
v_mfma_f32_16x16x32_bf16 v[40:43], a[232:235], a[64:67], v[40:43]
v_mfma_f32_16x16x32_bf16 v[40:43], a[236:239], a[68:71], v[40:43]
s_waitcnt lgkmcnt(2)
v_mfma_f32_16x16x32_bf16 v[44:47], a[240:243], a[64:67], v[44:47]
v_mfma_f32_16x16x32_bf16 v[44:47], a[244:247], a[68:71], v[44:47]
s_waitcnt lgkmcnt(0)
v_mfma_f32_16x16x32_bf16 v[48:51], a[216:219], a[64:67], v[48:51]
v_mfma_f32_16x16x32_bf16 v[48:51], a[220:223], a[68:71], v[48:51]
s_waitcnt vmcnt(12)
v_lshlrev_b32 v68, 16, v56
v_and_b32 v69, 0xffff0000, v56
v_add_f32 v32, v32, v68
v_add_f32 v33, v33, v69
v_lshlrev_b32 v70, 16, v57
v_and_b32 v71, 0xffff0000, v57
v_add_f32 v34, v34, v70
v_add_f32 v35, v35, v71
v_lshlrev_b32 v72, 16, v58
v_and_b32 v73, 0xffff0000, v58
v_add_f32 v36, v36, v72
v_add_f32 v37, v37, v73
v_lshlrev_b32 v74, 16, v59
v_and_b32 v75, 0xffff0000, v59
v_add_f32 v38, v38, v74
v_add_f32 v39, v39, v75
v_lshlrev_b32 v68, 16, v60
v_and_b32 v69, 0xffff0000, v60
v_add_f32 v40, v40, v68
v_add_f32 v41, v41, v69
v_lshlrev_b32 v70, 16, v61
v_and_b32 v71, 0xffff0000, v61
v_add_f32 v42, v42, v70
v_add_f32 v43, v43, v71
v_lshlrev_b32 v72, 16, v62
v_and_b32 v73, 0xffff0000, v62
v_add_f32 v44, v44, v72
v_add_f32 v45, v45, v73
v_lshlrev_b32 v74, 16, v63
v_and_b32 v75, 0xffff0000, v63
v_add_f32 v46, v46, v74
v_add_f32 v47, v47, v75
v_lshlrev_b32 v68, 16, v64
v_and_b32 v69, 0xffff0000, v64
v_add_f32 v48, v48, v68
v_add_f32 v49, v49, v69
v_lshlrev_b32 v70, 16, v65
v_and_b32 v71, 0xffff0000, v65
v_add_f32 v50, v50, v70
v_add_f32 v51, v51, v71
v_cvt_pk_bf16_f32 v80, v32, v33
v_cvt_pk_bf16_f32 v81, v34, v35
v_cvt_pk_bf16_f32 v82, v36, v37
v_cvt_pk_bf16_f32 v83, v38, v39
v_cvt_pk_bf16_f32 v84, v40, v41
v_cvt_pk_bf16_f32 v85, v42, v43
v_cvt_pk_bf16_f32 v86, v44, v45
v_cvt_pk_bf16_f32 v87, v46, v47
v_cvt_pk_bf16_f32 v88, v48, v49
v_cvt_pk_bf16_f32 v89, v50, v51
s_add_u32 s27, s26, s73
buffer_store_dwordx4 v[80:83], v2, s[8:11], s27 offen sc1
buffer_store_dwordx4 v[84:87], v2, s[8:11], s27 offen offset:1024 sc1
buffer_store_dwordx2 v[88:89], v4, s[8:11], s27 offen sc1
v_add_f32 v10, v32, v33
v_mul_f32 v11, v32, v32
v_mul_f32 v13, v33, v33
v_mov_b32 v12, 0
v_add_f32 v10, v10, v34
v_add_f32 v12, v12, v35
v_fmac_f32 v11, v34, v34
v_fmac_f32 v13, v35, v35
v_add_f32 v10, v10, v36
v_add_f32 v12, v12, v37
v_fmac_f32 v11, v36, v36
v_fmac_f32 v13, v37, v37
v_add_f32 v10, v10, v38
v_add_f32 v12, v12, v39
v_fmac_f32 v11, v38, v38
v_fmac_f32 v13, v39, v39
v_add_f32 v10, v10, v40
v_add_f32 v12, v12, v41
v_fmac_f32 v11, v40, v40
v_fmac_f32 v13, v41, v41
v_add_f32 v10, v10, v42
v_add_f32 v12, v12, v43
v_fmac_f32 v11, v42, v42
v_fmac_f32 v13, v43, v43
v_add_f32 v10, v10, v44
v_add_f32 v12, v12, v45
v_fmac_f32 v11, v44, v44
v_fmac_f32 v13, v45, v45
v_add_f32 v10, v10, v46
v_add_f32 v12, v12, v47
v_fmac_f32 v11, v46, v46
v_fmac_f32 v13, v47, v47
v_add_f32 v10, v10, v48
v_add_f32 v12, v12, v49
v_fmac_f32 v11, v48, v48
v_fmac_f32 v13, v49, v49
v_add_f32 v10, v10, v50
v_add_f32 v12, v12, v51
v_fmac_f32 v11, v50, v50
v_fmac_f32 v13, v51, v51
v_add_f32 v10, v10, v12
v_add_f32 v11, v11, v13
v_mov_b32 v12, v10
v_mov_b32 v13, v11
s_nop 0
v_permlane16_swap_b32 v10, v12
v_permlane16_swap_b32 v11, v13
v_add_f32 v10, v10, v12
v_add_f32 v11, v11, v13
v_mov_b32 v12, v10
v_mov_b32 v13, v11
s_nop 0
v_permlane32_swap_b32 v10, v12
v_permlane32_swap_b32 v11, v13
v_add_f32 v10, v10, v12
v_add_f32 v11, v11, v13
v_lshlrev_b32 v8, 3, v6
v_cmp_gt_u32 vcc, 16, v1
s_nop 1
v_cndmask_b32 v8, v9, v8, vcc
s_lshl_b32 s27, s20, 10
s_lshl_b32 s28, s21, 7
s_add_u32 s27, s27, s28
s_add_u32 s27, s27, s74
buffer_store_dwordx2 v[10:11], v8, s[8:11], s27 offen sc1
s_lshr_b32 s27, s20, 2
s_lshl_b32 s27, s27, 3
s_add_u32 s27, s27, s21
s_lshl_b32 s14, s27, 7
s_add_u32 s14, s14, 524288
s_add_u32 s14, s14, s77
s_lshl_b32 s44, s40, 4
s_lshl_b32 s45, s4, 2
s_add_u32 s44, s44, s45
s_mul_i32 s46, s44, 18432
s_add_u32 s20, s46, s73
v_add_u32 v4, 18432, v2
v_add_u32 v5, 36864, v2
v_add_u32 v6, 55296, v2
v_lshlrev_b32 v248, 3, v1
v_add_u32 v249, 18432, v248
v_add_u32 v250, 36864, v248
v_add_u32 v251, 55296, v248
v_and_b32 v13, 15, v1
v_lshrrev_b32 v14, 4, v1
v_add_u32 v7, 0x10000, v2
v_add_u32 v8, 0x20000, v2
v_and_b32 v9, 1, v14
v_mul_u32_u24 v9, 18432, v9
v_lshrrev_b32 v15, 1, v14
v_lshlrev_b32 v15, 8, v15
v_lshl_add_u32 v15, v13, 4, v15
v_add_u32 v9, v9, v15
v_and_b32 v11, 3, v1
v_lshlrev_b32 v11, 7, v11
s_lshl_b32 s49, s43, 7
v_mov_b32 v10, 2146435072
v_lshl_add_u32 v15, v1, 3, s49
v_cmp_gt_u32 vcc, 16, v1
s_nop 1
v_cndmask_b32 v10, v10, v15, vcc
s_lshl_b32 s49, s40, 3
s_add_u32 s49, s49, s42
s_lshl_b32 s50, s49, 2
s_add_u32 s50, s50, s4
s_lshl_b32 s50, s50, 9
s_add_u32 s34, s50, s77
s_add_u32 s34, s34, 0
s_lshl_b32 s49, s49, 4
s_add_u32 s49, s49, s45
s_mul_i32 s49, s49, 18432
s_add_u32 s49, s49, s75
s_add_u32 s50, s43, 0
s_and_b32 s50, s50, 3
s_mul_i32 s50, s50, 9
s_add_u32 s50, s50, 1
s_lshr_b32 s50, s50, 1
s_lshl_b32 s50, s50, 10
s_add_u32 s24, s49, s50
s_add_u32 s50, s43, 1
s_and_b32 s50, s50, 3
s_mul_i32 s50, s50, 9
s_add_u32 s50, s50, 1
s_lshr_b32 s50, s50, 1
s_lshl_b32 s50, s50, 10
s_add_u32 s25, s49, s50
s_add_u32 s50, s43, 2
s_and_b32 s50, s50, 3
s_mul_i32 s50, s50, 9
s_add_u32 s50, s50, 1
s_lshr_b32 s50, s50, 1
s_lshl_b32 s50, s50, 10
s_add_u32 s26, s49, s50
s_add_u32 s50, s43, 3
s_and_b32 s50, s50, 3
s_mul_i32 s50, s50, 9
s_add_u32 s50, s50, 1
s_lshr_b32 s50, s50, 1
s_lshl_b32 s50, s50, 10
s_add_u32 s27, s49, s50
s_add_u32 s28, s49, 4096
s_add_u32 s29, s49, 13312
s_cmp_ge_u32 s43, 2
s_cselect_b32 s50, s29, s28
s_and_b32 s51, s43, 1
s_lshl_b32 s51, s51, 9
s_add_u32 s30, s50, s51
s_mul_i32 s50, s42, 2359296
s_add_u32 s50, s50, s46
s_add_u32 s50, s50, s76
s_lshl_b32 s51, s43, 12
s_add_u32 s31, s50, s51
s_lshl_b32 s51, s43, 9
s_add_u32 s50, s50, s51
s_add_u32 s32, s50, 16384
s_add_u32 s33, s32, 36864
s_add_u32 s36, s31, 0
s_add_u32 s37, s31, 18432
s_add_u32 s38, s31, 36864
s_add_u32 s39, s31, 55296
v_lshlrev_b32 v252, 4, v13
v_lshl_add_u32 v252, v14, 9, v252
s_lshl_b32 s35, s40, 5
s_add_u32 s35, s35, s41
s_lshl_b32 s35, s35, 7
s_add_u32 s35, s35, s77
s_add_u32 s35, s35, 655360
v_lshlrev_b32 v17, 3, v13
v_lshl_add_u32 v17, v14, 8, v17
s_lshl_b32 s47, s44, 10
s_add_u32 s47, s47, s74
s_lshl_b32 s49, s44, 8
s_add_u32 s49, s49, s77
s_add_u32 s49, s49, 524288
v_and_b32 v16, 7, v1
v_lshlrev_b32 v16, 7, v16
v_mov_b32 v13, 2146435072
v_cmp_gt_u32 vcc, 16, v0
v_lshlrev_b32 v14, 3, v0
s_nop 0
v_cndmask_b32 v13, v13, v14, vcc
v_mov_b32 v14, s68
v_mov_b32 v15, s69
s_waitcnt vmcnt(0)
s_barrier
buffer_store_dwordx2 v[14:15], v13, s[8:11], s14 offen sc1
s_add_u32 m0, s22, 0
v_add_u32 v3, 20480, v3
buffer_load_dwordx4 v3, s[8:11], 0 offen offset:0 sc1 lds
buffer_load_dwordx4 v3, s[8:11], 0 offen offset:1024 sc1 lds
buffer_load_dwordx4 v3, s[8:11], 0 offen offset:2048 sc1 lds
buffer_load_dwordx4 v3, s[8:11], 0 offen offset:3072 sc1 lds
s_add_u32 m0, s22, 4096
v_add_u32 v3, 4096, v3
buffer_load_dwordx4 v3, s[8:11], 0 offen offset:0 sc1 lds
buffer_load_dwordx4 v3, s[8:11], 0 offen offset:1024 sc1 lds
s_add_u32 m0, s22, 24576
v_add_u32 v3, 20480, v3
buffer_load_dwordx4 v3, s[8:11], 0 offen offset:0 sc1 lds
buffer_load_dwordx4 v3, s[8:11], 0 offen offset:1024 sc1 lds
buffer_load_dwordx4 v3, s[8:11], 0 offen offset:2048 sc1 lds
buffer_load_dwordx4 v3, s[8:11], 0 offen offset:3072 sc1 lds
s_add_u32 m0, s22, 28672
v_add_u32 v3, 4096, v3
buffer_load_dwordx4 v3, s[8:11], 0 offen offset:0 sc1 lds
buffer_load_dwordx4 v3, s[8:11], 0 offen offset:1024 sc1 lds
ds_read_b128 v[48:51], v7 offset:32768
ds_read_b128 v[52:55], v7 offset:33792
ds_read_b128 v[56:59], v7 offset:34816
ds_read_b128 v[60:63], v7 offset:35840
ds_read_b128 v[64:67], v7 offset:36864
ds_read_b128 v[68:71], v7 offset:37888
s_mov_b32 s52, 0
L_poll3:
buffer_load_dwordx2 v[14:15], v16, s[8:11], s49 offen sc1
s_add_u32 s52, s52, 1
s_waitcnt vmcnt(0)
v_cmp_ne_u64 vcc, s[68:69], v[14:15]
s_cmp_ge_u32 s52, 1048576
s_cbranch_scc1 L_got3
s_and_b64 exec, exec, vcc
s_cbranch_execnz L_poll3
L_got3:
s_mov_b64 exec, -1
s_add_u32 s48, s20, 0
buffer_load_dwordx4 a[0:3], v2, s[8:11], s48 offen offset:0 sc1
buffer_load_dwordx4 a[4:7], v4, s[8:11], s48 offen offset:0 sc1
buffer_load_dwordx4 a[8:11], v5, s[8:11], s48 offen offset:0 sc1
buffer_load_dwordx4 a[12:15], v6, s[8:11], s48 offen offset:0 sc1
buffer_load_dwordx4 a[16:19], v2, s[8:11], s48 offen offset:1024 sc1
buffer_load_dwordx4 a[20:23], v4, s[8:11], s48 offen offset:1024 sc1
buffer_load_dwordx4 a[24:27], v5, s[8:11], s48 offen offset:1024 sc1
buffer_load_dwordx4 a[28:31], v6, s[8:11], s48 offen offset:1024 sc1
buffer_load_dwordx2 v[144:145], v17, s[8:11], s47 offen offset:0 sc1
buffer_load_dwordx2 v[146:147], v17, s[8:11], s47 offen offset:128 sc1
buffer_load_dwordx2 v[148:149], v17, s[8:11], s47 offen offset:1024 sc1
buffer_load_dwordx2 v[150:151], v17, s[8:11], s47 offen offset:1152 sc1
buffer_load_dwordx2 v[152:153], v17, s[8:11], s47 offen offset:2048 sc1
buffer_load_dwordx2 v[154:155], v17, s[8:11], s47 offen offset:2176 sc1
buffer_load_dwordx2 v[156:157], v17, s[8:11], s47 offen offset:3072 sc1
buffer_load_dwordx2 v[158:159], v17, s[8:11], s47 offen offset:3200 sc1
buffer_load_dwordx4 a[32:35], v2, s[8:11], s48 offen offset:2048 sc1
buffer_load_dwordx4 a[36:39], v4, s[8:11], s48 offen offset:2048 sc1
buffer_load_dwordx4 a[40:43], v5, s[8:11], s48 offen offset:2048 sc1
buffer_load_dwordx4 a[44:47], v6, s[8:11], s48 offen offset:2048 sc1
buffer_load_dwordx4 a[48:51], v2, s[8:11], s48 offen offset:3072 sc1
buffer_load_dwordx4 a[52:55], v4, s[8:11], s48 offen offset:3072 sc1
buffer_load_dwordx4 a[56:59], v5, s[8:11], s48 offen offset:3072 sc1
buffer_load_dwordx4 a[60:63], v6, s[8:11], s48 offen offset:3072 sc1
s_add_u32 s48, s20, 4096
buffer_load_dwordx4 a[64:67], v2, s[8:11], s48 offen offset:0 sc1
buffer_load_dwordx4 a[68:71], v4, s[8:11], s48 offen offset:0 sc1
buffer_load_dwordx4 a[72:75], v5, s[8:11], s48 offen offset:0 sc1
buffer_load_dwordx4 a[76:79], v6, s[8:11], s48 offen offset:0 sc1
s_waitcnt vmcnt(20)
s_waitcnt lgkmcnt(4)
v_mfma_f32_16x16x32_bf16 v[80:83], v[48:51], a[0:3], 0
buffer_load_dwordx4 a[80:83], v2, s[8:11], s48 offen offset:1024 sc1
v_mfma_f32_16x16x32_bf16 v[80:83], v[52:55], a[16:19], v[80:83]
v_mfma_f32_16x16x32_bf16 v[84:87], v[48:51], a[4:7], 0
ds_read_b128 v[72:75], v7 offset:38912
v_mfma_f32_16x16x32_bf16 v[84:87], v[52:55], a[20:23], v[84:87]
v_mfma_f32_16x16x32_bf16 v[88:91], v[48:51], a[8:11], 0
buffer_load_dwordx4 a[84:87], v4, s[8:11], s48 offen offset:1024 sc1
v_mfma_f32_16x16x32_bf16 v[88:91], v[52:55], a[24:27], v[88:91]
ds_read_b128 v[76:79], v7 offset:39936
v_mfma_f32_16x16x32_bf16 v[92:95], v[48:51], a[12:15], 0
v_mfma_f32_16x16x32_bf16 v[92:95], v[52:55], a[28:31], v[92:95]
s_waitcnt lgkmcnt(4)
v_mfma_f32_16x16x32_bf16 v[96:99], v[56:59], a[0:3], 0
buffer_load_dwordx4 a[88:91], v5, s[8:11], s48 offen offset:1024 sc1
v_mfma_f32_16x16x32_bf16 v[96:99], v[60:63], a[16:19], v[96:99]
v_mfma_f32_16x16x32_bf16 v[100:103], v[56:59], a[4:7], 0
ds_read_b128 v[48:51], v7 offset:40960
v_mfma_f32_16x16x32_bf16 v[100:103], v[60:63], a[20:23], v[100:103]
v_mfma_f32_16x16x32_bf16 v[104:107], v[56:59], a[8:11], 0
buffer_load_dwordx4 a[92:95], v6, s[8:11], s48 offen offset:1024 sc1
v_mfma_f32_16x16x32_bf16 v[104:107], v[60:63], a[24:27], v[104:107]
ds_read_b128 v[52:55], v7 offset:41984
v_mfma_f32_16x16x32_bf16 v[108:111], v[56:59], a[12:15], 0
v_mfma_f32_16x16x32_bf16 v[108:111], v[60:63], a[28:31], v[108:111]
s_waitcnt lgkmcnt(4)
v_mfma_f32_16x16x32_bf16 v[112:115], v[64:67], a[0:3], 0
buffer_load_dwordx4 a[96:99], v2, s[8:11], s48 offen offset:2048 sc1
v_mfma_f32_16x16x32_bf16 v[112:115], v[68:71], a[16:19], v[112:115]
v_mfma_f32_16x16x32_bf16 v[116:119], v[64:67], a[4:7], 0
ds_read_b128 v[56:59], v7 offset:43008
v_mfma_f32_16x16x32_bf16 v[116:119], v[68:71], a[20:23], v[116:119]
v_mfma_f32_16x16x32_bf16 v[120:123], v[64:67], a[8:11], 0
buffer_load_dwordx4 a[100:103], v4, s[8:11], s48 offen offset:2048 sc1
v_mfma_f32_16x16x32_bf16 v[120:123], v[68:71], a[24:27], v[120:123]
ds_read_b128 v[60:63], v7 offset:44032
v_mfma_f32_16x16x32_bf16 v[124:127], v[64:67], a[12:15], 0
v_mfma_f32_16x16x32_bf16 v[124:127], v[68:71], a[28:31], v[124:127]
s_waitcnt lgkmcnt(4)
v_mfma_f32_16x16x32_bf16 v[128:131], v[72:75], a[0:3], 0
buffer_load_dwordx4 a[104:107], v5, s[8:11], s48 offen offset:2048 sc1
v_mfma_f32_16x16x32_bf16 v[128:131], v[76:79], a[16:19], v[128:131]
v_mfma_f32_16x16x32_bf16 v[132:135], v[72:75], a[4:7], 0
ds_read_b128 v[64:67], v7 offset:45056
v_mfma_f32_16x16x32_bf16 v[132:135], v[76:79], a[20:23], v[132:135]
v_mfma_f32_16x16x32_bf16 v[136:139], v[72:75], a[8:11], 0
buffer_load_dwordx4 a[108:111], v6, s[8:11], s48 offen offset:2048 sc1
v_mfma_f32_16x16x32_bf16 v[136:139], v[76:79], a[24:27], v[136:139]
ds_read_b128 v[68:71], v7 offset:46080
v_mfma_f32_16x16x32_bf16 v[140:143], v[72:75], a[12:15], 0
v_mfma_f32_16x16x32_bf16 v[140:143], v[76:79], a[28:31], v[140:143]
s_waitcnt vmcnt(12)
s_waitcnt lgkmcnt(4)
v_mfma_f32_16x16x32_bf16 v[80:83], v[48:51], a[32:35], v[80:83]
buffer_load_dwordx4 a[112:115], v2, s[8:11], s48 offen offset:3072 sc1
v_mfma_f32_16x16x32_bf16 v[80:83], v[52:55], a[48:51], v[80:83]
v_mfma_f32_16x16x32_bf16 v[84:87], v[48:51], a[36:39], v[84:87]
ds_read_b128 v[72:75], v7 offset:47104
v_mfma_f32_16x16x32_bf16 v[84:87], v[52:55], a[52:55], v[84:87]
v_mfma_f32_16x16x32_bf16 v[88:91], v[48:51], a[40:43], v[88:91]
buffer_load_dwordx4 a[116:119], v4, s[8:11], s48 offen offset:3072 sc1
v_mfma_f32_16x16x32_bf16 v[88:91], v[52:55], a[56:59], v[88:91]
ds_read_b128 v[76:79], v7 offset:48128
v_mfma_f32_16x16x32_bf16 v[92:95], v[48:51], a[44:47], v[92:95]
v_mfma_f32_16x16x32_bf16 v[92:95], v[52:55], a[60:63], v[92:95]
s_waitcnt lgkmcnt(4)
v_mfma_f32_16x16x32_bf16 v[96:99], v[56:59], a[32:35], v[96:99]
buffer_load_dwordx4 a[120:123], v5, s[8:11], s48 offen offset:3072 sc1
v_mfma_f32_16x16x32_bf16 v[96:99], v[60:63], a[48:51], v[96:99]
v_mfma_f32_16x16x32_bf16 v[100:103], v[56:59], a[36:39], v[100:103]
ds_read_b128 v[48:51], v7 offset:49152
v_mfma_f32_16x16x32_bf16 v[100:103], v[60:63], a[52:55], v[100:103]
v_mfma_f32_16x16x32_bf16 v[104:107], v[56:59], a[40:43], v[104:107]
buffer_load_dwordx4 a[124:127], v6, s[8:11], s48 offen offset:3072 sc1
v_mfma_f32_16x16x32_bf16 v[104:107], v[60:63], a[56:59], v[104:107]
ds_read_b128 v[52:55], v7 offset:50176
s_add_u32 s48, s20, 8192
v_mfma_f32_16x16x32_bf16 v[108:111], v[56:59], a[44:47], v[108:111]
v_mfma_f32_16x16x32_bf16 v[108:111], v[60:63], a[60:63], v[108:111]
s_waitcnt lgkmcnt(4)
v_mfma_f32_16x16x32_bf16 v[112:115], v[64:67], a[32:35], v[112:115]
buffer_load_dwordx4 a[128:131], v2, s[8:11], s48 offen offset:0 sc1
v_mfma_f32_16x16x32_bf16 v[112:115], v[68:71], a[48:51], v[112:115]
v_mfma_f32_16x16x32_bf16 v[116:119], v[64:67], a[36:39], v[116:119]
ds_read_b128 v[56:59], v7 offset:51200
v_mfma_f32_16x16x32_bf16 v[116:119], v[68:71], a[52:55], v[116:119]
v_mfma_f32_16x16x32_bf16 v[120:123], v[64:67], a[40:43], v[120:123]
buffer_load_dwordx4 a[132:135], v4, s[8:11], s48 offen offset:0 sc1
v_mfma_f32_16x16x32_bf16 v[120:123], v[68:71], a[56:59], v[120:123]
ds_read_b128 v[60:63], v7 offset:52224
v_mfma_f32_16x16x32_bf16 v[124:127], v[64:67], a[44:47], v[124:127]
v_mfma_f32_16x16x32_bf16 v[124:127], v[68:71], a[60:63], v[124:127]
s_waitcnt lgkmcnt(4)
v_mfma_f32_16x16x32_bf16 v[128:131], v[72:75], a[32:35], v[128:131]
buffer_load_dwordx4 a[136:139], v5, s[8:11], s48 offen offset:0 sc1
v_mfma_f32_16x16x32_bf16 v[128:131], v[76:79], a[48:51], v[128:131]
v_mfma_f32_16x16x32_bf16 v[132:135], v[72:75], a[36:39], v[132:135]
ds_read_b128 v[64:67], v7 offset:53248
v_mfma_f32_16x16x32_bf16 v[132:135], v[76:79], a[52:55], v[132:135]
v_mfma_f32_16x16x32_bf16 v[136:139], v[72:75], a[40:43], v[136:139]
buffer_load_dwordx4 a[140:143], v6, s[8:11], s48 offen offset:0 sc1
v_mfma_f32_16x16x32_bf16 v[136:139], v[76:79], a[56:59], v[136:139]
ds_read_b128 v[68:71], v7 offset:54272
v_mfma_f32_16x16x32_bf16 v[140:143], v[72:75], a[44:47], v[140:143]
v_mfma_f32_16x16x32_bf16 v[140:143], v[76:79], a[60:63], v[140:143]
s_waitcnt vmcnt(12)
s_waitcnt lgkmcnt(4)
v_mfma_f32_16x16x32_bf16 v[80:83], v[48:51], a[64:67], v[80:83]
buffer_load_dwordx4 a[144:147], v2, s[8:11], s48 offen offset:1024 sc1
v_mfma_f32_16x16x32_bf16 v[80:83], v[52:55], a[80:83], v[80:83]
v_mfma_f32_16x16x32_bf16 v[84:87], v[48:51], a[68:71], v[84:87]
ds_read_b128 v[72:75], v7 offset:55296
v_mfma_f32_16x16x32_bf16 v[84:87], v[52:55], a[84:87], v[84:87]
v_add_f32 v144, v144, v146
v_add_f32 v145, v145, v147
v_mfma_f32_16x16x32_bf16 v[88:91], v[48:51], a[72:75], v[88:91]
buffer_load_dwordx4 a[148:151], v4, s[8:11], s48 offen offset:1024 sc1
v_mfma_f32_16x16x32_bf16 v[88:91], v[52:55], a[88:91], v[88:91]
ds_read_b128 v[76:79], v7 offset:56320
v_add_f32 v148, v148, v150
v_mfma_f32_16x16x32_bf16 v[92:95], v[48:51], a[76:79], v[92:95]
v_add_f32 v149, v149, v151
v_add_f32 v152, v152, v154
v_mfma_f32_16x16x32_bf16 v[92:95], v[52:55], a[92:95], v[92:95]
v_add_f32 v153, v153, v155
s_waitcnt lgkmcnt(4)
v_mfma_f32_16x16x32_bf16 v[96:99], v[56:59], a[64:67], v[96:99]
buffer_load_dwordx4 a[152:155], v5, s[8:11], s48 offen offset:1024 sc1
v_mfma_f32_16x16x32_bf16 v[96:99], v[60:63], a[80:83], v[96:99]
s_barrier
v_mfma_f32_16x16x32_bf16 v[100:103], v[56:59], a[68:71], v[100:103]
ds_read_b128 v[48:51], v7 offset:57344
v_add_f32 v156, v156, v158
v_mfma_f32_16x16x32_bf16 v[100:103], v[60:63], a[84:87], v[100:103]
v_add_f32 v157, v157, v159
v_mov_b32 v160, v144
v_mfma_f32_16x16x32_bf16 v[104:107], v[56:59], a[72:75], v[104:107]
buffer_load_dwordx4 a[156:159], v6, s[8:11], s48 offen offset:1024 sc1
v_mfma_f32_16x16x32_bf16 v[104:107], v[60:63], a[88:91], v[104:107]
ds_read_b128 v[52:55], v7 offset:58368
v_mov_b32 v161, v145
v_mfma_f32_16x16x32_bf16 v[108:111], v[56:59], a[76:79], v[108:111]
v_mov_b32 v162, v148
v_mov_b32 v163, v149
v_mfma_f32_16x16x32_bf16 v[108:111], v[60:63], a[92:95], v[108:111]
v_mov_b32 v164, v152
s_waitcnt lgkmcnt(4)
v_mfma_f32_16x16x32_bf16 v[112:115], v[64:67], a[64:67], v[112:115]
buffer_load_dwordx4 a[160:163], v2, s[8:11], s48 offen offset:2048 sc1
v_mfma_f32_16x16x32_bf16 v[112:115], v[68:71], a[80:83], v[112:115]
v_mov_b32 v165, v153
v_mov_b32 v166, v156
v_mfma_f32_16x16x32_bf16 v[116:119], v[64:67], a[68:71], v[116:119]
ds_read_b128 v[56:59], v7 offset:59392
v_mov_b32 v167, v157
v_mfma_f32_16x16x32_bf16 v[116:119], v[68:71], a[84:87], v[116:119]
v_permlane16_swap_b32 v144, v160
v_permlane16_swap_b32 v145, v161
v_mfma_f32_16x16x32_bf16 v[120:123], v[64:67], a[72:75], v[120:123]
buffer_load_dwordx4 a[164:167], v4, s[8:11], s48 offen offset:2048 sc1
v_mfma_f32_16x16x32_bf16 v[120:123], v[68:71], a[88:91], v[120:123]
ds_read_b128 v[60:63], v7 offset:60416
v_permlane16_swap_b32 v148, v162
v_mfma_f32_16x16x32_bf16 v[124:127], v[64:67], a[76:79], v[124:127]
v_permlane16_swap_b32 v149, v163
v_permlane16_swap_b32 v152, v164
v_mfma_f32_16x16x32_bf16 v[124:127], v[68:71], a[92:95], v[124:127]
v_permlane16_swap_b32 v153, v165
s_waitcnt lgkmcnt(4)
v_mfma_f32_16x16x32_bf16 v[128:131], v[72:75], a[64:67], v[128:131]
buffer_load_dwordx4 a[168:171], v5, s[8:11], s48 offen offset:2048 sc1
v_mfma_f32_16x16x32_bf16 v[128:131], v[76:79], a[80:83], v[128:131]
v_permlane16_swap_b32 v156, v166
v_permlane16_swap_b32 v157, v167
v_mfma_f32_16x16x32_bf16 v[132:135], v[72:75], a[68:71], v[132:135]
ds_read_b128 v[64:67], v7 offset:61440
v_add_f32 v144, v144, v160
v_mfma_f32_16x16x32_bf16 v[132:135], v[76:79], a[84:87], v[132:135]
v_add_f32 v145, v145, v161
v_add_f32 v148, v148, v162
v_mfma_f32_16x16x32_bf16 v[136:139], v[72:75], a[72:75], v[136:139]
buffer_load_dwordx4 a[172:175], v6, s[8:11], s48 offen offset:2048 sc1
v_mfma_f32_16x16x32_bf16 v[136:139], v[76:79], a[88:91], v[136:139]
ds_read_b128 v[68:71], v7 offset:62464
v_add_f32 v149, v149, v163
v_mfma_f32_16x16x32_bf16 v[140:143], v[72:75], a[76:79], v[140:143]
v_add_f32 v152, v152, v164
v_add_f32 v153, v153, v165
v_mfma_f32_16x16x32_bf16 v[140:143], v[76:79], a[92:95], v[140:143]
v_add_f32 v156, v156, v166
s_waitcnt vmcnt(12)
s_waitcnt lgkmcnt(4)
v_mfma_f32_16x16x32_bf16 v[80:83], v[48:51], a[96:99], v[80:83]
buffer_load_dwordx4 a[176:179], v2, s[8:11], s48 offen offset:3072 sc1
v_mfma_f32_16x16x32_bf16 v[80:83], v[52:55], a[112:115], v[80:83]
v_add_f32 v157, v157, v167
v_mov_b32 v160, v144
v_mfma_f32_16x16x32_bf16 v[84:87], v[48:51], a[100:103], v[84:87]
ds_read_b128 v[72:75], v7 offset:63488
v_mov_b32 v161, v145
v_mfma_f32_16x16x32_bf16 v[84:87], v[52:55], a[116:119], v[84:87]
v_mov_b32 v162, v148
v_mov_b32 v163, v149
v_mfma_f32_16x16x32_bf16 v[88:91], v[48:51], a[104:107], v[88:91]
buffer_load_dwordx4 a[180:183], v4, s[8:11], s48 offen offset:3072 sc1
v_mfma_f32_16x16x32_bf16 v[88:91], v[52:55], a[120:123], v[88:91]
ds_read_b128 v[76:79], v7 offset:64512
v_mov_b32 v164, v152
v_mfma_f32_16x16x32_bf16 v[92:95], v[48:51], a[108:111], v[92:95]
v_mov_b32 v165, v153
v_mov_b32 v166, v156
v_mfma_f32_16x16x32_bf16 v[92:95], v[52:55], a[124:127], v[92:95]
v_mov_b32 v167, v157
s_waitcnt lgkmcnt(4)
v_mfma_f32_16x16x32_bf16 v[96:99], v[56:59], a[96:99], v[96:99]
buffer_load_dwordx4 a[184:187], v5, s[8:11], s48 offen offset:3072 sc1
v_mfma_f32_16x16x32_bf16 v[96:99], v[60:63], a[112:115], v[96:99]
v_permlane32_swap_b32 v144, v160
v_permlane32_swap_b32 v145, v161
v_mfma_f32_16x16x32_bf16 v[100:103], v[56:59], a[100:103], v[100:103]
ds_read_b128 v[48:51], v8 offset:0
v_permlane32_swap_b32 v148, v162
v_mfma_f32_16x16x32_bf16 v[100:103], v[60:63], a[116:119], v[100:103]
v_permlane32_swap_b32 v149, v163
v_permlane32_swap_b32 v152, v164
v_mfma_f32_16x16x32_bf16 v[104:107], v[56:59], a[104:107], v[104:107]
buffer_load_dwordx4 a[188:191], v6, s[8:11], s48 offen offset:3072 sc1
v_mfma_f32_16x16x32_bf16 v[104:107], v[60:63], a[120:123], v[104:107]
ds_read_b128 v[52:55], v8 offset:1024
s_add_u32 s48, s20, 12288
v_mfma_f32_16x16x32_bf16 v[108:111], v[56:59], a[108:111], v[108:111]
v_permlane32_swap_b32 v153, v165
v_permlane32_swap_b32 v156, v166
v_mfma_f32_16x16x32_bf16 v[108:111], v[60:63], a[124:127], v[108:111]
v_permlane32_swap_b32 v157, v167
s_waitcnt lgkmcnt(4)
v_mfma_f32_16x16x32_bf16 v[112:115], v[64:67], a[96:99], v[112:115]
buffer_load_dwordx4 a[192:195], v2, s[8:11], s48 offen offset:0 sc1
v_mfma_f32_16x16x32_bf16 v[112:115], v[68:71], a[112:115], v[112:115]
v_add_f32 v144, v144, v160
v_add_f32 v145, v145, v161
v_mfma_f32_16x16x32_bf16 v[116:119], v[64:67], a[100:103], v[116:119]
ds_read_b128 v[56:59], v8 offset:2048
v_add_f32 v148, v148, v162
v_mfma_f32_16x16x32_bf16 v[116:119], v[68:71], a[116:119], v[116:119]
v_add_f32 v149, v149, v163
v_add_f32 v152, v152, v164
v_mfma_f32_16x16x32_bf16 v[120:123], v[64:67], a[104:107], v[120:123]
buffer_load_dwordx4 a[196:199], v4, s[8:11], s48 offen offset:0 sc1
v_mfma_f32_16x16x32_bf16 v[120:123], v[68:71], a[120:123], v[120:123]
ds_read_b128 v[60:63], v8 offset:3072
v_add_f32 v153, v153, v165
v_mfma_f32_16x16x32_bf16 v[124:127], v[64:67], a[108:111], v[124:127]
v_add_f32 v156, v156, v166
v_add_f32 v157, v157, v167
v_mfma_f32_16x16x32_bf16 v[124:127], v[68:71], a[124:127], v[124:127]
v_mul_f32 v144, 0x3ae38e39, v144
s_waitcnt lgkmcnt(4)
v_mfma_f32_16x16x32_bf16 v[128:131], v[72:75], a[96:99], v[128:131]
buffer_load_dwordx4 a[200:203], v5, s[8:11], s48 offen offset:0 sc1
v_mfma_f32_16x16x32_bf16 v[128:131], v[76:79], a[112:115], v[128:131]
v_mul_f32 v148, 0x3ae38e39, v148
v_mul_f32 v152, 0x3ae38e39, v152
v_mfma_f32_16x16x32_bf16 v[132:135], v[72:75], a[100:103], v[132:135]
ds_read_b128 v[64:67], v8 offset:4096
v_mul_f32 v156, 0x3ae38e39, v156
v_mfma_f32_16x16x32_bf16 v[132:135], v[76:79], a[116:119], v[132:135]
v_mul_f32 v145, 0x3ae38e39, v145
v_mul_f32 v149, 0x3ae38e39, v149
v_mfma_f32_16x16x32_bf16 v[136:139], v[72:75], a[104:107], v[136:139]
buffer_load_dwordx4 a[204:207], v6, s[8:11], s48 offen offset:0 sc1
v_mfma_f32_16x16x32_bf16 v[136:139], v[76:79], a[120:123], v[136:139]
ds_read_b128 v[68:71], v8 offset:5120
v_mul_f32 v153, 0x3ae38e39, v153
L_hop4:
s_cmp_eq_u32 s15, 1
s_cbranch_scc1 L_hop8
v_mfma_f32_16x16x32_bf16 v[140:143], v[72:75], a[108:111], v[140:143]
v_mul_f32 v157, 0x3ae38e39, v157
v_fma_f32 v145, -v144, v144, v145
v_mfma_f32_16x16x32_bf16 v[140:143], v[76:79], a[124:127], v[140:143]
v_fma_f32 v149, -v148, v148, v149
s_waitcnt vmcnt(12)
s_waitcnt lgkmcnt(4)
v_mfma_f32_16x16x32_bf16 v[80:83], v[48:51], a[128:131], v[80:83]
buffer_load_dwordx4 a[208:211], v2, s[8:11], s48 offen offset:1024 sc1
v_mfma_f32_16x16x32_bf16 v[80:83], v[52:55], a[144:147], v[80:83]
v_fma_f32 v153, -v152, v152, v153
v_fma_f32 v157, -v156, v156, v157
v_mfma_f32_16x16x32_bf16 v[84:87], v[48:51], a[132:135], v[84:87]
ds_read_b128 v[72:75], v8 offset:6144
v_max_f32 v145, 0, v145
v_mfma_f32_16x16x32_bf16 v[84:87], v[52:55], a[148:151], v[84:87]
v_max_f32 v149, 0, v149
v_max_f32 v153, 0, v153
v_mfma_f32_16x16x32_bf16 v[88:91], v[48:51], a[136:139], v[88:91]
buffer_load_dwordx4 a[212:215], v4, s[8:11], s48 offen offset:1024 sc1
v_mfma_f32_16x16x32_bf16 v[88:91], v[52:55], a[152:155], v[88:91]
ds_read_b128 v[76:79], v8 offset:7168
v_max_f32 v157, 0, v157
v_mfma_f32_16x16x32_bf16 v[92:95], v[48:51], a[140:143], v[92:95]
v_add_f32 v234, 0x3727c5ac, v145
v_add_f32 v238, 0x3727c5ac, v149
v_mfma_f32_16x16x32_bf16 v[92:95], v[52:55], a[156:159], v[92:95]
v_add_f32 v242, 0x3727c5ac, v153
s_waitcnt lgkmcnt(4)
v_mfma_f32_16x16x32_bf16 v[96:99], v[56:59], a[128:131], v[96:99]
buffer_load_dwordx4 a[216:219], v5, s[8:11], s48 offen offset:1024 sc1
v_mfma_f32_16x16x32_bf16 v[96:99], v[60:63], a[144:147], v[96:99]
v_add_f32 v246, 0x3727c5ac, v157
v_mfma_f32_16x16x32_bf16 v[100:103], v[56:59], a[132:135], v[100:103]
ds_read_b128 v[48:51], v8 offset:8192
v_mfma_f32_16x16x32_bf16 v[100:103], v[60:63], a[148:151], v[100:103]
v_rsq_f32 v144, v234
v_mfma_f32_16x16x32_bf16 v[104:107], v[56:59], a[136:139], v[104:107]
buffer_load_dwordx4 a[220:223], v6, s[8:11], s48 offen offset:1024 sc1
v_mfma_f32_16x16x32_bf16 v[104:107], v[60:63], a[152:155], v[104:107]
ds_read_b128 v[52:55], v8 offset:9216
v_mul_f32 v232, 0xc0135761, v144
v_mfma_f32_16x16x32_bf16 v[108:111], v[56:59], a[140:143], v[108:111]
v_rsq_f32 v148, v238
v_mfma_f32_16x16x32_bf16 v[108:111], v[60:63], a[156:159], v[108:111]
v_mul_f32 v236, 0xc0135761, v148
s_waitcnt lgkmcnt(4)
v_mfma_f32_16x16x32_bf16 v[112:115], v[64:67], a[128:131], v[112:115]
buffer_load_dwordx4 a[224:227], v2, s[8:11], s48 offen offset:2048 sc1
v_mfma_f32_16x16x32_bf16 v[112:115], v[68:71], a[144:147], v[112:115]
v_rsq_f32 v152, v242
v_mfma_f32_16x16x32_bf16 v[116:119], v[64:67], a[132:135], v[116:119]
ds_read_b128 v[56:59], v8 offset:10240
v_mul_f32 v240, 0xc0135761, v152
v_mfma_f32_16x16x32_bf16 v[116:119], v[68:71], a[148:151], v[116:119]
v_rsq_f32 v156, v246
v_mfma_f32_16x16x32_bf16 v[120:123], v[64:67], a[136:139], v[120:123]
buffer_load_dwordx4 a[228:231], v4, s[8:11], s48 offen offset:2048 sc1
v_mfma_f32_16x16x32_bf16 v[120:123], v[68:71], a[152:155], v[120:123]
ds_read_b128 v[60:63], v8 offset:11264
v_mul_f32 v244, 0xc0135761, v156
v_mfma_f32_16x16x32_bf16 v[124:127], v[64:67], a[140:143], v[124:127]
v_mul_f32 v145, v144, v144
v_mul_f32 v149, v148, v148
v_mfma_f32_16x16x32_bf16 v[124:127], v[68:71], a[156:159], v[124:127]
v_mul_f32 v153, v152, v152
s_waitcnt lgkmcnt(4)
v_mfma_f32_16x16x32_bf16 v[128:131], v[72:75], a[128:131], v[128:131]
buffer_load_dwordx4 a[232:235], v5, s[8:11], s48 offen offset:2048 sc1
v_mfma_f32_16x16x32_bf16 v[128:131], v[76:79], a[144:147], v[128:131]
v_mul_f32 v157, v156, v156
v_mul_f32 v145, v145, v144
v_mfma_f32_16x16x32_bf16 v[132:135], v[72:75], a[132:135], v[132:135]
ds_read_b128 v[64:67], v8 offset:12288
v_mul_f32 v149, v149, v148
v_mfma_f32_16x16x32_bf16 v[132:135], v[76:79], a[148:151], v[132:135]
v_mul_f32 v153, v153, v152
v_mul_f32 v157, v157, v156
v_mfma_f32_16x16x32_bf16 v[136:139], v[72:75], a[136:139], v[136:139]
buffer_load_dwordx4 a[236:239], v6, s[8:11], s48 offen offset:2048 sc1
v_mfma_f32_16x16x32_bf16 v[136:139], v[76:79], a[152:155], v[136:139]
ds_read_b128 v[68:71], v8 offset:13312
v_mul_f32 v233, 0xbdd2d3e8, v145
v_mfma_f32_16x16x32_bf16 v[140:143], v[72:75], a[140:143], v[140:143]
v_mul_f32 v237, 0xbdd2d3e8, v149
v_mul_f32 v241, 0xbdd2d3e8, v153
v_mfma_f32_16x16x32_bf16 v[140:143], v[76:79], a[156:159], v[140:143]
v_mul_f32 v245, 0xbdd2d3e8, v157
s_waitcnt vmcnt(12)
s_waitcnt lgkmcnt(4)
v_mfma_f32_16x16x32_bf16 v[80:83], v[48:51], a[160:163], v[80:83]
buffer_load_dwordx4 a[240:243], v2, s[8:11], s48 offen offset:3072 sc1
v_mfma_f32_16x16x32_bf16 v[80:83], v[52:55], a[176:179], v[80:83]
v_mfma_f32_16x16x32_bf16 v[84:87], v[48:51], a[164:167], v[84:87]
ds_read_b128 v[72:75], v8 offset:14336
v_mfma_f32_16x16x32_bf16 v[84:87], v[52:55], a[180:183], v[84:87]
v_mfma_f32_16x16x32_bf16 v[88:91], v[48:51], a[168:171], v[88:91]
buffer_load_dwordx4 a[244:247], v4, s[8:11], s48 offen offset:3072 sc1
v_mfma_f32_16x16x32_bf16 v[88:91], v[52:55], a[184:187], v[88:91]
ds_read_b128 v[76:79], v8 offset:15360
v_mfma_f32_16x16x32_bf16 v[92:95], v[48:51], a[172:175], v[92:95]
v_mfma_f32_16x16x32_bf16 v[92:95], v[52:55], a[188:191], v[92:95]
s_waitcnt lgkmcnt(4)
v_mfma_f32_16x16x32_bf16 v[96:99], v[56:59], a[160:163], v[96:99]
buffer_load_dwordx4 a[248:251], v5, s[8:11], s48 offen offset:3072 sc1
v_mfma_f32_16x16x32_bf16 v[96:99], v[60:63], a[176:179], v[96:99]
s_barrier
v_mfma_f32_16x16x32_bf16 v[100:103], v[56:59], a[164:167], v[100:103]
ds_read_b128 v[48:51], v2 offset:0
v_mfma_f32_16x16x32_bf16 v[100:103], v[60:63], a[180:183], v[100:103]
v_mfma_f32_16x16x32_bf16 v[104:107], v[56:59], a[168:171], v[104:107]
buffer_load_dwordx4 a[252:255], v6, s[8:11], s48 offen offset:3072 sc1
v_mfma_f32_16x16x32_bf16 v[104:107], v[60:63], a[184:187], v[104:107]
ds_read_b128 v[52:55], v2 offset:1024
s_add_u32 s48, s20, 16384
v_mfma_f32_16x16x32_bf16 v[108:111], v[56:59], a[172:175], v[108:111]
v_mfma_f32_16x16x32_bf16 v[108:111], v[60:63], a[188:191], v[108:111]
s_waitcnt lgkmcnt(4)
v_mfma_f32_16x16x32_bf16 v[112:115], v[64:67], a[160:163], v[112:115]
buffer_load_dwordx4 v[16:19], v2, s[8:11], s48 offen offset:0 sc1
v_mfma_f32_16x16x32_bf16 v[112:115], v[68:71], a[176:179], v[112:115]
v_mfma_f32_16x16x32_bf16 v[116:119], v[64:67], a[164:167], v[116:119]
ds_read_b128 v[56:59], v2 offset:2048
v_mfma_f32_16x16x32_bf16 v[116:119], v[68:71], a[180:183], v[116:119]
v_mfma_f32_16x16x32_bf16 v[120:123], v[64:67], a[168:171], v[120:123]
buffer_load_dwordx4 v[20:23], v4, s[8:11], s48 offen offset:0 sc1
v_mfma_f32_16x16x32_bf16 v[120:123], v[68:71], a[184:187], v[120:123]
ds_read_b128 v[60:63], v2 offset:3072
v_mfma_f32_16x16x32_bf16 v[124:127], v[64:67], a[172:175], v[124:127]
v_mfma_f32_16x16x32_bf16 v[124:127], v[68:71], a[188:191], v[124:127]
s_waitcnt lgkmcnt(4)
v_mfma_f32_16x16x32_bf16 v[128:131], v[72:75], a[160:163], v[128:131]
buffer_load_dwordx4 v[24:27], v5, s[8:11], s48 offen offset:0 sc1
v_mfma_f32_16x16x32_bf16 v[128:131], v[76:79], a[176:179], v[128:131]
v_mfma_f32_16x16x32_bf16 v[132:135], v[72:75], a[164:167], v[132:135]
ds_read_b128 v[64:67], v2 offset:4096
v_mfma_f32_16x16x32_bf16 v[132:135], v[76:79], a[180:183], v[132:135]
v_mfma_f32_16x16x32_bf16 v[136:139], v[72:75], a[168:171], v[136:139]
buffer_load_dwordx4 v[28:31], v6, s[8:11], s48 offen offset:0 sc1
v_mfma_f32_16x16x32_bf16 v[136:139], v[76:79], a[184:187], v[136:139]
ds_read_b128 v[68:71], v2 offset:5120
v_mfma_f32_16x16x32_bf16 v[140:143], v[72:75], a[172:175], v[140:143]
v_mfma_f32_16x16x32_bf16 v[140:143], v[76:79], a[188:191], v[140:143]
s_waitcnt vmcnt(12)
s_waitcnt lgkmcnt(4)
v_mfma_f32_16x16x32_bf16 v[80:83], v[48:51], a[192:195], v[80:83]
buffer_load_dwordx4 v[32:35], v2, s[8:11], s48 offen offset:1024 sc1
v_mfma_f32_16x16x32_bf16 v[80:83], v[52:55], a[208:211], v[80:83]
v_mfma_f32_16x16x32_bf16 v[84:87], v[48:51], a[196:199], v[84:87]
ds_read_b128 v[72:75], v2 offset:6144
v_mfma_f32_16x16x32_bf16 v[84:87], v[52:55], a[212:215], v[84:87]
v_mfma_f32_16x16x32_bf16 v[88:91], v[48:51], a[200:203], v[88:91]
buffer_load_dwordx4 v[36:39], v4, s[8:11], s48 offen offset:1024 sc1
v_mfma_f32_16x16x32_bf16 v[88:91], v[52:55], a[216:219], v[88:91]
ds_read_b128 v[76:79], v2 offset:7168
v_mfma_f32_16x16x32_bf16 v[92:95], v[48:51], a[204:207], v[92:95]
v_mfma_f32_16x16x32_bf16 v[92:95], v[52:55], a[220:223], v[92:95]
s_waitcnt lgkmcnt(4)
v_mfma_f32_16x16x32_bf16 v[96:99], v[56:59], a[192:195], v[96:99]
buffer_load_dwordx4 v[40:43], v5, s[8:11], s48 offen offset:1024 sc1
v_mfma_f32_16x16x32_bf16 v[96:99], v[60:63], a[208:211], v[96:99]
v_mfma_f32_16x16x32_bf16 v[100:103], v[56:59], a[196:199], v[100:103]
ds_read_b128 v[48:51], v2 offset:8192
v_mfma_f32_16x16x32_bf16 v[100:103], v[60:63], a[212:215], v[100:103]
v_mfma_f32_16x16x32_bf16 v[104:107], v[56:59], a[200:203], v[104:107]
buffer_load_dwordx4 v[44:47], v6, s[8:11], s48 offen offset:1024 sc1
v_mfma_f32_16x16x32_bf16 v[104:107], v[60:63], a[216:219], v[104:107]
ds_read_b128 v[52:55], v2 offset:9216
s_add_u32 m0, s22, 49152
v_mfma_f32_16x16x32_bf16 v[108:111], v[56:59], a[204:207], v[108:111]
v_add_u32 v3, 20480, v3
v_mfma_f32_16x16x32_bf16 v[108:111], v[60:63], a[220:223], v[108:111]
s_waitcnt lgkmcnt(4)
v_mfma_f32_16x16x32_bf16 v[112:115], v[64:67], a[192:195], v[112:115]
buffer_load_dwordx4 v3, s[8:11], 0 offen offset:0 sc1 lds
v_mfma_f32_16x16x32_bf16 v[112:115], v[68:71], a[208:211], v[112:115]
v_mfma_f32_16x16x32_bf16 v[116:119], v[64:67], a[196:199], v[116:119]
ds_read_b128 v[56:59], v2 offset:10240
v_mfma_f32_16x16x32_bf16 v[116:119], v[68:71], a[212:215], v[116:119]
v_mfma_f32_16x16x32_bf16 v[120:123], v[64:67], a[200:203], v[120:123]
buffer_load_dwordx4 v3, s[8:11], 0 offen offset:1024 sc1 lds
v_mfma_f32_16x16x32_bf16 v[120:123], v[68:71], a[216:219], v[120:123]
ds_read_b128 v[60:63], v2 offset:11264
v_mfma_f32_16x16x32_bf16 v[124:127], v[64:67], a[204:207], v[124:127]
v_mfma_f32_16x16x32_bf16 v[124:127], v[68:71], a[220:223], v[124:127]
s_waitcnt lgkmcnt(4)
v_mfma_f32_16x16x32_bf16 v[128:131], v[72:75], a[192:195], v[128:131]
buffer_load_dwordx4 v3, s[8:11], 0 offen offset:2048 sc1 lds
v_mfma_f32_16x16x32_bf16 v[128:131], v[76:79], a[208:211], v[128:131]
v_mfma_f32_16x16x32_bf16 v[132:135], v[72:75], a[196:199], v[132:135]
ds_read_b128 v[64:67], v2 offset:12288
v_mfma_f32_16x16x32_bf16 v[132:135], v[76:79], a[212:215], v[132:135]
v_mfma_f32_16x16x32_bf16 v[136:139], v[72:75], a[200:203], v[136:139]
buffer_load_dwordx4 v3, s[8:11], 0 offen offset:3072 sc1 lds
v_mfma_f32_16x16x32_bf16 v[136:139], v[76:79], a[216:219], v[136:139]
ds_read_b128 v[68:71], v2 offset:13312
s_add_u32 m0, s22, 53248
v_mfma_f32_16x16x32_bf16 v[140:143], v[72:75], a[204:207], v[140:143]
v_add_u32 v3, 4096, v3
v_mfma_f32_16x16x32_bf16 v[140:143], v[76:79], a[220:223], v[140:143]
s_waitcnt vmcnt(12)
s_waitcnt lgkmcnt(4)
v_mfma_f32_16x16x32_bf16 v[80:83], v[48:51], a[224:227], v[80:83]
buffer_load_dwordx4 v3, s[8:11], 0 offen offset:0 sc1 lds
v_mfma_f32_16x16x32_bf16 v[80:83], v[52:55], a[240:243], v[80:83]
v_mfma_f32_16x16x32_bf16 v[84:87], v[48:51], a[228:231], v[84:87]
ds_read_b128 v[72:75], v2 offset:14336
v_mfma_f32_16x16x32_bf16 v[84:87], v[52:55], a[244:247], v[84:87]
v_mfma_f32_16x16x32_bf16 v[88:91], v[48:51], a[232:235], v[88:91]
buffer_load_dwordx4 v3, s[8:11], 0 offen offset:1024 sc1 lds
v_mfma_f32_16x16x32_bf16 v[88:91], v[52:55], a[248:251], v[88:91]
ds_read_b128 v[76:79], v2 offset:15360
s_add_u32 m0, s22, 73728
v_mfma_f32_16x16x32_bf16 v[92:95], v[48:51], a[236:239], v[92:95]
v_add_u32 v3, 20480, v3
v_mfma_f32_16x16x32_bf16 v[92:95], v[52:55], a[252:255], v[92:95]
s_waitcnt lgkmcnt(4)
v_mfma_f32_16x16x32_bf16 v[96:99], v[56:59], a[224:227], v[96:99]
buffer_load_dwordx4 v3, s[8:11], 0 offen offset:0 sc1 lds
v_mfma_f32_16x16x32_bf16 v[96:99], v[60:63], a[240:243], v[96:99]
v_mfma_f32_16x16x32_bf16 v[100:103], v[56:59], a[228:231], v[100:103]
ds_read_b128 v[48:51], v2 offset:16384
v_mfma_f32_16x16x32_bf16 v[100:103], v[60:63], a[244:247], v[100:103]
v_mfma_f32_16x16x32_bf16 v[104:107], v[56:59], a[232:235], v[104:107]
buffer_load_dwordx4 v3, s[8:11], 0 offen offset:1024 sc1 lds
v_mfma_f32_16x16x32_bf16 v[104:107], v[60:63], a[248:251], v[104:107]
ds_read_b128 v[52:55], v2 offset:17408
v_mfma_f32_16x16x32_bf16 v[108:111], v[56:59], a[236:239], v[108:111]
v_mfma_f32_16x16x32_bf16 v[108:111], v[60:63], a[252:255], v[108:111]
s_waitcnt lgkmcnt(4)
v_mfma_f32_16x16x32_bf16 v[112:115], v[64:67], a[224:227], v[112:115]
buffer_load_dwordx4 v3, s[8:11], 0 offen offset:2048 sc1 lds
v_mfma_f32_16x16x32_bf16 v[112:115], v[68:71], a[240:243], v[112:115]
v_mfma_f32_16x16x32_bf16 v[116:119], v[64:67], a[228:231], v[116:119]
ds_read_b128 v[56:59], v2 offset:18432
v_mfma_f32_16x16x32_bf16 v[116:119], v[68:71], a[244:247], v[116:119]
v_mfma_f32_16x16x32_bf16 v[120:123], v[64:67], a[232:235], v[120:123]
buffer_load_dwordx4 v3, s[8:11], 0 offen offset:3072 sc1 lds
v_mfma_f32_16x16x32_bf16 v[120:123], v[68:71], a[248:251], v[120:123]
ds_read_b128 v[60:63], v2 offset:19456
s_add_u32 m0, s22, 77824
v_mfma_f32_16x16x32_bf16 v[124:127], v[64:67], a[236:239], v[124:127]
v_add_u32 v3, 4096, v3
v_mfma_f32_16x16x32_bf16 v[124:127], v[68:71], a[252:255], v[124:127]
s_waitcnt lgkmcnt(4)
v_mfma_f32_16x16x32_bf16 v[128:131], v[72:75], a[224:227], v[128:131]
buffer_load_dwordx4 v3, s[8:11], 0 offen offset:0 sc1 lds
v_mfma_f32_16x16x32_bf16 v[128:131], v[76:79], a[240:243], v[128:131]
v_mfma_f32_16x16x32_bf16 v[132:135], v[72:75], a[228:231], v[132:135]
ds_read_b128 v[64:67], v2 offset:20480
v_mfma_f32_16x16x32_bf16 v[132:135], v[76:79], a[244:247], v[132:135]
v_mfma_f32_16x16x32_bf16 v[136:139], v[72:75], a[232:235], v[136:139]
buffer_load_dwordx4 v3, s[8:11], 0 offen offset:1024 sc1 lds
v_mfma_f32_16x16x32_bf16 v[136:139], v[76:79], a[248:251], v[136:139]
ds_read_b128 v[68:71], v2 offset:21504
s_add_u32 m0, s22, 98304
v_mfma_f32_16x16x32_bf16 v[140:143], v[72:75], a[236:239], v[140:143]
v_add_u32 v3, 20480, v3
v_mfma_f32_16x16x32_bf16 v[140:143], v[76:79], a[252:255], v[140:143]
s_waitcnt vmcnt(12)
s_waitcnt lgkmcnt(4)
v_mfma_f32_16x16x32_bf16 v[80:83], v[48:51], v[16:19], v[80:83]
buffer_load_dwordx4 v3, s[8:11], 0 offen offset:0 sc1 lds
v_mfma_f32_16x16x32_bf16 v[80:83], v[52:55], v[32:35], v[80:83]
v_mfma_f32_16x16x32_bf16 v[84:87], v[48:51], v[20:23], v[84:87]
ds_read_b128 v[72:75], v2 offset:22528
v_mfma_f32_16x16x32_bf16 v[84:87], v[52:55], v[36:39], v[84:87]
v_mfma_f32_16x16x32_bf16 v[88:91], v[48:51], v[24:27], v[88:91]
buffer_load_dwordx4 v3, s[8:11], 0 offen offset:1024 sc1 lds
v_mfma_f32_16x16x32_bf16 v[88:91], v[52:55], v[40:43], v[88:91]
ds_read_b128 v[76:79], v2 offset:23552
v_mfma_f32_16x16x32_bf16 v[92:95], v[48:51], v[28:31], v[92:95]
v_mfma_f32_16x16x32_bf16 v[92:95], v[52:55], v[44:47], v[92:95]
s_waitcnt lgkmcnt(4)
v_mfma_f32_16x16x32_bf16 v[96:99], v[56:59], v[16:19], v[96:99]
buffer_load_dwordx4 v3, s[8:11], 0 offen offset:2048 sc1 lds
v_mfma_f32_16x16x32_bf16 v[96:99], v[60:63], v[32:35], v[96:99]
s_barrier
v_mfma_f32_16x16x32_bf16 v[100:103], v[56:59], v[20:23], v[100:103]
ds_read_b128 v[48:51], v2 offset:24576
v_mfma_f32_16x16x32_bf16 v[100:103], v[60:63], v[36:39], v[100:103]
v_mfma_f32_16x16x32_bf16 v[104:107], v[56:59], v[24:27], v[104:107]
buffer_load_dwordx4 v3, s[8:11], 0 offen offset:3072 sc1 lds
v_mfma_f32_16x16x32_bf16 v[104:107], v[60:63], v[40:43], v[104:107]
ds_read_b128 v[52:55], v2 offset:25600
s_add_u32 m0, s22, 102400
v_mfma_f32_16x16x32_bf16 v[108:111], v[56:59], v[28:31], v[108:111]
v_add_u32 v3, 4096, v3
v_mfma_f32_16x16x32_bf16 v[108:111], v[60:63], v[44:47], v[108:111]
s_waitcnt lgkmcnt(4)
v_mfma_f32_16x16x32_bf16 v[112:115], v[64:67], v[16:19], v[112:115]
buffer_load_dwordx4 v3, s[8:11], 0 offen offset:0 sc1 lds
v_mfma_f32_16x16x32_bf16 v[112:115], v[68:71], v[32:35], v[112:115]
v_mfma_f32_16x16x32_bf16 v[116:119], v[64:67], v[20:23], v[116:119]
ds_read_b128 v[56:59], v2 offset:26624
v_mfma_f32_16x16x32_bf16 v[116:119], v[68:71], v[36:39], v[116:119]
v_mfma_f32_16x16x32_bf16 v[120:123], v[64:67], v[24:27], v[120:123]
buffer_load_dwordx4 v3, s[8:11], 0 offen offset:1024 sc1 lds
v_mfma_f32_16x16x32_bf16 v[120:123], v[68:71], v[40:43], v[120:123]
ds_read_b128 v[60:63], v2 offset:27648
s_add_u32 m0, s22, 122880
v_mfma_f32_16x16x32_bf16 v[124:127], v[64:67], v[28:31], v[124:127]
v_add_u32 v3, 20480, v3
v_mfma_f32_16x16x32_bf16 v[124:127], v[68:71], v[44:47], v[124:127]
s_waitcnt lgkmcnt(4)
v_mfma_f32_16x16x32_bf16 v[128:131], v[72:75], v[16:19], v[128:131]
v_mfma_f32_16x16x32_bf16 v[128:131], v[76:79], v[32:35], v[128:131]
buffer_load_dwordx4 v3, s[8:11], 0 offen offset:0 sc1 lds
v_mfma_f32_16x16x32_bf16 v[132:135], v[72:75], v[20:23], v[132:135]
ds_read_b128 v[64:67], v2 offset:28672
v_mfma_f32_16x16x32_bf16 v[132:135], v[76:79], v[36:39], v[132:135]
v_mfma_f32_16x16x32_bf16 v[136:139], v[72:75], v[24:27], v[136:139]
v_mfma_f32_16x16x32_bf16 v[136:139], v[76:79], v[40:43], v[136:139]
ds_read_b128 v[68:71], v2 offset:29696
v_mfma_f32_16x16x32_bf16 v[140:143], v[72:75], v[28:31], v[140:143]
buffer_load_dwordx4 v3, s[8:11], 0 offen offset:1024 sc1 lds
v_mfma_f32_16x16x32_bf16 v[140:143], v[76:79], v[44:47], v[140:143]
s_waitcnt lgkmcnt(4)
v_mfma_f32_16x16x32_bf16 v[176:179], v[48:51], a[0:3], 0
v_mfma_f32_16x16x32_bf16 v[176:179], v[52:55], a[16:19], v[176:179]
v_mfma_f32_16x16x32_bf16 v[180:183], v[48:51], a[4:7], 0
ds_read_b128 v[72:75], v2 offset:30720
v_mfma_f32_16x16x32_bf16 v[180:183], v[52:55], a[20:23], v[180:183]
buffer_load_dwordx4 v3, s[8:11], 0 offen offset:2048 sc1 lds
v_mfma_f32_16x16x32_bf16 v[184:187], v[48:51], a[8:11], 0
v_mul_f32 v208, v80, v80
v_mul_f32 v210, v81, v81
v_mfma_f32_16x16x32_bf16 v[184:187], v[52:55], a[24:27], v[184:187]
ds_read_b128 v[76:79], v2 offset:31744
v_fma_f32 v208, v208, v233, v232
v_mfma_f32_16x16x32_bf16 v[188:191], v[48:51], a[12:15], 0
v_fma_f32 v210, v210, v233, v232
v_mul_f32 v208, v208, v80
v_mfma_f32_16x16x32_bf16 v[188:191], v[52:55], a[28:31], v[188:191]
v_mul_f32 v210, v210, v81
s_waitcnt lgkmcnt(4)
v_mfma_f32_16x16x32_bf16 v[192:195], v[56:59], a[0:3], 0
buffer_load_dwordx4 v3, s[8:11], 0 offen offset:3072 sc1 lds
v_mfma_f32_16x16x32_bf16 v[192:195], v[60:63], a[16:19], v[192:195]
s_add_u32 m0, s22, 126976
v_add_u32 v3, 4096, v3
v_mfma_f32_16x16x32_bf16 v[196:199], v[56:59], a[4:7], 0
ds_read_b128 v[48:51], v2 offset:32768
v_mul_f32 v209, v80, v96
v_mfma_f32_16x16x32_bf16 v[196:199], v[60:63], a[20:23], v[196:199]
v_exp_f32 v208, v208
v_mfma_f32_16x16x32_bf16 v[200:203], v[56:59], a[8:11], 0
v_exp_f32 v210, v210
v_mfma_f32_16x16x32_bf16 v[200:203], v[60:63], a[24:27], v[200:203]
ds_read_b128 v[52:55], v2 offset:33792
v_mul_f32 v211, v81, v97
v_mfma_f32_16x16x32_bf16 v[204:207], v[56:59], a[12:15], 0
buffer_load_dwordx4 v3, s[8:11], 0 offen offset:0 sc1 lds
v_mfma_f32_16x16x32_bf16 v[204:207], v[60:63], a[28:31], v[204:207]
v_fma_f32 v208, v208, v234, v234
s_waitcnt lgkmcnt(4)
v_mfma_f32_16x16x32_bf16 v[176:179], v[64:67], a[32:35], v[176:179]
v_fma_f32 v210, v210, v234, v234
v_mul_f32 v212, v82, v82
v_mfma_f32_16x16x32_bf16 v[176:179], v[68:71], a[48:51], v[176:179]
v_rcp_f32 v208, v208
v_mfma_f32_16x16x32_bf16 v[180:183], v[64:67], a[36:39], v[180:183]
ds_read_b128 v[56:59], v2 offset:34816
v_mul_f32 v209, v209, v208
v_mfma_f32_16x16x32_bf16 v[180:183], v[68:71], a[52:55], v[180:183]
buffer_load_dwordx4 v3, s[8:11], 0 offen offset:1024 sc1 lds
v_mfma_f32_16x16x32_bf16 v[184:187], v[64:67], a[40:43], v[184:187]
v_rcp_f32 v210, v210
v_mfma_f32_16x16x32_bf16 v[184:187], v[68:71], a[56:59], v[184:187]
ds_read_b128 v[60:63], v2 offset:35840
v_mul_f32 v211, v211, v210
v_mfma_f32_16x16x32_bf16 v[188:191], v[64:67], a[44:47], v[188:191]
v_cvt_pk_bf16_f32 v224, v209, v211
v_mul_f32 v214, v83, v83
v_mfma_f32_16x16x32_bf16 v[188:191], v[68:71], a[60:63], v[188:191]
v_fma_f32 v212, v212, v233, v232
s_waitcnt lgkmcnt(4)
v_mfma_f32_16x16x32_bf16 v[192:195], v[72:75], a[32:35], v[192:195]
v_fma_f32 v214, v214, v233, v232
v_mul_f32 v212, v212, v82
v_mfma_f32_16x16x32_bf16 v[192:195], v[76:79], a[48:51], v[192:195]
v_mul_f32 v214, v214, v83
v_mul_f32 v213, v82, v98
v_mfma_f32_16x16x32_bf16 v[196:199], v[72:75], a[36:39], v[196:199]
ds_read_b128 v[64:67], v2 offset:36864
v_mul_f32 v215, v83, v99
v_mfma_f32_16x16x32_bf16 v[196:199], v[76:79], a[52:55], v[196:199]
v_exp_f32 v212, v212
v_mfma_f32_16x16x32_bf16 v[200:203], v[72:75], a[40:43], v[200:203]
v_exp_f32 v214, v214
v_mfma_f32_16x16x32_bf16 v[200:203], v[76:79], a[56:59], v[200:203]
ds_read_b128 v[68:71], v2 offset:37888
v_fma_f32 v212, v212, v234, v234
v_mfma_f32_16x16x32_bf16 v[204:207], v[72:75], a[44:47], v[204:207]
v_fma_f32 v214, v214, v234, v234
v_mul_f32 v208, v84, v84
v_mfma_f32_16x16x32_bf16 v[204:207], v[76:79], a[60:63], v[204:207]
v_mul_f32 v210, v85, v85
s_waitcnt lgkmcnt(4)
v_mfma_f32_16x16x32_bf16 v[176:179], v[48:51], a[64:67], v[176:179]
v_rcp_f32 v212, v212
v_mfma_f32_16x16x32_bf16 v[176:179], v[52:55], a[80:83], v[176:179]
v_rcp_f32 v214, v214
v_mfma_f32_16x16x32_bf16 v[180:183], v[48:51], a[68:71], v[180:183]
ds_read_b128 v[72:75], v2 offset:38912
v_mul_f32 v213, v213, v212
v_mfma_f32_16x16x32_bf16 v[180:183], v[52:55], a[84:87], v[180:183]
v_mul_f32 v215, v215, v214
v_cvt_pk_bf16_f32 v225, v213, v215
v_mfma_f32_16x16x32_bf16 v[184:187], v[48:51], a[72:75], v[184:187]
buffer_store_dwordx2 v[224:225], v248, s[8:11], s30 offen sc1
v_mfma_f32_16x16x32_bf16 v[184:187], v[52:55], a[88:91], v[184:187]
ds_read_b128 v[76:79], v2 offset:39936
v_fma_f32 v208, v208, v237, v236
v_mfma_f32_16x16x32_bf16 v[188:191], v[48:51], a[76:79], v[188:191]
v_fma_f32 v210, v210, v237, v236
v_mul_f32 v208, v208, v84
v_mfma_f32_16x16x32_bf16 v[188:191], v[52:55], a[92:95], v[188:191]
v_mul_f32 v210, v210, v85
s_waitcnt lgkmcnt(4)
v_mfma_f32_16x16x32_bf16 v[192:195], v[56:59], a[64:67], v[192:195]
v_exp_f32 v208, v208
v_mfma_f32_16x16x32_bf16 v[192:195], v[60:63], a[80:83], v[192:195]
v_exp_f32 v210, v210
v_mfma_f32_16x16x32_bf16 v[196:199], v[56:59], a[68:71], v[196:199]
ds_read_b128 v[48:51], v2 offset:40960
v_mul_f32 v209, v84, v100
v_mfma_f32_16x16x32_bf16 v[196:199], v[60:63], a[84:87], v[196:199]
v_mul_f32 v211, v85, v101
v_fma_f32 v208, v208, v238, v238
v_mfma_f32_16x16x32_bf16 v[200:203], v[56:59], a[72:75], v[200:203]
v_fma_f32 v210, v210, v238, v238
v_mul_f32 v212, v86, v86
v_mfma_f32_16x16x32_bf16 v[200:203], v[60:63], a[88:91], v[200:203]
ds_read_b128 v[52:55], v2 offset:41984
v_mul_f32 v214, v87, v87
v_mfma_f32_16x16x32_bf16 v[204:207], v[56:59], a[76:79], v[204:207]
v_rcp_f32 v208, v208
v_mfma_f32_16x16x32_bf16 v[204:207], v[60:63], a[92:95], v[204:207]
v_mul_f32 v209, v209, v208
s_waitcnt lgkmcnt(4)
v_mfma_f32_16x16x32_bf16 v[176:179], v[64:67], a[96:99], v[176:179]
v_rcp_f32 v210, v210
v_mfma_f32_16x16x32_bf16 v[176:179], v[68:71], a[112:115], v[176:179]
v_mul_f32 v211, v211, v210
v_cvt_pk_bf16_f32 v226, v209, v211
v_mfma_f32_16x16x32_bf16 v[180:183], v[64:67], a[100:103], v[180:183]
ds_read_b128 v[56:59], v2 offset:43008
v_fma_f32 v212, v212, v237, v236
v_mfma_f32_16x16x32_bf16 v[180:183], v[68:71], a[116:119], v[180:183]
v_fma_f32 v214, v214, v237, v236
v_mul_f32 v212, v212, v86
v_mfma_f32_16x16x32_bf16 v[184:187], v[64:67], a[104:107], v[184:187]
v_mul_f32 v214, v214, v87
v_mul_f32 v213, v86, v102
v_mfma_f32_16x16x32_bf16 v[184:187], v[68:71], a[120:123], v[184:187]
ds_read_b128 v[60:63], v2 offset:44032
v_mul_f32 v215, v87, v103
v_mfma_f32_16x16x32_bf16 v[188:191], v[64:67], a[108:111], v[188:191]
v_exp_f32 v212, v212
v_mfma_f32_16x16x32_bf16 v[188:191], v[68:71], a[124:127], v[188:191]
v_fma_f32 v212, v212, v238, v238
s_waitcnt lgkmcnt(4)
v_mfma_f32_16x16x32_bf16 v[192:195], v[72:75], a[96:99], v[192:195]
v_exp_f32 v214, v214
v_mfma_f32_16x16x32_bf16 v[192:195], v[76:79], a[112:115], v[192:195]
v_fma_f32 v214, v214, v238, v238
v_mul_f32 v208, v88, v88
v_mfma_f32_16x16x32_bf16 v[196:199], v[72:75], a[100:103], v[196:199]
ds_read_b128 v[64:67], v2 offset:45056
v_mul_f32 v210, v89, v89
v_mfma_f32_16x16x32_bf16 v[196:199], v[76:79], a[116:119], v[196:199]
v_rcp_f32 v212, v212
v_mfma_f32_16x16x32_bf16 v[200:203], v[72:75], a[104:107], v[200:203]
v_rcp_f32 v214, v214
v_mfma_f32_16x16x32_bf16 v[200:203], v[76:79], a[120:123], v[200:203]
ds_read_b128 v[68:71], v2 offset:46080
v_mul_f32 v213, v213, v212
v_mfma_f32_16x16x32_bf16 v[204:207], v[72:75], a[108:111], v[204:207]
v_mul_f32 v215, v215, v214
v_cvt_pk_bf16_f32 v227, v213, v215
v_mfma_f32_16x16x32_bf16 v[204:207], v[76:79], a[124:127], v[204:207]
v_fma_f32 v208, v208, v241, v240
s_waitcnt lgkmcnt(4)
v_mfma_f32_16x16x32_bf16 v[176:179], v[48:51], a[128:131], v[176:179]
buffer_store_dwordx2 v[226:227], v249, s[8:11], s30 offen sc1
v_mfma_f32_16x16x32_bf16 v[176:179], v[52:55], a[144:147], v[176:179]
v_fma_f32 v210, v210, v241, v240
v_mul_f32 v208, v208, v88
v_mfma_f32_16x16x32_bf16 v[180:183], v[48:51], a[132:135], v[180:183]
ds_read_b128 v[72:75], v2 offset:47104
v_mul_f32 v210, v210, v89
v_mfma_f32_16x16x32_bf16 v[180:183], v[52:55], a[148:151], v[180:183]
v_exp_f32 v208, v208
v_mfma_f32_16x16x32_bf16 v[184:187], v[48:51], a[136:139], v[184:187]
v_exp_f32 v210, v210
v_mfma_f32_16x16x32_bf16 v[184:187], v[52:55], a[152:155], v[184:187]
ds_read_b128 v[76:79], v2 offset:48128
v_mul_f32 v209, v88, v104
v_mfma_f32_16x16x32_bf16 v[188:191], v[48:51], a[140:143], v[188:191]
v_mul_f32 v211, v89, v105
v_fma_f32 v208, v208, v242, v242
v_mfma_f32_16x16x32_bf16 v[188:191], v[52:55], a[156:159], v[188:191]
v_fma_f32 v210, v210, v242, v242
s_waitcnt lgkmcnt(4)
v_mfma_f32_16x16x32_bf16 v[192:195], v[56:59], a[128:131], v[192:195]
s_waitcnt vmcnt(20)
v_mul_f32 v212, v90, v90
v_mfma_f32_16x16x32_bf16 v[192:195], v[60:63], a[144:147], v[192:195]
s_barrier
v_mfma_f32_16x16x32_bf16 v[196:199], v[56:59], a[132:135], v[196:199]
ds_read_b128 v[48:51], v2 offset:49152
s_add_u32 m0, s22, 0
v_mfma_f32_16x16x32_bf16 v[196:199], v[60:63], a[148:151], v[196:199]
v_add_u32 v3, 20480, v3
buffer_load_dwordx4 v3, s[8:11], 0 offen offset:0 sc1 lds
v_mfma_f32_16x16x32_bf16 v[200:203], v[56:59], a[136:139], v[200:203]
v_rcp_f32 v208, v208
v_mfma_f32_16x16x32_bf16 v[200:203], v[60:63], a[152:155], v[200:203]
ds_read_b128 v[52:55], v2 offset:50176
v_mul_f32 v209, v209, v208
v_mfma_f32_16x16x32_bf16 v[204:207], v[56:59], a[140:143], v[204:207]
v_rcp_f32 v210, v210
v_mfma_f32_16x16x32_bf16 v[204:207], v[60:63], a[156:159], v[204:207]
v_mul_f32 v211, v211, v210
s_waitcnt lgkmcnt(4)
v_mfma_f32_16x16x32_bf16 v[176:179], v[64:67], a[160:163], v[176:179]
buffer_load_dwordx4 v3, s[8:11], 0 offen offset:1024 sc1 lds
v_mfma_f32_16x16x32_bf16 v[176:179], v[68:71], a[176:179], v[176:179]
v_cvt_pk_bf16_f32 v228, v209, v211
v_mul_f32 v214, v91, v91
v_mfma_f32_16x16x32_bf16 v[180:183], v[64:67], a[164:167], v[180:183]
ds_read_b128 v[56:59], v2 offset:51200
v_fma_f32 v212, v212, v241, v240
v_mfma_f32_16x16x32_bf16 v[180:183], v[68:71], a[180:183], v[180:183]
v_fma_f32 v214, v214, v241, v240
v_mul_f32 v212, v212, v90
v_mfma_f32_16x16x32_bf16 v[184:187], v[64:67], a[168:171], v[184:187]
v_mul_f32 v214, v214, v91
v_mul_f32 v213, v90, v106
v_mfma_f32_16x16x32_bf16 v[184:187], v[68:71], a[184:187], v[184:187]
ds_read_b128 v[60:63], v2 offset:52224
v_mul_f32 v215, v91, v107
v_mfma_f32_16x16x32_bf16 v[188:191], v[64:67], a[172:175], v[188:191]
buffer_load_dwordx4 v3, s[8:11], 0 offen offset:2048 sc1 lds
v_mfma_f32_16x16x32_bf16 v[188:191], v[68:71], a[188:191], v[188:191]
v_mul_f32 v208, v92, v92
s_waitcnt lgkmcnt(4)
v_mfma_f32_16x16x32_bf16 v[192:195], v[72:75], a[160:163], v[192:195]
v_exp_f32 v212, v212
v_mfma_f32_16x16x32_bf16 v[192:195], v[76:79], a[176:179], v[192:195]
v_exp_f32 v214, v214
v_mfma_f32_16x16x32_bf16 v[196:199], v[72:75], a[164:167], v[196:199]
ds_read_b128 v[64:67], v2 offset:53248
v_fma_f32 v212, v212, v242, v242
v_mfma_f32_16x16x32_bf16 v[196:199], v[76:79], a[180:183], v[196:199]
buffer_load_dwordx4 v3, s[8:11], 0 offen offset:3072 sc1 lds
v_mfma_f32_16x16x32_bf16 v[200:203], v[72:75], a[168:171], v[200:203]
s_add_u32 m0, s22, 4096
v_add_u32 v3, 4096, v3
v_mfma_f32_16x16x32_bf16 v[200:203], v[76:79], a[184:187], v[200:203]
ds_read_b128 v[68:71], v2 offset:54272
v_fma_f32 v214, v214, v242, v242
v_mfma_f32_16x16x32_bf16 v[204:207], v[72:75], a[172:175], v[204:207]
v_rcp_f32 v212, v212
v_mfma_f32_16x16x32_bf16 v[204:207], v[76:79], a[188:191], v[204:207]
v_mul_f32 v213, v213, v212
s_waitcnt lgkmcnt(4)
v_mfma_f32_16x16x32_bf16 v[176:179], v[48:51], a[192:195], v[176:179]
buffer_load_dwordx4 v3, s[8:11], 0 offen offset:0 sc1 lds
v_mfma_f32_16x16x32_bf16 v[176:179], v[52:55], a[208:211], v[176:179]
v_rcp_f32 v214, v214
v_mfma_f32_16x16x32_bf16 v[180:183], v[48:51], a[196:199], v[180:183]
ds_read_b128 v[72:75], v2 offset:55296
v_mul_f32 v215, v215, v214
v_mfma_f32_16x16x32_bf16 v[180:183], v[52:55], a[212:215], v[180:183]
v_cvt_pk_bf16_f32 v229, v213, v215
L_hop5:
s_cmp_eq_u32 s15, 1
s_cbranch_scc1 L_hop9
v_mul_f32 v210, v93, v93
v_mfma_f32_16x16x32_bf16 v[184:187], v[48:51], a[200:203], v[184:187]
buffer_store_dwordx2 v[228:229], v250, s[8:11], s30 offen sc1
v_mfma_f32_16x16x32_bf16 v[184:187], v[52:55], a[216:219], v[184:187]
ds_read_b128 v[76:79], v2 offset:56320
v_fma_f32 v208, v208, v245, v244
v_mfma_f32_16x16x32_bf16 v[188:191], v[48:51], a[204:207], v[188:191]
v_fma_f32 v210, v210, v245, v244
v_mul_f32 v208, v208, v92
v_mfma_f32_16x16x32_bf16 v[188:191], v[52:55], a[220:223], v[188:191]
v_mul_f32 v210, v210, v93
s_waitcnt lgkmcnt(4)
v_mfma_f32_16x16x32_bf16 v[192:195], v[56:59], a[192:195], v[192:195]
v_exp_f32 v208, v208
v_mfma_f32_16x16x32_bf16 v[192:195], v[60:63], a[208:211], v[192:195]
buffer_load_dwordx4 v3, s[8:11], 0 offen offset:1024 sc1 lds
v_mfma_f32_16x16x32_bf16 v[196:199], v[56:59], a[196:199], v[196:199]
ds_read_b128 v[48:51], v2 offset:57344
v_mul_f32 v209, v92, v108
v_mfma_f32_16x16x32_bf16 v[196:199], v[60:63], a[212:215], v[196:199]
v_exp_f32 v210, v210
v_mfma_f32_16x16x32_bf16 v[200:203], v[56:59], a[200:203], v[200:203]
v_mul_f32 v211, v93, v109
v_fma_f32 v208, v208, v246, v246
v_mfma_f32_16x16x32_bf16 v[200:203], v[60:63], a[216:219], v[200:203]
ds_read_b128 v[52:55], v2 offset:58368
v_fma_f32 v210, v210, v246, v246
v_mfma_f32_16x16x32_bf16 v[204:207], v[56:59], a[204:207], v[204:207]
v_rcp_f32 v208, v208
v_mfma_f32_16x16x32_bf16 v[204:207], v[60:63], a[220:223], v[204:207]
v_mul_f32 v209, v209, v208
s_waitcnt lgkmcnt(4)
v_mfma_f32_16x16x32_bf16 v[176:179], v[64:67], a[224:227], v[176:179]
v_rcp_f32 v210, v210
v_mfma_f32_16x16x32_bf16 v[176:179], v[68:71], a[240:243], v[176:179]
v_mul_f32 v211, v211, v210
v_cvt_pk_bf16_f32 v230, v209, v211
v_mfma_f32_16x16x32_bf16 v[180:183], v[64:67], a[228:231], v[180:183]
ds_read_b128 v[56:59], v2 offset:59392
v_mul_f32 v212, v94, v94
v_mfma_f32_16x16x32_bf16 v[180:183], v[68:71], a[244:247], v[180:183]
v_mul_f32 v214, v95, v95
v_fma_f32 v212, v212, v245, v244
v_mfma_f32_16x16x32_bf16 v[184:187], v[64:67], a[232:235], v[184:187]
v_fma_f32 v214, v214, v245, v244
v_mul_f32 v212, v212, v94
v_mfma_f32_16x16x32_bf16 v[184:187], v[68:71], a[248:251], v[184:187]
ds_read_b128 v[60:63], v2 offset:60416
v_mul_f32 v214, v214, v95
v_mfma_f32_16x16x32_bf16 v[188:191], v[64:67], a[236:239], v[188:191]
v_exp_f32 v212, v212
v_mfma_f32_16x16x32_bf16 v[188:191], v[68:71], a[252:255], v[188:191]
v_mul_f32 v213, v94, v110
s_waitcnt lgkmcnt(4)
v_mfma_f32_16x16x32_bf16 v[192:195], v[72:75], a[224:227], v[192:195]
v_exp_f32 v214, v214
v_mfma_f32_16x16x32_bf16 v[192:195], v[76:79], a[240:243], v[192:195]
v_mul_f32 v215, v95, v111
v_fma_f32 v212, v212, v246, v246
v_mfma_f32_16x16x32_bf16 v[196:199], v[72:75], a[228:231], v[196:199]
ds_read_b128 v[64:67], v2 offset:61440
v_fma_f32 v214, v214, v246, v246
v_mfma_f32_16x16x32_bf16 v[196:199], v[76:79], a[244:247], v[196:199]
v_rcp_f32 v212, v212
v_mfma_f32_16x16x32_bf16 v[200:203], v[72:75], a[232:235], v[200:203]
v_rcp_f32 v214, v214
v_mfma_f32_16x16x32_bf16 v[200:203], v[76:79], a[248:251], v[200:203]
ds_read_b128 v[68:71], v2 offset:62464
v_mul_f32 v213, v213, v212
v_mfma_f32_16x16x32_bf16 v[204:207], v[72:75], a[236:239], v[204:207]
v_mul_f32 v215, v215, v214
v_cvt_pk_bf16_f32 v231, v213, v215
v_mfma_f32_16x16x32_bf16 v[204:207], v[76:79], a[252:255], v[204:207]
v_mul_f32 v208, v112, v112
s_waitcnt lgkmcnt(4)
v_mfma_f32_16x16x32_bf16 v[176:179], v[48:51], v[16:19], v[176:179]
buffer_store_dwordx2 v[230:231], v251, s[8:11], s30 offen sc1
v_mfma_f32_16x16x32_bf16 v[176:179], v[52:55], v[32:35], v[176:179]
v_mul_f32 v210, v113, v113
v_fma_f32 v208, v208, v233, v232
v_mfma_f32_16x16x32_bf16 v[180:183], v[48:51], v[20:23], v[180:183]
ds_read_b128 v[72:75], v2 offset:63488
v_fma_f32 v210, v210, v233, v232
v_mfma_f32_16x16x32_bf16 v[180:183], v[52:55], v[36:39], v[180:183]
v_mul_f32 v208, v208, v112
v_mul_f32 v210, v210, v113
v_mfma_f32_16x16x32_bf16 v[184:187], v[48:51], v[24:27], v[184:187]
v_exp_f32 v208, v208
v_mfma_f32_16x16x32_bf16 v[184:187], v[52:55], v[40:43], v[184:187]
ds_read_b128 v[76:79], v2 offset:64512
v_mul_f32 v209, v112, v128
v_mfma_f32_16x16x32_bf16 v[188:191], v[48:51], v[28:31], v[188:191]
v_exp_f32 v210, v210
v_mfma_f32_16x16x32_bf16 v[188:191], v[52:55], v[44:47], v[188:191]
v_mul_f32 v211, v113, v129
s_waitcnt lgkmcnt(4)
v_mfma_f32_16x16x32_bf16 v[192:195], v[56:59], v[16:19], v[192:195]
v_fma_f32 v208, v208, v234, v234
v_fma_f32 v210, v210, v234, v234
v_mfma_f32_16x16x32_bf16 v[192:195], v[60:63], v[32:35], v[192:195]
v_rcp_f32 v208, v208
v_mfma_f32_16x16x32_bf16 v[196:199], v[56:59], v[20:23], v[196:199]
ds_read_b128 v[48:51], v7 offset:0
v_mul_f32 v209, v209, v208
v_mfma_f32_16x16x32_bf16 v[196:199], v[60:63], v[36:39], v[196:199]
v_rcp_f32 v210, v210
v_mfma_f32_16x16x32_bf16 v[200:203], v[56:59], v[24:27], v[200:203]
v_mul_f32 v211, v211, v210
v_cvt_pk_bf16_f32 v144, v209, v211
v_mfma_f32_16x16x32_bf16 v[200:203], v[60:63], v[40:43], v[200:203]
ds_read_b128 v[52:55], v7 offset:1024
v_mul_f32 v212, v114, v114
v_mfma_f32_16x16x32_bf16 v[204:207], v[56:59], v[28:31], v[204:207]
v_mul_f32 v214, v115, v115
v_fma_f32 v212, v212, v233, v232
v_mfma_f32_16x16x32_bf16 v[204:207], v[60:63], v[44:47], v[204:207]
v_fma_f32 v214, v214, v233, v232
s_waitcnt lgkmcnt(4)
v_mfma_f32_16x16x32_bf16 v[80:83], v[64:67], a[0:3], 0
v_mul_f32 v212, v212, v114
v_mul_f32 v214, v214, v115
v_mfma_f32_16x16x32_bf16 v[80:83], v[68:71], a[16:19], v[80:83]
v_exp_f32 v212, v212
v_mfma_f32_16x16x32_bf16 v[84:87], v[64:67], a[4:7], 0
ds_read_b128 v[56:59], v7 offset:2048
v_mul_f32 v213, v114, v130
v_mfma_f32_16x16x32_bf16 v[84:87], v[68:71], a[20:23], v[84:87]
v_exp_f32 v214, v214
v_mfma_f32_16x16x32_bf16 v[88:91], v[64:67], a[8:11], 0
v_mul_f32 v215, v115, v131
v_fma_f32 v212, v212, v234, v234
v_mfma_f32_16x16x32_bf16 v[88:91], v[68:71], a[24:27], v[88:91]
ds_read_b128 v[60:63], v7 offset:3072
v_fma_f32 v214, v214, v234, v234
v_mfma_f32_16x16x32_bf16 v[92:95], v[64:67], a[12:15], 0
v_rcp_f32 v212, v212
v_mfma_f32_16x16x32_bf16 v[92:95], v[68:71], a[28:31], v[92:95]
v_mul_f32 v213, v213, v212
s_waitcnt lgkmcnt(4)
v_mfma_f32_16x16x32_bf16 v[96:99], v[72:75], a[0:3], 0
v_rcp_f32 v214, v214
v_mfma_f32_16x16x32_bf16 v[96:99], v[76:79], a[16:19], v[96:99]
v_mul_f32 v215, v215, v214
v_cvt_pk_bf16_f32 v145, v213, v215
v_mfma_f32_16x16x32_bf16 v[100:103], v[72:75], a[4:7], 0
ds_read_b128 v[64:67], v7 offset:4096
v_mul_f32 v208, v116, v116
v_mfma_f32_16x16x32_bf16 v[100:103], v[76:79], a[20:23], v[100:103]
v_mul_f32 v210, v117, v117
v_fma_f32 v208, v208, v237, v236
v_mfma_f32_16x16x32_bf16 v[104:107], v[72:75], a[8:11], 0
v_fma_f32 v210, v210, v237, v236
v_mul_f32 v208, v208, v116
v_mfma_f32_16x16x32_bf16 v[104:107], v[76:79], a[24:27], v[104:107]
ds_read_b128 v[68:71], v7 offset:5120
v_mul_f32 v210, v210, v117
v_mfma_f32_16x16x32_bf16 v[108:111], v[72:75], a[12:15], 0
v_exp_f32 v208, v208
v_mfma_f32_16x16x32_bf16 v[108:111], v[76:79], a[28:31], v[108:111]
v_mul_f32 v209, v116, v132
s_waitcnt lgkmcnt(4)
v_mfma_f32_16x16x32_bf16 v[80:83], v[48:51], a[32:35], v[80:83]
v_exp_f32 v210, v210
v_mfma_f32_16x16x32_bf16 v[80:83], v[52:55], a[48:51], v[80:83]
v_mul_f32 v211, v117, v133
v_fma_f32 v208, v208, v238, v238
v_mfma_f32_16x16x32_bf16 v[84:87], v[48:51], a[36:39], v[84:87]
ds_read_b128 v[72:75], v7 offset:6144
v_fma_f32 v210, v210, v238, v238
v_mfma_f32_16x16x32_bf16 v[84:87], v[52:55], a[52:55], v[84:87]
v_rcp_f32 v208, v208
v_mfma_f32_16x16x32_bf16 v[88:91], v[48:51], a[40:43], v[88:91]
v_rcp_f32 v210, v210
v_mfma_f32_16x16x32_bf16 v[88:91], v[52:55], a[56:59], v[88:91]
ds_read_b128 v[76:79], v7 offset:7168
v_mul_f32 v209, v209, v208
v_mfma_f32_16x16x32_bf16 v[92:95], v[48:51], a[44:47], v[92:95]
v_mul_f32 v211, v211, v210
v_cvt_pk_bf16_f32 v148, v209, v211
v_mfma_f32_16x16x32_bf16 v[92:95], v[52:55], a[60:63], v[92:95]
v_mul_f32 v212, v118, v118
s_waitcnt lgkmcnt(4)
v_mfma_f32_16x16x32_bf16 v[96:99], v[56:59], a[32:35], v[96:99]
s_waitcnt vmcnt(22)
v_mul_f32 v214, v119, v119
v_mfma_f32_16x16x32_bf16 v[96:99], v[60:63], a[48:51], v[96:99]
s_barrier
v_mfma_f32_16x16x32_bf16 v[100:103], v[56:59], a[36:39], v[100:103]
ds_read_b128 v[48:51], v7 offset:8192
s_add_u32 m0, s22, 24576
v_mfma_f32_16x16x32_bf16 v[100:103], v[60:63], a[52:55], v[100:103]
v_add_u32 v3, 20480, v3
buffer_load_dwordx4 v3, s[8:11], 0 offen offset:0 sc1 lds
v_mfma_f32_16x16x32_bf16 v[104:107], v[56:59], a[40:43], v[104:107]
v_fma_f32 v212, v212, v237, v236
v_fma_f32 v214, v214, v237, v236
v_mfma_f32_16x16x32_bf16 v[104:107], v[60:63], a[56:59], v[104:107]
ds_read_b128 v[52:55], v7 offset:9216
v_mul_f32 v212, v212, v118
v_mfma_f32_16x16x32_bf16 v[108:111], v[56:59], a[44:47], v[108:111]
v_mul_f32 v214, v214, v119
v_mul_f32 v213, v118, v134
v_mfma_f32_16x16x32_bf16 v[108:111], v[60:63], a[60:63], v[108:111]
v_mul_f32 v215, v119, v135
s_waitcnt lgkmcnt(4)
v_mfma_f32_16x16x32_bf16 v[80:83], v[64:67], a[64:67], v[80:83]
buffer_load_dwordx4 v3, s[8:11], 0 offen offset:1024 sc1 lds
v_mfma_f32_16x16x32_bf16 v[80:83], v[68:71], a[80:83], v[80:83]
v_exp_f32 v212, v212
v_mfma_f32_16x16x32_bf16 v[84:87], v[64:67], a[68:71], v[84:87]
ds_read_b128 v[56:59], v7 offset:10240
v_fma_f32 v212, v212, v238, v238
v_mfma_f32_16x16x32_bf16 v[84:87], v[68:71], a[84:87], v[84:87]
v_exp_f32 v214, v214
v_mfma_f32_16x16x32_bf16 v[88:91], v[64:67], a[72:75], v[88:91]
v_fma_f32 v214, v214, v238, v238
v_mul_f32 v208, v120, v120
v_mfma_f32_16x16x32_bf16 v[88:91], v[68:71], a[88:91], v[88:91]
ds_read_b128 v[60:63], v7 offset:11264
v_mul_f32 v210, v121, v121
v_mfma_f32_16x16x32_bf16 v[92:95], v[64:67], a[76:79], v[92:95]
buffer_load_dwordx4 v3, s[8:11], 0 offen offset:2048 sc1 lds
v_mfma_f32_16x16x32_bf16 v[92:95], v[68:71], a[92:95], v[92:95]
v_fma_f32 v208, v208, v241, v240
s_waitcnt lgkmcnt(4)
v_mfma_f32_16x16x32_bf16 v[96:99], v[72:75], a[64:67], v[96:99]
v_rcp_f32 v212, v212
v_mfma_f32_16x16x32_bf16 v[96:99], v[76:79], a[80:83], v[96:99]
v_rcp_f32 v214, v214
v_mfma_f32_16x16x32_bf16 v[100:103], v[72:75], a[68:71], v[100:103]
ds_read_b128 v[64:67], v7 offset:12288
v_mul_f32 v213, v213, v212
v_mfma_f32_16x16x32_bf16 v[100:103], v[76:79], a[84:87], v[100:103]
buffer_load_dwordx4 v3, s[8:11], 0 offen offset:3072 sc1 lds
v_mfma_f32_16x16x32_bf16 v[104:107], v[72:75], a[72:75], v[104:107]
s_add_u32 m0, s22, 28672
v_add_u32 v3, 4096, v3
v_mfma_f32_16x16x32_bf16 v[104:107], v[76:79], a[88:91], v[104:107]
ds_read_b128 v[68:71], v7 offset:13312
v_mul_f32 v215, v215, v214
v_mfma_f32_16x16x32_bf16 v[108:111], v[72:75], a[76:79], v[108:111]
v_cvt_pk_bf16_f32 v149, v213, v215
v_fma_f32 v210, v210, v241, v240
v_mfma_f32_16x16x32_bf16 v[108:111], v[76:79], a[92:95], v[108:111]
v_mul_f32 v208, v208, v120
s_waitcnt lgkmcnt(4)
v_mfma_f32_16x16x32_bf16 v[80:83], v[48:51], a[96:99], v[80:83]
buffer_load_dwordx4 v3, s[8:11], 0 offen offset:0 sc1 lds
v_mfma_f32_16x16x32_bf16 v[80:83], v[52:55], a[112:115], v[80:83]
v_mul_f32 v210, v210, v121
v_mul_f32 v209, v120, v136
v_mfma_f32_16x16x32_bf16 v[84:87], v[48:51], a[100:103], v[84:87]
ds_read_b128 v[72:75], v7 offset:14336
v_mul_f32 v211, v121, v137
v_mfma_f32_16x16x32_bf16 v[84:87], v[52:55], a[116:119], v[84:87]
v_exp_f32 v208, v208
v_mfma_f32_16x16x32_bf16 v[88:91], v[48:51], a[104:107], v[88:91]
v_exp_f32 v210, v210
v_mfma_f32_16x16x32_bf16 v[88:91], v[52:55], a[120:123], v[88:91]
ds_read_b128 v[76:79], v7 offset:15360
v_fma_f32 v208, v208, v242, v242
v_mfma_f32_16x16x32_bf16 v[92:95], v[48:51], a[108:111], v[92:95]
buffer_load_dwordx4 v3, s[8:11], 0 offen offset:1024 sc1 lds
v_mfma_f32_16x16x32_bf16 v[92:95], v[52:55], a[124:127], v[92:95]
v_fma_f32 v210, v210, v242, v242
s_waitcnt lgkmcnt(4)
v_mfma_f32_16x16x32_bf16 v[96:99], v[56:59], a[96:99], v[96:99]
v_rcp_f32 v208, v208
v_mfma_f32_16x16x32_bf16 v[96:99], v[60:63], a[112:115], v[96:99]
v_rcp_f32 v210, v210
v_mfma_f32_16x16x32_bf16 v[100:103], v[56:59], a[100:103], v[100:103]
ds_read_b128 v[48:51], v7 offset:16384
v_mul_f32 v209, v209, v208
v_mfma_f32_16x16x32_bf16 v[100:103], v[60:63], a[116:119], v[100:103]
v_mul_f32 v211, v211, v210
v_cvt_pk_bf16_f32 v152, v209, v211
v_mfma_f32_16x16x32_bf16 v[104:107], v[56:59], a[104:107], v[104:107]
v_mul_f32 v212, v122, v122
v_mul_f32 v214, v123, v123
v_mfma_f32_16x16x32_bf16 v[104:107], v[60:63], a[120:123], v[104:107]
ds_read_b128 v[52:55], v7 offset:17408
v_fma_f32 v212, v212, v241, v240
v_mfma_f32_16x16x32_bf16 v[108:111], v[56:59], a[108:111], v[108:111]
v_fma_f32 v214, v214, v241, v240
v_mul_f32 v212, v212, v122
v_mfma_f32_16x16x32_bf16 v[108:111], v[60:63], a[124:127], v[108:111]
v_mul_f32 v214, v214, v123
s_waitcnt lgkmcnt(4)
v_mfma_f32_16x16x32_bf16 v[80:83], v[64:67], a[128:131], v[80:83]
v_exp_f32 v212, v212
v_mfma_f32_16x16x32_bf16 v[80:83], v[68:71], a[144:147], v[80:83]
v_exp_f32 v214, v214
v_mfma_f32_16x16x32_bf16 v[84:87], v[64:67], a[132:135], v[84:87]
ds_read_b128 v[56:59], v7 offset:18432
v_mul_f32 v213, v122, v138
v_mfma_f32_16x16x32_bf16 v[84:87], v[68:71], a[148:151], v[84:87]
v_mul_f32 v215, v123, v139
v_fma_f32 v212, v212, v242, v242
v_mfma_f32_16x16x32_bf16 v[88:91], v[64:67], a[136:139], v[88:91]
v_fma_f32 v214, v214, v242, v242
v_mul_f32 v208, v124, v124
v_mfma_f32_16x16x32_bf16 v[88:91], v[68:71], a[152:155], v[88:91]
ds_read_b128 v[60:63], v7 offset:19456
v_mul_f32 v210, v125, v125
v_mfma_f32_16x16x32_bf16 v[92:95], v[64:67], a[140:143], v[92:95]
v_rcp_f32 v212, v212
v_mfma_f32_16x16x32_bf16 v[92:95], v[68:71], a[156:159], v[92:95]
v_mul_f32 v213, v213, v212
s_waitcnt lgkmcnt(4)
v_mfma_f32_16x16x32_bf16 v[96:99], v[72:75], a[128:131], v[96:99]
v_rcp_f32 v214, v214
v_mfma_f32_16x16x32_bf16 v[96:99], v[76:79], a[144:147], v[96:99]
v_mul_f32 v215, v215, v214
v_cvt_pk_bf16_f32 v153, v213, v215
v_mfma_f32_16x16x32_bf16 v[100:103], v[72:75], a[132:135], v[100:103]
ds_read_b128 v[64:67], v7 offset:20480
v_fma_f32 v208, v208, v245, v244
v_mfma_f32_16x16x32_bf16 v[100:103], v[76:79], a[148:151], v[100:103]
v_fma_f32 v210, v210, v245, v244
v_mul_f32 v208, v208, v124
v_mfma_f32_16x16x32_bf16 v[104:107], v[72:75], a[136:139], v[104:107]
v_mul_f32 v210, v210, v125
v_mul_f32 v209, v124, v140
v_mfma_f32_16x16x32_bf16 v[104:107], v[76:79], a[152:155], v[104:107]
ds_read_b128 v[68:71], v7 offset:21504
v_mul_f32 v211, v125, v141
v_mfma_f32_16x16x32_bf16 v[108:111], v[72:75], a[140:143], v[108:111]
v_exp_f32 v208, v208
v_mfma_f32_16x16x32_bf16 v[108:111], v[76:79], a[156:159], v[108:111]
v_fma_f32 v208, v208, v246, v246
s_waitcnt lgkmcnt(4)
v_mfma_f32_16x16x32_bf16 v[80:83], v[48:51], a[160:163], v[80:83]
v_exp_f32 v210, v210
v_mfma_f32_16x16x32_bf16 v[80:83], v[52:55], a[176:179], v[80:83]
v_fma_f32 v210, v210, v246, v246
v_mul_f32 v212, v126, v126
v_mfma_f32_16x16x32_bf16 v[84:87], v[48:51], a[164:167], v[84:87]
ds_read_b128 v[72:75], v7 offset:22528
v_mul_f32 v214, v127, v127
v_mfma_f32_16x16x32_bf16 v[84:87], v[52:55], a[180:183], v[84:87]
v_rcp_f32 v208, v208
v_mfma_f32_16x16x32_bf16 v[88:91], v[48:51], a[168:171], v[88:91]
v_rcp_f32 v210, v210
v_mfma_f32_16x16x32_bf16 v[88:91], v[52:55], a[184:187], v[88:91]
ds_read_b128 v[76:79], v7 offset:23552
v_mul_f32 v209, v209, v208
v_mfma_f32_16x16x32_bf16 v[92:95], v[48:51], a[172:175], v[92:95]
v_mul_f32 v211, v211, v210
v_cvt_pk_bf16_f32 v156, v209, v211
v_mfma_f32_16x16x32_bf16 v[92:95], v[52:55], a[188:191], v[92:95]
v_fma_f32 v212, v212, v245, v244
s_waitcnt lgkmcnt(4)
v_mfma_f32_16x16x32_bf16 v[96:99], v[56:59], a[160:163], v[96:99]
v_fma_f32 v214, v214, v245, v244
v_mul_f32 v212, v212, v126
v_mfma_f32_16x16x32_bf16 v[96:99], v[60:63], a[176:179], v[96:99]
v_mul_f32 v214, v214, v127
v_mul_f32 v213, v126, v142
v_mfma_f32_16x16x32_bf16 v[100:103], v[56:59], a[164:167], v[100:103]
ds_read_b128 v[48:51], v7 offset:24576
v_mul_f32 v215, v127, v143
v_mfma_f32_16x16x32_bf16 v[100:103], v[60:63], a[180:183], v[100:103]
v_exp_f32 v212, v212
v_mfma_f32_16x16x32_bf16 v[104:107], v[56:59], a[168:171], v[104:107]
v_exp_f32 v214, v214
v_mfma_f32_16x16x32_bf16 v[104:107], v[60:63], a[184:187], v[104:107]
ds_read_b128 v[52:55], v7 offset:25600
v_fma_f32 v212, v212, v246, v246
v_mfma_f32_16x16x32_bf16 v[108:111], v[56:59], a[172:175], v[108:111]
v_fma_f32 v214, v214, v246, v246
v_mul_f32 v216, v176, v176
v_mfma_f32_16x16x32_bf16 v[108:111], v[60:63], a[188:191], v[108:111]
v_mul_f32 v218, v177, v177
s_waitcnt lgkmcnt(4)
v_mfma_f32_16x16x32_bf16 v[80:83], v[64:67], a[192:195], v[80:83]
v_rcp_f32 v212, v212
v_mfma_f32_16x16x32_bf16 v[80:83], v[68:71], a[208:211], v[80:83]
v_rcp_f32 v214, v214
v_mfma_f32_16x16x32_bf16 v[84:87], v[64:67], a[196:199], v[84:87]
ds_read_b128 v[56:59], v7 offset:26624
v_mul_f32 v213, v213, v212
v_mfma_f32_16x16x32_bf16 v[84:87], v[68:71], a[212:215], v[84:87]
v_mul_f32 v215, v215, v214
v_cvt_pk_bf16_f32 v157, v213, v215
v_mfma_f32_16x16x32_bf16 v[88:91], v[64:67], a[200:203], v[88:91]
v_fma_f32 v216, v216, v233, v232
v_fma_f32 v218, v218, v233, v232
v_mfma_f32_16x16x32_bf16 v[88:91], v[68:71], a[216:219], v[88:91]
ds_read_b128 v[60:63], v7 offset:27648
v_mul_f32 v216, v216, v176
v_mfma_f32_16x16x32_bf16 v[92:95], v[64:67], a[204:207], v[92:95]
v_mul_f32 v218, v218, v177
v_mul_f32 v217, v176, v192
v_mfma_f32_16x16x32_bf16 v[92:95], v[68:71], a[220:223], v[92:95]
v_mul_f32 v219, v177, v193
s_waitcnt lgkmcnt(4)
v_mfma_f32_16x16x32_bf16 v[96:99], v[72:75], a[192:195], v[96:99]
v_exp_f32 v216, v216
v_mfma_f32_16x16x32_bf16 v[96:99], v[76:79], a[208:211], v[96:99]
v_exp_f32 v218, v218
v_mfma_f32_16x16x32_bf16 v[100:103], v[72:75], a[196:199], v[100:103]
ds_read_b128 v[64:67], v7 offset:28672
v_fma_f32 v216, v216, v234, v234
v_mfma_f32_16x16x32_bf16 v[100:103], v[76:79], a[212:215], v[100:103]
v_fma_f32 v218, v218, v234, v234
v_mul_f32 v220, v178, v178
v_mfma_f32_16x16x32_bf16 v[104:107], v[72:75], a[200:203], v[104:107]
v_rcp_f32 v216, v216
v_mfma_f32_16x16x32_bf16 v[104:107], v[76:79], a[216:219], v[104:107]
ds_read_b128 v[68:71], v7 offset:29696
v_mul_f32 v217, v217, v216
v_mfma_f32_16x16x32_bf16 v[108:111], v[72:75], a[204:207], v[108:111]
v_rcp_f32 v218, v218
v_mfma_f32_16x16x32_bf16 v[108:111], v[76:79], a[220:223], v[108:111]
v_mul_f32 v219, v219, v218
s_waitcnt lgkmcnt(4)
v_mfma_f32_16x16x32_bf16 v[80:83], v[48:51], a[224:227], v[80:83]
v_cvt_pk_bf16_f32 v146, v217, v219
v_mul_f32 v222, v179, v179
v_mfma_f32_16x16x32_bf16 v[80:83], v[52:55], a[240:243], v[80:83]
v_fma_f32 v220, v220, v233, v232
v_fma_f32 v222, v222, v233, v232
v_mfma_f32_16x16x32_bf16 v[84:87], v[48:51], a[228:231], v[84:87]
ds_read_b128 v[72:75], v7 offset:30720
v_mul_f32 v220, v220, v178
v_mfma_f32_16x16x32_bf16 v[84:87], v[52:55], a[244:247], v[84:87]
v_mul_f32 v222, v222, v179
v_mul_f32 v221, v178, v194
v_mfma_f32_16x16x32_bf16 v[88:91], v[48:51], a[232:235], v[88:91]
v_exp_f32 v220, v220
v_mfma_f32_16x16x32_bf16 v[88:91], v[52:55], a[248:251], v[88:91]
ds_read_b128 v[76:79], v7 offset:31744
v_mul_f32 v223, v179, v195
v_mfma_f32_16x16x32_bf16 v[92:95], v[48:51], a[236:239], v[92:95]
v_exp_f32 v222, v222
v_mfma_f32_16x16x32_bf16 v[92:95], v[52:55], a[252:255], v[92:95]
v_fma_f32 v220, v220, v234, v234
s_waitcnt lgkmcnt(4)
v_mfma_f32_16x16x32_bf16 v[96:99], v[56:59], a[224:227], v[96:99]
s_waitcnt vmcnt(22)
v_fma_f32 v222, v222, v234, v234
v_mfma_f32_16x16x32_bf16 v[96:99], v[60:63], a[240:243], v[96:99]
s_barrier
v_mfma_f32_16x16x32_bf16 v[100:103], v[56:59], a[228:231], v[100:103]
ds_read_b128 v[48:51], v7 offset:32768
s_add_u32 m0, s22, 49152
v_mfma_f32_16x16x32_bf16 v[100:103], v[60:63], a[244:247], v[100:103]
v_add_u32 v3, 20480, v3
buffer_load_dwordx4 v3, s[8:11], 0 offen offset:0 sc1 lds
v_mfma_f32_16x16x32_bf16 v[104:107], v[56:59], a[232:235], v[104:107]
v_rcp_f32 v220, v220
v_mfma_f32_16x16x32_bf16 v[104:107], v[60:63], a[248:251], v[104:107]
ds_read_b128 v[52:55], v7 offset:33792
v_mul_f32 v221, v221, v220
v_mfma_f32_16x16x32_bf16 v[108:111], v[56:59], a[236:239], v[108:111]
v_rcp_f32 v222, v222
v_mfma_f32_16x16x32_bf16 v[108:111], v[60:63], a[252:255], v[108:111]
v_mul_f32 v223, v223, v222
s_waitcnt lgkmcnt(4)
v_mfma_f32_16x16x32_bf16 v[80:83], v[64:67], v[16:19], v[80:83]
buffer_load_dwordx4 v3, s[8:11], 0 offen offset:1024 sc1 lds
v_mfma_f32_16x16x32_bf16 v[80:83], v[68:71], v[32:35], v[80:83]
v_cvt_pk_bf16_f32 v147, v221, v223
v_mul_f32 v216, v180, v180
v_mfma_f32_16x16x32_bf16 v[84:87], v[64:67], v[20:23], v[84:87]
ds_read_b128 v[56:59], v7 offset:34816
v_mul_f32 v218, v181, v181
v_mfma_f32_16x16x32_bf16 v[84:87], v[68:71], v[36:39], v[84:87]
buffer_store_dwordx4 v[144:147], v2, s[8:11], s24 offen offset:0 sc1
v_mfma_f32_16x16x32_bf16 v[88:91], v[64:67], v[24:27], v[88:91]
v_fma_f32 v216, v216, v237, v236
v_fma_f32 v218, v218, v237, v236
v_mfma_f32_16x16x32_bf16 v[88:91], v[68:71], v[40:43], v[88:91]
ds_read_b128 v[60:63], v7 offset:35840
v_mul_f32 v216, v216, v180
v_mfma_f32_16x16x32_bf16 v[92:95], v[64:67], v[28:31], v[92:95]
v_mul_f32 v218, v218, v181
v_mul_f32 v217, v180, v196
v_mfma_f32_16x16x32_bf16 v[92:95], v[68:71], v[44:47], v[92:95]
v_mul_f32 v219, v181, v197
s_waitcnt lgkmcnt(4)
v_mfma_f32_16x16x32_bf16 v[96:99], v[72:75], v[16:19], v[96:99]
buffer_load_dwordx4 v3, s[8:11], 0 offen offset:2048 sc1 lds
v_mfma_f32_16x16x32_bf16 v[96:99], v[76:79], v[32:35], v[96:99]
v_exp_f32 v216, v216
v_mfma_f32_16x16x32_bf16 v[100:103], v[72:75], v[20:23], v[100:103]
ds_read_b128 v[64:67], v7 offset:36864
v_fma_f32 v216, v216, v238, v238
v_mfma_f32_16x16x32_bf16 v[100:103], v[76:79], v[36:39], v[100:103]
v_exp_f32 v218, v218
v_mfma_f32_16x16x32_bf16 v[104:107], v[72:75], v[24:27], v[104:107]
v_fma_f32 v218, v218, v238, v238
v_mul_f32 v220, v182, v182
v_mfma_f32_16x16x32_bf16 v[104:107], v[76:79], v[40:43], v[104:107]
ds_read_b128 v[68:71], v7 offset:37888
v_mul_f32 v222, v183, v183
v_mfma_f32_16x16x32_bf16 v[108:111], v[72:75], v[28:31], v[108:111]
buffer_load_dwordx4 v3, s[8:11], 0 offen offset:3072 sc1 lds
v_mfma_f32_16x16x32_bf16 v[108:111], v[76:79], v[44:47], v[108:111]
s_add_u32 m0, s22, 53248
s_waitcnt lgkmcnt(4)
v_mfma_f32_16x16x32_bf16 v[112:115], v[48:51], a[0:3], 0
v_add_u32 v3, 4096, v3
v_fma_f32 v220, v220, v237, v236
v_mfma_f32_16x16x32_bf16 v[112:115], v[52:55], a[16:19], v[112:115]
v_rcp_f32 v216, v216
v_mfma_f32_16x16x32_bf16 v[116:119], v[48:51], a[4:7], 0
ds_read_b128 v[72:75], v7 offset:38912
v_mul_f32 v217, v217, v216
v_mfma_f32_16x16x32_bf16 v[116:119], v[52:55], a[20:23], v[116:119]
buffer_load_dwordx4 v3, s[8:11], 0 offen offset:0 sc1 lds
v_mfma_f32_16x16x32_bf16 v[120:123], v[48:51], a[8:11], 0
v_mul_f32 v208, v80, v80
v_mul_f32 v210, v81, v81
v_mfma_f32_16x16x32_bf16 v[120:123], v[52:55], a[24:27], v[120:123]
ds_read_b128 v[76:79], v7 offset:39936
v_fma_f32 v208, v208, v233, v232
v_mfma_f32_16x16x32_bf16 v[124:127], v[48:51], a[12:15], 0
v_fma_f32 v210, v210, v233, v232
v_mul_f32 v208, v208, v80
v_mfma_f32_16x16x32_bf16 v[124:127], v[52:55], a[28:31], v[124:127]
v_mul_f32 v210, v210, v81
s_waitcnt lgkmcnt(4)
v_mfma_f32_16x16x32_bf16 v[128:131], v[56:59], a[0:3], 0
buffer_load_dwordx4 v3, s[8:11], 0 offen offset:1024 sc1 lds
v_mfma_f32_16x16x32_bf16 v[128:131], v[60:63], a[16:19], v[128:131]
v_exp_f32 v208, v208
v_mfma_f32_16x16x32_bf16 v[132:135], v[56:59], a[4:7], 0
ds_read_b128 v[48:51], v7 offset:40960
v_mul_f32 v209, v80, v96
v_mfma_f32_16x16x32_bf16 v[132:135], v[60:63], a[20:23], v[132:135]
v_exp_f32 v210, v210
v_mfma_f32_16x16x32_bf16 v[136:139], v[56:59], a[8:11], 0
v_mul_f32 v211, v81, v97
v_fma_f32 v208, v208, v234, v234
v_mfma_f32_16x16x32_bf16 v[136:139], v[60:63], a[24:27], v[136:139]
ds_read_b128 v[52:55], v7 offset:41984
v_fma_f32 v210, v210, v234, v234
v_mfma_f32_16x16x32_bf16 v[140:143], v[56:59], a[12:15], 0
v_rcp_f32 v208, v208
v_mfma_f32_16x16x32_bf16 v[140:143], v[60:63], a[28:31], v[140:143]
v_mul_f32 v209, v209, v208
s_waitcnt lgkmcnt(4)
v_mfma_f32_16x16x32_bf16 v[112:115], v[64:67], a[32:35], v[112:115]
v_rcp_f32 v210, v210
v_mfma_f32_16x16x32_bf16 v[112:115], v[68:71], a[48:51], v[112:115]
v_mul_f32 v211, v211, v210
v_cvt_pk_bf16_f32 v160, v209, v211
v_mfma_f32_16x16x32_bf16 v[116:119], v[64:67], a[36:39], v[116:119]
ds_read_b128 v[56:59], v7 offset:43008
v_mul_f32 v212, v82, v82
v_mfma_f32_16x16x32_bf16 v[116:119], v[68:71], a[52:55], v[116:119]
v_mul_f32 v214, v83, v83
v_fma_f32 v212, v212, v233, v232
v_mfma_f32_16x16x32_bf16 v[120:123], v[64:67], a[40:43], v[120:123]
v_fma_f32 v214, v214, v233, v232
v_mul_f32 v212, v212, v82
v_mfma_f32_16x16x32_bf16 v[120:123], v[68:71], a[56:59], v[120:123]
ds_read_b128 v[60:63], v7 offset:44032
v_mul_f32 v214, v214, v83
v_mfma_f32_16x16x32_bf16 v[124:127], v[64:67], a[44:47], v[124:127]
v_exp_f32 v212, v212
v_mfma_f32_16x16x32_bf16 v[124:127], v[68:71], a[60:63], v[124:127]
v_mul_f32 v213, v82, v98
s_waitcnt lgkmcnt(4)
v_mfma_f32_16x16x32_bf16 v[128:131], v[72:75], a[32:35], v[128:131]
v_exp_f32 v214, v214
v_mfma_f32_16x16x32_bf16 v[128:131], v[76:79], a[48:51], v[128:131]
v_mul_f32 v215, v83, v99
v_fma_f32 v212, v212, v234, v234
v_mfma_f32_16x16x32_bf16 v[132:135], v[72:75], a[36:39], v[132:135]
ds_read_b128 v[64:67], v7 offset:45056
v_fma_f32 v214, v214, v234, v234
v_mfma_f32_16x16x32_bf16 v[132:135], v[76:79], a[52:55], v[132:135]
v_rcp_f32 v212, v212
v_mfma_f32_16x16x32_bf16 v[136:139], v[72:75], a[40:43], v[136:139]
v_rcp_f32 v214, v214
v_mfma_f32_16x16x32_bf16 v[136:139], v[76:79], a[56:59], v[136:139]
ds_read_b128 v[68:71], v7 offset:46080
v_mul_f32 v213, v213, v212
v_mfma_f32_16x16x32_bf16 v[140:143], v[72:75], a[44:47], v[140:143]
v_mul_f32 v215, v215, v214
v_cvt_pk_bf16_f32 v161, v213, v215
v_mfma_f32_16x16x32_bf16 v[140:143], v[76:79], a[60:63], v[140:143]
v_mul_f32 v208, v84, v84
s_waitcnt lgkmcnt(4)
v_mfma_f32_16x16x32_bf16 v[112:115], v[48:51], a[64:67], v[112:115]
v_mul_f32 v210, v85, v85
v_fma_f32 v208, v208, v237, v236
v_mfma_f32_16x16x32_bf16 v[112:115], v[52:55], a[80:83], v[112:115]
v_fma_f32 v210, v210, v237, v236
v_mul_f32 v208, v208, v84
v_mfma_f32_16x16x32_bf16 v[116:119], v[48:51], a[68:71], v[116:119]
ds_read_b128 v[72:75], v7 offset:47104
v_mul_f32 v210, v210, v85
v_mfma_f32_16x16x32_bf16 v[116:119], v[52:55], a[84:87], v[116:119]
v_exp_f32 v208, v208
v_mfma_f32_16x16x32_bf16 v[120:123], v[48:51], a[72:75], v[120:123]
v_exp_f32 v210, v210
v_mfma_f32_16x16x32_bf16 v[120:123], v[52:55], a[88:91], v[120:123]
ds_read_b128 v[76:79], v7 offset:48128
v_mul_f32 v209, v84, v100
v_mfma_f32_16x16x32_bf16 v[124:127], v[48:51], a[76:79], v[124:127]
v_mul_f32 v211, v85, v101
v_fma_f32 v208, v208, v238, v238
v_mfma_f32_16x16x32_bf16 v[124:127], v[52:55], a[92:95], v[124:127]
v_fma_f32 v210, v210, v238, v238
s_waitcnt lgkmcnt(4)
v_mfma_f32_16x16x32_bf16 v[128:131], v[56:59], a[64:67], v[128:131]
v_rcp_f32 v208, v208
v_mfma_f32_16x16x32_bf16 v[128:131], v[60:63], a[80:83], v[128:131]
v_rcp_f32 v210, v210
v_mfma_f32_16x16x32_bf16 v[132:135], v[56:59], a[68:71], v[132:135]
ds_read_b128 v[48:51], v7 offset:49152
v_mul_f32 v209, v209, v208
v_mfma_f32_16x16x32_bf16 v[132:135], v[60:63], a[84:87], v[132:135]
v_mul_f32 v211, v211, v210
v_cvt_pk_bf16_f32 v164, v209, v211
v_mfma_f32_16x16x32_bf16 v[136:139], v[56:59], a[72:75], v[136:139]
v_mul_f32 v212, v86, v86
v_mul_f32 v214, v87, v87
v_mfma_f32_16x16x32_bf16 v[136:139], v[60:63], a[88:91], v[136:139]
ds_read_b128 v[52:55], v7 offset:50176
v_fma_f32 v212, v212, v237, v236
L_hop6:
s_cmp_eq_u32 s15, 1
s_cbranch_scc1 L_hop10
v_mfma_f32_16x16x32_bf16 v[140:143], v[56:59], a[76:79], v[140:143]
v_fma_f32 v214, v214, v237, v236
v_mul_f32 v212, v212, v86
v_mfma_f32_16x16x32_bf16 v[140:143], v[60:63], a[92:95], v[140:143]
v_mul_f32 v214, v214, v87
s_waitcnt lgkmcnt(4)
v_mfma_f32_16x16x32_bf16 v[112:115], v[64:67], a[96:99], v[112:115]
v_exp_f32 v212, v212
v_mfma_f32_16x16x32_bf16 v[112:115], v[68:71], a[112:115], v[112:115]
v_exp_f32 v214, v214
v_mfma_f32_16x16x32_bf16 v[116:119], v[64:67], a[100:103], v[116:119]
ds_read_b128 v[56:59], v7 offset:51200
v_mul_f32 v213, v86, v102
v_mfma_f32_16x16x32_bf16 v[116:119], v[68:71], a[116:119], v[116:119]
v_mul_f32 v215, v87, v103
v_fma_f32 v212, v212, v238, v238
v_mfma_f32_16x16x32_bf16 v[120:123], v[64:67], a[104:107], v[120:123]
v_fma_f32 v214, v214, v238, v238
v_mul_f32 v208, v88, v88
v_mfma_f32_16x16x32_bf16 v[120:123], v[68:71], a[120:123], v[120:123]
ds_read_b128 v[60:63], v7 offset:52224
v_mul_f32 v210, v89, v89
v_mfma_f32_16x16x32_bf16 v[124:127], v[64:67], a[108:111], v[124:127]
v_rcp_f32 v212, v212
v_mfma_f32_16x16x32_bf16 v[124:127], v[68:71], a[124:127], v[124:127]
v_mul_f32 v213, v213, v212
s_waitcnt lgkmcnt(4)
v_mfma_f32_16x16x32_bf16 v[128:131], v[72:75], a[96:99], v[128:131]
v_rcp_f32 v214, v214
v_mfma_f32_16x16x32_bf16 v[128:131], v[76:79], a[112:115], v[128:131]
v_mul_f32 v215, v215, v214
v_cvt_pk_bf16_f32 v165, v213, v215
v_mfma_f32_16x16x32_bf16 v[132:135], v[72:75], a[100:103], v[132:135]
ds_read_b128 v[64:67], v7 offset:53248
v_fma_f32 v208, v208, v241, v240
v_mfma_f32_16x16x32_bf16 v[132:135], v[76:79], a[116:119], v[132:135]
v_fma_f32 v210, v210, v241, v240
v_mul_f32 v208, v208, v88
v_mfma_f32_16x16x32_bf16 v[136:139], v[72:75], a[104:107], v[136:139]
v_mul_f32 v210, v210, v89
v_mul_f32 v209, v88, v104
v_mfma_f32_16x16x32_bf16 v[136:139], v[76:79], a[120:123], v[136:139]
ds_read_b128 v[68:71], v7 offset:54272
v_mul_f32 v211, v89, v105
v_mfma_f32_16x16x32_bf16 v[140:143], v[72:75], a[108:111], v[140:143]
v_exp_f32 v208, v208
v_mfma_f32_16x16x32_bf16 v[140:143], v[76:79], a[124:127], v[140:143]
v_fma_f32 v208, v208, v242, v242
s_waitcnt lgkmcnt(4)
v_mfma_f32_16x16x32_bf16 v[112:115], v[48:51], a[128:131], v[112:115]
v_exp_f32 v210, v210
v_mfma_f32_16x16x32_bf16 v[112:115], v[52:55], a[144:147], v[112:115]
v_fma_f32 v210, v210, v242, v242
v_mul_f32 v212, v90, v90
v_mfma_f32_16x16x32_bf16 v[116:119], v[48:51], a[132:135], v[116:119]
ds_read_b128 v[72:75], v7 offset:55296
v_mul_f32 v214, v91, v91
v_mfma_f32_16x16x32_bf16 v[116:119], v[52:55], a[148:151], v[116:119]
v_rcp_f32 v208, v208
v_mfma_f32_16x16x32_bf16 v[120:123], v[48:51], a[136:139], v[120:123]
v_rcp_f32 v210, v210
v_mfma_f32_16x16x32_bf16 v[120:123], v[52:55], a[152:155], v[120:123]
ds_read_b128 v[76:79], v7 offset:56320
v_mul_f32 v209, v209, v208
v_mfma_f32_16x16x32_bf16 v[124:127], v[48:51], a[140:143], v[124:127]
v_mul_f32 v211, v211, v210
v_cvt_pk_bf16_f32 v168, v209, v211
v_mfma_f32_16x16x32_bf16 v[124:127], v[52:55], a[156:159], v[124:127]
v_fma_f32 v212, v212, v241, v240
s_waitcnt lgkmcnt(4)
v_mfma_f32_16x16x32_bf16 v[128:131], v[56:59], a[128:131], v[128:131]
s_waitcnt vmcnt(23)
v_fma_f32 v214, v214, v241, v240
v_mfma_f32_16x16x32_bf16 v[128:131], v[60:63], a[144:147], v[128:131]
s_barrier
v_mfma_f32_16x16x32_bf16 v[132:135], v[56:59], a[132:135], v[132:135]
ds_read_b128 v[48:51], v7 offset:57344
s_add_u32 m0, s22, 73728
v_mfma_f32_16x16x32_bf16 v[132:135], v[60:63], a[148:151], v[132:135]
v_add_u32 v3, 20480, v3
buffer_load_dwordx4 v3, s[8:11], 0 offen offset:0 sc1 lds
v_mfma_f32_16x16x32_bf16 v[136:139], v[56:59], a[136:139], v[136:139]
v_mul_f32 v212, v212, v90
v_mul_f32 v214, v214, v91
v_mfma_f32_16x16x32_bf16 v[136:139], v[60:63], a[152:155], v[136:139]
ds_read_b128 v[52:55], v7 offset:58368
v_mul_f32 v213, v90, v106
v_mfma_f32_16x16x32_bf16 v[140:143], v[56:59], a[140:143], v[140:143]
v_exp_f32 v212, v212
v_mfma_f32_16x16x32_bf16 v[140:143], v[60:63], a[156:159], v[140:143]
v_mul_f32 v215, v91, v107
s_waitcnt lgkmcnt(4)
v_mfma_f32_16x16x32_bf16 v[112:115], v[64:67], a[160:163], v[112:115]
buffer_load_dwordx4 v3, s[8:11], 0 offen offset:1024 sc1 lds
v_mfma_f32_16x16x32_bf16 v[112:115], v[68:71], a[176:179], v[112:115]
v_exp_f32 v214, v214
v_mfma_f32_16x16x32_bf16 v[116:119], v[64:67], a[164:167], v[116:119]
ds_read_b128 v[56:59], v7 offset:59392
v_fma_f32 v212, v212, v242, v242
v_mfma_f32_16x16x32_bf16 v[116:119], v[68:71], a[180:183], v[116:119]
v_fma_f32 v214, v214, v242, v242
v_mul_f32 v208, v92, v92
v_mfma_f32_16x16x32_bf16 v[120:123], v[64:67], a[168:171], v[120:123]
v_rcp_f32 v212, v212
v_mfma_f32_16x16x32_bf16 v[120:123], v[68:71], a[184:187], v[120:123]
ds_read_b128 v[60:63], v7 offset:60416
v_mul_f32 v213, v213, v212
v_mfma_f32_16x16x32_bf16 v[124:127], v[64:67], a[172:175], v[124:127]
buffer_load_dwordx4 v3, s[8:11], 0 offen offset:2048 sc1 lds
v_mfma_f32_16x16x32_bf16 v[124:127], v[68:71], a[188:191], v[124:127]
v_mul_f32 v210, v93, v93
s_waitcnt lgkmcnt(4)
v_mfma_f32_16x16x32_bf16 v[128:131], v[72:75], a[160:163], v[128:131]
v_rcp_f32 v214, v214
v_mfma_f32_16x16x32_bf16 v[128:131], v[76:79], a[176:179], v[128:131]
v_mul_f32 v215, v215, v214
v_cvt_pk_bf16_f32 v169, v213, v215
v_mfma_f32_16x16x32_bf16 v[132:135], v[72:75], a[164:167], v[132:135]
ds_read_b128 v[64:67], v7 offset:61440
v_fma_f32 v208, v208, v245, v244
v_mfma_f32_16x16x32_bf16 v[132:135], v[76:79], a[180:183], v[132:135]
buffer_load_dwordx4 v3, s[8:11], 0 offen offset:3072 sc1 lds
v_mfma_f32_16x16x32_bf16 v[136:139], v[72:75], a[168:171], v[136:139]
s_add_u32 m0, s22, 77824
v_add_u32 v3, 4096, v3
v_mfma_f32_16x16x32_bf16 v[136:139], v[76:79], a[184:187], v[136:139]
ds_read_b128 v[68:71], v7 offset:62464
v_fma_f32 v210, v210, v245, v244
v_mfma_f32_16x16x32_bf16 v[140:143], v[72:75], a[172:175], v[140:143]
v_mul_f32 v208, v208, v92
v_mul_f32 v210, v210, v93
v_mfma_f32_16x16x32_bf16 v[140:143], v[76:79], a[188:191], v[140:143]
v_mul_f32 v209, v92, v108
s_waitcnt lgkmcnt(4)
v_mfma_f32_16x16x32_bf16 v[112:115], v[48:51], a[192:195], v[112:115]
buffer_load_dwordx4 v3, s[8:11], 0 offen offset:0 sc1 lds
v_mfma_f32_16x16x32_bf16 v[112:115], v[52:55], a[208:211], v[112:115]
v_exp_f32 v208, v208
v_mfma_f32_16x16x32_bf16 v[116:119], v[48:51], a[196:199], v[116:119]
ds_read_b128 v[72:75], v7 offset:63488
v_mul_f32 v211, v93, v109
v_mfma_f32_16x16x32_bf16 v[116:119], v[52:55], a[212:215], v[116:119]
v_exp_f32 v210, v210
v_mfma_f32_16x16x32_bf16 v[120:123], v[48:51], a[200:203], v[120:123]
v_fma_f32 v208, v208, v246, v246
v_fma_f32 v210, v210, v246, v246
v_mfma_f32_16x16x32_bf16 v[120:123], v[52:55], a[216:219], v[120:123]
ds_read_b128 v[76:79], v7 offset:64512
v_mul_f32 v212, v94, v94
v_mfma_f32_16x16x32_bf16 v[124:127], v[48:51], a[204:207], v[124:127]
buffer_load_dwordx4 v3, s[8:11], 0 offen offset:1024 sc1 lds
v_mfma_f32_16x16x32_bf16 v[124:127], v[52:55], a[220:223], v[124:127]
v_mul_f32 v214, v95, v95
s_waitcnt lgkmcnt(4)
v_mfma_f32_16x16x32_bf16 v[128:131], v[56:59], a[192:195], v[128:131]
v_rcp_f32 v208, v208
v_mfma_f32_16x16x32_bf16 v[128:131], v[60:63], a[208:211], v[128:131]
v_rcp_f32 v210, v210
v_mfma_f32_16x16x32_bf16 v[132:135], v[56:59], a[196:199], v[132:135]
ds_read_b128 v[48:51], v8 offset:0
v_mul_f32 v209, v209, v208
v_mfma_f32_16x16x32_bf16 v[132:135], v[60:63], a[212:215], v[132:135]
v_mul_f32 v211, v211, v210
v_cvt_pk_bf16_f32 v172, v209, v211
v_mfma_f32_16x16x32_bf16 v[136:139], v[56:59], a[200:203], v[136:139]
v_fma_f32 v212, v212, v245, v244
v_fma_f32 v214, v214, v245, v244
v_mfma_f32_16x16x32_bf16 v[136:139], v[60:63], a[216:219], v[136:139]
ds_read_b128 v[52:55], v8 offset:1024
v_mul_f32 v212, v212, v94
v_mfma_f32_16x16x32_bf16 v[140:143], v[56:59], a[204:207], v[140:143]
v_mul_f32 v214, v214, v95
v_mul_f32 v213, v94, v110
v_mfma_f32_16x16x32_bf16 v[140:143], v[60:63], a[220:223], v[140:143]
v_mul_f32 v215, v95, v111
s_waitcnt lgkmcnt(4)
v_mfma_f32_16x16x32_bf16 v[112:115], v[64:67], a[224:227], v[112:115]
v_exp_f32 v212, v212
v_mfma_f32_16x16x32_bf16 v[112:115], v[68:71], a[240:243], v[112:115]
v_exp_f32 v214, v214
v_mfma_f32_16x16x32_bf16 v[116:119], v[64:67], a[228:231], v[116:119]
ds_read_b128 v[56:59], v8 offset:2048
v_fma_f32 v212, v212, v246, v246
v_mfma_f32_16x16x32_bf16 v[116:119], v[68:71], a[244:247], v[116:119]
v_fma_f32 v214, v214, v246, v246
v_fma_f32 v222, v222, v237, v236
v_mfma_f32_16x16x32_bf16 v[120:123], v[64:67], a[232:235], v[120:123]
v_rcp_f32 v212, v212
v_mfma_f32_16x16x32_bf16 v[120:123], v[68:71], a[248:251], v[120:123]
ds_read_b128 v[60:63], v8 offset:3072
v_mul_f32 v213, v213, v212
v_mfma_f32_16x16x32_bf16 v[124:127], v[64:67], a[236:239], v[124:127]
v_rcp_f32 v214, v214
v_mfma_f32_16x16x32_bf16 v[124:127], v[68:71], a[252:255], v[124:127]
v_mul_f32 v215, v215, v214
s_waitcnt lgkmcnt(4)
v_mfma_f32_16x16x32_bf16 v[128:131], v[72:75], a[224:227], v[128:131]
v_cvt_pk_bf16_f32 v173, v213, v215
v_mul_f32 v220, v220, v182
v_mfma_f32_16x16x32_bf16 v[128:131], v[76:79], a[240:243], v[128:131]
v_rcp_f32 v218, v218
v_mfma_f32_16x16x32_bf16 v[132:135], v[72:75], a[228:231], v[132:135]
ds_read_b128 v[64:67], v8 offset:4096
v_mul_f32 v219, v219, v218
v_mfma_f32_16x16x32_bf16 v[132:135], v[76:79], a[244:247], v[132:135]
v_cvt_pk_bf16_f32 v150, v217, v219
v_mul_f32 v222, v222, v183
v_mfma_f32_16x16x32_bf16 v[136:139], v[72:75], a[232:235], v[136:139]
v_exp_f32 v220, v220
v_mfma_f32_16x16x32_bf16 v[136:139], v[76:79], a[248:251], v[136:139]
ds_read_b128 v[68:71], v8 offset:5120
v_mul_f32 v221, v182, v198
v_mfma_f32_16x16x32_bf16 v[140:143], v[72:75], a[236:239], v[140:143]
v_exp_f32 v222, v222
v_mfma_f32_16x16x32_bf16 v[140:143], v[76:79], a[252:255], v[140:143]
v_mul_f32 v223, v183, v199
s_waitcnt lgkmcnt(4)
v_mfma_f32_16x16x32_bf16 v[112:115], v[48:51], v[16:19], v[112:115]
v_fma_f32 v220, v220, v238, v238
v_fma_f32 v222, v222, v238, v238
v_mfma_f32_16x16x32_bf16 v[112:115], v[52:55], v[32:35], v[112:115]
v_rcp_f32 v220, v220
v_mfma_f32_16x16x32_bf16 v[116:119], v[48:51], v[20:23], v[116:119]
ds_read_b128 v[72:75], v8 offset:6144
v_mul_f32 v221, v221, v220
v_mfma_f32_16x16x32_bf16 v[116:119], v[52:55], v[36:39], v[116:119]
v_rcp_f32 v222, v222
v_mfma_f32_16x16x32_bf16 v[120:123], v[48:51], v[24:27], v[120:123]
v_mul_f32 v223, v223, v222
v_cvt_pk_bf16_f32 v151, v221, v223
v_mfma_f32_16x16x32_bf16 v[120:123], v[52:55], v[40:43], v[120:123]
ds_read_b128 v[76:79], v8 offset:7168
v_mul_f32 v216, v184, v184
v_mfma_f32_16x16x32_bf16 v[124:127], v[48:51], v[28:31], v[124:127]
buffer_store_dwordx4 v[148:151], v4, s[8:11], s24 offen offset:0 sc1
v_mfma_f32_16x16x32_bf16 v[124:127], v[52:55], v[44:47], v[124:127]
v_mul_f32 v218, v185, v185
s_waitcnt lgkmcnt(4)
v_mfma_f32_16x16x32_bf16 v[128:131], v[56:59], v[16:19], v[128:131]
v_fma_f32 v216, v216, v241, v240
v_fma_f32 v218, v218, v241, v240
v_mfma_f32_16x16x32_bf16 v[128:131], v[60:63], v[32:35], v[128:131]
v_mul_f32 v216, v216, v184
v_mul_f32 v218, v218, v185
v_mfma_f32_16x16x32_bf16 v[132:135], v[56:59], v[20:23], v[132:135]
ds_read_b128 v[48:51], v8 offset:8192
v_mul_f32 v217, v184, v200
v_mfma_f32_16x16x32_bf16 v[132:135], v[60:63], v[36:39], v[132:135]
v_exp_f32 v216, v216
v_mfma_f32_16x16x32_bf16 v[136:139], v[56:59], v[24:27], v[136:139]
v_exp_f32 v218, v218
v_mfma_f32_16x16x32_bf16 v[136:139], v[60:63], v[40:43], v[136:139]
ds_read_b128 v[52:55], v8 offset:9216
v_mul_f32 v219, v185, v201
v_mfma_f32_16x16x32_bf16 v[140:143], v[56:59], v[28:31], v[140:143]
v_fma_f32 v216, v216, v242, v242
v_fma_f32 v218, v218, v242, v242
v_mfma_f32_16x16x32_bf16 v[140:143], v[60:63], v[44:47], v[140:143]
v_mul_f32 v220, v186, v186
s_waitcnt lgkmcnt(4)
v_mfma_f32_16x16x32_bf16 v[80:83], v[64:67], a[0:3], 0
v_rcp_f32 v216, v216
v_mfma_f32_16x16x32_bf16 v[80:83], v[68:71], a[16:19], v[80:83]
v_rcp_f32 v218, v218
v_mfma_f32_16x16x32_bf16 v[84:87], v[64:67], a[4:7], 0
ds_read_b128 v[56:59], v8 offset:10240
v_mul_f32 v217, v217, v216
v_mfma_f32_16x16x32_bf16 v[84:87], v[68:71], a[20:23], v[84:87]
v_mul_f32 v208, v112, v112
v_mul_f32 v210, v113, v113
v_mfma_f32_16x16x32_bf16 v[88:91], v[64:67], a[8:11], 0
v_fma_f32 v208, v208, v233, v232
v_fma_f32 v210, v210, v233, v232
v_mfma_f32_16x16x32_bf16 v[88:91], v[68:71], a[24:27], v[88:91]
ds_read_b128 v[60:63], v8 offset:11264
v_mul_f32 v208, v208, v112
v_mfma_f32_16x16x32_bf16 v[92:95], v[64:67], a[12:15], 0
v_mul_f32 v210, v210, v113
v_mul_f32 v209, v112, v128
v_mfma_f32_16x16x32_bf16 v[92:95], v[68:71], a[28:31], v[92:95]
v_mul_f32 v211, v113, v129
s_waitcnt lgkmcnt(4)
v_mfma_f32_16x16x32_bf16 v[96:99], v[72:75], a[0:3], 0
v_exp_f32 v208, v208
v_mfma_f32_16x16x32_bf16 v[96:99], v[76:79], a[16:19], v[96:99]
v_exp_f32 v210, v210
v_mfma_f32_16x16x32_bf16 v[100:103], v[72:75], a[4:7], 0
ds_read_b128 v[64:67], v8 offset:12288
v_fma_f32 v208, v208, v234, v234
v_mfma_f32_16x16x32_bf16 v[100:103], v[76:79], a[20:23], v[100:103]
v_fma_f32 v210, v210, v234, v234
v_mul_f32 v212, v114, v114
v_mfma_f32_16x16x32_bf16 v[104:107], v[72:75], a[8:11], 0
v_rcp_f32 v208, v208
v_mfma_f32_16x16x32_bf16 v[104:107], v[76:79], a[24:27], v[104:107]
ds_read_b128 v[68:71], v8 offset:13312
v_mul_f32 v209, v209, v208
v_mfma_f32_16x16x32_bf16 v[108:111], v[72:75], a[12:15], 0
v_rcp_f32 v210, v210
v_mfma_f32_16x16x32_bf16 v[108:111], v[76:79], a[28:31], v[108:111]
v_mul_f32 v211, v211, v210
s_waitcnt lgkmcnt(4)
v_mfma_f32_16x16x32_bf16 v[80:83], v[48:51], a[32:35], v[80:83]
v_cvt_pk_bf16_f32 v162, v209, v211
v_mul_f32 v214, v115, v115
v_mfma_f32_16x16x32_bf16 v[80:83], v[52:55], a[48:51], v[80:83]
v_fma_f32 v212, v212, v233, v232
v_fma_f32 v214, v214, v233, v232
v_mfma_f32_16x16x32_bf16 v[84:87], v[48:51], a[36:39], v[84:87]
ds_read_b128 v[72:75], v8 offset:14336
v_mul_f32 v212, v212, v114
v_mfma_f32_16x16x32_bf16 v[84:87], v[52:55], a[52:55], v[84:87]
v_mul_f32 v214, v214, v115
v_mul_f32 v213, v114, v130
v_mfma_f32_16x16x32_bf16 v[88:91], v[48:51], a[40:43], v[88:91]
v_exp_f32 v212, v212
v_mfma_f32_16x16x32_bf16 v[88:91], v[52:55], a[56:59], v[88:91]
ds_read_b128 v[76:79], v8 offset:15360
v_mul_f32 v215, v115, v131
v_mfma_f32_16x16x32_bf16 v[92:95], v[48:51], a[44:47], v[92:95]
v_exp_f32 v214, v214
v_mfma_f32_16x16x32_bf16 v[92:95], v[52:55], a[60:63], v[92:95]
v_fma_f32 v212, v212, v234, v234
s_waitcnt lgkmcnt(4)
v_mfma_f32_16x16x32_bf16 v[96:99], v[56:59], a[32:35], v[96:99]
s_waitcnt vmcnt(21)
v_fma_f32 v214, v214, v234, v234
v_mfma_f32_16x16x32_bf16 v[96:99], v[60:63], a[48:51], v[96:99]
s_barrier
v_mfma_f32_16x16x32_bf16 v[100:103], v[56:59], a[36:39], v[100:103]
ds_read_b128 v[48:51], v2 offset:0
s_add_u32 m0, s22, 98304
v_mfma_f32_16x16x32_bf16 v[100:103], v[60:63], a[52:55], v[100:103]
v_add_u32 v3, 20480, v3
buffer_load_dwordx4 v3, s[8:11], 0 offen offset:0 sc1 lds
v_mfma_f32_16x16x32_bf16 v[104:107], v[56:59], a[40:43], v[104:107]
v_rcp_f32 v212, v212
v_mfma_f32_16x16x32_bf16 v[104:107], v[60:63], a[56:59], v[104:107]
ds_read_b128 v[52:55], v2 offset:1024
v_mul_f32 v213, v213, v212
v_mfma_f32_16x16x32_bf16 v[108:111], v[56:59], a[44:47], v[108:111]
v_rcp_f32 v214, v214
v_mfma_f32_16x16x32_bf16 v[108:111], v[60:63], a[60:63], v[108:111]
v_mul_f32 v215, v215, v214
s_waitcnt lgkmcnt(4)
v_mfma_f32_16x16x32_bf16 v[80:83], v[64:67], a[64:67], v[80:83]
buffer_load_dwordx4 v3, s[8:11], 0 offen offset:1024 sc1 lds
v_mfma_f32_16x16x32_bf16 v[80:83], v[68:71], a[80:83], v[80:83]
v_cvt_pk_bf16_f32 v163, v213, v215
v_mul_f32 v208, v116, v116
v_mfma_f32_16x16x32_bf16 v[84:87], v[64:67], a[68:71], v[84:87]
ds_read_b128 v[56:59], v2 offset:2048
v_mul_f32 v210, v117, v117
v_mfma_f32_16x16x32_bf16 v[84:87], v[68:71], a[84:87], v[84:87]
buffer_store_dwordx4 v[160:163], v2, s[8:11], s24 offen offset:1024 sc1
v_mfma_f32_16x16x32_bf16 v[88:91], v[64:67], a[72:75], v[88:91]
v_fma_f32 v208, v208, v237, v236
v_fma_f32 v210, v210, v237, v236
v_mfma_f32_16x16x32_bf16 v[88:91], v[68:71], a[88:91], v[88:91]
ds_read_b128 v[60:63], v2 offset:3072
v_mul_f32 v208, v208, v116
v_mfma_f32_16x16x32_bf16 v[92:95], v[64:67], a[76:79], v[92:95]
v_mul_f32 v210, v210, v117
v_mul_f32 v209, v116, v132
v_mfma_f32_16x16x32_bf16 v[92:95], v[68:71], a[92:95], v[92:95]
v_mul_f32 v211, v117, v133
s_waitcnt lgkmcnt(4)
v_mfma_f32_16x16x32_bf16 v[96:99], v[72:75], a[64:67], v[96:99]
buffer_load_dwordx4 v3, s[8:11], 0 offen offset:2048 sc1 lds
v_mfma_f32_16x16x32_bf16 v[96:99], v[76:79], a[80:83], v[96:99]
v_exp_f32 v208, v208
v_mfma_f32_16x16x32_bf16 v[100:103], v[72:75], a[68:71], v[100:103]
ds_read_b128 v[64:67], v2 offset:4096
v_fma_f32 v208, v208, v238, v238
v_mfma_f32_16x16x32_bf16 v[100:103], v[76:79], a[84:87], v[100:103]
v_exp_f32 v210, v210
v_mfma_f32_16x16x32_bf16 v[104:107], v[72:75], a[72:75], v[104:107]
v_fma_f32 v210, v210, v238, v238
v_mul_f32 v212, v118, v118
v_mfma_f32_16x16x32_bf16 v[104:107], v[76:79], a[88:91], v[104:107]
ds_read_b128 v[68:71], v2 offset:5120
v_mul_f32 v214, v119, v119
v_mfma_f32_16x16x32_bf16 v[108:111], v[72:75], a[76:79], v[108:111]
buffer_load_dwordx4 v3, s[8:11], 0 offen offset:3072 sc1 lds
v_mfma_f32_16x16x32_bf16 v[108:111], v[76:79], a[92:95], v[108:111]
s_add_u32 m0, s22, 102400
s_waitcnt lgkmcnt(4)
v_mfma_f32_16x16x32_bf16 v[80:83], v[48:51], a[96:99], v[80:83]
v_add_u32 v3, 4096, v3
v_fma_f32 v212, v212, v237, v236
v_mfma_f32_16x16x32_bf16 v[80:83], v[52:55], a[112:115], v[80:83]
v_rcp_f32 v208, v208
v_mfma_f32_16x16x32_bf16 v[84:87], v[48:51], a[100:103], v[84:87]
ds_read_b128 v[72:75], v2 offset:6144
v_mul_f32 v209, v209, v208
v_mfma_f32_16x16x32_bf16 v[84:87], v[52:55], a[116:119], v[84:87]
buffer_load_dwordx4 v3, s[8:11], 0 offen offset:0 sc1 lds
v_mfma_f32_16x16x32_bf16 v[88:91], v[48:51], a[104:107], v[88:91]
v_rcp_f32 v210, v210
v_mfma_f32_16x16x32_bf16 v[88:91], v[52:55], a[120:123], v[88:91]
ds_read_b128 v[76:79], v2 offset:7168
v_mul_f32 v211, v211, v210
v_mfma_f32_16x16x32_bf16 v[92:95], v[48:51], a[108:111], v[92:95]
v_cvt_pk_bf16_f32 v166, v209, v211
v_fma_f32 v214, v214, v237, v236
v_mfma_f32_16x16x32_bf16 v[92:95], v[52:55], a[124:127], v[92:95]
v_mul_f32 v212, v212, v118
s_waitcnt lgkmcnt(4)
v_mfma_f32_16x16x32_bf16 v[96:99], v[56:59], a[96:99], v[96:99]
buffer_load_dwordx4 v3, s[8:11], 0 offen offset:1024 sc1 lds
v_mfma_f32_16x16x32_bf16 v[96:99], v[60:63], a[112:115], v[96:99]
v_mul_f32 v214, v214, v119
v_mul_f32 v213, v118, v134
v_mfma_f32_16x16x32_bf16 v[100:103], v[56:59], a[100:103], v[100:103]
ds_read_b128 v[48:51], v2 offset:8192
v_mul_f32 v215, v119, v135
v_mfma_f32_16x16x32_bf16 v[100:103], v[60:63], a[116:119], v[100:103]
v_exp_f32 v212, v212
v_mfma_f32_16x16x32_bf16 v[104:107], v[56:59], a[104:107], v[104:107]
v_exp_f32 v214, v214
v_mfma_f32_16x16x32_bf16 v[104:107], v[60:63], a[120:123], v[104:107]
ds_read_b128 v[52:55], v2 offset:9216
v_fma_f32 v212, v212, v238, v238
v_mfma_f32_16x16x32_bf16 v[108:111], v[56:59], a[108:111], v[108:111]
v_fma_f32 v214, v214, v238, v238
v_mul_f32 v208, v120, v120
v_mfma_f32_16x16x32_bf16 v[108:111], v[60:63], a[124:127], v[108:111]
v_mul_f32 v210, v121, v121
s_waitcnt lgkmcnt(4)
v_mfma_f32_16x16x32_bf16 v[80:83], v[64:67], a[128:131], v[80:83]
v_rcp_f32 v212, v212
v_mfma_f32_16x16x32_bf16 v[80:83], v[68:71], a[144:147], v[80:83]
v_rcp_f32 v214, v214
v_mfma_f32_16x16x32_bf16 v[84:87], v[64:67], a[132:135], v[84:87]
ds_read_b128 v[56:59], v2 offset:10240
v_mul_f32 v213, v213, v212
v_mfma_f32_16x16x32_bf16 v[84:87], v[68:71], a[148:151], v[84:87]
v_mul_f32 v215, v215, v214
v_cvt_pk_bf16_f32 v167, v213, v215
v_mfma_f32_16x16x32_bf16 v[88:91], v[64:67], a[136:139], v[88:91]
buffer_store_dwordx4 v[164:167], v4, s[8:11], s24 offen offset:1024 sc1
v_mfma_f32_16x16x32_bf16 v[88:91], v[68:71], a[152:155], v[88:91]
ds_read_b128 v[60:63], v2 offset:11264
v_fma_f32 v208, v208, v241, v240
v_mfma_f32_16x16x32_bf16 v[92:95], v[64:67], a[140:143], v[92:95]
v_fma_f32 v210, v210, v241, v240
v_mul_f32 v208, v208, v120
v_mfma_f32_16x16x32_bf16 v[92:95], v[68:71], a[156:159], v[92:95]
v_mul_f32 v210, v210, v121
s_waitcnt lgkmcnt(4)
v_mfma_f32_16x16x32_bf16 v[96:99], v[72:75], a[128:131], v[96:99]
v_exp_f32 v208, v208
v_mfma_f32_16x16x32_bf16 v[96:99], v[76:79], a[144:147], v[96:99]
v_exp_f32 v210, v210
v_mfma_f32_16x16x32_bf16 v[100:103], v[72:75], a[132:135], v[100:103]
ds_read_b128 v[64:67], v2 offset:12288
v_mul_f32 v209, v120, v136
v_mfma_f32_16x16x32_bf16 v[100:103], v[76:79], a[148:151], v[100:103]
v_mul_f32 v211, v121, v137
v_fma_f32 v208, v208, v242, v242
v_mfma_f32_16x16x32_bf16 v[104:107], v[72:75], a[136:139], v[104:107]
v_fma_f32 v210, v210, v242, v242
v_mul_f32 v212, v122, v122
v_mfma_f32_16x16x32_bf16 v[104:107], v[76:79], a[152:155], v[104:107]
ds_read_b128 v[68:71], v2 offset:13312
v_mul_f32 v214, v123, v123
v_mfma_f32_16x16x32_bf16 v[108:111], v[72:75], a[140:143], v[108:111]
v_rcp_f32 v208, v208
v_mfma_f32_16x16x32_bf16 v[108:111], v[76:79], a[156:159], v[108:111]
v_mul_f32 v209, v209, v208
s_waitcnt lgkmcnt(4)
v_mfma_f32_16x16x32_bf16 v[80:83], v[48:51], a[160:163], v[80:83]
v_rcp_f32 v210, v210
v_mfma_f32_16x16x32_bf16 v[80:83], v[52:55], a[176:179], v[80:83]
v_mul_f32 v211, v211, v210
v_cvt_pk_bf16_f32 v170, v209, v211
v_mfma_f32_16x16x32_bf16 v[84:87], v[48:51], a[164:167], v[84:87]
ds_read_b128 v[72:75], v2 offset:14336
v_fma_f32 v212, v212, v241, v240
v_mfma_f32_16x16x32_bf16 v[84:87], v[52:55], a[180:183], v[84:87]
v_fma_f32 v214, v214, v241, v240
v_mul_f32 v212, v212, v122
v_mfma_f32_16x16x32_bf16 v[88:91], v[48:51], a[168:171], v[88:91]
v_mul_f32 v214, v214, v123
v_mul_f32 v213, v122, v138
v_mfma_f32_16x16x32_bf16 v[88:91], v[52:55], a[184:187], v[88:91]
ds_read_b128 v[76:79], v2 offset:15360
v_mul_f32 v215, v123, v139
v_mfma_f32_16x16x32_bf16 v[92:95], v[48:51], a[172:175], v[92:95]
v_exp_f32 v212, v212
v_mfma_f32_16x16x32_bf16 v[92:95], v[52:55], a[188:191], v[92:95]
v_fma_f32 v212, v212, v242, v242
s_waitcnt lgkmcnt(4)
v_mfma_f32_16x16x32_bf16 v[96:99], v[56:59], a[160:163], v[96:99]
v_exp_f32 v214, v214
v_mfma_f32_16x16x32_bf16 v[96:99], v[60:63], a[176:179], v[96:99]
v_fma_f32 v214, v214, v242, v242
v_mul_f32 v208, v124, v124
v_mfma_f32_16x16x32_bf16 v[100:103], v[56:59], a[164:167], v[100:103]
ds_read_b128 v[48:51], v2 offset:16384
v_mul_f32 v210, v125, v125
v_mfma_f32_16x16x32_bf16 v[100:103], v[60:63], a[180:183], v[100:103]
v_rcp_f32 v212, v212
v_mfma_f32_16x16x32_bf16 v[104:107], v[56:59], a[168:171], v[104:107]
v_rcp_f32 v214, v214
v_mfma_f32_16x16x32_bf16 v[104:107], v[60:63], a[184:187], v[104:107]
ds_read_b128 v[52:55], v2 offset:17408
v_mul_f32 v213, v213, v212
v_mfma_f32_16x16x32_bf16 v[108:111], v[56:59], a[172:175], v[108:111]
v_mul_f32 v215, v215, v214
v_cvt_pk_bf16_f32 v171, v213, v215
v_mfma_f32_16x16x32_bf16 v[108:111], v[60:63], a[188:191], v[108:111]
v_fma_f32 v208, v208, v245, v244
s_waitcnt lgkmcnt(4)
v_mfma_f32_16x16x32_bf16 v[80:83], v[64:67], a[192:195], v[80:83]
buffer_store_dwordx4 v[168:171], v5, s[8:11], s24 offen offset:1024 sc1
v_mfma_f32_16x16x32_bf16 v[80:83], v[68:71], a[208:211], v[80:83]
v_fma_f32 v210, v210, v245, v244
v_mul_f32 v208, v208, v124
v_mfma_f32_16x16x32_bf16 v[84:87], v[64:67], a[196:199], v[84:87]
ds_read_b128 v[56:59], v2 offset:18432
v_mul_f32 v210, v210, v125
v_mfma_f32_16x16x32_bf16 v[84:87], v[68:71], a[212:215], v[84:87]
v_exp_f32 v208, v208
v_mfma_f32_16x16x32_bf16 v[88:91], v[64:67], a[200:203], v[88:91]
v_exp_f32 v210, v210
v_mfma_f32_16x16x32_bf16 v[88:91], v[68:71], a[216:219], v[88:91]
ds_read_b128 v[60:63], v2 offset:19456
v_mul_f32 v209, v124, v140
v_mfma_f32_16x16x32_bf16 v[92:95], v[64:67], a[204:207], v[92:95]
v_mul_f32 v211, v125, v141
v_fma_f32 v208, v208, v246, v246
v_mfma_f32_16x16x32_bf16 v[92:95], v[68:71], a[220:223], v[92:95]
v_fma_f32 v210, v210, v246, v246
s_waitcnt lgkmcnt(4)
v_mfma_f32_16x16x32_bf16 v[96:99], v[72:75], a[192:195], v[96:99]
v_rcp_f32 v208, v208
v_mfma_f32_16x16x32_bf16 v[96:99], v[76:79], a[208:211], v[96:99]
v_rcp_f32 v210, v210
v_mfma_f32_16x16x32_bf16 v[100:103], v[72:75], a[196:199], v[100:103]
ds_read_b128 v[64:67], v2 offset:20480
v_mul_f32 v209, v209, v208
v_mfma_f32_16x16x32_bf16 v[100:103], v[76:79], a[212:215], v[100:103]
v_mul_f32 v211, v211, v210
v_cvt_pk_bf16_f32 v174, v209, v211
v_mfma_f32_16x16x32_bf16 v[104:107], v[72:75], a[200:203], v[104:107]
v_mul_f32 v212, v126, v126
v_mul_f32 v214, v127, v127
v_mfma_f32_16x16x32_bf16 v[104:107], v[76:79], a[216:219], v[104:107]
ds_read_b128 v[68:71], v2 offset:21504
v_fma_f32 v212, v212, v245, v244
v_mfma_f32_16x16x32_bf16 v[108:111], v[72:75], a[204:207], v[108:111]
v_fma_f32 v214, v214, v245, v244
v_mul_f32 v212, v212, v126
v_mfma_f32_16x16x32_bf16 v[108:111], v[76:79], a[220:223], v[108:111]
v_mul_f32 v214, v214, v127
s_waitcnt lgkmcnt(4)
v_mfma_f32_16x16x32_bf16 v[80:83], v[48:51], a[224:227], v[80:83]
v_exp_f32 v212, v212
v_mfma_f32_16x16x32_bf16 v[80:83], v[52:55], a[240:243], v[80:83]
v_exp_f32 v214, v214
v_mfma_f32_16x16x32_bf16 v[84:87], v[48:51], a[228:231], v[84:87]
ds_read_b128 v[72:75], v2 offset:22528
v_mul_f32 v213, v126, v142
v_mfma_f32_16x16x32_bf16 v[84:87], v[52:55], a[244:247], v[84:87]
v_mul_f32 v215, v127, v143
v_fma_f32 v212, v212, v246, v246
v_mfma_f32_16x16x32_bf16 v[88:91], v[48:51], a[232:235], v[88:91]
v_fma_f32 v214, v214, v246, v246
v_mul_f32 v219, v219, v218
v_mfma_f32_16x16x32_bf16 v[88:91], v[52:55], a[248:251], v[88:91]
ds_read_b128 v[76:79], v2 offset:23552
v_cvt_pk_bf16_f32 v154, v217, v219
v_mfma_f32_16x16x32_bf16 v[92:95], v[48:51], a[236:239], v[92:95]
v_rcp_f32 v212, v212
v_mfma_f32_16x16x32_bf16 v[92:95], v[52:55], a[252:255], v[92:95]
v_mul_f32 v213, v213, v212
s_waitcnt lgkmcnt(4)
v_mfma_f32_16x16x32_bf16 v[96:99], v[56:59], a[224:227], v[96:99]
s_waitcnt vmcnt(23)
v_mul_f32 v222, v187, v187
v_mfma_f32_16x16x32_bf16 v[96:99], v[60:63], a[240:243], v[96:99]
s_barrier
v_mfma_f32_16x16x32_bf16 v[100:103], v[56:59], a[228:231], v[100:103]
ds_read_b128 v[48:51], v2 offset:24576
s_add_u32 m0, s22, 122880
v_mfma_f32_16x16x32_bf16 v[100:103], v[60:63], a[244:247], v[100:103]
v_add_u32 v3, 20480, v3
buffer_load_dwordx4 v3, s[8:11], 0 offen offset:0 sc1 lds
v_mfma_f32_16x16x32_bf16 v[104:107], v[56:59], a[232:235], v[104:107]
v_rcp_f32 v214, v214
v_mfma_f32_16x16x32_bf16 v[104:107], v[60:63], a[248:251], v[104:107]
ds_read_b128 v[52:55], v2 offset:25600
v_mul_f32 v215, v215, v214
v_mfma_f32_16x16x32_bf16 v[108:111], v[56:59], a[236:239], v[108:111]
v_cvt_pk_bf16_f32 v175, v213, v215
v_fma_f32 v220, v220, v241, v240
v_mfma_f32_16x16x32_bf16 v[108:111], v[60:63], a[252:255], v[108:111]
v_fma_f32 v222, v222, v241, v240
s_waitcnt lgkmcnt(4)
v_mfma_f32_16x16x32_bf16 v[80:83], v[64:67], v[16:19], v[80:83]
buffer_load_dwordx4 v3, s[8:11], 0 offen offset:1024 sc1 lds
v_mfma_f32_16x16x32_bf16 v[80:83], v[68:71], v[32:35], v[80:83]
v_mul_f32 v220, v220, v186
v_mul_f32 v222, v222, v187
v_mfma_f32_16x16x32_bf16 v[84:87], v[64:67], v[20:23], v[84:87]
ds_read_b128 v[56:59], v2 offset:26624
v_mul_f32 v221, v186, v202
v_mfma_f32_16x16x32_bf16 v[84:87], v[68:71], v[36:39], v[84:87]
buffer_store_dwordx4 v[172:175], v6, s[8:11], s24 offen offset:1024 sc1
v_mfma_f32_16x16x32_bf16 v[88:91], v[64:67], v[24:27], v[88:91]
v_exp_f32 v220, v220
v_mfma_f32_16x16x32_bf16 v[88:91], v[68:71], v[40:43], v[88:91]
ds_read_b128 v[60:63], v2 offset:27648
v_mul_f32 v223, v187, v203
v_mfma_f32_16x16x32_bf16 v[92:95], v[64:67], v[28:31], v[92:95]
v_exp_f32 v222, v222
v_mfma_f32_16x16x32_bf16 v[92:95], v[68:71], v[44:47], v[92:95]
v_fma_f32 v220, v220, v242, v242
s_waitcnt lgkmcnt(4)
v_mfma_f32_16x16x32_bf16 v[96:99], v[72:75], v[16:19], v[96:99]
buffer_load_dwordx4 v3, s[8:11], 0 offen offset:2048 sc1 lds
L_hop7:
s_cmp_eq_u32 s15, 1
s_cbranch_scc1 L_hop11
v_mfma_f32_16x16x32_bf16 v[96:99], v[76:79], v[32:35], v[96:99]
v_fma_f32 v222, v222, v242, v242
v_mul_f32 v216, v188, v188
v_mfma_f32_16x16x32_bf16 v[100:103], v[72:75], v[20:23], v[100:103]
ds_read_b128 v[64:67], v2 offset:28672
v_mul_f32 v218, v189, v189
v_mfma_f32_16x16x32_bf16 v[100:103], v[76:79], v[36:39], v[100:103]
v_rcp_f32 v220, v220
v_mfma_f32_16x16x32_bf16 v[104:107], v[72:75], v[24:27], v[104:107]
v_rcp_f32 v222, v222
v_mfma_f32_16x16x32_bf16 v[104:107], v[76:79], v[40:43], v[104:107]
ds_read_b128 v[68:71], v2 offset:29696
v_mul_f32 v221, v221, v220
v_mfma_f32_16x16x32_bf16 v[108:111], v[72:75], v[28:31], v[108:111]
buffer_load_dwordx4 v3, s[8:11], 0 offen offset:3072 sc1 lds
v_mfma_f32_16x16x32_bf16 v[108:111], v[76:79], v[44:47], v[108:111]
s_add_u32 m0, s22, 126976
s_waitcnt lgkmcnt(4)
v_mfma_f32_16x16x32_bf16 v[112:115], v[48:51], a[0:3], 0
v_add_u32 v3, 4096, v3
v_mul_f32 v223, v223, v222
v_mfma_f32_16x16x32_bf16 v[112:115], v[52:55], a[16:19], v[112:115]
v_cvt_pk_bf16_f32 v155, v221, v223
v_fma_f32 v216, v216, v245, v244
v_mfma_f32_16x16x32_bf16 v[116:119], v[48:51], a[4:7], 0
ds_read_b128 v[72:75], v2 offset:30720
v_fma_f32 v218, v218, v245, v244
v_mfma_f32_16x16x32_bf16 v[116:119], v[52:55], a[20:23], v[116:119]
buffer_load_dwordx4 v3, s[8:11], 0 offen offset:0 sc1 lds
v_mfma_f32_16x16x32_bf16 v[120:123], v[48:51], a[8:11], 0
v_mul_f32 v216, v216, v188
v_mul_f32 v218, v218, v189
v_mfma_f32_16x16x32_bf16 v[120:123], v[52:55], a[24:27], v[120:123]
ds_read_b128 v[76:79], v2 offset:31744
v_mul_f32 v217, v188, v204
v_mfma_f32_16x16x32_bf16 v[124:127], v[48:51], a[12:15], 0
buffer_store_dwordx4 v[152:155], v5, s[8:11], s24 offen offset:0 sc1
v_mfma_f32_16x16x32_bf16 v[124:127], v[52:55], a[28:31], v[124:127]
v_mul_f32 v219, v189, v205
s_waitcnt lgkmcnt(4)
v_mfma_f32_16x16x32_bf16 v[128:131], v[56:59], a[0:3], 0
v_exp_f32 v216, v216
v_mfma_f32_16x16x32_bf16 v[128:131], v[60:63], a[16:19], v[128:131]
v_exp_f32 v218, v218
v_mfma_f32_16x16x32_bf16 v[132:135], v[56:59], a[4:7], 0
ds_read_b128 v[48:51], v2 offset:32768
v_fma_f32 v216, v216, v246, v246
v_mfma_f32_16x16x32_bf16 v[132:135], v[60:63], a[20:23], v[132:135]
buffer_load_dwordx4 v3, s[8:11], 0 offen offset:1024 sc1 lds
v_mfma_f32_16x16x32_bf16 v[136:139], v[56:59], a[8:11], 0
v_fma_f32 v218, v218, v246, v246
v_mul_f32 v220, v190, v190
v_mfma_f32_16x16x32_bf16 v[136:139], v[60:63], a[24:27], v[136:139]
ds_read_b128 v[52:55], v2 offset:33792
v_mul_f32 v222, v191, v191
v_mfma_f32_16x16x32_bf16 v[140:143], v[56:59], a[12:15], 0
v_rcp_f32 v216, v216
v_mfma_f32_16x16x32_bf16 v[140:143], v[60:63], a[28:31], v[140:143]
v_mul_f32 v217, v217, v216
s_waitcnt lgkmcnt(4)
v_mfma_f32_16x16x32_bf16 v[112:115], v[64:67], a[32:35], v[112:115]
v_rcp_f32 v218, v218
v_mfma_f32_16x16x32_bf16 v[112:115], v[68:71], a[48:51], v[112:115]
v_mul_f32 v219, v219, v218
v_cvt_pk_bf16_f32 v158, v217, v219
v_mfma_f32_16x16x32_bf16 v[116:119], v[64:67], a[36:39], v[116:119]
ds_read_b128 v[56:59], v2 offset:34816
v_fma_f32 v220, v220, v245, v244
v_mfma_f32_16x16x32_bf16 v[116:119], v[68:71], a[52:55], v[116:119]
v_fma_f32 v222, v222, v245, v244
v_mul_f32 v220, v220, v190
v_mfma_f32_16x16x32_bf16 v[120:123], v[64:67], a[40:43], v[120:123]
v_mul_f32 v222, v222, v191
v_mul_f32 v221, v190, v206
v_mfma_f32_16x16x32_bf16 v[120:123], v[68:71], a[56:59], v[120:123]
ds_read_b128 v[60:63], v2 offset:35840
v_mul_f32 v223, v191, v207
v_mfma_f32_16x16x32_bf16 v[124:127], v[64:67], a[44:47], v[124:127]
v_exp_f32 v220, v220
v_mfma_f32_16x16x32_bf16 v[124:127], v[68:71], a[60:63], v[124:127]
v_fma_f32 v220, v220, v246, v246
s_waitcnt lgkmcnt(4)
v_mfma_f32_16x16x32_bf16 v[128:131], v[72:75], a[32:35], v[128:131]
v_exp_f32 v222, v222
v_mfma_f32_16x16x32_bf16 v[128:131], v[76:79], a[48:51], v[128:131]
v_fma_f32 v222, v222, v246, v246
v_mfma_f32_16x16x32_bf16 v[132:135], v[72:75], a[36:39], v[132:135]
ds_read_b128 v[64:67], v2 offset:36864
v_mfma_f32_16x16x32_bf16 v[132:135], v[76:79], a[52:55], v[132:135]
v_rcp_f32 v220, v220
v_mfma_f32_16x16x32_bf16 v[136:139], v[72:75], a[40:43], v[136:139]
v_rcp_f32 v222, v222
v_mfma_f32_16x16x32_bf16 v[136:139], v[76:79], a[56:59], v[136:139]
ds_read_b128 v[68:71], v2 offset:37888
v_mul_f32 v221, v221, v220
v_mfma_f32_16x16x32_bf16 v[140:143], v[72:75], a[44:47], v[140:143]
v_mul_f32 v223, v223, v222
v_cvt_pk_bf16_f32 v159, v221, v223
v_mfma_f32_16x16x32_bf16 v[140:143], v[76:79], a[60:63], v[140:143]
s_waitcnt lgkmcnt(4)
v_mfma_f32_16x16x32_bf16 v[112:115], v[48:51], a[64:67], v[112:115]
buffer_store_dwordx4 v[156:159], v6, s[8:11], s24 offen offset:0 sc1
v_mfma_f32_16x16x32_bf16 v[112:115], v[52:55], a[80:83], v[112:115]
v_mul_f32 v208, v80, v80
v_mul_f32 v210, v81, v81
v_mfma_f32_16x16x32_bf16 v[116:119], v[48:51], a[68:71], v[116:119]
ds_read_b128 v[72:75], v2 offset:38912
v_fma_f32 v208, v208, v233, v232
v_mfma_f32_16x16x32_bf16 v[116:119], v[52:55], a[84:87], v[116:119]
v_fma_f32 v210, v210, v233, v232
v_mul_f32 v208, v208, v80
v_mfma_f32_16x16x32_bf16 v[120:123], v[48:51], a[72:75], v[120:123]
v_mul_f32 v210, v210, v81
v_mul_f32 v209, v80, v96
v_mfma_f32_16x16x32_bf16 v[120:123], v[52:55], a[88:91], v[120:123]
ds_read_b128 v[76:79], v2 offset:39936
v_mul_f32 v211, v81, v97
v_mfma_f32_16x16x32_bf16 v[124:127], v[48:51], a[76:79], v[124:127]
v_exp_f32 v208, v208
v_mfma_f32_16x16x32_bf16 v[124:127], v[52:55], a[92:95], v[124:127]
v_fma_f32 v208, v208, v234, v234
s_waitcnt lgkmcnt(4)
v_mfma_f32_16x16x32_bf16 v[128:131], v[56:59], a[64:67], v[128:131]
v_exp_f32 v210, v210
v_mfma_f32_16x16x32_bf16 v[128:131], v[60:63], a[80:83], v[128:131]
v_fma_f32 v210, v210, v234, v234
v_mul_f32 v212, v82, v82
v_mfma_f32_16x16x32_bf16 v[132:135], v[56:59], a[68:71], v[132:135]
ds_read_b128 v[48:51], v2 offset:40960
v_mul_f32 v214, v83, v83
v_mfma_f32_16x16x32_bf16 v[132:135], v[60:63], a[84:87], v[132:135]
v_rcp_f32 v208, v208
v_mfma_f32_16x16x32_bf16 v[136:139], v[56:59], a[72:75], v[136:139]
v_rcp_f32 v210, v210
v_mfma_f32_16x16x32_bf16 v[136:139], v[60:63], a[88:91], v[136:139]
ds_read_b128 v[52:55], v2 offset:41984
v_mul_f32 v209, v209, v208
v_mfma_f32_16x16x32_bf16 v[140:143], v[56:59], a[76:79], v[140:143]
v_mul_f32 v211, v211, v210
v_cvt_pk_bf16_f32 v176, v209, v211
v_mfma_f32_16x16x32_bf16 v[140:143], v[60:63], a[92:95], v[140:143]
v_fma_f32 v212, v212, v233, v232
s_waitcnt lgkmcnt(4)
v_mfma_f32_16x16x32_bf16 v[112:115], v[64:67], a[96:99], v[112:115]
v_fma_f32 v214, v214, v233, v232
v_mul_f32 v212, v212, v82
v_mfma_f32_16x16x32_bf16 v[112:115], v[68:71], a[112:115], v[112:115]
v_mul_f32 v214, v214, v83
v_mul_f32 v213, v82, v98
v_mfma_f32_16x16x32_bf16 v[116:119], v[64:67], a[100:103], v[116:119]
ds_read_b128 v[56:59], v2 offset:43008
v_mul_f32 v215, v83, v99
v_mfma_f32_16x16x32_bf16 v[116:119], v[68:71], a[116:119], v[116:119]
v_exp_f32 v212, v212
v_mfma_f32_16x16x32_bf16 v[120:123], v[64:67], a[104:107], v[120:123]
v_exp_f32 v214, v214
v_mfma_f32_16x16x32_bf16 v[120:123], v[68:71], a[120:123], v[120:123]
ds_read_b128 v[60:63], v2 offset:44032
v_fma_f32 v212, v212, v234, v234
v_mfma_f32_16x16x32_bf16 v[124:127], v[64:67], a[108:111], v[124:127]
v_fma_f32 v214, v214, v234, v234
v_mul_f32 v208, v84, v84
v_mfma_f32_16x16x32_bf16 v[124:127], v[68:71], a[124:127], v[124:127]
v_mul_f32 v210, v85, v85
s_waitcnt lgkmcnt(4)
v_mfma_f32_16x16x32_bf16 v[128:131], v[72:75], a[96:99], v[128:131]
v_rcp_f32 v212, v212
v_mfma_f32_16x16x32_bf16 v[128:131], v[76:79], a[112:115], v[128:131]
v_rcp_f32 v214, v214
v_mfma_f32_16x16x32_bf16 v[132:135], v[72:75], a[100:103], v[132:135]
ds_read_b128 v[64:67], v2 offset:45056
v_mul_f32 v213, v213, v212
v_mfma_f32_16x16x32_bf16 v[132:135], v[76:79], a[116:119], v[132:135]
v_mul_f32 v215, v215, v214
v_cvt_pk_bf16_f32 v177, v213, v215
v_mfma_f32_16x16x32_bf16 v[136:139], v[72:75], a[104:107], v[136:139]
v_fma_f32 v208, v208, v237, v236
v_fma_f32 v210, v210, v237, v236
v_mfma_f32_16x16x32_bf16 v[136:139], v[76:79], a[120:123], v[136:139]
ds_read_b128 v[68:71], v2 offset:46080
v_mul_f32 v208, v208, v84
v_mfma_f32_16x16x32_bf16 v[140:143], v[72:75], a[108:111], v[140:143]
v_mul_f32 v210, v210, v85
v_mul_f32 v209, v84, v100
v_mfma_f32_16x16x32_bf16 v[140:143], v[76:79], a[124:127], v[140:143]
v_mul_f32 v211, v85, v101
s_waitcnt lgkmcnt(4)
v_mfma_f32_16x16x32_bf16 v[112:115], v[48:51], a[128:131], v[112:115]
v_exp_f32 v208, v208
v_mfma_f32_16x16x32_bf16 v[112:115], v[52:55], a[144:147], v[112:115]
v_exp_f32 v210, v210
v_mfma_f32_16x16x32_bf16 v[116:119], v[48:51], a[132:135], v[116:119]
ds_read_b128 v[72:75], v2 offset:47104
v_fma_f32 v208, v208, v238, v238
v_mfma_f32_16x16x32_bf16 v[116:119], v[52:55], a[148:151], v[116:119]
v_fma_f32 v210, v210, v238, v238
v_mul_f32 v212, v86, v86
v_mfma_f32_16x16x32_bf16 v[120:123], v[48:51], a[136:139], v[120:123]
v_rcp_f32 v208, v208
v_mfma_f32_16x16x32_bf16 v[120:123], v[52:55], a[152:155], v[120:123]
ds_read_b128 v[76:79], v2 offset:48128
v_mul_f32 v209, v209, v208
v_mfma_f32_16x16x32_bf16 v[124:127], v[48:51], a[140:143], v[124:127]
v_rcp_f32 v210, v210
v_mfma_f32_16x16x32_bf16 v[124:127], v[52:55], a[156:159], v[124:127]
v_mul_f32 v211, v211, v210
s_waitcnt lgkmcnt(4)
v_mfma_f32_16x16x32_bf16 v[128:131], v[56:59], a[128:131], v[128:131]
s_waitcnt vmcnt(25)
v_cvt_pk_bf16_f32 v180, v209, v211
v_mfma_f32_16x16x32_bf16 v[128:131], v[60:63], a[144:147], v[128:131]
s_barrier
v_mfma_f32_16x16x32_bf16 v[132:135], v[56:59], a[132:135], v[132:135]
ds_read_b128 v[48:51], v2 offset:49152
s_add_u32 m0, s22, 0
v_mfma_f32_16x16x32_bf16 v[132:135], v[60:63], a[148:151], v[132:135]
v_add_u32 v3, 20480, v3
buffer_load_dwordx4 v3, s[8:11], 0 offen offset:0 sc1 lds
v_mfma_f32_16x16x32_bf16 v[136:139], v[56:59], a[136:139], v[136:139]
v_mul_f32 v214, v87, v87
v_fma_f32 v212, v212, v237, v236
v_mfma_f32_16x16x32_bf16 v[136:139], v[60:63], a[152:155], v[136:139]
ds_read_b128 v[52:55], v2 offset:50176
v_fma_f32 v214, v214, v237, v236
v_mfma_f32_16x16x32_bf16 v[140:143], v[56:59], a[140:143], v[140:143]
v_mul_f32 v212, v212, v86
v_mul_f32 v214, v214, v87
v_mfma_f32_16x16x32_bf16 v[140:143], v[60:63], a[156:159], v[140:143]
v_mul_f32 v213, v86, v102
s_waitcnt lgkmcnt(4)
v_mfma_f32_16x16x32_bf16 v[112:115], v[64:67], a[160:163], v[112:115]
buffer_load_dwordx4 v3, s[8:11], 0 offen offset:1024 sc1 lds
v_mfma_f32_16x16x32_bf16 v[112:115], v[68:71], a[176:179], v[112:115]
v_exp_f32 v212, v212
v_mfma_f32_16x16x32_bf16 v[116:119], v[64:67], a[164:167], v[116:119]
ds_read_b128 v[56:59], v2 offset:51200
v_mul_f32 v215, v87, v103
v_mfma_f32_16x16x32_bf16 v[116:119], v[68:71], a[180:183], v[116:119]
v_exp_f32 v214, v214
v_mfma_f32_16x16x32_bf16 v[120:123], v[64:67], a[168:171], v[120:123]
v_fma_f32 v212, v212, v238, v238
v_fma_f32 v214, v214, v238, v238
v_mfma_f32_16x16x32_bf16 v[120:123], v[68:71], a[184:187], v[120:123]
ds_read_b128 v[60:63], v2 offset:52224
v_mul_f32 v208, v88, v88
v_mfma_f32_16x16x32_bf16 v[124:127], v[64:67], a[172:175], v[124:127]
buffer_load_dwordx4 v3, s[8:11], 0 offen offset:2048 sc1 lds
v_mfma_f32_16x16x32_bf16 v[124:127], v[68:71], a[188:191], v[124:127]
v_mul_f32 v210, v89, v89
s_waitcnt lgkmcnt(4)
v_mfma_f32_16x16x32_bf16 v[128:131], v[72:75], a[160:163], v[128:131]
v_rcp_f32 v212, v212
v_mfma_f32_16x16x32_bf16 v[128:131], v[76:79], a[176:179], v[128:131]
v_rcp_f32 v214, v214
v_mfma_f32_16x16x32_bf16 v[132:135], v[72:75], a[164:167], v[132:135]
ds_read_b128 v[64:67], v2 offset:53248
v_mul_f32 v213, v213, v212
v_mfma_f32_16x16x32_bf16 v[132:135], v[76:79], a[180:183], v[132:135]
buffer_load_dwordx4 v3, s[8:11], 0 offen offset:3072 sc1 lds
v_mfma_f32_16x16x32_bf16 v[136:139], v[72:75], a[168:171], v[136:139]
s_add_u32 m0, s22, 4096
v_add_u32 v3, 4096, v3
v_mfma_f32_16x16x32_bf16 v[136:139], v[76:79], a[184:187], v[136:139]
ds_read_b128 v[68:71], v2 offset:54272
v_mul_f32 v215, v215, v214
v_mfma_f32_16x16x32_bf16 v[140:143], v[72:75], a[172:175], v[140:143]
v_cvt_pk_bf16_f32 v181, v213, v215
v_fma_f32 v208, v208, v241, v240
v_mfma_f32_16x16x32_bf16 v[140:143], v[76:79], a[188:191], v[140:143]
v_fma_f32 v210, v210, v241, v240
s_waitcnt lgkmcnt(4)
v_mfma_f32_16x16x32_bf16 v[112:115], v[48:51], a[192:195], v[112:115]
buffer_load_dwordx4 v3, s[8:11], 0 offen offset:0 sc1 lds
v_mfma_f32_16x16x32_bf16 v[112:115], v[52:55], a[208:211], v[112:115]
v_mul_f32 v208, v208, v88
v_mul_f32 v210, v210, v89
v_mfma_f32_16x16x32_bf16 v[116:119], v[48:51], a[196:199], v[116:119]
ds_read_b128 v[72:75], v2 offset:55296
v_mul_f32 v209, v88, v104
v_mfma_f32_16x16x32_bf16 v[116:119], v[52:55], a[212:215], v[116:119]
v_exp_f32 v208, v208
v_mfma_f32_16x16x32_bf16 v[120:123], v[48:51], a[200:203], v[120:123]
v_exp_f32 v210, v210
v_mfma_f32_16x16x32_bf16 v[120:123], v[52:55], a[216:219], v[120:123]
ds_read_b128 v[76:79], v2 offset:56320
v_mul_f32 v211, v89, v105
v_mfma_f32_16x16x32_bf16 v[124:127], v[48:51], a[204:207], v[124:127]
buffer_load_dwordx4 v3, s[8:11], 0 offen offset:1024 sc1 lds
v_mfma_f32_16x16x32_bf16 v[124:127], v[52:55], a[220:223], v[124:127]
v_fma_f32 v208, v208, v242, v242
s_waitcnt lgkmcnt(4)
v_mfma_f32_16x16x32_bf16 v[128:131], v[56:59], a[192:195], v[128:131]
v_mov_b32 v12, s68
v_mov_b32 v13, s69
v_mfma_f32_16x16x32_bf16 v[128:131], v[60:63], a[208:211], v[128:131]
s_add_u32 s53, s34, 0
s_waitcnt vmcnt(6)
v_fma_f32 v210, v210, v242, v242
v_mfma_f32_16x16x32_bf16 v[132:135], v[56:59], a[196:199], v[132:135]
ds_read_b128 v[48:51], v2 offset:57344
v_rcp_f32 v208, v208
v_mfma_f32_16x16x32_bf16 v[132:135], v[60:63], a[212:215], v[132:135]
buffer_store_dwordx2 v[12:13], v10, s[8:11], s53 offen sc1
v_rcp_f32 v210, v210
v_mfma_f32_16x16x32_bf16 v[136:139], v[56:59], a[200:203], v[136:139]
v_mul_f32 v209, v209, v208
v_mul_f32 v211, v211, v210
v_mfma_f32_16x16x32_bf16 v[136:139], v[60:63], a[216:219], v[136:139]
ds_read_b128 v[52:55], v2 offset:58368
v_cvt_pk_bf16_f32 v184, v209, v211
v_mfma_f32_16x16x32_bf16 v[140:143], v[56:59], a[204:207], v[140:143]
v_mul_f32 v212, v90, v90
v_mul_f32 v214, v91, v91
v_mfma_f32_16x16x32_bf16 v[140:143], v[60:63], a[220:223], v[140:143]
v_fma_f32 v212, v212, v241, v240
s_waitcnt lgkmcnt(4)
v_mfma_f32_16x16x32_bf16 v[112:115], v[64:67], a[224:227], v[112:115]
v_fma_f32 v214, v214, v241, v240
v_mul_f32 v212, v212, v90
v_mfma_f32_16x16x32_bf16 v[112:115], v[68:71], a[240:243], v[112:115]
v_mul_f32 v214, v214, v91
v_exp_f32 v212, v212
v_mfma_f32_16x16x32_bf16 v[116:119], v[64:67], a[228:231], v[116:119]
ds_read_b128 v[56:59], v2 offset:59392
v_exp_f32 v214, v214
v_mfma_f32_16x16x32_bf16 v[116:119], v[68:71], a[244:247], v[116:119]
v_mul_f32 v213, v90, v106
v_mul_f32 v215, v91, v107
v_mfma_f32_16x16x32_bf16 v[120:123], v[64:67], a[232:235], v[120:123]
v_fma_f32 v212, v212, v242, v242
v_fma_f32 v214, v214, v242, v242
v_mfma_f32_16x16x32_bf16 v[120:123], v[68:71], a[248:251], v[120:123]
ds_read_b128 v[60:63], v2 offset:60416
v_rcp_f32 v212, v212
v_mfma_f32_16x16x32_bf16 v[124:127], v[64:67], a[236:239], v[124:127]
v_rcp_f32 v214, v214
v_mfma_f32_16x16x32_bf16 v[124:127], v[68:71], a[252:255], v[124:127]
v_mul_f32 v213, v213, v212
s_waitcnt lgkmcnt(4)
v_mfma_f32_16x16x32_bf16 v[128:131], v[72:75], a[224:227], v[128:131]
v_mul_f32 v215, v215, v214
v_cvt_pk_bf16_f32 v185, v213, v215
v_mfma_f32_16x16x32_bf16 v[128:131], v[76:79], a[240:243], v[128:131]
v_mul_f32 v208, v92, v92
v_mul_f32 v210, v93, v93
v_mfma_f32_16x16x32_bf16 v[132:135], v[72:75], a[228:231], v[132:135]
ds_read_b128 v[64:67], v2 offset:61440
v_fma_f32 v208, v208, v245, v244
v_mfma_f32_16x16x32_bf16 v[132:135], v[76:79], a[244:247], v[132:135]
v_fma_f32 v210, v210, v245, v244
v_mul_f32 v208, v208, v92
v_mfma_f32_16x16x32_bf16 v[136:139], v[72:75], a[232:235], v[136:139]
v_mul_f32 v210, v210, v93
v_exp_f32 v208, v208
v_mfma_f32_16x16x32_bf16 v[136:139], v[76:79], a[248:251], v[136:139]
ds_read_b128 v[68:71], v2 offset:62464
v_exp_f32 v210, v210
v_mfma_f32_16x16x32_bf16 v[140:143], v[72:75], a[236:239], v[140:143]
v_mul_f32 v209, v92, v108
v_mul_f32 v211, v93, v109
v_mfma_f32_16x16x32_bf16 v[140:143], v[76:79], a[252:255], v[140:143]
v_fma_f32 v208, v208, v246, v246
s_waitcnt lgkmcnt(4)
v_mfma_f32_16x16x32_bf16 v[112:115], v[48:51], v[16:19], v[112:115]
v_fma_f32 v210, v210, v246, v246
v_rcp_f32 v208, v208
v_mfma_f32_16x16x32_bf16 v[112:115], v[52:55], v[32:35], v[112:115]
v_rcp_f32 v210, v210
v_mfma_f32_16x16x32_bf16 v[116:119], v[48:51], v[20:23], v[116:119]
ds_read_b128 v[72:75], v2 offset:63488
v_mul_f32 v209, v209, v208
v_mfma_f32_16x16x32_bf16 v[116:119], v[52:55], v[36:39], v[116:119]
v_mul_f32 v211, v211, v210
v_cvt_pk_bf16_f32 v188, v209, v211
v_mfma_f32_16x16x32_bf16 v[120:123], v[48:51], v[24:27], v[120:123]
v_mul_f32 v212, v94, v94
v_mul_f32 v214, v95, v95
v_mfma_f32_16x16x32_bf16 v[120:123], v[52:55], v[40:43], v[120:123]
ds_read_b128 v[76:79], v2 offset:64512
v_fma_f32 v212, v212, v245, v244
v_mfma_f32_16x16x32_bf16 v[124:127], v[48:51], v[28:31], v[124:127]
v_fma_f32 v214, v214, v245, v244
v_mul_f32 v212, v212, v94
v_mfma_f32_16x16x32_bf16 v[124:127], v[52:55], v[44:47], v[124:127]
v_mul_f32 v214, v214, v95
s_waitcnt lgkmcnt(4)
v_mfma_f32_16x16x32_bf16 v[128:131], v[56:59], v[16:19], v[128:131]
v_exp_f32 v212, v212
v_mfma_f32_16x16x32_bf16 v[128:131], v[60:63], v[32:35], v[128:131]
v_exp_f32 v214, v214
v_mfma_f32_16x16x32_bf16 v[132:135], v[56:59], v[20:23], v[132:135]
ds_read_b128 v[48:51], v7 offset:0
v_mul_f32 v213, v94, v110
v_mfma_f32_16x16x32_bf16 v[132:135], v[60:63], v[36:39], v[132:135]
v_mul_f32 v215, v95, v111
v_fma_f32 v212, v212, v246, v246
v_mfma_f32_16x16x32_bf16 v[136:139], v[56:59], v[24:27], v[136:139]
v_fma_f32 v214, v214, v246, v246
v_rcp_f32 v212, v212
v_mfma_f32_16x16x32_bf16 v[136:139], v[60:63], v[40:43], v[136:139]
ds_read_b128 v[52:55], v7 offset:1024
v_rcp_f32 v214, v214
v_mfma_f32_16x16x32_bf16 v[140:143], v[56:59], v[28:31], v[140:143]
v_mul_f32 v213, v213, v212
v_mul_f32 v215, v215, v214
v_mfma_f32_16x16x32_bf16 v[140:143], v[60:63], v[44:47], v[140:143]
v_cvt_pk_bf16_f32 v189, v213, v215
s_waitcnt lgkmcnt(4)
v_mfma_f32_16x16x32_bf16 v[80:83], v[64:67], a[0:3], 0
v_mfma_f32_16x16x32_bf16 v[80:83], v[68:71], a[16:19], v[80:83]
v_mfma_f32_16x16x32_bf16 v[84:87], v[64:67], a[4:7], 0
ds_read_b128 v[56:59], v7 offset:2048
v_mfma_f32_16x16x32_bf16 v[84:87], v[68:71], a[20:23], v[84:87]
v_mul_f32 v208, v112, v112
v_mul_f32 v210, v113, v113
v_mfma_f32_16x16x32_bf16 v[88:91], v[64:67], a[8:11], 0
v_fma_f32 v208, v208, v233, v232
v_fma_f32 v210, v210, v233, v232
v_mfma_f32_16x16x32_bf16 v[88:91], v[68:71], a[24:27], v[88:91]
ds_read_b128 v[60:63], v7 offset:3072
v_mul_f32 v208, v208, v112
v_mfma_f32_16x16x32_bf16 v[92:95], v[64:67], a[12:15], 0
v_mul_f32 v210, v210, v113
v_mul_f32 v209, v112, v128
v_mfma_f32_16x16x32_bf16 v[92:95], v[68:71], a[28:31], v[92:95]
v_mul_f32 v211, v113, v129
s_waitcnt lgkmcnt(4)
v_mfma_f32_16x16x32_bf16 v[96:99], v[72:75], a[0:3], 0
v_exp_f32 v208, v208
v_mfma_f32_16x16x32_bf16 v[96:99], v[76:79], a[16:19], v[96:99]
v_exp_f32 v210, v210
v_mfma_f32_16x16x32_bf16 v[100:103], v[72:75], a[4:7], 0
ds_read_b128 v[64:67], v7 offset:4096
v_fma_f32 v208, v208, v234, v234
v_mfma_f32_16x16x32_bf16 v[100:103], v[76:79], a[20:23], v[100:103]
v_fma_f32 v210, v210, v234, v234
v_mul_f32 v212, v114, v114
v_mfma_f32_16x16x32_bf16 v[104:107], v[72:75], a[8:11], 0
v_rcp_f32 v208, v208
v_mfma_f32_16x16x32_bf16 v[104:107], v[76:79], a[24:27], v[104:107]
ds_read_b128 v[68:71], v7 offset:5120
v_mul_f32 v209, v209, v208
v_mfma_f32_16x16x32_bf16 v[108:111], v[72:75], a[12:15], 0
v_rcp_f32 v210, v210
v_mfma_f32_16x16x32_bf16 v[108:111], v[76:79], a[28:31], v[108:111]
v_mul_f32 v211, v211, v210
s_waitcnt lgkmcnt(4)
v_mfma_f32_16x16x32_bf16 v[80:83], v[48:51], a[32:35], v[80:83]
v_cvt_pk_bf16_f32 v178, v209, v211
v_mul_f32 v214, v115, v115
v_mfma_f32_16x16x32_bf16 v[80:83], v[52:55], a[48:51], v[80:83]
v_fma_f32 v212, v212, v233, v232
v_fma_f32 v214, v214, v233, v232
v_mfma_f32_16x16x32_bf16 v[84:87], v[48:51], a[36:39], v[84:87]
ds_read_b128 v[72:75], v7 offset:6144
v_mul_f32 v212, v212, v114
v_mfma_f32_16x16x32_bf16 v[84:87], v[52:55], a[52:55], v[84:87]
v_mul_f32 v214, v214, v115
v_mul_f32 v213, v114, v130
v_mfma_f32_16x16x32_bf16 v[88:91], v[48:51], a[40:43], v[88:91]
v_exp_f32 v212, v212
v_mfma_f32_16x16x32_bf16 v[88:91], v[52:55], a[56:59], v[88:91]
ds_read_b128 v[76:79], v7 offset:7168
v_mul_f32 v215, v115, v131
v_mfma_f32_16x16x32_bf16 v[92:95], v[48:51], a[44:47], v[92:95]
v_exp_f32 v214, v214
v_mfma_f32_16x16x32_bf16 v[92:95], v[52:55], a[60:63], v[92:95]
v_fma_f32 v212, v212, v234, v234
s_waitcnt lgkmcnt(4)
v_mfma_f32_16x16x32_bf16 v[96:99], v[56:59], a[32:35], v[96:99]
s_waitcnt vmcnt(26)
v_fma_f32 v214, v214, v234, v234
v_mfma_f32_16x16x32_bf16 v[96:99], v[60:63], a[48:51], v[96:99]
s_barrier
v_mfma_f32_16x16x32_bf16 v[100:103], v[56:59], a[36:39], v[100:103]
ds_read_b128 v[48:51], v7 offset:8192
s_add_u32 m0, s22, 24576
v_mfma_f32_16x16x32_bf16 v[100:103], v[60:63], a[52:55], v[100:103]
v_add_u32 v3, 20480, v3
buffer_load_dwordx4 v3, s[8:11], 0 offen offset:0 sc1 lds
v_mfma_f32_16x16x32_bf16 v[104:107], v[56:59], a[40:43], v[104:107]
v_rcp_f32 v212, v212
v_mfma_f32_16x16x32_bf16 v[104:107], v[60:63], a[56:59], v[104:107]
ds_read_b128 v[52:55], v7 offset:9216
v_mul_f32 v213, v213, v212
v_mfma_f32_16x16x32_bf16 v[108:111], v[56:59], a[44:47], v[108:111]
v_rcp_f32 v214, v214
v_mfma_f32_16x16x32_bf16 v[108:111], v[60:63], a[60:63], v[108:111]
v_mul_f32 v215, v215, v214
s_waitcnt lgkmcnt(4)
v_mfma_f32_16x16x32_bf16 v[80:83], v[64:67], a[64:67], v[80:83]
buffer_load_dwordx4 v3, s[8:11], 0 offen offset:1024 sc1 lds
v_mfma_f32_16x16x32_bf16 v[80:83], v[68:71], a[80:83], v[80:83]
v_cvt_pk_bf16_f32 v179, v213, v215
v_mul_f32 v208, v116, v116
v_mfma_f32_16x16x32_bf16 v[84:87], v[64:67], a[68:71], v[84:87]
ds_read_b128 v[56:59], v7 offset:10240
v_mul_f32 v210, v117, v117
v_mfma_f32_16x16x32_bf16 v[84:87], v[68:71], a[84:87], v[84:87]
buffer_store_dwordx4 v[176:179], v2, s[8:11], s24 offen offset:2048 sc1
v_mfma_f32_16x16x32_bf16 v[88:91], v[64:67], a[72:75], v[88:91]
v_fma_f32 v208, v208, v237, v236
v_fma_f32 v210, v210, v237, v236
v_mfma_f32_16x16x32_bf16 v[88:91], v[68:71], a[88:91], v[88:91]
ds_read_b128 v[60:63], v7 offset:11264
v_mul_f32 v208, v208, v116
v_mfma_f32_16x16x32_bf16 v[92:95], v[64:67], a[76:79], v[92:95]
v_mul_f32 v210, v210, v117
v_mul_f32 v209, v116, v132
v_mfma_f32_16x16x32_bf16 v[92:95], v[68:71], a[92:95], v[92:95]
v_mul_f32 v211, v117, v133
s_waitcnt lgkmcnt(4)
v_mfma_f32_16x16x32_bf16 v[96:99], v[72:75], a[64:67], v[96:99]
buffer_load_dwordx4 v3, s[8:11], 0 offen offset:2048 sc1 lds
v_mfma_f32_16x16x32_bf16 v[96:99], v[76:79], a[80:83], v[96:99]
v_exp_f32 v208, v208
v_mfma_f32_16x16x32_bf16 v[100:103], v[72:75], a[68:71], v[100:103]
ds_read_b128 v[64:67], v7 offset:12288
v_fma_f32 v208, v208, v238, v238
v_mfma_f32_16x16x32_bf16 v[100:103], v[76:79], a[84:87], v[100:103]
v_exp_f32 v210, v210
v_mfma_f32_16x16x32_bf16 v[104:107], v[72:75], a[72:75], v[104:107]
v_fma_f32 v210, v210, v238, v238
v_mul_f32 v212, v118, v118
v_mfma_f32_16x16x32_bf16 v[104:107], v[76:79], a[88:91], v[104:107]
ds_read_b128 v[68:71], v7 offset:13312
v_mul_f32 v214, v119, v119
v_mfma_f32_16x16x32_bf16 v[108:111], v[72:75], a[76:79], v[108:111]
buffer_load_dwordx4 v3, s[8:11], 0 offen offset:3072 sc1 lds
v_mfma_f32_16x16x32_bf16 v[108:111], v[76:79], a[92:95], v[108:111]
s_add_u32 m0, s22, 28672
s_waitcnt lgkmcnt(4)
v_mfma_f32_16x16x32_bf16 v[80:83], v[48:51], a[96:99], v[80:83]
s_add_u32 s23, s34, 0
v_fma_f32 v212, v212, v237, v236
v_mfma_f32_16x16x32_bf16 v[80:83], v[52:55], a[112:115], v[80:83]
v_rcp_f32 v208, v208
v_mfma_f32_16x16x32_bf16 v[84:87], v[48:51], a[100:103], v[84:87]
ds_read_b128 v[72:75], v7 offset:14336
v_mul_f32 v209, v209, v208
v_mfma_f32_16x16x32_bf16 v[84:87], v[52:55], a[116:119], v[84:87]
buffer_load_dwordx2 v[14:15], v11, s[8:11], s23 offen sc1
v_mfma_f32_16x16x32_bf16 v[88:91], v[48:51], a[104:107], v[88:91]
v_add_u32 v3, 4096, v3
v_fma_f32 v214, v214, v237, v236
v_mfma_f32_16x16x32_bf16 v[88:91], v[52:55], a[120:123], v[88:91]
ds_read_b128 v[76:79], v7 offset:15360
v_mul_f32 v212, v212, v118
v_mfma_f32_16x16x32_bf16 v[92:95], v[48:51], a[108:111], v[92:95]
v_rcp_f32 v210, v210
v_mfma_f32_16x16x32_bf16 v[92:95], v[52:55], a[124:127], v[92:95]
v_mul_f32 v211, v211, v210
s_waitcnt lgkmcnt(4)
v_mfma_f32_16x16x32_bf16 v[96:99], v[56:59], a[96:99], v[96:99]
buffer_load_dwordx4 v3, s[8:11], 0 offen offset:0 sc1 lds
v_mfma_f32_16x16x32_bf16 v[96:99], v[60:63], a[112:115], v[96:99]
v_cvt_pk_bf16_f32 v182, v209, v211
v_mul_f32 v214, v214, v119
v_mfma_f32_16x16x32_bf16 v[100:103], v[56:59], a[100:103], v[100:103]
ds_read_b128 v[48:51], v7 offset:16384
v_mul_f32 v213, v118, v134
v_mfma_f32_16x16x32_bf16 v[100:103], v[60:63], a[116:119], v[100:103]
v_exp_f32 v212, v212
v_mfma_f32_16x16x32_bf16 v[104:107], v[56:59], a[104:107], v[104:107]
v_exp_f32 v214, v214
v_mfma_f32_16x16x32_bf16 v[104:107], v[60:63], a[120:123], v[104:107]
ds_read_b128 v[52:55], v7 offset:17408
v_mul_f32 v215, v119, v135
v_mfma_f32_16x16x32_bf16 v[108:111], v[56:59], a[108:111], v[108:111]
buffer_load_dwordx4 v3, s[8:11], 0 offen offset:1024 sc1 lds
v_mfma_f32_16x16x32_bf16 v[108:111], v[60:63], a[124:127], v[108:111]
v_fma_f32 v212, v212, v238, v238
s_waitcnt lgkmcnt(4)
v_mfma_f32_16x16x32_bf16 v[80:83], v[64:67], a[128:131], v[80:83]
v_fma_f32 v214, v214, v238, v238
v_mul_f32 v208, v120, v120
v_mfma_f32_16x16x32_bf16 v[80:83], v[68:71], a[144:147], v[80:83]
v_rcp_f32 v212, v212
v_mfma_f32_16x16x32_bf16 v[84:87], v[64:67], a[132:135], v[84:87]
ds_read_b128 v[56:59], v7 offset:18432
v_mul_f32 v213, v213, v212
v_mfma_f32_16x16x32_bf16 v[84:87], v[68:71], a[148:151], v[84:87]
v_rcp_f32 v214, v214
v_mfma_f32_16x16x32_bf16 v[88:91], v[64:67], a[136:139], v[88:91]
v_mul_f32 v215, v215, v214
v_cvt_pk_bf16_f32 v183, v213, v215
v_mfma_f32_16x16x32_bf16 v[88:91], v[68:71], a[152:155], v[88:91]
ds_read_b128 v[60:63], v7 offset:19456
v_mul_f32 v210, v121, v121
v_mfma_f32_16x16x32_bf16 v[92:95], v[64:67], a[140:143], v[92:95]
buffer_store_dwordx4 v[180:183], v4, s[8:11], s24 offen offset:2048 sc1
v_mfma_f32_16x16x32_bf16 v[92:95], v[68:71], a[156:159], v[92:95]
v_fma_f32 v208, v208, v241, v240
s_waitcnt lgkmcnt(4)
v_mfma_f32_16x16x32_bf16 v[96:99], v[72:75], a[128:131], v[96:99]
v_fma_f32 v210, v210, v241, v240
v_mul_f32 v208, v208, v120
v_mfma_f32_16x16x32_bf16 v[96:99], v[76:79], a[144:147], v[96:99]
v_mul_f32 v210, v210, v121
v_mul_f32 v209, v120, v136
v_mfma_f32_16x16x32_bf16 v[100:103], v[72:75], a[132:135], v[100:103]
ds_read_b128 v[64:67], v7 offset:20480
v_mul_f32 v211, v121, v137
v_mfma_f32_16x16x32_bf16 v[100:103], v[76:79], a[148:151], v[100:103]
v_exp_f32 v208, v208
v_mfma_f32_16x16x32_bf16 v[104:107], v[72:75], a[136:139], v[104:107]
v_exp_f32 v210, v210
v_mfma_f32_16x16x32_bf16 v[104:107], v[76:79], a[152:155], v[104:107]
ds_read_b128 v[68:71], v7 offset:21504
v_fma_f32 v208, v208, v242, v242
v_mfma_f32_16x16x32_bf16 v[108:111], v[72:75], a[140:143], v[108:111]
v_fma_f32 v210, v210, v242, v242
v_mul_f32 v212, v122, v122
v_mfma_f32_16x16x32_bf16 v[108:111], v[76:79], a[156:159], v[108:111]
v_mul_f32 v214, v123, v123
s_waitcnt lgkmcnt(4)
v_mfma_f32_16x16x32_bf16 v[80:83], v[48:51], a[160:163], v[80:83]
v_rcp_f32 v208, v208
v_mfma_f32_16x16x32_bf16 v[80:83], v[52:55], a[176:179], v[80:83]
v_rcp_f32 v210, v210
v_mfma_f32_16x16x32_bf16 v[84:87], v[48:51], a[164:167], v[84:87]
ds_read_b128 v[72:75], v7 offset:22528
L_hop8:
s_cmp_eq_u32 s15, 1
s_cbranch_scc1 L_hop12
v_mul_f32 v209, v209, v208
v_mfma_f32_16x16x32_bf16 v[84:87], v[52:55], a[180:183], v[84:87]
v_mul_f32 v211, v211, v210
v_cvt_pk_bf16_f32 v186, v209, v211
v_mfma_f32_16x16x32_bf16 v[88:91], v[48:51], a[168:171], v[88:91]
v_fma_f32 v212, v212, v241, v240
v_fma_f32 v214, v214, v241, v240
v_mfma_f32_16x16x32_bf16 v[88:91], v[52:55], a[184:187], v[88:91]
ds_read_b128 v[76:79], v7 offset:23552
v_mul_f32 v212, v212, v122
v_mfma_f32_16x16x32_bf16 v[92:95], v[48:51], a[172:175], v[92:95]
v_mul_f32 v214, v214, v123
v_mul_f32 v213, v122, v138
v_mfma_f32_16x16x32_bf16 v[92:95], v[52:55], a[188:191], v[92:95]
v_mul_f32 v215, v123, v139
s_waitcnt lgkmcnt(4)
v_mfma_f32_16x16x32_bf16 v[96:99], v[56:59], a[160:163], v[96:99]
v_exp_f32 v212, v212
v_mfma_f32_16x16x32_bf16 v[96:99], v[60:63], a[176:179], v[96:99]
v_exp_f32 v214, v214
v_mfma_f32_16x16x32_bf16 v[100:103], v[56:59], a[164:167], v[100:103]
ds_read_b128 v[48:51], v7 offset:24576
v_fma_f32 v212, v212, v242, v242
v_mfma_f32_16x16x32_bf16 v[100:103], v[60:63], a[180:183], v[100:103]
v_fma_f32 v214, v214, v242, v242
v_mul_f32 v208, v124, v124
v_mfma_f32_16x16x32_bf16 v[104:107], v[56:59], a[168:171], v[104:107]
v_rcp_f32 v212, v212
v_mfma_f32_16x16x32_bf16 v[104:107], v[60:63], a[184:187], v[104:107]
ds_read_b128 v[52:55], v7 offset:25600
v_mfma_f32_16x16x32_bf16 v[108:111], v[56:59], a[172:175], v[108:111]
v_rcp_f32 v214, v214
v_mfma_f32_16x16x32_bf16 v[108:111], v[60:63], a[188:191], v[108:111]
s_waitcnt lgkmcnt(4)
v_mfma_f32_16x16x32_bf16 v[80:83], v[64:67], a[192:195], v[80:83]
v_mul_f32 v213, v213, v212
v_mul_f32 v215, v215, v214
v_mfma_f32_16x16x32_bf16 v[80:83], v[68:71], a[208:211], v[80:83]
v_cvt_pk_bf16_f32 v187, v213, v215
v_mul_f32 v210, v125, v125
v_mfma_f32_16x16x32_bf16 v[84:87], v[64:67], a[196:199], v[84:87]
ds_read_b128 v[56:59], v7 offset:26624
v_mfma_f32_16x16x32_bf16 v[84:87], v[68:71], a[212:215], v[84:87]
buffer_store_dwordx4 v[184:187], v5, s[8:11], s24 offen offset:2048 sc1
v_mfma_f32_16x16x32_bf16 v[88:91], v[64:67], a[200:203], v[88:91]
v_mfma_f32_16x16x32_bf16 v[88:91], v[68:71], a[216:219], v[88:91]
ds_read_b128 v[60:63], v7 offset:27648
v_fma_f32 v208, v208, v245, v244
v_mfma_f32_16x16x32_bf16 v[92:95], v[64:67], a[204:207], v[92:95]
v_fma_f32 v210, v210, v245, v244
v_mul_f32 v208, v208, v124
v_mfma_f32_16x16x32_bf16 v[92:95], v[68:71], a[220:223], v[92:95]
v_mul_f32 v210, v210, v125
s_waitcnt lgkmcnt(4)
v_mfma_f32_16x16x32_bf16 v[96:99], v[72:75], a[192:195], v[96:99]
v_exp_f32 v208, v208
v_mfma_f32_16x16x32_bf16 v[96:99], v[76:79], a[208:211], v[96:99]
v_mfma_f32_16x16x32_bf16 v[100:103], v[72:75], a[196:199], v[100:103]
ds_read_b128 v[64:67], v7 offset:28672
v_mul_f32 v209, v124, v140
v_mfma_f32_16x16x32_bf16 v[100:103], v[76:79], a[212:215], v[100:103]
v_exp_f32 v210, v210
v_mfma_f32_16x16x32_bf16 v[104:107], v[72:75], a[200:203], v[104:107]
v_mfma_f32_16x16x32_bf16 v[104:107], v[76:79], a[216:219], v[104:107]
ds_read_b128 v[68:71], v7 offset:29696
v_mul_f32 v211, v125, v141
v_mfma_f32_16x16x32_bf16 v[108:111], v[72:75], a[204:207], v[108:111]
v_fma_f32 v208, v208, v246, v246
v_fma_f32 v210, v210, v246, v246
v_mfma_f32_16x16x32_bf16 v[108:111], v[76:79], a[220:223], v[108:111]
v_mul_f32 v212, v126, v126
s_waitcnt lgkmcnt(4)
v_mfma_f32_16x16x32_bf16 v[80:83], v[48:51], a[224:227], v[80:83]
v_rcp_f32 v208, v208
v_mfma_f32_16x16x32_bf16 v[80:83], v[52:55], a[240:243], v[80:83]
v_mfma_f32_16x16x32_bf16 v[84:87], v[48:51], a[228:231], v[84:87]
ds_read_b128 v[72:75], v7 offset:30720
v_mul_f32 v209, v209, v208
v_mfma_f32_16x16x32_bf16 v[84:87], v[52:55], a[244:247], v[84:87]
v_rcp_f32 v210, v210
v_mfma_f32_16x16x32_bf16 v[88:91], v[48:51], a[232:235], v[88:91]
v_mul_f32 v211, v211, v210
v_cvt_pk_bf16_f32 v190, v209, v211
v_mfma_f32_16x16x32_bf16 v[88:91], v[52:55], a[248:251], v[88:91]
ds_read_b128 v[76:79], v7 offset:31744
v_mfma_f32_16x16x32_bf16 v[92:95], v[48:51], a[236:239], v[92:95]
v_mul_f32 v214, v127, v127
v_fma_f32 v212, v212, v245, v244
v_mfma_f32_16x16x32_bf16 v[92:95], v[52:55], a[252:255], v[92:95]
s_waitcnt lgkmcnt(4)
v_mfma_f32_16x16x32_bf16 v[96:99], v[56:59], a[224:227], v[96:99]
s_waitcnt vmcnt(28)
v_fma_f32 v214, v214, v245, v244
v_mfma_f32_16x16x32_bf16 v[96:99], v[60:63], a[240:243], v[96:99]
s_barrier
v_mfma_f32_16x16x32_bf16 v[100:103], v[56:59], a[228:231], v[100:103]
ds_read_b128 v[48:51], v7 offset:32768
s_add_u32 m0, s22, 49152
v_mfma_f32_16x16x32_bf16 v[100:103], v[60:63], a[244:247], v[100:103]
v_add_u32 v3, 20480, v3
buffer_load_dwordx4 v3, s[8:11], 0 offen offset:0 sc1 lds
v_mfma_f32_16x16x32_bf16 v[104:107], v[56:59], a[232:235], v[104:107]
v_mul_f32 v212, v212, v126
v_mul_f32 v214, v214, v127
v_mfma_f32_16x16x32_bf16 v[104:107], v[60:63], a[248:251], v[104:107]
ds_read_b128 v[52:55], v7 offset:33792
v_mul_f32 v213, v126, v142
v_mfma_f32_16x16x32_bf16 v[108:111], v[56:59], a[236:239], v[108:111]
v_exp_f32 v212, v212
v_mfma_f32_16x16x32_bf16 v[108:111], v[60:63], a[252:255], v[108:111]
v_mul_f32 v215, v127, v143
s_waitcnt lgkmcnt(4)
v_mfma_f32_16x16x32_bf16 v[80:83], v[64:67], v[16:19], v[80:83]
buffer_load_dwordx4 v3, s[8:11], 0 offen offset:1024 sc1 lds
v_mfma_f32_16x16x32_bf16 v[80:83], v[68:71], v[32:35], v[80:83]
v_exp_f32 v214, v214
v_mfma_f32_16x16x32_bf16 v[84:87], v[64:67], v[20:23], v[84:87]
ds_read_b128 v[56:59], v7 offset:34816
v_fma_f32 v212, v212, v246, v246
v_mfma_f32_16x16x32_bf16 v[84:87], v[68:71], v[36:39], v[84:87]
v_fma_f32 v214, v214, v246, v246
v_mfma_f32_16x16x32_bf16 v[88:91], v[64:67], v[24:27], v[88:91]
v_rcp_f32 v212, v212
v_mfma_f32_16x16x32_bf16 v[88:91], v[68:71], v[40:43], v[88:91]
ds_read_b128 v[60:63], v7 offset:35840
v_mul_f32 v213, v213, v212
v_mfma_f32_16x16x32_bf16 v[92:95], v[64:67], v[28:31], v[92:95]
buffer_load_dwordx4 v3, s[8:11], 0 offen offset:2048 sc1 lds
v_mfma_f32_16x16x32_bf16 v[92:95], v[68:71], v[44:47], v[92:95]
s_waitcnt lgkmcnt(4)
v_mfma_f32_16x16x32_bf16 v[96:99], v[72:75], v[16:19], v[96:99]
s_waitcnt vmcnt(7)
v_cmp_eq_u64 vcc, s[68:69], v[14:15]
s_nop 0
s_cmp_eq_u64 vcc, exec
s_cbranch_scc0 L_f_slow1
L_f_back1:
v_mfma_f32_16x16x32_bf16 v[96:99], v[76:79], v[32:35], v[96:99]
v_rcp_f32 v214, v214
v_mfma_f32_16x16x32_bf16 v[100:103], v[72:75], v[20:23], v[100:103]
ds_read_b128 v[64:67], v7 offset:36864
v_mul_f32 v215, v215, v214
v_mfma_f32_16x16x32_bf16 v[100:103], v[76:79], v[36:39], v[100:103]
buffer_load_dwordx4 v3, s[8:11], 0 offen offset:3072 sc1 lds
v_mfma_f32_16x16x32_bf16 v[104:107], v[72:75], v[24:27], v[104:107]
s_add_u32 m0, s22, 53248
v_add_u32 v3, 4096, v3
v_mfma_f32_16x16x32_bf16 v[104:107], v[76:79], v[40:43], v[104:107]
ds_read_b128 v[68:71], v7 offset:37888
v_cvt_pk_bf16_f32 v191, v213, v215
v_mfma_f32_16x16x32_bf16 v[108:111], v[72:75], v[28:31], v[108:111]
buffer_store_dwordx4 v[188:191], v6, s[8:11], s24 offen offset:2048 sc1
v_mfma_f32_16x16x32_bf16 v[108:111], v[76:79], v[44:47], v[108:111]
s_waitcnt lgkmcnt(4)
v_mfma_f32_16x16x32_bf16 v[112:115], v[48:51], a[0:3], 0
v_mfma_f32_16x16x32_bf16 v[112:115], v[52:55], a[16:19], v[112:115]
v_mfma_f32_16x16x32_bf16 v[116:119], v[48:51], a[4:7], 0
ds_read_b128 v[72:75], v7 offset:38912
v_mfma_f32_16x16x32_bf16 v[116:119], v[52:55], a[20:23], v[116:119]
buffer_load_dwordx4 v3, s[8:11], 0 offen offset:0 sc1 lds
v_mfma_f32_16x16x32_bf16 v[120:123], v[48:51], a[8:11], 0
v_mul_f32 v208, v80, v80
v_mul_f32 v210, v81, v81
v_mfma_f32_16x16x32_bf16 v[120:123], v[52:55], a[24:27], v[120:123]
ds_read_b128 v[76:79], v7 offset:39936
v_fma_f32 v208, v208, v233, v232
v_mfma_f32_16x16x32_bf16 v[124:127], v[48:51], a[12:15], 0
v_fma_f32 v210, v210, v233, v232
v_mul_f32 v208, v208, v80
v_mfma_f32_16x16x32_bf16 v[124:127], v[52:55], a[28:31], v[124:127]
v_mul_f32 v210, v210, v81
s_waitcnt lgkmcnt(4)
v_mfma_f32_16x16x32_bf16 v[128:131], v[56:59], a[0:3], 0
buffer_load_dwordx4 v3, s[8:11], 0 offen offset:1024 sc1 lds
v_mfma_f32_16x16x32_bf16 v[128:131], v[60:63], a[16:19], v[128:131]
v_exp_f32 v208, v208
v_mfma_f32_16x16x32_bf16 v[132:135], v[56:59], a[4:7], 0
ds_read_b128 v[48:51], v7 offset:40960
v_mul_f32 v209, v80, v96
v_mfma_f32_16x16x32_bf16 v[132:135], v[60:63], a[20:23], v[132:135]
v_exp_f32 v210, v210
v_mfma_f32_16x16x32_bf16 v[136:139], v[56:59], a[8:11], 0
v_mul_f32 v211, v81, v97
v_fma_f32 v208, v208, v234, v234
v_mfma_f32_16x16x32_bf16 v[136:139], v[60:63], a[24:27], v[136:139]
ds_read_b128 v[52:55], v7 offset:41984
v_fma_f32 v210, v210, v234, v234
v_mfma_f32_16x16x32_bf16 v[140:143], v[56:59], a[12:15], 0
v_rcp_f32 v208, v208
v_mfma_f32_16x16x32_bf16 v[140:143], v[60:63], a[28:31], v[140:143]
v_mul_f32 v209, v209, v208
s_waitcnt lgkmcnt(4)
v_mfma_f32_16x16x32_bf16 v[112:115], v[64:67], a[32:35], v[112:115]
buffer_load_dwordx4 a[0:3], v2, s[8:11], s25 offen offset:0 sc1
v_mfma_f32_16x16x32_bf16 v[112:115], v[68:71], a[48:51], v[112:115]
v_rcp_f32 v210, v210
v_mfma_f32_16x16x32_bf16 v[116:119], v[64:67], a[36:39], v[116:119]
ds_read_b128 v[56:59], v7 offset:43008
v_mul_f32 v211, v211, v210
v_mfma_f32_16x16x32_bf16 v[116:119], v[68:71], a[52:55], v[116:119]
v_cvt_pk_bf16_f32 v192, v209, v211
v_mul_f32 v212, v82, v82
v_mfma_f32_16x16x32_bf16 v[120:123], v[64:67], a[40:43], v[120:123]
v_mul_f32 v214, v83, v83
v_fma_f32 v212, v212, v233, v232
v_mfma_f32_16x16x32_bf16 v[120:123], v[68:71], a[56:59], v[120:123]
ds_read_b128 v[60:63], v7 offset:44032
v_fma_f32 v214, v214, v233, v232
v_mfma_f32_16x16x32_bf16 v[124:127], v[64:67], a[44:47], v[124:127]
buffer_load_dwordx4 a[4:7], v4, s[8:11], s25 offen offset:0 sc1
v_mfma_f32_16x16x32_bf16 v[124:127], v[68:71], a[60:63], v[124:127]
v_mul_f32 v212, v212, v82
s_waitcnt lgkmcnt(4)
v_mfma_f32_16x16x32_bf16 v[128:131], v[72:75], a[32:35], v[128:131]
v_mul_f32 v214, v214, v83
v_mul_f32 v213, v82, v98
v_mfma_f32_16x16x32_bf16 v[128:131], v[76:79], a[48:51], v[128:131]
v_exp_f32 v212, v212
v_mfma_f32_16x16x32_bf16 v[132:135], v[72:75], a[36:39], v[132:135]
ds_read_b128 v[64:67], v7 offset:45056
v_mul_f32 v215, v83, v99
v_mfma_f32_16x16x32_bf16 v[132:135], v[76:79], a[52:55], v[132:135]
buffer_load_dwordx4 a[8:11], v5, s[8:11], s25 offen offset:0 sc1
v_mfma_f32_16x16x32_bf16 v[136:139], v[72:75], a[40:43], v[136:139]
v_exp_f32 v214, v214
v_mfma_f32_16x16x32_bf16 v[136:139], v[76:79], a[56:59], v[136:139]
ds_read_b128 v[68:71], v7 offset:46080
v_fma_f32 v212, v212, v234, v234
v_mfma_f32_16x16x32_bf16 v[140:143], v[72:75], a[44:47], v[140:143]
v_fma_f32 v214, v214, v234, v234
v_mul_f32 v208, v84, v84
v_mfma_f32_16x16x32_bf16 v[140:143], v[76:79], a[60:63], v[140:143]
v_mul_f32 v210, v85, v85
s_waitcnt lgkmcnt(4)
v_mfma_f32_16x16x32_bf16 v[112:115], v[48:51], a[64:67], v[112:115]
buffer_load_dwordx4 a[12:15], v6, s[8:11], s25 offen offset:0 sc1
v_mfma_f32_16x16x32_bf16 v[112:115], v[52:55], a[80:83], v[112:115]
v_rcp_f32 v212, v212
v_mfma_f32_16x16x32_bf16 v[116:119], v[48:51], a[68:71], v[116:119]
ds_read_b128 v[72:75], v7 offset:47104
v_mul_f32 v213, v213, v212
v_mfma_f32_16x16x32_bf16 v[116:119], v[52:55], a[84:87], v[116:119]
v_rcp_f32 v214, v214
v_mfma_f32_16x16x32_bf16 v[120:123], v[48:51], a[72:75], v[120:123]
v_mul_f32 v215, v215, v214
v_cvt_pk_bf16_f32 v193, v213, v215
v_mfma_f32_16x16x32_bf16 v[120:123], v[52:55], a[88:91], v[120:123]
ds_read_b128 v[76:79], v7 offset:48128
v_fma_f32 v208, v208, v237, v236
v_mfma_f32_16x16x32_bf16 v[124:127], v[48:51], a[76:79], v[124:127]
buffer_load_dwordx4 a[16:19], v2, s[8:11], s26 offen offset:0 sc1
v_mfma_f32_16x16x32_bf16 v[124:127], v[52:55], a[92:95], v[124:127]
v_fma_f32 v210, v210, v237, v236
s_waitcnt lgkmcnt(4)
v_mfma_f32_16x16x32_bf16 v[128:131], v[56:59], a[64:67], v[128:131]
v_mul_f32 v208, v208, v84
v_mul_f32 v210, v210, v85
v_mfma_f32_16x16x32_bf16 v[128:131], v[60:63], a[80:83], v[128:131]
v_exp_f32 v208, v208
v_mfma_f32_16x16x32_bf16 v[132:135], v[56:59], a[68:71], v[132:135]
ds_read_b128 v[48:51], v7 offset:49152
v_mul_f32 v209, v84, v100
v_mfma_f32_16x16x32_bf16 v[132:135], v[60:63], a[84:87], v[132:135]
buffer_load_dwordx4 a[20:23], v4, s[8:11], s26 offen offset:0 sc1
v_mfma_f32_16x16x32_bf16 v[136:139], v[56:59], a[72:75], v[136:139]
v_exp_f32 v210, v210
v_mfma_f32_16x16x32_bf16 v[136:139], v[60:63], a[88:91], v[136:139]
ds_read_b128 v[52:55], v7 offset:50176
v_mul_f32 v211, v85, v101
v_mfma_f32_16x16x32_bf16 v[140:143], v[56:59], a[76:79], v[140:143]
v_fma_f32 v208, v208, v238, v238
v_fma_f32 v210, v210, v238, v238
v_mfma_f32_16x16x32_bf16 v[140:143], v[60:63], a[92:95], v[140:143]
v_mul_f32 v212, v86, v86
s_waitcnt lgkmcnt(4)
v_mfma_f32_16x16x32_bf16 v[112:115], v[64:67], a[96:99], v[112:115]
v_mov_b32 v12, s68
v_mov_b32 v13, s69
v_mfma_f32_16x16x32_bf16 v[112:115], v[68:71], a[112:115], v[112:115]
s_add_u32 s53, s34, 131072
s_waitcnt vmcnt(8)
buffer_store_dwordx2 v[12:13], v10, s[8:11], s53 offen sc1
v_mfma_f32_16x16x32_bf16 v[116:119], v[64:67], a[100:103], v[116:119]
ds_read_b128 v[56:59], v7 offset:51200
v_mul_f32 v214, v87, v87
v_mfma_f32_16x16x32_bf16 v[116:119], v[68:71], a[116:119], v[116:119]
v_rcp_f32 v208, v208
v_mfma_f32_16x16x32_bf16 v[120:123], v[64:67], a[104:107], v[120:123]
v_rcp_f32 v210, v210
v_mfma_f32_16x16x32_bf16 v[120:123], v[68:71], a[120:123], v[120:123]
ds_read_b128 v[60:63], v7 offset:52224
v_mul_f32 v209, v209, v208
v_mfma_f32_16x16x32_bf16 v[124:127], v[64:67], a[108:111], v[124:127]
buffer_load_dwordx4 a[24:27], v5, s[8:11], s26 offen offset:0 sc1
v_mfma_f32_16x16x32_bf16 v[124:127], v[68:71], a[124:127], v[124:127]
v_mul_f32 v211, v211, v210
s_waitcnt lgkmcnt(4)
v_mfma_f32_16x16x32_bf16 v[128:131], v[72:75], a[96:99], v[128:131]
v_cvt_pk_bf16_f32 v196, v209, v211
v_fma_f32 v212, v212, v237, v236
v_mfma_f32_16x16x32_bf16 v[128:131], v[76:79], a[112:115], v[128:131]
v_fma_f32 v214, v214, v237, v236
v_mul_f32 v212, v212, v86
v_mfma_f32_16x16x32_bf16 v[132:135], v[72:75], a[100:103], v[132:135]
ds_read_b128 v[64:67], v7 offset:53248
v_mul_f32 v214, v214, v87
v_mfma_f32_16x16x32_bf16 v[132:135], v[76:79], a[116:119], v[132:135]
buffer_load_dwordx4 a[28:31], v6, s[8:11], s26 offen offset:0 sc1
v_mfma_f32_16x16x32_bf16 v[136:139], v[72:75], a[104:107], v[136:139]
v_exp_f32 v212, v212
v_mfma_f32_16x16x32_bf16 v[136:139], v[76:79], a[120:123], v[136:139]
ds_read_b128 v[68:71], v7 offset:54272
v_mul_f32 v213, v86, v102
v_mfma_f32_16x16x32_bf16 v[140:143], v[72:75], a[108:111], v[140:143]
v_exp_f32 v214, v214
v_mfma_f32_16x16x32_bf16 v[140:143], v[76:79], a[124:127], v[140:143]
v_mul_f32 v215, v87, v103
s_waitcnt lgkmcnt(4)
v_mfma_f32_16x16x32_bf16 v[112:115], v[48:51], a[128:131], v[112:115]
buffer_load_dwordx4 a[32:35], v2, s[8:11], s27 offen offset:0 sc1
v_mfma_f32_16x16x32_bf16 v[112:115], v[52:55], a[144:147], v[112:115]
v_fma_f32 v212, v212, v238, v238
v_fma_f32 v214, v214, v238, v238
v_mfma_f32_16x16x32_bf16 v[116:119], v[48:51], a[132:135], v[116:119]
ds_read_b128 v[72:75], v7 offset:55296
v_mul_f32 v208, v88, v88
v_mfma_f32_16x16x32_bf16 v[116:119], v[52:55], a[148:151], v[116:119]
v_rcp_f32 v212, v212
v_mfma_f32_16x16x32_bf16 v[120:123], v[48:51], a[136:139], v[120:123]
v_rcp_f32 v214, v214
v_mfma_f32_16x16x32_bf16 v[120:123], v[52:55], a[152:155], v[120:123]
ds_read_b128 v[76:79], v7 offset:56320
v_mul_f32 v213, v213, v212
v_mfma_f32_16x16x32_bf16 v[124:127], v[48:51], a[140:143], v[124:127]
buffer_load_dwordx4 a[36:39], v4, s[8:11], s27 offen offset:0 sc1
v_mfma_f32_16x16x32_bf16 v[124:127], v[52:55], a[156:159], v[124:127]
v_mul_f32 v215, v215, v214
s_waitcnt lgkmcnt(4)
v_mfma_f32_16x16x32_bf16 v[128:131], v[56:59], a[128:131], v[128:131]
s_waitcnt vmcnt(36)
v_cvt_pk_bf16_f32 v197, v213, v215
v_mfma_f32_16x16x32_bf16 v[128:131], v[60:63], a[144:147], v[128:131]
s_barrier
v_mfma_f32_16x16x32_bf16 v[132:135], v[56:59], a[132:135], v[132:135]
ds_read_b128 v[48:51], v7 offset:57344
v_mul_f32 v210, v89, v89
v_mfma_f32_16x16x32_bf16 v[132:135], v[60:63], a[148:151], v[132:135]
buffer_load_dwordx4 a[40:43], v5, s[8:11], s27 offen offset:0 sc1
v_mfma_f32_16x16x32_bf16 v[136:139], v[56:59], a[136:139], v[136:139]
v_fma_f32 v208, v208, v241, v240
v_fma_f32 v210, v210, v241, v240
v_mfma_f32_16x16x32_bf16 v[136:139], v[60:63], a[152:155], v[136:139]
ds_read_b128 v[52:55], v7 offset:58368
v_mul_f32 v208, v208, v88
v_mfma_f32_16x16x32_bf16 v[140:143], v[56:59], a[140:143], v[140:143]
v_mul_f32 v210, v210, v89
v_mul_f32 v209, v88, v104
v_mfma_f32_16x16x32_bf16 v[140:143], v[60:63], a[156:159], v[140:143]
v_mul_f32 v211, v89, v105
s_waitcnt lgkmcnt(4)
v_mfma_f32_16x16x32_bf16 v[112:115], v[64:67], a[160:163], v[112:115]
buffer_load_dwordx4 a[44:47], v6, s[8:11], s27 offen offset:0 sc1
v_mfma_f32_16x16x32_bf16 v[112:115], v[68:71], a[176:179], v[112:115]
v_exp_f32 v208, v208
v_mfma_f32_16x16x32_bf16 v[116:119], v[64:67], a[164:167], v[116:119]
ds_read_b128 v[56:59], v7 offset:59392
v_fma_f32 v208, v208, v242, v242
v_mfma_f32_16x16x32_bf16 v[116:119], v[68:71], a[180:183], v[116:119]
v_exp_f32 v210, v210
v_mfma_f32_16x16x32_bf16 v[120:123], v[64:67], a[168:171], v[120:123]
v_fma_f32 v210, v210, v242, v242
v_mul_f32 v212, v90, v90
v_mfma_f32_16x16x32_bf16 v[120:123], v[68:71], a[184:187], v[120:123]
ds_read_b128 v[60:63], v7 offset:60416
v_mul_f32 v214, v91, v91
v_mfma_f32_16x16x32_bf16 v[124:127], v[64:67], a[172:175], v[124:127]
buffer_load_dwordx4 a[48:51], v2, s[8:11], s25 offen offset:1024 sc1
v_mfma_f32_16x16x32_bf16 v[124:127], v[68:71], a[188:191], v[124:127]
v_fma_f32 v212, v212, v241, v240
s_waitcnt lgkmcnt(4)
v_mfma_f32_16x16x32_bf16 v[128:131], v[72:75], a[160:163], v[128:131]
v_rcp_f32 v208, v208
v_mfma_f32_16x16x32_bf16 v[128:131], v[76:79], a[176:179], v[128:131]
v_rcp_f32 v210, v210
v_mfma_f32_16x16x32_bf16 v[132:135], v[72:75], a[164:167], v[132:135]
ds_read_b128 v[64:67], v7 offset:61440
v_mul_f32 v209, v209, v208
v_mfma_f32_16x16x32_bf16 v[132:135], v[76:79], a[180:183], v[132:135]
buffer_load_dwordx4 a[52:55], v4, s[8:11], s25 offen offset:1024 sc1
v_mfma_f32_16x16x32_bf16 v[136:139], v[72:75], a[168:171], v[136:139]
v_mul_f32 v211, v211, v210
v_cvt_pk_bf16_f32 v200, v209, v211
v_mfma_f32_16x16x32_bf16 v[136:139], v[76:79], a[184:187], v[136:139]
ds_read_b128 v[68:71], v7 offset:62464
v_fma_f32 v214, v214, v241, v240
v_mfma_f32_16x16x32_bf16 v[140:143], v[72:75], a[172:175], v[140:143]
v_mul_f32 v212, v212, v90
v_mul_f32 v214, v214, v91
v_mfma_f32_16x16x32_bf16 v[140:143], v[76:79], a[188:191], v[140:143]
v_mul_f32 v213, v90, v106
s_waitcnt lgkmcnt(4)
v_mfma_f32_16x16x32_bf16 v[112:115], v[48:51], a[192:195], v[112:115]
buffer_load_dwordx4 a[56:59], v5, s[8:11], s25 offen offset:1024 sc1
v_mfma_f32_16x16x32_bf16 v[112:115], v[52:55], a[208:211], v[112:115]
v_exp_f32 v212, v212
v_mfma_f32_16x16x32_bf16 v[116:119], v[48:51], a[196:199], v[116:119]
ds_read_b128 v[72:75], v7 offset:63488
v_mul_f32 v215, v91, v107
v_mfma_f32_16x16x32_bf16 v[116:119], v[52:55], a[212:215], v[116:119]
v_exp_f32 v214, v214
v_mfma_f32_16x16x32_bf16 v[120:123], v[48:51], a[200:203], v[120:123]
v_fma_f32 v212, v212, v242, v242
v_fma_f32 v214, v214, v242, v242
v_mfma_f32_16x16x32_bf16 v[120:123], v[52:55], a[216:219], v[120:123]
ds_read_b128 v[76:79], v7 offset:64512
v_mul_f32 v208, v92, v92
v_mfma_f32_16x16x32_bf16 v[124:127], v[48:51], a[204:207], v[124:127]
buffer_load_dwordx4 a[60:63], v6, s[8:11], s25 offen offset:1024 sc1
v_mfma_f32_16x16x32_bf16 v[124:127], v[52:55], a[220:223], v[124:127]
v_mul_f32 v210, v93, v93
s_waitcnt lgkmcnt(4)
v_mfma_f32_16x16x32_bf16 v[128:131], v[56:59], a[192:195], v[128:131]
v_rcp_f32 v212, v212
v_mfma_f32_16x16x32_bf16 v[128:131], v[60:63], a[208:211], v[128:131]
v_rcp_f32 v214, v214
v_mfma_f32_16x16x32_bf16 v[132:135], v[56:59], a[196:199], v[132:135]
ds_read_b128 v[48:51], v8 offset:0
v_mul_f32 v213, v213, v212
v_mfma_f32_16x16x32_bf16 v[132:135], v[60:63], a[212:215], v[132:135]
buffer_load_dwordx4 a[64:67], v2, s[8:11], s26 offen offset:1024 sc1
v_mfma_f32_16x16x32_bf16 v[136:139], v[56:59], a[200:203], v[136:139]
v_mul_f32 v215, v215, v214
v_cvt_pk_bf16_f32 v201, v213, v215
v_mfma_f32_16x16x32_bf16 v[136:139], v[60:63], a[216:219], v[136:139]
ds_read_b128 v[52:55], v8 offset:1024
v_fma_f32 v208, v208, v245, v244
v_mfma_f32_16x16x32_bf16 v[140:143], v[56:59], a[204:207], v[140:143]
v_fma_f32 v210, v210, v245, v244
v_mul_f32 v208, v208, v92
v_mfma_f32_16x16x32_bf16 v[140:143], v[60:63], a[220:223], v[140:143]
v_mul_f32 v210, v210, v93
s_waitcnt lgkmcnt(4)
v_mfma_f32_16x16x32_bf16 v[112:115], v[64:67], a[224:227], v[112:115]
buffer_load_dwordx4 a[68:71], v4, s[8:11], s26 offen offset:1024 sc1
v_mfma_f32_16x16x32_bf16 v[112:115], v[68:71], a[240:243], v[112:115]
v_exp_f32 v208, v208
v_mfma_f32_16x16x32_bf16 v[116:119], v[64:67], a[228:231], v[116:119]
ds_read_b128 v[56:59], v8 offset:2048
v_mul_f32 v209, v92, v108
v_mfma_f32_16x16x32_bf16 v[116:119], v[68:71], a[244:247], v[116:119]
v_exp_f32 v210, v210
v_mfma_f32_16x16x32_bf16 v[120:123], v[64:67], a[232:235], v[120:123]
v_mul_f32 v211, v93, v109
v_fma_f32 v208, v208, v246, v246
v_mfma_f32_16x16x32_bf16 v[120:123], v[68:71], a[248:251], v[120:123]
ds_read_b128 v[60:63], v8 offset:3072
v_fma_f32 v210, v210, v246, v246
v_mfma_f32_16x16x32_bf16 v[124:127], v[64:67], a[236:239], v[124:127]
buffer_load_dwordx4 a[72:75], v5, s[8:11], s26 offen offset:1024 sc1
v_mfma_f32_16x16x32_bf16 v[124:127], v[68:71], a[252:255], v[124:127]
v_mul_f32 v212, v94, v94
s_waitcnt lgkmcnt(4)
v_mfma_f32_16x16x32_bf16 v[128:131], v[72:75], a[224:227], v[128:131]
v_rcp_f32 v208, v208
v_mfma_f32_16x16x32_bf16 v[128:131], v[76:79], a[240:243], v[128:131]
v_rcp_f32 v210, v210
v_mfma_f32_16x16x32_bf16 v[132:135], v[72:75], a[228:231], v[132:135]
ds_read_b128 v[64:67], v8 offset:4096
v_mul_f32 v209, v209, v208
v_mfma_f32_16x16x32_bf16 v[132:135], v[76:79], a[244:247], v[132:135]
buffer_load_dwordx4 a[76:79], v6, s[8:11], s26 offen offset:1024 sc1
v_mfma_f32_16x16x32_bf16 v[136:139], v[72:75], a[232:235], v[136:139]
v_mul_f32 v211, v211, v210
v_cvt_pk_bf16_f32 v204, v209, v211
v_mfma_f32_16x16x32_bf16 v[136:139], v[76:79], a[248:251], v[136:139]
ds_read_b128 v[68:71], v8 offset:5120
v_mul_f32 v214, v95, v95
v_mfma_f32_16x16x32_bf16 v[140:143], v[72:75], a[236:239], v[140:143]
v_fma_f32 v212, v212, v245, v244
v_fma_f32 v214, v214, v245, v244
v_mfma_f32_16x16x32_bf16 v[140:143], v[76:79], a[252:255], v[140:143]
v_mul_f32 v212, v212, v94
s_waitcnt lgkmcnt(4)
v_mfma_f32_16x16x32_bf16 v[112:115], v[48:51], v[16:19], v[112:115]
s_add_u32 s23, s34, 131072
v_mul_f32 v214, v214, v95
v_mfma_f32_16x16x32_bf16 v[112:115], v[52:55], v[32:35], v[112:115]
buffer_load_dwordx2 v[14:15], v11, s[8:11], s23 offen sc1
v_mfma_f32_16x16x32_bf16 v[116:119], v[48:51], v[20:23], v[116:119]
ds_read_b128 v[72:75], v8 offset:6144
v_mul_f32 v213, v94, v110
v_mfma_f32_16x16x32_bf16 v[116:119], v[52:55], v[36:39], v[116:119]
v_exp_f32 v212, v212
v_mfma_f32_16x16x32_bf16 v[120:123], v[48:51], v[24:27], v[120:123]
v_exp_f32 v214, v214
v_mfma_f32_16x16x32_bf16 v[120:123], v[52:55], v[40:43], v[120:123]
ds_read_b128 v[76:79], v8 offset:7168
v_mul_f32 v215, v95, v111
v_mfma_f32_16x16x32_bf16 v[124:127], v[48:51], v[28:31], v[124:127]
buffer_load_dwordx4 a[80:83], v2, s[8:11], s27 offen offset:1024 sc1
v_mfma_f32_16x16x32_bf16 v[124:127], v[52:55], v[44:47], v[124:127]
v_fma_f32 v212, v212, v246, v246
s_waitcnt lgkmcnt(4)
v_mfma_f32_16x16x32_bf16 v[128:131], v[56:59], v[16:19], v[128:131]
v_fma_f32 v214, v214, v246, v246
v_mfma_f32_16x16x32_bf16 v[128:131], v[60:63], v[32:35], v[128:131]
v_rcp_f32 v212, v212
v_mfma_f32_16x16x32_bf16 v[132:135], v[56:59], v[20:23], v[132:135]
ds_read_b128 v[48:51], v8 offset:8192
v_mul_f32 v213, v213, v212
v_mfma_f32_16x16x32_bf16 v[132:135], v[60:63], v[36:39], v[132:135]
buffer_load_dwordx4 a[84:87], v4, s[8:11], s27 offen offset:1024 sc1
v_mfma_f32_16x16x32_bf16 v[136:139], v[56:59], v[24:27], v[136:139]
v_rcp_f32 v214, v214
v_mfma_f32_16x16x32_bf16 v[136:139], v[60:63], v[40:43], v[136:139]
ds_read_b128 v[52:55], v8 offset:9216
v_mul_f32 v215, v215, v214
v_mfma_f32_16x16x32_bf16 v[140:143], v[56:59], v[28:31], v[140:143]
v_cvt_pk_bf16_f32 v205, v213, v215
v_mfma_f32_16x16x32_bf16 v[140:143], v[60:63], v[44:47], v[140:143]
s_waitcnt lgkmcnt(4)
v_mfma_f32_16x16x32_bf16 a[112:115], v[64:67], v[144:147], 0
v_mfma_f32_16x16x32_bf16 a[112:115], v[68:71], v[160:163], a[112:115]
v_mfma_f32_16x16x32_bf16 a[116:119], v[64:67], v[148:151], 0
ds_read_b128 v[56:59], v8 offset:10240
v_mfma_f32_16x16x32_bf16 a[116:119], v[68:71], v[164:167], a[116:119]
v_mul_f32 v208, v112, v112
v_mul_f32 v210, v113, v113
v_mfma_f32_16x16x32_bf16 a[120:123], v[64:67], v[152:155], 0
v_fma_f32 v208, v208, v233, v232
v_fma_f32 v210, v210, v233, v232
v_mfma_f32_16x16x32_bf16 a[120:123], v[68:71], v[168:171], a[120:123]
ds_read_b128 v[60:63], v8 offset:11264
v_mul_f32 v208, v208, v112
v_mfma_f32_16x16x32_bf16 a[124:127], v[64:67], v[156:159], 0
v_mul_f32 v210, v210, v113
v_mul_f32 v209, v112, v128
v_mfma_f32_16x16x32_bf16 a[124:127], v[68:71], v[172:175], a[124:127]
v_mul_f32 v211, v113, v129
s_waitcnt lgkmcnt(4)
v_mfma_f32_16x16x32_bf16 a[128:131], v[72:75], v[144:147], 0
v_exp_f32 v208, v208
v_mfma_f32_16x16x32_bf16 a[128:131], v[76:79], v[160:163], a[128:131]
v_exp_f32 v210, v210
v_mfma_f32_16x16x32_bf16 a[132:135], v[72:75], v[148:151], 0
ds_read_b128 v[64:67], v8 offset:12288
v_fma_f32 v208, v208, v234, v234
v_mfma_f32_16x16x32_bf16 a[132:135], v[76:79], v[164:167], a[132:135]
v_fma_f32 v210, v210, v234, v234
v_mul_f32 v212, v114, v114
v_mfma_f32_16x16x32_bf16 a[136:139], v[72:75], v[152:155], 0
v_rcp_f32 v208, v208
v_mfma_f32_16x16x32_bf16 a[136:139], v[76:79], v[168:171], a[136:139]
ds_read_b128 v[68:71], v8 offset:13312
v_mul_f32 v209, v209, v208
v_mfma_f32_16x16x32_bf16 a[140:143], v[72:75], v[156:159], 0
v_rcp_f32 v210, v210
v_mfma_f32_16x16x32_bf16 a[140:143], v[76:79], v[172:175], a[140:143]
v_mul_f32 v211, v211, v210
s_waitcnt lgkmcnt(4)
v_mfma_f32_16x16x32_bf16 a[144:147], v[48:51], v[144:147], 0
v_cvt_pk_bf16_f32 v194, v209, v211
v_mul_f32 v214, v115, v115
v_mfma_f32_16x16x32_bf16 a[144:147], v[52:55], v[160:163], a[144:147]
v_fma_f32 v212, v212, v233, v232
v_fma_f32 v214, v214, v233, v232
v_mfma_f32_16x16x32_bf16 a[148:151], v[48:51], v[148:151], 0
ds_read_b128 v[72:75], v8 offset:14336
v_mul_f32 v212, v212, v114
v_mfma_f32_16x16x32_bf16 a[148:151], v[52:55], v[164:167], a[148:151]
v_mul_f32 v214, v214, v115
v_mul_f32 v213, v114, v130
v_mfma_f32_16x16x32_bf16 a[152:155], v[48:51], v[152:155], 0
v_exp_f32 v212, v212
v_mfma_f32_16x16x32_bf16 a[152:155], v[52:55], v[168:171], a[152:155]
ds_read_b128 v[76:79], v8 offset:15360
v_mul_f32 v215, v115, v131
v_mfma_f32_16x16x32_bf16 a[156:159], v[48:51], v[156:159], 0
v_exp_f32 v214, v214
v_mfma_f32_16x16x32_bf16 a[156:159], v[52:55], v[172:175], a[156:159]
v_fma_f32 v212, v212, v234, v234
s_waitcnt lgkmcnt(4)
v_mfma_f32_16x16x32_bf16 a[160:163], v[56:59], v[144:147], 0
s_waitcnt vmcnt(42)
v_fma_f32 v214, v214, v234, v234
v_mfma_f32_16x16x32_bf16 a[160:163], v[60:63], v[160:163], a[160:163]
s_barrier
v_mfma_f32_16x16x32_bf16 a[164:167], v[56:59], v[148:151], 0
ds_read_b128 v[48:51], v2 offset:0
v_mul_f32 v208, v116, v116
v_mfma_f32_16x16x32_bf16 a[164:167], v[60:63], v[164:167], a[164:167]
v_rcp_f32 v212, v212
v_mfma_f32_16x16x32_bf16 a[168:171], v[56:59], v[152:155], 0
v_rcp_f32 v214, v214
v_mfma_f32_16x16x32_bf16 a[168:171], v[60:63], v[168:171], a[168:171]
ds_read_b128 v[52:55], v2 offset:1024
v_mul_f32 v213, v213, v212
v_mfma_f32_16x16x32_bf16 a[172:175], v[56:59], v[156:159], 0
v_mul_f32 v215, v215, v214
v_cvt_pk_bf16_f32 v195, v213, v215
v_mfma_f32_16x16x32_bf16 a[172:175], v[60:63], v[172:175], a[172:175]
v_mul_f32 v210, v117, v117
s_waitcnt lgkmcnt(4)
v_mfma_f32_16x16x32_bf16 a[176:179], v[64:67], v[144:147], 0
buffer_store_dwordx4 v[192:195], v2, s[8:11], s24 offen offset:3072 sc1
v_mfma_f32_16x16x32_bf16 a[176:179], v[68:71], v[160:163], a[176:179]
v_fma_f32 v208, v208, v237, v236
v_fma_f32 v210, v210, v237, v236
v_mfma_f32_16x16x32_bf16 a[180:183], v[64:67], v[148:151], 0
ds_read_b128 v[56:59], v2 offset:2048
v_mul_f32 v208, v208, v116
v_mfma_f32_16x16x32_bf16 a[180:183], v[68:71], v[164:167], a[180:183]
v_mul_f32 v210, v210, v117
v_mul_f32 v209, v116, v132
v_mfma_f32_16x16x32_bf16 a[184:187], v[64:67], v[152:155], 0
L_hop9:
s_cmp_eq_u32 s15, 1
s_cbranch_scc1 L_hop13
v_exp_f32 v208, v208
v_mfma_f32_16x16x32_bf16 a[184:187], v[68:71], v[168:171], a[184:187]
ds_read_b128 v[60:63], v2 offset:3072
v_mul_f32 v211, v117, v133
v_mfma_f32_16x16x32_bf16 a[188:191], v[64:67], v[156:159], 0
v_exp_f32 v210, v210
v_mfma_f32_16x16x32_bf16 a[188:191], v[68:71], v[172:175], a[188:191]
v_fma_f32 v208, v208, v238, v238
s_waitcnt lgkmcnt(4)
v_mfma_f32_16x16x32_bf16 a[192:195], v[72:75], v[144:147], 0
v_fma_f32 v210, v210, v238, v238
v_rcp_f32 v208, v208
v_mfma_f32_16x16x32_bf16 a[192:195], v[76:79], v[160:163], a[192:195]
v_rcp_f32 v210, v210
v_mfma_f32_16x16x32_bf16 a[196:199], v[72:75], v[148:151], 0
ds_read_b128 v[64:67], v2 offset:4096
v_mul_f32 v209, v209, v208
v_mfma_f32_16x16x32_bf16 a[196:199], v[76:79], v[164:167], a[196:199]
v_mul_f32 v211, v211, v210
v_cvt_pk_bf16_f32 v198, v209, v211
v_mfma_f32_16x16x32_bf16 a[200:203], v[72:75], v[152:155], 0
v_mul_f32 v212, v118, v118
v_mul_f32 v214, v119, v119
v_mfma_f32_16x16x32_bf16 a[200:203], v[76:79], v[168:171], a[200:203]
ds_read_b128 v[68:71], v2 offset:5120
v_fma_f32 v212, v212, v237, v236
v_mfma_f32_16x16x32_bf16 a[204:207], v[72:75], v[156:159], 0
v_fma_f32 v214, v214, v237, v236
v_mul_f32 v212, v212, v118
v_mfma_f32_16x16x32_bf16 a[204:207], v[76:79], v[172:175], a[204:207]
v_mul_f32 v214, v214, v119
s_waitcnt lgkmcnt(4)
v_mfma_f32_16x16x32_bf16 a[208:211], v[48:51], v[144:147], 0
v_exp_f32 v212, v212
v_mfma_f32_16x16x32_bf16 a[208:211], v[52:55], v[160:163], a[208:211]
v_exp_f32 v214, v214
v_mfma_f32_16x16x32_bf16 a[212:215], v[48:51], v[148:151], 0
ds_read_b128 v[72:75], v2 offset:6144
v_mul_f32 v213, v118, v134
v_mfma_f32_16x16x32_bf16 a[212:215], v[52:55], v[164:167], a[212:215]
v_mul_f32 v215, v119, v135
v_fma_f32 v212, v212, v238, v238
v_mfma_f32_16x16x32_bf16 a[216:219], v[48:51], v[152:155], 0
v_fma_f32 v214, v214, v238, v238
v_rcp_f32 v212, v212
v_mfma_f32_16x16x32_bf16 a[216:219], v[52:55], v[168:171], a[216:219]
ds_read_b128 v[76:79], v2 offset:7168
v_rcp_f32 v214, v214
v_mfma_f32_16x16x32_bf16 a[220:223], v[48:51], v[156:159], 0
v_mul_f32 v213, v213, v212
v_mul_f32 v215, v215, v214
v_mfma_f32_16x16x32_bf16 a[220:223], v[52:55], v[172:175], a[220:223]
v_cvt_pk_bf16_f32 v199, v213, v215
s_waitcnt lgkmcnt(4)
v_mfma_f32_16x16x32_bf16 a[224:227], v[56:59], v[144:147], 0
buffer_store_dwordx4 v[196:199], v4, s[8:11], s24 offen offset:3072 sc1
v_mfma_f32_16x16x32_bf16 a[224:227], v[60:63], v[160:163], a[224:227]
v_mul_f32 v208, v120, v120
v_mul_f32 v210, v121, v121
v_mfma_f32_16x16x32_bf16 a[228:231], v[56:59], v[148:151], 0
ds_read_b128 v[48:51], v2 offset:8192
v_fma_f32 v208, v208, v241, v240
v_mfma_f32_16x16x32_bf16 a[228:231], v[60:63], v[164:167], a[228:231]
v_fma_f32 v210, v210, v241, v240
v_mul_f32 v208, v208, v120
v_mfma_f32_16x16x32_bf16 a[232:235], v[56:59], v[152:155], 0
v_mul_f32 v210, v210, v121
v_exp_f32 v208, v208
v_mfma_f32_16x16x32_bf16 a[232:235], v[60:63], v[168:171], a[232:235]
ds_read_b128 v[52:55], v2 offset:9216
v_exp_f32 v210, v210
v_mfma_f32_16x16x32_bf16 a[236:239], v[56:59], v[156:159], 0
v_mul_f32 v209, v120, v136
v_mul_f32 v211, v121, v137
v_mfma_f32_16x16x32_bf16 a[236:239], v[60:63], v[172:175], a[236:239]
v_fma_f32 v208, v208, v242, v242
s_waitcnt vmcnt(22)
s_waitcnt lgkmcnt(4)
v_mfma_f32_16x16x32_bf16 a[112:115], v[64:67], v[176:179], a[112:115]
v_fma_f32 v210, v210, v242, v242
v_rcp_f32 v208, v208
v_mfma_f32_16x16x32_bf16 a[112:115], v[68:71], a[0:3], a[112:115]
v_rcp_f32 v210, v210
v_mfma_f32_16x16x32_bf16 a[116:119], v[64:67], v[180:183], a[116:119]
ds_read_b128 v[56:59], v2 offset:10240
v_mul_f32 v209, v209, v208
v_mfma_f32_16x16x32_bf16 a[116:119], v[68:71], a[4:7], a[116:119]
v_mul_f32 v211, v211, v210
v_cvt_pk_bf16_f32 v202, v209, v211
v_mfma_f32_16x16x32_bf16 a[120:123], v[64:67], v[184:187], a[120:123]
v_mul_f32 v212, v122, v122
v_mul_f32 v214, v123, v123
v_mfma_f32_16x16x32_bf16 a[120:123], v[68:71], a[8:11], a[120:123]
ds_read_b128 v[60:63], v2 offset:11264
v_fma_f32 v212, v212, v241, v240
v_mfma_f32_16x16x32_bf16 a[124:127], v[64:67], v[188:191], a[124:127]
v_fma_f32 v214, v214, v241, v240
v_mul_f32 v212, v212, v122
v_mfma_f32_16x16x32_bf16 a[124:127], v[68:71], a[12:15], a[124:127]
v_mul_f32 v214, v214, v123
s_waitcnt lgkmcnt(4)
v_mfma_f32_16x16x32_bf16 a[128:131], v[72:75], v[176:179], a[128:131]
s_waitcnt vmcnt(4)
v_cmp_eq_u64 vcc, s[68:69], v[14:15]
s_nop 0
s_cmp_eq_u64 vcc, exec
s_cbranch_scc0 L_f_slow2
L_f_back2:
v_exp_f32 v212, v212
v_mfma_f32_16x16x32_bf16 a[128:131], v[76:79], a[0:3], a[128:131]
v_exp_f32 v214, v214
v_mfma_f32_16x16x32_bf16 a[132:135], v[72:75], v[180:183], a[132:135]
ds_read_b128 v[64:67], v2 offset:12288
v_mul_f32 v213, v122, v138
v_mfma_f32_16x16x32_bf16 a[132:135], v[76:79], a[4:7], a[132:135]
v_mul_f32 v215, v123, v139
v_fma_f32 v212, v212, v242, v242
v_mfma_f32_16x16x32_bf16 a[136:139], v[72:75], v[184:187], a[136:139]
v_fma_f32 v214, v214, v242, v242
v_rcp_f32 v212, v212
v_mfma_f32_16x16x32_bf16 a[136:139], v[76:79], a[8:11], a[136:139]
ds_read_b128 v[68:71], v2 offset:13312
v_rcp_f32 v214, v214
v_mfma_f32_16x16x32_bf16 a[140:143], v[72:75], v[188:191], a[140:143]
v_mul_f32 v213, v213, v212
v_mul_f32 v215, v215, v214
v_mfma_f32_16x16x32_bf16 a[140:143], v[76:79], a[12:15], a[140:143]
v_cvt_pk_bf16_f32 v203, v213, v215
s_waitcnt lgkmcnt(4)
v_mfma_f32_16x16x32_bf16 a[144:147], v[48:51], v[176:179], a[144:147]
buffer_store_dwordx4 v[200:203], v5, s[8:11], s24 offen offset:3072 sc1
v_mfma_f32_16x16x32_bf16 a[144:147], v[52:55], a[0:3], a[144:147]
v_mul_f32 v208, v124, v124
v_mul_f32 v210, v125, v125
v_mfma_f32_16x16x32_bf16 a[148:151], v[48:51], v[180:183], a[148:151]
ds_read_b128 v[72:75], v2 offset:14336
v_fma_f32 v208, v208, v245, v244
v_mfma_f32_16x16x32_bf16 a[148:151], v[52:55], a[4:7], a[148:151]
v_fma_f32 v210, v210, v245, v244
v_mul_f32 v208, v208, v124
v_mfma_f32_16x16x32_bf16 a[152:155], v[48:51], v[184:187], a[152:155]
v_mul_f32 v210, v210, v125
v_exp_f32 v208, v208
v_mfma_f32_16x16x32_bf16 a[152:155], v[52:55], a[8:11], a[152:155]
ds_read_b128 v[76:79], v2 offset:15360
v_exp_f32 v210, v210
v_mfma_f32_16x16x32_bf16 a[156:159], v[48:51], v[188:191], a[156:159]
v_mul_f32 v209, v124, v140
v_mul_f32 v211, v125, v141
v_mfma_f32_16x16x32_bf16 a[156:159], v[52:55], a[12:15], a[156:159]
v_fma_f32 v208, v208, v246, v246
s_waitcnt lgkmcnt(4)
v_mfma_f32_16x16x32_bf16 a[160:163], v[56:59], v[176:179], a[160:163]
v_fma_f32 v210, v210, v246, v246
v_rcp_f32 v208, v208
v_mfma_f32_16x16x32_bf16 a[160:163], v[60:63], a[0:3], a[160:163]
v_rcp_f32 v210, v210
v_mfma_f32_16x16x32_bf16 a[164:167], v[56:59], v[180:183], a[164:167]
ds_read_b128 v[48:51], v2 offset:16384
v_mul_f32 v209, v209, v208
v_mfma_f32_16x16x32_bf16 a[164:167], v[60:63], a[4:7], a[164:167]
v_mul_f32 v211, v211, v210
v_cvt_pk_bf16_f32 v206, v209, v211
v_mfma_f32_16x16x32_bf16 a[168:171], v[56:59], v[184:187], a[168:171]
v_mul_f32 v212, v126, v126
v_mul_f32 v214, v127, v127
v_mfma_f32_16x16x32_bf16 a[168:171], v[60:63], a[8:11], a[168:171]
ds_read_b128 v[52:55], v2 offset:17408
v_fma_f32 v212, v212, v245, v244
v_mfma_f32_16x16x32_bf16 a[172:175], v[56:59], v[188:191], a[172:175]
v_fma_f32 v214, v214, v245, v244
v_mul_f32 v212, v212, v126
v_mfma_f32_16x16x32_bf16 a[172:175], v[60:63], a[12:15], a[172:175]
v_mul_f32 v214, v214, v127
s_waitcnt lgkmcnt(4)
v_mfma_f32_16x16x32_bf16 a[176:179], v[64:67], v[176:179], a[176:179]
v_exp_f32 v212, v212
v_mfma_f32_16x16x32_bf16 a[176:179], v[68:71], a[0:3], a[176:179]
v_exp_f32 v214, v214
v_mfma_f32_16x16x32_bf16 a[180:183], v[64:67], v[180:183], a[180:183]
ds_read_b128 v[56:59], v2 offset:18432
v_mul_f32 v213, v126, v142
v_mfma_f32_16x16x32_bf16 a[180:183], v[68:71], a[4:7], a[180:183]
v_mul_f32 v215, v127, v143
v_fma_f32 v212, v212, v246, v246
v_mfma_f32_16x16x32_bf16 a[184:187], v[64:67], v[184:187], a[184:187]
v_fma_f32 v214, v214, v246, v246
v_rcp_f32 v212, v212
v_mfma_f32_16x16x32_bf16 a[184:187], v[68:71], a[8:11], a[184:187]
ds_read_b128 v[60:63], v2 offset:19456
v_rcp_f32 v214, v214
v_mfma_f32_16x16x32_bf16 a[188:191], v[64:67], v[188:191], a[188:191]
v_mul_f32 v213, v213, v212
v_mul_f32 v215, v215, v214
v_mfma_f32_16x16x32_bf16 a[188:191], v[68:71], a[12:15], a[188:191]
v_cvt_pk_bf16_f32 v207, v213, v215
buffer_store_dwordx4 v[204:207], v6, s[8:11], s24 offen offset:3072 sc1
s_waitcnt lgkmcnt(4)
v_mfma_f32_16x16x32_bf16 a[192:195], v[72:75], v[176:179], a[192:195]
buffer_load_dwordx4 a[88:91], v5, s[8:11], s27 offen offset:1024 sc1
v_mfma_f32_16x16x32_bf16 a[192:195], v[76:79], a[0:3], a[192:195]
v_mfma_f32_16x16x32_bf16 a[196:199], v[72:75], v[180:183], a[196:199]
ds_read_b128 v[64:67], v2 offset:20480
v_mfma_f32_16x16x32_bf16 a[196:199], v[76:79], a[4:7], a[196:199]
v_mfma_f32_16x16x32_bf16 a[200:203], v[72:75], v[184:187], a[200:203]
v_mfma_f32_16x16x32_bf16 a[200:203], v[76:79], a[8:11], a[200:203]
ds_read_b128 v[68:71], v2 offset:21504
v_mfma_f32_16x16x32_bf16 a[204:207], v[72:75], v[188:191], a[204:207]
buffer_load_dwordx4 a[92:95], v6, s[8:11], s27 offen offset:1024 sc1
v_mfma_f32_16x16x32_bf16 a[204:207], v[76:79], a[12:15], a[204:207]
s_waitcnt lgkmcnt(4)
v_mfma_f32_16x16x32_bf16 a[208:211], v[48:51], v[176:179], a[208:211]
v_mfma_f32_16x16x32_bf16 a[208:211], v[52:55], a[0:3], a[208:211]
v_mfma_f32_16x16x32_bf16 a[212:215], v[48:51], v[180:183], a[212:215]
ds_read_b128 v[72:75], v2 offset:22528
v_mfma_f32_16x16x32_bf16 a[212:215], v[52:55], a[4:7], a[212:215]
buffer_load_dwordx2 a[96:97], v248, s[8:11], s28 offen offset:0 sc1
v_mfma_f32_16x16x32_bf16 a[216:219], v[48:51], v[184:187], a[216:219]
v_mfma_f32_16x16x32_bf16 a[216:219], v[52:55], a[8:11], a[216:219]
ds_read_b128 v[76:79], v2 offset:23552
v_mfma_f32_16x16x32_bf16 a[220:223], v[48:51], v[188:191], a[220:223]
v_mfma_f32_16x16x32_bf16 a[220:223], v[52:55], a[12:15], a[220:223]
s_waitcnt lgkmcnt(4)
v_mfma_f32_16x16x32_bf16 a[224:227], v[56:59], v[176:179], a[224:227]
s_waitcnt vmcnt(40)
v_mfma_f32_16x16x32_bf16 a[224:227], v[60:63], a[0:3], a[224:227]
s_barrier
v_mfma_f32_16x16x32_bf16 a[228:231], v[56:59], v[180:183], a[228:231]
ds_read_b128 v[48:51], v2 offset:24576
buffer_load_dwordx2 a[98:99], v248, s[8:11], s28 offen offset:512 sc1
v_mfma_f32_16x16x32_bf16 a[228:231], v[60:63], a[4:7], a[228:231]
v_mfma_f32_16x16x32_bf16 a[232:235], v[56:59], v[184:187], a[232:235]
v_mfma_f32_16x16x32_bf16 a[232:235], v[60:63], a[8:11], a[232:235]
ds_read_b128 v[52:55], v2 offset:25600
v_mfma_f32_16x16x32_bf16 a[236:239], v[56:59], v[188:191], a[236:239]
v_mfma_f32_16x16x32_bf16 a[236:239], v[60:63], a[12:15], a[236:239]
s_waitcnt vmcnt(19)
s_waitcnt lgkmcnt(4)
v_mfma_f32_16x16x32_bf16 a[112:115], v[64:67], a[16:19], a[112:115]
buffer_load_dwordx2 a[100:101], v249, s[8:11], s28 offen offset:0 sc1
v_mfma_f32_16x16x32_bf16 a[112:115], v[68:71], a[32:35], a[112:115]
v_mfma_f32_16x16x32_bf16 a[116:119], v[64:67], a[20:23], a[116:119]
ds_read_b128 v[56:59], v2 offset:26624
v_mfma_f32_16x16x32_bf16 a[116:119], v[68:71], a[36:39], a[116:119]
v_mfma_f32_16x16x32_bf16 a[120:123], v[64:67], a[24:27], a[120:123]
v_mfma_f32_16x16x32_bf16 a[120:123], v[68:71], a[40:43], a[120:123]
ds_read_b128 v[60:63], v2 offset:27648
v_mfma_f32_16x16x32_bf16 a[124:127], v[64:67], a[28:31], a[124:127]
buffer_load_dwordx2 a[102:103], v249, s[8:11], s28 offen offset:512 sc1
v_mfma_f32_16x16x32_bf16 a[124:127], v[68:71], a[44:47], a[124:127]
s_waitcnt lgkmcnt(4)
v_mfma_f32_16x16x32_bf16 a[128:131], v[72:75], a[16:19], a[128:131]
v_mfma_f32_16x16x32_bf16 a[128:131], v[76:79], a[32:35], a[128:131]
v_mfma_f32_16x16x32_bf16 a[132:135], v[72:75], a[20:23], a[132:135]
ds_read_b128 v[64:67], v2 offset:28672
v_mfma_f32_16x16x32_bf16 a[132:135], v[76:79], a[36:39], a[132:135]
buffer_load_dwordx2 a[104:105], v250, s[8:11], s28 offen offset:0 sc1
v_mfma_f32_16x16x32_bf16 a[136:139], v[72:75], a[24:27], a[136:139]
v_mfma_f32_16x16x32_bf16 a[136:139], v[76:79], a[40:43], a[136:139]
ds_read_b128 v[68:71], v2 offset:29696
v_mfma_f32_16x16x32_bf16 a[140:143], v[72:75], a[28:31], a[140:143]
v_mfma_f32_16x16x32_bf16 a[140:143], v[76:79], a[44:47], a[140:143]
s_waitcnt lgkmcnt(4)
v_mfma_f32_16x16x32_bf16 a[144:147], v[48:51], a[16:19], a[144:147]
buffer_load_dwordx2 a[106:107], v250, s[8:11], s28 offen offset:512 sc1
v_mfma_f32_16x16x32_bf16 a[144:147], v[52:55], a[32:35], a[144:147]
v_mfma_f32_16x16x32_bf16 a[148:151], v[48:51], a[20:23], a[148:151]
ds_read_b128 v[72:75], v2 offset:30720
v_mfma_f32_16x16x32_bf16 a[148:151], v[52:55], a[36:39], a[148:151]
v_mfma_f32_16x16x32_bf16 a[152:155], v[48:51], a[24:27], a[152:155]
buffer_load_dwordx2 a[108:109], v251, s[8:11], s28 offen offset:0 sc1
v_mfma_f32_16x16x32_bf16 a[152:155], v[52:55], a[40:43], a[152:155]
ds_read_b128 v[76:79], v2 offset:31744
v_mfma_f32_16x16x32_bf16 a[156:159], v[48:51], a[28:31], a[156:159]
v_mfma_f32_16x16x32_bf16 a[156:159], v[52:55], a[44:47], a[156:159]
s_waitcnt lgkmcnt(4)
v_mfma_f32_16x16x32_bf16 a[160:163], v[56:59], a[16:19], a[160:163]
buffer_load_dwordx2 a[110:111], v251, s[8:11], s28 offen offset:512 sc1
v_mfma_f32_16x16x32_bf16 a[160:163], v[60:63], a[32:35], a[160:163]
s_add_u32 m0, s22, 73728
v_add_u32 v3, 20480, v3
v_mfma_f32_16x16x32_bf16 a[164:167], v[56:59], a[20:23], a[164:167]
ds_read_b128 v[48:51], v2 offset:32768
v_mfma_f32_16x16x32_bf16 a[164:167], v[60:63], a[36:39], a[164:167]
v_mfma_f32_16x16x32_bf16 a[168:171], v[56:59], a[24:27], a[168:171]
v_mfma_f32_16x16x32_bf16 a[168:171], v[60:63], a[40:43], a[168:171]
ds_read_b128 v[52:55], v2 offset:33792
v_mfma_f32_16x16x32_bf16 a[172:175], v[56:59], a[28:31], a[172:175]
buffer_load_dwordx4 v3, s[8:11], 0 offen offset:0 sc1 lds
v_mfma_f32_16x16x32_bf16 a[172:175], v[60:63], a[44:47], a[172:175]
s_waitcnt lgkmcnt(4)
v_mfma_f32_16x16x32_bf16 a[176:179], v[64:67], a[16:19], a[176:179]
v_mov_b32 v12, s68
v_mov_b32 v13, s69
v_mfma_f32_16x16x32_bf16 a[176:179], v[68:71], a[32:35], a[176:179]
s_add_u32 s53, s34, 262144
s_waitcnt vmcnt(11)
v_mfma_f32_16x16x32_bf16 a[180:183], v[64:67], a[20:23], a[180:183]
ds_read_b128 v[56:59], v2 offset:34816
v_mfma_f32_16x16x32_bf16 a[180:183], v[68:71], a[36:39], a[180:183]
buffer_store_dwordx2 v[12:13], v10, s[8:11], s53 offen sc1
v_mfma_f32_16x16x32_bf16 a[184:187], v[64:67], a[24:27], a[184:187]
v_mfma_f32_16x16x32_bf16 a[184:187], v[68:71], a[40:43], a[184:187]
ds_read_b128 v[60:63], v2 offset:35840
v_mfma_f32_16x16x32_bf16 a[188:191], v[64:67], a[28:31], a[188:191]
v_mfma_f32_16x16x32_bf16 a[188:191], v[68:71], a[44:47], a[188:191]
s_waitcnt lgkmcnt(4)
v_mfma_f32_16x16x32_bf16 a[192:195], v[72:75], a[16:19], a[192:195]
buffer_load_dwordx4 v3, s[8:11], 0 offen offset:1024 sc1 lds
v_mfma_f32_16x16x32_bf16 a[192:195], v[76:79], a[32:35], a[192:195]
v_mfma_f32_16x16x32_bf16 a[196:199], v[72:75], a[20:23], a[196:199]
ds_read_b128 v[64:67], v2 offset:36864
v_mfma_f32_16x16x32_bf16 a[196:199], v[76:79], a[36:39], a[196:199]
v_mfma_f32_16x16x32_bf16 a[200:203], v[72:75], a[24:27], a[200:203]
v_mfma_f32_16x16x32_bf16 a[200:203], v[76:79], a[40:43], a[200:203]
ds_read_b128 v[68:71], v2 offset:37888
v_mfma_f32_16x16x32_bf16 a[204:207], v[72:75], a[28:31], a[204:207]
buffer_load_dwordx4 v3, s[8:11], 0 offen offset:2048 sc1 lds
v_mfma_f32_16x16x32_bf16 a[204:207], v[76:79], a[44:47], a[204:207]
s_waitcnt lgkmcnt(4)
v_mfma_f32_16x16x32_bf16 a[208:211], v[48:51], a[16:19], a[208:211]
v_mfma_f32_16x16x32_bf16 a[208:211], v[52:55], a[32:35], a[208:211]
v_mfma_f32_16x16x32_bf16 a[212:215], v[48:51], a[20:23], a[212:215]
ds_read_b128 v[72:75], v2 offset:38912
v_mfma_f32_16x16x32_bf16 a[212:215], v[52:55], a[36:39], a[212:215]
buffer_load_dwordx4 v3, s[8:11], 0 offen offset:3072 sc1 lds
v_mfma_f32_16x16x32_bf16 a[216:219], v[48:51], a[24:27], a[216:219]
s_add_u32 m0, s22, 77824
v_add_u32 v3, 4096, v3
v_mfma_f32_16x16x32_bf16 a[216:219], v[52:55], a[40:43], a[216:219]
ds_read_b128 v[76:79], v2 offset:39936
v_mfma_f32_16x16x32_bf16 a[220:223], v[48:51], a[28:31], a[220:223]
v_mfma_f32_16x16x32_bf16 a[220:223], v[52:55], a[44:47], a[220:223]
s_waitcnt lgkmcnt(4)
v_mfma_f32_16x16x32_bf16 a[224:227], v[56:59], a[16:19], a[224:227]
buffer_load_dwordx4 v3, s[8:11], 0 offen offset:0 sc1 lds
v_mfma_f32_16x16x32_bf16 a[224:227], v[60:63], a[32:35], a[224:227]
v_mfma_f32_16x16x32_bf16 a[228:231], v[56:59], a[20:23], a[228:231]
ds_read_b128 v[48:51], v2 offset:40960
v_mfma_f32_16x16x32_bf16 a[228:231], v[60:63], a[36:39], a[228:231]
v_mfma_f32_16x16x32_bf16 a[232:235], v[56:59], a[24:27], a[232:235]
v_mfma_f32_16x16x32_bf16 a[232:235], v[60:63], a[40:43], a[232:235]
ds_read_b128 v[52:55], v2 offset:41984
v_mfma_f32_16x16x32_bf16 a[236:239], v[56:59], a[28:31], a[236:239]
buffer_load_dwordx4 v3, s[8:11], 0 offen offset:1024 sc1 lds
v_mfma_f32_16x16x32_bf16 a[236:239], v[60:63], a[44:47], a[236:239]
s_waitcnt vmcnt(24)
s_waitcnt lgkmcnt(4)
v_mfma_f32_16x16x32_bf16 a[112:115], v[64:67], a[48:51], a[112:115]
v_mfma_f32_16x16x32_bf16 a[112:115], v[68:71], a[64:67], a[112:115]
v_mfma_f32_16x16x32_bf16 a[116:119], v[64:67], a[52:55], a[116:119]
ds_read_b128 v[56:59], v2 offset:43008
v_mfma_f32_16x16x32_bf16 a[116:119], v[68:71], a[68:71], a[116:119]
buffer_load_dwordx2 v[16:17], v248, s[8:11], s29 offen offset:0 sc1
v_mfma_f32_16x16x32_bf16 a[120:123], v[64:67], a[56:59], a[120:123]
v_mfma_f32_16x16x32_bf16 a[120:123], v[68:71], a[72:75], a[120:123]
ds_read_b128 v[60:63], v2 offset:44032
v_mfma_f32_16x16x32_bf16 a[124:127], v[64:67], a[60:63], a[124:127]
v_mfma_f32_16x16x32_bf16 a[124:127], v[68:71], a[76:79], a[124:127]
s_waitcnt lgkmcnt(4)
v_mfma_f32_16x16x32_bf16 a[128:131], v[72:75], a[48:51], a[128:131]
buffer_load_dwordx2 v[18:19], v248, s[8:11], s29 offen offset:512 sc1
v_mfma_f32_16x16x32_bf16 a[128:131], v[76:79], a[64:67], a[128:131]
v_mfma_f32_16x16x32_bf16 a[132:135], v[72:75], a[52:55], a[132:135]
ds_read_b128 v[64:67], v2 offset:45056
v_mfma_f32_16x16x32_bf16 a[132:135], v[76:79], a[68:71], a[132:135]
v_mfma_f32_16x16x32_bf16 a[136:139], v[72:75], a[56:59], a[136:139]
v_mfma_f32_16x16x32_bf16 a[136:139], v[76:79], a[72:75], a[136:139]
ds_read_b128 v[68:71], v2 offset:46080
v_mfma_f32_16x16x32_bf16 a[140:143], v[72:75], a[60:63], a[140:143]
buffer_load_dwordx2 v[20:21], v249, s[8:11], s29 offen offset:0 sc1
v_mfma_f32_16x16x32_bf16 a[140:143], v[76:79], a[76:79], a[140:143]
s_waitcnt lgkmcnt(4)
v_mfma_f32_16x16x32_bf16 a[144:147], v[48:51], a[48:51], a[144:147]
s_add_u32 s23, s34, 262144
v_mfma_f32_16x16x32_bf16 a[144:147], v[52:55], a[64:67], a[144:147]
v_mfma_f32_16x16x32_bf16 a[148:151], v[48:51], a[52:55], a[148:151]
ds_read_b128 v[72:75], v2 offset:47104
v_mfma_f32_16x16x32_bf16 a[148:151], v[52:55], a[68:71], a[148:151]
buffer_load_dwordx2 v[14:15], v11, s[8:11], s23 offen sc1
v_mfma_f32_16x16x32_bf16 a[152:155], v[48:51], a[56:59], a[152:155]
v_mfma_f32_16x16x32_bf16 a[152:155], v[52:55], a[72:75], a[152:155]
ds_read_b128 v[76:79], v2 offset:48128
v_mfma_f32_16x16x32_bf16 a[156:159], v[48:51], a[60:63], a[156:159]
v_mfma_f32_16x16x32_bf16 a[156:159], v[52:55], a[76:79], a[156:159]
s_waitcnt lgkmcnt(4)
v_mfma_f32_16x16x32_bf16 a[160:163], v[56:59], a[48:51], a[160:163]
s_waitcnt vmcnt(49)
v_mfma_f32_16x16x32_bf16 a[160:163], v[60:63], a[64:67], a[160:163]
s_barrier
v_mfma_f32_16x16x32_bf16 a[164:167], v[56:59], a[52:55], a[164:167]
ds_read_b128 v[48:51], v2 offset:49152
buffer_load_dwordx2 v[22:23], v249, s[8:11], s29 offen offset:512 sc1
v_mfma_f32_16x16x32_bf16 a[164:167], v[60:63], a[68:71], a[164:167]
v_mfma_f32_16x16x32_bf16 a[168:171], v[56:59], a[56:59], a[168:171]
v_mfma_f32_16x16x32_bf16 a[168:171], v[60:63], a[72:75], a[168:171]
ds_read_b128 v[52:55], v2 offset:50176
v_mfma_f32_16x16x32_bf16 a[172:175], v[56:59], a[60:63], a[172:175]
buffer_load_dwordx2 v[24:25], v250, s[8:11], s29 offen offset:0 sc1
v_mfma_f32_16x16x32_bf16 a[172:175], v[60:63], a[76:79], a[172:175]
s_waitcnt lgkmcnt(4)
v_mfma_f32_16x16x32_bf16 a[176:179], v[64:67], a[48:51], a[176:179]
v_mfma_f32_16x16x32_bf16 a[176:179], v[68:71], a[64:67], a[176:179]
v_mfma_f32_16x16x32_bf16 a[180:183], v[64:67], a[52:55], a[180:183]
ds_read_b128 v[56:59], v2 offset:51200
v_mfma_f32_16x16x32_bf16 a[180:183], v[68:71], a[68:71], a[180:183]
buffer_load_dwordx2 v[26:27], v250, s[8:11], s29 offen offset:512 sc1
v_mfma_f32_16x16x32_bf16 a[184:187], v[64:67], a[56:59], a[184:187]
v_mfma_f32_16x16x32_bf16 a[184:187], v[68:71], a[72:75], a[184:187]
ds_read_b128 v[60:63], v2 offset:52224
v_mfma_f32_16x16x32_bf16 a[188:191], v[64:67], a[60:63], a[188:191]
v_mfma_f32_16x16x32_bf16 a[188:191], v[68:71], a[76:79], a[188:191]
s_waitcnt lgkmcnt(4)
v_mfma_f32_16x16x32_bf16 a[192:195], v[72:75], a[48:51], a[192:195]
buffer_load_dwordx2 v[28:29], v251, s[8:11], s29 offen offset:0 sc1
v_mfma_f32_16x16x32_bf16 a[192:195], v[76:79], a[64:67], a[192:195]
v_mfma_f32_16x16x32_bf16 a[196:199], v[72:75], a[52:55], a[196:199]
ds_read_b128 v[64:67], v2 offset:53248
v_mfma_f32_16x16x32_bf16 a[196:199], v[76:79], a[68:71], a[196:199]
v_mfma_f32_16x16x32_bf16 a[200:203], v[72:75], a[56:59], a[200:203]
buffer_load_dwordx2 v[30:31], v251, s[8:11], s29 offen offset:512 sc1
v_mfma_f32_16x16x32_bf16 a[200:203], v[76:79], a[72:75], a[200:203]
ds_read_b128 v[68:71], v2 offset:54272
v_mfma_f32_16x16x32_bf16 a[204:207], v[72:75], a[60:63], a[204:207]
v_mfma_f32_16x16x32_bf16 a[204:207], v[76:79], a[76:79], a[204:207]
s_waitcnt lgkmcnt(4)
v_mfma_f32_16x16x32_bf16 a[208:211], v[48:51], a[48:51], a[208:211]
buffer_load_dwordx4 v[32:35], v2, s[8:11], s25 offen offset:2048 sc1
v_mfma_f32_16x16x32_bf16 a[208:211], v[52:55], a[64:67], a[208:211]
v_mfma_f32_16x16x32_bf16 a[212:215], v[48:51], a[52:55], a[212:215]
ds_read_b128 v[72:75], v2 offset:55296
v_mfma_f32_16x16x32_bf16 a[212:215], v[52:55], a[68:71], a[212:215]
v_mfma_f32_16x16x32_bf16 a[216:219], v[48:51], a[56:59], a[216:219]
buffer_load_dwordx4 v[36:39], v4, s[8:11], s25 offen offset:2048 sc1
v_mfma_f32_16x16x32_bf16 a[216:219], v[52:55], a[72:75], a[216:219]
ds_read_b128 v[76:79], v2 offset:56320
v_mfma_f32_16x16x32_bf16 a[220:223], v[48:51], a[60:63], a[220:223]
v_mfma_f32_16x16x32_bf16 a[220:223], v[52:55], a[76:79], a[220:223]
s_waitcnt lgkmcnt(4)
v_mfma_f32_16x16x32_bf16 a[224:227], v[56:59], a[48:51], a[224:227]
buffer_load_dwordx4 v[40:43], v5, s[8:11], s25 offen offset:2048 sc1
v_mfma_f32_16x16x32_bf16 a[224:227], v[60:63], a[64:67], a[224:227]
v_mfma_f32_16x16x32_bf16 a[228:231], v[56:59], a[52:55], a[228:231]
ds_read_b128 v[48:51], v2 offset:57344
v_mfma_f32_16x16x32_bf16 a[228:231], v[60:63], a[68:71], a[228:231]
v_mfma_f32_16x16x32_bf16 a[232:235], v[56:59], a[56:59], a[232:235]
buffer_load_dwordx4 v[44:47], v6, s[8:11], s25 offen offset:2048 sc1
v_mfma_f32_16x16x32_bf16 a[232:235], v[60:63], a[72:75], a[232:235]
ds_read_b128 v[52:55], v2 offset:58368
v_mfma_f32_16x16x32_bf16 a[236:239], v[56:59], a[60:63], a[236:239]
v_mfma_f32_16x16x32_bf16 a[236:239], v[60:63], a[76:79], a[236:239]
s_waitcnt vmcnt(20)
s_waitcnt lgkmcnt(4)
v_mfma_f32_16x16x32_bf16 a[112:115], v[64:67], a[80:83], a[112:115]
buffer_load_dwordx4 v[80:83], v2, s[8:11], s26 offen offset:2048 sc1
v_mfma_f32_16x16x32_bf16 a[112:115], v[68:71], a[96:99], a[112:115]
v_mfma_f32_16x16x32_bf16 a[116:119], v[64:67], a[84:87], a[116:119]
ds_read_b128 v[56:59], v2 offset:59392
v_mfma_f32_16x16x32_bf16 a[116:119], v[68:71], a[100:103], a[116:119]
v_mfma_f32_16x16x32_bf16 a[120:123], v[64:67], a[88:91], a[120:123]
buffer_load_dwordx4 v[84:87], v4, s[8:11], s26 offen offset:2048 sc1
v_mfma_f32_16x16x32_bf16 a[120:123], v[68:71], a[104:107], a[120:123]
ds_read_b128 v[60:63], v2 offset:60416
v_mfma_f32_16x16x32_bf16 a[124:127], v[64:67], a[92:95], a[124:127]
v_mfma_f32_16x16x32_bf16 a[124:127], v[68:71], a[108:111], a[124:127]
s_waitcnt lgkmcnt(4)
v_mfma_f32_16x16x32_bf16 a[128:131], v[72:75], a[80:83], a[128:131]
buffer_load_dwordx4 v[88:91], v5, s[8:11], s26 offen offset:2048 sc1
v_mfma_f32_16x16x32_bf16 a[128:131], v[76:79], a[96:99], a[128:131]
v_mfma_f32_16x16x32_bf16 a[132:135], v[72:75], a[84:87], a[132:135]
ds_read_b128 v[64:67], v2 offset:61440
v_mfma_f32_16x16x32_bf16 a[132:135], v[76:79], a[100:103], a[132:135]
v_mfma_f32_16x16x32_bf16 a[136:139], v[72:75], a[88:91], a[136:139]
buffer_load_dwordx4 v[92:95], v6, s[8:11], s26 offen offset:2048 sc1
v_mfma_f32_16x16x32_bf16 a[136:139], v[76:79], a[104:107], a[136:139]
ds_read_b128 v[68:71], v2 offset:62464
s_waitcnt vmcnt(13)
v_cmp_eq_u64 vcc, s[68:69], v[14:15]
s_nop 0
s_cmp_eq_u64 vcc, exec
s_cbranch_scc0 L_f_slow3
L_f_back3:
v_mfma_f32_16x16x32_bf16 a[140:143], v[72:75], a[92:95], a[140:143]
v_mfma_f32_16x16x32_bf16 a[140:143], v[76:79], a[108:111], a[140:143]
s_waitcnt lgkmcnt(4)
v_mfma_f32_16x16x32_bf16 a[144:147], v[48:51], a[80:83], a[144:147]
buffer_load_dwordx4 v[96:99], v2, s[8:11], s27 offen offset:2048 sc1
v_mfma_f32_16x16x32_bf16 a[144:147], v[52:55], a[96:99], a[144:147]
v_mfma_f32_16x16x32_bf16 a[148:151], v[48:51], a[84:87], a[148:151]
ds_read_b128 v[72:75], v2 offset:63488
v_mfma_f32_16x16x32_bf16 a[148:151], v[52:55], a[100:103], a[148:151]
v_mfma_f32_16x16x32_bf16 a[152:155], v[48:51], a[88:91], a[152:155]
buffer_load_dwordx4 v[100:103], v4, s[8:11], s27 offen offset:2048 sc1
v_mfma_f32_16x16x32_bf16 a[152:155], v[52:55], a[104:107], a[152:155]
ds_read_b128 v[76:79], v2 offset:64512
v_mfma_f32_16x16x32_bf16 a[156:159], v[48:51], a[92:95], a[156:159]
v_mfma_f32_16x16x32_bf16 a[156:159], v[52:55], a[108:111], a[156:159]
s_waitcnt lgkmcnt(4)
v_mfma_f32_16x16x32_bf16 a[160:163], v[56:59], a[80:83], a[160:163]
buffer_load_dwordx4 v[104:107], v5, s[8:11], s27 offen offset:2048 sc1
v_mfma_f32_16x16x32_bf16 a[160:163], v[60:63], a[96:99], a[160:163]
v_mfma_f32_16x16x32_bf16 a[164:167], v[56:59], a[84:87], a[164:167]
ds_read_b128 v[48:51], v7 offset:0
v_mfma_f32_16x16x32_bf16 a[164:167], v[60:63], a[100:103], a[164:167]
v_mfma_f32_16x16x32_bf16 a[168:171], v[56:59], a[88:91], a[168:171]
buffer_load_dwordx4 v[108:111], v6, s[8:11], s27 offen offset:2048 sc1
v_mfma_f32_16x16x32_bf16 a[168:171], v[60:63], a[104:107], a[168:171]
ds_read_b128 v[52:55], v7 offset:1024
v_mfma_f32_16x16x32_bf16 a[172:175], v[56:59], a[92:95], a[172:175]
v_mfma_f32_16x16x32_bf16 a[172:175], v[60:63], a[108:111], a[172:175]
s_waitcnt lgkmcnt(4)
v_mfma_f32_16x16x32_bf16 a[176:179], v[64:67], a[80:83], a[176:179]
buffer_load_dwordx4 v[112:115], v2, s[8:11], s25 offen offset:3072 sc1
v_mfma_f32_16x16x32_bf16 a[176:179], v[68:71], a[96:99], a[176:179]
v_mfma_f32_16x16x32_bf16 a[180:183], v[64:67], a[84:87], a[180:183]
ds_read_b128 v[56:59], v7 offset:2048
v_mfma_f32_16x16x32_bf16 a[180:183], v[68:71], a[100:103], a[180:183]
v_mfma_f32_16x16x32_bf16 a[184:187], v[64:67], a[88:91], a[184:187]
buffer_load_dwordx4 v[116:119], v4, s[8:11], s25 offen offset:3072 sc1
v_mfma_f32_16x16x32_bf16 a[184:187], v[68:71], a[104:107], a[184:187]
ds_read_b128 v[60:63], v7 offset:3072
v_mfma_f32_16x16x32_bf16 a[188:191], v[64:67], a[92:95], a[188:191]
v_mfma_f32_16x16x32_bf16 a[188:191], v[68:71], a[108:111], a[188:191]
s_waitcnt lgkmcnt(4)
v_mfma_f32_16x16x32_bf16 a[192:195], v[72:75], a[80:83], a[192:195]
buffer_load_dwordx4 v[120:123], v5, s[8:11], s25 offen offset:3072 sc1
v_mfma_f32_16x16x32_bf16 a[192:195], v[76:79], a[96:99], a[192:195]
v_mfma_f32_16x16x32_bf16 a[196:199], v[72:75], a[84:87], a[196:199]
ds_read_b128 v[64:67], v7 offset:4096
v_mfma_f32_16x16x32_bf16 a[196:199], v[76:79], a[100:103], a[196:199]
v_mfma_f32_16x16x32_bf16 a[200:203], v[72:75], a[88:91], a[200:203]
buffer_load_dwordx4 v[124:127], v6, s[8:11], s25 offen offset:3072 sc1
v_mfma_f32_16x16x32_bf16 a[200:203], v[76:79], a[104:107], a[200:203]
ds_read_b128 v[68:71], v7 offset:5120
v_mfma_f32_16x16x32_bf16 a[204:207], v[72:75], a[92:95], a[204:207]
v_mfma_f32_16x16x32_bf16 a[204:207], v[76:79], a[108:111], a[204:207]
s_waitcnt lgkmcnt(4)
v_mfma_f32_16x16x32_bf16 a[208:211], v[48:51], a[80:83], a[208:211]
buffer_load_dwordx4 v[128:131], v2, s[8:11], s26 offen offset:3072 sc1
v_mfma_f32_16x16x32_bf16 a[208:211], v[52:55], a[96:99], a[208:211]
v_mfma_f32_16x16x32_bf16 a[212:215], v[48:51], a[84:87], a[212:215]
ds_read_b128 v[72:75], v7 offset:6144
v_mfma_f32_16x16x32_bf16 a[212:215], v[52:55], a[100:103], a[212:215]
v_mfma_f32_16x16x32_bf16 a[216:219], v[48:51], a[88:91], a[216:219]
buffer_load_dwordx4 v[132:135], v4, s[8:11], s26 offen offset:3072 sc1
v_mfma_f32_16x16x32_bf16 a[216:219], v[52:55], a[104:107], a[216:219]
ds_read_b128 v[76:79], v7 offset:7168
v_mfma_f32_16x16x32_bf16 a[220:223], v[48:51], a[92:95], a[220:223]
v_mfma_f32_16x16x32_bf16 a[220:223], v[52:55], a[108:111], a[220:223]
s_waitcnt lgkmcnt(4)
v_mfma_f32_16x16x32_bf16 a[224:227], v[56:59], a[80:83], a[224:227]
s_waitcnt vmcnt(27)
v_mfma_f32_16x16x32_bf16 a[224:227], v[60:63], a[96:99], a[224:227]
s_barrier
v_mfma_f32_16x16x32_bf16 a[228:231], v[56:59], a[84:87], a[228:231]
ds_read_b128 v[48:51], v7 offset:8192
buffer_load_dwordx4 v[136:139], v5, s[8:11], s26 offen offset:3072 sc1
v_mfma_f32_16x16x32_bf16 a[228:231], v[60:63], a[100:103], a[228:231]
v_mfma_f32_16x16x32_bf16 a[232:235], v[56:59], a[88:91], a[232:235]
v_mfma_f32_16x16x32_bf16 a[232:235], v[60:63], a[104:107], a[232:235]
ds_read_b128 v[52:55], v7 offset:9216
v_mfma_f32_16x16x32_bf16 a[236:239], v[56:59], a[92:95], a[236:239]
buffer_load_dwordx4 v[140:143], v6, s[8:11], s26 offen offset:3072 sc1
v_mfma_f32_16x16x32_bf16 a[236:239], v[60:63], a[108:111], a[236:239]
s_waitcnt vmcnt(20)
s_waitcnt lgkmcnt(4)
v_mfma_f32_16x16x32_bf16 a[112:115], v[64:67], v[16:19], a[112:115]
v_mfma_f32_16x16x32_bf16 a[112:115], v[68:71], v[192:195], a[112:115]
v_mfma_f32_16x16x32_bf16 a[116:119], v[64:67], v[20:23], a[116:119]
ds_read_b128 v[56:59], v7 offset:10240
v_mfma_f32_16x16x32_bf16 a[116:119], v[68:71], v[196:199], a[116:119]
buffer_load_dwordx4 v[232:235], v2, s[8:11], s27 offen offset:3072 sc1
v_mfma_f32_16x16x32_bf16 a[120:123], v[64:67], v[24:27], a[120:123]
v_mfma_f32_16x16x32_bf16 a[120:123], v[68:71], v[200:203], a[120:123]
ds_read_b128 v[60:63], v7 offset:11264
v_mfma_f32_16x16x32_bf16 a[124:127], v[64:67], v[28:31], a[124:127]
L_hop10:
s_cmp_eq_u32 s15, 1
s_cbranch_scc1 L_hop14
v_mfma_f32_16x16x32_bf16 a[124:127], v[68:71], v[204:207], a[124:127]
s_waitcnt lgkmcnt(4)
v_mfma_f32_16x16x32_bf16 a[128:131], v[72:75], v[16:19], a[128:131]
buffer_load_dwordx4 v[236:239], v4, s[8:11], s27 offen offset:3072 sc1
v_mfma_f32_16x16x32_bf16 a[128:131], v[76:79], v[192:195], a[128:131]
v_mfma_f32_16x16x32_bf16 a[132:135], v[72:75], v[20:23], a[132:135]
ds_read_b128 v[64:67], v7 offset:12288
v_mfma_f32_16x16x32_bf16 a[132:135], v[76:79], v[196:199], a[132:135]
v_mfma_f32_16x16x32_bf16 a[136:139], v[72:75], v[24:27], a[136:139]
buffer_load_dwordx4 v[240:243], v5, s[8:11], s27 offen offset:3072 sc1
v_mfma_f32_16x16x32_bf16 a[136:139], v[76:79], v[200:203], a[136:139]
ds_read_b128 v[68:71], v7 offset:13312
v_mfma_f32_16x16x32_bf16 a[140:143], v[72:75], v[28:31], a[140:143]
v_mfma_f32_16x16x32_bf16 a[140:143], v[76:79], v[204:207], a[140:143]
s_waitcnt lgkmcnt(4)
v_mfma_f32_16x16x32_bf16 a[144:147], v[48:51], v[16:19], a[144:147]
buffer_load_dwordx4 v[244:247], v6, s[8:11], s27 offen offset:3072 sc1
v_mfma_f32_16x16x32_bf16 a[144:147], v[52:55], v[192:195], a[144:147]
s_add_u32 m0, s22, 98304
v_add_u32 v3, 20480, v3
v_mfma_f32_16x16x32_bf16 a[148:151], v[48:51], v[20:23], a[148:151]
ds_read_b128 v[72:75], v7 offset:14336
v_mfma_f32_16x16x32_bf16 a[148:151], v[52:55], v[196:199], a[148:151]
v_mfma_f32_16x16x32_bf16 a[152:155], v[48:51], v[24:27], a[152:155]
buffer_load_dwordx4 v3, s[8:11], 0 offen offset:0 sc1 lds
v_mfma_f32_16x16x32_bf16 a[152:155], v[52:55], v[200:203], a[152:155]
ds_read_b128 v[76:79], v7 offset:15360
v_mfma_f32_16x16x32_bf16 a[156:159], v[48:51], v[28:31], a[156:159]
v_mfma_f32_16x16x32_bf16 a[156:159], v[52:55], v[204:207], a[156:159]
s_waitcnt lgkmcnt(4)
v_mfma_f32_16x16x32_bf16 a[160:163], v[56:59], v[16:19], a[160:163]
buffer_load_dwordx4 v3, s[8:11], 0 offen offset:1024 sc1 lds
v_mfma_f32_16x16x32_bf16 a[160:163], v[60:63], v[192:195], a[160:163]
v_mfma_f32_16x16x32_bf16 a[164:167], v[56:59], v[20:23], a[164:167]
ds_read_b128 v[48:51], v7 offset:16384
v_mfma_f32_16x16x32_bf16 a[164:167], v[60:63], v[196:199], a[164:167]
v_mfma_f32_16x16x32_bf16 a[168:171], v[56:59], v[24:27], a[168:171]
buffer_load_dwordx4 v3, s[8:11], 0 offen offset:2048 sc1 lds
v_mfma_f32_16x16x32_bf16 a[168:171], v[60:63], v[200:203], a[168:171]
ds_read_b128 v[52:55], v7 offset:17408
v_mfma_f32_16x16x32_bf16 a[172:175], v[56:59], v[28:31], a[172:175]
v_mfma_f32_16x16x32_bf16 a[172:175], v[60:63], v[204:207], a[172:175]
s_waitcnt vmcnt(19)
s_waitcnt lgkmcnt(4)
v_mfma_f32_16x16x32_bf16 a[112:115], v[64:67], v[32:35], a[112:115]
buffer_load_dwordx4 v3, s[8:11], 0 offen offset:3072 sc1 lds
v_mfma_f32_16x16x32_bf16 a[112:115], v[68:71], v[80:83], a[112:115]
s_add_u32 m0, s22, 102400
v_add_u32 v3, 4096, v3
v_mfma_f32_16x16x32_bf16 a[116:119], v[64:67], v[36:39], a[116:119]
ds_read_b128 v[56:59], v7 offset:18432
v_mfma_f32_16x16x32_bf16 a[116:119], v[68:71], v[84:87], a[116:119]
v_mfma_f32_16x16x32_bf16 a[120:123], v[64:67], v[40:43], a[120:123]
buffer_load_dwordx4 v3, s[8:11], 0 offen offset:0 sc1 lds
v_mfma_f32_16x16x32_bf16 a[120:123], v[68:71], v[88:91], a[120:123]
ds_read_b128 v[60:63], v7 offset:19456
v_mfma_f32_16x16x32_bf16 a[124:127], v[64:67], v[44:47], a[124:127]
v_mfma_f32_16x16x32_bf16 a[124:127], v[68:71], v[92:95], a[124:127]
s_waitcnt lgkmcnt(4)
v_mfma_f32_16x16x32_bf16 a[128:131], v[72:75], v[32:35], a[128:131]
buffer_load_dwordx4 v3, s[8:11], 0 offen offset:1024 sc1 lds
v_mfma_f32_16x16x32_bf16 a[128:131], v[76:79], v[80:83], a[128:131]
s_add_u32 m0, s22, 122880
v_add_u32 v3, 20480, v3
v_mfma_f32_16x16x32_bf16 a[132:135], v[72:75], v[36:39], a[132:135]
ds_read_b128 v[64:67], v7 offset:20480
v_mfma_f32_16x16x32_bf16 a[132:135], v[76:79], v[84:87], a[132:135]
v_mfma_f32_16x16x32_bf16 a[136:139], v[72:75], v[40:43], a[136:139]
v_mfma_f32_16x16x32_bf16 a[136:139], v[76:79], v[88:91], a[136:139]
ds_read_b128 v[68:71], v7 offset:21504
v_mfma_f32_16x16x32_bf16 a[140:143], v[72:75], v[44:47], a[140:143]
buffer_load_dwordx4 v3, s[8:11], 0 offen offset:0 sc1 lds
v_mfma_f32_16x16x32_bf16 a[140:143], v[76:79], v[92:95], a[140:143]
s_waitcnt lgkmcnt(4)
v_mfma_f32_16x16x32_bf16 a[144:147], v[48:51], v[32:35], a[144:147]
v_mfma_f32_16x16x32_bf16 a[144:147], v[52:55], v[80:83], a[144:147]
v_mfma_f32_16x16x32_bf16 a[148:151], v[48:51], v[36:39], a[148:151]
ds_read_b128 v[72:75], v7 offset:22528
v_mfma_f32_16x16x32_bf16 a[148:151], v[52:55], v[84:87], a[148:151]
buffer_load_dwordx4 v3, s[8:11], 0 offen offset:1024 sc1 lds
v_mfma_f32_16x16x32_bf16 a[152:155], v[48:51], v[40:43], a[152:155]
v_mfma_f32_16x16x32_bf16 a[152:155], v[52:55], v[88:91], a[152:155]
ds_read_b128 v[76:79], v7 offset:23552
v_mfma_f32_16x16x32_bf16 a[156:159], v[48:51], v[44:47], a[156:159]
v_mfma_f32_16x16x32_bf16 a[156:159], v[52:55], v[92:95], a[156:159]
s_waitcnt lgkmcnt(4)
v_mfma_f32_16x16x32_bf16 a[160:163], v[56:59], v[32:35], a[160:163]
buffer_load_dwordx4 v3, s[8:11], 0 offen offset:2048 sc1 lds
v_mfma_f32_16x16x32_bf16 a[160:163], v[60:63], v[80:83], a[160:163]
v_mfma_f32_16x16x32_bf16 a[164:167], v[56:59], v[36:39], a[164:167]
ds_read_b128 v[48:51], v7 offset:24576
v_mfma_f32_16x16x32_bf16 a[164:167], v[60:63], v[84:87], a[164:167]
v_mfma_f32_16x16x32_bf16 a[168:171], v[56:59], v[40:43], a[168:171]
v_mfma_f32_16x16x32_bf16 a[168:171], v[60:63], v[88:91], a[168:171]
ds_read_b128 v[52:55], v7 offset:25600
v_mfma_f32_16x16x32_bf16 a[172:175], v[56:59], v[44:47], a[172:175]
buffer_load_dwordx4 v3, s[8:11], 0 offen offset:3072 sc1 lds
v_mfma_f32_16x16x32_bf16 a[172:175], v[60:63], v[92:95], a[172:175]
s_add_u32 m0, s22, 126976
s_waitcnt vmcnt(18)
s_waitcnt lgkmcnt(4)
v_mfma_f32_16x16x32_bf16 a[112:115], v[64:67], v[96:99], a[112:115]
v_add_u32 v3, 4096, v3
v_mfma_f32_16x16x32_bf16 a[112:115], v[68:71], v[112:115], a[112:115]
v_mfma_f32_16x16x32_bf16 a[116:119], v[64:67], v[100:103], a[116:119]
ds_read_b128 v[56:59], v7 offset:26624
v_mfma_f32_16x16x32_bf16 a[116:119], v[68:71], v[116:119], a[116:119]
buffer_load_dwordx4 v3, s[8:11], 0 offen offset:0 sc1 lds
v_mfma_f32_16x16x32_bf16 a[120:123], v[64:67], v[104:107], a[120:123]
v_mfma_f32_16x16x32_bf16 a[120:123], v[68:71], v[120:123], a[120:123]
ds_read_b128 v[60:63], v7 offset:27648
v_mfma_f32_16x16x32_bf16 a[124:127], v[64:67], v[108:111], a[124:127]
v_mfma_f32_16x16x32_bf16 a[124:127], v[68:71], v[124:127], a[124:127]
s_waitcnt vmcnt(11)
s_waitcnt lgkmcnt(4)
v_mfma_f32_16x16x32_bf16 a[112:115], v[72:75], v[128:131], a[112:115]
buffer_load_dwordx4 v3, s[8:11], 0 offen offset:1024 sc1 lds
v_mfma_f32_16x16x32_bf16 a[112:115], v[76:79], v[232:235], a[112:115]
s_lshl_b32 s21, s4, 11
s_add_u32 m0, s21, 0
v_mfma_f32_16x16x32_bf16 a[116:119], v[72:75], v[132:135], a[116:119]
ds_read_b128 v[64:67], v7 offset:28672
s_sub_u32 s21, s21, s22
v_mfma_f32_16x16x32_bf16 a[116:119], v[76:79], v[236:239], a[116:119]
s_add_u32 s21, s21, 20480
v_add_u32 v3, s21, v3
v_mfma_f32_16x16x32_bf16 a[120:123], v[72:75], v[136:139], a[120:123]
v_mfma_f32_16x16x32_bf16 a[120:123], v[76:79], v[240:243], a[120:123]
ds_read_b128 v[68:71], v7 offset:29696
v_mfma_f32_16x16x32_bf16 a[124:127], v[72:75], v[140:143], a[124:127]
buffer_load_dwordx4 v3, s[8:11], 0 offen offset:0 sc1 lds
v_mfma_f32_16x16x32_bf16 a[124:127], v[76:79], v[244:247], a[124:127]
s_waitcnt lgkmcnt(4)
v_mfma_f32_16x16x32_bf16 a[128:131], v[48:51], v[96:99], a[128:131]
v_mfma_f32_16x16x32_bf16 a[128:131], v[52:55], v[112:115], a[128:131]
v_mfma_f32_16x16x32_bf16 a[132:135], v[48:51], v[100:103], a[132:135]
ds_read_b128 v[72:75], v7 offset:30720
v_mfma_f32_16x16x32_bf16 a[132:135], v[52:55], v[116:119], a[132:135]
buffer_load_dwordx4 v3, s[8:11], 0 offen offset:1024 sc1 lds
v_mfma_f32_16x16x32_bf16 a[136:139], v[48:51], v[104:107], a[136:139]
v_mfma_f32_16x16x32_bf16 a[136:139], v[52:55], v[120:123], a[136:139]
ds_read_b128 v[76:79], v7 offset:31744
v_mfma_f32_16x16x32_bf16 a[140:143], v[48:51], v[108:111], a[140:143]
v_mfma_f32_16x16x32_bf16 a[140:143], v[52:55], v[124:127], a[140:143]
s_waitcnt lgkmcnt(4)
v_mfma_f32_16x16x32_bf16 a[128:131], v[56:59], v[128:131], a[128:131]
s_waitcnt vmcnt(8)
v_mfma_f32_16x16x32_bf16 a[128:131], v[60:63], v[232:235], a[128:131]
s_barrier
v_mfma_f32_16x16x32_bf16 a[132:135], v[56:59], v[132:135], a[132:135]
ds_read_b128 v[48:51], v7 offset:32768
v_mfma_f32_16x16x32_bf16 a[132:135], v[60:63], v[236:239], a[132:135]
v_mfma_f32_16x16x32_bf16 a[136:139], v[56:59], v[136:139], a[136:139]
v_mfma_f32_16x16x32_bf16 a[136:139], v[60:63], v[240:243], a[136:139]
ds_read_b128 v[52:55], v7 offset:33792
v_mfma_f32_16x16x32_bf16 a[140:143], v[56:59], v[140:143], a[140:143]
v_mfma_f32_16x16x32_bf16 a[140:143], v[60:63], v[244:247], a[140:143]
s_waitcnt lgkmcnt(4)
v_mfma_f32_16x16x32_bf16 a[144:147], v[64:67], v[96:99], a[144:147]
v_mfma_f32_16x16x32_bf16 a[144:147], v[68:71], v[112:115], a[144:147]
v_mfma_f32_16x16x32_bf16 a[148:151], v[64:67], v[100:103], a[148:151]
ds_read_b128 v[56:59], v7 offset:34816
v_mfma_f32_16x16x32_bf16 a[148:151], v[68:71], v[116:119], a[148:151]
v_mfma_f32_16x16x32_bf16 a[152:155], v[64:67], v[104:107], a[152:155]
v_mfma_f32_16x16x32_bf16 a[152:155], v[68:71], v[120:123], a[152:155]
ds_read_b128 v[60:63], v7 offset:35840
v_mfma_f32_16x16x32_bf16 a[156:159], v[64:67], v[108:111], a[156:159]
v_mfma_f32_16x16x32_bf16 a[156:159], v[68:71], v[124:127], a[156:159]
s_waitcnt lgkmcnt(4)
v_mfma_f32_16x16x32_bf16 a[144:147], v[72:75], v[128:131], a[144:147]
v_mfma_f32_16x16x32_bf16 a[144:147], v[76:79], v[232:235], a[144:147]
v_mfma_f32_16x16x32_bf16 a[148:151], v[72:75], v[132:135], a[148:151]
ds_read_b128 v[64:67], v7 offset:36864
v_mfma_f32_16x16x32_bf16 a[148:151], v[76:79], v[236:239], a[148:151]
v_mfma_f32_16x16x32_bf16 a[152:155], v[72:75], v[136:139], a[152:155]
v_mfma_f32_16x16x32_bf16 a[152:155], v[76:79], v[240:243], a[152:155]
ds_read_b128 v[68:71], v7 offset:37888
v_mfma_f32_16x16x32_bf16 a[156:159], v[72:75], v[140:143], a[156:159]
v_mfma_f32_16x16x32_bf16 a[156:159], v[76:79], v[244:247], a[156:159]
s_waitcnt lgkmcnt(4)
v_mfma_f32_16x16x32_bf16 a[160:163], v[48:51], v[96:99], a[160:163]
v_mfma_f32_16x16x32_bf16 a[160:163], v[52:55], v[112:115], a[160:163]
v_mfma_f32_16x16x32_bf16 a[164:167], v[48:51], v[100:103], a[164:167]
ds_read_b128 v[72:75], v7 offset:38912
v_mfma_f32_16x16x32_bf16 a[164:167], v[52:55], v[116:119], a[164:167]
v_mfma_f32_16x16x32_bf16 a[168:171], v[48:51], v[104:107], a[168:171]
v_mfma_f32_16x16x32_bf16 a[168:171], v[52:55], v[120:123], a[168:171]
ds_read_b128 v[76:79], v7 offset:39936
v_mfma_f32_16x16x32_bf16 a[172:175], v[48:51], v[108:111], a[172:175]
v_mfma_f32_16x16x32_bf16 a[172:175], v[52:55], v[124:127], a[172:175]
s_waitcnt lgkmcnt(4)
v_mfma_f32_16x16x32_bf16 a[160:163], v[56:59], v[128:131], a[160:163]
v_mfma_f32_16x16x32_bf16 a[160:163], v[60:63], v[232:235], a[160:163]
v_mfma_f32_16x16x32_bf16 a[164:167], v[56:59], v[132:135], a[164:167]
ds_read_b128 v[48:51], v7 offset:40960
v_mfma_f32_16x16x32_bf16 a[164:167], v[60:63], v[236:239], a[164:167]
v_mfma_f32_16x16x32_bf16 a[168:171], v[56:59], v[136:139], a[168:171]
v_mfma_f32_16x16x32_bf16 a[168:171], v[60:63], v[240:243], a[168:171]
ds_read_b128 v[52:55], v7 offset:41984
v_mfma_f32_16x16x32_bf16 a[172:175], v[56:59], v[140:143], a[172:175]
v_mfma_f32_16x16x32_bf16 a[172:175], v[60:63], v[244:247], a[172:175]
s_waitcnt lgkmcnt(4)
v_mfma_f32_16x16x32_bf16 a[176:179], v[64:67], v[16:19], a[176:179]
v_mfma_f32_16x16x32_bf16 a[176:179], v[68:71], v[192:195], a[176:179]
v_mfma_f32_16x16x32_bf16 a[180:183], v[64:67], v[20:23], a[180:183]
ds_read_b128 v[56:59], v7 offset:43008
v_mfma_f32_16x16x32_bf16 a[180:183], v[68:71], v[196:199], a[180:183]
v_accvgpr_read_b32 v208, a112
v_accvgpr_read_b32 v209, a128
v_mfma_f32_16x16x32_bf16 a[184:187], v[64:67], v[24:27], a[184:187]
v_accvgpr_read_b32 v210, a144
v_accvgpr_read_b32 v211, a160
v_mfma_f32_16x16x32_bf16 a[184:187], v[68:71], v[200:203], a[184:187]
ds_read_b128 v[60:63], v7 offset:44032
v_accvgpr_read_b32 v212, a113
v_mfma_f32_16x16x32_bf16 a[188:191], v[64:67], v[28:31], a[188:191]
v_accvgpr_read_b32 v213, a129
v_accvgpr_read_b32 v214, a145
v_mfma_f32_16x16x32_bf16 a[188:191], v[68:71], v[204:207], a[188:191]
v_accvgpr_read_b32 v215, a161
s_waitcnt lgkmcnt(4)
v_mfma_f32_16x16x32_bf16 a[192:195], v[72:75], v[16:19], a[192:195]
v_cvt_pk_bf16_f32 v224, v208, v209
v_cvt_pk_bf16_f32 v225, v210, v211
v_mfma_f32_16x16x32_bf16 a[192:195], v[76:79], v[192:195], a[192:195]
v_cvt_pk_bf16_f32 v226, v212, v213
v_cvt_pk_bf16_f32 v227, v214, v215
v_mfma_f32_16x16x32_bf16 a[196:199], v[72:75], v[20:23], a[196:199]
ds_read_b128 v[64:67], v7 offset:45056
v_accvgpr_read_b32 v216, a114
v_mfma_f32_16x16x32_bf16 a[196:199], v[76:79], v[196:199], a[196:199]
buffer_store_dwordx4 v[224:227], v252, s[8:11], s36 offen offset:0 sc1
v_mfma_f32_16x16x32_bf16 a[200:203], v[72:75], v[24:27], a[200:203]
v_accvgpr_read_b32 v217, a130
v_accvgpr_read_b32 v218, a146
v_mfma_f32_16x16x32_bf16 a[200:203], v[76:79], v[200:203], a[200:203]
ds_read_b128 v[68:71], v7 offset:46080
v_accvgpr_read_b32 v219, a162
v_mfma_f32_16x16x32_bf16 a[204:207], v[72:75], v[28:31], a[204:207]
v_accvgpr_read_b32 v220, a115
v_accvgpr_read_b32 v221, a131
v_mfma_f32_16x16x32_bf16 a[204:207], v[76:79], v[204:207], a[204:207]
v_accvgpr_read_b32 v222, a147
s_waitcnt lgkmcnt(4)
v_mfma_f32_16x16x32_bf16 a[208:211], v[48:51], v[16:19], a[208:211]
v_accvgpr_read_b32 v223, a163
v_cvt_pk_bf16_f32 v228, v216, v217
v_mfma_f32_16x16x32_bf16 a[208:211], v[52:55], v[192:195], a[208:211]
v_cvt_pk_bf16_f32 v229, v218, v219
v_cvt_pk_bf16_f32 v230, v220, v221
v_mfma_f32_16x16x32_bf16 a[212:215], v[48:51], v[20:23], a[212:215]
ds_read_b128 v[72:75], v7 offset:47104
v_cvt_pk_bf16_f32 v231, v222, v223
v_mfma_f32_16x16x32_bf16 a[212:215], v[52:55], v[196:199], a[212:215]
buffer_store_dwordx4 v[228:231], v252, s[8:11], s36 offen offset:256 sc1
v_mfma_f32_16x16x32_bf16 a[216:219], v[48:51], v[24:27], a[216:219]
v_accvgpr_read_b32 v208, a116
v_accvgpr_read_b32 v209, a132
v_mfma_f32_16x16x32_bf16 a[216:219], v[52:55], v[200:203], a[216:219]
ds_read_b128 v[76:79], v7 offset:48128
v_accvgpr_read_b32 v210, a148
v_mfma_f32_16x16x32_bf16 a[220:223], v[48:51], v[28:31], a[220:223]
v_accvgpr_read_b32 v211, a164
v_accvgpr_read_b32 v212, a117
v_mfma_f32_16x16x32_bf16 a[220:223], v[52:55], v[204:207], a[220:223]
v_accvgpr_read_b32 v213, a133
s_waitcnt lgkmcnt(4)
v_mfma_f32_16x16x32_bf16 a[224:227], v[56:59], v[16:19], a[224:227]
v_accvgpr_read_b32 v214, a149
v_accvgpr_read_b32 v215, a165
v_mfma_f32_16x16x32_bf16 a[224:227], v[60:63], v[192:195], a[224:227]
v_cvt_pk_bf16_f32 v224, v208, v209
v_cvt_pk_bf16_f32 v225, v210, v211
v_mfma_f32_16x16x32_bf16 a[228:231], v[56:59], v[20:23], a[228:231]
ds_read_b128 v[48:51], v7 offset:49152
v_cvt_pk_bf16_f32 v226, v212, v213
v_mfma_f32_16x16x32_bf16 a[228:231], v[60:63], v[196:199], a[228:231]
v_cvt_pk_bf16_f32 v227, v214, v215
v_accvgpr_read_b32 v216, a118
v_mfma_f32_16x16x32_bf16 a[232:235], v[56:59], v[24:27], a[232:235]
buffer_store_dwordx4 v[224:227], v252, s[8:11], s37 offen offset:0 sc1
v_mfma_f32_16x16x32_bf16 a[232:235], v[60:63], v[200:203], a[232:235]
ds_read_b128 v[52:55], v7 offset:50176
v_accvgpr_read_b32 v217, a134
v_mfma_f32_16x16x32_bf16 a[236:239], v[56:59], v[28:31], a[236:239]
v_accvgpr_read_b32 v218, a150
v_accvgpr_read_b32 v219, a166
v_mfma_f32_16x16x32_bf16 a[236:239], v[60:63], v[204:207], a[236:239]
v_accvgpr_read_b32 v220, a119
s_waitcnt lgkmcnt(4)
v_mfma_f32_16x16x32_bf16 a[176:179], v[64:67], v[32:35], a[176:179]
v_accvgpr_read_b32 v221, a135
v_accvgpr_read_b32 v222, a151
v_mfma_f32_16x16x32_bf16 a[176:179], v[68:71], v[80:83], a[176:179]
v_accvgpr_read_b32 v223, a167
v_cvt_pk_bf16_f32 v228, v216, v217
v_mfma_f32_16x16x32_bf16 a[180:183], v[64:67], v[36:39], a[180:183]
ds_read_b128 v[56:59], v7 offset:51200
v_cvt_pk_bf16_f32 v229, v218, v219
v_mfma_f32_16x16x32_bf16 a[180:183], v[68:71], v[84:87], a[180:183]
v_cvt_pk_bf16_f32 v230, v220, v221
v_cvt_pk_bf16_f32 v231, v222, v223
v_mfma_f32_16x16x32_bf16 a[184:187], v[64:67], v[40:43], a[184:187]
buffer_store_dwordx4 v[228:231], v252, s[8:11], s37 offen offset:256 sc1
v_mfma_f32_16x16x32_bf16 a[184:187], v[68:71], v[88:91], a[184:187]
ds_read_b128 v[60:63], v7 offset:52224
v_accvgpr_read_b32 v208, a120
v_mfma_f32_16x16x32_bf16 a[188:191], v[64:67], v[44:47], a[188:191]
v_accvgpr_read_b32 v209, a136
v_accvgpr_read_b32 v210, a152
v_mfma_f32_16x16x32_bf16 a[188:191], v[68:71], v[92:95], a[188:191]
v_accvgpr_read_b32 v211, a168
s_waitcnt lgkmcnt(4)
v_mfma_f32_16x16x32_bf16 a[192:195], v[72:75], v[32:35], a[192:195]
v_accvgpr_read_b32 v212, a121
v_accvgpr_read_b32 v213, a137
v_mfma_f32_16x16x32_bf16 a[192:195], v[76:79], v[80:83], a[192:195]
v_accvgpr_read_b32 v214, a153
v_accvgpr_read_b32 v215, a169
v_mfma_f32_16x16x32_bf16 a[196:199], v[72:75], v[36:39], a[196:199]
ds_read_b128 v[64:67], v7 offset:53248
v_cvt_pk_bf16_f32 v224, v208, v209
v_mfma_f32_16x16x32_bf16 a[196:199], v[76:79], v[84:87], a[196:199]
v_cvt_pk_bf16_f32 v225, v210, v211
v_cvt_pk_bf16_f32 v226, v212, v213
v_mfma_f32_16x16x32_bf16 a[200:203], v[72:75], v[40:43], a[200:203]
v_cvt_pk_bf16_f32 v227, v214, v215
v_accvgpr_read_b32 v216, a122
v_mfma_f32_16x16x32_bf16 a[200:203], v[76:79], v[88:91], a[200:203]
ds_read_b128 v[68:71], v7 offset:54272
v_accvgpr_read_b32 v217, a138
v_mfma_f32_16x16x32_bf16 a[204:207], v[72:75], v[44:47], a[204:207]
buffer_store_dwordx4 v[224:227], v252, s[8:11], s38 offen offset:0 sc1
v_mfma_f32_16x16x32_bf16 a[204:207], v[76:79], v[92:95], a[204:207]
v_accvgpr_read_b32 v218, a154
s_waitcnt lgkmcnt(4)
v_mfma_f32_16x16x32_bf16 a[208:211], v[48:51], v[32:35], a[208:211]
v_accvgpr_read_b32 v219, a170
v_accvgpr_read_b32 v220, a123
v_mfma_f32_16x16x32_bf16 a[208:211], v[52:55], v[80:83], a[208:211]
v_accvgpr_read_b32 v221, a139
v_accvgpr_read_b32 v222, a155
v_mfma_f32_16x16x32_bf16 a[212:215], v[48:51], v[36:39], a[212:215]
ds_read_b128 v[72:75], v7 offset:55296
v_accvgpr_read_b32 v223, a171
v_mfma_f32_16x16x32_bf16 a[212:215], v[52:55], v[84:87], a[212:215]
v_cvt_pk_bf16_f32 v228, v216, v217
v_cvt_pk_bf16_f32 v229, v218, v219
v_mfma_f32_16x16x32_bf16 a[216:219], v[48:51], v[40:43], a[216:219]
v_cvt_pk_bf16_f32 v230, v220, v221
v_cvt_pk_bf16_f32 v231, v222, v223
v_mfma_f32_16x16x32_bf16 a[216:219], v[52:55], v[88:91], a[216:219]
ds_read_b128 v[76:79], v7 offset:56320
v_accvgpr_read_b32 v208, a124
v_mfma_f32_16x16x32_bf16 a[220:223], v[48:51], v[44:47], a[220:223]
buffer_store_dwordx4 v[228:231], v252, s[8:11], s38 offen offset:256 sc1
v_mfma_f32_16x16x32_bf16 a[220:223], v[52:55], v[92:95], a[220:223]
v_accvgpr_read_b32 v209, a140
s_waitcnt lgkmcnt(4)
v_mfma_f32_16x16x32_bf16 a[224:227], v[56:59], v[32:35], a[224:227]
s_waitcnt vmcnt(8)
v_accvgpr_read_b32 v210, a156
v_mfma_f32_16x16x32_bf16 a[224:227], v[60:63], v[80:83], a[224:227]
s_barrier
v_mfma_f32_16x16x32_bf16 a[228:231], v[56:59], v[36:39], a[228:231]
ds_read_b128 v[48:51], v7 offset:57344
v_accvgpr_read_b32 v211, a172
v_mfma_f32_16x16x32_bf16 a[228:231], v[60:63], v[84:87], a[228:231]
v_accvgpr_read_b32 v212, a125
v_accvgpr_read_b32 v213, a141
v_mfma_f32_16x16x32_bf16 a[232:235], v[56:59], v[40:43], a[232:235]
v_accvgpr_read_b32 v214, a157
v_accvgpr_read_b32 v215, a173
v_mfma_f32_16x16x32_bf16 a[232:235], v[60:63], v[88:91], a[232:235]
ds_read_b128 v[52:55], v7 offset:58368
v_cvt_pk_bf16_f32 v224, v208, v209
v_mfma_f32_16x16x32_bf16 a[236:239], v[56:59], v[44:47], a[236:239]
v_cvt_pk_bf16_f32 v225, v210, v211
v_cvt_pk_bf16_f32 v226, v212, v213
v_mfma_f32_16x16x32_bf16 a[236:239], v[60:63], v[92:95], a[236:239]
v_cvt_pk_bf16_f32 v227, v214, v215
s_waitcnt lgkmcnt(4)
v_mfma_f32_16x16x32_bf16 a[176:179], v[64:67], v[96:99], a[176:179]
buffer_store_dwordx4 v[224:227], v252, s[8:11], s39 offen offset:0 sc1
v_mfma_f32_16x16x32_bf16 a[176:179], v[68:71], v[112:115], a[176:179]
v_accvgpr_read_b32 v216, a126
v_accvgpr_read_b32 v217, a142
v_mfma_f32_16x16x32_bf16 a[180:183], v[64:67], v[100:103], a[180:183]
ds_read_b128 v[56:59], v7 offset:59392
v_accvgpr_read_b32 v218, a158
v_mfma_f32_16x16x32_bf16 a[180:183], v[68:71], v[116:119], a[180:183]
v_accvgpr_read_b32 v219, a174
v_accvgpr_read_b32 v220, a127
v_mfma_f32_16x16x32_bf16 a[184:187], v[64:67], v[104:107], a[184:187]
v_accvgpr_read_b32 v221, a143
v_accvgpr_read_b32 v222, a159
v_mfma_f32_16x16x32_bf16 a[184:187], v[68:71], v[120:123], a[184:187]
ds_read_b128 v[60:63], v7 offset:60416
v_accvgpr_read_b32 v223, a175
v_mfma_f32_16x16x32_bf16 a[188:191], v[64:67], v[108:111], a[188:191]
v_cvt_pk_bf16_f32 v228, v216, v217
v_cvt_pk_bf16_f32 v229, v218, v219
v_mfma_f32_16x16x32_bf16 a[188:191], v[68:71], v[124:127], a[188:191]
v_cvt_pk_bf16_f32 v230, v220, v221
s_waitcnt lgkmcnt(4)
v_mfma_f32_16x16x32_bf16 a[176:179], v[72:75], v[128:131], a[176:179]
v_cvt_pk_bf16_f32 v231, v222, v223
v_mfma_f32_16x16x32_bf16 a[176:179], v[76:79], v[232:235], a[176:179]
buffer_store_dwordx4 v[228:231], v252, s[8:11], s39 offen offset:256 sc1
v_mfma_f32_16x16x32_bf16 a[180:183], v[72:75], v[132:135], a[180:183]
ds_read_b128 v[64:67], v7 offset:61440
v_mfma_f32_16x16x32_bf16 a[180:183], v[76:79], v[236:239], a[180:183]
v_mfma_f32_16x16x32_bf16 a[184:187], v[72:75], v[136:139], a[184:187]
v_mfma_f32_16x16x32_bf16 a[184:187], v[76:79], v[240:243], a[184:187]
ds_read_b128 v[68:71], v7 offset:62464
v_mfma_f32_16x16x32_bf16 a[188:191], v[72:75], v[140:143], a[188:191]
v_mfma_f32_16x16x32_bf16 a[188:191], v[76:79], v[244:247], a[188:191]
s_waitcnt lgkmcnt(4)
v_mfma_f32_16x16x32_bf16 a[192:195], v[48:51], v[96:99], a[192:195]
v_mfma_f32_16x16x32_bf16 a[192:195], v[52:55], v[112:115], a[192:195]
v_mfma_f32_16x16x32_bf16 a[196:199], v[48:51], v[100:103], a[196:199]
ds_read_b128 v[72:75], v7 offset:63488
v_mfma_f32_16x16x32_bf16 a[196:199], v[52:55], v[116:119], a[196:199]
v_mfma_f32_16x16x32_bf16 a[200:203], v[48:51], v[104:107], a[200:203]
v_mfma_f32_16x16x32_bf16 a[200:203], v[52:55], v[120:123], a[200:203]
ds_read_b128 v[76:79], v7 offset:64512
v_mfma_f32_16x16x32_bf16 a[204:207], v[48:51], v[108:111], a[204:207]
v_mfma_f32_16x16x32_bf16 a[204:207], v[52:55], v[124:127], a[204:207]
s_waitcnt lgkmcnt(4)
v_mfma_f32_16x16x32_bf16 a[192:195], v[56:59], v[128:131], a[192:195]
v_mfma_f32_16x16x32_bf16 a[192:195], v[60:63], v[232:235], a[192:195]
v_mfma_f32_16x16x32_bf16 a[196:199], v[56:59], v[132:135], a[196:199]
ds_read_b128 v[48:51], v8 offset:0
v_mfma_f32_16x16x32_bf16 a[196:199], v[60:63], v[236:239], a[196:199]
v_mfma_f32_16x16x32_bf16 a[200:203], v[56:59], v[136:139], a[200:203]
v_mfma_f32_16x16x32_bf16 a[200:203], v[60:63], v[240:243], a[200:203]
ds_read_b128 v[52:55], v8 offset:1024
v_mfma_f32_16x16x32_bf16 a[204:207], v[56:59], v[140:143], a[204:207]
v_mfma_f32_16x16x32_bf16 a[204:207], v[60:63], v[244:247], a[204:207]
s_waitcnt lgkmcnt(4)
v_mfma_f32_16x16x32_bf16 a[208:211], v[64:67], v[96:99], a[208:211]
v_mfma_f32_16x16x32_bf16 a[208:211], v[68:71], v[112:115], a[208:211]
v_mfma_f32_16x16x32_bf16 a[212:215], v[64:67], v[100:103], a[212:215]
ds_read_b128 v[56:59], v8 offset:2048
v_mfma_f32_16x16x32_bf16 a[212:215], v[68:71], v[116:119], a[212:215]
v_mfma_f32_16x16x32_bf16 a[216:219], v[64:67], v[104:107], a[216:219]
v_mfma_f32_16x16x32_bf16 a[216:219], v[68:71], v[120:123], a[216:219]
ds_read_b128 v[60:63], v8 offset:3072
v_mfma_f32_16x16x32_bf16 a[220:223], v[64:67], v[108:111], a[220:223]
v_mfma_f32_16x16x32_bf16 a[220:223], v[68:71], v[124:127], a[220:223]
s_waitcnt lgkmcnt(4)
v_mfma_f32_16x16x32_bf16 a[208:211], v[72:75], v[128:131], a[208:211]
v_mfma_f32_16x16x32_bf16 a[208:211], v[76:79], v[232:235], a[208:211]
v_mfma_f32_16x16x32_bf16 a[212:215], v[72:75], v[132:135], a[212:215]
ds_read_b128 v[64:67], v8 offset:4096
v_mfma_f32_16x16x32_bf16 a[212:215], v[76:79], v[236:239], a[212:215]
v_mfma_f32_16x16x32_bf16 a[216:219], v[72:75], v[136:139], a[216:219]
v_mfma_f32_16x16x32_bf16 a[216:219], v[76:79], v[240:243], a[216:219]
ds_read_b128 v[68:71], v8 offset:5120
v_mfma_f32_16x16x32_bf16 a[220:223], v[72:75], v[140:143], a[220:223]
v_mfma_f32_16x16x32_bf16 a[220:223], v[76:79], v[244:247], a[220:223]
s_waitcnt lgkmcnt(4)
v_mfma_f32_16x16x32_bf16 a[224:227], v[48:51], v[96:99], a[224:227]
v_mfma_f32_16x16x32_bf16 a[224:227], v[52:55], v[112:115], a[224:227]
v_mfma_f32_16x16x32_bf16 a[228:231], v[48:51], v[100:103], a[228:231]
ds_read_b128 v[72:75], v8 offset:6144
v_mfma_f32_16x16x32_bf16 a[228:231], v[52:55], v[116:119], a[228:231]
v_mfma_f32_16x16x32_bf16 a[232:235], v[48:51], v[104:107], a[232:235]
v_mfma_f32_16x16x32_bf16 a[232:235], v[52:55], v[120:123], a[232:235]
ds_read_b128 v[76:79], v8 offset:7168
v_mfma_f32_16x16x32_bf16 a[236:239], v[48:51], v[108:111], a[236:239]
v_mfma_f32_16x16x32_bf16 a[236:239], v[52:55], v[124:127], a[236:239]
s_waitcnt lgkmcnt(4)
v_mfma_f32_16x16x32_bf16 a[224:227], v[56:59], v[128:131], a[224:227]
v_mfma_f32_16x16x32_bf16 a[224:227], v[60:63], v[232:235], a[224:227]
v_mfma_f32_16x16x32_bf16 a[228:231], v[56:59], v[132:135], a[228:231]
ds_read_b128 v[48:51], v8 offset:8192
v_mfma_f32_16x16x32_bf16 a[228:231], v[60:63], v[236:239], a[228:231]
v_mfma_f32_16x16x32_bf16 a[232:235], v[56:59], v[136:139], a[232:235]
v_mfma_f32_16x16x32_bf16 a[232:235], v[60:63], v[240:243], a[232:235]
ds_read_b128 v[52:55], v8 offset:9216
v_mfma_f32_16x16x32_bf16 a[236:239], v[56:59], v[140:143], a[236:239]
v_mfma_f32_16x16x32_bf16 a[236:239], v[60:63], v[244:247], a[236:239]
s_waitcnt lgkmcnt(4)
v_mfma_f32_16x16x32_bf16 a[240:243], v[64:67], v[144:147], 0
v_mfma_f32_16x16x32_bf16 a[240:243], v[68:71], v[160:163], a[240:243]
v_mfma_f32_16x16x32_bf16 a[244:247], v[64:67], v[148:151], 0
ds_read_b128 v[56:59], v8 offset:10240
v_mfma_f32_16x16x32_bf16 a[244:247], v[68:71], v[164:167], a[244:247]
v_accvgpr_read_b32 v208, a176
v_accvgpr_read_b32 v209, a192
v_mfma_f32_16x16x32_bf16 a[248:251], v[64:67], v[152:155], 0
v_accvgpr_read_b32 v210, a208
v_accvgpr_read_b32 v211, a224
v_mfma_f32_16x16x32_bf16 a[248:251], v[68:71], v[168:171], a[248:251]
ds_read_b128 v[60:63], v8 offset:11264
v_accvgpr_read_b32 v212, a177
v_mfma_f32_16x16x32_bf16 a[252:255], v[64:67], v[156:159], 0
v_accvgpr_read_b32 v213, a193
v_accvgpr_read_b32 v214, a209
v_mfma_f32_16x16x32_bf16 a[252:255], v[68:71], v[172:175], a[252:255]
v_accvgpr_read_b32 v215, a225
s_waitcnt lgkmcnt(4)
v_mfma_f32_16x16x32_bf16 a[240:243], v[72:75], v[176:179], a[240:243]
v_cvt_pk_bf16_f32 v224, v208, v209
v_cvt_pk_bf16_f32 v225, v210, v211
v_mfma_f32_16x16x32_bf16 a[240:243], v[76:79], a[0:3], a[240:243]
v_cvt_pk_bf16_f32 v226, v212, v213
v_cvt_pk_bf16_f32 v227, v214, v215
v_mfma_f32_16x16x32_bf16 a[244:247], v[72:75], v[180:183], a[244:247]
ds_read_b128 v[64:67], v8 offset:12288
v_accvgpr_read_b32 v216, a178
v_mfma_f32_16x16x32_bf16 a[244:247], v[76:79], a[4:7], a[244:247]
buffer_store_dwordx4 v[224:227], v252, s[8:11], s36 offen offset:2048 sc1
v_mfma_f32_16x16x32_bf16 a[248:251], v[72:75], v[184:187], a[248:251]
v_accvgpr_read_b32 v217, a194
v_accvgpr_read_b32 v218, a210
v_mfma_f32_16x16x32_bf16 a[248:251], v[76:79], a[8:11], a[248:251]
ds_read_b128 v[68:71], v8 offset:13312
v_accvgpr_read_b32 v219, a226
v_mfma_f32_16x16x32_bf16 a[252:255], v[72:75], v[188:191], a[252:255]
v_accvgpr_read_b32 v220, a179
v_accvgpr_read_b32 v221, a195
v_mfma_f32_16x16x32_bf16 a[252:255], v[76:79], a[12:15], a[252:255]
v_accvgpr_read_b32 v222, a211
s_waitcnt lgkmcnt(4)
v_mfma_f32_16x16x32_bf16 a[240:243], v[48:51], a[16:19], a[240:243]
v_accvgpr_read_b32 v223, a227
v_cvt_pk_bf16_f32 v228, v216, v217
v_mfma_f32_16x16x32_bf16 a[240:243], v[52:55], a[32:35], a[240:243]
v_cvt_pk_bf16_f32 v229, v218, v219
v_cvt_pk_bf16_f32 v230, v220, v221
v_mfma_f32_16x16x32_bf16 a[244:247], v[48:51], a[20:23], a[244:247]
ds_read_b128 v[72:75], v8 offset:14336
L_hop11:
s_cmp_eq_u32 s15, 1
s_cbranch_scc1 L_hop_done
v_cvt_pk_bf16_f32 v231, v222, v223
v_mfma_f32_16x16x32_bf16 a[244:247], v[52:55], a[36:39], a[244:247]
buffer_store_dwordx4 v[228:231], v252, s[8:11], s36 offen offset:2304 sc1
v_mfma_f32_16x16x32_bf16 a[248:251], v[48:51], a[24:27], a[248:251]
v_accvgpr_read_b32 v208, a180
v_accvgpr_read_b32 v209, a196
v_mfma_f32_16x16x32_bf16 a[248:251], v[52:55], a[40:43], a[248:251]
ds_read_b128 v[76:79], v8 offset:15360
v_accvgpr_read_b32 v210, a212
v_mfma_f32_16x16x32_bf16 a[252:255], v[48:51], a[28:31], a[252:255]
v_accvgpr_read_b32 v211, a228
v_accvgpr_read_b32 v212, a181
v_mfma_f32_16x16x32_bf16 a[252:255], v[52:55], a[44:47], a[252:255]
v_accvgpr_read_b32 v213, a197
s_waitcnt lgkmcnt(4)
v_mfma_f32_16x16x32_bf16 a[240:243], v[56:59], a[48:51], a[240:243]
s_waitcnt vmcnt(2)
v_mov_b32 v12, s68
v_mfma_f32_16x16x32_bf16 a[240:243], v[60:63], a[64:67], a[240:243]
s_barrier
v_mfma_f32_16x16x32_bf16 a[244:247], v[56:59], a[52:55], a[244:247]
ds_read_b128 v[48:51], v2 offset:0
v_mov_b32 v13, s69
v_mfma_f32_16x16x32_bf16 a[244:247], v[60:63], a[68:71], a[244:247]
s_add_u32 s53, s35, 262144
s_cmp_eq_u32 s4, 0
v_mfma_f32_16x16x32_bf16 a[248:251], v[56:59], a[56:59], a[248:251]
s_cselect_b32 s53, s53, 2146435072
s_lshl_b32 s23, s43, 7
v_mfma_f32_16x16x32_bf16 a[248:251], v[60:63], a[72:75], a[248:251]
ds_read_b128 v[52:55], v2 offset:1024
s_sub_u32 s53, s53, s23
v_mfma_f32_16x16x32_bf16 a[252:255], v[56:59], a[60:63], a[252:255]
buffer_store_dwordx2 v[12:13], v10, s[8:11], s53 offen sc1
v_mfma_f32_16x16x32_bf16 a[252:255], v[60:63], a[76:79], a[252:255]
v_accvgpr_read_b32 v214, a213
s_waitcnt lgkmcnt(4)
v_mfma_f32_16x16x32_bf16 a[240:243], v[64:67], a[80:83], a[240:243]
v_accvgpr_read_b32 v215, a229
v_cvt_pk_bf16_f32 v224, v208, v209
v_mfma_f32_16x16x32_bf16 a[240:243], v[68:71], a[96:99], a[240:243]
v_cvt_pk_bf16_f32 v225, v210, v211
v_cvt_pk_bf16_f32 v226, v212, v213
v_mfma_f32_16x16x32_bf16 a[244:247], v[64:67], a[84:87], a[244:247]
ds_read_b128 v[56:59], v2 offset:2048
v_cvt_pk_bf16_f32 v227, v214, v215
v_mfma_f32_16x16x32_bf16 a[244:247], v[68:71], a[100:103], a[244:247]
buffer_store_dwordx4 v[224:227], v252, s[8:11], s37 offen offset:2048 sc1
v_mfma_f32_16x16x32_bf16 a[248:251], v[64:67], a[88:91], a[248:251]
v_accvgpr_read_b32 v216, a182
v_accvgpr_read_b32 v217, a198
v_mfma_f32_16x16x32_bf16 a[248:251], v[68:71], a[104:107], a[248:251]
ds_read_b128 v[60:63], v2 offset:3072
v_accvgpr_read_b32 v218, a214
v_mfma_f32_16x16x32_bf16 a[252:255], v[64:67], a[92:95], a[252:255]
v_accvgpr_read_b32 v219, a230
v_accvgpr_read_b32 v220, a183
v_mfma_f32_16x16x32_bf16 a[252:255], v[68:71], a[108:111], a[252:255]
v_accvgpr_read_b32 v221, a199
s_waitcnt lgkmcnt(4)
v_mfma_f32_16x16x32_bf16 a[240:243], v[72:75], v[16:19], a[240:243]
v_accvgpr_read_b32 v222, a215
v_accvgpr_read_b32 v223, a231
v_mfma_f32_16x16x32_bf16 a[240:243], v[76:79], v[192:195], a[240:243]
v_cvt_pk_bf16_f32 v228, v216, v217
v_cvt_pk_bf16_f32 v229, v218, v219
v_mfma_f32_16x16x32_bf16 a[244:247], v[72:75], v[20:23], a[244:247]
ds_read_b128 v[64:67], v2 offset:4096
v_cvt_pk_bf16_f32 v230, v220, v221
v_mfma_f32_16x16x32_bf16 a[244:247], v[76:79], v[196:199], a[244:247]
v_cvt_pk_bf16_f32 v231, v222, v223
v_accvgpr_read_b32 v208, a184
v_mfma_f32_16x16x32_bf16 a[248:251], v[72:75], v[24:27], a[248:251]
buffer_store_dwordx4 v[228:231], v252, s[8:11], s37 offen offset:2304 sc1
v_mfma_f32_16x16x32_bf16 a[248:251], v[76:79], v[200:203], a[248:251]
ds_read_b128 v[68:71], v2 offset:5120
v_accvgpr_read_b32 v209, a200
v_mfma_f32_16x16x32_bf16 a[252:255], v[72:75], v[28:31], a[252:255]
v_accvgpr_read_b32 v210, a216
v_accvgpr_read_b32 v211, a232
v_mfma_f32_16x16x32_bf16 a[252:255], v[76:79], v[204:207], a[252:255]
v_accvgpr_read_b32 v212, a185
s_waitcnt lgkmcnt(4)
v_mfma_f32_16x16x32_bf16 a[240:243], v[48:51], v[32:35], a[240:243]
v_accvgpr_read_b32 v213, a201
v_accvgpr_read_b32 v214, a217
v_mfma_f32_16x16x32_bf16 a[240:243], v[52:55], v[80:83], a[240:243]
v_accvgpr_read_b32 v215, a233
v_cvt_pk_bf16_f32 v224, v208, v209
v_mfma_f32_16x16x32_bf16 a[244:247], v[48:51], v[36:39], a[244:247]
v_cvt_pk_bf16_f32 v225, v210, v211
v_cvt_pk_bf16_f32 v226, v212, v213
v_mfma_f32_16x16x32_bf16 a[244:247], v[52:55], v[84:87], a[244:247]
v_cvt_pk_bf16_f32 v227, v214, v215
v_accvgpr_read_b32 v216, a186
v_mfma_f32_16x16x32_bf16 a[248:251], v[48:51], v[40:43], a[248:251]
buffer_store_dwordx4 v[224:227], v252, s[8:11], s38 offen offset:2048 sc1
v_mfma_f32_16x16x32_bf16 a[248:251], v[52:55], v[88:91], a[248:251]
v_accvgpr_read_b32 v217, a202
v_accvgpr_read_b32 v218, a218
v_mfma_f32_16x16x32_bf16 a[252:255], v[48:51], v[44:47], a[252:255]
v_accvgpr_read_b32 v219, a234
v_accvgpr_read_b32 v220, a187
v_mfma_f32_16x16x32_bf16 a[252:255], v[52:55], v[92:95], a[252:255]
v_accvgpr_read_b32 v221, a203
s_waitcnt lgkmcnt(2)
v_mfma_f32_16x16x32_bf16 a[240:243], v[56:59], v[96:99], a[240:243]
v_accvgpr_read_b32 v222, a219
v_accvgpr_read_b32 v223, a235
v_mfma_f32_16x16x32_bf16 a[240:243], v[60:63], v[112:115], a[240:243]
v_cvt_pk_bf16_f32 v228, v216, v217
v_cvt_pk_bf16_f32 v229, v218, v219
v_mfma_f32_16x16x32_bf16 a[244:247], v[56:59], v[100:103], a[244:247]
v_cvt_pk_bf16_f32 v230, v220, v221
v_cvt_pk_bf16_f32 v231, v222, v223
v_mfma_f32_16x16x32_bf16 a[244:247], v[60:63], v[116:119], a[244:247]
buffer_store_dwordx4 v[228:231], v252, s[8:11], s38 offen offset:2304 sc1
v_mfma_f32_16x16x32_bf16 a[248:251], v[56:59], v[104:107], a[248:251]
v_accvgpr_read_b32 v208, a188
v_accvgpr_read_b32 v209, a204
v_mfma_f32_16x16x32_bf16 a[248:251], v[60:63], v[120:123], a[248:251]
v_accvgpr_read_b32 v210, a220
v_accvgpr_read_b32 v211, a236
v_mfma_f32_16x16x32_bf16 a[252:255], v[56:59], v[108:111], a[252:255]
v_accvgpr_read_b32 v212, a189
v_accvgpr_read_b32 v213, a205
v_mfma_f32_16x16x32_bf16 a[252:255], v[60:63], v[124:127], a[252:255]
v_accvgpr_read_b32 v214, a221
s_waitcnt lgkmcnt(0)
v_mfma_f32_16x16x32_bf16 a[240:243], v[64:67], v[128:131], a[240:243]
v_accvgpr_read_b32 v215, a237
v_cvt_pk_bf16_f32 v224, v208, v209
v_mfma_f32_16x16x32_bf16 a[240:243], v[68:71], v[232:235], a[240:243]
v_cvt_pk_bf16_f32 v225, v210, v211
v_cvt_pk_bf16_f32 v226, v212, v213
v_mfma_f32_16x16x32_bf16 a[244:247], v[64:67], v[132:135], a[244:247]
v_cvt_pk_bf16_f32 v227, v214, v215
v_accvgpr_read_b32 v216, a190
v_mfma_f32_16x16x32_bf16 a[244:247], v[68:71], v[236:239], a[244:247]
buffer_store_dwordx4 v[224:227], v252, s[8:11], s39 offen offset:2048 sc1
v_mfma_f32_16x16x32_bf16 a[248:251], v[64:67], v[136:139], a[248:251]
v_accvgpr_read_b32 v217, a206
v_accvgpr_read_b32 v218, a222
v_mfma_f32_16x16x32_bf16 a[248:251], v[68:71], v[240:243], a[248:251]
v_accvgpr_read_b32 v219, a238
v_accvgpr_read_b32 v220, a191
v_mfma_f32_16x16x32_bf16 a[252:255], v[64:67], v[140:143], a[252:255]
v_accvgpr_read_b32 v221, a207
v_accvgpr_read_b32 v222, a223
v_mfma_f32_16x16x32_bf16 a[252:255], v[68:71], v[244:247], a[252:255]
v_accvgpr_read_b32 v223, a239
v_cvt_pk_bf16_f32 v228, v216, v217
v_cvt_pk_bf16_f32 v229, v218, v219
v_cvt_pk_bf16_f32 v230, v220, v221
v_cvt_pk_bf16_f32 v231, v222, v223
buffer_store_dwordx4 v[228:231], v252, s[8:11], s39 offen offset:2304 sc1
v_accvgpr_read_b32 v208, a240
v_accvgpr_read_b32 v209, a241
v_accvgpr_read_b32 v210, a242
v_accvgpr_read_b32 v211, a243
v_accvgpr_read_b32 v212, a244
v_accvgpr_read_b32 v213, a245
v_accvgpr_read_b32 v214, a246
v_accvgpr_read_b32 v215, a247
v_cvt_pk_bf16_f32 v224, v208, v209
v_cvt_pk_bf16_f32 v225, v210, v211
v_cvt_pk_bf16_f32 v226, v212, v213
v_cvt_pk_bf16_f32 v227, v214, v215
s_nop 0
v_permlane16_swap_b32 v224, v226
v_permlane16_swap_b32 v225, v227
buffer_store_dwordx4 v[224:227], v9, s[8:11], s32 offen sc1
v_accvgpr_read_b32 v216, a248
v_accvgpr_read_b32 v217, a249
v_accvgpr_read_b32 v218, a250
v_accvgpr_read_b32 v219, a251
v_accvgpr_read_b32 v220, a252
v_accvgpr_read_b32 v221, a253
v_accvgpr_read_b32 v222, a254
v_accvgpr_read_b32 v223, a255
v_cvt_pk_bf16_f32 v228, v216, v217
v_cvt_pk_bf16_f32 v229, v218, v219
v_cvt_pk_bf16_f32 v230, v220, v221
v_cvt_pk_bf16_f32 v231, v222, v223
s_nop 0
v_permlane16_swap_b32 v228, v230
v_permlane16_swap_b32 v229, v231
buffer_store_dwordx4 v[228:231], v9, s[8:11], s33 offen sc1
s_mov_b32 s14, s35
s_cmp_eq_u32 s7, 1
s_cbranch_scc1 L_last
s_cmp_eq_u32 s4, 3
s_cbranch_scc1 L_r_side
v_and_b32 v6, 7, v1
v_lshrrev_b32 v7, 3, v1
s_and_b32 s23, s6, 1
s_lshl_b32 s23, s23, 3
v_add_u32 v8, s23, v6
v_lshlrev_b32 v8, 4, v8
v_lshl_add_u32 v4, v7, 8, v8
s_lshl_b32 s24, s5, 4
s_lshr_b32 s25, s6, 1
s_add_u32 s24, s24, s25
s_mul_i32 s20, s24, 18432
s_lshl_b32 s22, s4, 2
s_lshr_b32 s23, 1056, s22
s_and_b32 s23, s23, 15
s_lshl_b32 s24, s23, 11
s_add_u32 s28, s20, s24
s_lshr_b32 s23, 790, s22
s_and_b32 s23, s23, 15
s_lshl_b32 s24, s23, 11
s_add_u32 s29, s20, s24
s_lshr_b32 s23, 2165, s22
s_and_b32 s23, s23, 15
s_lshl_b32 s24, s23, 11
s_add_u32 s30, s20, s24
s_lshl_b32 s26, s5, 12
s_add_u32 s27, s26, 917504
s_add_u32 s26, s26, 655360
v_and_b32 v6, 31, v1
v_lshlrev_b32 v6, 7, v6
buffer_load_dwordx2 v[10:11], v6, s[8:11], s27 offen sc1
v_mov_b32 v13, 2146435072
v_cmp_gt_u32 vcc, 16, v0
v_lshlrev_b32 v14, 3, v0
s_nop 0
v_cndmask_b32 v13, v13, v14, vcc
v_mov_b32 v14, s68
v_mov_b32 v15, s69
s_waitcnt vmcnt(0)
s_barrier
buffer_store_dwordx2 v[14:15], v13, s[8:11], s14 offen sc1
s_add_u32 s24, s28, 37126144
buffer_load_dwordx4 v[16:19], v4, s[8:11], s24 offen sc1
s_add_u32 s25, s29, 37126144
buffer_load_dwordx4 v[20:23], v4, s[8:11], s25 offen sc1
s_add_u32 s24, s30, 37126144
buffer_load_dwordx4 v[24:27], v4, s[8:11], s24 offen sc1
v_cmp_eq_u64 vcc, s[68:69], v[10:11]
s_nop 0
s_cmp_eq_u64 vcc, exec
s_cbranch_scc0 L_re_slow4
L_re_back4:
s_add_u32 s25, s28, 79855616
buffer_load_dwordx4 v[28:31], v4, s[8:11], s25 offen sc1
s_add_u32 s24, s28, 82214912
buffer_load_dwordx4 v[40:43], v4, s[8:11], s24 offen sc1
s_add_u32 s25, s28, 84574208
buffer_load_dwordx4 v[52:55], v4, s[8:11], s25 offen sc1
s_add_u32 s24, s28, 86933504
buffer_load_dwordx4 v[64:67], v4, s[8:11], s24 offen sc1
s_add_u32 s25, s28, 89292800
buffer_load_dwordx4 v[76:79], v4, s[8:11], s25 offen sc1
s_add_u32 s24, s28, 91652096
buffer_load_dwordx4 v[88:91], v4, s[8:11], s24 offen sc1
s_add_u32 s25, s28, 94011392
buffer_load_dwordx4 v[100:103], v4, s[8:11], s25 offen sc1
s_add_u32 s24, s28, 96370688
buffer_load_dwordx4 v[112:115], v4, s[8:11], s24 offen sc1
s_mov_b32 s52, 0
L_poll6:
buffer_load_dwordx2 v[14:15], v6, s[8:11], s26 offen sc1
s_add_u32 s52, s52, 1
s_waitcnt vmcnt(0)
v_cmp_ne_u64 vcc, s[68:69], v[14:15]
s_cmp_ge_u32 s52, 1048576
s_cbranch_scc1 L_got6
s_and_b64 exec, exec, vcc
s_cbranch_execnz L_poll6
L_got6:
s_mov_b64 exec, -1
s_add_u32 s24, s29, 79855616
buffer_load_dwordx4 v[32:35], v4, s[8:11], s24 offen sc1
s_add_u32 s25, s30, 79855616
buffer_load_dwordx4 v[36:39], v4, s[8:11], s25 offen sc1
s_add_u32 s25, s29, 82214912
buffer_load_dwordx4 v[44:47], v4, s[8:11], s25 offen sc1
s_add_u32 s24, s30, 82214912
buffer_load_dwordx4 v[48:51], v4, s[8:11], s24 offen sc1
s_add_u32 s24, s29, 84574208
buffer_load_dwordx4 v[56:59], v4, s[8:11], s24 offen sc1
s_add_u32 s25, s30, 84574208
buffer_load_dwordx4 v[60:63], v4, s[8:11], s25 offen sc1
s_add_u32 s25, s29, 86933504
buffer_load_dwordx4 v[68:71], v4, s[8:11], s25 offen sc1
s_add_u32 s24, s30, 86933504
buffer_load_dwordx4 v[72:75], v4, s[8:11], s24 offen sc1
s_add_u32 s24, s29, 89292800
buffer_load_dwordx4 v[80:83], v4, s[8:11], s24 offen sc1
s_add_u32 s25, s30, 89292800
buffer_load_dwordx4 v[84:87], v4, s[8:11], s25 offen sc1
s_add_u32 s25, s29, 91652096
buffer_load_dwordx4 v[92:95], v4, s[8:11], s25 offen sc1
s_add_u32 s24, s30, 91652096
buffer_load_dwordx4 v[96:99], v4, s[8:11], s24 offen sc1
s_add_u32 s24, s29, 94011392
buffer_load_dwordx4 v[104:107], v4, s[8:11], s24 offen sc1
s_add_u32 s25, s30, 94011392
buffer_load_dwordx4 v[108:111], v4, s[8:11], s25 offen sc1
s_add_u32 s25, s29, 96370688
buffer_load_dwordx4 v[116:119], v4, s[8:11], s25 offen sc1
s_add_u32 s24, s30, 96370688
buffer_load_dwordx4 v[120:123], v4, s[8:11], s24 offen sc1
s_waitcnt vmcnt(26)
v_lshlrev_b32 v128, 16, v16
v_and_b32 v129, 0xffff0000, v16
v_lshlrev_b32 v130, 16, v17
v_and_b32 v131, 0xffff0000, v17
v_lshlrev_b32 v132, 16, v18
v_and_b32 v133, 0xffff0000, v18
v_lshlrev_b32 v134, 16, v19
v_and_b32 v135, 0xffff0000, v19
s_waitcnt vmcnt(25)
v_lshlrev_b32 v136, 16, v20
v_and_b32 v137, 0xffff0000, v20
v_lshlrev_b32 v138, 16, v21
v_and_b32 v139, 0xffff0000, v21
v_lshlrev_b32 v140, 16, v22
v_and_b32 v141, 0xffff0000, v22
v_lshlrev_b32 v142, 16, v23
v_and_b32 v143, 0xffff0000, v23
s_waitcnt vmcnt(24)
v_lshlrev_b32 v144, 16, v24
v_and_b32 v145, 0xffff0000, v24
v_lshlrev_b32 v146, 16, v25
v_and_b32 v147, 0xffff0000, v25
v_lshlrev_b32 v148, 16, v26
v_and_b32 v149, 0xffff0000, v26
v_lshlrev_b32 v150, 16, v27
v_and_b32 v151, 0xffff0000, v27
s_waitcnt vmcnt(23)
v_lshlrev_b32 v6, 16, v28
v_and_b32 v7, 0xffff0000, v28
v_add_f32 v128, v128, v6
v_add_f32 v129, v129, v7
v_lshlrev_b32 v8, 16, v29
v_and_b32 v9, 0xffff0000, v29
v_add_f32 v130, v130, v8
v_add_f32 v131, v131, v9
v_lshlrev_b32 v6, 16, v30
v_and_b32 v7, 0xffff0000, v30
v_add_f32 v132, v132, v6
v_add_f32 v133, v133, v7
v_lshlrev_b32 v8, 16, v31
v_and_b32 v9, 0xffff0000, v31
v_add_f32 v134, v134, v8
v_add_f32 v135, v135, v9
s_waitcnt vmcnt(22)
v_lshlrev_b32 v6, 16, v40
v_and_b32 v7, 0xffff0000, v40
v_add_f32 v128, v128, v6
v_add_f32 v129, v129, v7
v_lshlrev_b32 v8, 16, v41
v_and_b32 v9, 0xffff0000, v41
v_add_f32 v130, v130, v8
v_add_f32 v131, v131, v9
v_lshlrev_b32 v6, 16, v42
v_and_b32 v7, 0xffff0000, v42
v_add_f32 v132, v132, v6
v_add_f32 v133, v133, v7
v_lshlrev_b32 v8, 16, v43
v_and_b32 v9, 0xffff0000, v43
v_add_f32 v134, v134, v8
v_add_f32 v135, v135, v9
s_waitcnt vmcnt(21)
v_lshlrev_b32 v6, 16, v52
v_and_b32 v7, 0xffff0000, v52
v_add_f32 v128, v128, v6
v_add_f32 v129, v129, v7
v_lshlrev_b32 v8, 16, v53
v_and_b32 v9, 0xffff0000, v53
v_add_f32 v130, v130, v8
v_add_f32 v131, v131, v9
v_lshlrev_b32 v6, 16, v54
v_and_b32 v7, 0xffff0000, v54
v_add_f32 v132, v132, v6
v_add_f32 v133, v133, v7
v_lshlrev_b32 v8, 16, v55
v_and_b32 v9, 0xffff0000, v55
v_add_f32 v134, v134, v8
v_add_f32 v135, v135, v9
s_waitcnt vmcnt(20)
v_lshlrev_b32 v6, 16, v64
v_and_b32 v7, 0xffff0000, v64
v_add_f32 v128, v128, v6
v_add_f32 v129, v129, v7
v_lshlrev_b32 v8, 16, v65
v_and_b32 v9, 0xffff0000, v65
v_add_f32 v130, v130, v8
v_add_f32 v131, v131, v9
v_lshlrev_b32 v6, 16, v66
v_and_b32 v7, 0xffff0000, v66
v_add_f32 v132, v132, v6
v_add_f32 v133, v133, v7
v_lshlrev_b32 v8, 16, v67
v_and_b32 v9, 0xffff0000, v67
v_add_f32 v134, v134, v8
v_add_f32 v135, v135, v9
s_waitcnt vmcnt(19)
v_lshlrev_b32 v6, 16, v76
v_and_b32 v7, 0xffff0000, v76
v_add_f32 v128, v128, v6
v_add_f32 v129, v129, v7
v_lshlrev_b32 v8, 16, v77
v_and_b32 v9, 0xffff0000, v77
v_add_f32 v130, v130, v8
v_add_f32 v131, v131, v9
v_lshlrev_b32 v6, 16, v78
v_and_b32 v7, 0xffff0000, v78
v_add_f32 v132, v132, v6
v_add_f32 v133, v133, v7
v_lshlrev_b32 v8, 16, v79
v_and_b32 v9, 0xffff0000, v79
v_add_f32 v134, v134, v8
v_add_f32 v135, v135, v9
s_waitcnt vmcnt(18)
v_lshlrev_b32 v6, 16, v88
v_and_b32 v7, 0xffff0000, v88
v_add_f32 v128, v128, v6
v_add_f32 v129, v129, v7
v_lshlrev_b32 v8, 16, v89
v_and_b32 v9, 0xffff0000, v89
v_add_f32 v130, v130, v8
v_add_f32 v131, v131, v9
v_lshlrev_b32 v6, 16, v90
v_and_b32 v7, 0xffff0000, v90
v_add_f32 v132, v132, v6
v_add_f32 v133, v133, v7
v_lshlrev_b32 v8, 16, v91
v_and_b32 v9, 0xffff0000, v91
v_add_f32 v134, v134, v8
v_add_f32 v135, v135, v9
s_waitcnt vmcnt(17)
v_lshlrev_b32 v6, 16, v100
v_and_b32 v7, 0xffff0000, v100
v_add_f32 v128, v128, v6
v_add_f32 v129, v129, v7
v_lshlrev_b32 v8, 16, v101
v_and_b32 v9, 0xffff0000, v101
v_add_f32 v130, v130, v8
v_add_f32 v131, v131, v9
v_lshlrev_b32 v6, 16, v102
v_and_b32 v7, 0xffff0000, v102
v_add_f32 v132, v132, v6
v_add_f32 v133, v133, v7
v_lshlrev_b32 v8, 16, v103
v_and_b32 v9, 0xffff0000, v103
v_add_f32 v134, v134, v8
v_add_f32 v135, v135, v9
s_waitcnt vmcnt(16)
v_lshlrev_b32 v6, 16, v112
v_and_b32 v7, 0xffff0000, v112
v_add_f32 v128, v128, v6
v_add_f32 v129, v129, v7
v_lshlrev_b32 v8, 16, v113
v_and_b32 v9, 0xffff0000, v113
v_add_f32 v130, v130, v8
v_add_f32 v131, v131, v9
v_lshlrev_b32 v6, 16, v114
v_and_b32 v7, 0xffff0000, v114
v_add_f32 v132, v132, v6
v_add_f32 v133, v133, v7
v_lshlrev_b32 v8, 16, v115
v_and_b32 v9, 0xffff0000, v115
v_add_f32 v134, v134, v8
v_add_f32 v135, v135, v9
s_waitcnt vmcnt(15)
v_lshlrev_b32 v6, 16, v32
v_and_b32 v7, 0xffff0000, v32
v_add_f32 v136, v136, v6
v_add_f32 v137, v137, v7
v_lshlrev_b32 v8, 16, v33
v_and_b32 v9, 0xffff0000, v33
v_add_f32 v138, v138, v8
v_add_f32 v139, v139, v9
v_lshlrev_b32 v6, 16, v34
v_and_b32 v7, 0xffff0000, v34
v_add_f32 v140, v140, v6
v_add_f32 v141, v141, v7
v_lshlrev_b32 v8, 16, v35
v_and_b32 v9, 0xffff0000, v35
v_add_f32 v142, v142, v8
v_add_f32 v143, v143, v9
s_waitcnt vmcnt(14)
v_lshlrev_b32 v6, 16, v36
v_and_b32 v7, 0xffff0000, v36
v_add_f32 v144, v144, v6
v_add_f32 v145, v145, v7
v_lshlrev_b32 v8, 16, v37
v_and_b32 v9, 0xffff0000, v37
v_add_f32 v146, v146, v8
v_add_f32 v147, v147, v9
v_lshlrev_b32 v6, 16, v38
v_and_b32 v7, 0xffff0000, v38
v_add_f32 v148, v148, v6
v_add_f32 v149, v149, v7
v_lshlrev_b32 v8, 16, v39
v_and_b32 v9, 0xffff0000, v39
v_add_f32 v150, v150, v8
v_add_f32 v151, v151, v9
s_waitcnt vmcnt(13)
v_lshlrev_b32 v6, 16, v44
v_and_b32 v7, 0xffff0000, v44
v_add_f32 v136, v136, v6
v_add_f32 v137, v137, v7
v_lshlrev_b32 v8, 16, v45
v_and_b32 v9, 0xffff0000, v45
v_add_f32 v138, v138, v8
v_add_f32 v139, v139, v9
v_lshlrev_b32 v6, 16, v46
v_and_b32 v7, 0xffff0000, v46
v_add_f32 v140, v140, v6
v_add_f32 v141, v141, v7
v_lshlrev_b32 v8, 16, v47
v_and_b32 v9, 0xffff0000, v47
v_add_f32 v142, v142, v8
v_add_f32 v143, v143, v9
s_waitcnt vmcnt(12)
v_lshlrev_b32 v6, 16, v48
v_and_b32 v7, 0xffff0000, v48
v_add_f32 v144, v144, v6
v_add_f32 v145, v145, v7
v_lshlrev_b32 v8, 16, v49
v_and_b32 v9, 0xffff0000, v49
v_add_f32 v146, v146, v8
v_add_f32 v147, v147, v9
v_lshlrev_b32 v6, 16, v50
v_and_b32 v7, 0xffff0000, v50
v_add_f32 v148, v148, v6
v_add_f32 v149, v149, v7
v_lshlrev_b32 v8, 16, v51
v_and_b32 v9, 0xffff0000, v51
v_add_f32 v150, v150, v8
v_add_f32 v151, v151, v9
s_waitcnt vmcnt(11)
v_lshlrev_b32 v6, 16, v56
v_and_b32 v7, 0xffff0000, v56
v_add_f32 v136, v136, v6
v_add_f32 v137, v137, v7
v_lshlrev_b32 v8, 16, v57
v_and_b32 v9, 0xffff0000, v57
v_add_f32 v138, v138, v8
v_add_f32 v139, v139, v9
v_lshlrev_b32 v6, 16, v58
v_and_b32 v7, 0xffff0000, v58
v_add_f32 v140, v140, v6
v_add_f32 v141, v141, v7
v_lshlrev_b32 v8, 16, v59
v_and_b32 v9, 0xffff0000, v59
v_add_f32 v142, v142, v8
v_add_f32 v143, v143, v9
s_waitcnt vmcnt(10)
v_lshlrev_b32 v6, 16, v60
v_and_b32 v7, 0xffff0000, v60
v_add_f32 v144, v144, v6
v_add_f32 v145, v145, v7
v_lshlrev_b32 v8, 16, v61
v_and_b32 v9, 0xffff0000, v61
v_add_f32 v146, v146, v8
v_add_f32 v147, v147, v9
v_lshlrev_b32 v6, 16, v62
v_and_b32 v7, 0xffff0000, v62
v_add_f32 v148, v148, v6
v_add_f32 v149, v149, v7
v_lshlrev_b32 v8, 16, v63
v_and_b32 v9, 0xffff0000, v63
v_add_f32 v150, v150, v8
v_add_f32 v151, v151, v9
s_waitcnt vmcnt(9)
v_lshlrev_b32 v6, 16, v68
v_and_b32 v7, 0xffff0000, v68
v_add_f32 v136, v136, v6
v_add_f32 v137, v137, v7
v_lshlrev_b32 v8, 16, v69
v_and_b32 v9, 0xffff0000, v69
v_add_f32 v138, v138, v8
v_add_f32 v139, v139, v9
v_lshlrev_b32 v6, 16, v70
v_and_b32 v7, 0xffff0000, v70
v_add_f32 v140, v140, v6
v_add_f32 v141, v141, v7
v_lshlrev_b32 v8, 16, v71
v_and_b32 v9, 0xffff0000, v71
v_add_f32 v142, v142, v8
v_add_f32 v143, v143, v9
s_waitcnt vmcnt(8)
v_lshlrev_b32 v6, 16, v72
v_and_b32 v7, 0xffff0000, v72
v_add_f32 v144, v144, v6
v_add_f32 v145, v145, v7
v_lshlrev_b32 v8, 16, v73
v_and_b32 v9, 0xffff0000, v73
v_add_f32 v146, v146, v8
v_add_f32 v147, v147, v9
v_lshlrev_b32 v6, 16, v74
v_and_b32 v7, 0xffff0000, v74
v_add_f32 v148, v148, v6
v_add_f32 v149, v149, v7
v_lshlrev_b32 v8, 16, v75
v_and_b32 v9, 0xffff0000, v75
v_add_f32 v150, v150, v8
v_add_f32 v151, v151, v9
s_waitcnt vmcnt(7)
v_lshlrev_b32 v6, 16, v80
v_and_b32 v7, 0xffff0000, v80
v_add_f32 v136, v136, v6
v_add_f32 v137, v137, v7
v_lshlrev_b32 v8, 16, v81
v_and_b32 v9, 0xffff0000, v81
v_add_f32 v138, v138, v8
v_add_f32 v139, v139, v9
v_lshlrev_b32 v6, 16, v82
v_and_b32 v7, 0xffff0000, v82
v_add_f32 v140, v140, v6
v_add_f32 v141, v141, v7
v_lshlrev_b32 v8, 16, v83
v_and_b32 v9, 0xffff0000, v83
v_add_f32 v142, v142, v8
v_add_f32 v143, v143, v9
s_waitcnt vmcnt(6)
v_lshlrev_b32 v6, 16, v84
v_and_b32 v7, 0xffff0000, v84
v_add_f32 v144, v144, v6
v_add_f32 v145, v145, v7
v_lshlrev_b32 v8, 16, v85
v_and_b32 v9, 0xffff0000, v85
v_add_f32 v146, v146, v8
v_add_f32 v147, v147, v9
v_lshlrev_b32 v6, 16, v86
v_and_b32 v7, 0xffff0000, v86
v_add_f32 v148, v148, v6
v_add_f32 v149, v149, v7
v_lshlrev_b32 v8, 16, v87
v_and_b32 v9, 0xffff0000, v87
v_add_f32 v150, v150, v8
v_add_f32 v151, v151, v9
s_waitcnt vmcnt(5)
v_lshlrev_b32 v6, 16, v92
v_and_b32 v7, 0xffff0000, v92
v_add_f32 v136, v136, v6
v_add_f32 v137, v137, v7
v_lshlrev_b32 v8, 16, v93
v_and_b32 v9, 0xffff0000, v93
v_add_f32 v138, v138, v8
v_add_f32 v139, v139, v9
v_lshlrev_b32 v6, 16, v94
v_and_b32 v7, 0xffff0000, v94
v_add_f32 v140, v140, v6
v_add_f32 v141, v141, v7
v_lshlrev_b32 v8, 16, v95
v_and_b32 v9, 0xffff0000, v95
v_add_f32 v142, v142, v8
v_add_f32 v143, v143, v9
s_waitcnt vmcnt(4)
v_lshlrev_b32 v6, 16, v96
v_and_b32 v7, 0xffff0000, v96
v_add_f32 v144, v144, v6
v_add_f32 v145, v145, v7
v_lshlrev_b32 v8, 16, v97
v_and_b32 v9, 0xffff0000, v97
v_add_f32 v146, v146, v8
v_add_f32 v147, v147, v9
v_lshlrev_b32 v6, 16, v98
v_and_b32 v7, 0xffff0000, v98
v_add_f32 v148, v148, v6
v_add_f32 v149, v149, v7
v_lshlrev_b32 v8, 16, v99
v_and_b32 v9, 0xffff0000, v99
v_add_f32 v150, v150, v8
v_add_f32 v151, v151, v9
s_waitcnt vmcnt(3)
v_lshlrev_b32 v6, 16, v104
v_and_b32 v7, 0xffff0000, v104
v_add_f32 v136, v136, v6
v_add_f32 v137, v137, v7
v_lshlrev_b32 v8, 16, v105
v_and_b32 v9, 0xffff0000, v105
v_add_f32 v138, v138, v8
v_add_f32 v139, v139, v9
v_lshlrev_b32 v6, 16, v106
v_and_b32 v7, 0xffff0000, v106
v_add_f32 v140, v140, v6
v_add_f32 v141, v141, v7
v_lshlrev_b32 v8, 16, v107
v_and_b32 v9, 0xffff0000, v107
v_add_f32 v142, v142, v8
v_add_f32 v143, v143, v9
s_waitcnt vmcnt(2)
v_lshlrev_b32 v6, 16, v108
v_and_b32 v7, 0xffff0000, v108
v_add_f32 v144, v144, v6
L_hop12:
s_cmp_eq_u32 s15, 1
s_cbranch_scc1 L_hop_done
v_add_f32 v145, v145, v7
v_lshlrev_b32 v8, 16, v109
v_and_b32 v9, 0xffff0000, v109
v_add_f32 v146, v146, v8
v_add_f32 v147, v147, v9
v_lshlrev_b32 v6, 16, v110
v_and_b32 v7, 0xffff0000, v110
v_add_f32 v148, v148, v6
v_add_f32 v149, v149, v7
v_lshlrev_b32 v8, 16, v111
v_and_b32 v9, 0xffff0000, v111
v_add_f32 v150, v150, v8
v_add_f32 v151, v151, v9
s_waitcnt vmcnt(1)
v_lshlrev_b32 v6, 16, v116
v_and_b32 v7, 0xffff0000, v116
v_add_f32 v136, v136, v6
v_add_f32 v137, v137, v7
v_lshlrev_b32 v8, 16, v117
v_and_b32 v9, 0xffff0000, v117
v_add_f32 v138, v138, v8
v_add_f32 v139, v139, v9
v_lshlrev_b32 v6, 16, v118
v_and_b32 v7, 0xffff0000, v118
v_add_f32 v140, v140, v6
v_add_f32 v141, v141, v7
v_lshlrev_b32 v8, 16, v119
v_and_b32 v9, 0xffff0000, v119
v_add_f32 v142, v142, v8
v_add_f32 v143, v143, v9
s_waitcnt vmcnt(0)
v_lshlrev_b32 v6, 16, v120
v_and_b32 v7, 0xffff0000, v120
v_add_f32 v144, v144, v6
v_add_f32 v145, v145, v7
v_lshlrev_b32 v8, 16, v121
v_and_b32 v9, 0xffff0000, v121
v_add_f32 v146, v146, v8
v_add_f32 v147, v147, v9
v_lshlrev_b32 v6, 16, v122
v_and_b32 v7, 0xffff0000, v122
v_add_f32 v148, v148, v6
v_add_f32 v149, v149, v7
v_lshlrev_b32 v8, 16, v123
v_and_b32 v9, 0xffff0000, v123
v_add_f32 v150, v150, v8
v_add_f32 v151, v151, v9
v_cvt_pk_bf16_f32 v152, v128, v129
v_cvt_pk_bf16_f32 v153, v130, v131
v_cvt_pk_bf16_f32 v154, v132, v133
v_cvt_pk_bf16_f32 v155, v134, v135
v_cvt_pk_bf16_f32 v156, v136, v137
v_cvt_pk_bf16_f32 v157, v138, v139
v_cvt_pk_bf16_f32 v158, v140, v141
v_cvt_pk_bf16_f32 v159, v142, v143
v_cvt_pk_bf16_f32 v160, v144, v145
v_cvt_pk_bf16_f32 v161, v146, v147
v_cvt_pk_bf16_f32 v162, v148, v149
v_cvt_pk_bf16_f32 v163, v150, v151
v_add_f32 v6, v128, v129
v_mul_f32 v7, v128, v128
v_mul_f32 v9, v129, v129
v_mov_b32 v8, 0
v_add_f32 v6, v6, v130
v_add_f32 v8, v8, v131
v_fmac_f32 v7, v130, v130
v_fmac_f32 v9, v131, v131
v_add_f32 v6, v6, v132
v_add_f32 v8, v8, v133
v_fmac_f32 v7, v132, v132
v_fmac_f32 v9, v133, v133
v_add_f32 v6, v6, v134
v_add_f32 v8, v8, v135
v_fmac_f32 v7, v134, v134
v_fmac_f32 v9, v135, v135
v_add_f32 v6, v6, v136
v_add_f32 v8, v8, v137
v_fmac_f32 v7, v136, v136
v_fmac_f32 v9, v137, v137
v_add_f32 v6, v6, v138
v_add_f32 v8, v8, v139
v_fmac_f32 v7, v138, v138
v_fmac_f32 v9, v139, v139
v_add_f32 v6, v6, v140
v_add_f32 v8, v8, v141
v_fmac_f32 v7, v140, v140
v_fmac_f32 v9, v141, v141
v_add_f32 v6, v6, v142
v_add_f32 v8, v8, v143
v_fmac_f32 v7, v142, v142
v_fmac_f32 v9, v143, v143
v_add_f32 v6, v6, v144
v_add_f32 v8, v8, v145
v_fmac_f32 v7, v144, v144
v_fmac_f32 v9, v145, v145
v_add_f32 v6, v6, v146
v_add_f32 v8, v8, v147
v_fmac_f32 v7, v146, v146
v_fmac_f32 v9, v147, v147
v_add_f32 v6, v6, v148
v_add_f32 v8, v8, v149
v_fmac_f32 v7, v148, v148
v_fmac_f32 v9, v149, v149
v_add_f32 v6, v6, v150
v_add_f32 v8, v8, v151
v_fmac_f32 v7, v150, v150
v_fmac_f32 v9, v151, v151
v_add_f32 v6, v6, v8
v_add_f32 v7, v7, v9
s_nop 0
v_add_f32_dpp v6, v6, v6 row_ror:8 row_mask:0xf bank_mask:0xf
v_add_f32_dpp v7, v7, v7 row_ror:8 row_mask:0xf bank_mask:0xf
v_mov_b32 v8, v6
v_mov_b32 v9, v7
s_nop 0
v_permlane16_swap_b32 v6, v8
v_permlane16_swap_b32 v7, v9
v_add_f32 v6, v6, v8
v_add_f32 v7, v7, v9
v_mov_b32 v8, v6
v_mov_b32 v9, v7
s_nop 0
v_permlane32_swap_b32 v6, v8
v_permlane32_swap_b32 v7, v9
v_add_f32 v6, v6, v8
v_add_f32 v7, v7, v9
v_and_b32 v10, 7, v1
v_lshlrev_b32 v10, 3, v10
v_add_u32 v10, 147456, v10
s_lshl_b32 s24, s4, 6
v_add_u32 v11, s24, v10
ds_write_b64 v11, v[6:7]
s_add_u32 s24, s28, 30048256
buffer_store_dwordx4 v[152:155], v4, s[8:11], s24 offen sc1
s_add_u32 s25, s29, 30048256
buffer_store_dwordx4 v[156:159], v4, s[8:11], s25 offen sc1
s_add_u32 s24, s30, 30048256
buffer_store_dwordx4 v[160:163], v4, s[8:11], s24 offen sc1
s_waitcnt lgkmcnt(0)
s_barrier
ds_read_b64 v[6:7], v10
ds_read_b64 v[8:9], v10 offset:64
ds_read_b64 v[12:13], v10 offset:128
s_waitcnt lgkmcnt(0)
v_add_f32 v6, v6, v8
v_add_f32 v7, v7, v9
v_add_f32 v6, v6, v12
v_add_f32 v7, v7, v13
v_mul_f32 v6, 0x3ae38e39, v6
v_mul_f32 v7, 0x3ae38e39, v7
v_fma_f32 v7, -v6, v6, v7
v_max_f32 v7, 0, v7
v_add_f32 v7, 0x3727c5ac, v7
v_rsq_f32 v7, v7
s_nop 0
v_mul_f32 v6, v6, v7
v_fma_f32 v128, v128, v7, -v6
v_fma_f32 v129, v129, v7, -v6
v_fma_f32 v130, v130, v7, -v6
v_fma_f32 v131, v131, v7, -v6
v_fma_f32 v132, v132, v7, -v6
v_fma_f32 v133, v133, v7, -v6
v_fma_f32 v134, v134, v7, -v6
v_fma_f32 v135, v135, v7, -v6
v_cvt_pk_bf16_f32 v168, v128, v129
v_cvt_pk_bf16_f32 v169, v130, v131
v_cvt_pk_bf16_f32 v170, v132, v133
v_cvt_pk_bf16_f32 v171, v134, v135
s_add_u32 s24, s28, 25329664
buffer_store_dwordx4 v[168:171], v4, s[8:11], s24 offen sc1
v_fma_f32 v136, v136, v7, -v6
v_fma_f32 v137, v137, v7, -v6
v_fma_f32 v138, v138, v7, -v6
v_fma_f32 v139, v139, v7, -v6
v_fma_f32 v140, v140, v7, -v6
v_fma_f32 v141, v141, v7, -v6
v_fma_f32 v142, v142, v7, -v6
v_fma_f32 v143, v143, v7, -v6
v_cvt_pk_bf16_f32 v172, v136, v137
v_cvt_pk_bf16_f32 v173, v138, v139
v_cvt_pk_bf16_f32 v174, v140, v141
v_cvt_pk_bf16_f32 v175, v142, v143
s_add_u32 s25, s29, 25329664
buffer_store_dwordx4 v[172:175], v4, s[8:11], s25 offen sc1
v_fma_f32 v144, v144, v7, -v6
v_fma_f32 v145, v145, v7, -v6
v_fma_f32 v146, v146, v7, -v6
v_fma_f32 v147, v147, v7, -v6
v_fma_f32 v148, v148, v7, -v6
v_fma_f32 v149, v149, v7, -v6
v_fma_f32 v150, v150, v7, -v6
v_fma_f32 v151, v151, v7, -v6
v_cvt_pk_bf16_f32 v176, v144, v145
v_cvt_pk_bf16_f32 v177, v146, v147
v_cvt_pk_bf16_f32 v178, v148, v149
v_cvt_pk_bf16_f32 v179, v150, v151
s_add_u32 s24, s30, 25329664
buffer_store_dwordx4 v[176:179], v4, s[8:11], s24 offen sc1
s_lshl_b32 s24, s5, 5
s_add_u32 s24, s24, s6
s_lshl_b32 s14, s24, 7
s_add_u32 s14, s14, 1835008
s_branch L_r_done
L_r_side:
v_mov_b32 v13, 2146435072
v_cmp_gt_u32 vcc, 16, v0
v_lshlrev_b32 v14, 3, v0
s_nop 0
v_cndmask_b32 v13, v13, v14, vcc
v_mov_b32 v14, s68
v_mov_b32 v15, s69
s_waitcnt vmcnt(0)
s_barrier
buffer_store_dwordx2 v[14:15], v13, s[8:11], s14 offen sc1
s_lshr_b32 s20, s5, 2
s_lshl_b32 s20, s20, 3
s_lshr_b32 s21, s6, 2
s_add_u32 s20, s20, s21
s_and_b32 s21, s5, 3
s_lshl_b32 s21, s21, 2
s_and_b32 s22, s6, 3
s_add_u32 s21, s21, s22
s_mul_i32 s32, s21, 129024
s_add_u32 s32, s32, 4198400
s_mul_i32 s33, s4, 0
s_add_u32 s32, s32, s33
s_add_u32 m0, s33, 0
s_add_u32 s40, s32, 0
buffer_load_dwordx4 v2, s[8:11], s40 offen offset:0 sc1 lds
buffer_load_dwordx4 v2, s[8:11], s40 offen offset:1024 sc1 lds
buffer_load_dwordx4 v2, s[8:11], s40 offen offset:2048 sc1 lds
buffer_load_dwordx4 v2, s[8:11], s40 offen offset:3072 sc1 lds
s_add_u32 m0, s33, 4096
s_add_u32 s40, s32, 4096
buffer_load_dwordx4 v2, s[8:11], s40 offen offset:0 sc1 lds
buffer_load_dwordx4 v2, s[8:11], s40 offen offset:1024 sc1 lds
buffer_load_dwordx4 v2, s[8:11], s40 offen offset:2048 sc1 lds
buffer_load_dwordx4 v2, s[8:11], s40 offen offset:3072 sc1 lds
s_add_u32 m0, s33, 8192
s_add_u32 s40, s32, 8192
buffer_load_dwordx4 v2, s[8:11], s40 offen offset:0 sc1 lds
buffer_load_dwordx4 v2, s[8:11], s40 offen offset:1024 sc1 lds
buffer_load_dwordx4 v2, s[8:11], s40 offen offset:2048 sc1 lds
buffer_load_dwordx4 v2, s[8:11], s40 offen offset:3072 sc1 lds
s_add_u32 m0, s33, 12288
s_add_u32 s40, s32, 12288
buffer_load_dwordx4 v2, s[8:11], s40 offen offset:0 sc1 lds
buffer_load_dwordx4 v2, s[8:11], s40 offen offset:1024 sc1 lds
buffer_load_dwordx4 v2, s[8:11], s40 offen offset:2048 sc1 lds
buffer_load_dwordx4 v2, s[8:11], s40 offen offset:3072 sc1 lds
s_add_u32 m0, s33, 16384
s_add_u32 s40, s32, 16384
buffer_load_dwordx4 v2, s[8:11], s40 offen offset:0 sc1 lds
buffer_load_dwordx4 v2, s[8:11], s40 offen offset:1024 sc1 lds
buffer_load_dwordx4 v2, s[8:11], s40 offen offset:2048 sc1 lds
buffer_load_dwordx4 v2, s[8:11], s40 offen offset:3072 sc1 lds
s_add_u32 m0, s33, 20480
s_add_u32 s40, s32, 20480
buffer_load_dwordx4 v2, s[8:11], s40 offen offset:0 sc1 lds
buffer_load_dwordx4 v2, s[8:11], s40 offen offset:1024 sc1 lds
buffer_load_dwordx4 v2, s[8:11], s40 offen offset:2048 sc1 lds
buffer_load_dwordx4 v2, s[8:11], s40 offen offset:3072 sc1 lds
s_add_u32 m0, s33, 24576
s_add_u32 s40, s32, 24576
buffer_load_dwordx4 v2, s[8:11], s40 offen offset:0 sc1 lds
buffer_load_dwordx4 v2, s[8:11], s40 offen offset:1024 sc1 lds
buffer_load_dwordx4 v2, s[8:11], s40 offen offset:2048 sc1 lds
buffer_load_dwordx4 v2, s[8:11], s40 offen offset:3072 sc1 lds
s_add_u32 m0, s33, 28672
s_add_u32 s40, s32, 28672
buffer_load_dwordx4 v2, s[8:11], s40 offen offset:0 sc1 lds
buffer_load_dwordx4 v2, s[8:11], s40 offen offset:1024 sc1 lds
buffer_load_dwordx4 v2, s[8:11], s40 offen offset:2048 sc1 lds
buffer_load_dwordx4 v2, s[8:11], s40 offen offset:3072 sc1 lds
s_add_u32 m0, s33, 32768
s_add_u32 s40, s32, 32768
buffer_load_dwordx4 v2, s[8:11], s40 offen offset:0 sc1 lds
buffer_load_dwordx4 v2, s[8:11], s40 offen offset:1024 sc1 lds
buffer_load_dwordx4 v2, s[8:11], s40 offen offset:2048 sc1 lds
buffer_load_dwordx4 v2, s[8:11], s40 offen offset:3072 sc1 lds
s_add_u32 m0, s33, 36864
s_add_u32 s40, s32, 36864
buffer_load_dwordx4 v2, s[8:11], s40 offen offset:0 sc1 lds
buffer_load_dwordx4 v2, s[8:11], s40 offen offset:1024 sc1 lds
buffer_load_dwordx4 v2, s[8:11], s40 offen offset:2048 sc1 lds
buffer_load_dwordx4 v2, s[8:11], s40 offen offset:3072 sc1 lds
s_add_u32 m0, s33, 40960
s_add_u32 s40, s32, 40960
buffer_load_dwordx4 v2, s[8:11], s40 offen offset:0 sc1 lds
buffer_load_dwordx4 v2, s[8:11], s40 offen offset:1024 sc1 lds
buffer_load_dwordx4 v2, s[8:11], s40 offen offset:2048 sc1 lds
buffer_load_dwordx4 v2, s[8:11], s40 offen offset:3072 sc1 lds
s_add_u32 m0, s33, 45056
s_add_u32 s40, s32, 45056
buffer_load_dwordx4 v2, s[8:11], s40 offen offset:0 sc1 lds
buffer_load_dwordx4 v2, s[8:11], s40 offen offset:1024 sc1 lds
buffer_load_dwordx4 v2, s[8:11], s40 offen offset:2048 sc1 lds
buffer_load_dwordx4 v2, s[8:11], s40 offen offset:3072 sc1 lds
s_add_u32 m0, s33, 49152
s_add_u32 s40, s32, 49152
buffer_load_dwordx4 v2, s[8:11], s40 offen offset:0 sc1 lds
buffer_load_dwordx4 v2, s[8:11], s40 offen offset:1024 sc1 lds
buffer_load_dwordx4 v2, s[8:11], s40 offen offset:2048 sc1 lds
buffer_load_dwordx4 v2, s[8:11], s40 offen offset:3072 sc1 lds
s_add_u32 m0, s33, 53248
s_add_u32 s40, s32, 53248
buffer_load_dwordx4 v2, s[8:11], s40 offen offset:0 sc1 lds
buffer_load_dwordx4 v2, s[8:11], s40 offen offset:1024 sc1 lds
buffer_load_dwordx4 v2, s[8:11], s40 offen offset:2048 sc1 lds
buffer_load_dwordx4 v2, s[8:11], s40 offen offset:3072 sc1 lds
s_add_u32 m0, s33, 57344
s_add_u32 s40, s32, 57344
buffer_load_dwordx4 v2, s[8:11], s40 offen offset:0 sc1 lds
buffer_load_dwordx4 v2, s[8:11], s40 offen offset:1024 sc1 lds
buffer_load_dwordx4 v2, s[8:11], s40 offen offset:2048 sc1 lds
buffer_load_dwordx4 v2, s[8:11], s40 offen offset:3072 sc1 lds
s_add_u32 m0, s33, 61440
s_add_u32 s40, s32, 61440
buffer_load_dwordx4 v2, s[8:11], s40 offen offset:0 sc1 lds
buffer_load_dwordx4 v2, s[8:11], s40 offen offset:1024 sc1 lds
buffer_load_dwordx4 v2, s[8:11], s40 offen offset:2048 sc1 lds
buffer_load_dwordx4 v2, s[8:11], s40 offen offset:3072 sc1 lds
s_add_u32 m0, s33, 65536
s_add_u32 s40, s32, 65536
buffer_load_dwordx4 v2, s[8:11], s40 offen offset:0 sc1 lds
buffer_load_dwordx4 v2, s[8:11], s40 offen offset:1024 sc1 lds
buffer_load_dwordx4 v2, s[8:11], s40 offen offset:2048 sc1 lds
buffer_load_dwordx4 v2, s[8:11], s40 offen offset:3072 sc1 lds
s_add_u32 m0, s33, 69632
s_add_u32 s40, s32, 69632
buffer_load_dwordx4 v2, s[8:11], s40 offen offset:0 sc1 lds
buffer_load_dwordx4 v2, s[8:11], s40 offen offset:1024 sc1 lds
buffer_load_dwordx4 v2, s[8:11], s40 offen offset:2048 sc1 lds
buffer_load_dwordx4 v2, s[8:11], s40 offen offset:3072 sc1 lds
s_add_u32 m0, s33, 73728
s_add_u32 s40, s32, 73728
buffer_load_dwordx4 v2, s[8:11], s40 offen offset:0 sc1 lds
buffer_load_dwordx4 v2, s[8:11], s40 offen offset:1024 sc1 lds
buffer_load_dwordx4 v2, s[8:11], s40 offen offset:2048 sc1 lds
buffer_load_dwordx4 v2, s[8:11], s40 offen offset:3072 sc1 lds
s_add_u32 m0, s33, 77824
s_add_u32 s40, s32, 77824
buffer_load_dwordx4 v2, s[8:11], s40 offen offset:0 sc1 lds
buffer_load_dwordx4 v2, s[8:11], s40 offen offset:1024 sc1 lds
buffer_load_dwordx4 v2, s[8:11], s40 offen offset:2048 sc1 lds
buffer_load_dwordx4 v2, s[8:11], s40 offen offset:3072 sc1 lds
s_add_u32 m0, s33, 81920
s_add_u32 s40, s32, 81920
buffer_load_dwordx4 v2, s[8:11], s40 offen offset:0 sc1 lds
buffer_load_dwordx4 v2, s[8:11], s40 offen offset:1024 sc1 lds
buffer_load_dwordx4 v2, s[8:11], s40 offen offset:2048 sc1 lds
buffer_load_dwordx4 v2, s[8:11], s40 offen offset:3072 sc1 lds
s_add_u32 m0, s33, 86016
s_add_u32 s40, s32, 86016
buffer_load_dwordx4 v2, s[8:11], s40 offen offset:0 sc1 lds
buffer_load_dwordx4 v2, s[8:11], s40 offen offset:1024 sc1 lds
buffer_load_dwordx4 v2, s[8:11], s40 offen offset:2048 sc1 lds
buffer_load_dwordx4 v2, s[8:11], s40 offen offset:3072 sc1 lds
s_add_u32 m0, s33, 90112
s_add_u32 s40, s32, 90112
buffer_load_dwordx4 v2, s[8:11], s40 offen offset:0 sc1 lds
buffer_load_dwordx4 v2, s[8:11], s40 offen offset:1024 sc1 lds
buffer_load_dwordx4 v2, s[8:11], s40 offen offset:2048 sc1 lds
buffer_load_dwordx4 v2, s[8:11], s40 offen offset:3072 sc1 lds
s_add_u32 m0, s33, 94208
s_add_u32 s40, s32, 94208
buffer_load_dwordx4 v2, s[8:11], s40 offen offset:0 sc1 lds
buffer_load_dwordx4 v2, s[8:11], s40 offen offset:1024 sc1 lds
buffer_load_dwordx4 v2, s[8:11], s40 offen offset:2048 sc1 lds
buffer_load_dwordx4 v2, s[8:11], s40 offen offset:3072 sc1 lds
s_add_u32 m0, s33, 98304
s_add_u32 s40, s32, 98304
buffer_load_dwordx4 v2, s[8:11], s40 offen offset:0 sc1 lds
buffer_load_dwordx4 v2, s[8:11], s40 offen offset:1024 sc1 lds
buffer_load_dwordx4 v2, s[8:11], s40 offen offset:2048 sc1 lds
buffer_load_dwordx4 v2, s[8:11], s40 offen offset:3072 sc1 lds
s_add_u32 m0, s33, 102400
s_add_u32 s40, s32, 102400
buffer_load_dwordx4 v2, s[8:11], s40 offen offset:0 sc1 lds
buffer_load_dwordx4 v2, s[8:11], s40 offen offset:1024 sc1 lds
buffer_load_dwordx4 v2, s[8:11], s40 offen offset:2048 sc1 lds
buffer_load_dwordx4 v2, s[8:11], s40 offen offset:3072 sc1 lds
s_add_u32 m0, s33, 106496
s_add_u32 s40, s32, 106496
buffer_load_dwordx4 v2, s[8:11], s40 offen offset:0 sc1 lds
buffer_load_dwordx4 v2, s[8:11], s40 offen offset:1024 sc1 lds
buffer_load_dwordx4 v2, s[8:11], s40 offen offset:2048 sc1 lds
buffer_load_dwordx4 v2, s[8:11], s40 offen offset:3072 sc1 lds
s_add_u32 m0, s33, 110592
s_add_u32 s40, s32, 110592
buffer_load_dwordx4 v2, s[8:11], s40 offen offset:0 sc1 lds
buffer_load_dwordx4 v2, s[8:11], s40 offen offset:1024 sc1 lds
buffer_load_dwordx4 v2, s[8:11], s40 offen offset:2048 sc1 lds
buffer_load_dwordx4 v2, s[8:11], s40 offen offset:3072 sc1 lds
s_add_u32 m0, s33, 114688
s_add_u32 s40, s32, 114688
buffer_load_dwordx4 v2, s[8:11], s40 offen offset:0 sc1 lds
buffer_load_dwordx4 v2, s[8:11], s40 offen offset:1024 sc1 lds
buffer_load_dwordx4 v2, s[8:11], s40 offen offset:2048 sc1 lds
buffer_load_dwordx4 v2, s[8:11], s40 offen offset:3072 sc1 lds
s_add_u32 m0, s33, 118784
s_add_u32 s40, s32, 118784
buffer_load_dwordx4 v2, s[8:11], s40 offen offset:0 sc1 lds
buffer_load_dwordx4 v2, s[8:11], s40 offen offset:1024 sc1 lds
buffer_load_dwordx4 v2, s[8:11], s40 offen offset:2048 sc1 lds
buffer_load_dwordx4 v2, s[8:11], s40 offen offset:3072 sc1 lds
s_add_u32 m0, s33, 122880
s_add_u32 s40, s32, 122880
buffer_load_dwordx4 v2, s[8:11], s40 offen offset:0 sc1 lds
buffer_load_dwordx4 v2, s[8:11], s40 offen offset:1024 sc1 lds
buffer_load_dwordx4 v2, s[8:11], s40 offen offset:2048 sc1 lds
buffer_load_dwordx4 v2, s[8:11], s40 offen offset:3072 sc1 lds
s_add_u32 m0, s33, 126976
s_add_u32 s40, s32, 126976
buffer_load_dwordx4 v2, s[8:11], s40 offen offset:0 sc1 lds
buffer_load_dwordx4 v2, s[8:11], s40 offen offset:1024 sc1 lds
s_barrier
L_r_done:
s_mov_b32 s70, 25329664
s_mov_b32 s71, 30048256
s_mov_b32 s72, 34766848
s_mov_b32 s73, 39485440
s_mov_b32 s74, 41975808
s_mov_b32 s75, 60981248
s_mov_b32 s76, 98729984
s_mov_b32 s77, 1048576
s_mov_b32 s7, 1
s_lshr_b32 s20, s5, 2
s_lshl_b32 s20, s20, 3
s_lshr_b32 s21, s6, 2
s_add_u32 s20, s20, s21
s_and_b32 s21, s5, 3
s_lshl_b32 s21, s21, 2
s_and_b32 s22, s6, 3
s_add_u32 s21, s21, s22
s_lshl_b32 s24, s20, 3
s_sub_u32 s25, s24, 1
s_max_i32 s35, s25, 0
s_mul_i32 s25, s35, 18432
s_lshl_b32 s26, s4, 1
s_add_u32 s36, s24, s26
s_mul_i32 s24, s36, 18432
s_add_u32 s26, s24, s70
s_add_u32 s27, s26, 18432
s_add_u32 s28, s25, s70
v_add_u32 v4, 0x10000, v2
v_add_u32 v5, 0x20000, v2
s_cmp_eq_u32 s4, 3
s_cselect_b32 s29, 0, s4
s_cselect_b32 s31, 16, 9
s_lshl_b32 s30, s29, 10
v_and_b32 v12, 15, v1
v_mov_b32 v13, 2146435072
v_cmp_le_u32 vcc, s31, v12
s_nop 1
v_cndmask_b32 v3, v13, v2, vcc
s_add_u32 s31, s30, 2048
v_add_u32 v6, s31, v2
v_add_u32 v7, s31, v4
v_add_u32 v8, s31, v5
s_and_b32 s30, s30, 1024
s_add_u32 s31, s30, 5120
v_add_u32 v9, s31, v2
v_add_u32 v10, s31, v4
v_add_u32 v11, s31, v5
s_lshl_b32 s22, s36, 1
s_lshl_b32 s23, s35, 1
s_add_u32 s23, s23, 1
v_and_b32 v16, 3, v1
v_add_u32 v16, s22, v16
v_mov_b32 v17, s23
v_cmp_eq_u32 vcc, 4, v1
s_nop 1
v_cndmask_b32 v16, v16, v17, vcc
v_lshlrev_b32 v16, 7, v16
s_add_u32 s22, s77, 786432
v_mov_b32 v13, 2146435072
v_cmp_gt_u32 vcc, 16, v0
v_lshlrev_b32 v14, 3, v0
s_nop 0
v_cndmask_b32 v13, v13, v14, vcc
v_mov_b32 v14, s68
v_mov_b32 v15, s69
s_waitcnt vmcnt(0)
s_barrier
buffer_store_dwordx2 v[14:15], v13, s[8:11], s14 offen sc1
s_mov_b32 s52, 0
L_poll7:
buffer_load_dwordx2 v[14:15], v16, s[8:11], s22 offen sc1
s_add_u32 s52, s52, 1
s_waitcnt vmcnt(0)
v_cmp_ne_u64 vcc, s[68:69], v[14:15]
s_cmp_ge_u32 s52, 1048576
s_cbranch_scc1 L_got7
s_and_b64 exec, exec, vcc
s_cbranch_execnz L_poll7
L_got7:
s_mov_b64 exec, -1
buffer_load_dwordx4 a[0:3], v2, s[8:11], s26 offen offset:0 sc1
buffer_load_dwordx4 a[72:75], v2, s[8:11], s27 offen offset:0 sc1
buffer_load_dwordx4 a[144:147], v3, s[8:11], s28 offen offset:0 sc1
buffer_load_dwordx4 a[4:7], v2, s[8:11], s26 offen offset:1024 sc1
buffer_load_dwordx4 a[76:79], v2, s[8:11], s27 offen offset:1024 sc1
buffer_load_dwordx4 a[148:151], v3, s[8:11], s28 offen offset:1024 sc1
buffer_load_dwordx4 a[8:11], v2, s[8:11], s26 offen offset:2048 sc1
buffer_load_dwordx4 a[80:83], v2, s[8:11], s27 offen offset:2048 sc1
buffer_load_dwordx4 a[152:155], v3, s[8:11], s28 offen offset:2048 sc1
buffer_load_dwordx4 a[12:15], v2, s[8:11], s26 offen offset:3072 sc1
buffer_load_dwordx4 a[84:87], v2, s[8:11], s27 offen offset:3072 sc1
buffer_load_dwordx4 a[156:159], v3, s[8:11], s28 offen offset:3072 sc1
s_add_u32 s26, s26, 4096
s_add_u32 s27, s27, 4096
s_add_u32 s28, s28, 4096
buffer_load_dwordx4 a[16:19], v2, s[8:11], s26 offen offset:0 sc1
buffer_load_dwordx4 a[88:91], v2, s[8:11], s27 offen offset:0 sc1
buffer_load_dwordx4 a[160:163], v3, s[8:11], s28 offen offset:0 sc1
buffer_load_dwordx4 a[20:23], v2, s[8:11], s26 offen offset:1024 sc1
buffer_load_dwordx4 a[92:95], v2, s[8:11], s27 offen offset:1024 sc1
buffer_load_dwordx4 a[164:167], v3, s[8:11], s28 offen offset:1024 sc1
buffer_load_dwordx4 a[24:27], v2, s[8:11], s26 offen offset:2048 sc1
buffer_load_dwordx4 a[96:99], v2, s[8:11], s27 offen offset:2048 sc1
buffer_load_dwordx4 a[168:171], v3, s[8:11], s28 offen offset:2048 sc1
buffer_load_dwordx4 a[28:31], v2, s[8:11], s26 offen offset:3072 sc1
buffer_load_dwordx4 a[100:103], v2, s[8:11], s27 offen offset:3072 sc1
buffer_load_dwordx4 a[172:175], v3, s[8:11], s28 offen offset:3072 sc1
v_lshrrev_b32 v13, 4, v1
v_lshlrev_b32 v14, 2, v13
v_sub_u32 v14, v12, v14
v_subrev_u32 v15, 0, v14
v_cmp_gt_u32 s[52:53], 8, v15
v_cmp_gt_i32 s[44:45], -8, v15
v_subrev_u32 v15, 1, v14
v_cmp_gt_u32 s[54:55], 8, v15
v_cmp_gt_i32 s[46:47], -8, v15
v_subrev_u32 v15, 2, v14
v_cmp_gt_u32 s[56:57], 8, v15
v_cmp_gt_i32 s[48:49], -8, v15
v_subrev_u32 v15, 3, v14
v_cmp_gt_u32 s[58:59], 8, v15
v_cmp_gt_i32 s[50:51], -8, v15
s_and_b32 s31, s20, 7
s_or_b32 s31, s31, s4
s_cmp_eq_u32 s31, 0
s_cselect_b64 s[60:61], 0, s[44:45]
s_cselect_b64 s[62:63], 0, s[46:47]
s_cselect_b64 s[64:65], 0, s[48:49]
s_cselect_b64 s[66:67], 0, s[50:51]
ds_read_b128 a[216:219], v2 offset:0
ds_read_b128 a[220:223], v2 offset:7168
ds_read_b128 a[224:227], v2 offset:1024
ds_read_b128 a[228:231], v2 offset:8192
ds_read_b128 a[232:235], v2 offset:2048
ds_read_b128 a[236:239], v2 offset:9216
s_waitcnt vmcnt(18)
s_waitcnt lgkmcnt(4)
v_mfma_f32_16x16x32_bf16 v[32:35], a[216:219], a[0:3], 0
s_add_u32 s26, s26, 4096
s_add_u32 s27, s27, 4096
s_add_u32 s28, s28, 4096
buffer_load_dwordx4 a[32:35], v2, s[8:11], s26 offen offset:0 sc1
v_mfma_f32_16x16x32_bf16 v[32:35], a[220:223], a[4:7], v[32:35]
ds_read_b128 a[240:243], v2 offset:3072
v_lshlrev_b32 v14, 3, v1
v_mfma_f32_16x16x32_bf16 v[36:39], a[216:219], a[72:75], 0
s_mul_i32 s31, s4, 3072
s_add_u32 s41, s31, 147456
v_mfma_f32_16x16x32_bf16 v[36:39], a[220:223], a[76:79], v[36:39]
ds_read_b128 a[244:247], v2 offset:10240
s_waitcnt lgkmcnt(4)
v_mfma_f32_16x16x32_bf16 v[40:43], a[224:227], a[0:3], 0
buffer_load_dwordx4 a[104:107], v2, s[8:11], s27 offen offset:0 sc1
v_mfma_f32_16x16x32_bf16 v[40:43], a[228:231], a[4:7], v[40:43]
ds_read_b128 a[216:219], v2 offset:4096
v_add_u32 v15, s41, v14
v_mfma_f32_16x16x32_bf16 v[44:47], a[224:227], a[72:75], 0
s_lshl_b32 s42, s29, 9
s_add_u32 s42, s42, 147456
v_mfma_f32_16x16x32_bf16 v[44:47], a[228:231], a[76:79], v[44:47]
ds_read_b128 a[220:223], v2 offset:11264
s_waitcnt lgkmcnt(4)
v_mfma_f32_16x16x32_bf16 v[48:51], a[232:235], a[0:3], 0
buffer_load_dwordx4 a[176:179], v3, s[8:11], s28 offen offset:0 sc1
v_mfma_f32_16x16x32_bf16 v[48:51], a[236:239], a[4:7], v[48:51]
ds_read_b128 a[224:227], v2 offset:5120
v_add_u32 v16, s42, v14
v_mfma_f32_16x16x32_bf16 v[52:55], a[232:235], a[72:75], 0
s_and_b32 s42, s42, 512
s_add_u32 s42, s42, 147456
v_mfma_f32_16x16x32_bf16 v[52:55], a[236:239], a[76:79], v[52:55]
ds_read_b128 a[228:231], v2 offset:12288
s_waitcnt lgkmcnt(4)
v_mfma_f32_16x16x32_bf16 v[56:59], a[240:243], a[0:3], 0
buffer_load_dwordx4 a[36:39], v2, s[8:11], s26 offen offset:1024 sc1
v_mfma_f32_16x16x32_bf16 v[56:59], a[244:247], a[4:7], v[56:59]
ds_read_b128 a[232:235], v2 offset:6144
v_add_u32 v19, s42, v14
v_mfma_f32_16x16x32_bf16 v[60:63], a[240:243], a[72:75], 0
v_add_u32 v18, 150016, v14
v_mov_b32 v96, 0
v_mfma_f32_16x16x32_bf16 v[60:63], a[244:247], a[76:79], v[60:63]
ds_read_b128 a[236:239], v2 offset:13312
s_waitcnt lgkmcnt(4)
v_mfma_f32_16x16x32_bf16 v[64:67], a[216:219], a[0:3], 0
buffer_load_dwordx4 a[108:111], v2, s[8:11], s27 offen offset:1024 sc1
v_mfma_f32_16x16x32_bf16 v[64:67], a[220:223], a[4:7], v[64:67]
ds_read_b128 a[240:243], v6 offset:0
v_mov_b32 v97, 0
v_mfma_f32_16x16x32_bf16 v[68:71], a[216:219], a[72:75], 0
v_mov_b32 v100, 0
v_mov_b32 v101, 0
v_mfma_f32_16x16x32_bf16 v[68:71], a[220:223], a[76:79], v[68:71]
ds_read_b128 a[244:247], v6 offset:7168
s_waitcnt lgkmcnt(4)
v_mfma_f32_16x16x32_bf16 v[72:75], a[0:3], a[224:227], 0
buffer_load_dwordx4 a[180:183], v3, s[8:11], s28 offen offset:1024 sc1
v_mfma_f32_16x16x32_bf16 v[72:75], a[4:7], a[228:231], v[72:75]
ds_read_b128 a[216:219], v9 offset:0
v_and_b32 v13, 1, v1
v_mfma_f32_16x16x32_bf16 v[76:79], a[72:75], a[224:227], 0
v_lshlrev_b32 v13, 4, v13
v_mov_b32 v102, 0x3f80
v_mfma_f32_16x16x32_bf16 v[76:79], a[76:79], a[228:231], v[76:79]
ds_read_b128 a[220:223], v9 offset:7168
s_waitcnt lgkmcnt(4)
v_mfma_f32_16x16x32_bf16 v[80:83], a[0:3], a[232:235], 0
buffer_load_dwordx4 a[40:43], v2, s[8:11], s26 offen offset:2048 sc1
v_mfma_f32_16x16x32_bf16 v[80:83], a[4:7], a[236:239], v[80:83]
ds_read_b128 a[224:227], v2 offset:14336
v_lshlrev_b32 v13, v13, v102
v_mfma_f32_16x16x32_bf16 v[84:87], a[72:75], a[232:235], 0
v_lshrrev_b32 v102, 1, v1
L_hop13:
s_cmp_eq_u32 s15, 1
s_cbranch_scc1 L_hop_done
v_cmp_eq_u32 vcc, 16, v102
v_mfma_f32_16x16x32_bf16 v[84:87], a[76:79], a[236:239], v[84:87]
ds_read_b128 a[228:231], v2 offset:21504
s_waitcnt lgkmcnt(4)
v_mfma_f32_16x16x32_bf16 v[88:91], a[240:243], a[144:147], 0
ds_read_b128 a[232:235], v2 offset:15360
buffer_load_dwordx4 a[112:115], v2, s[8:11], s27 offen offset:2048 sc1
v_mfma_f32_16x16x32_bf16 v[88:91], a[244:247], a[148:151], v[88:91]
ds_read_b128 a[236:239], v2 offset:22528
s_waitcnt lgkmcnt(4)
v_mfma_f32_16x16x32_bf16 v[92:95], a[144:147], a[216:219], 0
ds_read_b128 a[240:243], v2 offset:16384
v_cndmask_b32 v98, 0, v13, vcc
v_mfma_f32_16x16x32_bf16 v[92:95], a[148:151], a[220:223], v[92:95]
ds_read_b128 a[244:247], v2 offset:23552
s_waitcnt vmcnt(20)
s_waitcnt lgkmcnt(4)
v_mfma_f32_16x16x32_bf16 v[32:35], a[224:227], a[8:11], v[32:35]
buffer_load_dwordx4 a[184:187], v3, s[8:11], s28 offen offset:2048 sc1
v_mfma_f32_16x16x32_bf16 v[32:35], a[228:231], a[12:15], v[32:35]
ds_read_b128 a[216:219], v2 offset:17408
v_cmp_eq_u32 vcc, 17, v102
v_mfma_f32_16x16x32_bf16 v[36:39], a[224:227], a[80:83], v[36:39]
s_nop 0
v_cndmask_b32 v99, 0, v13, vcc
v_add_u32 v17, 16, v12
v_mfma_f32_16x16x32_bf16 v[36:39], a[228:231], a[84:87], v[36:39]
ds_read_b128 a[220:223], v2 offset:24576
s_waitcnt lgkmcnt(4)
v_mfma_f32_16x16x32_bf16 v[40:43], a[232:235], a[8:11], v[40:43]
buffer_load_dwordx4 a[44:47], v2, s[8:11], s26 offen offset:3072 sc1
v_mfma_f32_16x16x32_bf16 v[40:43], a[236:239], a[12:15], v[40:43]
ds_read_b128 a[224:227], v2 offset:18432
v_cmp_gt_u32 vcc, 16, v1
v_mfma_f32_16x16x32_bf16 v[44:47], a[232:235], a[80:83], v[44:47]
v_add_u32 v14, 48, v12
s_mov_b32 s34, 0x3eae1a93
v_mfma_f32_16x16x32_bf16 v[44:47], a[236:239], a[84:87], v[44:47]
ds_read_b128 a[228:231], v2 offset:25600
s_waitcnt lgkmcnt(4)
v_mfma_f32_16x16x32_bf16 v[48:51], a[240:243], a[8:11], v[48:51]
buffer_load_dwordx4 a[116:119], v2, s[8:11], s27 offen offset:3072 sc1
v_mfma_f32_16x16x32_bf16 v[48:51], a[244:247], a[12:15], v[48:51]
ds_read_b128 a[232:235], v2 offset:19456
v_cndmask_b32 v17, v14, v17, vcc
v_mfma_f32_16x16x32_bf16 v[52:55], a[240:243], a[80:83], v[52:55]
v_lshlrev_b32 v17, 3, v17
v_add_u32 v17, s41, v17
v_mfma_f32_16x16x32_bf16 v[52:55], a[244:247], a[84:87], v[52:55]
ds_read_b128 a[236:239], v2 offset:26624
s_waitcnt lgkmcnt(4)
v_mfma_f32_16x16x32_bf16 v[56:59], a[216:219], a[8:11], v[56:59]
buffer_load_dwordx4 a[188:191], v3, s[8:11], s28 offen offset:3072 sc1
v_mfma_f32_16x16x32_bf16 v[56:59], a[220:223], a[12:15], v[56:59]
ds_read_b128 a[240:243], v2 offset:20480
v_mov_b32 v103, 0xff61b1e6
v_mfma_f32_16x16x32_bf16 v[60:63], a[216:219], a[80:83], v[60:63]
v_mov_b32 v102, 0xffff
v_cndmask_b32 v172, v103, 0, s[44:45]
v_mfma_f32_16x16x32_bf16 v[60:63], a[220:223], a[84:87], v[60:63]
ds_read_b128 a[244:247], v2 offset:27648
s_waitcnt lgkmcnt(4)
v_mfma_f32_16x16x32_bf16 v[64:67], a[224:227], a[8:11], v[64:67]
s_add_u32 s26, s26, 4096
s_add_u32 s27, s27, 4096
s_add_u32 s28, s28, 4096
buffer_load_dwordx4 a[48:51], v2, s[8:11], s26 offen offset:0 sc1
v_mfma_f32_16x16x32_bf16 v[64:67], a[228:231], a[12:15], v[64:67]
ds_read_b128 a[216:219], v6 offset:14336
v_cndmask_b32 v173, v103, 0, s[46:47]
v_mfma_f32_16x16x32_bf16 v[68:71], a[224:227], a[80:83], v[68:71]
v_cndmask_b32 v174, v103, 0, s[48:49]
v_cndmask_b32 v175, v103, 0, s[50:51]
v_mfma_f32_16x16x32_bf16 v[68:71], a[228:231], a[84:87], v[68:71]
ds_read_b128 a[220:223], v6 offset:21504
s_waitcnt lgkmcnt(4)
v_mfma_f32_16x16x32_bf16 v[72:75], a[8:11], a[232:235], v[72:75]
buffer_load_dwordx4 a[120:123], v2, s[8:11], s27 offen offset:0 sc1
v_mfma_f32_16x16x32_bf16 v[72:75], a[12:15], a[236:239], v[72:75]
ds_read_b128 a[224:227], v9 offset:14336
v_cndmask_b32 v184, 0, v102, s[44:45]
v_mfma_f32_16x16x32_bf16 v[76:79], a[80:83], a[232:235], v[76:79]
v_cndmask_b32 v13, 0, v102, s[46:47]
v_lshl_or_b32 v184, v13, 16, v184
v_mfma_f32_16x16x32_bf16 v[76:79], a[84:87], a[236:239], v[76:79]
ds_read_b128 a[228:231], v9 offset:21504
s_waitcnt lgkmcnt(4)
v_mfma_f32_16x16x32_bf16 v[80:83], a[8:11], a[240:243], v[80:83]
buffer_load_dwordx4 a[192:195], v3, s[8:11], s28 offen offset:0 sc1
v_mfma_f32_16x16x32_bf16 v[80:83], a[12:15], a[244:247], v[80:83]
ds_read_b128 a[232:235], v2 offset:28672
v_cndmask_b32 v185, 0, v102, s[48:49]
v_mfma_f32_16x16x32_bf16 v[84:87], a[80:83], a[240:243], v[84:87]
v_cndmask_b32 v13, 0, v102, s[50:51]
v_lshl_or_b32 v185, v13, 16, v185
v_mfma_f32_16x16x32_bf16 v[84:87], a[84:87], a[244:247], v[84:87]
ds_read_b128 a[236:239], v2 offset:35840
s_waitcnt lgkmcnt(4)
v_mfma_f32_16x16x32_bf16 v[88:91], a[216:219], a[152:155], v[88:91]
ds_read_b128 a[240:243], v2 offset:29696
buffer_load_dwordx4 a[52:55], v2, s[8:11], s26 offen offset:1024 sc1
v_mfma_f32_16x16x32_bf16 v[88:91], a[220:223], a[156:159], v[88:91]
ds_read_b128 a[244:247], v2 offset:36864
s_waitcnt lgkmcnt(4)
v_mfma_f32_16x16x32_bf16 v[92:95], a[152:155], a[224:227], v[92:95]
ds_read_b128 a[216:219], v2 offset:30720
v_cndmask_b32 v176, v103, 0, s[52:53]
v_mfma_f32_16x16x32_bf16 v[92:95], a[156:159], a[228:231], v[92:95]
ds_read_b128 a[220:223], v2 offset:37888
s_waitcnt vmcnt(22)
s_waitcnt lgkmcnt(4)
v_mfma_f32_16x16x32_bf16 v[32:35], a[232:235], a[16:19], v[32:35]
buffer_load_dwordx4 a[124:127], v2, s[8:11], s27 offen offset:1024 sc1
v_mfma_f32_16x16x32_bf16 v[32:35], a[236:239], a[20:23], v[32:35]
ds_read_b128 a[224:227], v2 offset:31744
v_cndmask_b32 v177, v103, 0, s[54:55]
v_mfma_f32_16x16x32_bf16 v[36:39], a[232:235], a[88:91], v[36:39]
v_cndmask_b32 v178, v103, 0, s[56:57]
v_cndmask_b32 v179, v103, 0, s[58:59]
v_mfma_f32_16x16x32_bf16 v[36:39], a[236:239], a[92:95], v[36:39]
ds_read_b128 a[228:231], v2 offset:38912
s_waitcnt lgkmcnt(4)
v_mfma_f32_16x16x32_bf16 v[40:43], a[240:243], a[16:19], v[40:43]
buffer_load_dwordx4 a[196:199], v3, s[8:11], s28 offen offset:1024 sc1
v_mfma_f32_16x16x32_bf16 v[40:43], a[244:247], a[20:23], v[40:43]
ds_read_b128 a[232:235], v2 offset:32768
v_cndmask_b32 v186, 0, v102, s[52:53]
v_mfma_f32_16x16x32_bf16 v[44:47], a[240:243], a[88:91], v[44:47]
v_cndmask_b32 v13, 0, v102, s[54:55]
v_lshl_or_b32 v186, v13, 16, v186
v_mfma_f32_16x16x32_bf16 v[44:47], a[244:247], a[92:95], v[44:47]
ds_read_b128 a[236:239], v2 offset:39936
s_waitcnt lgkmcnt(4)
v_mfma_f32_16x16x32_bf16 v[48:51], a[216:219], a[16:19], v[48:51]
buffer_load_dwordx4 a[56:59], v2, s[8:11], s26 offen offset:2048 sc1
v_mfma_f32_16x16x32_bf16 v[48:51], a[220:223], a[20:23], v[48:51]
ds_read_b128 a[240:243], v2 offset:33792
v_cndmask_b32 v187, 0, v102, s[56:57]
v_mfma_f32_16x16x32_bf16 v[52:55], a[216:219], a[88:91], v[52:55]
v_cndmask_b32 v13, 0, v102, s[58:59]
v_lshl_or_b32 v187, v13, 16, v187
v_mfma_f32_16x16x32_bf16 v[52:55], a[220:223], a[92:95], v[52:55]
ds_read_b128 a[244:247], v2 offset:40960
s_waitcnt lgkmcnt(4)
v_mfma_f32_16x16x32_bf16 v[56:59], a[224:227], a[16:19], v[56:59]
buffer_load_dwordx4 a[128:131], v2, s[8:11], s27 offen offset:2048 sc1
v_mfma_f32_16x16x32_bf16 v[56:59], a[228:231], a[20:23], v[56:59]
ds_read_b128 a[216:219], v2 offset:34816
v_cndmask_b32 v180, v103, 0, s[60:61]
v_mfma_f32_16x16x32_bf16 v[60:63], a[224:227], a[88:91], v[60:63]
v_cndmask_b32 v181, v103, 0, s[62:63]
v_cndmask_b32 v182, v103, 0, s[64:65]
v_mfma_f32_16x16x32_bf16 v[60:63], a[228:231], a[92:95], v[60:63]
ds_read_b128 a[220:223], v2 offset:41984
s_waitcnt lgkmcnt(4)
v_mfma_f32_16x16x32_bf16 v[64:67], a[232:235], a[16:19], v[64:67]
buffer_load_dwordx4 a[200:203], v3, s[8:11], s28 offen offset:2048 sc1
v_mfma_f32_16x16x32_bf16 v[64:67], a[236:239], a[20:23], v[64:67]
ds_read_b128 a[224:227], v6 offset:28672
v_cndmask_b32 v183, v103, 0, s[66:67]
v_mfma_f32_16x16x32_bf16 v[68:71], a[232:235], a[88:91], v[68:71]
v_cndmask_b32 v188, 0, v102, s[60:61]
v_cndmask_b32 v13, 0, v102, s[62:63]
v_mfma_f32_16x16x32_bf16 v[68:71], a[236:239], a[92:95], v[68:71]
ds_read_b128 a[228:231], v6 offset:35840
s_waitcnt lgkmcnt(4)
v_mfma_f32_16x16x32_bf16 v[72:75], a[16:19], a[240:243], v[72:75]
buffer_load_dwordx4 a[60:63], v2, s[8:11], s26 offen offset:3072 sc1
v_mfma_f32_16x16x32_bf16 v[72:75], a[20:23], a[244:247], v[72:75]
ds_read_b128 a[232:235], v9 offset:28672
v_lshl_or_b32 v188, v13, 16, v188
v_mfma_f32_16x16x32_bf16 v[76:79], a[88:91], a[240:243], v[76:79]
v_cndmask_b32 v189, 0, v102, s[64:65]
v_cndmask_b32 v13, 0, v102, s[66:67]
v_mfma_f32_16x16x32_bf16 v[76:79], a[92:95], a[244:247], v[76:79]
ds_read_b128 a[236:239], v9 offset:35840
s_waitcnt lgkmcnt(4)
v_mfma_f32_16x16x32_bf16 v[80:83], a[16:19], a[216:219], v[80:83]
buffer_load_dwordx4 a[132:135], v2, s[8:11], s27 offen offset:3072 sc1
v_mfma_f32_16x16x32_bf16 v[80:83], a[20:23], a[220:223], v[80:83]
ds_read_b128 a[240:243], v2 offset:43008
v_lshl_or_b32 v189, v13, 16, v189
v_mfma_f32_16x16x32_bf16 v[84:87], a[88:91], a[216:219], v[84:87]
v_mfma_f32_16x16x32_bf16 v[84:87], a[92:95], a[220:223], v[84:87]
ds_read_b128 a[244:247], v2 offset:50176
s_waitcnt lgkmcnt(4)
v_mfma_f32_16x16x32_bf16 v[88:91], a[224:227], a[160:163], v[88:91]
ds_read_b128 a[216:219], v2 offset:44032
buffer_load_dwordx4 a[204:207], v3, s[8:11], s28 offen offset:3072 sc1
v_mfma_f32_16x16x32_bf16 v[88:91], a[228:231], a[164:167], v[88:91]
ds_read_b128 a[220:223], v2 offset:51200
s_waitcnt lgkmcnt(4)
v_mfma_f32_16x16x32_bf16 v[92:95], a[160:163], a[232:235], v[92:95]
ds_read_b128 a[224:227], v2 offset:45056
v_mfma_f32_16x16x32_bf16 v[92:95], a[164:167], a[236:239], v[92:95]
ds_read_b128 a[228:231], v2 offset:52224
s_waitcnt vmcnt(24)
s_waitcnt lgkmcnt(4)
v_mfma_f32_16x16x32_bf16 v[32:35], a[240:243], a[24:27], v[32:35]
s_add_u32 s26, s26, 4096
s_add_u32 s27, s27, 4096
s_add_u32 s28, s28, 4096
buffer_load_dwordx4 a[64:67], v2, s[8:11], s26 offen offset:0 sc1
v_mfma_f32_16x16x32_bf16 v[32:35], a[244:247], a[28:31], v[32:35]
ds_read_b128 a[232:235], v2 offset:46080
v_mfma_f32_16x16x32_bf16 v[36:39], a[240:243], a[96:99], v[36:39]
v_mfma_f32_16x16x32_bf16 v[36:39], a[244:247], a[100:103], v[36:39]
ds_read_b128 a[236:239], v2 offset:53248
s_waitcnt lgkmcnt(4)
v_mfma_f32_16x16x32_bf16 v[40:43], a[216:219], a[24:27], v[40:43]
buffer_load_dwordx4 a[136:139], v2, s[8:11], s27 offen offset:0 sc1
v_mfma_f32_16x16x32_bf16 v[40:43], a[220:223], a[28:31], v[40:43]
ds_read_b128 a[240:243], v2 offset:47104
v_mfma_f32_16x16x32_bf16 v[44:47], a[216:219], a[96:99], v[44:47]
v_mfma_f32_16x16x32_bf16 v[44:47], a[220:223], a[100:103], v[44:47]
ds_read_b128 a[244:247], v2 offset:54272
s_waitcnt lgkmcnt(4)
v_mfma_f32_16x16x32_bf16 v[48:51], a[224:227], a[24:27], v[48:51]
buffer_load_dwordx4 a[208:211], v3, s[8:11], s28 offen offset:0 sc1
v_mfma_f32_16x16x32_bf16 v[48:51], a[228:231], a[28:31], v[48:51]
ds_read_b128 a[216:219], v2 offset:48128
v_mfma_f32_16x16x32_bf16 v[52:55], a[224:227], a[96:99], v[52:55]
v_mfma_f32_16x16x32_bf16 v[52:55], a[228:231], a[100:103], v[52:55]
ds_read_b128 a[220:223], v2 offset:55296
s_waitcnt lgkmcnt(4)
v_mfma_f32_16x16x32_bf16 v[56:59], a[232:235], a[24:27], v[56:59]
buffer_load_dwordx4 a[68:71], v2, s[8:11], s26 offen offset:1024 sc1
v_mfma_f32_16x16x32_bf16 v[56:59], a[236:239], a[28:31], v[56:59]
ds_read_b128 a[224:227], v2 offset:49152
v_mfma_f32_16x16x32_bf16 v[60:63], a[232:235], a[96:99], v[60:63]
v_mfma_f32_16x16x32_bf16 v[60:63], a[236:239], a[100:103], v[60:63]
ds_read_b128 a[228:231], v2 offset:56320
s_waitcnt lgkmcnt(4)
v_mfma_f32_16x16x32_bf16 v[64:67], a[240:243], a[24:27], v[64:67]
buffer_load_dwordx4 a[140:143], v2, s[8:11], s27 offen offset:1024 sc1
v_mfma_f32_16x16x32_bf16 v[64:67], a[244:247], a[28:31], v[64:67]
ds_read_b128 a[232:235], v6 offset:43008
v_mfma_f32_16x16x32_bf16 v[68:71], a[240:243], a[96:99], v[68:71]
v_mfma_f32_16x16x32_bf16 v[68:71], a[244:247], a[100:103], v[68:71]
ds_read_b128 a[236:239], v6 offset:50176
s_waitcnt lgkmcnt(4)
v_mfma_f32_16x16x32_bf16 v[72:75], a[24:27], a[216:219], v[72:75]
buffer_load_dwordx4 a[212:215], v3, s[8:11], s28 offen offset:1024 sc1
v_mfma_f32_16x16x32_bf16 v[72:75], a[28:31], a[220:223], v[72:75]
ds_read_b128 a[240:243], v9 offset:43008
v_mfma_f32_16x16x32_bf16 v[76:79], a[96:99], a[216:219], v[76:79]
v_mfma_f32_16x16x32_bf16 v[76:79], a[100:103], a[220:223], v[76:79]
ds_read_b128 a[244:247], v9 offset:50176
s_waitcnt lgkmcnt(4)
v_mfma_f32_16x16x32_bf16 v[80:83], a[24:27], a[224:227], v[80:83]
v_mfma_f32_16x16x32_bf16 v[80:83], a[28:31], a[228:231], v[80:83]
ds_read_b128 a[216:219], v2 offset:57344
v_mfma_f32_16x16x32_bf16 v[84:87], a[96:99], a[224:227], v[84:87]
v_mfma_f32_16x16x32_bf16 v[84:87], a[100:103], a[228:231], v[84:87]
ds_read_b128 a[220:223], v2 offset:64512
s_waitcnt lgkmcnt(4)
v_mfma_f32_16x16x32_bf16 v[88:91], a[232:235], a[168:171], v[88:91]
ds_read_b128 a[224:227], v2 offset:58368
v_mfma_f32_16x16x32_bf16 v[88:91], a[236:239], a[172:175], v[88:91]
ds_read_b128 a[228:231], v4 offset:0
s_waitcnt lgkmcnt(4)
v_mfma_f32_16x16x32_bf16 v[92:95], a[168:171], a[240:243], v[92:95]
ds_read_b128 a[232:235], v2 offset:59392
v_mfma_f32_16x16x32_bf16 v[92:95], a[172:175], a[244:247], v[92:95]
ds_read_b128 a[236:239], v4 offset:1024
s_waitcnt vmcnt(24)
s_waitcnt lgkmcnt(4)
v_mfma_f32_16x16x32_bf16 v[32:35], a[216:219], a[32:35], v[32:35]
v_mfma_f32_16x16x32_bf16 v[32:35], a[220:223], a[36:39], v[32:35]
ds_read_b128 a[240:243], v2 offset:60416
v_mfma_f32_16x16x32_bf16 v[36:39], a[216:219], a[104:107], v[36:39]
v_mfma_f32_16x16x32_bf16 v[36:39], a[220:223], a[108:111], v[36:39]
ds_read_b128 a[244:247], v4 offset:2048
s_waitcnt lgkmcnt(4)
v_mfma_f32_16x16x32_bf16 v[40:43], a[224:227], a[32:35], v[40:43]
v_mfma_f32_16x16x32_bf16 v[40:43], a[228:231], a[36:39], v[40:43]
ds_read_b128 a[216:219], v2 offset:61440
v_mfma_f32_16x16x32_bf16 v[44:47], a[224:227], a[104:107], v[44:47]
v_mfma_f32_16x16x32_bf16 v[44:47], a[228:231], a[108:111], v[44:47]
ds_read_b128 a[220:223], v4 offset:3072
s_waitcnt lgkmcnt(4)
v_mfma_f32_16x16x32_bf16 v[48:51], a[232:235], a[32:35], v[48:51]
v_mfma_f32_16x16x32_bf16 v[48:51], a[236:239], a[36:39], v[48:51]
ds_read_b128 a[224:227], v2 offset:62464
v_mfma_f32_16x16x32_bf16 v[52:55], a[232:235], a[104:107], v[52:55]
v_mfma_f32_16x16x32_bf16 v[52:55], a[236:239], a[108:111], v[52:55]
ds_read_b128 a[228:231], v4 offset:4096
s_waitcnt lgkmcnt(4)
v_mfma_f32_16x16x32_bf16 v[56:59], a[240:243], a[32:35], v[56:59]
v_mfma_f32_16x16x32_bf16 v[56:59], a[244:247], a[36:39], v[56:59]
ds_read_b128 a[232:235], v2 offset:63488
v_mfma_f32_16x16x32_bf16 v[60:63], a[240:243], a[104:107], v[60:63]
v_mfma_f32_16x16x32_bf16 v[60:63], a[244:247], a[108:111], v[60:63]
ds_read_b128 a[236:239], v4 offset:5120
s_waitcnt lgkmcnt(4)
v_mfma_f32_16x16x32_bf16 v[64:67], a[216:219], a[32:35], v[64:67]
v_mfma_f32_16x16x32_bf16 v[64:67], a[220:223], a[36:39], v[64:67]
ds_read_b128 a[240:243], v6 offset:57344
v_mfma_f32_16x16x32_bf16 v[68:71], a[216:219], a[104:107], v[68:71]
v_mfma_f32_16x16x32_bf16 v[68:71], a[220:223], a[108:111], v[68:71]
ds_read_b128 a[244:247], v6 offset:64512
s_waitcnt lgkmcnt(4)
v_mfma_f32_16x16x32_bf16 v[72:75], a[32:35], a[224:227], v[72:75]
v_mfma_f32_16x16x32_bf16 v[72:75], a[36:39], a[228:231], v[72:75]
ds_read_b128 a[216:219], v9 offset:57344
v_mfma_f32_16x16x32_bf16 v[76:79], a[104:107], a[224:227], v[76:79]
v_mfma_f32_16x16x32_bf16 v[76:79], a[108:111], a[228:231], v[76:79]
ds_read_b128 a[220:223], v9 offset:64512
s_waitcnt lgkmcnt(4)
v_mfma_f32_16x16x32_bf16 v[80:83], a[32:35], a[232:235], v[80:83]
v_mfma_f32_16x16x32_bf16 v[80:83], a[36:39], a[236:239], v[80:83]
ds_read_b128 a[224:227], v4 offset:6144
v_mfma_f32_16x16x32_bf16 v[84:87], a[104:107], a[232:235], v[84:87]
v_mfma_f32_16x16x32_bf16 v[84:87], a[108:111], a[236:239], v[84:87]
ds_read_b128 a[228:231], v4 offset:13312
s_waitcnt lgkmcnt(4)
v_mfma_f32_16x16x32_bf16 v[88:91], a[240:243], a[176:179], v[88:91]
ds_read_b128 a[232:235], v4 offset:7168
v_mfma_f32_16x16x32_bf16 v[88:91], a[244:247], a[180:183], v[88:91]
ds_read_b128 a[236:239], v4 offset:14336
s_waitcnt lgkmcnt(4)
v_mfma_f32_16x16x32_bf16 v[92:95], a[176:179], a[216:219], v[92:95]
ds_read_b128 a[240:243], v4 offset:8192
v_mfma_f32_16x16x32_bf16 v[92:95], a[180:183], a[220:223], v[92:95]
ds_read_b128 a[244:247], v4 offset:15360
s_waitcnt vmcnt(18)
s_waitcnt lgkmcnt(4)
v_mfma_f32_16x16x32_bf16 v[32:35], a[224:227], a[40:43], v[32:35]
v_mfma_f32_16x16x32_bf16 v[32:35], a[228:231], a[44:47], v[32:35]
ds_read_b128 a[216:219], v4 offset:9216
v_mfma_f32_16x16x32_bf16 v[36:39], a[224:227], a[112:115], v[36:39]
v_mfma_f32_16x16x32_bf16 v[36:39], a[228:231], a[116:119], v[36:39]
ds_read_b128 a[220:223], v4 offset:16384
s_waitcnt lgkmcnt(4)
v_mfma_f32_16x16x32_bf16 v[40:43], a[232:235], a[40:43], v[40:43]
v_mfma_f32_16x16x32_bf16 v[40:43], a[236:239], a[44:47], v[40:43]
ds_read_b128 a[224:227], v4 offset:10240
v_mfma_f32_16x16x32_bf16 v[44:47], a[232:235], a[112:115], v[44:47]
v_mfma_f32_16x16x32_bf16 v[44:47], a[236:239], a[116:119], v[44:47]
ds_read_b128 a[228:231], v4 offset:17408
s_waitcnt lgkmcnt(4)
v_mfma_f32_16x16x32_bf16 v[48:51], a[240:243], a[40:43], v[48:51]
v_mfma_f32_16x16x32_bf16 v[48:51], a[244:247], a[44:47], v[48:51]
ds_read_b128 a[232:235], v4 offset:11264
v_mfma_f32_16x16x32_bf16 v[52:55], a[240:243], a[112:115], v[52:55]
v_mfma_f32_16x16x32_bf16 v[52:55], a[244:247], a[116:119], v[52:55]
ds_read_b128 a[236:239], v4 offset:18432
s_waitcnt lgkmcnt(4)
v_mfma_f32_16x16x32_bf16 v[56:59], a[216:219], a[40:43], v[56:59]
v_mfma_f32_16x16x32_bf16 v[56:59], a[220:223], a[44:47], v[56:59]
ds_read_b128 a[240:243], v4 offset:12288
v_mfma_f32_16x16x32_bf16 v[60:63], a[216:219], a[112:115], v[60:63]
v_mfma_f32_16x16x32_bf16 v[60:63], a[220:223], a[116:119], v[60:63]
ds_read_b128 a[244:247], v4 offset:19456
s_waitcnt lgkmcnt(4)
v_mfma_f32_16x16x32_bf16 v[64:67], a[224:227], a[40:43], v[64:67]
v_mfma_f32_16x16x32_bf16 v[64:67], a[228:231], a[44:47], v[64:67]
ds_read_b128 a[216:219], v7 offset:6144
v_mfma_f32_16x16x32_bf16 v[68:71], a[224:227], a[112:115], v[68:71]
v_mfma_f32_16x16x32_bf16 v[68:71], a[228:231], a[116:119], v[68:71]
ds_read_b128 a[220:223], v7 offset:13312
s_waitcnt lgkmcnt(4)
v_mfma_f32_16x16x32_bf16 v[72:75], a[40:43], a[232:235], v[72:75]
v_mfma_f32_16x16x32_bf16 v[72:75], a[44:47], a[236:239], v[72:75]
ds_read_b128 a[224:227], v10 offset:6144
v_mfma_f32_16x16x32_bf16 v[76:79], a[112:115], a[232:235], v[76:79]
v_mfma_f32_16x16x32_bf16 v[76:79], a[116:119], a[236:239], v[76:79]
ds_read_b128 a[228:231], v10 offset:13312
s_waitcnt lgkmcnt(4)
v_mfma_f32_16x16x32_bf16 v[80:83], a[40:43], a[240:243], v[80:83]
v_mfma_f32_16x16x32_bf16 v[80:83], a[44:47], a[244:247], v[80:83]
ds_read_b128 a[232:235], v4 offset:20480
v_mfma_f32_16x16x32_bf16 v[84:87], a[112:115], a[240:243], v[84:87]
v_mfma_f32_16x16x32_bf16 v[84:87], a[116:119], a[244:247], v[84:87]
ds_read_b128 a[236:239], v4 offset:27648
s_waitcnt lgkmcnt(4)
v_mfma_f32_16x16x32_bf16 v[88:91], a[216:219], a[184:187], v[88:91]
ds_read_b128 a[240:243], v4 offset:21504
v_mfma_f32_16x16x32_bf16 v[88:91], a[220:223], a[188:191], v[88:91]
ds_read_b128 a[244:247], v4 offset:28672
s_waitcnt lgkmcnt(4)
v_mfma_f32_16x16x32_bf16 v[92:95], a[184:187], a[224:227], v[92:95]
ds_read_b128 a[216:219], v4 offset:22528
v_mfma_f32_16x16x32_bf16 v[92:95], a[188:191], a[228:231], v[92:95]
ds_read_b128 a[220:223], v4 offset:29696
s_waitcnt vmcnt(12)
s_waitcnt lgkmcnt(4)
v_mfma_f32_16x16x32_bf16 v[32:35], a[232:235], a[48:51], v[32:35]
v_mfma_f32_16x16x32_bf16 v[32:35], a[236:239], a[52:55], v[32:35]
ds_read_b128 a[224:227], v4 offset:23552
v_mfma_f32_16x16x32_bf16 v[36:39], a[232:235], a[120:123], v[36:39]
v_mfma_f32_16x16x32_bf16 v[36:39], a[236:239], a[124:127], v[36:39]
ds_read_b128 a[228:231], v4 offset:30720
s_waitcnt lgkmcnt(4)
v_mfma_f32_16x16x32_bf16 v[40:43], a[240:243], a[48:51], v[40:43]
v_mfma_f32_16x16x32_bf16 v[40:43], a[244:247], a[52:55], v[40:43]
ds_read_b128 a[232:235], v4 offset:24576
v_mfma_f32_16x16x32_bf16 v[44:47], a[240:243], a[120:123], v[44:47]
v_mfma_f32_16x16x32_bf16 v[44:47], a[244:247], a[124:127], v[44:47]
ds_read_b128 a[236:239], v4 offset:31744
s_waitcnt lgkmcnt(4)
v_mfma_f32_16x16x32_bf16 v[48:51], a[216:219], a[48:51], v[48:51]
v_mfma_f32_16x16x32_bf16 v[48:51], a[220:223], a[52:55], v[48:51]
ds_read_b128 a[240:243], v4 offset:25600
v_mfma_f32_16x16x32_bf16 v[52:55], a[216:219], a[120:123], v[52:55]
v_mfma_f32_16x16x32_bf16 v[52:55], a[220:223], a[124:127], v[52:55]
ds_read_b128 a[244:247], v4 offset:32768
s_waitcnt lgkmcnt(4)
v_mfma_f32_16x16x32_bf16 v[56:59], a[224:227], a[48:51], v[56:59]
v_mfma_f32_16x16x32_bf16 v[56:59], a[228:231], a[52:55], v[56:59]
ds_read_b128 a[216:219], v4 offset:26624
v_mfma_f32_16x16x32_bf16 v[60:63], a[224:227], a[120:123], v[60:63]
v_mfma_f32_16x16x32_bf16 v[60:63], a[228:231], a[124:127], v[60:63]
ds_read_b128 a[220:223], v4 offset:33792
s_waitcnt lgkmcnt(4)
v_mfma_f32_16x16x32_bf16 v[64:67], a[232:235], a[48:51], v[64:67]
v_mfma_f32_16x16x32_bf16 v[64:67], a[236:239], a[52:55], v[64:67]
ds_read_b128 a[224:227], v7 offset:20480
v_mfma_f32_16x16x32_bf16 v[68:71], a[232:235], a[120:123], v[68:71]
v_mfma_f32_16x16x32_bf16 v[68:71], a[236:239], a[124:127], v[68:71]
ds_read_b128 a[228:231], v7 offset:27648
s_waitcnt lgkmcnt(4)
v_mfma_f32_16x16x32_bf16 v[72:75], a[48:51], a[240:243], v[72:75]
v_mfma_f32_16x16x32_bf16 v[72:75], a[52:55], a[244:247], v[72:75]
ds_read_b128 a[232:235], v10 offset:20480
v_mfma_f32_16x16x32_bf16 v[76:79], a[120:123], a[240:243], v[76:79]
v_mfma_f32_16x16x32_bf16 v[76:79], a[124:127], a[244:247], v[76:79]
ds_read_b128 a[236:239], v10 offset:27648
s_waitcnt lgkmcnt(4)
v_mfma_f32_16x16x32_bf16 v[80:83], a[48:51], a[216:219], v[80:83]
v_mfma_f32_16x16x32_bf16 v[80:83], a[52:55], a[220:223], v[80:83]
ds_read_b128 a[240:243], v4 offset:34816
v_mfma_f32_16x16x32_bf16 v[84:87], a[120:123], a[216:219], v[84:87]
v_mfma_f32_16x16x32_bf16 v[84:87], a[124:127], a[220:223], v[84:87]
ds_read_b128 a[244:247], v4 offset:41984
s_waitcnt lgkmcnt(4)
v_mfma_f32_16x16x32_bf16 v[88:91], a[224:227], a[192:195], v[88:91]
ds_read_b128 a[216:219], v4 offset:35840
v_mfma_f32_16x16x32_bf16 v[88:91], a[228:231], a[196:199], v[88:91]
ds_read_b128 a[220:223], v4 offset:43008
s_waitcnt lgkmcnt(4)
v_mfma_f32_16x16x32_bf16 v[92:95], a[192:195], a[232:235], v[92:95]
ds_read_b128 a[224:227], v4 offset:36864
v_mfma_f32_16x16x32_bf16 v[92:95], a[196:199], a[236:239], v[92:95]
ds_read_b128 a[228:231], v4 offset:44032
s_waitcnt vmcnt(6)
s_waitcnt lgkmcnt(4)
v_mfma_f32_16x16x32_bf16 v[32:35], a[240:243], a[56:59], v[32:35]
v_mfma_f32_16x16x32_bf16 v[32:35], a[244:247], a[60:63], v[32:35]
ds_read_b128 a[232:235], v4 offset:37888
v_mfma_f32_16x16x32_bf16 v[36:39], a[240:243], a[128:131], v[36:39]
v_mfma_f32_16x16x32_bf16 v[36:39], a[244:247], a[132:135], v[36:39]
ds_read_b128 a[236:239], v4 offset:45056
s_waitcnt lgkmcnt(4)
v_mfma_f32_16x16x32_bf16 v[40:43], a[216:219], a[56:59], v[40:43]
v_mfma_f32_16x16x32_bf16 v[40:43], a[220:223], a[60:63], v[40:43]
ds_read_b128 a[240:243], v4 offset:38912
v_mfma_f32_16x16x32_bf16 v[44:47], a[216:219], a[128:131], v[44:47]
v_mfma_f32_16x16x32_bf16 v[44:47], a[220:223], a[132:135], v[44:47]
ds_read_b128 a[244:247], v4 offset:46080
s_waitcnt lgkmcnt(4)
v_mfma_f32_16x16x32_bf16 v[48:51], a[224:227], a[56:59], v[48:51]
v_mfma_f32_16x16x32_bf16 v[48:51], a[228:231], a[60:63], v[48:51]
ds_read_b128 a[216:219], v4 offset:39936
v_mfma_f32_16x16x32_bf16 v[52:55], a[224:227], a[128:131], v[52:55]
v_mfma_f32_16x16x32_bf16 v[52:55], a[228:231], a[132:135], v[52:55]
ds_read_b128 a[220:223], v4 offset:47104
s_waitcnt lgkmcnt(4)
v_mfma_f32_16x16x32_bf16 v[56:59], a[232:235], a[56:59], v[56:59]
v_mfma_f32_16x16x32_bf16 v[56:59], a[236:239], a[60:63], v[56:59]
ds_read_b128 a[224:227], v4 offset:40960
v_mfma_f32_16x16x32_bf16 v[60:63], a[232:235], a[128:131], v[60:63]
v_mfma_f32_16x16x32_bf16 v[60:63], a[236:239], a[132:135], v[60:63]
ds_read_b128 a[228:231], v4 offset:48128
s_waitcnt lgkmcnt(4)
v_mfma_f32_16x16x32_bf16 v[64:67], a[240:243], a[56:59], v[64:67]
v_mfma_f32_16x16x32_bf16 v[64:67], a[244:247], a[60:63], v[64:67]
ds_read_b128 a[232:235], v7 offset:34816
v_mfma_f32_16x16x32_bf16 v[68:71], a[240:243], a[128:131], v[68:71]
v_mfma_f32_16x16x32_bf16 v[68:71], a[244:247], a[132:135], v[68:71]
ds_read_b128 a[236:239], v7 offset:41984
s_waitcnt lgkmcnt(4)
v_mfma_f32_16x16x32_bf16 v[72:75], a[56:59], a[216:219], v[72:75]
v_mfma_f32_16x16x32_bf16 v[72:75], a[60:63], a[220:223], v[72:75]
ds_read_b128 a[240:243], v10 offset:34816
v_mfma_f32_16x16x32_bf16 v[76:79], a[128:131], a[216:219], v[76:79]
v_mfma_f32_16x16x32_bf16 v[76:79], a[132:135], a[220:223], v[76:79]
ds_read_b128 a[244:247], v10 offset:41984
s_waitcnt lgkmcnt(4)
v_mfma_f32_16x16x32_bf16 v[80:83], a[56:59], a[224:227], v[80:83]
v_mfma_f32_16x16x32_bf16 v[80:83], a[60:63], a[228:231], v[80:83]
ds_read_b128 a[216:219], v4 offset:49152
v_mfma_f32_16x16x32_bf16 v[84:87], a[128:131], a[224:227], v[84:87]
v_mfma_f32_16x16x32_bf16 v[84:87], a[132:135], a[228:231], v[84:87]
ds_read_b128 a[220:223], v4 offset:56320
s_waitcnt lgkmcnt(4)
v_mfma_f32_16x16x32_bf16 v[88:91], a[232:235], a[200:203], v[88:91]
ds_read_b128 a[224:227], v4 offset:50176
v_mfma_f32_16x16x32_bf16 v[88:91], a[236:239], a[204:207], v[88:91]
ds_read_b128 a[228:231], v4 offset:57344
s_waitcnt lgkmcnt(4)
v_mfma_f32_16x16x32_bf16 v[92:95], a[200:203], a[240:243], v[92:95]
ds_read_b128 a[232:235], v4 offset:51200
v_mfma_f32_16x16x32_bf16 v[92:95], a[204:207], a[244:247], v[92:95]
ds_read_b128 a[236:239], v4 offset:58368
s_waitcnt vmcnt(0)
s_waitcnt lgkmcnt(4)
v_mfma_f32_16x16x32_bf16 v[32:35], a[216:219], a[64:67], v[32:35]
v_mfma_f32_16x16x32_bf16 v[32:35], a[220:223], a[68:71], v[32:35]
ds_read_b128 a[240:243], v4 offset:52224
v_mfma_f32_16x16x32_bf16 v[36:39], a[216:219], a[136:139], v[36:39]
v_mfma_f32_16x16x32_bf16 v[36:39], a[220:223], a[140:143], v[36:39]
ds_read_b128 a[244:247], v4 offset:59392
s_waitcnt lgkmcnt(4)
v_mfma_f32_16x16x32_bf16 v[40:43], a[224:227], a[64:67], v[40:43]
v_mfma_f32_16x16x32_bf16 v[40:43], a[228:231], a[68:71], v[40:43]
ds_read_b128 a[216:219], v4 offset:53248
v_mfma_f32_16x16x32_bf16 v[44:47], a[224:227], a[136:139], v[44:47]
v_mfma_f32_16x16x32_bf16 v[44:47], a[228:231], a[140:143], v[44:47]
ds_read_b128 a[220:223], v4 offset:60416
s_waitcnt lgkmcnt(4)
v_mfma_f32_16x16x32_bf16 v[48:51], a[232:235], a[64:67], v[48:51]
v_mfma_f32_16x16x32_bf16 v[48:51], a[236:239], a[68:71], v[48:51]
ds_read_b128 a[224:227], v4 offset:54272
v_mfma_f32_16x16x32_bf16 v[52:55], a[232:235], a[136:139], v[52:55]
v_mfma_f32_16x16x32_bf16 v[52:55], a[236:239], a[140:143], v[52:55]
ds_read_b128 a[228:231], v4 offset:61440
s_waitcnt lgkmcnt(4)
v_mfma_f32_16x16x32_bf16 v[56:59], a[240:243], a[64:67], v[56:59]
v_mfma_f32_16x16x32_bf16 v[56:59], a[244:247], a[68:71], v[56:59]
ds_read_b128 a[232:235], v4 offset:55296
v_mfma_f32_16x16x32_bf16 v[60:63], a[240:243], a[136:139], v[60:63]
v_mfma_f32_16x16x32_bf16 v[60:63], a[244:247], a[140:143], v[60:63]
ds_read_b128 a[236:239], v4 offset:62464
s_waitcnt lgkmcnt(4)
v_mfma_f32_16x16x32_bf16 v[64:67], a[216:219], a[64:67], v[64:67]
v_mfma_f32_16x16x32_bf16 v[64:67], a[220:223], a[68:71], v[64:67]
ds_read_b128 a[240:243], v7 offset:49152
v_mfma_f32_16x16x32_bf16 v[68:71], a[216:219], a[136:139], v[68:71]
v_mfma_f32_16x16x32_bf16 v[68:71], a[220:223], a[140:143], v[68:71]
ds_read_b128 a[244:247], v7 offset:56320
s_waitcnt lgkmcnt(4)
v_mfma_f32_16x16x32_bf16 v[72:75], a[64:67], a[224:227], v[72:75]
v_mfma_f32_16x16x32_bf16 v[72:75], a[68:71], a[228:231], v[72:75]
ds_read_b128 a[216:219], v10 offset:49152
v_mfma_f32_16x16x32_bf16 v[76:79], a[136:139], a[224:227], v[76:79]
v_mfma_f32_16x16x32_bf16 v[76:79], a[140:143], a[228:231], v[76:79]
ds_read_b128 a[220:223], v10 offset:56320
s_waitcnt lgkmcnt(4)
v_mfma_f32_16x16x32_bf16 v[80:83], a[64:67], a[232:235], v[80:83]
v_mfma_f32_16x16x32_bf16 v[80:83], a[68:71], a[236:239], v[80:83]
v_mfma_f32_16x16x32_bf16 v[84:87], a[136:139], a[232:235], v[84:87]
v_mfma_f32_16x16x32_bf16 v[84:87], a[140:143], a[236:239], v[84:87]
s_waitcnt lgkmcnt(2)
v_mfma_f32_16x16x32_bf16 v[88:91], a[240:243], a[208:211], v[88:91]
v_mfma_f32_16x16x32_bf16 v[88:91], a[244:247], a[212:215], v[88:91]
s_waitcnt lgkmcnt(0)
v_mfma_f32_16x16x32_bf16 v[92:95], a[208:211], a[216:219], v[92:95]
L_hop14:
s_cmp_eq_u32 s15, 1
s_cbranch_scc1 L_hop_done
v_mfma_f32_16x16x32_bf16 v[92:95], a[212:215], a[220:223], v[92:95]
s_branch L_att
L_last:
s_cmp_eq_u32 s4, 3
s_cbranch_scc1 L_epoch
v_and_b32 v6, 7, v1
v_lshrrev_b32 v7, 3, v1
s_and_b32 s23, s6, 1
s_lshl_b32 s23, s23, 3
v_add_u32 v8, s23, v6
v_lshlrev_b32 v8, 4, v8
v_lshl_add_u32 v4, v7, 8, v8
s_lshl_b32 s24, s5, 4
s_lshr_b32 s25, s6, 1
s_add_u32 s24, s24, s25
s_mul_i32 s20, s24, 18432
s_lshl_b32 s24, s5, 8
s_lshl_b32 s25, s6, 3
s_add_u32 s24, s24, s25
s_and_b32 s25, s24, 1023
s_lshl_b32 s25, s25, 1
s_lshr_b32 s24, s24, 10
s_add_u32 s24, s24, s25
s_mul_i32 s21, s24, 1152
v_mul_u32_u24 v8, 2304, v6
v_lshl_add_u32 v5, v7, 4, v8
s_load_dwordx2 s[12:13], s[0:1], 56
s_waitcnt lgkmcnt(0)
s_mov_b32 s16, s12
s_and_b32 s17, s13, 0xffff
s_mov_b32 s18, 2359296
s_mov_b32 s19, 0x20000
s_lshl_b32 s22, s4, 2
s_lshr_b32 s23, 1056, s22
s_and_b32 s23, s23, 15
s_lshl_b32 s24, s23, 11
s_add_u32 s28, s20, s24
s_lshl_b32 s24, s23, 7
s_add_u32 s31, s21, s24
s_lshr_b32 s23, 790, s22
s_and_b32 s23, s23, 15
s_lshl_b32 s24, s23, 11
s_add_u32 s29, s20, s24
s_lshl_b32 s24, s23, 7
s_add_u32 s32, s21, s24
s_lshr_b32 s23, 2165, s22
s_and_b32 s23, s23, 15
s_lshl_b32 s24, s23, 11
s_add_u32 s30, s20, s24
s_lshl_b32 s24, s23, 7
s_add_u32 s33, s21, s24
s_lshl_b32 s26, s5, 12
s_add_u32 s27, s26, 1966080
s_add_u32 s26, s26, 1703936
v_and_b32 v6, 31, v1
v_lshlrev_b32 v6, 7, v6
buffer_load_dwordx2 v[10:11], v6, s[8:11], s27 offen sc1
v_mov_b32 v13, 2146435072
v_cmp_gt_u32 vcc, 16, v0
v_lshlrev_b32 v14, 3, v0
s_nop 0
v_cndmask_b32 v13, v13, v14, vcc
v_mov_b32 v14, s68
v_mov_b32 v15, s69
s_waitcnt vmcnt(0)
s_barrier
buffer_store_dwordx2 v[14:15], v13, s[8:11], s14 offen sc1
s_add_u32 s24, s28, 39485440
buffer_load_dwordx4 v[16:19], v4, s[8:11], s24 offen sc1
s_add_u32 s25, s29, 39485440
buffer_load_dwordx4 v[20:23], v4, s[8:11], s25 offen sc1
s_add_u32 s24, s30, 39485440
buffer_load_dwordx4 v[24:27], v4, s[8:11], s24 offen sc1
v_cmp_eq_u64 vcc, s[68:69], v[10:11]
s_nop 0
s_cmp_eq_u64 vcc, exec
s_cbranch_scc0 L_re_slow8
L_re_back8:
s_add_u32 s25, s28, 98729984
buffer_load_dwordx4 v[28:31], v4, s[8:11], s25 offen sc1
s_add_u32 s24, s28, 101089280
buffer_load_dwordx4 v[40:43], v4, s[8:11], s24 offen sc1
s_add_u32 s25, s28, 103448576
buffer_load_dwordx4 v[52:55], v4, s[8:11], s25 offen sc1
s_add_u32 s24, s28, 105807872
buffer_load_dwordx4 v[64:67], v4, s[8:11], s24 offen sc1
s_add_u32 s25, s28, 108167168
buffer_load_dwordx4 v[76:79], v4, s[8:11], s25 offen sc1
s_add_u32 s24, s28, 110526464
buffer_load_dwordx4 v[88:91], v4, s[8:11], s24 offen sc1
s_add_u32 s25, s28, 112885760
buffer_load_dwordx4 v[100:103], v4, s[8:11], s25 offen sc1
s_add_u32 s24, s28, 115245056
buffer_load_dwordx4 v[112:115], v4, s[8:11], s24 offen sc1
s_mov_b32 s52, 0
L_poll10:
buffer_load_dwordx2 v[14:15], v6, s[8:11], s26 offen sc1
s_add_u32 s52, s52, 1
s_waitcnt vmcnt(0)
v_cmp_ne_u64 vcc, s[68:69], v[14:15]
s_cmp_ge_u32 s52, 1048576
s_cbranch_scc1 L_got10
s_and_b64 exec, exec, vcc
s_cbranch_execnz L_poll10
L_got10:
s_mov_b64 exec, -1
s_add_u32 s24, s29, 98729984
buffer_load_dwordx4 v[32:35], v4, s[8:11], s24 offen sc1
s_add_u32 s25, s30, 98729984
buffer_load_dwordx4 v[36:39], v4, s[8:11], s25 offen sc1
s_add_u32 s25, s29, 101089280
buffer_load_dwordx4 v[44:47], v4, s[8:11], s25 offen sc1
s_add_u32 s24, s30, 101089280
buffer_load_dwordx4 v[48:51], v4, s[8:11], s24 offen sc1
s_add_u32 s24, s29, 103448576
buffer_load_dwordx4 v[56:59], v4, s[8:11], s24 offen sc1
s_add_u32 s25, s30, 103448576
buffer_load_dwordx4 v[60:63], v4, s[8:11], s25 offen sc1
s_add_u32 s25, s29, 105807872
buffer_load_dwordx4 v[68:71], v4, s[8:11], s25 offen sc1
s_add_u32 s24, s30, 105807872
buffer_load_dwordx4 v[72:75], v4, s[8:11], s24 offen sc1
s_add_u32 s24, s29, 108167168
buffer_load_dwordx4 v[80:83], v4, s[8:11], s24 offen sc1
s_add_u32 s25, s30, 108167168
buffer_load_dwordx4 v[84:87], v4, s[8:11], s25 offen sc1
s_add_u32 s25, s29, 110526464
buffer_load_dwordx4 v[92:95], v4, s[8:11], s25 offen sc1
s_add_u32 s24, s30, 110526464
buffer_load_dwordx4 v[96:99], v4, s[8:11], s24 offen sc1
s_add_u32 s24, s29, 112885760
buffer_load_dwordx4 v[104:107], v4, s[8:11], s24 offen sc1
s_add_u32 s25, s30, 112885760
buffer_load_dwordx4 v[108:111], v4, s[8:11], s25 offen sc1
s_add_u32 s25, s29, 115245056
buffer_load_dwordx4 v[116:119], v4, s[8:11], s25 offen sc1
s_add_u32 s24, s30, 115245056
buffer_load_dwordx4 v[120:123], v4, s[8:11], s24 offen sc1
s_waitcnt vmcnt(26)
v_lshlrev_b32 v128, 16, v16
v_and_b32 v129, 0xffff0000, v16
v_lshlrev_b32 v130, 16, v17
v_and_b32 v131, 0xffff0000, v17
v_lshlrev_b32 v132, 16, v18
v_and_b32 v133, 0xffff0000, v18
v_lshlrev_b32 v134, 16, v19
v_and_b32 v135, 0xffff0000, v19
s_waitcnt vmcnt(25)
v_lshlrev_b32 v136, 16, v20
v_and_b32 v137, 0xffff0000, v20
v_lshlrev_b32 v138, 16, v21
v_and_b32 v139, 0xffff0000, v21
v_lshlrev_b32 v140, 16, v22
v_and_b32 v141, 0xffff0000, v22
v_lshlrev_b32 v142, 16, v23
v_and_b32 v143, 0xffff0000, v23
s_waitcnt vmcnt(24)
v_lshlrev_b32 v144, 16, v24
v_and_b32 v145, 0xffff0000, v24
v_lshlrev_b32 v146, 16, v25
v_and_b32 v147, 0xffff0000, v25
v_lshlrev_b32 v148, 16, v26
v_and_b32 v149, 0xffff0000, v26
v_lshlrev_b32 v150, 16, v27
v_and_b32 v151, 0xffff0000, v27
s_waitcnt vmcnt(23)
v_lshlrev_b32 v6, 16, v28
v_and_b32 v7, 0xffff0000, v28
v_add_f32 v128, v128, v6
v_add_f32 v129, v129, v7
v_lshlrev_b32 v8, 16, v29
v_and_b32 v9, 0xffff0000, v29
v_add_f32 v130, v130, v8
v_add_f32 v131, v131, v9
v_lshlrev_b32 v6, 16, v30
v_and_b32 v7, 0xffff0000, v30
v_add_f32 v132, v132, v6
v_add_f32 v133, v133, v7
v_lshlrev_b32 v8, 16, v31
v_and_b32 v9, 0xffff0000, v31
v_add_f32 v134, v134, v8
v_add_f32 v135, v135, v9
s_waitcnt vmcnt(22)
v_lshlrev_b32 v6, 16, v40
v_and_b32 v7, 0xffff0000, v40
v_add_f32 v128, v128, v6
v_add_f32 v129, v129, v7
v_lshlrev_b32 v8, 16, v41
v_and_b32 v9, 0xffff0000, v41
v_add_f32 v130, v130, v8
v_add_f32 v131, v131, v9
v_lshlrev_b32 v6, 16, v42
v_and_b32 v7, 0xffff0000, v42
v_add_f32 v132, v132, v6
v_add_f32 v133, v133, v7
v_lshlrev_b32 v8, 16, v43
v_and_b32 v9, 0xffff0000, v43
v_add_f32 v134, v134, v8
v_add_f32 v135, v135, v9
s_waitcnt vmcnt(21)
v_lshlrev_b32 v6, 16, v52
v_and_b32 v7, 0xffff0000, v52
v_add_f32 v128, v128, v6
v_add_f32 v129, v129, v7
v_lshlrev_b32 v8, 16, v53
v_and_b32 v9, 0xffff0000, v53
v_add_f32 v130, v130, v8
v_add_f32 v131, v131, v9
v_lshlrev_b32 v6, 16, v54
v_and_b32 v7, 0xffff0000, v54
v_add_f32 v132, v132, v6
v_add_f32 v133, v133, v7
v_lshlrev_b32 v8, 16, v55
v_and_b32 v9, 0xffff0000, v55
v_add_f32 v134, v134, v8
v_add_f32 v135, v135, v9
s_waitcnt vmcnt(20)
v_lshlrev_b32 v6, 16, v64
v_and_b32 v7, 0xffff0000, v64
v_add_f32 v128, v128, v6
v_add_f32 v129, v129, v7
v_lshlrev_b32 v8, 16, v65
v_and_b32 v9, 0xffff0000, v65
v_add_f32 v130, v130, v8
v_add_f32 v131, v131, v9
v_lshlrev_b32 v6, 16, v66
v_and_b32 v7, 0xffff0000, v66
v_add_f32 v132, v132, v6
v_add_f32 v133, v133, v7
v_lshlrev_b32 v8, 16, v67
v_and_b32 v9, 0xffff0000, v67
v_add_f32 v134, v134, v8
v_add_f32 v135, v135, v9
s_waitcnt vmcnt(19)
v_lshlrev_b32 v6, 16, v76
v_and_b32 v7, 0xffff0000, v76
v_add_f32 v128, v128, v6
v_add_f32 v129, v129, v7
v_lshlrev_b32 v8, 16, v77
v_and_b32 v9, 0xffff0000, v77
v_add_f32 v130, v130, v8
v_add_f32 v131, v131, v9
v_lshlrev_b32 v6, 16, v78
v_and_b32 v7, 0xffff0000, v78
v_add_f32 v132, v132, v6
v_add_f32 v133, v133, v7
v_lshlrev_b32 v8, 16, v79
v_and_b32 v9, 0xffff0000, v79
v_add_f32 v134, v134, v8
v_add_f32 v135, v135, v9
s_waitcnt vmcnt(18)
v_lshlrev_b32 v6, 16, v88
v_and_b32 v7, 0xffff0000, v88
v_add_f32 v128, v128, v6
v_add_f32 v129, v129, v7
v_lshlrev_b32 v8, 16, v89
v_and_b32 v9, 0xffff0000, v89
v_add_f32 v130, v130, v8
v_add_f32 v131, v131, v9
v_lshlrev_b32 v6, 16, v90
v_and_b32 v7, 0xffff0000, v90
v_add_f32 v132, v132, v6
v_add_f32 v133, v133, v7
v_lshlrev_b32 v8, 16, v91
v_and_b32 v9, 0xffff0000, v91
v_add_f32 v134, v134, v8
v_add_f32 v135, v135, v9
s_waitcnt vmcnt(17)
v_lshlrev_b32 v6, 16, v100
v_and_b32 v7, 0xffff0000, v100
v_add_f32 v128, v128, v6
v_add_f32 v129, v129, v7
v_lshlrev_b32 v8, 16, v101
v_and_b32 v9, 0xffff0000, v101
v_add_f32 v130, v130, v8
v_add_f32 v131, v131, v9
v_lshlrev_b32 v6, 16, v102
v_and_b32 v7, 0xffff0000, v102
v_add_f32 v132, v132, v6
v_add_f32 v133, v133, v7
v_lshlrev_b32 v8, 16, v103
v_and_b32 v9, 0xffff0000, v103
v_add_f32 v134, v134, v8
v_add_f32 v135, v135, v9
s_waitcnt vmcnt(16)
v_lshlrev_b32 v6, 16, v112
v_and_b32 v7, 0xffff0000, v112
v_add_f32 v128, v128, v6
v_add_f32 v129, v129, v7
v_lshlrev_b32 v8, 16, v113
v_and_b32 v9, 0xffff0000, v113
v_add_f32 v130, v130, v8
v_add_f32 v131, v131, v9
v_lshlrev_b32 v6, 16, v114
v_and_b32 v7, 0xffff0000, v114
v_add_f32 v132, v132, v6
v_add_f32 v133, v133, v7
v_lshlrev_b32 v8, 16, v115
v_and_b32 v9, 0xffff0000, v115
v_add_f32 v134, v134, v8
v_add_f32 v135, v135, v9
s_waitcnt vmcnt(15)
v_lshlrev_b32 v6, 16, v32
v_and_b32 v7, 0xffff0000, v32
v_add_f32 v136, v136, v6
v_add_f32 v137, v137, v7
v_lshlrev_b32 v8, 16, v33
v_and_b32 v9, 0xffff0000, v33
v_add_f32 v138, v138, v8
v_add_f32 v139, v139, v9
v_lshlrev_b32 v6, 16, v34
v_and_b32 v7, 0xffff0000, v34
v_add_f32 v140, v140, v6
v_add_f32 v141, v141, v7
v_lshlrev_b32 v8, 16, v35
v_and_b32 v9, 0xffff0000, v35
v_add_f32 v142, v142, v8
v_add_f32 v143, v143, v9
s_waitcnt vmcnt(14)
v_lshlrev_b32 v6, 16, v36
v_and_b32 v7, 0xffff0000, v36
v_add_f32 v144, v144, v6
v_add_f32 v145, v145, v7
v_lshlrev_b32 v8, 16, v37
v_and_b32 v9, 0xffff0000, v37
v_add_f32 v146, v146, v8
v_add_f32 v147, v147, v9
v_lshlrev_b32 v6, 16, v38
v_and_b32 v7, 0xffff0000, v38
v_add_f32 v148, v148, v6
v_add_f32 v149, v149, v7
v_lshlrev_b32 v8, 16, v39
v_and_b32 v9, 0xffff0000, v39
v_add_f32 v150, v150, v8
v_add_f32 v151, v151, v9
s_waitcnt vmcnt(13)
v_lshlrev_b32 v6, 16, v44
v_and_b32 v7, 0xffff0000, v44
v_add_f32 v136, v136, v6
v_add_f32 v137, v137, v7
v_lshlrev_b32 v8, 16, v45
v_and_b32 v9, 0xffff0000, v45
v_add_f32 v138, v138, v8
v_add_f32 v139, v139, v9
v_lshlrev_b32 v6, 16, v46
v_and_b32 v7, 0xffff0000, v46
v_add_f32 v140, v140, v6
v_add_f32 v141, v141, v7
v_lshlrev_b32 v8, 16, v47
v_and_b32 v9, 0xffff0000, v47
v_add_f32 v142, v142, v8
v_add_f32 v143, v143, v9
s_waitcnt vmcnt(12)
v_lshlrev_b32 v6, 16, v48
v_and_b32 v7, 0xffff0000, v48
v_add_f32 v144, v144, v6
v_add_f32 v145, v145, v7
v_lshlrev_b32 v8, 16, v49
v_and_b32 v9, 0xffff0000, v49
v_add_f32 v146, v146, v8
v_add_f32 v147, v147, v9
v_lshlrev_b32 v6, 16, v50
v_and_b32 v7, 0xffff0000, v50
v_add_f32 v148, v148, v6
v_add_f32 v149, v149, v7
v_lshlrev_b32 v8, 16, v51
v_and_b32 v9, 0xffff0000, v51
v_add_f32 v150, v150, v8
v_add_f32 v151, v151, v9
s_waitcnt vmcnt(11)
v_lshlrev_b32 v6, 16, v56
v_and_b32 v7, 0xffff0000, v56
v_add_f32 v136, v136, v6
v_add_f32 v137, v137, v7
v_lshlrev_b32 v8, 16, v57
v_and_b32 v9, 0xffff0000, v57
v_add_f32 v138, v138, v8
v_add_f32 v139, v139, v9
v_lshlrev_b32 v6, 16, v58
v_and_b32 v7, 0xffff0000, v58
v_add_f32 v140, v140, v6
v_add_f32 v141, v141, v7
v_lshlrev_b32 v8, 16, v59
v_and_b32 v9, 0xffff0000, v59
v_add_f32 v142, v142, v8
v_add_f32 v143, v143, v9
s_waitcnt vmcnt(10)
v_lshlrev_b32 v6, 16, v60
v_and_b32 v7, 0xffff0000, v60
v_add_f32 v144, v144, v6
v_add_f32 v145, v145, v7
v_lshlrev_b32 v8, 16, v61
v_and_b32 v9, 0xffff0000, v61
v_add_f32 v146, v146, v8
v_add_f32 v147, v147, v9
v_lshlrev_b32 v6, 16, v62
v_and_b32 v7, 0xffff0000, v62
v_add_f32 v148, v148, v6
v_add_f32 v149, v149, v7
v_lshlrev_b32 v8, 16, v63
v_and_b32 v9, 0xffff0000, v63
v_add_f32 v150, v150, v8
v_add_f32 v151, v151, v9
s_waitcnt vmcnt(9)
v_lshlrev_b32 v6, 16, v68
v_and_b32 v7, 0xffff0000, v68
v_add_f32 v136, v136, v6
v_add_f32 v137, v137, v7
v_lshlrev_b32 v8, 16, v69
v_and_b32 v9, 0xffff0000, v69
v_add_f32 v138, v138, v8
v_add_f32 v139, v139, v9
v_lshlrev_b32 v6, 16, v70
v_and_b32 v7, 0xffff0000, v70
v_add_f32 v140, v140, v6
v_add_f32 v141, v141, v7
v_lshlrev_b32 v8, 16, v71
v_and_b32 v9, 0xffff0000, v71
v_add_f32 v142, v142, v8
v_add_f32 v143, v143, v9
s_waitcnt vmcnt(8)
v_lshlrev_b32 v6, 16, v72
v_and_b32 v7, 0xffff0000, v72
v_add_f32 v144, v144, v6
v_add_f32 v145, v145, v7
v_lshlrev_b32 v8, 16, v73
v_and_b32 v9, 0xffff0000, v73
v_add_f32 v146, v146, v8
v_add_f32 v147, v147, v9
v_lshlrev_b32 v6, 16, v74
v_and_b32 v7, 0xffff0000, v74
v_add_f32 v148, v148, v6
v_add_f32 v149, v149, v7
v_lshlrev_b32 v8, 16, v75
v_and_b32 v9, 0xffff0000, v75
v_add_f32 v150, v150, v8
v_add_f32 v151, v151, v9
s_waitcnt vmcnt(7)
v_lshlrev_b32 v6, 16, v80
v_and_b32 v7, 0xffff0000, v80
v_add_f32 v136, v136, v6
v_add_f32 v137, v137, v7
v_lshlrev_b32 v8, 16, v81
v_and_b32 v9, 0xffff0000, v81
v_add_f32 v138, v138, v8
v_add_f32 v139, v139, v9
v_lshlrev_b32 v6, 16, v82
v_and_b32 v7, 0xffff0000, v82
v_add_f32 v140, v140, v6
v_add_f32 v141, v141, v7
v_lshlrev_b32 v8, 16, v83
v_and_b32 v9, 0xffff0000, v83
v_add_f32 v142, v142, v8
v_add_f32 v143, v143, v9
s_waitcnt vmcnt(6)
v_lshlrev_b32 v6, 16, v84
v_and_b32 v7, 0xffff0000, v84
v_add_f32 v144, v144, v6
v_add_f32 v145, v145, v7
v_lshlrev_b32 v8, 16, v85
v_and_b32 v9, 0xffff0000, v85
v_add_f32 v146, v146, v8
v_add_f32 v147, v147, v9
v_lshlrev_b32 v6, 16, v86
v_and_b32 v7, 0xffff0000, v86
v_add_f32 v148, v148, v6
v_add_f32 v149, v149, v7
v_lshlrev_b32 v8, 16, v87
v_and_b32 v9, 0xffff0000, v87
v_add_f32 v150, v150, v8
v_add_f32 v151, v151, v9
s_waitcnt vmcnt(5)
v_lshlrev_b32 v6, 16, v92
v_and_b32 v7, 0xffff0000, v92
v_add_f32 v136, v136, v6
v_add_f32 v137, v137, v7
v_lshlrev_b32 v8, 16, v93
v_and_b32 v9, 0xffff0000, v93
v_add_f32 v138, v138, v8
v_add_f32 v139, v139, v9
v_lshlrev_b32 v6, 16, v94
v_and_b32 v7, 0xffff0000, v94
v_add_f32 v140, v140, v6
v_add_f32 v141, v141, v7
v_lshlrev_b32 v8, 16, v95
v_and_b32 v9, 0xffff0000, v95
v_add_f32 v142, v142, v8
v_add_f32 v143, v143, v9
s_waitcnt vmcnt(4)
v_lshlrev_b32 v6, 16, v96
v_and_b32 v7, 0xffff0000, v96
v_add_f32 v144, v144, v6
v_add_f32 v145, v145, v7
v_lshlrev_b32 v8, 16, v97
v_and_b32 v9, 0xffff0000, v97
v_add_f32 v146, v146, v8
v_add_f32 v147, v147, v9
v_lshlrev_b32 v6, 16, v98
v_and_b32 v7, 0xffff0000, v98
v_add_f32 v148, v148, v6
v_add_f32 v149, v149, v7
v_lshlrev_b32 v8, 16, v99
v_and_b32 v9, 0xffff0000, v99
v_add_f32 v150, v150, v8
v_add_f32 v151, v151, v9
s_waitcnt vmcnt(3)
v_lshlrev_b32 v6, 16, v104
v_and_b32 v7, 0xffff0000, v104
v_add_f32 v136, v136, v6
v_add_f32 v137, v137, v7
v_lshlrev_b32 v8, 16, v105
v_and_b32 v9, 0xffff0000, v105
v_add_f32 v138, v138, v8
v_add_f32 v139, v139, v9
v_lshlrev_b32 v6, 16, v106
v_and_b32 v7, 0xffff0000, v106
v_add_f32 v140, v140, v6
v_add_f32 v141, v141, v7
v_lshlrev_b32 v8, 16, v107
v_and_b32 v9, 0xffff0000, v107
v_add_f32 v142, v142, v8
v_add_f32 v143, v143, v9
s_waitcnt vmcnt(2)
v_lshlrev_b32 v6, 16, v108
v_and_b32 v7, 0xffff0000, v108
v_add_f32 v144, v144, v6
v_add_f32 v145, v145, v7
v_lshlrev_b32 v8, 16, v109
v_and_b32 v9, 0xffff0000, v109
v_add_f32 v146, v146, v8
v_add_f32 v147, v147, v9
v_lshlrev_b32 v6, 16, v110
v_and_b32 v7, 0xffff0000, v110
v_add_f32 v148, v148, v6
v_add_f32 v149, v149, v7
v_lshlrev_b32 v8, 16, v111
v_and_b32 v9, 0xffff0000, v111
v_add_f32 v150, v150, v8
v_add_f32 v151, v151, v9
s_waitcnt vmcnt(1)
v_lshlrev_b32 v6, 16, v116
v_and_b32 v7, 0xffff0000, v116
v_add_f32 v136, v136, v6
v_add_f32 v137, v137, v7
v_lshlrev_b32 v8, 16, v117
v_and_b32 v9, 0xffff0000, v117
v_add_f32 v138, v138, v8
v_add_f32 v139, v139, v9
v_lshlrev_b32 v6, 16, v118
v_and_b32 v7, 0xffff0000, v118
v_add_f32 v140, v140, v6
v_add_f32 v141, v141, v7
v_lshlrev_b32 v8, 16, v119
v_and_b32 v9, 0xffff0000, v119
v_add_f32 v142, v142, v8
v_add_f32 v143, v143, v9
s_waitcnt vmcnt(0)
v_lshlrev_b32 v6, 16, v120
v_and_b32 v7, 0xffff0000, v120
v_add_f32 v144, v144, v6
v_add_f32 v145, v145, v7
v_lshlrev_b32 v8, 16, v121
v_and_b32 v9, 0xffff0000, v121
v_add_f32 v146, v146, v8
v_add_f32 v147, v147, v9
v_lshlrev_b32 v6, 16, v122
v_and_b32 v7, 0xffff0000, v122
v_add_f32 v148, v148, v6
v_add_f32 v149, v149, v7
v_lshlrev_b32 v8, 16, v123
v_and_b32 v9, 0xffff0000, v123
v_add_f32 v150, v150, v8
v_add_f32 v151, v151, v9
v_cvt_pk_bf16_f32 v152, v128, v129
v_cvt_pk_bf16_f32 v153, v130, v131
v_cvt_pk_bf16_f32 v154, v132, v133
v_cvt_pk_bf16_f32 v155, v134, v135
v_cvt_pk_bf16_f32 v156, v136, v137
v_cvt_pk_bf16_f32 v157, v138, v139
v_cvt_pk_bf16_f32 v158, v140, v141
v_cvt_pk_bf16_f32 v159, v142, v143
v_cvt_pk_bf16_f32 v160, v144, v145
v_cvt_pk_bf16_f32 v161, v146, v147
v_cvt_pk_bf16_f32 v162, v148, v149
v_cvt_pk_bf16_f32 v163, v150, v151
buffer_store_dwordx4 v[152:155], v5, s[16:19], s31 offen
buffer_store_dwordx4 v[156:159], v5, s[16:19], s32 offen
buffer_store_dwordx4 v[160:163], v5, s[16:19], s33 offen
L_end:
s_endpgm
L_f_slow1:
s_mov_b32 s52, 0
L_f_spin1:
buffer_load_dwordx2 v[14:15], v11, s[8:11], s23 offen sc1
s_add_u32 s52, s52, 1
s_waitcnt vmcnt(0)
v_cmp_eq_u64 vcc, s[68:69], v[14:15]
s_cmp_gt_u32 s52, 1048576
s_cbranch_scc1 L_f_back1
s_cmp_eq_u64 vcc, exec
s_cbranch_scc0 L_f_spin1
s_branch L_f_back1
L_f_slow2:
s_mov_b32 s52, 0
L_f_spin2:
buffer_load_dwordx2 v[14:15], v11, s[8:11], s23 offen sc1
s_add_u32 s52, s52, 1
s_waitcnt vmcnt(0)
v_cmp_eq_u64 vcc, s[68:69], v[14:15]
s_cmp_gt_u32 s52, 1048576
s_cbranch_scc1 L_f_back2
s_cmp_eq_u64 vcc, exec
s_cbranch_scc0 L_f_spin2
s_branch L_f_back2
L_f_slow3:
s_mov_b32 s52, 0
L_f_spin3:
buffer_load_dwordx2 v[14:15], v11, s[8:11], s23 offen sc1
s_add_u32 s52, s52, 1
s_waitcnt vmcnt(0)
v_cmp_eq_u64 vcc, s[68:69], v[14:15]
s_cmp_gt_u32 s52, 1048576
s_cbranch_scc1 L_f_back3
s_cmp_eq_u64 vcc, exec
s_cbranch_scc0 L_f_spin3
s_branch L_f_back3
L_re_slow4:
s_mov_b32 s52, 0
L_poll5:
buffer_load_dwordx2 v[14:15], v6, s[8:11], s27 offen sc1
s_add_u32 s52, s52, 1
s_waitcnt vmcnt(0)
v_cmp_ne_u64 vcc, s[68:69], v[14:15]
s_cmp_ge_u32 s52, 1048576
s_cbranch_scc1 L_got5
s_and_b64 exec, exec, vcc
s_cbranch_execnz L_poll5
L_got5:
s_mov_b64 exec, -1
s_branch L_re_back4
L_re_slow8:
s_mov_b32 s52, 0
L_poll9:
buffer_load_dwordx2 v[14:15], v6, s[8:11], s27 offen sc1
s_add_u32 s52, s52, 1
s_waitcnt vmcnt(0)
v_cmp_ne_u64 vcc, s[68:69], v[14:15]
s_cmp_ge_u32 s52, 1048576
s_cbranch_scc1 L_got9
s_and_b64 exec, exec, vcc
s_cbranch_execnz L_poll9
L_got9:
s_mov_b64 exec, -1
s_branch L_re_back8
L_epoch:
v_mov_b32 v13, 2146435072
v_cmp_gt_u32 vcc, 16, v0
v_lshlrev_b32 v14, 3, v0
s_nop 0
v_cndmask_b32 v13, v13, v14, vcc
v_mov_b32 v14, s68
v_mov_b32 v15, s69
s_waitcnt vmcnt(0)
s_barrier
buffer_store_dwordx2 v[14:15], v13, s[8:11], s14 offen sc1
s_cmp_lg_u32 s2, 0
s_cbranch_scc1 L_end
v_lshlrev_b32 v4, 7, v1
s_mov_b32 s40, 786432
s_mov_b32 s52, 0
L_poll11:
buffer_load_dwordx2 v[14:15], v4, s[8:11], s40 offen sc1
s_add_u32 s52, s52, 1
s_waitcnt vmcnt(0)
v_cmp_ne_u64 vcc, s[68:69], v[14:15]
s_cmp_ge_u32 s52, 1048576
s_cbranch_scc1 L_got11
s_and_b64 exec, exec, vcc
s_cbranch_execnz L_poll11
L_got11:
s_mov_b64 exec, -1
s_mov_b32 s40, 794624
s_mov_b32 s52, 0
L_poll12:
buffer_load_dwordx2 v[14:15], v4, s[8:11], s40 offen sc1
s_add_u32 s52, s52, 1
s_waitcnt vmcnt(0)
v_cmp_ne_u64 vcc, s[68:69], v[14:15]
s_cmp_ge_u32 s52, 1048576
s_cbranch_scc1 L_got12
s_and_b64 exec, exec, vcc
s_cbranch_execnz L_poll12
L_got12:
s_mov_b64 exec, -1
s_mov_b32 s40, 802816
s_mov_b32 s52, 0
L_poll13:
buffer_load_dwordx2 v[14:15], v4, s[8:11], s40 offen sc1
s_add_u32 s52, s52, 1
s_waitcnt vmcnt(0)
v_cmp_ne_u64 vcc, s[68:69], v[14:15]
s_cmp_ge_u32 s52, 1048576
s_cbranch_scc1 L_got13
s_and_b64 exec, exec, vcc
s_cbranch_execnz L_poll13
L_got13:
s_mov_b64 exec, -1
s_mov_b32 s40, 811008
s_mov_b32 s52, 0
L_poll14:
buffer_load_dwordx2 v[14:15], v4, s[8:11], s40 offen sc1
s_add_u32 s52, s52, 1
s_waitcnt vmcnt(0)
v_cmp_ne_u64 vcc, s[68:69], v[14:15]
s_cmp_ge_u32 s52, 1048576
s_cbranch_scc1 L_got14
s_and_b64 exec, exec, vcc
s_cbranch_execnz L_poll14
L_got14:
s_mov_b64 exec, -1
s_mov_b32 s40, 4194304
v_mov_b32 v13, 2146435072
v_cmp_gt_u32 vcc, 16, v1
v_lshlrev_b32 v14, 3, v1
s_nop 0
v_cndmask_b32 v13, v13, v14, vcc
v_mov_b32 v14, s68
v_mov_b32 v15, s69
buffer_store_dwordx2 v[14:15], v13, s[8:11], s40 offen sc1
s_branch L_end
L_code_end:
s_endpgm
.section .rodata,"a"
.p2align 6
.amdhsa_kernel interleave_layers__sliding_local_dilated__glu_gated_geglu__prompt_kernel
  .amdhsa_next_free_vgpr 512
  .amdhsa_next_free_sgpr 102
  .amdhsa_accum_offset 256
  .amdhsa_group_segment_fixed_size 0
  .amdhsa_kernarg_size 80
  .amdhsa_user_sgpr_count 2
  .amdhsa_user_sgpr_kernarg_segment_ptr 1
  .amdhsa_system_sgpr_workgroup_id_x 1
.end_amdhsa_kernel
```

```asm
; @launch grid=(256,1,1) block=(256,1,1) lds=160768
.amdgcn_target "amdgcn-amd-amdhsa--gfx950"
.text
.p2align 8
.globl interleave_layers__sliding_local_dilated__glu_gated_geglu__prompt_kernel
.type interleave_layers__sliding_local_dilated__glu_gated_geglu__prompt_kernel,@function
interleave_layers__sliding_local_dilated__glu_gated_geglu__prompt_kernel:
s_cmp_ge_u32 s2, 256
s_cbranch_scc1 L_end
s_getpc_b64 s[40:41]
L_warm_pc:
s_lshr_b32 s42, s2, 3
s_lshl_b32 s42, s42, 11
v_lshlrev_b32 v10, 3, v0
v_add_u32 v10, s42, v10
v_min_u32 v10, L_code_end - L_warm_pc - 8, v10
v_mov_b32 v11, s41
v_add_co_u32 v10, vcc, s40, v10
s_nop 1
v_addc_co_u32 v11, vcc, 0, v11, vcc
global_load_dwordx2 a[0:1], v[10:11], off
v_add_co_u32 v10, vcc, 0x10000, v10
s_nop 1
v_addc_co_u32 v11, vcc, 0, v11, vcc
s_add_u32 s42, s42, 67584
s_cmp_le_u32 s42, L_code_end - L_warm_pc - 8
s_cbranch_scc0 L_warm_done
global_load_dwordx2 a[2:3], v[10:11], off
L_warm_done:
s_load_dwordx4 s[56:59], s[0:1], 0
s_load_dwordx2 s[60:61], s[0:1], 16
s_load_dwordx4 s[64:67], s[0:1], 32
s_load_dwordx2 s[62:63], s[0:1], 48
s_load_dwordx2 s[12:13], s[0:1], 72
v_and_b32 v1, 63, v0
v_lshrrev_b32 v3, 6, v0
v_lshlrev_b32 v2, 4, v1
v_readfirstlane_b32 s4, v3
s_and_b32 s5, s2, 7
s_lshr_b32 s6, s2, 3
s_waitcnt lgkmcnt(0)
s_mov_b32 s8, s12
s_and_b32 s9, s13, 0xffff
s_mov_b32 s10, 268435456
s_mov_b32 s11, 0x20000
s_mov_b32 s16, s56
s_and_b32 s17, s57, 0xffff
s_mov_b32 s18, 2359296
s_mov_b32 s19, 0x20000
v_mov_b32 v3, 4194304
buffer_load_dwordx2 v[14:15], v3, s[8:11], 0 offen sc1
v_and_b32 v6, 15, v1
v_lshrrev_b32 v7, 4, v1
v_lshrrev_b32 v8, 2, v6
v_mov_b32 v12, 2146435072
s_mov_b32 s37, 0
s_cmp_lt_u32 s2, 144
s_cbranch_scc0 L_p0_0
s_mul_i32 s40, s2, 911
s_lshr_b32 s40, s40, 16
s_mul_i32 s41, s40, 72
s_sub_u32 s41, s2, s41
s_cmp_eq_u32 s40, 0
s_cselect_b64 s[12:13], s[64:65], s[66:67]
s_mov_b32 s48, s12
s_and_b32 s49, s13, 0xffff
s_mov_b32 s50, 5308416
s_mov_b32 s51, 0x20000
s_lshl_b32 s42, s41, 7
v_lshlrev_b32 v9, 3, v6
v_mul_u32_u24 v10, 73728, v7
v_add3_u32 v4, v9, v10, s42
s_bitcmp1_b32 s4, 0
s_cselect_b64 vcc, -1, 0
v_cndmask_b32 v5, v4, v12, vcc
s_mul_i32 s43, s4, 9
s_add_u32 s43, s43, 1
s_lshr_b32 s43, s43, 1
s_mul_i32 s53, s43, 294912
s_mul_i32 s42, s41, 7282
s_lshr_b32 s42, s42, 16
s_mul_i32 s35, s42, 9
s_sub_u32 s41, s41, s35
s_lshl_b32 s41, s41, 2
s_lshl_b32 s42, s42, 2
s_lshl_b32 s40, s40, 11
s_add_u32 s40, s40, 7012352
s_mov_b32 s35, 497664
v_and_b32 v6, 3, v1
v_add_u32 v6, s41, v6
v_mul_u32_u24 v7, 57, v6
v_lshrrev_b32 v7, 9, v7
v_mul_u32_u24 v8, 9, v7
v_sub_u32 v6, v6, v8
v_add_u32 v8, 1, v6
v_cmp_eq_u32 vcc, 9, v8
s_nop 1
v_cndmask_b32 v8, v8, 0, vcc
v_and_b32 v9, 1, v7
v_cmp_eq_u32 vcc, 0, v9
s_nop 1
v_cndmask_b32 v6, v6, v8, vcc
v_add_u32 v7, s42, v7
v_mul_lo_u32 v7, v7, s35
v_add_u32 v7, s40, v7
v_lshrrev_b32 v8, 2, v1
v_add_u32 v8, s43, v8
v_and_b32 v9, 1, v8
v_lshl_add_u32 v7, v9, 10, v7
v_lshrrev_b32 v9, 1, v8
v_lshlrev_b32 v9, 12, v9
v_add_u32 v7, v7, v9
v_lshl_add_u32 v9, v6, 12, v9
v_mul_u32_u24 v10, 36864, v6
v_cmp_gt_u32 vcc, 2, v6
s_nop 1
v_cndmask_b32 v9, v10, v9, vcc
v_add_u32 v7, v7, v9
v_cmp_gt_u32 vcc, 18, v8
s_nop 1
v_cndmask_b32 v7, v12, v7, vcc
s_bitcmp1_b32 s4, 0
s_cselect_b32 s41, 16, 20
v_cmp_gt_u32 vcc, s41, v1
s_nop 1
v_cndmask_b32 v7, v12, v7, vcc
s_nop 0
v_readlane_b32 s40, v7, 0
v_readlane_b32 s41, v7, 1
v_readlane_b32 s42, v7, 2
v_readlane_b32 s43, v7, 3
v_add_u32 v156, s40, v2
v_add_u32 v157, s41, v2
v_add_u32 v158, s42, v2
v_add_u32 v159, s43, v2
v_readlane_b32 s40, v7, 4
v_readlane_b32 s41, v7, 5
v_readlane_b32 s42, v7, 6
v_readlane_b32 s43, v7, 7
v_add_u32 v160, s40, v2
v_add_u32 v161, s41, v2
v_add_u32 v162, s42, v2
v_add_u32 v163, s43, v2
v_readlane_b32 s40, v7, 8
v_readlane_b32 s41, v7, 9
v_readlane_b32 s42, v7, 10
v_readlane_b32 s43, v7, 11
v_add_u32 v164, s40, v2
v_add_u32 v165, s41, v2
v_add_u32 v166, s42, v2
v_add_u32 v167, s43, v2
v_readlane_b32 s40, v7, 12
v_readlane_b32 s41, v7, 13
v_readlane_b32 s42, v7, 14
v_readlane_b32 s43, v7, 15
v_add_u32 v168, s40, v2
v_add_u32 v169, s41, v2
v_add_u32 v170, s42, v2
v_add_u32 v171, s43, v2
v_readlane_b32 s40, v7, 16
v_readlane_b32 s41, v7, 17
v_readlane_b32 s42, v7, 18
v_readlane_b32 s43, v7, 19
v_add_u32 v172, s40, v2
v_add_u32 v173, s41, v2
v_add_u32 v174, s42, v2
v_add_u32 v175, s43, v2
buffer_load_dwordx2 v[76:77], v4, s[48:51], s53 offen
s_add_u32 s53, s53, 9216
buffer_load_dwordx2 v[78:79], v4, s[48:51], s53 offen
s_add_u32 s53, s53, 9216
buffer_load_dwordx2 v[80:81], v4, s[48:51], s53 offen
s_add_u32 s53, s53, 9216
buffer_load_dwordx2 v[82:83], v4, s[48:51], s53 offen
s_add_u32 s53, s53, 9216
buffer_load_dwordx2 v[84:85], v4, s[48:51], s53 offen
s_add_u32 s53, s53, 9216
buffer_load_dwordx2 v[86:87], v4, s[48:51], s53 offen
s_add_u32 s53, s53, 9216
buffer_load_dwordx2 v[88:89], v4, s[48:51], s53 offen
s_add_u32 s53, s53, 9216
buffer_load_dwordx2 v[90:91], v4, s[48:51], s53 offen
s_add_u32 s53, s53, 230400
buffer_load_dwordx2 v[92:93], v4, s[48:51], s53 offen
s_add_u32 s53, s53, 9216
buffer_load_dwordx2 v[94:95], v4, s[48:51], s53 offen
s_add_u32 s53, s53, 9216
buffer_load_dwordx2 v[96:97], v4, s[48:51], s53 offen
s_add_u32 s53, s53, 9216
buffer_load_dwordx2 v[98:99], v4, s[48:51], s53 offen
s_add_u32 s53, s53, 9216
buffer_load_dwordx2 v[100:101], v4, s[48:51], s53 offen
s_add_u32 s53, s53, 9216
buffer_load_dwordx2 v[102:103], v4, s[48:51], s53 offen
s_add_u32 s53, s53, 9216
buffer_load_dwordx2 v[104:105], v4, s[48:51], s53 offen
s_add_u32 s53, s53, 9216
buffer_load_dwordx2 v[106:107], v4, s[48:51], s53 offen
s_add_u32 s53, s53, 230400
buffer_load_dwordx2 v[108:109], v4, s[48:51], s53 offen
s_add_u32 s53, s53, 9216
buffer_load_dwordx2 v[110:111], v4, s[48:51], s53 offen
s_add_u32 s53, s53, 9216
buffer_load_dwordx2 v[112:113], v4, s[48:51], s53 offen
s_add_u32 s53, s53, 9216
buffer_load_dwordx2 v[114:115], v4, s[48:51], s53 offen
s_add_u32 s53, s53, 9216
buffer_load_dwordx2 v[116:117], v4, s[48:51], s53 offen
s_add_u32 s53, s53, 9216
buffer_load_dwordx2 v[118:119], v4, s[48:51], s53 offen
s_add_u32 s53, s53, 9216
buffer_load_dwordx2 v[120:121], v4, s[48:51], s53 offen
s_add_u32 s53, s53, 9216
buffer_load_dwordx2 v[122:123], v4, s[48:51], s53 offen
s_add_u32 s53, s53, 230400
buffer_load_dwordx2 v[124:125], v4, s[48:51], s53 offen
s_add_u32 s53, s53, 9216
buffer_load_dwordx2 v[126:127], v4, s[48:51], s53 offen
s_add_u32 s53, s53, 9216
buffer_load_dwordx2 v[128:129], v4, s[48:51], s53 offen
s_add_u32 s53, s53, 9216
buffer_load_dwordx2 v[130:131], v4, s[48:51], s53 offen
s_add_u32 s53, s53, 9216
buffer_load_dwordx2 v[132:133], v4, s[48:51], s53 offen
s_add_u32 s53, s53, 9216
buffer_load_dwordx2 v[134:135], v4, s[48:51], s53 offen
s_add_u32 s53, s53, 9216
buffer_load_dwordx2 v[136:137], v4, s[48:51], s53 offen
s_add_u32 s53, s53, 9216
buffer_load_dwordx2 v[138:139], v4, s[48:51], s53 offen
s_add_u32 s53, s53, 230400
buffer_load_dwordx2 v[140:141], v5, s[48:51], s53 offen
s_add_u32 s53, s53, 9216
buffer_load_dwordx2 v[142:143], v5, s[48:51], s53 offen
s_add_u32 s53, s53, 9216
buffer_load_dwordx2 v[144:145], v5, s[48:51], s53 offen
s_add_u32 s53, s53, 9216
buffer_load_dwordx2 v[146:147], v5, s[48:51], s53 offen
s_add_u32 s53, s53, 9216
buffer_load_dwordx2 v[148:149], v5, s[48:51], s53 offen
s_add_u32 s53, s53, 9216
buffer_load_dwordx2 v[150:151], v5, s[48:51], s53 offen
s_add_u32 s53, s53, 9216
buffer_load_dwordx2 v[152:153], v5, s[48:51], s53 offen
s_add_u32 s53, s53, 9216
buffer_load_dwordx2 v[154:155], v5, s[48:51], s53 offen
s_add_u32 s53, s53, 230400
s_mov_b32 s34, 0x05040100
s_mov_b32 s35, 0x07060302
s_mov_b32 s38, 0x00003f80
s_mov_b32 s39, 0x3f800000
v_mov_b32 v68, 0x3f803f80
v_mov_b32 v69, 0x3f803f80
v_mov_b32 v70, 0x3f803f80
v_mov_b32 v71, 0x3f803f80
v_and_b32 v72, 15, v1
v_lshlrev_b32 v72, 4, v72
v_add_u32 v72, 159744, v72
s_lshl_b32 s44, s4, 2
v_add_u32 v73, s44, v72
s_waitcnt vmcnt(32)
v_perm_b32 v176, v78, v76, s34
v_perm_b32 v177, v82, v80, s34
v_perm_b32 v178, v86, v84, s34
v_perm_b32 v179, v90, v88, s34
v_perm_b32 v180, v78, v76, s35
v_perm_b32 v181, v82, v80, s35
v_perm_b32 v182, v86, v84, s35
v_perm_b32 v183, v90, v88, s35
v_perm_b32 v184, v79, v77, s34
v_perm_b32 v185, v83, v81, s34
v_perm_b32 v186, v87, v85, s34
v_perm_b32 v187, v91, v89, s34
v_perm_b32 v188, v79, v77, s35
v_perm_b32 v189, v83, v81, s35
v_perm_b32 v190, v87, v85, s35
v_perm_b32 v191, v91, v89, s35
v_mfma_f32_16x16x32_bf16 v[52:55], v[68:71], v[176:179], 0
v_mfma_f32_16x16x32_bf16 v[56:59], v[68:71], v[180:183], 0
v_mfma_f32_16x16x32_bf16 v[60:63], v[68:71], v[184:187], 0
v_mfma_f32_16x16x32_bf16 v[64:67], v[68:71], v[188:191], 0
s_waitcnt vmcnt(24)
v_perm_b32 v192, v94, v92, s34
v_perm_b32 v193, v98, v96, s34
v_perm_b32 v194, v102, v100, s34
v_perm_b32 v195, v106, v104, s34
v_perm_b32 v196, v94, v92, s35
v_perm_b32 v197, v98, v96, s35
v_perm_b32 v198, v102, v100, s35
v_perm_b32 v199, v106, v104, s35
v_perm_b32 v200, v95, v93, s34
v_perm_b32 v201, v99, v97, s34
v_perm_b32 v202, v103, v101, s34
v_perm_b32 v203, v107, v105, s34
v_perm_b32 v204, v95, v93, s35
v_perm_b32 v205, v99, v97, s35
v_perm_b32 v206, v103, v101, s35
v_perm_b32 v207, v107, v105, s35
v_mfma_f32_16x16x32_bf16 v[52:55], v[68:71], v[192:195], v[52:55]
v_mfma_f32_16x16x32_bf16 v[56:59], v[68:71], v[196:199], v[56:59]
v_mfma_f32_16x16x32_bf16 v[60:63], v[68:71], v[200:203], v[60:63]
v_mfma_f32_16x16x32_bf16 v[64:67], v[68:71], v[204:207], v[64:67]
s_waitcnt vmcnt(16)
v_perm_b32 v208, v110, v108, s34
v_perm_b32 v209, v114, v112, s34
v_perm_b32 v210, v118, v116, s34
v_perm_b32 v211, v122, v120, s34
v_perm_b32 v212, v110, v108, s35
v_perm_b32 v213, v114, v112, s35
v_perm_b32 v214, v118, v116, s35
v_perm_b32 v215, v122, v120, s35
v_perm_b32 v216, v111, v109, s34
v_perm_b32 v217, v115, v113, s34
v_perm_b32 v218, v119, v117, s34
v_perm_b32 v219, v123, v121, s34
v_perm_b32 v220, v111, v109, s35
v_perm_b32 v221, v115, v113, s35
v_perm_b32 v222, v119, v117, s35
v_perm_b32 v223, v123, v121, s35
v_mfma_f32_16x16x32_bf16 v[52:55], v[68:71], v[208:211], v[52:55]
v_mfma_f32_16x16x32_bf16 v[56:59], v[68:71], v[212:215], v[56:59]
v_mfma_f32_16x16x32_bf16 v[60:63], v[68:71], v[216:219], v[60:63]
v_mfma_f32_16x16x32_bf16 v[64:67], v[68:71], v[220:223], v[64:67]
s_waitcnt vmcnt(8)
v_perm_b32 v224, v126, v124, s34
v_perm_b32 v225, v130, v128, s34
v_perm_b32 v226, v134, v132, s34
v_perm_b32 v227, v138, v136, s34
v_perm_b32 v228, v126, v124, s35
v_perm_b32 v229, v130, v128, s35
v_perm_b32 v230, v134, v132, s35
v_perm_b32 v231, v138, v136, s35
v_perm_b32 v232, v127, v125, s34
v_perm_b32 v233, v131, v129, s34
v_perm_b32 v234, v135, v133, s34
v_perm_b32 v235, v139, v137, s34
v_perm_b32 v236, v127, v125, s35
v_perm_b32 v237, v131, v129, s35
v_perm_b32 v238, v135, v133, s35
v_perm_b32 v239, v139, v137, s35
v_mfma_f32_16x16x32_bf16 v[52:55], v[68:71], v[224:227], v[52:55]
v_mfma_f32_16x16x32_bf16 v[56:59], v[68:71], v[228:231], v[56:59]
v_mfma_f32_16x16x32_bf16 v[60:63], v[68:71], v[232:235], v[60:63]
v_mfma_f32_16x16x32_bf16 v[64:67], v[68:71], v[236:239], v[64:67]
s_waitcnt vmcnt(0)
v_perm_b32 v240, v142, v140, s34
v_perm_b32 v241, v146, v144, s34
v_perm_b32 v242, v150, v148, s34
v_perm_b32 v243, v154, v152, s34
v_perm_b32 v244, v142, v140, s35
v_perm_b32 v245, v146, v144, s35
v_perm_b32 v246, v150, v148, s35
v_perm_b32 v247, v154, v152, s35
v_perm_b32 v248, v143, v141, s34
v_perm_b32 v249, v147, v145, s34
v_perm_b32 v250, v151, v149, s34
v_perm_b32 v251, v155, v153, s34
v_perm_b32 v252, v143, v141, s35
v_perm_b32 v253, v147, v145, s35
v_perm_b32 v254, v151, v149, s35
v_perm_b32 v255, v155, v153, s35
v_mfma_f32_16x16x32_bf16 v[52:55], v[68:71], v[240:243], v[52:55]
v_mfma_f32_16x16x32_bf16 v[56:59], v[68:71], v[244:247], v[56:59]
v_mfma_f32_16x16x32_bf16 v[60:63], v[68:71], v[248:251], v[60:63]
v_mfma_f32_16x16x32_bf16 v[64:67], v[68:71], v[252:255], v[64:67]
v_readfirstlane_b32 s12, v14
v_readfirstlane_b32 s13, v15
s_add_u32 s68, s12, 1
s_addc_u32 s69, s13, 0
s_nop 0
ds_write_b32 v73, v52 offset:0
ds_write_b32 v73, v56 offset:256
ds_write_b32 v73, v60 offset:512
ds_write_b32 v73, v64 offset:768
s_waitcnt lgkmcnt(0)
s_barrier
ds_read_b128 v[52:55], v72 offset:0
ds_read_b128 v[56:59], v72 offset:256
ds_read_b128 v[60:63], v72 offset:512
ds_read_b128 v[64:67], v72 offset:768
s_waitcnt lgkmcnt(0)
v_add_f32 v52, v52, v53
v_add_f32 v54, v54, v55
v_add_f32 v56, v56, v57
v_add_f32 v58, v58, v59
v_add_f32 v60, v60, v61
v_add_f32 v62, v62, v63
v_add_f32 v64, v64, v65
v_add_f32 v66, v66, v67
v_add_f32 v52, v52, v54
v_add_f32 v56, v56, v58
v_add_f32 v60, v60, v62
v_add_f32 v64, v64, v66
v_mul_f32 v20, 0xbae38e39, v52
v_mul_f32 v21, 0xbae38e39, v56
v_mul_f32 v22, 0xbae38e39, v60
v_mul_f32 v23, 0xbae38e39, v64
v_dot2_f32_bf16 v24, v176, s38, v20
v_dot2_f32_bf16 v25, v176, s39, v20
v_dot2_f32_bf16 v26, v177, s38, v20
v_dot2_f32_bf16 v27, v177, s39, v20
v_dot2_f32_bf16 v28, v178, s38, v20
v_dot2_f32_bf16 v29, v178, s39, v20
v_dot2_f32_bf16 v30, v179, s38, v20
v_dot2_f32_bf16 v31, v179, s39, v20
v_cvt_pk_bf16_f32 v176, v24, v25
v_cvt_pk_bf16_f32 v177, v26, v27
v_cvt_pk_bf16_f32 v178, v28, v29
v_cvt_pk_bf16_f32 v179, v30, v31
v_dot2_f32_bf16 v36, v180, s38, v21
v_dot2_f32_bf16 v37, v180, s39, v21
v_dot2_f32_bf16 v38, v181, s38, v21
v_dot2_f32_bf16 v39, v181, s39, v21
v_dot2_f32_bf16 v40, v182, s38, v21
v_dot2_f32_bf16 v41, v182, s39, v21
v_dot2_f32_bf16 v42, v183, s38, v21
v_dot2_f32_bf16 v43, v183, s39, v21
v_cvt_pk_bf16_f32 v180, v36, v37
v_cvt_pk_bf16_f32 v181, v38, v39
v_cvt_pk_bf16_f32 v182, v40, v41
v_cvt_pk_bf16_f32 v183, v42, v43
v_dot2_f32_bf16 v24, v184, s38, v22
v_dot2_f32_bf16 v25, v184, s39, v22
v_dot2_f32_bf16 v26, v185, s38, v22
v_dot2_f32_bf16 v27, v185, s39, v22
v_dot2_f32_bf16 v28, v186, s38, v22
v_dot2_f32_bf16 v29, v186, s39, v22
v_dot2_f32_bf16 v30, v187, s38, v22
v_dot2_f32_bf16 v31, v187, s39, v22
v_cvt_pk_bf16_f32 v184, v24, v25
v_cvt_pk_bf16_f32 v185, v26, v27
v_cvt_pk_bf16_f32 v186, v28, v29
v_cvt_pk_bf16_f32 v187, v30, v31
v_dot2_f32_bf16 v36, v188, s38, v23
v_dot2_f32_bf16 v37, v188, s39, v23
v_dot2_f32_bf16 v38, v189, s38, v23
v_dot2_f32_bf16 v39, v189, s39, v23
v_dot2_f32_bf16 v40, v190, s38, v23
v_dot2_f32_bf16 v41, v190, s39, v23
v_dot2_f32_bf16 v42, v191, s38, v23
v_dot2_f32_bf16 v43, v191, s39, v23
v_cvt_pk_bf16_f32 v188, v36, v37
v_cvt_pk_bf16_f32 v189, v38, v39
v_cvt_pk_bf16_f32 v190, v40, v41
v_cvt_pk_bf16_f32 v191, v42, v43
v_dot2_f32_bf16 v24, v192, s38, v20
v_dot2_f32_bf16 v25, v192, s39, v20
v_dot2_f32_bf16 v26, v193, s38, v20
v_dot2_f32_bf16 v27, v193, s39, v20
v_dot2_f32_bf16 v28, v194, s38, v20
v_dot2_f32_bf16 v29, v194, s39, v20
v_dot2_f32_bf16 v30, v195, s38, v20
v_dot2_f32_bf16 v31, v195, s39, v20
v_cvt_pk_bf16_f32 v192, v24, v25
v_cvt_pk_bf16_f32 v193, v26, v27
v_cvt_pk_bf16_f32 v194, v28, v29
v_cvt_pk_bf16_f32 v195, v30, v31
v_dot2_f32_bf16 v36, v196, s38, v21
v_dot2_f32_bf16 v37, v196, s39, v21
v_dot2_f32_bf16 v38, v197, s38, v21
v_dot2_f32_bf16 v39, v197, s39, v21
v_dot2_f32_bf16 v40, v198, s38, v21
v_dot2_f32_bf16 v41, v198, s39, v21
v_dot2_f32_bf16 v42, v199, s38, v21
v_dot2_f32_bf16 v43, v199, s39, v21
v_cvt_pk_bf16_f32 v196, v36, v37
v_cvt_pk_bf16_f32 v197, v38, v39
v_cvt_pk_bf16_f32 v198, v40, v41
v_cvt_pk_bf16_f32 v199, v42, v43
v_dot2_f32_bf16 v24, v200, s38, v22
v_dot2_f32_bf16 v25, v200, s39, v22
v_dot2_f32_bf16 v26, v201, s38, v22
v_dot2_f32_bf16 v27, v201, s39, v22
v_dot2_f32_bf16 v28, v202, s38, v22
v_dot2_f32_bf16 v29, v202, s39, v22
v_dot2_f32_bf16 v30, v203, s38, v22
v_dot2_f32_bf16 v31, v203, s39, v22
v_cvt_pk_bf16_f32 v200, v24, v25
v_cvt_pk_bf16_f32 v201, v26, v27
v_cvt_pk_bf16_f32 v202, v28, v29
v_cvt_pk_bf16_f32 v203, v30, v31
v_dot2_f32_bf16 v36, v204, s38, v23
v_dot2_f32_bf16 v37, v204, s39, v23
v_dot2_f32_bf16 v38, v205, s38, v23
v_dot2_f32_bf16 v39, v205, s39, v23
v_dot2_f32_bf16 v40, v206, s38, v23
v_dot2_f32_bf16 v41, v206, s39, v23
v_dot2_f32_bf16 v42, v207, s38, v23
v_dot2_f32_bf16 v43, v207, s39, v23
v_cvt_pk_bf16_f32 v204, v36, v37
v_cvt_pk_bf16_f32 v205, v38, v39
v_cvt_pk_bf16_f32 v206, v40, v41
v_cvt_pk_bf16_f32 v207, v42, v43
v_dot2_f32_bf16 v24, v208, s38, v20
v_dot2_f32_bf16 v25, v208, s39, v20
v_dot2_f32_bf16 v26, v209, s38, v20
v_dot2_f32_bf16 v27, v209, s39, v20
v_dot2_f32_bf16 v28, v210, s38, v20
v_dot2_f32_bf16 v29, v210, s39, v20
v_dot2_f32_bf16 v30, v211, s38, v20
v_dot2_f32_bf16 v31, v211, s39, v20
v_cvt_pk_bf16_f32 v208, v24, v25
v_cvt_pk_bf16_f32 v209, v26, v27
v_cvt_pk_bf16_f32 v210, v28, v29
v_cvt_pk_bf16_f32 v211, v30, v31
v_dot2_f32_bf16 v36, v212, s38, v21
v_dot2_f32_bf16 v37, v212, s39, v21
v_dot2_f32_bf16 v38, v213, s38, v21
v_dot2_f32_bf16 v39, v213, s39, v21
v_dot2_f32_bf16 v40, v214, s38, v21
v_dot2_f32_bf16 v41, v214, s39, v21
v_dot2_f32_bf16 v42, v215, s38, v21
v_dot2_f32_bf16 v43, v215, s39, v21
v_cvt_pk_bf16_f32 v212, v36, v37
v_cvt_pk_bf16_f32 v213, v38, v39
v_cvt_pk_bf16_f32 v214, v40, v41
v_cvt_pk_bf16_f32 v215, v42, v43
v_dot2_f32_bf16 v24, v216, s38, v22
v_dot2_f32_bf16 v25, v216, s39, v22
v_dot2_f32_bf16 v26, v217, s38, v22
v_dot2_f32_bf16 v27, v217, s39, v22
v_dot2_f32_bf16 v28, v218, s38, v22
v_dot2_f32_bf16 v29, v218, s39, v22
v_dot2_f32_bf16 v30, v219, s38, v22
v_dot2_f32_bf16 v31, v219, s39, v22
v_cvt_pk_bf16_f32 v216, v24, v25
v_cvt_pk_bf16_f32 v217, v26, v27
v_cvt_pk_bf16_f32 v218, v28, v29
v_cvt_pk_bf16_f32 v219, v30, v31
v_dot2_f32_bf16 v36, v220, s38, v23
v_dot2_f32_bf16 v37, v220, s39, v23
v_dot2_f32_bf16 v38, v221, s38, v23
v_dot2_f32_bf16 v39, v221, s39, v23
v_dot2_f32_bf16 v40, v222, s38, v23
v_dot2_f32_bf16 v41, v222, s39, v23
v_dot2_f32_bf16 v42, v223, s38, v23
v_dot2_f32_bf16 v43, v223, s39, v23
v_cvt_pk_bf16_f32 v220, v36, v37
v_cvt_pk_bf16_f32 v221, v38, v39
v_cvt_pk_bf16_f32 v222, v40, v41
v_cvt_pk_bf16_f32 v223, v42, v43
v_dot2_f32_bf16 v24, v224, s38, v20
v_dot2_f32_bf16 v25, v224, s39, v20
v_dot2_f32_bf16 v26, v225, s38, v20
v_dot2_f32_bf16 v27, v225, s39, v20
v_dot2_f32_bf16 v28, v226, s38, v20
v_dot2_f32_bf16 v29, v226, s39, v20
v_dot2_f32_bf16 v30, v227, s38, v20
v_dot2_f32_bf16 v31, v227, s39, v20
v_cvt_pk_bf16_f32 v224, v24, v25
v_cvt_pk_bf16_f32 v225, v26, v27
v_cvt_pk_bf16_f32 v226, v28, v29
v_cvt_pk_bf16_f32 v227, v30, v31
v_dot2_f32_bf16 v36, v228, s38, v21
v_dot2_f32_bf16 v37, v228, s39, v21
v_dot2_f32_bf16 v38, v229, s38, v21
v_dot2_f32_bf16 v39, v229, s39, v21
v_dot2_f32_bf16 v40, v230, s38, v21
v_dot2_f32_bf16 v41, v230, s39, v21
v_dot2_f32_bf16 v42, v231, s38, v21
v_dot2_f32_bf16 v43, v231, s39, v21
v_cvt_pk_bf16_f32 v228, v36, v37
v_cvt_pk_bf16_f32 v229, v38, v39
v_cvt_pk_bf16_f32 v230, v40, v41
v_cvt_pk_bf16_f32 v231, v42, v43
v_dot2_f32_bf16 v24, v232, s38, v22
v_dot2_f32_bf16 v25, v232, s39, v22
v_dot2_f32_bf16 v26, v233, s38, v22
v_dot2_f32_bf16 v27, v233, s39, v22
v_dot2_f32_bf16 v28, v234, s38, v22
v_dot2_f32_bf16 v29, v234, s39, v22
v_dot2_f32_bf16 v30, v235, s38, v22
v_dot2_f32_bf16 v31, v235, s39, v22
v_cvt_pk_bf16_f32 v232, v24, v25
v_cvt_pk_bf16_f32 v233, v26, v27
v_cvt_pk_bf16_f32 v234, v28, v29
v_cvt_pk_bf16_f32 v235, v30, v31
v_dot2_f32_bf16 v36, v236, s38, v23
v_dot2_f32_bf16 v37, v236, s39, v23
v_dot2_f32_bf16 v38, v237, s38, v23
v_dot2_f32_bf16 v39, v237, s39, v23
v_dot2_f32_bf16 v40, v238, s38, v23
v_dot2_f32_bf16 v41, v238, s39, v23
v_dot2_f32_bf16 v42, v239, s38, v23
v_dot2_f32_bf16 v43, v239, s39, v23
v_cvt_pk_bf16_f32 v236, v36, v37
v_cvt_pk_bf16_f32 v237, v38, v39
v_cvt_pk_bf16_f32 v238, v40, v41
v_cvt_pk_bf16_f32 v239, v42, v43
v_dot2_f32_bf16 v24, v240, s38, v20
v_dot2_f32_bf16 v25, v240, s39, v20
v_dot2_f32_bf16 v26, v241, s38, v20
v_dot2_f32_bf16 v27, v241, s39, v20
v_dot2_f32_bf16 v28, v242, s38, v20
v_dot2_f32_bf16 v29, v242, s39, v20
v_dot2_f32_bf16 v30, v243, s38, v20
v_dot2_f32_bf16 v31, v243, s39, v20
v_cvt_pk_bf16_f32 v240, v24, v25
v_cvt_pk_bf16_f32 v241, v26, v27
v_cvt_pk_bf16_f32 v242, v28, v29
v_cvt_pk_bf16_f32 v243, v30, v31
v_dot2_f32_bf16 v36, v244, s38, v21
v_dot2_f32_bf16 v37, v244, s39, v21
v_dot2_f32_bf16 v38, v245, s38, v21
v_dot2_f32_bf16 v39, v245, s39, v21
v_dot2_f32_bf16 v40, v246, s38, v21
v_dot2_f32_bf16 v41, v246, s39, v21
v_dot2_f32_bf16 v42, v247, s38, v21
v_dot2_f32_bf16 v43, v247, s39, v21
v_cvt_pk_bf16_f32 v244, v36, v37
v_cvt_pk_bf16_f32 v245, v38, v39
v_cvt_pk_bf16_f32 v246, v40, v41
v_cvt_pk_bf16_f32 v247, v42, v43
v_dot2_f32_bf16 v24, v248, s38, v22
v_dot2_f32_bf16 v25, v248, s39, v22
v_dot2_f32_bf16 v26, v249, s38, v22
v_dot2_f32_bf16 v27, v249, s39, v22
v_dot2_f32_bf16 v28, v250, s38, v22
v_dot2_f32_bf16 v29, v250, s39, v22
v_dot2_f32_bf16 v30, v251, s38, v22
v_dot2_f32_bf16 v31, v251, s39, v22
v_cvt_pk_bf16_f32 v248, v24, v25
v_cvt_pk_bf16_f32 v249, v26, v27
v_cvt_pk_bf16_f32 v250, v28, v29
v_cvt_pk_bf16_f32 v251, v30, v31
v_dot2_f32_bf16 v36, v252, s38, v23
v_dot2_f32_bf16 v37, v252, s39, v23
v_dot2_f32_bf16 v38, v253, s38, v23
v_dot2_f32_bf16 v39, v253, s39, v23
v_dot2_f32_bf16 v40, v254, s38, v23
v_dot2_f32_bf16 v41, v254, s39, v23
v_dot2_f32_bf16 v42, v255, s38, v23
v_dot2_f32_bf16 v43, v255, s39, v23
v_cvt_pk_bf16_f32 v252, v36, v37
v_cvt_pk_bf16_f32 v253, v38, v39
v_cvt_pk_bf16_f32 v254, v40, v41
v_cvt_pk_bf16_f32 v255, v42, v43
s_branch L_p0_e
L_p0_0:
s_sub_u32 s39, s6, 18
s_lshl_b32 s39, s39, 2
s_add_u32 s39, s39, s4
s_cmp_lt_u32 s39, 32
s_cbranch_scc0 L_cr_0
v_and_b32 v9, 7, v1
v_lshrrev_b32 v10, 3, v1
v_mul_u32_u24 v5, 2304, v9
v_lshl_add_u32 v5, v10, 4, v5
s_lshl_b32 s36, s5, 8
s_lshl_b32 s37, s39, 3
s_add_u32 s36, s36, s37
s_and_b32 s37, s36, 1023
s_lshl_b32 s37, s37, 1
s_lshr_b32 s36, s36, 10
s_add_u32 s36, s36, s37
s_mul_i32 s36, s36, 1152
buffer_load_dwordx4 v[16:19], v5, s[16:19], s36 offen offset:0
buffer_load_dwordx4 v[20:23], v5, s[16:19], s36 offen offset:128
buffer_load_dwordx4 v[24:27], v5, s[16:19], s36 offen offset:256
buffer_load_dwordx4 v[28:31], v5, s[16:19], s36 offen offset:384
buffer_load_dwordx4 v[32:35], v5, s[16:19], s36 offen offset:512
buffer_load_dwordx4 v[36:39], v5, s[16:19], s36 offen offset:640
buffer_load_dwordx4 v[40:43], v5, s[16:19], s36 offen offset:768
buffer_load_dwordx4 v[44:47], v5, s[16:19], s36 offen offset:896
buffer_load_dwordx4 v[48:51], v5, s[16:19], s36 offen offset:1024
s_and_b32 s37, s39, 1
s_lshl_b32 s37, s37, 3
v_add_u32 v9, s37, v9
v_lshlrev_b32 v9, 4, v9
v_lshl_add_u32 v4, v10, 8, v9
s_lshl_b32 s36, s5, 4
s_lshr_b32 s37, s39, 1
s_add_u32 s36, s36, s37
s_mul_i32 s36, s36, 18432
s_lshr_b32 s40, s39, 2
s_mov_b32 s44, s58
s_and_b32 s45, s59, 0xffff
s_mov_b32 s46, 1990656
s_mov_b32 s47, 0x20000
s_mul_i32 s42, s40, 110592
s_mul_i32 s43, s4, 27648
s_add_u32 s42, s42, s43
s_mul_i32 s43, s5, 144
s_add_u32 s42, s42, s43
s_lshl_b32 s43, s4, 11
s_add_u32 s43, s43, 0
v_mul_u32_u24 v9, 3456, v7
v_lshl_add_u32 v9, v6, 4, v9
v_cmp_gt_u32 vcc, 9, v6
s_nop 1
v_cndmask_b32 v9, v12, v9, vcc
s_add_u32 m0, s43, 0
s_add_u32 s41, s42, 0
buffer_load_dwordx4 v9, s[44:47], s41 offen lds
s_add_u32 m0, s43, 1024
s_add_u32 s41, s42, 13824
buffer_load_dwordx4 v9, s[44:47], s41 offen lds
s_lshl_b32 s43, s4, 11
s_add_u32 s43, s43, 8192
s_add_u32 m0, s43, 0
s_add_u32 s41, s42, 1152
buffer_load_dwordx4 v9, s[44:47], s41 offen lds
s_add_u32 m0, s43, 1024
s_add_u32 s41, s42, 14976
buffer_load_dwordx4 v9, s[44:47], s41 offen lds
s_lshl_b32 s43, s4, 11
s_add_u32 s43, s43, 16384
s_add_u32 m0, s43, 0
s_add_u32 s41, s42, 2304
buffer_load_dwordx4 v9, s[44:47], s41 offen lds
s_add_u32 m0, s43, 1024
s_add_u32 s41, s42, 16128
buffer_load_dwordx4 v9, s[44:47], s41 offen lds
s_waitcnt vmcnt(6)
v_lshlrev_b32 v52, 16, v16
v_and_b32 v53, 0xffff0000, v16
v_lshlrev_b32 v54, 16, v17
v_and_b32 v55, 0xffff0000, v17
v_lshlrev_b32 v56, 16, v18
v_and_b32 v57, 0xffff0000, v18
v_lshlrev_b32 v58, 16, v19
v_and_b32 v59, 0xffff0000, v19
v_lshlrev_b32 v60, 16, v20
v_and_b32 v61, 0xffff0000, v20
v_lshlrev_b32 v62, 16, v21
v_and_b32 v63, 0xffff0000, v21
v_lshlrev_b32 v64, 16, v22
v_and_b32 v65, 0xffff0000, v22
v_lshlrev_b32 v66, 16, v23
v_and_b32 v67, 0xffff0000, v23
v_lshlrev_b32 v68, 16, v24
v_and_b32 v69, 0xffff0000, v24
v_lshlrev_b32 v70, 16, v25
v_and_b32 v71, 0xffff0000, v25
v_lshlrev_b32 v72, 16, v26
v_and_b32 v73, 0xffff0000, v26
v_lshlrev_b32 v74, 16, v27
v_and_b32 v75, 0xffff0000, v27
v_lshlrev_b32 v76, 16, v28
v_and_b32 v77, 0xffff0000, v28
v_lshlrev_b32 v78, 16, v29
v_and_b32 v79, 0xffff0000, v29
v_lshlrev_b32 v80, 16, v30
v_and_b32 v81, 0xffff0000, v30
v_lshlrev_b32 v82, 16, v31
v_and_b32 v83, 0xffff0000, v31
v_lshlrev_b32 v84, 16, v32
v_and_b32 v85, 0xffff0000, v32
v_lshlrev_b32 v86, 16, v33
v_and_b32 v87, 0xffff0000, v33
v_lshlrev_b32 v88, 16, v34
v_and_b32 v89, 0xffff0000, v34
v_lshlrev_b32 v90, 16, v35
v_and_b32 v91, 0xffff0000, v35
v_lshlrev_b32 v92, 16, v36
v_and_b32 v93, 0xffff0000, v36
v_lshlrev_b32 v94, 16, v37
v_and_b32 v95, 0xffff0000, v37
v_lshlrev_b32 v96, 16, v38
v_and_b32 v97, 0xffff0000, v38
v_lshlrev_b32 v98, 16, v39
v_and_b32 v99, 0xffff0000, v39
v_lshlrev_b32 v100, 16, v40
v_and_b32 v101, 0xffff0000, v40
v_lshlrev_b32 v102, 16, v41
v_and_b32 v103, 0xffff0000, v41
v_lshlrev_b32 v104, 16, v42
v_and_b32 v105, 0xffff0000, v42
v_lshlrev_b32 v106, 16, v43
v_and_b32 v107, 0xffff0000, v43
v_lshlrev_b32 v108, 16, v44
v_and_b32 v109, 0xffff0000, v44
v_lshlrev_b32 v110, 16, v45
v_and_b32 v111, 0xffff0000, v45
v_lshlrev_b32 v112, 16, v46
v_and_b32 v113, 0xffff0000, v46
v_lshlrev_b32 v114, 16, v47
v_and_b32 v115, 0xffff0000, v47
v_lshlrev_b32 v116, 16, v48
v_and_b32 v117, 0xffff0000, v48
v_lshlrev_b32 v118, 16, v49
v_and_b32 v119, 0xffff0000, v49
v_lshlrev_b32 v120, 16, v50
v_and_b32 v121, 0xffff0000, v50
v_lshlrev_b32 v122, 16, v51
v_and_b32 v123, 0xffff0000, v51
s_mov_b32 s37, 0x3f803f80
v_mov_b32 v6, 0
v_mov_b32 v7, 0
v_mov_b32 v8, 0
v_mov_b32 v9, 0
v_dot2_f32_bf16 v6, v16, s37, v6
v_dot2_f32_bf16 v8, v16, v16, v8
v_dot2_f32_bf16 v7, v17, s37, v7
v_dot2_f32_bf16 v9, v17, v17, v9
v_dot2_f32_bf16 v6, v18, s37, v6
v_dot2_f32_bf16 v8, v18, v18, v8
v_dot2_f32_bf16 v7, v19, s37, v7
v_dot2_f32_bf16 v9, v19, v19, v9
v_dot2_f32_bf16 v6, v20, s37, v6
v_dot2_f32_bf16 v8, v20, v20, v8
v_dot2_f32_bf16 v7, v21, s37, v7
v_dot2_f32_bf16 v9, v21, v21, v9
v_dot2_f32_bf16 v6, v22, s37, v6
v_dot2_f32_bf16 v8, v22, v22, v8
v_dot2_f32_bf16 v7, v23, s37, v7
v_dot2_f32_bf16 v9, v23, v23, v9
v_dot2_f32_bf16 v6, v24, s37, v6
v_dot2_f32_bf16 v8, v24, v24, v8
v_dot2_f32_bf16 v7, v25, s37, v7
v_dot2_f32_bf16 v9, v25, v25, v9
v_dot2_f32_bf16 v6, v26, s37, v6
v_dot2_f32_bf16 v8, v26, v26, v8
v_dot2_f32_bf16 v7, v27, s37, v7
v_dot2_f32_bf16 v9, v27, v27, v9
v_dot2_f32_bf16 v6, v28, s37, v6
v_dot2_f32_bf16 v8, v28, v28, v8
v_dot2_f32_bf16 v7, v29, s37, v7
v_dot2_f32_bf16 v9, v29, v29, v9
v_dot2_f32_bf16 v6, v30, s37, v6
v_dot2_f32_bf16 v8, v30, v30, v8
v_dot2_f32_bf16 v7, v31, s37, v7
v_dot2_f32_bf16 v9, v31, v31, v9
v_dot2_f32_bf16 v6, v32, s37, v6
v_dot2_f32_bf16 v8, v32, v32, v8
v_dot2_f32_bf16 v7, v33, s37, v7
v_dot2_f32_bf16 v9, v33, v33, v9
v_dot2_f32_bf16 v6, v34, s37, v6
v_dot2_f32_bf16 v8, v34, v34, v8
v_dot2_f32_bf16 v7, v35, s37, v7
v_dot2_f32_bf16 v9, v35, v35, v9
v_dot2_f32_bf16 v6, v36, s37, v6
v_dot2_f32_bf16 v8, v36, v36, v8
v_dot2_f32_bf16 v7, v37, s37, v7
v_dot2_f32_bf16 v9, v37, v37, v9
v_dot2_f32_bf16 v6, v38, s37, v6
v_dot2_f32_bf16 v8, v38, v38, v8
v_dot2_f32_bf16 v7, v39, s37, v7
v_dot2_f32_bf16 v9, v39, v39, v9
v_dot2_f32_bf16 v6, v40, s37, v6
v_dot2_f32_bf16 v8, v40, v40, v8
v_dot2_f32_bf16 v7, v41, s37, v7
v_dot2_f32_bf16 v9, v41, v41, v9
v_dot2_f32_bf16 v6, v42, s37, v6
v_dot2_f32_bf16 v8, v42, v42, v8
v_dot2_f32_bf16 v7, v43, s37, v7
v_dot2_f32_bf16 v9, v43, v43, v9
v_dot2_f32_bf16 v6, v44, s37, v6
v_dot2_f32_bf16 v8, v44, v44, v8
v_dot2_f32_bf16 v7, v45, s37, v7
v_dot2_f32_bf16 v9, v45, v45, v9
v_dot2_f32_bf16 v6, v46, s37, v6
v_dot2_f32_bf16 v8, v46, v46, v8
v_dot2_f32_bf16 v7, v47, s37, v7
v_dot2_f32_bf16 v9, v47, v47, v9
v_dot2_f32_bf16 v6, v48, s37, v6
v_dot2_f32_bf16 v8, v48, v48, v8
v_dot2_f32_bf16 v7, v49, s37, v7
v_dot2_f32_bf16 v9, v49, v49, v9
v_dot2_f32_bf16 v6, v50, s37, v6
v_dot2_f32_bf16 v8, v50, v50, v8
v_dot2_f32_bf16 v7, v51, s37, v7
v_dot2_f32_bf16 v9, v51, v51, v9
s_add_u32 s37, s36, 27688960
buffer_store_dwordx4 v[16:19], v4, s[8:11], s37 offen offset:0 sc1
buffer_store_dwordx4 v[20:23], v4, s[8:11], s37 offen offset:2048 sc1
s_add_u32 s37, s36, 27693056
buffer_store_dwordx4 v[24:27], v4, s[8:11], s37 offen offset:0 sc1
buffer_store_dwordx4 v[28:31], v4, s[8:11], s37 offen offset:2048 sc1
s_add_u32 s37, s36, 27697152
buffer_store_dwordx4 v[32:35], v4, s[8:11], s37 offen offset:0 sc1
buffer_store_dwordx4 v[36:39], v4, s[8:11], s37 offen offset:2048 sc1
s_add_u32 s37, s36, 27701248
buffer_store_dwordx4 v[40:43], v4, s[8:11], s37 offen offset:0 sc1
buffer_store_dwordx4 v[44:47], v4, s[8:11], s37 offen offset:2048 sc1
s_add_u32 s37, s36, 27705344
buffer_store_dwordx4 v[48:51], v4, s[8:11], s37 offen offset:0 sc1
v_add_f32 v6, v6, v7
v_add_f32 v7, v8, v9
s_nop 0
v_add_f32_dpp v6, v6, v6 row_ror:8 row_mask:0xf bank_mask:0xf
v_add_f32_dpp v7, v7, v7 row_ror:8 row_mask:0xf bank_mask:0xf
v_mov_b32 v8, v6
v_mov_b32 v9, v7
s_nop 0
v_permlane16_swap_b32 v6, v8
v_permlane16_swap_b32 v7, v9
v_add_f32 v6, v6, v8
v_add_f32 v7, v7, v9
v_mov_b32 v8, v6
v_mov_b32 v9, v7
s_nop 0
v_permlane32_swap_b32 v6, v8
v_permlane32_swap_b32 v7, v9
v_add_f32 v6, v6, v8
v_add_f32 v7, v7, v9
v_mul_f32 v6, 0x3ae38e39, v6
v_mul_f32 v7, 0x3ae38e39, v7
v_fma_f32 v7, -v6, v6, v7
v_max_f32 v7, 0, v7
v_add_f32 v7, 0x3727c5ac, v7
v_rsq_f32 v7, v7
s_nop 0
v_mul_f32 v6, v6, v7
v_fma_f32 v52, v52, v7, -v6
v_fma_f32 v53, v53, v7, -v6
v_fma_f32 v54, v54, v7, -v6
v_fma_f32 v55, v55, v7, -v6
v_fma_f32 v56, v56, v7, -v6
v_fma_f32 v57, v57, v7, -v6
v_fma_f32 v58, v58, v7, -v6
v_fma_f32 v59, v59, v7, -v6
v_fma_f32 v60, v60, v7, -v6
v_fma_f32 v61, v61, v7, -v6
v_fma_f32 v62, v62, v7, -v6
v_fma_f32 v63, v63, v7, -v6
v_fma_f32 v64, v64, v7, -v6
v_fma_f32 v65, v65, v7, -v6
v_fma_f32 v66, v66, v7, -v6
v_fma_f32 v67, v67, v7, -v6
v_fma_f32 v68, v68, v7, -v6
v_fma_f32 v69, v69, v7, -v6
v_fma_f32 v70, v70, v7, -v6
v_fma_f32 v71, v71, v7, -v6
v_fma_f32 v72, v72, v7, -v6
v_fma_f32 v73, v73, v7, -v6
v_fma_f32 v74, v74, v7, -v6
v_fma_f32 v75, v75, v7, -v6
v_fma_f32 v76, v76, v7, -v6
v_fma_f32 v77, v77, v7, -v6
v_fma_f32 v78, v78, v7, -v6
v_fma_f32 v79, v79, v7, -v6
v_fma_f32 v80, v80, v7, -v6
v_fma_f32 v81, v81, v7, -v6
v_fma_f32 v82, v82, v7, -v6
v_fma_f32 v83, v83, v7, -v6
v_fma_f32 v84, v84, v7, -v6
v_fma_f32 v85, v85, v7, -v6
v_fma_f32 v86, v86, v7, -v6
v_fma_f32 v87, v87, v7, -v6
v_fma_f32 v88, v88, v7, -v6
v_fma_f32 v89, v89, v7, -v6
v_fma_f32 v90, v90, v7, -v6
v_fma_f32 v91, v91, v7, -v6
v_fma_f32 v92, v92, v7, -v6
v_fma_f32 v93, v93, v7, -v6
v_fma_f32 v94, v94, v7, -v6
v_fma_f32 v95, v95, v7, -v6
v_fma_f32 v96, v96, v7, -v6
v_fma_f32 v97, v97, v7, -v6
v_fma_f32 v98, v98, v7, -v6
v_fma_f32 v99, v99, v7, -v6
v_fma_f32 v100, v100, v7, -v6
v_fma_f32 v101, v101, v7, -v6
v_fma_f32 v102, v102, v7, -v6
v_fma_f32 v103, v103, v7, -v6
v_fma_f32 v104, v104, v7, -v6
v_fma_f32 v105, v105, v7, -v6
v_fma_f32 v106, v106, v7, -v6
v_fma_f32 v107, v107, v7, -v6
v_fma_f32 v108, v108, v7, -v6
v_fma_f32 v109, v109, v7, -v6
v_fma_f32 v110, v110, v7, -v6
v_fma_f32 v111, v111, v7, -v6
v_fma_f32 v112, v112, v7, -v6
v_fma_f32 v113, v113, v7, -v6
v_fma_f32 v114, v114, v7, -v6
v_fma_f32 v115, v115, v7, -v6
v_fma_f32 v116, v116, v7, -v6
v_fma_f32 v117, v117, v7, -v6
v_fma_f32 v118, v118, v7, -v6
v_fma_f32 v119, v119, v7, -v6
v_fma_f32 v120, v120, v7, -v6
v_fma_f32 v121, v121, v7, -v6
v_fma_f32 v122, v122, v7, -v6
v_fma_f32 v123, v123, v7, -v6
v_cvt_pk_bf16_f32 v16, v52, v53
v_cvt_pk_bf16_f32 v17, v54, v55
v_cvt_pk_bf16_f32 v18, v56, v57
v_cvt_pk_bf16_f32 v19, v58, v59
v_cvt_pk_bf16_f32 v20, v60, v61
v_cvt_pk_bf16_f32 v21, v62, v63
v_cvt_pk_bf16_f32 v22, v64, v65
v_cvt_pk_bf16_f32 v23, v66, v67
v_cvt_pk_bf16_f32 v24, v68, v69
v_cvt_pk_bf16_f32 v25, v70, v71
v_cvt_pk_bf16_f32 v26, v72, v73
v_cvt_pk_bf16_f32 v27, v74, v75
v_cvt_pk_bf16_f32 v28, v76, v77
v_cvt_pk_bf16_f32 v29, v78, v79
v_cvt_pk_bf16_f32 v30, v80, v81
v_cvt_pk_bf16_f32 v31, v82, v83
v_cvt_pk_bf16_f32 v32, v84, v85
v_cvt_pk_bf16_f32 v33, v86, v87
v_cvt_pk_bf16_f32 v34, v88, v89
v_cvt_pk_bf16_f32 v35, v90, v91
v_cvt_pk_bf16_f32 v36, v92, v93
v_cvt_pk_bf16_f32 v37, v94, v95
v_cvt_pk_bf16_f32 v38, v96, v97
v_cvt_pk_bf16_f32 v39, v98, v99
v_cvt_pk_bf16_f32 v40, v100, v101
v_cvt_pk_bf16_f32 v41, v102, v103
v_cvt_pk_bf16_f32 v42, v104, v105
v_cvt_pk_bf16_f32 v43, v106, v107
v_cvt_pk_bf16_f32 v44, v108, v109
v_cvt_pk_bf16_f32 v45, v110, v111
v_cvt_pk_bf16_f32 v46, v112, v113
v_cvt_pk_bf16_f32 v47, v114, v115
v_cvt_pk_bf16_f32 v48, v116, v117
v_cvt_pk_bf16_f32 v49, v118, v119
v_cvt_pk_bf16_f32 v50, v120, v121
v_cvt_pk_bf16_f32 v51, v122, v123
s_add_u32 s37, s36, 22970368
buffer_store_dwordx4 v[16:19], v4, s[8:11], s37 offen offset:0 sc1
buffer_store_dwordx4 v[20:23], v4, s[8:11], s37 offen offset:2048 sc1
s_add_u32 s37, s36, 22974464
buffer_store_dwordx4 v[24:27], v4, s[8:11], s37 offen offset:0 sc1
buffer_store_dwordx4 v[28:31], v4, s[8:11], s37 offen offset:2048 sc1
s_add_u32 s37, s36, 22978560
buffer_store_dwordx4 v[32:35], v4, s[8:11], s37 offen offset:0 sc1
buffer_store_dwordx4 v[36:39], v4, s[8:11], s37 offen offset:2048 sc1
s_add_u32 s37, s36, 22982656
buffer_store_dwordx4 v[40:43], v4, s[8:11], s37 offen offset:0 sc1
buffer_store_dwordx4 v[44:47], v4, s[8:11], s37 offen offset:2048 sc1
s_add_u32 s37, s36, 22986752
buffer_store_dwordx4 v[48:51], v4, s[8:11], s37 offen offset:0 sc1
s_waitcnt vmcnt(18)
s_barrier
v_readfirstlane_b32 s12, v14
v_readfirstlane_b32 s13, v15
s_add_u32 s68, s12, 1
s_addc_u32 s69, s13, 0
s_and_b32 s41, s4, 1
s_mul_i32 s42, s41, 72
s_lshl_b32 s43, s5, 1
s_add_u32 s41, s41, s43
s_mul_i32 s41, s41, 129024
s_mul_i32 s43, s40, 7168
s_add_u32 s41, s41, s43
s_add_u32 s41, s41, 4198400
s_lshr_b32 s43, s4, 1
s_lshl_b32 s29, s43, 12
s_add_u32 s41, s41, s29
v_and_b32 v6, 15, v1
v_lshrrev_b32 v7, 4, v1
v_lshlrev_b32 v10, 11, v7
v_add_u32 v10, s42, v10
v_lshl_add_u32 v11, v6, 1, v10
v_and_b32 v9, 1, v6
v_bfe_u32 v13, v6, 1, 1
v_mad_u32_u24 v9, v13, 18, v9
v_lshl_add_u32 v9, v9, 1, v10
v_lshrrev_b32 v13, 2, v6
v_lshl_add_u32 v9, v13, 13, v9
v_add_u32 v9, 32, v9
v_mov_b32 v13, 160
v_cmp_gt_u32 vcc, 12, v6
s_nop 1
v_cndmask_b32 v9, v13, v9, vcc
s_cmp_eq_u32 s43, 0
s_cselect_b64 vcc, -1, 0
v_add_u32 v4, 0, v11
v_cndmask_b32 v4, v9, v4, vcc
v_add_u32 v5, 36, v11
v_add_u32 v13, 16384, v11
v_cndmask_b32 v5, v13, v5, vcc
v_add_u32 v6, 8192, v11
v_add_u32 v13, 16420, v11
v_cndmask_b32 v6, v13, v6, vcc
v_add_u32 v7, 8228, v11
v_add_u32 v13, 0, v11
v_cndmask_b32 v7, v13, v7, vcc
s_add_u32 s20, s41, 0
s_add_u32 s29, s40, 0
s_cmp_lt_u32 s29, 18
s_cselect_b32 s20, s20, 2146435072
s_cmp_eq_u32 s43, 0
s_cselect_b32 s21, s20, 2146435072
ds_read_u16 v124, v4 offset:0
ds_read_u16 v125, v4 offset:256
ds_read_u16 v126, v4 offset:512
ds_read_u16 v127, v4 offset:768
ds_read_u16 v128, v4 offset:1024
ds_read_u16 v129, v4 offset:1280
ds_read_u16 v130, v4 offset:1536
ds_read_u16 v131, v4 offset:1792
ds_read_u16 v132, v5 offset:0
ds_read_u16 v133, v5 offset:256
ds_read_u16 v134, v5 offset:512
ds_read_u16 v135, v5 offset:768
ds_read_u16 v136, v5 offset:1024
ds_read_u16 v137, v5 offset:1280
ds_read_u16 v138, v5 offset:1536
ds_read_u16 v139, v5 offset:1792
s_waitcnt lgkmcnt(8)
v_lshl_or_b32 v124, v125, 16, v124
v_lshl_or_b32 v125, v127, 16, v126
v_lshl_or_b32 v126, v129, 16, v128
v_lshl_or_b32 v127, v131, 16, v130
buffer_store_dwordx4 v[124:127], v2, s[8:11], s20 offen offset:0 sc1
ds_read_u16 v140, v6 offset:0
ds_read_u16 v141, v6 offset:256
ds_read_u16 v142, v6 offset:512
ds_read_u16 v143, v6 offset:768
ds_read_u16 v144, v6 offset:1024
ds_read_u16 v145, v6 offset:1280
ds_read_u16 v146, v6 offset:1536
ds_read_u16 v147, v6 offset:1792
s_waitcnt lgkmcnt(8)
v_lshl_or_b32 v132, v133, 16, v132
v_lshl_or_b32 v133, v135, 16, v134
v_lshl_or_b32 v134, v137, 16, v136
v_lshl_or_b32 v135, v139, 16, v138
buffer_store_dwordx4 v[132:135], v2, s[8:11], s20 offen offset:1024 sc1
ds_read_u16 v148, v7 offset:0
ds_read_u16 v149, v7 offset:256
ds_read_u16 v150, v7 offset:512
ds_read_u16 v151, v7 offset:768
ds_read_u16 v152, v7 offset:1024
ds_read_u16 v153, v7 offset:1280
ds_read_u16 v154, v7 offset:1536
ds_read_u16 v155, v7 offset:1792
s_waitcnt lgkmcnt(8)
v_lshl_or_b32 v140, v141, 16, v140
v_lshl_or_b32 v141, v143, 16, v142
v_lshl_or_b32 v142, v145, 16, v144
v_lshl_or_b32 v143, v147, 16, v146
buffer_store_dwordx4 v[140:143], v2, s[8:11], s20 offen offset:2048 sc1
s_waitcnt lgkmcnt(0)
v_lshl_or_b32 v148, v149, 16, v148
v_lshl_or_b32 v149, v151, 16, v150
v_lshl_or_b32 v150, v153, 16, v152
v_lshl_or_b32 v151, v155, 16, v154
buffer_store_dwordx4 v[148:151], v2, s[8:11], s21 offen offset:3072 sc1
s_branch L_cr_e
L_cr_0:
s_cmp_lt_u32 s39, 48
s_cbranch_scc0 L_cr_1
s_lshr_b32 s40, s39, 2
s_mul_i32 s40, s40, 3
s_sub_u32 s40, s40, 16
s_mov_b32 s44, s58
s_and_b32 s45, s59, 0xffff
s_mov_b32 s46, 1990656
s_mov_b32 s47, 0x20000
s_mul_i32 s42, s40, 110592
s_mul_i32 s43, s4, 27648
s_add_u32 s42, s42, s43
s_mul_i32 s43, s5, 144
s_add_u32 s42, s42, s43
s_lshl_b32 s43, s4, 11
s_add_u32 s43, s43, 0
v_mul_u32_u24 v9, 3456, v7
v_lshl_add_u32 v9, v6, 4, v9
v_cmp_gt_u32 vcc, 9, v6
s_nop 1
v_cndmask_b32 v9, v12, v9, vcc
s_add_u32 m0, s43, 0
s_add_u32 s41, s42, 0
buffer_load_dwordx4 v9, s[44:47], s41 offen lds
s_add_u32 m0, s43, 1024
s_add_u32 s41, s42, 13824
buffer_load_dwordx4 v9, s[44:47], s41 offen lds
s_lshl_b32 s43, s4, 11
s_add_u32 s43, s43, 8192
s_add_u32 m0, s43, 0
s_add_u32 s41, s42, 1152
buffer_load_dwordx4 v9, s[44:47], s41 offen lds
s_add_u32 m0, s43, 1024
s_add_u32 s41, s42, 14976
buffer_load_dwordx4 v9, s[44:47], s41 offen lds
s_lshl_b32 s43, s4, 11
s_add_u32 s43, s43, 16384
s_add_u32 m0, s43, 0
s_add_u32 s41, s42, 2304
buffer_load_dwordx4 v9, s[44:47], s41 offen lds
s_add_u32 m0, s43, 1024
s_add_u32 s41, s42, 16128
buffer_load_dwordx4 v9, s[44:47], s41 offen lds
s_lshl_b32 s43, s4, 11
s_add_u32 s43, s43, 24576
s_add_u32 m0, s43, 0
s_add_u32 s41, s42, 110592
buffer_load_dwordx4 v9, s[44:47], s41 offen lds
s_add_u32 m0, s43, 1024
s_add_u32 s41, s42, 124416
buffer_load_dwordx4 v9, s[44:47], s41 offen lds
s_lshl_b32 s43, s4, 11
s_add_u32 s43, s43, 32768
s_add_u32 m0, s43, 0
s_add_u32 s41, s42, 111744
buffer_load_dwordx4 v9, s[44:47], s41 offen lds
s_add_u32 m0, s43, 1024
s_add_u32 s41, s42, 125568
buffer_load_dwordx4 v9, s[44:47], s41 offen lds
s_lshl_b32 s43, s4, 11
s_add_u32 s43, s43, 40960
s_add_u32 m0, s43, 0
s_add_u32 s41, s42, 112896
buffer_load_dwordx4 v9, s[44:47], s41 offen lds
s_add_u32 m0, s43, 1024
s_add_u32 s41, s42, 126720
buffer_load_dwordx4 v9, s[44:47], s41 offen lds
s_lshl_b32 s43, s4, 11
s_add_u32 s43, s43, 49152
s_add_u32 m0, s43, 0
s_add_u32 s41, s42, 221184
buffer_load_dwordx4 v9, s[44:47], s41 offen lds
s_add_u32 m0, s43, 1024
s_add_u32 s41, s42, 235008
buffer_load_dwordx4 v9, s[44:47], s41 offen lds
s_lshl_b32 s43, s4, 11
s_add_u32 s43, s43, 57344
s_add_u32 m0, s43, 0
s_add_u32 s41, s42, 222336
buffer_load_dwordx4 v9, s[44:47], s41 offen lds
s_add_u32 m0, s43, 1024
s_add_u32 s41, s42, 236160
buffer_load_dwordx4 v9, s[44:47], s41 offen lds
s_lshl_b32 s43, s4, 11
s_add_u32 s43, s43, 65536
s_add_u32 m0, s43, 0
s_add_u32 s41, s42, 223488
buffer_load_dwordx4 v9, s[44:47], s41 offen lds
s_add_u32 m0, s43, 1024
s_add_u32 s41, s42, 237312
buffer_load_dwordx4 v9, s[44:47], s41 offen lds
s_waitcnt vmcnt(0)
s_barrier
v_readfirstlane_b32 s12, v14
v_readfirstlane_b32 s13, v15
s_add_u32 s68, s12, 1
s_addc_u32 s69, s13, 0
s_and_b32 s41, s4, 1
s_mul_i32 s42, s41, 72
s_lshl_b32 s43, s5, 1
s_add_u32 s41, s41, s43
s_mul_i32 s41, s41, 129024
s_mul_i32 s43, s40, 7168
s_add_u32 s41, s41, s43
s_add_u32 s41, s41, 4198400
s_lshr_b32 s43, s4, 1
s_lshl_b32 s29, s43, 12
s_add_u32 s41, s41, s29
v_and_b32 v6, 15, v1
v_lshrrev_b32 v7, 4, v1
v_lshlrev_b32 v10, 11, v7
v_add_u32 v10, s42, v10
v_lshl_add_u32 v11, v6, 1, v10
v_and_b32 v9, 1, v6
v_bfe_u32 v13, v6, 1, 1
v_mad_u32_u24 v9, v13, 18, v9
v_lshl_add_u32 v9, v9, 1, v10
v_lshrrev_b32 v13, 2, v6
v_lshl_add_u32 v9, v13, 13, v9
v_add_u32 v9, 32, v9
v_mov_b32 v13, 160
v_cmp_gt_u32 vcc, 12, v6
s_nop 1
v_cndmask_b32 v9, v13, v9, vcc
s_cmp_eq_u32 s43, 0
s_cselect_b64 vcc, -1, 0
v_add_u32 v4, 0, v11
v_cndmask_b32 v4, v9, v4, vcc
v_add_u32 v5, 36, v11
v_add_u32 v13, 16384, v11
v_cndmask_b32 v5, v13, v5, vcc
v_add_u32 v6, 8192, v11
v_add_u32 v13, 16420, v11
v_cndmask_b32 v6, v13, v6, vcc
v_add_u32 v7, 8228, v11
v_add_u32 v13, 0, v11
v_cndmask_b32 v7, v13, v7, vcc
s_add_u32 s20, s41, 0
s_add_u32 s29, s40, 0
s_cmp_lt_u32 s29, 18
s_cselect_b32 s20, s20, 2146435072
s_cmp_eq_u32 s43, 0
s_cselect_b32 s21, s20, 2146435072
s_add_u32 s22, s41, 7168
s_add_u32 s29, s40, 1
s_cmp_lt_u32 s29, 18
s_cselect_b32 s22, s22, 2146435072
s_cmp_eq_u32 s43, 0
s_cselect_b32 s23, s22, 2146435072
s_add_u32 s24, s41, 14336
s_add_u32 s29, s40, 2
s_cmp_lt_u32 s29, 18
s_cselect_b32 s24, s24, 2146435072
s_cmp_eq_u32 s43, 0
s_cselect_b32 s25, s24, 2146435072
ds_read_u16 v124, v4 offset:0
ds_read_u16 v125, v4 offset:256
ds_read_u16 v126, v4 offset:512
ds_read_u16 v127, v4 offset:768
ds_read_u16 v128, v4 offset:1024
ds_read_u16 v129, v4 offset:1280
ds_read_u16 v130, v4 offset:1536
ds_read_u16 v131, v4 offset:1792
ds_read_u16 v132, v5 offset:0
ds_read_u16 v133, v5 offset:256
ds_read_u16 v134, v5 offset:512
ds_read_u16 v135, v5 offset:768
ds_read_u16 v136, v5 offset:1024
ds_read_u16 v137, v5 offset:1280
ds_read_u16 v138, v5 offset:1536
ds_read_u16 v139, v5 offset:1792
s_waitcnt lgkmcnt(8)
v_lshl_or_b32 v124, v125, 16, v124
v_lshl_or_b32 v125, v127, 16, v126
v_lshl_or_b32 v126, v129, 16, v128
v_lshl_or_b32 v127, v131, 16, v130
buffer_store_dwordx4 v[124:127], v2, s[8:11], s20 offen offset:0 sc1
ds_read_u16 v140, v6 offset:0
ds_read_u16 v141, v6 offset:256
ds_read_u16 v142, v6 offset:512
ds_read_u16 v143, v6 offset:768
ds_read_u16 v144, v6 offset:1024
ds_read_u16 v145, v6 offset:1280
ds_read_u16 v146, v6 offset:1536
ds_read_u16 v147, v6 offset:1792
s_waitcnt lgkmcnt(8)
v_lshl_or_b32 v132, v133, 16, v132
v_lshl_or_b32 v133, v135, 16, v134
v_lshl_or_b32 v134, v137, 16, v136
v_lshl_or_b32 v135, v139, 16, v138
buffer_store_dwordx4 v[132:135], v2, s[8:11], s20 offen offset:1024 sc1
ds_read_u16 v148, v7 offset:0
ds_read_u16 v149, v7 offset:256
ds_read_u16 v150, v7 offset:512
ds_read_u16 v151, v7 offset:768
ds_read_u16 v152, v7 offset:1024
ds_read_u16 v153, v7 offset:1280
ds_read_u16 v154, v7 offset:1536
ds_read_u16 v155, v7 offset:1792
s_waitcnt lgkmcnt(8)
v_lshl_or_b32 v140, v141, 16, v140
v_lshl_or_b32 v141, v143, 16, v142
v_lshl_or_b32 v142, v145, 16, v144
v_lshl_or_b32 v143, v147, 16, v146
buffer_store_dwordx4 v[140:143], v2, s[8:11], s20 offen offset:2048 sc1
ds_read_u16 v124, v4 offset:24576
ds_read_u16 v125, v4 offset:24832
ds_read_u16 v126, v4 offset:25088
ds_read_u16 v127, v4 offset:25344
ds_read_u16 v128, v4 offset:25600
ds_read_u16 v129, v4 offset:25856
ds_read_u16 v130, v4 offset:26112
ds_read_u16 v131, v4 offset:26368
s_waitcnt lgkmcnt(8)
v_lshl_or_b32 v148, v149, 16, v148
v_lshl_or_b32 v149, v151, 16, v150
v_lshl_or_b32 v150, v153, 16, v152
v_lshl_or_b32 v151, v155, 16, v154
buffer_store_dwordx4 v[148:151], v2, s[8:11], s21 offen offset:3072 sc1
ds_read_u16 v132, v5 offset:24576
ds_read_u16 v133, v5 offset:24832
ds_read_u16 v134, v5 offset:25088
ds_read_u16 v135, v5 offset:25344
ds_read_u16 v136, v5 offset:25600
ds_read_u16 v137, v5 offset:25856
ds_read_u16 v138, v5 offset:26112
ds_read_u16 v139, v5 offset:26368
s_waitcnt lgkmcnt(8)
v_lshl_or_b32 v124, v125, 16, v124
v_lshl_or_b32 v125, v127, 16, v126
v_lshl_or_b32 v126, v129, 16, v128
v_lshl_or_b32 v127, v131, 16, v130
buffer_store_dwordx4 v[124:127], v2, s[8:11], s22 offen offset:0 sc1
ds_read_u16 v140, v6 offset:24576
ds_read_u16 v141, v6 offset:24832
ds_read_u16 v142, v6 offset:25088
ds_read_u16 v143, v6 offset:25344
ds_read_u16 v144, v6 offset:25600
ds_read_u16 v145, v6 offset:25856
ds_read_u16 v146, v6 offset:26112
ds_read_u16 v147, v6 offset:26368
s_waitcnt lgkmcnt(8)
v_lshl_or_b32 v132, v133, 16, v132
v_lshl_or_b32 v133, v135, 16, v134
v_lshl_or_b32 v134, v137, 16, v136
v_lshl_or_b32 v135, v139, 16, v138
buffer_store_dwordx4 v[132:135], v2, s[8:11], s22 offen offset:1024 sc1
ds_read_u16 v148, v7 offset:24576
ds_read_u16 v149, v7 offset:24832
ds_read_u16 v150, v7 offset:25088
ds_read_u16 v151, v7 offset:25344
ds_read_u16 v152, v7 offset:25600
ds_read_u16 v153, v7 offset:25856
ds_read_u16 v154, v7 offset:26112
ds_read_u16 v155, v7 offset:26368
s_waitcnt lgkmcnt(8)
v_lshl_or_b32 v140, v141, 16, v140
v_lshl_or_b32 v141, v143, 16, v142
v_lshl_or_b32 v142, v145, 16, v144
v_lshl_or_b32 v143, v147, 16, v146
buffer_store_dwordx4 v[140:143], v2, s[8:11], s22 offen offset:2048 sc1
ds_read_u16 v124, v4 offset:49152
ds_read_u16 v125, v4 offset:49408
ds_read_u16 v126, v4 offset:49664
ds_read_u16 v127, v4 offset:49920
ds_read_u16 v128, v4 offset:50176
ds_read_u16 v129, v4 offset:50432
ds_read_u16 v130, v4 offset:50688
ds_read_u16 v131, v4 offset:50944
s_waitcnt lgkmcnt(8)
v_lshl_or_b32 v148, v149, 16, v148
v_lshl_or_b32 v149, v151, 16, v150
v_lshl_or_b32 v150, v153, 16, v152
v_lshl_or_b32 v151, v155, 16, v154
buffer_store_dwordx4 v[148:151], v2, s[8:11], s23 offen offset:3072 sc1
ds_read_u16 v132, v5 offset:49152
ds_read_u16 v133, v5 offset:49408
ds_read_u16 v134, v5 offset:49664
ds_read_u16 v135, v5 offset:49920
ds_read_u16 v136, v5 offset:50176
ds_read_u16 v137, v5 offset:50432
ds_read_u16 v138, v5 offset:50688
ds_read_u16 v139, v5 offset:50944
s_waitcnt lgkmcnt(8)
v_lshl_or_b32 v124, v125, 16, v124
v_lshl_or_b32 v125, v127, 16, v126
v_lshl_or_b32 v126, v129, 16, v128
v_lshl_or_b32 v127, v131, 16, v130
buffer_store_dwordx4 v[124:127], v2, s[8:11], s24 offen offset:0 sc1
ds_read_u16 v140, v6 offset:49152
ds_read_u16 v141, v6 offset:49408
ds_read_u16 v142, v6 offset:49664
ds_read_u16 v143, v6 offset:49920
ds_read_u16 v144, v6 offset:50176
ds_read_u16 v145, v6 offset:50432
ds_read_u16 v146, v6 offset:50688
ds_read_u16 v147, v6 offset:50944
s_waitcnt lgkmcnt(8)
v_lshl_or_b32 v132, v133, 16, v132
v_lshl_or_b32 v133, v135, 16, v134
v_lshl_or_b32 v134, v137, 16, v136
v_lshl_or_b32 v135, v139, 16, v138
buffer_store_dwordx4 v[132:135], v2, s[8:11], s24 offen offset:1024 sc1
ds_read_u16 v148, v7 offset:49152
ds_read_u16 v149, v7 offset:49408
ds_read_u16 v150, v7 offset:49664
ds_read_u16 v151, v7 offset:49920
ds_read_u16 v152, v7 offset:50176
ds_read_u16 v153, v7 offset:50432
ds_read_u16 v154, v7 offset:50688
ds_read_u16 v155, v7 offset:50944
s_waitcnt lgkmcnt(8)
v_lshl_or_b32 v140, v141, 16, v140
v_lshl_or_b32 v141, v143, 16, v142
v_lshl_or_b32 v142, v145, 16, v144
v_lshl_or_b32 v143, v147, 16, v146
buffer_store_dwordx4 v[140:143], v2, s[8:11], s24 offen offset:2048 sc1
s_waitcnt lgkmcnt(0)
v_lshl_or_b32 v148, v149, 16, v148
v_lshl_or_b32 v149, v151, 16, v150
v_lshl_or_b32 v150, v153, 16, v152
v_lshl_or_b32 v151, v155, 16, v154
buffer_store_dwordx4 v[148:151], v2, s[8:11], s25 offen offset:3072 sc1
s_branch L_cr_e
L_cr_1:
s_lshr_b32 s40, s39, 2
s_sub_u32 s40, s40, 12
s_mov_b32 s44, s60
s_and_b32 s45, s61, 0xffff
s_mov_b32 s46, 663552
s_mov_b32 s47, 0x20000
s_mul_i32 s42, s40, 331776
s_mul_i32 s43, s4, 82944
s_add_u32 s42, s42, s43
s_mul_i32 s43, s5, 144
s_add_u32 s42, s42, s43
s_mul_i32 s43, s4, 18432
v_mul_u32_u24 v9, 1152, v7
v_lshl_add_u32 v9, v6, 4, v9
v_cmp_gt_u32 vcc, 9, v6
s_nop 1
v_cndmask_b32 v9, v12, v9, vcc
s_add_u32 m0, s43, 0
s_add_u32 s41, s42, 0
buffer_load_dwordx4 v9, s[44:47], s41 offen lds
s_add_u32 m0, s43, 1024
s_add_u32 s41, s42, 4608
buffer_load_dwordx4 v9, s[44:47], s41 offen lds
s_add_u32 m0, s43, 2048
s_add_u32 s41, s42, 9216
buffer_load_dwordx4 v9, s[44:47], s41 offen lds
s_add_u32 m0, s43, 3072
s_add_u32 s41, s42, 13824
buffer_load_dwordx4 v9, s[44:47], s41 offen lds
s_add_u32 m0, s43, 4096
s_add_u32 s41, s42, 18432
buffer_load_dwordx4 v9, s[44:47], s41 offen lds
s_add_u32 m0, s43, 5120
s_add_u32 s41, s42, 23040
buffer_load_dwordx4 v9, s[44:47], s41 offen lds
s_add_u32 m0, s43, 6144
s_add_u32 s41, s42, 27648
buffer_load_dwordx4 v9, s[44:47], s41 offen lds
s_add_u32 m0, s43, 7168
s_add_u32 s41, s42, 32256
buffer_load_dwordx4 v9, s[44:47], s41 offen lds
s_add_u32 m0, s43, 8192
s_add_u32 s41, s42, 36864
buffer_load_dwordx4 v9, s[44:47], s41 offen lds
s_add_u32 m0, s43, 9216
s_add_u32 s41, s42, 41472
buffer_load_dwordx4 v9, s[44:47], s41 offen lds
s_add_u32 m0, s43, 10240
s_add_u32 s41, s42, 46080
buffer_load_dwordx4 v9, s[44:47], s41 offen lds
s_add_u32 m0, s43, 11264
s_add_u32 s41, s42, 50688
buffer_load_dwordx4 v9, s[44:47], s41 offen lds
s_add_u32 m0, s43, 12288
s_add_u32 s41, s42, 55296
buffer_load_dwordx4 v9, s[44:47], s41 offen lds
s_add_u32 m0, s43, 13312
s_add_u32 s41, s42, 59904
buffer_load_dwordx4 v9, s[44:47], s41 offen lds
s_add_u32 m0, s43, 14336
s_add_u32 s41, s42, 64512
buffer_load_dwordx4 v9, s[44:47], s41 offen lds
s_add_u32 m0, s43, 15360
s_add_u32 s41, s42, 69120
buffer_load_dwordx4 v9, s[44:47], s41 offen lds
s_add_u32 m0, s43, 16384
s_add_u32 s41, s42, 73728
buffer_load_dwordx4 v9, s[44:47], s41 offen lds
s_add_u32 m0, s43, 17408
s_add_u32 s41, s42, 78336
buffer_load_dwordx4 v9, s[44:47], s41 offen lds
s_waitcnt vmcnt(0)
s_barrier
v_readfirstlane_b32 s12, v14
v_readfirstlane_b32 s13, v15
s_add_u32 s68, s12, 1
s_addc_u32 s69, s13, 0
s_mul_i32 s41, s5, 92160
s_add_u32 s41, s41, 6266880
s_lshl_b32 s42, s40, 3
s_lshl_b32 s43, s4, 1
s_add_u32 s42, s42, s43
s_mul_i32 s42, s42, 5120
s_add_u32 s20, s41, s42
s_add_u32 s21, s20, 4096
s_add_u32 s22, s20, 5120
s_add_u32 s23, s22, 4096
s_add_u32 s42, s40, 16
s_mul_i32 s42, s42, 5120
s_add_u32 s41, s41, s42
s_lshl_b32 s42, s4, 10
s_add_u32 s24, s41, s42
s_add_u32 s25, s41, 4096
s_cmp_eq_u32 s4, 0
s_cselect_b32 s25, s25, 2146435072
v_and_b32 v9, 3, v6
v_lshl_add_u32 v9, v8, 3, v9
v_lshlrev_b32 v9, 1, v9
v_lshlrev_b32 v10, 1, v6
v_add_u32 v10, 128, v10
v_mov_b32 v13, 160
v_cmp_gt_u32 vcc, 8, v6
s_nop 1
v_cndmask_b32 v10, v13, v10, vcc
s_mul_i32 s42, s4, 18432
v_lshlrev_b32 v11, 10, v7
v_add_u32 v11, s42, v11
v_add_u32 v4, v11, v9
v_add_u32 v5, v11, v10
v_mul_u32_u24 v11, 18432, v7
v_add_u32 v7, v11, v10
s_lshr_b32 s42, s4, 1
s_lshl_b32 s42, s42, 6
s_and_b32 s43, s4, 1
s_lshl_b32 s43, s43, 3
s_add_u32 s42, s42, s43
v_add3_u32 v6, v11, v9, s42
ds_read_u16 v124, v4 offset:0
ds_read_u16 v125, v4 offset:256
ds_read_u16 v126, v4 offset:512
ds_read_u16 v127, v4 offset:768
ds_read_u16 v128, v4 offset:4608
ds_read_u16 v129, v4 offset:4864
ds_read_u16 v130, v4 offset:5120
ds_read_u16 v131, v4 offset:5376
ds_read_u16 v132, v4 offset:8
ds_read_u16 v133, v4 offset:264
ds_read_u16 v134, v4 offset:520
ds_read_u16 v135, v4 offset:776
ds_read_u16 v136, v4 offset:4616
ds_read_u16 v137, v4 offset:4872
ds_read_u16 v138, v4 offset:5128
ds_read_u16 v139, v4 offset:5384
s_waitcnt lgkmcnt(8)
v_lshl_or_b32 v124, v125, 16, v124
v_lshl_or_b32 v125, v127, 16, v126
v_lshl_or_b32 v126, v129, 16, v128
v_lshl_or_b32 v127, v131, 16, v130
buffer_store_dwordx4 v[124:127], v2, s[8:11], s20 offen offset:0 sc1
ds_read_u16 v140, v4 offset:64
ds_read_u16 v141, v4 offset:320
ds_read_u16 v142, v4 offset:576
ds_read_u16 v143, v4 offset:832
ds_read_u16 v144, v4 offset:4672
ds_read_u16 v145, v4 offset:4928
ds_read_u16 v146, v4 offset:5184
ds_read_u16 v147, v4 offset:5440
s_waitcnt lgkmcnt(8)
v_lshl_or_b32 v132, v133, 16, v132
v_lshl_or_b32 v133, v135, 16, v134
v_lshl_or_b32 v134, v137, 16, v136
v_lshl_or_b32 v135, v139, 16, v138
buffer_store_dwordx4 v[132:135], v2, s[8:11], s20 offen offset:1024 sc1
ds_read_u16 v148, v4 offset:72
ds_read_u16 v149, v4 offset:328
ds_read_u16 v150, v4 offset:584
ds_read_u16 v151, v4 offset:840
ds_read_u16 v152, v4 offset:4680
ds_read_u16 v153, v4 offset:4936
ds_read_u16 v154, v4 offset:5192
ds_read_u16 v155, v4 offset:5448
s_waitcnt lgkmcnt(8)
v_lshl_or_b32 v140, v141, 16, v140
v_lshl_or_b32 v141, v143, 16, v142
v_lshl_or_b32 v142, v145, 16, v144
v_lshl_or_b32 v143, v147, 16, v146
buffer_store_dwordx4 v[140:143], v2, s[8:11], s20 offen offset:2048 sc1
ds_read_u16 v124, v5 offset:0
ds_read_u16 v125, v5 offset:256
ds_read_u16 v126, v5 offset:512
ds_read_u16 v127, v5 offset:768
ds_read_u16 v128, v5 offset:4608
ds_read_u16 v129, v5 offset:4864
ds_read_u16 v130, v5 offset:5120
ds_read_u16 v131, v5 offset:5376
s_waitcnt lgkmcnt(8)
v_lshl_or_b32 v148, v149, 16, v148
v_lshl_or_b32 v149, v151, 16, v150
v_lshl_or_b32 v150, v153, 16, v152
v_lshl_or_b32 v151, v155, 16, v154
buffer_store_dwordx4 v[148:151], v2, s[8:11], s20 offen offset:3072 sc1
ds_read_u16 v132, v4 offset:9216
ds_read_u16 v133, v4 offset:9472
ds_read_u16 v134, v4 offset:9728
ds_read_u16 v135, v4 offset:9984
ds_read_u16 v136, v4 offset:13824
ds_read_u16 v137, v4 offset:14080
ds_read_u16 v138, v4 offset:14336
ds_read_u16 v139, v4 offset:14592
s_waitcnt lgkmcnt(8)
v_lshl_or_b32 v124, v125, 16, v124
v_lshl_or_b32 v125, v127, 16, v126
v_lshl_or_b32 v126, v129, 16, v128
v_lshl_or_b32 v127, v131, 16, v130
buffer_store_dwordx4 v[124:127], v2, s[8:11], s21 offen offset:0 sc1
ds_read_u16 v140, v4 offset:9224
ds_read_u16 v141, v4 offset:9480
ds_read_u16 v142, v4 offset:9736
ds_read_u16 v143, v4 offset:9992
ds_read_u16 v144, v4 offset:13832
ds_read_u16 v145, v4 offset:14088
ds_read_u16 v146, v4 offset:14344
ds_read_u16 v147, v4 offset:14600
s_waitcnt lgkmcnt(8)
v_lshl_or_b32 v132, v133, 16, v132
v_lshl_or_b32 v133, v135, 16, v134
v_lshl_or_b32 v134, v137, 16, v136
v_lshl_or_b32 v135, v139, 16, v138
buffer_store_dwordx4 v[132:135], v2, s[8:11], s22 offen offset:0 sc1
ds_read_u16 v148, v4 offset:9280
ds_read_u16 v149, v4 offset:9536
ds_read_u16 v150, v4 offset:9792
ds_read_u16 v151, v4 offset:10048
ds_read_u16 v152, v4 offset:13888
ds_read_u16 v153, v4 offset:14144
ds_read_u16 v154, v4 offset:14400
ds_read_u16 v155, v4 offset:14656
s_waitcnt lgkmcnt(8)
v_lshl_or_b32 v140, v141, 16, v140
v_lshl_or_b32 v141, v143, 16, v142
v_lshl_or_b32 v142, v145, 16, v144
v_lshl_or_b32 v143, v147, 16, v146
buffer_store_dwordx4 v[140:143], v2, s[8:11], s22 offen offset:1024 sc1
ds_read_u16 v124, v4 offset:9288
ds_read_u16 v125, v4 offset:9544
ds_read_u16 v126, v4 offset:9800
ds_read_u16 v127, v4 offset:10056
ds_read_u16 v128, v4 offset:13896
ds_read_u16 v129, v4 offset:14152
ds_read_u16 v130, v4 offset:14408
ds_read_u16 v131, v4 offset:14664
s_waitcnt lgkmcnt(8)
v_lshl_or_b32 v148, v149, 16, v148
v_lshl_or_b32 v149, v151, 16, v150
v_lshl_or_b32 v150, v153, 16, v152
v_lshl_or_b32 v151, v155, 16, v154
buffer_store_dwordx4 v[148:151], v2, s[8:11], s22 offen offset:2048 sc1
ds_read_u16 v132, v5 offset:9216
ds_read_u16 v133, v5 offset:9472
ds_read_u16 v134, v5 offset:9728
ds_read_u16 v135, v5 offset:9984
ds_read_u16 v136, v5 offset:13824
ds_read_u16 v137, v5 offset:14080
ds_read_u16 v138, v5 offset:14336
ds_read_u16 v139, v5 offset:14592
s_waitcnt lgkmcnt(8)
v_lshl_or_b32 v124, v125, 16, v124
v_lshl_or_b32 v125, v127, 16, v126
v_lshl_or_b32 v126, v129, 16, v128
v_lshl_or_b32 v127, v131, 16, v130
buffer_store_dwordx4 v[124:127], v2, s[8:11], s22 offen offset:3072 sc1
ds_read_u16 v140, v6 offset:4096
ds_read_u16 v141, v6 offset:4352
ds_read_u16 v142, v6 offset:8704
ds_read_u16 v143, v6 offset:8960
ds_read_u16 v144, v6 offset:13312
ds_read_u16 v145, v6 offset:13568
ds_read_u16 v146, v6 offset:17920
ds_read_u16 v147, v6 offset:18176
s_waitcnt lgkmcnt(8)
v_lshl_or_b32 v132, v133, 16, v132
v_lshl_or_b32 v133, v135, 16, v134
v_lshl_or_b32 v134, v137, 16, v136
v_lshl_or_b32 v135, v139, 16, v138
buffer_store_dwordx4 v[132:135], v2, s[8:11], s23 offen offset:0 sc1
ds_read_u16 v148, v7 offset:4096
ds_read_u16 v149, v7 offset:4352
ds_read_u16 v150, v7 offset:8704
ds_read_u16 v151, v7 offset:8960
ds_read_u16 v152, v7 offset:13312
ds_read_u16 v153, v7 offset:13568
ds_read_u16 v154, v7 offset:17920
ds_read_u16 v155, v7 offset:18176
s_waitcnt lgkmcnt(8)
v_lshl_or_b32 v140, v141, 16, v140
v_lshl_or_b32 v141, v143, 16, v142
v_lshl_or_b32 v142, v145, 16, v144
v_lshl_or_b32 v143, v147, 16, v146
buffer_store_dwordx4 v[140:143], v2, s[8:11], s24 offen offset:0 sc1
s_waitcnt lgkmcnt(0)
v_lshl_or_b32 v148, v149, 16, v148
v_lshl_or_b32 v149, v151, 16, v150
v_lshl_or_b32 v150, v153, 16, v152
v_lshl_or_b32 v151, v155, 16, v154
buffer_store_dwordx4 v[148:151], v2, s[8:11], s25 offen offset:0 sc1
L_cr_e:
s_lshl_b32 s24, s5, 5
s_add_u32 s24, s24, s6
s_lshl_b32 s14, s24, 7
s_add_u32 s14, s14, 786432
v_mov_b32 v13, 2146435072
v_cmp_gt_u32 vcc, 16, v0
v_lshlrev_b32 v14, 3, v0
s_nop 0
v_cndmask_b32 v13, v13, v14, vcc
v_mov_b32 v14, s68
v_mov_b32 v15, s69
s_waitcnt vmcnt(0)
s_barrier
buffer_store_dwordx2 v[14:15], v13, s[8:11], s14 offen sc1
v_mov_b32 v20, 0
v_mov_b32 v21, 0
v_mov_b32 v22, 0
v_mov_b32 v23, 0
s_mov_b32 s38, 0x00003f80
s_mov_b32 s39, 0x3f800000
s_cmp_lt_u32 s2, 216
s_cbranch_scc0 L_wd_0
s_mov_b32 s16, s62
s_and_b32 s17, s63, 0xffff
s_mov_b32 s18, 5308416
s_mov_b32 s19, 0x20000
v_and_b32 v6, 15, v1
v_lshrrev_b32 v7, 4, v1
v_mov_b32 v12, 2146435072
s_sub_u32 s40, s2, 144
s_mul_i32 s37, s40, 73728
s_lshl_b32 s41, s4, 8
s_lshl_b32 s42, s4, 5
v_mul_u32_u24 v10, 18432, v7
v_lshl_add_u32 v9, v6, 3, v10
v_add_u32 v4, s41, v9
v_lshl_add_u32 v9, v6, 1, v10
v_add_u32 v5, s42, v9
s_add_u32 s43, s37, 0
buffer_load_dwordx2 v[76:77], v4, s[16:19], s43 offen offset:0
buffer_load_dwordx2 v[92:93], v4, s[16:19], s43 offen offset:128
buffer_load_ushort v108, v5, s[16:19], s43 offen offset:1024
s_add_u32 s43, s37, 4608
buffer_load_dwordx2 v[78:79], v4, s[16:19], s43 offen offset:0
buffer_load_dwordx2 v[94:95], v4, s[16:19], s43 offen offset:128
buffer_load_ushort v109, v5, s[16:19], s43 offen offset:1024
s_add_u32 s43, s37, 9216
buffer_load_dwordx2 v[80:81], v4, s[16:19], s43 offen offset:0
buffer_load_dwordx2 v[96:97], v4, s[16:19], s43 offen offset:128
buffer_load_ushort v110, v5, s[16:19], s43 offen offset:1024
s_add_u32 s43, s37, 13824
buffer_load_dwordx2 v[82:83], v4, s[16:19], s43 offen offset:0
buffer_load_dwordx2 v[98:99], v4, s[16:19], s43 offen offset:128
buffer_load_ushort v111, v5, s[16:19], s43 offen offset:1024
s_add_u32 s43, s37, 1152
buffer_load_dwordx2 v[84:85], v4, s[16:19], s43 offen offset:0
buffer_load_dwordx2 v[100:101], v4, s[16:19], s43 offen offset:128
buffer_load_ushort v112, v5, s[16:19], s43 offen offset:1024
s_add_u32 s43, s37, 5760
buffer_load_dwordx2 v[86:87], v4, s[16:19], s43 offen offset:0
buffer_load_dwordx2 v[102:103], v4, s[16:19], s43 offen offset:128
buffer_load_ushort v113, v5, s[16:19], s43 offen offset:1024
s_add_u32 s43, s37, 10368
buffer_load_dwordx2 v[88:89], v4, s[16:19], s43 offen offset:0
buffer_load_dwordx2 v[104:105], v4, s[16:19], s43 offen offset:128
buffer_load_ushort v114, v5, s[16:19], s43 offen offset:1024
s_add_u32 s43, s37, 14976
buffer_load_dwordx2 v[90:91], v4, s[16:19], s43 offen offset:0
buffer_load_dwordx2 v[106:107], v4, s[16:19], s43 offen offset:128
buffer_load_ushort v115, v5, s[16:19], s43 offen offset:1024
s_add_u32 s43, s37, 2304
buffer_load_dwordx2 v[116:117], v4, s[16:19], s43 offen offset:0
buffer_load_dwordx2 v[132:133], v4, s[16:19], s43 offen offset:128
buffer_load_ushort v148, v5, s[16:19], s43 offen offset:1024
s_add_u32 s43, s37, 6912
buffer_load_dwordx2 v[118:119], v4, s[16:19], s43 offen offset:0
buffer_load_dwordx2 v[134:135], v4, s[16:19], s43 offen offset:128
buffer_load_ushort v149, v5, s[16:19], s43 offen offset:1024
s_add_u32 s43, s37, 11520
buffer_load_dwordx2 v[120:121], v4, s[16:19], s43 offen offset:0
buffer_load_dwordx2 v[136:137], v4, s[16:19], s43 offen offset:128
buffer_load_ushort v150, v5, s[16:19], s43 offen offset:1024
s_add_u32 s43, s37, 16128
buffer_load_dwordx2 v[122:123], v4, s[16:19], s43 offen offset:0
buffer_load_dwordx2 v[138:139], v4, s[16:19], s43 offen offset:128
buffer_load_ushort v151, v5, s[16:19], s43 offen offset:1024
s_add_u32 s43, s37, 3456
buffer_load_dwordx2 v[124:125], v4, s[16:19], s43 offen offset:0
buffer_load_dwordx2 v[140:141], v4, s[16:19], s43 offen offset:128
buffer_load_ushort v152, v5, s[16:19], s43 offen offset:1024
s_add_u32 s43, s37, 8064
buffer_load_dwordx2 v[126:127], v4, s[16:19], s43 offen offset:0
buffer_load_dwordx2 v[142:143], v4, s[16:19], s43 offen offset:128
buffer_load_ushort v153, v5, s[16:19], s43 offen offset:1024
s_add_u32 s43, s37, 12672
buffer_load_dwordx2 v[128:129], v4, s[16:19], s43 offen offset:0
buffer_load_dwordx2 v[144:145], v4, s[16:19], s43 offen offset:128
buffer_load_ushort v154, v5, s[16:19], s43 offen offset:1024
s_add_u32 s43, s37, 17280
buffer_load_dwordx2 v[130:131], v4, s[16:19], s43 offen offset:0
buffer_load_dwordx2 v[146:147], v4, s[16:19], s43 offen offset:128
buffer_load_ushort v155, v5, s[16:19], s43 offen offset:1024
s_sub_u32 s48, s2, 144
s_mul_i32 s49, s48, 7282
s_lshr_b32 s49, s49, 16
s_mul_i32 s50, s49, 9
s_sub_u32 s48, s48, s50
s_lshl_b32 s48, s48, 1
s_lshl_b32 s49, s49, 2
s_add_u32 s49, s49, s4
s_mul_i32 s49, s49, 497664
s_add_u32 s49, s49, 7344128
v_cmp_lt_u32 vcc, 8, v1
s_nop 1
v_cndmask_b32 v6, 0, 1, vcc
v_mul_u32_u24 v7, 9, v6
v_sub_u32 v7, v1, v7
v_add_u32 v6, s48, v6
v_mov_b32 v8, 0
v_cmp_lt_u32 vcc, 4, v6
s_nop 1
v_addc_co_u32 v8, vcc, 0, v8, vcc
v_cmp_lt_u32 vcc, 8, v6
s_nop 1
v_addc_co_u32 v8, vcc, 0, v8, vcc
v_cmp_lt_u32 vcc, 13, v6
s_nop 1
v_addc_co_u32 v8, vcc, 0, v8, vcc
v_mul_u32_u24 v9, 9, v8
v_add_u32 v9, 1, v9
v_lshrrev_b32 v9, 1, v9
v_sub_u32 v9, v6, v9
v_subrev_u32 v8, s4, v8
v_and_b32 v8, 3, v8
v_mul_u32_u24 v10, 3, v9
v_add3_u32 v10, v10, v8, 2
v_add_u32 v11, 3, v10
v_cmp_lt_u32 vcc, 1, v9
s_nop 1
v_cndmask_b32 v10, v10, v11, vcc
v_cmp_eq_u32 vcc, 3, v9
s_nop 1
v_cndmask_b32 v9, v9, 11, vcc
v_cmp_eq_u32 vcc, 0, v8
s_nop 1
v_cndmask_b32 v10, v10, v9, vcc
v_cmp_eq_u32 vcc, 4, v6
s_nop 1
v_cndmask_b32 v10, v10, 9, vcc
v_cmp_eq_u32 vcc, 13, v6
s_nop 1
v_cndmask_b32 v10, v10, 10, vcc
v_and_b32 v6, 30, v10
v_and_b32 v8, 1, v10
v_lshl_add_u32 v8, v7, 1, v8
v_lshl_add_u32 v9, v6, 3, v8
v_lshrrev_b32 v11, 2, v7
v_mul_u32_u24 v13, 24, v11
v_lshl_add_u32 v6, v6, 2, v8
v_add3_u32 v6, v6, v13, 40
v_cmp_gt_u32 vcc, 10, v10
s_nop 1
v_cndmask_b32 v9, v6, v9, vcc
v_lshl_add_u32 v6, v7, 2, v10
v_lshl_add_u32 v6, v11, 4, v6
v_add_u32 v6, 82, v6
v_cmp_gt_u32 vcc, 14, v10
s_nop 1
v_cndmask_b32 v9, v6, v9, vcc
v_add_u32 v6, 144, v10
v_add_u32 v11, 96, v10
v_cmp_gt_u32 vcc, 0, v10
s_nop 1
v_cndmask_b32 v6, v6, v11, vcc
v_cmp_eq_u32 vcc, 8, v7
s_nop 1
v_cndmask_b32 v9, v9, v6, vcc
v_lshlrev_b32 v9, 10, v9
v_add_u32 v9, s49, v9
v_cmp_gt_u32 vcc, 18, v1
s_nop 1
v_cndmask_b32 v9, v12, v9, vcc
s_nop 0
v_readlane_b32 s48, v9, 0
v_readlane_b32 s49, v9, 1
v_readlane_b32 s50, v9, 2
v_readlane_b32 s51, v9, 3
v_add_u32 v156, s48, v2
v_add_u32 v157, s49, v2
v_add_u32 v158, s50, v2
v_add_u32 v159, s51, v2
v_readlane_b32 s48, v9, 4
v_readlane_b32 s49, v9, 5
v_readlane_b32 s50, v9, 6
v_readlane_b32 s51, v9, 7
v_add_u32 v160, s48, v2
v_add_u32 v161, s49, v2
v_add_u32 v162, s50, v2
v_add_u32 v163, s51, v2
v_readlane_b32 s48, v9, 8
v_readlane_b32 s49, v9, 9
v_readlane_b32 s50, v9, 10
v_readlane_b32 s51, v9, 11
v_add_u32 v164, s48, v2
v_add_u32 v165, s49, v2
v_add_u32 v166, s50, v2
v_add_u32 v167, s51, v2
v_readlane_b32 s48, v9, 12
v_readlane_b32 s49, v9, 13
v_readlane_b32 s50, v9, 14
v_readlane_b32 s51, v9, 15
v_add_u32 v168, s48, v2
v_add_u32 v169, s49, v2
v_add_u32 v170, s50, v2
v_add_u32 v171, s51, v2
v_readlane_b32 s48, v9, 16
v_readlane_b32 s49, v9, 17
v_readlane_b32 s50, v9, 18
v_readlane_b32 s51, v9, 19
v_add_u32 v172, s48, v2
v_add_u32 v173, s49, v2
v_add_u32 v174, s50, v2
v_add_u32 v175, s51, v2
s_branch L_wd_e
L_wd_0:
v_mov_b32 v156, 2146435072
v_mov_b32 v157, 2146435072
v_mov_b32 v158, 2146435072
v_mov_b32 v159, 2146435072
v_mov_b32 v160, 2146435072
v_mov_b32 v161, 2146435072
v_mov_b32 v162, 2146435072
v_mov_b32 v163, 2146435072
v_mov_b32 v164, 2146435072
v_mov_b32 v165, 2146435072
v_mov_b32 v166, 2146435072
v_mov_b32 v167, 2146435072
v_mov_b32 v168, 2146435072
v_mov_b32 v169, 2146435072
v_mov_b32 v170, 2146435072
v_mov_b32 v171, 2146435072
v_mov_b32 v172, 2146435072
v_mov_b32 v173, 2146435072
v_mov_b32 v174, 2146435072
v_mov_b32 v175, 2146435072
L_wd_e:
L_p0_e:
s_mov_b32 s15, 1
s_cmp_eq_u32 s4, 0
s_cbranch_scc1 L_hop0
s_cmp_eq_u32 s4, 1
s_cbranch_scc1 L_hop1
s_cmp_eq_u32 s4, 2
s_cbranch_scc1 L_hop2
s_cmp_eq_u32 s4, 3
s_cbranch_scc1 L_hop3
L_hop_done:
s_mov_b32 s15, 0
s_mov_b32 s70, 22970368
s_mov_b32 s71, 27688960
s_mov_b32 s72, 32407552
s_mov_b32 s73, 37126144
s_mov_b32 s74, 41844736
s_mov_b32 s75, 42106880
s_mov_b32 s76, 79855616
s_mov_b32 s77, 0
s_mov_b32 s7, 0
s_lshr_b32 s20, s5, 2
s_lshl_b32 s20, s20, 3
s_lshr_b32 s21, s6, 2
s_add_u32 s20, s20, s21
s_and_b32 s21, s5, 3
s_lshl_b32 s21, s21, 2
s_and_b32 s22, s6, 3
s_add_u32 s21, s21, s22
s_lshl_b32 s24, s20, 3
s_sub_u32 s25, s24, 1
s_max_i32 s35, s25, 0
s_mul_i32 s25, s35, 18432
s_lshl_b32 s26, s4, 1
s_add_u32 s36, s24, s26
s_mul_i32 s24, s36, 18432
s_add_u32 s26, s24, s70
s_add_u32 s27, s26, 18432
s_add_u32 s28, s25, s70
v_add_u32 v4, 0x10000, v2
v_add_u32 v5, 0x20000, v2
s_cmp_eq_u32 s4, 3
s_cselect_b32 s29, 0, s4
s_cselect_b32 s31, 16, 9
s_lshl_b32 s30, s29, 10
v_and_b32 v12, 15, v1
v_mov_b32 v13, 2146435072
v_cmp_le_u32 vcc, s31, v12
s_nop 1
v_cndmask_b32 v3, v13, v2, vcc
s_add_u32 s31, s30, 2048
v_add_u32 v6, s31, v2
v_add_u32 v7, s31, v4
v_add_u32 v8, s31, v5
s_and_b32 s30, s30, 1024
s_add_u32 s31, s30, 5120
v_add_u32 v9, s31, v2
v_add_u32 v10, s31, v4
v_add_u32 v11, s31, v5
s_lshr_b32 s22, s36, 4
s_lshl_b32 s22, s22, 5
s_bfe_u32 s31, s36, 0x30001
s_add_u32 s22, s22, s31
s_add_u32 s22, s22, 18
s_lshr_b32 s23, s35, 4
s_lshl_b32 s23, s23, 5
s_bfe_u32 s31, s35, 0x30001
s_add_u32 s23, s23, s31
s_add_u32 s23, s23, 18
v_mov_b32 v16, s22
v_mov_b32 v17, s23
v_cmp_eq_u32 vcc, 4, v1
s_nop 1
v_cndmask_b32 v16, v16, v17, vcc
s_lshr_b32 s22, s21, 1
s_lshl_b32 s22, s22, 5
s_add_u32 s22, s22, 10
v_add_u32 v17, s22, v1
v_subrev_u32 v14, 8, v1
v_cmp_gt_u32 vcc, 12, v14
s_nop 1
v_cndmask_b32 v16, v16, v17, vcc
s_and_b32 s22, s6, 7
s_lshl_b32 s22, s22, 5
v_add_u32 v17, s22, v1
v_subrev_u32 v14, 30, v1
v_cmp_gt_u32 vcc, 2, v14
s_nop 1
v_cndmask_b32 v16, v16, v17, vcc
v_lshlrev_b32 v16, 7, v16
s_add_u32 s22, s77, 786432
s_mov_b32 s52, 0
L_poll1:
buffer_load_dwordx2 v[14:15], v16, s[8:11], s22 offen sc1
s_add_u32 s52, s52, 1
s_waitcnt vmcnt(0)
v_cmp_ne_u64 vcc, s[68:69], v[14:15]
s_cmp_ge_u32 s52, 1048576
s_cbranch_scc1 L_got1
s_and_b64 exec, exec, vcc
s_cbranch_execnz L_poll1
L_got1:
s_mov_b64 exec, -1
s_lshr_b32 s20, s5, 2
s_lshl_b32 s20, s20, 3
s_lshr_b32 s21, s6, 2
s_add_u32 s20, s20, s21
s_and_b32 s21, s5, 3
s_lshl_b32 s21, s21, 2
s_and_b32 s22, s6, 3
s_add_u32 s21, s21, s22
s_mul_i32 s32, s21, 129024
s_add_u32 s32, s32, 4198400
s_mul_i32 s33, s4, 32768
s_add_u32 s32, s32, s33
s_sub_u32 s48, s2, 144
s_cmp_lt_u32 s48, 72
s_cbranch_scc0 L_wp_0
s_mov_b32 s46, 0x05040100
s_mov_b32 s47, 0x07060302
v_perm_b32 v176, v78, v76, s46
v_perm_b32 v177, v82, v80, s46
s_add_u32 m0, s33, 0
s_add_u32 s40, s32, 0
buffer_load_dwordx4 v2, s[8:11], s40 offen offset:0 sc1 lds
v_perm_b32 v178, v86, v84, s46
v_perm_b32 v179, v90, v88, s46
buffer_load_dwordx4 v2, s[8:11], s40 offen offset:1024 sc1 lds
v_perm_b32 v180, v78, v76, s47
v_perm_b32 v181, v82, v80, s47
buffer_load_dwordx4 v2, s[8:11], s40 offen offset:2048 sc1 lds
v_perm_b32 v182, v86, v84, s47
v_perm_b32 v183, v90, v88, s47
buffer_load_dwordx4 v2, s[8:11], s40 offen offset:3072 sc1 lds
v_perm_b32 v184, v79, v77, s46
v_perm_b32 v185, v83, v81, s46
s_add_u32 m0, s33, 4096
s_add_u32 s40, s32, 4096
buffer_load_dwordx4 v2, s[8:11], s40 offen offset:0 sc1 lds
v_perm_b32 v186, v87, v85, s46
v_perm_b32 v187, v91, v89, s46
buffer_load_dwordx4 v2, s[8:11], s40 offen offset:1024 sc1 lds
v_perm_b32 v188, v79, v77, s47
v_perm_b32 v189, v83, v81, s47
buffer_load_dwordx4 v2, s[8:11], s40 offen offset:2048 sc1 lds
v_perm_b32 v190, v87, v85, s47
v_perm_b32 v191, v91, v89, s47
buffer_load_dwordx4 v2, s[8:11], s40 offen offset:3072 sc1 lds
v_perm_b32 v192, v94, v92, s46
v_perm_b32 v193, v98, v96, s46
s_add_u32 m0, s33, 8192
s_add_u32 s40, s32, 8192
buffer_load_dwordx4 v2, s[8:11], s40 offen offset:0 sc1 lds
v_perm_b32 v194, v102, v100, s46
v_perm_b32 v195, v106, v104, s46
buffer_load_dwordx4 v2, s[8:11], s40 offen offset:1024 sc1 lds
v_perm_b32 v196, v94, v92, s47
v_perm_b32 v197, v98, v96, s47
buffer_load_dwordx4 v2, s[8:11], s40 offen offset:2048 sc1 lds
v_perm_b32 v198, v102, v100, s47
v_perm_b32 v199, v106, v104, s47
buffer_load_dwordx4 v2, s[8:11], s40 offen offset:3072 sc1 lds
v_perm_b32 v200, v95, v93, s46
v_perm_b32 v201, v99, v97, s46
s_add_u32 m0, s33, 12288
s_add_u32 s40, s32, 12288
buffer_load_dwordx4 v2, s[8:11], s40 offen offset:0 sc1 lds
v_perm_b32 v202, v103, v101, s46
v_perm_b32 v203, v107, v105, s46
buffer_load_dwordx4 v2, s[8:11], s40 offen offset:1024 sc1 lds
v_perm_b32 v204, v95, v93, s47
v_perm_b32 v205, v99, v97, s47
buffer_load_dwordx4 v2, s[8:11], s40 offen offset:2048 sc1 lds
v_perm_b32 v206, v103, v101, s47
v_perm_b32 v207, v107, v105, s47
buffer_load_dwordx4 v2, s[8:11], s40 offen offset:3072 sc1 lds
v_lshl_or_b32 v208, v109, 16, v108
v_lshl_or_b32 v209, v111, 16, v110
s_add_u32 m0, s33, 16384
s_add_u32 s40, s32, 16384
buffer_load_dwordx4 v2, s[8:11], s40 offen offset:0 sc1 lds
v_lshl_or_b32 v210, v113, 16, v112
v_lshl_or_b32 v211, v115, 16, v114
buffer_load_dwordx4 v2, s[8:11], s40 offen offset:1024 sc1 lds
v_perm_b32 v212, v118, v116, s46
v_perm_b32 v213, v122, v120, s46
buffer_load_dwordx4 v2, s[8:11], s40 offen offset:2048 sc1 lds
v_perm_b32 v214, v126, v124, s46
v_perm_b32 v215, v130, v128, s46
buffer_load_dwordx4 v2, s[8:11], s40 offen offset:3072 sc1 lds
v_perm_b32 v216, v118, v116, s47
v_perm_b32 v217, v122, v120, s47
s_add_u32 m0, s33, 20480
s_add_u32 s40, s32, 20480
buffer_load_dwordx4 v2, s[8:11], s40 offen offset:0 sc1 lds
v_perm_b32 v218, v126, v124, s47
v_perm_b32 v219, v130, v128, s47
buffer_load_dwordx4 v2, s[8:11], s40 offen offset:1024 sc1 lds
v_perm_b32 v220, v119, v117, s46
v_perm_b32 v221, v123, v121, s46
buffer_load_dwordx4 v2, s[8:11], s40 offen offset:2048 sc1 lds
v_perm_b32 v222, v127, v125, s46
v_perm_b32 v223, v131, v129, s46
buffer_load_dwordx4 v2, s[8:11], s40 offen offset:3072 sc1 lds
v_perm_b32 v224, v119, v117, s47
v_perm_b32 v225, v123, v121, s47
s_add_u32 m0, s33, 24576
s_add_u32 s40, s32, 24576
buffer_load_dwordx4 v2, s[8:11], s40 offen offset:0 sc1 lds
v_perm_b32 v226, v127, v125, s47
v_perm_b32 v227, v131, v129, s47
buffer_load_dwordx4 v2, s[8:11], s40 offen offset:1024 sc1 lds
v_perm_b32 v228, v134, v132, s46
v_perm_b32 v229, v138, v136, s46
buffer_load_dwordx4 v2, s[8:11], s40 offen offset:2048 sc1 lds
v_perm_b32 v230, v142, v140, s46
v_perm_b32 v231, v146, v144, s46
buffer_load_dwordx4 v2, s[8:11], s40 offen offset:3072 sc1 lds
v_perm_b32 v232, v134, v132, s47
v_perm_b32 v233, v138, v136, s47
s_add_u32 m0, s33, 28672
s_add_u32 s40, s32, 28672
buffer_load_dwordx4 v2, s[8:11], s40 offen offset:0 sc1 lds
v_perm_b32 v234, v142, v140, s47
v_perm_b32 v235, v146, v144, s47
buffer_load_dwordx4 v2, s[8:11], s40 offen offset:1024 sc1 lds
v_perm_b32 v236, v135, v133, s46
v_perm_b32 v237, v139, v137, s46
buffer_load_dwordx4 v2, s[8:11], s40 offen offset:2048 sc1 lds
v_perm_b32 v238, v143, v141, s46
v_perm_b32 v239, v147, v145, s46
buffer_load_dwordx4 v2, s[8:11], s40 offen offset:3072 sc1 lds
v_perm_b32 v240, v135, v133, s47
v_perm_b32 v241, v139, v137, s47
v_perm_b32 v242, v143, v141, s47
v_perm_b32 v243, v147, v145, s47
v_lshl_or_b32 v244, v149, 16, v148
v_lshl_or_b32 v245, v151, 16, v150
v_lshl_or_b32 v246, v153, 16, v152
v_lshl_or_b32 v247, v155, 16, v154
s_branch L_wp_e
L_wp_0:
s_add_u32 m0, s33, 0
s_add_u32 s40, s32, 0
buffer_load_dwordx4 v2, s[8:11], s40 offen offset:0 sc1 lds
buffer_load_dwordx4 v2, s[8:11], s40 offen offset:1024 sc1 lds
buffer_load_dwordx4 v2, s[8:11], s40 offen offset:2048 sc1 lds
buffer_load_dwordx4 v2, s[8:11], s40 offen offset:3072 sc1 lds
s_add_u32 m0, s33, 4096
s_add_u32 s40, s32, 4096
buffer_load_dwordx4 v2, s[8:11], s40 offen offset:0 sc1 lds
buffer_load_dwordx4 v2, s[8:11], s40 offen offset:1024 sc1 lds
buffer_load_dwordx4 v2, s[8:11], s40 offen offset:2048 sc1 lds
buffer_load_dwordx4 v2, s[8:11], s40 offen offset:3072 sc1 lds
s_add_u32 m0, s33, 8192
s_add_u32 s40, s32, 8192
buffer_load_dwordx4 v2, s[8:11], s40 offen offset:0 sc1 lds
buffer_load_dwordx4 v2, s[8:11], s40 offen offset:1024 sc1 lds
buffer_load_dwordx4 v2, s[8:11], s40 offen offset:2048 sc1 lds
buffer_load_dwordx4 v2, s[8:11], s40 offen offset:3072 sc1 lds
s_add_u32 m0, s33, 12288
s_add_u32 s40, s32, 12288
buffer_load_dwordx4 v2, s[8:11], s40 offen offset:0 sc1 lds
buffer_load_dwordx4 v2, s[8:11], s40 offen offset:1024 sc1 lds
buffer_load_dwordx4 v2, s[8:11], s40 offen offset:2048 sc1 lds
buffer_load_dwordx4 v2, s[8:11], s40 offen offset:3072 sc1 lds
s_add_u32 m0, s33, 16384
s_add_u32 s40, s32, 16384
buffer_load_dwordx4 v2, s[8:11], s40 offen offset:0 sc1 lds
buffer_load_dwordx4 v2, s[8:11], s40 offen offset:1024 sc1 lds
buffer_load_dwordx4 v2, s[8:11], s40 offen offset:2048 sc1 lds
buffer_load_dwordx4 v2, s[8:11], s40 offen offset:3072 sc1 lds
s_add_u32 m0, s33, 20480
s_add_u32 s40, s32, 20480
buffer_load_dwordx4 v2, s[8:11], s40 offen offset:0 sc1 lds
buffer_load_dwordx4 v2, s[8:11], s40 offen offset:1024 sc1 lds
buffer_load_dwordx4 v2, s[8:11], s40 offen offset:2048 sc1 lds
buffer_load_dwordx4 v2, s[8:11], s40 offen offset:3072 sc1 lds
s_add_u32 m0, s33, 24576
s_add_u32 s40, s32, 24576
buffer_load_dwordx4 v2, s[8:11], s40 offen offset:0 sc1 lds
buffer_load_dwordx4 v2, s[8:11], s40 offen offset:1024 sc1 lds
buffer_load_dwordx4 v2, s[8:11], s40 offen offset:2048 sc1 lds
buffer_load_dwordx4 v2, s[8:11], s40 offen offset:3072 sc1 lds
s_add_u32 m0, s33, 28672
s_add_u32 s40, s32, 28672
buffer_load_dwordx4 v2, s[8:11], s40 offen offset:0 sc1 lds
buffer_load_dwordx4 v2, s[8:11], s40 offen offset:1024 sc1 lds
buffer_load_dwordx4 v2, s[8:11], s40 offen offset:2048 sc1 lds
buffer_load_dwordx4 v2, s[8:11], s40 offen offset:3072 sc1 lds
L_wp_e:
buffer_load_dwordx4 a[0:3], v2, s[8:11], s26 offen offset:0 sc1
buffer_load_dwordx4 a[72:75], v2, s[8:11], s27 offen offset:0 sc1
buffer_load_dwordx4 a[144:147], v3, s[8:11], s28 offen offset:0 sc1
buffer_load_dwordx4 a[4:7], v2, s[8:11], s26 offen offset:1024 sc1
buffer_load_dwordx4 a[76:79], v2, s[8:11], s27 offen offset:1024 sc1
buffer_load_dwordx4 a[148:151], v3, s[8:11], s28 offen offset:1024 sc1
buffer_load_dwordx4 a[8:11], v2, s[8:11], s26 offen offset:2048 sc1
buffer_load_dwordx4 a[80:83], v2, s[8:11], s27 offen offset:2048 sc1
buffer_load_dwordx4 a[152:155], v3, s[8:11], s28 offen offset:2048 sc1
buffer_load_dwordx4 a[12:15], v2, s[8:11], s26 offen offset:3072 sc1
buffer_load_dwordx4 a[84:87], v2, s[8:11], s27 offen offset:3072 sc1
buffer_load_dwordx4 a[156:159], v3, s[8:11], s28 offen offset:3072 sc1
s_add_u32 s26, s26, 4096
s_add_u32 s27, s27, 4096
s_add_u32 s28, s28, 4096
buffer_load_dwordx4 a[16:19], v2, s[8:11], s26 offen offset:0 sc1
buffer_load_dwordx4 a[88:91], v2, s[8:11], s27 offen offset:0 sc1
buffer_load_dwordx4 a[160:163], v3, s[8:11], s28 offen offset:0 sc1
buffer_load_dwordx4 a[20:23], v2, s[8:11], s26 offen offset:1024 sc1
buffer_load_dwordx4 a[92:95], v2, s[8:11], s27 offen offset:1024 sc1
buffer_load_dwordx4 a[164:167], v3, s[8:11], s28 offen offset:1024 sc1
buffer_load_dwordx4 a[24:27], v2, s[8:11], s26 offen offset:2048 sc1
buffer_load_dwordx4 a[96:99], v2, s[8:11], s27 offen offset:2048 sc1
buffer_load_dwordx4 a[168:171], v3, s[8:11], s28 offen offset:2048 sc1
buffer_load_dwordx4 a[28:31], v2, s[8:11], s26 offen offset:3072 sc1
buffer_load_dwordx4 a[100:103], v2, s[8:11], s27 offen offset:3072 sc1
buffer_load_dwordx4 a[172:175], v3, s[8:11], s28 offen offset:3072 sc1
v_lshrrev_b32 v13, 4, v1
v_lshlrev_b32 v14, 2, v13
v_sub_u32 v14, v12, v14
v_subrev_u32 v15, 0, v14
v_cmp_gt_u32 s[52:53], 8, v15
v_cmp_gt_i32 s[44:45], -8, v15
v_subrev_u32 v15, 1, v14
v_cmp_gt_u32 s[54:55], 8, v15
v_cmp_gt_i32 s[46:47], -8, v15
v_subrev_u32 v15, 2, v14
v_cmp_gt_u32 s[56:57], 8, v15
v_cmp_gt_i32 s[48:49], -8, v15
v_subrev_u32 v15, 3, v14
v_cmp_gt_u32 s[58:59], 8, v15
v_cmp_gt_i32 s[50:51], -8, v15
s_and_b32 s31, s20, 7
s_or_b32 s31, s31, s4
s_cmp_eq_u32 s31, 0
s_cselect_b64 s[60:61], 0, s[44:45]
s_cselect_b64 s[62:63], 0, s[46:47]
s_cselect_b64 s[64:65], 0, s[48:49]
s_cselect_b64 s[66:67], 0, s[50:51]
s_waitcnt vmcnt(24)
s_barrier
ds_read_b128 a[216:219], v2 offset:0
ds_read_b128 a[220:223], v2 offset:7168
ds_read_b128 a[224:227], v2 offset:1024
ds_read_b128 a[228:231], v2 offset:8192
ds_read_b128 a[232:235], v2 offset:2048
ds_read_b128 a[236:239], v2 offset:9216
s_waitcnt vmcnt(18)
s_waitcnt lgkmcnt(4)
v_mfma_f32_16x16x32_bf16 v[32:35], a[216:219], a[0:3], 0
s_add_u32 s26, s26, 4096
s_add_u32 s27, s27, 4096
s_add_u32 s28, s28, 4096
buffer_load_dwordx4 a[32:35], v2, s[8:11], s26 offen offset:0 sc1
v_mfma_f32_16x16x32_bf16 v[32:35], a[220:223], a[4:7], v[32:35]
ds_read_b128 a[240:243], v2 offset:3072
v_lshlrev_b32 v14, 3, v1
v_mfma_f32_16x16x32_bf16 v[36:39], a[216:219], a[72:75], 0
s_mul_i32 s31, s4, 3072
s_add_u32 s41, s31, 147456
v_mfma_f32_16x16x32_bf16 v[36:39], a[220:223], a[76:79], v[36:39]
ds_read_b128 a[244:247], v2 offset:10240
s_waitcnt lgkmcnt(4)
v_mfma_f32_16x16x32_bf16 v[40:43], a[224:227], a[0:3], 0
buffer_load_dwordx4 a[104:107], v2, s[8:11], s27 offen offset:0 sc1
v_mfma_f32_16x16x32_bf16 v[40:43], a[228:231], a[4:7], v[40:43]
ds_read_b128 a[216:219], v2 offset:4096
v_add_u32 v15, s41, v14
v_mfma_f32_16x16x32_bf16 v[44:47], a[224:227], a[72:75], 0
s_lshl_b32 s42, s29, 9
s_add_u32 s42, s42, 147456
v_mfma_f32_16x16x32_bf16 v[44:47], a[228:231], a[76:79], v[44:47]
ds_read_b128 a[220:223], v2 offset:11264
s_waitcnt lgkmcnt(4)
v_mfma_f32_16x16x32_bf16 v[48:51], a[232:235], a[0:3], 0
buffer_load_dwordx4 a[176:179], v3, s[8:11], s28 offen offset:0 sc1
v_mfma_f32_16x16x32_bf16 v[48:51], a[236:239], a[4:7], v[48:51]
ds_read_b128 a[224:227], v2 offset:5120
v_add_u32 v16, s42, v14
v_mfma_f32_16x16x32_bf16 v[52:55], a[232:235], a[72:75], 0
s_and_b32 s42, s42, 512
s_add_u32 s42, s42, 147456
v_mfma_f32_16x16x32_bf16 v[52:55], a[236:239], a[76:79], v[52:55]
ds_read_b128 a[228:231], v2 offset:12288
s_waitcnt lgkmcnt(4)
v_mfma_f32_16x16x32_bf16 v[56:59], a[240:243], a[0:3], 0
buffer_load_dwordx4 a[36:39], v2, s[8:11], s26 offen offset:1024 sc1
v_mfma_f32_16x16x32_bf16 v[56:59], a[244:247], a[4:7], v[56:59]
ds_read_b128 a[232:235], v2 offset:6144
v_add_u32 v19, s42, v14
v_mfma_f32_16x16x32_bf16 v[60:63], a[240:243], a[72:75], 0
v_add_u32 v18, 150016, v14
v_mov_b32 v96, 0
v_mfma_f32_16x16x32_bf16 v[60:63], a[244:247], a[76:79], v[60:63]
ds_read_b128 a[236:239], v2 offset:13312
s_waitcnt lgkmcnt(4)
v_mfma_f32_16x16x32_bf16 v[64:67], a[216:219], a[0:3], 0
buffer_load_dwordx4 a[108:111], v2, s[8:11], s27 offen offset:1024 sc1
v_mfma_f32_16x16x32_bf16 v[64:67], a[220:223], a[4:7], v[64:67]
ds_read_b128 a[240:243], v6 offset:0
v_mov_b32 v97, 0
v_mfma_f32_16x16x32_bf16 v[68:71], a[216:219], a[72:75], 0
v_mov_b32 v100, 0
v_mov_b32 v101, 0
v_mfma_f32_16x16x32_bf16 v[68:71], a[220:223], a[76:79], v[68:71]
ds_read_b128 a[244:247], v6 offset:7168
s_waitcnt lgkmcnt(4)
v_mfma_f32_16x16x32_bf16 v[72:75], a[0:3], a[224:227], 0
buffer_load_dwordx4 a[180:183], v3, s[8:11], s28 offen offset:1024 sc1
v_mfma_f32_16x16x32_bf16 v[72:75], a[4:7], a[228:231], v[72:75]
ds_read_b128 a[216:219], v9 offset:0
v_and_b32 v13, 1, v1
v_mfma_f32_16x16x32_bf16 v[76:79], a[72:75], a[224:227], 0
v_lshlrev_b32 v13, 4, v13
v_mov_b32 v102, 0x3f80
v_mfma_f32_16x16x32_bf16 v[76:79], a[76:79], a[228:231], v[76:79]
ds_read_b128 a[220:223], v9 offset:7168
s_waitcnt lgkmcnt(4)
v_mfma_f32_16x16x32_bf16 v[80:83], a[0:3], a[232:235], 0
buffer_load_dwordx4 a[40:43], v2, s[8:11], s26 offen offset:2048 sc1
v_mfma_f32_16x16x32_bf16 v[80:83], a[4:7], a[236:239], v[80:83]
ds_read_b128 a[224:227], v2 offset:14336
v_lshlrev_b32 v13, v13, v102
v_mfma_f32_16x16x32_bf16 v[84:87], a[72:75], a[232:235], 0
v_lshrrev_b32 v102, 1, v1
v_cmp_eq_u32 vcc, 16, v102
v_mfma_f32_16x16x32_bf16 v[84:87], a[76:79], a[236:239], v[84:87]
ds_read_b128 a[228:231], v2 offset:21504
s_waitcnt lgkmcnt(4)
v_mfma_f32_16x16x32_bf16 v[88:91], a[240:243], a[144:147], 0
ds_read_b128 a[232:235], v2 offset:15360
buffer_load_dwordx4 a[112:115], v2, s[8:11], s27 offen offset:2048 sc1
L_hop0:
s_cmp_eq_u32 s15, 1
s_cbranch_scc1 L_hop4
v_mfma_f32_16x16x32_bf16 v[88:91], a[244:247], a[148:151], v[88:91]
ds_read_b128 a[236:239], v2 offset:22528
s_waitcnt lgkmcnt(4)
v_mfma_f32_16x16x32_bf16 v[92:95], a[144:147], a[216:219], 0
ds_read_b128 a[240:243], v2 offset:16384
v_cndmask_b32 v98, 0, v13, vcc
v_mfma_f32_16x16x32_bf16 v[92:95], a[148:151], a[220:223], v[92:95]
ds_read_b128 a[244:247], v2 offset:23552
s_waitcnt vmcnt(20)
s_waitcnt lgkmcnt(4)
v_mfma_f32_16x16x32_bf16 v[32:35], a[224:227], a[8:11], v[32:35]
buffer_load_dwordx4 a[184:187], v3, s[8:11], s28 offen offset:2048 sc1
v_mfma_f32_16x16x32_bf16 v[32:35], a[228:231], a[12:15], v[32:35]
ds_read_b128 a[216:219], v2 offset:17408
v_cmp_eq_u32 vcc, 17, v102
v_mfma_f32_16x16x32_bf16 v[36:39], a[224:227], a[80:83], v[36:39]
s_nop 0
v_cndmask_b32 v99, 0, v13, vcc
v_add_u32 v17, 16, v12
v_mfma_f32_16x16x32_bf16 v[36:39], a[228:231], a[84:87], v[36:39]
ds_read_b128 a[220:223], v2 offset:24576
s_waitcnt lgkmcnt(4)
v_mfma_f32_16x16x32_bf16 v[40:43], a[232:235], a[8:11], v[40:43]
buffer_load_dwordx4 a[44:47], v2, s[8:11], s26 offen offset:3072 sc1
v_mfma_f32_16x16x32_bf16 v[40:43], a[236:239], a[12:15], v[40:43]
ds_read_b128 a[224:227], v2 offset:18432
v_cmp_gt_u32 vcc, 16, v1
v_mfma_f32_16x16x32_bf16 v[44:47], a[232:235], a[80:83], v[44:47]
v_add_u32 v14, 48, v12
s_mov_b32 s34, 0x3eae1a93
v_mfma_f32_16x16x32_bf16 v[44:47], a[236:239], a[84:87], v[44:47]
ds_read_b128 a[228:231], v2 offset:25600
s_waitcnt lgkmcnt(4)
v_mfma_f32_16x16x32_bf16 v[48:51], a[240:243], a[8:11], v[48:51]
buffer_load_dwordx4 a[116:119], v2, s[8:11], s27 offen offset:3072 sc1
v_mfma_f32_16x16x32_bf16 v[48:51], a[244:247], a[12:15], v[48:51]
ds_read_b128 a[232:235], v2 offset:19456
v_cndmask_b32 v17, v14, v17, vcc
v_mfma_f32_16x16x32_bf16 v[52:55], a[240:243], a[80:83], v[52:55]
v_lshlrev_b32 v17, 3, v17
v_add_u32 v17, s41, v17
v_mfma_f32_16x16x32_bf16 v[52:55], a[244:247], a[84:87], v[52:55]
ds_read_b128 a[236:239], v2 offset:26624
s_waitcnt lgkmcnt(4)
v_mfma_f32_16x16x32_bf16 v[56:59], a[216:219], a[8:11], v[56:59]
buffer_load_dwordx4 a[188:191], v3, s[8:11], s28 offen offset:3072 sc1
v_mfma_f32_16x16x32_bf16 v[56:59], a[220:223], a[12:15], v[56:59]
ds_read_b128 a[240:243], v2 offset:20480
v_mfma_f32_16x16x32_bf16 v[60:63], a[216:219], a[80:83], v[60:63]
v_mfma_f32_16x16x32_bf16 v[60:63], a[220:223], a[84:87], v[60:63]
ds_read_b128 a[244:247], v2 offset:27648
s_waitcnt lgkmcnt(4)
v_mfma_f32_16x16x32_bf16 v[64:67], a[224:227], a[8:11], v[64:67]
s_add_u32 s26, s26, 4096
s_add_u32 s27, s27, 4096
s_add_u32 s28, s28, 4096
buffer_load_dwordx4 a[48:51], v2, s[8:11], s26 offen offset:0 sc1
v_mfma_f32_16x16x32_bf16 v[64:67], a[228:231], a[12:15], v[64:67]
ds_read_b128 a[216:219], v6 offset:14336
v_mfma_f32_16x16x32_bf16 v[68:71], a[224:227], a[80:83], v[68:71]
v_mfma_f32_16x16x32_bf16 v[68:71], a[228:231], a[84:87], v[68:71]
ds_read_b128 a[220:223], v6 offset:21504
s_waitcnt lgkmcnt(4)
v_mfma_f32_16x16x32_bf16 v[72:75], a[8:11], a[232:235], v[72:75]
buffer_load_dwordx4 a[120:123], v2, s[8:11], s27 offen offset:0 sc1
v_mfma_f32_16x16x32_bf16 v[72:75], a[12:15], a[236:239], v[72:75]
ds_read_b128 a[224:227], v9 offset:14336
v_mfma_f32_16x16x32_bf16 v[76:79], a[80:83], a[232:235], v[76:79]
v_mfma_f32_16x16x32_bf16 v[76:79], a[84:87], a[236:239], v[76:79]
ds_read_b128 a[228:231], v9 offset:21504
s_waitcnt lgkmcnt(4)
v_mfma_f32_16x16x32_bf16 v[80:83], a[8:11], a[240:243], v[80:83]
buffer_load_dwordx4 a[192:195], v3, s[8:11], s28 offen offset:0 sc1
v_mfma_f32_16x16x32_bf16 v[80:83], a[12:15], a[244:247], v[80:83]
ds_read_b128 a[232:235], v2 offset:28672
v_mfma_f32_16x16x32_bf16 v[84:87], a[80:83], a[240:243], v[84:87]
v_mfma_f32_16x16x32_bf16 v[84:87], a[84:87], a[244:247], v[84:87]
ds_read_b128 a[236:239], v2 offset:35840
s_waitcnt lgkmcnt(4)
v_mfma_f32_16x16x32_bf16 v[88:91], a[216:219], a[152:155], v[88:91]
ds_read_b128 a[240:243], v2 offset:29696
buffer_load_dwordx4 a[52:55], v2, s[8:11], s26 offen offset:1024 sc1
v_mfma_f32_16x16x32_bf16 v[88:91], a[220:223], a[156:159], v[88:91]
ds_read_b128 a[244:247], v2 offset:36864
s_waitcnt lgkmcnt(4)
v_mfma_f32_16x16x32_bf16 v[92:95], a[152:155], a[224:227], v[92:95]
ds_read_b128 a[216:219], v2 offset:30720
v_mfma_f32_16x16x32_bf16 v[92:95], a[156:159], a[228:231], v[92:95]
ds_read_b128 a[220:223], v2 offset:37888
s_waitcnt vmcnt(22)
s_waitcnt lgkmcnt(4)
v_mfma_f32_16x16x32_bf16 v[32:35], a[232:235], a[16:19], v[32:35]
buffer_load_dwordx4 a[124:127], v2, s[8:11], s27 offen offset:1024 sc1
v_mfma_f32_16x16x32_bf16 v[32:35], a[236:239], a[20:23], v[32:35]
ds_read_b128 a[224:227], v2 offset:31744
v_mfma_f32_16x16x32_bf16 v[36:39], a[232:235], a[88:91], v[36:39]
v_mfma_f32_16x16x32_bf16 v[36:39], a[236:239], a[92:95], v[36:39]
ds_read_b128 a[228:231], v2 offset:38912
s_waitcnt lgkmcnt(4)
v_mfma_f32_16x16x32_bf16 v[40:43], a[240:243], a[16:19], v[40:43]
buffer_load_dwordx4 a[196:199], v3, s[8:11], s28 offen offset:1024 sc1
v_mfma_f32_16x16x32_bf16 v[40:43], a[244:247], a[20:23], v[40:43]
ds_read_b128 a[232:235], v2 offset:32768
v_mfma_f32_16x16x32_bf16 v[44:47], a[240:243], a[88:91], v[44:47]
v_mfma_f32_16x16x32_bf16 v[44:47], a[244:247], a[92:95], v[44:47]
ds_read_b128 a[236:239], v2 offset:39936
s_waitcnt lgkmcnt(4)
v_mfma_f32_16x16x32_bf16 v[48:51], a[216:219], a[16:19], v[48:51]
buffer_load_dwordx4 a[56:59], v2, s[8:11], s26 offen offset:2048 sc1
v_mfma_f32_16x16x32_bf16 v[48:51], a[220:223], a[20:23], v[48:51]
ds_read_b128 a[240:243], v2 offset:33792
v_mfma_f32_16x16x32_bf16 v[52:55], a[216:219], a[88:91], v[52:55]
v_mfma_f32_16x16x32_bf16 v[52:55], a[220:223], a[92:95], v[52:55]
ds_read_b128 a[244:247], v2 offset:40960
s_waitcnt lgkmcnt(4)
v_mfma_f32_16x16x32_bf16 v[56:59], a[224:227], a[16:19], v[56:59]
buffer_load_dwordx4 a[128:131], v2, s[8:11], s27 offen offset:2048 sc1
v_mfma_f32_16x16x32_bf16 v[56:59], a[228:231], a[20:23], v[56:59]
ds_read_b128 a[216:219], v2 offset:34816
v_mfma_f32_16x16x32_bf16 v[60:63], a[224:227], a[88:91], v[60:63]
v_mfma_f32_16x16x32_bf16 v[60:63], a[228:231], a[92:95], v[60:63]
ds_read_b128 a[220:223], v2 offset:41984
s_waitcnt lgkmcnt(4)
v_mfma_f32_16x16x32_bf16 v[64:67], a[232:235], a[16:19], v[64:67]
buffer_load_dwordx4 a[200:203], v3, s[8:11], s28 offen offset:2048 sc1
v_mfma_f32_16x16x32_bf16 v[64:67], a[236:239], a[20:23], v[64:67]
ds_read_b128 a[224:227], v6 offset:28672
v_mfma_f32_16x16x32_bf16 v[68:71], a[232:235], a[88:91], v[68:71]
v_mfma_f32_16x16x32_bf16 v[68:71], a[236:239], a[92:95], v[68:71]
ds_read_b128 a[228:231], v6 offset:35840
s_waitcnt lgkmcnt(4)
v_mfma_f32_16x16x32_bf16 v[72:75], a[16:19], a[240:243], v[72:75]
buffer_load_dwordx4 a[60:63], v2, s[8:11], s26 offen offset:3072 sc1
v_mfma_f32_16x16x32_bf16 v[72:75], a[20:23], a[244:247], v[72:75]
ds_read_b128 a[232:235], v9 offset:28672
v_mfma_f32_16x16x32_bf16 v[76:79], a[88:91], a[240:243], v[76:79]
v_mfma_f32_16x16x32_bf16 v[76:79], a[92:95], a[244:247], v[76:79]
ds_read_b128 a[236:239], v9 offset:35840
s_waitcnt lgkmcnt(4)
v_mfma_f32_16x16x32_bf16 v[80:83], a[16:19], a[216:219], v[80:83]
buffer_load_dwordx4 a[132:135], v2, s[8:11], s27 offen offset:3072 sc1
v_mfma_f32_16x16x32_bf16 v[80:83], a[20:23], a[220:223], v[80:83]
ds_read_b128 a[240:243], v2 offset:43008
v_mfma_f32_16x16x32_bf16 v[84:87], a[88:91], a[216:219], v[84:87]
v_mfma_f32_16x16x32_bf16 v[84:87], a[92:95], a[220:223], v[84:87]
ds_read_b128 a[244:247], v2 offset:50176
s_waitcnt lgkmcnt(4)
v_mfma_f32_16x16x32_bf16 v[88:91], a[224:227], a[160:163], v[88:91]
ds_read_b128 a[216:219], v2 offset:44032
buffer_load_dwordx4 a[204:207], v3, s[8:11], s28 offen offset:3072 sc1
v_mfma_f32_16x16x32_bf16 v[88:91], a[228:231], a[164:167], v[88:91]
ds_read_b128 a[220:223], v2 offset:51200
s_waitcnt lgkmcnt(4)
v_mfma_f32_16x16x32_bf16 v[92:95], a[160:163], a[232:235], v[92:95]
ds_read_b128 a[224:227], v2 offset:45056
v_mfma_f32_16x16x32_bf16 v[92:95], a[164:167], a[236:239], v[92:95]
ds_read_b128 a[228:231], v2 offset:52224
s_waitcnt vmcnt(24)
s_waitcnt lgkmcnt(4)
v_mfma_f32_16x16x32_bf16 v[32:35], a[240:243], a[24:27], v[32:35]
s_add_u32 s26, s26, 4096
s_add_u32 s27, s27, 4096
s_add_u32 s28, s28, 4096
buffer_load_dwordx4 a[64:67], v2, s[8:11], s26 offen offset:0 sc1
v_mfma_f32_16x16x32_bf16 v[32:35], a[244:247], a[28:31], v[32:35]
ds_read_b128 a[232:235], v2 offset:46080
v_mfma_f32_16x16x32_bf16 v[36:39], a[240:243], a[96:99], v[36:39]
v_mfma_f32_16x16x32_bf16 v[36:39], a[244:247], a[100:103], v[36:39]
ds_read_b128 a[236:239], v2 offset:53248
s_waitcnt lgkmcnt(4)
v_mfma_f32_16x16x32_bf16 v[40:43], a[216:219], a[24:27], v[40:43]
buffer_load_dwordx4 a[136:139], v2, s[8:11], s27 offen offset:0 sc1
v_mfma_f32_16x16x32_bf16 v[40:43], a[220:223], a[28:31], v[40:43]
ds_read_b128 a[240:243], v2 offset:47104
v_mfma_f32_16x16x32_bf16 v[44:47], a[216:219], a[96:99], v[44:47]
v_mfma_f32_16x16x32_bf16 v[44:47], a[220:223], a[100:103], v[44:47]
ds_read_b128 a[244:247], v2 offset:54272
s_waitcnt lgkmcnt(4)
v_mfma_f32_16x16x32_bf16 v[48:51], a[224:227], a[24:27], v[48:51]
buffer_load_dwordx4 a[208:211], v3, s[8:11], s28 offen offset:0 sc1
v_mfma_f32_16x16x32_bf16 v[48:51], a[228:231], a[28:31], v[48:51]
ds_read_b128 a[216:219], v2 offset:48128
v_mfma_f32_16x16x32_bf16 v[52:55], a[224:227], a[96:99], v[52:55]
v_mfma_f32_16x16x32_bf16 v[52:55], a[228:231], a[100:103], v[52:55]
ds_read_b128 a[220:223], v2 offset:55296
s_waitcnt lgkmcnt(4)
v_mfma_f32_16x16x32_bf16 v[56:59], a[232:235], a[24:27], v[56:59]
buffer_load_dwordx4 a[68:71], v2, s[8:11], s26 offen offset:1024 sc1
v_mfma_f32_16x16x32_bf16 v[56:59], a[236:239], a[28:31], v[56:59]
ds_read_b128 a[224:227], v2 offset:49152
v_mfma_f32_16x16x32_bf16 v[60:63], a[232:235], a[96:99], v[60:63]
v_mfma_f32_16x16x32_bf16 v[60:63], a[236:239], a[100:103], v[60:63]
ds_read_b128 a[228:231], v2 offset:56320
s_waitcnt lgkmcnt(4)
v_mfma_f32_16x16x32_bf16 v[64:67], a[240:243], a[24:27], v[64:67]
buffer_load_dwordx4 a[140:143], v2, s[8:11], s27 offen offset:1024 sc1
v_mfma_f32_16x16x32_bf16 v[64:67], a[244:247], a[28:31], v[64:67]
ds_read_b128 a[232:235], v6 offset:43008
v_mfma_f32_16x16x32_bf16 v[68:71], a[240:243], a[96:99], v[68:71]
v_mfma_f32_16x16x32_bf16 v[68:71], a[244:247], a[100:103], v[68:71]
ds_read_b128 a[236:239], v6 offset:50176
s_waitcnt lgkmcnt(4)
v_mfma_f32_16x16x32_bf16 v[72:75], a[24:27], a[216:219], v[72:75]
buffer_load_dwordx4 a[212:215], v3, s[8:11], s28 offen offset:1024 sc1
v_mfma_f32_16x16x32_bf16 v[72:75], a[28:31], a[220:223], v[72:75]
ds_read_b128 a[240:243], v9 offset:43008
v_mfma_f32_16x16x32_bf16 v[76:79], a[96:99], a[216:219], v[76:79]
v_mfma_f32_16x16x32_bf16 v[76:79], a[100:103], a[220:223], v[76:79]
ds_read_b128 a[244:247], v9 offset:50176
s_waitcnt lgkmcnt(4)
v_mfma_f32_16x16x32_bf16 v[80:83], a[24:27], a[224:227], v[80:83]
buffer_store_dwordx4 v[176:179], v156, s[8:11], 0 offen sc1
v_mfma_f32_16x16x32_bf16 v[80:83], a[28:31], a[228:231], v[80:83]
ds_read_b128 a[216:219], v2 offset:57344
v_mfma_f32_16x16x32_bf16 v[84:87], a[96:99], a[224:227], v[84:87]
v_mfma_f32_16x16x32_bf16 v[84:87], a[100:103], a[228:231], v[84:87]
ds_read_b128 a[220:223], v2 offset:64512
s_waitcnt lgkmcnt(4)
v_mfma_f32_16x16x32_bf16 v[88:91], a[232:235], a[168:171], v[88:91]
ds_read_b128 a[224:227], v2 offset:58368
v_mfma_f32_16x16x32_bf16 v[88:91], a[236:239], a[172:175], v[88:91]
ds_read_b128 a[228:231], v4 offset:0
s_waitcnt lgkmcnt(4)
v_mfma_f32_16x16x32_bf16 v[92:95], a[168:171], a[240:243], v[92:95]
ds_read_b128 a[232:235], v2 offset:59392
buffer_store_dwordx4 v[180:183], v157, s[8:11], 0 offen sc1
v_mfma_f32_16x16x32_bf16 v[92:95], a[172:175], a[244:247], v[92:95]
ds_read_b128 a[236:239], v4 offset:1024
s_waitcnt vmcnt(26)
s_waitcnt lgkmcnt(4)
v_mfma_f32_16x16x32_bf16 v[32:35], a[216:219], a[32:35], v[32:35]
v_mfma_f32_16x16x32_bf16 v[32:35], a[220:223], a[36:39], v[32:35]
ds_read_b128 a[240:243], v2 offset:60416
v_mfma_f32_16x16x32_bf16 v[36:39], a[216:219], a[104:107], v[36:39]
v_mfma_f32_16x16x32_bf16 v[36:39], a[220:223], a[108:111], v[36:39]
ds_read_b128 a[244:247], v4 offset:2048
s_waitcnt lgkmcnt(4)
v_mfma_f32_16x16x32_bf16 v[40:43], a[224:227], a[32:35], v[40:43]
buffer_store_dwordx4 v[184:187], v158, s[8:11], 0 offen sc1
v_mfma_f32_16x16x32_bf16 v[40:43], a[228:231], a[36:39], v[40:43]
ds_read_b128 a[216:219], v2 offset:61440
v_mfma_f32_16x16x32_bf16 v[44:47], a[224:227], a[104:107], v[44:47]
v_mfma_f32_16x16x32_bf16 v[44:47], a[228:231], a[108:111], v[44:47]
ds_read_b128 a[220:223], v4 offset:3072
s_waitcnt lgkmcnt(4)
v_mfma_f32_16x16x32_bf16 v[48:51], a[232:235], a[32:35], v[48:51]
v_mfma_f32_16x16x32_bf16 v[48:51], a[236:239], a[36:39], v[48:51]
ds_read_b128 a[224:227], v2 offset:62464
v_mfma_f32_16x16x32_bf16 v[52:55], a[232:235], a[104:107], v[52:55]
buffer_store_dwordx4 v[188:191], v159, s[8:11], 0 offen sc1
v_mfma_f32_16x16x32_bf16 v[52:55], a[236:239], a[108:111], v[52:55]
ds_read_b128 a[228:231], v4 offset:4096
s_waitcnt lgkmcnt(4)
v_mfma_f32_16x16x32_bf16 v[56:59], a[240:243], a[32:35], v[56:59]
v_mfma_f32_16x16x32_bf16 v[56:59], a[244:247], a[36:39], v[56:59]
ds_read_b128 a[232:235], v2 offset:63488
v_mfma_f32_16x16x32_bf16 v[60:63], a[240:243], a[104:107], v[60:63]
v_mfma_f32_16x16x32_bf16 v[60:63], a[244:247], a[108:111], v[60:63]
ds_read_b128 a[236:239], v4 offset:5120
s_waitcnt lgkmcnt(4)
v_mfma_f32_16x16x32_bf16 v[64:67], a[216:219], a[32:35], v[64:67]
buffer_store_dwordx4 v[192:195], v160, s[8:11], 0 offen sc1
v_mfma_f32_16x16x32_bf16 v[64:67], a[220:223], a[36:39], v[64:67]
ds_read_b128 a[240:243], v6 offset:57344
v_mfma_f32_16x16x32_bf16 v[68:71], a[216:219], a[104:107], v[68:71]
v_mfma_f32_16x16x32_bf16 v[68:71], a[220:223], a[108:111], v[68:71]
ds_read_b128 a[244:247], v6 offset:64512
s_waitcnt lgkmcnt(4)
v_mfma_f32_16x16x32_bf16 v[72:75], a[32:35], a[224:227], v[72:75]
v_mfma_f32_16x16x32_bf16 v[72:75], a[36:39], a[228:231], v[72:75]
ds_read_b128 a[216:219], v9 offset:57344
v_mfma_f32_16x16x32_bf16 v[76:79], a[104:107], a[224:227], v[76:79]
buffer_store_dwordx4 v[196:199], v161, s[8:11], 0 offen sc1
v_mfma_f32_16x16x32_bf16 v[76:79], a[108:111], a[228:231], v[76:79]
ds_read_b128 a[220:223], v9 offset:64512
s_waitcnt lgkmcnt(4)
v_mfma_f32_16x16x32_bf16 v[80:83], a[32:35], a[232:235], v[80:83]
v_mfma_f32_16x16x32_bf16 v[80:83], a[36:39], a[236:239], v[80:83]
ds_read_b128 a[224:227], v4 offset:6144
v_mfma_f32_16x16x32_bf16 v[84:87], a[104:107], a[232:235], v[84:87]
v_mfma_f32_16x16x32_bf16 v[84:87], a[108:111], a[236:239], v[84:87]
ds_read_b128 a[228:231], v4 offset:13312
s_waitcnt lgkmcnt(4)
v_mfma_f32_16x16x32_bf16 v[88:91], a[240:243], a[176:179], v[88:91]
ds_read_b128 a[232:235], v4 offset:7168
buffer_store_dwordx4 v[200:203], v162, s[8:11], 0 offen sc1
v_mfma_f32_16x16x32_bf16 v[88:91], a[244:247], a[180:183], v[88:91]
ds_read_b128 a[236:239], v4 offset:14336
s_waitcnt lgkmcnt(4)
v_mfma_f32_16x16x32_bf16 v[92:95], a[176:179], a[216:219], v[92:95]
ds_read_b128 a[240:243], v4 offset:8192
v_mfma_f32_16x16x32_bf16 v[92:95], a[180:183], a[220:223], v[92:95]
ds_read_b128 a[244:247], v4 offset:15360
s_waitcnt vmcnt(25)
s_waitcnt lgkmcnt(4)
v_mfma_f32_16x16x32_bf16 v[32:35], a[224:227], a[40:43], v[32:35]
v_mfma_f32_16x16x32_bf16 v[32:35], a[228:231], a[44:47], v[32:35]
ds_read_b128 a[216:219], v4 offset:9216
v_mfma_f32_16x16x32_bf16 v[36:39], a[224:227], a[112:115], v[36:39]
buffer_store_dwordx4 v[204:207], v163, s[8:11], 0 offen sc1
v_mfma_f32_16x16x32_bf16 v[36:39], a[228:231], a[116:119], v[36:39]
ds_read_b128 a[220:223], v4 offset:16384
s_waitcnt lgkmcnt(4)
v_mfma_f32_16x16x32_bf16 v[40:43], a[232:235], a[40:43], v[40:43]
v_mfma_f32_16x16x32_bf16 v[40:43], a[236:239], a[44:47], v[40:43]
ds_read_b128 a[224:227], v4 offset:10240
v_mfma_f32_16x16x32_bf16 v[44:47], a[232:235], a[112:115], v[44:47]
v_mfma_f32_16x16x32_bf16 v[44:47], a[236:239], a[116:119], v[44:47]
ds_read_b128 a[228:231], v4 offset:17408
s_waitcnt lgkmcnt(4)
v_mfma_f32_16x16x32_bf16 v[48:51], a[240:243], a[40:43], v[48:51]
buffer_store_dwordx4 v[208:211], v164, s[8:11], 0 offen sc1
v_mfma_f32_16x16x32_bf16 v[48:51], a[244:247], a[44:47], v[48:51]
ds_read_b128 a[232:235], v4 offset:11264
v_mfma_f32_16x16x32_bf16 v[52:55], a[240:243], a[112:115], v[52:55]
v_mfma_f32_16x16x32_bf16 v[52:55], a[244:247], a[116:119], v[52:55]
ds_read_b128 a[236:239], v4 offset:18432
s_waitcnt lgkmcnt(4)
v_mfma_f32_16x16x32_bf16 v[56:59], a[216:219], a[40:43], v[56:59]
v_mfma_f32_16x16x32_bf16 v[56:59], a[220:223], a[44:47], v[56:59]
ds_read_b128 a[240:243], v4 offset:12288
v_mfma_f32_16x16x32_bf16 v[60:63], a[216:219], a[112:115], v[60:63]
buffer_store_dwordx4 v[212:215], v165, s[8:11], 0 offen sc1
v_mfma_f32_16x16x32_bf16 v[60:63], a[220:223], a[116:119], v[60:63]
ds_read_b128 a[244:247], v4 offset:19456
s_waitcnt lgkmcnt(4)
v_mfma_f32_16x16x32_bf16 v[64:67], a[224:227], a[40:43], v[64:67]
v_mfma_f32_16x16x32_bf16 v[64:67], a[228:231], a[44:47], v[64:67]
ds_read_b128 a[216:219], v7 offset:6144
v_mfma_f32_16x16x32_bf16 v[68:71], a[224:227], a[112:115], v[68:71]
v_mfma_f32_16x16x32_bf16 v[68:71], a[228:231], a[116:119], v[68:71]
ds_read_b128 a[220:223], v7 offset:13312
s_waitcnt lgkmcnt(4)
v_mfma_f32_16x16x32_bf16 v[72:75], a[40:43], a[232:235], v[72:75]
buffer_store_dwordx4 v[216:219], v166, s[8:11], 0 offen sc1
v_mfma_f32_16x16x32_bf16 v[72:75], a[44:47], a[236:239], v[72:75]
ds_read_b128 a[224:227], v10 offset:6144
v_mfma_f32_16x16x32_bf16 v[76:79], a[112:115], a[232:235], v[76:79]
v_mfma_f32_16x16x32_bf16 v[76:79], a[116:119], a[236:239], v[76:79]
ds_read_b128 a[228:231], v10 offset:13312
s_waitcnt lgkmcnt(4)
v_mfma_f32_16x16x32_bf16 v[80:83], a[40:43], a[240:243], v[80:83]
v_mfma_f32_16x16x32_bf16 v[80:83], a[44:47], a[244:247], v[80:83]
ds_read_b128 a[232:235], v4 offset:20480
v_mfma_f32_16x16x32_bf16 v[84:87], a[112:115], a[240:243], v[84:87]
buffer_store_dwordx4 v[220:223], v167, s[8:11], 0 offen sc1
v_mfma_f32_16x16x32_bf16 v[84:87], a[116:119], a[244:247], v[84:87]
ds_read_b128 a[236:239], v4 offset:27648
s_waitcnt lgkmcnt(4)
v_mfma_f32_16x16x32_bf16 v[88:91], a[216:219], a[184:187], v[88:91]
ds_read_b128 a[240:243], v4 offset:21504
v_mfma_f32_16x16x32_bf16 v[88:91], a[220:223], a[188:191], v[88:91]
ds_read_b128 a[244:247], v4 offset:28672
s_waitcnt lgkmcnt(4)
v_mfma_f32_16x16x32_bf16 v[92:95], a[184:187], a[224:227], v[92:95]
ds_read_b128 a[216:219], v4 offset:22528
v_mfma_f32_16x16x32_bf16 v[92:95], a[188:191], a[228:231], v[92:95]
ds_read_b128 a[220:223], v4 offset:29696
s_waitcnt vmcnt(24)
s_waitcnt lgkmcnt(4)
v_mfma_f32_16x16x32_bf16 v[32:35], a[232:235], a[48:51], v[32:35]
buffer_store_dwordx4 v[224:227], v168, s[8:11], 0 offen sc1
v_mfma_f32_16x16x32_bf16 v[32:35], a[236:239], a[52:55], v[32:35]
ds_read_b128 a[224:227], v4 offset:23552
v_mfma_f32_16x16x32_bf16 v[36:39], a[232:235], a[120:123], v[36:39]
v_mfma_f32_16x16x32_bf16 v[36:39], a[236:239], a[124:127], v[36:39]
ds_read_b128 a[228:231], v4 offset:30720
s_waitcnt lgkmcnt(4)
v_mfma_f32_16x16x32_bf16 v[40:43], a[240:243], a[48:51], v[40:43]
v_mfma_f32_16x16x32_bf16 v[40:43], a[244:247], a[52:55], v[40:43]
ds_read_b128 a[232:235], v4 offset:24576
v_mfma_f32_16x16x32_bf16 v[44:47], a[240:243], a[120:123], v[44:47]
buffer_store_dwordx4 v[228:231], v169, s[8:11], 0 offen sc1
v_mfma_f32_16x16x32_bf16 v[44:47], a[244:247], a[124:127], v[44:47]
ds_read_b128 a[236:239], v4 offset:31744
s_waitcnt lgkmcnt(4)
v_mfma_f32_16x16x32_bf16 v[48:51], a[216:219], a[48:51], v[48:51]
v_mfma_f32_16x16x32_bf16 v[48:51], a[220:223], a[52:55], v[48:51]
ds_read_b128 a[240:243], v4 offset:25600
v_mfma_f32_16x16x32_bf16 v[52:55], a[216:219], a[120:123], v[52:55]
v_mfma_f32_16x16x32_bf16 v[52:55], a[220:223], a[124:127], v[52:55]
ds_read_b128 a[244:247], v4 offset:32768
s_waitcnt lgkmcnt(4)
v_mfma_f32_16x16x32_bf16 v[56:59], a[224:227], a[48:51], v[56:59]
buffer_store_dwordx4 v[232:235], v170, s[8:11], 0 offen sc1
v_mfma_f32_16x16x32_bf16 v[56:59], a[228:231], a[52:55], v[56:59]
ds_read_b128 a[216:219], v4 offset:26624
v_mfma_f32_16x16x32_bf16 v[60:63], a[224:227], a[120:123], v[60:63]
v_mfma_f32_16x16x32_bf16 v[60:63], a[228:231], a[124:127], v[60:63]
ds_read_b128 a[220:223], v4 offset:33792
s_waitcnt lgkmcnt(4)
v_mfma_f32_16x16x32_bf16 v[64:67], a[232:235], a[48:51], v[64:67]
v_mfma_f32_16x16x32_bf16 v[64:67], a[236:239], a[52:55], v[64:67]
ds_read_b128 a[224:227], v7 offset:20480
v_mfma_f32_16x16x32_bf16 v[68:71], a[232:235], a[120:123], v[68:71]
buffer_store_dwordx4 v[236:239], v171, s[8:11], 0 offen sc1
v_mfma_f32_16x16x32_bf16 v[68:71], a[236:239], a[124:127], v[68:71]
ds_read_b128 a[228:231], v7 offset:27648
s_waitcnt lgkmcnt(4)
v_mfma_f32_16x16x32_bf16 v[72:75], a[48:51], a[240:243], v[72:75]
v_mfma_f32_16x16x32_bf16 v[72:75], a[52:55], a[244:247], v[72:75]
ds_read_b128 a[232:235], v10 offset:20480
v_mfma_f32_16x16x32_bf16 v[76:79], a[120:123], a[240:243], v[76:79]
v_mfma_f32_16x16x32_bf16 v[76:79], a[124:127], a[244:247], v[76:79]
ds_read_b128 a[236:239], v10 offset:27648
s_waitcnt lgkmcnt(4)
v_mfma_f32_16x16x32_bf16 v[80:83], a[48:51], a[216:219], v[80:83]
buffer_store_dwordx4 v[240:243], v172, s[8:11], 0 offen sc1
v_mfma_f32_16x16x32_bf16 v[80:83], a[52:55], a[220:223], v[80:83]
ds_read_b128 a[240:243], v4 offset:34816
v_mfma_f32_16x16x32_bf16 v[84:87], a[120:123], a[216:219], v[84:87]
v_mfma_f32_16x16x32_bf16 v[84:87], a[124:127], a[220:223], v[84:87]
ds_read_b128 a[244:247], v4 offset:41984
s_waitcnt lgkmcnt(4)
v_mfma_f32_16x16x32_bf16 v[88:91], a[224:227], a[192:195], v[88:91]
ds_read_b128 a[216:219], v4 offset:35840
v_mfma_f32_16x16x32_bf16 v[88:91], a[228:231], a[196:199], v[88:91]
ds_read_b128 a[220:223], v4 offset:43008
s_waitcnt lgkmcnt(4)
v_mfma_f32_16x16x32_bf16 v[92:95], a[192:195], a[232:235], v[92:95]
ds_read_b128 a[224:227], v4 offset:36864
buffer_store_dwordx4 v[244:247], v173, s[8:11], 0 offen sc1
v_mfma_f32_16x16x32_bf16 v[92:95], a[196:199], a[236:239], v[92:95]
ds_read_b128 a[228:231], v4 offset:44032
s_waitcnt vmcnt(24)
s_waitcnt lgkmcnt(4)
v_mfma_f32_16x16x32_bf16 v[32:35], a[240:243], a[56:59], v[32:35]
v_mfma_f32_16x16x32_bf16 v[32:35], a[244:247], a[60:63], v[32:35]
ds_read_b128 a[232:235], v4 offset:37888
v_mfma_f32_16x16x32_bf16 v[36:39], a[240:243], a[128:131], v[36:39]
v_mfma_f32_16x16x32_bf16 v[36:39], a[244:247], a[132:135], v[36:39]
ds_read_b128 a[236:239], v4 offset:45056
s_waitcnt lgkmcnt(4)
v_mfma_f32_16x16x32_bf16 v[40:43], a[216:219], a[56:59], v[40:43]
buffer_store_dwordx4 v[248:251], v174, s[8:11], 0 offen sc1
v_mfma_f32_16x16x32_bf16 v[40:43], a[220:223], a[60:63], v[40:43]
ds_read_b128 a[240:243], v4 offset:38912
v_mfma_f32_16x16x32_bf16 v[44:47], a[216:219], a[128:131], v[44:47]
v_mfma_f32_16x16x32_bf16 v[44:47], a[220:223], a[132:135], v[44:47]
ds_read_b128 a[244:247], v4 offset:46080
s_waitcnt lgkmcnt(4)
v_mfma_f32_16x16x32_bf16 v[48:51], a[224:227], a[56:59], v[48:51]
v_mfma_f32_16x16x32_bf16 v[48:51], a[228:231], a[60:63], v[48:51]
ds_read_b128 a[216:219], v4 offset:39936
v_mfma_f32_16x16x32_bf16 v[52:55], a[224:227], a[128:131], v[52:55]
buffer_store_dwordx4 v[252:255], v175, s[8:11], 0 offen sc1
v_mfma_f32_16x16x32_bf16 v[52:55], a[228:231], a[132:135], v[52:55]
ds_read_b128 a[220:223], v4 offset:47104
s_waitcnt lgkmcnt(4)
v_mfma_f32_16x16x32_bf16 v[56:59], a[232:235], a[56:59], v[56:59]
v_mfma_f32_16x16x32_bf16 v[56:59], a[236:239], a[60:63], v[56:59]
ds_read_b128 a[224:227], v4 offset:40960
v_mfma_f32_16x16x32_bf16 v[60:63], a[232:235], a[128:131], v[60:63]
v_mfma_f32_16x16x32_bf16 v[60:63], a[236:239], a[132:135], v[60:63]
ds_read_b128 a[228:231], v4 offset:48128
s_waitcnt lgkmcnt(4)
v_mfma_f32_16x16x32_bf16 v[64:67], a[240:243], a[56:59], v[64:67]
v_mfma_f32_16x16x32_bf16 v[64:67], a[244:247], a[60:63], v[64:67]
ds_read_b128 a[232:235], v7 offset:34816
v_mfma_f32_16x16x32_bf16 v[68:71], a[240:243], a[128:131], v[68:71]
v_mfma_f32_16x16x32_bf16 v[68:71], a[244:247], a[132:135], v[68:71]
ds_read_b128 a[236:239], v7 offset:41984
s_waitcnt lgkmcnt(4)
v_mfma_f32_16x16x32_bf16 v[72:75], a[56:59], a[216:219], v[72:75]
v_mfma_f32_16x16x32_bf16 v[72:75], a[60:63], a[220:223], v[72:75]
ds_read_b128 a[240:243], v10 offset:34816
v_mfma_f32_16x16x32_bf16 v[76:79], a[128:131], a[216:219], v[76:79]
v_mfma_f32_16x16x32_bf16 v[76:79], a[132:135], a[220:223], v[76:79]
ds_read_b128 a[244:247], v10 offset:41984
s_waitcnt lgkmcnt(4)
v_mfma_f32_16x16x32_bf16 v[80:83], a[56:59], a[224:227], v[80:83]
v_mfma_f32_16x16x32_bf16 v[80:83], a[60:63], a[228:231], v[80:83]
ds_read_b128 a[216:219], v4 offset:49152
v_mfma_f32_16x16x32_bf16 v[84:87], a[128:131], a[224:227], v[84:87]
v_mfma_f32_16x16x32_bf16 v[84:87], a[132:135], a[228:231], v[84:87]
ds_read_b128 a[220:223], v4 offset:56320
s_waitcnt lgkmcnt(4)
v_mfma_f32_16x16x32_bf16 v[88:91], a[232:235], a[200:203], v[88:91]
ds_read_b128 a[224:227], v4 offset:50176
v_mfma_f32_16x16x32_bf16 v[88:91], a[236:239], a[204:207], v[88:91]
ds_read_b128 a[228:231], v4 offset:57344
s_waitcnt lgkmcnt(4)
v_mfma_f32_16x16x32_bf16 v[92:95], a[200:203], a[240:243], v[92:95]
ds_read_b128 a[232:235], v4 offset:51200
v_mfma_f32_16x16x32_bf16 v[92:95], a[204:207], a[244:247], v[92:95]
ds_read_b128 a[236:239], v4 offset:58368
s_waitcnt vmcnt(20)
s_waitcnt lgkmcnt(4)
v_mfma_f32_16x16x32_bf16 v[32:35], a[216:219], a[64:67], v[32:35]
v_mfma_f32_16x16x32_bf16 v[32:35], a[220:223], a[68:71], v[32:35]
ds_read_b128 a[240:243], v4 offset:52224
v_mfma_f32_16x16x32_bf16 v[36:39], a[216:219], a[136:139], v[36:39]
v_mfma_f32_16x16x32_bf16 v[36:39], a[220:223], a[140:143], v[36:39]
ds_read_b128 a[244:247], v4 offset:59392
s_waitcnt lgkmcnt(4)
v_mfma_f32_16x16x32_bf16 v[40:43], a[224:227], a[64:67], v[40:43]
v_mfma_f32_16x16x32_bf16 v[40:43], a[228:231], a[68:71], v[40:43]
ds_read_b128 a[216:219], v4 offset:53248
v_mfma_f32_16x16x32_bf16 v[44:47], a[224:227], a[136:139], v[44:47]
v_mfma_f32_16x16x32_bf16 v[44:47], a[228:231], a[140:143], v[44:47]
ds_read_b128 a[220:223], v4 offset:60416
s_waitcnt lgkmcnt(4)
v_mfma_f32_16x16x32_bf16 v[48:51], a[232:235], a[64:67], v[48:51]
v_mfma_f32_16x16x32_bf16 v[48:51], a[236:239], a[68:71], v[48:51]
ds_read_b128 a[224:227], v4 offset:54272
v_mfma_f32_16x16x32_bf16 v[52:55], a[232:235], a[136:139], v[52:55]
v_mfma_f32_16x16x32_bf16 v[52:55], a[236:239], a[140:143], v[52:55]
ds_read_b128 a[228:231], v4 offset:61440
s_waitcnt lgkmcnt(4)
v_mfma_f32_16x16x32_bf16 v[56:59], a[240:243], a[64:67], v[56:59]
v_mfma_f32_16x16x32_bf16 v[56:59], a[244:247], a[68:71], v[56:59]
ds_read_b128 a[232:235], v4 offset:55296
v_mfma_f32_16x16x32_bf16 v[60:63], a[240:243], a[136:139], v[60:63]
v_mfma_f32_16x16x32_bf16 v[60:63], a[244:247], a[140:143], v[60:63]
ds_read_b128 a[236:239], v4 offset:62464
s_waitcnt lgkmcnt(4)
v_mfma_f32_16x16x32_bf16 v[64:67], a[216:219], a[64:67], v[64:67]
v_mfma_f32_16x16x32_bf16 v[64:67], a[220:223], a[68:71], v[64:67]
ds_read_b128 a[240:243], v7 offset:49152
v_mfma_f32_16x16x32_bf16 v[68:71], a[216:219], a[136:139], v[68:71]
v_mfma_f32_16x16x32_bf16 v[68:71], a[220:223], a[140:143], v[68:71]
ds_read_b128 a[244:247], v7 offset:56320
s_waitcnt lgkmcnt(4)
v_mfma_f32_16x16x32_bf16 v[72:75], a[64:67], a[224:227], v[72:75]
v_mfma_f32_16x16x32_bf16 v[72:75], a[68:71], a[228:231], v[72:75]
ds_read_b128 a[216:219], v10 offset:49152
v_mfma_f32_16x16x32_bf16 v[76:79], a[136:139], a[224:227], v[76:79]
v_mfma_f32_16x16x32_bf16 v[76:79], a[140:143], a[228:231], v[76:79]
ds_read_b128 a[220:223], v10 offset:56320
s_waitcnt lgkmcnt(4)
v_mfma_f32_16x16x32_bf16 v[80:83], a[64:67], a[232:235], v[80:83]
v_mfma_f32_16x16x32_bf16 v[80:83], a[68:71], a[236:239], v[80:83]
v_mfma_f32_16x16x32_bf16 v[84:87], a[136:139], a[232:235], v[84:87]
v_mfma_f32_16x16x32_bf16 v[84:87], a[140:143], a[236:239], v[84:87]
s_waitcnt lgkmcnt(2)
v_mfma_f32_16x16x32_bf16 v[88:91], a[240:243], a[208:211], v[88:91]
v_mfma_f32_16x16x32_bf16 v[88:91], a[244:247], a[212:215], v[88:91]
s_waitcnt lgkmcnt(0)
v_mfma_f32_16x16x32_bf16 v[92:95], a[208:211], a[216:219], v[92:95]
v_mfma_f32_16x16x32_bf16 v[92:95], a[212:215], a[220:223], v[92:95]
v_mov_b32 v103, 0xff61b1e6
v_mov_b32 v102, 0xffff
v_cndmask_b32 v172, v103, 0, s[44:45]
v_cndmask_b32 v173, v103, 0, s[46:47]
v_cndmask_b32 v174, v103, 0, s[48:49]
v_cndmask_b32 v175, v103, 0, s[50:51]
v_cndmask_b32 v184, 0, v102, s[44:45]
v_cndmask_b32 v13, 0, v102, s[46:47]
v_lshl_or_b32 v184, v13, 16, v184
v_cndmask_b32 v185, 0, v102, s[48:49]
v_cndmask_b32 v13, 0, v102, s[50:51]
v_lshl_or_b32 v185, v13, 16, v185
v_cndmask_b32 v176, v103, 0, s[52:53]
v_cndmask_b32 v177, v103, 0, s[54:55]
v_cndmask_b32 v178, v103, 0, s[56:57]
v_cndmask_b32 v179, v103, 0, s[58:59]
L_hop1:
s_cmp_eq_u32 s15, 1
s_cbranch_scc1 L_hop5
v_cndmask_b32 v186, 0, v102, s[52:53]
v_cndmask_b32 v13, 0, v102, s[54:55]
v_lshl_or_b32 v186, v13, 16, v186
v_cndmask_b32 v187, 0, v102, s[56:57]
v_cndmask_b32 v13, 0, v102, s[58:59]
v_lshl_or_b32 v187, v13, 16, v187
v_cndmask_b32 v180, v103, 0, s[60:61]
v_cndmask_b32 v181, v103, 0, s[62:63]
v_cndmask_b32 v182, v103, 0, s[64:65]
v_cndmask_b32 v183, v103, 0, s[66:67]
v_cndmask_b32 v188, 0, v102, s[60:61]
v_cndmask_b32 v13, 0, v102, s[62:63]
v_lshl_or_b32 v188, v13, 16, v188
v_cndmask_b32 v189, 0, v102, s[64:65]
v_cndmask_b32 v13, 0, v102, s[66:67]
v_lshl_or_b32 v189, v13, 16, v189
L_att:
v_cvt_pk_bf16_f32 v160, v64, v65
v_cvt_pk_bf16_f32 v161, v66, v67
v_cvt_pk_bf16_f32 v162, v68, v69
v_cvt_pk_bf16_f32 v163, v70, v71
v_cvt_pk_bf16_f32 v156, v88, v89
v_cvt_pk_bf16_f32 v157, v90, v91
v_cvt_pk_bf16_f32 v158, v92, v93
v_cvt_pk_bf16_f32 v159, v94, v95
v_mfma_f32_16x16x32_bf16 v[164:167], v[160:163], v[96:99], 0
s_nop 0
v_mfma_f32_16x16x32_bf16 v[168:171], v[156:159], v[98:101], 0
v_mfma_f32_16x16x32_bf16 v[88:91], v[160:163], v[98:101], 0
v_cvt_pk_bf16_f32 v116, v52, v53
v_cvt_pk_bf16_f32 v117, v54, v55
v_cvt_pk_bf16_f32 v120, v60, v61
v_cvt_pk_bf16_f32 v121, v62, v63
v_cvt_pk_bf16_f32 v126, v76, v77
v_cvt_pk_bf16_f32 v127, v78, v79
v_cvt_pk_bf16_f32 v132, v84, v85
v_cvt_pk_bf16_f32 v133, v86, v87
v_cvt_pk_bf16_f32 v138, v164, v165
v_cvt_pk_bf16_f32 v139, v166, v167
v_cvt_pk_bf16_f32 v164, v168, v169
v_cvt_pk_bf16_f32 v165, v170, v171
s_cmp_eq_u32 s4, 3
s_cbranch_scc1 L_a1_noxch
ds_write_b64 v16, v[156:157]
ds_write_b64 v15, v[116:117] offset:3072
ds_write_b64 v15, v[120:121] offset:3584
ds_write_b64 v15, v[162:163] offset:4096
ds_write_b64 v15, v[126:127] offset:4608
ds_write_b64 v15, v[132:133] offset:5120
ds_write_b64 v15, v[138:139] offset:5632
s_cmp_eq_u32 s4, 2
s_cbranch_scc1 L_a1_left
ds_write_b64 v19, v[158:159] offset:1536
s_branch L_a1_noxch
L_a1_left:
ds_write_b64 v18, v[164:165]
L_a1_noxch:
v_cvt_pk_bf16_f32 v136, v88, v89
v_cvt_pk_bf16_f32 v137, v90, v91
v_cvt_pk_bf16_f32 v110, v48, v49
v_cvt_pk_bf16_f32 v111, v50, v51
v_cvt_pk_bf16_f32 v114, v56, v57
v_cvt_pk_bf16_f32 v115, v58, v59
v_cvt_pk_bf16_f32 v124, v72, v73
v_cvt_pk_bf16_f32 v125, v74, v75
v_cvt_pk_bf16_f32 v130, v80, v81
v_cvt_pk_bf16_f32 v131, v82, v83
v_cvt_pk_bf16_f32 v140, v32, v33
v_cvt_pk_bf16_f32 v141, v34, v35
v_cvt_pk_bf16_f32 v146, v40, v41
v_cvt_pk_bf16_f32 v147, v42, v43
v_mov_b32 v142, v160
v_mov_b32 v145, v161
v_mov_b32 v143, 0
v_mov_b32 v144, 0
v_mov_b32 v112, 0
v_mov_b32 v113, 0
s_nop 0
v_permlane16_swap_b32 v142, v112
v_permlane16_swap_b32 v145, v113
v_cvt_pk_bf16_f32 v148, v36, v37
v_cvt_pk_bf16_f32 v149, v38, v39
v_cvt_pk_bf16_f32 v154, v44, v45
v_cvt_pk_bf16_f32 v155, v46, v47
v_mov_b32 v150, v162
v_mov_b32 v153, v163
v_mov_b32 v151, 0
v_mov_b32 v152, 0
v_mov_b32 v118, 0
v_mov_b32 v119, 0
s_nop 0
v_permlane16_swap_b32 v150, v118
v_permlane16_swap_b32 v153, v119
s_waitcnt lgkmcnt(0)
s_barrier
s_and_b32 s37, s6, 7
s_mul_i32 s37, s37, 92160
s_mul_i32 s38, s4, 23552
s_add_u32 s37, s37, s38
s_add_u32 s37, s37, 6266880
ds_read_b64 v[104:105], v15
ds_read_b64 v[108:109], v15 offset:512
ds_read_b64 v[106:107], v17 offset:1024
ds_read_b64 v[122:123], v15 offset:1536
ds_read_b64 v[128:129], v15 offset:2048
ds_read_b64 v[134:135], v15 offset:2560
v_mfma_f32_16x16x32_bf16 v[32:35], v[110:113], v[148:151], v[172:175]
v_mfma_f32_16x16x32_bf16 v[36:39], v[116:119], v[148:151], v[176:179]
v_mfma_f32_16x16x32_bf16 v[40:43], v[112:115], v[152:155], v[172:175]
v_mfma_f32_16x16x32_bf16 v[44:47], v[118:121], v[152:155], v[176:179]
s_waitcnt lgkmcnt(3)
v_mfma_f32_16x16x32_bf16 v[48:51], v[104:107], v[140:143], v[180:183]
v_mfma_f32_16x16x32_bf16 v[52:55], v[110:113], v[140:143], v[176:179]
v_mfma_f32_16x16x32_bf16 v[56:59], v[106:109], v[144:147], v[180:183]
v_mfma_f32_16x16x32_bf16 v[60:63], v[112:115], v[144:147], v[176:179]
s_nop 0
v_max_f32 v32, v32, v36
v_max_f32 v33, v33, v37
v_max_f32 v34, v34, v38
v_max_f32 v35, v35, v39
v_max_f32 v40, v40, v44
v_max_f32 v41, v41, v45
v_max_f32 v42, v42, v46
v_max_f32 v43, v43, v47
v_max_f32 v48, v48, v52
v_max_f32 v49, v49, v53
v_max_f32 v50, v50, v54
v_max_f32 v51, v51, v55
v_max_f32 v56, v56, v60
v_max_f32 v57, v57, v61
v_max_f32 v58, v58, v62
v_max_f32 v59, v59, v63
v_max3_f32 v20, v32, v33, v34
v_max3_f32 v21, v40, v41, v42
v_max3_f32 v22, v48, v49, v50
v_max3_f32 v23, v56, v57, v58
v_max_f32 v20, v20, v35
v_max_f32 v21, v21, v43
v_max_f32 v22, v22, v51
v_max_f32 v23, v23, v59
v_mov_b32 v24, v20
v_mov_b32 v25, v21
v_mov_b32 v26, v22
v_mov_b32 v27, v23
v_permlane16_swap_b32 v20, v24
v_permlane16_swap_b32 v21, v25
v_permlane16_swap_b32 v22, v26
v_permlane16_swap_b32 v23, v27
v_max_f32 v20, v20, v24
v_max_f32 v21, v21, v25
v_max_f32 v22, v22, v26
v_max_f32 v23, v23, v27
v_mov_b32 v24, v20
v_mov_b32 v25, v21
v_mov_b32 v26, v22
v_mov_b32 v27, v23
v_permlane32_swap_b32 v20, v24
v_permlane32_swap_b32 v21, v25
v_permlane32_swap_b32 v22, v26
v_permlane32_swap_b32 v23, v27
v_max_f32 v20, v20, v24
v_max_f32 v21, v21, v25
v_max_f32 v22, v22, v26
v_max_f32 v23, v23, v27
v_mul_f32 v20, s34, v20
v_mul_f32 v21, s34, v21
v_mul_f32 v22, s34, v22
v_mul_f32 v23, s34, v23
v_fma_f32 v32, v32, s34, -v20
v_fma_f32 v40, v40, s34, -v21
v_fma_f32 v48, v48, s34, -v22
v_fma_f32 v56, v56, s34, -v23
v_exp_f32 v32, v32
v_exp_f32 v40, v40
v_exp_f32 v48, v48
v_exp_f32 v56, v56
v_fma_f32 v33, v33, s34, -v20
v_fma_f32 v41, v41, s34, -v21
v_fma_f32 v49, v49, s34, -v22
v_fma_f32 v57, v57, s34, -v23
v_exp_f32 v33, v33
v_exp_f32 v41, v41
v_exp_f32 v49, v49
v_exp_f32 v57, v57
v_fma_f32 v34, v34, s34, -v20
v_fma_f32 v42, v42, s34, -v21
v_fma_f32 v50, v50, s34, -v22
v_fma_f32 v58, v58, s34, -v23
v_exp_f32 v34, v34
v_exp_f32 v42, v42
v_exp_f32 v50, v50
v_exp_f32 v58, v58
v_fma_f32 v35, v35, s34, -v20
v_fma_f32 v43, v43, s34, -v21
v_fma_f32 v51, v51, s34, -v22
v_fma_f32 v59, v59, s34, -v23
v_exp_f32 v35, v35
v_exp_f32 v43, v43
v_exp_f32 v51, v51
v_exp_f32 v59, v59
v_add_f32 v28, v32, v33
v_add_f32 v29, v40, v41
v_add_f32 v30, v48, v49
v_add_f32 v31, v56, v57
v_add_f32 v28, v28, v34
v_add_f32 v29, v29, v42
v_add_f32 v30, v30, v50
v_add_f32 v31, v31, v58
v_add_f32 v28, v28, v35
v_add_f32 v29, v29, v43
v_add_f32 v30, v30, v51
v_add_f32 v31, v31, v59
v_mov_b32 v24, v28
v_mov_b32 v25, v29
v_mov_b32 v26, v30
v_mov_b32 v27, v31
v_permlane16_swap_b32 v28, v24
v_permlane16_swap_b32 v29, v25
v_permlane16_swap_b32 v30, v26
v_permlane16_swap_b32 v31, v27
v_add_f32 v28, v28, v24
v_add_f32 v29, v29, v25
v_add_f32 v30, v30, v26
v_add_f32 v31, v31, v27
v_mov_b32 v24, v28
v_mov_b32 v25, v29
v_mov_b32 v26, v30
v_mov_b32 v27, v31
v_permlane32_swap_b32 v28, v24
v_permlane32_swap_b32 v29, v25
v_permlane32_swap_b32 v30, v26
v_permlane32_swap_b32 v31, v27
v_add_f32 v28, v28, v24
v_add_f32 v29, v29, v25
v_add_f32 v30, v30, v26
v_add_f32 v31, v31, v27
v_rcp_f32 v28, v28
v_rcp_f32 v29, v29
v_rcp_f32 v30, v30
v_rcp_f32 v31, v31
v_mul_f32 v32, v32, v28
v_mul_f32 v40, v40, v29
v_mul_f32 v48, v48, v30
v_mul_f32 v56, v56, v31
v_mul_f32 v33, v33, v28
v_mul_f32 v41, v41, v29
v_mul_f32 v49, v49, v30
v_mul_f32 v57, v57, v31
v_mul_f32 v34, v34, v28
v_mul_f32 v42, v42, v29
v_mul_f32 v50, v50, v30
v_mul_f32 v58, v58, v31
v_mul_f32 v35, v35, v28
v_mul_f32 v43, v43, v29
v_mul_f32 v51, v51, v30
v_mul_f32 v59, v59, v31
v_cvt_pk_bf16_f32 v36, v32, v33
v_cvt_pk_bf16_f32 v37, v34, v35
v_cvt_pk_bf16_f32 v44, v40, v41
v_cvt_pk_bf16_f32 v45, v42, v43
v_cvt_pk_bf16_f32 v52, v48, v49
v_cvt_pk_bf16_f32 v53, v50, v51
v_cvt_pk_bf16_f32 v60, v56, v57
v_cvt_pk_bf16_f32 v61, v58, v59
v_and_b32 v64, v184, v36
v_and_b32 v66, v186, v36
v_and_b32 v65, v185, v37
v_and_b32 v67, v187, v37
v_and_b32 v68, v184, v44
v_and_b32 v70, v186, v44
v_and_b32 v69, v185, v45
v_and_b32 v71, v187, v45
v_and_b32 v72, v188, v52
v_and_b32 v74, v186, v52
v_and_b32 v73, v189, v53
v_and_b32 v75, v187, v53
v_and_b32 v76, v188, v60
v_and_b32 v78, v186, v60
v_and_b32 v77, v189, v61
v_and_b32 v79, v187, v61
s_waitcnt lgkmcnt(0)
v_mfma_f32_16x16x32_bf16 v[80:83], v[124:127], v[64:67], 0
v_mfma_f32_16x16x32_bf16 v[84:87], v[136:139], v[64:67], 0
v_mfma_f32_16x16x32_bf16 v[88:91], v[130:133], v[68:71], 0
v_mfma_f32_16x16x32_bf16 v[92:95], v[136:139], v[68:71], 0
v_mfma_f32_16x16x32_bf16 v[96:99], v[122:125], v[72:75], 0
v_mfma_f32_16x16x32_bf16 v[100:103], v[134:137], v[72:75], 0
v_mfma_f32_16x16x32_bf16 v[164:167], v[128:131], v[76:79], 0
v_mfma_f32_16x16x32_bf16 v[168:171], v[134:137], v[76:79], 0
v_lshlrev_b32 v14, 3, v12
v_mov_b32 v15, 2146435072
v_cmp_gt_u32 vcc, 16, v1
s_nop 1
v_cndmask_b32 v14, v15, v14, vcc
s_add_u32 s26, s24, s72
s_lshl_b32 s27, s21, 10
s_add_u32 s27, s27, s26
s_lshl_b32 s28, s21, 7
s_add_u32 s28, s28, 16384
s_add_u32 s28, s28, s26
s_add_u32 s30, s27, 18432
s_add_u32 s31, s28, 18432
v_cvt_pk_bf16_f32 v40, v80, v81
v_cvt_pk_bf16_f32 v41, v82, v83
v_cvt_pk_bf16_f32 v42, v88, v89
v_cvt_pk_bf16_f32 v43, v90, v91
v_cvt_pk_bf16_f32 v44, v84, v85
v_cvt_pk_bf16_f32 v45, v94, v95
buffer_store_dwordx4 v[40:43], v2, s[8:11], s30 offen sc1
buffer_store_dwordx2 v[44:45], v14, s[8:11], s31 offen sc1
v_cvt_pk_bf16_f32 v32, v96, v97
v_cvt_pk_bf16_f32 v33, v98, v99
v_cvt_pk_bf16_f32 v34, v164, v165
v_cvt_pk_bf16_f32 v35, v166, v167
v_cvt_pk_bf16_f32 v36, v100, v101
v_cvt_pk_bf16_f32 v37, v170, v171
buffer_store_dwordx4 v[32:35], v2, s[8:11], s27 offen sc1
buffer_store_dwordx2 v[36:37], v14, s[8:11], s28 offen sc1
s_lshl_b32 s26, s20, 4
s_add_u32 s26, s26, s21
s_lshl_b32 s14, s26, 7
s_add_u32 s14, s14, 393216
s_add_u32 s14, s14, s77
s_lshr_b32 s20, s6, 3
s_lshl_b32 s21, s5, 2
s_add_u32 s20, s20, s21
s_lshl_b32 s20, s20, 2
s_add_u32 s20, s20, s4
s_and_b32 s21, s6, 7
s_mul_i32 s24, s20, 18432
s_add_u32 s25, s24, s72
s_mul_i32 s26, s21, 2304
s_add_u32 s26, s26, s24
s_add_u32 s27, s26, s71
v_and_b32 v6, 15, v1
v_lshrrev_b32 v7, 4, v1
v_lshlrev_b32 v8, 4, v6
v_lshl_add_u32 v8, v7, 3, v8
v_add_u32 v8, 2048, v8
v_mov_b32 v9, 2146435072
v_cmp_gt_u32 vcc, 32, v1
s_nop 1
v_cndmask_b32 v4, v9, v8, vcc
v_add_u32 v5, 0x10000, v2
s_and_b32 s40, s5, 1
s_lshl_b32 s40, s40, 2
s_lshr_b32 s41, s6, 3
s_add_u32 s40, s40, s41
s_lshr_b32 s41, s5, 1
s_lshl_b32 s41, s41, 3
s_and_b32 s42, s6, 7
s_add_u32 s41, s41, s42
s_lshr_b32 s42, s41, 2
s_and_b32 s43, s41, 3
s_lshr_b32 s22, s20, 3
s_lshl_b32 s22, s22, 4
v_add_u32 v10, s22, v6
v_subrev_u32 v12, 16, v1
v_min_u32 v12, 26, v12
v_mul_u32_u24 v16, 57, v12
v_lshrrev_b32 v16, 9, v16
v_mad_u32_u24 v12, v16, 63, v12
s_mul_i32 s22, s42, 9
v_add_u32 v12, s22, v12
v_and_b32 v16, 7, v12
v_lshrrev_b32 v12, 3, v12
v_lshrrev_b32 v17, 2, v16
v_lshlrev_b32 v17, 3, v17
v_lshrrev_b32 v18, 2, v12
v_add_lshl_u32 v17, v17, v18, 4
v_and_b32 v16, 3, v16
v_lshl_add_u32 v17, v16, 2, v17
v_and_b32 v12, 3, v12
v_add_u32 v17, v17, v12
s_cmp_eq_u32 s7, 0
s_cselect_b32 s22, 16, 64
v_cmp_le_u32 vcc, s22, v1
s_nop 1
v_cndmask_b32 v10, v10, v17, vcc
v_lshlrev_b32 v10, 7, v10
s_add_u32 s22, s77, 393216
v_lshlrev_b32 v11, 3, v6
v_lshl_add_u32 v11, v7, 8, v11
v_mov_b32 v13, 2146435072
v_cmp_gt_u32 vcc, 16, v0
v_lshlrev_b32 v14, 3, v0
s_nop 0
v_cndmask_b32 v13, v13, v14, vcc
v_mov_b32 v14, s68
v_mov_b32 v15, s69
s_waitcnt vmcnt(0)
s_barrier
buffer_store_dwordx2 v[14:15], v13, s[8:11], s14 offen sc1
s_add_u32 m0, s38, 0
s_add_u32 s39, s37, 0
buffer_load_dwordx4 v2, s[8:11], s39 offen offset:0 sc1 lds
buffer_load_dwordx4 v2, s[8:11], s39 offen offset:1024 sc1 lds
buffer_load_dwordx4 v2, s[8:11], s39 offen offset:2048 sc1 lds
buffer_load_dwordx4 v2, s[8:11], s39 offen offset:3072 sc1 lds
s_add_u32 m0, s38, 4096
s_add_u32 s39, s37, 4096
buffer_load_dwordx4 v2, s[8:11], s39 offen offset:0 sc1 lds
buffer_load_dwordx4 v2, s[8:11], s39 offen offset:1024 sc1 lds
buffer_load_dwordx4 v2, s[8:11], s39 offen offset:2048 sc1 lds
buffer_load_dwordx4 v2, s[8:11], s39 offen offset:3072 sc1 lds
s_add_u32 m0, s38, 8192
s_add_u32 s39, s37, 8192
buffer_load_dwordx4 v2, s[8:11], s39 offen offset:0 sc1 lds
buffer_load_dwordx4 v2, s[8:11], s39 offen offset:1024 sc1 lds
buffer_load_dwordx4 v2, s[8:11], s39 offen offset:2048 sc1 lds
buffer_load_dwordx4 v2, s[8:11], s39 offen offset:3072 sc1 lds
s_add_u32 m0, s38, 12288
s_add_u32 s39, s37, 12288
buffer_load_dwordx4 v2, s[8:11], s39 offen offset:0 sc1 lds
buffer_load_dwordx4 v2, s[8:11], s39 offen offset:1024 sc1 lds
buffer_load_dwordx4 v2, s[8:11], s39 offen offset:2048 sc1 lds
buffer_load_dwordx4 v2, s[8:11], s39 offen offset:3072 sc1 lds
s_add_u32 m0, s38, 16384
s_add_u32 s39, s37, 16384
buffer_load_dwordx4 v2, s[8:11], s39 offen offset:0 sc1 lds
buffer_load_dwordx4 v2, s[8:11], s39 offen offset:1024 sc1 lds
buffer_load_dwordx4 v2, s[8:11], s39 offen offset:2048 sc1 lds
buffer_load_dwordx4 v2, s[8:11], s39 offen offset:3072 sc1 lds
s_add_u32 m0, s38, 20480
s_add_u32 s39, s37, 20480
buffer_load_dwordx4 v2, s[8:11], s39 offen offset:0 sc1 lds
buffer_load_dwordx4 v2, s[8:11], s39 offen offset:1024 sc1 lds
buffer_load_dwordx4 v2, s[8:11], s39 offen offset:2048 sc1 lds
s_mov_b32 s52, 0
L_poll2:
buffer_load_dwordx2 v[14:15], v10, s[8:11], s22 offen sc1
s_add_u32 s52, s52, 1
s_waitcnt vmcnt(0)
v_cmp_ne_u64 vcc, s[68:69], v[14:15]
s_cmp_ge_u32 s52, 1048576
s_cbranch_scc1 L_got2
s_and_b64 exec, exec, vcc
s_cbranch_execnz L_poll2
L_got2:
s_mov_b64 exec, -1
buffer_load_dwordx4 a[0:3], v2, s[8:11], s25 offen offset:0 sc1
buffer_load_dwordx4 a[4:7], v2, s[8:11], s25 offen offset:1024 sc1
buffer_load_dwordx4 a[8:11], v2, s[8:11], s25 offen offset:2048 sc1
buffer_load_dwordx4 a[12:15], v2, s[8:11], s25 offen offset:3072 sc1
s_add_u32 s25, s25, 4096
buffer_load_dwordx4 a[16:19], v2, s[8:11], s25 offen offset:0 sc1
buffer_load_dwordx4 a[20:23], v2, s[8:11], s25 offen offset:1024 sc1
buffer_load_dwordx4 a[24:27], v2, s[8:11], s25 offen offset:2048 sc1
buffer_load_dwordx4 a[28:31], v2, s[8:11], s25 offen offset:3072 sc1
s_add_u32 s25, s25, 4096
buffer_load_dwordx4 a[32:35], v2, s[8:11], s25 offen offset:0 sc1
buffer_load_dwordx4 a[36:39], v2, s[8:11], s25 offen offset:1024 sc1
buffer_load_dwordx4 a[40:43], v2, s[8:11], s25 offen offset:2048 sc1
buffer_load_dwordx4 a[44:47], v2, s[8:11], s25 offen offset:3072 sc1
s_barrier
ds_read_b128 a[216:219], v2 offset:0
ds_read_b128 a[220:223], v2 offset:5120
ds_read_b128 a[224:227], v2 offset:1024
ds_read_b128 a[228:231], v2 offset:6144
ds_read_b128 a[232:235], v2 offset:2048
ds_read_b128 a[236:239], v2 offset:7168
s_mul_i32 s22, s4, 6144
s_mul_i32 s23, s41, 497664
s_add_u32 s23, s23, s22
s_add_u32 s23, s23, 7012352
v_add_u32 v3, s23, v2
s_waitcnt vmcnt(10)
s_waitcnt lgkmcnt(4)
v_mfma_f32_16x16x32_bf16 v[32:35], a[216:219], a[0:3], 0
ds_read_b128 a[240:243], v2 offset:3072
v_mfma_f32_16x16x32_bf16 v[32:35], a[220:223], a[4:7], v[32:35]
ds_read_b128 a[244:247], v2 offset:8192
s_add_u32 s25, s25, 4096
buffer_load_dwordx4 a[48:51], v2, s[8:11], s25 offen offset:0 sc1
s_waitcnt lgkmcnt(4)
v_mfma_f32_16x16x32_bf16 v[36:39], a[224:227], a[0:3], 0
ds_read_b128 a[216:219], v2 offset:4096
v_mfma_f32_16x16x32_bf16 v[36:39], a[228:231], a[4:7], v[36:39]
ds_read_b128 a[220:223], v2 offset:9216
s_waitcnt lgkmcnt(4)
v_mfma_f32_16x16x32_bf16 v[40:43], a[232:235], a[0:3], 0
ds_read_b128 a[224:227], v2 offset:10240
v_mfma_f32_16x16x32_bf16 v[40:43], a[236:239], a[4:7], v[40:43]
ds_read_b128 a[228:231], v2 offset:15360
buffer_load_dwordx4 a[52:55], v2, s[8:11], s25 offen offset:1024 sc1
s_waitcnt lgkmcnt(4)
v_mfma_f32_16x16x32_bf16 v[44:47], a[240:243], a[0:3], 0
ds_read_b128 a[232:235], v2 offset:11264
v_mfma_f32_16x16x32_bf16 v[44:47], a[244:247], a[4:7], v[44:47]
ds_read_b128 a[236:239], v2 offset:16384
s_waitcnt lgkmcnt(4)
v_mfma_f32_16x16x32_bf16 v[48:51], a[216:219], a[0:3], 0
ds_read_b128 a[240:243], v2 offset:12288
v_mfma_f32_16x16x32_bf16 v[48:51], a[220:223], a[4:7], v[48:51]
ds_read_b128 a[244:247], v2 offset:17408
buffer_load_dwordx4 a[56:59], v2, s[8:11], s25 offen offset:2048 sc1
s_waitcnt vmcnt(11)
s_waitcnt lgkmcnt(4)
v_mfma_f32_16x16x32_bf16 v[32:35], a[224:227], a[8:11], v[32:35]
ds_read_b128 a[216:219], v2 offset:13312
v_mfma_f32_16x16x32_bf16 v[32:35], a[228:231], a[12:15], v[32:35]
ds_read_b128 a[220:223], v2 offset:18432
s_waitcnt lgkmcnt(4)
v_mfma_f32_16x16x32_bf16 v[36:39], a[232:235], a[8:11], v[36:39]
ds_read_b128 a[224:227], v2 offset:14336
v_mfma_f32_16x16x32_bf16 v[36:39], a[236:239], a[12:15], v[36:39]
ds_read_b128 a[228:231], v2 offset:19456
buffer_load_dwordx4 a[60:63], v2, s[8:11], s25 offen offset:3072 sc1
s_waitcnt lgkmcnt(4)
v_mfma_f32_16x16x32_bf16 v[40:43], a[240:243], a[8:11], v[40:43]
ds_read_b128 a[232:235], v2 offset:20480
v_mfma_f32_16x16x32_bf16 v[40:43], a[244:247], a[12:15], v[40:43]
ds_read_b128 a[236:239], v2 offset:25600
s_waitcnt lgkmcnt(4)
v_mfma_f32_16x16x32_bf16 v[44:47], a[216:219], a[8:11], v[44:47]
ds_read_b128 a[240:243], v2 offset:21504
v_mfma_f32_16x16x32_bf16 v[44:47], a[220:223], a[12:15], v[44:47]
ds_read_b128 a[244:247], v2 offset:26624
s_add_u32 s25, s25, 4096
buffer_load_dwordx2 a[64:65], v11, s[8:11], s25 offen offset:0 sc1
buffer_load_dwordx2 a[66:67], v11, s[8:11], s25 offen offset:128 sc1
s_waitcnt lgkmcnt(4)
v_mfma_f32_16x16x32_bf16 v[48:51], a[224:227], a[8:11], v[48:51]
ds_read_b128 a[216:219], v2 offset:22528
v_mfma_f32_16x16x32_bf16 v[48:51], a[228:231], a[12:15], v[48:51]
ds_read_b128 a[220:223], v2 offset:27648
s_waitcnt vmcnt(12)
s_waitcnt lgkmcnt(4)
v_mfma_f32_16x16x32_bf16 v[32:35], a[232:235], a[16:19], v[32:35]
ds_read_b128 a[224:227], v2 offset:23552
v_mfma_f32_16x16x32_bf16 v[32:35], a[236:239], a[20:23], v[32:35]
ds_read_b128 a[228:231], v2 offset:28672
buffer_load_dwordx2 a[68:69], v11, s[8:11], s25 offen offset:1024 sc1
buffer_load_dwordx2 a[70:71], v11, s[8:11], s25 offen offset:1152 sc1
s_waitcnt lgkmcnt(4)
v_mfma_f32_16x16x32_bf16 v[36:39], a[240:243], a[16:19], v[36:39]
ds_read_b128 a[232:235], v2 offset:24576
v_mfma_f32_16x16x32_bf16 v[36:39], a[244:247], a[20:23], v[36:39]
ds_read_b128 a[236:239], v2 offset:29696
s_waitcnt lgkmcnt(4)
v_mfma_f32_16x16x32_bf16 v[40:43], a[216:219], a[16:19], v[40:43]
ds_read_b128 a[240:243], v2 offset:30720
v_mfma_f32_16x16x32_bf16 v[40:43], a[220:223], a[20:23], v[40:43]
ds_read_b128 a[244:247], v2 offset:35840
buffer_load_dwordx4 v[56:59], v2, s[8:11], s27 offen sc1
s_waitcnt lgkmcnt(4)
v_mfma_f32_16x16x32_bf16 v[44:47], a[224:227], a[16:19], v[44:47]
ds_read_b128 a[216:219], v2 offset:31744
v_mfma_f32_16x16x32_bf16 v[44:47], a[228:231], a[20:23], v[44:47]
ds_read_b128 a[220:223], v2 offset:36864
s_waitcnt lgkmcnt(4)
v_mfma_f32_16x16x32_bf16 v[48:51], a[232:235], a[16:19], v[48:51]
ds_read_b128 a[224:227], v2 offset:32768
v_mfma_f32_16x16x32_bf16 v[48:51], a[236:239], a[20:23], v[48:51]
ds_read_b128 a[228:231], v2 offset:37888
buffer_load_dwordx4 v[60:63], v2, s[8:11], s27 offen offset:1024 sc1
s_waitcnt vmcnt(14)
s_waitcnt lgkmcnt(4)
v_mfma_f32_16x16x32_bf16 v[32:35], a[240:243], a[24:27], v[32:35]
ds_read_b128 a[232:235], v2 offset:33792
v_mfma_f32_16x16x32_bf16 v[32:35], a[244:247], a[28:31], v[32:35]
ds_read_b128 a[236:239], v2 offset:38912
s_waitcnt lgkmcnt(4)
v_mfma_f32_16x16x32_bf16 v[36:39], a[216:219], a[24:27], v[36:39]
ds_read_b128 a[240:243], v2 offset:34816
v_mfma_f32_16x16x32_bf16 v[36:39], a[220:223], a[28:31], v[36:39]
ds_read_b128 a[244:247], v2 offset:39936
buffer_load_dwordx2 v[64:65], v4, s[8:11], s27 offen sc1
s_waitcnt lgkmcnt(4)
v_mfma_f32_16x16x32_bf16 v[40:43], a[224:227], a[24:27], v[40:43]
ds_read_b128 a[216:219], v2 offset:40960
v_mfma_f32_16x16x32_bf16 v[40:43], a[228:231], a[28:31], v[40:43]
ds_read_b128 a[220:223], v2 offset:46080
s_waitcnt lgkmcnt(4)
v_mfma_f32_16x16x32_bf16 v[44:47], a[232:235], a[24:27], v[44:47]
ds_read_b128 a[224:227], v2 offset:41984
v_mfma_f32_16x16x32_bf16 v[44:47], a[236:239], a[28:31], v[44:47]
ds_read_b128 a[228:231], v2 offset:47104
s_add_u32 m0, s22, 98304
s_nop 0
buffer_load_dwordx4 v3, s[8:11], 0 offen offset:0 sc1 lds
s_waitcnt lgkmcnt(4)
v_mfma_f32_16x16x32_bf16 v[48:51], a[240:243], a[24:27], v[48:51]
ds_read_b128 a[232:235], v2 offset:43008
v_mfma_f32_16x16x32_bf16 v[48:51], a[244:247], a[28:31], v[48:51]
ds_read_b128 a[236:239], v2 offset:48128
s_waitcnt vmcnt(14)
s_waitcnt lgkmcnt(4)
v_mfma_f32_16x16x32_bf16 v[32:35], a[216:219], a[32:35], v[32:35]
ds_read_b128 a[240:243], v2 offset:44032
v_mfma_f32_16x16x32_bf16 v[32:35], a[220:223], a[36:39], v[32:35]
ds_read_b128 a[244:247], v2 offset:49152
buffer_load_dwordx4 v3, s[8:11], 0 offen offset:1024 sc1 lds
s_waitcnt lgkmcnt(4)
v_mfma_f32_16x16x32_bf16 v[36:39], a[224:227], a[32:35], v[36:39]
ds_read_b128 a[216:219], v2 offset:45056
v_mfma_f32_16x16x32_bf16 v[36:39], a[228:231], a[36:39], v[36:39]
ds_read_b128 a[220:223], v2 offset:50176
s_waitcnt lgkmcnt(4)
v_mfma_f32_16x16x32_bf16 v[40:43], a[232:235], a[32:35], v[40:43]
ds_read_b128 a[224:227], v2 offset:51200
v_mfma_f32_16x16x32_bf16 v[40:43], a[236:239], a[36:39], v[40:43]
ds_read_b128 a[228:231], v2 offset:56320
buffer_load_dwordx4 v3, s[8:11], 0 offen offset:2048 sc1 lds
s_waitcnt lgkmcnt(4)
v_mfma_f32_16x16x32_bf16 v[44:47], a[240:243], a[32:35], v[44:47]
ds_read_b128 a[232:235], v2 offset:52224
v_mfma_f32_16x16x32_bf16 v[44:47], a[244:247], a[36:39], v[44:47]
ds_read_b128 a[236:239], v2 offset:57344
s_waitcnt lgkmcnt(4)
v_mfma_f32_16x16x32_bf16 v[48:51], a[216:219], a[32:35], v[48:51]
ds_read_b128 a[240:243], v2 offset:53248
v_mfma_f32_16x16x32_bf16 v[48:51], a[220:223], a[36:39], v[48:51]
ds_read_b128 a[244:247], v2 offset:58368
buffer_load_dwordx4 v3, s[8:11], 0 offen offset:3072 sc1 lds
s_waitcnt vmcnt(15)
s_waitcnt lgkmcnt(4)
v_mfma_f32_16x16x32_bf16 v[32:35], a[224:227], a[40:43], v[32:35]
ds_read_b128 a[216:219], v2 offset:54272
v_mfma_f32_16x16x32_bf16 v[32:35], a[228:231], a[44:47], v[32:35]
ds_read_b128 a[220:223], v2 offset:59392
s_waitcnt lgkmcnt(4)
v_mfma_f32_16x16x32_bf16 v[36:39], a[232:235], a[40:43], v[36:39]
ds_read_b128 a[224:227], v2 offset:55296
v_mfma_f32_16x16x32_bf16 v[36:39], a[236:239], a[44:47], v[36:39]
ds_read_b128 a[228:231], v2 offset:60416
s_add_u32 m0, s22, 102400
v_add_u32 v3, 4096, v3
buffer_load_dwordx4 v3, s[8:11], 0 offen offset:0 sc1 lds
s_waitcnt lgkmcnt(4)
v_mfma_f32_16x16x32_bf16 v[40:43], a[240:243], a[40:43], v[40:43]
ds_read_b128 a[232:235], v2 offset:61440
v_mfma_f32_16x16x32_bf16 v[40:43], a[244:247], a[44:47], v[40:43]
ds_read_b128 a[236:239], v5 offset:1024
s_waitcnt lgkmcnt(4)
v_mfma_f32_16x16x32_bf16 v[44:47], a[216:219], a[40:43], v[44:47]
ds_read_b128 a[240:243], v2 offset:62464
v_mfma_f32_16x16x32_bf16 v[44:47], a[220:223], a[44:47], v[44:47]
ds_read_b128 a[244:247], v5 offset:2048
buffer_load_dwordx4 v3, s[8:11], 0 offen offset:1024 sc1 lds
s_waitcnt lgkmcnt(4)
v_mfma_f32_16x16x32_bf16 v[48:51], a[224:227], a[40:43], v[48:51]
ds_read_b128 a[216:219], v2 offset:63488
v_mfma_f32_16x16x32_bf16 v[48:51], a[228:231], a[44:47], v[48:51]
ds_read_b128 a[220:223], v5 offset:3072
s_waitcnt vmcnt(15)
s_waitcnt lgkmcnt(4)
v_mfma_f32_16x16x32_bf16 v[32:35], a[232:235], a[48:51], v[32:35]
ds_read_b128 a[224:227], v2 offset:64512
v_mfma_f32_16x16x32_bf16 v[32:35], a[236:239], a[52:55], v[32:35]
ds_read_b128 a[228:231], v5 offset:4096
s_add_u32 m0, s22, 122880
v_add_u32 v3, 20480, v3
buffer_load_dwordx4 v3, s[8:11], 0 offen offset:0 sc1 lds
s_waitcnt lgkmcnt(4)
v_mfma_f32_16x16x32_bf16 v[36:39], a[240:243], a[48:51], v[36:39]
ds_read_b128 a[232:235], v5 offset:0
v_mfma_f32_16x16x32_bf16 v[36:39], a[244:247], a[52:55], v[36:39]
ds_read_b128 a[236:239], v5 offset:5120
s_waitcnt lgkmcnt(4)
v_mfma_f32_16x16x32_bf16 v[40:43], a[216:219], a[48:51], v[40:43]
ds_read_b128 a[240:243], v5 offset:6144
L_hop2:
s_cmp_eq_u32 s15, 1
s_cbranch_scc1 L_hop6
v_mfma_f32_16x16x32_bf16 v[40:43], a[220:223], a[52:55], v[40:43]
ds_read_b128 a[244:247], v5 offset:11264
buffer_load_dwordx4 v3, s[8:11], 0 offen offset:1024 sc1 lds
s_waitcnt lgkmcnt(4)
v_mfma_f32_16x16x32_bf16 v[44:47], a[224:227], a[48:51], v[44:47]
ds_read_b128 a[216:219], v5 offset:7168
v_mfma_f32_16x16x32_bf16 v[44:47], a[228:231], a[52:55], v[44:47]
ds_read_b128 a[220:223], v5 offset:12288
s_waitcnt lgkmcnt(4)
v_mfma_f32_16x16x32_bf16 v[48:51], a[232:235], a[48:51], v[48:51]
ds_read_b128 a[224:227], v5 offset:8192
v_mfma_f32_16x16x32_bf16 v[48:51], a[236:239], a[52:55], v[48:51]
ds_read_b128 a[228:231], v5 offset:13312
buffer_load_dwordx4 v3, s[8:11], 0 offen offset:2048 sc1 lds
s_waitcnt vmcnt(16)
s_waitcnt lgkmcnt(4)
v_mfma_f32_16x16x32_bf16 v[32:35], a[240:243], a[56:59], v[32:35]
ds_read_b128 a[232:235], v5 offset:9216
v_mfma_f32_16x16x32_bf16 v[32:35], a[244:247], a[60:63], v[32:35]
ds_read_b128 a[236:239], v5 offset:14336
s_waitcnt lgkmcnt(4)
v_mfma_f32_16x16x32_bf16 v[36:39], a[216:219], a[56:59], v[36:39]
ds_read_b128 a[240:243], v5 offset:10240
v_mfma_f32_16x16x32_bf16 v[36:39], a[220:223], a[60:63], v[36:39]
ds_read_b128 a[244:247], v5 offset:15360
buffer_load_dwordx4 v3, s[8:11], 0 offen offset:3072 sc1 lds
s_waitcnt lgkmcnt(4)
v_mfma_f32_16x16x32_bf16 v[40:43], a[224:227], a[56:59], v[40:43]
ds_read_b128 a[216:219], v5 offset:16384
v_mfma_f32_16x16x32_bf16 v[40:43], a[228:231], a[60:63], v[40:43]
ds_read_b128 a[220:223], v5 offset:21504
s_waitcnt lgkmcnt(4)
v_mfma_f32_16x16x32_bf16 v[44:47], a[232:235], a[56:59], v[44:47]
ds_read_b128 a[224:227], v5 offset:17408
v_mfma_f32_16x16x32_bf16 v[44:47], a[236:239], a[60:63], v[44:47]
ds_read_b128 a[228:231], v5 offset:22528
s_add_u32 m0, s22, 126976
v_add_u32 v3, 4096, v3
buffer_load_dwordx4 v3, s[8:11], 0 offen offset:0 sc1 lds
s_waitcnt lgkmcnt(4)
v_mfma_f32_16x16x32_bf16 v[48:51], a[240:243], a[56:59], v[48:51]
ds_read_b128 a[232:235], v5 offset:18432
v_mfma_f32_16x16x32_bf16 v[48:51], a[244:247], a[60:63], v[48:51]
ds_read_b128 a[236:239], v5 offset:23552
s_waitcnt vmcnt(14)
s_waitcnt lgkmcnt(4)
v_mfma_f32_16x16x32_bf16 v[32:35], a[216:219], a[64:67], v[32:35]
ds_read_b128 a[240:243], v5 offset:19456
v_mfma_f32_16x16x32_bf16 v[32:35], a[220:223], a[68:71], v[32:35]
ds_read_b128 a[244:247], v5 offset:24576
buffer_load_dwordx4 v3, s[8:11], 0 offen offset:1024 sc1 lds
s_waitcnt lgkmcnt(4)
v_mfma_f32_16x16x32_bf16 v[36:39], a[224:227], a[64:67], v[36:39]
ds_read_b128 a[216:219], v5 offset:20480
v_mfma_f32_16x16x32_bf16 v[36:39], a[228:231], a[68:71], v[36:39]
ds_read_b128 a[220:223], v5 offset:25600
s_waitcnt lgkmcnt(4)
v_mfma_f32_16x16x32_bf16 v[40:43], a[232:235], a[64:67], v[40:43]
v_mfma_f32_16x16x32_bf16 v[40:43], a[236:239], a[68:71], v[40:43]
s_waitcnt lgkmcnt(2)
v_mfma_f32_16x16x32_bf16 v[44:47], a[240:243], a[64:67], v[44:47]
v_mfma_f32_16x16x32_bf16 v[44:47], a[244:247], a[68:71], v[44:47]
s_waitcnt lgkmcnt(0)
v_mfma_f32_16x16x32_bf16 v[48:51], a[216:219], a[64:67], v[48:51]
v_mfma_f32_16x16x32_bf16 v[48:51], a[220:223], a[68:71], v[48:51]
s_waitcnt vmcnt(12)
v_lshlrev_b32 v68, 16, v56
v_and_b32 v69, 0xffff0000, v56
v_add_f32 v32, v32, v68
v_add_f32 v33, v33, v69
v_lshlrev_b32 v70, 16, v57
v_and_b32 v71, 0xffff0000, v57
v_add_f32 v34, v34, v70
v_add_f32 v35, v35, v71
v_lshlrev_b32 v72, 16, v58
v_and_b32 v73, 0xffff0000, v58
v_add_f32 v36, v36, v72
v_add_f32 v37, v37, v73
v_lshlrev_b32 v74, 16, v59
v_and_b32 v75, 0xffff0000, v59
v_add_f32 v38, v38, v74
v_add_f32 v39, v39, v75
v_lshlrev_b32 v68, 16, v60
v_and_b32 v69, 0xffff0000, v60
v_add_f32 v40, v40, v68
v_add_f32 v41, v41, v69
v_lshlrev_b32 v70, 16, v61
v_and_b32 v71, 0xffff0000, v61
v_add_f32 v42, v42, v70
v_add_f32 v43, v43, v71
v_lshlrev_b32 v72, 16, v62
v_and_b32 v73, 0xffff0000, v62
v_add_f32 v44, v44, v72
v_add_f32 v45, v45, v73
v_lshlrev_b32 v74, 16, v63
v_and_b32 v75, 0xffff0000, v63
v_add_f32 v46, v46, v74
v_add_f32 v47, v47, v75
v_lshlrev_b32 v68, 16, v64
v_and_b32 v69, 0xffff0000, v64
v_add_f32 v48, v48, v68
v_add_f32 v49, v49, v69
v_lshlrev_b32 v70, 16, v65
v_and_b32 v71, 0xffff0000, v65
v_add_f32 v50, v50, v70
v_add_f32 v51, v51, v71
v_cvt_pk_bf16_f32 v80, v32, v33
v_cvt_pk_bf16_f32 v81, v34, v35
v_cvt_pk_bf16_f32 v82, v36, v37
v_cvt_pk_bf16_f32 v83, v38, v39
v_cvt_pk_bf16_f32 v84, v40, v41
v_cvt_pk_bf16_f32 v85, v42, v43
v_cvt_pk_bf16_f32 v86, v44, v45
v_cvt_pk_bf16_f32 v87, v46, v47
v_cvt_pk_bf16_f32 v88, v48, v49
v_cvt_pk_bf16_f32 v89, v50, v51
s_add_u32 s27, s26, s73
buffer_store_dwordx4 v[80:83], v2, s[8:11], s27 offen sc1
buffer_store_dwordx4 v[84:87], v2, s[8:11], s27 offen offset:1024 sc1
buffer_store_dwordx2 v[88:89], v4, s[8:11], s27 offen sc1
v_add_f32 v10, v32, v33
v_mul_f32 v11, v32, v32
v_mul_f32 v13, v33, v33
v_mov_b32 v12, 0
v_add_f32 v10, v10, v34
v_add_f32 v12, v12, v35
v_fmac_f32 v11, v34, v34
v_fmac_f32 v13, v35, v35
v_add_f32 v10, v10, v36
v_add_f32 v12, v12, v37
v_fmac_f32 v11, v36, v36
v_fmac_f32 v13, v37, v37
v_add_f32 v10, v10, v38
v_add_f32 v12, v12, v39
v_fmac_f32 v11, v38, v38
v_fmac_f32 v13, v39, v39
v_add_f32 v10, v10, v40
v_add_f32 v12, v12, v41
v_fmac_f32 v11, v40, v40
v_fmac_f32 v13, v41, v41
v_add_f32 v10, v10, v42
v_add_f32 v12, v12, v43
v_fmac_f32 v11, v42, v42
v_fmac_f32 v13, v43, v43
v_add_f32 v10, v10, v44
v_add_f32 v12, v12, v45
v_fmac_f32 v11, v44, v44
v_fmac_f32 v13, v45, v45
v_add_f32 v10, v10, v46
v_add_f32 v12, v12, v47
v_fmac_f32 v11, v46, v46
v_fmac_f32 v13, v47, v47
v_add_f32 v10, v10, v48
v_add_f32 v12, v12, v49
v_fmac_f32 v11, v48, v48
v_fmac_f32 v13, v49, v49
v_add_f32 v10, v10, v50
v_add_f32 v12, v12, v51
v_fmac_f32 v11, v50, v50
v_fmac_f32 v13, v51, v51
v_add_f32 v10, v10, v12
v_add_f32 v11, v11, v13
v_mov_b32 v12, v10
v_mov_b32 v13, v11
s_nop 0
v_permlane16_swap_b32 v10, v12
v_permlane16_swap_b32 v11, v13
v_add_f32 v10, v10, v12
v_add_f32 v11, v11, v13
v_mov_b32 v12, v10
v_mov_b32 v13, v11
s_nop 0
v_permlane32_swap_b32 v10, v12
v_permlane32_swap_b32 v11, v13
v_add_f32 v10, v10, v12
v_add_f32 v11, v11, v13
v_lshlrev_b32 v8, 3, v6
v_cmp_gt_u32 vcc, 16, v1
s_nop 1
v_cndmask_b32 v8, v9, v8, vcc
s_lshl_b32 s27, s20, 10
s_lshl_b32 s28, s21, 7
s_add_u32 s27, s27, s28
s_add_u32 s27, s27, s74
buffer_store_dwordx2 v[10:11], v8, s[8:11], s27 offen sc1
s_lshr_b32 s27, s20, 2
s_lshl_b32 s27, s27, 3
s_add_u32 s27, s27, s21
s_lshl_b32 s14, s27, 7
s_add_u32 s14, s14, 524288
s_add_u32 s14, s14, s77
s_lshl_b32 s44, s40, 4
s_lshl_b32 s45, s4, 2
s_add_u32 s44, s44, s45
s_mul_i32 s46, s44, 18432
s_add_u32 s20, s46, s73
v_add_u32 v4, 18432, v2
v_add_u32 v5, 36864, v2
v_add_u32 v6, 55296, v2
v_lshlrev_b32 v248, 3, v1
v_add_u32 v249, 18432, v248
v_add_u32 v250, 36864, v248
v_add_u32 v251, 55296, v248
v_and_b32 v13, 15, v1
v_lshrrev_b32 v14, 4, v1
v_add_u32 v7, 0x10000, v2
v_add_u32 v8, 0x20000, v2
v_and_b32 v9, 1, v14
v_mul_u32_u24 v9, 18432, v9
v_lshrrev_b32 v15, 1, v14
v_lshlrev_b32 v15, 8, v15
v_lshl_add_u32 v15, v13, 4, v15
v_add_u32 v9, v9, v15
v_and_b32 v11, 3, v1
v_lshlrev_b32 v11, 7, v11
s_lshl_b32 s49, s43, 7
v_mov_b32 v10, 2146435072
v_lshl_add_u32 v15, v1, 3, s49
v_cmp_gt_u32 vcc, 16, v1
s_nop 1
v_cndmask_b32 v10, v10, v15, vcc
s_lshl_b32 s49, s40, 3
s_add_u32 s49, s49, s42
s_lshl_b32 s50, s49, 2
s_add_u32 s50, s50, s4
s_lshl_b32 s50, s50, 9
s_add_u32 s34, s50, s77
s_add_u32 s34, s34, 0
s_lshl_b32 s49, s49, 4
s_add_u32 s49, s49, s45
s_mul_i32 s49, s49, 18432
s_add_u32 s49, s49, s75
s_add_u32 s50, s43, 0
s_and_b32 s50, s50, 3
s_mul_i32 s50, s50, 9
s_add_u32 s50, s50, 1
s_lshr_b32 s50, s50, 1
s_lshl_b32 s50, s50, 10
s_add_u32 s24, s49, s50
s_add_u32 s50, s43, 1
s_and_b32 s50, s50, 3
s_mul_i32 s50, s50, 9
s_add_u32 s50, s50, 1
s_lshr_b32 s50, s50, 1
s_lshl_b32 s50, s50, 10
s_add_u32 s25, s49, s50
s_add_u32 s50, s43, 2
s_and_b32 s50, s50, 3
s_mul_i32 s50, s50, 9
s_add_u32 s50, s50, 1
s_lshr_b32 s50, s50, 1
s_lshl_b32 s50, s50, 10
s_add_u32 s26, s49, s50
s_add_u32 s50, s43, 3
s_and_b32 s50, s50, 3
s_mul_i32 s50, s50, 9
s_add_u32 s50, s50, 1
s_lshr_b32 s50, s50, 1
s_lshl_b32 s50, s50, 10
s_add_u32 s27, s49, s50
s_add_u32 s28, s49, 4096
s_add_u32 s29, s49, 13312
s_cmp_ge_u32 s43, 2
s_cselect_b32 s50, s29, s28
s_and_b32 s51, s43, 1
s_lshl_b32 s51, s51, 9
s_add_u32 s30, s50, s51
s_mul_i32 s50, s42, 2359296
s_add_u32 s50, s50, s46
s_add_u32 s50, s50, s76
s_lshl_b32 s51, s43, 12
s_add_u32 s31, s50, s51
s_lshl_b32 s51, s43, 9
s_add_u32 s50, s50, s51
s_add_u32 s32, s50, 16384
s_add_u32 s33, s32, 36864
s_add_u32 s36, s31, 0
s_add_u32 s37, s31, 18432
s_add_u32 s38, s31, 36864
s_add_u32 s39, s31, 55296
v_lshlrev_b32 v252, 4, v13
v_lshl_add_u32 v252, v14, 9, v252
s_lshl_b32 s35, s40, 5
s_add_u32 s35, s35, s41
s_lshl_b32 s35, s35, 7
s_add_u32 s35, s35, s77
s_add_u32 s35, s35, 655360
v_lshlrev_b32 v17, 3, v13
v_lshl_add_u32 v17, v14, 8, v17
s_lshl_b32 s47, s44, 10
s_add_u32 s47, s47, s74
s_lshl_b32 s49, s44, 8
s_add_u32 s49, s49, s77
s_add_u32 s49, s49, 524288
v_and_b32 v16, 7, v1
v_lshlrev_b32 v16, 7, v16
s_lshl_b32 s50, s43, 7
s_add_u32 s44, s35, 262144
s_sub_u32 s44, s44, s50
s_cmp_eq_u32 s4, 0
s_cselect_b32 s44, s44, 2146435072
v_mov_b32 v13, 2146435072
v_cmp_gt_u32 vcc, 16, v0
v_lshlrev_b32 v14, 3, v0
s_nop 0
v_cndmask_b32 v13, v13, v14, vcc
v_mov_b32 v14, s68
v_mov_b32 v15, s69
s_waitcnt vmcnt(0)
s_barrier
buffer_store_dwordx2 v[14:15], v13, s[8:11], s14 offen sc1
s_add_u32 m0, s22, 0
v_add_u32 v3, 20480, v3
buffer_load_dwordx4 v3, s[8:11], 0 offen offset:0 sc1 lds
buffer_load_dwordx4 v3, s[8:11], 0 offen offset:1024 sc1 lds
buffer_load_dwordx4 v3, s[8:11], 0 offen offset:2048 sc1 lds
buffer_load_dwordx4 v3, s[8:11], 0 offen offset:3072 sc1 lds
s_add_u32 m0, s22, 4096
v_add_u32 v3, 4096, v3
buffer_load_dwordx4 v3, s[8:11], 0 offen offset:0 sc1 lds
buffer_load_dwordx4 v3, s[8:11], 0 offen offset:1024 sc1 lds
s_add_u32 m0, s22, 24576
v_add_u32 v3, 20480, v3
buffer_load_dwordx4 v3, s[8:11], 0 offen offset:0 sc1 lds
buffer_load_dwordx4 v3, s[8:11], 0 offen offset:1024 sc1 lds
buffer_load_dwordx4 v3, s[8:11], 0 offen offset:2048 sc1 lds
buffer_load_dwordx4 v3, s[8:11], 0 offen offset:3072 sc1 lds
s_add_u32 m0, s22, 28672
v_add_u32 v3, 4096, v3
buffer_load_dwordx4 v3, s[8:11], 0 offen offset:0 sc1 lds
buffer_load_dwordx4 v3, s[8:11], 0 offen offset:1024 sc1 lds
ds_read_b128 v[48:51], v7 offset:32768
ds_read_b128 v[52:55], v7 offset:33792
ds_read_b128 v[56:59], v7 offset:34816
ds_read_b128 v[60:63], v7 offset:35840
ds_read_b128 v[64:67], v7 offset:36864
ds_read_b128 v[68:71], v7 offset:37888
s_mov_b32 s52, 0
L_poll3:
buffer_load_dwordx2 v[14:15], v16, s[8:11], s49 offen sc1
s_add_u32 s52, s52, 1
s_waitcnt vmcnt(0)
v_cmp_ne_u64 vcc, s[68:69], v[14:15]
s_cmp_ge_u32 s52, 1048576
s_cbranch_scc1 L_got3
s_and_b64 exec, exec, vcc
s_cbranch_execnz L_poll3
L_got3:
s_mov_b64 exec, -1
s_add_u32 s48, s20, 0
buffer_load_dwordx4 a[0:3], v2, s[8:11], s48 offen offset:0 sc1
buffer_load_dwordx4 a[4:7], v4, s[8:11], s48 offen offset:0 sc1
buffer_load_dwordx4 a[8:11], v5, s[8:11], s48 offen offset:0 sc1
buffer_load_dwordx4 a[12:15], v6, s[8:11], s48 offen offset:0 sc1
buffer_load_dwordx4 a[16:19], v2, s[8:11], s48 offen offset:1024 sc1
buffer_load_dwordx4 a[20:23], v4, s[8:11], s48 offen offset:1024 sc1
buffer_load_dwordx4 a[24:27], v5, s[8:11], s48 offen offset:1024 sc1
buffer_load_dwordx4 a[28:31], v6, s[8:11], s48 offen offset:1024 sc1
buffer_load_dwordx2 v[144:145], v17, s[8:11], s47 offen offset:0 sc1
buffer_load_dwordx2 v[146:147], v17, s[8:11], s47 offen offset:128 sc1
buffer_load_dwordx2 v[148:149], v17, s[8:11], s47 offen offset:1024 sc1
buffer_load_dwordx2 v[150:151], v17, s[8:11], s47 offen offset:1152 sc1
buffer_load_dwordx2 v[152:153], v17, s[8:11], s47 offen offset:2048 sc1
buffer_load_dwordx2 v[154:155], v17, s[8:11], s47 offen offset:2176 sc1
buffer_load_dwordx2 v[156:157], v17, s[8:11], s47 offen offset:3072 sc1
buffer_load_dwordx2 v[158:159], v17, s[8:11], s47 offen offset:3200 sc1
buffer_load_dwordx4 a[32:35], v2, s[8:11], s48 offen offset:2048 sc1
buffer_load_dwordx4 a[36:39], v4, s[8:11], s48 offen offset:2048 sc1
buffer_load_dwordx4 a[40:43], v5, s[8:11], s48 offen offset:2048 sc1
buffer_load_dwordx4 a[44:47], v6, s[8:11], s48 offen offset:2048 sc1
buffer_load_dwordx4 a[48:51], v2, s[8:11], s48 offen offset:3072 sc1
buffer_load_dwordx4 a[52:55], v4, s[8:11], s48 offen offset:3072 sc1
buffer_load_dwordx4 a[56:59], v5, s[8:11], s48 offen offset:3072 sc1
buffer_load_dwordx4 a[60:63], v6, s[8:11], s48 offen offset:3072 sc1
s_add_u32 s48, s20, 4096
buffer_load_dwordx4 a[64:67], v2, s[8:11], s48 offen offset:0 sc1
buffer_load_dwordx4 a[68:71], v4, s[8:11], s48 offen offset:0 sc1
buffer_load_dwordx4 a[72:75], v5, s[8:11], s48 offen offset:0 sc1
buffer_load_dwordx4 a[76:79], v6, s[8:11], s48 offen offset:0 sc1
s_waitcnt vmcnt(20)
s_waitcnt lgkmcnt(4)
v_mfma_f32_16x16x32_bf16 v[80:83], v[48:51], a[0:3], 0
buffer_load_dwordx4 a[80:83], v2, s[8:11], s48 offen offset:1024 sc1
v_mfma_f32_16x16x32_bf16 v[80:83], v[52:55], a[16:19], v[80:83]
v_mfma_f32_16x16x32_bf16 v[84:87], v[48:51], a[4:7], 0
ds_read_b128 v[72:75], v7 offset:38912
v_mfma_f32_16x16x32_bf16 v[84:87], v[52:55], a[20:23], v[84:87]
v_mfma_f32_16x16x32_bf16 v[88:91], v[48:51], a[8:11], 0
buffer_load_dwordx4 a[84:87], v4, s[8:11], s48 offen offset:1024 sc1
v_mfma_f32_16x16x32_bf16 v[88:91], v[52:55], a[24:27], v[88:91]
ds_read_b128 v[76:79], v7 offset:39936
v_mfma_f32_16x16x32_bf16 v[92:95], v[48:51], a[12:15], 0
v_mfma_f32_16x16x32_bf16 v[92:95], v[52:55], a[28:31], v[92:95]
s_waitcnt lgkmcnt(4)
v_mfma_f32_16x16x32_bf16 v[96:99], v[56:59], a[0:3], 0
buffer_load_dwordx4 a[88:91], v5, s[8:11], s48 offen offset:1024 sc1
v_mfma_f32_16x16x32_bf16 v[96:99], v[60:63], a[16:19], v[96:99]
v_mfma_f32_16x16x32_bf16 v[100:103], v[56:59], a[4:7], 0
ds_read_b128 v[48:51], v7 offset:40960
v_mfma_f32_16x16x32_bf16 v[100:103], v[60:63], a[20:23], v[100:103]
v_mfma_f32_16x16x32_bf16 v[104:107], v[56:59], a[8:11], 0
buffer_load_dwordx4 a[92:95], v6, s[8:11], s48 offen offset:1024 sc1
v_mfma_f32_16x16x32_bf16 v[104:107], v[60:63], a[24:27], v[104:107]
ds_read_b128 v[52:55], v7 offset:41984
v_mfma_f32_16x16x32_bf16 v[108:111], v[56:59], a[12:15], 0
v_mfma_f32_16x16x32_bf16 v[108:111], v[60:63], a[28:31], v[108:111]
s_waitcnt lgkmcnt(4)
v_mfma_f32_16x16x32_bf16 v[112:115], v[64:67], a[0:3], 0
buffer_load_dwordx4 a[96:99], v2, s[8:11], s48 offen offset:2048 sc1
v_mfma_f32_16x16x32_bf16 v[112:115], v[68:71], a[16:19], v[112:115]
v_mfma_f32_16x16x32_bf16 v[116:119], v[64:67], a[4:7], 0
ds_read_b128 v[56:59], v7 offset:43008
v_mfma_f32_16x16x32_bf16 v[116:119], v[68:71], a[20:23], v[116:119]
v_mfma_f32_16x16x32_bf16 v[120:123], v[64:67], a[8:11], 0
buffer_load_dwordx4 a[100:103], v4, s[8:11], s48 offen offset:2048 sc1
v_mfma_f32_16x16x32_bf16 v[120:123], v[68:71], a[24:27], v[120:123]
ds_read_b128 v[60:63], v7 offset:44032
v_mfma_f32_16x16x32_bf16 v[124:127], v[64:67], a[12:15], 0
v_mfma_f32_16x16x32_bf16 v[124:127], v[68:71], a[28:31], v[124:127]
s_waitcnt lgkmcnt(4)
v_mfma_f32_16x16x32_bf16 v[128:131], v[72:75], a[0:3], 0
buffer_load_dwordx4 a[104:107], v5, s[8:11], s48 offen offset:2048 sc1
v_mfma_f32_16x16x32_bf16 v[128:131], v[76:79], a[16:19], v[128:131]
v_mfma_f32_16x16x32_bf16 v[132:135], v[72:75], a[4:7], 0
ds_read_b128 v[64:67], v7 offset:45056
v_mfma_f32_16x16x32_bf16 v[132:135], v[76:79], a[20:23], v[132:135]
v_mfma_f32_16x16x32_bf16 v[136:139], v[72:75], a[8:11], 0
buffer_load_dwordx4 a[108:111], v6, s[8:11], s48 offen offset:2048 sc1
v_mfma_f32_16x16x32_bf16 v[136:139], v[76:79], a[24:27], v[136:139]
ds_read_b128 v[68:71], v7 offset:46080
v_mfma_f32_16x16x32_bf16 v[140:143], v[72:75], a[12:15], 0
v_mfma_f32_16x16x32_bf16 v[140:143], v[76:79], a[28:31], v[140:143]
s_waitcnt vmcnt(12)
s_waitcnt lgkmcnt(4)
v_mfma_f32_16x16x32_bf16 v[80:83], v[48:51], a[32:35], v[80:83]
buffer_load_dwordx4 a[112:115], v2, s[8:11], s48 offen offset:3072 sc1
v_mfma_f32_16x16x32_bf16 v[80:83], v[52:55], a[48:51], v[80:83]
v_mfma_f32_16x16x32_bf16 v[84:87], v[48:51], a[36:39], v[84:87]
ds_read_b128 v[72:75], v7 offset:47104
v_mfma_f32_16x16x32_bf16 v[84:87], v[52:55], a[52:55], v[84:87]
v_mfma_f32_16x16x32_bf16 v[88:91], v[48:51], a[40:43], v[88:91]
buffer_load_dwordx4 a[116:119], v4, s[8:11], s48 offen offset:3072 sc1
v_mfma_f32_16x16x32_bf16 v[88:91], v[52:55], a[56:59], v[88:91]
ds_read_b128 v[76:79], v7 offset:48128
v_mfma_f32_16x16x32_bf16 v[92:95], v[48:51], a[44:47], v[92:95]
v_mfma_f32_16x16x32_bf16 v[92:95], v[52:55], a[60:63], v[92:95]
s_waitcnt lgkmcnt(4)
v_mfma_f32_16x16x32_bf16 v[96:99], v[56:59], a[32:35], v[96:99]
buffer_load_dwordx4 a[120:123], v5, s[8:11], s48 offen offset:3072 sc1
v_mfma_f32_16x16x32_bf16 v[96:99], v[60:63], a[48:51], v[96:99]
v_mfma_f32_16x16x32_bf16 v[100:103], v[56:59], a[36:39], v[100:103]
ds_read_b128 v[48:51], v7 offset:49152
v_mfma_f32_16x16x32_bf16 v[100:103], v[60:63], a[52:55], v[100:103]
v_mfma_f32_16x16x32_bf16 v[104:107], v[56:59], a[40:43], v[104:107]
buffer_load_dwordx4 a[124:127], v6, s[8:11], s48 offen offset:3072 sc1
v_mfma_f32_16x16x32_bf16 v[104:107], v[60:63], a[56:59], v[104:107]
ds_read_b128 v[52:55], v7 offset:50176
s_add_u32 s48, s20, 8192
v_mfma_f32_16x16x32_bf16 v[108:111], v[56:59], a[44:47], v[108:111]
v_mfma_f32_16x16x32_bf16 v[108:111], v[60:63], a[60:63], v[108:111]
s_waitcnt lgkmcnt(4)
v_mfma_f32_16x16x32_bf16 v[112:115], v[64:67], a[32:35], v[112:115]
buffer_load_dwordx4 a[128:131], v2, s[8:11], s48 offen offset:0 sc1
v_mfma_f32_16x16x32_bf16 v[112:115], v[68:71], a[48:51], v[112:115]
v_mfma_f32_16x16x32_bf16 v[116:119], v[64:67], a[36:39], v[116:119]
ds_read_b128 v[56:59], v7 offset:51200
v_mfma_f32_16x16x32_bf16 v[116:119], v[68:71], a[52:55], v[116:119]
v_mfma_f32_16x16x32_bf16 v[120:123], v[64:67], a[40:43], v[120:123]
buffer_load_dwordx4 a[132:135], v4, s[8:11], s48 offen offset:0 sc1
v_mfma_f32_16x16x32_bf16 v[120:123], v[68:71], a[56:59], v[120:123]
ds_read_b128 v[60:63], v7 offset:52224
v_mfma_f32_16x16x32_bf16 v[124:127], v[64:67], a[44:47], v[124:127]
v_mfma_f32_16x16x32_bf16 v[124:127], v[68:71], a[60:63], v[124:127]
s_waitcnt lgkmcnt(4)
v_mfma_f32_16x16x32_bf16 v[128:131], v[72:75], a[32:35], v[128:131]
buffer_load_dwordx4 a[136:139], v5, s[8:11], s48 offen offset:0 sc1
v_mfma_f32_16x16x32_bf16 v[128:131], v[76:79], a[48:51], v[128:131]
v_mfma_f32_16x16x32_bf16 v[132:135], v[72:75], a[36:39], v[132:135]
ds_read_b128 v[64:67], v7 offset:53248
v_mfma_f32_16x16x32_bf16 v[132:135], v[76:79], a[52:55], v[132:135]
v_mfma_f32_16x16x32_bf16 v[136:139], v[72:75], a[40:43], v[136:139]
buffer_load_dwordx4 a[140:143], v6, s[8:11], s48 offen offset:0 sc1
v_mfma_f32_16x16x32_bf16 v[136:139], v[76:79], a[56:59], v[136:139]
ds_read_b128 v[68:71], v7 offset:54272
v_mfma_f32_16x16x32_bf16 v[140:143], v[72:75], a[44:47], v[140:143]
v_mfma_f32_16x16x32_bf16 v[140:143], v[76:79], a[60:63], v[140:143]
s_waitcnt vmcnt(12)
s_waitcnt lgkmcnt(4)
v_mfma_f32_16x16x32_bf16 v[80:83], v[48:51], a[64:67], v[80:83]
buffer_load_dwordx4 a[144:147], v2, s[8:11], s48 offen offset:1024 sc1
v_mfma_f32_16x16x32_bf16 v[80:83], v[52:55], a[80:83], v[80:83]
v_mfma_f32_16x16x32_bf16 v[84:87], v[48:51], a[68:71], v[84:87]
ds_read_b128 v[72:75], v7 offset:55296
v_mfma_f32_16x16x32_bf16 v[84:87], v[52:55], a[84:87], v[84:87]
v_add_f32 v144, v144, v146
v_add_f32 v145, v145, v147
v_mfma_f32_16x16x32_bf16 v[88:91], v[48:51], a[72:75], v[88:91]
buffer_load_dwordx4 a[148:151], v4, s[8:11], s48 offen offset:1024 sc1
v_mfma_f32_16x16x32_bf16 v[88:91], v[52:55], a[88:91], v[88:91]
ds_read_b128 v[76:79], v7 offset:56320
v_add_f32 v148, v148, v150
v_mfma_f32_16x16x32_bf16 v[92:95], v[48:51], a[76:79], v[92:95]
v_add_f32 v149, v149, v151
v_add_f32 v152, v152, v154
v_mfma_f32_16x16x32_bf16 v[92:95], v[52:55], a[92:95], v[92:95]
v_add_f32 v153, v153, v155
s_waitcnt lgkmcnt(4)
v_mfma_f32_16x16x32_bf16 v[96:99], v[56:59], a[64:67], v[96:99]
buffer_load_dwordx4 a[152:155], v5, s[8:11], s48 offen offset:1024 sc1
v_mfma_f32_16x16x32_bf16 v[96:99], v[60:63], a[80:83], v[96:99]
s_barrier
v_mfma_f32_16x16x32_bf16 v[100:103], v[56:59], a[68:71], v[100:103]
ds_read_b128 v[48:51], v7 offset:57344
v_add_f32 v156, v156, v158
v_mfma_f32_16x16x32_bf16 v[100:103], v[60:63], a[84:87], v[100:103]
v_add_f32 v157, v157, v159
v_mov_b32 v160, v144
v_mfma_f32_16x16x32_bf16 v[104:107], v[56:59], a[72:75], v[104:107]
buffer_load_dwordx4 a[156:159], v6, s[8:11], s48 offen offset:1024 sc1
v_mfma_f32_16x16x32_bf16 v[104:107], v[60:63], a[88:91], v[104:107]
ds_read_b128 v[52:55], v7 offset:58368
v_mov_b32 v161, v145
v_mfma_f32_16x16x32_bf16 v[108:111], v[56:59], a[76:79], v[108:111]
v_mov_b32 v162, v148
v_mov_b32 v163, v149
v_mfma_f32_16x16x32_bf16 v[108:111], v[60:63], a[92:95], v[108:111]
v_mov_b32 v164, v152
s_waitcnt lgkmcnt(4)
v_mfma_f32_16x16x32_bf16 v[112:115], v[64:67], a[64:67], v[112:115]
buffer_load_dwordx4 a[160:163], v2, s[8:11], s48 offen offset:2048 sc1
v_mfma_f32_16x16x32_bf16 v[112:115], v[68:71], a[80:83], v[112:115]
v_mov_b32 v165, v153
v_mov_b32 v166, v156
v_mfma_f32_16x16x32_bf16 v[116:119], v[64:67], a[68:71], v[116:119]
ds_read_b128 v[56:59], v7 offset:59392
v_mov_b32 v167, v157
v_mfma_f32_16x16x32_bf16 v[116:119], v[68:71], a[84:87], v[116:119]
v_permlane16_swap_b32 v144, v160
v_permlane16_swap_b32 v145, v161
v_mfma_f32_16x16x32_bf16 v[120:123], v[64:67], a[72:75], v[120:123]
buffer_load_dwordx4 a[164:167], v4, s[8:11], s48 offen offset:2048 sc1
v_mfma_f32_16x16x32_bf16 v[120:123], v[68:71], a[88:91], v[120:123]
ds_read_b128 v[60:63], v7 offset:60416
v_permlane16_swap_b32 v148, v162
v_mfma_f32_16x16x32_bf16 v[124:127], v[64:67], a[76:79], v[124:127]
v_permlane16_swap_b32 v149, v163
v_permlane16_swap_b32 v152, v164
v_mfma_f32_16x16x32_bf16 v[124:127], v[68:71], a[92:95], v[124:127]
v_permlane16_swap_b32 v153, v165
s_waitcnt lgkmcnt(4)
v_mfma_f32_16x16x32_bf16 v[128:131], v[72:75], a[64:67], v[128:131]
buffer_load_dwordx4 a[168:171], v5, s[8:11], s48 offen offset:2048 sc1
v_mfma_f32_16x16x32_bf16 v[128:131], v[76:79], a[80:83], v[128:131]
v_permlane16_swap_b32 v156, v166
v_permlane16_swap_b32 v157, v167
v_mfma_f32_16x16x32_bf16 v[132:135], v[72:75], a[68:71], v[132:135]
ds_read_b128 v[64:67], v7 offset:61440
v_add_f32 v144, v144, v160
v_mfma_f32_16x16x32_bf16 v[132:135], v[76:79], a[84:87], v[132:135]
v_add_f32 v145, v145, v161
v_add_f32 v148, v148, v162
v_mfma_f32_16x16x32_bf16 v[136:139], v[72:75], a[72:75], v[136:139]
buffer_load_dwordx4 a[172:175], v6, s[8:11], s48 offen offset:2048 sc1
v_mfma_f32_16x16x32_bf16 v[136:139], v[76:79], a[88:91], v[136:139]
ds_read_b128 v[68:71], v7 offset:62464
v_add_f32 v149, v149, v163
v_mfma_f32_16x16x32_bf16 v[140:143], v[72:75], a[76:79], v[140:143]
v_add_f32 v152, v152, v164
v_add_f32 v153, v153, v165
v_mfma_f32_16x16x32_bf16 v[140:143], v[76:79], a[92:95], v[140:143]
v_add_f32 v156, v156, v166
s_waitcnt vmcnt(12)
s_waitcnt lgkmcnt(4)
v_mfma_f32_16x16x32_bf16 v[80:83], v[48:51], a[96:99], v[80:83]
buffer_load_dwordx4 a[176:179], v2, s[8:11], s48 offen offset:3072 sc1
v_mfma_f32_16x16x32_bf16 v[80:83], v[52:55], a[112:115], v[80:83]
v_add_f32 v157, v157, v167
v_mov_b32 v160, v144
v_mfma_f32_16x16x32_bf16 v[84:87], v[48:51], a[100:103], v[84:87]
ds_read_b128 v[72:75], v7 offset:63488
v_mov_b32 v161, v145
v_mfma_f32_16x16x32_bf16 v[84:87], v[52:55], a[116:119], v[84:87]
v_mov_b32 v162, v148
v_mov_b32 v163, v149
v_mfma_f32_16x16x32_bf16 v[88:91], v[48:51], a[104:107], v[88:91]
buffer_load_dwordx4 a[180:183], v4, s[8:11], s48 offen offset:3072 sc1
v_mfma_f32_16x16x32_bf16 v[88:91], v[52:55], a[120:123], v[88:91]
ds_read_b128 v[76:79], v7 offset:64512
v_mov_b32 v164, v152
v_mfma_f32_16x16x32_bf16 v[92:95], v[48:51], a[108:111], v[92:95]
v_mov_b32 v165, v153
v_mov_b32 v166, v156
v_mfma_f32_16x16x32_bf16 v[92:95], v[52:55], a[124:127], v[92:95]
v_mov_b32 v167, v157
s_waitcnt lgkmcnt(4)
v_mfma_f32_16x16x32_bf16 v[96:99], v[56:59], a[96:99], v[96:99]
buffer_load_dwordx4 a[184:187], v5, s[8:11], s48 offen offset:3072 sc1
v_mfma_f32_16x16x32_bf16 v[96:99], v[60:63], a[112:115], v[96:99]
v_permlane32_swap_b32 v144, v160
v_permlane32_swap_b32 v145, v161
v_mfma_f32_16x16x32_bf16 v[100:103], v[56:59], a[100:103], v[100:103]
ds_read_b128 v[48:51], v8 offset:0
v_permlane32_swap_b32 v148, v162
v_mfma_f32_16x16x32_bf16 v[100:103], v[60:63], a[116:119], v[100:103]
v_permlane32_swap_b32 v149, v163
v_permlane32_swap_b32 v152, v164
v_mfma_f32_16x16x32_bf16 v[104:107], v[56:59], a[104:107], v[104:107]
buffer_load_dwordx4 a[188:191], v6, s[8:11], s48 offen offset:3072 sc1
v_mfma_f32_16x16x32_bf16 v[104:107], v[60:63], a[120:123], v[104:107]
ds_read_b128 v[52:55], v8 offset:1024
s_add_u32 s48, s20, 12288
v_mfma_f32_16x16x32_bf16 v[108:111], v[56:59], a[108:111], v[108:111]
v_permlane32_swap_b32 v153, v165
v_permlane32_swap_b32 v156, v166
v_mfma_f32_16x16x32_bf16 v[108:111], v[60:63], a[124:127], v[108:111]
v_permlane32_swap_b32 v157, v167
s_waitcnt lgkmcnt(4)
v_mfma_f32_16x16x32_bf16 v[112:115], v[64:67], a[96:99], v[112:115]
buffer_load_dwordx4 a[192:195], v2, s[8:11], s48 offen offset:0 sc1
v_mfma_f32_16x16x32_bf16 v[112:115], v[68:71], a[112:115], v[112:115]
v_add_f32 v144, v144, v160
v_add_f32 v145, v145, v161
v_mfma_f32_16x16x32_bf16 v[116:119], v[64:67], a[100:103], v[116:119]
ds_read_b128 v[56:59], v8 offset:2048
v_add_f32 v148, v148, v162
v_mfma_f32_16x16x32_bf16 v[116:119], v[68:71], a[116:119], v[116:119]
v_add_f32 v149, v149, v163
v_add_f32 v152, v152, v164
v_mfma_f32_16x16x32_bf16 v[120:123], v[64:67], a[104:107], v[120:123]
buffer_load_dwordx4 a[196:199], v4, s[8:11], s48 offen offset:0 sc1
v_mfma_f32_16x16x32_bf16 v[120:123], v[68:71], a[120:123], v[120:123]
ds_read_b128 v[60:63], v8 offset:3072
v_add_f32 v153, v153, v165
v_mfma_f32_16x16x32_bf16 v[124:127], v[64:67], a[108:111], v[124:127]
v_add_f32 v156, v156, v166
v_add_f32 v157, v157, v167
v_mfma_f32_16x16x32_bf16 v[124:127], v[68:71], a[124:127], v[124:127]
v_mul_f32 v144, 0x3ae38e39, v144
s_waitcnt lgkmcnt(4)
v_mfma_f32_16x16x32_bf16 v[128:131], v[72:75], a[96:99], v[128:131]
buffer_load_dwordx4 a[200:203], v5, s[8:11], s48 offen offset:0 sc1
v_mfma_f32_16x16x32_bf16 v[128:131], v[76:79], a[112:115], v[128:131]
v_mul_f32 v148, 0x3ae38e39, v148
v_mul_f32 v152, 0x3ae38e39, v152
v_mfma_f32_16x16x32_bf16 v[132:135], v[72:75], a[100:103], v[132:135]
ds_read_b128 v[64:67], v8 offset:4096
v_mul_f32 v156, 0x3ae38e39, v156
v_mfma_f32_16x16x32_bf16 v[132:135], v[76:79], a[116:119], v[132:135]
v_mul_f32 v145, 0x3ae38e39, v145
v_mul_f32 v149, 0x3ae38e39, v149
v_mfma_f32_16x16x32_bf16 v[136:139], v[72:75], a[104:107], v[136:139]
buffer_load_dwordx4 a[204:207], v6, s[8:11], s48 offen offset:0 sc1
v_mfma_f32_16x16x32_bf16 v[136:139], v[76:79], a[120:123], v[136:139]
ds_read_b128 v[68:71], v8 offset:5120
v_mul_f32 v153, 0x3ae38e39, v153
v_mfma_f32_16x16x32_bf16 v[140:143], v[72:75], a[108:111], v[140:143]
v_mul_f32 v157, 0x3ae38e39, v157
v_fma_f32 v145, -v144, v144, v145
v_mfma_f32_16x16x32_bf16 v[140:143], v[76:79], a[124:127], v[140:143]
L_hop3:
s_cmp_eq_u32 s15, 1
s_cbranch_scc1 L_hop7
v_fma_f32 v149, -v148, v148, v149
s_waitcnt vmcnt(12)
s_waitcnt lgkmcnt(4)
v_mfma_f32_16x16x32_bf16 v[80:83], v[48:51], a[128:131], v[80:83]
buffer_load_dwordx4 a[208:211], v2, s[8:11], s48 offen offset:1024 sc1
v_mfma_f32_16x16x32_bf16 v[80:83], v[52:55], a[144:147], v[80:83]
v_fma_f32 v153, -v152, v152, v153
v_fma_f32 v157, -v156, v156, v157
v_mfma_f32_16x16x32_bf16 v[84:87], v[48:51], a[132:135], v[84:87]
ds_read_b128 v[72:75], v8 offset:6144
v_max_f32 v145, 0, v145
v_mfma_f32_16x16x32_bf16 v[84:87], v[52:55], a[148:151], v[84:87]
v_max_f32 v149, 0, v149
v_max_f32 v153, 0, v153
v_mfma_f32_16x16x32_bf16 v[88:91], v[48:51], a[136:139], v[88:91]
buffer_load_dwordx4 a[212:215], v4, s[8:11], s48 offen offset:1024 sc1
v_mfma_f32_16x16x32_bf16 v[88:91], v[52:55], a[152:155], v[88:91]
ds_read_b128 v[76:79], v8 offset:7168
v_max_f32 v157, 0, v157
v_mfma_f32_16x16x32_bf16 v[92:95], v[48:51], a[140:143], v[92:95]
v_add_f32 v234, 0x3727c5ac, v145
v_add_f32 v238, 0x3727c5ac, v149
v_mfma_f32_16x16x32_bf16 v[92:95], v[52:55], a[156:159], v[92:95]
v_add_f32 v242, 0x3727c5ac, v153
s_waitcnt lgkmcnt(4)
v_mfma_f32_16x16x32_bf16 v[96:99], v[56:59], a[128:131], v[96:99]
buffer_load_dwordx4 a[216:219], v5, s[8:11], s48 offen offset:1024 sc1
v_mfma_f32_16x16x32_bf16 v[96:99], v[60:63], a[144:147], v[96:99]
v_add_f32 v246, 0x3727c5ac, v157
v_mfma_f32_16x16x32_bf16 v[100:103], v[56:59], a[132:135], v[100:103]
ds_read_b128 v[48:51], v8 offset:8192
v_mfma_f32_16x16x32_bf16 v[100:103], v[60:63], a[148:151], v[100:103]
v_rsq_f32 v144, v234
v_mfma_f32_16x16x32_bf16 v[104:107], v[56:59], a[136:139], v[104:107]
buffer_load_dwordx4 a[220:223], v6, s[8:11], s48 offen offset:1024 sc1
v_mfma_f32_16x16x32_bf16 v[104:107], v[60:63], a[152:155], v[104:107]
ds_read_b128 v[52:55], v8 offset:9216
v_mul_f32 v232, 0xc0135761, v144
v_mfma_f32_16x16x32_bf16 v[108:111], v[56:59], a[140:143], v[108:111]
v_rsq_f32 v148, v238
v_mfma_f32_16x16x32_bf16 v[108:111], v[60:63], a[156:159], v[108:111]
v_mul_f32 v236, 0xc0135761, v148
s_waitcnt lgkmcnt(4)
v_mfma_f32_16x16x32_bf16 v[112:115], v[64:67], a[128:131], v[112:115]
buffer_load_dwordx4 a[224:227], v2, s[8:11], s48 offen offset:2048 sc1
v_mfma_f32_16x16x32_bf16 v[112:115], v[68:71], a[144:147], v[112:115]
v_rsq_f32 v152, v242
v_mfma_f32_16x16x32_bf16 v[116:119], v[64:67], a[132:135], v[116:119]
ds_read_b128 v[56:59], v8 offset:10240
v_mul_f32 v240, 0xc0135761, v152
v_mfma_f32_16x16x32_bf16 v[116:119], v[68:71], a[148:151], v[116:119]
v_rsq_f32 v156, v246
v_mfma_f32_16x16x32_bf16 v[120:123], v[64:67], a[136:139], v[120:123]
buffer_load_dwordx4 a[228:231], v4, s[8:11], s48 offen offset:2048 sc1
v_mfma_f32_16x16x32_bf16 v[120:123], v[68:71], a[152:155], v[120:123]
ds_read_b128 v[60:63], v8 offset:11264
v_mul_f32 v244, 0xc0135761, v156
v_mfma_f32_16x16x32_bf16 v[124:127], v[64:67], a[140:143], v[124:127]
v_mul_f32 v145, v144, v144
v_mul_f32 v149, v148, v148
v_mfma_f32_16x16x32_bf16 v[124:127], v[68:71], a[156:159], v[124:127]
v_mul_f32 v153, v152, v152
s_waitcnt lgkmcnt(4)
v_mfma_f32_16x16x32_bf16 v[128:131], v[72:75], a[128:131], v[128:131]
buffer_load_dwordx4 a[232:235], v5, s[8:11], s48 offen offset:2048 sc1
v_mfma_f32_16x16x32_bf16 v[128:131], v[76:79], a[144:147], v[128:131]
v_mul_f32 v157, v156, v156
v_mul_f32 v145, v145, v144
v_mfma_f32_16x16x32_bf16 v[132:135], v[72:75], a[132:135], v[132:135]
ds_read_b128 v[64:67], v8 offset:12288
v_mul_f32 v149, v149, v148
v_mfma_f32_16x16x32_bf16 v[132:135], v[76:79], a[148:151], v[132:135]
v_mul_f32 v153, v153, v152
v_mul_f32 v157, v157, v156
v_mfma_f32_16x16x32_bf16 v[136:139], v[72:75], a[136:139], v[136:139]
buffer_load_dwordx4 a[236:239], v6, s[8:11], s48 offen offset:2048 sc1
v_mfma_f32_16x16x32_bf16 v[136:139], v[76:79], a[152:155], v[136:139]
ds_read_b128 v[68:71], v8 offset:13312
v_mul_f32 v233, 0xbdd2d3e8, v145
v_mfma_f32_16x16x32_bf16 v[140:143], v[72:75], a[140:143], v[140:143]
v_mul_f32 v237, 0xbdd2d3e8, v149
v_mul_f32 v241, 0xbdd2d3e8, v153
v_mfma_f32_16x16x32_bf16 v[140:143], v[76:79], a[156:159], v[140:143]
v_mul_f32 v245, 0xbdd2d3e8, v157
s_waitcnt vmcnt(12)
s_waitcnt lgkmcnt(4)
v_mfma_f32_16x16x32_bf16 v[80:83], v[48:51], a[160:163], v[80:83]
buffer_load_dwordx4 a[240:243], v2, s[8:11], s48 offen offset:3072 sc1
v_mfma_f32_16x16x32_bf16 v[80:83], v[52:55], a[176:179], v[80:83]
v_mfma_f32_16x16x32_bf16 v[84:87], v[48:51], a[164:167], v[84:87]
ds_read_b128 v[72:75], v8 offset:14336
v_mfma_f32_16x16x32_bf16 v[84:87], v[52:55], a[180:183], v[84:87]
v_mfma_f32_16x16x32_bf16 v[88:91], v[48:51], a[168:171], v[88:91]
buffer_load_dwordx4 a[244:247], v4, s[8:11], s48 offen offset:3072 sc1
v_mfma_f32_16x16x32_bf16 v[88:91], v[52:55], a[184:187], v[88:91]
ds_read_b128 v[76:79], v8 offset:15360
v_mfma_f32_16x16x32_bf16 v[92:95], v[48:51], a[172:175], v[92:95]
v_mfma_f32_16x16x32_bf16 v[92:95], v[52:55], a[188:191], v[92:95]
s_waitcnt lgkmcnt(4)
v_mfma_f32_16x16x32_bf16 v[96:99], v[56:59], a[160:163], v[96:99]
buffer_load_dwordx4 a[248:251], v5, s[8:11], s48 offen offset:3072 sc1
v_mfma_f32_16x16x32_bf16 v[96:99], v[60:63], a[176:179], v[96:99]
s_barrier
v_mfma_f32_16x16x32_bf16 v[100:103], v[56:59], a[164:167], v[100:103]
ds_read_b128 v[48:51], v2 offset:0
v_mfma_f32_16x16x32_bf16 v[100:103], v[60:63], a[180:183], v[100:103]
v_mfma_f32_16x16x32_bf16 v[104:107], v[56:59], a[168:171], v[104:107]
buffer_load_dwordx4 a[252:255], v6, s[8:11], s48 offen offset:3072 sc1
v_mfma_f32_16x16x32_bf16 v[104:107], v[60:63], a[184:187], v[104:107]
ds_read_b128 v[52:55], v2 offset:1024
s_add_u32 s48, s20, 16384
v_mfma_f32_16x16x32_bf16 v[108:111], v[56:59], a[172:175], v[108:111]
v_mfma_f32_16x16x32_bf16 v[108:111], v[60:63], a[188:191], v[108:111]
s_waitcnt lgkmcnt(4)
v_mfma_f32_16x16x32_bf16 v[112:115], v[64:67], a[160:163], v[112:115]
buffer_load_dwordx4 v[16:19], v2, s[8:11], s48 offen offset:0 sc1
v_mfma_f32_16x16x32_bf16 v[112:115], v[68:71], a[176:179], v[112:115]
v_mfma_f32_16x16x32_bf16 v[116:119], v[64:67], a[164:167], v[116:119]
ds_read_b128 v[56:59], v2 offset:2048
v_mfma_f32_16x16x32_bf16 v[116:119], v[68:71], a[180:183], v[116:119]
v_mfma_f32_16x16x32_bf16 v[120:123], v[64:67], a[168:171], v[120:123]
buffer_load_dwordx4 v[20:23], v4, s[8:11], s48 offen offset:0 sc1
v_mfma_f32_16x16x32_bf16 v[120:123], v[68:71], a[184:187], v[120:123]
ds_read_b128 v[60:63], v2 offset:3072
v_mfma_f32_16x16x32_bf16 v[124:127], v[64:67], a[172:175], v[124:127]
v_mfma_f32_16x16x32_bf16 v[124:127], v[68:71], a[188:191], v[124:127]
s_waitcnt lgkmcnt(4)
v_mfma_f32_16x16x32_bf16 v[128:131], v[72:75], a[160:163], v[128:131]
buffer_load_dwordx4 v[24:27], v5, s[8:11], s48 offen offset:0 sc1
v_mfma_f32_16x16x32_bf16 v[128:131], v[76:79], a[176:179], v[128:131]
v_mfma_f32_16x16x32_bf16 v[132:135], v[72:75], a[164:167], v[132:135]
ds_read_b128 v[64:67], v2 offset:4096
v_mfma_f32_16x16x32_bf16 v[132:135], v[76:79], a[180:183], v[132:135]
v_mfma_f32_16x16x32_bf16 v[136:139], v[72:75], a[168:171], v[136:139]
buffer_load_dwordx4 v[28:31], v6, s[8:11], s48 offen offset:0 sc1
v_mfma_f32_16x16x32_bf16 v[136:139], v[76:79], a[184:187], v[136:139]
ds_read_b128 v[68:71], v2 offset:5120
v_mfma_f32_16x16x32_bf16 v[140:143], v[72:75], a[172:175], v[140:143]
v_mfma_f32_16x16x32_bf16 v[140:143], v[76:79], a[188:191], v[140:143]
s_waitcnt vmcnt(12)
s_waitcnt lgkmcnt(4)
v_mfma_f32_16x16x32_bf16 v[80:83], v[48:51], a[192:195], v[80:83]
buffer_load_dwordx4 v[32:35], v2, s[8:11], s48 offen offset:1024 sc1
v_mfma_f32_16x16x32_bf16 v[80:83], v[52:55], a[208:211], v[80:83]
v_mfma_f32_16x16x32_bf16 v[84:87], v[48:51], a[196:199], v[84:87]
ds_read_b128 v[72:75], v2 offset:6144
v_mfma_f32_16x16x32_bf16 v[84:87], v[52:55], a[212:215], v[84:87]
v_mfma_f32_16x16x32_bf16 v[88:91], v[48:51], a[200:203], v[88:91]
buffer_load_dwordx4 v[36:39], v4, s[8:11], s48 offen offset:1024 sc1
v_mfma_f32_16x16x32_bf16 v[88:91], v[52:55], a[216:219], v[88:91]
ds_read_b128 v[76:79], v2 offset:7168
v_mfma_f32_16x16x32_bf16 v[92:95], v[48:51], a[204:207], v[92:95]
v_mfma_f32_16x16x32_bf16 v[92:95], v[52:55], a[220:223], v[92:95]
s_waitcnt lgkmcnt(4)
v_mfma_f32_16x16x32_bf16 v[96:99], v[56:59], a[192:195], v[96:99]
buffer_load_dwordx4 v[40:43], v5, s[8:11], s48 offen offset:1024 sc1
v_mfma_f32_16x16x32_bf16 v[96:99], v[60:63], a[208:211], v[96:99]
v_mfma_f32_16x16x32_bf16 v[100:103], v[56:59], a[196:199], v[100:103]
ds_read_b128 v[48:51], v2 offset:8192
v_mfma_f32_16x16x32_bf16 v[100:103], v[60:63], a[212:215], v[100:103]
v_mfma_f32_16x16x32_bf16 v[104:107], v[56:59], a[200:203], v[104:107]
buffer_load_dwordx4 v[44:47], v6, s[8:11], s48 offen offset:1024 sc1
v_mfma_f32_16x16x32_bf16 v[104:107], v[60:63], a[216:219], v[104:107]
ds_read_b128 v[52:55], v2 offset:9216
s_add_u32 m0, s22, 49152
v_mfma_f32_16x16x32_bf16 v[108:111], v[56:59], a[204:207], v[108:111]
v_add_u32 v3, 20480, v3
v_mfma_f32_16x16x32_bf16 v[108:111], v[60:63], a[220:223], v[108:111]
s_waitcnt lgkmcnt(4)
v_mfma_f32_16x16x32_bf16 v[112:115], v[64:67], a[192:195], v[112:115]
buffer_load_dwordx4 v3, s[8:11], 0 offen offset:0 sc1 lds
v_mfma_f32_16x16x32_bf16 v[112:115], v[68:71], a[208:211], v[112:115]
v_mfma_f32_16x16x32_bf16 v[116:119], v[64:67], a[196:199], v[116:119]
ds_read_b128 v[56:59], v2 offset:10240
v_mfma_f32_16x16x32_bf16 v[116:119], v[68:71], a[212:215], v[116:119]
v_mfma_f32_16x16x32_bf16 v[120:123], v[64:67], a[200:203], v[120:123]
buffer_load_dwordx4 v3, s[8:11], 0 offen offset:1024 sc1 lds
v_mfma_f32_16x16x32_bf16 v[120:123], v[68:71], a[216:219], v[120:123]
ds_read_b128 v[60:63], v2 offset:11264
v_mfma_f32_16x16x32_bf16 v[124:127], v[64:67], a[204:207], v[124:127]
v_mfma_f32_16x16x32_bf16 v[124:127], v[68:71], a[220:223], v[124:127]
s_waitcnt lgkmcnt(4)
v_mfma_f32_16x16x32_bf16 v[128:131], v[72:75], a[192:195], v[128:131]
buffer_load_dwordx4 v3, s[8:11], 0 offen offset:2048 sc1 lds
v_mfma_f32_16x16x32_bf16 v[128:131], v[76:79], a[208:211], v[128:131]
v_mfma_f32_16x16x32_bf16 v[132:135], v[72:75], a[196:199], v[132:135]
ds_read_b128 v[64:67], v2 offset:12288
v_mfma_f32_16x16x32_bf16 v[132:135], v[76:79], a[212:215], v[132:135]
v_mfma_f32_16x16x32_bf16 v[136:139], v[72:75], a[200:203], v[136:139]
buffer_load_dwordx4 v3, s[8:11], 0 offen offset:3072 sc1 lds
v_mfma_f32_16x16x32_bf16 v[136:139], v[76:79], a[216:219], v[136:139]
ds_read_b128 v[68:71], v2 offset:13312
s_add_u32 m0, s22, 53248
v_mfma_f32_16x16x32_bf16 v[140:143], v[72:75], a[204:207], v[140:143]
v_add_u32 v3, 4096, v3
v_mfma_f32_16x16x32_bf16 v[140:143], v[76:79], a[220:223], v[140:143]
s_waitcnt vmcnt(12)
s_waitcnt lgkmcnt(4)
v_mfma_f32_16x16x32_bf16 v[80:83], v[48:51], a[224:227], v[80:83]
buffer_load_dwordx4 v3, s[8:11], 0 offen offset:0 sc1 lds
v_mfma_f32_16x16x32_bf16 v[80:83], v[52:55], a[240:243], v[80:83]
v_mfma_f32_16x16x32_bf16 v[84:87], v[48:51], a[228:231], v[84:87]
ds_read_b128 v[72:75], v2 offset:14336
v_mfma_f32_16x16x32_bf16 v[84:87], v[52:55], a[244:247], v[84:87]
v_mfma_f32_16x16x32_bf16 v[88:91], v[48:51], a[232:235], v[88:91]
buffer_load_dwordx4 v3, s[8:11], 0 offen offset:1024 sc1 lds
v_mfma_f32_16x16x32_bf16 v[88:91], v[52:55], a[248:251], v[88:91]
ds_read_b128 v[76:79], v2 offset:15360
s_add_u32 m0, s22, 73728
v_mfma_f32_16x16x32_bf16 v[92:95], v[48:51], a[236:239], v[92:95]
v_add_u32 v3, 20480, v3
v_mfma_f32_16x16x32_bf16 v[92:95], v[52:55], a[252:255], v[92:95]
s_waitcnt lgkmcnt(4)
v_mfma_f32_16x16x32_bf16 v[96:99], v[56:59], a[224:227], v[96:99]
buffer_load_dwordx4 v3, s[8:11], 0 offen offset:0 sc1 lds
v_mfma_f32_16x16x32_bf16 v[96:99], v[60:63], a[240:243], v[96:99]
v_mfma_f32_16x16x32_bf16 v[100:103], v[56:59], a[228:231], v[100:103]
ds_read_b128 v[48:51], v2 offset:16384
v_mfma_f32_16x16x32_bf16 v[100:103], v[60:63], a[244:247], v[100:103]
v_mfma_f32_16x16x32_bf16 v[104:107], v[56:59], a[232:235], v[104:107]
buffer_load_dwordx4 v3, s[8:11], 0 offen offset:1024 sc1 lds
v_mfma_f32_16x16x32_bf16 v[104:107], v[60:63], a[248:251], v[104:107]
ds_read_b128 v[52:55], v2 offset:17408
v_mfma_f32_16x16x32_bf16 v[108:111], v[56:59], a[236:239], v[108:111]
v_mfma_f32_16x16x32_bf16 v[108:111], v[60:63], a[252:255], v[108:111]
s_waitcnt lgkmcnt(4)
v_mfma_f32_16x16x32_bf16 v[112:115], v[64:67], a[224:227], v[112:115]
buffer_load_dwordx4 v3, s[8:11], 0 offen offset:2048 sc1 lds
v_mfma_f32_16x16x32_bf16 v[112:115], v[68:71], a[240:243], v[112:115]
v_mfma_f32_16x16x32_bf16 v[116:119], v[64:67], a[228:231], v[116:119]
ds_read_b128 v[56:59], v2 offset:18432
v_mfma_f32_16x16x32_bf16 v[116:119], v[68:71], a[244:247], v[116:119]
v_mfma_f32_16x16x32_bf16 v[120:123], v[64:67], a[232:235], v[120:123]
buffer_load_dwordx4 v3, s[8:11], 0 offen offset:3072 sc1 lds
v_mfma_f32_16x16x32_bf16 v[120:123], v[68:71], a[248:251], v[120:123]
ds_read_b128 v[60:63], v2 offset:19456
s_add_u32 m0, s22, 77824
v_mfma_f32_16x16x32_bf16 v[124:127], v[64:67], a[236:239], v[124:127]
v_add_u32 v3, 4096, v3
v_mfma_f32_16x16x32_bf16 v[124:127], v[68:71], a[252:255], v[124:127]
s_waitcnt lgkmcnt(4)
v_mfma_f32_16x16x32_bf16 v[128:131], v[72:75], a[224:227], v[128:131]
buffer_load_dwordx4 v3, s[8:11], 0 offen offset:0 sc1 lds
v_mfma_f32_16x16x32_bf16 v[128:131], v[76:79], a[240:243], v[128:131]
v_mfma_f32_16x16x32_bf16 v[132:135], v[72:75], a[228:231], v[132:135]
ds_read_b128 v[64:67], v2 offset:20480
v_mfma_f32_16x16x32_bf16 v[132:135], v[76:79], a[244:247], v[132:135]
v_mfma_f32_16x16x32_bf16 v[136:139], v[72:75], a[232:235], v[136:139]
buffer_load_dwordx4 v3, s[8:11], 0 offen offset:1024 sc1 lds
v_mfma_f32_16x16x32_bf16 v[136:139], v[76:79], a[248:251], v[136:139]
ds_read_b128 v[68:71], v2 offset:21504
s_add_u32 m0, s22, 98304
v_mfma_f32_16x16x32_bf16 v[140:143], v[72:75], a[236:239], v[140:143]
v_add_u32 v3, 20480, v3
v_mfma_f32_16x16x32_bf16 v[140:143], v[76:79], a[252:255], v[140:143]
s_waitcnt vmcnt(12)
s_waitcnt lgkmcnt(4)
v_mfma_f32_16x16x32_bf16 v[80:83], v[48:51], v[16:19], v[80:83]
buffer_load_dwordx4 v3, s[8:11], 0 offen offset:0 sc1 lds
v_mfma_f32_16x16x32_bf16 v[80:83], v[52:55], v[32:35], v[80:83]
v_mfma_f32_16x16x32_bf16 v[84:87], v[48:51], v[20:23], v[84:87]
ds_read_b128 v[72:75], v2 offset:22528
v_mfma_f32_16x16x32_bf16 v[84:87], v[52:55], v[36:39], v[84:87]
v_mfma_f32_16x16x32_bf16 v[88:91], v[48:51], v[24:27], v[88:91]
buffer_load_dwordx4 v3, s[8:11], 0 offen offset:1024 sc1 lds
v_mfma_f32_16x16x32_bf16 v[88:91], v[52:55], v[40:43], v[88:91]
ds_read_b128 v[76:79], v2 offset:23552
v_mfma_f32_16x16x32_bf16 v[92:95], v[48:51], v[28:31], v[92:95]
v_mfma_f32_16x16x32_bf16 v[92:95], v[52:55], v[44:47], v[92:95]
s_waitcnt lgkmcnt(4)
v_mfma_f32_16x16x32_bf16 v[96:99], v[56:59], v[16:19], v[96:99]
buffer_load_dwordx4 v3, s[8:11], 0 offen offset:2048 sc1 lds
v_mfma_f32_16x16x32_bf16 v[96:99], v[60:63], v[32:35], v[96:99]
s_barrier
v_mfma_f32_16x16x32_bf16 v[100:103], v[56:59], v[20:23], v[100:103]
ds_read_b128 v[48:51], v2 offset:24576
v_mfma_f32_16x16x32_bf16 v[100:103], v[60:63], v[36:39], v[100:103]
v_mfma_f32_16x16x32_bf16 v[104:107], v[56:59], v[24:27], v[104:107]
buffer_load_dwordx4 v3, s[8:11], 0 offen offset:3072 sc1 lds
v_mfma_f32_16x16x32_bf16 v[104:107], v[60:63], v[40:43], v[104:107]
ds_read_b128 v[52:55], v2 offset:25600
s_add_u32 m0, s22, 102400
v_mfma_f32_16x16x32_bf16 v[108:111], v[56:59], v[28:31], v[108:111]
v_add_u32 v3, 4096, v3
v_mfma_f32_16x16x32_bf16 v[108:111], v[60:63], v[44:47], v[108:111]
s_waitcnt lgkmcnt(4)
v_mfma_f32_16x16x32_bf16 v[112:115], v[64:67], v[16:19], v[112:115]
buffer_load_dwordx4 v3, s[8:11], 0 offen offset:0 sc1 lds
v_mfma_f32_16x16x32_bf16 v[112:115], v[68:71], v[32:35], v[112:115]
v_mfma_f32_16x16x32_bf16 v[116:119], v[64:67], v[20:23], v[116:119]
ds_read_b128 v[56:59], v2 offset:26624
v_mfma_f32_16x16x32_bf16 v[116:119], v[68:71], v[36:39], v[116:119]
v_mfma_f32_16x16x32_bf16 v[120:123], v[64:67], v[24:27], v[120:123]
buffer_load_dwordx4 v3, s[8:11], 0 offen offset:1024 sc1 lds
v_mfma_f32_16x16x32_bf16 v[120:123], v[68:71], v[40:43], v[120:123]
ds_read_b128 v[60:63], v2 offset:27648
s_add_u32 m0, s22, 122880
v_mfma_f32_16x16x32_bf16 v[124:127], v[64:67], v[28:31], v[124:127]
v_add_u32 v3, 20480, v3
v_mfma_f32_16x16x32_bf16 v[124:127], v[68:71], v[44:47], v[124:127]
s_waitcnt lgkmcnt(4)
v_mfma_f32_16x16x32_bf16 v[128:131], v[72:75], v[16:19], v[128:131]
v_mfma_f32_16x16x32_bf16 v[128:131], v[76:79], v[32:35], v[128:131]
buffer_load_dwordx4 v3, s[8:11], 0 offen offset:0 sc1 lds
v_mfma_f32_16x16x32_bf16 v[132:135], v[72:75], v[20:23], v[132:135]
ds_read_b128 v[64:67], v2 offset:28672
v_mfma_f32_16x16x32_bf16 v[132:135], v[76:79], v[36:39], v[132:135]
v_mfma_f32_16x16x32_bf16 v[136:139], v[72:75], v[24:27], v[136:139]
v_mfma_f32_16x16x32_bf16 v[136:139], v[76:79], v[40:43], v[136:139]
ds_read_b128 v[68:71], v2 offset:29696
v_mfma_f32_16x16x32_bf16 v[140:143], v[72:75], v[28:31], v[140:143]
buffer_load_dwordx4 v3, s[8:11], 0 offen offset:1024 sc1 lds
v_mfma_f32_16x16x32_bf16 v[140:143], v[76:79], v[44:47], v[140:143]
s_waitcnt lgkmcnt(4)
v_mfma_f32_16x16x32_bf16 v[176:179], v[48:51], a[0:3], 0
v_mfma_f32_16x16x32_bf16 v[176:179], v[52:55], a[16:19], v[176:179]
v_mfma_f32_16x16x32_bf16 v[180:183], v[48:51], a[4:7], 0
ds_read_b128 v[72:75], v2 offset:30720
v_mfma_f32_16x16x32_bf16 v[180:183], v[52:55], a[20:23], v[180:183]
buffer_load_dwordx4 v3, s[8:11], 0 offen offset:2048 sc1 lds
v_mfma_f32_16x16x32_bf16 v[184:187], v[48:51], a[8:11], 0
v_mul_f32 v208, v80, v80
v_mul_f32 v210, v81, v81
v_mfma_f32_16x16x32_bf16 v[184:187], v[52:55], a[24:27], v[184:187]
ds_read_b128 v[76:79], v2 offset:31744
v_fma_f32 v208, v208, v233, v232
v_mfma_f32_16x16x32_bf16 v[188:191], v[48:51], a[12:15], 0
v_fma_f32 v210, v210, v233, v232
v_mul_f32 v208, v208, v80
v_mfma_f32_16x16x32_bf16 v[188:191], v[52:55], a[28:31], v[188:191]
v_mul_f32 v210, v210, v81
s_waitcnt lgkmcnt(4)
v_mfma_f32_16x16x32_bf16 v[192:195], v[56:59], a[0:3], 0
buffer_load_dwordx4 v3, s[8:11], 0 offen offset:3072 sc1 lds
v_mfma_f32_16x16x32_bf16 v[192:195], v[60:63], a[16:19], v[192:195]
s_add_u32 m0, s22, 126976
v_add_u32 v3, 4096, v3
v_mfma_f32_16x16x32_bf16 v[196:199], v[56:59], a[4:7], 0
ds_read_b128 v[48:51], v2 offset:32768
v_mul_f32 v209, v80, v96
v_mfma_f32_16x16x32_bf16 v[196:199], v[60:63], a[20:23], v[196:199]
v_exp_f32 v208, v208
v_mfma_f32_16x16x32_bf16 v[200:203], v[56:59], a[8:11], 0
v_exp_f32 v210, v210
v_mfma_f32_16x16x32_bf16 v[200:203], v[60:63], a[24:27], v[200:203]
ds_read_b128 v[52:55], v2 offset:33792
v_mul_f32 v211, v81, v97
v_mfma_f32_16x16x32_bf16 v[204:207], v[56:59], a[12:15], 0
buffer_load_dwordx4 v3, s[8:11], 0 offen offset:0 sc1 lds
v_mfma_f32_16x16x32_bf16 v[204:207], v[60:63], a[28:31], v[204:207]
v_fma_f32 v208, v208, v234, v234
s_waitcnt lgkmcnt(4)
v_mfma_f32_16x16x32_bf16 v[176:179], v[64:67], a[32:35], v[176:179]
v_fma_f32 v210, v210, v234, v234
v_mul_f32 v212, v82, v82
v_mfma_f32_16x16x32_bf16 v[176:179], v[68:71], a[48:51], v[176:179]
v_rcp_f32 v208, v208
v_mfma_f32_16x16x32_bf16 v[180:183], v[64:67], a[36:39], v[180:183]
ds_read_b128 v[56:59], v2 offset:34816
v_mul_f32 v209, v209, v208
v_mfma_f32_16x16x32_bf16 v[180:183], v[68:71], a[52:55], v[180:183]
buffer_load_dwordx4 v3, s[8:11], 0 offen offset:1024 sc1 lds
v_mfma_f32_16x16x32_bf16 v[184:187], v[64:67], a[40:43], v[184:187]
v_rcp_f32 v210, v210
v_mfma_f32_16x16x32_bf16 v[184:187], v[68:71], a[56:59], v[184:187]
ds_read_b128 v[60:63], v2 offset:35840
v_mul_f32 v211, v211, v210
v_mfma_f32_16x16x32_bf16 v[188:191], v[64:67], a[44:47], v[188:191]
v_cvt_pk_bf16_f32 v224, v209, v211
v_mul_f32 v214, v83, v83
v_mfma_f32_16x16x32_bf16 v[188:191], v[68:71], a[60:63], v[188:191]
v_fma_f32 v212, v212, v233, v232
s_waitcnt lgkmcnt(4)
v_mfma_f32_16x16x32_bf16 v[192:195], v[72:75], a[32:35], v[192:195]
v_fma_f32 v214, v214, v233, v232
v_mul_f32 v212, v212, v82
v_mfma_f32_16x16x32_bf16 v[192:195], v[76:79], a[48:51], v[192:195]
v_mul_f32 v214, v214, v83
v_mul_f32 v213, v82, v98
v_mfma_f32_16x16x32_bf16 v[196:199], v[72:75], a[36:39], v[196:199]
ds_read_b128 v[64:67], v2 offset:36864
v_mul_f32 v215, v83, v99
v_mfma_f32_16x16x32_bf16 v[196:199], v[76:79], a[52:55], v[196:199]
v_exp_f32 v212, v212
v_mfma_f32_16x16x32_bf16 v[200:203], v[72:75], a[40:43], v[200:203]
v_exp_f32 v214, v214
v_mfma_f32_16x16x32_bf16 v[200:203], v[76:79], a[56:59], v[200:203]
ds_read_b128 v[68:71], v2 offset:37888
v_fma_f32 v212, v212, v234, v234
v_mfma_f32_16x16x32_bf16 v[204:207], v[72:75], a[44:47], v[204:207]
v_fma_f32 v214, v214, v234, v234
v_mul_f32 v208, v84, v84
v_mfma_f32_16x16x32_bf16 v[204:207], v[76:79], a[60:63], v[204:207]
v_mul_f32 v210, v85, v85
s_waitcnt lgkmcnt(4)
v_mfma_f32_16x16x32_bf16 v[176:179], v[48:51], a[64:67], v[176:179]
v_rcp_f32 v212, v212
v_mfma_f32_16x16x32_bf16 v[176:179], v[52:55], a[80:83], v[176:179]
v_rcp_f32 v214, v214
v_mfma_f32_16x16x32_bf16 v[180:183], v[48:51], a[68:71], v[180:183]
ds_read_b128 v[72:75], v2 offset:38912
v_mul_f32 v213, v213, v212
v_mfma_f32_16x16x32_bf16 v[180:183], v[52:55], a[84:87], v[180:183]
v_mul_f32 v215, v215, v214
v_cvt_pk_bf16_f32 v225, v213, v215
v_mfma_f32_16x16x32_bf16 v[184:187], v[48:51], a[72:75], v[184:187]
buffer_store_dwordx2 v[224:225], v248, s[8:11], s30 offen sc1
v_mfma_f32_16x16x32_bf16 v[184:187], v[52:55], a[88:91], v[184:187]
ds_read_b128 v[76:79], v2 offset:39936
v_fma_f32 v208, v208, v237, v236
v_mfma_f32_16x16x32_bf16 v[188:191], v[48:51], a[76:79], v[188:191]
v_fma_f32 v210, v210, v237, v236
v_mul_f32 v208, v208, v84
v_mfma_f32_16x16x32_bf16 v[188:191], v[52:55], a[92:95], v[188:191]
v_mul_f32 v210, v210, v85
s_waitcnt lgkmcnt(4)
v_mfma_f32_16x16x32_bf16 v[192:195], v[56:59], a[64:67], v[192:195]
v_exp_f32 v208, v208
v_mfma_f32_16x16x32_bf16 v[192:195], v[60:63], a[80:83], v[192:195]
v_exp_f32 v210, v210
v_mfma_f32_16x16x32_bf16 v[196:199], v[56:59], a[68:71], v[196:199]
ds_read_b128 v[48:51], v2 offset:40960
v_mul_f32 v209, v84, v100
v_mfma_f32_16x16x32_bf16 v[196:199], v[60:63], a[84:87], v[196:199]
v_mul_f32 v211, v85, v101
v_fma_f32 v208, v208, v238, v238
v_mfma_f32_16x16x32_bf16 v[200:203], v[56:59], a[72:75], v[200:203]
v_fma_f32 v210, v210, v238, v238
v_mul_f32 v212, v86, v86
v_mfma_f32_16x16x32_bf16 v[200:203], v[60:63], a[88:91], v[200:203]
ds_read_b128 v[52:55], v2 offset:41984
v_mul_f32 v214, v87, v87
v_mfma_f32_16x16x32_bf16 v[204:207], v[56:59], a[76:79], v[204:207]
v_rcp_f32 v208, v208
v_mfma_f32_16x16x32_bf16 v[204:207], v[60:63], a[92:95], v[204:207]
v_mul_f32 v209, v209, v208
s_waitcnt lgkmcnt(4)
v_mfma_f32_16x16x32_bf16 v[176:179], v[64:67], a[96:99], v[176:179]
v_rcp_f32 v210, v210
v_mfma_f32_16x16x32_bf16 v[176:179], v[68:71], a[112:115], v[176:179]
v_mul_f32 v211, v211, v210
v_cvt_pk_bf16_f32 v226, v209, v211
v_mfma_f32_16x16x32_bf16 v[180:183], v[64:67], a[100:103], v[180:183]
ds_read_b128 v[56:59], v2 offset:43008
v_fma_f32 v212, v212, v237, v236
v_mfma_f32_16x16x32_bf16 v[180:183], v[68:71], a[116:119], v[180:183]
v_fma_f32 v214, v214, v237, v236
v_mul_f32 v212, v212, v86
v_mfma_f32_16x16x32_bf16 v[184:187], v[64:67], a[104:107], v[184:187]
v_mul_f32 v214, v214, v87
v_mul_f32 v213, v86, v102
v_mfma_f32_16x16x32_bf16 v[184:187], v[68:71], a[120:123], v[184:187]
ds_read_b128 v[60:63], v2 offset:44032
v_mul_f32 v215, v87, v103
v_mfma_f32_16x16x32_bf16 v[188:191], v[64:67], a[108:111], v[188:191]
v_exp_f32 v212, v212
v_mfma_f32_16x16x32_bf16 v[188:191], v[68:71], a[124:127], v[188:191]
v_fma_f32 v212, v212, v238, v238
s_waitcnt lgkmcnt(4)
v_mfma_f32_16x16x32_bf16 v[192:195], v[72:75], a[96:99], v[192:195]
v_exp_f32 v214, v214
v_mfma_f32_16x16x32_bf16 v[192:195], v[76:79], a[112:115], v[192:195]
v_fma_f32 v214, v214, v238, v238
v_mul_f32 v208, v88, v88
v_mfma_f32_16x16x32_bf16 v[196:199], v[72:75], a[100:103], v[196:199]
ds_read_b128 v[64:67], v2 offset:45056
v_mul_f32 v210, v89, v89
v_mfma_f32_16x16x32_bf16 v[196:199], v[76:79], a[116:119], v[196:199]
v_rcp_f32 v212, v212
v_mfma_f32_16x16x32_bf16 v[200:203], v[72:75], a[104:107], v[200:203]
v_rcp_f32 v214, v214
v_mfma_f32_16x16x32_bf16 v[200:203], v[76:79], a[120:123], v[200:203]
ds_read_b128 v[68:71], v2 offset:46080
v_mul_f32 v213, v213, v212
v_mfma_f32_16x16x32_bf16 v[204:207], v[72:75], a[108:111], v[204:207]
v_mul_f32 v215, v215, v214
v_cvt_pk_bf16_f32 v227, v213, v215
v_mfma_f32_16x16x32_bf16 v[204:207], v[76:79], a[124:127], v[204:207]
v_fma_f32 v208, v208, v241, v240
s_waitcnt lgkmcnt(4)
v_mfma_f32_16x16x32_bf16 v[176:179], v[48:51], a[128:131], v[176:179]
buffer_store_dwordx2 v[226:227], v249, s[8:11], s30 offen sc1
v_mfma_f32_16x16x32_bf16 v[176:179], v[52:55], a[144:147], v[176:179]
v_fma_f32 v210, v210, v241, v240
v_mul_f32 v208, v208, v88
v_mfma_f32_16x16x32_bf16 v[180:183], v[48:51], a[132:135], v[180:183]
ds_read_b128 v[72:75], v2 offset:47104
v_mul_f32 v210, v210, v89
v_mfma_f32_16x16x32_bf16 v[180:183], v[52:55], a[148:151], v[180:183]
v_exp_f32 v208, v208
v_mfma_f32_16x16x32_bf16 v[184:187], v[48:51], a[136:139], v[184:187]
v_exp_f32 v210, v210
v_mfma_f32_16x16x32_bf16 v[184:187], v[52:55], a[152:155], v[184:187]
ds_read_b128 v[76:79], v2 offset:48128
v_mul_f32 v209, v88, v104
v_mfma_f32_16x16x32_bf16 v[188:191], v[48:51], a[140:143], v[188:191]
v_mul_f32 v211, v89, v105
v_fma_f32 v208, v208, v242, v242
v_mfma_f32_16x16x32_bf16 v[188:191], v[52:55], a[156:159], v[188:191]
v_fma_f32 v210, v210, v242, v242
s_waitcnt lgkmcnt(4)
v_mfma_f32_16x16x32_bf16 v[192:195], v[56:59], a[128:131], v[192:195]
s_waitcnt vmcnt(20)
v_mul_f32 v212, v90, v90
v_mfma_f32_16x16x32_bf16 v[192:195], v[60:63], a[144:147], v[192:195]
s_barrier
v_mfma_f32_16x16x32_bf16 v[196:199], v[56:59], a[132:135], v[196:199]
ds_read_b128 v[48:51], v2 offset:49152
s_add_u32 m0, s22, 0
v_mfma_f32_16x16x32_bf16 v[196:199], v[60:63], a[148:151], v[196:199]
v_add_u32 v3, 20480, v3
buffer_load_dwordx4 v3, s[8:11], 0 offen offset:0 sc1 lds
v_mfma_f32_16x16x32_bf16 v[200:203], v[56:59], a[136:139], v[200:203]
v_rcp_f32 v208, v208
v_mfma_f32_16x16x32_bf16 v[200:203], v[60:63], a[152:155], v[200:203]
ds_read_b128 v[52:55], v2 offset:50176
v_mul_f32 v209, v209, v208
v_mfma_f32_16x16x32_bf16 v[204:207], v[56:59], a[140:143], v[204:207]
v_rcp_f32 v210, v210
v_mfma_f32_16x16x32_bf16 v[204:207], v[60:63], a[156:159], v[204:207]
v_mul_f32 v211, v211, v210
s_waitcnt lgkmcnt(4)
v_mfma_f32_16x16x32_bf16 v[176:179], v[64:67], a[160:163], v[176:179]
buffer_load_dwordx4 v3, s[8:11], 0 offen offset:1024 sc1 lds
v_mfma_f32_16x16x32_bf16 v[176:179], v[68:71], a[176:179], v[176:179]
v_cvt_pk_bf16_f32 v228, v209, v211
v_mul_f32 v214, v91, v91
v_mfma_f32_16x16x32_bf16 v[180:183], v[64:67], a[164:167], v[180:183]
ds_read_b128 v[56:59], v2 offset:51200
v_fma_f32 v212, v212, v241, v240
v_mfma_f32_16x16x32_bf16 v[180:183], v[68:71], a[180:183], v[180:183]
v_fma_f32 v214, v214, v241, v240
v_mul_f32 v212, v212, v90
v_mfma_f32_16x16x32_bf16 v[184:187], v[64:67], a[168:171], v[184:187]
v_mul_f32 v214, v214, v91
v_mul_f32 v213, v90, v106
v_mfma_f32_16x16x32_bf16 v[184:187], v[68:71], a[184:187], v[184:187]
ds_read_b128 v[60:63], v2 offset:52224
v_mul_f32 v215, v91, v107
v_mfma_f32_16x16x32_bf16 v[188:191], v[64:67], a[172:175], v[188:191]
buffer_load_dwordx4 v3, s[8:11], 0 offen offset:2048 sc1 lds
v_mfma_f32_16x16x32_bf16 v[188:191], v[68:71], a[188:191], v[188:191]
v_mul_f32 v208, v92, v92
s_waitcnt lgkmcnt(4)
v_mfma_f32_16x16x32_bf16 v[192:195], v[72:75], a[160:163], v[192:195]
v_exp_f32 v212, v212
v_mfma_f32_16x16x32_bf16 v[192:195], v[76:79], a[176:179], v[192:195]
v_exp_f32 v214, v214
v_mfma_f32_16x16x32_bf16 v[196:199], v[72:75], a[164:167], v[196:199]
ds_read_b128 v[64:67], v2 offset:53248
v_fma_f32 v212, v212, v242, v242
v_mfma_f32_16x16x32_bf16 v[196:199], v[76:79], a[180:183], v[196:199]
buffer_load_dwordx4 v3, s[8:11], 0 offen offset:3072 sc1 lds
v_mfma_f32_16x16x32_bf16 v[200:203], v[72:75], a[168:171], v[200:203]
s_add_u32 m0, s22, 4096
v_add_u32 v3, 4096, v3
v_mfma_f32_16x16x32_bf16 v[200:203], v[76:79], a[184:187], v[200:203]
ds_read_b128 v[68:71], v2 offset:54272
v_fma_f32 v214, v214, v242, v242
v_mfma_f32_16x16x32_bf16 v[204:207], v[72:75], a[172:175], v[204:207]
v_rcp_f32 v212, v212
v_mfma_f32_16x16x32_bf16 v[204:207], v[76:79], a[188:191], v[204:207]
v_mul_f32 v213, v213, v212
s_waitcnt lgkmcnt(4)
v_mfma_f32_16x16x32_bf16 v[176:179], v[48:51], a[192:195], v[176:179]
buffer_load_dwordx4 v3, s[8:11], 0 offen offset:0 sc1 lds
v_mfma_f32_16x16x32_bf16 v[176:179], v[52:55], a[208:211], v[176:179]
v_rcp_f32 v214, v214
v_mfma_f32_16x16x32_bf16 v[180:183], v[48:51], a[196:199], v[180:183]
ds_read_b128 v[72:75], v2 offset:55296
v_mul_f32 v215, v215, v214
v_mfma_f32_16x16x32_bf16 v[180:183], v[52:55], a[212:215], v[180:183]
v_cvt_pk_bf16_f32 v229, v213, v215
v_mul_f32 v210, v93, v93
v_mfma_f32_16x16x32_bf16 v[184:187], v[48:51], a[200:203], v[184:187]
buffer_store_dwordx2 v[228:229], v250, s[8:11], s30 offen sc1
v_mfma_f32_16x16x32_bf16 v[184:187], v[52:55], a[216:219], v[184:187]
L_hop4:
s_cmp_eq_u32 s15, 1
s_cbranch_scc1 L_hop8
ds_read_b128 v[76:79], v2 offset:56320
v_fma_f32 v208, v208, v245, v244
v_mfma_f32_16x16x32_bf16 v[188:191], v[48:51], a[204:207], v[188:191]
v_fma_f32 v210, v210, v245, v244
v_mul_f32 v208, v208, v92
v_mfma_f32_16x16x32_bf16 v[188:191], v[52:55], a[220:223], v[188:191]
v_mul_f32 v210, v210, v93
s_waitcnt lgkmcnt(4)
v_mfma_f32_16x16x32_bf16 v[192:195], v[56:59], a[192:195], v[192:195]
v_exp_f32 v208, v208
v_mfma_f32_16x16x32_bf16 v[192:195], v[60:63], a[208:211], v[192:195]
buffer_load_dwordx4 v3, s[8:11], 0 offen offset:1024 sc1 lds
v_mfma_f32_16x16x32_bf16 v[196:199], v[56:59], a[196:199], v[196:199]
ds_read_b128 v[48:51], v2 offset:57344
v_mul_f32 v209, v92, v108
v_mfma_f32_16x16x32_bf16 v[196:199], v[60:63], a[212:215], v[196:199]
v_exp_f32 v210, v210
v_mfma_f32_16x16x32_bf16 v[200:203], v[56:59], a[200:203], v[200:203]
v_mul_f32 v211, v93, v109
v_fma_f32 v208, v208, v246, v246
v_mfma_f32_16x16x32_bf16 v[200:203], v[60:63], a[216:219], v[200:203]
ds_read_b128 v[52:55], v2 offset:58368
v_fma_f32 v210, v210, v246, v246
v_mfma_f32_16x16x32_bf16 v[204:207], v[56:59], a[204:207], v[204:207]
v_rcp_f32 v208, v208
v_mfma_f32_16x16x32_bf16 v[204:207], v[60:63], a[220:223], v[204:207]
v_mul_f32 v209, v209, v208
s_waitcnt lgkmcnt(4)
v_mfma_f32_16x16x32_bf16 v[176:179], v[64:67], a[224:227], v[176:179]
v_rcp_f32 v210, v210
v_mfma_f32_16x16x32_bf16 v[176:179], v[68:71], a[240:243], v[176:179]
v_mul_f32 v211, v211, v210
v_cvt_pk_bf16_f32 v230, v209, v211
v_mfma_f32_16x16x32_bf16 v[180:183], v[64:67], a[228:231], v[180:183]
ds_read_b128 v[56:59], v2 offset:59392
v_mul_f32 v212, v94, v94
v_mfma_f32_16x16x32_bf16 v[180:183], v[68:71], a[244:247], v[180:183]
v_mul_f32 v214, v95, v95
v_fma_f32 v212, v212, v245, v244
v_mfma_f32_16x16x32_bf16 v[184:187], v[64:67], a[232:235], v[184:187]
v_fma_f32 v214, v214, v245, v244
v_mul_f32 v212, v212, v94
v_mfma_f32_16x16x32_bf16 v[184:187], v[68:71], a[248:251], v[184:187]
ds_read_b128 v[60:63], v2 offset:60416
v_mul_f32 v214, v214, v95
v_mfma_f32_16x16x32_bf16 v[188:191], v[64:67], a[236:239], v[188:191]
v_exp_f32 v212, v212
v_mfma_f32_16x16x32_bf16 v[188:191], v[68:71], a[252:255], v[188:191]
v_mul_f32 v213, v94, v110
s_waitcnt lgkmcnt(4)
v_mfma_f32_16x16x32_bf16 v[192:195], v[72:75], a[224:227], v[192:195]
v_exp_f32 v214, v214
v_mfma_f32_16x16x32_bf16 v[192:195], v[76:79], a[240:243], v[192:195]
v_mul_f32 v215, v95, v111
v_fma_f32 v212, v212, v246, v246
v_mfma_f32_16x16x32_bf16 v[196:199], v[72:75], a[228:231], v[196:199]
ds_read_b128 v[64:67], v2 offset:61440
v_fma_f32 v214, v214, v246, v246
v_mfma_f32_16x16x32_bf16 v[196:199], v[76:79], a[244:247], v[196:199]
v_rcp_f32 v212, v212
v_mfma_f32_16x16x32_bf16 v[200:203], v[72:75], a[232:235], v[200:203]
v_rcp_f32 v214, v214
v_mfma_f32_16x16x32_bf16 v[200:203], v[76:79], a[248:251], v[200:203]
ds_read_b128 v[68:71], v2 offset:62464
v_mul_f32 v213, v213, v212
v_mfma_f32_16x16x32_bf16 v[204:207], v[72:75], a[236:239], v[204:207]
v_mul_f32 v215, v215, v214
v_cvt_pk_bf16_f32 v231, v213, v215
v_mfma_f32_16x16x32_bf16 v[204:207], v[76:79], a[252:255], v[204:207]
v_mul_f32 v208, v112, v112
s_waitcnt lgkmcnt(4)
v_mfma_f32_16x16x32_bf16 v[176:179], v[48:51], v[16:19], v[176:179]
buffer_store_dwordx2 v[230:231], v251, s[8:11], s30 offen sc1
v_mfma_f32_16x16x32_bf16 v[176:179], v[52:55], v[32:35], v[176:179]
v_mul_f32 v210, v113, v113
v_fma_f32 v208, v208, v233, v232
v_mfma_f32_16x16x32_bf16 v[180:183], v[48:51], v[20:23], v[180:183]
ds_read_b128 v[72:75], v2 offset:63488
v_fma_f32 v210, v210, v233, v232
v_mfma_f32_16x16x32_bf16 v[180:183], v[52:55], v[36:39], v[180:183]
v_mul_f32 v208, v208, v112
v_mul_f32 v210, v210, v113
v_mfma_f32_16x16x32_bf16 v[184:187], v[48:51], v[24:27], v[184:187]
v_exp_f32 v208, v208
v_mfma_f32_16x16x32_bf16 v[184:187], v[52:55], v[40:43], v[184:187]
ds_read_b128 v[76:79], v2 offset:64512
v_mul_f32 v209, v112, v128
v_mfma_f32_16x16x32_bf16 v[188:191], v[48:51], v[28:31], v[188:191]
v_exp_f32 v210, v210
v_mfma_f32_16x16x32_bf16 v[188:191], v[52:55], v[44:47], v[188:191]
v_mul_f32 v211, v113, v129
s_waitcnt lgkmcnt(4)
v_mfma_f32_16x16x32_bf16 v[192:195], v[56:59], v[16:19], v[192:195]
v_fma_f32 v208, v208, v234, v234
v_fma_f32 v210, v210, v234, v234
v_mfma_f32_16x16x32_bf16 v[192:195], v[60:63], v[32:35], v[192:195]
v_rcp_f32 v208, v208
v_mfma_f32_16x16x32_bf16 v[196:199], v[56:59], v[20:23], v[196:199]
ds_read_b128 v[48:51], v7 offset:0
v_mul_f32 v209, v209, v208
v_mfma_f32_16x16x32_bf16 v[196:199], v[60:63], v[36:39], v[196:199]
v_rcp_f32 v210, v210
v_mfma_f32_16x16x32_bf16 v[200:203], v[56:59], v[24:27], v[200:203]
v_mul_f32 v211, v211, v210
v_cvt_pk_bf16_f32 v144, v209, v211
v_mfma_f32_16x16x32_bf16 v[200:203], v[60:63], v[40:43], v[200:203]
ds_read_b128 v[52:55], v7 offset:1024
v_mul_f32 v212, v114, v114
v_mfma_f32_16x16x32_bf16 v[204:207], v[56:59], v[28:31], v[204:207]
v_mul_f32 v214, v115, v115
v_fma_f32 v212, v212, v233, v232
v_mfma_f32_16x16x32_bf16 v[204:207], v[60:63], v[44:47], v[204:207]
v_fma_f32 v214, v214, v233, v232
s_waitcnt lgkmcnt(4)
v_mfma_f32_16x16x32_bf16 v[80:83], v[64:67], a[0:3], 0
v_mul_f32 v212, v212, v114
v_mul_f32 v214, v214, v115
v_mfma_f32_16x16x32_bf16 v[80:83], v[68:71], a[16:19], v[80:83]
v_exp_f32 v212, v212
v_mfma_f32_16x16x32_bf16 v[84:87], v[64:67], a[4:7], 0
ds_read_b128 v[56:59], v7 offset:2048
v_mul_f32 v213, v114, v130
v_mfma_f32_16x16x32_bf16 v[84:87], v[68:71], a[20:23], v[84:87]
v_exp_f32 v214, v214
v_mfma_f32_16x16x32_bf16 v[88:91], v[64:67], a[8:11], 0
v_mul_f32 v215, v115, v131
v_fma_f32 v212, v212, v234, v234
v_mfma_f32_16x16x32_bf16 v[88:91], v[68:71], a[24:27], v[88:91]
ds_read_b128 v[60:63], v7 offset:3072
v_fma_f32 v214, v214, v234, v234
v_mfma_f32_16x16x32_bf16 v[92:95], v[64:67], a[12:15], 0
v_rcp_f32 v212, v212
v_mfma_f32_16x16x32_bf16 v[92:95], v[68:71], a[28:31], v[92:95]
v_mul_f32 v213, v213, v212
s_waitcnt lgkmcnt(4)
v_mfma_f32_16x16x32_bf16 v[96:99], v[72:75], a[0:3], 0
v_rcp_f32 v214, v214
v_mfma_f32_16x16x32_bf16 v[96:99], v[76:79], a[16:19], v[96:99]
v_mul_f32 v215, v215, v214
v_cvt_pk_bf16_f32 v145, v213, v215
v_mfma_f32_16x16x32_bf16 v[100:103], v[72:75], a[4:7], 0
ds_read_b128 v[64:67], v7 offset:4096
v_mul_f32 v208, v116, v116
v_mfma_f32_16x16x32_bf16 v[100:103], v[76:79], a[20:23], v[100:103]
v_mul_f32 v210, v117, v117
v_fma_f32 v208, v208, v237, v236
v_mfma_f32_16x16x32_bf16 v[104:107], v[72:75], a[8:11], 0
v_fma_f32 v210, v210, v237, v236
v_mul_f32 v208, v208, v116
v_mfma_f32_16x16x32_bf16 v[104:107], v[76:79], a[24:27], v[104:107]
ds_read_b128 v[68:71], v7 offset:5120
v_mul_f32 v210, v210, v117
v_mfma_f32_16x16x32_bf16 v[108:111], v[72:75], a[12:15], 0
v_exp_f32 v208, v208
v_mfma_f32_16x16x32_bf16 v[108:111], v[76:79], a[28:31], v[108:111]
v_mul_f32 v209, v116, v132
s_waitcnt lgkmcnt(4)
v_mfma_f32_16x16x32_bf16 v[80:83], v[48:51], a[32:35], v[80:83]
v_exp_f32 v210, v210
v_mfma_f32_16x16x32_bf16 v[80:83], v[52:55], a[48:51], v[80:83]
v_mul_f32 v211, v117, v133
v_fma_f32 v208, v208, v238, v238
v_mfma_f32_16x16x32_bf16 v[84:87], v[48:51], a[36:39], v[84:87]
ds_read_b128 v[72:75], v7 offset:6144
v_fma_f32 v210, v210, v238, v238
v_mfma_f32_16x16x32_bf16 v[84:87], v[52:55], a[52:55], v[84:87]
v_rcp_f32 v208, v208
v_mfma_f32_16x16x32_bf16 v[88:91], v[48:51], a[40:43], v[88:91]
v_rcp_f32 v210, v210
v_mfma_f32_16x16x32_bf16 v[88:91], v[52:55], a[56:59], v[88:91]
ds_read_b128 v[76:79], v7 offset:7168
v_mul_f32 v209, v209, v208
v_mfma_f32_16x16x32_bf16 v[92:95], v[48:51], a[44:47], v[92:95]
v_mul_f32 v211, v211, v210
v_cvt_pk_bf16_f32 v148, v209, v211
v_mfma_f32_16x16x32_bf16 v[92:95], v[52:55], a[60:63], v[92:95]
v_mul_f32 v212, v118, v118
s_waitcnt lgkmcnt(4)
v_mfma_f32_16x16x32_bf16 v[96:99], v[56:59], a[32:35], v[96:99]
s_waitcnt vmcnt(22)
v_mul_f32 v214, v119, v119
v_mfma_f32_16x16x32_bf16 v[96:99], v[60:63], a[48:51], v[96:99]
s_barrier
v_mfma_f32_16x16x32_bf16 v[100:103], v[56:59], a[36:39], v[100:103]
ds_read_b128 v[48:51], v7 offset:8192
s_add_u32 m0, s22, 24576
v_mfma_f32_16x16x32_bf16 v[100:103], v[60:63], a[52:55], v[100:103]
v_add_u32 v3, 20480, v3
buffer_load_dwordx4 v3, s[8:11], 0 offen offset:0 sc1 lds
v_mfma_f32_16x16x32_bf16 v[104:107], v[56:59], a[40:43], v[104:107]
v_fma_f32 v212, v212, v237, v236
v_fma_f32 v214, v214, v237, v236
v_mfma_f32_16x16x32_bf16 v[104:107], v[60:63], a[56:59], v[104:107]
ds_read_b128 v[52:55], v7 offset:9216
v_mul_f32 v212, v212, v118
v_mfma_f32_16x16x32_bf16 v[108:111], v[56:59], a[44:47], v[108:111]
v_mul_f32 v214, v214, v119
v_mul_f32 v213, v118, v134
v_mfma_f32_16x16x32_bf16 v[108:111], v[60:63], a[60:63], v[108:111]
v_mul_f32 v215, v119, v135
s_waitcnt lgkmcnt(4)
v_mfma_f32_16x16x32_bf16 v[80:83], v[64:67], a[64:67], v[80:83]
buffer_load_dwordx4 v3, s[8:11], 0 offen offset:1024 sc1 lds
v_mfma_f32_16x16x32_bf16 v[80:83], v[68:71], a[80:83], v[80:83]
v_exp_f32 v212, v212
v_mfma_f32_16x16x32_bf16 v[84:87], v[64:67], a[68:71], v[84:87]
ds_read_b128 v[56:59], v7 offset:10240
v_fma_f32 v212, v212, v238, v238
v_mfma_f32_16x16x32_bf16 v[84:87], v[68:71], a[84:87], v[84:87]
v_exp_f32 v214, v214
v_mfma_f32_16x16x32_bf16 v[88:91], v[64:67], a[72:75], v[88:91]
v_fma_f32 v214, v214, v238, v238
v_mul_f32 v208, v120, v120
v_mfma_f32_16x16x32_bf16 v[88:91], v[68:71], a[88:91], v[88:91]
ds_read_b128 v[60:63], v7 offset:11264
v_mul_f32 v210, v121, v121
v_mfma_f32_16x16x32_bf16 v[92:95], v[64:67], a[76:79], v[92:95]
buffer_load_dwordx4 v3, s[8:11], 0 offen offset:2048 sc1 lds
v_mfma_f32_16x16x32_bf16 v[92:95], v[68:71], a[92:95], v[92:95]
v_fma_f32 v208, v208, v241, v240
s_waitcnt lgkmcnt(4)
v_mfma_f32_16x16x32_bf16 v[96:99], v[72:75], a[64:67], v[96:99]
v_rcp_f32 v212, v212
v_mfma_f32_16x16x32_bf16 v[96:99], v[76:79], a[80:83], v[96:99]
v_rcp_f32 v214, v214
v_mfma_f32_16x16x32_bf16 v[100:103], v[72:75], a[68:71], v[100:103]
ds_read_b128 v[64:67], v7 offset:12288
v_mul_f32 v213, v213, v212
v_mfma_f32_16x16x32_bf16 v[100:103], v[76:79], a[84:87], v[100:103]
buffer_load_dwordx4 v3, s[8:11], 0 offen offset:3072 sc1 lds
v_mfma_f32_16x16x32_bf16 v[104:107], v[72:75], a[72:75], v[104:107]
s_add_u32 m0, s22, 28672
v_add_u32 v3, 4096, v3
v_mfma_f32_16x16x32_bf16 v[104:107], v[76:79], a[88:91], v[104:107]
ds_read_b128 v[68:71], v7 offset:13312
v_mul_f32 v215, v215, v214
v_mfma_f32_16x16x32_bf16 v[108:111], v[72:75], a[76:79], v[108:111]
v_cvt_pk_bf16_f32 v149, v213, v215
v_fma_f32 v210, v210, v241, v240
v_mfma_f32_16x16x32_bf16 v[108:111], v[76:79], a[92:95], v[108:111]
v_mul_f32 v208, v208, v120
s_waitcnt lgkmcnt(4)
v_mfma_f32_16x16x32_bf16 v[80:83], v[48:51], a[96:99], v[80:83]
buffer_load_dwordx4 v3, s[8:11], 0 offen offset:0 sc1 lds
v_mfma_f32_16x16x32_bf16 v[80:83], v[52:55], a[112:115], v[80:83]
v_mul_f32 v210, v210, v121
v_mul_f32 v209, v120, v136
v_mfma_f32_16x16x32_bf16 v[84:87], v[48:51], a[100:103], v[84:87]
ds_read_b128 v[72:75], v7 offset:14336
v_mul_f32 v211, v121, v137
v_mfma_f32_16x16x32_bf16 v[84:87], v[52:55], a[116:119], v[84:87]
v_exp_f32 v208, v208
v_mfma_f32_16x16x32_bf16 v[88:91], v[48:51], a[104:107], v[88:91]
v_exp_f32 v210, v210
v_mfma_f32_16x16x32_bf16 v[88:91], v[52:55], a[120:123], v[88:91]
ds_read_b128 v[76:79], v7 offset:15360
v_fma_f32 v208, v208, v242, v242
v_mfma_f32_16x16x32_bf16 v[92:95], v[48:51], a[108:111], v[92:95]
buffer_load_dwordx4 v3, s[8:11], 0 offen offset:1024 sc1 lds
v_mfma_f32_16x16x32_bf16 v[92:95], v[52:55], a[124:127], v[92:95]
v_fma_f32 v210, v210, v242, v242
s_waitcnt lgkmcnt(4)
v_mfma_f32_16x16x32_bf16 v[96:99], v[56:59], a[96:99], v[96:99]
v_rcp_f32 v208, v208
v_mfma_f32_16x16x32_bf16 v[96:99], v[60:63], a[112:115], v[96:99]
v_rcp_f32 v210, v210
v_mfma_f32_16x16x32_bf16 v[100:103], v[56:59], a[100:103], v[100:103]
ds_read_b128 v[48:51], v7 offset:16384
v_mul_f32 v209, v209, v208
v_mfma_f32_16x16x32_bf16 v[100:103], v[60:63], a[116:119], v[100:103]
v_mul_f32 v211, v211, v210
v_cvt_pk_bf16_f32 v152, v209, v211
v_mfma_f32_16x16x32_bf16 v[104:107], v[56:59], a[104:107], v[104:107]
v_mul_f32 v212, v122, v122
v_mul_f32 v214, v123, v123
v_mfma_f32_16x16x32_bf16 v[104:107], v[60:63], a[120:123], v[104:107]
ds_read_b128 v[52:55], v7 offset:17408
v_fma_f32 v212, v212, v241, v240
v_mfma_f32_16x16x32_bf16 v[108:111], v[56:59], a[108:111], v[108:111]
v_fma_f32 v214, v214, v241, v240
v_mul_f32 v212, v212, v122
v_mfma_f32_16x16x32_bf16 v[108:111], v[60:63], a[124:127], v[108:111]
v_mul_f32 v214, v214, v123
s_waitcnt lgkmcnt(4)
v_mfma_f32_16x16x32_bf16 v[80:83], v[64:67], a[128:131], v[80:83]
v_exp_f32 v212, v212
v_mfma_f32_16x16x32_bf16 v[80:83], v[68:71], a[144:147], v[80:83]
v_exp_f32 v214, v214
v_mfma_f32_16x16x32_bf16 v[84:87], v[64:67], a[132:135], v[84:87]
ds_read_b128 v[56:59], v7 offset:18432
v_mul_f32 v213, v122, v138
v_mfma_f32_16x16x32_bf16 v[84:87], v[68:71], a[148:151], v[84:87]
v_mul_f32 v215, v123, v139
v_fma_f32 v212, v212, v242, v242
v_mfma_f32_16x16x32_bf16 v[88:91], v[64:67], a[136:139], v[88:91]
v_fma_f32 v214, v214, v242, v242
v_mul_f32 v208, v124, v124
v_mfma_f32_16x16x32_bf16 v[88:91], v[68:71], a[152:155], v[88:91]
ds_read_b128 v[60:63], v7 offset:19456
v_mul_f32 v210, v125, v125
v_mfma_f32_16x16x32_bf16 v[92:95], v[64:67], a[140:143], v[92:95]
v_rcp_f32 v212, v212
v_mfma_f32_16x16x32_bf16 v[92:95], v[68:71], a[156:159], v[92:95]
v_mul_f32 v213, v213, v212
s_waitcnt lgkmcnt(4)
v_mfma_f32_16x16x32_bf16 v[96:99], v[72:75], a[128:131], v[96:99]
v_rcp_f32 v214, v214
v_mfma_f32_16x16x32_bf16 v[96:99], v[76:79], a[144:147], v[96:99]
v_mul_f32 v215, v215, v214
v_cvt_pk_bf16_f32 v153, v213, v215
v_mfma_f32_16x16x32_bf16 v[100:103], v[72:75], a[132:135], v[100:103]
ds_read_b128 v[64:67], v7 offset:20480
v_fma_f32 v208, v208, v245, v244
v_mfma_f32_16x16x32_bf16 v[100:103], v[76:79], a[148:151], v[100:103]
v_fma_f32 v210, v210, v245, v244
v_mul_f32 v208, v208, v124
v_mfma_f32_16x16x32_bf16 v[104:107], v[72:75], a[136:139], v[104:107]
v_mul_f32 v210, v210, v125
v_mul_f32 v209, v124, v140
v_mfma_f32_16x16x32_bf16 v[104:107], v[76:79], a[152:155], v[104:107]
ds_read_b128 v[68:71], v7 offset:21504
v_mul_f32 v211, v125, v141
v_mfma_f32_16x16x32_bf16 v[108:111], v[72:75], a[140:143], v[108:111]
v_exp_f32 v208, v208
v_mfma_f32_16x16x32_bf16 v[108:111], v[76:79], a[156:159], v[108:111]
v_fma_f32 v208, v208, v246, v246
s_waitcnt lgkmcnt(4)
v_mfma_f32_16x16x32_bf16 v[80:83], v[48:51], a[160:163], v[80:83]
v_exp_f32 v210, v210
v_mfma_f32_16x16x32_bf16 v[80:83], v[52:55], a[176:179], v[80:83]
v_fma_f32 v210, v210, v246, v246
v_mul_f32 v212, v126, v126
v_mfma_f32_16x16x32_bf16 v[84:87], v[48:51], a[164:167], v[84:87]
ds_read_b128 v[72:75], v7 offset:22528
v_mul_f32 v214, v127, v127
v_mfma_f32_16x16x32_bf16 v[84:87], v[52:55], a[180:183], v[84:87]
v_rcp_f32 v208, v208
v_mfma_f32_16x16x32_bf16 v[88:91], v[48:51], a[168:171], v[88:91]
v_rcp_f32 v210, v210
v_mfma_f32_16x16x32_bf16 v[88:91], v[52:55], a[184:187], v[88:91]
ds_read_b128 v[76:79], v7 offset:23552
v_mul_f32 v209, v209, v208
v_mfma_f32_16x16x32_bf16 v[92:95], v[48:51], a[172:175], v[92:95]
v_mul_f32 v211, v211, v210
v_cvt_pk_bf16_f32 v156, v209, v211
v_mfma_f32_16x16x32_bf16 v[92:95], v[52:55], a[188:191], v[92:95]
v_fma_f32 v212, v212, v245, v244
s_waitcnt lgkmcnt(4)
v_mfma_f32_16x16x32_bf16 v[96:99], v[56:59], a[160:163], v[96:99]
v_fma_f32 v214, v214, v245, v244
v_mul_f32 v212, v212, v126
v_mfma_f32_16x16x32_bf16 v[96:99], v[60:63], a[176:179], v[96:99]
v_mul_f32 v214, v214, v127
v_mul_f32 v213, v126, v142
v_mfma_f32_16x16x32_bf16 v[100:103], v[56:59], a[164:167], v[100:103]
ds_read_b128 v[48:51], v7 offset:24576
v_mul_f32 v215, v127, v143
v_mfma_f32_16x16x32_bf16 v[100:103], v[60:63], a[180:183], v[100:103]
v_exp_f32 v212, v212
v_mfma_f32_16x16x32_bf16 v[104:107], v[56:59], a[168:171], v[104:107]
v_exp_f32 v214, v214
v_mfma_f32_16x16x32_bf16 v[104:107], v[60:63], a[184:187], v[104:107]
ds_read_b128 v[52:55], v7 offset:25600
v_fma_f32 v212, v212, v246, v246
v_mfma_f32_16x16x32_bf16 v[108:111], v[56:59], a[172:175], v[108:111]
v_fma_f32 v214, v214, v246, v246
v_mul_f32 v216, v176, v176
v_mfma_f32_16x16x32_bf16 v[108:111], v[60:63], a[188:191], v[108:111]
v_mul_f32 v218, v177, v177
s_waitcnt lgkmcnt(4)
v_mfma_f32_16x16x32_bf16 v[80:83], v[64:67], a[192:195], v[80:83]
v_rcp_f32 v212, v212
v_mfma_f32_16x16x32_bf16 v[80:83], v[68:71], a[208:211], v[80:83]
v_rcp_f32 v214, v214
v_mfma_f32_16x16x32_bf16 v[84:87], v[64:67], a[196:199], v[84:87]
ds_read_b128 v[56:59], v7 offset:26624
v_mul_f32 v213, v213, v212
v_mfma_f32_16x16x32_bf16 v[84:87], v[68:71], a[212:215], v[84:87]
v_mul_f32 v215, v215, v214
v_cvt_pk_bf16_f32 v157, v213, v215
v_mfma_f32_16x16x32_bf16 v[88:91], v[64:67], a[200:203], v[88:91]
v_fma_f32 v216, v216, v233, v232
v_fma_f32 v218, v218, v233, v232
v_mfma_f32_16x16x32_bf16 v[88:91], v[68:71], a[216:219], v[88:91]
ds_read_b128 v[60:63], v7 offset:27648
v_mul_f32 v216, v216, v176
v_mfma_f32_16x16x32_bf16 v[92:95], v[64:67], a[204:207], v[92:95]
v_mul_f32 v218, v218, v177
v_mul_f32 v217, v176, v192
v_mfma_f32_16x16x32_bf16 v[92:95], v[68:71], a[220:223], v[92:95]
v_mul_f32 v219, v177, v193
s_waitcnt lgkmcnt(4)
v_mfma_f32_16x16x32_bf16 v[96:99], v[72:75], a[192:195], v[96:99]
v_exp_f32 v216, v216
v_mfma_f32_16x16x32_bf16 v[96:99], v[76:79], a[208:211], v[96:99]
v_exp_f32 v218, v218
v_mfma_f32_16x16x32_bf16 v[100:103], v[72:75], a[196:199], v[100:103]
ds_read_b128 v[64:67], v7 offset:28672
v_fma_f32 v216, v216, v234, v234
v_mfma_f32_16x16x32_bf16 v[100:103], v[76:79], a[212:215], v[100:103]
v_fma_f32 v218, v218, v234, v234
v_mul_f32 v220, v178, v178
v_mfma_f32_16x16x32_bf16 v[104:107], v[72:75], a[200:203], v[104:107]
v_rcp_f32 v216, v216
v_mfma_f32_16x16x32_bf16 v[104:107], v[76:79], a[216:219], v[104:107]
ds_read_b128 v[68:71], v7 offset:29696
v_mul_f32 v217, v217, v216
v_mfma_f32_16x16x32_bf16 v[108:111], v[72:75], a[204:207], v[108:111]
v_rcp_f32 v218, v218
v_mfma_f32_16x16x32_bf16 v[108:111], v[76:79], a[220:223], v[108:111]
v_mul_f32 v219, v219, v218
s_waitcnt lgkmcnt(4)
v_mfma_f32_16x16x32_bf16 v[80:83], v[48:51], a[224:227], v[80:83]
v_cvt_pk_bf16_f32 v146, v217, v219
v_mul_f32 v222, v179, v179
v_mfma_f32_16x16x32_bf16 v[80:83], v[52:55], a[240:243], v[80:83]
v_fma_f32 v220, v220, v233, v232
v_fma_f32 v222, v222, v233, v232
v_mfma_f32_16x16x32_bf16 v[84:87], v[48:51], a[228:231], v[84:87]
ds_read_b128 v[72:75], v7 offset:30720
v_mul_f32 v220, v220, v178
v_mfma_f32_16x16x32_bf16 v[84:87], v[52:55], a[244:247], v[84:87]
v_mul_f32 v222, v222, v179
v_mul_f32 v221, v178, v194
v_mfma_f32_16x16x32_bf16 v[88:91], v[48:51], a[232:235], v[88:91]
v_exp_f32 v220, v220
v_mfma_f32_16x16x32_bf16 v[88:91], v[52:55], a[248:251], v[88:91]
ds_read_b128 v[76:79], v7 offset:31744
v_mul_f32 v223, v179, v195
v_mfma_f32_16x16x32_bf16 v[92:95], v[48:51], a[236:239], v[92:95]
v_exp_f32 v222, v222
v_mfma_f32_16x16x32_bf16 v[92:95], v[52:55], a[252:255], v[92:95]
v_fma_f32 v220, v220, v234, v234
s_waitcnt lgkmcnt(4)
v_mfma_f32_16x16x32_bf16 v[96:99], v[56:59], a[224:227], v[96:99]
s_waitcnt vmcnt(22)
v_fma_f32 v222, v222, v234, v234
v_mfma_f32_16x16x32_bf16 v[96:99], v[60:63], a[240:243], v[96:99]
s_barrier
v_mfma_f32_16x16x32_bf16 v[100:103], v[56:59], a[228:231], v[100:103]
ds_read_b128 v[48:51], v7 offset:32768
s_add_u32 m0, s22, 49152
v_mfma_f32_16x16x32_bf16 v[100:103], v[60:63], a[244:247], v[100:103]
v_add_u32 v3, 20480, v3
buffer_load_dwordx4 v3, s[8:11], 0 offen offset:0 sc1 lds
v_mfma_f32_16x16x32_bf16 v[104:107], v[56:59], a[232:235], v[104:107]
v_rcp_f32 v220, v220
v_mfma_f32_16x16x32_bf16 v[104:107], v[60:63], a[248:251], v[104:107]
ds_read_b128 v[52:55], v7 offset:33792
v_mul_f32 v221, v221, v220
v_mfma_f32_16x16x32_bf16 v[108:111], v[56:59], a[236:239], v[108:111]
v_rcp_f32 v222, v222
v_mfma_f32_16x16x32_bf16 v[108:111], v[60:63], a[252:255], v[108:111]
v_mul_f32 v223, v223, v222
s_waitcnt lgkmcnt(4)
v_mfma_f32_16x16x32_bf16 v[80:83], v[64:67], v[16:19], v[80:83]
buffer_load_dwordx4 v3, s[8:11], 0 offen offset:1024 sc1 lds
v_mfma_f32_16x16x32_bf16 v[80:83], v[68:71], v[32:35], v[80:83]
v_cvt_pk_bf16_f32 v147, v221, v223
v_mul_f32 v216, v180, v180
v_mfma_f32_16x16x32_bf16 v[84:87], v[64:67], v[20:23], v[84:87]
ds_read_b128 v[56:59], v7 offset:34816
v_mul_f32 v218, v181, v181
v_mfma_f32_16x16x32_bf16 v[84:87], v[68:71], v[36:39], v[84:87]
buffer_store_dwordx4 v[144:147], v2, s[8:11], s24 offen offset:0 sc1
v_mfma_f32_16x16x32_bf16 v[88:91], v[64:67], v[24:27], v[88:91]
v_fma_f32 v216, v216, v237, v236
v_fma_f32 v218, v218, v237, v236
v_mfma_f32_16x16x32_bf16 v[88:91], v[68:71], v[40:43], v[88:91]
ds_read_b128 v[60:63], v7 offset:35840
v_mul_f32 v216, v216, v180
v_mfma_f32_16x16x32_bf16 v[92:95], v[64:67], v[28:31], v[92:95]
v_mul_f32 v218, v218, v181
v_mul_f32 v217, v180, v196
v_mfma_f32_16x16x32_bf16 v[92:95], v[68:71], v[44:47], v[92:95]
v_mul_f32 v219, v181, v197
s_waitcnt lgkmcnt(4)
v_mfma_f32_16x16x32_bf16 v[96:99], v[72:75], v[16:19], v[96:99]
buffer_load_dwordx4 v3, s[8:11], 0 offen offset:2048 sc1 lds
v_mfma_f32_16x16x32_bf16 v[96:99], v[76:79], v[32:35], v[96:99]
v_exp_f32 v216, v216
v_mfma_f32_16x16x32_bf16 v[100:103], v[72:75], v[20:23], v[100:103]
ds_read_b128 v[64:67], v7 offset:36864
v_fma_f32 v216, v216, v238, v238
v_mfma_f32_16x16x32_bf16 v[100:103], v[76:79], v[36:39], v[100:103]
v_exp_f32 v218, v218
v_mfma_f32_16x16x32_bf16 v[104:107], v[72:75], v[24:27], v[104:107]
v_fma_f32 v218, v218, v238, v238
v_mul_f32 v220, v182, v182
v_mfma_f32_16x16x32_bf16 v[104:107], v[76:79], v[40:43], v[104:107]
ds_read_b128 v[68:71], v7 offset:37888
v_mul_f32 v222, v183, v183
v_mfma_f32_16x16x32_bf16 v[108:111], v[72:75], v[28:31], v[108:111]
buffer_load_dwordx4 v3, s[8:11], 0 offen offset:3072 sc1 lds
v_mfma_f32_16x16x32_bf16 v[108:111], v[76:79], v[44:47], v[108:111]
s_add_u32 m0, s22, 53248
s_waitcnt lgkmcnt(4)
v_mfma_f32_16x16x32_bf16 v[112:115], v[48:51], a[0:3], 0
v_add_u32 v3, 4096, v3
v_fma_f32 v220, v220, v237, v236
v_mfma_f32_16x16x32_bf16 v[112:115], v[52:55], a[16:19], v[112:115]
v_rcp_f32 v216, v216
v_mfma_f32_16x16x32_bf16 v[116:119], v[48:51], a[4:7], 0
ds_read_b128 v[72:75], v7 offset:38912
v_mul_f32 v217, v217, v216
v_mfma_f32_16x16x32_bf16 v[116:119], v[52:55], a[20:23], v[116:119]
buffer_load_dwordx4 v3, s[8:11], 0 offen offset:0 sc1 lds
v_mfma_f32_16x16x32_bf16 v[120:123], v[48:51], a[8:11], 0
v_mul_f32 v208, v80, v80
v_mul_f32 v210, v81, v81
v_mfma_f32_16x16x32_bf16 v[120:123], v[52:55], a[24:27], v[120:123]
ds_read_b128 v[76:79], v7 offset:39936
v_fma_f32 v208, v208, v233, v232
v_mfma_f32_16x16x32_bf16 v[124:127], v[48:51], a[12:15], 0
v_fma_f32 v210, v210, v233, v232
v_mul_f32 v208, v208, v80
v_mfma_f32_16x16x32_bf16 v[124:127], v[52:55], a[28:31], v[124:127]
v_mul_f32 v210, v210, v81
s_waitcnt lgkmcnt(4)
v_mfma_f32_16x16x32_bf16 v[128:131], v[56:59], a[0:3], 0
buffer_load_dwordx4 v3, s[8:11], 0 offen offset:1024 sc1 lds
v_mfma_f32_16x16x32_bf16 v[128:131], v[60:63], a[16:19], v[128:131]
v_exp_f32 v208, v208
v_mfma_f32_16x16x32_bf16 v[132:135], v[56:59], a[4:7], 0
ds_read_b128 v[48:51], v7 offset:40960
v_mul_f32 v209, v80, v96
v_mfma_f32_16x16x32_bf16 v[132:135], v[60:63], a[20:23], v[132:135]
v_exp_f32 v210, v210
v_mfma_f32_16x16x32_bf16 v[136:139], v[56:59], a[8:11], 0
v_mul_f32 v211, v81, v97
v_fma_f32 v208, v208, v234, v234
v_mfma_f32_16x16x32_bf16 v[136:139], v[60:63], a[24:27], v[136:139]
ds_read_b128 v[52:55], v7 offset:41984
v_fma_f32 v210, v210, v234, v234
v_mfma_f32_16x16x32_bf16 v[140:143], v[56:59], a[12:15], 0
v_rcp_f32 v208, v208
v_mfma_f32_16x16x32_bf16 v[140:143], v[60:63], a[28:31], v[140:143]
v_mul_f32 v209, v209, v208
s_waitcnt lgkmcnt(4)
v_mfma_f32_16x16x32_bf16 v[112:115], v[64:67], a[32:35], v[112:115]
v_rcp_f32 v210, v210
v_mfma_f32_16x16x32_bf16 v[112:115], v[68:71], a[48:51], v[112:115]
v_mul_f32 v211, v211, v210
v_cvt_pk_bf16_f32 v160, v209, v211
v_mfma_f32_16x16x32_bf16 v[116:119], v[64:67], a[36:39], v[116:119]
ds_read_b128 v[56:59], v7 offset:43008
v_mul_f32 v212, v82, v82
v_mfma_f32_16x16x32_bf16 v[116:119], v[68:71], a[52:55], v[116:119]
v_mul_f32 v214, v83, v83
v_fma_f32 v212, v212, v233, v232
v_mfma_f32_16x16x32_bf16 v[120:123], v[64:67], a[40:43], v[120:123]
v_fma_f32 v214, v214, v233, v232
v_mul_f32 v212, v212, v82
v_mfma_f32_16x16x32_bf16 v[120:123], v[68:71], a[56:59], v[120:123]
ds_read_b128 v[60:63], v7 offset:44032
v_mul_f32 v214, v214, v83
v_mfma_f32_16x16x32_bf16 v[124:127], v[64:67], a[44:47], v[124:127]
v_exp_f32 v212, v212
v_mfma_f32_16x16x32_bf16 v[124:127], v[68:71], a[60:63], v[124:127]
v_mul_f32 v213, v82, v98
s_waitcnt lgkmcnt(4)
v_mfma_f32_16x16x32_bf16 v[128:131], v[72:75], a[32:35], v[128:131]
v_exp_f32 v214, v214
v_mfma_f32_16x16x32_bf16 v[128:131], v[76:79], a[48:51], v[128:131]
v_mul_f32 v215, v83, v99
v_fma_f32 v212, v212, v234, v234
v_mfma_f32_16x16x32_bf16 v[132:135], v[72:75], a[36:39], v[132:135]
ds_read_b128 v[64:67], v7 offset:45056
v_fma_f32 v214, v214, v234, v234
v_mfma_f32_16x16x32_bf16 v[132:135], v[76:79], a[52:55], v[132:135]
v_rcp_f32 v212, v212
v_mfma_f32_16x16x32_bf16 v[136:139], v[72:75], a[40:43], v[136:139]
v_rcp_f32 v214, v214
v_mfma_f32_16x16x32_bf16 v[136:139], v[76:79], a[56:59], v[136:139]
ds_read_b128 v[68:71], v7 offset:46080
v_mul_f32 v213, v213, v212
v_mfma_f32_16x16x32_bf16 v[140:143], v[72:75], a[44:47], v[140:143]
v_mul_f32 v215, v215, v214
v_cvt_pk_bf16_f32 v161, v213, v215
v_mfma_f32_16x16x32_bf16 v[140:143], v[76:79], a[60:63], v[140:143]
v_mul_f32 v208, v84, v84
s_waitcnt lgkmcnt(4)
v_mfma_f32_16x16x32_bf16 v[112:115], v[48:51], a[64:67], v[112:115]
v_mul_f32 v210, v85, v85
v_fma_f32 v208, v208, v237, v236
v_mfma_f32_16x16x32_bf16 v[112:115], v[52:55], a[80:83], v[112:115]
v_fma_f32 v210, v210, v237, v236
v_mul_f32 v208, v208, v84
v_mfma_f32_16x16x32_bf16 v[116:119], v[48:51], a[68:71], v[116:119]
ds_read_b128 v[72:75], v7 offset:47104
v_mul_f32 v210, v210, v85
v_mfma_f32_16x16x32_bf16 v[116:119], v[52:55], a[84:87], v[116:119]
v_exp_f32 v208, v208
v_mfma_f32_16x16x32_bf16 v[120:123], v[48:51], a[72:75], v[120:123]
v_exp_f32 v210, v210
v_mfma_f32_16x16x32_bf16 v[120:123], v[52:55], a[88:91], v[120:123]
ds_read_b128 v[76:79], v7 offset:48128
v_mul_f32 v209, v84, v100
v_mfma_f32_16x16x32_bf16 v[124:127], v[48:51], a[76:79], v[124:127]
v_mul_f32 v211, v85, v101
v_fma_f32 v208, v208, v238, v238
v_mfma_f32_16x16x32_bf16 v[124:127], v[52:55], a[92:95], v[124:127]
v_fma_f32 v210, v210, v238, v238
s_waitcnt lgkmcnt(4)
v_mfma_f32_16x16x32_bf16 v[128:131], v[56:59], a[64:67], v[128:131]
v_rcp_f32 v208, v208
v_mfma_f32_16x16x32_bf16 v[128:131], v[60:63], a[80:83], v[128:131]
v_rcp_f32 v210, v210
v_mfma_f32_16x16x32_bf16 v[132:135], v[56:59], a[68:71], v[132:135]
ds_read_b128 v[48:51], v7 offset:49152
v_mul_f32 v209, v209, v208
v_mfma_f32_16x16x32_bf16 v[132:135], v[60:63], a[84:87], v[132:135]
v_mul_f32 v211, v211, v210
v_cvt_pk_bf16_f32 v164, v209, v211
v_mfma_f32_16x16x32_bf16 v[136:139], v[56:59], a[72:75], v[136:139]
v_mul_f32 v212, v86, v86
v_mul_f32 v214, v87, v87
v_mfma_f32_16x16x32_bf16 v[136:139], v[60:63], a[88:91], v[136:139]
ds_read_b128 v[52:55], v7 offset:50176
v_fma_f32 v212, v212, v237, v236
v_mfma_f32_16x16x32_bf16 v[140:143], v[56:59], a[76:79], v[140:143]
v_fma_f32 v214, v214, v237, v236
v_mul_f32 v212, v212, v86
v_mfma_f32_16x16x32_bf16 v[140:143], v[60:63], a[92:95], v[140:143]
L_hop5:
s_cmp_eq_u32 s15, 1
s_cbranch_scc1 L_hop9
v_mul_f32 v214, v214, v87
s_waitcnt lgkmcnt(4)
v_mfma_f32_16x16x32_bf16 v[112:115], v[64:67], a[96:99], v[112:115]
v_exp_f32 v212, v212
v_mfma_f32_16x16x32_bf16 v[112:115], v[68:71], a[112:115], v[112:115]
v_exp_f32 v214, v214
v_mfma_f32_16x16x32_bf16 v[116:119], v[64:67], a[100:103], v[116:119]
ds_read_b128 v[56:59], v7 offset:51200
v_mul_f32 v213, v86, v102
v_mfma_f32_16x16x32_bf16 v[116:119], v[68:71], a[116:119], v[116:119]
v_mul_f32 v215, v87, v103
v_fma_f32 v212, v212, v238, v238
v_mfma_f32_16x16x32_bf16 v[120:123], v[64:67], a[104:107], v[120:123]
v_fma_f32 v214, v214, v238, v238
v_mul_f32 v208, v88, v88
v_mfma_f32_16x16x32_bf16 v[120:123], v[68:71], a[120:123], v[120:123]
ds_read_b128 v[60:63], v7 offset:52224
v_mul_f32 v210, v89, v89
v_mfma_f32_16x16x32_bf16 v[124:127], v[64:67], a[108:111], v[124:127]
v_rcp_f32 v212, v212
v_mfma_f32_16x16x32_bf16 v[124:127], v[68:71], a[124:127], v[124:127]
v_mul_f32 v213, v213, v212
s_waitcnt lgkmcnt(4)
v_mfma_f32_16x16x32_bf16 v[128:131], v[72:75], a[96:99], v[128:131]
v_rcp_f32 v214, v214
v_mfma_f32_16x16x32_bf16 v[128:131], v[76:79], a[112:115], v[128:131]
v_mul_f32 v215, v215, v214
v_cvt_pk_bf16_f32 v165, v213, v215
v_mfma_f32_16x16x32_bf16 v[132:135], v[72:75], a[100:103], v[132:135]
ds_read_b128 v[64:67], v7 offset:53248
v_fma_f32 v208, v208, v241, v240
v_mfma_f32_16x16x32_bf16 v[132:135], v[76:79], a[116:119], v[132:135]
v_fma_f32 v210, v210, v241, v240
v_mul_f32 v208, v208, v88
v_mfma_f32_16x16x32_bf16 v[136:139], v[72:75], a[104:107], v[136:139]
v_mul_f32 v210, v210, v89
v_mul_f32 v209, v88, v104
v_mfma_f32_16x16x32_bf16 v[136:139], v[76:79], a[120:123], v[136:139]
ds_read_b128 v[68:71], v7 offset:54272
v_mul_f32 v211, v89, v105
v_mfma_f32_16x16x32_bf16 v[140:143], v[72:75], a[108:111], v[140:143]
v_exp_f32 v208, v208
v_mfma_f32_16x16x32_bf16 v[140:143], v[76:79], a[124:127], v[140:143]
v_fma_f32 v208, v208, v242, v242
s_waitcnt lgkmcnt(4)
v_mfma_f32_16x16x32_bf16 v[112:115], v[48:51], a[128:131], v[112:115]
v_exp_f32 v210, v210
v_mfma_f32_16x16x32_bf16 v[112:115], v[52:55], a[144:147], v[112:115]
v_fma_f32 v210, v210, v242, v242
v_mul_f32 v212, v90, v90
v_mfma_f32_16x16x32_bf16 v[116:119], v[48:51], a[132:135], v[116:119]
ds_read_b128 v[72:75], v7 offset:55296
v_mul_f32 v214, v91, v91
v_mfma_f32_16x16x32_bf16 v[116:119], v[52:55], a[148:151], v[116:119]
v_rcp_f32 v208, v208
v_mfma_f32_16x16x32_bf16 v[120:123], v[48:51], a[136:139], v[120:123]
v_rcp_f32 v210, v210
v_mfma_f32_16x16x32_bf16 v[120:123], v[52:55], a[152:155], v[120:123]
ds_read_b128 v[76:79], v7 offset:56320
v_mul_f32 v209, v209, v208
v_mfma_f32_16x16x32_bf16 v[124:127], v[48:51], a[140:143], v[124:127]
v_mul_f32 v211, v211, v210
v_cvt_pk_bf16_f32 v168, v209, v211
v_mfma_f32_16x16x32_bf16 v[124:127], v[52:55], a[156:159], v[124:127]
v_fma_f32 v212, v212, v241, v240
s_waitcnt lgkmcnt(4)
v_mfma_f32_16x16x32_bf16 v[128:131], v[56:59], a[128:131], v[128:131]
s_waitcnt vmcnt(23)
v_fma_f32 v214, v214, v241, v240
v_mfma_f32_16x16x32_bf16 v[128:131], v[60:63], a[144:147], v[128:131]
s_barrier
v_mfma_f32_16x16x32_bf16 v[132:135], v[56:59], a[132:135], v[132:135]
ds_read_b128 v[48:51], v7 offset:57344
s_add_u32 m0, s22, 73728
v_mfma_f32_16x16x32_bf16 v[132:135], v[60:63], a[148:151], v[132:135]
v_add_u32 v3, 20480, v3
buffer_load_dwordx4 v3, s[8:11], 0 offen offset:0 sc1 lds
v_mfma_f32_16x16x32_bf16 v[136:139], v[56:59], a[136:139], v[136:139]
v_mul_f32 v212, v212, v90
v_mul_f32 v214, v214, v91
v_mfma_f32_16x16x32_bf16 v[136:139], v[60:63], a[152:155], v[136:139]
ds_read_b128 v[52:55], v7 offset:58368
v_mul_f32 v213, v90, v106
v_mfma_f32_16x16x32_bf16 v[140:143], v[56:59], a[140:143], v[140:143]
v_exp_f32 v212, v212
v_mfma_f32_16x16x32_bf16 v[140:143], v[60:63], a[156:159], v[140:143]
v_mul_f32 v215, v91, v107
s_waitcnt lgkmcnt(4)
v_mfma_f32_16x16x32_bf16 v[112:115], v[64:67], a[160:163], v[112:115]
buffer_load_dwordx4 v3, s[8:11], 0 offen offset:1024 sc1 lds
v_mfma_f32_16x16x32_bf16 v[112:115], v[68:71], a[176:179], v[112:115]
v_exp_f32 v214, v214
v_mfma_f32_16x16x32_bf16 v[116:119], v[64:67], a[164:167], v[116:119]
ds_read_b128 v[56:59], v7 offset:59392
v_fma_f32 v212, v212, v242, v242
v_mfma_f32_16x16x32_bf16 v[116:119], v[68:71], a[180:183], v[116:119]
v_fma_f32 v214, v214, v242, v242
v_mul_f32 v208, v92, v92
v_mfma_f32_16x16x32_bf16 v[120:123], v[64:67], a[168:171], v[120:123]
v_rcp_f32 v212, v212
v_mfma_f32_16x16x32_bf16 v[120:123], v[68:71], a[184:187], v[120:123]
ds_read_b128 v[60:63], v7 offset:60416
v_mul_f32 v213, v213, v212
v_mfma_f32_16x16x32_bf16 v[124:127], v[64:67], a[172:175], v[124:127]
buffer_load_dwordx4 v3, s[8:11], 0 offen offset:2048 sc1 lds
v_mfma_f32_16x16x32_bf16 v[124:127], v[68:71], a[188:191], v[124:127]
v_mul_f32 v210, v93, v93
s_waitcnt lgkmcnt(4)
v_mfma_f32_16x16x32_bf16 v[128:131], v[72:75], a[160:163], v[128:131]
v_rcp_f32 v214, v214
v_mfma_f32_16x16x32_bf16 v[128:131], v[76:79], a[176:179], v[128:131]
v_mul_f32 v215, v215, v214
v_cvt_pk_bf16_f32 v169, v213, v215
v_mfma_f32_16x16x32_bf16 v[132:135], v[72:75], a[164:167], v[132:135]
ds_read_b128 v[64:67], v7 offset:61440
v_fma_f32 v208, v208, v245, v244
v_mfma_f32_16x16x32_bf16 v[132:135], v[76:79], a[180:183], v[132:135]
buffer_load_dwordx4 v3, s[8:11], 0 offen offset:3072 sc1 lds
v_mfma_f32_16x16x32_bf16 v[136:139], v[72:75], a[168:171], v[136:139]
s_add_u32 m0, s22, 77824
v_add_u32 v3, 4096, v3
v_mfma_f32_16x16x32_bf16 v[136:139], v[76:79], a[184:187], v[136:139]
ds_read_b128 v[68:71], v7 offset:62464
v_fma_f32 v210, v210, v245, v244
v_mfma_f32_16x16x32_bf16 v[140:143], v[72:75], a[172:175], v[140:143]
v_mul_f32 v208, v208, v92
v_mul_f32 v210, v210, v93
v_mfma_f32_16x16x32_bf16 v[140:143], v[76:79], a[188:191], v[140:143]
v_mul_f32 v209, v92, v108
s_waitcnt lgkmcnt(4)
v_mfma_f32_16x16x32_bf16 v[112:115], v[48:51], a[192:195], v[112:115]
buffer_load_dwordx4 v3, s[8:11], 0 offen offset:0 sc1 lds
v_mfma_f32_16x16x32_bf16 v[112:115], v[52:55], a[208:211], v[112:115]
v_exp_f32 v208, v208
v_mfma_f32_16x16x32_bf16 v[116:119], v[48:51], a[196:199], v[116:119]
ds_read_b128 v[72:75], v7 offset:63488
v_mul_f32 v211, v93, v109
v_mfma_f32_16x16x32_bf16 v[116:119], v[52:55], a[212:215], v[116:119]
v_exp_f32 v210, v210
v_mfma_f32_16x16x32_bf16 v[120:123], v[48:51], a[200:203], v[120:123]
v_fma_f32 v208, v208, v246, v246
v_fma_f32 v210, v210, v246, v246
v_mfma_f32_16x16x32_bf16 v[120:123], v[52:55], a[216:219], v[120:123]
ds_read_b128 v[76:79], v7 offset:64512
v_mul_f32 v212, v94, v94
v_mfma_f32_16x16x32_bf16 v[124:127], v[48:51], a[204:207], v[124:127]
buffer_load_dwordx4 v3, s[8:11], 0 offen offset:1024 sc1 lds
v_mfma_f32_16x16x32_bf16 v[124:127], v[52:55], a[220:223], v[124:127]
v_mul_f32 v214, v95, v95
s_waitcnt lgkmcnt(4)
v_mfma_f32_16x16x32_bf16 v[128:131], v[56:59], a[192:195], v[128:131]
v_rcp_f32 v208, v208
v_mfma_f32_16x16x32_bf16 v[128:131], v[60:63], a[208:211], v[128:131]
v_rcp_f32 v210, v210
v_mfma_f32_16x16x32_bf16 v[132:135], v[56:59], a[196:199], v[132:135]
ds_read_b128 v[48:51], v8 offset:0
v_mul_f32 v209, v209, v208
v_mfma_f32_16x16x32_bf16 v[132:135], v[60:63], a[212:215], v[132:135]
v_mul_f32 v211, v211, v210
v_cvt_pk_bf16_f32 v172, v209, v211
v_mfma_f32_16x16x32_bf16 v[136:139], v[56:59], a[200:203], v[136:139]
v_fma_f32 v212, v212, v245, v244
v_fma_f32 v214, v214, v245, v244
v_mfma_f32_16x16x32_bf16 v[136:139], v[60:63], a[216:219], v[136:139]
ds_read_b128 v[52:55], v8 offset:1024
v_mul_f32 v212, v212, v94
v_mfma_f32_16x16x32_bf16 v[140:143], v[56:59], a[204:207], v[140:143]
v_mul_f32 v214, v214, v95
v_mul_f32 v213, v94, v110
v_mfma_f32_16x16x32_bf16 v[140:143], v[60:63], a[220:223], v[140:143]
v_mul_f32 v215, v95, v111
s_waitcnt lgkmcnt(4)
v_mfma_f32_16x16x32_bf16 v[112:115], v[64:67], a[224:227], v[112:115]
v_exp_f32 v212, v212
v_mfma_f32_16x16x32_bf16 v[112:115], v[68:71], a[240:243], v[112:115]
v_exp_f32 v214, v214
v_mfma_f32_16x16x32_bf16 v[116:119], v[64:67], a[228:231], v[116:119]
ds_read_b128 v[56:59], v8 offset:2048
v_fma_f32 v212, v212, v246, v246
v_mfma_f32_16x16x32_bf16 v[116:119], v[68:71], a[244:247], v[116:119]
v_fma_f32 v214, v214, v246, v246
v_fma_f32 v222, v222, v237, v236
v_mfma_f32_16x16x32_bf16 v[120:123], v[64:67], a[232:235], v[120:123]
v_rcp_f32 v212, v212
v_mfma_f32_16x16x32_bf16 v[120:123], v[68:71], a[248:251], v[120:123]
ds_read_b128 v[60:63], v8 offset:3072
v_mul_f32 v213, v213, v212
v_mfma_f32_16x16x32_bf16 v[124:127], v[64:67], a[236:239], v[124:127]
v_rcp_f32 v214, v214
v_mfma_f32_16x16x32_bf16 v[124:127], v[68:71], a[252:255], v[124:127]
v_mul_f32 v215, v215, v214
s_waitcnt lgkmcnt(4)
v_mfma_f32_16x16x32_bf16 v[128:131], v[72:75], a[224:227], v[128:131]
v_cvt_pk_bf16_f32 v173, v213, v215
v_mul_f32 v220, v220, v182
v_mfma_f32_16x16x32_bf16 v[128:131], v[76:79], a[240:243], v[128:131]
v_rcp_f32 v218, v218
v_mfma_f32_16x16x32_bf16 v[132:135], v[72:75], a[228:231], v[132:135]
ds_read_b128 v[64:67], v8 offset:4096
v_mul_f32 v219, v219, v218
v_mfma_f32_16x16x32_bf16 v[132:135], v[76:79], a[244:247], v[132:135]
v_cvt_pk_bf16_f32 v150, v217, v219
v_mul_f32 v222, v222, v183
v_mfma_f32_16x16x32_bf16 v[136:139], v[72:75], a[232:235], v[136:139]
v_exp_f32 v220, v220
v_mfma_f32_16x16x32_bf16 v[136:139], v[76:79], a[248:251], v[136:139]
ds_read_b128 v[68:71], v8 offset:5120
v_mul_f32 v221, v182, v198
v_mfma_f32_16x16x32_bf16 v[140:143], v[72:75], a[236:239], v[140:143]
v_exp_f32 v222, v222
v_mfma_f32_16x16x32_bf16 v[140:143], v[76:79], a[252:255], v[140:143]
v_mul_f32 v223, v183, v199
s_waitcnt lgkmcnt(4)
v_mfma_f32_16x16x32_bf16 v[112:115], v[48:51], v[16:19], v[112:115]
v_fma_f32 v220, v220, v238, v238
v_fma_f32 v222, v222, v238, v238
v_mfma_f32_16x16x32_bf16 v[112:115], v[52:55], v[32:35], v[112:115]
v_rcp_f32 v220, v220
v_mfma_f32_16x16x32_bf16 v[116:119], v[48:51], v[20:23], v[116:119]
ds_read_b128 v[72:75], v8 offset:6144
v_mul_f32 v221, v221, v220
v_mfma_f32_16x16x32_bf16 v[116:119], v[52:55], v[36:39], v[116:119]
v_rcp_f32 v222, v222
v_mfma_f32_16x16x32_bf16 v[120:123], v[48:51], v[24:27], v[120:123]
v_mul_f32 v223, v223, v222
v_cvt_pk_bf16_f32 v151, v221, v223
v_mfma_f32_16x16x32_bf16 v[120:123], v[52:55], v[40:43], v[120:123]
ds_read_b128 v[76:79], v8 offset:7168
v_mul_f32 v216, v184, v184
v_mfma_f32_16x16x32_bf16 v[124:127], v[48:51], v[28:31], v[124:127]
buffer_store_dwordx4 v[148:151], v4, s[8:11], s24 offen offset:0 sc1
v_mfma_f32_16x16x32_bf16 v[124:127], v[52:55], v[44:47], v[124:127]
v_mul_f32 v218, v185, v185
s_waitcnt lgkmcnt(4)
v_mfma_f32_16x16x32_bf16 v[128:131], v[56:59], v[16:19], v[128:131]
v_fma_f32 v216, v216, v241, v240
v_fma_f32 v218, v218, v241, v240
v_mfma_f32_16x16x32_bf16 v[128:131], v[60:63], v[32:35], v[128:131]
v_mul_f32 v216, v216, v184
v_mul_f32 v218, v218, v185
v_mfma_f32_16x16x32_bf16 v[132:135], v[56:59], v[20:23], v[132:135]
ds_read_b128 v[48:51], v8 offset:8192
v_mul_f32 v217, v184, v200
v_mfma_f32_16x16x32_bf16 v[132:135], v[60:63], v[36:39], v[132:135]
v_exp_f32 v216, v216
v_mfma_f32_16x16x32_bf16 v[136:139], v[56:59], v[24:27], v[136:139]
v_exp_f32 v218, v218
v_mfma_f32_16x16x32_bf16 v[136:139], v[60:63], v[40:43], v[136:139]
ds_read_b128 v[52:55], v8 offset:9216
v_mul_f32 v219, v185, v201
v_mfma_f32_16x16x32_bf16 v[140:143], v[56:59], v[28:31], v[140:143]
v_fma_f32 v216, v216, v242, v242
v_fma_f32 v218, v218, v242, v242
v_mfma_f32_16x16x32_bf16 v[140:143], v[60:63], v[44:47], v[140:143]
v_mul_f32 v220, v186, v186
s_waitcnt lgkmcnt(4)
v_mfma_f32_16x16x32_bf16 v[80:83], v[64:67], a[0:3], 0
v_rcp_f32 v216, v216
v_mfma_f32_16x16x32_bf16 v[80:83], v[68:71], a[16:19], v[80:83]
v_rcp_f32 v218, v218
v_mfma_f32_16x16x32_bf16 v[84:87], v[64:67], a[4:7], 0
ds_read_b128 v[56:59], v8 offset:10240
v_mul_f32 v217, v217, v216
v_mfma_f32_16x16x32_bf16 v[84:87], v[68:71], a[20:23], v[84:87]
v_mul_f32 v208, v112, v112
v_mul_f32 v210, v113, v113
v_mfma_f32_16x16x32_bf16 v[88:91], v[64:67], a[8:11], 0
v_fma_f32 v208, v208, v233, v232
v_fma_f32 v210, v210, v233, v232
v_mfma_f32_16x16x32_bf16 v[88:91], v[68:71], a[24:27], v[88:91]
ds_read_b128 v[60:63], v8 offset:11264
v_mul_f32 v208, v208, v112
v_mfma_f32_16x16x32_bf16 v[92:95], v[64:67], a[12:15], 0
v_mul_f32 v210, v210, v113
v_mul_f32 v209, v112, v128
v_mfma_f32_16x16x32_bf16 v[92:95], v[68:71], a[28:31], v[92:95]
v_mul_f32 v211, v113, v129
s_waitcnt lgkmcnt(4)
v_mfma_f32_16x16x32_bf16 v[96:99], v[72:75], a[0:3], 0
v_exp_f32 v208, v208
v_mfma_f32_16x16x32_bf16 v[96:99], v[76:79], a[16:19], v[96:99]
v_exp_f32 v210, v210
v_mfma_f32_16x16x32_bf16 v[100:103], v[72:75], a[4:7], 0
ds_read_b128 v[64:67], v8 offset:12288
v_fma_f32 v208, v208, v234, v234
v_mfma_f32_16x16x32_bf16 v[100:103], v[76:79], a[20:23], v[100:103]
v_fma_f32 v210, v210, v234, v234
v_mul_f32 v212, v114, v114
v_mfma_f32_16x16x32_bf16 v[104:107], v[72:75], a[8:11], 0
v_rcp_f32 v208, v208
v_mfma_f32_16x16x32_bf16 v[104:107], v[76:79], a[24:27], v[104:107]
ds_read_b128 v[68:71], v8 offset:13312
v_mul_f32 v209, v209, v208
v_mfma_f32_16x16x32_bf16 v[108:111], v[72:75], a[12:15], 0
v_rcp_f32 v210, v210
v_mfma_f32_16x16x32_bf16 v[108:111], v[76:79], a[28:31], v[108:111]
v_mul_f32 v211, v211, v210
s_waitcnt lgkmcnt(4)
v_mfma_f32_16x16x32_bf16 v[80:83], v[48:51], a[32:35], v[80:83]
v_cvt_pk_bf16_f32 v162, v209, v211
v_mul_f32 v214, v115, v115
v_mfma_f32_16x16x32_bf16 v[80:83], v[52:55], a[48:51], v[80:83]
v_fma_f32 v212, v212, v233, v232
v_fma_f32 v214, v214, v233, v232
v_mfma_f32_16x16x32_bf16 v[84:87], v[48:51], a[36:39], v[84:87]
ds_read_b128 v[72:75], v8 offset:14336
v_mul_f32 v212, v212, v114
v_mfma_f32_16x16x32_bf16 v[84:87], v[52:55], a[52:55], v[84:87]
v_mul_f32 v214, v214, v115
v_mul_f32 v213, v114, v130
v_mfma_f32_16x16x32_bf16 v[88:91], v[48:51], a[40:43], v[88:91]
v_exp_f32 v212, v212
v_mfma_f32_16x16x32_bf16 v[88:91], v[52:55], a[56:59], v[88:91]
ds_read_b128 v[76:79], v8 offset:15360
v_mul_f32 v215, v115, v131
v_mfma_f32_16x16x32_bf16 v[92:95], v[48:51], a[44:47], v[92:95]
v_exp_f32 v214, v214
v_mfma_f32_16x16x32_bf16 v[92:95], v[52:55], a[60:63], v[92:95]
v_fma_f32 v212, v212, v234, v234
s_waitcnt lgkmcnt(4)
v_mfma_f32_16x16x32_bf16 v[96:99], v[56:59], a[32:35], v[96:99]
s_waitcnt vmcnt(21)
v_fma_f32 v214, v214, v234, v234
v_mfma_f32_16x16x32_bf16 v[96:99], v[60:63], a[48:51], v[96:99]
s_barrier
v_mfma_f32_16x16x32_bf16 v[100:103], v[56:59], a[36:39], v[100:103]
ds_read_b128 v[48:51], v2 offset:0
s_add_u32 m0, s22, 98304
v_mfma_f32_16x16x32_bf16 v[100:103], v[60:63], a[52:55], v[100:103]
v_add_u32 v3, 20480, v3
buffer_load_dwordx4 v3, s[8:11], 0 offen offset:0 sc1 lds
v_mfma_f32_16x16x32_bf16 v[104:107], v[56:59], a[40:43], v[104:107]
v_rcp_f32 v212, v212
v_mfma_f32_16x16x32_bf16 v[104:107], v[60:63], a[56:59], v[104:107]
ds_read_b128 v[52:55], v2 offset:1024
v_mul_f32 v213, v213, v212
v_mfma_f32_16x16x32_bf16 v[108:111], v[56:59], a[44:47], v[108:111]
v_rcp_f32 v214, v214
v_mfma_f32_16x16x32_bf16 v[108:111], v[60:63], a[60:63], v[108:111]
v_mul_f32 v215, v215, v214
s_waitcnt lgkmcnt(4)
v_mfma_f32_16x16x32_bf16 v[80:83], v[64:67], a[64:67], v[80:83]
buffer_load_dwordx4 v3, s[8:11], 0 offen offset:1024 sc1 lds
v_mfma_f32_16x16x32_bf16 v[80:83], v[68:71], a[80:83], v[80:83]
v_cvt_pk_bf16_f32 v163, v213, v215
v_mul_f32 v208, v116, v116
v_mfma_f32_16x16x32_bf16 v[84:87], v[64:67], a[68:71], v[84:87]
ds_read_b128 v[56:59], v2 offset:2048
v_mul_f32 v210, v117, v117
v_mfma_f32_16x16x32_bf16 v[84:87], v[68:71], a[84:87], v[84:87]
buffer_store_dwordx4 v[160:163], v2, s[8:11], s24 offen offset:1024 sc1
v_mfma_f32_16x16x32_bf16 v[88:91], v[64:67], a[72:75], v[88:91]
v_fma_f32 v208, v208, v237, v236
v_fma_f32 v210, v210, v237, v236
v_mfma_f32_16x16x32_bf16 v[88:91], v[68:71], a[88:91], v[88:91]
ds_read_b128 v[60:63], v2 offset:3072
v_mul_f32 v208, v208, v116
v_mfma_f32_16x16x32_bf16 v[92:95], v[64:67], a[76:79], v[92:95]
v_mul_f32 v210, v210, v117
v_mul_f32 v209, v116, v132
v_mfma_f32_16x16x32_bf16 v[92:95], v[68:71], a[92:95], v[92:95]
v_mul_f32 v211, v117, v133
s_waitcnt lgkmcnt(4)
v_mfma_f32_16x16x32_bf16 v[96:99], v[72:75], a[64:67], v[96:99]
buffer_load_dwordx4 v3, s[8:11], 0 offen offset:2048 sc1 lds
v_mfma_f32_16x16x32_bf16 v[96:99], v[76:79], a[80:83], v[96:99]
v_exp_f32 v208, v208
v_mfma_f32_16x16x32_bf16 v[100:103], v[72:75], a[68:71], v[100:103]
ds_read_b128 v[64:67], v2 offset:4096
v_fma_f32 v208, v208, v238, v238
v_mfma_f32_16x16x32_bf16 v[100:103], v[76:79], a[84:87], v[100:103]
v_exp_f32 v210, v210
v_mfma_f32_16x16x32_bf16 v[104:107], v[72:75], a[72:75], v[104:107]
v_fma_f32 v210, v210, v238, v238
v_mul_f32 v212, v118, v118
v_mfma_f32_16x16x32_bf16 v[104:107], v[76:79], a[88:91], v[104:107]
ds_read_b128 v[68:71], v2 offset:5120
v_mul_f32 v214, v119, v119
v_mfma_f32_16x16x32_bf16 v[108:111], v[72:75], a[76:79], v[108:111]
buffer_load_dwordx4 v3, s[8:11], 0 offen offset:3072 sc1 lds
v_mfma_f32_16x16x32_bf16 v[108:111], v[76:79], a[92:95], v[108:111]
s_add_u32 m0, s22, 102400
s_waitcnt lgkmcnt(4)
v_mfma_f32_16x16x32_bf16 v[80:83], v[48:51], a[96:99], v[80:83]
v_add_u32 v3, 4096, v3
v_fma_f32 v212, v212, v237, v236
v_mfma_f32_16x16x32_bf16 v[80:83], v[52:55], a[112:115], v[80:83]
v_rcp_f32 v208, v208
v_mfma_f32_16x16x32_bf16 v[84:87], v[48:51], a[100:103], v[84:87]
ds_read_b128 v[72:75], v2 offset:6144
v_mul_f32 v209, v209, v208
v_mfma_f32_16x16x32_bf16 v[84:87], v[52:55], a[116:119], v[84:87]
buffer_load_dwordx4 v3, s[8:11], 0 offen offset:0 sc1 lds
v_mfma_f32_16x16x32_bf16 v[88:91], v[48:51], a[104:107], v[88:91]
v_rcp_f32 v210, v210
v_mfma_f32_16x16x32_bf16 v[88:91], v[52:55], a[120:123], v[88:91]
ds_read_b128 v[76:79], v2 offset:7168
v_mul_f32 v211, v211, v210
v_mfma_f32_16x16x32_bf16 v[92:95], v[48:51], a[108:111], v[92:95]
v_cvt_pk_bf16_f32 v166, v209, v211
v_fma_f32 v214, v214, v237, v236
v_mfma_f32_16x16x32_bf16 v[92:95], v[52:55], a[124:127], v[92:95]
v_mul_f32 v212, v212, v118
s_waitcnt lgkmcnt(4)
v_mfma_f32_16x16x32_bf16 v[96:99], v[56:59], a[96:99], v[96:99]
buffer_load_dwordx4 v3, s[8:11], 0 offen offset:1024 sc1 lds
v_mfma_f32_16x16x32_bf16 v[96:99], v[60:63], a[112:115], v[96:99]
v_mul_f32 v214, v214, v119
v_mul_f32 v213, v118, v134
v_mfma_f32_16x16x32_bf16 v[100:103], v[56:59], a[100:103], v[100:103]
ds_read_b128 v[48:51], v2 offset:8192
v_mul_f32 v215, v119, v135
v_mfma_f32_16x16x32_bf16 v[100:103], v[60:63], a[116:119], v[100:103]
v_exp_f32 v212, v212
v_mfma_f32_16x16x32_bf16 v[104:107], v[56:59], a[104:107], v[104:107]
v_exp_f32 v214, v214
v_mfma_f32_16x16x32_bf16 v[104:107], v[60:63], a[120:123], v[104:107]
ds_read_b128 v[52:55], v2 offset:9216
v_fma_f32 v212, v212, v238, v238
v_mfma_f32_16x16x32_bf16 v[108:111], v[56:59], a[108:111], v[108:111]
v_fma_f32 v214, v214, v238, v238
v_mul_f32 v208, v120, v120
v_mfma_f32_16x16x32_bf16 v[108:111], v[60:63], a[124:127], v[108:111]
v_mul_f32 v210, v121, v121
s_waitcnt lgkmcnt(4)
v_mfma_f32_16x16x32_bf16 v[80:83], v[64:67], a[128:131], v[80:83]
v_rcp_f32 v212, v212
v_mfma_f32_16x16x32_bf16 v[80:83], v[68:71], a[144:147], v[80:83]
v_rcp_f32 v214, v214
v_mfma_f32_16x16x32_bf16 v[84:87], v[64:67], a[132:135], v[84:87]
ds_read_b128 v[56:59], v2 offset:10240
v_mul_f32 v213, v213, v212
v_mfma_f32_16x16x32_bf16 v[84:87], v[68:71], a[148:151], v[84:87]
v_mul_f32 v215, v215, v214
v_cvt_pk_bf16_f32 v167, v213, v215
v_mfma_f32_16x16x32_bf16 v[88:91], v[64:67], a[136:139], v[88:91]
buffer_store_dwordx4 v[164:167], v4, s[8:11], s24 offen offset:1024 sc1
v_mfma_f32_16x16x32_bf16 v[88:91], v[68:71], a[152:155], v[88:91]
ds_read_b128 v[60:63], v2 offset:11264
v_fma_f32 v208, v208, v241, v240
v_mfma_f32_16x16x32_bf16 v[92:95], v[64:67], a[140:143], v[92:95]
v_fma_f32 v210, v210, v241, v240
v_mul_f32 v208, v208, v120
v_mfma_f32_16x16x32_bf16 v[92:95], v[68:71], a[156:159], v[92:95]
v_mul_f32 v210, v210, v121
s_waitcnt lgkmcnt(4)
v_mfma_f32_16x16x32_bf16 v[96:99], v[72:75], a[128:131], v[96:99]
v_exp_f32 v208, v208
v_mfma_f32_16x16x32_bf16 v[96:99], v[76:79], a[144:147], v[96:99]
v_exp_f32 v210, v210
v_mfma_f32_16x16x32_bf16 v[100:103], v[72:75], a[132:135], v[100:103]
ds_read_b128 v[64:67], v2 offset:12288
v_mul_f32 v209, v120, v136
v_mfma_f32_16x16x32_bf16 v[100:103], v[76:79], a[148:151], v[100:103]
v_mul_f32 v211, v121, v137
v_fma_f32 v208, v208, v242, v242
v_mfma_f32_16x16x32_bf16 v[104:107], v[72:75], a[136:139], v[104:107]
v_fma_f32 v210, v210, v242, v242
v_mul_f32 v212, v122, v122
v_mfma_f32_16x16x32_bf16 v[104:107], v[76:79], a[152:155], v[104:107]
ds_read_b128 v[68:71], v2 offset:13312
v_mul_f32 v214, v123, v123
v_mfma_f32_16x16x32_bf16 v[108:111], v[72:75], a[140:143], v[108:111]
v_rcp_f32 v208, v208
v_mfma_f32_16x16x32_bf16 v[108:111], v[76:79], a[156:159], v[108:111]
v_mul_f32 v209, v209, v208
s_waitcnt lgkmcnt(4)
v_mfma_f32_16x16x32_bf16 v[80:83], v[48:51], a[160:163], v[80:83]
v_rcp_f32 v210, v210
v_mfma_f32_16x16x32_bf16 v[80:83], v[52:55], a[176:179], v[80:83]
v_mul_f32 v211, v211, v210
v_cvt_pk_bf16_f32 v170, v209, v211
v_mfma_f32_16x16x32_bf16 v[84:87], v[48:51], a[164:167], v[84:87]
ds_read_b128 v[72:75], v2 offset:14336
v_fma_f32 v212, v212, v241, v240
v_mfma_f32_16x16x32_bf16 v[84:87], v[52:55], a[180:183], v[84:87]
v_fma_f32 v214, v214, v241, v240
v_mul_f32 v212, v212, v122
v_mfma_f32_16x16x32_bf16 v[88:91], v[48:51], a[168:171], v[88:91]
v_mul_f32 v214, v214, v123
v_mul_f32 v213, v122, v138
v_mfma_f32_16x16x32_bf16 v[88:91], v[52:55], a[184:187], v[88:91]
ds_read_b128 v[76:79], v2 offset:15360
v_mul_f32 v215, v123, v139
v_mfma_f32_16x16x32_bf16 v[92:95], v[48:51], a[172:175], v[92:95]
v_exp_f32 v212, v212
v_mfma_f32_16x16x32_bf16 v[92:95], v[52:55], a[188:191], v[92:95]
v_fma_f32 v212, v212, v242, v242
s_waitcnt lgkmcnt(4)
v_mfma_f32_16x16x32_bf16 v[96:99], v[56:59], a[160:163], v[96:99]
v_exp_f32 v214, v214
v_mfma_f32_16x16x32_bf16 v[96:99], v[60:63], a[176:179], v[96:99]
v_fma_f32 v214, v214, v242, v242
v_mul_f32 v208, v124, v124
v_mfma_f32_16x16x32_bf16 v[100:103], v[56:59], a[164:167], v[100:103]
ds_read_b128 v[48:51], v2 offset:16384
v_mul_f32 v210, v125, v125
v_mfma_f32_16x16x32_bf16 v[100:103], v[60:63], a[180:183], v[100:103]
v_rcp_f32 v212, v212
v_mfma_f32_16x16x32_bf16 v[104:107], v[56:59], a[168:171], v[104:107]
v_rcp_f32 v214, v214
v_mfma_f32_16x16x32_bf16 v[104:107], v[60:63], a[184:187], v[104:107]
ds_read_b128 v[52:55], v2 offset:17408
v_mul_f32 v213, v213, v212
v_mfma_f32_16x16x32_bf16 v[108:111], v[56:59], a[172:175], v[108:111]
v_mul_f32 v215, v215, v214
v_cvt_pk_bf16_f32 v171, v213, v215
v_mfma_f32_16x16x32_bf16 v[108:111], v[60:63], a[188:191], v[108:111]
v_fma_f32 v208, v208, v245, v244
s_waitcnt lgkmcnt(4)
v_mfma_f32_16x16x32_bf16 v[80:83], v[64:67], a[192:195], v[80:83]
buffer_store_dwordx4 v[168:171], v5, s[8:11], s24 offen offset:1024 sc1
v_mfma_f32_16x16x32_bf16 v[80:83], v[68:71], a[208:211], v[80:83]
v_fma_f32 v210, v210, v245, v244
v_mul_f32 v208, v208, v124
v_mfma_f32_16x16x32_bf16 v[84:87], v[64:67], a[196:199], v[84:87]
ds_read_b128 v[56:59], v2 offset:18432
v_mul_f32 v210, v210, v125
v_mfma_f32_16x16x32_bf16 v[84:87], v[68:71], a[212:215], v[84:87]
v_exp_f32 v208, v208
v_mfma_f32_16x16x32_bf16 v[88:91], v[64:67], a[200:203], v[88:91]
v_exp_f32 v210, v210
v_mfma_f32_16x16x32_bf16 v[88:91], v[68:71], a[216:219], v[88:91]
ds_read_b128 v[60:63], v2 offset:19456
v_mul_f32 v209, v124, v140
v_mfma_f32_16x16x32_bf16 v[92:95], v[64:67], a[204:207], v[92:95]
v_mul_f32 v211, v125, v141
v_fma_f32 v208, v208, v246, v246
v_mfma_f32_16x16x32_bf16 v[92:95], v[68:71], a[220:223], v[92:95]
v_fma_f32 v210, v210, v246, v246
s_waitcnt lgkmcnt(4)
v_mfma_f32_16x16x32_bf16 v[96:99], v[72:75], a[192:195], v[96:99]
v_rcp_f32 v208, v208
v_mfma_f32_16x16x32_bf16 v[96:99], v[76:79], a[208:211], v[96:99]
v_rcp_f32 v210, v210
v_mfma_f32_16x16x32_bf16 v[100:103], v[72:75], a[196:199], v[100:103]
ds_read_b128 v[64:67], v2 offset:20480
v_mul_f32 v209, v209, v208
v_mfma_f32_16x16x32_bf16 v[100:103], v[76:79], a[212:215], v[100:103]
v_mul_f32 v211, v211, v210
v_cvt_pk_bf16_f32 v174, v209, v211
v_mfma_f32_16x16x32_bf16 v[104:107], v[72:75], a[200:203], v[104:107]
v_mul_f32 v212, v126, v126
v_mul_f32 v214, v127, v127
v_mfma_f32_16x16x32_bf16 v[104:107], v[76:79], a[216:219], v[104:107]
ds_read_b128 v[68:71], v2 offset:21504
v_fma_f32 v212, v212, v245, v244
v_mfma_f32_16x16x32_bf16 v[108:111], v[72:75], a[204:207], v[108:111]
v_fma_f32 v214, v214, v245, v244
v_mul_f32 v212, v212, v126
v_mfma_f32_16x16x32_bf16 v[108:111], v[76:79], a[220:223], v[108:111]
v_mul_f32 v214, v214, v127
s_waitcnt lgkmcnt(4)
v_mfma_f32_16x16x32_bf16 v[80:83], v[48:51], a[224:227], v[80:83]
v_exp_f32 v212, v212
v_mfma_f32_16x16x32_bf16 v[80:83], v[52:55], a[240:243], v[80:83]
v_exp_f32 v214, v214
v_mfma_f32_16x16x32_bf16 v[84:87], v[48:51], a[228:231], v[84:87]
ds_read_b128 v[72:75], v2 offset:22528
v_mul_f32 v213, v126, v142
v_mfma_f32_16x16x32_bf16 v[84:87], v[52:55], a[244:247], v[84:87]
v_mul_f32 v215, v127, v143
v_fma_f32 v212, v212, v246, v246
v_mfma_f32_16x16x32_bf16 v[88:91], v[48:51], a[232:235], v[88:91]
v_fma_f32 v214, v214, v246, v246
v_mul_f32 v219, v219, v218
v_mfma_f32_16x16x32_bf16 v[88:91], v[52:55], a[248:251], v[88:91]
ds_read_b128 v[76:79], v2 offset:23552
v_cvt_pk_bf16_f32 v154, v217, v219
v_mfma_f32_16x16x32_bf16 v[92:95], v[48:51], a[236:239], v[92:95]
v_rcp_f32 v212, v212
v_mfma_f32_16x16x32_bf16 v[92:95], v[52:55], a[252:255], v[92:95]
v_mul_f32 v213, v213, v212
s_waitcnt lgkmcnt(4)
v_mfma_f32_16x16x32_bf16 v[96:99], v[56:59], a[224:227], v[96:99]
s_waitcnt vmcnt(23)
v_mul_f32 v222, v187, v187
v_mfma_f32_16x16x32_bf16 v[96:99], v[60:63], a[240:243], v[96:99]
s_barrier
v_mfma_f32_16x16x32_bf16 v[100:103], v[56:59], a[228:231], v[100:103]
ds_read_b128 v[48:51], v2 offset:24576
s_add_u32 m0, s22, 122880
v_mfma_f32_16x16x32_bf16 v[100:103], v[60:63], a[244:247], v[100:103]
v_add_u32 v3, 20480, v3
buffer_load_dwordx4 v3, s[8:11], 0 offen offset:0 sc1 lds
v_mfma_f32_16x16x32_bf16 v[104:107], v[56:59], a[232:235], v[104:107]
v_rcp_f32 v214, v214
v_mfma_f32_16x16x32_bf16 v[104:107], v[60:63], a[248:251], v[104:107]
ds_read_b128 v[52:55], v2 offset:25600
v_mul_f32 v215, v215, v214
v_mfma_f32_16x16x32_bf16 v[108:111], v[56:59], a[236:239], v[108:111]
v_cvt_pk_bf16_f32 v175, v213, v215
v_fma_f32 v220, v220, v241, v240
v_mfma_f32_16x16x32_bf16 v[108:111], v[60:63], a[252:255], v[108:111]
v_fma_f32 v222, v222, v241, v240
s_waitcnt lgkmcnt(4)
v_mfma_f32_16x16x32_bf16 v[80:83], v[64:67], v[16:19], v[80:83]
buffer_load_dwordx4 v3, s[8:11], 0 offen offset:1024 sc1 lds
v_mfma_f32_16x16x32_bf16 v[80:83], v[68:71], v[32:35], v[80:83]
v_mul_f32 v220, v220, v186
v_mul_f32 v222, v222, v187
v_mfma_f32_16x16x32_bf16 v[84:87], v[64:67], v[20:23], v[84:87]
ds_read_b128 v[56:59], v2 offset:26624
v_mul_f32 v221, v186, v202
v_mfma_f32_16x16x32_bf16 v[84:87], v[68:71], v[36:39], v[84:87]
buffer_store_dwordx4 v[172:175], v6, s[8:11], s24 offen offset:1024 sc1
v_mfma_f32_16x16x32_bf16 v[88:91], v[64:67], v[24:27], v[88:91]
v_exp_f32 v220, v220
v_mfma_f32_16x16x32_bf16 v[88:91], v[68:71], v[40:43], v[88:91]
ds_read_b128 v[60:63], v2 offset:27648
v_mul_f32 v223, v187, v203
v_mfma_f32_16x16x32_bf16 v[92:95], v[64:67], v[28:31], v[92:95]
v_exp_f32 v222, v222
v_mfma_f32_16x16x32_bf16 v[92:95], v[68:71], v[44:47], v[92:95]
v_fma_f32 v220, v220, v242, v242
s_waitcnt lgkmcnt(4)
v_mfma_f32_16x16x32_bf16 v[96:99], v[72:75], v[16:19], v[96:99]
buffer_load_dwordx4 v3, s[8:11], 0 offen offset:2048 sc1 lds
v_mfma_f32_16x16x32_bf16 v[96:99], v[76:79], v[32:35], v[96:99]
v_fma_f32 v222, v222, v242, v242
v_mul_f32 v216, v188, v188
v_mfma_f32_16x16x32_bf16 v[100:103], v[72:75], v[20:23], v[100:103]
L_hop6:
s_cmp_eq_u32 s15, 1
s_cbranch_scc1 L_hop10
ds_read_b128 v[64:67], v2 offset:28672
v_mul_f32 v218, v189, v189
v_mfma_f32_16x16x32_bf16 v[100:103], v[76:79], v[36:39], v[100:103]
v_rcp_f32 v220, v220
v_mfma_f32_16x16x32_bf16 v[104:107], v[72:75], v[24:27], v[104:107]
v_rcp_f32 v222, v222
v_mfma_f32_16x16x32_bf16 v[104:107], v[76:79], v[40:43], v[104:107]
ds_read_b128 v[68:71], v2 offset:29696
v_mul_f32 v221, v221, v220
v_mfma_f32_16x16x32_bf16 v[108:111], v[72:75], v[28:31], v[108:111]
buffer_load_dwordx4 v3, s[8:11], 0 offen offset:3072 sc1 lds
v_mfma_f32_16x16x32_bf16 v[108:111], v[76:79], v[44:47], v[108:111]
s_add_u32 m0, s22, 126976
s_waitcnt lgkmcnt(4)
v_mfma_f32_16x16x32_bf16 v[112:115], v[48:51], a[0:3], 0
v_add_u32 v3, 4096, v3
v_mul_f32 v223, v223, v222
v_mfma_f32_16x16x32_bf16 v[112:115], v[52:55], a[16:19], v[112:115]
v_cvt_pk_bf16_f32 v155, v221, v223
v_fma_f32 v216, v216, v245, v244
v_mfma_f32_16x16x32_bf16 v[116:119], v[48:51], a[4:7], 0
ds_read_b128 v[72:75], v2 offset:30720
v_fma_f32 v218, v218, v245, v244
v_mfma_f32_16x16x32_bf16 v[116:119], v[52:55], a[20:23], v[116:119]
buffer_load_dwordx4 v3, s[8:11], 0 offen offset:0 sc1 lds
v_mfma_f32_16x16x32_bf16 v[120:123], v[48:51], a[8:11], 0
v_mul_f32 v216, v216, v188
v_mul_f32 v218, v218, v189
v_mfma_f32_16x16x32_bf16 v[120:123], v[52:55], a[24:27], v[120:123]
ds_read_b128 v[76:79], v2 offset:31744
v_mul_f32 v217, v188, v204
v_mfma_f32_16x16x32_bf16 v[124:127], v[48:51], a[12:15], 0
buffer_store_dwordx4 v[152:155], v5, s[8:11], s24 offen offset:0 sc1
v_mfma_f32_16x16x32_bf16 v[124:127], v[52:55], a[28:31], v[124:127]
v_mul_f32 v219, v189, v205
s_waitcnt lgkmcnt(4)
v_mfma_f32_16x16x32_bf16 v[128:131], v[56:59], a[0:3], 0
v_exp_f32 v216, v216
v_mfma_f32_16x16x32_bf16 v[128:131], v[60:63], a[16:19], v[128:131]
v_exp_f32 v218, v218
v_mfma_f32_16x16x32_bf16 v[132:135], v[56:59], a[4:7], 0
ds_read_b128 v[48:51], v2 offset:32768
v_fma_f32 v216, v216, v246, v246
v_mfma_f32_16x16x32_bf16 v[132:135], v[60:63], a[20:23], v[132:135]
buffer_load_dwordx4 v3, s[8:11], 0 offen offset:1024 sc1 lds
v_mfma_f32_16x16x32_bf16 v[136:139], v[56:59], a[8:11], 0
v_fma_f32 v218, v218, v246, v246
v_mul_f32 v220, v190, v190
v_mfma_f32_16x16x32_bf16 v[136:139], v[60:63], a[24:27], v[136:139]
ds_read_b128 v[52:55], v2 offset:33792
v_mul_f32 v222, v191, v191
v_mfma_f32_16x16x32_bf16 v[140:143], v[56:59], a[12:15], 0
v_rcp_f32 v216, v216
v_mfma_f32_16x16x32_bf16 v[140:143], v[60:63], a[28:31], v[140:143]
v_mul_f32 v217, v217, v216
s_waitcnt lgkmcnt(4)
v_mfma_f32_16x16x32_bf16 v[112:115], v[64:67], a[32:35], v[112:115]
v_rcp_f32 v218, v218
v_mfma_f32_16x16x32_bf16 v[112:115], v[68:71], a[48:51], v[112:115]
v_mul_f32 v219, v219, v218
v_cvt_pk_bf16_f32 v158, v217, v219
v_mfma_f32_16x16x32_bf16 v[116:119], v[64:67], a[36:39], v[116:119]
ds_read_b128 v[56:59], v2 offset:34816
v_fma_f32 v220, v220, v245, v244
v_mfma_f32_16x16x32_bf16 v[116:119], v[68:71], a[52:55], v[116:119]
v_fma_f32 v222, v222, v245, v244
v_mul_f32 v220, v220, v190
v_mfma_f32_16x16x32_bf16 v[120:123], v[64:67], a[40:43], v[120:123]
v_mul_f32 v222, v222, v191
v_mul_f32 v221, v190, v206
v_mfma_f32_16x16x32_bf16 v[120:123], v[68:71], a[56:59], v[120:123]
ds_read_b128 v[60:63], v2 offset:35840
v_mul_f32 v223, v191, v207
v_mfma_f32_16x16x32_bf16 v[124:127], v[64:67], a[44:47], v[124:127]
v_exp_f32 v220, v220
v_mfma_f32_16x16x32_bf16 v[124:127], v[68:71], a[60:63], v[124:127]
v_fma_f32 v220, v220, v246, v246
s_waitcnt lgkmcnt(4)
v_mfma_f32_16x16x32_bf16 v[128:131], v[72:75], a[32:35], v[128:131]
v_exp_f32 v222, v222
v_mfma_f32_16x16x32_bf16 v[128:131], v[76:79], a[48:51], v[128:131]
v_fma_f32 v222, v222, v246, v246
v_mfma_f32_16x16x32_bf16 v[132:135], v[72:75], a[36:39], v[132:135]
ds_read_b128 v[64:67], v2 offset:36864
v_mfma_f32_16x16x32_bf16 v[132:135], v[76:79], a[52:55], v[132:135]
v_rcp_f32 v220, v220
v_mfma_f32_16x16x32_bf16 v[136:139], v[72:75], a[40:43], v[136:139]
v_rcp_f32 v222, v222
v_mfma_f32_16x16x32_bf16 v[136:139], v[76:79], a[56:59], v[136:139]
ds_read_b128 v[68:71], v2 offset:37888
v_mul_f32 v221, v221, v220
v_mfma_f32_16x16x32_bf16 v[140:143], v[72:75], a[44:47], v[140:143]
v_mul_f32 v223, v223, v222
v_cvt_pk_bf16_f32 v159, v221, v223
v_mfma_f32_16x16x32_bf16 v[140:143], v[76:79], a[60:63], v[140:143]
s_waitcnt lgkmcnt(4)
v_mfma_f32_16x16x32_bf16 v[112:115], v[48:51], a[64:67], v[112:115]
buffer_store_dwordx4 v[156:159], v6, s[8:11], s24 offen offset:0 sc1
v_mfma_f32_16x16x32_bf16 v[112:115], v[52:55], a[80:83], v[112:115]
v_mul_f32 v208, v80, v80
v_mul_f32 v210, v81, v81
v_mfma_f32_16x16x32_bf16 v[116:119], v[48:51], a[68:71], v[116:119]
ds_read_b128 v[72:75], v2 offset:38912
v_fma_f32 v208, v208, v233, v232
v_mfma_f32_16x16x32_bf16 v[116:119], v[52:55], a[84:87], v[116:119]
v_fma_f32 v210, v210, v233, v232
v_mul_f32 v208, v208, v80
v_mfma_f32_16x16x32_bf16 v[120:123], v[48:51], a[72:75], v[120:123]
v_mul_f32 v210, v210, v81
v_mul_f32 v209, v80, v96
v_mfma_f32_16x16x32_bf16 v[120:123], v[52:55], a[88:91], v[120:123]
ds_read_b128 v[76:79], v2 offset:39936
v_mul_f32 v211, v81, v97
v_mfma_f32_16x16x32_bf16 v[124:127], v[48:51], a[76:79], v[124:127]
v_exp_f32 v208, v208
v_mfma_f32_16x16x32_bf16 v[124:127], v[52:55], a[92:95], v[124:127]
v_fma_f32 v208, v208, v234, v234
s_waitcnt lgkmcnt(4)
v_mfma_f32_16x16x32_bf16 v[128:131], v[56:59], a[64:67], v[128:131]
v_exp_f32 v210, v210
v_mfma_f32_16x16x32_bf16 v[128:131], v[60:63], a[80:83], v[128:131]
v_fma_f32 v210, v210, v234, v234
v_mul_f32 v212, v82, v82
v_mfma_f32_16x16x32_bf16 v[132:135], v[56:59], a[68:71], v[132:135]
ds_read_b128 v[48:51], v2 offset:40960
v_mul_f32 v214, v83, v83
v_mfma_f32_16x16x32_bf16 v[132:135], v[60:63], a[84:87], v[132:135]
v_rcp_f32 v208, v208
v_mfma_f32_16x16x32_bf16 v[136:139], v[56:59], a[72:75], v[136:139]
v_rcp_f32 v210, v210
v_mfma_f32_16x16x32_bf16 v[136:139], v[60:63], a[88:91], v[136:139]
ds_read_b128 v[52:55], v2 offset:41984
v_mul_f32 v209, v209, v208
v_mfma_f32_16x16x32_bf16 v[140:143], v[56:59], a[76:79], v[140:143]
v_mul_f32 v211, v211, v210
v_cvt_pk_bf16_f32 v176, v209, v211
v_mfma_f32_16x16x32_bf16 v[140:143], v[60:63], a[92:95], v[140:143]
v_fma_f32 v212, v212, v233, v232
s_waitcnt lgkmcnt(4)
v_mfma_f32_16x16x32_bf16 v[112:115], v[64:67], a[96:99], v[112:115]
v_fma_f32 v214, v214, v233, v232
v_mul_f32 v212, v212, v82
v_mfma_f32_16x16x32_bf16 v[112:115], v[68:71], a[112:115], v[112:115]
v_mul_f32 v214, v214, v83
v_mul_f32 v213, v82, v98
v_mfma_f32_16x16x32_bf16 v[116:119], v[64:67], a[100:103], v[116:119]
ds_read_b128 v[56:59], v2 offset:43008
v_mul_f32 v215, v83, v99
v_mfma_f32_16x16x32_bf16 v[116:119], v[68:71], a[116:119], v[116:119]
v_exp_f32 v212, v212
v_mfma_f32_16x16x32_bf16 v[120:123], v[64:67], a[104:107], v[120:123]
v_exp_f32 v214, v214
v_mfma_f32_16x16x32_bf16 v[120:123], v[68:71], a[120:123], v[120:123]
ds_read_b128 v[60:63], v2 offset:44032
v_fma_f32 v212, v212, v234, v234
v_mfma_f32_16x16x32_bf16 v[124:127], v[64:67], a[108:111], v[124:127]
v_fma_f32 v214, v214, v234, v234
v_mul_f32 v208, v84, v84
v_mfma_f32_16x16x32_bf16 v[124:127], v[68:71], a[124:127], v[124:127]
v_mul_f32 v210, v85, v85
s_waitcnt lgkmcnt(4)
v_mfma_f32_16x16x32_bf16 v[128:131], v[72:75], a[96:99], v[128:131]
v_rcp_f32 v212, v212
v_mfma_f32_16x16x32_bf16 v[128:131], v[76:79], a[112:115], v[128:131]
v_rcp_f32 v214, v214
v_mfma_f32_16x16x32_bf16 v[132:135], v[72:75], a[100:103], v[132:135]
ds_read_b128 v[64:67], v2 offset:45056
v_mul_f32 v213, v213, v212
v_mfma_f32_16x16x32_bf16 v[132:135], v[76:79], a[116:119], v[132:135]
v_mul_f32 v215, v215, v214
v_cvt_pk_bf16_f32 v177, v213, v215
v_mfma_f32_16x16x32_bf16 v[136:139], v[72:75], a[104:107], v[136:139]
v_fma_f32 v208, v208, v237, v236
v_fma_f32 v210, v210, v237, v236
v_mfma_f32_16x16x32_bf16 v[136:139], v[76:79], a[120:123], v[136:139]
ds_read_b128 v[68:71], v2 offset:46080
v_mul_f32 v208, v208, v84
v_mfma_f32_16x16x32_bf16 v[140:143], v[72:75], a[108:111], v[140:143]
v_mul_f32 v210, v210, v85
v_mul_f32 v209, v84, v100
v_mfma_f32_16x16x32_bf16 v[140:143], v[76:79], a[124:127], v[140:143]
v_mul_f32 v211, v85, v101
s_waitcnt lgkmcnt(4)
v_mfma_f32_16x16x32_bf16 v[112:115], v[48:51], a[128:131], v[112:115]
v_exp_f32 v208, v208
v_mfma_f32_16x16x32_bf16 v[112:115], v[52:55], a[144:147], v[112:115]
v_exp_f32 v210, v210
v_mfma_f32_16x16x32_bf16 v[116:119], v[48:51], a[132:135], v[116:119]
ds_read_b128 v[72:75], v2 offset:47104
v_fma_f32 v208, v208, v238, v238
v_mfma_f32_16x16x32_bf16 v[116:119], v[52:55], a[148:151], v[116:119]
v_fma_f32 v210, v210, v238, v238
v_mul_f32 v212, v86, v86
v_mfma_f32_16x16x32_bf16 v[120:123], v[48:51], a[136:139], v[120:123]
v_rcp_f32 v208, v208
v_mfma_f32_16x16x32_bf16 v[120:123], v[52:55], a[152:155], v[120:123]
ds_read_b128 v[76:79], v2 offset:48128
v_mul_f32 v209, v209, v208
v_mfma_f32_16x16x32_bf16 v[124:127], v[48:51], a[140:143], v[124:127]
v_rcp_f32 v210, v210
v_mfma_f32_16x16x32_bf16 v[124:127], v[52:55], a[156:159], v[124:127]
v_mul_f32 v211, v211, v210
s_waitcnt lgkmcnt(4)
v_mfma_f32_16x16x32_bf16 v[128:131], v[56:59], a[128:131], v[128:131]
s_waitcnt vmcnt(25)
v_cvt_pk_bf16_f32 v180, v209, v211
v_mfma_f32_16x16x32_bf16 v[128:131], v[60:63], a[144:147], v[128:131]
s_barrier
v_mfma_f32_16x16x32_bf16 v[132:135], v[56:59], a[132:135], v[132:135]
ds_read_b128 v[48:51], v2 offset:49152
s_add_u32 m0, s22, 0
v_mfma_f32_16x16x32_bf16 v[132:135], v[60:63], a[148:151], v[132:135]
v_add_u32 v3, 20480, v3
buffer_load_dwordx4 v3, s[8:11], 0 offen offset:0 sc1 lds
v_mfma_f32_16x16x32_bf16 v[136:139], v[56:59], a[136:139], v[136:139]
v_mul_f32 v214, v87, v87
v_fma_f32 v212, v212, v237, v236
v_mfma_f32_16x16x32_bf16 v[136:139], v[60:63], a[152:155], v[136:139]
ds_read_b128 v[52:55], v2 offset:50176
v_fma_f32 v214, v214, v237, v236
v_mfma_f32_16x16x32_bf16 v[140:143], v[56:59], a[140:143], v[140:143]
v_mul_f32 v212, v212, v86
v_mul_f32 v214, v214, v87
v_mfma_f32_16x16x32_bf16 v[140:143], v[60:63], a[156:159], v[140:143]
v_mul_f32 v213, v86, v102
s_waitcnt lgkmcnt(4)
v_mfma_f32_16x16x32_bf16 v[112:115], v[64:67], a[160:163], v[112:115]
buffer_load_dwordx4 v3, s[8:11], 0 offen offset:1024 sc1 lds
v_mfma_f32_16x16x32_bf16 v[112:115], v[68:71], a[176:179], v[112:115]
v_exp_f32 v212, v212
v_mfma_f32_16x16x32_bf16 v[116:119], v[64:67], a[164:167], v[116:119]
ds_read_b128 v[56:59], v2 offset:51200
v_mul_f32 v215, v87, v103
v_mfma_f32_16x16x32_bf16 v[116:119], v[68:71], a[180:183], v[116:119]
v_exp_f32 v214, v214
v_mfma_f32_16x16x32_bf16 v[120:123], v[64:67], a[168:171], v[120:123]
v_fma_f32 v212, v212, v238, v238
v_fma_f32 v214, v214, v238, v238
v_mfma_f32_16x16x32_bf16 v[120:123], v[68:71], a[184:187], v[120:123]
ds_read_b128 v[60:63], v2 offset:52224
v_mul_f32 v208, v88, v88
v_mfma_f32_16x16x32_bf16 v[124:127], v[64:67], a[172:175], v[124:127]
buffer_load_dwordx4 v3, s[8:11], 0 offen offset:2048 sc1 lds
v_mfma_f32_16x16x32_bf16 v[124:127], v[68:71], a[188:191], v[124:127]
v_mul_f32 v210, v89, v89
s_waitcnt lgkmcnt(4)
v_mfma_f32_16x16x32_bf16 v[128:131], v[72:75], a[160:163], v[128:131]
v_rcp_f32 v212, v212
v_mfma_f32_16x16x32_bf16 v[128:131], v[76:79], a[176:179], v[128:131]
v_rcp_f32 v214, v214
v_mfma_f32_16x16x32_bf16 v[132:135], v[72:75], a[164:167], v[132:135]
ds_read_b128 v[64:67], v2 offset:53248
v_mul_f32 v213, v213, v212
v_mfma_f32_16x16x32_bf16 v[132:135], v[76:79], a[180:183], v[132:135]
buffer_load_dwordx4 v3, s[8:11], 0 offen offset:3072 sc1 lds
v_mfma_f32_16x16x32_bf16 v[136:139], v[72:75], a[168:171], v[136:139]
s_add_u32 m0, s22, 4096
v_add_u32 v3, 4096, v3
v_mfma_f32_16x16x32_bf16 v[136:139], v[76:79], a[184:187], v[136:139]
ds_read_b128 v[68:71], v2 offset:54272
v_mul_f32 v215, v215, v214
v_mfma_f32_16x16x32_bf16 v[140:143], v[72:75], a[172:175], v[140:143]
v_cvt_pk_bf16_f32 v181, v213, v215
v_fma_f32 v208, v208, v241, v240
v_mfma_f32_16x16x32_bf16 v[140:143], v[76:79], a[188:191], v[140:143]
v_fma_f32 v210, v210, v241, v240
s_waitcnt lgkmcnt(4)
v_mfma_f32_16x16x32_bf16 v[112:115], v[48:51], a[192:195], v[112:115]
buffer_load_dwordx4 v3, s[8:11], 0 offen offset:0 sc1 lds
v_mfma_f32_16x16x32_bf16 v[112:115], v[52:55], a[208:211], v[112:115]
v_mul_f32 v208, v208, v88
v_mul_f32 v210, v210, v89
v_mfma_f32_16x16x32_bf16 v[116:119], v[48:51], a[196:199], v[116:119]
ds_read_b128 v[72:75], v2 offset:55296
v_mul_f32 v209, v88, v104
v_mfma_f32_16x16x32_bf16 v[116:119], v[52:55], a[212:215], v[116:119]
v_exp_f32 v208, v208
v_mfma_f32_16x16x32_bf16 v[120:123], v[48:51], a[200:203], v[120:123]
v_exp_f32 v210, v210
v_mfma_f32_16x16x32_bf16 v[120:123], v[52:55], a[216:219], v[120:123]
ds_read_b128 v[76:79], v2 offset:56320
v_mul_f32 v211, v89, v105
v_mfma_f32_16x16x32_bf16 v[124:127], v[48:51], a[204:207], v[124:127]
buffer_load_dwordx4 v3, s[8:11], 0 offen offset:1024 sc1 lds
v_mfma_f32_16x16x32_bf16 v[124:127], v[52:55], a[220:223], v[124:127]
v_fma_f32 v208, v208, v242, v242
s_waitcnt lgkmcnt(4)
v_mfma_f32_16x16x32_bf16 v[128:131], v[56:59], a[192:195], v[128:131]
v_mov_b32 v12, s68
v_mov_b32 v13, s69
v_mfma_f32_16x16x32_bf16 v[128:131], v[60:63], a[208:211], v[128:131]
s_add_u32 s53, s34, 0
s_waitcnt vmcnt(6)
v_fma_f32 v210, v210, v242, v242
v_mfma_f32_16x16x32_bf16 v[132:135], v[56:59], a[196:199], v[132:135]
ds_read_b128 v[48:51], v2 offset:57344
v_rcp_f32 v208, v208
v_mfma_f32_16x16x32_bf16 v[132:135], v[60:63], a[212:215], v[132:135]
buffer_store_dwordx2 v[12:13], v10, s[8:11], s53 offen sc1
v_rcp_f32 v210, v210
v_mfma_f32_16x16x32_bf16 v[136:139], v[56:59], a[200:203], v[136:139]
v_mul_f32 v209, v209, v208
v_mul_f32 v211, v211, v210
v_mfma_f32_16x16x32_bf16 v[136:139], v[60:63], a[216:219], v[136:139]
ds_read_b128 v[52:55], v2 offset:58368
v_cvt_pk_bf16_f32 v184, v209, v211
v_mfma_f32_16x16x32_bf16 v[140:143], v[56:59], a[204:207], v[140:143]
v_mul_f32 v212, v90, v90
v_mul_f32 v214, v91, v91
v_mfma_f32_16x16x32_bf16 v[140:143], v[60:63], a[220:223], v[140:143]
v_fma_f32 v212, v212, v241, v240
s_waitcnt lgkmcnt(4)
v_mfma_f32_16x16x32_bf16 v[112:115], v[64:67], a[224:227], v[112:115]
v_fma_f32 v214, v214, v241, v240
v_mul_f32 v212, v212, v90
v_mfma_f32_16x16x32_bf16 v[112:115], v[68:71], a[240:243], v[112:115]
v_mul_f32 v214, v214, v91
v_exp_f32 v212, v212
v_mfma_f32_16x16x32_bf16 v[116:119], v[64:67], a[228:231], v[116:119]
ds_read_b128 v[56:59], v2 offset:59392
v_exp_f32 v214, v214
v_mfma_f32_16x16x32_bf16 v[116:119], v[68:71], a[244:247], v[116:119]
v_mul_f32 v213, v90, v106
v_mul_f32 v215, v91, v107
v_mfma_f32_16x16x32_bf16 v[120:123], v[64:67], a[232:235], v[120:123]
v_fma_f32 v212, v212, v242, v242
v_fma_f32 v214, v214, v242, v242
v_mfma_f32_16x16x32_bf16 v[120:123], v[68:71], a[248:251], v[120:123]
ds_read_b128 v[60:63], v2 offset:60416
v_rcp_f32 v212, v212
v_mfma_f32_16x16x32_bf16 v[124:127], v[64:67], a[236:239], v[124:127]
v_rcp_f32 v214, v214
v_mfma_f32_16x16x32_bf16 v[124:127], v[68:71], a[252:255], v[124:127]
v_mul_f32 v213, v213, v212
s_waitcnt lgkmcnt(4)
v_mfma_f32_16x16x32_bf16 v[128:131], v[72:75], a[224:227], v[128:131]
v_mul_f32 v215, v215, v214
v_cvt_pk_bf16_f32 v185, v213, v215
v_mfma_f32_16x16x32_bf16 v[128:131], v[76:79], a[240:243], v[128:131]
v_mul_f32 v208, v92, v92
v_mul_f32 v210, v93, v93
v_mfma_f32_16x16x32_bf16 v[132:135], v[72:75], a[228:231], v[132:135]
ds_read_b128 v[64:67], v2 offset:61440
v_fma_f32 v208, v208, v245, v244
v_mfma_f32_16x16x32_bf16 v[132:135], v[76:79], a[244:247], v[132:135]
v_fma_f32 v210, v210, v245, v244
v_mul_f32 v208, v208, v92
v_mfma_f32_16x16x32_bf16 v[136:139], v[72:75], a[232:235], v[136:139]
v_mul_f32 v210, v210, v93
v_exp_f32 v208, v208
v_mfma_f32_16x16x32_bf16 v[136:139], v[76:79], a[248:251], v[136:139]
ds_read_b128 v[68:71], v2 offset:62464
v_exp_f32 v210, v210
v_mfma_f32_16x16x32_bf16 v[140:143], v[72:75], a[236:239], v[140:143]
v_mul_f32 v209, v92, v108
v_mul_f32 v211, v93, v109
v_mfma_f32_16x16x32_bf16 v[140:143], v[76:79], a[252:255], v[140:143]
v_fma_f32 v208, v208, v246, v246
s_waitcnt lgkmcnt(4)
v_mfma_f32_16x16x32_bf16 v[112:115], v[48:51], v[16:19], v[112:115]
v_fma_f32 v210, v210, v246, v246
v_rcp_f32 v208, v208
v_mfma_f32_16x16x32_bf16 v[112:115], v[52:55], v[32:35], v[112:115]
v_rcp_f32 v210, v210
v_mfma_f32_16x16x32_bf16 v[116:119], v[48:51], v[20:23], v[116:119]
ds_read_b128 v[72:75], v2 offset:63488
v_mul_f32 v209, v209, v208
v_mfma_f32_16x16x32_bf16 v[116:119], v[52:55], v[36:39], v[116:119]
v_mul_f32 v211, v211, v210
v_cvt_pk_bf16_f32 v188, v209, v211
v_mfma_f32_16x16x32_bf16 v[120:123], v[48:51], v[24:27], v[120:123]
v_mul_f32 v212, v94, v94
v_mul_f32 v214, v95, v95
v_mfma_f32_16x16x32_bf16 v[120:123], v[52:55], v[40:43], v[120:123]
ds_read_b128 v[76:79], v2 offset:64512
v_fma_f32 v212, v212, v245, v244
v_mfma_f32_16x16x32_bf16 v[124:127], v[48:51], v[28:31], v[124:127]
v_fma_f32 v214, v214, v245, v244
v_mul_f32 v212, v212, v94
v_mfma_f32_16x16x32_bf16 v[124:127], v[52:55], v[44:47], v[124:127]
v_mul_f32 v214, v214, v95
s_waitcnt lgkmcnt(4)
v_mfma_f32_16x16x32_bf16 v[128:131], v[56:59], v[16:19], v[128:131]
v_exp_f32 v212, v212
v_mfma_f32_16x16x32_bf16 v[128:131], v[60:63], v[32:35], v[128:131]
v_exp_f32 v214, v214
v_mfma_f32_16x16x32_bf16 v[132:135], v[56:59], v[20:23], v[132:135]
ds_read_b128 v[48:51], v7 offset:0
v_mul_f32 v213, v94, v110
v_mfma_f32_16x16x32_bf16 v[132:135], v[60:63], v[36:39], v[132:135]
v_mul_f32 v215, v95, v111
v_fma_f32 v212, v212, v246, v246
v_mfma_f32_16x16x32_bf16 v[136:139], v[56:59], v[24:27], v[136:139]
v_fma_f32 v214, v214, v246, v246
v_rcp_f32 v212, v212
v_mfma_f32_16x16x32_bf16 v[136:139], v[60:63], v[40:43], v[136:139]
ds_read_b128 v[52:55], v7 offset:1024
v_rcp_f32 v214, v214
v_mfma_f32_16x16x32_bf16 v[140:143], v[56:59], v[28:31], v[140:143]
v_mul_f32 v213, v213, v212
v_mul_f32 v215, v215, v214
v_mfma_f32_16x16x32_bf16 v[140:143], v[60:63], v[44:47], v[140:143]
v_cvt_pk_bf16_f32 v189, v213, v215
s_waitcnt lgkmcnt(4)
v_mfma_f32_16x16x32_bf16 v[80:83], v[64:67], a[0:3], 0
v_mfma_f32_16x16x32_bf16 v[80:83], v[68:71], a[16:19], v[80:83]
v_mfma_f32_16x16x32_bf16 v[84:87], v[64:67], a[4:7], 0
ds_read_b128 v[56:59], v7 offset:2048
v_mfma_f32_16x16x32_bf16 v[84:87], v[68:71], a[20:23], v[84:87]
v_mul_f32 v208, v112, v112
v_mul_f32 v210, v113, v113
v_mfma_f32_16x16x32_bf16 v[88:91], v[64:67], a[8:11], 0
v_fma_f32 v208, v208, v233, v232
v_fma_f32 v210, v210, v233, v232
v_mfma_f32_16x16x32_bf16 v[88:91], v[68:71], a[24:27], v[88:91]
ds_read_b128 v[60:63], v7 offset:3072
v_mul_f32 v208, v208, v112
v_mfma_f32_16x16x32_bf16 v[92:95], v[64:67], a[12:15], 0
v_mul_f32 v210, v210, v113
v_mul_f32 v209, v112, v128
v_mfma_f32_16x16x32_bf16 v[92:95], v[68:71], a[28:31], v[92:95]
v_mul_f32 v211, v113, v129
s_waitcnt lgkmcnt(4)
v_mfma_f32_16x16x32_bf16 v[96:99], v[72:75], a[0:3], 0
v_exp_f32 v208, v208
v_mfma_f32_16x16x32_bf16 v[96:99], v[76:79], a[16:19], v[96:99]
v_exp_f32 v210, v210
v_mfma_f32_16x16x32_bf16 v[100:103], v[72:75], a[4:7], 0
ds_read_b128 v[64:67], v7 offset:4096
v_fma_f32 v208, v208, v234, v234
v_mfma_f32_16x16x32_bf16 v[100:103], v[76:79], a[20:23], v[100:103]
v_fma_f32 v210, v210, v234, v234
v_mul_f32 v212, v114, v114
v_mfma_f32_16x16x32_bf16 v[104:107], v[72:75], a[8:11], 0
v_rcp_f32 v208, v208
v_mfma_f32_16x16x32_bf16 v[104:107], v[76:79], a[24:27], v[104:107]
ds_read_b128 v[68:71], v7 offset:5120
v_mul_f32 v209, v209, v208
v_mfma_f32_16x16x32_bf16 v[108:111], v[72:75], a[12:15], 0
v_rcp_f32 v210, v210
v_mfma_f32_16x16x32_bf16 v[108:111], v[76:79], a[28:31], v[108:111]
v_mul_f32 v211, v211, v210
s_waitcnt lgkmcnt(4)
v_mfma_f32_16x16x32_bf16 v[80:83], v[48:51], a[32:35], v[80:83]
v_cvt_pk_bf16_f32 v178, v209, v211
v_mul_f32 v214, v115, v115
v_mfma_f32_16x16x32_bf16 v[80:83], v[52:55], a[48:51], v[80:83]
v_fma_f32 v212, v212, v233, v232
v_fma_f32 v214, v214, v233, v232
v_mfma_f32_16x16x32_bf16 v[84:87], v[48:51], a[36:39], v[84:87]
ds_read_b128 v[72:75], v7 offset:6144
v_mul_f32 v212, v212, v114
v_mfma_f32_16x16x32_bf16 v[84:87], v[52:55], a[52:55], v[84:87]
v_mul_f32 v214, v214, v115
v_mul_f32 v213, v114, v130
v_mfma_f32_16x16x32_bf16 v[88:91], v[48:51], a[40:43], v[88:91]
v_exp_f32 v212, v212
v_mfma_f32_16x16x32_bf16 v[88:91], v[52:55], a[56:59], v[88:91]
ds_read_b128 v[76:79], v7 offset:7168
v_mul_f32 v215, v115, v131
v_mfma_f32_16x16x32_bf16 v[92:95], v[48:51], a[44:47], v[92:95]
v_exp_f32 v214, v214
v_mfma_f32_16x16x32_bf16 v[92:95], v[52:55], a[60:63], v[92:95]
v_fma_f32 v212, v212, v234, v234
s_waitcnt lgkmcnt(4)
v_mfma_f32_16x16x32_bf16 v[96:99], v[56:59], a[32:35], v[96:99]
s_waitcnt vmcnt(26)
v_fma_f32 v214, v214, v234, v234
v_mfma_f32_16x16x32_bf16 v[96:99], v[60:63], a[48:51], v[96:99]
s_barrier
v_mfma_f32_16x16x32_bf16 v[100:103], v[56:59], a[36:39], v[100:103]
ds_read_b128 v[48:51], v7 offset:8192
s_add_u32 m0, s22, 24576
v_mfma_f32_16x16x32_bf16 v[100:103], v[60:63], a[52:55], v[100:103]
v_add_u32 v3, 20480, v3
buffer_load_dwordx4 v3, s[8:11], 0 offen offset:0 sc1 lds
v_mfma_f32_16x16x32_bf16 v[104:107], v[56:59], a[40:43], v[104:107]
v_rcp_f32 v212, v212
v_mfma_f32_16x16x32_bf16 v[104:107], v[60:63], a[56:59], v[104:107]
ds_read_b128 v[52:55], v7 offset:9216
v_mul_f32 v213, v213, v212
v_mfma_f32_16x16x32_bf16 v[108:111], v[56:59], a[44:47], v[108:111]
v_rcp_f32 v214, v214
v_mfma_f32_16x16x32_bf16 v[108:111], v[60:63], a[60:63], v[108:111]
v_mul_f32 v215, v215, v214
s_waitcnt lgkmcnt(4)
v_mfma_f32_16x16x32_bf16 v[80:83], v[64:67], a[64:67], v[80:83]
buffer_load_dwordx4 v3, s[8:11], 0 offen offset:1024 sc1 lds
v_mfma_f32_16x16x32_bf16 v[80:83], v[68:71], a[80:83], v[80:83]
v_cvt_pk_bf16_f32 v179, v213, v215
v_mul_f32 v208, v116, v116
v_mfma_f32_16x16x32_bf16 v[84:87], v[64:67], a[68:71], v[84:87]
ds_read_b128 v[56:59], v7 offset:10240
v_mul_f32 v210, v117, v117
v_mfma_f32_16x16x32_bf16 v[84:87], v[68:71], a[84:87], v[84:87]
buffer_store_dwordx4 v[176:179], v2, s[8:11], s24 offen offset:2048 sc1
v_mfma_f32_16x16x32_bf16 v[88:91], v[64:67], a[72:75], v[88:91]
v_fma_f32 v208, v208, v237, v236
v_fma_f32 v210, v210, v237, v236
v_mfma_f32_16x16x32_bf16 v[88:91], v[68:71], a[88:91], v[88:91]
ds_read_b128 v[60:63], v7 offset:11264
v_mul_f32 v208, v208, v116
v_mfma_f32_16x16x32_bf16 v[92:95], v[64:67], a[76:79], v[92:95]
v_mul_f32 v210, v210, v117
v_mul_f32 v209, v116, v132
v_mfma_f32_16x16x32_bf16 v[92:95], v[68:71], a[92:95], v[92:95]
v_mul_f32 v211, v117, v133
s_waitcnt lgkmcnt(4)
v_mfma_f32_16x16x32_bf16 v[96:99], v[72:75], a[64:67], v[96:99]
buffer_load_dwordx4 v3, s[8:11], 0 offen offset:2048 sc1 lds
v_mfma_f32_16x16x32_bf16 v[96:99], v[76:79], a[80:83], v[96:99]
v_exp_f32 v208, v208
v_mfma_f32_16x16x32_bf16 v[100:103], v[72:75], a[68:71], v[100:103]
ds_read_b128 v[64:67], v7 offset:12288
v_fma_f32 v208, v208, v238, v238
v_mfma_f32_16x16x32_bf16 v[100:103], v[76:79], a[84:87], v[100:103]
v_exp_f32 v210, v210
v_mfma_f32_16x16x32_bf16 v[104:107], v[72:75], a[72:75], v[104:107]
v_fma_f32 v210, v210, v238, v238
v_mul_f32 v212, v118, v118
v_mfma_f32_16x16x32_bf16 v[104:107], v[76:79], a[88:91], v[104:107]
ds_read_b128 v[68:71], v7 offset:13312
v_mul_f32 v214, v119, v119
v_mfma_f32_16x16x32_bf16 v[108:111], v[72:75], a[76:79], v[108:111]
buffer_load_dwordx4 v3, s[8:11], 0 offen offset:3072 sc1 lds
v_mfma_f32_16x16x32_bf16 v[108:111], v[76:79], a[92:95], v[108:111]
s_add_u32 m0, s22, 28672
s_waitcnt lgkmcnt(4)
v_mfma_f32_16x16x32_bf16 v[80:83], v[48:51], a[96:99], v[80:83]
s_add_u32 s23, s34, 0
v_fma_f32 v212, v212, v237, v236
v_mfma_f32_16x16x32_bf16 v[80:83], v[52:55], a[112:115], v[80:83]
v_rcp_f32 v208, v208
v_mfma_f32_16x16x32_bf16 v[84:87], v[48:51], a[100:103], v[84:87]
ds_read_b128 v[72:75], v7 offset:14336
v_mul_f32 v209, v209, v208
v_mfma_f32_16x16x32_bf16 v[84:87], v[52:55], a[116:119], v[84:87]
buffer_load_dwordx2 v[14:15], v11, s[8:11], s23 offen sc1
v_mfma_f32_16x16x32_bf16 v[88:91], v[48:51], a[104:107], v[88:91]
v_add_u32 v3, 4096, v3
v_fma_f32 v214, v214, v237, v236
v_mfma_f32_16x16x32_bf16 v[88:91], v[52:55], a[120:123], v[88:91]
ds_read_b128 v[76:79], v7 offset:15360
v_mul_f32 v212, v212, v118
v_mfma_f32_16x16x32_bf16 v[92:95], v[48:51], a[108:111], v[92:95]
v_rcp_f32 v210, v210
v_mfma_f32_16x16x32_bf16 v[92:95], v[52:55], a[124:127], v[92:95]
v_mul_f32 v211, v211, v210
s_waitcnt lgkmcnt(4)
v_mfma_f32_16x16x32_bf16 v[96:99], v[56:59], a[96:99], v[96:99]
buffer_load_dwordx4 v3, s[8:11], 0 offen offset:0 sc1 lds
v_mfma_f32_16x16x32_bf16 v[96:99], v[60:63], a[112:115], v[96:99]
v_cvt_pk_bf16_f32 v182, v209, v211
v_mul_f32 v214, v214, v119
v_mfma_f32_16x16x32_bf16 v[100:103], v[56:59], a[100:103], v[100:103]
ds_read_b128 v[48:51], v7 offset:16384
v_mul_f32 v213, v118, v134
v_mfma_f32_16x16x32_bf16 v[100:103], v[60:63], a[116:119], v[100:103]
v_exp_f32 v212, v212
v_mfma_f32_16x16x32_bf16 v[104:107], v[56:59], a[104:107], v[104:107]
v_exp_f32 v214, v214
v_mfma_f32_16x16x32_bf16 v[104:107], v[60:63], a[120:123], v[104:107]
ds_read_b128 v[52:55], v7 offset:17408
v_mul_f32 v215, v119, v135
v_mfma_f32_16x16x32_bf16 v[108:111], v[56:59], a[108:111], v[108:111]
buffer_load_dwordx4 v3, s[8:11], 0 offen offset:1024 sc1 lds
v_mfma_f32_16x16x32_bf16 v[108:111], v[60:63], a[124:127], v[108:111]
v_fma_f32 v212, v212, v238, v238
s_waitcnt lgkmcnt(4)
v_mfma_f32_16x16x32_bf16 v[80:83], v[64:67], a[128:131], v[80:83]
v_fma_f32 v214, v214, v238, v238
v_mul_f32 v208, v120, v120
v_mfma_f32_16x16x32_bf16 v[80:83], v[68:71], a[144:147], v[80:83]
v_rcp_f32 v212, v212
v_mfma_f32_16x16x32_bf16 v[84:87], v[64:67], a[132:135], v[84:87]
ds_read_b128 v[56:59], v7 offset:18432
v_mul_f32 v213, v213, v212
v_mfma_f32_16x16x32_bf16 v[84:87], v[68:71], a[148:151], v[84:87]
v_rcp_f32 v214, v214
v_mfma_f32_16x16x32_bf16 v[88:91], v[64:67], a[136:139], v[88:91]
v_mul_f32 v215, v215, v214
v_cvt_pk_bf16_f32 v183, v213, v215
v_mfma_f32_16x16x32_bf16 v[88:91], v[68:71], a[152:155], v[88:91]
ds_read_b128 v[60:63], v7 offset:19456
v_mul_f32 v210, v121, v121
v_mfma_f32_16x16x32_bf16 v[92:95], v[64:67], a[140:143], v[92:95]
buffer_store_dwordx4 v[180:183], v4, s[8:11], s24 offen offset:2048 sc1
v_mfma_f32_16x16x32_bf16 v[92:95], v[68:71], a[156:159], v[92:95]
v_fma_f32 v208, v208, v241, v240
s_waitcnt lgkmcnt(4)
v_mfma_f32_16x16x32_bf16 v[96:99], v[72:75], a[128:131], v[96:99]
v_fma_f32 v210, v210, v241, v240
v_mul_f32 v208, v208, v120
v_mfma_f32_16x16x32_bf16 v[96:99], v[76:79], a[144:147], v[96:99]
v_mul_f32 v210, v210, v121
v_mul_f32 v209, v120, v136
v_mfma_f32_16x16x32_bf16 v[100:103], v[72:75], a[132:135], v[100:103]
ds_read_b128 v[64:67], v7 offset:20480
v_mul_f32 v211, v121, v137
v_mfma_f32_16x16x32_bf16 v[100:103], v[76:79], a[148:151], v[100:103]
v_exp_f32 v208, v208
v_mfma_f32_16x16x32_bf16 v[104:107], v[72:75], a[136:139], v[104:107]
v_exp_f32 v210, v210
v_mfma_f32_16x16x32_bf16 v[104:107], v[76:79], a[152:155], v[104:107]
ds_read_b128 v[68:71], v7 offset:21504
v_fma_f32 v208, v208, v242, v242
v_mfma_f32_16x16x32_bf16 v[108:111], v[72:75], a[140:143], v[108:111]
v_fma_f32 v210, v210, v242, v242
v_mul_f32 v212, v122, v122
v_mfma_f32_16x16x32_bf16 v[108:111], v[76:79], a[156:159], v[108:111]
v_mul_f32 v214, v123, v123
s_waitcnt lgkmcnt(4)
v_mfma_f32_16x16x32_bf16 v[80:83], v[48:51], a[160:163], v[80:83]
v_rcp_f32 v208, v208
v_mfma_f32_16x16x32_bf16 v[80:83], v[52:55], a[176:179], v[80:83]
v_rcp_f32 v210, v210
v_mfma_f32_16x16x32_bf16 v[84:87], v[48:51], a[164:167], v[84:87]
ds_read_b128 v[72:75], v7 offset:22528
v_mul_f32 v209, v209, v208
v_mfma_f32_16x16x32_bf16 v[84:87], v[52:55], a[180:183], v[84:87]
v_mul_f32 v211, v211, v210
v_cvt_pk_bf16_f32 v186, v209, v211
v_mfma_f32_16x16x32_bf16 v[88:91], v[48:51], a[168:171], v[88:91]
L_hop7:
s_cmp_eq_u32 s15, 1
s_cbranch_scc1 L_hop11
v_fma_f32 v212, v212, v241, v240
v_fma_f32 v214, v214, v241, v240
v_mfma_f32_16x16x32_bf16 v[88:91], v[52:55], a[184:187], v[88:91]
ds_read_b128 v[76:79], v7 offset:23552
v_mul_f32 v212, v212, v122
v_mfma_f32_16x16x32_bf16 v[92:95], v[48:51], a[172:175], v[92:95]
v_mul_f32 v214, v214, v123
v_mul_f32 v213, v122, v138
v_mfma_f32_16x16x32_bf16 v[92:95], v[52:55], a[188:191], v[92:95]
v_mul_f32 v215, v123, v139
s_waitcnt lgkmcnt(4)
v_mfma_f32_16x16x32_bf16 v[96:99], v[56:59], a[160:163], v[96:99]
v_exp_f32 v212, v212
v_mfma_f32_16x16x32_bf16 v[96:99], v[60:63], a[176:179], v[96:99]
v_exp_f32 v214, v214
v_mfma_f32_16x16x32_bf16 v[100:103], v[56:59], a[164:167], v[100:103]
ds_read_b128 v[48:51], v7 offset:24576
v_fma_f32 v212, v212, v242, v242
v_mfma_f32_16x16x32_bf16 v[100:103], v[60:63], a[180:183], v[100:103]
v_fma_f32 v214, v214, v242, v242
v_mul_f32 v208, v124, v124
v_mfma_f32_16x16x32_bf16 v[104:107], v[56:59], a[168:171], v[104:107]
v_rcp_f32 v212, v212
v_mfma_f32_16x16x32_bf16 v[104:107], v[60:63], a[184:187], v[104:107]
ds_read_b128 v[52:55], v7 offset:25600
v_mfma_f32_16x16x32_bf16 v[108:111], v[56:59], a[172:175], v[108:111]
v_rcp_f32 v214, v214
v_mfma_f32_16x16x32_bf16 v[108:111], v[60:63], a[188:191], v[108:111]
s_waitcnt lgkmcnt(4)
v_mfma_f32_16x16x32_bf16 v[80:83], v[64:67], a[192:195], v[80:83]
v_mul_f32 v213, v213, v212
v_mul_f32 v215, v215, v214
v_mfma_f32_16x16x32_bf16 v[80:83], v[68:71], a[208:211], v[80:83]
v_cvt_pk_bf16_f32 v187, v213, v215
v_mul_f32 v210, v125, v125
v_mfma_f32_16x16x32_bf16 v[84:87], v[64:67], a[196:199], v[84:87]
ds_read_b128 v[56:59], v7 offset:26624
v_mfma_f32_16x16x32_bf16 v[84:87], v[68:71], a[212:215], v[84:87]
buffer_store_dwordx4 v[184:187], v5, s[8:11], s24 offen offset:2048 sc1
v_mfma_f32_16x16x32_bf16 v[88:91], v[64:67], a[200:203], v[88:91]
v_mfma_f32_16x16x32_bf16 v[88:91], v[68:71], a[216:219], v[88:91]
ds_read_b128 v[60:63], v7 offset:27648
v_fma_f32 v208, v208, v245, v244
v_mfma_f32_16x16x32_bf16 v[92:95], v[64:67], a[204:207], v[92:95]
v_fma_f32 v210, v210, v245, v244
v_mul_f32 v208, v208, v124
v_mfma_f32_16x16x32_bf16 v[92:95], v[68:71], a[220:223], v[92:95]
v_mul_f32 v210, v210, v125
s_waitcnt lgkmcnt(4)
v_mfma_f32_16x16x32_bf16 v[96:99], v[72:75], a[192:195], v[96:99]
v_exp_f32 v208, v208
v_mfma_f32_16x16x32_bf16 v[96:99], v[76:79], a[208:211], v[96:99]
v_mfma_f32_16x16x32_bf16 v[100:103], v[72:75], a[196:199], v[100:103]
ds_read_b128 v[64:67], v7 offset:28672
v_mul_f32 v209, v124, v140
v_mfma_f32_16x16x32_bf16 v[100:103], v[76:79], a[212:215], v[100:103]
v_exp_f32 v210, v210
v_mfma_f32_16x16x32_bf16 v[104:107], v[72:75], a[200:203], v[104:107]
v_mfma_f32_16x16x32_bf16 v[104:107], v[76:79], a[216:219], v[104:107]
ds_read_b128 v[68:71], v7 offset:29696
v_mul_f32 v211, v125, v141
v_mfma_f32_16x16x32_bf16 v[108:111], v[72:75], a[204:207], v[108:111]
v_fma_f32 v208, v208, v246, v246
v_fma_f32 v210, v210, v246, v246
v_mfma_f32_16x16x32_bf16 v[108:111], v[76:79], a[220:223], v[108:111]
v_mul_f32 v212, v126, v126
s_waitcnt lgkmcnt(4)
v_mfma_f32_16x16x32_bf16 v[80:83], v[48:51], a[224:227], v[80:83]
v_rcp_f32 v208, v208
v_mfma_f32_16x16x32_bf16 v[80:83], v[52:55], a[240:243], v[80:83]
v_mfma_f32_16x16x32_bf16 v[84:87], v[48:51], a[228:231], v[84:87]
ds_read_b128 v[72:75], v7 offset:30720
v_mul_f32 v209, v209, v208
v_mfma_f32_16x16x32_bf16 v[84:87], v[52:55], a[244:247], v[84:87]
v_rcp_f32 v210, v210
v_mfma_f32_16x16x32_bf16 v[88:91], v[48:51], a[232:235], v[88:91]
v_mul_f32 v211, v211, v210
v_cvt_pk_bf16_f32 v190, v209, v211
v_mfma_f32_16x16x32_bf16 v[88:91], v[52:55], a[248:251], v[88:91]
ds_read_b128 v[76:79], v7 offset:31744
v_mfma_f32_16x16x32_bf16 v[92:95], v[48:51], a[236:239], v[92:95]
v_mul_f32 v214, v127, v127
v_fma_f32 v212, v212, v245, v244
v_mfma_f32_16x16x32_bf16 v[92:95], v[52:55], a[252:255], v[92:95]
s_waitcnt lgkmcnt(4)
v_mfma_f32_16x16x32_bf16 v[96:99], v[56:59], a[224:227], v[96:99]
s_waitcnt vmcnt(28)
v_fma_f32 v214, v214, v245, v244
v_mfma_f32_16x16x32_bf16 v[96:99], v[60:63], a[240:243], v[96:99]
s_barrier
v_mfma_f32_16x16x32_bf16 v[100:103], v[56:59], a[228:231], v[100:103]
ds_read_b128 v[48:51], v7 offset:32768
s_add_u32 m0, s22, 49152
v_mfma_f32_16x16x32_bf16 v[100:103], v[60:63], a[244:247], v[100:103]
v_add_u32 v3, 20480, v3
buffer_load_dwordx4 v3, s[8:11], 0 offen offset:0 sc1 lds
v_mfma_f32_16x16x32_bf16 v[104:107], v[56:59], a[232:235], v[104:107]
v_mul_f32 v212, v212, v126
v_mul_f32 v214, v214, v127
v_mfma_f32_16x16x32_bf16 v[104:107], v[60:63], a[248:251], v[104:107]
ds_read_b128 v[52:55], v7 offset:33792
v_mul_f32 v213, v126, v142
v_mfma_f32_16x16x32_bf16 v[108:111], v[56:59], a[236:239], v[108:111]
v_exp_f32 v212, v212
v_mfma_f32_16x16x32_bf16 v[108:111], v[60:63], a[252:255], v[108:111]
v_mul_f32 v215, v127, v143
s_waitcnt lgkmcnt(4)
v_mfma_f32_16x16x32_bf16 v[80:83], v[64:67], v[16:19], v[80:83]
buffer_load_dwordx4 v3, s[8:11], 0 offen offset:1024 sc1 lds
v_mfma_f32_16x16x32_bf16 v[80:83], v[68:71], v[32:35], v[80:83]
v_exp_f32 v214, v214
v_mfma_f32_16x16x32_bf16 v[84:87], v[64:67], v[20:23], v[84:87]
ds_read_b128 v[56:59], v7 offset:34816
v_fma_f32 v212, v212, v246, v246
v_mfma_f32_16x16x32_bf16 v[84:87], v[68:71], v[36:39], v[84:87]
v_fma_f32 v214, v214, v246, v246
v_mfma_f32_16x16x32_bf16 v[88:91], v[64:67], v[24:27], v[88:91]
v_rcp_f32 v212, v212
v_mfma_f32_16x16x32_bf16 v[88:91], v[68:71], v[40:43], v[88:91]
ds_read_b128 v[60:63], v7 offset:35840
v_mul_f32 v213, v213, v212
v_mfma_f32_16x16x32_bf16 v[92:95], v[64:67], v[28:31], v[92:95]
buffer_load_dwordx4 v3, s[8:11], 0 offen offset:2048 sc1 lds
v_mfma_f32_16x16x32_bf16 v[92:95], v[68:71], v[44:47], v[92:95]
s_waitcnt lgkmcnt(4)
v_mfma_f32_16x16x32_bf16 v[96:99], v[72:75], v[16:19], v[96:99]
s_waitcnt vmcnt(7)
v_cmp_eq_u64 vcc, s[68:69], v[14:15]
s_nop 0
s_cmp_eq_u64 vcc, exec
s_cbranch_scc0 L_f_slow1
L_f_back1:
v_mfma_f32_16x16x32_bf16 v[96:99], v[76:79], v[32:35], v[96:99]
v_rcp_f32 v214, v214
v_mfma_f32_16x16x32_bf16 v[100:103], v[72:75], v[20:23], v[100:103]
ds_read_b128 v[64:67], v7 offset:36864
v_mul_f32 v215, v215, v214
v_mfma_f32_16x16x32_bf16 v[100:103], v[76:79], v[36:39], v[100:103]
buffer_load_dwordx4 v3, s[8:11], 0 offen offset:3072 sc1 lds
v_mfma_f32_16x16x32_bf16 v[104:107], v[72:75], v[24:27], v[104:107]
s_add_u32 m0, s22, 53248
v_add_u32 v3, 4096, v3
v_mfma_f32_16x16x32_bf16 v[104:107], v[76:79], v[40:43], v[104:107]
ds_read_b128 v[68:71], v7 offset:37888
v_cvt_pk_bf16_f32 v191, v213, v215
v_mfma_f32_16x16x32_bf16 v[108:111], v[72:75], v[28:31], v[108:111]
buffer_store_dwordx4 v[188:191], v6, s[8:11], s24 offen offset:2048 sc1
v_mfma_f32_16x16x32_bf16 v[108:111], v[76:79], v[44:47], v[108:111]
s_waitcnt lgkmcnt(4)
v_mfma_f32_16x16x32_bf16 v[112:115], v[48:51], a[0:3], 0
v_mfma_f32_16x16x32_bf16 v[112:115], v[52:55], a[16:19], v[112:115]
v_mfma_f32_16x16x32_bf16 v[116:119], v[48:51], a[4:7], 0
ds_read_b128 v[72:75], v7 offset:38912
v_mfma_f32_16x16x32_bf16 v[116:119], v[52:55], a[20:23], v[116:119]
buffer_load_dwordx4 v3, s[8:11], 0 offen offset:0 sc1 lds
v_mfma_f32_16x16x32_bf16 v[120:123], v[48:51], a[8:11], 0
v_mul_f32 v208, v80, v80
v_mul_f32 v210, v81, v81
v_mfma_f32_16x16x32_bf16 v[120:123], v[52:55], a[24:27], v[120:123]
ds_read_b128 v[76:79], v7 offset:39936
v_fma_f32 v208, v208, v233, v232
v_mfma_f32_16x16x32_bf16 v[124:127], v[48:51], a[12:15], 0
v_fma_f32 v210, v210, v233, v232
v_mul_f32 v208, v208, v80
v_mfma_f32_16x16x32_bf16 v[124:127], v[52:55], a[28:31], v[124:127]
v_mul_f32 v210, v210, v81
s_waitcnt lgkmcnt(4)
v_mfma_f32_16x16x32_bf16 v[128:131], v[56:59], a[0:3], 0
buffer_load_dwordx4 v3, s[8:11], 0 offen offset:1024 sc1 lds
v_mfma_f32_16x16x32_bf16 v[128:131], v[60:63], a[16:19], v[128:131]
v_exp_f32 v208, v208
v_mfma_f32_16x16x32_bf16 v[132:135], v[56:59], a[4:7], 0
ds_read_b128 v[48:51], v7 offset:40960
v_mul_f32 v209, v80, v96
v_mfma_f32_16x16x32_bf16 v[132:135], v[60:63], a[20:23], v[132:135]
v_exp_f32 v210, v210
v_mfma_f32_16x16x32_bf16 v[136:139], v[56:59], a[8:11], 0
v_mul_f32 v211, v81, v97
v_fma_f32 v208, v208, v234, v234
v_mfma_f32_16x16x32_bf16 v[136:139], v[60:63], a[24:27], v[136:139]
ds_read_b128 v[52:55], v7 offset:41984
v_fma_f32 v210, v210, v234, v234
v_mfma_f32_16x16x32_bf16 v[140:143], v[56:59], a[12:15], 0
v_rcp_f32 v208, v208
v_mfma_f32_16x16x32_bf16 v[140:143], v[60:63], a[28:31], v[140:143]
v_mul_f32 v209, v209, v208
s_waitcnt lgkmcnt(4)
v_mfma_f32_16x16x32_bf16 v[112:115], v[64:67], a[32:35], v[112:115]
buffer_load_dwordx4 a[0:3], v2, s[8:11], s25 offen offset:0 sc1
v_mfma_f32_16x16x32_bf16 v[112:115], v[68:71], a[48:51], v[112:115]
v_rcp_f32 v210, v210
v_mfma_f32_16x16x32_bf16 v[116:119], v[64:67], a[36:39], v[116:119]
ds_read_b128 v[56:59], v7 offset:43008
v_mul_f32 v211, v211, v210
v_mfma_f32_16x16x32_bf16 v[116:119], v[68:71], a[52:55], v[116:119]
v_cvt_pk_bf16_f32 v192, v209, v211
v_mul_f32 v212, v82, v82
v_mfma_f32_16x16x32_bf16 v[120:123], v[64:67], a[40:43], v[120:123]
v_mul_f32 v214, v83, v83
v_fma_f32 v212, v212, v233, v232
v_mfma_f32_16x16x32_bf16 v[120:123], v[68:71], a[56:59], v[120:123]
ds_read_b128 v[60:63], v7 offset:44032
v_fma_f32 v214, v214, v233, v232
v_mfma_f32_16x16x32_bf16 v[124:127], v[64:67], a[44:47], v[124:127]
buffer_load_dwordx4 a[4:7], v4, s[8:11], s25 offen offset:0 sc1
v_mfma_f32_16x16x32_bf16 v[124:127], v[68:71], a[60:63], v[124:127]
v_mul_f32 v212, v212, v82
s_waitcnt lgkmcnt(4)
v_mfma_f32_16x16x32_bf16 v[128:131], v[72:75], a[32:35], v[128:131]
v_mul_f32 v214, v214, v83
v_mul_f32 v213, v82, v98
v_mfma_f32_16x16x32_bf16 v[128:131], v[76:79], a[48:51], v[128:131]
v_exp_f32 v212, v212
v_mfma_f32_16x16x32_bf16 v[132:135], v[72:75], a[36:39], v[132:135]
ds_read_b128 v[64:67], v7 offset:45056
v_mul_f32 v215, v83, v99
v_mfma_f32_16x16x32_bf16 v[132:135], v[76:79], a[52:55], v[132:135]
buffer_load_dwordx4 a[8:11], v5, s[8:11], s25 offen offset:0 sc1
v_mfma_f32_16x16x32_bf16 v[136:139], v[72:75], a[40:43], v[136:139]
v_exp_f32 v214, v214
v_mfma_f32_16x16x32_bf16 v[136:139], v[76:79], a[56:59], v[136:139]
ds_read_b128 v[68:71], v7 offset:46080
v_fma_f32 v212, v212, v234, v234
v_mfma_f32_16x16x32_bf16 v[140:143], v[72:75], a[44:47], v[140:143]
v_fma_f32 v214, v214, v234, v234
v_mul_f32 v208, v84, v84
v_mfma_f32_16x16x32_bf16 v[140:143], v[76:79], a[60:63], v[140:143]
v_mul_f32 v210, v85, v85
s_waitcnt lgkmcnt(4)
v_mfma_f32_16x16x32_bf16 v[112:115], v[48:51], a[64:67], v[112:115]
buffer_load_dwordx4 a[12:15], v6, s[8:11], s25 offen offset:0 sc1
v_mfma_f32_16x16x32_bf16 v[112:115], v[52:55], a[80:83], v[112:115]
v_rcp_f32 v212, v212
v_mfma_f32_16x16x32_bf16 v[116:119], v[48:51], a[68:71], v[116:119]
ds_read_b128 v[72:75], v7 offset:47104
v_mul_f32 v213, v213, v212
v_mfma_f32_16x16x32_bf16 v[116:119], v[52:55], a[84:87], v[116:119]
v_rcp_f32 v214, v214
v_mfma_f32_16x16x32_bf16 v[120:123], v[48:51], a[72:75], v[120:123]
v_mul_f32 v215, v215, v214
v_cvt_pk_bf16_f32 v193, v213, v215
v_mfma_f32_16x16x32_bf16 v[120:123], v[52:55], a[88:91], v[120:123]
ds_read_b128 v[76:79], v7 offset:48128
v_fma_f32 v208, v208, v237, v236
v_mfma_f32_16x16x32_bf16 v[124:127], v[48:51], a[76:79], v[124:127]
buffer_load_dwordx4 a[16:19], v2, s[8:11], s26 offen offset:0 sc1
v_mfma_f32_16x16x32_bf16 v[124:127], v[52:55], a[92:95], v[124:127]
v_fma_f32 v210, v210, v237, v236
s_waitcnt lgkmcnt(4)
v_mfma_f32_16x16x32_bf16 v[128:131], v[56:59], a[64:67], v[128:131]
v_mul_f32 v208, v208, v84
v_mul_f32 v210, v210, v85
v_mfma_f32_16x16x32_bf16 v[128:131], v[60:63], a[80:83], v[128:131]
v_exp_f32 v208, v208
v_mfma_f32_16x16x32_bf16 v[132:135], v[56:59], a[68:71], v[132:135]
ds_read_b128 v[48:51], v7 offset:49152
v_mul_f32 v209, v84, v100
v_mfma_f32_16x16x32_bf16 v[132:135], v[60:63], a[84:87], v[132:135]
buffer_load_dwordx4 a[20:23], v4, s[8:11], s26 offen offset:0 sc1
v_mfma_f32_16x16x32_bf16 v[136:139], v[56:59], a[72:75], v[136:139]
v_exp_f32 v210, v210
v_mfma_f32_16x16x32_bf16 v[136:139], v[60:63], a[88:91], v[136:139]
ds_read_b128 v[52:55], v7 offset:50176
v_mul_f32 v211, v85, v101
v_mfma_f32_16x16x32_bf16 v[140:143], v[56:59], a[76:79], v[140:143]
v_fma_f32 v208, v208, v238, v238
v_fma_f32 v210, v210, v238, v238
v_mfma_f32_16x16x32_bf16 v[140:143], v[60:63], a[92:95], v[140:143]
v_mul_f32 v212, v86, v86
s_waitcnt lgkmcnt(4)
v_mfma_f32_16x16x32_bf16 v[112:115], v[64:67], a[96:99], v[112:115]
v_mov_b32 v12, s68
v_mov_b32 v13, s69
v_mfma_f32_16x16x32_bf16 v[112:115], v[68:71], a[112:115], v[112:115]
s_add_u32 s53, s34, 131072
s_waitcnt vmcnt(8)
buffer_store_dwordx2 v[12:13], v10, s[8:11], s53 offen sc1
v_mfma_f32_16x16x32_bf16 v[116:119], v[64:67], a[100:103], v[116:119]
ds_read_b128 v[56:59], v7 offset:51200
v_mul_f32 v214, v87, v87
v_mfma_f32_16x16x32_bf16 v[116:119], v[68:71], a[116:119], v[116:119]
v_rcp_f32 v208, v208
v_mfma_f32_16x16x32_bf16 v[120:123], v[64:67], a[104:107], v[120:123]
v_rcp_f32 v210, v210
v_mfma_f32_16x16x32_bf16 v[120:123], v[68:71], a[120:123], v[120:123]
ds_read_b128 v[60:63], v7 offset:52224
v_mul_f32 v209, v209, v208
v_mfma_f32_16x16x32_bf16 v[124:127], v[64:67], a[108:111], v[124:127]
buffer_load_dwordx4 a[24:27], v5, s[8:11], s26 offen offset:0 sc1
v_mfma_f32_16x16x32_bf16 v[124:127], v[68:71], a[124:127], v[124:127]
v_mul_f32 v211, v211, v210
s_waitcnt lgkmcnt(4)
v_mfma_f32_16x16x32_bf16 v[128:131], v[72:75], a[96:99], v[128:131]
v_cvt_pk_bf16_f32 v196, v209, v211
v_fma_f32 v212, v212, v237, v236
v_mfma_f32_16x16x32_bf16 v[128:131], v[76:79], a[112:115], v[128:131]
v_fma_f32 v214, v214, v237, v236
v_mul_f32 v212, v212, v86
v_mfma_f32_16x16x32_bf16 v[132:135], v[72:75], a[100:103], v[132:135]
ds_read_b128 v[64:67], v7 offset:53248
v_mul_f32 v214, v214, v87
v_mfma_f32_16x16x32_bf16 v[132:135], v[76:79], a[116:119], v[132:135]
buffer_load_dwordx4 a[28:31], v6, s[8:11], s26 offen offset:0 sc1
v_mfma_f32_16x16x32_bf16 v[136:139], v[72:75], a[104:107], v[136:139]
v_exp_f32 v212, v212
v_mfma_f32_16x16x32_bf16 v[136:139], v[76:79], a[120:123], v[136:139]
ds_read_b128 v[68:71], v7 offset:54272
v_mul_f32 v213, v86, v102
v_mfma_f32_16x16x32_bf16 v[140:143], v[72:75], a[108:111], v[140:143]
v_exp_f32 v214, v214
v_mfma_f32_16x16x32_bf16 v[140:143], v[76:79], a[124:127], v[140:143]
v_mul_f32 v215, v87, v103
s_waitcnt lgkmcnt(4)
v_mfma_f32_16x16x32_bf16 v[112:115], v[48:51], a[128:131], v[112:115]
buffer_load_dwordx4 a[32:35], v2, s[8:11], s27 offen offset:0 sc1
v_mfma_f32_16x16x32_bf16 v[112:115], v[52:55], a[144:147], v[112:115]
v_fma_f32 v212, v212, v238, v238
v_fma_f32 v214, v214, v238, v238
v_mfma_f32_16x16x32_bf16 v[116:119], v[48:51], a[132:135], v[116:119]
ds_read_b128 v[72:75], v7 offset:55296
v_mul_f32 v208, v88, v88
v_mfma_f32_16x16x32_bf16 v[116:119], v[52:55], a[148:151], v[116:119]
v_rcp_f32 v212, v212
v_mfma_f32_16x16x32_bf16 v[120:123], v[48:51], a[136:139], v[120:123]
v_rcp_f32 v214, v214
v_mfma_f32_16x16x32_bf16 v[120:123], v[52:55], a[152:155], v[120:123]
ds_read_b128 v[76:79], v7 offset:56320
v_mul_f32 v213, v213, v212
v_mfma_f32_16x16x32_bf16 v[124:127], v[48:51], a[140:143], v[124:127]
buffer_load_dwordx4 a[36:39], v4, s[8:11], s27 offen offset:0 sc1
v_mfma_f32_16x16x32_bf16 v[124:127], v[52:55], a[156:159], v[124:127]
v_mul_f32 v215, v215, v214
s_waitcnt lgkmcnt(4)
v_mfma_f32_16x16x32_bf16 v[128:131], v[56:59], a[128:131], v[128:131]
s_waitcnt vmcnt(36)
v_cvt_pk_bf16_f32 v197, v213, v215
v_mfma_f32_16x16x32_bf16 v[128:131], v[60:63], a[144:147], v[128:131]
s_barrier
v_mfma_f32_16x16x32_bf16 v[132:135], v[56:59], a[132:135], v[132:135]
ds_read_b128 v[48:51], v7 offset:57344
v_mul_f32 v210, v89, v89
v_mfma_f32_16x16x32_bf16 v[132:135], v[60:63], a[148:151], v[132:135]
buffer_load_dwordx4 a[40:43], v5, s[8:11], s27 offen offset:0 sc1
v_mfma_f32_16x16x32_bf16 v[136:139], v[56:59], a[136:139], v[136:139]
v_fma_f32 v208, v208, v241, v240
v_fma_f32 v210, v210, v241, v240
v_mfma_f32_16x16x32_bf16 v[136:139], v[60:63], a[152:155], v[136:139]
ds_read_b128 v[52:55], v7 offset:58368
v_mul_f32 v208, v208, v88
v_mfma_f32_16x16x32_bf16 v[140:143], v[56:59], a[140:143], v[140:143]
v_mul_f32 v210, v210, v89
v_mul_f32 v209, v88, v104
v_mfma_f32_16x16x32_bf16 v[140:143], v[60:63], a[156:159], v[140:143]
v_mul_f32 v211, v89, v105
s_waitcnt lgkmcnt(4)
v_mfma_f32_16x16x32_bf16 v[112:115], v[64:67], a[160:163], v[112:115]
buffer_load_dwordx4 a[44:47], v6, s[8:11], s27 offen offset:0 sc1
v_mfma_f32_16x16x32_bf16 v[112:115], v[68:71], a[176:179], v[112:115]
v_exp_f32 v208, v208
v_mfma_f32_16x16x32_bf16 v[116:119], v[64:67], a[164:167], v[116:119]
ds_read_b128 v[56:59], v7 offset:59392
v_fma_f32 v208, v208, v242, v242
v_mfma_f32_16x16x32_bf16 v[116:119], v[68:71], a[180:183], v[116:119]
v_exp_f32 v210, v210
v_mfma_f32_16x16x32_bf16 v[120:123], v[64:67], a[168:171], v[120:123]
v_fma_f32 v210, v210, v242, v242
v_mul_f32 v212, v90, v90
v_mfma_f32_16x16x32_bf16 v[120:123], v[68:71], a[184:187], v[120:123]
ds_read_b128 v[60:63], v7 offset:60416
v_mul_f32 v214, v91, v91
v_mfma_f32_16x16x32_bf16 v[124:127], v[64:67], a[172:175], v[124:127]
buffer_load_dwordx4 a[48:51], v2, s[8:11], s25 offen offset:1024 sc1
v_mfma_f32_16x16x32_bf16 v[124:127], v[68:71], a[188:191], v[124:127]
v_fma_f32 v212, v212, v241, v240
s_waitcnt lgkmcnt(4)
v_mfma_f32_16x16x32_bf16 v[128:131], v[72:75], a[160:163], v[128:131]
v_rcp_f32 v208, v208
v_mfma_f32_16x16x32_bf16 v[128:131], v[76:79], a[176:179], v[128:131]
v_rcp_f32 v210, v210
v_mfma_f32_16x16x32_bf16 v[132:135], v[72:75], a[164:167], v[132:135]
ds_read_b128 v[64:67], v7 offset:61440
v_mul_f32 v209, v209, v208
v_mfma_f32_16x16x32_bf16 v[132:135], v[76:79], a[180:183], v[132:135]
buffer_load_dwordx4 a[52:55], v4, s[8:11], s25 offen offset:1024 sc1
v_mfma_f32_16x16x32_bf16 v[136:139], v[72:75], a[168:171], v[136:139]
v_mul_f32 v211, v211, v210
v_cvt_pk_bf16_f32 v200, v209, v211
v_mfma_f32_16x16x32_bf16 v[136:139], v[76:79], a[184:187], v[136:139]
ds_read_b128 v[68:71], v7 offset:62464
v_fma_f32 v214, v214, v241, v240
v_mfma_f32_16x16x32_bf16 v[140:143], v[72:75], a[172:175], v[140:143]
v_mul_f32 v212, v212, v90
v_mul_f32 v214, v214, v91
v_mfma_f32_16x16x32_bf16 v[140:143], v[76:79], a[188:191], v[140:143]
v_mul_f32 v213, v90, v106
s_waitcnt lgkmcnt(4)
v_mfma_f32_16x16x32_bf16 v[112:115], v[48:51], a[192:195], v[112:115]
buffer_load_dwordx4 a[56:59], v5, s[8:11], s25 offen offset:1024 sc1
v_mfma_f32_16x16x32_bf16 v[112:115], v[52:55], a[208:211], v[112:115]
v_exp_f32 v212, v212
v_mfma_f32_16x16x32_bf16 v[116:119], v[48:51], a[196:199], v[116:119]
ds_read_b128 v[72:75], v7 offset:63488
v_mul_f32 v215, v91, v107
v_mfma_f32_16x16x32_bf16 v[116:119], v[52:55], a[212:215], v[116:119]
v_exp_f32 v214, v214
v_mfma_f32_16x16x32_bf16 v[120:123], v[48:51], a[200:203], v[120:123]
v_fma_f32 v212, v212, v242, v242
v_fma_f32 v214, v214, v242, v242
v_mfma_f32_16x16x32_bf16 v[120:123], v[52:55], a[216:219], v[120:123]
ds_read_b128 v[76:79], v7 offset:64512
v_mul_f32 v208, v92, v92
v_mfma_f32_16x16x32_bf16 v[124:127], v[48:51], a[204:207], v[124:127]
buffer_load_dwordx4 a[60:63], v6, s[8:11], s25 offen offset:1024 sc1
v_mfma_f32_16x16x32_bf16 v[124:127], v[52:55], a[220:223], v[124:127]
v_mul_f32 v210, v93, v93
s_waitcnt lgkmcnt(4)
v_mfma_f32_16x16x32_bf16 v[128:131], v[56:59], a[192:195], v[128:131]
v_rcp_f32 v212, v212
v_mfma_f32_16x16x32_bf16 v[128:131], v[60:63], a[208:211], v[128:131]
v_rcp_f32 v214, v214
v_mfma_f32_16x16x32_bf16 v[132:135], v[56:59], a[196:199], v[132:135]
ds_read_b128 v[48:51], v8 offset:0
v_mul_f32 v213, v213, v212
v_mfma_f32_16x16x32_bf16 v[132:135], v[60:63], a[212:215], v[132:135]
buffer_load_dwordx4 a[64:67], v2, s[8:11], s26 offen offset:1024 sc1
v_mfma_f32_16x16x32_bf16 v[136:139], v[56:59], a[200:203], v[136:139]
v_mul_f32 v215, v215, v214
v_cvt_pk_bf16_f32 v201, v213, v215
v_mfma_f32_16x16x32_bf16 v[136:139], v[60:63], a[216:219], v[136:139]
ds_read_b128 v[52:55], v8 offset:1024
v_fma_f32 v208, v208, v245, v244
v_mfma_f32_16x16x32_bf16 v[140:143], v[56:59], a[204:207], v[140:143]
v_fma_f32 v210, v210, v245, v244
v_mul_f32 v208, v208, v92
v_mfma_f32_16x16x32_bf16 v[140:143], v[60:63], a[220:223], v[140:143]
v_mul_f32 v210, v210, v93
s_waitcnt lgkmcnt(4)
v_mfma_f32_16x16x32_bf16 v[112:115], v[64:67], a[224:227], v[112:115]
buffer_load_dwordx4 a[68:71], v4, s[8:11], s26 offen offset:1024 sc1
v_mfma_f32_16x16x32_bf16 v[112:115], v[68:71], a[240:243], v[112:115]
v_exp_f32 v208, v208
v_mfma_f32_16x16x32_bf16 v[116:119], v[64:67], a[228:231], v[116:119]
ds_read_b128 v[56:59], v8 offset:2048
v_mul_f32 v209, v92, v108
v_mfma_f32_16x16x32_bf16 v[116:119], v[68:71], a[244:247], v[116:119]
v_exp_f32 v210, v210
v_mfma_f32_16x16x32_bf16 v[120:123], v[64:67], a[232:235], v[120:123]
v_mul_f32 v211, v93, v109
v_fma_f32 v208, v208, v246, v246
v_mfma_f32_16x16x32_bf16 v[120:123], v[68:71], a[248:251], v[120:123]
ds_read_b128 v[60:63], v8 offset:3072
v_fma_f32 v210, v210, v246, v246
v_mfma_f32_16x16x32_bf16 v[124:127], v[64:67], a[236:239], v[124:127]
buffer_load_dwordx4 a[72:75], v5, s[8:11], s26 offen offset:1024 sc1
v_mfma_f32_16x16x32_bf16 v[124:127], v[68:71], a[252:255], v[124:127]
v_mul_f32 v212, v94, v94
s_waitcnt lgkmcnt(4)
v_mfma_f32_16x16x32_bf16 v[128:131], v[72:75], a[224:227], v[128:131]
v_rcp_f32 v208, v208
v_mfma_f32_16x16x32_bf16 v[128:131], v[76:79], a[240:243], v[128:131]
v_rcp_f32 v210, v210
v_mfma_f32_16x16x32_bf16 v[132:135], v[72:75], a[228:231], v[132:135]
ds_read_b128 v[64:67], v8 offset:4096
v_mul_f32 v209, v209, v208
v_mfma_f32_16x16x32_bf16 v[132:135], v[76:79], a[244:247], v[132:135]
buffer_load_dwordx4 a[76:79], v6, s[8:11], s26 offen offset:1024 sc1
v_mfma_f32_16x16x32_bf16 v[136:139], v[72:75], a[232:235], v[136:139]
v_mul_f32 v211, v211, v210
v_cvt_pk_bf16_f32 v204, v209, v211
v_mfma_f32_16x16x32_bf16 v[136:139], v[76:79], a[248:251], v[136:139]
ds_read_b128 v[68:71], v8 offset:5120
v_mul_f32 v214, v95, v95
v_mfma_f32_16x16x32_bf16 v[140:143], v[72:75], a[236:239], v[140:143]
v_fma_f32 v212, v212, v245, v244
v_fma_f32 v214, v214, v245, v244
v_mfma_f32_16x16x32_bf16 v[140:143], v[76:79], a[252:255], v[140:143]
v_mul_f32 v212, v212, v94
s_waitcnt lgkmcnt(4)
v_mfma_f32_16x16x32_bf16 v[112:115], v[48:51], v[16:19], v[112:115]
s_add_u32 s23, s34, 131072
v_mul_f32 v214, v214, v95
v_mfma_f32_16x16x32_bf16 v[112:115], v[52:55], v[32:35], v[112:115]
buffer_load_dwordx2 v[14:15], v11, s[8:11], s23 offen sc1
v_mfma_f32_16x16x32_bf16 v[116:119], v[48:51], v[20:23], v[116:119]
ds_read_b128 v[72:75], v8 offset:6144
v_mul_f32 v213, v94, v110
v_mfma_f32_16x16x32_bf16 v[116:119], v[52:55], v[36:39], v[116:119]
v_exp_f32 v212, v212
v_mfma_f32_16x16x32_bf16 v[120:123], v[48:51], v[24:27], v[120:123]
v_exp_f32 v214, v214
v_mfma_f32_16x16x32_bf16 v[120:123], v[52:55], v[40:43], v[120:123]
ds_read_b128 v[76:79], v8 offset:7168
v_mul_f32 v215, v95, v111
v_mfma_f32_16x16x32_bf16 v[124:127], v[48:51], v[28:31], v[124:127]
buffer_load_dwordx4 a[80:83], v2, s[8:11], s27 offen offset:1024 sc1
v_mfma_f32_16x16x32_bf16 v[124:127], v[52:55], v[44:47], v[124:127]
v_fma_f32 v212, v212, v246, v246
s_waitcnt lgkmcnt(4)
v_mfma_f32_16x16x32_bf16 v[128:131], v[56:59], v[16:19], v[128:131]
v_fma_f32 v214, v214, v246, v246
v_mfma_f32_16x16x32_bf16 v[128:131], v[60:63], v[32:35], v[128:131]
v_rcp_f32 v212, v212
v_mfma_f32_16x16x32_bf16 v[132:135], v[56:59], v[20:23], v[132:135]
ds_read_b128 v[48:51], v8 offset:8192
v_mul_f32 v213, v213, v212
v_mfma_f32_16x16x32_bf16 v[132:135], v[60:63], v[36:39], v[132:135]
buffer_load_dwordx4 a[84:87], v4, s[8:11], s27 offen offset:1024 sc1
v_mfma_f32_16x16x32_bf16 v[136:139], v[56:59], v[24:27], v[136:139]
v_rcp_f32 v214, v214
v_mfma_f32_16x16x32_bf16 v[136:139], v[60:63], v[40:43], v[136:139]
ds_read_b128 v[52:55], v8 offset:9216
v_mul_f32 v215, v215, v214
v_mfma_f32_16x16x32_bf16 v[140:143], v[56:59], v[28:31], v[140:143]
v_cvt_pk_bf16_f32 v205, v213, v215
v_mfma_f32_16x16x32_bf16 v[140:143], v[60:63], v[44:47], v[140:143]
s_waitcnt lgkmcnt(4)
v_mfma_f32_16x16x32_bf16 a[112:115], v[64:67], v[144:147], 0
v_mfma_f32_16x16x32_bf16 a[112:115], v[68:71], v[160:163], a[112:115]
v_mfma_f32_16x16x32_bf16 a[116:119], v[64:67], v[148:151], 0
ds_read_b128 v[56:59], v8 offset:10240
v_mfma_f32_16x16x32_bf16 a[116:119], v[68:71], v[164:167], a[116:119]
v_mul_f32 v208, v112, v112
v_mul_f32 v210, v113, v113
v_mfma_f32_16x16x32_bf16 a[120:123], v[64:67], v[152:155], 0
v_fma_f32 v208, v208, v233, v232
v_fma_f32 v210, v210, v233, v232
v_mfma_f32_16x16x32_bf16 a[120:123], v[68:71], v[168:171], a[120:123]
ds_read_b128 v[60:63], v8 offset:11264
v_mul_f32 v208, v208, v112
v_mfma_f32_16x16x32_bf16 a[124:127], v[64:67], v[156:159], 0
v_mul_f32 v210, v210, v113
v_mul_f32 v209, v112, v128
v_mfma_f32_16x16x32_bf16 a[124:127], v[68:71], v[172:175], a[124:127]
v_mul_f32 v211, v113, v129
s_waitcnt lgkmcnt(4)
v_mfma_f32_16x16x32_bf16 a[128:131], v[72:75], v[144:147], 0
v_exp_f32 v208, v208
v_mfma_f32_16x16x32_bf16 a[128:131], v[76:79], v[160:163], a[128:131]
v_exp_f32 v210, v210
v_mfma_f32_16x16x32_bf16 a[132:135], v[72:75], v[148:151], 0
ds_read_b128 v[64:67], v8 offset:12288
v_fma_f32 v208, v208, v234, v234
v_mfma_f32_16x16x32_bf16 a[132:135], v[76:79], v[164:167], a[132:135]
v_fma_f32 v210, v210, v234, v234
v_mul_f32 v212, v114, v114
v_mfma_f32_16x16x32_bf16 a[136:139], v[72:75], v[152:155], 0
v_rcp_f32 v208, v208
v_mfma_f32_16x16x32_bf16 a[136:139], v[76:79], v[168:171], a[136:139]
ds_read_b128 v[68:71], v8 offset:13312
v_mul_f32 v209, v209, v208
v_mfma_f32_16x16x32_bf16 a[140:143], v[72:75], v[156:159], 0
v_rcp_f32 v210, v210
v_mfma_f32_16x16x32_bf16 a[140:143], v[76:79], v[172:175], a[140:143]
v_mul_f32 v211, v211, v210
s_waitcnt lgkmcnt(4)
v_mfma_f32_16x16x32_bf16 a[144:147], v[48:51], v[144:147], 0
v_cvt_pk_bf16_f32 v194, v209, v211
v_mul_f32 v214, v115, v115
v_mfma_f32_16x16x32_bf16 a[144:147], v[52:55], v[160:163], a[144:147]
v_fma_f32 v212, v212, v233, v232
v_fma_f32 v214, v214, v233, v232
v_mfma_f32_16x16x32_bf16 a[148:151], v[48:51], v[148:151], 0
ds_read_b128 v[72:75], v8 offset:14336
v_mul_f32 v212, v212, v114
v_mfma_f32_16x16x32_bf16 a[148:151], v[52:55], v[164:167], a[148:151]
v_mul_f32 v214, v214, v115
v_mul_f32 v213, v114, v130
v_mfma_f32_16x16x32_bf16 a[152:155], v[48:51], v[152:155], 0
v_exp_f32 v212, v212
v_mfma_f32_16x16x32_bf16 a[152:155], v[52:55], v[168:171], a[152:155]
ds_read_b128 v[76:79], v8 offset:15360
v_mul_f32 v215, v115, v131
v_mfma_f32_16x16x32_bf16 a[156:159], v[48:51], v[156:159], 0
v_exp_f32 v214, v214
v_mfma_f32_16x16x32_bf16 a[156:159], v[52:55], v[172:175], a[156:159]
v_fma_f32 v212, v212, v234, v234
s_waitcnt lgkmcnt(4)
v_mfma_f32_16x16x32_bf16 a[160:163], v[56:59], v[144:147], 0
s_waitcnt vmcnt(42)
v_fma_f32 v214, v214, v234, v234
v_mfma_f32_16x16x32_bf16 a[160:163], v[60:63], v[160:163], a[160:163]
s_barrier
v_mfma_f32_16x16x32_bf16 a[164:167], v[56:59], v[148:151], 0
ds_read_b128 v[48:51], v2 offset:0
v_mul_f32 v208, v116, v116
v_mfma_f32_16x16x32_bf16 a[164:167], v[60:63], v[164:167], a[164:167]
v_rcp_f32 v212, v212
v_mfma_f32_16x16x32_bf16 a[168:171], v[56:59], v[152:155], 0
v_rcp_f32 v214, v214
v_mfma_f32_16x16x32_bf16 a[168:171], v[60:63], v[168:171], a[168:171]
ds_read_b128 v[52:55], v2 offset:1024
v_mul_f32 v213, v213, v212
v_mfma_f32_16x16x32_bf16 a[172:175], v[56:59], v[156:159], 0
v_mul_f32 v215, v215, v214
v_cvt_pk_bf16_f32 v195, v213, v215
v_mfma_f32_16x16x32_bf16 a[172:175], v[60:63], v[172:175], a[172:175]
v_mul_f32 v210, v117, v117
s_waitcnt lgkmcnt(4)
v_mfma_f32_16x16x32_bf16 a[176:179], v[64:67], v[144:147], 0
buffer_store_dwordx4 v[192:195], v2, s[8:11], s24 offen offset:3072 sc1
v_mfma_f32_16x16x32_bf16 a[176:179], v[68:71], v[160:163], a[176:179]
v_fma_f32 v208, v208, v237, v236
v_fma_f32 v210, v210, v237, v236
v_mfma_f32_16x16x32_bf16 a[180:183], v[64:67], v[148:151], 0
ds_read_b128 v[56:59], v2 offset:2048
v_mul_f32 v208, v208, v116
v_mfma_f32_16x16x32_bf16 a[180:183], v[68:71], v[164:167], a[180:183]
v_mul_f32 v210, v210, v117
v_mul_f32 v209, v116, v132
v_mfma_f32_16x16x32_bf16 a[184:187], v[64:67], v[152:155], 0
v_exp_f32 v208, v208
v_mfma_f32_16x16x32_bf16 a[184:187], v[68:71], v[168:171], a[184:187]
ds_read_b128 v[60:63], v2 offset:3072
v_mul_f32 v211, v117, v133
v_mfma_f32_16x16x32_bf16 a[188:191], v[64:67], v[156:159], 0
L_hop8:
s_cmp_eq_u32 s15, 1
s_cbranch_scc1 L_hop12
v_exp_f32 v210, v210
v_mfma_f32_16x16x32_bf16 a[188:191], v[68:71], v[172:175], a[188:191]
v_fma_f32 v208, v208, v238, v238
s_waitcnt lgkmcnt(4)
v_mfma_f32_16x16x32_bf16 a[192:195], v[72:75], v[144:147], 0
v_fma_f32 v210, v210, v238, v238
v_rcp_f32 v208, v208
v_mfma_f32_16x16x32_bf16 a[192:195], v[76:79], v[160:163], a[192:195]
v_rcp_f32 v210, v210
v_mfma_f32_16x16x32_bf16 a[196:199], v[72:75], v[148:151], 0
ds_read_b128 v[64:67], v2 offset:4096
v_mul_f32 v209, v209, v208
v_mfma_f32_16x16x32_bf16 a[196:199], v[76:79], v[164:167], a[196:199]
v_mul_f32 v211, v211, v210
v_cvt_pk_bf16_f32 v198, v209, v211
v_mfma_f32_16x16x32_bf16 a[200:203], v[72:75], v[152:155], 0
v_mul_f32 v212, v118, v118
v_mul_f32 v214, v119, v119
v_mfma_f32_16x16x32_bf16 a[200:203], v[76:79], v[168:171], a[200:203]
ds_read_b128 v[68:71], v2 offset:5120
v_fma_f32 v212, v212, v237, v236
v_mfma_f32_16x16x32_bf16 a[204:207], v[72:75], v[156:159], 0
v_fma_f32 v214, v214, v237, v236
v_mul_f32 v212, v212, v118
v_mfma_f32_16x16x32_bf16 a[204:207], v[76:79], v[172:175], a[204:207]
v_mul_f32 v214, v214, v119
s_waitcnt lgkmcnt(4)
v_mfma_f32_16x16x32_bf16 a[208:211], v[48:51], v[144:147], 0
v_exp_f32 v212, v212
v_mfma_f32_16x16x32_bf16 a[208:211], v[52:55], v[160:163], a[208:211]
v_exp_f32 v214, v214
v_mfma_f32_16x16x32_bf16 a[212:215], v[48:51], v[148:151], 0
ds_read_b128 v[72:75], v2 offset:6144
v_mul_f32 v213, v118, v134
v_mfma_f32_16x16x32_bf16 a[212:215], v[52:55], v[164:167], a[212:215]
v_mul_f32 v215, v119, v135
v_fma_f32 v212, v212, v238, v238
v_mfma_f32_16x16x32_bf16 a[216:219], v[48:51], v[152:155], 0
v_fma_f32 v214, v214, v238, v238
v_rcp_f32 v212, v212
v_mfma_f32_16x16x32_bf16 a[216:219], v[52:55], v[168:171], a[216:219]
ds_read_b128 v[76:79], v2 offset:7168
v_rcp_f32 v214, v214
v_mfma_f32_16x16x32_bf16 a[220:223], v[48:51], v[156:159], 0
v_mul_f32 v213, v213, v212
v_mul_f32 v215, v215, v214
v_mfma_f32_16x16x32_bf16 a[220:223], v[52:55], v[172:175], a[220:223]
v_cvt_pk_bf16_f32 v199, v213, v215
s_waitcnt lgkmcnt(4)
v_mfma_f32_16x16x32_bf16 a[224:227], v[56:59], v[144:147], 0
buffer_store_dwordx4 v[196:199], v4, s[8:11], s24 offen offset:3072 sc1
v_mfma_f32_16x16x32_bf16 a[224:227], v[60:63], v[160:163], a[224:227]
v_mul_f32 v208, v120, v120
v_mul_f32 v210, v121, v121
v_mfma_f32_16x16x32_bf16 a[228:231], v[56:59], v[148:151], 0
ds_read_b128 v[48:51], v2 offset:8192
v_fma_f32 v208, v208, v241, v240
v_mfma_f32_16x16x32_bf16 a[228:231], v[60:63], v[164:167], a[228:231]
v_fma_f32 v210, v210, v241, v240
v_mul_f32 v208, v208, v120
v_mfma_f32_16x16x32_bf16 a[232:235], v[56:59], v[152:155], 0
v_mul_f32 v210, v210, v121
v_exp_f32 v208, v208
v_mfma_f32_16x16x32_bf16 a[232:235], v[60:63], v[168:171], a[232:235]
ds_read_b128 v[52:55], v2 offset:9216
v_exp_f32 v210, v210
v_mfma_f32_16x16x32_bf16 a[236:239], v[56:59], v[156:159], 0
v_mul_f32 v209, v120, v136
v_mul_f32 v211, v121, v137
v_mfma_f32_16x16x32_bf16 a[236:239], v[60:63], v[172:175], a[236:239]
v_fma_f32 v208, v208, v242, v242
s_waitcnt vmcnt(22)
s_waitcnt lgkmcnt(4)
v_mfma_f32_16x16x32_bf16 a[112:115], v[64:67], v[176:179], a[112:115]
v_fma_f32 v210, v210, v242, v242
v_rcp_f32 v208, v208
v_mfma_f32_16x16x32_bf16 a[112:115], v[68:71], a[0:3], a[112:115]
v_rcp_f32 v210, v210
v_mfma_f32_16x16x32_bf16 a[116:119], v[64:67], v[180:183], a[116:119]
ds_read_b128 v[56:59], v2 offset:10240
v_mul_f32 v209, v209, v208
v_mfma_f32_16x16x32_bf16 a[116:119], v[68:71], a[4:7], a[116:119]
v_mul_f32 v211, v211, v210
v_cvt_pk_bf16_f32 v202, v209, v211
v_mfma_f32_16x16x32_bf16 a[120:123], v[64:67], v[184:187], a[120:123]
v_mul_f32 v212, v122, v122
v_mul_f32 v214, v123, v123
v_mfma_f32_16x16x32_bf16 a[120:123], v[68:71], a[8:11], a[120:123]
ds_read_b128 v[60:63], v2 offset:11264
v_fma_f32 v212, v212, v241, v240
v_mfma_f32_16x16x32_bf16 a[124:127], v[64:67], v[188:191], a[124:127]
v_fma_f32 v214, v214, v241, v240
v_mul_f32 v212, v212, v122
v_mfma_f32_16x16x32_bf16 a[124:127], v[68:71], a[12:15], a[124:127]
v_mul_f32 v214, v214, v123
s_waitcnt lgkmcnt(4)
v_mfma_f32_16x16x32_bf16 a[128:131], v[72:75], v[176:179], a[128:131]
s_waitcnt vmcnt(4)
v_cmp_eq_u64 vcc, s[68:69], v[14:15]
s_nop 0
s_cmp_eq_u64 vcc, exec
s_cbranch_scc0 L_f_slow2
L_f_back2:
v_exp_f32 v212, v212
v_mfma_f32_16x16x32_bf16 a[128:131], v[76:79], a[0:3], a[128:131]
v_exp_f32 v214, v214
v_mfma_f32_16x16x32_bf16 a[132:135], v[72:75], v[180:183], a[132:135]
ds_read_b128 v[64:67], v2 offset:12288
v_mul_f32 v213, v122, v138
v_mfma_f32_16x16x32_bf16 a[132:135], v[76:79], a[4:7], a[132:135]
v_mul_f32 v215, v123, v139
v_fma_f32 v212, v212, v242, v242
v_mfma_f32_16x16x32_bf16 a[136:139], v[72:75], v[184:187], a[136:139]
v_fma_f32 v214, v214, v242, v242
v_rcp_f32 v212, v212
v_mfma_f32_16x16x32_bf16 a[136:139], v[76:79], a[8:11], a[136:139]
ds_read_b128 v[68:71], v2 offset:13312
v_rcp_f32 v214, v214
v_mfma_f32_16x16x32_bf16 a[140:143], v[72:75], v[188:191], a[140:143]
v_mul_f32 v213, v213, v212
v_mul_f32 v215, v215, v214
v_mfma_f32_16x16x32_bf16 a[140:143], v[76:79], a[12:15], a[140:143]
v_cvt_pk_bf16_f32 v203, v213, v215
s_waitcnt lgkmcnt(4)
v_mfma_f32_16x16x32_bf16 a[144:147], v[48:51], v[176:179], a[144:147]
buffer_store_dwordx4 v[200:203], v5, s[8:11], s24 offen offset:3072 sc1
v_mfma_f32_16x16x32_bf16 a[144:147], v[52:55], a[0:3], a[144:147]
v_mul_f32 v208, v124, v124
v_mul_f32 v210, v125, v125
v_mfma_f32_16x16x32_bf16 a[148:151], v[48:51], v[180:183], a[148:151]
ds_read_b128 v[72:75], v2 offset:14336
v_fma_f32 v208, v208, v245, v244
v_mfma_f32_16x16x32_bf16 a[148:151], v[52:55], a[4:7], a[148:151]
v_fma_f32 v210, v210, v245, v244
v_mul_f32 v208, v208, v124
v_mfma_f32_16x16x32_bf16 a[152:155], v[48:51], v[184:187], a[152:155]
v_mul_f32 v210, v210, v125
v_exp_f32 v208, v208
v_mfma_f32_16x16x32_bf16 a[152:155], v[52:55], a[8:11], a[152:155]
ds_read_b128 v[76:79], v2 offset:15360
v_exp_f32 v210, v210
v_mfma_f32_16x16x32_bf16 a[156:159], v[48:51], v[188:191], a[156:159]
v_mul_f32 v209, v124, v140
v_mul_f32 v211, v125, v141
v_mfma_f32_16x16x32_bf16 a[156:159], v[52:55], a[12:15], a[156:159]
v_fma_f32 v208, v208, v246, v246
s_waitcnt lgkmcnt(4)
v_mfma_f32_16x16x32_bf16 a[160:163], v[56:59], v[176:179], a[160:163]
v_fma_f32 v210, v210, v246, v246
v_rcp_f32 v208, v208
v_mfma_f32_16x16x32_bf16 a[160:163], v[60:63], a[0:3], a[160:163]
v_rcp_f32 v210, v210
v_mfma_f32_16x16x32_bf16 a[164:167], v[56:59], v[180:183], a[164:167]
ds_read_b128 v[48:51], v2 offset:16384
v_mul_f32 v209, v209, v208
v_mfma_f32_16x16x32_bf16 a[164:167], v[60:63], a[4:7], a[164:167]
v_mul_f32 v211, v211, v210
v_cvt_pk_bf16_f32 v206, v209, v211
v_mfma_f32_16x16x32_bf16 a[168:171], v[56:59], v[184:187], a[168:171]
v_mul_f32 v212, v126, v126
v_mul_f32 v214, v127, v127
v_mfma_f32_16x16x32_bf16 a[168:171], v[60:63], a[8:11], a[168:171]
ds_read_b128 v[52:55], v2 offset:17408
v_fma_f32 v212, v212, v245, v244
v_mfma_f32_16x16x32_bf16 a[172:175], v[56:59], v[188:191], a[172:175]
v_fma_f32 v214, v214, v245, v244
v_mul_f32 v212, v212, v126
v_mfma_f32_16x16x32_bf16 a[172:175], v[60:63], a[12:15], a[172:175]
v_mul_f32 v214, v214, v127
s_waitcnt lgkmcnt(4)
v_mfma_f32_16x16x32_bf16 a[176:179], v[64:67], v[176:179], a[176:179]
v_exp_f32 v212, v212
v_mfma_f32_16x16x32_bf16 a[176:179], v[68:71], a[0:3], a[176:179]
v_exp_f32 v214, v214
v_mfma_f32_16x16x32_bf16 a[180:183], v[64:67], v[180:183], a[180:183]
ds_read_b128 v[56:59], v2 offset:18432
v_mul_f32 v213, v126, v142
v_mfma_f32_16x16x32_bf16 a[180:183], v[68:71], a[4:7], a[180:183]
v_mul_f32 v215, v127, v143
v_fma_f32 v212, v212, v246, v246
v_mfma_f32_16x16x32_bf16 a[184:187], v[64:67], v[184:187], a[184:187]
v_fma_f32 v214, v214, v246, v246
v_rcp_f32 v212, v212
v_mfma_f32_16x16x32_bf16 a[184:187], v[68:71], a[8:11], a[184:187]
ds_read_b128 v[60:63], v2 offset:19456
v_rcp_f32 v214, v214
v_mfma_f32_16x16x32_bf16 a[188:191], v[64:67], v[188:191], a[188:191]
v_mul_f32 v213, v213, v212
v_mul_f32 v215, v215, v214
v_mfma_f32_16x16x32_bf16 a[188:191], v[68:71], a[12:15], a[188:191]
v_cvt_pk_bf16_f32 v207, v213, v215
buffer_store_dwordx4 v[204:207], v6, s[8:11], s24 offen offset:3072 sc1
s_waitcnt lgkmcnt(4)
v_mfma_f32_16x16x32_bf16 a[192:195], v[72:75], v[176:179], a[192:195]
buffer_load_dwordx4 a[88:91], v5, s[8:11], s27 offen offset:1024 sc1
v_mfma_f32_16x16x32_bf16 a[192:195], v[76:79], a[0:3], a[192:195]
v_mfma_f32_16x16x32_bf16 a[196:199], v[72:75], v[180:183], a[196:199]
ds_read_b128 v[64:67], v2 offset:20480
v_mfma_f32_16x16x32_bf16 a[196:199], v[76:79], a[4:7], a[196:199]
v_mfma_f32_16x16x32_bf16 a[200:203], v[72:75], v[184:187], a[200:203]
v_mfma_f32_16x16x32_bf16 a[200:203], v[76:79], a[8:11], a[200:203]
ds_read_b128 v[68:71], v2 offset:21504
v_mfma_f32_16x16x32_bf16 a[204:207], v[72:75], v[188:191], a[204:207]
buffer_load_dwordx4 a[92:95], v6, s[8:11], s27 offen offset:1024 sc1
v_mfma_f32_16x16x32_bf16 a[204:207], v[76:79], a[12:15], a[204:207]
s_waitcnt lgkmcnt(4)
v_mfma_f32_16x16x32_bf16 a[208:211], v[48:51], v[176:179], a[208:211]
v_mfma_f32_16x16x32_bf16 a[208:211], v[52:55], a[0:3], a[208:211]
v_mfma_f32_16x16x32_bf16 a[212:215], v[48:51], v[180:183], a[212:215]
ds_read_b128 v[72:75], v2 offset:22528
v_mfma_f32_16x16x32_bf16 a[212:215], v[52:55], a[4:7], a[212:215]
buffer_load_dwordx2 a[96:97], v248, s[8:11], s28 offen offset:0 sc1
v_mfma_f32_16x16x32_bf16 a[216:219], v[48:51], v[184:187], a[216:219]
v_mfma_f32_16x16x32_bf16 a[216:219], v[52:55], a[8:11], a[216:219]
ds_read_b128 v[76:79], v2 offset:23552
v_mfma_f32_16x16x32_bf16 a[220:223], v[48:51], v[188:191], a[220:223]
v_mfma_f32_16x16x32_bf16 a[220:223], v[52:55], a[12:15], a[220:223]
s_waitcnt lgkmcnt(4)
v_mfma_f32_16x16x32_bf16 a[224:227], v[56:59], v[176:179], a[224:227]
s_waitcnt vmcnt(40)
v_mfma_f32_16x16x32_bf16 a[224:227], v[60:63], a[0:3], a[224:227]
s_barrier
v_mfma_f32_16x16x32_bf16 a[228:231], v[56:59], v[180:183], a[228:231]
ds_read_b128 v[48:51], v2 offset:24576
buffer_load_dwordx2 a[98:99], v248, s[8:11], s28 offen offset:512 sc1
v_mfma_f32_16x16x32_bf16 a[228:231], v[60:63], a[4:7], a[228:231]
v_mfma_f32_16x16x32_bf16 a[232:235], v[56:59], v[184:187], a[232:235]
v_mfma_f32_16x16x32_bf16 a[232:235], v[60:63], a[8:11], a[232:235]
ds_read_b128 v[52:55], v2 offset:25600
v_mfma_f32_16x16x32_bf16 a[236:239], v[56:59], v[188:191], a[236:239]
v_mfma_f32_16x16x32_bf16 a[236:239], v[60:63], a[12:15], a[236:239]
s_waitcnt vmcnt(19)
s_waitcnt lgkmcnt(4)
v_mfma_f32_16x16x32_bf16 a[112:115], v[64:67], a[16:19], a[112:115]
buffer_load_dwordx2 a[100:101], v249, s[8:11], s28 offen offset:0 sc1
v_mfma_f32_16x16x32_bf16 a[112:115], v[68:71], a[32:35], a[112:115]
v_mfma_f32_16x16x32_bf16 a[116:119], v[64:67], a[20:23], a[116:119]
ds_read_b128 v[56:59], v2 offset:26624
v_mfma_f32_16x16x32_bf16 a[116:119], v[68:71], a[36:39], a[116:119]
v_mfma_f32_16x16x32_bf16 a[120:123], v[64:67], a[24:27], a[120:123]
v_mfma_f32_16x16x32_bf16 a[120:123], v[68:71], a[40:43], a[120:123]
ds_read_b128 v[60:63], v2 offset:27648
v_mfma_f32_16x16x32_bf16 a[124:127], v[64:67], a[28:31], a[124:127]
buffer_load_dwordx2 a[102:103], v249, s[8:11], s28 offen offset:512 sc1
v_mfma_f32_16x16x32_bf16 a[124:127], v[68:71], a[44:47], a[124:127]
s_waitcnt lgkmcnt(4)
v_mfma_f32_16x16x32_bf16 a[128:131], v[72:75], a[16:19], a[128:131]
v_mfma_f32_16x16x32_bf16 a[128:131], v[76:79], a[32:35], a[128:131]
v_mfma_f32_16x16x32_bf16 a[132:135], v[72:75], a[20:23], a[132:135]
ds_read_b128 v[64:67], v2 offset:28672
v_mfma_f32_16x16x32_bf16 a[132:135], v[76:79], a[36:39], a[132:135]
buffer_load_dwordx2 a[104:105], v250, s[8:11], s28 offen offset:0 sc1
v_mfma_f32_16x16x32_bf16 a[136:139], v[72:75], a[24:27], a[136:139]
v_mfma_f32_16x16x32_bf16 a[136:139], v[76:79], a[40:43], a[136:139]
ds_read_b128 v[68:71], v2 offset:29696
v_mfma_f32_16x16x32_bf16 a[140:143], v[72:75], a[28:31], a[140:143]
v_mfma_f32_16x16x32_bf16 a[140:143], v[76:79], a[44:47], a[140:143]
s_waitcnt lgkmcnt(4)
v_mfma_f32_16x16x32_bf16 a[144:147], v[48:51], a[16:19], a[144:147]
buffer_load_dwordx2 a[106:107], v250, s[8:11], s28 offen offset:512 sc1
v_mfma_f32_16x16x32_bf16 a[144:147], v[52:55], a[32:35], a[144:147]
v_mfma_f32_16x16x32_bf16 a[148:151], v[48:51], a[20:23], a[148:151]
ds_read_b128 v[72:75], v2 offset:30720
v_mfma_f32_16x16x32_bf16 a[148:151], v[52:55], a[36:39], a[148:151]
v_mfma_f32_16x16x32_bf16 a[152:155], v[48:51], a[24:27], a[152:155]
buffer_load_dwordx2 a[108:109], v251, s[8:11], s28 offen offset:0 sc1
v_mfma_f32_16x16x32_bf16 a[152:155], v[52:55], a[40:43], a[152:155]
ds_read_b128 v[76:79], v2 offset:31744
v_mfma_f32_16x16x32_bf16 a[156:159], v[48:51], a[28:31], a[156:159]
v_mfma_f32_16x16x32_bf16 a[156:159], v[52:55], a[44:47], a[156:159]
s_waitcnt lgkmcnt(4)
v_mfma_f32_16x16x32_bf16 a[160:163], v[56:59], a[16:19], a[160:163]
buffer_load_dwordx2 a[110:111], v251, s[8:11], s28 offen offset:512 sc1
v_mfma_f32_16x16x32_bf16 a[160:163], v[60:63], a[32:35], a[160:163]
s_add_u32 m0, s22, 73728
v_add_u32 v3, 20480, v3
v_mfma_f32_16x16x32_bf16 a[164:167], v[56:59], a[20:23], a[164:167]
ds_read_b128 v[48:51], v2 offset:32768
v_mfma_f32_16x16x32_bf16 a[164:167], v[60:63], a[36:39], a[164:167]
v_mfma_f32_16x16x32_bf16 a[168:171], v[56:59], a[24:27], a[168:171]
v_mfma_f32_16x16x32_bf16 a[168:171], v[60:63], a[40:43], a[168:171]
ds_read_b128 v[52:55], v2 offset:33792
v_mfma_f32_16x16x32_bf16 a[172:175], v[56:59], a[28:31], a[172:175]
buffer_load_dwordx4 v3, s[8:11], 0 offen offset:0 sc1 lds
v_mfma_f32_16x16x32_bf16 a[172:175], v[60:63], a[44:47], a[172:175]
s_waitcnt lgkmcnt(4)
v_mfma_f32_16x16x32_bf16 a[176:179], v[64:67], a[16:19], a[176:179]
v_mov_b32 v12, s68
v_mov_b32 v13, s69
v_mfma_f32_16x16x32_bf16 a[176:179], v[68:71], a[32:35], a[176:179]
s_add_u32 s53, s34, 262144
s_waitcnt vmcnt(11)
v_mfma_f32_16x16x32_bf16 a[180:183], v[64:67], a[20:23], a[180:183]
ds_read_b128 v[56:59], v2 offset:34816
v_mfma_f32_16x16x32_bf16 a[180:183], v[68:71], a[36:39], a[180:183]
buffer_store_dwordx2 v[12:13], v10, s[8:11], s53 offen sc1
v_mfma_f32_16x16x32_bf16 a[184:187], v[64:67], a[24:27], a[184:187]
v_mfma_f32_16x16x32_bf16 a[184:187], v[68:71], a[40:43], a[184:187]
ds_read_b128 v[60:63], v2 offset:35840
v_mfma_f32_16x16x32_bf16 a[188:191], v[64:67], a[28:31], a[188:191]
v_mfma_f32_16x16x32_bf16 a[188:191], v[68:71], a[44:47], a[188:191]
s_waitcnt lgkmcnt(4)
v_mfma_f32_16x16x32_bf16 a[192:195], v[72:75], a[16:19], a[192:195]
buffer_load_dwordx4 v3, s[8:11], 0 offen offset:1024 sc1 lds
v_mfma_f32_16x16x32_bf16 a[192:195], v[76:79], a[32:35], a[192:195]
v_mfma_f32_16x16x32_bf16 a[196:199], v[72:75], a[20:23], a[196:199]
ds_read_b128 v[64:67], v2 offset:36864
v_mfma_f32_16x16x32_bf16 a[196:199], v[76:79], a[36:39], a[196:199]
v_mfma_f32_16x16x32_bf16 a[200:203], v[72:75], a[24:27], a[200:203]
v_mfma_f32_16x16x32_bf16 a[200:203], v[76:79], a[40:43], a[200:203]
ds_read_b128 v[68:71], v2 offset:37888
v_mfma_f32_16x16x32_bf16 a[204:207], v[72:75], a[28:31], a[204:207]
buffer_load_dwordx4 v3, s[8:11], 0 offen offset:2048 sc1 lds
v_mfma_f32_16x16x32_bf16 a[204:207], v[76:79], a[44:47], a[204:207]
s_waitcnt lgkmcnt(4)
v_mfma_f32_16x16x32_bf16 a[208:211], v[48:51], a[16:19], a[208:211]
v_mfma_f32_16x16x32_bf16 a[208:211], v[52:55], a[32:35], a[208:211]
v_mfma_f32_16x16x32_bf16 a[212:215], v[48:51], a[20:23], a[212:215]
ds_read_b128 v[72:75], v2 offset:38912
v_mfma_f32_16x16x32_bf16 a[212:215], v[52:55], a[36:39], a[212:215]
buffer_load_dwordx4 v3, s[8:11], 0 offen offset:3072 sc1 lds
v_mfma_f32_16x16x32_bf16 a[216:219], v[48:51], a[24:27], a[216:219]
s_add_u32 m0, s22, 77824
v_add_u32 v3, 4096, v3
v_mfma_f32_16x16x32_bf16 a[216:219], v[52:55], a[40:43], a[216:219]
ds_read_b128 v[76:79], v2 offset:39936
v_mfma_f32_16x16x32_bf16 a[220:223], v[48:51], a[28:31], a[220:223]
v_mfma_f32_16x16x32_bf16 a[220:223], v[52:55], a[44:47], a[220:223]
s_waitcnt lgkmcnt(4)
v_mfma_f32_16x16x32_bf16 a[224:227], v[56:59], a[16:19], a[224:227]
buffer_load_dwordx4 v3, s[8:11], 0 offen offset:0 sc1 lds
v_mfma_f32_16x16x32_bf16 a[224:227], v[60:63], a[32:35], a[224:227]
v_mfma_f32_16x16x32_bf16 a[228:231], v[56:59], a[20:23], a[228:231]
ds_read_b128 v[48:51], v2 offset:40960
v_mfma_f32_16x16x32_bf16 a[228:231], v[60:63], a[36:39], a[228:231]
v_mfma_f32_16x16x32_bf16 a[232:235], v[56:59], a[24:27], a[232:235]
v_mfma_f32_16x16x32_bf16 a[232:235], v[60:63], a[40:43], a[232:235]
ds_read_b128 v[52:55], v2 offset:41984
v_mfma_f32_16x16x32_bf16 a[236:239], v[56:59], a[28:31], a[236:239]
buffer_load_dwordx4 v3, s[8:11], 0 offen offset:1024 sc1 lds
v_mfma_f32_16x16x32_bf16 a[236:239], v[60:63], a[44:47], a[236:239]
s_waitcnt vmcnt(24)
s_waitcnt lgkmcnt(4)
v_mfma_f32_16x16x32_bf16 a[112:115], v[64:67], a[48:51], a[112:115]
v_mfma_f32_16x16x32_bf16 a[112:115], v[68:71], a[64:67], a[112:115]
v_mfma_f32_16x16x32_bf16 a[116:119], v[64:67], a[52:55], a[116:119]
ds_read_b128 v[56:59], v2 offset:43008
v_mfma_f32_16x16x32_bf16 a[116:119], v[68:71], a[68:71], a[116:119]
buffer_load_dwordx2 v[16:17], v248, s[8:11], s29 offen offset:0 sc1
v_mfma_f32_16x16x32_bf16 a[120:123], v[64:67], a[56:59], a[120:123]
v_mfma_f32_16x16x32_bf16 a[120:123], v[68:71], a[72:75], a[120:123]
ds_read_b128 v[60:63], v2 offset:44032
v_mfma_f32_16x16x32_bf16 a[124:127], v[64:67], a[60:63], a[124:127]
v_mfma_f32_16x16x32_bf16 a[124:127], v[68:71], a[76:79], a[124:127]
s_waitcnt lgkmcnt(4)
v_mfma_f32_16x16x32_bf16 a[128:131], v[72:75], a[48:51], a[128:131]
buffer_load_dwordx2 v[18:19], v248, s[8:11], s29 offen offset:512 sc1
v_mfma_f32_16x16x32_bf16 a[128:131], v[76:79], a[64:67], a[128:131]
v_mfma_f32_16x16x32_bf16 a[132:135], v[72:75], a[52:55], a[132:135]
ds_read_b128 v[64:67], v2 offset:45056
v_mfma_f32_16x16x32_bf16 a[132:135], v[76:79], a[68:71], a[132:135]
v_mfma_f32_16x16x32_bf16 a[136:139], v[72:75], a[56:59], a[136:139]
v_mfma_f32_16x16x32_bf16 a[136:139], v[76:79], a[72:75], a[136:139]
ds_read_b128 v[68:71], v2 offset:46080
v_mfma_f32_16x16x32_bf16 a[140:143], v[72:75], a[60:63], a[140:143]
buffer_load_dwordx2 v[20:21], v249, s[8:11], s29 offen offset:0 sc1
v_mfma_f32_16x16x32_bf16 a[140:143], v[76:79], a[76:79], a[140:143]
s_waitcnt lgkmcnt(4)
v_mfma_f32_16x16x32_bf16 a[144:147], v[48:51], a[48:51], a[144:147]
s_add_u32 s23, s34, 262144
v_mfma_f32_16x16x32_bf16 a[144:147], v[52:55], a[64:67], a[144:147]
v_mfma_f32_16x16x32_bf16 a[148:151], v[48:51], a[52:55], a[148:151]
ds_read_b128 v[72:75], v2 offset:47104
v_mfma_f32_16x16x32_bf16 a[148:151], v[52:55], a[68:71], a[148:151]
buffer_load_dwordx2 v[14:15], v11, s[8:11], s23 offen sc1
v_mfma_f32_16x16x32_bf16 a[152:155], v[48:51], a[56:59], a[152:155]
v_mfma_f32_16x16x32_bf16 a[152:155], v[52:55], a[72:75], a[152:155]
ds_read_b128 v[76:79], v2 offset:48128
v_mfma_f32_16x16x32_bf16 a[156:159], v[48:51], a[60:63], a[156:159]
v_mfma_f32_16x16x32_bf16 a[156:159], v[52:55], a[76:79], a[156:159]
s_waitcnt lgkmcnt(4)
v_mfma_f32_16x16x32_bf16 a[160:163], v[56:59], a[48:51], a[160:163]
s_waitcnt vmcnt(49)
v_mfma_f32_16x16x32_bf16 a[160:163], v[60:63], a[64:67], a[160:163]
s_barrier
v_mfma_f32_16x16x32_bf16 a[164:167], v[56:59], a[52:55], a[164:167]
ds_read_b128 v[48:51], v2 offset:49152
buffer_load_dwordx2 v[22:23], v249, s[8:11], s29 offen offset:512 sc1
v_mfma_f32_16x16x32_bf16 a[164:167], v[60:63], a[68:71], a[164:167]
v_mfma_f32_16x16x32_bf16 a[168:171], v[56:59], a[56:59], a[168:171]
v_mfma_f32_16x16x32_bf16 a[168:171], v[60:63], a[72:75], a[168:171]
ds_read_b128 v[52:55], v2 offset:50176
v_mfma_f32_16x16x32_bf16 a[172:175], v[56:59], a[60:63], a[172:175]
buffer_load_dwordx2 v[24:25], v250, s[8:11], s29 offen offset:0 sc1
v_mfma_f32_16x16x32_bf16 a[172:175], v[60:63], a[76:79], a[172:175]
s_waitcnt lgkmcnt(4)
v_mfma_f32_16x16x32_bf16 a[176:179], v[64:67], a[48:51], a[176:179]
v_mfma_f32_16x16x32_bf16 a[176:179], v[68:71], a[64:67], a[176:179]
v_mfma_f32_16x16x32_bf16 a[180:183], v[64:67], a[52:55], a[180:183]
ds_read_b128 v[56:59], v2 offset:51200
v_mfma_f32_16x16x32_bf16 a[180:183], v[68:71], a[68:71], a[180:183]
buffer_load_dwordx2 v[26:27], v250, s[8:11], s29 offen offset:512 sc1
v_mfma_f32_16x16x32_bf16 a[184:187], v[64:67], a[56:59], a[184:187]
v_mfma_f32_16x16x32_bf16 a[184:187], v[68:71], a[72:75], a[184:187]
ds_read_b128 v[60:63], v2 offset:52224
v_mfma_f32_16x16x32_bf16 a[188:191], v[64:67], a[60:63], a[188:191]
v_mfma_f32_16x16x32_bf16 a[188:191], v[68:71], a[76:79], a[188:191]
s_waitcnt lgkmcnt(4)
v_mfma_f32_16x16x32_bf16 a[192:195], v[72:75], a[48:51], a[192:195]
buffer_load_dwordx2 v[28:29], v251, s[8:11], s29 offen offset:0 sc1
v_mfma_f32_16x16x32_bf16 a[192:195], v[76:79], a[64:67], a[192:195]
v_mfma_f32_16x16x32_bf16 a[196:199], v[72:75], a[52:55], a[196:199]
ds_read_b128 v[64:67], v2 offset:53248
v_mfma_f32_16x16x32_bf16 a[196:199], v[76:79], a[68:71], a[196:199]
v_mfma_f32_16x16x32_bf16 a[200:203], v[72:75], a[56:59], a[200:203]
buffer_load_dwordx2 v[30:31], v251, s[8:11], s29 offen offset:512 sc1
v_mfma_f32_16x16x32_bf16 a[200:203], v[76:79], a[72:75], a[200:203]
ds_read_b128 v[68:71], v2 offset:54272
v_mfma_f32_16x16x32_bf16 a[204:207], v[72:75], a[60:63], a[204:207]
v_mfma_f32_16x16x32_bf16 a[204:207], v[76:79], a[76:79], a[204:207]
s_waitcnt lgkmcnt(4)
v_mfma_f32_16x16x32_bf16 a[208:211], v[48:51], a[48:51], a[208:211]
buffer_load_dwordx4 v[32:35], v2, s[8:11], s25 offen offset:2048 sc1
v_mfma_f32_16x16x32_bf16 a[208:211], v[52:55], a[64:67], a[208:211]
v_mfma_f32_16x16x32_bf16 a[212:215], v[48:51], a[52:55], a[212:215]
ds_read_b128 v[72:75], v2 offset:55296
v_mfma_f32_16x16x32_bf16 a[212:215], v[52:55], a[68:71], a[212:215]
v_mfma_f32_16x16x32_bf16 a[216:219], v[48:51], a[56:59], a[216:219]
buffer_load_dwordx4 v[36:39], v4, s[8:11], s25 offen offset:2048 sc1
v_mfma_f32_16x16x32_bf16 a[216:219], v[52:55], a[72:75], a[216:219]
ds_read_b128 v[76:79], v2 offset:56320
v_mfma_f32_16x16x32_bf16 a[220:223], v[48:51], a[60:63], a[220:223]
v_mfma_f32_16x16x32_bf16 a[220:223], v[52:55], a[76:79], a[220:223]
s_waitcnt lgkmcnt(4)
v_mfma_f32_16x16x32_bf16 a[224:227], v[56:59], a[48:51], a[224:227]
buffer_load_dwordx4 v[40:43], v5, s[8:11], s25 offen offset:2048 sc1
v_mfma_f32_16x16x32_bf16 a[224:227], v[60:63], a[64:67], a[224:227]
v_mfma_f32_16x16x32_bf16 a[228:231], v[56:59], a[52:55], a[228:231]
ds_read_b128 v[48:51], v2 offset:57344
v_mfma_f32_16x16x32_bf16 a[228:231], v[60:63], a[68:71], a[228:231]
v_mfma_f32_16x16x32_bf16 a[232:235], v[56:59], a[56:59], a[232:235]
buffer_load_dwordx4 v[44:47], v6, s[8:11], s25 offen offset:2048 sc1
v_mfma_f32_16x16x32_bf16 a[232:235], v[60:63], a[72:75], a[232:235]
ds_read_b128 v[52:55], v2 offset:58368
v_mfma_f32_16x16x32_bf16 a[236:239], v[56:59], a[60:63], a[236:239]
v_mfma_f32_16x16x32_bf16 a[236:239], v[60:63], a[76:79], a[236:239]
s_waitcnt vmcnt(20)
s_waitcnt lgkmcnt(4)
v_mfma_f32_16x16x32_bf16 a[112:115], v[64:67], a[80:83], a[112:115]
buffer_load_dwordx4 v[80:83], v2, s[8:11], s26 offen offset:2048 sc1
v_mfma_f32_16x16x32_bf16 a[112:115], v[68:71], a[96:99], a[112:115]
v_mfma_f32_16x16x32_bf16 a[116:119], v[64:67], a[84:87], a[116:119]
ds_read_b128 v[56:59], v2 offset:59392
v_mfma_f32_16x16x32_bf16 a[116:119], v[68:71], a[100:103], a[116:119]
v_mfma_f32_16x16x32_bf16 a[120:123], v[64:67], a[88:91], a[120:123]
buffer_load_dwordx4 v[84:87], v4, s[8:11], s26 offen offset:2048 sc1
v_mfma_f32_16x16x32_bf16 a[120:123], v[68:71], a[104:107], a[120:123]
ds_read_b128 v[60:63], v2 offset:60416
v_mfma_f32_16x16x32_bf16 a[124:127], v[64:67], a[92:95], a[124:127]
v_mfma_f32_16x16x32_bf16 a[124:127], v[68:71], a[108:111], a[124:127]
s_waitcnt lgkmcnt(4)
v_mfma_f32_16x16x32_bf16 a[128:131], v[72:75], a[80:83], a[128:131]
buffer_load_dwordx4 v[88:91], v5, s[8:11], s26 offen offset:2048 sc1
v_mfma_f32_16x16x32_bf16 a[128:131], v[76:79], a[96:99], a[128:131]
v_mfma_f32_16x16x32_bf16 a[132:135], v[72:75], a[84:87], a[132:135]
ds_read_b128 v[64:67], v2 offset:61440
v_mfma_f32_16x16x32_bf16 a[132:135], v[76:79], a[100:103], a[132:135]
v_mfma_f32_16x16x32_bf16 a[136:139], v[72:75], a[88:91], a[136:139]
buffer_load_dwordx4 v[92:95], v6, s[8:11], s26 offen offset:2048 sc1
v_mfma_f32_16x16x32_bf16 a[136:139], v[76:79], a[104:107], a[136:139]
ds_read_b128 v[68:71], v2 offset:62464
s_waitcnt vmcnt(13)
v_cmp_eq_u64 vcc, s[68:69], v[14:15]
s_nop 0
s_cmp_eq_u64 vcc, exec
s_cbranch_scc0 L_f_slow3
L_f_back3:
v_mfma_f32_16x16x32_bf16 a[140:143], v[72:75], a[92:95], a[140:143]
v_mfma_f32_16x16x32_bf16 a[140:143], v[76:79], a[108:111], a[140:143]
s_waitcnt lgkmcnt(4)
v_mfma_f32_16x16x32_bf16 a[144:147], v[48:51], a[80:83], a[144:147]
buffer_load_dwordx4 v[96:99], v2, s[8:11], s27 offen offset:2048 sc1
v_mfma_f32_16x16x32_bf16 a[144:147], v[52:55], a[96:99], a[144:147]
v_mfma_f32_16x16x32_bf16 a[148:151], v[48:51], a[84:87], a[148:151]
ds_read_b128 v[72:75], v2 offset:63488
v_mfma_f32_16x16x32_bf16 a[148:151], v[52:55], a[100:103], a[148:151]
v_mfma_f32_16x16x32_bf16 a[152:155], v[48:51], a[88:91], a[152:155]
buffer_load_dwordx4 v[100:103], v4, s[8:11], s27 offen offset:2048 sc1
v_mfma_f32_16x16x32_bf16 a[152:155], v[52:55], a[104:107], a[152:155]
ds_read_b128 v[76:79], v2 offset:64512
v_mfma_f32_16x16x32_bf16 a[156:159], v[48:51], a[92:95], a[156:159]
v_mfma_f32_16x16x32_bf16 a[156:159], v[52:55], a[108:111], a[156:159]
s_waitcnt lgkmcnt(4)
v_mfma_f32_16x16x32_bf16 a[160:163], v[56:59], a[80:83], a[160:163]
buffer_load_dwordx4 v[104:107], v5, s[8:11], s27 offen offset:2048 sc1
v_mfma_f32_16x16x32_bf16 a[160:163], v[60:63], a[96:99], a[160:163]
v_mfma_f32_16x16x32_bf16 a[164:167], v[56:59], a[84:87], a[164:167]
ds_read_b128 v[48:51], v7 offset:0
v_mfma_f32_16x16x32_bf16 a[164:167], v[60:63], a[100:103], a[164:167]
v_mfma_f32_16x16x32_bf16 a[168:171], v[56:59], a[88:91], a[168:171]
buffer_load_dwordx4 v[108:111], v6, s[8:11], s27 offen offset:2048 sc1
v_mfma_f32_16x16x32_bf16 a[168:171], v[60:63], a[104:107], a[168:171]
ds_read_b128 v[52:55], v7 offset:1024
v_mfma_f32_16x16x32_bf16 a[172:175], v[56:59], a[92:95], a[172:175]
v_mfma_f32_16x16x32_bf16 a[172:175], v[60:63], a[108:111], a[172:175]
s_waitcnt lgkmcnt(4)
v_mfma_f32_16x16x32_bf16 a[176:179], v[64:67], a[80:83], a[176:179]
buffer_load_dwordx4 v[112:115], v2, s[8:11], s25 offen offset:3072 sc1
v_mfma_f32_16x16x32_bf16 a[176:179], v[68:71], a[96:99], a[176:179]
v_mfma_f32_16x16x32_bf16 a[180:183], v[64:67], a[84:87], a[180:183]
ds_read_b128 v[56:59], v7 offset:2048
v_mfma_f32_16x16x32_bf16 a[180:183], v[68:71], a[100:103], a[180:183]
v_mfma_f32_16x16x32_bf16 a[184:187], v[64:67], a[88:91], a[184:187]
buffer_load_dwordx4 v[116:119], v4, s[8:11], s25 offen offset:3072 sc1
v_mfma_f32_16x16x32_bf16 a[184:187], v[68:71], a[104:107], a[184:187]
ds_read_b128 v[60:63], v7 offset:3072
v_mfma_f32_16x16x32_bf16 a[188:191], v[64:67], a[92:95], a[188:191]
v_mfma_f32_16x16x32_bf16 a[188:191], v[68:71], a[108:111], a[188:191]
s_waitcnt lgkmcnt(4)
v_mfma_f32_16x16x32_bf16 a[192:195], v[72:75], a[80:83], a[192:195]
buffer_load_dwordx4 v[120:123], v5, s[8:11], s25 offen offset:3072 sc1
v_mfma_f32_16x16x32_bf16 a[192:195], v[76:79], a[96:99], a[192:195]
v_mfma_f32_16x16x32_bf16 a[196:199], v[72:75], a[84:87], a[196:199]
ds_read_b128 v[64:67], v7 offset:4096
v_mfma_f32_16x16x32_bf16 a[196:199], v[76:79], a[100:103], a[196:199]
v_mfma_f32_16x16x32_bf16 a[200:203], v[72:75], a[88:91], a[200:203]
buffer_load_dwordx4 v[124:127], v6, s[8:11], s25 offen offset:3072 sc1
v_mfma_f32_16x16x32_bf16 a[200:203], v[76:79], a[104:107], a[200:203]
ds_read_b128 v[68:71], v7 offset:5120
v_mfma_f32_16x16x32_bf16 a[204:207], v[72:75], a[92:95], a[204:207]
v_mfma_f32_16x16x32_bf16 a[204:207], v[76:79], a[108:111], a[204:207]
s_waitcnt lgkmcnt(4)
v_mfma_f32_16x16x32_bf16 a[208:211], v[48:51], a[80:83], a[208:211]
buffer_load_dwordx4 v[128:131], v2, s[8:11], s26 offen offset:3072 sc1
v_mfma_f32_16x16x32_bf16 a[208:211], v[52:55], a[96:99], a[208:211]
v_mfma_f32_16x16x32_bf16 a[212:215], v[48:51], a[84:87], a[212:215]
ds_read_b128 v[72:75], v7 offset:6144
v_mfma_f32_16x16x32_bf16 a[212:215], v[52:55], a[100:103], a[212:215]
v_mfma_f32_16x16x32_bf16 a[216:219], v[48:51], a[88:91], a[216:219]
buffer_load_dwordx4 v[132:135], v4, s[8:11], s26 offen offset:3072 sc1
v_mfma_f32_16x16x32_bf16 a[216:219], v[52:55], a[104:107], a[216:219]
ds_read_b128 v[76:79], v7 offset:7168
v_mfma_f32_16x16x32_bf16 a[220:223], v[48:51], a[92:95], a[220:223]
v_mfma_f32_16x16x32_bf16 a[220:223], v[52:55], a[108:111], a[220:223]
s_waitcnt lgkmcnt(4)
v_mfma_f32_16x16x32_bf16 a[224:227], v[56:59], a[80:83], a[224:227]
s_waitcnt vmcnt(27)
v_mfma_f32_16x16x32_bf16 a[224:227], v[60:63], a[96:99], a[224:227]
s_barrier
v_mfma_f32_16x16x32_bf16 a[228:231], v[56:59], a[84:87], a[228:231]
ds_read_b128 v[48:51], v7 offset:8192
buffer_load_dwordx4 v[136:139], v5, s[8:11], s26 offen offset:3072 sc1
v_mfma_f32_16x16x32_bf16 a[228:231], v[60:63], a[100:103], a[228:231]
v_mfma_f32_16x16x32_bf16 a[232:235], v[56:59], a[88:91], a[232:235]
v_mfma_f32_16x16x32_bf16 a[232:235], v[60:63], a[104:107], a[232:235]
ds_read_b128 v[52:55], v7 offset:9216
v_mfma_f32_16x16x32_bf16 a[236:239], v[56:59], a[92:95], a[236:239]
buffer_load_dwordx4 v[140:143], v6, s[8:11], s26 offen offset:3072 sc1
v_mfma_f32_16x16x32_bf16 a[236:239], v[60:63], a[108:111], a[236:239]
s_waitcnt vmcnt(20)
s_waitcnt lgkmcnt(4)
v_mfma_f32_16x16x32_bf16 a[112:115], v[64:67], v[16:19], a[112:115]
v_mfma_f32_16x16x32_bf16 a[112:115], v[68:71], v[192:195], a[112:115]
v_mfma_f32_16x16x32_bf16 a[116:119], v[64:67], v[20:23], a[116:119]
ds_read_b128 v[56:59], v7 offset:10240
v_mfma_f32_16x16x32_bf16 a[116:119], v[68:71], v[196:199], a[116:119]
buffer_load_dwordx4 v[232:235], v2, s[8:11], s27 offen offset:3072 sc1
v_mfma_f32_16x16x32_bf16 a[120:123], v[64:67], v[24:27], a[120:123]
v_mfma_f32_16x16x32_bf16 a[120:123], v[68:71], v[200:203], a[120:123]
ds_read_b128 v[60:63], v7 offset:11264
v_mfma_f32_16x16x32_bf16 a[124:127], v[64:67], v[28:31], a[124:127]
v_mfma_f32_16x16x32_bf16 a[124:127], v[68:71], v[204:207], a[124:127]
s_waitcnt lgkmcnt(4)
v_mfma_f32_16x16x32_bf16 a[128:131], v[72:75], v[16:19], a[128:131]
buffer_load_dwordx4 v[236:239], v4, s[8:11], s27 offen offset:3072 sc1
v_mfma_f32_16x16x32_bf16 a[128:131], v[76:79], v[192:195], a[128:131]
L_hop9:
s_cmp_eq_u32 s15, 1
s_cbranch_scc1 L_hop13
v_mfma_f32_16x16x32_bf16 a[132:135], v[72:75], v[20:23], a[132:135]
ds_read_b128 v[64:67], v7 offset:12288
v_mfma_f32_16x16x32_bf16 a[132:135], v[76:79], v[196:199], a[132:135]
v_mfma_f32_16x16x32_bf16 a[136:139], v[72:75], v[24:27], a[136:139]
buffer_load_dwordx4 v[240:243], v5, s[8:11], s27 offen offset:3072 sc1
v_mfma_f32_16x16x32_bf16 a[136:139], v[76:79], v[200:203], a[136:139]
ds_read_b128 v[68:71], v7 offset:13312
v_mfma_f32_16x16x32_bf16 a[140:143], v[72:75], v[28:31], a[140:143]
v_mfma_f32_16x16x32_bf16 a[140:143], v[76:79], v[204:207], a[140:143]
s_waitcnt lgkmcnt(4)
v_mfma_f32_16x16x32_bf16 a[144:147], v[48:51], v[16:19], a[144:147]
buffer_load_dwordx4 v[244:247], v6, s[8:11], s27 offen offset:3072 sc1
v_mfma_f32_16x16x32_bf16 a[144:147], v[52:55], v[192:195], a[144:147]
s_add_u32 m0, s22, 98304
v_add_u32 v3, 20480, v3
v_mfma_f32_16x16x32_bf16 a[148:151], v[48:51], v[20:23], a[148:151]
ds_read_b128 v[72:75], v7 offset:14336
v_mfma_f32_16x16x32_bf16 a[148:151], v[52:55], v[196:199], a[148:151]
v_mfma_f32_16x16x32_bf16 a[152:155], v[48:51], v[24:27], a[152:155]
buffer_load_dwordx4 v3, s[8:11], 0 offen offset:0 sc1 lds
v_mfma_f32_16x16x32_bf16 a[152:155], v[52:55], v[200:203], a[152:155]
ds_read_b128 v[76:79], v7 offset:15360
v_mfma_f32_16x16x32_bf16 a[156:159], v[48:51], v[28:31], a[156:159]
v_mfma_f32_16x16x32_bf16 a[156:159], v[52:55], v[204:207], a[156:159]
s_waitcnt lgkmcnt(4)
v_mfma_f32_16x16x32_bf16 a[160:163], v[56:59], v[16:19], a[160:163]
buffer_load_dwordx4 v3, s[8:11], 0 offen offset:1024 sc1 lds
v_mfma_f32_16x16x32_bf16 a[160:163], v[60:63], v[192:195], a[160:163]
v_mfma_f32_16x16x32_bf16 a[164:167], v[56:59], v[20:23], a[164:167]
ds_read_b128 v[48:51], v7 offset:16384
v_mfma_f32_16x16x32_bf16 a[164:167], v[60:63], v[196:199], a[164:167]
v_mfma_f32_16x16x32_bf16 a[168:171], v[56:59], v[24:27], a[168:171]
buffer_load_dwordx4 v3, s[8:11], 0 offen offset:2048 sc1 lds
v_mfma_f32_16x16x32_bf16 a[168:171], v[60:63], v[200:203], a[168:171]
ds_read_b128 v[52:55], v7 offset:17408
v_mfma_f32_16x16x32_bf16 a[172:175], v[56:59], v[28:31], a[172:175]
v_mfma_f32_16x16x32_bf16 a[172:175], v[60:63], v[204:207], a[172:175]
s_waitcnt vmcnt(19)
s_waitcnt lgkmcnt(4)
v_mfma_f32_16x16x32_bf16 a[112:115], v[64:67], v[32:35], a[112:115]
buffer_load_dwordx4 v3, s[8:11], 0 offen offset:3072 sc1 lds
v_mfma_f32_16x16x32_bf16 a[112:115], v[68:71], v[80:83], a[112:115]
s_add_u32 m0, s22, 102400
v_add_u32 v3, 4096, v3
v_mfma_f32_16x16x32_bf16 a[116:119], v[64:67], v[36:39], a[116:119]
ds_read_b128 v[56:59], v7 offset:18432
v_mfma_f32_16x16x32_bf16 a[116:119], v[68:71], v[84:87], a[116:119]
v_mfma_f32_16x16x32_bf16 a[120:123], v[64:67], v[40:43], a[120:123]
buffer_load_dwordx4 v3, s[8:11], 0 offen offset:0 sc1 lds
v_mfma_f32_16x16x32_bf16 a[120:123], v[68:71], v[88:91], a[120:123]
ds_read_b128 v[60:63], v7 offset:19456
v_mfma_f32_16x16x32_bf16 a[124:127], v[64:67], v[44:47], a[124:127]
v_mfma_f32_16x16x32_bf16 a[124:127], v[68:71], v[92:95], a[124:127]
s_waitcnt lgkmcnt(4)
v_mfma_f32_16x16x32_bf16 a[128:131], v[72:75], v[32:35], a[128:131]
buffer_load_dwordx4 v3, s[8:11], 0 offen offset:1024 sc1 lds
v_mfma_f32_16x16x32_bf16 a[128:131], v[76:79], v[80:83], a[128:131]
s_add_u32 m0, s22, 122880
v_add_u32 v3, 20480, v3
v_mfma_f32_16x16x32_bf16 a[132:135], v[72:75], v[36:39], a[132:135]
ds_read_b128 v[64:67], v7 offset:20480
v_mfma_f32_16x16x32_bf16 a[132:135], v[76:79], v[84:87], a[132:135]
v_mfma_f32_16x16x32_bf16 a[136:139], v[72:75], v[40:43], a[136:139]
v_mfma_f32_16x16x32_bf16 a[136:139], v[76:79], v[88:91], a[136:139]
ds_read_b128 v[68:71], v7 offset:21504
v_mfma_f32_16x16x32_bf16 a[140:143], v[72:75], v[44:47], a[140:143]
buffer_load_dwordx4 v3, s[8:11], 0 offen offset:0 sc1 lds
v_mfma_f32_16x16x32_bf16 a[140:143], v[76:79], v[92:95], a[140:143]
s_waitcnt lgkmcnt(4)
v_mfma_f32_16x16x32_bf16 a[144:147], v[48:51], v[32:35], a[144:147]
v_mfma_f32_16x16x32_bf16 a[144:147], v[52:55], v[80:83], a[144:147]
v_mfma_f32_16x16x32_bf16 a[148:151], v[48:51], v[36:39], a[148:151]
ds_read_b128 v[72:75], v7 offset:22528
v_mfma_f32_16x16x32_bf16 a[148:151], v[52:55], v[84:87], a[148:151]
buffer_load_dwordx4 v3, s[8:11], 0 offen offset:1024 sc1 lds
v_mfma_f32_16x16x32_bf16 a[152:155], v[48:51], v[40:43], a[152:155]
v_mfma_f32_16x16x32_bf16 a[152:155], v[52:55], v[88:91], a[152:155]
ds_read_b128 v[76:79], v7 offset:23552
v_mfma_f32_16x16x32_bf16 a[156:159], v[48:51], v[44:47], a[156:159]
v_mfma_f32_16x16x32_bf16 a[156:159], v[52:55], v[92:95], a[156:159]
s_waitcnt lgkmcnt(4)
v_mfma_f32_16x16x32_bf16 a[160:163], v[56:59], v[32:35], a[160:163]
buffer_load_dwordx4 v3, s[8:11], 0 offen offset:2048 sc1 lds
v_mfma_f32_16x16x32_bf16 a[160:163], v[60:63], v[80:83], a[160:163]
v_mfma_f32_16x16x32_bf16 a[164:167], v[56:59], v[36:39], a[164:167]
ds_read_b128 v[48:51], v7 offset:24576
v_mfma_f32_16x16x32_bf16 a[164:167], v[60:63], v[84:87], a[164:167]
v_mfma_f32_16x16x32_bf16 a[168:171], v[56:59], v[40:43], a[168:171]
v_mfma_f32_16x16x32_bf16 a[168:171], v[60:63], v[88:91], a[168:171]
ds_read_b128 v[52:55], v7 offset:25600
v_mfma_f32_16x16x32_bf16 a[172:175], v[56:59], v[44:47], a[172:175]
buffer_load_dwordx4 v3, s[8:11], 0 offen offset:3072 sc1 lds
v_mfma_f32_16x16x32_bf16 a[172:175], v[60:63], v[92:95], a[172:175]
s_add_u32 m0, s22, 126976
s_waitcnt vmcnt(18)
s_waitcnt lgkmcnt(4)
v_mfma_f32_16x16x32_bf16 a[112:115], v[64:67], v[96:99], a[112:115]
v_add_u32 v3, 4096, v3
v_mfma_f32_16x16x32_bf16 a[112:115], v[68:71], v[112:115], a[112:115]
v_mfma_f32_16x16x32_bf16 a[116:119], v[64:67], v[100:103], a[116:119]
ds_read_b128 v[56:59], v7 offset:26624
v_mfma_f32_16x16x32_bf16 a[116:119], v[68:71], v[116:119], a[116:119]
buffer_load_dwordx4 v3, s[8:11], 0 offen offset:0 sc1 lds
v_mfma_f32_16x16x32_bf16 a[120:123], v[64:67], v[104:107], a[120:123]
v_mfma_f32_16x16x32_bf16 a[120:123], v[68:71], v[120:123], a[120:123]
ds_read_b128 v[60:63], v7 offset:27648
v_mfma_f32_16x16x32_bf16 a[124:127], v[64:67], v[108:111], a[124:127]
v_mfma_f32_16x16x32_bf16 a[124:127], v[68:71], v[124:127], a[124:127]
s_waitcnt vmcnt(11)
s_waitcnt lgkmcnt(4)
v_mfma_f32_16x16x32_bf16 a[112:115], v[72:75], v[128:131], a[112:115]
buffer_load_dwordx4 v3, s[8:11], 0 offen offset:1024 sc1 lds
v_mfma_f32_16x16x32_bf16 a[112:115], v[76:79], v[232:235], a[112:115]
s_lshl_b32 s21, s4, 11
s_add_u32 m0, s21, 0
v_mfma_f32_16x16x32_bf16 a[116:119], v[72:75], v[132:135], a[116:119]
ds_read_b128 v[64:67], v7 offset:28672
s_sub_u32 s21, s21, s22
v_mfma_f32_16x16x32_bf16 a[116:119], v[76:79], v[236:239], a[116:119]
s_add_u32 s21, s21, 20480
v_add_u32 v3, s21, v3
v_mfma_f32_16x16x32_bf16 a[120:123], v[72:75], v[136:139], a[120:123]
v_mfma_f32_16x16x32_bf16 a[120:123], v[76:79], v[240:243], a[120:123]
ds_read_b128 v[68:71], v7 offset:29696
v_mfma_f32_16x16x32_bf16 a[124:127], v[72:75], v[140:143], a[124:127]
buffer_load_dwordx4 v3, s[8:11], 0 offen offset:0 sc1 lds
v_mfma_f32_16x16x32_bf16 a[124:127], v[76:79], v[244:247], a[124:127]
s_waitcnt lgkmcnt(4)
v_mfma_f32_16x16x32_bf16 a[128:131], v[48:51], v[96:99], a[128:131]
v_mfma_f32_16x16x32_bf16 a[128:131], v[52:55], v[112:115], a[128:131]
v_mfma_f32_16x16x32_bf16 a[132:135], v[48:51], v[100:103], a[132:135]
ds_read_b128 v[72:75], v7 offset:30720
v_mfma_f32_16x16x32_bf16 a[132:135], v[52:55], v[116:119], a[132:135]
buffer_load_dwordx4 v3, s[8:11], 0 offen offset:1024 sc1 lds
v_mfma_f32_16x16x32_bf16 a[136:139], v[48:51], v[104:107], a[136:139]
v_mfma_f32_16x16x32_bf16 a[136:139], v[52:55], v[120:123], a[136:139]
ds_read_b128 v[76:79], v7 offset:31744
v_mfma_f32_16x16x32_bf16 a[140:143], v[48:51], v[108:111], a[140:143]
v_mfma_f32_16x16x32_bf16 a[140:143], v[52:55], v[124:127], a[140:143]
s_waitcnt lgkmcnt(4)
v_mfma_f32_16x16x32_bf16 a[128:131], v[56:59], v[128:131], a[128:131]
s_waitcnt vmcnt(8)
v_mfma_f32_16x16x32_bf16 a[128:131], v[60:63], v[232:235], a[128:131]
s_barrier
v_mfma_f32_16x16x32_bf16 a[132:135], v[56:59], v[132:135], a[132:135]
ds_read_b128 v[48:51], v7 offset:32768
v_mfma_f32_16x16x32_bf16 a[132:135], v[60:63], v[236:239], a[132:135]
v_mfma_f32_16x16x32_bf16 a[136:139], v[56:59], v[136:139], a[136:139]
v_mfma_f32_16x16x32_bf16 a[136:139], v[60:63], v[240:243], a[136:139]
ds_read_b128 v[52:55], v7 offset:33792
v_mfma_f32_16x16x32_bf16 a[140:143], v[56:59], v[140:143], a[140:143]
v_mfma_f32_16x16x32_bf16 a[140:143], v[60:63], v[244:247], a[140:143]
s_waitcnt lgkmcnt(4)
v_mfma_f32_16x16x32_bf16 a[144:147], v[64:67], v[96:99], a[144:147]
v_mfma_f32_16x16x32_bf16 a[144:147], v[68:71], v[112:115], a[144:147]
v_mfma_f32_16x16x32_bf16 a[148:151], v[64:67], v[100:103], a[148:151]
ds_read_b128 v[56:59], v7 offset:34816
v_mfma_f32_16x16x32_bf16 a[148:151], v[68:71], v[116:119], a[148:151]
v_mfma_f32_16x16x32_bf16 a[152:155], v[64:67], v[104:107], a[152:155]
v_mfma_f32_16x16x32_bf16 a[152:155], v[68:71], v[120:123], a[152:155]
ds_read_b128 v[60:63], v7 offset:35840
v_mfma_f32_16x16x32_bf16 a[156:159], v[64:67], v[108:111], a[156:159]
v_mfma_f32_16x16x32_bf16 a[156:159], v[68:71], v[124:127], a[156:159]
s_waitcnt lgkmcnt(4)
v_mfma_f32_16x16x32_bf16 a[144:147], v[72:75], v[128:131], a[144:147]
v_mfma_f32_16x16x32_bf16 a[144:147], v[76:79], v[232:235], a[144:147]
v_mfma_f32_16x16x32_bf16 a[148:151], v[72:75], v[132:135], a[148:151]
ds_read_b128 v[64:67], v7 offset:36864
v_mfma_f32_16x16x32_bf16 a[148:151], v[76:79], v[236:239], a[148:151]
v_mfma_f32_16x16x32_bf16 a[152:155], v[72:75], v[136:139], a[152:155]
v_mfma_f32_16x16x32_bf16 a[152:155], v[76:79], v[240:243], a[152:155]
ds_read_b128 v[68:71], v7 offset:37888
v_mfma_f32_16x16x32_bf16 a[156:159], v[72:75], v[140:143], a[156:159]
v_mfma_f32_16x16x32_bf16 a[156:159], v[76:79], v[244:247], a[156:159]
s_waitcnt lgkmcnt(4)
v_mfma_f32_16x16x32_bf16 a[160:163], v[48:51], v[96:99], a[160:163]
v_mfma_f32_16x16x32_bf16 a[160:163], v[52:55], v[112:115], a[160:163]
v_mfma_f32_16x16x32_bf16 a[164:167], v[48:51], v[100:103], a[164:167]
ds_read_b128 v[72:75], v7 offset:38912
v_mfma_f32_16x16x32_bf16 a[164:167], v[52:55], v[116:119], a[164:167]
v_mfma_f32_16x16x32_bf16 a[168:171], v[48:51], v[104:107], a[168:171]
v_mfma_f32_16x16x32_bf16 a[168:171], v[52:55], v[120:123], a[168:171]
ds_read_b128 v[76:79], v7 offset:39936
v_mfma_f32_16x16x32_bf16 a[172:175], v[48:51], v[108:111], a[172:175]
v_mfma_f32_16x16x32_bf16 a[172:175], v[52:55], v[124:127], a[172:175]
s_waitcnt lgkmcnt(4)
v_mfma_f32_16x16x32_bf16 a[160:163], v[56:59], v[128:131], a[160:163]
v_mfma_f32_16x16x32_bf16 a[160:163], v[60:63], v[232:235], a[160:163]
v_mfma_f32_16x16x32_bf16 a[164:167], v[56:59], v[132:135], a[164:167]
ds_read_b128 v[48:51], v7 offset:40960
v_mfma_f32_16x16x32_bf16 a[164:167], v[60:63], v[236:239], a[164:167]
v_mfma_f32_16x16x32_bf16 a[168:171], v[56:59], v[136:139], a[168:171]
v_mfma_f32_16x16x32_bf16 a[168:171], v[60:63], v[240:243], a[168:171]
ds_read_b128 v[52:55], v7 offset:41984
v_mfma_f32_16x16x32_bf16 a[172:175], v[56:59], v[140:143], a[172:175]
v_mfma_f32_16x16x32_bf16 a[172:175], v[60:63], v[244:247], a[172:175]
s_waitcnt lgkmcnt(4)
v_mfma_f32_16x16x32_bf16 a[176:179], v[64:67], v[16:19], a[176:179]
v_mfma_f32_16x16x32_bf16 a[176:179], v[68:71], v[192:195], a[176:179]
v_mfma_f32_16x16x32_bf16 a[180:183], v[64:67], v[20:23], a[180:183]
ds_read_b128 v[56:59], v7 offset:43008
v_mfma_f32_16x16x32_bf16 a[180:183], v[68:71], v[196:199], a[180:183]
v_accvgpr_read_b32 v208, a112
v_accvgpr_read_b32 v209, a128
v_mfma_f32_16x16x32_bf16 a[184:187], v[64:67], v[24:27], a[184:187]
v_accvgpr_read_b32 v210, a144
v_accvgpr_read_b32 v211, a160
v_mfma_f32_16x16x32_bf16 a[184:187], v[68:71], v[200:203], a[184:187]
ds_read_b128 v[60:63], v7 offset:44032
v_accvgpr_read_b32 v212, a113
v_mfma_f32_16x16x32_bf16 a[188:191], v[64:67], v[28:31], a[188:191]
v_accvgpr_read_b32 v213, a129
v_accvgpr_read_b32 v214, a145
v_mfma_f32_16x16x32_bf16 a[188:191], v[68:71], v[204:207], a[188:191]
v_accvgpr_read_b32 v215, a161
s_waitcnt lgkmcnt(4)
v_mfma_f32_16x16x32_bf16 a[192:195], v[72:75], v[16:19], a[192:195]
v_cvt_pk_bf16_f32 v224, v208, v209
v_cvt_pk_bf16_f32 v225, v210, v211
v_mfma_f32_16x16x32_bf16 a[192:195], v[76:79], v[192:195], a[192:195]
v_cvt_pk_bf16_f32 v226, v212, v213
v_cvt_pk_bf16_f32 v227, v214, v215
v_mfma_f32_16x16x32_bf16 a[196:199], v[72:75], v[20:23], a[196:199]
ds_read_b128 v[64:67], v7 offset:45056
v_accvgpr_read_b32 v216, a114
v_mfma_f32_16x16x32_bf16 a[196:199], v[76:79], v[196:199], a[196:199]
buffer_store_dwordx4 v[224:227], v252, s[8:11], s36 offen offset:0 sc1
v_mfma_f32_16x16x32_bf16 a[200:203], v[72:75], v[24:27], a[200:203]
v_accvgpr_read_b32 v217, a130
v_accvgpr_read_b32 v218, a146
v_mfma_f32_16x16x32_bf16 a[200:203], v[76:79], v[200:203], a[200:203]
ds_read_b128 v[68:71], v7 offset:46080
v_accvgpr_read_b32 v219, a162
v_mfma_f32_16x16x32_bf16 a[204:207], v[72:75], v[28:31], a[204:207]
v_accvgpr_read_b32 v220, a115
v_accvgpr_read_b32 v221, a131
v_mfma_f32_16x16x32_bf16 a[204:207], v[76:79], v[204:207], a[204:207]
v_accvgpr_read_b32 v222, a147
s_waitcnt lgkmcnt(4)
v_mfma_f32_16x16x32_bf16 a[208:211], v[48:51], v[16:19], a[208:211]
v_accvgpr_read_b32 v223, a163
v_cvt_pk_bf16_f32 v228, v216, v217
v_mfma_f32_16x16x32_bf16 a[208:211], v[52:55], v[192:195], a[208:211]
v_cvt_pk_bf16_f32 v229, v218, v219
v_cvt_pk_bf16_f32 v230, v220, v221
v_mfma_f32_16x16x32_bf16 a[212:215], v[48:51], v[20:23], a[212:215]
ds_read_b128 v[72:75], v7 offset:47104
v_cvt_pk_bf16_f32 v231, v222, v223
v_mfma_f32_16x16x32_bf16 a[212:215], v[52:55], v[196:199], a[212:215]
buffer_store_dwordx4 v[228:231], v252, s[8:11], s36 offen offset:256 sc1
v_mfma_f32_16x16x32_bf16 a[216:219], v[48:51], v[24:27], a[216:219]
v_accvgpr_read_b32 v208, a116
v_accvgpr_read_b32 v209, a132
v_mfma_f32_16x16x32_bf16 a[216:219], v[52:55], v[200:203], a[216:219]
ds_read_b128 v[76:79], v7 offset:48128
v_accvgpr_read_b32 v210, a148
v_mfma_f32_16x16x32_bf16 a[220:223], v[48:51], v[28:31], a[220:223]
v_accvgpr_read_b32 v211, a164
v_accvgpr_read_b32 v212, a117
v_mfma_f32_16x16x32_bf16 a[220:223], v[52:55], v[204:207], a[220:223]
v_accvgpr_read_b32 v213, a133
s_waitcnt lgkmcnt(4)
v_mfma_f32_16x16x32_bf16 a[224:227], v[56:59], v[16:19], a[224:227]
v_accvgpr_read_b32 v214, a149
v_accvgpr_read_b32 v215, a165
v_mfma_f32_16x16x32_bf16 a[224:227], v[60:63], v[192:195], a[224:227]
v_cvt_pk_bf16_f32 v224, v208, v209
v_cvt_pk_bf16_f32 v225, v210, v211
v_mfma_f32_16x16x32_bf16 a[228:231], v[56:59], v[20:23], a[228:231]
ds_read_b128 v[48:51], v7 offset:49152
v_cvt_pk_bf16_f32 v226, v212, v213
v_mfma_f32_16x16x32_bf16 a[228:231], v[60:63], v[196:199], a[228:231]
v_cvt_pk_bf16_f32 v227, v214, v215
v_accvgpr_read_b32 v216, a118
v_mfma_f32_16x16x32_bf16 a[232:235], v[56:59], v[24:27], a[232:235]
buffer_store_dwordx4 v[224:227], v252, s[8:11], s37 offen offset:0 sc1
v_mfma_f32_16x16x32_bf16 a[232:235], v[60:63], v[200:203], a[232:235]
ds_read_b128 v[52:55], v7 offset:50176
v_accvgpr_read_b32 v217, a134
v_mfma_f32_16x16x32_bf16 a[236:239], v[56:59], v[28:31], a[236:239]
v_accvgpr_read_b32 v218, a150
v_accvgpr_read_b32 v219, a166
v_mfma_f32_16x16x32_bf16 a[236:239], v[60:63], v[204:207], a[236:239]
v_accvgpr_read_b32 v220, a119
s_waitcnt lgkmcnt(4)
v_mfma_f32_16x16x32_bf16 a[176:179], v[64:67], v[32:35], a[176:179]
v_accvgpr_read_b32 v221, a135
v_accvgpr_read_b32 v222, a151
v_mfma_f32_16x16x32_bf16 a[176:179], v[68:71], v[80:83], a[176:179]
v_accvgpr_read_b32 v223, a167
v_cvt_pk_bf16_f32 v228, v216, v217
v_mfma_f32_16x16x32_bf16 a[180:183], v[64:67], v[36:39], a[180:183]
ds_read_b128 v[56:59], v7 offset:51200
v_cvt_pk_bf16_f32 v229, v218, v219
v_mfma_f32_16x16x32_bf16 a[180:183], v[68:71], v[84:87], a[180:183]
v_cvt_pk_bf16_f32 v230, v220, v221
v_cvt_pk_bf16_f32 v231, v222, v223
v_mfma_f32_16x16x32_bf16 a[184:187], v[64:67], v[40:43], a[184:187]
buffer_store_dwordx4 v[228:231], v252, s[8:11], s37 offen offset:256 sc1
v_mfma_f32_16x16x32_bf16 a[184:187], v[68:71], v[88:91], a[184:187]
ds_read_b128 v[60:63], v7 offset:52224
v_accvgpr_read_b32 v208, a120
v_mfma_f32_16x16x32_bf16 a[188:191], v[64:67], v[44:47], a[188:191]
v_accvgpr_read_b32 v209, a136
v_accvgpr_read_b32 v210, a152
v_mfma_f32_16x16x32_bf16 a[188:191], v[68:71], v[92:95], a[188:191]
v_accvgpr_read_b32 v211, a168
s_waitcnt lgkmcnt(4)
v_mfma_f32_16x16x32_bf16 a[192:195], v[72:75], v[32:35], a[192:195]
v_accvgpr_read_b32 v212, a121
v_accvgpr_read_b32 v213, a137
v_mfma_f32_16x16x32_bf16 a[192:195], v[76:79], v[80:83], a[192:195]
v_accvgpr_read_b32 v214, a153
v_accvgpr_read_b32 v215, a169
v_mfma_f32_16x16x32_bf16 a[196:199], v[72:75], v[36:39], a[196:199]
ds_read_b128 v[64:67], v7 offset:53248
v_cvt_pk_bf16_f32 v224, v208, v209
v_mfma_f32_16x16x32_bf16 a[196:199], v[76:79], v[84:87], a[196:199]
v_cvt_pk_bf16_f32 v225, v210, v211
v_cvt_pk_bf16_f32 v226, v212, v213
v_mfma_f32_16x16x32_bf16 a[200:203], v[72:75], v[40:43], a[200:203]
v_cvt_pk_bf16_f32 v227, v214, v215
v_accvgpr_read_b32 v216, a122
v_mfma_f32_16x16x32_bf16 a[200:203], v[76:79], v[88:91], a[200:203]
ds_read_b128 v[68:71], v7 offset:54272
v_accvgpr_read_b32 v217, a138
v_mfma_f32_16x16x32_bf16 a[204:207], v[72:75], v[44:47], a[204:207]
buffer_store_dwordx4 v[224:227], v252, s[8:11], s38 offen offset:0 sc1
v_mfma_f32_16x16x32_bf16 a[204:207], v[76:79], v[92:95], a[204:207]
v_accvgpr_read_b32 v218, a154
s_waitcnt lgkmcnt(4)
v_mfma_f32_16x16x32_bf16 a[208:211], v[48:51], v[32:35], a[208:211]
v_accvgpr_read_b32 v219, a170
v_accvgpr_read_b32 v220, a123
v_mfma_f32_16x16x32_bf16 a[208:211], v[52:55], v[80:83], a[208:211]
v_accvgpr_read_b32 v221, a139
v_accvgpr_read_b32 v222, a155
v_mfma_f32_16x16x32_bf16 a[212:215], v[48:51], v[36:39], a[212:215]
ds_read_b128 v[72:75], v7 offset:55296
v_accvgpr_read_b32 v223, a171
v_mfma_f32_16x16x32_bf16 a[212:215], v[52:55], v[84:87], a[212:215]
v_cvt_pk_bf16_f32 v228, v216, v217
v_cvt_pk_bf16_f32 v229, v218, v219
v_mfma_f32_16x16x32_bf16 a[216:219], v[48:51], v[40:43], a[216:219]
v_cvt_pk_bf16_f32 v230, v220, v221
v_cvt_pk_bf16_f32 v231, v222, v223
v_mfma_f32_16x16x32_bf16 a[216:219], v[52:55], v[88:91], a[216:219]
ds_read_b128 v[76:79], v7 offset:56320
v_accvgpr_read_b32 v208, a124
v_mfma_f32_16x16x32_bf16 a[220:223], v[48:51], v[44:47], a[220:223]
buffer_store_dwordx4 v[228:231], v252, s[8:11], s38 offen offset:256 sc1
v_mfma_f32_16x16x32_bf16 a[220:223], v[52:55], v[92:95], a[220:223]
v_accvgpr_read_b32 v209, a140
s_waitcnt lgkmcnt(4)
v_mfma_f32_16x16x32_bf16 a[224:227], v[56:59], v[32:35], a[224:227]
s_waitcnt vmcnt(8)
v_accvgpr_read_b32 v210, a156
v_mfma_f32_16x16x32_bf16 a[224:227], v[60:63], v[80:83], a[224:227]
s_barrier
v_mfma_f32_16x16x32_bf16 a[228:231], v[56:59], v[36:39], a[228:231]
ds_read_b128 v[48:51], v7 offset:57344
v_accvgpr_read_b32 v211, a172
v_mfma_f32_16x16x32_bf16 a[228:231], v[60:63], v[84:87], a[228:231]
v_accvgpr_read_b32 v212, a125
v_accvgpr_read_b32 v213, a141
v_mfma_f32_16x16x32_bf16 a[232:235], v[56:59], v[40:43], a[232:235]
v_accvgpr_read_b32 v214, a157
v_accvgpr_read_b32 v215, a173
v_mfma_f32_16x16x32_bf16 a[232:235], v[60:63], v[88:91], a[232:235]
ds_read_b128 v[52:55], v7 offset:58368
v_cvt_pk_bf16_f32 v224, v208, v209
v_mfma_f32_16x16x32_bf16 a[236:239], v[56:59], v[44:47], a[236:239]
v_cvt_pk_bf16_f32 v225, v210, v211
v_cvt_pk_bf16_f32 v226, v212, v213
v_mfma_f32_16x16x32_bf16 a[236:239], v[60:63], v[92:95], a[236:239]
v_cvt_pk_bf16_f32 v227, v214, v215
s_waitcnt lgkmcnt(4)
v_mfma_f32_16x16x32_bf16 a[176:179], v[64:67], v[96:99], a[176:179]
buffer_store_dwordx4 v[224:227], v252, s[8:11], s39 offen offset:0 sc1
v_mfma_f32_16x16x32_bf16 a[176:179], v[68:71], v[112:115], a[176:179]
v_accvgpr_read_b32 v216, a126
v_accvgpr_read_b32 v217, a142
v_mfma_f32_16x16x32_bf16 a[180:183], v[64:67], v[100:103], a[180:183]
ds_read_b128 v[56:59], v7 offset:59392
v_accvgpr_read_b32 v218, a158
v_mfma_f32_16x16x32_bf16 a[180:183], v[68:71], v[116:119], a[180:183]
v_accvgpr_read_b32 v219, a174
v_accvgpr_read_b32 v220, a127
v_mfma_f32_16x16x32_bf16 a[184:187], v[64:67], v[104:107], a[184:187]
v_accvgpr_read_b32 v221, a143
v_accvgpr_read_b32 v222, a159
v_mfma_f32_16x16x32_bf16 a[184:187], v[68:71], v[120:123], a[184:187]
ds_read_b128 v[60:63], v7 offset:60416
v_accvgpr_read_b32 v223, a175
v_mfma_f32_16x16x32_bf16 a[188:191], v[64:67], v[108:111], a[188:191]
v_cvt_pk_bf16_f32 v228, v216, v217
v_cvt_pk_bf16_f32 v229, v218, v219
v_mfma_f32_16x16x32_bf16 a[188:191], v[68:71], v[124:127], a[188:191]
v_cvt_pk_bf16_f32 v230, v220, v221
s_waitcnt lgkmcnt(4)
v_mfma_f32_16x16x32_bf16 a[176:179], v[72:75], v[128:131], a[176:179]
v_cvt_pk_bf16_f32 v231, v222, v223
v_mfma_f32_16x16x32_bf16 a[176:179], v[76:79], v[232:235], a[176:179]
buffer_store_dwordx4 v[228:231], v252, s[8:11], s39 offen offset:256 sc1
v_mfma_f32_16x16x32_bf16 a[180:183], v[72:75], v[132:135], a[180:183]
ds_read_b128 v[64:67], v7 offset:61440
v_mfma_f32_16x16x32_bf16 a[180:183], v[76:79], v[236:239], a[180:183]
v_mfma_f32_16x16x32_bf16 a[184:187], v[72:75], v[136:139], a[184:187]
v_mfma_f32_16x16x32_bf16 a[184:187], v[76:79], v[240:243], a[184:187]
ds_read_b128 v[68:71], v7 offset:62464
v_mfma_f32_16x16x32_bf16 a[188:191], v[72:75], v[140:143], a[188:191]
v_mfma_f32_16x16x32_bf16 a[188:191], v[76:79], v[244:247], a[188:191]
s_waitcnt lgkmcnt(4)
v_mfma_f32_16x16x32_bf16 a[192:195], v[48:51], v[96:99], a[192:195]
v_mfma_f32_16x16x32_bf16 a[192:195], v[52:55], v[112:115], a[192:195]
v_mfma_f32_16x16x32_bf16 a[196:199], v[48:51], v[100:103], a[196:199]
ds_read_b128 v[72:75], v7 offset:63488
v_mfma_f32_16x16x32_bf16 a[196:199], v[52:55], v[116:119], a[196:199]
v_mfma_f32_16x16x32_bf16 a[200:203], v[48:51], v[104:107], a[200:203]
v_mfma_f32_16x16x32_bf16 a[200:203], v[52:55], v[120:123], a[200:203]
ds_read_b128 v[76:79], v7 offset:64512
v_mfma_f32_16x16x32_bf16 a[204:207], v[48:51], v[108:111], a[204:207]
v_mfma_f32_16x16x32_bf16 a[204:207], v[52:55], v[124:127], a[204:207]
s_waitcnt lgkmcnt(4)
v_mfma_f32_16x16x32_bf16 a[192:195], v[56:59], v[128:131], a[192:195]
v_mfma_f32_16x16x32_bf16 a[192:195], v[60:63], v[232:235], a[192:195]
v_mfma_f32_16x16x32_bf16 a[196:199], v[56:59], v[132:135], a[196:199]
ds_read_b128 v[48:51], v8 offset:0
v_mfma_f32_16x16x32_bf16 a[196:199], v[60:63], v[236:239], a[196:199]
v_mfma_f32_16x16x32_bf16 a[200:203], v[56:59], v[136:139], a[200:203]
v_mfma_f32_16x16x32_bf16 a[200:203], v[60:63], v[240:243], a[200:203]
ds_read_b128 v[52:55], v8 offset:1024
v_mfma_f32_16x16x32_bf16 a[204:207], v[56:59], v[140:143], a[204:207]
v_mfma_f32_16x16x32_bf16 a[204:207], v[60:63], v[244:247], a[204:207]
s_waitcnt lgkmcnt(4)
v_mfma_f32_16x16x32_bf16 a[208:211], v[64:67], v[96:99], a[208:211]
v_mfma_f32_16x16x32_bf16 a[208:211], v[68:71], v[112:115], a[208:211]
v_mfma_f32_16x16x32_bf16 a[212:215], v[64:67], v[100:103], a[212:215]
ds_read_b128 v[56:59], v8 offset:2048
v_mfma_f32_16x16x32_bf16 a[212:215], v[68:71], v[116:119], a[212:215]
v_mfma_f32_16x16x32_bf16 a[216:219], v[64:67], v[104:107], a[216:219]
v_mfma_f32_16x16x32_bf16 a[216:219], v[68:71], v[120:123], a[216:219]
ds_read_b128 v[60:63], v8 offset:3072
v_mfma_f32_16x16x32_bf16 a[220:223], v[64:67], v[108:111], a[220:223]
v_mfma_f32_16x16x32_bf16 a[220:223], v[68:71], v[124:127], a[220:223]
s_waitcnt lgkmcnt(4)
v_mfma_f32_16x16x32_bf16 a[208:211], v[72:75], v[128:131], a[208:211]
v_mfma_f32_16x16x32_bf16 a[208:211], v[76:79], v[232:235], a[208:211]
v_mfma_f32_16x16x32_bf16 a[212:215], v[72:75], v[132:135], a[212:215]
ds_read_b128 v[64:67], v8 offset:4096
v_mfma_f32_16x16x32_bf16 a[212:215], v[76:79], v[236:239], a[212:215]
v_mfma_f32_16x16x32_bf16 a[216:219], v[72:75], v[136:139], a[216:219]
v_mfma_f32_16x16x32_bf16 a[216:219], v[76:79], v[240:243], a[216:219]
ds_read_b128 v[68:71], v8 offset:5120
v_mfma_f32_16x16x32_bf16 a[220:223], v[72:75], v[140:143], a[220:223]
v_mfma_f32_16x16x32_bf16 a[220:223], v[76:79], v[244:247], a[220:223]
s_waitcnt lgkmcnt(4)
v_mfma_f32_16x16x32_bf16 a[224:227], v[48:51], v[96:99], a[224:227]
v_mfma_f32_16x16x32_bf16 a[224:227], v[52:55], v[112:115], a[224:227]
v_mfma_f32_16x16x32_bf16 a[228:231], v[48:51], v[100:103], a[228:231]
ds_read_b128 v[72:75], v8 offset:6144
v_mfma_f32_16x16x32_bf16 a[228:231], v[52:55], v[116:119], a[228:231]
v_mfma_f32_16x16x32_bf16 a[232:235], v[48:51], v[104:107], a[232:235]
v_mfma_f32_16x16x32_bf16 a[232:235], v[52:55], v[120:123], a[232:235]
ds_read_b128 v[76:79], v8 offset:7168
v_mfma_f32_16x16x32_bf16 a[236:239], v[48:51], v[108:111], a[236:239]
v_mfma_f32_16x16x32_bf16 a[236:239], v[52:55], v[124:127], a[236:239]
s_waitcnt lgkmcnt(4)
v_mfma_f32_16x16x32_bf16 a[224:227], v[56:59], v[128:131], a[224:227]
v_mfma_f32_16x16x32_bf16 a[224:227], v[60:63], v[232:235], a[224:227]
v_mfma_f32_16x16x32_bf16 a[228:231], v[56:59], v[132:135], a[228:231]
ds_read_b128 v[48:51], v8 offset:8192
v_mfma_f32_16x16x32_bf16 a[228:231], v[60:63], v[236:239], a[228:231]
v_mfma_f32_16x16x32_bf16 a[232:235], v[56:59], v[136:139], a[232:235]
v_mfma_f32_16x16x32_bf16 a[232:235], v[60:63], v[240:243], a[232:235]
ds_read_b128 v[52:55], v8 offset:9216
v_mfma_f32_16x16x32_bf16 a[236:239], v[56:59], v[140:143], a[236:239]
v_mfma_f32_16x16x32_bf16 a[236:239], v[60:63], v[244:247], a[236:239]
s_waitcnt lgkmcnt(4)
v_mfma_f32_16x16x32_bf16 a[240:243], v[64:67], v[144:147], 0
v_mfma_f32_16x16x32_bf16 a[240:243], v[68:71], v[160:163], a[240:243]
v_mfma_f32_16x16x32_bf16 a[244:247], v[64:67], v[148:151], 0
ds_read_b128 v[56:59], v8 offset:10240
v_mfma_f32_16x16x32_bf16 a[244:247], v[68:71], v[164:167], a[244:247]
v_accvgpr_read_b32 v208, a176
v_accvgpr_read_b32 v209, a192
v_mfma_f32_16x16x32_bf16 a[248:251], v[64:67], v[152:155], 0
v_accvgpr_read_b32 v210, a208
v_accvgpr_read_b32 v211, a224
v_mfma_f32_16x16x32_bf16 a[248:251], v[68:71], v[168:171], a[248:251]
ds_read_b128 v[60:63], v8 offset:11264
v_accvgpr_read_b32 v212, a177
v_mfma_f32_16x16x32_bf16 a[252:255], v[64:67], v[156:159], 0
v_accvgpr_read_b32 v213, a193
v_accvgpr_read_b32 v214, a209
v_mfma_f32_16x16x32_bf16 a[252:255], v[68:71], v[172:175], a[252:255]
v_accvgpr_read_b32 v215, a225
s_waitcnt lgkmcnt(4)
v_mfma_f32_16x16x32_bf16 a[240:243], v[72:75], v[176:179], a[240:243]
v_cvt_pk_bf16_f32 v224, v208, v209
v_cvt_pk_bf16_f32 v225, v210, v211
v_mfma_f32_16x16x32_bf16 a[240:243], v[76:79], a[0:3], a[240:243]
v_cvt_pk_bf16_f32 v226, v212, v213
v_cvt_pk_bf16_f32 v227, v214, v215
v_mfma_f32_16x16x32_bf16 a[244:247], v[72:75], v[180:183], a[244:247]
ds_read_b128 v[64:67], v8 offset:12288
v_accvgpr_read_b32 v216, a178
v_mfma_f32_16x16x32_bf16 a[244:247], v[76:79], a[4:7], a[244:247]
buffer_store_dwordx4 v[224:227], v252, s[8:11], s36 offen offset:2048 sc1
v_mfma_f32_16x16x32_bf16 a[248:251], v[72:75], v[184:187], a[248:251]
v_accvgpr_read_b32 v217, a194
v_accvgpr_read_b32 v218, a210
v_mfma_f32_16x16x32_bf16 a[248:251], v[76:79], a[8:11], a[248:251]
ds_read_b128 v[68:71], v8 offset:13312
v_accvgpr_read_b32 v219, a226
v_mfma_f32_16x16x32_bf16 a[252:255], v[72:75], v[188:191], a[252:255]
v_accvgpr_read_b32 v220, a179
v_accvgpr_read_b32 v221, a195
v_mfma_f32_16x16x32_bf16 a[252:255], v[76:79], a[12:15], a[252:255]
v_accvgpr_read_b32 v222, a211
s_waitcnt lgkmcnt(4)
v_mfma_f32_16x16x32_bf16 a[240:243], v[48:51], a[16:19], a[240:243]
v_accvgpr_read_b32 v223, a227
v_cvt_pk_bf16_f32 v228, v216, v217
v_mfma_f32_16x16x32_bf16 a[240:243], v[52:55], a[32:35], a[240:243]
v_cvt_pk_bf16_f32 v229, v218, v219
v_cvt_pk_bf16_f32 v230, v220, v221
v_mfma_f32_16x16x32_bf16 a[244:247], v[48:51], a[20:23], a[244:247]
ds_read_b128 v[72:75], v8 offset:14336
v_cvt_pk_bf16_f32 v231, v222, v223
v_mfma_f32_16x16x32_bf16 a[244:247], v[52:55], a[36:39], a[244:247]
buffer_store_dwordx4 v[228:231], v252, s[8:11], s36 offen offset:2304 sc1
v_mfma_f32_16x16x32_bf16 a[248:251], v[48:51], a[24:27], a[248:251]
L_hop10:
s_cmp_eq_u32 s15, 1
s_cbranch_scc1 L_hop_done
v_accvgpr_read_b32 v208, a180
v_accvgpr_read_b32 v209, a196
v_mfma_f32_16x16x32_bf16 a[248:251], v[52:55], a[40:43], a[248:251]
ds_read_b128 v[76:79], v8 offset:15360
v_accvgpr_read_b32 v210, a212
v_mfma_f32_16x16x32_bf16 a[252:255], v[48:51], a[28:31], a[252:255]
v_accvgpr_read_b32 v211, a228
v_accvgpr_read_b32 v212, a181
v_mfma_f32_16x16x32_bf16 a[252:255], v[52:55], a[44:47], a[252:255]
v_accvgpr_read_b32 v213, a197
s_waitcnt lgkmcnt(4)
v_mfma_f32_16x16x32_bf16 a[240:243], v[56:59], a[48:51], a[240:243]
s_waitcnt vmcnt(2)
v_mov_b32 v12, s68
v_mfma_f32_16x16x32_bf16 a[240:243], v[60:63], a[64:67], a[240:243]
s_barrier
v_mfma_f32_16x16x32_bf16 a[244:247], v[56:59], a[52:55], a[244:247]
ds_read_b128 v[48:51], v2 offset:0
v_mov_b32 v13, s69
v_mfma_f32_16x16x32_bf16 a[244:247], v[60:63], a[68:71], a[244:247]
v_accvgpr_read_b32 v214, a213
v_accvgpr_read_b32 v215, a229
v_mfma_f32_16x16x32_bf16 a[248:251], v[56:59], a[56:59], a[248:251]
v_cvt_pk_bf16_f32 v224, v208, v209
v_cvt_pk_bf16_f32 v225, v210, v211
v_mfma_f32_16x16x32_bf16 a[248:251], v[60:63], a[72:75], a[248:251]
ds_read_b128 v[52:55], v2 offset:1024
v_cvt_pk_bf16_f32 v226, v212, v213
v_mfma_f32_16x16x32_bf16 a[252:255], v[56:59], a[60:63], a[252:255]
buffer_store_dwordx2 v[12:13], v10, s[8:11], s44 offen sc1
v_mfma_f32_16x16x32_bf16 a[252:255], v[60:63], a[76:79], a[252:255]
v_cvt_pk_bf16_f32 v227, v214, v215
s_waitcnt lgkmcnt(4)
v_mfma_f32_16x16x32_bf16 a[240:243], v[64:67], a[80:83], a[240:243]
buffer_store_dwordx4 v[224:227], v252, s[8:11], s37 offen offset:2048 sc1
v_mfma_f32_16x16x32_bf16 a[240:243], v[68:71], a[96:99], a[240:243]
v_accvgpr_read_b32 v216, a182
v_accvgpr_read_b32 v217, a198
v_mfma_f32_16x16x32_bf16 a[244:247], v[64:67], a[84:87], a[244:247]
ds_read_b128 v[56:59], v2 offset:2048
v_accvgpr_read_b32 v218, a214
v_mfma_f32_16x16x32_bf16 a[244:247], v[68:71], a[100:103], a[244:247]
v_accvgpr_read_b32 v219, a230
v_accvgpr_read_b32 v220, a183
v_mfma_f32_16x16x32_bf16 a[248:251], v[64:67], a[88:91], a[248:251]
v_accvgpr_read_b32 v221, a199
v_accvgpr_read_b32 v222, a215
v_mfma_f32_16x16x32_bf16 a[248:251], v[68:71], a[104:107], a[248:251]
ds_read_b128 v[60:63], v2 offset:3072
v_accvgpr_read_b32 v223, a231
v_mfma_f32_16x16x32_bf16 a[252:255], v[64:67], a[92:95], a[252:255]
v_cvt_pk_bf16_f32 v228, v216, v217
v_cvt_pk_bf16_f32 v229, v218, v219
v_mfma_f32_16x16x32_bf16 a[252:255], v[68:71], a[108:111], a[252:255]
v_cvt_pk_bf16_f32 v230, v220, v221
s_waitcnt lgkmcnt(4)
v_mfma_f32_16x16x32_bf16 a[240:243], v[72:75], v[16:19], a[240:243]
v_cvt_pk_bf16_f32 v231, v222, v223
v_accvgpr_read_b32 v208, a184
v_mfma_f32_16x16x32_bf16 a[240:243], v[76:79], v[192:195], a[240:243]
buffer_store_dwordx4 v[228:231], v252, s[8:11], s37 offen offset:2304 sc1
v_mfma_f32_16x16x32_bf16 a[244:247], v[72:75], v[20:23], a[244:247]
ds_read_b128 v[64:67], v2 offset:4096
v_accvgpr_read_b32 v209, a200
v_mfma_f32_16x16x32_bf16 a[244:247], v[76:79], v[196:199], a[244:247]
v_accvgpr_read_b32 v210, a216
v_accvgpr_read_b32 v211, a232
v_mfma_f32_16x16x32_bf16 a[248:251], v[72:75], v[24:27], a[248:251]
v_accvgpr_read_b32 v212, a185
v_accvgpr_read_b32 v213, a201
v_mfma_f32_16x16x32_bf16 a[248:251], v[76:79], v[200:203], a[248:251]
ds_read_b128 v[68:71], v2 offset:5120
v_accvgpr_read_b32 v214, a217
v_mfma_f32_16x16x32_bf16 a[252:255], v[72:75], v[28:31], a[252:255]
v_accvgpr_read_b32 v215, a233
v_cvt_pk_bf16_f32 v224, v208, v209
v_mfma_f32_16x16x32_bf16 a[252:255], v[76:79], v[204:207], a[252:255]
v_cvt_pk_bf16_f32 v225, v210, v211
s_waitcnt lgkmcnt(4)
v_mfma_f32_16x16x32_bf16 a[240:243], v[48:51], v[32:35], a[240:243]
v_cvt_pk_bf16_f32 v226, v212, v213
v_cvt_pk_bf16_f32 v227, v214, v215
v_mfma_f32_16x16x32_bf16 a[240:243], v[52:55], v[80:83], a[240:243]
buffer_store_dwordx4 v[224:227], v252, s[8:11], s38 offen offset:2048 sc1
v_mfma_f32_16x16x32_bf16 a[244:247], v[48:51], v[36:39], a[244:247]
v_accvgpr_read_b32 v216, a186
v_accvgpr_read_b32 v217, a202
v_mfma_f32_16x16x32_bf16 a[244:247], v[52:55], v[84:87], a[244:247]
v_accvgpr_read_b32 v218, a218
v_accvgpr_read_b32 v219, a234
v_mfma_f32_16x16x32_bf16 a[248:251], v[48:51], v[40:43], a[248:251]
v_accvgpr_read_b32 v220, a187
v_accvgpr_read_b32 v221, a203
v_mfma_f32_16x16x32_bf16 a[248:251], v[52:55], v[88:91], a[248:251]
v_accvgpr_read_b32 v222, a219
v_accvgpr_read_b32 v223, a235
v_mfma_f32_16x16x32_bf16 a[252:255], v[48:51], v[44:47], a[252:255]
v_cvt_pk_bf16_f32 v228, v216, v217
v_cvt_pk_bf16_f32 v229, v218, v219
v_mfma_f32_16x16x32_bf16 a[252:255], v[52:55], v[92:95], a[252:255]
v_cvt_pk_bf16_f32 v230, v220, v221
s_waitcnt lgkmcnt(2)
v_mfma_f32_16x16x32_bf16 a[240:243], v[56:59], v[96:99], a[240:243]
v_cvt_pk_bf16_f32 v231, v222, v223
v_accvgpr_read_b32 v208, a188
v_mfma_f32_16x16x32_bf16 a[240:243], v[60:63], v[112:115], a[240:243]
buffer_store_dwordx4 v[228:231], v252, s[8:11], s38 offen offset:2304 sc1
v_mfma_f32_16x16x32_bf16 a[244:247], v[56:59], v[100:103], a[244:247]
v_accvgpr_read_b32 v209, a204
v_accvgpr_read_b32 v210, a220
v_mfma_f32_16x16x32_bf16 a[244:247], v[60:63], v[116:119], a[244:247]
v_accvgpr_read_b32 v211, a236
v_accvgpr_read_b32 v212, a189
v_mfma_f32_16x16x32_bf16 a[248:251], v[56:59], v[104:107], a[248:251]
v_accvgpr_read_b32 v213, a205
v_accvgpr_read_b32 v214, a221
v_mfma_f32_16x16x32_bf16 a[248:251], v[60:63], v[120:123], a[248:251]
v_accvgpr_read_b32 v215, a237
v_cvt_pk_bf16_f32 v224, v208, v209
v_mfma_f32_16x16x32_bf16 a[252:255], v[56:59], v[108:111], a[252:255]
v_cvt_pk_bf16_f32 v225, v210, v211
v_cvt_pk_bf16_f32 v226, v212, v213
v_mfma_f32_16x16x32_bf16 a[252:255], v[60:63], v[124:127], a[252:255]
v_cvt_pk_bf16_f32 v227, v214, v215
s_waitcnt lgkmcnt(0)
v_mfma_f32_16x16x32_bf16 a[240:243], v[64:67], v[128:131], a[240:243]
buffer_store_dwordx4 v[224:227], v252, s[8:11], s39 offen offset:2048 sc1
v_mfma_f32_16x16x32_bf16 a[240:243], v[68:71], v[232:235], a[240:243]
v_accvgpr_read_b32 v216, a190
v_accvgpr_read_b32 v217, a206
v_mfma_f32_16x16x32_bf16 a[244:247], v[64:67], v[132:135], a[244:247]
v_accvgpr_read_b32 v218, a222
v_accvgpr_read_b32 v219, a238
v_mfma_f32_16x16x32_bf16 a[244:247], v[68:71], v[236:239], a[244:247]
v_accvgpr_read_b32 v220, a191
v_accvgpr_read_b32 v221, a207
v_mfma_f32_16x16x32_bf16 a[248:251], v[64:67], v[136:139], a[248:251]
v_accvgpr_read_b32 v222, a223
v_accvgpr_read_b32 v223, a239
v_mfma_f32_16x16x32_bf16 a[248:251], v[68:71], v[240:243], a[248:251]
v_cvt_pk_bf16_f32 v228, v216, v217
v_cvt_pk_bf16_f32 v229, v218, v219
v_mfma_f32_16x16x32_bf16 a[252:255], v[64:67], v[140:143], a[252:255]
v_cvt_pk_bf16_f32 v230, v220, v221
v_cvt_pk_bf16_f32 v231, v222, v223
v_mfma_f32_16x16x32_bf16 a[252:255], v[68:71], v[244:247], a[252:255]
buffer_store_dwordx4 v[228:231], v252, s[8:11], s39 offen offset:2304 sc1
v_accvgpr_read_b32 v208, a240
v_accvgpr_read_b32 v209, a241
v_accvgpr_read_b32 v210, a242
v_accvgpr_read_b32 v211, a243
v_accvgpr_read_b32 v212, a244
v_accvgpr_read_b32 v213, a245
v_accvgpr_read_b32 v214, a246
v_accvgpr_read_b32 v215, a247
v_cvt_pk_bf16_f32 v224, v208, v209
v_cvt_pk_bf16_f32 v225, v210, v211
v_cvt_pk_bf16_f32 v226, v212, v213
v_cvt_pk_bf16_f32 v227, v214, v215
s_nop 0
v_permlane16_swap_b32 v224, v226
v_permlane16_swap_b32 v225, v227
buffer_store_dwordx4 v[224:227], v9, s[8:11], s32 offen sc1
v_accvgpr_read_b32 v216, a248
v_accvgpr_read_b32 v217, a249
v_accvgpr_read_b32 v218, a250
v_accvgpr_read_b32 v219, a251
v_accvgpr_read_b32 v220, a252
v_accvgpr_read_b32 v221, a253
v_accvgpr_read_b32 v222, a254
v_accvgpr_read_b32 v223, a255
v_cvt_pk_bf16_f32 v228, v216, v217
v_cvt_pk_bf16_f32 v229, v218, v219
v_cvt_pk_bf16_f32 v230, v220, v221
v_cvt_pk_bf16_f32 v231, v222, v223
s_nop 0
v_permlane16_swap_b32 v228, v230
v_permlane16_swap_b32 v229, v231
buffer_store_dwordx4 v[228:231], v9, s[8:11], s33 offen sc1
s_mov_b32 s14, s35
s_cmp_eq_u32 s7, 1
s_cbranch_scc1 L_last
s_cmp_eq_u32 s4, 3
s_cbranch_scc1 L_r_side
v_and_b32 v6, 7, v1
v_lshrrev_b32 v7, 3, v1
s_and_b32 s23, s6, 1
s_lshl_b32 s23, s23, 3
v_add_u32 v8, s23, v6
v_lshlrev_b32 v8, 4, v8
v_lshl_add_u32 v4, v7, 8, v8
s_lshl_b32 s24, s5, 4
s_lshr_b32 s25, s6, 1
s_add_u32 s24, s24, s25
s_mul_i32 s20, s24, 18432
s_lshl_b32 s22, s4, 2
s_lshr_b32 s23, 1056, s22
s_and_b32 s23, s23, 15
s_lshl_b32 s24, s23, 11
s_add_u32 s28, s20, s24
s_lshr_b32 s23, 790, s22
s_and_b32 s23, s23, 15
s_lshl_b32 s24, s23, 11
s_add_u32 s29, s20, s24
s_lshr_b32 s23, 2165, s22
s_and_b32 s23, s23, 15
s_lshl_b32 s24, s23, 11
s_add_u32 s30, s20, s24
s_lshl_b32 s26, s5, 12
s_add_u32 s27, s26, 917504
s_add_u32 s26, s26, 655360
v_and_b32 v6, 31, v1
v_lshlrev_b32 v6, 7, v6
buffer_load_dwordx2 v[10:11], v6, s[8:11], s27 offen sc1
v_mov_b32 v13, 2146435072
v_cmp_gt_u32 vcc, 16, v0
v_lshlrev_b32 v14, 3, v0
s_nop 0
v_cndmask_b32 v13, v13, v14, vcc
v_mov_b32 v14, s68
v_mov_b32 v15, s69
s_waitcnt vmcnt(0)
s_barrier
buffer_store_dwordx2 v[14:15], v13, s[8:11], s14 offen sc1
s_add_u32 s24, s28, 37126144
buffer_load_dwordx4 v[16:19], v4, s[8:11], s24 offen sc1
s_add_u32 s25, s29, 37126144
buffer_load_dwordx4 v[20:23], v4, s[8:11], s25 offen sc1
s_add_u32 s24, s30, 37126144
buffer_load_dwordx4 v[24:27], v4, s[8:11], s24 offen sc1
v_cmp_eq_u64 vcc, s[68:69], v[10:11]
s_nop 0
s_cmp_eq_u64 vcc, exec
s_cbranch_scc0 L_re_slow4
L_re_back4:
s_add_u32 s25, s28, 79855616
buffer_load_dwordx4 v[28:31], v4, s[8:11], s25 offen sc1
s_add_u32 s24, s28, 82214912
buffer_load_dwordx4 v[40:43], v4, s[8:11], s24 offen sc1
s_add_u32 s25, s28, 84574208
buffer_load_dwordx4 v[52:55], v4, s[8:11], s25 offen sc1
s_add_u32 s24, s28, 86933504
buffer_load_dwordx4 v[64:67], v4, s[8:11], s24 offen sc1
s_add_u32 s25, s28, 89292800
buffer_load_dwordx4 v[76:79], v4, s[8:11], s25 offen sc1
s_add_u32 s24, s28, 91652096
buffer_load_dwordx4 v[88:91], v4, s[8:11], s24 offen sc1
s_add_u32 s25, s28, 94011392
buffer_load_dwordx4 v[100:103], v4, s[8:11], s25 offen sc1
s_add_u32 s24, s28, 96370688
buffer_load_dwordx4 v[112:115], v4, s[8:11], s24 offen sc1
s_mov_b32 s52, 0
L_poll6:
buffer_load_dwordx2 v[14:15], v6, s[8:11], s26 offen sc1
s_add_u32 s52, s52, 1
s_waitcnt vmcnt(0)
v_cmp_ne_u64 vcc, s[68:69], v[14:15]
s_cmp_ge_u32 s52, 1048576
s_cbranch_scc1 L_got6
s_and_b64 exec, exec, vcc
s_cbranch_execnz L_poll6
L_got6:
s_mov_b64 exec, -1
s_add_u32 s24, s29, 79855616
buffer_load_dwordx4 v[32:35], v4, s[8:11], s24 offen sc1
s_add_u32 s25, s30, 79855616
buffer_load_dwordx4 v[36:39], v4, s[8:11], s25 offen sc1
s_add_u32 s25, s29, 82214912
buffer_load_dwordx4 v[44:47], v4, s[8:11], s25 offen sc1
s_add_u32 s24, s30, 82214912
buffer_load_dwordx4 v[48:51], v4, s[8:11], s24 offen sc1
s_add_u32 s24, s29, 84574208
buffer_load_dwordx4 v[56:59], v4, s[8:11], s24 offen sc1
s_add_u32 s25, s30, 84574208
buffer_load_dwordx4 v[60:63], v4, s[8:11], s25 offen sc1
s_add_u32 s25, s29, 86933504
buffer_load_dwordx4 v[68:71], v4, s[8:11], s25 offen sc1
s_add_u32 s24, s30, 86933504
buffer_load_dwordx4 v[72:75], v4, s[8:11], s24 offen sc1
s_add_u32 s24, s29, 89292800
buffer_load_dwordx4 v[80:83], v4, s[8:11], s24 offen sc1
s_add_u32 s25, s30, 89292800
buffer_load_dwordx4 v[84:87], v4, s[8:11], s25 offen sc1
s_add_u32 s25, s29, 91652096
buffer_load_dwordx4 v[92:95], v4, s[8:11], s25 offen sc1
s_add_u32 s24, s30, 91652096
buffer_load_dwordx4 v[96:99], v4, s[8:11], s24 offen sc1
s_add_u32 s24, s29, 94011392
buffer_load_dwordx4 v[104:107], v4, s[8:11], s24 offen sc1
s_add_u32 s25, s30, 94011392
buffer_load_dwordx4 v[108:111], v4, s[8:11], s25 offen sc1
s_add_u32 s25, s29, 96370688
buffer_load_dwordx4 v[116:119], v4, s[8:11], s25 offen sc1
s_add_u32 s24, s30, 96370688
buffer_load_dwordx4 v[120:123], v4, s[8:11], s24 offen sc1
s_waitcnt vmcnt(26)
v_lshlrev_b32 v128, 16, v16
v_and_b32 v129, 0xffff0000, v16
v_lshlrev_b32 v130, 16, v17
v_and_b32 v131, 0xffff0000, v17
v_lshlrev_b32 v132, 16, v18
v_and_b32 v133, 0xffff0000, v18
v_lshlrev_b32 v134, 16, v19
v_and_b32 v135, 0xffff0000, v19
s_waitcnt vmcnt(25)
v_lshlrev_b32 v136, 16, v20
v_and_b32 v137, 0xffff0000, v20
v_lshlrev_b32 v138, 16, v21
v_and_b32 v139, 0xffff0000, v21
v_lshlrev_b32 v140, 16, v22
v_and_b32 v141, 0xffff0000, v22
v_lshlrev_b32 v142, 16, v23
v_and_b32 v143, 0xffff0000, v23
s_waitcnt vmcnt(24)
v_lshlrev_b32 v144, 16, v24
v_and_b32 v145, 0xffff0000, v24
v_lshlrev_b32 v146, 16, v25
v_and_b32 v147, 0xffff0000, v25
v_lshlrev_b32 v148, 16, v26
v_and_b32 v149, 0xffff0000, v26
v_lshlrev_b32 v150, 16, v27
v_and_b32 v151, 0xffff0000, v27
s_waitcnt vmcnt(23)
v_lshlrev_b32 v6, 16, v28
v_and_b32 v7, 0xffff0000, v28
v_add_f32 v128, v128, v6
v_add_f32 v129, v129, v7
v_lshlrev_b32 v8, 16, v29
v_and_b32 v9, 0xffff0000, v29
v_add_f32 v130, v130, v8
v_add_f32 v131, v131, v9
v_lshlrev_b32 v6, 16, v30
v_and_b32 v7, 0xffff0000, v30
v_add_f32 v132, v132, v6
v_add_f32 v133, v133, v7
v_lshlrev_b32 v8, 16, v31
v_and_b32 v9, 0xffff0000, v31
v_add_f32 v134, v134, v8
v_add_f32 v135, v135, v9
s_waitcnt vmcnt(22)
v_lshlrev_b32 v6, 16, v40
v_and_b32 v7, 0xffff0000, v40
v_add_f32 v128, v128, v6
v_add_f32 v129, v129, v7
v_lshlrev_b32 v8, 16, v41
v_and_b32 v9, 0xffff0000, v41
v_add_f32 v130, v130, v8
v_add_f32 v131, v131, v9
v_lshlrev_b32 v6, 16, v42
v_and_b32 v7, 0xffff0000, v42
v_add_f32 v132, v132, v6
v_add_f32 v133, v133, v7
v_lshlrev_b32 v8, 16, v43
v_and_b32 v9, 0xffff0000, v43
v_add_f32 v134, v134, v8
v_add_f32 v135, v135, v9
s_waitcnt vmcnt(21)
v_lshlrev_b32 v6, 16, v52
v_and_b32 v7, 0xffff0000, v52
v_add_f32 v128, v128, v6
v_add_f32 v129, v129, v7
v_lshlrev_b32 v8, 16, v53
v_and_b32 v9, 0xffff0000, v53
v_add_f32 v130, v130, v8
v_add_f32 v131, v131, v9
v_lshlrev_b32 v6, 16, v54
v_and_b32 v7, 0xffff0000, v54
v_add_f32 v132, v132, v6
v_add_f32 v133, v133, v7
v_lshlrev_b32 v8, 16, v55
v_and_b32 v9, 0xffff0000, v55
v_add_f32 v134, v134, v8
v_add_f32 v135, v135, v9
s_waitcnt vmcnt(20)
v_lshlrev_b32 v6, 16, v64
v_and_b32 v7, 0xffff0000, v64
v_add_f32 v128, v128, v6
v_add_f32 v129, v129, v7
v_lshlrev_b32 v8, 16, v65
v_and_b32 v9, 0xffff0000, v65
v_add_f32 v130, v130, v8
v_add_f32 v131, v131, v9
v_lshlrev_b32 v6, 16, v66
v_and_b32 v7, 0xffff0000, v66
v_add_f32 v132, v132, v6
v_add_f32 v133, v133, v7
v_lshlrev_b32 v8, 16, v67
v_and_b32 v9, 0xffff0000, v67
v_add_f32 v134, v134, v8
v_add_f32 v135, v135, v9
s_waitcnt vmcnt(19)
v_lshlrev_b32 v6, 16, v76
v_and_b32 v7, 0xffff0000, v76
v_add_f32 v128, v128, v6
v_add_f32 v129, v129, v7
v_lshlrev_b32 v8, 16, v77
v_and_b32 v9, 0xffff0000, v77
v_add_f32 v130, v130, v8
v_add_f32 v131, v131, v9
v_lshlrev_b32 v6, 16, v78
v_and_b32 v7, 0xffff0000, v78
v_add_f32 v132, v132, v6
v_add_f32 v133, v133, v7
v_lshlrev_b32 v8, 16, v79
v_and_b32 v9, 0xffff0000, v79
v_add_f32 v134, v134, v8
v_add_f32 v135, v135, v9
s_waitcnt vmcnt(18)
v_lshlrev_b32 v6, 16, v88
v_and_b32 v7, 0xffff0000, v88
v_add_f32 v128, v128, v6
v_add_f32 v129, v129, v7
v_lshlrev_b32 v8, 16, v89
v_and_b32 v9, 0xffff0000, v89
v_add_f32 v130, v130, v8
v_add_f32 v131, v131, v9
v_lshlrev_b32 v6, 16, v90
v_and_b32 v7, 0xffff0000, v90
v_add_f32 v132, v132, v6
v_add_f32 v133, v133, v7
v_lshlrev_b32 v8, 16, v91
v_and_b32 v9, 0xffff0000, v91
v_add_f32 v134, v134, v8
v_add_f32 v135, v135, v9
s_waitcnt vmcnt(17)
v_lshlrev_b32 v6, 16, v100
v_and_b32 v7, 0xffff0000, v100
v_add_f32 v128, v128, v6
v_add_f32 v129, v129, v7
v_lshlrev_b32 v8, 16, v101
v_and_b32 v9, 0xffff0000, v101
v_add_f32 v130, v130, v8
v_add_f32 v131, v131, v9
v_lshlrev_b32 v6, 16, v102
v_and_b32 v7, 0xffff0000, v102
v_add_f32 v132, v132, v6
v_add_f32 v133, v133, v7
v_lshlrev_b32 v8, 16, v103
v_and_b32 v9, 0xffff0000, v103
v_add_f32 v134, v134, v8
v_add_f32 v135, v135, v9
s_waitcnt vmcnt(16)
v_lshlrev_b32 v6, 16, v112
v_and_b32 v7, 0xffff0000, v112
v_add_f32 v128, v128, v6
v_add_f32 v129, v129, v7
v_lshlrev_b32 v8, 16, v113
v_and_b32 v9, 0xffff0000, v113
v_add_f32 v130, v130, v8
v_add_f32 v131, v131, v9
v_lshlrev_b32 v6, 16, v114
v_and_b32 v7, 0xffff0000, v114
v_add_f32 v132, v132, v6
v_add_f32 v133, v133, v7
v_lshlrev_b32 v8, 16, v115
v_and_b32 v9, 0xffff0000, v115
v_add_f32 v134, v134, v8
v_add_f32 v135, v135, v9
s_waitcnt vmcnt(15)
v_lshlrev_b32 v6, 16, v32
v_and_b32 v7, 0xffff0000, v32
v_add_f32 v136, v136, v6
v_add_f32 v137, v137, v7
v_lshlrev_b32 v8, 16, v33
v_and_b32 v9, 0xffff0000, v33
v_add_f32 v138, v138, v8
v_add_f32 v139, v139, v9
v_lshlrev_b32 v6, 16, v34
v_and_b32 v7, 0xffff0000, v34
v_add_f32 v140, v140, v6
v_add_f32 v141, v141, v7
v_lshlrev_b32 v8, 16, v35
v_and_b32 v9, 0xffff0000, v35
v_add_f32 v142, v142, v8
v_add_f32 v143, v143, v9
s_waitcnt vmcnt(14)
v_lshlrev_b32 v6, 16, v36
v_and_b32 v7, 0xffff0000, v36
v_add_f32 v144, v144, v6
v_add_f32 v145, v145, v7
v_lshlrev_b32 v8, 16, v37
v_and_b32 v9, 0xffff0000, v37
v_add_f32 v146, v146, v8
v_add_f32 v147, v147, v9
v_lshlrev_b32 v6, 16, v38
v_and_b32 v7, 0xffff0000, v38
v_add_f32 v148, v148, v6
v_add_f32 v149, v149, v7
v_lshlrev_b32 v8, 16, v39
v_and_b32 v9, 0xffff0000, v39
v_add_f32 v150, v150, v8
v_add_f32 v151, v151, v9
s_waitcnt vmcnt(13)
v_lshlrev_b32 v6, 16, v44
v_and_b32 v7, 0xffff0000, v44
v_add_f32 v136, v136, v6
v_add_f32 v137, v137, v7
v_lshlrev_b32 v8, 16, v45
v_and_b32 v9, 0xffff0000, v45
v_add_f32 v138, v138, v8
v_add_f32 v139, v139, v9
v_lshlrev_b32 v6, 16, v46
v_and_b32 v7, 0xffff0000, v46
v_add_f32 v140, v140, v6
v_add_f32 v141, v141, v7
v_lshlrev_b32 v8, 16, v47
v_and_b32 v9, 0xffff0000, v47
v_add_f32 v142, v142, v8
v_add_f32 v143, v143, v9
s_waitcnt vmcnt(12)
v_lshlrev_b32 v6, 16, v48
v_and_b32 v7, 0xffff0000, v48
v_add_f32 v144, v144, v6
v_add_f32 v145, v145, v7
v_lshlrev_b32 v8, 16, v49
v_and_b32 v9, 0xffff0000, v49
v_add_f32 v146, v146, v8
v_add_f32 v147, v147, v9
v_lshlrev_b32 v6, 16, v50
v_and_b32 v7, 0xffff0000, v50
v_add_f32 v148, v148, v6
v_add_f32 v149, v149, v7
v_lshlrev_b32 v8, 16, v51
v_and_b32 v9, 0xffff0000, v51
v_add_f32 v150, v150, v8
v_add_f32 v151, v151, v9
s_waitcnt vmcnt(11)
v_lshlrev_b32 v6, 16, v56
v_and_b32 v7, 0xffff0000, v56
v_add_f32 v136, v136, v6
v_add_f32 v137, v137, v7
v_lshlrev_b32 v8, 16, v57
v_and_b32 v9, 0xffff0000, v57
v_add_f32 v138, v138, v8
v_add_f32 v139, v139, v9
v_lshlrev_b32 v6, 16, v58
v_and_b32 v7, 0xffff0000, v58
v_add_f32 v140, v140, v6
v_add_f32 v141, v141, v7
v_lshlrev_b32 v8, 16, v59
v_and_b32 v9, 0xffff0000, v59
v_add_f32 v142, v142, v8
v_add_f32 v143, v143, v9
s_waitcnt vmcnt(10)
v_lshlrev_b32 v6, 16, v60
v_and_b32 v7, 0xffff0000, v60
v_add_f32 v144, v144, v6
v_add_f32 v145, v145, v7
v_lshlrev_b32 v8, 16, v61
v_and_b32 v9, 0xffff0000, v61
v_add_f32 v146, v146, v8
v_add_f32 v147, v147, v9
v_lshlrev_b32 v6, 16, v62
v_and_b32 v7, 0xffff0000, v62
v_add_f32 v148, v148, v6
v_add_f32 v149, v149, v7
v_lshlrev_b32 v8, 16, v63
v_and_b32 v9, 0xffff0000, v63
v_add_f32 v150, v150, v8
v_add_f32 v151, v151, v9
s_waitcnt vmcnt(9)
v_lshlrev_b32 v6, 16, v68
v_and_b32 v7, 0xffff0000, v68
v_add_f32 v136, v136, v6
v_add_f32 v137, v137, v7
v_lshlrev_b32 v8, 16, v69
v_and_b32 v9, 0xffff0000, v69
v_add_f32 v138, v138, v8
v_add_f32 v139, v139, v9
v_lshlrev_b32 v6, 16, v70
v_and_b32 v7, 0xffff0000, v70
v_add_f32 v140, v140, v6
v_add_f32 v141, v141, v7
v_lshlrev_b32 v8, 16, v71
v_and_b32 v9, 0xffff0000, v71
v_add_f32 v142, v142, v8
v_add_f32 v143, v143, v9
s_waitcnt vmcnt(8)
v_lshlrev_b32 v6, 16, v72
v_and_b32 v7, 0xffff0000, v72
v_add_f32 v144, v144, v6
v_add_f32 v145, v145, v7
v_lshlrev_b32 v8, 16, v73
v_and_b32 v9, 0xffff0000, v73
v_add_f32 v146, v146, v8
v_add_f32 v147, v147, v9
v_lshlrev_b32 v6, 16, v74
v_and_b32 v7, 0xffff0000, v74
v_add_f32 v148, v148, v6
v_add_f32 v149, v149, v7
v_lshlrev_b32 v8, 16, v75
v_and_b32 v9, 0xffff0000, v75
v_add_f32 v150, v150, v8
v_add_f32 v151, v151, v9
s_waitcnt vmcnt(7)
v_lshlrev_b32 v6, 16, v80
v_and_b32 v7, 0xffff0000, v80
v_add_f32 v136, v136, v6
v_add_f32 v137, v137, v7
v_lshlrev_b32 v8, 16, v81
v_and_b32 v9, 0xffff0000, v81
v_add_f32 v138, v138, v8
v_add_f32 v139, v139, v9
v_lshlrev_b32 v6, 16, v82
v_and_b32 v7, 0xffff0000, v82
v_add_f32 v140, v140, v6
v_add_f32 v141, v141, v7
v_lshlrev_b32 v8, 16, v83
v_and_b32 v9, 0xffff0000, v83
v_add_f32 v142, v142, v8
v_add_f32 v143, v143, v9
s_waitcnt vmcnt(6)
v_lshlrev_b32 v6, 16, v84
v_and_b32 v7, 0xffff0000, v84
v_add_f32 v144, v144, v6
v_add_f32 v145, v145, v7
v_lshlrev_b32 v8, 16, v85
v_and_b32 v9, 0xffff0000, v85
v_add_f32 v146, v146, v8
v_add_f32 v147, v147, v9
v_lshlrev_b32 v6, 16, v86
v_and_b32 v7, 0xffff0000, v86
v_add_f32 v148, v148, v6
v_add_f32 v149, v149, v7
v_lshlrev_b32 v8, 16, v87
v_and_b32 v9, 0xffff0000, v87
v_add_f32 v150, v150, v8
v_add_f32 v151, v151, v9
s_waitcnt vmcnt(5)
v_lshlrev_b32 v6, 16, v92
v_and_b32 v7, 0xffff0000, v92
v_add_f32 v136, v136, v6
v_add_f32 v137, v137, v7
v_lshlrev_b32 v8, 16, v93
v_and_b32 v9, 0xffff0000, v93
v_add_f32 v138, v138, v8
v_add_f32 v139, v139, v9
v_lshlrev_b32 v6, 16, v94
v_and_b32 v7, 0xffff0000, v94
v_add_f32 v140, v140, v6
v_add_f32 v141, v141, v7
v_lshlrev_b32 v8, 16, v95
v_and_b32 v9, 0xffff0000, v95
v_add_f32 v142, v142, v8
v_add_f32 v143, v143, v9
s_waitcnt vmcnt(4)
v_lshlrev_b32 v6, 16, v96
v_and_b32 v7, 0xffff0000, v96
v_add_f32 v144, v144, v6
v_add_f32 v145, v145, v7
v_lshlrev_b32 v8, 16, v97
v_and_b32 v9, 0xffff0000, v97
v_add_f32 v146, v146, v8
v_add_f32 v147, v147, v9
v_lshlrev_b32 v6, 16, v98
v_and_b32 v7, 0xffff0000, v98
v_add_f32 v148, v148, v6
v_add_f32 v149, v149, v7
v_lshlrev_b32 v8, 16, v99
v_and_b32 v9, 0xffff0000, v99
v_add_f32 v150, v150, v8
v_add_f32 v151, v151, v9
s_waitcnt vmcnt(3)
v_lshlrev_b32 v6, 16, v104
v_and_b32 v7, 0xffff0000, v104
v_add_f32 v136, v136, v6
v_add_f32 v137, v137, v7
v_lshlrev_b32 v8, 16, v105
v_and_b32 v9, 0xffff0000, v105
v_add_f32 v138, v138, v8
v_add_f32 v139, v139, v9
v_lshlrev_b32 v6, 16, v106
v_and_b32 v7, 0xffff0000, v106
v_add_f32 v140, v140, v6
v_add_f32 v141, v141, v7
v_lshlrev_b32 v8, 16, v107
v_and_b32 v9, 0xffff0000, v107
v_add_f32 v142, v142, v8
v_add_f32 v143, v143, v9
s_waitcnt vmcnt(2)
v_lshlrev_b32 v6, 16, v108
v_and_b32 v7, 0xffff0000, v108
v_add_f32 v144, v144, v6
v_add_f32 v145, v145, v7
v_lshlrev_b32 v8, 16, v109
v_and_b32 v9, 0xffff0000, v109
v_add_f32 v146, v146, v8
v_add_f32 v147, v147, v9
v_lshlrev_b32 v6, 16, v110
v_and_b32 v7, 0xffff0000, v110
v_add_f32 v148, v148, v6
v_add_f32 v149, v149, v7
v_lshlrev_b32 v8, 16, v111
v_and_b32 v9, 0xffff0000, v111
v_add_f32 v150, v150, v8
L_hop11:
s_cmp_eq_u32 s15, 1
s_cbranch_scc1 L_hop_done
v_add_f32 v151, v151, v9
s_waitcnt vmcnt(1)
v_lshlrev_b32 v6, 16, v116
v_and_b32 v7, 0xffff0000, v116
v_add_f32 v136, v136, v6
v_add_f32 v137, v137, v7
v_lshlrev_b32 v8, 16, v117
v_and_b32 v9, 0xffff0000, v117
v_add_f32 v138, v138, v8
v_add_f32 v139, v139, v9
v_lshlrev_b32 v6, 16, v118
v_and_b32 v7, 0xffff0000, v118
v_add_f32 v140, v140, v6
v_add_f32 v141, v141, v7
v_lshlrev_b32 v8, 16, v119
v_and_b32 v9, 0xffff0000, v119
v_add_f32 v142, v142, v8
v_add_f32 v143, v143, v9
s_waitcnt vmcnt(0)
v_lshlrev_b32 v6, 16, v120
v_and_b32 v7, 0xffff0000, v120
v_add_f32 v144, v144, v6
v_add_f32 v145, v145, v7
v_lshlrev_b32 v8, 16, v121
v_and_b32 v9, 0xffff0000, v121
v_add_f32 v146, v146, v8
v_add_f32 v147, v147, v9
v_lshlrev_b32 v6, 16, v122
v_and_b32 v7, 0xffff0000, v122
v_add_f32 v148, v148, v6
v_add_f32 v149, v149, v7
v_lshlrev_b32 v8, 16, v123
v_and_b32 v9, 0xffff0000, v123
v_add_f32 v150, v150, v8
v_add_f32 v151, v151, v9
v_cvt_pk_bf16_f32 v152, v128, v129
v_cvt_pk_bf16_f32 v153, v130, v131
v_cvt_pk_bf16_f32 v154, v132, v133
v_cvt_pk_bf16_f32 v155, v134, v135
v_cvt_pk_bf16_f32 v156, v136, v137
v_cvt_pk_bf16_f32 v157, v138, v139
v_cvt_pk_bf16_f32 v158, v140, v141
v_cvt_pk_bf16_f32 v159, v142, v143
v_cvt_pk_bf16_f32 v160, v144, v145
v_cvt_pk_bf16_f32 v161, v146, v147
v_cvt_pk_bf16_f32 v162, v148, v149
v_cvt_pk_bf16_f32 v163, v150, v151
v_add_f32 v6, v128, v129
v_mul_f32 v7, v128, v128
v_mul_f32 v9, v129, v129
v_mov_b32 v8, 0
v_add_f32 v6, v6, v130
v_add_f32 v8, v8, v131
v_fmac_f32 v7, v130, v130
v_fmac_f32 v9, v131, v131
v_add_f32 v6, v6, v132
v_add_f32 v8, v8, v133
v_fmac_f32 v7, v132, v132
v_fmac_f32 v9, v133, v133
v_add_f32 v6, v6, v134
v_add_f32 v8, v8, v135
v_fmac_f32 v7, v134, v134
v_fmac_f32 v9, v135, v135
v_add_f32 v6, v6, v136
v_add_f32 v8, v8, v137
v_fmac_f32 v7, v136, v136
v_fmac_f32 v9, v137, v137
v_add_f32 v6, v6, v138
v_add_f32 v8, v8, v139
v_fmac_f32 v7, v138, v138
v_fmac_f32 v9, v139, v139
v_add_f32 v6, v6, v140
v_add_f32 v8, v8, v141
v_fmac_f32 v7, v140, v140
v_fmac_f32 v9, v141, v141
v_add_f32 v6, v6, v142
v_add_f32 v8, v8, v143
v_fmac_f32 v7, v142, v142
v_fmac_f32 v9, v143, v143
v_add_f32 v6, v6, v144
v_add_f32 v8, v8, v145
v_fmac_f32 v7, v144, v144
v_fmac_f32 v9, v145, v145
v_add_f32 v6, v6, v146
v_add_f32 v8, v8, v147
v_fmac_f32 v7, v146, v146
v_fmac_f32 v9, v147, v147
v_add_f32 v6, v6, v148
v_add_f32 v8, v8, v149
v_fmac_f32 v7, v148, v148
v_fmac_f32 v9, v149, v149
v_add_f32 v6, v6, v150
v_add_f32 v8, v8, v151
v_fmac_f32 v7, v150, v150
v_fmac_f32 v9, v151, v151
v_add_f32 v6, v6, v8
v_add_f32 v7, v7, v9
s_nop 0
v_add_f32_dpp v6, v6, v6 row_ror:8 row_mask:0xf bank_mask:0xf
v_add_f32_dpp v7, v7, v7 row_ror:8 row_mask:0xf bank_mask:0xf
v_mov_b32 v8, v6
v_mov_b32 v9, v7
s_nop 0
v_permlane16_swap_b32 v6, v8
v_permlane16_swap_b32 v7, v9
v_add_f32 v6, v6, v8
v_add_f32 v7, v7, v9
v_mov_b32 v8, v6
v_mov_b32 v9, v7
s_nop 0
v_permlane32_swap_b32 v6, v8
v_permlane32_swap_b32 v7, v9
v_add_f32 v6, v6, v8
v_add_f32 v7, v7, v9
v_and_b32 v10, 7, v1
v_lshlrev_b32 v10, 3, v10
v_add_u32 v10, 147456, v10
s_lshl_b32 s24, s4, 6
v_add_u32 v11, s24, v10
ds_write_b64 v11, v[6:7]
s_add_u32 s24, s28, 30048256
buffer_store_dwordx4 v[152:155], v4, s[8:11], s24 offen sc1
s_add_u32 s25, s29, 30048256
buffer_store_dwordx4 v[156:159], v4, s[8:11], s25 offen sc1
s_add_u32 s24, s30, 30048256
buffer_store_dwordx4 v[160:163], v4, s[8:11], s24 offen sc1
s_waitcnt lgkmcnt(0)
s_barrier
ds_read_b64 v[6:7], v10
ds_read_b64 v[8:9], v10 offset:64
ds_read_b64 v[12:13], v10 offset:128
s_waitcnt lgkmcnt(0)
v_add_f32 v6, v6, v8
v_add_f32 v7, v7, v9
v_add_f32 v6, v6, v12
v_add_f32 v7, v7, v13
v_mul_f32 v6, 0x3ae38e39, v6
v_mul_f32 v7, 0x3ae38e39, v7
v_fma_f32 v7, -v6, v6, v7
v_max_f32 v7, 0, v7
v_add_f32 v7, 0x3727c5ac, v7
v_rsq_f32 v7, v7
s_nop 0
v_mul_f32 v6, v6, v7
v_fma_f32 v128, v128, v7, -v6
v_fma_f32 v129, v129, v7, -v6
v_fma_f32 v130, v130, v7, -v6
v_fma_f32 v131, v131, v7, -v6
v_fma_f32 v132, v132, v7, -v6
v_fma_f32 v133, v133, v7, -v6
v_fma_f32 v134, v134, v7, -v6
v_fma_f32 v135, v135, v7, -v6
v_cvt_pk_bf16_f32 v168, v128, v129
v_cvt_pk_bf16_f32 v169, v130, v131
v_cvt_pk_bf16_f32 v170, v132, v133
v_cvt_pk_bf16_f32 v171, v134, v135
s_add_u32 s24, s28, 25329664
buffer_store_dwordx4 v[168:171], v4, s[8:11], s24 offen sc1
v_fma_f32 v136, v136, v7, -v6
v_fma_f32 v137, v137, v7, -v6
v_fma_f32 v138, v138, v7, -v6
v_fma_f32 v139, v139, v7, -v6
v_fma_f32 v140, v140, v7, -v6
v_fma_f32 v141, v141, v7, -v6
v_fma_f32 v142, v142, v7, -v6
v_fma_f32 v143, v143, v7, -v6
v_cvt_pk_bf16_f32 v172, v136, v137
v_cvt_pk_bf16_f32 v173, v138, v139
v_cvt_pk_bf16_f32 v174, v140, v141
v_cvt_pk_bf16_f32 v175, v142, v143
s_add_u32 s25, s29, 25329664
buffer_store_dwordx4 v[172:175], v4, s[8:11], s25 offen sc1
v_fma_f32 v144, v144, v7, -v6
v_fma_f32 v145, v145, v7, -v6
v_fma_f32 v146, v146, v7, -v6
v_fma_f32 v147, v147, v7, -v6
v_fma_f32 v148, v148, v7, -v6
v_fma_f32 v149, v149, v7, -v6
v_fma_f32 v150, v150, v7, -v6
v_fma_f32 v151, v151, v7, -v6
v_cvt_pk_bf16_f32 v176, v144, v145
v_cvt_pk_bf16_f32 v177, v146, v147
v_cvt_pk_bf16_f32 v178, v148, v149
v_cvt_pk_bf16_f32 v179, v150, v151
s_add_u32 s24, s30, 25329664
buffer_store_dwordx4 v[176:179], v4, s[8:11], s24 offen sc1
s_lshl_b32 s24, s5, 5
s_add_u32 s24, s24, s6
s_lshl_b32 s14, s24, 7
s_add_u32 s14, s14, 1835008
s_branch L_r_done
L_r_side:
v_mov_b32 v13, 2146435072
v_cmp_gt_u32 vcc, 16, v0
v_lshlrev_b32 v14, 3, v0
s_nop 0
v_cndmask_b32 v13, v13, v14, vcc
v_mov_b32 v14, s68
v_mov_b32 v15, s69
s_waitcnt vmcnt(0)
s_barrier
buffer_store_dwordx2 v[14:15], v13, s[8:11], s14 offen sc1
s_lshr_b32 s20, s5, 2
s_lshl_b32 s20, s20, 3
s_lshr_b32 s21, s6, 2
s_add_u32 s20, s20, s21
s_and_b32 s21, s5, 3
s_lshl_b32 s21, s21, 2
s_and_b32 s22, s6, 3
s_add_u32 s21, s21, s22
s_mul_i32 s32, s21, 129024
s_add_u32 s32, s32, 4198400
s_mul_i32 s33, s4, 0
s_add_u32 s32, s32, s33
s_add_u32 m0, s33, 0
s_add_u32 s40, s32, 0
buffer_load_dwordx4 v2, s[8:11], s40 offen offset:0 sc1 lds
buffer_load_dwordx4 v2, s[8:11], s40 offen offset:1024 sc1 lds
buffer_load_dwordx4 v2, s[8:11], s40 offen offset:2048 sc1 lds
buffer_load_dwordx4 v2, s[8:11], s40 offen offset:3072 sc1 lds
s_add_u32 m0, s33, 4096
s_add_u32 s40, s32, 4096
buffer_load_dwordx4 v2, s[8:11], s40 offen offset:0 sc1 lds
buffer_load_dwordx4 v2, s[8:11], s40 offen offset:1024 sc1 lds
buffer_load_dwordx4 v2, s[8:11], s40 offen offset:2048 sc1 lds
buffer_load_dwordx4 v2, s[8:11], s40 offen offset:3072 sc1 lds
s_add_u32 m0, s33, 8192
s_add_u32 s40, s32, 8192
buffer_load_dwordx4 v2, s[8:11], s40 offen offset:0 sc1 lds
buffer_load_dwordx4 v2, s[8:11], s40 offen offset:1024 sc1 lds
buffer_load_dwordx4 v2, s[8:11], s40 offen offset:2048 sc1 lds
buffer_load_dwordx4 v2, s[8:11], s40 offen offset:3072 sc1 lds
s_add_u32 m0, s33, 12288
s_add_u32 s40, s32, 12288
buffer_load_dwordx4 v2, s[8:11], s40 offen offset:0 sc1 lds
buffer_load_dwordx4 v2, s[8:11], s40 offen offset:1024 sc1 lds
buffer_load_dwordx4 v2, s[8:11], s40 offen offset:2048 sc1 lds
buffer_load_dwordx4 v2, s[8:11], s40 offen offset:3072 sc1 lds
s_add_u32 m0, s33, 16384
s_add_u32 s40, s32, 16384
buffer_load_dwordx4 v2, s[8:11], s40 offen offset:0 sc1 lds
buffer_load_dwordx4 v2, s[8:11], s40 offen offset:1024 sc1 lds
buffer_load_dwordx4 v2, s[8:11], s40 offen offset:2048 sc1 lds
buffer_load_dwordx4 v2, s[8:11], s40 offen offset:3072 sc1 lds
s_add_u32 m0, s33, 20480
s_add_u32 s40, s32, 20480
buffer_load_dwordx4 v2, s[8:11], s40 offen offset:0 sc1 lds
buffer_load_dwordx4 v2, s[8:11], s40 offen offset:1024 sc1 lds
buffer_load_dwordx4 v2, s[8:11], s40 offen offset:2048 sc1 lds
buffer_load_dwordx4 v2, s[8:11], s40 offen offset:3072 sc1 lds
s_add_u32 m0, s33, 24576
s_add_u32 s40, s32, 24576
buffer_load_dwordx4 v2, s[8:11], s40 offen offset:0 sc1 lds
buffer_load_dwordx4 v2, s[8:11], s40 offen offset:1024 sc1 lds
buffer_load_dwordx4 v2, s[8:11], s40 offen offset:2048 sc1 lds
buffer_load_dwordx4 v2, s[8:11], s40 offen offset:3072 sc1 lds
s_add_u32 m0, s33, 28672
s_add_u32 s40, s32, 28672
buffer_load_dwordx4 v2, s[8:11], s40 offen offset:0 sc1 lds
buffer_load_dwordx4 v2, s[8:11], s40 offen offset:1024 sc1 lds
buffer_load_dwordx4 v2, s[8:11], s40 offen offset:2048 sc1 lds
buffer_load_dwordx4 v2, s[8:11], s40 offen offset:3072 sc1 lds
s_add_u32 m0, s33, 32768
s_add_u32 s40, s32, 32768
buffer_load_dwordx4 v2, s[8:11], s40 offen offset:0 sc1 lds
buffer_load_dwordx4 v2, s[8:11], s40 offen offset:1024 sc1 lds
buffer_load_dwordx4 v2, s[8:11], s40 offen offset:2048 sc1 lds
buffer_load_dwordx4 v2, s[8:11], s40 offen offset:3072 sc1 lds
s_add_u32 m0, s33, 36864
s_add_u32 s40, s32, 36864
buffer_load_dwordx4 v2, s[8:11], s40 offen offset:0 sc1 lds
buffer_load_dwordx4 v2, s[8:11], s40 offen offset:1024 sc1 lds
buffer_load_dwordx4 v2, s[8:11], s40 offen offset:2048 sc1 lds
buffer_load_dwordx4 v2, s[8:11], s40 offen offset:3072 sc1 lds
s_add_u32 m0, s33, 40960
s_add_u32 s40, s32, 40960
buffer_load_dwordx4 v2, s[8:11], s40 offen offset:0 sc1 lds
buffer_load_dwordx4 v2, s[8:11], s40 offen offset:1024 sc1 lds
buffer_load_dwordx4 v2, s[8:11], s40 offen offset:2048 sc1 lds
buffer_load_dwordx4 v2, s[8:11], s40 offen offset:3072 sc1 lds
s_add_u32 m0, s33, 45056
s_add_u32 s40, s32, 45056
buffer_load_dwordx4 v2, s[8:11], s40 offen offset:0 sc1 lds
buffer_load_dwordx4 v2, s[8:11], s40 offen offset:1024 sc1 lds
buffer_load_dwordx4 v2, s[8:11], s40 offen offset:2048 sc1 lds
buffer_load_dwordx4 v2, s[8:11], s40 offen offset:3072 sc1 lds
s_add_u32 m0, s33, 49152
s_add_u32 s40, s32, 49152
buffer_load_dwordx4 v2, s[8:11], s40 offen offset:0 sc1 lds
buffer_load_dwordx4 v2, s[8:11], s40 offen offset:1024 sc1 lds
buffer_load_dwordx4 v2, s[8:11], s40 offen offset:2048 sc1 lds
buffer_load_dwordx4 v2, s[8:11], s40 offen offset:3072 sc1 lds
s_add_u32 m0, s33, 53248
s_add_u32 s40, s32, 53248
buffer_load_dwordx4 v2, s[8:11], s40 offen offset:0 sc1 lds
buffer_load_dwordx4 v2, s[8:11], s40 offen offset:1024 sc1 lds
buffer_load_dwordx4 v2, s[8:11], s40 offen offset:2048 sc1 lds
buffer_load_dwordx4 v2, s[8:11], s40 offen offset:3072 sc1 lds
s_add_u32 m0, s33, 57344
s_add_u32 s40, s32, 57344
buffer_load_dwordx4 v2, s[8:11], s40 offen offset:0 sc1 lds
buffer_load_dwordx4 v2, s[8:11], s40 offen offset:1024 sc1 lds
buffer_load_dwordx4 v2, s[8:11], s40 offen offset:2048 sc1 lds
buffer_load_dwordx4 v2, s[8:11], s40 offen offset:3072 sc1 lds
s_add_u32 m0, s33, 61440
s_add_u32 s40, s32, 61440
buffer_load_dwordx4 v2, s[8:11], s40 offen offset:0 sc1 lds
buffer_load_dwordx4 v2, s[8:11], s40 offen offset:1024 sc1 lds
buffer_load_dwordx4 v2, s[8:11], s40 offen offset:2048 sc1 lds
buffer_load_dwordx4 v2, s[8:11], s40 offen offset:3072 sc1 lds
s_add_u32 m0, s33, 65536
s_add_u32 s40, s32, 65536
buffer_load_dwordx4 v2, s[8:11], s40 offen offset:0 sc1 lds
buffer_load_dwordx4 v2, s[8:11], s40 offen offset:1024 sc1 lds
buffer_load_dwordx4 v2, s[8:11], s40 offen offset:2048 sc1 lds
buffer_load_dwordx4 v2, s[8:11], s40 offen offset:3072 sc1 lds
s_add_u32 m0, s33, 69632
s_add_u32 s40, s32, 69632
buffer_load_dwordx4 v2, s[8:11], s40 offen offset:0 sc1 lds
buffer_load_dwordx4 v2, s[8:11], s40 offen offset:1024 sc1 lds
buffer_load_dwordx4 v2, s[8:11], s40 offen offset:2048 sc1 lds
buffer_load_dwordx4 v2, s[8:11], s40 offen offset:3072 sc1 lds
s_add_u32 m0, s33, 73728
s_add_u32 s40, s32, 73728
buffer_load_dwordx4 v2, s[8:11], s40 offen offset:0 sc1 lds
buffer_load_dwordx4 v2, s[8:11], s40 offen offset:1024 sc1 lds
buffer_load_dwordx4 v2, s[8:11], s40 offen offset:2048 sc1 lds
buffer_load_dwordx4 v2, s[8:11], s40 offen offset:3072 sc1 lds
s_add_u32 m0, s33, 77824
s_add_u32 s40, s32, 77824
buffer_load_dwordx4 v2, s[8:11], s40 offen offset:0 sc1 lds
buffer_load_dwordx4 v2, s[8:11], s40 offen offset:1024 sc1 lds
buffer_load_dwordx4 v2, s[8:11], s40 offen offset:2048 sc1 lds
buffer_load_dwordx4 v2, s[8:11], s40 offen offset:3072 sc1 lds
s_add_u32 m0, s33, 81920
s_add_u32 s40, s32, 81920
buffer_load_dwordx4 v2, s[8:11], s40 offen offset:0 sc1 lds
buffer_load_dwordx4 v2, s[8:11], s40 offen offset:1024 sc1 lds
buffer_load_dwordx4 v2, s[8:11], s40 offen offset:2048 sc1 lds
buffer_load_dwordx4 v2, s[8:11], s40 offen offset:3072 sc1 lds
s_add_u32 m0, s33, 86016
s_add_u32 s40, s32, 86016
buffer_load_dwordx4 v2, s[8:11], s40 offen offset:0 sc1 lds
buffer_load_dwordx4 v2, s[8:11], s40 offen offset:1024 sc1 lds
buffer_load_dwordx4 v2, s[8:11], s40 offen offset:2048 sc1 lds
buffer_load_dwordx4 v2, s[8:11], s40 offen offset:3072 sc1 lds
s_add_u32 m0, s33, 90112
s_add_u32 s40, s32, 90112
buffer_load_dwordx4 v2, s[8:11], s40 offen offset:0 sc1 lds
buffer_load_dwordx4 v2, s[8:11], s40 offen offset:1024 sc1 lds
buffer_load_dwordx4 v2, s[8:11], s40 offen offset:2048 sc1 lds
buffer_load_dwordx4 v2, s[8:11], s40 offen offset:3072 sc1 lds
s_add_u32 m0, s33, 94208
s_add_u32 s40, s32, 94208
buffer_load_dwordx4 v2, s[8:11], s40 offen offset:0 sc1 lds
buffer_load_dwordx4 v2, s[8:11], s40 offen offset:1024 sc1 lds
buffer_load_dwordx4 v2, s[8:11], s40 offen offset:2048 sc1 lds
buffer_load_dwordx4 v2, s[8:11], s40 offen offset:3072 sc1 lds
s_add_u32 m0, s33, 98304
s_add_u32 s40, s32, 98304
buffer_load_dwordx4 v2, s[8:11], s40 offen offset:0 sc1 lds
buffer_load_dwordx4 v2, s[8:11], s40 offen offset:1024 sc1 lds
buffer_load_dwordx4 v2, s[8:11], s40 offen offset:2048 sc1 lds
buffer_load_dwordx4 v2, s[8:11], s40 offen offset:3072 sc1 lds
s_add_u32 m0, s33, 102400
s_add_u32 s40, s32, 102400
buffer_load_dwordx4 v2, s[8:11], s40 offen offset:0 sc1 lds
buffer_load_dwordx4 v2, s[8:11], s40 offen offset:1024 sc1 lds
buffer_load_dwordx4 v2, s[8:11], s40 offen offset:2048 sc1 lds
buffer_load_dwordx4 v2, s[8:11], s40 offen offset:3072 sc1 lds
s_add_u32 m0, s33, 106496
s_add_u32 s40, s32, 106496
buffer_load_dwordx4 v2, s[8:11], s40 offen offset:0 sc1 lds
buffer_load_dwordx4 v2, s[8:11], s40 offen offset:1024 sc1 lds
buffer_load_dwordx4 v2, s[8:11], s40 offen offset:2048 sc1 lds
buffer_load_dwordx4 v2, s[8:11], s40 offen offset:3072 sc1 lds
s_add_u32 m0, s33, 110592
s_add_u32 s40, s32, 110592
buffer_load_dwordx4 v2, s[8:11], s40 offen offset:0 sc1 lds
buffer_load_dwordx4 v2, s[8:11], s40 offen offset:1024 sc1 lds
buffer_load_dwordx4 v2, s[8:11], s40 offen offset:2048 sc1 lds
buffer_load_dwordx4 v2, s[8:11], s40 offen offset:3072 sc1 lds
s_add_u32 m0, s33, 114688
s_add_u32 s40, s32, 114688
buffer_load_dwordx4 v2, s[8:11], s40 offen offset:0 sc1 lds
buffer_load_dwordx4 v2, s[8:11], s40 offen offset:1024 sc1 lds
buffer_load_dwordx4 v2, s[8:11], s40 offen offset:2048 sc1 lds
buffer_load_dwordx4 v2, s[8:11], s40 offen offset:3072 sc1 lds
s_add_u32 m0, s33, 118784
s_add_u32 s40, s32, 118784
buffer_load_dwordx4 v2, s[8:11], s40 offen offset:0 sc1 lds
buffer_load_dwordx4 v2, s[8:11], s40 offen offset:1024 sc1 lds
buffer_load_dwordx4 v2, s[8:11], s40 offen offset:2048 sc1 lds
buffer_load_dwordx4 v2, s[8:11], s40 offen offset:3072 sc1 lds
s_add_u32 m0, s33, 122880
s_add_u32 s40, s32, 122880
buffer_load_dwordx4 v2, s[8:11], s40 offen offset:0 sc1 lds
buffer_load_dwordx4 v2, s[8:11], s40 offen offset:1024 sc1 lds
buffer_load_dwordx4 v2, s[8:11], s40 offen offset:2048 sc1 lds
buffer_load_dwordx4 v2, s[8:11], s40 offen offset:3072 sc1 lds
s_add_u32 m0, s33, 126976
s_add_u32 s40, s32, 126976
buffer_load_dwordx4 v2, s[8:11], s40 offen offset:0 sc1 lds
buffer_load_dwordx4 v2, s[8:11], s40 offen offset:1024 sc1 lds
s_barrier
L_r_done:
s_mov_b32 s70, 25329664
s_mov_b32 s71, 30048256
s_mov_b32 s72, 34766848
s_mov_b32 s73, 39485440
s_mov_b32 s74, 41975808
s_mov_b32 s75, 60981248
s_mov_b32 s76, 98729984
s_mov_b32 s77, 1048576
s_mov_b32 s7, 1
s_lshr_b32 s20, s5, 2
s_lshl_b32 s20, s20, 3
s_lshr_b32 s21, s6, 2
s_add_u32 s20, s20, s21
s_and_b32 s21, s5, 3
s_lshl_b32 s21, s21, 2
s_and_b32 s22, s6, 3
s_add_u32 s21, s21, s22
s_lshl_b32 s24, s20, 3
s_sub_u32 s25, s24, 1
s_max_i32 s35, s25, 0
s_mul_i32 s25, s35, 18432
s_lshl_b32 s26, s4, 1
s_add_u32 s36, s24, s26
s_mul_i32 s24, s36, 18432
s_add_u32 s26, s24, s70
s_add_u32 s27, s26, 18432
s_add_u32 s28, s25, s70
v_add_u32 v4, 0x10000, v2
v_add_u32 v5, 0x20000, v2
s_cmp_eq_u32 s4, 3
s_cselect_b32 s29, 0, s4
s_cselect_b32 s31, 16, 9
s_lshl_b32 s30, s29, 10
v_and_b32 v12, 15, v1
v_mov_b32 v13, 2146435072
v_cmp_le_u32 vcc, s31, v12
s_nop 1
v_cndmask_b32 v3, v13, v2, vcc
s_add_u32 s31, s30, 2048
v_add_u32 v6, s31, v2
v_add_u32 v7, s31, v4
v_add_u32 v8, s31, v5
s_and_b32 s30, s30, 1024
s_add_u32 s31, s30, 5120
v_add_u32 v9, s31, v2
v_add_u32 v10, s31, v4
v_add_u32 v11, s31, v5
s_lshl_b32 s22, s36, 1
s_lshl_b32 s23, s35, 1
s_add_u32 s23, s23, 1
v_and_b32 v16, 3, v1
v_add_u32 v16, s22, v16
v_mov_b32 v17, s23
v_cmp_eq_u32 vcc, 4, v1
s_nop 1
v_cndmask_b32 v16, v16, v17, vcc
v_lshlrev_b32 v16, 7, v16
s_add_u32 s22, s77, 786432
v_mov_b32 v13, 2146435072
v_cmp_gt_u32 vcc, 16, v0
v_lshlrev_b32 v14, 3, v0
s_nop 0
v_cndmask_b32 v13, v13, v14, vcc
v_mov_b32 v14, s68
v_mov_b32 v15, s69
s_waitcnt vmcnt(0)
s_barrier
buffer_store_dwordx2 v[14:15], v13, s[8:11], s14 offen sc1
s_mov_b32 s52, 0
L_poll7:
buffer_load_dwordx2 v[14:15], v16, s[8:11], s22 offen sc1
s_add_u32 s52, s52, 1
s_waitcnt vmcnt(0)
v_cmp_ne_u64 vcc, s[68:69], v[14:15]
s_cmp_ge_u32 s52, 1048576
s_cbranch_scc1 L_got7
s_and_b64 exec, exec, vcc
s_cbranch_execnz L_poll7
L_got7:
s_mov_b64 exec, -1
buffer_load_dwordx4 a[0:3], v2, s[8:11], s26 offen offset:0 sc1
buffer_load_dwordx4 a[72:75], v2, s[8:11], s27 offen offset:0 sc1
buffer_load_dwordx4 a[144:147], v3, s[8:11], s28 offen offset:0 sc1
buffer_load_dwordx4 a[4:7], v2, s[8:11], s26 offen offset:1024 sc1
buffer_load_dwordx4 a[76:79], v2, s[8:11], s27 offen offset:1024 sc1
buffer_load_dwordx4 a[148:151], v3, s[8:11], s28 offen offset:1024 sc1
buffer_load_dwordx4 a[8:11], v2, s[8:11], s26 offen offset:2048 sc1
buffer_load_dwordx4 a[80:83], v2, s[8:11], s27 offen offset:2048 sc1
buffer_load_dwordx4 a[152:155], v3, s[8:11], s28 offen offset:2048 sc1
buffer_load_dwordx4 a[12:15], v2, s[8:11], s26 offen offset:3072 sc1
buffer_load_dwordx4 a[84:87], v2, s[8:11], s27 offen offset:3072 sc1
buffer_load_dwordx4 a[156:159], v3, s[8:11], s28 offen offset:3072 sc1
s_add_u32 s26, s26, 4096
s_add_u32 s27, s27, 4096
s_add_u32 s28, s28, 4096
buffer_load_dwordx4 a[16:19], v2, s[8:11], s26 offen offset:0 sc1
buffer_load_dwordx4 a[88:91], v2, s[8:11], s27 offen offset:0 sc1
buffer_load_dwordx4 a[160:163], v3, s[8:11], s28 offen offset:0 sc1
buffer_load_dwordx4 a[20:23], v2, s[8:11], s26 offen offset:1024 sc1
buffer_load_dwordx4 a[92:95], v2, s[8:11], s27 offen offset:1024 sc1
buffer_load_dwordx4 a[164:167], v3, s[8:11], s28 offen offset:1024 sc1
buffer_load_dwordx4 a[24:27], v2, s[8:11], s26 offen offset:2048 sc1
buffer_load_dwordx4 a[96:99], v2, s[8:11], s27 offen offset:2048 sc1
buffer_load_dwordx4 a[168:171], v3, s[8:11], s28 offen offset:2048 sc1
buffer_load_dwordx4 a[28:31], v2, s[8:11], s26 offen offset:3072 sc1
buffer_load_dwordx4 a[100:103], v2, s[8:11], s27 offen offset:3072 sc1
buffer_load_dwordx4 a[172:175], v3, s[8:11], s28 offen offset:3072 sc1
v_lshrrev_b32 v13, 4, v1
v_lshlrev_b32 v14, 2, v13
v_sub_u32 v14, v12, v14
v_subrev_u32 v15, 0, v14
v_cmp_gt_u32 s[52:53], 8, v15
v_cmp_gt_i32 s[44:45], -8, v15
v_subrev_u32 v15, 1, v14
v_cmp_gt_u32 s[54:55], 8, v15
v_cmp_gt_i32 s[46:47], -8, v15
v_subrev_u32 v15, 2, v14
v_cmp_gt_u32 s[56:57], 8, v15
v_cmp_gt_i32 s[48:49], -8, v15
v_subrev_u32 v15, 3, v14
v_cmp_gt_u32 s[58:59], 8, v15
v_cmp_gt_i32 s[50:51], -8, v15
s_and_b32 s31, s20, 7
s_or_b32 s31, s31, s4
s_cmp_eq_u32 s31, 0
s_cselect_b64 s[60:61], 0, s[44:45]
s_cselect_b64 s[62:63], 0, s[46:47]
s_cselect_b64 s[64:65], 0, s[48:49]
s_cselect_b64 s[66:67], 0, s[50:51]
ds_read_b128 a[216:219], v2 offset:0
ds_read_b128 a[220:223], v2 offset:7168
ds_read_b128 a[224:227], v2 offset:1024
ds_read_b128 a[228:231], v2 offset:8192
ds_read_b128 a[232:235], v2 offset:2048
ds_read_b128 a[236:239], v2 offset:9216
s_waitcnt vmcnt(18)
s_waitcnt lgkmcnt(4)
v_mfma_f32_16x16x32_bf16 v[32:35], a[216:219], a[0:3], 0
s_add_u32 s26, s26, 4096
s_add_u32 s27, s27, 4096
s_add_u32 s28, s28, 4096
buffer_load_dwordx4 a[32:35], v2, s[8:11], s26 offen offset:0 sc1
v_mfma_f32_16x16x32_bf16 v[32:35], a[220:223], a[4:7], v[32:35]
ds_read_b128 a[240:243], v2 offset:3072
v_lshlrev_b32 v14, 3, v1
v_mfma_f32_16x16x32_bf16 v[36:39], a[216:219], a[72:75], 0
s_mul_i32 s31, s4, 3072
s_add_u32 s41, s31, 147456
v_mfma_f32_16x16x32_bf16 v[36:39], a[220:223], a[76:79], v[36:39]
ds_read_b128 a[244:247], v2 offset:10240
s_waitcnt lgkmcnt(4)
v_mfma_f32_16x16x32_bf16 v[40:43], a[224:227], a[0:3], 0
buffer_load_dwordx4 a[104:107], v2, s[8:11], s27 offen offset:0 sc1
v_mfma_f32_16x16x32_bf16 v[40:43], a[228:231], a[4:7], v[40:43]
ds_read_b128 a[216:219], v2 offset:4096
v_add_u32 v15, s41, v14
v_mfma_f32_16x16x32_bf16 v[44:47], a[224:227], a[72:75], 0
s_lshl_b32 s42, s29, 9
s_add_u32 s42, s42, 147456
v_mfma_f32_16x16x32_bf16 v[44:47], a[228:231], a[76:79], v[44:47]
ds_read_b128 a[220:223], v2 offset:11264
s_waitcnt lgkmcnt(4)
v_mfma_f32_16x16x32_bf16 v[48:51], a[232:235], a[0:3], 0
buffer_load_dwordx4 a[176:179], v3, s[8:11], s28 offen offset:0 sc1
v_mfma_f32_16x16x32_bf16 v[48:51], a[236:239], a[4:7], v[48:51]
ds_read_b128 a[224:227], v2 offset:5120
v_add_u32 v16, s42, v14
v_mfma_f32_16x16x32_bf16 v[52:55], a[232:235], a[72:75], 0
s_and_b32 s42, s42, 512
s_add_u32 s42, s42, 147456
v_mfma_f32_16x16x32_bf16 v[52:55], a[236:239], a[76:79], v[52:55]
ds_read_b128 a[228:231], v2 offset:12288
s_waitcnt lgkmcnt(4)
v_mfma_f32_16x16x32_bf16 v[56:59], a[240:243], a[0:3], 0
buffer_load_dwordx4 a[36:39], v2, s[8:11], s26 offen offset:1024 sc1
v_mfma_f32_16x16x32_bf16 v[56:59], a[244:247], a[4:7], v[56:59]
ds_read_b128 a[232:235], v2 offset:6144
v_add_u32 v19, s42, v14
v_mfma_f32_16x16x32_bf16 v[60:63], a[240:243], a[72:75], 0
v_add_u32 v18, 150016, v14
v_mov_b32 v96, 0
v_mfma_f32_16x16x32_bf16 v[60:63], a[244:247], a[76:79], v[60:63]
ds_read_b128 a[236:239], v2 offset:13312
s_waitcnt lgkmcnt(4)
v_mfma_f32_16x16x32_bf16 v[64:67], a[216:219], a[0:3], 0
buffer_load_dwordx4 a[108:111], v2, s[8:11], s27 offen offset:1024 sc1
v_mfma_f32_16x16x32_bf16 v[64:67], a[220:223], a[4:7], v[64:67]
ds_read_b128 a[240:243], v6 offset:0
v_mov_b32 v97, 0
v_mfma_f32_16x16x32_bf16 v[68:71], a[216:219], a[72:75], 0
v_mov_b32 v100, 0
v_mov_b32 v101, 0
v_mfma_f32_16x16x32_bf16 v[68:71], a[220:223], a[76:79], v[68:71]
ds_read_b128 a[244:247], v6 offset:7168
s_waitcnt lgkmcnt(4)
v_mfma_f32_16x16x32_bf16 v[72:75], a[0:3], a[224:227], 0
buffer_load_dwordx4 a[180:183], v3, s[8:11], s28 offen offset:1024 sc1
v_mfma_f32_16x16x32_bf16 v[72:75], a[4:7], a[228:231], v[72:75]
ds_read_b128 a[216:219], v9 offset:0
v_and_b32 v13, 1, v1
v_mfma_f32_16x16x32_bf16 v[76:79], a[72:75], a[224:227], 0
v_lshlrev_b32 v13, 4, v13
v_mov_b32 v102, 0x3f80
v_mfma_f32_16x16x32_bf16 v[76:79], a[76:79], a[228:231], v[76:79]
ds_read_b128 a[220:223], v9 offset:7168
s_waitcnt lgkmcnt(4)
v_mfma_f32_16x16x32_bf16 v[80:83], a[0:3], a[232:235], 0
buffer_load_dwordx4 a[40:43], v2, s[8:11], s26 offen offset:2048 sc1
v_mfma_f32_16x16x32_bf16 v[80:83], a[4:7], a[236:239], v[80:83]
ds_read_b128 a[224:227], v2 offset:14336
v_lshlrev_b32 v13, v13, v102
v_mfma_f32_16x16x32_bf16 v[84:87], a[72:75], a[232:235], 0
v_lshrrev_b32 v102, 1, v1
v_cmp_eq_u32 vcc, 16, v102
v_mfma_f32_16x16x32_bf16 v[84:87], a[76:79], a[236:239], v[84:87]
ds_read_b128 a[228:231], v2 offset:21504
s_waitcnt lgkmcnt(4)
v_mfma_f32_16x16x32_bf16 v[88:91], a[240:243], a[144:147], 0
ds_read_b128 a[232:235], v2 offset:15360
buffer_load_dwordx4 a[112:115], v2, s[8:11], s27 offen offset:2048 sc1
v_mfma_f32_16x16x32_bf16 v[88:91], a[244:247], a[148:151], v[88:91]
ds_read_b128 a[236:239], v2 offset:22528
L_hop12:
s_cmp_eq_u32 s15, 1
s_cbranch_scc1 L_hop_done
s_waitcnt lgkmcnt(4)
v_mfma_f32_16x16x32_bf16 v[92:95], a[144:147], a[216:219], 0
ds_read_b128 a[240:243], v2 offset:16384
v_cndmask_b32 v98, 0, v13, vcc
v_mfma_f32_16x16x32_bf16 v[92:95], a[148:151], a[220:223], v[92:95]
ds_read_b128 a[244:247], v2 offset:23552
s_waitcnt vmcnt(20)
s_waitcnt lgkmcnt(4)
v_mfma_f32_16x16x32_bf16 v[32:35], a[224:227], a[8:11], v[32:35]
buffer_load_dwordx4 a[184:187], v3, s[8:11], s28 offen offset:2048 sc1
v_mfma_f32_16x16x32_bf16 v[32:35], a[228:231], a[12:15], v[32:35]
ds_read_b128 a[216:219], v2 offset:17408
v_cmp_eq_u32 vcc, 17, v102
v_mfma_f32_16x16x32_bf16 v[36:39], a[224:227], a[80:83], v[36:39]
s_nop 0
v_cndmask_b32 v99, 0, v13, vcc
v_add_u32 v17, 16, v12
v_mfma_f32_16x16x32_bf16 v[36:39], a[228:231], a[84:87], v[36:39]
ds_read_b128 a[220:223], v2 offset:24576
s_waitcnt lgkmcnt(4)
v_mfma_f32_16x16x32_bf16 v[40:43], a[232:235], a[8:11], v[40:43]
buffer_load_dwordx4 a[44:47], v2, s[8:11], s26 offen offset:3072 sc1
v_mfma_f32_16x16x32_bf16 v[40:43], a[236:239], a[12:15], v[40:43]
ds_read_b128 a[224:227], v2 offset:18432
v_cmp_gt_u32 vcc, 16, v1
v_mfma_f32_16x16x32_bf16 v[44:47], a[232:235], a[80:83], v[44:47]
v_add_u32 v14, 48, v12
s_mov_b32 s34, 0x3eae1a93
v_mfma_f32_16x16x32_bf16 v[44:47], a[236:239], a[84:87], v[44:47]
ds_read_b128 a[228:231], v2 offset:25600
s_waitcnt lgkmcnt(4)
v_mfma_f32_16x16x32_bf16 v[48:51], a[240:243], a[8:11], v[48:51]
buffer_load_dwordx4 a[116:119], v2, s[8:11], s27 offen offset:3072 sc1
v_mfma_f32_16x16x32_bf16 v[48:51], a[244:247], a[12:15], v[48:51]
ds_read_b128 a[232:235], v2 offset:19456
v_cndmask_b32 v17, v14, v17, vcc
v_mfma_f32_16x16x32_bf16 v[52:55], a[240:243], a[80:83], v[52:55]
v_lshlrev_b32 v17, 3, v17
v_add_u32 v17, s41, v17
v_mfma_f32_16x16x32_bf16 v[52:55], a[244:247], a[84:87], v[52:55]
ds_read_b128 a[236:239], v2 offset:26624
s_waitcnt lgkmcnt(4)
v_mfma_f32_16x16x32_bf16 v[56:59], a[216:219], a[8:11], v[56:59]
buffer_load_dwordx4 a[188:191], v3, s[8:11], s28 offen offset:3072 sc1
v_mfma_f32_16x16x32_bf16 v[56:59], a[220:223], a[12:15], v[56:59]
ds_read_b128 a[240:243], v2 offset:20480
v_mov_b32 v103, 0xff61b1e6
v_mfma_f32_16x16x32_bf16 v[60:63], a[216:219], a[80:83], v[60:63]
v_mov_b32 v102, 0xffff
v_cndmask_b32 v172, v103, 0, s[44:45]
v_mfma_f32_16x16x32_bf16 v[60:63], a[220:223], a[84:87], v[60:63]
ds_read_b128 a[244:247], v2 offset:27648
s_waitcnt lgkmcnt(4)
v_mfma_f32_16x16x32_bf16 v[64:67], a[224:227], a[8:11], v[64:67]
s_add_u32 s26, s26, 4096
s_add_u32 s27, s27, 4096
s_add_u32 s28, s28, 4096
buffer_load_dwordx4 a[48:51], v2, s[8:11], s26 offen offset:0 sc1
v_mfma_f32_16x16x32_bf16 v[64:67], a[228:231], a[12:15], v[64:67]
ds_read_b128 a[216:219], v6 offset:14336
v_cndmask_b32 v173, v103, 0, s[46:47]
v_mfma_f32_16x16x32_bf16 v[68:71], a[224:227], a[80:83], v[68:71]
v_cndmask_b32 v174, v103, 0, s[48:49]
v_cndmask_b32 v175, v103, 0, s[50:51]
v_mfma_f32_16x16x32_bf16 v[68:71], a[228:231], a[84:87], v[68:71]
ds_read_b128 a[220:223], v6 offset:21504
s_waitcnt lgkmcnt(4)
v_mfma_f32_16x16x32_bf16 v[72:75], a[8:11], a[232:235], v[72:75]
buffer_load_dwordx4 a[120:123], v2, s[8:11], s27 offen offset:0 sc1
v_mfma_f32_16x16x32_bf16 v[72:75], a[12:15], a[236:239], v[72:75]
ds_read_b128 a[224:227], v9 offset:14336
v_cndmask_b32 v184, 0, v102, s[44:45]
v_mfma_f32_16x16x32_bf16 v[76:79], a[80:83], a[232:235], v[76:79]
v_cndmask_b32 v13, 0, v102, s[46:47]
v_lshl_or_b32 v184, v13, 16, v184
v_mfma_f32_16x16x32_bf16 v[76:79], a[84:87], a[236:239], v[76:79]
ds_read_b128 a[228:231], v9 offset:21504
s_waitcnt lgkmcnt(4)
v_mfma_f32_16x16x32_bf16 v[80:83], a[8:11], a[240:243], v[80:83]
buffer_load_dwordx4 a[192:195], v3, s[8:11], s28 offen offset:0 sc1
v_mfma_f32_16x16x32_bf16 v[80:83], a[12:15], a[244:247], v[80:83]
ds_read_b128 a[232:235], v2 offset:28672
v_cndmask_b32 v185, 0, v102, s[48:49]
v_mfma_f32_16x16x32_bf16 v[84:87], a[80:83], a[240:243], v[84:87]
v_cndmask_b32 v13, 0, v102, s[50:51]
v_lshl_or_b32 v185, v13, 16, v185
v_mfma_f32_16x16x32_bf16 v[84:87], a[84:87], a[244:247], v[84:87]
ds_read_b128 a[236:239], v2 offset:35840
s_waitcnt lgkmcnt(4)
v_mfma_f32_16x16x32_bf16 v[88:91], a[216:219], a[152:155], v[88:91]
ds_read_b128 a[240:243], v2 offset:29696
buffer_load_dwordx4 a[52:55], v2, s[8:11], s26 offen offset:1024 sc1
v_mfma_f32_16x16x32_bf16 v[88:91], a[220:223], a[156:159], v[88:91]
ds_read_b128 a[244:247], v2 offset:36864
s_waitcnt lgkmcnt(4)
v_mfma_f32_16x16x32_bf16 v[92:95], a[152:155], a[224:227], v[92:95]
ds_read_b128 a[216:219], v2 offset:30720
v_cndmask_b32 v176, v103, 0, s[52:53]
v_mfma_f32_16x16x32_bf16 v[92:95], a[156:159], a[228:231], v[92:95]
ds_read_b128 a[220:223], v2 offset:37888
s_waitcnt vmcnt(22)
s_waitcnt lgkmcnt(4)
v_mfma_f32_16x16x32_bf16 v[32:35], a[232:235], a[16:19], v[32:35]
buffer_load_dwordx4 a[124:127], v2, s[8:11], s27 offen offset:1024 sc1
v_mfma_f32_16x16x32_bf16 v[32:35], a[236:239], a[20:23], v[32:35]
ds_read_b128 a[224:227], v2 offset:31744
v_cndmask_b32 v177, v103, 0, s[54:55]
v_mfma_f32_16x16x32_bf16 v[36:39], a[232:235], a[88:91], v[36:39]
v_cndmask_b32 v178, v103, 0, s[56:57]
v_cndmask_b32 v179, v103, 0, s[58:59]
v_mfma_f32_16x16x32_bf16 v[36:39], a[236:239], a[92:95], v[36:39]
ds_read_b128 a[228:231], v2 offset:38912
s_waitcnt lgkmcnt(4)
v_mfma_f32_16x16x32_bf16 v[40:43], a[240:243], a[16:19], v[40:43]
buffer_load_dwordx4 a[196:199], v3, s[8:11], s28 offen offset:1024 sc1
v_mfma_f32_16x16x32_bf16 v[40:43], a[244:247], a[20:23], v[40:43]
ds_read_b128 a[232:235], v2 offset:32768
v_cndmask_b32 v186, 0, v102, s[52:53]
v_mfma_f32_16x16x32_bf16 v[44:47], a[240:243], a[88:91], v[44:47]
v_cndmask_b32 v13, 0, v102, s[54:55]
v_lshl_or_b32 v186, v13, 16, v186
v_mfma_f32_16x16x32_bf16 v[44:47], a[244:247], a[92:95], v[44:47]
ds_read_b128 a[236:239], v2 offset:39936
s_waitcnt lgkmcnt(4)
v_mfma_f32_16x16x32_bf16 v[48:51], a[216:219], a[16:19], v[48:51]
buffer_load_dwordx4 a[56:59], v2, s[8:11], s26 offen offset:2048 sc1
v_mfma_f32_16x16x32_bf16 v[48:51], a[220:223], a[20:23], v[48:51]
ds_read_b128 a[240:243], v2 offset:33792
v_cndmask_b32 v187, 0, v102, s[56:57]
v_mfma_f32_16x16x32_bf16 v[52:55], a[216:219], a[88:91], v[52:55]
v_cndmask_b32 v13, 0, v102, s[58:59]
v_lshl_or_b32 v187, v13, 16, v187
v_mfma_f32_16x16x32_bf16 v[52:55], a[220:223], a[92:95], v[52:55]
ds_read_b128 a[244:247], v2 offset:40960
s_waitcnt lgkmcnt(4)
v_mfma_f32_16x16x32_bf16 v[56:59], a[224:227], a[16:19], v[56:59]
buffer_load_dwordx4 a[128:131], v2, s[8:11], s27 offen offset:2048 sc1
v_mfma_f32_16x16x32_bf16 v[56:59], a[228:231], a[20:23], v[56:59]
ds_read_b128 a[216:219], v2 offset:34816
v_cndmask_b32 v180, v103, 0, s[60:61]
v_mfma_f32_16x16x32_bf16 v[60:63], a[224:227], a[88:91], v[60:63]
v_cndmask_b32 v181, v103, 0, s[62:63]
v_cndmask_b32 v182, v103, 0, s[64:65]
v_mfma_f32_16x16x32_bf16 v[60:63], a[228:231], a[92:95], v[60:63]
ds_read_b128 a[220:223], v2 offset:41984
s_waitcnt lgkmcnt(4)
v_mfma_f32_16x16x32_bf16 v[64:67], a[232:235], a[16:19], v[64:67]
buffer_load_dwordx4 a[200:203], v3, s[8:11], s28 offen offset:2048 sc1
v_mfma_f32_16x16x32_bf16 v[64:67], a[236:239], a[20:23], v[64:67]
ds_read_b128 a[224:227], v6 offset:28672
v_cndmask_b32 v183, v103, 0, s[66:67]
v_mfma_f32_16x16x32_bf16 v[68:71], a[232:235], a[88:91], v[68:71]
v_cndmask_b32 v188, 0, v102, s[60:61]
v_cndmask_b32 v13, 0, v102, s[62:63]
v_mfma_f32_16x16x32_bf16 v[68:71], a[236:239], a[92:95], v[68:71]
ds_read_b128 a[228:231], v6 offset:35840
s_waitcnt lgkmcnt(4)
v_mfma_f32_16x16x32_bf16 v[72:75], a[16:19], a[240:243], v[72:75]
buffer_load_dwordx4 a[60:63], v2, s[8:11], s26 offen offset:3072 sc1
v_mfma_f32_16x16x32_bf16 v[72:75], a[20:23], a[244:247], v[72:75]
ds_read_b128 a[232:235], v9 offset:28672
v_lshl_or_b32 v188, v13, 16, v188
v_mfma_f32_16x16x32_bf16 v[76:79], a[88:91], a[240:243], v[76:79]
v_cndmask_b32 v189, 0, v102, s[64:65]
v_cndmask_b32 v13, 0, v102, s[66:67]
v_mfma_f32_16x16x32_bf16 v[76:79], a[92:95], a[244:247], v[76:79]
ds_read_b128 a[236:239], v9 offset:35840
s_waitcnt lgkmcnt(4)
v_mfma_f32_16x16x32_bf16 v[80:83], a[16:19], a[216:219], v[80:83]
buffer_load_dwordx4 a[132:135], v2, s[8:11], s27 offen offset:3072 sc1
v_mfma_f32_16x16x32_bf16 v[80:83], a[20:23], a[220:223], v[80:83]
ds_read_b128 a[240:243], v2 offset:43008
v_lshl_or_b32 v189, v13, 16, v189
v_mfma_f32_16x16x32_bf16 v[84:87], a[88:91], a[216:219], v[84:87]
v_mfma_f32_16x16x32_bf16 v[84:87], a[92:95], a[220:223], v[84:87]
ds_read_b128 a[244:247], v2 offset:50176
s_waitcnt lgkmcnt(4)
v_mfma_f32_16x16x32_bf16 v[88:91], a[224:227], a[160:163], v[88:91]
ds_read_b128 a[216:219], v2 offset:44032
buffer_load_dwordx4 a[204:207], v3, s[8:11], s28 offen offset:3072 sc1
v_mfma_f32_16x16x32_bf16 v[88:91], a[228:231], a[164:167], v[88:91]
ds_read_b128 a[220:223], v2 offset:51200
s_waitcnt lgkmcnt(4)
v_mfma_f32_16x16x32_bf16 v[92:95], a[160:163], a[232:235], v[92:95]
ds_read_b128 a[224:227], v2 offset:45056
v_mfma_f32_16x16x32_bf16 v[92:95], a[164:167], a[236:239], v[92:95]
ds_read_b128 a[228:231], v2 offset:52224
s_waitcnt vmcnt(24)
s_waitcnt lgkmcnt(4)
v_mfma_f32_16x16x32_bf16 v[32:35], a[240:243], a[24:27], v[32:35]
s_add_u32 s26, s26, 4096
s_add_u32 s27, s27, 4096
s_add_u32 s28, s28, 4096
buffer_load_dwordx4 a[64:67], v2, s[8:11], s26 offen offset:0 sc1
v_mfma_f32_16x16x32_bf16 v[32:35], a[244:247], a[28:31], v[32:35]
ds_read_b128 a[232:235], v2 offset:46080
v_mfma_f32_16x16x32_bf16 v[36:39], a[240:243], a[96:99], v[36:39]
v_mfma_f32_16x16x32_bf16 v[36:39], a[244:247], a[100:103], v[36:39]
ds_read_b128 a[236:239], v2 offset:53248
s_waitcnt lgkmcnt(4)
v_mfma_f32_16x16x32_bf16 v[40:43], a[216:219], a[24:27], v[40:43]
buffer_load_dwordx4 a[136:139], v2, s[8:11], s27 offen offset:0 sc1
v_mfma_f32_16x16x32_bf16 v[40:43], a[220:223], a[28:31], v[40:43]
ds_read_b128 a[240:243], v2 offset:47104
v_mfma_f32_16x16x32_bf16 v[44:47], a[216:219], a[96:99], v[44:47]
v_mfma_f32_16x16x32_bf16 v[44:47], a[220:223], a[100:103], v[44:47]
ds_read_b128 a[244:247], v2 offset:54272
s_waitcnt lgkmcnt(4)
v_mfma_f32_16x16x32_bf16 v[48:51], a[224:227], a[24:27], v[48:51]
buffer_load_dwordx4 a[208:211], v3, s[8:11], s28 offen offset:0 sc1
v_mfma_f32_16x16x32_bf16 v[48:51], a[228:231], a[28:31], v[48:51]
ds_read_b128 a[216:219], v2 offset:48128
v_mfma_f32_16x16x32_bf16 v[52:55], a[224:227], a[96:99], v[52:55]
v_mfma_f32_16x16x32_bf16 v[52:55], a[228:231], a[100:103], v[52:55]
ds_read_b128 a[220:223], v2 offset:55296
s_waitcnt lgkmcnt(4)
v_mfma_f32_16x16x32_bf16 v[56:59], a[232:235], a[24:27], v[56:59]
buffer_load_dwordx4 a[68:71], v2, s[8:11], s26 offen offset:1024 sc1
v_mfma_f32_16x16x32_bf16 v[56:59], a[236:239], a[28:31], v[56:59]
ds_read_b128 a[224:227], v2 offset:49152
v_mfma_f32_16x16x32_bf16 v[60:63], a[232:235], a[96:99], v[60:63]
v_mfma_f32_16x16x32_bf16 v[60:63], a[236:239], a[100:103], v[60:63]
ds_read_b128 a[228:231], v2 offset:56320
s_waitcnt lgkmcnt(4)
v_mfma_f32_16x16x32_bf16 v[64:67], a[240:243], a[24:27], v[64:67]
buffer_load_dwordx4 a[140:143], v2, s[8:11], s27 offen offset:1024 sc1
v_mfma_f32_16x16x32_bf16 v[64:67], a[244:247], a[28:31], v[64:67]
ds_read_b128 a[232:235], v6 offset:43008
v_mfma_f32_16x16x32_bf16 v[68:71], a[240:243], a[96:99], v[68:71]
v_mfma_f32_16x16x32_bf16 v[68:71], a[244:247], a[100:103], v[68:71]
ds_read_b128 a[236:239], v6 offset:50176
s_waitcnt lgkmcnt(4)
v_mfma_f32_16x16x32_bf16 v[72:75], a[24:27], a[216:219], v[72:75]
buffer_load_dwordx4 a[212:215], v3, s[8:11], s28 offen offset:1024 sc1
v_mfma_f32_16x16x32_bf16 v[72:75], a[28:31], a[220:223], v[72:75]
ds_read_b128 a[240:243], v9 offset:43008
v_mfma_f32_16x16x32_bf16 v[76:79], a[96:99], a[216:219], v[76:79]
v_mfma_f32_16x16x32_bf16 v[76:79], a[100:103], a[220:223], v[76:79]
ds_read_b128 a[244:247], v9 offset:50176
s_waitcnt lgkmcnt(4)
v_mfma_f32_16x16x32_bf16 v[80:83], a[24:27], a[224:227], v[80:83]
v_mfma_f32_16x16x32_bf16 v[80:83], a[28:31], a[228:231], v[80:83]
ds_read_b128 a[216:219], v2 offset:57344
v_mfma_f32_16x16x32_bf16 v[84:87], a[96:99], a[224:227], v[84:87]
v_mfma_f32_16x16x32_bf16 v[84:87], a[100:103], a[228:231], v[84:87]
ds_read_b128 a[220:223], v2 offset:64512
s_waitcnt lgkmcnt(4)
v_mfma_f32_16x16x32_bf16 v[88:91], a[232:235], a[168:171], v[88:91]
ds_read_b128 a[224:227], v2 offset:58368
v_mfma_f32_16x16x32_bf16 v[88:91], a[236:239], a[172:175], v[88:91]
ds_read_b128 a[228:231], v4 offset:0
s_waitcnt lgkmcnt(4)
v_mfma_f32_16x16x32_bf16 v[92:95], a[168:171], a[240:243], v[92:95]
ds_read_b128 a[232:235], v2 offset:59392
v_mfma_f32_16x16x32_bf16 v[92:95], a[172:175], a[244:247], v[92:95]
ds_read_b128 a[236:239], v4 offset:1024
s_waitcnt vmcnt(24)
s_waitcnt lgkmcnt(4)
v_mfma_f32_16x16x32_bf16 v[32:35], a[216:219], a[32:35], v[32:35]
v_mfma_f32_16x16x32_bf16 v[32:35], a[220:223], a[36:39], v[32:35]
ds_read_b128 a[240:243], v2 offset:60416
v_mfma_f32_16x16x32_bf16 v[36:39], a[216:219], a[104:107], v[36:39]
v_mfma_f32_16x16x32_bf16 v[36:39], a[220:223], a[108:111], v[36:39]
ds_read_b128 a[244:247], v4 offset:2048
s_waitcnt lgkmcnt(4)
v_mfma_f32_16x16x32_bf16 v[40:43], a[224:227], a[32:35], v[40:43]
v_mfma_f32_16x16x32_bf16 v[40:43], a[228:231], a[36:39], v[40:43]
ds_read_b128 a[216:219], v2 offset:61440
v_mfma_f32_16x16x32_bf16 v[44:47], a[224:227], a[104:107], v[44:47]
v_mfma_f32_16x16x32_bf16 v[44:47], a[228:231], a[108:111], v[44:47]
ds_read_b128 a[220:223], v4 offset:3072
s_waitcnt lgkmcnt(4)
v_mfma_f32_16x16x32_bf16 v[48:51], a[232:235], a[32:35], v[48:51]
v_mfma_f32_16x16x32_bf16 v[48:51], a[236:239], a[36:39], v[48:51]
ds_read_b128 a[224:227], v2 offset:62464
v_mfma_f32_16x16x32_bf16 v[52:55], a[232:235], a[104:107], v[52:55]
v_mfma_f32_16x16x32_bf16 v[52:55], a[236:239], a[108:111], v[52:55]
ds_read_b128 a[228:231], v4 offset:4096
s_waitcnt lgkmcnt(4)
v_mfma_f32_16x16x32_bf16 v[56:59], a[240:243], a[32:35], v[56:59]
v_mfma_f32_16x16x32_bf16 v[56:59], a[244:247], a[36:39], v[56:59]
ds_read_b128 a[232:235], v2 offset:63488
v_mfma_f32_16x16x32_bf16 v[60:63], a[240:243], a[104:107], v[60:63]
v_mfma_f32_16x16x32_bf16 v[60:63], a[244:247], a[108:111], v[60:63]
ds_read_b128 a[236:239], v4 offset:5120
s_waitcnt lgkmcnt(4)
v_mfma_f32_16x16x32_bf16 v[64:67], a[216:219], a[32:35], v[64:67]
v_mfma_f32_16x16x32_bf16 v[64:67], a[220:223], a[36:39], v[64:67]
ds_read_b128 a[240:243], v6 offset:57344
v_mfma_f32_16x16x32_bf16 v[68:71], a[216:219], a[104:107], v[68:71]
v_mfma_f32_16x16x32_bf16 v[68:71], a[220:223], a[108:111], v[68:71]
ds_read_b128 a[244:247], v6 offset:64512
s_waitcnt lgkmcnt(4)
v_mfma_f32_16x16x32_bf16 v[72:75], a[32:35], a[224:227], v[72:75]
v_mfma_f32_16x16x32_bf16 v[72:75], a[36:39], a[228:231], v[72:75]
ds_read_b128 a[216:219], v9 offset:57344
v_mfma_f32_16x16x32_bf16 v[76:79], a[104:107], a[224:227], v[76:79]
v_mfma_f32_16x16x32_bf16 v[76:79], a[108:111], a[228:231], v[76:79]
ds_read_b128 a[220:223], v9 offset:64512
s_waitcnt lgkmcnt(4)
v_mfma_f32_16x16x32_bf16 v[80:83], a[32:35], a[232:235], v[80:83]
v_mfma_f32_16x16x32_bf16 v[80:83], a[36:39], a[236:239], v[80:83]
ds_read_b128 a[224:227], v4 offset:6144
v_mfma_f32_16x16x32_bf16 v[84:87], a[104:107], a[232:235], v[84:87]
v_mfma_f32_16x16x32_bf16 v[84:87], a[108:111], a[236:239], v[84:87]
ds_read_b128 a[228:231], v4 offset:13312
s_waitcnt lgkmcnt(4)
v_mfma_f32_16x16x32_bf16 v[88:91], a[240:243], a[176:179], v[88:91]
ds_read_b128 a[232:235], v4 offset:7168
v_mfma_f32_16x16x32_bf16 v[88:91], a[244:247], a[180:183], v[88:91]
ds_read_b128 a[236:239], v4 offset:14336
s_waitcnt lgkmcnt(4)
v_mfma_f32_16x16x32_bf16 v[92:95], a[176:179], a[216:219], v[92:95]
ds_read_b128 a[240:243], v4 offset:8192
v_mfma_f32_16x16x32_bf16 v[92:95], a[180:183], a[220:223], v[92:95]
ds_read_b128 a[244:247], v4 offset:15360
s_waitcnt vmcnt(18)
s_waitcnt lgkmcnt(4)
v_mfma_f32_16x16x32_bf16 v[32:35], a[224:227], a[40:43], v[32:35]
v_mfma_f32_16x16x32_bf16 v[32:35], a[228:231], a[44:47], v[32:35]
ds_read_b128 a[216:219], v4 offset:9216
v_mfma_f32_16x16x32_bf16 v[36:39], a[224:227], a[112:115], v[36:39]
v_mfma_f32_16x16x32_bf16 v[36:39], a[228:231], a[116:119], v[36:39]
ds_read_b128 a[220:223], v4 offset:16384
s_waitcnt lgkmcnt(4)
v_mfma_f32_16x16x32_bf16 v[40:43], a[232:235], a[40:43], v[40:43]
v_mfma_f32_16x16x32_bf16 v[40:43], a[236:239], a[44:47], v[40:43]
ds_read_b128 a[224:227], v4 offset:10240
v_mfma_f32_16x16x32_bf16 v[44:47], a[232:235], a[112:115], v[44:47]
v_mfma_f32_16x16x32_bf16 v[44:47], a[236:239], a[116:119], v[44:47]
ds_read_b128 a[228:231], v4 offset:17408
s_waitcnt lgkmcnt(4)
v_mfma_f32_16x16x32_bf16 v[48:51], a[240:243], a[40:43], v[48:51]
v_mfma_f32_16x16x32_bf16 v[48:51], a[244:247], a[44:47], v[48:51]
ds_read_b128 a[232:235], v4 offset:11264
v_mfma_f32_16x16x32_bf16 v[52:55], a[240:243], a[112:115], v[52:55]
v_mfma_f32_16x16x32_bf16 v[52:55], a[244:247], a[116:119], v[52:55]
ds_read_b128 a[236:239], v4 offset:18432
s_waitcnt lgkmcnt(4)
v_mfma_f32_16x16x32_bf16 v[56:59], a[216:219], a[40:43], v[56:59]
v_mfma_f32_16x16x32_bf16 v[56:59], a[220:223], a[44:47], v[56:59]
ds_read_b128 a[240:243], v4 offset:12288
v_mfma_f32_16x16x32_bf16 v[60:63], a[216:219], a[112:115], v[60:63]
v_mfma_f32_16x16x32_bf16 v[60:63], a[220:223], a[116:119], v[60:63]
ds_read_b128 a[244:247], v4 offset:19456
s_waitcnt lgkmcnt(4)
v_mfma_f32_16x16x32_bf16 v[64:67], a[224:227], a[40:43], v[64:67]
v_mfma_f32_16x16x32_bf16 v[64:67], a[228:231], a[44:47], v[64:67]
ds_read_b128 a[216:219], v7 offset:6144
v_mfma_f32_16x16x32_bf16 v[68:71], a[224:227], a[112:115], v[68:71]
v_mfma_f32_16x16x32_bf16 v[68:71], a[228:231], a[116:119], v[68:71]
ds_read_b128 a[220:223], v7 offset:13312
s_waitcnt lgkmcnt(4)
v_mfma_f32_16x16x32_bf16 v[72:75], a[40:43], a[232:235], v[72:75]
v_mfma_f32_16x16x32_bf16 v[72:75], a[44:47], a[236:239], v[72:75]
ds_read_b128 a[224:227], v10 offset:6144
v_mfma_f32_16x16x32_bf16 v[76:79], a[112:115], a[232:235], v[76:79]
v_mfma_f32_16x16x32_bf16 v[76:79], a[116:119], a[236:239], v[76:79]
ds_read_b128 a[228:231], v10 offset:13312
s_waitcnt lgkmcnt(4)
v_mfma_f32_16x16x32_bf16 v[80:83], a[40:43], a[240:243], v[80:83]
v_mfma_f32_16x16x32_bf16 v[80:83], a[44:47], a[244:247], v[80:83]
ds_read_b128 a[232:235], v4 offset:20480
v_mfma_f32_16x16x32_bf16 v[84:87], a[112:115], a[240:243], v[84:87]
v_mfma_f32_16x16x32_bf16 v[84:87], a[116:119], a[244:247], v[84:87]
ds_read_b128 a[236:239], v4 offset:27648
s_waitcnt lgkmcnt(4)
v_mfma_f32_16x16x32_bf16 v[88:91], a[216:219], a[184:187], v[88:91]
ds_read_b128 a[240:243], v4 offset:21504
v_mfma_f32_16x16x32_bf16 v[88:91], a[220:223], a[188:191], v[88:91]
ds_read_b128 a[244:247], v4 offset:28672
s_waitcnt lgkmcnt(4)
v_mfma_f32_16x16x32_bf16 v[92:95], a[184:187], a[224:227], v[92:95]
ds_read_b128 a[216:219], v4 offset:22528
v_mfma_f32_16x16x32_bf16 v[92:95], a[188:191], a[228:231], v[92:95]
ds_read_b128 a[220:223], v4 offset:29696
s_waitcnt vmcnt(12)
s_waitcnt lgkmcnt(4)
v_mfma_f32_16x16x32_bf16 v[32:35], a[232:235], a[48:51], v[32:35]
v_mfma_f32_16x16x32_bf16 v[32:35], a[236:239], a[52:55], v[32:35]
ds_read_b128 a[224:227], v4 offset:23552
v_mfma_f32_16x16x32_bf16 v[36:39], a[232:235], a[120:123], v[36:39]
v_mfma_f32_16x16x32_bf16 v[36:39], a[236:239], a[124:127], v[36:39]
ds_read_b128 a[228:231], v4 offset:30720
s_waitcnt lgkmcnt(4)
v_mfma_f32_16x16x32_bf16 v[40:43], a[240:243], a[48:51], v[40:43]
v_mfma_f32_16x16x32_bf16 v[40:43], a[244:247], a[52:55], v[40:43]
ds_read_b128 a[232:235], v4 offset:24576
v_mfma_f32_16x16x32_bf16 v[44:47], a[240:243], a[120:123], v[44:47]
v_mfma_f32_16x16x32_bf16 v[44:47], a[244:247], a[124:127], v[44:47]
ds_read_b128 a[236:239], v4 offset:31744
s_waitcnt lgkmcnt(4)
v_mfma_f32_16x16x32_bf16 v[48:51], a[216:219], a[48:51], v[48:51]
v_mfma_f32_16x16x32_bf16 v[48:51], a[220:223], a[52:55], v[48:51]
ds_read_b128 a[240:243], v4 offset:25600
v_mfma_f32_16x16x32_bf16 v[52:55], a[216:219], a[120:123], v[52:55]
v_mfma_f32_16x16x32_bf16 v[52:55], a[220:223], a[124:127], v[52:55]
ds_read_b128 a[244:247], v4 offset:32768
s_waitcnt lgkmcnt(4)
v_mfma_f32_16x16x32_bf16 v[56:59], a[224:227], a[48:51], v[56:59]
v_mfma_f32_16x16x32_bf16 v[56:59], a[228:231], a[52:55], v[56:59]
ds_read_b128 a[216:219], v4 offset:26624
v_mfma_f32_16x16x32_bf16 v[60:63], a[224:227], a[120:123], v[60:63]
v_mfma_f32_16x16x32_bf16 v[60:63], a[228:231], a[124:127], v[60:63]
ds_read_b128 a[220:223], v4 offset:33792
s_waitcnt lgkmcnt(4)
v_mfma_f32_16x16x32_bf16 v[64:67], a[232:235], a[48:51], v[64:67]
v_mfma_f32_16x16x32_bf16 v[64:67], a[236:239], a[52:55], v[64:67]
ds_read_b128 a[224:227], v7 offset:20480
v_mfma_f32_16x16x32_bf16 v[68:71], a[232:235], a[120:123], v[68:71]
v_mfma_f32_16x16x32_bf16 v[68:71], a[236:239], a[124:127], v[68:71]
ds_read_b128 a[228:231], v7 offset:27648
s_waitcnt lgkmcnt(4)
v_mfma_f32_16x16x32_bf16 v[72:75], a[48:51], a[240:243], v[72:75]
v_mfma_f32_16x16x32_bf16 v[72:75], a[52:55], a[244:247], v[72:75]
ds_read_b128 a[232:235], v10 offset:20480
v_mfma_f32_16x16x32_bf16 v[76:79], a[120:123], a[240:243], v[76:79]
v_mfma_f32_16x16x32_bf16 v[76:79], a[124:127], a[244:247], v[76:79]
ds_read_b128 a[236:239], v10 offset:27648
s_waitcnt lgkmcnt(4)
v_mfma_f32_16x16x32_bf16 v[80:83], a[48:51], a[216:219], v[80:83]
v_mfma_f32_16x16x32_bf16 v[80:83], a[52:55], a[220:223], v[80:83]
ds_read_b128 a[240:243], v4 offset:34816
v_mfma_f32_16x16x32_bf16 v[84:87], a[120:123], a[216:219], v[84:87]
v_mfma_f32_16x16x32_bf16 v[84:87], a[124:127], a[220:223], v[84:87]
ds_read_b128 a[244:247], v4 offset:41984
s_waitcnt lgkmcnt(4)
v_mfma_f32_16x16x32_bf16 v[88:91], a[224:227], a[192:195], v[88:91]
ds_read_b128 a[216:219], v4 offset:35840
v_mfma_f32_16x16x32_bf16 v[88:91], a[228:231], a[196:199], v[88:91]
ds_read_b128 a[220:223], v4 offset:43008
s_waitcnt lgkmcnt(4)
v_mfma_f32_16x16x32_bf16 v[92:95], a[192:195], a[232:235], v[92:95]
ds_read_b128 a[224:227], v4 offset:36864
v_mfma_f32_16x16x32_bf16 v[92:95], a[196:199], a[236:239], v[92:95]
ds_read_b128 a[228:231], v4 offset:44032
s_waitcnt vmcnt(6)
s_waitcnt lgkmcnt(4)
v_mfma_f32_16x16x32_bf16 v[32:35], a[240:243], a[56:59], v[32:35]
v_mfma_f32_16x16x32_bf16 v[32:35], a[244:247], a[60:63], v[32:35]
ds_read_b128 a[232:235], v4 offset:37888
v_mfma_f32_16x16x32_bf16 v[36:39], a[240:243], a[128:131], v[36:39]
v_mfma_f32_16x16x32_bf16 v[36:39], a[244:247], a[132:135], v[36:39]
ds_read_b128 a[236:239], v4 offset:45056
s_waitcnt lgkmcnt(4)
v_mfma_f32_16x16x32_bf16 v[40:43], a[216:219], a[56:59], v[40:43]
v_mfma_f32_16x16x32_bf16 v[40:43], a[220:223], a[60:63], v[40:43]
ds_read_b128 a[240:243], v4 offset:38912
v_mfma_f32_16x16x32_bf16 v[44:47], a[216:219], a[128:131], v[44:47]
v_mfma_f32_16x16x32_bf16 v[44:47], a[220:223], a[132:135], v[44:47]
ds_read_b128 a[244:247], v4 offset:46080
s_waitcnt lgkmcnt(4)
v_mfma_f32_16x16x32_bf16 v[48:51], a[224:227], a[56:59], v[48:51]
v_mfma_f32_16x16x32_bf16 v[48:51], a[228:231], a[60:63], v[48:51]
ds_read_b128 a[216:219], v4 offset:39936
v_mfma_f32_16x16x32_bf16 v[52:55], a[224:227], a[128:131], v[52:55]
v_mfma_f32_16x16x32_bf16 v[52:55], a[228:231], a[132:135], v[52:55]
ds_read_b128 a[220:223], v4 offset:47104
s_waitcnt lgkmcnt(4)
v_mfma_f32_16x16x32_bf16 v[56:59], a[232:235], a[56:59], v[56:59]
v_mfma_f32_16x16x32_bf16 v[56:59], a[236:239], a[60:63], v[56:59]
ds_read_b128 a[224:227], v4 offset:40960
v_mfma_f32_16x16x32_bf16 v[60:63], a[232:235], a[128:131], v[60:63]
v_mfma_f32_16x16x32_bf16 v[60:63], a[236:239], a[132:135], v[60:63]
ds_read_b128 a[228:231], v4 offset:48128
s_waitcnt lgkmcnt(4)
v_mfma_f32_16x16x32_bf16 v[64:67], a[240:243], a[56:59], v[64:67]
v_mfma_f32_16x16x32_bf16 v[64:67], a[244:247], a[60:63], v[64:67]
ds_read_b128 a[232:235], v7 offset:34816
v_mfma_f32_16x16x32_bf16 v[68:71], a[240:243], a[128:131], v[68:71]
v_mfma_f32_16x16x32_bf16 v[68:71], a[244:247], a[132:135], v[68:71]
ds_read_b128 a[236:239], v7 offset:41984
s_waitcnt lgkmcnt(4)
v_mfma_f32_16x16x32_bf16 v[72:75], a[56:59], a[216:219], v[72:75]
v_mfma_f32_16x16x32_bf16 v[72:75], a[60:63], a[220:223], v[72:75]
ds_read_b128 a[240:243], v10 offset:34816
v_mfma_f32_16x16x32_bf16 v[76:79], a[128:131], a[216:219], v[76:79]
v_mfma_f32_16x16x32_bf16 v[76:79], a[132:135], a[220:223], v[76:79]
ds_read_b128 a[244:247], v10 offset:41984
s_waitcnt lgkmcnt(4)
v_mfma_f32_16x16x32_bf16 v[80:83], a[56:59], a[224:227], v[80:83]
v_mfma_f32_16x16x32_bf16 v[80:83], a[60:63], a[228:231], v[80:83]
ds_read_b128 a[216:219], v4 offset:49152
v_mfma_f32_16x16x32_bf16 v[84:87], a[128:131], a[224:227], v[84:87]
v_mfma_f32_16x16x32_bf16 v[84:87], a[132:135], a[228:231], v[84:87]
ds_read_b128 a[220:223], v4 offset:56320
s_waitcnt lgkmcnt(4)
v_mfma_f32_16x16x32_bf16 v[88:91], a[232:235], a[200:203], v[88:91]
ds_read_b128 a[224:227], v4 offset:50176
v_mfma_f32_16x16x32_bf16 v[88:91], a[236:239], a[204:207], v[88:91]
ds_read_b128 a[228:231], v4 offset:57344
s_waitcnt lgkmcnt(4)
v_mfma_f32_16x16x32_bf16 v[92:95], a[200:203], a[240:243], v[92:95]
ds_read_b128 a[232:235], v4 offset:51200
v_mfma_f32_16x16x32_bf16 v[92:95], a[204:207], a[244:247], v[92:95]
ds_read_b128 a[236:239], v4 offset:58368
s_waitcnt vmcnt(0)
s_waitcnt lgkmcnt(4)
v_mfma_f32_16x16x32_bf16 v[32:35], a[216:219], a[64:67], v[32:35]
v_mfma_f32_16x16x32_bf16 v[32:35], a[220:223], a[68:71], v[32:35]
ds_read_b128 a[240:243], v4 offset:52224
v_mfma_f32_16x16x32_bf16 v[36:39], a[216:219], a[136:139], v[36:39]
v_mfma_f32_16x16x32_bf16 v[36:39], a[220:223], a[140:143], v[36:39]
ds_read_b128 a[244:247], v4 offset:59392
s_waitcnt lgkmcnt(4)
v_mfma_f32_16x16x32_bf16 v[40:43], a[224:227], a[64:67], v[40:43]
v_mfma_f32_16x16x32_bf16 v[40:43], a[228:231], a[68:71], v[40:43]
ds_read_b128 a[216:219], v4 offset:53248
v_mfma_f32_16x16x32_bf16 v[44:47], a[224:227], a[136:139], v[44:47]
v_mfma_f32_16x16x32_bf16 v[44:47], a[228:231], a[140:143], v[44:47]
ds_read_b128 a[220:223], v4 offset:60416
s_waitcnt lgkmcnt(4)
v_mfma_f32_16x16x32_bf16 v[48:51], a[232:235], a[64:67], v[48:51]
v_mfma_f32_16x16x32_bf16 v[48:51], a[236:239], a[68:71], v[48:51]
ds_read_b128 a[224:227], v4 offset:54272
v_mfma_f32_16x16x32_bf16 v[52:55], a[232:235], a[136:139], v[52:55]
v_mfma_f32_16x16x32_bf16 v[52:55], a[236:239], a[140:143], v[52:55]
ds_read_b128 a[228:231], v4 offset:61440
s_waitcnt lgkmcnt(4)
v_mfma_f32_16x16x32_bf16 v[56:59], a[240:243], a[64:67], v[56:59]
v_mfma_f32_16x16x32_bf16 v[56:59], a[244:247], a[68:71], v[56:59]
ds_read_b128 a[232:235], v4 offset:55296
v_mfma_f32_16x16x32_bf16 v[60:63], a[240:243], a[136:139], v[60:63]
v_mfma_f32_16x16x32_bf16 v[60:63], a[244:247], a[140:143], v[60:63]
ds_read_b128 a[236:239], v4 offset:62464
s_waitcnt lgkmcnt(4)
v_mfma_f32_16x16x32_bf16 v[64:67], a[216:219], a[64:67], v[64:67]
v_mfma_f32_16x16x32_bf16 v[64:67], a[220:223], a[68:71], v[64:67]
ds_read_b128 a[240:243], v7 offset:49152
v_mfma_f32_16x16x32_bf16 v[68:71], a[216:219], a[136:139], v[68:71]
v_mfma_f32_16x16x32_bf16 v[68:71], a[220:223], a[140:143], v[68:71]
ds_read_b128 a[244:247], v7 offset:56320
s_waitcnt lgkmcnt(4)
v_mfma_f32_16x16x32_bf16 v[72:75], a[64:67], a[224:227], v[72:75]
v_mfma_f32_16x16x32_bf16 v[72:75], a[68:71], a[228:231], v[72:75]
ds_read_b128 a[216:219], v10 offset:49152
v_mfma_f32_16x16x32_bf16 v[76:79], a[136:139], a[224:227], v[76:79]
v_mfma_f32_16x16x32_bf16 v[76:79], a[140:143], a[228:231], v[76:79]
ds_read_b128 a[220:223], v10 offset:56320
s_waitcnt lgkmcnt(4)
v_mfma_f32_16x16x32_bf16 v[80:83], a[64:67], a[232:235], v[80:83]
v_mfma_f32_16x16x32_bf16 v[80:83], a[68:71], a[236:239], v[80:83]
v_mfma_f32_16x16x32_bf16 v[84:87], a[136:139], a[232:235], v[84:87]
v_mfma_f32_16x16x32_bf16 v[84:87], a[140:143], a[236:239], v[84:87]
s_waitcnt lgkmcnt(2)
v_mfma_f32_16x16x32_bf16 v[88:91], a[240:243], a[208:211], v[88:91]
v_mfma_f32_16x16x32_bf16 v[88:91], a[244:247], a[212:215], v[88:91]
s_waitcnt lgkmcnt(0)
v_mfma_f32_16x16x32_bf16 v[92:95], a[208:211], a[216:219], v[92:95]
v_mfma_f32_16x16x32_bf16 v[92:95], a[212:215], a[220:223], v[92:95]
s_branch L_att
L_last:
s_cmp_eq_u32 s4, 3
s_cbranch_scc1 L_epoch
v_and_b32 v6, 7, v1
v_lshrrev_b32 v7, 3, v1
s_and_b32 s23, s6, 1
s_lshl_b32 s23, s23, 3
v_add_u32 v8, s23, v6
v_lshlrev_b32 v8, 4, v8
v_lshl_add_u32 v4, v7, 8, v8
s_lshl_b32 s24, s5, 4
L_hop13:
s_cmp_eq_u32 s15, 1
s_cbranch_scc1 L_hop_done
s_lshr_b32 s25, s6, 1
s_add_u32 s24, s24, s25
s_mul_i32 s20, s24, 18432
s_lshl_b32 s24, s5, 8
s_lshl_b32 s25, s6, 3
s_add_u32 s24, s24, s25
s_and_b32 s25, s24, 1023
s_lshl_b32 s25, s25, 1
s_lshr_b32 s24, s24, 10
s_add_u32 s24, s24, s25
s_mul_i32 s21, s24, 1152
v_mul_u32_u24 v8, 2304, v6
v_lshl_add_u32 v5, v7, 4, v8
s_load_dwordx2 s[12:13], s[0:1], 56
s_waitcnt lgkmcnt(0)
s_mov_b32 s16, s12
s_and_b32 s17, s13, 0xffff
s_mov_b32 s18, 2359296
s_mov_b32 s19, 0x20000
s_lshl_b32 s22, s4, 2
s_lshr_b32 s23, 1056, s22
s_and_b32 s23, s23, 15
s_lshl_b32 s24, s23, 11
s_add_u32 s28, s20, s24
s_lshl_b32 s24, s23, 7
s_add_u32 s31, s21, s24
s_lshr_b32 s23, 790, s22
s_and_b32 s23, s23, 15
s_lshl_b32 s24, s23, 11
s_add_u32 s29, s20, s24
s_lshl_b32 s24, s23, 7
s_add_u32 s32, s21, s24
s_lshr_b32 s23, 2165, s22
s_and_b32 s23, s23, 15
s_lshl_b32 s24, s23, 11
s_add_u32 s30, s20, s24
s_lshl_b32 s24, s23, 7
s_add_u32 s33, s21, s24
s_lshl_b32 s26, s5, 12
s_add_u32 s27, s26, 1966080
s_add_u32 s26, s26, 1703936
v_and_b32 v6, 31, v1
v_lshlrev_b32 v6, 7, v6
buffer_load_dwordx2 v[10:11], v6, s[8:11], s27 offen sc1
v_mov_b32 v13, 2146435072
v_cmp_gt_u32 vcc, 16, v0
v_lshlrev_b32 v14, 3, v0
s_nop 0
v_cndmask_b32 v13, v13, v14, vcc
v_mov_b32 v14, s68
v_mov_b32 v15, s69
s_waitcnt vmcnt(0)
s_barrier
buffer_store_dwordx2 v[14:15], v13, s[8:11], s14 offen sc1
s_add_u32 s24, s28, 39485440
buffer_load_dwordx4 v[16:19], v4, s[8:11], s24 offen sc1
s_add_u32 s25, s29, 39485440
buffer_load_dwordx4 v[20:23], v4, s[8:11], s25 offen sc1
s_add_u32 s24, s30, 39485440
buffer_load_dwordx4 v[24:27], v4, s[8:11], s24 offen sc1
v_cmp_eq_u64 vcc, s[68:69], v[10:11]
s_nop 0
s_cmp_eq_u64 vcc, exec
s_cbranch_scc0 L_re_slow8
L_re_back8:
s_add_u32 s25, s28, 98729984
buffer_load_dwordx4 v[28:31], v4, s[8:11], s25 offen sc1
s_add_u32 s24, s28, 101089280
buffer_load_dwordx4 v[40:43], v4, s[8:11], s24 offen sc1
s_add_u32 s25, s28, 103448576
buffer_load_dwordx4 v[52:55], v4, s[8:11], s25 offen sc1
s_add_u32 s24, s28, 105807872
buffer_load_dwordx4 v[64:67], v4, s[8:11], s24 offen sc1
s_add_u32 s25, s28, 108167168
buffer_load_dwordx4 v[76:79], v4, s[8:11], s25 offen sc1
s_add_u32 s24, s28, 110526464
buffer_load_dwordx4 v[88:91], v4, s[8:11], s24 offen sc1
s_add_u32 s25, s28, 112885760
buffer_load_dwordx4 v[100:103], v4, s[8:11], s25 offen sc1
s_add_u32 s24, s28, 115245056
buffer_load_dwordx4 v[112:115], v4, s[8:11], s24 offen sc1
s_mov_b32 s52, 0
L_poll10:
buffer_load_dwordx2 v[14:15], v6, s[8:11], s26 offen sc1
s_add_u32 s52, s52, 1
s_waitcnt vmcnt(0)
v_cmp_ne_u64 vcc, s[68:69], v[14:15]
s_cmp_ge_u32 s52, 1048576
s_cbranch_scc1 L_got10
s_and_b64 exec, exec, vcc
s_cbranch_execnz L_poll10
L_got10:
s_mov_b64 exec, -1
s_add_u32 s24, s29, 98729984
buffer_load_dwordx4 v[32:35], v4, s[8:11], s24 offen sc1
s_add_u32 s25, s30, 98729984
buffer_load_dwordx4 v[36:39], v4, s[8:11], s25 offen sc1
s_add_u32 s25, s29, 101089280
buffer_load_dwordx4 v[44:47], v4, s[8:11], s25 offen sc1
s_add_u32 s24, s30, 101089280
buffer_load_dwordx4 v[48:51], v4, s[8:11], s24 offen sc1
s_add_u32 s24, s29, 103448576
buffer_load_dwordx4 v[56:59], v4, s[8:11], s24 offen sc1
s_add_u32 s25, s30, 103448576
buffer_load_dwordx4 v[60:63], v4, s[8:11], s25 offen sc1
s_add_u32 s25, s29, 105807872
buffer_load_dwordx4 v[68:71], v4, s[8:11], s25 offen sc1
s_add_u32 s24, s30, 105807872
buffer_load_dwordx4 v[72:75], v4, s[8:11], s24 offen sc1
s_add_u32 s24, s29, 108167168
buffer_load_dwordx4 v[80:83], v4, s[8:11], s24 offen sc1
s_add_u32 s25, s30, 108167168
buffer_load_dwordx4 v[84:87], v4, s[8:11], s25 offen sc1
s_add_u32 s25, s29, 110526464
buffer_load_dwordx4 v[92:95], v4, s[8:11], s25 offen sc1
s_add_u32 s24, s30, 110526464
buffer_load_dwordx4 v[96:99], v4, s[8:11], s24 offen sc1
s_add_u32 s24, s29, 112885760
buffer_load_dwordx4 v[104:107], v4, s[8:11], s24 offen sc1
s_add_u32 s25, s30, 112885760
buffer_load_dwordx4 v[108:111], v4, s[8:11], s25 offen sc1
s_add_u32 s25, s29, 115245056
buffer_load_dwordx4 v[116:119], v4, s[8:11], s25 offen sc1
s_add_u32 s24, s30, 115245056
buffer_load_dwordx4 v[120:123], v4, s[8:11], s24 offen sc1
s_waitcnt vmcnt(26)
v_lshlrev_b32 v128, 16, v16
v_and_b32 v129, 0xffff0000, v16
v_lshlrev_b32 v130, 16, v17
v_and_b32 v131, 0xffff0000, v17
v_lshlrev_b32 v132, 16, v18
v_and_b32 v133, 0xffff0000, v18
v_lshlrev_b32 v134, 16, v19
v_and_b32 v135, 0xffff0000, v19
s_waitcnt vmcnt(25)
v_lshlrev_b32 v136, 16, v20
v_and_b32 v137, 0xffff0000, v20
v_lshlrev_b32 v138, 16, v21
v_and_b32 v139, 0xffff0000, v21
v_lshlrev_b32 v140, 16, v22
v_and_b32 v141, 0xffff0000, v22
v_lshlrev_b32 v142, 16, v23
v_and_b32 v143, 0xffff0000, v23
s_waitcnt vmcnt(24)
v_lshlrev_b32 v144, 16, v24
v_and_b32 v145, 0xffff0000, v24
v_lshlrev_b32 v146, 16, v25
v_and_b32 v147, 0xffff0000, v25
v_lshlrev_b32 v148, 16, v26
v_and_b32 v149, 0xffff0000, v26
v_lshlrev_b32 v150, 16, v27
v_and_b32 v151, 0xffff0000, v27
s_waitcnt vmcnt(23)
v_lshlrev_b32 v6, 16, v28
v_and_b32 v7, 0xffff0000, v28
v_add_f32 v128, v128, v6
v_add_f32 v129, v129, v7
v_lshlrev_b32 v8, 16, v29
v_and_b32 v9, 0xffff0000, v29
v_add_f32 v130, v130, v8
v_add_f32 v131, v131, v9
v_lshlrev_b32 v6, 16, v30
v_and_b32 v7, 0xffff0000, v30
v_add_f32 v132, v132, v6
v_add_f32 v133, v133, v7
v_lshlrev_b32 v8, 16, v31
v_and_b32 v9, 0xffff0000, v31
v_add_f32 v134, v134, v8
v_add_f32 v135, v135, v9
s_waitcnt vmcnt(22)
v_lshlrev_b32 v6, 16, v40
v_and_b32 v7, 0xffff0000, v40
v_add_f32 v128, v128, v6
v_add_f32 v129, v129, v7
v_lshlrev_b32 v8, 16, v41
v_and_b32 v9, 0xffff0000, v41
v_add_f32 v130, v130, v8
v_add_f32 v131, v131, v9
v_lshlrev_b32 v6, 16, v42
v_and_b32 v7, 0xffff0000, v42
v_add_f32 v132, v132, v6
v_add_f32 v133, v133, v7
v_lshlrev_b32 v8, 16, v43
v_and_b32 v9, 0xffff0000, v43
v_add_f32 v134, v134, v8
v_add_f32 v135, v135, v9
s_waitcnt vmcnt(21)
v_lshlrev_b32 v6, 16, v52
v_and_b32 v7, 0xffff0000, v52
v_add_f32 v128, v128, v6
v_add_f32 v129, v129, v7
v_lshlrev_b32 v8, 16, v53
v_and_b32 v9, 0xffff0000, v53
v_add_f32 v130, v130, v8
v_add_f32 v131, v131, v9
v_lshlrev_b32 v6, 16, v54
v_and_b32 v7, 0xffff0000, v54
v_add_f32 v132, v132, v6
v_add_f32 v133, v133, v7
v_lshlrev_b32 v8, 16, v55
v_and_b32 v9, 0xffff0000, v55
v_add_f32 v134, v134, v8
v_add_f32 v135, v135, v9
s_waitcnt vmcnt(20)
v_lshlrev_b32 v6, 16, v64
v_and_b32 v7, 0xffff0000, v64
v_add_f32 v128, v128, v6
v_add_f32 v129, v129, v7
v_lshlrev_b32 v8, 16, v65
v_and_b32 v9, 0xffff0000, v65
v_add_f32 v130, v130, v8
v_add_f32 v131, v131, v9
v_lshlrev_b32 v6, 16, v66
v_and_b32 v7, 0xffff0000, v66
v_add_f32 v132, v132, v6
v_add_f32 v133, v133, v7
v_lshlrev_b32 v8, 16, v67
v_and_b32 v9, 0xffff0000, v67
v_add_f32 v134, v134, v8
v_add_f32 v135, v135, v9
s_waitcnt vmcnt(19)
v_lshlrev_b32 v6, 16, v76
v_and_b32 v7, 0xffff0000, v76
v_add_f32 v128, v128, v6
v_add_f32 v129, v129, v7
v_lshlrev_b32 v8, 16, v77
v_and_b32 v9, 0xffff0000, v77
v_add_f32 v130, v130, v8
v_add_f32 v131, v131, v9
v_lshlrev_b32 v6, 16, v78
v_and_b32 v7, 0xffff0000, v78
v_add_f32 v132, v132, v6
v_add_f32 v133, v133, v7
v_lshlrev_b32 v8, 16, v79
v_and_b32 v9, 0xffff0000, v79
v_add_f32 v134, v134, v8
v_add_f32 v135, v135, v9
s_waitcnt vmcnt(18)
v_lshlrev_b32 v6, 16, v88
v_and_b32 v7, 0xffff0000, v88
v_add_f32 v128, v128, v6
v_add_f32 v129, v129, v7
v_lshlrev_b32 v8, 16, v89
v_and_b32 v9, 0xffff0000, v89
v_add_f32 v130, v130, v8
v_add_f32 v131, v131, v9
v_lshlrev_b32 v6, 16, v90
v_and_b32 v7, 0xffff0000, v90
v_add_f32 v132, v132, v6
v_add_f32 v133, v133, v7
v_lshlrev_b32 v8, 16, v91
v_and_b32 v9, 0xffff0000, v91
v_add_f32 v134, v134, v8
v_add_f32 v135, v135, v9
s_waitcnt vmcnt(17)
v_lshlrev_b32 v6, 16, v100
v_and_b32 v7, 0xffff0000, v100
v_add_f32 v128, v128, v6
v_add_f32 v129, v129, v7
v_lshlrev_b32 v8, 16, v101
v_and_b32 v9, 0xffff0000, v101
v_add_f32 v130, v130, v8
v_add_f32 v131, v131, v9
v_lshlrev_b32 v6, 16, v102
v_and_b32 v7, 0xffff0000, v102
v_add_f32 v132, v132, v6
v_add_f32 v133, v133, v7
v_lshlrev_b32 v8, 16, v103
v_and_b32 v9, 0xffff0000, v103
v_add_f32 v134, v134, v8
v_add_f32 v135, v135, v9
s_waitcnt vmcnt(16)
v_lshlrev_b32 v6, 16, v112
v_and_b32 v7, 0xffff0000, v112
v_add_f32 v128, v128, v6
v_add_f32 v129, v129, v7
v_lshlrev_b32 v8, 16, v113
v_and_b32 v9, 0xffff0000, v113
v_add_f32 v130, v130, v8
v_add_f32 v131, v131, v9
v_lshlrev_b32 v6, 16, v114
v_and_b32 v7, 0xffff0000, v114
v_add_f32 v132, v132, v6
v_add_f32 v133, v133, v7
v_lshlrev_b32 v8, 16, v115
v_and_b32 v9, 0xffff0000, v115
v_add_f32 v134, v134, v8
v_add_f32 v135, v135, v9
s_waitcnt vmcnt(15)
v_lshlrev_b32 v6, 16, v32
v_and_b32 v7, 0xffff0000, v32
v_add_f32 v136, v136, v6
v_add_f32 v137, v137, v7
v_lshlrev_b32 v8, 16, v33
v_and_b32 v9, 0xffff0000, v33
v_add_f32 v138, v138, v8
v_add_f32 v139, v139, v9
v_lshlrev_b32 v6, 16, v34
v_and_b32 v7, 0xffff0000, v34
v_add_f32 v140, v140, v6
v_add_f32 v141, v141, v7
v_lshlrev_b32 v8, 16, v35
v_and_b32 v9, 0xffff0000, v35
v_add_f32 v142, v142, v8
v_add_f32 v143, v143, v9
s_waitcnt vmcnt(14)
v_lshlrev_b32 v6, 16, v36
v_and_b32 v7, 0xffff0000, v36
v_add_f32 v144, v144, v6
v_add_f32 v145, v145, v7
v_lshlrev_b32 v8, 16, v37
v_and_b32 v9, 0xffff0000, v37
v_add_f32 v146, v146, v8
v_add_f32 v147, v147, v9
v_lshlrev_b32 v6, 16, v38
v_and_b32 v7, 0xffff0000, v38
v_add_f32 v148, v148, v6
v_add_f32 v149, v149, v7
v_lshlrev_b32 v8, 16, v39
v_and_b32 v9, 0xffff0000, v39
v_add_f32 v150, v150, v8
v_add_f32 v151, v151, v9
s_waitcnt vmcnt(13)
v_lshlrev_b32 v6, 16, v44
v_and_b32 v7, 0xffff0000, v44
v_add_f32 v136, v136, v6
v_add_f32 v137, v137, v7
v_lshlrev_b32 v8, 16, v45
v_and_b32 v9, 0xffff0000, v45
v_add_f32 v138, v138, v8
v_add_f32 v139, v139, v9
v_lshlrev_b32 v6, 16, v46
v_and_b32 v7, 0xffff0000, v46
v_add_f32 v140, v140, v6
v_add_f32 v141, v141, v7
v_lshlrev_b32 v8, 16, v47
v_and_b32 v9, 0xffff0000, v47
v_add_f32 v142, v142, v8
v_add_f32 v143, v143, v9
s_waitcnt vmcnt(12)
v_lshlrev_b32 v6, 16, v48
v_and_b32 v7, 0xffff0000, v48
v_add_f32 v144, v144, v6
v_add_f32 v145, v145, v7
v_lshlrev_b32 v8, 16, v49
v_and_b32 v9, 0xffff0000, v49
v_add_f32 v146, v146, v8
v_add_f32 v147, v147, v9
v_lshlrev_b32 v6, 16, v50
v_and_b32 v7, 0xffff0000, v50
v_add_f32 v148, v148, v6
v_add_f32 v149, v149, v7
v_lshlrev_b32 v8, 16, v51
v_and_b32 v9, 0xffff0000, v51
v_add_f32 v150, v150, v8
v_add_f32 v151, v151, v9
s_waitcnt vmcnt(11)
v_lshlrev_b32 v6, 16, v56
v_and_b32 v7, 0xffff0000, v56
v_add_f32 v136, v136, v6
v_add_f32 v137, v137, v7
v_lshlrev_b32 v8, 16, v57
v_and_b32 v9, 0xffff0000, v57
v_add_f32 v138, v138, v8
v_add_f32 v139, v139, v9
v_lshlrev_b32 v6, 16, v58
v_and_b32 v7, 0xffff0000, v58
v_add_f32 v140, v140, v6
v_add_f32 v141, v141, v7
v_lshlrev_b32 v8, 16, v59
v_and_b32 v9, 0xffff0000, v59
v_add_f32 v142, v142, v8
v_add_f32 v143, v143, v9
s_waitcnt vmcnt(10)
v_lshlrev_b32 v6, 16, v60
v_and_b32 v7, 0xffff0000, v60
v_add_f32 v144, v144, v6
v_add_f32 v145, v145, v7
v_lshlrev_b32 v8, 16, v61
v_and_b32 v9, 0xffff0000, v61
v_add_f32 v146, v146, v8
v_add_f32 v147, v147, v9
v_lshlrev_b32 v6, 16, v62
v_and_b32 v7, 0xffff0000, v62
v_add_f32 v148, v148, v6
v_add_f32 v149, v149, v7
v_lshlrev_b32 v8, 16, v63
v_and_b32 v9, 0xffff0000, v63
v_add_f32 v150, v150, v8
v_add_f32 v151, v151, v9
s_waitcnt vmcnt(9)
v_lshlrev_b32 v6, 16, v68
v_and_b32 v7, 0xffff0000, v68
v_add_f32 v136, v136, v6
v_add_f32 v137, v137, v7
v_lshlrev_b32 v8, 16, v69
v_and_b32 v9, 0xffff0000, v69
v_add_f32 v138, v138, v8
v_add_f32 v139, v139, v9
v_lshlrev_b32 v6, 16, v70
v_and_b32 v7, 0xffff0000, v70
v_add_f32 v140, v140, v6
v_add_f32 v141, v141, v7
v_lshlrev_b32 v8, 16, v71
v_and_b32 v9, 0xffff0000, v71
v_add_f32 v142, v142, v8
v_add_f32 v143, v143, v9
s_waitcnt vmcnt(8)
v_lshlrev_b32 v6, 16, v72
v_and_b32 v7, 0xffff0000, v72
v_add_f32 v144, v144, v6
v_add_f32 v145, v145, v7
v_lshlrev_b32 v8, 16, v73
v_and_b32 v9, 0xffff0000, v73
v_add_f32 v146, v146, v8
v_add_f32 v147, v147, v9
v_lshlrev_b32 v6, 16, v74
v_and_b32 v7, 0xffff0000, v74
v_add_f32 v148, v148, v6
v_add_f32 v149, v149, v7
v_lshlrev_b32 v8, 16, v75
v_and_b32 v9, 0xffff0000, v75
v_add_f32 v150, v150, v8
v_add_f32 v151, v151, v9
s_waitcnt vmcnt(7)
v_lshlrev_b32 v6, 16, v80
v_and_b32 v7, 0xffff0000, v80
v_add_f32 v136, v136, v6
v_add_f32 v137, v137, v7
v_lshlrev_b32 v8, 16, v81
v_and_b32 v9, 0xffff0000, v81
v_add_f32 v138, v138, v8
v_add_f32 v139, v139, v9
v_lshlrev_b32 v6, 16, v82
v_and_b32 v7, 0xffff0000, v82
v_add_f32 v140, v140, v6
v_add_f32 v141, v141, v7
v_lshlrev_b32 v8, 16, v83
v_and_b32 v9, 0xffff0000, v83
v_add_f32 v142, v142, v8
v_add_f32 v143, v143, v9
s_waitcnt vmcnt(6)
v_lshlrev_b32 v6, 16, v84
v_and_b32 v7, 0xffff0000, v84
v_add_f32 v144, v144, v6
v_add_f32 v145, v145, v7
v_lshlrev_b32 v8, 16, v85
v_and_b32 v9, 0xffff0000, v85
v_add_f32 v146, v146, v8
v_add_f32 v147, v147, v9
v_lshlrev_b32 v6, 16, v86
v_and_b32 v7, 0xffff0000, v86
v_add_f32 v148, v148, v6
v_add_f32 v149, v149, v7
v_lshlrev_b32 v8, 16, v87
v_and_b32 v9, 0xffff0000, v87
v_add_f32 v150, v150, v8
v_add_f32 v151, v151, v9
s_waitcnt vmcnt(5)
v_lshlrev_b32 v6, 16, v92
v_and_b32 v7, 0xffff0000, v92
v_add_f32 v136, v136, v6
v_add_f32 v137, v137, v7
v_lshlrev_b32 v8, 16, v93
v_and_b32 v9, 0xffff0000, v93
v_add_f32 v138, v138, v8
v_add_f32 v139, v139, v9
v_lshlrev_b32 v6, 16, v94
v_and_b32 v7, 0xffff0000, v94
v_add_f32 v140, v140, v6
v_add_f32 v141, v141, v7
v_lshlrev_b32 v8, 16, v95
v_and_b32 v9, 0xffff0000, v95
v_add_f32 v142, v142, v8
v_add_f32 v143, v143, v9
s_waitcnt vmcnt(4)
v_lshlrev_b32 v6, 16, v96
v_and_b32 v7, 0xffff0000, v96
v_add_f32 v144, v144, v6
v_add_f32 v145, v145, v7
v_lshlrev_b32 v8, 16, v97
v_and_b32 v9, 0xffff0000, v97
v_add_f32 v146, v146, v8
v_add_f32 v147, v147, v9
v_lshlrev_b32 v6, 16, v98
v_and_b32 v7, 0xffff0000, v98
v_add_f32 v148, v148, v6
v_add_f32 v149, v149, v7
v_lshlrev_b32 v8, 16, v99
v_and_b32 v9, 0xffff0000, v99
v_add_f32 v150, v150, v8
v_add_f32 v151, v151, v9
s_waitcnt vmcnt(3)
v_lshlrev_b32 v6, 16, v104
v_and_b32 v7, 0xffff0000, v104
v_add_f32 v136, v136, v6
v_add_f32 v137, v137, v7
v_lshlrev_b32 v8, 16, v105
v_and_b32 v9, 0xffff0000, v105
v_add_f32 v138, v138, v8
v_add_f32 v139, v139, v9
v_lshlrev_b32 v6, 16, v106
v_and_b32 v7, 0xffff0000, v106
v_add_f32 v140, v140, v6
v_add_f32 v141, v141, v7
v_lshlrev_b32 v8, 16, v107
v_and_b32 v9, 0xffff0000, v107
v_add_f32 v142, v142, v8
v_add_f32 v143, v143, v9
s_waitcnt vmcnt(2)
v_lshlrev_b32 v6, 16, v108
v_and_b32 v7, 0xffff0000, v108
v_add_f32 v144, v144, v6
v_add_f32 v145, v145, v7
v_lshlrev_b32 v8, 16, v109
v_and_b32 v9, 0xffff0000, v109
v_add_f32 v146, v146, v8
v_add_f32 v147, v147, v9
v_lshlrev_b32 v6, 16, v110
v_and_b32 v7, 0xffff0000, v110
v_add_f32 v148, v148, v6
v_add_f32 v149, v149, v7
v_lshlrev_b32 v8, 16, v111
v_and_b32 v9, 0xffff0000, v111
v_add_f32 v150, v150, v8
v_add_f32 v151, v151, v9
s_waitcnt vmcnt(1)
v_lshlrev_b32 v6, 16, v116
v_and_b32 v7, 0xffff0000, v116
v_add_f32 v136, v136, v6
v_add_f32 v137, v137, v7
v_lshlrev_b32 v8, 16, v117
v_and_b32 v9, 0xffff0000, v117
v_add_f32 v138, v138, v8
v_add_f32 v139, v139, v9
v_lshlrev_b32 v6, 16, v118
v_and_b32 v7, 0xffff0000, v118
v_add_f32 v140, v140, v6
v_add_f32 v141, v141, v7
v_lshlrev_b32 v8, 16, v119
v_and_b32 v9, 0xffff0000, v119
v_add_f32 v142, v142, v8
v_add_f32 v143, v143, v9
s_waitcnt vmcnt(0)
v_lshlrev_b32 v6, 16, v120
v_and_b32 v7, 0xffff0000, v120
v_add_f32 v144, v144, v6
v_add_f32 v145, v145, v7
v_lshlrev_b32 v8, 16, v121
v_and_b32 v9, 0xffff0000, v121
v_add_f32 v146, v146, v8
v_add_f32 v147, v147, v9
v_lshlrev_b32 v6, 16, v122
v_and_b32 v7, 0xffff0000, v122
v_add_f32 v148, v148, v6
v_add_f32 v149, v149, v7
v_lshlrev_b32 v8, 16, v123
v_and_b32 v9, 0xffff0000, v123
v_add_f32 v150, v150, v8
v_add_f32 v151, v151, v9
v_cvt_pk_bf16_f32 v152, v128, v129
v_cvt_pk_bf16_f32 v153, v130, v131
v_cvt_pk_bf16_f32 v154, v132, v133
v_cvt_pk_bf16_f32 v155, v134, v135
v_cvt_pk_bf16_f32 v156, v136, v137
v_cvt_pk_bf16_f32 v157, v138, v139
v_cvt_pk_bf16_f32 v158, v140, v141
v_cvt_pk_bf16_f32 v159, v142, v143
v_cvt_pk_bf16_f32 v160, v144, v145
v_cvt_pk_bf16_f32 v161, v146, v147
v_cvt_pk_bf16_f32 v162, v148, v149
v_cvt_pk_bf16_f32 v163, v150, v151
buffer_store_dwordx4 v[152:155], v5, s[16:19], s31 offen
buffer_store_dwordx4 v[156:159], v5, s[16:19], s32 offen
buffer_store_dwordx4 v[160:163], v5, s[16:19], s33 offen
L_end:
s_endpgm
L_f_slow1:
s_mov_b32 s52, 0
L_f_spin1:
buffer_load_dwordx2 v[14:15], v11, s[8:11], s23 offen sc1
s_add_u32 s52, s52, 1
s_waitcnt vmcnt(0)
v_cmp_eq_u64 vcc, s[68:69], v[14:15]
s_cmp_gt_u32 s52, 1048576
s_cbranch_scc1 L_f_back1
s_cmp_eq_u64 vcc, exec
s_cbranch_scc0 L_f_spin1
s_branch L_f_back1
L_f_slow2:
s_mov_b32 s52, 0
L_f_spin2:
buffer_load_dwordx2 v[14:15], v11, s[8:11], s23 offen sc1
s_add_u32 s52, s52, 1
s_waitcnt vmcnt(0)
v_cmp_eq_u64 vcc, s[68:69], v[14:15]
s_cmp_gt_u32 s52, 1048576
s_cbranch_scc1 L_f_back2
s_cmp_eq_u64 vcc, exec
s_cbranch_scc0 L_f_spin2
s_branch L_f_back2
L_f_slow3:
s_mov_b32 s52, 0
L_f_spin3:
buffer_load_dwordx2 v[14:15], v11, s[8:11], s23 offen sc1
s_add_u32 s52, s52, 1
s_waitcnt vmcnt(0)
v_cmp_eq_u64 vcc, s[68:69], v[14:15]
s_cmp_gt_u32 s52, 1048576
s_cbranch_scc1 L_f_back3
s_cmp_eq_u64 vcc, exec
s_cbranch_scc0 L_f_spin3
s_branch L_f_back3
L_re_slow4:
s_mov_b32 s52, 0
L_poll5:
buffer_load_dwordx2 v[14:15], v6, s[8:11], s27 offen sc1
s_add_u32 s52, s52, 1
s_waitcnt vmcnt(0)
v_cmp_ne_u64 vcc, s[68:69], v[14:15]
s_cmp_ge_u32 s52, 1048576
s_cbranch_scc1 L_got5
s_and_b64 exec, exec, vcc
s_cbranch_execnz L_poll5
L_got5:
s_mov_b64 exec, -1
s_branch L_re_back4
L_re_slow8:
s_mov_b32 s52, 0
L_poll9:
buffer_load_dwordx2 v[14:15], v6, s[8:11], s27 offen sc1
s_add_u32 s52, s52, 1
s_waitcnt vmcnt(0)
v_cmp_ne_u64 vcc, s[68:69], v[14:15]
s_cmp_ge_u32 s52, 1048576
s_cbranch_scc1 L_got9
s_and_b64 exec, exec, vcc
s_cbranch_execnz L_poll9
L_got9:
s_mov_b64 exec, -1
s_branch L_re_back8
L_epoch:
v_mov_b32 v13, 2146435072
v_cmp_gt_u32 vcc, 16, v0
v_lshlrev_b32 v14, 3, v0
s_nop 0
v_cndmask_b32 v13, v13, v14, vcc
v_mov_b32 v14, s68
v_mov_b32 v15, s69
s_waitcnt vmcnt(0)
s_barrier
buffer_store_dwordx2 v[14:15], v13, s[8:11], s14 offen sc1
s_cmp_lg_u32 s2, 0
s_cbranch_scc1 L_end
v_lshlrev_b32 v4, 7, v1
s_mov_b32 s40, 393216
s_mov_b32 s52, 0
L_poll11:
buffer_load_dwordx2 v[14:15], v4, s[8:11], s40 offen sc1
s_add_u32 s52, s52, 1
s_waitcnt vmcnt(0)
v_cmp_ne_u64 vcc, s[68:69], v[14:15]
s_cmp_ge_u32 s52, 1048576
s_cbranch_scc1 L_got11
s_and_b64 exec, exec, vcc
s_cbranch_execnz L_poll11
L_got11:
s_mov_b64 exec, -1
s_mov_b32 s40, 401408
s_mov_b32 s52, 0
L_poll12:
buffer_load_dwordx2 v[14:15], v4, s[8:11], s40 offen sc1
s_add_u32 s52, s52, 1
s_waitcnt vmcnt(0)
v_cmp_ne_u64 vcc, s[68:69], v[14:15]
s_cmp_ge_u32 s52, 1048576
s_cbranch_scc1 L_got12
s_and_b64 exec, exec, vcc
s_cbranch_execnz L_poll12
L_got12:
s_mov_b64 exec, -1
s_mov_b32 s40, 409600
s_mov_b32 s52, 0
L_poll13:
buffer_load_dwordx2 v[14:15], v4, s[8:11], s40 offen sc1
s_add_u32 s52, s52, 1
s_waitcnt vmcnt(0)
v_cmp_ne_u64 vcc, s[68:69], v[14:15]
s_cmp_ge_u32 s52, 1048576
s_cbranch_scc1 L_got13
s_and_b64 exec, exec, vcc
s_cbranch_execnz L_poll13
L_got13:
s_mov_b64 exec, -1
s_mov_b32 s40, 417792
s_mov_b32 s52, 0
L_poll14:
buffer_load_dwordx2 v[14:15], v4, s[8:11], s40 offen sc1
s_add_u32 s52, s52, 1
s_waitcnt vmcnt(0)
v_cmp_ne_u64 vcc, s[68:69], v[14:15]
s_cmp_ge_u32 s52, 1048576
s_cbranch_scc1 L_got14
s_and_b64 exec, exec, vcc
s_cbranch_execnz L_poll14
L_got14:
s_mov_b64 exec, -1
s_mov_b32 s40, 4194304
v_mov_b32 v13, 2146435072
v_cmp_gt_u32 vcc, 16, v1
v_lshlrev_b32 v14, 3, v1
s_nop 0
v_cndmask_b32 v13, v13, v14, vcc
v_mov_b32 v14, s68
v_mov_b32 v15, s69
buffer_store_dwordx2 v[14:15], v13, s[8:11], s40 offen sc1
s_branch L_end
L_code_end:
s_endpgm
.section .rodata,"a"
.p2align 6
.amdhsa_kernel interleave_layers__sliding_local_dilated__glu_gated_geglu__prompt_kernel
  .amdhsa_next_free_vgpr 512
  .amdhsa_next_free_sgpr 102
  .amdhsa_accum_offset 256
  .amdhsa_group_segment_fixed_size 0
  .amdhsa_kernarg_size 80
  .amdhsa_user_sgpr_count 2
  .amdhsa_user_sgpr_kernarg_segment_ptr 1
  .amdhsa_system_sgpr_workgroup_id_x 1
.end_amdhsa_kernel
```

```asm
; @launch grid=(256,1,1) block=(256,1,1) lds=160768
.amdgcn_target "amdgcn-amd-amdhsa--gfx950"
.text
.p2align 8
.globl interleave_layers__sliding_local_dilated__glu_gated_geglu__prompt_kernel
.type interleave_layers__sliding_local_dilated__glu_gated_geglu__prompt_kernel,@function
interleave_layers__sliding_local_dilated__glu_gated_geglu__prompt_kernel:
s_cmp_ge_u32 s2, 256
s_cbranch_scc1 L_end
s_getpc_b64 s[40:41]
L_warm_pc:
s_lshr_b32 s42, s2, 3
s_lshl_b32 s42, s42, 11
v_lshlrev_b32 v10, 3, v0
v_add_u32 v10, s42, v10
v_min_u32 v10, L_code_end - L_warm_pc - 8, v10
v_mov_b32 v11, s41
v_add_co_u32 v10, vcc, s40, v10
s_nop 1
v_addc_co_u32 v11, vcc, 0, v11, vcc
global_load_dwordx2 a[0:1], v[10:11], off
v_add_co_u32 v10, vcc, 0x10000, v10
s_nop 1
v_addc_co_u32 v11, vcc, 0, v11, vcc
s_add_u32 s42, s42, 67584
s_cmp_le_u32 s42, L_code_end - L_warm_pc - 8
s_cbranch_scc0 L_warm_done
global_load_dwordx2 a[2:3], v[10:11], off
L_warm_done:
s_load_dwordx4 s[56:59], s[0:1], 0
s_load_dwordx2 s[60:61], s[0:1], 16
s_load_dwordx4 s[64:67], s[0:1], 32
s_load_dwordx2 s[62:63], s[0:1], 48
s_load_dwordx2 s[12:13], s[0:1], 72
v_and_b32 v1, 63, v0
v_lshrrev_b32 v3, 6, v0
v_lshlrev_b32 v2, 4, v1
v_readfirstlane_b32 s4, v3
s_and_b32 s5, s2, 7
s_lshr_b32 s6, s2, 3
s_waitcnt lgkmcnt(0)
s_mov_b32 s8, s12
s_and_b32 s9, s13, 0xffff
s_mov_b32 s10, 268435456
s_mov_b32 s11, 0x20000
s_mov_b32 s16, s56
s_and_b32 s17, s57, 0xffff
s_mov_b32 s18, 2359296
s_mov_b32 s19, 0x20000
v_mov_b32 v3, 4194304
buffer_load_dwordx2 v[14:15], v3, s[8:11], 0 offen sc1
v_and_b32 v6, 15, v1
v_lshrrev_b32 v7, 4, v1
v_lshrrev_b32 v8, 2, v6
v_mov_b32 v12, 2146435072
s_mov_b32 s37, 0
s_cmp_lt_u32 s2, 144
s_cbranch_scc0 L_p0_0
s_mul_i32 s40, s2, 911
s_lshr_b32 s40, s40, 16
s_mul_i32 s41, s40, 72
s_sub_u32 s41, s2, s41
s_cmp_eq_u32 s40, 0
s_cselect_b64 s[12:13], s[64:65], s[66:67]
s_mov_b32 s48, s12
s_and_b32 s49, s13, 0xffff
s_mov_b32 s50, 5308416
s_mov_b32 s51, 0x20000
s_lshl_b32 s42, s41, 7
v_lshlrev_b32 v9, 3, v6
v_mul_u32_u24 v10, 73728, v7
v_add3_u32 v4, v9, v10, s42
s_bitcmp1_b32 s4, 0
s_cselect_b64 vcc, -1, 0
v_cndmask_b32 v5, v4, v12, vcc
s_mul_i32 s43, s4, 9
s_add_u32 s43, s43, 1
s_lshr_b32 s43, s43, 1
s_mul_i32 s53, s43, 294912
s_mul_i32 s42, s41, 7282
s_lshr_b32 s42, s42, 16
s_mul_i32 s35, s42, 9
s_sub_u32 s41, s41, s35
s_lshl_b32 s41, s41, 2
s_lshl_b32 s42, s42, 2
s_lshl_b32 s40, s40, 11
s_add_u32 s40, s40, 7012352
s_mov_b32 s35, 497664
v_and_b32 v6, 3, v1
v_add_u32 v6, s41, v6
v_mul_u32_u24 v7, 57, v6
v_lshrrev_b32 v7, 9, v7
v_mul_u32_u24 v8, 9, v7
v_sub_u32 v6, v6, v8
v_subrev_u32 v8, 1, v6
v_min_u32 v8, 8, v8
v_and_b32 v9, 1, v7
v_cmp_eq_u32 vcc, 1, v9
s_nop 1
v_cndmask_b32 v6, v6, v8, vcc
v_add_u32 v7, s42, v7
v_mul_lo_u32 v7, v7, s35
v_add_u32 v7, s40, v7
v_lshrrev_b32 v8, 2, v1
v_add_u32 v8, s43, v8
v_and_b32 v9, 1, v8
v_lshl_add_u32 v7, v9, 10, v7
v_lshrrev_b32 v9, 1, v8
v_lshlrev_b32 v9, 12, v9
v_add_u32 v7, v7, v9
v_lshl_add_u32 v9, v6, 12, v9
v_mul_u32_u24 v10, 36864, v6
v_cmp_gt_u32 vcc, 2, v6
s_nop 1
v_cndmask_b32 v9, v10, v9, vcc
v_add_u32 v7, v7, v9
v_cmp_gt_u32 vcc, 18, v8
s_nop 1
v_cndmask_b32 v7, v12, v7, vcc
s_bitcmp1_b32 s4, 0
s_cselect_b32 s41, 16, 20
v_cmp_gt_u32 vcc, s41, v1
s_nop 1
v_cndmask_b32 v7, v12, v7, vcc
s_nop 0
v_readlane_b32 s40, v7, 0
v_readlane_b32 s41, v7, 1
v_readlane_b32 s42, v7, 2
v_readlane_b32 s43, v7, 3
v_add_u32 v156, s40, v2
v_add_u32 v157, s41, v2
v_add_u32 v158, s42, v2
v_add_u32 v159, s43, v2
v_readlane_b32 s40, v7, 4
v_readlane_b32 s41, v7, 5
v_readlane_b32 s42, v7, 6
v_readlane_b32 s43, v7, 7
v_add_u32 v160, s40, v2
v_add_u32 v161, s41, v2
v_add_u32 v162, s42, v2
v_add_u32 v163, s43, v2
v_readlane_b32 s40, v7, 8
v_readlane_b32 s41, v7, 9
v_readlane_b32 s42, v7, 10
v_readlane_b32 s43, v7, 11
v_add_u32 v164, s40, v2
v_add_u32 v165, s41, v2
v_add_u32 v166, s42, v2
v_add_u32 v167, s43, v2
v_readlane_b32 s40, v7, 12
v_readlane_b32 s41, v7, 13
v_readlane_b32 s42, v7, 14
v_readlane_b32 s43, v7, 15
v_add_u32 v168, s40, v2
v_add_u32 v169, s41, v2
v_add_u32 v170, s42, v2
v_add_u32 v171, s43, v2
v_readlane_b32 s40, v7, 16
v_readlane_b32 s41, v7, 17
v_readlane_b32 s42, v7, 18
v_readlane_b32 s43, v7, 19
v_add_u32 v172, s40, v2
v_add_u32 v173, s41, v2
v_add_u32 v174, s42, v2
v_add_u32 v175, s43, v2
buffer_load_dwordx2 v[76:77], v4, s[48:51], s53 offen
s_add_u32 s53, s53, 9216
buffer_load_dwordx2 v[78:79], v4, s[48:51], s53 offen
s_add_u32 s53, s53, 9216
buffer_load_dwordx2 v[80:81], v4, s[48:51], s53 offen
s_add_u32 s53, s53, 9216
buffer_load_dwordx2 v[82:83], v4, s[48:51], s53 offen
s_add_u32 s53, s53, 9216
buffer_load_dwordx2 v[84:85], v4, s[48:51], s53 offen
s_add_u32 s53, s53, 9216
buffer_load_dwordx2 v[86:87], v4, s[48:51], s53 offen
s_add_u32 s53, s53, 9216
buffer_load_dwordx2 v[88:89], v4, s[48:51], s53 offen
s_add_u32 s53, s53, 9216
buffer_load_dwordx2 v[90:91], v4, s[48:51], s53 offen
s_add_u32 s53, s53, 230400
buffer_load_dwordx2 v[92:93], v4, s[48:51], s53 offen
s_add_u32 s53, s53, 9216
buffer_load_dwordx2 v[94:95], v4, s[48:51], s53 offen
s_add_u32 s53, s53, 9216
buffer_load_dwordx2 v[96:97], v4, s[48:51], s53 offen
s_add_u32 s53, s53, 9216
buffer_load_dwordx2 v[98:99], v4, s[48:51], s53 offen
s_add_u32 s53, s53, 9216
buffer_load_dwordx2 v[100:101], v4, s[48:51], s53 offen
s_add_u32 s53, s53, 9216
buffer_load_dwordx2 v[102:103], v4, s[48:51], s53 offen
s_add_u32 s53, s53, 9216
buffer_load_dwordx2 v[104:105], v4, s[48:51], s53 offen
s_add_u32 s53, s53, 9216
buffer_load_dwordx2 v[106:107], v4, s[48:51], s53 offen
s_add_u32 s53, s53, 230400
buffer_load_dwordx2 v[108:109], v4, s[48:51], s53 offen
s_add_u32 s53, s53, 9216
buffer_load_dwordx2 v[110:111], v4, s[48:51], s53 offen
s_add_u32 s53, s53, 9216
buffer_load_dwordx2 v[112:113], v4, s[48:51], s53 offen
s_add_u32 s53, s53, 9216
buffer_load_dwordx2 v[114:115], v4, s[48:51], s53 offen
s_add_u32 s53, s53, 9216
buffer_load_dwordx2 v[116:117], v4, s[48:51], s53 offen
s_add_u32 s53, s53, 9216
buffer_load_dwordx2 v[118:119], v4, s[48:51], s53 offen
s_add_u32 s53, s53, 9216
buffer_load_dwordx2 v[120:121], v4, s[48:51], s53 offen
s_add_u32 s53, s53, 9216
buffer_load_dwordx2 v[122:123], v4, s[48:51], s53 offen
s_add_u32 s53, s53, 230400
buffer_load_dwordx2 v[124:125], v4, s[48:51], s53 offen
s_add_u32 s53, s53, 9216
buffer_load_dwordx2 v[126:127], v4, s[48:51], s53 offen
s_add_u32 s53, s53, 9216
buffer_load_dwordx2 v[128:129], v4, s[48:51], s53 offen
s_add_u32 s53, s53, 9216
buffer_load_dwordx2 v[130:131], v4, s[48:51], s53 offen
s_add_u32 s53, s53, 9216
buffer_load_dwordx2 v[132:133], v4, s[48:51], s53 offen
s_add_u32 s53, s53, 9216
buffer_load_dwordx2 v[134:135], v4, s[48:51], s53 offen
s_add_u32 s53, s53, 9216
buffer_load_dwordx2 v[136:137], v4, s[48:51], s53 offen
s_add_u32 s53, s53, 9216
buffer_load_dwordx2 v[138:139], v4, s[48:51], s53 offen
s_add_u32 s53, s53, 230400
buffer_load_dwordx2 v[140:141], v5, s[48:51], s53 offen
s_add_u32 s53, s53, 9216
buffer_load_dwordx2 v[142:143], v5, s[48:51], s53 offen
s_add_u32 s53, s53, 9216
buffer_load_dwordx2 v[144:145], v5, s[48:51], s53 offen
s_add_u32 s53, s53, 9216
buffer_load_dwordx2 v[146:147], v5, s[48:51], s53 offen
s_add_u32 s53, s53, 9216
buffer_load_dwordx2 v[148:149], v5, s[48:51], s53 offen
s_add_u32 s53, s53, 9216
buffer_load_dwordx2 v[150:151], v5, s[48:51], s53 offen
s_add_u32 s53, s53, 9216
buffer_load_dwordx2 v[152:153], v5, s[48:51], s53 offen
s_add_u32 s53, s53, 9216
buffer_load_dwordx2 v[154:155], v5, s[48:51], s53 offen
s_add_u32 s53, s53, 230400
s_mov_b32 s34, 0x05040100
s_mov_b32 s35, 0x07060302
s_mov_b32 s38, 0x00003f80
s_mov_b32 s39, 0x3f800000
v_mov_b32 v68, 0x3f803f80
v_mov_b32 v69, 0x3f803f80
v_mov_b32 v70, 0x3f803f80
v_mov_b32 v71, 0x3f803f80
v_and_b32 v72, 15, v1
v_lshlrev_b32 v72, 4, v72
v_add_u32 v72, 159744, v72
s_lshl_b32 s44, s4, 2
v_add_u32 v73, s44, v72
s_waitcnt vmcnt(32)
v_perm_b32 v176, v78, v76, s34
v_perm_b32 v177, v82, v80, s34
v_perm_b32 v178, v86, v84, s34
v_perm_b32 v179, v90, v88, s34
v_perm_b32 v180, v78, v76, s35
v_perm_b32 v181, v82, v80, s35
v_perm_b32 v182, v86, v84, s35
v_perm_b32 v183, v90, v88, s35
v_perm_b32 v184, v79, v77, s34
v_perm_b32 v185, v83, v81, s34
v_perm_b32 v186, v87, v85, s34
v_perm_b32 v187, v91, v89, s34
v_perm_b32 v188, v79, v77, s35
v_perm_b32 v189, v83, v81, s35
v_perm_b32 v190, v87, v85, s35
v_perm_b32 v191, v91, v89, s35
v_mfma_f32_16x16x32_bf16 v[52:55], v[68:71], v[176:179], 0
v_mfma_f32_16x16x32_bf16 v[56:59], v[68:71], v[180:183], 0
v_mfma_f32_16x16x32_bf16 v[60:63], v[68:71], v[184:187], 0
v_mfma_f32_16x16x32_bf16 v[64:67], v[68:71], v[188:191], 0
s_waitcnt vmcnt(24)
v_perm_b32 v192, v94, v92, s34
v_perm_b32 v193, v98, v96, s34
v_perm_b32 v194, v102, v100, s34
v_perm_b32 v195, v106, v104, s34
v_perm_b32 v196, v94, v92, s35
v_perm_b32 v197, v98, v96, s35
v_perm_b32 v198, v102, v100, s35
v_perm_b32 v199, v106, v104, s35
v_perm_b32 v200, v95, v93, s34
v_perm_b32 v201, v99, v97, s34
v_perm_b32 v202, v103, v101, s34
v_perm_b32 v203, v107, v105, s34
v_perm_b32 v204, v95, v93, s35
v_perm_b32 v205, v99, v97, s35
v_perm_b32 v206, v103, v101, s35
v_perm_b32 v207, v107, v105, s35
v_mfma_f32_16x16x32_bf16 v[52:55], v[68:71], v[192:195], v[52:55]
v_mfma_f32_16x16x32_bf16 v[56:59], v[68:71], v[196:199], v[56:59]
v_mfma_f32_16x16x32_bf16 v[60:63], v[68:71], v[200:203], v[60:63]
v_mfma_f32_16x16x32_bf16 v[64:67], v[68:71], v[204:207], v[64:67]
s_waitcnt vmcnt(16)
v_perm_b32 v208, v110, v108, s34
v_perm_b32 v209, v114, v112, s34
v_perm_b32 v210, v118, v116, s34
v_perm_b32 v211, v122, v120, s34
v_perm_b32 v212, v110, v108, s35
v_perm_b32 v213, v114, v112, s35
v_perm_b32 v214, v118, v116, s35
v_perm_b32 v215, v122, v120, s35
v_perm_b32 v216, v111, v109, s34
v_perm_b32 v217, v115, v113, s34
v_perm_b32 v218, v119, v117, s34
v_perm_b32 v219, v123, v121, s34
v_perm_b32 v220, v111, v109, s35
v_perm_b32 v221, v115, v113, s35
v_perm_b32 v222, v119, v117, s35
v_perm_b32 v223, v123, v121, s35
v_mfma_f32_16x16x32_bf16 v[52:55], v[68:71], v[208:211], v[52:55]
v_mfma_f32_16x16x32_bf16 v[56:59], v[68:71], v[212:215], v[56:59]
v_mfma_f32_16x16x32_bf16 v[60:63], v[68:71], v[216:219], v[60:63]
v_mfma_f32_16x16x32_bf16 v[64:67], v[68:71], v[220:223], v[64:67]
s_waitcnt vmcnt(8)
v_perm_b32 v224, v126, v124, s34
v_perm_b32 v225, v130, v128, s34
v_perm_b32 v226, v134, v132, s34
v_perm_b32 v227, v138, v136, s34
v_perm_b32 v228, v126, v124, s35
v_perm_b32 v229, v130, v128, s35
v_perm_b32 v230, v134, v132, s35
v_perm_b32 v231, v138, v136, s35
v_perm_b32 v232, v127, v125, s34
v_perm_b32 v233, v131, v129, s34
v_perm_b32 v234, v135, v133, s34
v_perm_b32 v235, v139, v137, s34
v_perm_b32 v236, v127, v125, s35
v_perm_b32 v237, v131, v129, s35
v_perm_b32 v238, v135, v133, s35
v_perm_b32 v239, v139, v137, s35
v_mfma_f32_16x16x32_bf16 v[52:55], v[68:71], v[224:227], v[52:55]
v_mfma_f32_16x16x32_bf16 v[56:59], v[68:71], v[228:231], v[56:59]
v_mfma_f32_16x16x32_bf16 v[60:63], v[68:71], v[232:235], v[60:63]
v_mfma_f32_16x16x32_bf16 v[64:67], v[68:71], v[236:239], v[64:67]
s_waitcnt vmcnt(0)
v_perm_b32 v240, v142, v140, s34
v_perm_b32 v241, v146, v144, s34
v_perm_b32 v242, v150, v148, s34
v_perm_b32 v243, v154, v152, s34
v_perm_b32 v244, v142, v140, s35
v_perm_b32 v245, v146, v144, s35
v_perm_b32 v246, v150, v148, s35
v_perm_b32 v247, v154, v152, s35
v_perm_b32 v248, v143, v141, s34
v_perm_b32 v249, v147, v145, s34
v_perm_b32 v250, v151, v149, s34
v_perm_b32 v251, v155, v153, s34
v_perm_b32 v252, v143, v141, s35
v_perm_b32 v253, v147, v145, s35
v_perm_b32 v254, v151, v149, s35
v_perm_b32 v255, v155, v153, s35
v_mfma_f32_16x16x32_bf16 v[52:55], v[68:71], v[240:243], v[52:55]
v_mfma_f32_16x16x32_bf16 v[56:59], v[68:71], v[244:247], v[56:59]
v_mfma_f32_16x16x32_bf16 v[60:63], v[68:71], v[248:251], v[60:63]
v_mfma_f32_16x16x32_bf16 v[64:67], v[68:71], v[252:255], v[64:67]
v_readfirstlane_b32 s12, v14
v_readfirstlane_b32 s13, v15
s_add_u32 s68, s12, 1
s_addc_u32 s69, s13, 0
s_nop 0
ds_write_b32 v73, v52 offset:0
ds_write_b32 v73, v56 offset:256
ds_write_b32 v73, v60 offset:512
ds_write_b32 v73, v64 offset:768
s_waitcnt lgkmcnt(0)
s_barrier
ds_read_b128 v[52:55], v72 offset:0
ds_read_b128 v[56:59], v72 offset:256
ds_read_b128 v[60:63], v72 offset:512
ds_read_b128 v[64:67], v72 offset:768
s_waitcnt lgkmcnt(0)
v_add_f32 v52, v52, v53
v_add_f32 v54, v54, v55
v_add_f32 v56, v56, v57
v_add_f32 v58, v58, v59
v_add_f32 v60, v60, v61
v_add_f32 v62, v62, v63
v_add_f32 v64, v64, v65
v_add_f32 v66, v66, v67
v_add_f32 v52, v52, v54
v_add_f32 v56, v56, v58
v_add_f32 v60, v60, v62
v_add_f32 v64, v64, v66
v_mul_f32 v20, 0xbae38e39, v52
v_mul_f32 v21, 0xbae38e39, v56
v_mul_f32 v22, 0xbae38e39, v60
v_mul_f32 v23, 0xbae38e39, v64
v_dot2_f32_bf16 v24, v176, s38, v20
v_dot2_f32_bf16 v25, v176, s39, v20
v_dot2_f32_bf16 v26, v177, s38, v20
v_dot2_f32_bf16 v27, v177, s39, v20
v_dot2_f32_bf16 v28, v178, s38, v20
v_dot2_f32_bf16 v29, v178, s39, v20
v_dot2_f32_bf16 v30, v179, s38, v20
v_dot2_f32_bf16 v31, v179, s39, v20
v_cvt_pk_bf16_f32 v176, v24, v25
v_cvt_pk_bf16_f32 v177, v26, v27
v_cvt_pk_bf16_f32 v178, v28, v29
v_cvt_pk_bf16_f32 v179, v30, v31
v_dot2_f32_bf16 v36, v180, s38, v21
v_dot2_f32_bf16 v37, v180, s39, v21
v_dot2_f32_bf16 v38, v181, s38, v21
v_dot2_f32_bf16 v39, v181, s39, v21
v_dot2_f32_bf16 v40, v182, s38, v21
v_dot2_f32_bf16 v41, v182, s39, v21
v_dot2_f32_bf16 v42, v183, s38, v21
v_dot2_f32_bf16 v43, v183, s39, v21
v_cvt_pk_bf16_f32 v180, v36, v37
v_cvt_pk_bf16_f32 v181, v38, v39
v_cvt_pk_bf16_f32 v182, v40, v41
v_cvt_pk_bf16_f32 v183, v42, v43
v_dot2_f32_bf16 v24, v184, s38, v22
v_dot2_f32_bf16 v25, v184, s39, v22
v_dot2_f32_bf16 v26, v185, s38, v22
v_dot2_f32_bf16 v27, v185, s39, v22
v_dot2_f32_bf16 v28, v186, s38, v22
v_dot2_f32_bf16 v29, v186, s39, v22
v_dot2_f32_bf16 v30, v187, s38, v22
v_dot2_f32_bf16 v31, v187, s39, v22
v_cvt_pk_bf16_f32 v184, v24, v25
v_cvt_pk_bf16_f32 v185, v26, v27
v_cvt_pk_bf16_f32 v186, v28, v29
v_cvt_pk_bf16_f32 v187, v30, v31
v_dot2_f32_bf16 v36, v188, s38, v23
v_dot2_f32_bf16 v37, v188, s39, v23
v_dot2_f32_bf16 v38, v189, s38, v23
v_dot2_f32_bf16 v39, v189, s39, v23
v_dot2_f32_bf16 v40, v190, s38, v23
v_dot2_f32_bf16 v41, v190, s39, v23
v_dot2_f32_bf16 v42, v191, s38, v23
v_dot2_f32_bf16 v43, v191, s39, v23
v_cvt_pk_bf16_f32 v188, v36, v37
v_cvt_pk_bf16_f32 v189, v38, v39
v_cvt_pk_bf16_f32 v190, v40, v41
v_cvt_pk_bf16_f32 v191, v42, v43
v_dot2_f32_bf16 v24, v192, s38, v20
v_dot2_f32_bf16 v25, v192, s39, v20
v_dot2_f32_bf16 v26, v193, s38, v20
v_dot2_f32_bf16 v27, v193, s39, v20
v_dot2_f32_bf16 v28, v194, s38, v20
v_dot2_f32_bf16 v29, v194, s39, v20
v_dot2_f32_bf16 v30, v195, s38, v20
v_dot2_f32_bf16 v31, v195, s39, v20
v_cvt_pk_bf16_f32 v192, v24, v25
v_cvt_pk_bf16_f32 v193, v26, v27
v_cvt_pk_bf16_f32 v194, v28, v29
v_cvt_pk_bf16_f32 v195, v30, v31
v_dot2_f32_bf16 v36, v196, s38, v21
v_dot2_f32_bf16 v37, v196, s39, v21
v_dot2_f32_bf16 v38, v197, s38, v21
v_dot2_f32_bf16 v39, v197, s39, v21
v_dot2_f32_bf16 v40, v198, s38, v21
v_dot2_f32_bf16 v41, v198, s39, v21
v_dot2_f32_bf16 v42, v199, s38, v21
v_dot2_f32_bf16 v43, v199, s39, v21
v_cvt_pk_bf16_f32 v196, v36, v37
v_cvt_pk_bf16_f32 v197, v38, v39
v_cvt_pk_bf16_f32 v198, v40, v41
v_cvt_pk_bf16_f32 v199, v42, v43
v_dot2_f32_bf16 v24, v200, s38, v22
v_dot2_f32_bf16 v25, v200, s39, v22
v_dot2_f32_bf16 v26, v201, s38, v22
v_dot2_f32_bf16 v27, v201, s39, v22
v_dot2_f32_bf16 v28, v202, s38, v22
v_dot2_f32_bf16 v29, v202, s39, v22
v_dot2_f32_bf16 v30, v203, s38, v22
v_dot2_f32_bf16 v31, v203, s39, v22
v_cvt_pk_bf16_f32 v200, v24, v25
v_cvt_pk_bf16_f32 v201, v26, v27
v_cvt_pk_bf16_f32 v202, v28, v29
v_cvt_pk_bf16_f32 v203, v30, v31
v_dot2_f32_bf16 v36, v204, s38, v23
v_dot2_f32_bf16 v37, v204, s39, v23
v_dot2_f32_bf16 v38, v205, s38, v23
v_dot2_f32_bf16 v39, v205, s39, v23
v_dot2_f32_bf16 v40, v206, s38, v23
v_dot2_f32_bf16 v41, v206, s39, v23
v_dot2_f32_bf16 v42, v207, s38, v23
v_dot2_f32_bf16 v43, v207, s39, v23
v_cvt_pk_bf16_f32 v204, v36, v37
v_cvt_pk_bf16_f32 v205, v38, v39
v_cvt_pk_bf16_f32 v206, v40, v41
v_cvt_pk_bf16_f32 v207, v42, v43
v_dot2_f32_bf16 v24, v208, s38, v20
v_dot2_f32_bf16 v25, v208, s39, v20
v_dot2_f32_bf16 v26, v209, s38, v20
v_dot2_f32_bf16 v27, v209, s39, v20
v_dot2_f32_bf16 v28, v210, s38, v20
v_dot2_f32_bf16 v29, v210, s39, v20
v_dot2_f32_bf16 v30, v211, s38, v20
v_dot2_f32_bf16 v31, v211, s39, v20
v_cvt_pk_bf16_f32 v208, v24, v25
v_cvt_pk_bf16_f32 v209, v26, v27
v_cvt_pk_bf16_f32 v210, v28, v29
v_cvt_pk_bf16_f32 v211, v30, v31
v_dot2_f32_bf16 v36, v212, s38, v21
v_dot2_f32_bf16 v37, v212, s39, v21
v_dot2_f32_bf16 v38, v213, s38, v21
v_dot2_f32_bf16 v39, v213, s39, v21
v_dot2_f32_bf16 v40, v214, s38, v21
v_dot2_f32_bf16 v41, v214, s39, v21
v_dot2_f32_bf16 v42, v215, s38, v21
v_dot2_f32_bf16 v43, v215, s39, v21
v_cvt_pk_bf16_f32 v212, v36, v37
v_cvt_pk_bf16_f32 v213, v38, v39
v_cvt_pk_bf16_f32 v214, v40, v41
v_cvt_pk_bf16_f32 v215, v42, v43
v_dot2_f32_bf16 v24, v216, s38, v22
v_dot2_f32_bf16 v25, v216, s39, v22
v_dot2_f32_bf16 v26, v217, s38, v22
v_dot2_f32_bf16 v27, v217, s39, v22
v_dot2_f32_bf16 v28, v218, s38, v22
v_dot2_f32_bf16 v29, v218, s39, v22
v_dot2_f32_bf16 v30, v219, s38, v22
v_dot2_f32_bf16 v31, v219, s39, v22
v_cvt_pk_bf16_f32 v216, v24, v25
v_cvt_pk_bf16_f32 v217, v26, v27
v_cvt_pk_bf16_f32 v218, v28, v29
v_cvt_pk_bf16_f32 v219, v30, v31
v_dot2_f32_bf16 v36, v220, s38, v23
v_dot2_f32_bf16 v37, v220, s39, v23
v_dot2_f32_bf16 v38, v221, s38, v23
v_dot2_f32_bf16 v39, v221, s39, v23
v_dot2_f32_bf16 v40, v222, s38, v23
v_dot2_f32_bf16 v41, v222, s39, v23
v_dot2_f32_bf16 v42, v223, s38, v23
v_dot2_f32_bf16 v43, v223, s39, v23
v_cvt_pk_bf16_f32 v220, v36, v37
v_cvt_pk_bf16_f32 v221, v38, v39
v_cvt_pk_bf16_f32 v222, v40, v41
v_cvt_pk_bf16_f32 v223, v42, v43
v_dot2_f32_bf16 v24, v224, s38, v20
v_dot2_f32_bf16 v25, v224, s39, v20
v_dot2_f32_bf16 v26, v225, s38, v20
v_dot2_f32_bf16 v27, v225, s39, v20
v_dot2_f32_bf16 v28, v226, s38, v20
v_dot2_f32_bf16 v29, v226, s39, v20
v_dot2_f32_bf16 v30, v227, s38, v20
v_dot2_f32_bf16 v31, v227, s39, v20
v_cvt_pk_bf16_f32 v224, v24, v25
v_cvt_pk_bf16_f32 v225, v26, v27
v_cvt_pk_bf16_f32 v226, v28, v29
v_cvt_pk_bf16_f32 v227, v30, v31
v_dot2_f32_bf16 v36, v228, s38, v21
v_dot2_f32_bf16 v37, v228, s39, v21
v_dot2_f32_bf16 v38, v229, s38, v21
v_dot2_f32_bf16 v39, v229, s39, v21
v_dot2_f32_bf16 v40, v230, s38, v21
v_dot2_f32_bf16 v41, v230, s39, v21
v_dot2_f32_bf16 v42, v231, s38, v21
v_dot2_f32_bf16 v43, v231, s39, v21
v_cvt_pk_bf16_f32 v228, v36, v37
v_cvt_pk_bf16_f32 v229, v38, v39
v_cvt_pk_bf16_f32 v230, v40, v41
v_cvt_pk_bf16_f32 v231, v42, v43
v_dot2_f32_bf16 v24, v232, s38, v22
v_dot2_f32_bf16 v25, v232, s39, v22
v_dot2_f32_bf16 v26, v233, s38, v22
v_dot2_f32_bf16 v27, v233, s39, v22
v_dot2_f32_bf16 v28, v234, s38, v22
v_dot2_f32_bf16 v29, v234, s39, v22
v_dot2_f32_bf16 v30, v235, s38, v22
v_dot2_f32_bf16 v31, v235, s39, v22
v_cvt_pk_bf16_f32 v232, v24, v25
v_cvt_pk_bf16_f32 v233, v26, v27
v_cvt_pk_bf16_f32 v234, v28, v29
v_cvt_pk_bf16_f32 v235, v30, v31
v_dot2_f32_bf16 v36, v236, s38, v23
v_dot2_f32_bf16 v37, v236, s39, v23
v_dot2_f32_bf16 v38, v237, s38, v23
v_dot2_f32_bf16 v39, v237, s39, v23
v_dot2_f32_bf16 v40, v238, s38, v23
v_dot2_f32_bf16 v41, v238, s39, v23
v_dot2_f32_bf16 v42, v239, s38, v23
v_dot2_f32_bf16 v43, v239, s39, v23
v_cvt_pk_bf16_f32 v236, v36, v37
v_cvt_pk_bf16_f32 v237, v38, v39
v_cvt_pk_bf16_f32 v238, v40, v41
v_cvt_pk_bf16_f32 v239, v42, v43
v_dot2_f32_bf16 v24, v240, s38, v20
v_dot2_f32_bf16 v25, v240, s39, v20
v_dot2_f32_bf16 v26, v241, s38, v20
v_dot2_f32_bf16 v27, v241, s39, v20
v_dot2_f32_bf16 v28, v242, s38, v20
v_dot2_f32_bf16 v29, v242, s39, v20
v_dot2_f32_bf16 v30, v243, s38, v20
v_dot2_f32_bf16 v31, v243, s39, v20
v_cvt_pk_bf16_f32 v240, v24, v25
v_cvt_pk_bf16_f32 v241, v26, v27
v_cvt_pk_bf16_f32 v242, v28, v29
v_cvt_pk_bf16_f32 v243, v30, v31
v_dot2_f32_bf16 v36, v244, s38, v21
v_dot2_f32_bf16 v37, v244, s39, v21
v_dot2_f32_bf16 v38, v245, s38, v21
v_dot2_f32_bf16 v39, v245, s39, v21
v_dot2_f32_bf16 v40, v246, s38, v21
v_dot2_f32_bf16 v41, v246, s39, v21
v_dot2_f32_bf16 v42, v247, s38, v21
v_dot2_f32_bf16 v43, v247, s39, v21
v_cvt_pk_bf16_f32 v244, v36, v37
v_cvt_pk_bf16_f32 v245, v38, v39
v_cvt_pk_bf16_f32 v246, v40, v41
v_cvt_pk_bf16_f32 v247, v42, v43
v_dot2_f32_bf16 v24, v248, s38, v22
v_dot2_f32_bf16 v25, v248, s39, v22
v_dot2_f32_bf16 v26, v249, s38, v22
v_dot2_f32_bf16 v27, v249, s39, v22
v_dot2_f32_bf16 v28, v250, s38, v22
v_dot2_f32_bf16 v29, v250, s39, v22
v_dot2_f32_bf16 v30, v251, s38, v22
v_dot2_f32_bf16 v31, v251, s39, v22
v_cvt_pk_bf16_f32 v248, v24, v25
v_cvt_pk_bf16_f32 v249, v26, v27
v_cvt_pk_bf16_f32 v250, v28, v29
v_cvt_pk_bf16_f32 v251, v30, v31
v_dot2_f32_bf16 v36, v252, s38, v23
v_dot2_f32_bf16 v37, v252, s39, v23
v_dot2_f32_bf16 v38, v253, s38, v23
v_dot2_f32_bf16 v39, v253, s39, v23
v_dot2_f32_bf16 v40, v254, s38, v23
v_dot2_f32_bf16 v41, v254, s39, v23
v_dot2_f32_bf16 v42, v255, s38, v23
v_dot2_f32_bf16 v43, v255, s39, v23
v_cvt_pk_bf16_f32 v252, v36, v37
v_cvt_pk_bf16_f32 v253, v38, v39
v_cvt_pk_bf16_f32 v254, v40, v41
v_cvt_pk_bf16_f32 v255, v42, v43
s_branch L_p0_e
L_p0_0:
s_sub_u32 s39, s6, 18
s_lshl_b32 s39, s39, 2
s_add_u32 s39, s39, s4
s_cmp_lt_u32 s39, 32
s_cbranch_scc0 L_cr_0
v_and_b32 v9, 7, v1
v_lshrrev_b32 v10, 3, v1
v_mul_u32_u24 v5, 2304, v9
v_lshl_add_u32 v5, v10, 4, v5
s_lshl_b32 s36, s5, 8
s_lshl_b32 s37, s39, 3
s_add_u32 s36, s36, s37
s_and_b32 s37, s36, 1023
s_lshl_b32 s37, s37, 1
s_lshr_b32 s36, s36, 10
s_add_u32 s36, s36, s37
s_mul_i32 s36, s36, 1152
buffer_load_dwordx4 v[16:19], v5, s[16:19], s36 offen offset:0
buffer_load_dwordx4 v[20:23], v5, s[16:19], s36 offen offset:128
buffer_load_dwordx4 v[24:27], v5, s[16:19], s36 offen offset:256
buffer_load_dwordx4 v[28:31], v5, s[16:19], s36 offen offset:384
buffer_load_dwordx4 v[32:35], v5, s[16:19], s36 offen offset:512
buffer_load_dwordx4 v[36:39], v5, s[16:19], s36 offen offset:640
buffer_load_dwordx4 v[40:43], v5, s[16:19], s36 offen offset:768
buffer_load_dwordx4 v[44:47], v5, s[16:19], s36 offen offset:896
buffer_load_dwordx4 v[48:51], v5, s[16:19], s36 offen offset:1024
s_and_b32 s37, s39, 1
s_lshl_b32 s37, s37, 3
v_add_u32 v9, s37, v9
v_lshlrev_b32 v9, 4, v9
v_lshl_add_u32 v4, v10, 8, v9
s_lshl_b32 s36, s5, 4
s_lshr_b32 s37, s39, 1
s_add_u32 s36, s36, s37
s_mul_i32 s36, s36, 18432
s_lshr_b32 s40, s39, 2
s_mov_b32 s44, s58
s_and_b32 s45, s59, 0xffff
s_mov_b32 s46, 1990656
s_mov_b32 s47, 0x20000
s_mul_i32 s42, s40, 110592
s_mul_i32 s43, s4, 27648
s_add_u32 s42, s42, s43
s_mul_i32 s43, s5, 144
s_add_u32 s42, s42, s43
s_lshl_b32 s43, s4, 11
s_add_u32 s43, s43, 0
v_mul_u32_u24 v9, 3456, v7
v_lshl_add_u32 v9, v6, 4, v9
v_cmp_gt_u32 vcc, 9, v6
s_nop 1
v_cndmask_b32 v9, v12, v9, vcc
s_add_u32 m0, s43, 0
s_add_u32 s41, s42, 0
buffer_load_dwordx4 v9, s[44:47], s41 offen lds
s_add_u32 m0, s43, 1024
s_add_u32 s41, s42, 13824
buffer_load_dwordx4 v9, s[44:47], s41 offen lds
s_lshl_b32 s43, s4, 11
s_add_u32 s43, s43, 8192
s_add_u32 m0, s43, 0
s_add_u32 s41, s42, 1152
buffer_load_dwordx4 v9, s[44:47], s41 offen lds
s_add_u32 m0, s43, 1024
s_add_u32 s41, s42, 14976
buffer_load_dwordx4 v9, s[44:47], s41 offen lds
s_lshl_b32 s43, s4, 11
s_add_u32 s43, s43, 16384
s_add_u32 m0, s43, 0
s_add_u32 s41, s42, 2304
buffer_load_dwordx4 v9, s[44:47], s41 offen lds
s_add_u32 m0, s43, 1024
s_add_u32 s41, s42, 16128
buffer_load_dwordx4 v9, s[44:47], s41 offen lds
s_waitcnt vmcnt(6)
v_lshlrev_b32 v52, 16, v16
v_and_b32 v53, 0xffff0000, v16
v_lshlrev_b32 v54, 16, v17
v_and_b32 v55, 0xffff0000, v17
v_lshlrev_b32 v56, 16, v18
v_and_b32 v57, 0xffff0000, v18
v_lshlrev_b32 v58, 16, v19
v_and_b32 v59, 0xffff0000, v19
v_lshlrev_b32 v60, 16, v20
v_and_b32 v61, 0xffff0000, v20
v_lshlrev_b32 v62, 16, v21
v_and_b32 v63, 0xffff0000, v21
v_lshlrev_b32 v64, 16, v22
v_and_b32 v65, 0xffff0000, v22
v_lshlrev_b32 v66, 16, v23
v_and_b32 v67, 0xffff0000, v23
v_lshlrev_b32 v68, 16, v24
v_and_b32 v69, 0xffff0000, v24
v_lshlrev_b32 v70, 16, v25
v_and_b32 v71, 0xffff0000, v25
v_lshlrev_b32 v72, 16, v26
v_and_b32 v73, 0xffff0000, v26
v_lshlrev_b32 v74, 16, v27
v_and_b32 v75, 0xffff0000, v27
v_lshlrev_b32 v76, 16, v28
v_and_b32 v77, 0xffff0000, v28
v_lshlrev_b32 v78, 16, v29
v_and_b32 v79, 0xffff0000, v29
v_lshlrev_b32 v80, 16, v30
v_and_b32 v81, 0xffff0000, v30
v_lshlrev_b32 v82, 16, v31
v_and_b32 v83, 0xffff0000, v31
v_lshlrev_b32 v84, 16, v32
v_and_b32 v85, 0xffff0000, v32
v_lshlrev_b32 v86, 16, v33
v_and_b32 v87, 0xffff0000, v33
v_lshlrev_b32 v88, 16, v34
v_and_b32 v89, 0xffff0000, v34
v_lshlrev_b32 v90, 16, v35
v_and_b32 v91, 0xffff0000, v35
v_lshlrev_b32 v92, 16, v36
v_and_b32 v93, 0xffff0000, v36
v_lshlrev_b32 v94, 16, v37
v_and_b32 v95, 0xffff0000, v37
v_lshlrev_b32 v96, 16, v38
v_and_b32 v97, 0xffff0000, v38
v_lshlrev_b32 v98, 16, v39
v_and_b32 v99, 0xffff0000, v39
v_lshlrev_b32 v100, 16, v40
v_and_b32 v101, 0xffff0000, v40
v_lshlrev_b32 v102, 16, v41
v_and_b32 v103, 0xffff0000, v41
v_lshlrev_b32 v104, 16, v42
v_and_b32 v105, 0xffff0000, v42
v_lshlrev_b32 v106, 16, v43
v_and_b32 v107, 0xffff0000, v43
v_lshlrev_b32 v108, 16, v44
v_and_b32 v109, 0xffff0000, v44
v_lshlrev_b32 v110, 16, v45
v_and_b32 v111, 0xffff0000, v45
v_lshlrev_b32 v112, 16, v46
v_and_b32 v113, 0xffff0000, v46
v_lshlrev_b32 v114, 16, v47
v_and_b32 v115, 0xffff0000, v47
v_lshlrev_b32 v116, 16, v48
v_and_b32 v117, 0xffff0000, v48
v_lshlrev_b32 v118, 16, v49
v_and_b32 v119, 0xffff0000, v49
v_lshlrev_b32 v120, 16, v50
v_and_b32 v121, 0xffff0000, v50
v_lshlrev_b32 v122, 16, v51
v_and_b32 v123, 0xffff0000, v51
s_mov_b32 s37, 0x3f803f80
v_mov_b32 v6, 0
v_mov_b32 v7, 0
v_mov_b32 v8, 0
v_mov_b32 v9, 0
v_dot2_f32_bf16 v6, v16, s37, v6
v_dot2_f32_bf16 v8, v16, v16, v8
v_dot2_f32_bf16 v7, v17, s37, v7
v_dot2_f32_bf16 v9, v17, v17, v9
v_dot2_f32_bf16 v6, v18, s37, v6
v_dot2_f32_bf16 v8, v18, v18, v8
v_dot2_f32_bf16 v7, v19, s37, v7
v_dot2_f32_bf16 v9, v19, v19, v9
v_dot2_f32_bf16 v6, v20, s37, v6
v_dot2_f32_bf16 v8, v20, v20, v8
v_dot2_f32_bf16 v7, v21, s37, v7
v_dot2_f32_bf16 v9, v21, v21, v9
v_dot2_f32_bf16 v6, v22, s37, v6
v_dot2_f32_bf16 v8, v22, v22, v8
v_dot2_f32_bf16 v7, v23, s37, v7
v_dot2_f32_bf16 v9, v23, v23, v9
v_dot2_f32_bf16 v6, v24, s37, v6
v_dot2_f32_bf16 v8, v24, v24, v8
v_dot2_f32_bf16 v7, v25, s37, v7
v_dot2_f32_bf16 v9, v25, v25, v9
v_dot2_f32_bf16 v6, v26, s37, v6
v_dot2_f32_bf16 v8, v26, v26, v8
v_dot2_f32_bf16 v7, v27, s37, v7
v_dot2_f32_bf16 v9, v27, v27, v9
v_dot2_f32_bf16 v6, v28, s37, v6
v_dot2_f32_bf16 v8, v28, v28, v8
v_dot2_f32_bf16 v7, v29, s37, v7
v_dot2_f32_bf16 v9, v29, v29, v9
v_dot2_f32_bf16 v6, v30, s37, v6
v_dot2_f32_bf16 v8, v30, v30, v8
v_dot2_f32_bf16 v7, v31, s37, v7
v_dot2_f32_bf16 v9, v31, v31, v9
v_dot2_f32_bf16 v6, v32, s37, v6
v_dot2_f32_bf16 v8, v32, v32, v8
v_dot2_f32_bf16 v7, v33, s37, v7
v_dot2_f32_bf16 v9, v33, v33, v9
v_dot2_f32_bf16 v6, v34, s37, v6
v_dot2_f32_bf16 v8, v34, v34, v8
v_dot2_f32_bf16 v7, v35, s37, v7
v_dot2_f32_bf16 v9, v35, v35, v9
v_dot2_f32_bf16 v6, v36, s37, v6
v_dot2_f32_bf16 v8, v36, v36, v8
v_dot2_f32_bf16 v7, v37, s37, v7
v_dot2_f32_bf16 v9, v37, v37, v9
v_dot2_f32_bf16 v6, v38, s37, v6
v_dot2_f32_bf16 v8, v38, v38, v8
v_dot2_f32_bf16 v7, v39, s37, v7
v_dot2_f32_bf16 v9, v39, v39, v9
v_dot2_f32_bf16 v6, v40, s37, v6
v_dot2_f32_bf16 v8, v40, v40, v8
v_dot2_f32_bf16 v7, v41, s37, v7
v_dot2_f32_bf16 v9, v41, v41, v9
v_dot2_f32_bf16 v6, v42, s37, v6
v_dot2_f32_bf16 v8, v42, v42, v8
v_dot2_f32_bf16 v7, v43, s37, v7
v_dot2_f32_bf16 v9, v43, v43, v9
v_dot2_f32_bf16 v6, v44, s37, v6
v_dot2_f32_bf16 v8, v44, v44, v8
v_dot2_f32_bf16 v7, v45, s37, v7
v_dot2_f32_bf16 v9, v45, v45, v9
v_dot2_f32_bf16 v6, v46, s37, v6
v_dot2_f32_bf16 v8, v46, v46, v8
v_dot2_f32_bf16 v7, v47, s37, v7
v_dot2_f32_bf16 v9, v47, v47, v9
v_dot2_f32_bf16 v6, v48, s37, v6
v_dot2_f32_bf16 v8, v48, v48, v8
v_dot2_f32_bf16 v7, v49, s37, v7
v_dot2_f32_bf16 v9, v49, v49, v9
v_dot2_f32_bf16 v6, v50, s37, v6
v_dot2_f32_bf16 v8, v50, v50, v8
v_dot2_f32_bf16 v7, v51, s37, v7
v_dot2_f32_bf16 v9, v51, v51, v9
s_add_u32 s37, s36, 27688960
buffer_store_dwordx4 v[16:19], v4, s[8:11], s37 offen offset:0 sc1
buffer_store_dwordx4 v[20:23], v4, s[8:11], s37 offen offset:2048 sc1
s_add_u32 s37, s36, 27693056
buffer_store_dwordx4 v[24:27], v4, s[8:11], s37 offen offset:0 sc1
buffer_store_dwordx4 v[28:31], v4, s[8:11], s37 offen offset:2048 sc1
s_add_u32 s37, s36, 27697152
buffer_store_dwordx4 v[32:35], v4, s[8:11], s37 offen offset:0 sc1
buffer_store_dwordx4 v[36:39], v4, s[8:11], s37 offen offset:2048 sc1
s_add_u32 s37, s36, 27701248
buffer_store_dwordx4 v[40:43], v4, s[8:11], s37 offen offset:0 sc1
buffer_store_dwordx4 v[44:47], v4, s[8:11], s37 offen offset:2048 sc1
s_add_u32 s37, s36, 27705344
buffer_store_dwordx4 v[48:51], v4, s[8:11], s37 offen offset:0 sc1
v_add_f32 v6, v6, v7
v_add_f32 v7, v8, v9
s_nop 0
v_add_f32_dpp v6, v6, v6 row_ror:8 row_mask:0xf bank_mask:0xf
v_add_f32_dpp v7, v7, v7 row_ror:8 row_mask:0xf bank_mask:0xf
v_mov_b32 v8, v6
v_mov_b32 v9, v7
s_nop 0
v_permlane16_swap_b32 v6, v8
v_permlane16_swap_b32 v7, v9
v_add_f32 v6, v6, v8
v_add_f32 v7, v7, v9
v_mov_b32 v8, v6
v_mov_b32 v9, v7
s_nop 0
v_permlane32_swap_b32 v6, v8
v_permlane32_swap_b32 v7, v9
v_add_f32 v6, v6, v8
v_add_f32 v7, v7, v9
v_mul_f32 v6, 0x3ae38e39, v6
v_mul_f32 v7, 0x3ae38e39, v7
v_fma_f32 v7, -v6, v6, v7
v_max_f32 v7, 0, v7
v_add_f32 v7, 0x3727c5ac, v7
v_rsq_f32 v7, v7
s_nop 0
v_mul_f32 v6, v6, v7
v_fma_f32 v52, v52, v7, -v6
v_fma_f32 v53, v53, v7, -v6
v_fma_f32 v54, v54, v7, -v6
v_fma_f32 v55, v55, v7, -v6
v_fma_f32 v56, v56, v7, -v6
v_fma_f32 v57, v57, v7, -v6
v_fma_f32 v58, v58, v7, -v6
v_fma_f32 v59, v59, v7, -v6
v_fma_f32 v60, v60, v7, -v6
v_fma_f32 v61, v61, v7, -v6
v_fma_f32 v62, v62, v7, -v6
v_fma_f32 v63, v63, v7, -v6
v_fma_f32 v64, v64, v7, -v6
v_fma_f32 v65, v65, v7, -v6
v_fma_f32 v66, v66, v7, -v6
v_fma_f32 v67, v67, v7, -v6
v_fma_f32 v68, v68, v7, -v6
v_fma_f32 v69, v69, v7, -v6
v_fma_f32 v70, v70, v7, -v6
v_fma_f32 v71, v71, v7, -v6
v_fma_f32 v72, v72, v7, -v6
v_fma_f32 v73, v73, v7, -v6
v_fma_f32 v74, v74, v7, -v6
v_fma_f32 v75, v75, v7, -v6
v_fma_f32 v76, v76, v7, -v6
v_fma_f32 v77, v77, v7, -v6
v_fma_f32 v78, v78, v7, -v6
v_fma_f32 v79, v79, v7, -v6
v_fma_f32 v80, v80, v7, -v6
v_fma_f32 v81, v81, v7, -v6
v_fma_f32 v82, v82, v7, -v6
v_fma_f32 v83, v83, v7, -v6
v_fma_f32 v84, v84, v7, -v6
v_fma_f32 v85, v85, v7, -v6
v_fma_f32 v86, v86, v7, -v6
v_fma_f32 v87, v87, v7, -v6
v_fma_f32 v88, v88, v7, -v6
v_fma_f32 v89, v89, v7, -v6
v_fma_f32 v90, v90, v7, -v6
v_fma_f32 v91, v91, v7, -v6
v_fma_f32 v92, v92, v7, -v6
v_fma_f32 v93, v93, v7, -v6
v_fma_f32 v94, v94, v7, -v6
v_fma_f32 v95, v95, v7, -v6
v_fma_f32 v96, v96, v7, -v6
v_fma_f32 v97, v97, v7, -v6
v_fma_f32 v98, v98, v7, -v6
v_fma_f32 v99, v99, v7, -v6
v_fma_f32 v100, v100, v7, -v6
v_fma_f32 v101, v101, v7, -v6
v_fma_f32 v102, v102, v7, -v6
v_fma_f32 v103, v103, v7, -v6
v_fma_f32 v104, v104, v7, -v6
v_fma_f32 v105, v105, v7, -v6
v_fma_f32 v106, v106, v7, -v6
v_fma_f32 v107, v107, v7, -v6
v_fma_f32 v108, v108, v7, -v6
v_fma_f32 v109, v109, v7, -v6
v_fma_f32 v110, v110, v7, -v6
v_fma_f32 v111, v111, v7, -v6
v_fma_f32 v112, v112, v7, -v6
v_fma_f32 v113, v113, v7, -v6
v_fma_f32 v114, v114, v7, -v6
v_fma_f32 v115, v115, v7, -v6
v_fma_f32 v116, v116, v7, -v6
v_fma_f32 v117, v117, v7, -v6
v_fma_f32 v118, v118, v7, -v6
v_fma_f32 v119, v119, v7, -v6
v_fma_f32 v120, v120, v7, -v6
v_fma_f32 v121, v121, v7, -v6
v_fma_f32 v122, v122, v7, -v6
v_fma_f32 v123, v123, v7, -v6
v_cvt_pk_bf16_f32 v16, v52, v53
v_cvt_pk_bf16_f32 v17, v54, v55
v_cvt_pk_bf16_f32 v18, v56, v57
v_cvt_pk_bf16_f32 v19, v58, v59
v_cvt_pk_bf16_f32 v20, v60, v61
v_cvt_pk_bf16_f32 v21, v62, v63
v_cvt_pk_bf16_f32 v22, v64, v65
v_cvt_pk_bf16_f32 v23, v66, v67
v_cvt_pk_bf16_f32 v24, v68, v69
v_cvt_pk_bf16_f32 v25, v70, v71
v_cvt_pk_bf16_f32 v26, v72, v73
v_cvt_pk_bf16_f32 v27, v74, v75
v_cvt_pk_bf16_f32 v28, v76, v77
v_cvt_pk_bf16_f32 v29, v78, v79
v_cvt_pk_bf16_f32 v30, v80, v81
v_cvt_pk_bf16_f32 v31, v82, v83
v_cvt_pk_bf16_f32 v32, v84, v85
v_cvt_pk_bf16_f32 v33, v86, v87
v_cvt_pk_bf16_f32 v34, v88, v89
v_cvt_pk_bf16_f32 v35, v90, v91
v_cvt_pk_bf16_f32 v36, v92, v93
v_cvt_pk_bf16_f32 v37, v94, v95
v_cvt_pk_bf16_f32 v38, v96, v97
v_cvt_pk_bf16_f32 v39, v98, v99
v_cvt_pk_bf16_f32 v40, v100, v101
v_cvt_pk_bf16_f32 v41, v102, v103
v_cvt_pk_bf16_f32 v42, v104, v105
v_cvt_pk_bf16_f32 v43, v106, v107
v_cvt_pk_bf16_f32 v44, v108, v109
v_cvt_pk_bf16_f32 v45, v110, v111
v_cvt_pk_bf16_f32 v46, v112, v113
v_cvt_pk_bf16_f32 v47, v114, v115
v_cvt_pk_bf16_f32 v48, v116, v117
v_cvt_pk_bf16_f32 v49, v118, v119
v_cvt_pk_bf16_f32 v50, v120, v121
v_cvt_pk_bf16_f32 v51, v122, v123
s_add_u32 s37, s36, 22970368
buffer_store_dwordx4 v[16:19], v4, s[8:11], s37 offen offset:0 sc1
buffer_store_dwordx4 v[20:23], v4, s[8:11], s37 offen offset:2048 sc1
s_add_u32 s37, s36, 22974464
buffer_store_dwordx4 v[24:27], v4, s[8:11], s37 offen offset:0 sc1
buffer_store_dwordx4 v[28:31], v4, s[8:11], s37 offen offset:2048 sc1
s_add_u32 s37, s36, 22978560
buffer_store_dwordx4 v[32:35], v4, s[8:11], s37 offen offset:0 sc1
buffer_store_dwordx4 v[36:39], v4, s[8:11], s37 offen offset:2048 sc1
s_add_u32 s37, s36, 22982656
buffer_store_dwordx4 v[40:43], v4, s[8:11], s37 offen offset:0 sc1
buffer_store_dwordx4 v[44:47], v4, s[8:11], s37 offen offset:2048 sc1
s_add_u32 s37, s36, 22986752
buffer_store_dwordx4 v[48:51], v4, s[8:11], s37 offen offset:0 sc1
s_waitcnt vmcnt(18)
s_barrier
v_readfirstlane_b32 s12, v14
v_readfirstlane_b32 s13, v15
s_add_u32 s68, s12, 1
s_addc_u32 s69, s13, 0
s_and_b32 s41, s4, 1
s_mul_i32 s42, s41, 72
s_lshl_b32 s43, s5, 1
s_add_u32 s41, s41, s43
s_mul_i32 s41, s41, 129024
s_mul_i32 s43, s40, 7168
s_add_u32 s41, s41, s43
s_add_u32 s41, s41, 4198400
s_lshr_b32 s43, s4, 1
s_lshl_b32 s29, s43, 12
s_add_u32 s41, s41, s29
v_and_b32 v6, 15, v1
v_lshrrev_b32 v7, 4, v1
v_lshlrev_b32 v10, 11, v7
v_add_u32 v10, s42, v10
v_lshl_add_u32 v11, v6, 1, v10
v_and_b32 v9, 1, v6
v_bfe_u32 v13, v6, 1, 1
v_mad_u32_u24 v9, v13, 18, v9
v_lshl_add_u32 v9, v9, 1, v10
v_lshrrev_b32 v13, 2, v6
v_lshl_add_u32 v9, v13, 13, v9
v_add_u32 v9, 32, v9
v_mov_b32 v13, 160
v_cmp_gt_u32 vcc, 12, v6
s_nop 1
v_cndmask_b32 v9, v13, v9, vcc
s_cmp_eq_u32 s43, 0
s_cselect_b64 vcc, -1, 0
v_add_u32 v4, 0, v11
v_cndmask_b32 v4, v9, v4, vcc
v_add_u32 v5, 36, v11
v_add_u32 v13, 16384, v11
v_cndmask_b32 v5, v13, v5, vcc
v_add_u32 v6, 8192, v11
v_add_u32 v13, 16420, v11
v_cndmask_b32 v6, v13, v6, vcc
v_add_u32 v7, 8228, v11
v_add_u32 v13, 0, v11
v_cndmask_b32 v7, v13, v7, vcc
s_add_u32 s20, s41, 0
s_add_u32 s29, s40, 0
s_cmp_lt_u32 s29, 18
s_cselect_b32 s20, s20, 2146435072
s_cmp_eq_u32 s43, 0
s_cselect_b32 s21, s20, 2146435072
ds_read_u16 v124, v4 offset:0
ds_read_u16 v125, v4 offset:256
ds_read_u16 v126, v4 offset:512
ds_read_u16 v127, v4 offset:768
ds_read_u16 v128, v4 offset:1024
ds_read_u16 v129, v4 offset:1280
ds_read_u16 v130, v4 offset:1536
ds_read_u16 v131, v4 offset:1792
ds_read_u16 v132, v5 offset:0
ds_read_u16 v133, v5 offset:256
ds_read_u16 v134, v5 offset:512
ds_read_u16 v135, v5 offset:768
ds_read_u16 v136, v5 offset:1024
ds_read_u16 v137, v5 offset:1280
ds_read_u16 v138, v5 offset:1536
ds_read_u16 v139, v5 offset:1792
s_waitcnt lgkmcnt(8)
v_lshl_or_b32 v124, v125, 16, v124
v_lshl_or_b32 v125, v127, 16, v126
v_lshl_or_b32 v126, v129, 16, v128
v_lshl_or_b32 v127, v131, 16, v130
buffer_store_dwordx4 v[124:127], v2, s[8:11], s20 offen offset:0 sc1
ds_read_u16 v140, v6 offset:0
ds_read_u16 v141, v6 offset:256
ds_read_u16 v142, v6 offset:512
ds_read_u16 v143, v6 offset:768
ds_read_u16 v144, v6 offset:1024
ds_read_u16 v145, v6 offset:1280
ds_read_u16 v146, v6 offset:1536
ds_read_u16 v147, v6 offset:1792
s_waitcnt lgkmcnt(8)
v_lshl_or_b32 v132, v133, 16, v132
v_lshl_or_b32 v133, v135, 16, v134
v_lshl_or_b32 v134, v137, 16, v136
v_lshl_or_b32 v135, v139, 16, v138
buffer_store_dwordx4 v[132:135], v2, s[8:11], s20 offen offset:1024 sc1
ds_read_u16 v148, v7 offset:0
ds_read_u16 v149, v7 offset:256
ds_read_u16 v150, v7 offset:512
ds_read_u16 v151, v7 offset:768
ds_read_u16 v152, v7 offset:1024
ds_read_u16 v153, v7 offset:1280
ds_read_u16 v154, v7 offset:1536
ds_read_u16 v155, v7 offset:1792
s_waitcnt lgkmcnt(8)
v_lshl_or_b32 v140, v141, 16, v140
v_lshl_or_b32 v141, v143, 16, v142
v_lshl_or_b32 v142, v145, 16, v144
v_lshl_or_b32 v143, v147, 16, v146
buffer_store_dwordx4 v[140:143], v2, s[8:11], s20 offen offset:2048 sc1
s_waitcnt lgkmcnt(0)
v_lshl_or_b32 v148, v149, 16, v148
v_lshl_or_b32 v149, v151, 16, v150
v_lshl_or_b32 v150, v153, 16, v152
v_lshl_or_b32 v151, v155, 16, v154
buffer_store_dwordx4 v[148:151], v2, s[8:11], s21 offen offset:3072 sc1
s_branch L_cr_e
L_cr_0:
s_cmp_lt_u32 s39, 48
s_cbranch_scc0 L_cr_1
s_lshr_b32 s40, s39, 2
s_mul_i32 s40, s40, 3
s_sub_u32 s40, s40, 16
s_mov_b32 s44, s58
s_and_b32 s45, s59, 0xffff
s_mov_b32 s46, 1990656
s_mov_b32 s47, 0x20000
s_mul_i32 s42, s40, 110592
s_mul_i32 s43, s4, 27648
s_add_u32 s42, s42, s43
s_mul_i32 s43, s5, 144
s_add_u32 s42, s42, s43
s_lshl_b32 s43, s4, 11
s_add_u32 s43, s43, 0
v_mul_u32_u24 v9, 3456, v7
v_lshl_add_u32 v9, v6, 4, v9
v_cmp_gt_u32 vcc, 9, v6
s_nop 1
v_cndmask_b32 v9, v12, v9, vcc
s_add_u32 m0, s43, 0
s_add_u32 s41, s42, 0
buffer_load_dwordx4 v9, s[44:47], s41 offen lds
s_add_u32 m0, s43, 1024
s_add_u32 s41, s42, 13824
buffer_load_dwordx4 v9, s[44:47], s41 offen lds
s_lshl_b32 s43, s4, 11
s_add_u32 s43, s43, 8192
s_add_u32 m0, s43, 0
s_add_u32 s41, s42, 1152
buffer_load_dwordx4 v9, s[44:47], s41 offen lds
s_add_u32 m0, s43, 1024
s_add_u32 s41, s42, 14976
buffer_load_dwordx4 v9, s[44:47], s41 offen lds
s_lshl_b32 s43, s4, 11
s_add_u32 s43, s43, 16384
s_add_u32 m0, s43, 0
s_add_u32 s41, s42, 2304
buffer_load_dwordx4 v9, s[44:47], s41 offen lds
s_add_u32 m0, s43, 1024
s_add_u32 s41, s42, 16128
buffer_load_dwordx4 v9, s[44:47], s41 offen lds
s_lshl_b32 s43, s4, 11
s_add_u32 s43, s43, 24576
s_add_u32 m0, s43, 0
s_add_u32 s41, s42, 110592
buffer_load_dwordx4 v9, s[44:47], s41 offen lds
s_add_u32 m0, s43, 1024
s_add_u32 s41, s42, 124416
buffer_load_dwordx4 v9, s[44:47], s41 offen lds
s_lshl_b32 s43, s4, 11
s_add_u32 s43, s43, 32768
s_add_u32 m0, s43, 0
s_add_u32 s41, s42, 111744
buffer_load_dwordx4 v9, s[44:47], s41 offen lds
s_add_u32 m0, s43, 1024
s_add_u32 s41, s42, 125568
buffer_load_dwordx4 v9, s[44:47], s41 offen lds
s_lshl_b32 s43, s4, 11
s_add_u32 s43, s43, 40960
s_add_u32 m0, s43, 0
s_add_u32 s41, s42, 112896
buffer_load_dwordx4 v9, s[44:47], s41 offen lds
s_add_u32 m0, s43, 1024
s_add_u32 s41, s42, 126720
buffer_load_dwordx4 v9, s[44:47], s41 offen lds
s_lshl_b32 s43, s4, 11
s_add_u32 s43, s43, 49152
s_add_u32 m0, s43, 0
s_add_u32 s41, s42, 221184
buffer_load_dwordx4 v9, s[44:47], s41 offen lds
s_add_u32 m0, s43, 1024
s_add_u32 s41, s42, 235008
buffer_load_dwordx4 v9, s[44:47], s41 offen lds
s_lshl_b32 s43, s4, 11
s_add_u32 s43, s43, 57344
s_add_u32 m0, s43, 0
s_add_u32 s41, s42, 222336
buffer_load_dwordx4 v9, s[44:47], s41 offen lds
s_add_u32 m0, s43, 1024
s_add_u32 s41, s42, 236160
buffer_load_dwordx4 v9, s[44:47], s41 offen lds
s_lshl_b32 s43, s4, 11
s_add_u32 s43, s43, 65536
s_add_u32 m0, s43, 0
s_add_u32 s41, s42, 223488
buffer_load_dwordx4 v9, s[44:47], s41 offen lds
s_add_u32 m0, s43, 1024
s_add_u32 s41, s42, 237312
buffer_load_dwordx4 v9, s[44:47], s41 offen lds
s_waitcnt vmcnt(0)
s_barrier
v_readfirstlane_b32 s12, v14
v_readfirstlane_b32 s13, v15
s_add_u32 s68, s12, 1
s_addc_u32 s69, s13, 0
s_and_b32 s41, s4, 1
s_mul_i32 s42, s41, 72
s_lshl_b32 s43, s5, 1
s_add_u32 s41, s41, s43
s_mul_i32 s41, s41, 129024
s_mul_i32 s43, s40, 7168
s_add_u32 s41, s41, s43
s_add_u32 s41, s41, 4198400
s_lshr_b32 s43, s4, 1
s_lshl_b32 s29, s43, 12
s_add_u32 s41, s41, s29
v_and_b32 v6, 15, v1
v_lshrrev_b32 v7, 4, v1
v_lshlrev_b32 v10, 11, v7
v_add_u32 v10, s42, v10
v_lshl_add_u32 v11, v6, 1, v10
v_and_b32 v9, 1, v6
v_bfe_u32 v13, v6, 1, 1
v_mad_u32_u24 v9, v13, 18, v9
v_lshl_add_u32 v9, v9, 1, v10
v_lshrrev_b32 v13, 2, v6
v_lshl_add_u32 v9, v13, 13, v9
v_add_u32 v9, 32, v9
v_mov_b32 v13, 160
v_cmp_gt_u32 vcc, 12, v6
s_nop 1
v_cndmask_b32 v9, v13, v9, vcc
s_cmp_eq_u32 s43, 0
s_cselect_b64 vcc, -1, 0
v_add_u32 v4, 0, v11
v_cndmask_b32 v4, v9, v4, vcc
v_add_u32 v5, 36, v11
v_add_u32 v13, 16384, v11
v_cndmask_b32 v5, v13, v5, vcc
v_add_u32 v6, 8192, v11
v_add_u32 v13, 16420, v11
v_cndmask_b32 v6, v13, v6, vcc
v_add_u32 v7, 8228, v11
v_add_u32 v13, 0, v11
v_cndmask_b32 v7, v13, v7, vcc
s_add_u32 s20, s41, 0
s_add_u32 s29, s40, 0
s_cmp_lt_u32 s29, 18
s_cselect_b32 s20, s20, 2146435072
s_cmp_eq_u32 s43, 0
s_cselect_b32 s21, s20, 2146435072
s_add_u32 s22, s41, 7168
s_add_u32 s29, s40, 1
s_cmp_lt_u32 s29, 18
s_cselect_b32 s22, s22, 2146435072
s_cmp_eq_u32 s43, 0
s_cselect_b32 s23, s22, 2146435072
s_add_u32 s24, s41, 14336
s_add_u32 s29, s40, 2
s_cmp_lt_u32 s29, 18
s_cselect_b32 s24, s24, 2146435072
s_cmp_eq_u32 s43, 0
s_cselect_b32 s25, s24, 2146435072
ds_read_u16 v124, v4 offset:0
ds_read_u16 v125, v4 offset:256
ds_read_u16 v126, v4 offset:512
ds_read_u16 v127, v4 offset:768
ds_read_u16 v128, v4 offset:1024
ds_read_u16 v129, v4 offset:1280
ds_read_u16 v130, v4 offset:1536
ds_read_u16 v131, v4 offset:1792
ds_read_u16 v132, v5 offset:0
ds_read_u16 v133, v5 offset:256
ds_read_u16 v134, v5 offset:512
ds_read_u16 v135, v5 offset:768
ds_read_u16 v136, v5 offset:1024
ds_read_u16 v137, v5 offset:1280
ds_read_u16 v138, v5 offset:1536
ds_read_u16 v139, v5 offset:1792
s_waitcnt lgkmcnt(8)
v_lshl_or_b32 v124, v125, 16, v124
v_lshl_or_b32 v125, v127, 16, v126
v_lshl_or_b32 v126, v129, 16, v128
v_lshl_or_b32 v127, v131, 16, v130
buffer_store_dwordx4 v[124:127], v2, s[8:11], s20 offen offset:0 sc1
ds_read_u16 v140, v6 offset:0
ds_read_u16 v141, v6 offset:256
ds_read_u16 v142, v6 offset:512
ds_read_u16 v143, v6 offset:768
ds_read_u16 v144, v6 offset:1024
ds_read_u16 v145, v6 offset:1280
ds_read_u16 v146, v6 offset:1536
ds_read_u16 v147, v6 offset:1792
s_waitcnt lgkmcnt(8)
v_lshl_or_b32 v132, v133, 16, v132
v_lshl_or_b32 v133, v135, 16, v134
v_lshl_or_b32 v134, v137, 16, v136
v_lshl_or_b32 v135, v139, 16, v138
buffer_store_dwordx4 v[132:135], v2, s[8:11], s20 offen offset:1024 sc1
ds_read_u16 v148, v7 offset:0
ds_read_u16 v149, v7 offset:256
ds_read_u16 v150, v7 offset:512
ds_read_u16 v151, v7 offset:768
ds_read_u16 v152, v7 offset:1024
ds_read_u16 v153, v7 offset:1280
ds_read_u16 v154, v7 offset:1536
ds_read_u16 v155, v7 offset:1792
s_waitcnt lgkmcnt(8)
v_lshl_or_b32 v140, v141, 16, v140
v_lshl_or_b32 v141, v143, 16, v142
v_lshl_or_b32 v142, v145, 16, v144
v_lshl_or_b32 v143, v147, 16, v146
buffer_store_dwordx4 v[140:143], v2, s[8:11], s20 offen offset:2048 sc1
ds_read_u16 v124, v4 offset:24576
ds_read_u16 v125, v4 offset:24832
ds_read_u16 v126, v4 offset:25088
ds_read_u16 v127, v4 offset:25344
ds_read_u16 v128, v4 offset:25600
ds_read_u16 v129, v4 offset:25856
ds_read_u16 v130, v4 offset:26112
ds_read_u16 v131, v4 offset:26368
s_waitcnt lgkmcnt(8)
v_lshl_or_b32 v148, v149, 16, v148
v_lshl_or_b32 v149, v151, 16, v150
v_lshl_or_b32 v150, v153, 16, v152
v_lshl_or_b32 v151, v155, 16, v154
buffer_store_dwordx4 v[148:151], v2, s[8:11], s21 offen offset:3072 sc1
ds_read_u16 v132, v5 offset:24576
ds_read_u16 v133, v5 offset:24832
ds_read_u16 v134, v5 offset:25088
ds_read_u16 v135, v5 offset:25344
ds_read_u16 v136, v5 offset:25600
ds_read_u16 v137, v5 offset:25856
ds_read_u16 v138, v5 offset:26112
ds_read_u16 v139, v5 offset:26368
s_waitcnt lgkmcnt(8)
v_lshl_or_b32 v124, v125, 16, v124
v_lshl_or_b32 v125, v127, 16, v126
v_lshl_or_b32 v126, v129, 16, v128
v_lshl_or_b32 v127, v131, 16, v130
buffer_store_dwordx4 v[124:127], v2, s[8:11], s22 offen offset:0 sc1
ds_read_u16 v140, v6 offset:24576
ds_read_u16 v141, v6 offset:24832
ds_read_u16 v142, v6 offset:25088
ds_read_u16 v143, v6 offset:25344
ds_read_u16 v144, v6 offset:25600
ds_read_u16 v145, v6 offset:25856
ds_read_u16 v146, v6 offset:26112
ds_read_u16 v147, v6 offset:26368
s_waitcnt lgkmcnt(8)
v_lshl_or_b32 v132, v133, 16, v132
v_lshl_or_b32 v133, v135, 16, v134
v_lshl_or_b32 v134, v137, 16, v136
v_lshl_or_b32 v135, v139, 16, v138
buffer_store_dwordx4 v[132:135], v2, s[8:11], s22 offen offset:1024 sc1
ds_read_u16 v148, v7 offset:24576
ds_read_u16 v149, v7 offset:24832
ds_read_u16 v150, v7 offset:25088
ds_read_u16 v151, v7 offset:25344
ds_read_u16 v152, v7 offset:25600
ds_read_u16 v153, v7 offset:25856
ds_read_u16 v154, v7 offset:26112
ds_read_u16 v155, v7 offset:26368
s_waitcnt lgkmcnt(8)
v_lshl_or_b32 v140, v141, 16, v140
v_lshl_or_b32 v141, v143, 16, v142
v_lshl_or_b32 v142, v145, 16, v144
v_lshl_or_b32 v143, v147, 16, v146
buffer_store_dwordx4 v[140:143], v2, s[8:11], s22 offen offset:2048 sc1
ds_read_u16 v124, v4 offset:49152
ds_read_u16 v125, v4 offset:49408
ds_read_u16 v126, v4 offset:49664
ds_read_u16 v127, v4 offset:49920
ds_read_u16 v128, v4 offset:50176
ds_read_u16 v129, v4 offset:50432
ds_read_u16 v130, v4 offset:50688
ds_read_u16 v131, v4 offset:50944
s_waitcnt lgkmcnt(8)
v_lshl_or_b32 v148, v149, 16, v148
v_lshl_or_b32 v149, v151, 16, v150
v_lshl_or_b32 v150, v153, 16, v152
v_lshl_or_b32 v151, v155, 16, v154
buffer_store_dwordx4 v[148:151], v2, s[8:11], s23 offen offset:3072 sc1
ds_read_u16 v132, v5 offset:49152
ds_read_u16 v133, v5 offset:49408
ds_read_u16 v134, v5 offset:49664
ds_read_u16 v135, v5 offset:49920
ds_read_u16 v136, v5 offset:50176
ds_read_u16 v137, v5 offset:50432
ds_read_u16 v138, v5 offset:50688
ds_read_u16 v139, v5 offset:50944
s_waitcnt lgkmcnt(8)
v_lshl_or_b32 v124, v125, 16, v124
v_lshl_or_b32 v125, v127, 16, v126
v_lshl_or_b32 v126, v129, 16, v128
v_lshl_or_b32 v127, v131, 16, v130
buffer_store_dwordx4 v[124:127], v2, s[8:11], s24 offen offset:0 sc1
ds_read_u16 v140, v6 offset:49152
ds_read_u16 v141, v6 offset:49408
ds_read_u16 v142, v6 offset:49664
ds_read_u16 v143, v6 offset:49920
ds_read_u16 v144, v6 offset:50176
ds_read_u16 v145, v6 offset:50432
ds_read_u16 v146, v6 offset:50688
ds_read_u16 v147, v6 offset:50944
s_waitcnt lgkmcnt(8)
v_lshl_or_b32 v132, v133, 16, v132
v_lshl_or_b32 v133, v135, 16, v134
v_lshl_or_b32 v134, v137, 16, v136
v_lshl_or_b32 v135, v139, 16, v138
buffer_store_dwordx4 v[132:135], v2, s[8:11], s24 offen offset:1024 sc1
ds_read_u16 v148, v7 offset:49152
ds_read_u16 v149, v7 offset:49408
ds_read_u16 v150, v7 offset:49664
ds_read_u16 v151, v7 offset:49920
ds_read_u16 v152, v7 offset:50176
ds_read_u16 v153, v7 offset:50432
ds_read_u16 v154, v7 offset:50688
ds_read_u16 v155, v7 offset:50944
s_waitcnt lgkmcnt(8)
v_lshl_or_b32 v140, v141, 16, v140
v_lshl_or_b32 v141, v143, 16, v142
v_lshl_or_b32 v142, v145, 16, v144
v_lshl_or_b32 v143, v147, 16, v146
buffer_store_dwordx4 v[140:143], v2, s[8:11], s24 offen offset:2048 sc1
s_waitcnt lgkmcnt(0)
v_lshl_or_b32 v148, v149, 16, v148
v_lshl_or_b32 v149, v151, 16, v150
v_lshl_or_b32 v150, v153, 16, v152
v_lshl_or_b32 v151, v155, 16, v154
buffer_store_dwordx4 v[148:151], v2, s[8:11], s25 offen offset:3072 sc1
s_branch L_cr_e
L_cr_1:
s_lshr_b32 s40, s39, 2
s_sub_u32 s40, s40, 12
s_mov_b32 s44, s60
s_and_b32 s45, s61, 0xffff
s_mov_b32 s46, 663552
s_mov_b32 s47, 0x20000
s_mul_i32 s42, s40, 331776
s_mul_i32 s43, s4, 82944
s_add_u32 s42, s42, s43
s_mul_i32 s43, s5, 144
s_add_u32 s42, s42, s43
s_mul_i32 s43, s4, 18432
v_mul_u32_u24 v9, 1152, v7
v_lshl_add_u32 v9, v6, 4, v9
v_cmp_gt_u32 vcc, 9, v6
s_nop 1
v_cndmask_b32 v9, v12, v9, vcc
s_add_u32 m0, s43, 0
s_add_u32 s41, s42, 0
buffer_load_dwordx4 v9, s[44:47], s41 offen lds
s_add_u32 m0, s43, 1024
s_add_u32 s41, s42, 4608
buffer_load_dwordx4 v9, s[44:47], s41 offen lds
s_add_u32 m0, s43, 2048
s_add_u32 s41, s42, 9216
buffer_load_dwordx4 v9, s[44:47], s41 offen lds
s_add_u32 m0, s43, 3072
s_add_u32 s41, s42, 13824
buffer_load_dwordx4 v9, s[44:47], s41 offen lds
s_add_u32 m0, s43, 4096
s_add_u32 s41, s42, 18432
buffer_load_dwordx4 v9, s[44:47], s41 offen lds
s_add_u32 m0, s43, 5120
s_add_u32 s41, s42, 23040
buffer_load_dwordx4 v9, s[44:47], s41 offen lds
s_add_u32 m0, s43, 6144
s_add_u32 s41, s42, 27648
buffer_load_dwordx4 v9, s[44:47], s41 offen lds
s_add_u32 m0, s43, 7168
s_add_u32 s41, s42, 32256
buffer_load_dwordx4 v9, s[44:47], s41 offen lds
s_add_u32 m0, s43, 8192
s_add_u32 s41, s42, 36864
buffer_load_dwordx4 v9, s[44:47], s41 offen lds
s_add_u32 m0, s43, 9216
s_add_u32 s41, s42, 41472
buffer_load_dwordx4 v9, s[44:47], s41 offen lds
s_add_u32 m0, s43, 10240
s_add_u32 s41, s42, 46080
buffer_load_dwordx4 v9, s[44:47], s41 offen lds
s_add_u32 m0, s43, 11264
s_add_u32 s41, s42, 50688
buffer_load_dwordx4 v9, s[44:47], s41 offen lds
s_add_u32 m0, s43, 12288
s_add_u32 s41, s42, 55296
buffer_load_dwordx4 v9, s[44:47], s41 offen lds
s_add_u32 m0, s43, 13312
s_add_u32 s41, s42, 59904
buffer_load_dwordx4 v9, s[44:47], s41 offen lds
s_add_u32 m0, s43, 14336
s_add_u32 s41, s42, 64512
buffer_load_dwordx4 v9, s[44:47], s41 offen lds
s_add_u32 m0, s43, 15360
s_add_u32 s41, s42, 69120
buffer_load_dwordx4 v9, s[44:47], s41 offen lds
s_add_u32 m0, s43, 16384
s_add_u32 s41, s42, 73728
buffer_load_dwordx4 v9, s[44:47], s41 offen lds
s_add_u32 m0, s43, 17408
s_add_u32 s41, s42, 78336
buffer_load_dwordx4 v9, s[44:47], s41 offen lds
s_waitcnt vmcnt(0)
s_barrier
v_readfirstlane_b32 s12, v14
v_readfirstlane_b32 s13, v15
s_add_u32 s68, s12, 1
s_addc_u32 s69, s13, 0
s_mul_i32 s41, s5, 92160
s_add_u32 s41, s41, 6266880
s_lshl_b32 s42, s40, 3
s_lshl_b32 s43, s4, 1
s_add_u32 s42, s42, s43
s_mul_i32 s42, s42, 5120
s_add_u32 s20, s41, s42
s_add_u32 s21, s20, 4096
s_add_u32 s22, s20, 5120
s_add_u32 s23, s22, 4096
s_add_u32 s42, s40, 16
s_mul_i32 s42, s42, 5120
s_add_u32 s41, s41, s42
s_lshl_b32 s42, s4, 10
s_add_u32 s24, s41, s42
s_add_u32 s25, s41, 4096
s_cmp_eq_u32 s4, 0
s_cselect_b32 s25, s25, 2146435072
v_and_b32 v9, 3, v6
v_lshl_add_u32 v9, v8, 3, v9
v_lshlrev_b32 v9, 1, v9
v_lshlrev_b32 v10, 1, v6
v_add_u32 v10, 128, v10
v_mov_b32 v13, 160
v_cmp_gt_u32 vcc, 8, v6
s_nop 1
v_cndmask_b32 v10, v13, v10, vcc
s_mul_i32 s42, s4, 18432
v_lshlrev_b32 v11, 10, v7
v_add_u32 v11, s42, v11
v_add_u32 v4, v11, v9
v_add_u32 v5, v11, v10
v_mul_u32_u24 v11, 18432, v7
v_add_u32 v7, v11, v10
s_lshr_b32 s42, s4, 1
s_lshl_b32 s42, s42, 6
s_and_b32 s43, s4, 1
s_lshl_b32 s43, s43, 3
s_add_u32 s42, s42, s43
v_add3_u32 v6, v11, v9, s42
ds_read_u16 v124, v4 offset:0
ds_read_u16 v125, v4 offset:256
ds_read_u16 v126, v4 offset:512
ds_read_u16 v127, v4 offset:768
ds_read_u16 v128, v4 offset:4608
ds_read_u16 v129, v4 offset:4864
ds_read_u16 v130, v4 offset:5120
ds_read_u16 v131, v4 offset:5376
ds_read_u16 v132, v4 offset:8
ds_read_u16 v133, v4 offset:264
ds_read_u16 v134, v4 offset:520
ds_read_u16 v135, v4 offset:776
ds_read_u16 v136, v4 offset:4616
ds_read_u16 v137, v4 offset:4872
ds_read_u16 v138, v4 offset:5128
ds_read_u16 v139, v4 offset:5384
s_waitcnt lgkmcnt(8)
v_lshl_or_b32 v124, v125, 16, v124
v_lshl_or_b32 v125, v127, 16, v126
v_lshl_or_b32 v126, v129, 16, v128
v_lshl_or_b32 v127, v131, 16, v130
buffer_store_dwordx4 v[124:127], v2, s[8:11], s20 offen offset:0 sc1
ds_read_u16 v140, v4 offset:64
ds_read_u16 v141, v4 offset:320
ds_read_u16 v142, v4 offset:576
ds_read_u16 v143, v4 offset:832
ds_read_u16 v144, v4 offset:4672
ds_read_u16 v145, v4 offset:4928
ds_read_u16 v146, v4 offset:5184
ds_read_u16 v147, v4 offset:5440
s_waitcnt lgkmcnt(8)
v_lshl_or_b32 v132, v133, 16, v132
v_lshl_or_b32 v133, v135, 16, v134
v_lshl_or_b32 v134, v137, 16, v136
v_lshl_or_b32 v135, v139, 16, v138
buffer_store_dwordx4 v[132:135], v2, s[8:11], s20 offen offset:1024 sc1
ds_read_u16 v148, v4 offset:72
ds_read_u16 v149, v4 offset:328
ds_read_u16 v150, v4 offset:584
ds_read_u16 v151, v4 offset:840
ds_read_u16 v152, v4 offset:4680
ds_read_u16 v153, v4 offset:4936
ds_read_u16 v154, v4 offset:5192
ds_read_u16 v155, v4 offset:5448
s_waitcnt lgkmcnt(8)
v_lshl_or_b32 v140, v141, 16, v140
v_lshl_or_b32 v141, v143, 16, v142
v_lshl_or_b32 v142, v145, 16, v144
v_lshl_or_b32 v143, v147, 16, v146
buffer_store_dwordx4 v[140:143], v2, s[8:11], s20 offen offset:2048 sc1
ds_read_u16 v124, v5 offset:0
ds_read_u16 v125, v5 offset:256
ds_read_u16 v126, v5 offset:512
ds_read_u16 v127, v5 offset:768
ds_read_u16 v128, v5 offset:4608
ds_read_u16 v129, v5 offset:4864
ds_read_u16 v130, v5 offset:5120
ds_read_u16 v131, v5 offset:5376
s_waitcnt lgkmcnt(8)
v_lshl_or_b32 v148, v149, 16, v148
v_lshl_or_b32 v149, v151, 16, v150
v_lshl_or_b32 v150, v153, 16, v152
v_lshl_or_b32 v151, v155, 16, v154
buffer_store_dwordx4 v[148:151], v2, s[8:11], s20 offen offset:3072 sc1
ds_read_u16 v132, v4 offset:9216
ds_read_u16 v133, v4 offset:9472
ds_read_u16 v134, v4 offset:9728
ds_read_u16 v135, v4 offset:9984
ds_read_u16 v136, v4 offset:13824
ds_read_u16 v137, v4 offset:14080
ds_read_u16 v138, v4 offset:14336
ds_read_u16 v139, v4 offset:14592
s_waitcnt lgkmcnt(8)
v_lshl_or_b32 v124, v125, 16, v124
v_lshl_or_b32 v125, v127, 16, v126
v_lshl_or_b32 v126, v129, 16, v128
v_lshl_or_b32 v127, v131, 16, v130
buffer_store_dwordx4 v[124:127], v2, s[8:11], s21 offen offset:0 sc1
ds_read_u16 v140, v4 offset:9224
ds_read_u16 v141, v4 offset:9480
ds_read_u16 v142, v4 offset:9736
ds_read_u16 v143, v4 offset:9992
ds_read_u16 v144, v4 offset:13832
ds_read_u16 v145, v4 offset:14088
ds_read_u16 v146, v4 offset:14344
ds_read_u16 v147, v4 offset:14600
s_waitcnt lgkmcnt(8)
v_lshl_or_b32 v132, v133, 16, v132
v_lshl_or_b32 v133, v135, 16, v134
v_lshl_or_b32 v134, v137, 16, v136
v_lshl_or_b32 v135, v139, 16, v138
buffer_store_dwordx4 v[132:135], v2, s[8:11], s22 offen offset:0 sc1
ds_read_u16 v148, v4 offset:9280
ds_read_u16 v149, v4 offset:9536
ds_read_u16 v150, v4 offset:9792
ds_read_u16 v151, v4 offset:10048
ds_read_u16 v152, v4 offset:13888
ds_read_u16 v153, v4 offset:14144
ds_read_u16 v154, v4 offset:14400
ds_read_u16 v155, v4 offset:14656
s_waitcnt lgkmcnt(8)
v_lshl_or_b32 v140, v141, 16, v140
v_lshl_or_b32 v141, v143, 16, v142
v_lshl_or_b32 v142, v145, 16, v144
v_lshl_or_b32 v143, v147, 16, v146
buffer_store_dwordx4 v[140:143], v2, s[8:11], s22 offen offset:1024 sc1
ds_read_u16 v124, v4 offset:9288
ds_read_u16 v125, v4 offset:9544
ds_read_u16 v126, v4 offset:9800
ds_read_u16 v127, v4 offset:10056
ds_read_u16 v128, v4 offset:13896
ds_read_u16 v129, v4 offset:14152
ds_read_u16 v130, v4 offset:14408
ds_read_u16 v131, v4 offset:14664
s_waitcnt lgkmcnt(8)
v_lshl_or_b32 v148, v149, 16, v148
v_lshl_or_b32 v149, v151, 16, v150
v_lshl_or_b32 v150, v153, 16, v152
v_lshl_or_b32 v151, v155, 16, v154
buffer_store_dwordx4 v[148:151], v2, s[8:11], s22 offen offset:2048 sc1
ds_read_u16 v132, v5 offset:9216
ds_read_u16 v133, v5 offset:9472
ds_read_u16 v134, v5 offset:9728
ds_read_u16 v135, v5 offset:9984
ds_read_u16 v136, v5 offset:13824
ds_read_u16 v137, v5 offset:14080
ds_read_u16 v138, v5 offset:14336
ds_read_u16 v139, v5 offset:14592
s_waitcnt lgkmcnt(8)
v_lshl_or_b32 v124, v125, 16, v124
v_lshl_or_b32 v125, v127, 16, v126
v_lshl_or_b32 v126, v129, 16, v128
v_lshl_or_b32 v127, v131, 16, v130
buffer_store_dwordx4 v[124:127], v2, s[8:11], s22 offen offset:3072 sc1
ds_read_u16 v140, v6 offset:4096
ds_read_u16 v141, v6 offset:4352
ds_read_u16 v142, v6 offset:8704
ds_read_u16 v143, v6 offset:8960
ds_read_u16 v144, v6 offset:13312
ds_read_u16 v145, v6 offset:13568
ds_read_u16 v146, v6 offset:17920
ds_read_u16 v147, v6 offset:18176
s_waitcnt lgkmcnt(8)
v_lshl_or_b32 v132, v133, 16, v132
v_lshl_or_b32 v133, v135, 16, v134
v_lshl_or_b32 v134, v137, 16, v136
v_lshl_or_b32 v135, v139, 16, v138
buffer_store_dwordx4 v[132:135], v2, s[8:11], s23 offen offset:0 sc1
ds_read_u16 v148, v7 offset:4096
ds_read_u16 v149, v7 offset:4352
ds_read_u16 v150, v7 offset:8704
ds_read_u16 v151, v7 offset:8960
ds_read_u16 v152, v7 offset:13312
ds_read_u16 v153, v7 offset:13568
ds_read_u16 v154, v7 offset:17920
ds_read_u16 v155, v7 offset:18176
s_waitcnt lgkmcnt(8)
v_lshl_or_b32 v140, v141, 16, v140
v_lshl_or_b32 v141, v143, 16, v142
v_lshl_or_b32 v142, v145, 16, v144
v_lshl_or_b32 v143, v147, 16, v146
buffer_store_dwordx4 v[140:143], v2, s[8:11], s24 offen offset:0 sc1
s_waitcnt lgkmcnt(0)
v_lshl_or_b32 v148, v149, 16, v148
v_lshl_or_b32 v149, v151, 16, v150
v_lshl_or_b32 v150, v153, 16, v152
v_lshl_or_b32 v151, v155, 16, v154
buffer_store_dwordx4 v[148:151], v2, s[8:11], s25 offen offset:0 sc1
L_cr_e:
s_lshl_b32 s24, s5, 5
s_add_u32 s24, s24, s6
s_lshl_b32 s14, s24, 7
s_add_u32 s14, s14, 786432
v_mov_b32 v13, 2146435072
v_cmp_gt_u32 vcc, 16, v0
v_lshlrev_b32 v14, 3, v0
s_nop 0
v_cndmask_b32 v13, v13, v14, vcc
v_mov_b32 v14, s68
v_mov_b32 v15, s69
s_waitcnt vmcnt(0)
s_barrier
buffer_store_dwordx2 v[14:15], v13, s[8:11], s14 offen sc1
v_mov_b32 v20, 0
v_mov_b32 v21, 0
v_mov_b32 v22, 0
v_mov_b32 v23, 0
s_mov_b32 s38, 0x00003f80
s_mov_b32 s39, 0x3f800000
s_cmp_lt_u32 s2, 216
s_cbranch_scc0 L_wd_0
s_mov_b32 s16, s62
s_and_b32 s17, s63, 0xffff
s_mov_b32 s18, 5308416
s_mov_b32 s19, 0x20000
v_and_b32 v6, 15, v1
v_lshrrev_b32 v7, 4, v1
v_mov_b32 v12, 2146435072
s_sub_u32 s40, s2, 144
s_mul_i32 s37, s40, 73728
s_lshl_b32 s41, s4, 8
s_lshl_b32 s42, s4, 5
v_mul_u32_u24 v10, 18432, v7
v_lshl_add_u32 v9, v6, 3, v10
v_add_u32 v4, s41, v9
v_lshl_add_u32 v9, v6, 1, v10
v_add_u32 v5, s42, v9
s_add_u32 s43, s37, 0
buffer_load_dwordx2 v[76:77], v4, s[16:19], s43 offen offset:0
buffer_load_dwordx2 v[92:93], v4, s[16:19], s43 offen offset:128
buffer_load_ushort v108, v5, s[16:19], s43 offen offset:1024
s_add_u32 s43, s37, 4608
buffer_load_dwordx2 v[78:79], v4, s[16:19], s43 offen offset:0
buffer_load_dwordx2 v[94:95], v4, s[16:19], s43 offen offset:128
buffer_load_ushort v109, v5, s[16:19], s43 offen offset:1024
s_add_u32 s43, s37, 9216
buffer_load_dwordx2 v[80:81], v4, s[16:19], s43 offen offset:0
buffer_load_dwordx2 v[96:97], v4, s[16:19], s43 offen offset:128
buffer_load_ushort v110, v5, s[16:19], s43 offen offset:1024
s_add_u32 s43, s37, 13824
buffer_load_dwordx2 v[82:83], v4, s[16:19], s43 offen offset:0
buffer_load_dwordx2 v[98:99], v4, s[16:19], s43 offen offset:128
buffer_load_ushort v111, v5, s[16:19], s43 offen offset:1024
s_add_u32 s43, s37, 1152
buffer_load_dwordx2 v[84:85], v4, s[16:19], s43 offen offset:0
buffer_load_dwordx2 v[100:101], v4, s[16:19], s43 offen offset:128
buffer_load_ushort v112, v5, s[16:19], s43 offen offset:1024
s_add_u32 s43, s37, 5760
buffer_load_dwordx2 v[86:87], v4, s[16:19], s43 offen offset:0
buffer_load_dwordx2 v[102:103], v4, s[16:19], s43 offen offset:128
buffer_load_ushort v113, v5, s[16:19], s43 offen offset:1024
s_add_u32 s43, s37, 10368
buffer_load_dwordx2 v[88:89], v4, s[16:19], s43 offen offset:0
buffer_load_dwordx2 v[104:105], v4, s[16:19], s43 offen offset:128
buffer_load_ushort v114, v5, s[16:19], s43 offen offset:1024
s_add_u32 s43, s37, 14976
buffer_load_dwordx2 v[90:91], v4, s[16:19], s43 offen offset:0
buffer_load_dwordx2 v[106:107], v4, s[16:19], s43 offen offset:128
buffer_load_ushort v115, v5, s[16:19], s43 offen offset:1024
s_add_u32 s43, s37, 2304
buffer_load_dwordx2 v[116:117], v4, s[16:19], s43 offen offset:0
buffer_load_dwordx2 v[132:133], v4, s[16:19], s43 offen offset:128
buffer_load_ushort v148, v5, s[16:19], s43 offen offset:1024
s_add_u32 s43, s37, 6912
buffer_load_dwordx2 v[118:119], v4, s[16:19], s43 offen offset:0
buffer_load_dwordx2 v[134:135], v4, s[16:19], s43 offen offset:128
buffer_load_ushort v149, v5, s[16:19], s43 offen offset:1024
s_add_u32 s43, s37, 11520
buffer_load_dwordx2 v[120:121], v4, s[16:19], s43 offen offset:0
buffer_load_dwordx2 v[136:137], v4, s[16:19], s43 offen offset:128
buffer_load_ushort v150, v5, s[16:19], s43 offen offset:1024
s_add_u32 s43, s37, 16128
buffer_load_dwordx2 v[122:123], v4, s[16:19], s43 offen offset:0
buffer_load_dwordx2 v[138:139], v4, s[16:19], s43 offen offset:128
buffer_load_ushort v151, v5, s[16:19], s43 offen offset:1024
s_add_u32 s43, s37, 3456
buffer_load_dwordx2 v[124:125], v4, s[16:19], s43 offen offset:0
buffer_load_dwordx2 v[140:141], v4, s[16:19], s43 offen offset:128
buffer_load_ushort v152, v5, s[16:19], s43 offen offset:1024
s_add_u32 s43, s37, 8064
buffer_load_dwordx2 v[126:127], v4, s[16:19], s43 offen offset:0
buffer_load_dwordx2 v[142:143], v4, s[16:19], s43 offen offset:128
buffer_load_ushort v153, v5, s[16:19], s43 offen offset:1024
s_add_u32 s43, s37, 12672
buffer_load_dwordx2 v[128:129], v4, s[16:19], s43 offen offset:0
buffer_load_dwordx2 v[144:145], v4, s[16:19], s43 offen offset:128
buffer_load_ushort v154, v5, s[16:19], s43 offen offset:1024
s_add_u32 s43, s37, 17280
buffer_load_dwordx2 v[130:131], v4, s[16:19], s43 offen offset:0
buffer_load_dwordx2 v[146:147], v4, s[16:19], s43 offen offset:128
buffer_load_ushort v155, v5, s[16:19], s43 offen offset:1024
s_sub_u32 s48, s2, 144
s_mul_i32 s49, s48, 7282
s_lshr_b32 s49, s49, 16
s_mul_i32 s50, s49, 9
s_sub_u32 s48, s48, s50
s_lshl_b32 s48, s48, 1
s_lshl_b32 s49, s49, 2
s_add_u32 s49, s49, s4
s_mul_i32 s49, s49, 497664
s_add_u32 s49, s49, 7344128
v_cmp_lt_u32 vcc, 8, v1
s_nop 1
v_cndmask_b32 v6, 0, 1, vcc
v_mul_u32_u24 v7, 9, v6
v_sub_u32 v7, v1, v7
v_add_u32 v6, s48, v6
v_mov_b32 v8, 0
v_cmp_lt_u32 vcc, 4, v6
s_nop 1
v_addc_co_u32 v8, vcc, 0, v8, vcc
v_cmp_lt_u32 vcc, 8, v6
s_nop 1
v_addc_co_u32 v8, vcc, 0, v8, vcc
v_cmp_lt_u32 vcc, 13, v6
s_nop 1
v_addc_co_u32 v8, vcc, 0, v8, vcc
v_mul_u32_u24 v9, 9, v8
v_add_u32 v9, 1, v9
v_lshrrev_b32 v9, 1, v9
v_sub_u32 v9, v6, v9
v_subrev_u32 v8, s4, v8
v_and_b32 v8, 3, v8
v_mul_u32_u24 v10, 3, v9
v_add3_u32 v10, v10, v8, 2
v_cmp_eq_u32 vcc, 0, v8
s_nop 1
v_cndmask_b32 v10, v10, v9, vcc
v_add_u32 v11, 12, v8
v_cmp_eq_u32 vcc, 3, v9
s_nop 1
v_cndmask_b32 v10, v10, v11, vcc
v_cmp_eq_u32 vcc, 4, v6
s_nop 1
v_cndmask_b32 v10, v10, 16, vcc
v_cmp_eq_u32 vcc, 13, v6
s_nop 1
v_cndmask_b32 v10, v10, 17, vcc
v_and_b32 v6, 30, v10
v_and_b32 v8, 1, v10
v_lshl_add_u32 v8, v7, 1, v8
v_lshl_add_u32 v9, v6, 3, v8
v_lshrrev_b32 v11, 2, v7
v_lshl_add_u32 v6, v6, 2, v8
v_lshl_add_u32 v6, v11, 5, v6
v_add_u32 v6, 32, v6
v_lshrrev_b32 v13, 4, v10
v_or_b32 v11, v11, v13
v_mad_u32_u24 v6, v11, 0, v6
v_cmp_gt_u32 vcc, 8, v10
s_nop 1
v_cndmask_b32 v9, v6, v9, vcc
v_add_u32 v6, 144, v10
v_add_u32 v11, 96, v10
v_cmp_gt_u32 vcc, 0, v10
s_nop 1
v_cndmask_b32 v6, v6, v11, vcc
v_cmp_eq_u32 vcc, 8, v7
s_nop 1
v_cndmask_b32 v9, v9, v6, vcc
v_lshlrev_b32 v9, 10, v9
v_add_u32 v9, s49, v9
v_cmp_gt_u32 vcc, 18, v1
s_nop 1
v_cndmask_b32 v9, v12, v9, vcc
s_nop 0
v_readlane_b32 s48, v9, 0
v_readlane_b32 s49, v9, 1
v_readlane_b32 s50, v9, 2
v_readlane_b32 s51, v9, 3
v_add_u32 v156, s48, v2
v_add_u32 v157, s49, v2
v_add_u32 v158, s50, v2
v_add_u32 v159, s51, v2
v_readlane_b32 s48, v9, 4
v_readlane_b32 s49, v9, 5
v_readlane_b32 s50, v9, 6
v_readlane_b32 s51, v9, 7
v_add_u32 v160, s48, v2
v_add_u32 v161, s49, v2
v_add_u32 v162, s50, v2
v_add_u32 v163, s51, v2
v_readlane_b32 s48, v9, 8
v_readlane_b32 s49, v9, 9
v_readlane_b32 s50, v9, 10
v_readlane_b32 s51, v9, 11
v_add_u32 v164, s48, v2
v_add_u32 v165, s49, v2
v_add_u32 v166, s50, v2
v_add_u32 v167, s51, v2
v_readlane_b32 s48, v9, 12
v_readlane_b32 s49, v9, 13
v_readlane_b32 s50, v9, 14
v_readlane_b32 s51, v9, 15
v_add_u32 v168, s48, v2
v_add_u32 v169, s49, v2
v_add_u32 v170, s50, v2
v_add_u32 v171, s51, v2
v_readlane_b32 s48, v9, 16
v_readlane_b32 s49, v9, 17
v_readlane_b32 s50, v9, 18
v_readlane_b32 s51, v9, 19
v_add_u32 v172, s48, v2
v_add_u32 v173, s49, v2
v_add_u32 v174, s50, v2
v_add_u32 v175, s51, v2
s_branch L_wd_e
L_wd_0:
v_mov_b32 v156, 2146435072
v_mov_b32 v157, 2146435072
v_mov_b32 v158, 2146435072
v_mov_b32 v159, 2146435072
v_mov_b32 v160, 2146435072
v_mov_b32 v161, 2146435072
v_mov_b32 v162, 2146435072
v_mov_b32 v163, 2146435072
v_mov_b32 v164, 2146435072
v_mov_b32 v165, 2146435072
v_mov_b32 v166, 2146435072
v_mov_b32 v167, 2146435072
v_mov_b32 v168, 2146435072
v_mov_b32 v169, 2146435072
v_mov_b32 v170, 2146435072
v_mov_b32 v171, 2146435072
v_mov_b32 v172, 2146435072
v_mov_b32 v173, 2146435072
v_mov_b32 v174, 2146435072
v_mov_b32 v175, 2146435072
L_wd_e:
L_p0_e:
s_mov_b32 s15, 1
s_cmp_eq_u32 s4, 0
s_cbranch_scc1 L_hop0
s_cmp_eq_u32 s4, 1
s_cbranch_scc1 L_hop1
s_cmp_eq_u32 s4, 2
s_cbranch_scc1 L_hop2
s_cmp_eq_u32 s4, 3
s_cbranch_scc1 L_hop3
L_hop_done:
s_mov_b32 s15, 0
s_mov_b32 s70, 22970368
s_mov_b32 s71, 27688960
s_mov_b32 s72, 32407552
s_mov_b32 s73, 37126144
s_mov_b32 s74, 41844736
s_mov_b32 s75, 42106880
s_mov_b32 s76, 79855616
s_mov_b32 s77, 0
s_mov_b32 s7, 0
s_lshr_b32 s20, s5, 2
s_lshl_b32 s20, s20, 3
s_lshr_b32 s21, s6, 2
s_add_u32 s20, s20, s21
s_and_b32 s21, s5, 3
s_lshl_b32 s21, s21, 2
s_and_b32 s22, s6, 3
s_add_u32 s21, s21, s22
s_lshl_b32 s24, s20, 3
s_sub_u32 s25, s24, 1
s_max_i32 s35, s25, 0
s_mul_i32 s25, s35, 18432
s_lshl_b32 s26, s4, 1
s_add_u32 s36, s24, s26
s_mul_i32 s24, s36, 18432
s_add_u32 s26, s24, s70
s_add_u32 s27, s26, 18432
s_add_u32 s28, s25, s70
v_add_u32 v4, 0x10000, v2
v_add_u32 v5, 0x20000, v2
s_cmp_eq_u32 s4, 3
s_cselect_b32 s29, 0, s4
s_cselect_b32 s31, 16, 9
s_lshl_b32 s30, s29, 10
v_and_b32 v12, 15, v1
v_mov_b32 v13, 2146435072
v_cmp_le_u32 vcc, s31, v12
s_nop 1
v_cndmask_b32 v3, v13, v2, vcc
s_add_u32 s31, s30, 2048
v_add_u32 v6, s31, v2
v_add_u32 v7, s31, v4
v_add_u32 v8, s31, v5
s_and_b32 s30, s30, 1024
s_add_u32 s31, s30, 5120
v_add_u32 v9, s31, v2
v_add_u32 v10, s31, v4
v_add_u32 v11, s31, v5
s_lshr_b32 s22, s36, 4
s_lshl_b32 s22, s22, 5
s_bfe_u32 s31, s36, 0x30001
s_add_u32 s22, s22, s31
s_add_u32 s22, s22, 18
s_lshr_b32 s23, s35, 4
s_lshl_b32 s23, s23, 5
s_bfe_u32 s31, s35, 0x30001
s_add_u32 s23, s23, s31
s_add_u32 s23, s23, 18
v_mov_b32 v16, s22
v_mov_b32 v17, s23
v_cmp_eq_u32 vcc, 4, v1
s_nop 1
v_cndmask_b32 v16, v16, v17, vcc
s_lshr_b32 s22, s21, 1
s_lshl_b32 s22, s22, 5
s_add_u32 s22, s22, 10
v_add_u32 v17, s22, v1
v_subrev_u32 v14, 8, v1
v_cmp_gt_u32 vcc, 12, v14
s_nop 1
v_cndmask_b32 v16, v16, v17, vcc
s_and_b32 s22, s6, 7
s_lshl_b32 s22, s22, 5
v_add_u32 v17, s22, v1
v_subrev_u32 v14, 30, v1
v_cmp_gt_u32 vcc, 2, v14
s_nop 1
v_cndmask_b32 v16, v16, v17, vcc
v_lshlrev_b32 v16, 7, v16
s_add_u32 s22, s77, 786432
s_mov_b32 s52, 0
L_poll1:
buffer_load_dwordx2 v[14:15], v16, s[8:11], s22 offen sc1
s_add_u32 s52, s52, 1
s_waitcnt vmcnt(0)
v_cmp_ne_u64 vcc, s[68:69], v[14:15]
s_cmp_ge_u32 s52, 1048576
s_cbranch_scc1 L_got1
s_and_b64 exec, exec, vcc
s_cbranch_execnz L_poll1
L_got1:
s_mov_b64 exec, -1
s_lshr_b32 s20, s5, 2
s_lshl_b32 s20, s20, 3
s_lshr_b32 s21, s6, 2
s_add_u32 s20, s20, s21
s_and_b32 s21, s5, 3
s_lshl_b32 s21, s21, 2
s_and_b32 s22, s6, 3
s_add_u32 s21, s21, s22
s_mul_i32 s32, s21, 129024
s_add_u32 s32, s32, 4198400
s_mul_i32 s33, s4, 32768
s_add_u32 s32, s32, s33
s_sub_u32 s48, s2, 144
s_cmp_lt_u32 s48, 72
s_cbranch_scc0 L_wp_0
s_mov_b32 s46, 0x05040100
s_mov_b32 s47, 0x07060302
v_perm_b32 v176, v78, v76, s46
v_perm_b32 v177, v82, v80, s46
s_add_u32 m0, s33, 0
s_add_u32 s40, s32, 0
buffer_load_dwordx4 v2, s[8:11], s40 offen offset:0 sc1 lds
v_perm_b32 v178, v86, v84, s46
v_perm_b32 v179, v90, v88, s46
buffer_load_dwordx4 v2, s[8:11], s40 offen offset:1024 sc1 lds
v_perm_b32 v180, v78, v76, s47
v_perm_b32 v181, v82, v80, s47
buffer_load_dwordx4 v2, s[8:11], s40 offen offset:2048 sc1 lds
v_perm_b32 v182, v86, v84, s47
v_perm_b32 v183, v90, v88, s47
buffer_load_dwordx4 v2, s[8:11], s40 offen offset:3072 sc1 lds
v_perm_b32 v184, v79, v77, s46
v_perm_b32 v185, v83, v81, s46
s_add_u32 m0, s33, 4096
s_add_u32 s40, s32, 4096
buffer_load_dwordx4 v2, s[8:11], s40 offen offset:0 sc1 lds
v_perm_b32 v186, v87, v85, s46
v_perm_b32 v187, v91, v89, s46
buffer_load_dwordx4 v2, s[8:11], s40 offen offset:1024 sc1 lds
v_perm_b32 v188, v79, v77, s47
v_perm_b32 v189, v83, v81, s47
buffer_load_dwordx4 v2, s[8:11], s40 offen offset:2048 sc1 lds
v_perm_b32 v190, v87, v85, s47
v_perm_b32 v191, v91, v89, s47
buffer_load_dwordx4 v2, s[8:11], s40 offen offset:3072 sc1 lds
v_perm_b32 v192, v94, v92, s46
v_perm_b32 v193, v98, v96, s46
s_add_u32 m0, s33, 8192
s_add_u32 s40, s32, 8192
buffer_load_dwordx4 v2, s[8:11], s40 offen offset:0 sc1 lds
v_perm_b32 v194, v102, v100, s46
v_perm_b32 v195, v106, v104, s46
buffer_load_dwordx4 v2, s[8:11], s40 offen offset:1024 sc1 lds
v_perm_b32 v196, v94, v92, s47
v_perm_b32 v197, v98, v96, s47
buffer_load_dwordx4 v2, s[8:11], s40 offen offset:2048 sc1 lds
v_perm_b32 v198, v102, v100, s47
v_perm_b32 v199, v106, v104, s47
buffer_load_dwordx4 v2, s[8:11], s40 offen offset:3072 sc1 lds
v_perm_b32 v200, v95, v93, s46
v_perm_b32 v201, v99, v97, s46
s_add_u32 m0, s33, 12288
s_add_u32 s40, s32, 12288
buffer_load_dwordx4 v2, s[8:11], s40 offen offset:0 sc1 lds
v_perm_b32 v202, v103, v101, s46
v_perm_b32 v203, v107, v105, s46
buffer_load_dwordx4 v2, s[8:11], s40 offen offset:1024 sc1 lds
v_perm_b32 v204, v95, v93, s47
v_perm_b32 v205, v99, v97, s47
buffer_load_dwordx4 v2, s[8:11], s40 offen offset:2048 sc1 lds
v_perm_b32 v206, v103, v101, s47
v_perm_b32 v207, v107, v105, s47
buffer_load_dwordx4 v2, s[8:11], s40 offen offset:3072 sc1 lds
v_lshl_or_b32 v208, v109, 16, v108
v_lshl_or_b32 v209, v111, 16, v110
s_add_u32 m0, s33, 16384
s_add_u32 s40, s32, 16384
buffer_load_dwordx4 v2, s[8:11], s40 offen offset:0 sc1 lds
v_lshl_or_b32 v210, v113, 16, v112
v_lshl_or_b32 v211, v115, 16, v114
buffer_load_dwordx4 v2, s[8:11], s40 offen offset:1024 sc1 lds
v_perm_b32 v212, v118, v116, s46
v_perm_b32 v213, v122, v120, s46
buffer_load_dwordx4 v2, s[8:11], s40 offen offset:2048 sc1 lds
v_perm_b32 v214, v126, v124, s46
v_perm_b32 v215, v130, v128, s46
buffer_load_dwordx4 v2, s[8:11], s40 offen offset:3072 sc1 lds
v_perm_b32 v216, v118, v116, s47
v_perm_b32 v217, v122, v120, s47
s_add_u32 m0, s33, 20480
s_add_u32 s40, s32, 20480
buffer_load_dwordx4 v2, s[8:11], s40 offen offset:0 sc1 lds
v_perm_b32 v218, v126, v124, s47
v_perm_b32 v219, v130, v128, s47
buffer_load_dwordx4 v2, s[8:11], s40 offen offset:1024 sc1 lds
v_perm_b32 v220, v119, v117, s46
v_perm_b32 v221, v123, v121, s46
buffer_load_dwordx4 v2, s[8:11], s40 offen offset:2048 sc1 lds
v_perm_b32 v222, v127, v125, s46
v_perm_b32 v223, v131, v129, s46
buffer_load_dwordx4 v2, s[8:11], s40 offen offset:3072 sc1 lds
v_perm_b32 v224, v119, v117, s47
v_perm_b32 v225, v123, v121, s47
s_add_u32 m0, s33, 24576
s_add_u32 s40, s32, 24576
buffer_load_dwordx4 v2, s[8:11], s40 offen offset:0 sc1 lds
v_perm_b32 v226, v127, v125, s47
v_perm_b32 v227, v131, v129, s47
buffer_load_dwordx4 v2, s[8:11], s40 offen offset:1024 sc1 lds
v_perm_b32 v228, v134, v132, s46
v_perm_b32 v229, v138, v136, s46
buffer_load_dwordx4 v2, s[8:11], s40 offen offset:2048 sc1 lds
v_perm_b32 v230, v142, v140, s46
v_perm_b32 v231, v146, v144, s46
buffer_load_dwordx4 v2, s[8:11], s40 offen offset:3072 sc1 lds
v_perm_b32 v232, v134, v132, s47
v_perm_b32 v233, v138, v136, s47
s_add_u32 m0, s33, 28672
s_add_u32 s40, s32, 28672
buffer_load_dwordx4 v2, s[8:11], s40 offen offset:0 sc1 lds
v_perm_b32 v234, v142, v140, s47
v_perm_b32 v235, v146, v144, s47
buffer_load_dwordx4 v2, s[8:11], s40 offen offset:1024 sc1 lds
v_perm_b32 v236, v135, v133, s46
v_perm_b32 v237, v139, v137, s46
buffer_load_dwordx4 v2, s[8:11], s40 offen offset:2048 sc1 lds
v_perm_b32 v238, v143, v141, s46
v_perm_b32 v239, v147, v145, s46
buffer_load_dwordx4 v2, s[8:11], s40 offen offset:3072 sc1 lds
v_perm_b32 v240, v135, v133, s47
v_perm_b32 v241, v139, v137, s47
v_perm_b32 v242, v143, v141, s47
v_perm_b32 v243, v147, v145, s47
v_lshl_or_b32 v244, v149, 16, v148
v_lshl_or_b32 v245, v151, 16, v150
v_lshl_or_b32 v246, v153, 16, v152
v_lshl_or_b32 v247, v155, 16, v154
s_branch L_wp_e
L_wp_0:
s_add_u32 m0, s33, 0
s_add_u32 s40, s32, 0
buffer_load_dwordx4 v2, s[8:11], s40 offen offset:0 sc1 lds
buffer_load_dwordx4 v2, s[8:11], s40 offen offset:1024 sc1 lds
buffer_load_dwordx4 v2, s[8:11], s40 offen offset:2048 sc1 lds
buffer_load_dwordx4 v2, s[8:11], s40 offen offset:3072 sc1 lds
s_add_u32 m0, s33, 4096
s_add_u32 s40, s32, 4096
buffer_load_dwordx4 v2, s[8:11], s40 offen offset:0 sc1 lds
buffer_load_dwordx4 v2, s[8:11], s40 offen offset:1024 sc1 lds
buffer_load_dwordx4 v2, s[8:11], s40 offen offset:2048 sc1 lds
buffer_load_dwordx4 v2, s[8:11], s40 offen offset:3072 sc1 lds
s_add_u32 m0, s33, 8192
s_add_u32 s40, s32, 8192
buffer_load_dwordx4 v2, s[8:11], s40 offen offset:0 sc1 lds
buffer_load_dwordx4 v2, s[8:11], s40 offen offset:1024 sc1 lds
buffer_load_dwordx4 v2, s[8:11], s40 offen offset:2048 sc1 lds
buffer_load_dwordx4 v2, s[8:11], s40 offen offset:3072 sc1 lds
s_add_u32 m0, s33, 12288
s_add_u32 s40, s32, 12288
buffer_load_dwordx4 v2, s[8:11], s40 offen offset:0 sc1 lds
buffer_load_dwordx4 v2, s[8:11], s40 offen offset:1024 sc1 lds
buffer_load_dwordx4 v2, s[8:11], s40 offen offset:2048 sc1 lds
buffer_load_dwordx4 v2, s[8:11], s40 offen offset:3072 sc1 lds
s_add_u32 m0, s33, 16384
s_add_u32 s40, s32, 16384
buffer_load_dwordx4 v2, s[8:11], s40 offen offset:0 sc1 lds
buffer_load_dwordx4 v2, s[8:11], s40 offen offset:1024 sc1 lds
buffer_load_dwordx4 v2, s[8:11], s40 offen offset:2048 sc1 lds
buffer_load_dwordx4 v2, s[8:11], s40 offen offset:3072 sc1 lds
s_add_u32 m0, s33, 20480
s_add_u32 s40, s32, 20480
buffer_load_dwordx4 v2, s[8:11], s40 offen offset:0 sc1 lds
buffer_load_dwordx4 v2, s[8:11], s40 offen offset:1024 sc1 lds
buffer_load_dwordx4 v2, s[8:11], s40 offen offset:2048 sc1 lds
buffer_load_dwordx4 v2, s[8:11], s40 offen offset:3072 sc1 lds
s_add_u32 m0, s33, 24576
s_add_u32 s40, s32, 24576
buffer_load_dwordx4 v2, s[8:11], s40 offen offset:0 sc1 lds
buffer_load_dwordx4 v2, s[8:11], s40 offen offset:1024 sc1 lds
buffer_load_dwordx4 v2, s[8:11], s40 offen offset:2048 sc1 lds
buffer_load_dwordx4 v2, s[8:11], s40 offen offset:3072 sc1 lds
s_add_u32 m0, s33, 28672
s_add_u32 s40, s32, 28672
buffer_load_dwordx4 v2, s[8:11], s40 offen offset:0 sc1 lds
buffer_load_dwordx4 v2, s[8:11], s40 offen offset:1024 sc1 lds
buffer_load_dwordx4 v2, s[8:11], s40 offen offset:2048 sc1 lds
buffer_load_dwordx4 v2, s[8:11], s40 offen offset:3072 sc1 lds
L_wp_e:
buffer_load_dwordx4 a[0:3], v2, s[8:11], s26 offen offset:0 sc1
buffer_load_dwordx4 a[72:75], v2, s[8:11], s27 offen offset:0 sc1
buffer_load_dwordx4 a[144:147], v3, s[8:11], s28 offen offset:0 sc1
buffer_load_dwordx4 a[4:7], v2, s[8:11], s26 offen offset:1024 sc1
buffer_load_dwordx4 a[76:79], v2, s[8:11], s27 offen offset:1024 sc1
buffer_load_dwordx4 a[148:151], v3, s[8:11], s28 offen offset:1024 sc1
buffer_load_dwordx4 a[8:11], v2, s[8:11], s26 offen offset:2048 sc1
buffer_load_dwordx4 a[80:83], v2, s[8:11], s27 offen offset:2048 sc1
buffer_load_dwordx4 a[152:155], v3, s[8:11], s28 offen offset:2048 sc1
buffer_load_dwordx4 a[12:15], v2, s[8:11], s26 offen offset:3072 sc1
buffer_load_dwordx4 a[84:87], v2, s[8:11], s27 offen offset:3072 sc1
buffer_load_dwordx4 a[156:159], v3, s[8:11], s28 offen offset:3072 sc1
s_add_u32 s26, s26, 4096
s_add_u32 s27, s27, 4096
s_add_u32 s28, s28, 4096
buffer_load_dwordx4 a[16:19], v2, s[8:11], s26 offen offset:0 sc1
buffer_load_dwordx4 a[88:91], v2, s[8:11], s27 offen offset:0 sc1
buffer_load_dwordx4 a[160:163], v3, s[8:11], s28 offen offset:0 sc1
buffer_load_dwordx4 a[20:23], v2, s[8:11], s26 offen offset:1024 sc1
buffer_load_dwordx4 a[92:95], v2, s[8:11], s27 offen offset:1024 sc1
buffer_load_dwordx4 a[164:167], v3, s[8:11], s28 offen offset:1024 sc1
buffer_load_dwordx4 a[24:27], v2, s[8:11], s26 offen offset:2048 sc1
buffer_load_dwordx4 a[96:99], v2, s[8:11], s27 offen offset:2048 sc1
buffer_load_dwordx4 a[168:171], v3, s[8:11], s28 offen offset:2048 sc1
buffer_load_dwordx4 a[28:31], v2, s[8:11], s26 offen offset:3072 sc1
buffer_load_dwordx4 a[100:103], v2, s[8:11], s27 offen offset:3072 sc1
buffer_load_dwordx4 a[172:175], v3, s[8:11], s28 offen offset:3072 sc1
v_lshrrev_b32 v13, 4, v1
v_lshlrev_b32 v14, 2, v13
v_sub_u32 v14, v12, v14
v_subrev_u32 v15, 0, v14
v_cmp_gt_u32 s[52:53], 8, v15
v_cmp_gt_i32 s[44:45], -8, v15
v_subrev_u32 v15, 1, v14
v_cmp_gt_u32 s[54:55], 8, v15
v_cmp_gt_i32 s[46:47], -8, v15
v_subrev_u32 v15, 2, v14
v_cmp_gt_u32 s[56:57], 8, v15
v_cmp_gt_i32 s[48:49], -8, v15
v_subrev_u32 v15, 3, v14
v_cmp_gt_u32 s[58:59], 8, v15
v_cmp_gt_i32 s[50:51], -8, v15
s_and_b32 s31, s20, 7
s_or_b32 s31, s31, s4
s_cmp_eq_u32 s31, 0
s_cselect_b64 s[60:61], 0, s[44:45]
s_cselect_b64 s[62:63], 0, s[46:47]
s_cselect_b64 s[64:65], 0, s[48:49]
s_cselect_b64 s[66:67], 0, s[50:51]
s_waitcnt vmcnt(24)
s_barrier
ds_read_b128 a[216:219], v2 offset:0
ds_read_b128 a[220:223], v2 offset:7168
ds_read_b128 a[224:227], v2 offset:1024
ds_read_b128 a[228:231], v2 offset:8192
ds_read_b128 a[232:235], v2 offset:2048
ds_read_b128 a[236:239], v2 offset:9216
s_waitcnt vmcnt(18)
s_waitcnt lgkmcnt(4)
v_mfma_f32_16x16x32_bf16 v[32:35], a[216:219], a[0:3], 0
s_add_u32 s26, s26, 4096
s_add_u32 s27, s27, 4096
s_add_u32 s28, s28, 4096
buffer_load_dwordx4 a[32:35], v2, s[8:11], s26 offen offset:0 sc1
v_mfma_f32_16x16x32_bf16 v[32:35], a[220:223], a[4:7], v[32:35]
ds_read_b128 a[240:243], v2 offset:3072
v_lshlrev_b32 v14, 3, v1
v_mfma_f32_16x16x32_bf16 v[36:39], a[216:219], a[72:75], 0
s_mul_i32 s31, s4, 3072
s_add_u32 s41, s31, 147456
v_mfma_f32_16x16x32_bf16 v[36:39], a[220:223], a[76:79], v[36:39]
ds_read_b128 a[244:247], v2 offset:10240
s_waitcnt lgkmcnt(4)
v_mfma_f32_16x16x32_bf16 v[40:43], a[224:227], a[0:3], 0
buffer_load_dwordx4 a[104:107], v2, s[8:11], s27 offen offset:0 sc1
v_mfma_f32_16x16x32_bf16 v[40:43], a[228:231], a[4:7], v[40:43]
ds_read_b128 a[216:219], v2 offset:4096
v_add_u32 v15, s41, v14
v_mfma_f32_16x16x32_bf16 v[44:47], a[224:227], a[72:75], 0
s_lshl_b32 s42, s29, 9
s_add_u32 s42, s42, 147456
v_mfma_f32_16x16x32_bf16 v[44:47], a[228:231], a[76:79], v[44:47]
ds_read_b128 a[220:223], v2 offset:11264
s_waitcnt lgkmcnt(4)
v_mfma_f32_16x16x32_bf16 v[48:51], a[232:235], a[0:3], 0
buffer_load_dwordx4 a[176:179], v3, s[8:11], s28 offen offset:0 sc1
v_mfma_f32_16x16x32_bf16 v[48:51], a[236:239], a[4:7], v[48:51]
ds_read_b128 a[224:227], v2 offset:5120
v_add_u32 v16, s42, v14
v_mfma_f32_16x16x32_bf16 v[52:55], a[232:235], a[72:75], 0
s_and_b32 s42, s42, 512
s_add_u32 s42, s42, 147456
v_mfma_f32_16x16x32_bf16 v[52:55], a[236:239], a[76:79], v[52:55]
ds_read_b128 a[228:231], v2 offset:12288
s_waitcnt lgkmcnt(4)
v_mfma_f32_16x16x32_bf16 v[56:59], a[240:243], a[0:3], 0
buffer_load_dwordx4 a[36:39], v2, s[8:11], s26 offen offset:1024 sc1
v_mfma_f32_16x16x32_bf16 v[56:59], a[244:247], a[4:7], v[56:59]
ds_read_b128 a[232:235], v2 offset:6144
v_add_u32 v19, s42, v14
v_mfma_f32_16x16x32_bf16 v[60:63], a[240:243], a[72:75], 0
v_add_u32 v18, 150016, v14
v_mov_b32 v96, 0
v_mfma_f32_16x16x32_bf16 v[60:63], a[244:247], a[76:79], v[60:63]
ds_read_b128 a[236:239], v2 offset:13312
s_waitcnt lgkmcnt(4)
v_mfma_f32_16x16x32_bf16 v[64:67], a[216:219], a[0:3], 0
buffer_load_dwordx4 a[108:111], v2, s[8:11], s27 offen offset:1024 sc1
v_mfma_f32_16x16x32_bf16 v[64:67], a[220:223], a[4:7], v[64:67]
ds_read_b128 a[240:243], v6 offset:0
v_mov_b32 v97, 0
v_mfma_f32_16x16x32_bf16 v[68:71], a[216:219], a[72:75], 0
v_mov_b32 v100, 0
v_mov_b32 v101, 0
v_mfma_f32_16x16x32_bf16 v[68:71], a[220:223], a[76:79], v[68:71]
ds_read_b128 a[244:247], v6 offset:7168
s_waitcnt lgkmcnt(4)
v_mfma_f32_16x16x32_bf16 v[72:75], a[0:3], a[224:227], 0
buffer_load_dwordx4 a[180:183], v3, s[8:11], s28 offen offset:1024 sc1
v_mfma_f32_16x16x32_bf16 v[72:75], a[4:7], a[228:231], v[72:75]
ds_read_b128 a[216:219], v9 offset:0
v_and_b32 v13, 1, v1
v_mfma_f32_16x16x32_bf16 v[76:79], a[72:75], a[224:227], 0
v_lshlrev_b32 v13, 4, v13
v_mov_b32 v102, 0x3f80
v_mfma_f32_16x16x32_bf16 v[76:79], a[76:79], a[228:231], v[76:79]
ds_read_b128 a[220:223], v9 offset:7168
s_waitcnt lgkmcnt(4)
v_mfma_f32_16x16x32_bf16 v[80:83], a[0:3], a[232:235], 0
buffer_load_dwordx4 a[40:43], v2, s[8:11], s26 offen offset:2048 sc1
v_mfma_f32_16x16x32_bf16 v[80:83], a[4:7], a[236:239], v[80:83]
ds_read_b128 a[224:227], v2 offset:14336
v_lshlrev_b32 v13, v13, v102
v_mfma_f32_16x16x32_bf16 v[84:87], a[72:75], a[232:235], 0
v_lshrrev_b32 v102, 1, v1
v_cmp_eq_u32 vcc, 16, v102
v_mfma_f32_16x16x32_bf16 v[84:87], a[76:79], a[236:239], v[84:87]
ds_read_b128 a[228:231], v2 offset:21504
s_waitcnt lgkmcnt(4)
v_mfma_f32_16x16x32_bf16 v[88:91], a[240:243], a[144:147], 0
ds_read_b128 a[232:235], v2 offset:15360
buffer_load_dwordx4 a[112:115], v2, s[8:11], s27 offen offset:2048 sc1
v_mfma_f32_16x16x32_bf16 v[88:91], a[244:247], a[148:151], v[88:91]
ds_read_b128 a[236:239], v2 offset:22528
s_waitcnt lgkmcnt(4)
v_mfma_f32_16x16x32_bf16 v[92:95], a[144:147], a[216:219], 0
ds_read_b128 a[240:243], v2 offset:16384
v_cndmask_b32 v98, 0, v13, vcc
v_mfma_f32_16x16x32_bf16 v[92:95], a[148:151], a[220:223], v[92:95]
L_hop0:
s_cmp_eq_u32 s15, 1
s_cbranch_scc1 L_hop4
ds_read_b128 a[244:247], v2 offset:23552
s_waitcnt vmcnt(20)
s_waitcnt lgkmcnt(4)
v_mfma_f32_16x16x32_bf16 v[32:35], a[224:227], a[8:11], v[32:35]
buffer_load_dwordx4 a[184:187], v3, s[8:11], s28 offen offset:2048 sc1
v_mfma_f32_16x16x32_bf16 v[32:35], a[228:231], a[12:15], v[32:35]
ds_read_b128 a[216:219], v2 offset:17408
v_cmp_eq_u32 vcc, 17, v102
v_mfma_f32_16x16x32_bf16 v[36:39], a[224:227], a[80:83], v[36:39]
s_nop 0
v_cndmask_b32 v99, 0, v13, vcc
v_add_u32 v17, 16, v12
v_mfma_f32_16x16x32_bf16 v[36:39], a[228:231], a[84:87], v[36:39]
ds_read_b128 a[220:223], v2 offset:24576
s_waitcnt lgkmcnt(4)
v_mfma_f32_16x16x32_bf16 v[40:43], a[232:235], a[8:11], v[40:43]
buffer_load_dwordx4 a[44:47], v2, s[8:11], s26 offen offset:3072 sc1
v_mfma_f32_16x16x32_bf16 v[40:43], a[236:239], a[12:15], v[40:43]
ds_read_b128 a[224:227], v2 offset:18432
v_cmp_gt_u32 vcc, 16, v1
v_mfma_f32_16x16x32_bf16 v[44:47], a[232:235], a[80:83], v[44:47]
v_add_u32 v14, 48, v12
s_mov_b32 s34, 0x3eae1a93
v_mfma_f32_16x16x32_bf16 v[44:47], a[236:239], a[84:87], v[44:47]
ds_read_b128 a[228:231], v2 offset:25600
s_waitcnt lgkmcnt(4)
v_mfma_f32_16x16x32_bf16 v[48:51], a[240:243], a[8:11], v[48:51]
buffer_load_dwordx4 a[116:119], v2, s[8:11], s27 offen offset:3072 sc1
v_mfma_f32_16x16x32_bf16 v[48:51], a[244:247], a[12:15], v[48:51]
ds_read_b128 a[232:235], v2 offset:19456
v_cndmask_b32 v17, v14, v17, vcc
v_mfma_f32_16x16x32_bf16 v[52:55], a[240:243], a[80:83], v[52:55]
v_lshlrev_b32 v17, 3, v17
v_add_u32 v17, s41, v17
v_mfma_f32_16x16x32_bf16 v[52:55], a[244:247], a[84:87], v[52:55]
ds_read_b128 a[236:239], v2 offset:26624
s_waitcnt lgkmcnt(4)
v_mfma_f32_16x16x32_bf16 v[56:59], a[216:219], a[8:11], v[56:59]
buffer_load_dwordx4 a[188:191], v3, s[8:11], s28 offen offset:3072 sc1
v_mfma_f32_16x16x32_bf16 v[56:59], a[220:223], a[12:15], v[56:59]
ds_read_b128 a[240:243], v2 offset:20480
v_mfma_f32_16x16x32_bf16 v[60:63], a[216:219], a[80:83], v[60:63]
v_mfma_f32_16x16x32_bf16 v[60:63], a[220:223], a[84:87], v[60:63]
ds_read_b128 a[244:247], v2 offset:27648
s_waitcnt lgkmcnt(4)
v_mfma_f32_16x16x32_bf16 v[64:67], a[224:227], a[8:11], v[64:67]
s_add_u32 s26, s26, 4096
s_add_u32 s27, s27, 4096
s_add_u32 s28, s28, 4096
buffer_load_dwordx4 a[48:51], v2, s[8:11], s26 offen offset:0 sc1
v_mfma_f32_16x16x32_bf16 v[64:67], a[228:231], a[12:15], v[64:67]
ds_read_b128 a[216:219], v6 offset:14336
v_mfma_f32_16x16x32_bf16 v[68:71], a[224:227], a[80:83], v[68:71]
v_mfma_f32_16x16x32_bf16 v[68:71], a[228:231], a[84:87], v[68:71]
ds_read_b128 a[220:223], v6 offset:21504
s_waitcnt lgkmcnt(4)
v_mfma_f32_16x16x32_bf16 v[72:75], a[8:11], a[232:235], v[72:75]
buffer_load_dwordx4 a[120:123], v2, s[8:11], s27 offen offset:0 sc1
v_mfma_f32_16x16x32_bf16 v[72:75], a[12:15], a[236:239], v[72:75]
ds_read_b128 a[224:227], v9 offset:14336
v_mfma_f32_16x16x32_bf16 v[76:79], a[80:83], a[232:235], v[76:79]
v_mfma_f32_16x16x32_bf16 v[76:79], a[84:87], a[236:239], v[76:79]
ds_read_b128 a[228:231], v9 offset:21504
s_waitcnt lgkmcnt(4)
v_mfma_f32_16x16x32_bf16 v[80:83], a[8:11], a[240:243], v[80:83]
buffer_load_dwordx4 a[192:195], v3, s[8:11], s28 offen offset:0 sc1
v_mfma_f32_16x16x32_bf16 v[80:83], a[12:15], a[244:247], v[80:83]
ds_read_b128 a[232:235], v2 offset:28672
v_mfma_f32_16x16x32_bf16 v[84:87], a[80:83], a[240:243], v[84:87]
v_mfma_f32_16x16x32_bf16 v[84:87], a[84:87], a[244:247], v[84:87]
ds_read_b128 a[236:239], v2 offset:35840
s_waitcnt lgkmcnt(4)
v_mfma_f32_16x16x32_bf16 v[88:91], a[216:219], a[152:155], v[88:91]
ds_read_b128 a[240:243], v2 offset:29696
buffer_load_dwordx4 a[52:55], v2, s[8:11], s26 offen offset:1024 sc1
v_mfma_f32_16x16x32_bf16 v[88:91], a[220:223], a[156:159], v[88:91]
ds_read_b128 a[244:247], v2 offset:36864
s_waitcnt lgkmcnt(4)
v_mfma_f32_16x16x32_bf16 v[92:95], a[152:155], a[224:227], v[92:95]
ds_read_b128 a[216:219], v2 offset:30720
v_mfma_f32_16x16x32_bf16 v[92:95], a[156:159], a[228:231], v[92:95]
ds_read_b128 a[220:223], v2 offset:37888
s_waitcnt vmcnt(22)
s_waitcnt lgkmcnt(4)
v_mfma_f32_16x16x32_bf16 v[32:35], a[232:235], a[16:19], v[32:35]
buffer_load_dwordx4 a[124:127], v2, s[8:11], s27 offen offset:1024 sc1
v_mfma_f32_16x16x32_bf16 v[32:35], a[236:239], a[20:23], v[32:35]
ds_read_b128 a[224:227], v2 offset:31744
v_mfma_f32_16x16x32_bf16 v[36:39], a[232:235], a[88:91], v[36:39]
v_mfma_f32_16x16x32_bf16 v[36:39], a[236:239], a[92:95], v[36:39]
ds_read_b128 a[228:231], v2 offset:38912
s_waitcnt lgkmcnt(4)
v_mfma_f32_16x16x32_bf16 v[40:43], a[240:243], a[16:19], v[40:43]
buffer_load_dwordx4 a[196:199], v3, s[8:11], s28 offen offset:1024 sc1
v_mfma_f32_16x16x32_bf16 v[40:43], a[244:247], a[20:23], v[40:43]
ds_read_b128 a[232:235], v2 offset:32768
v_mfma_f32_16x16x32_bf16 v[44:47], a[240:243], a[88:91], v[44:47]
v_mfma_f32_16x16x32_bf16 v[44:47], a[244:247], a[92:95], v[44:47]
ds_read_b128 a[236:239], v2 offset:39936
s_waitcnt lgkmcnt(4)
v_mfma_f32_16x16x32_bf16 v[48:51], a[216:219], a[16:19], v[48:51]
buffer_load_dwordx4 a[56:59], v2, s[8:11], s26 offen offset:2048 sc1
v_mfma_f32_16x16x32_bf16 v[48:51], a[220:223], a[20:23], v[48:51]
ds_read_b128 a[240:243], v2 offset:33792
v_mfma_f32_16x16x32_bf16 v[52:55], a[216:219], a[88:91], v[52:55]
v_mfma_f32_16x16x32_bf16 v[52:55], a[220:223], a[92:95], v[52:55]
ds_read_b128 a[244:247], v2 offset:40960
s_waitcnt lgkmcnt(4)
v_mfma_f32_16x16x32_bf16 v[56:59], a[224:227], a[16:19], v[56:59]
buffer_load_dwordx4 a[128:131], v2, s[8:11], s27 offen offset:2048 sc1
v_mfma_f32_16x16x32_bf16 v[56:59], a[228:231], a[20:23], v[56:59]
ds_read_b128 a[216:219], v2 offset:34816
v_mfma_f32_16x16x32_bf16 v[60:63], a[224:227], a[88:91], v[60:63]
v_mfma_f32_16x16x32_bf16 v[60:63], a[228:231], a[92:95], v[60:63]
ds_read_b128 a[220:223], v2 offset:41984
s_waitcnt lgkmcnt(4)
v_mfma_f32_16x16x32_bf16 v[64:67], a[232:235], a[16:19], v[64:67]
buffer_load_dwordx4 a[200:203], v3, s[8:11], s28 offen offset:2048 sc1
v_mfma_f32_16x16x32_bf16 v[64:67], a[236:239], a[20:23], v[64:67]
ds_read_b128 a[224:227], v6 offset:28672
v_mfma_f32_16x16x32_bf16 v[68:71], a[232:235], a[88:91], v[68:71]
v_mfma_f32_16x16x32_bf16 v[68:71], a[236:239], a[92:95], v[68:71]
ds_read_b128 a[228:231], v6 offset:35840
s_waitcnt lgkmcnt(4)
v_mfma_f32_16x16x32_bf16 v[72:75], a[16:19], a[240:243], v[72:75]
buffer_load_dwordx4 a[60:63], v2, s[8:11], s26 offen offset:3072 sc1
v_mfma_f32_16x16x32_bf16 v[72:75], a[20:23], a[244:247], v[72:75]
ds_read_b128 a[232:235], v9 offset:28672
v_mfma_f32_16x16x32_bf16 v[76:79], a[88:91], a[240:243], v[76:79]
v_mfma_f32_16x16x32_bf16 v[76:79], a[92:95], a[244:247], v[76:79]
ds_read_b128 a[236:239], v9 offset:35840
s_waitcnt lgkmcnt(4)
v_mfma_f32_16x16x32_bf16 v[80:83], a[16:19], a[216:219], v[80:83]
buffer_load_dwordx4 a[132:135], v2, s[8:11], s27 offen offset:3072 sc1
v_mfma_f32_16x16x32_bf16 v[80:83], a[20:23], a[220:223], v[80:83]
ds_read_b128 a[240:243], v2 offset:43008
v_mfma_f32_16x16x32_bf16 v[84:87], a[88:91], a[216:219], v[84:87]
v_mfma_f32_16x16x32_bf16 v[84:87], a[92:95], a[220:223], v[84:87]
ds_read_b128 a[244:247], v2 offset:50176
s_waitcnt lgkmcnt(4)
v_mfma_f32_16x16x32_bf16 v[88:91], a[224:227], a[160:163], v[88:91]
ds_read_b128 a[216:219], v2 offset:44032
buffer_load_dwordx4 a[204:207], v3, s[8:11], s28 offen offset:3072 sc1
v_mfma_f32_16x16x32_bf16 v[88:91], a[228:231], a[164:167], v[88:91]
ds_read_b128 a[220:223], v2 offset:51200
s_waitcnt lgkmcnt(4)
v_mfma_f32_16x16x32_bf16 v[92:95], a[160:163], a[232:235], v[92:95]
ds_read_b128 a[224:227], v2 offset:45056
v_mfma_f32_16x16x32_bf16 v[92:95], a[164:167], a[236:239], v[92:95]
ds_read_b128 a[228:231], v2 offset:52224
s_waitcnt vmcnt(24)
s_waitcnt lgkmcnt(4)
v_mfma_f32_16x16x32_bf16 v[32:35], a[240:243], a[24:27], v[32:35]
s_add_u32 s26, s26, 4096
s_add_u32 s27, s27, 4096
s_add_u32 s28, s28, 4096
buffer_load_dwordx4 a[64:67], v2, s[8:11], s26 offen offset:0 sc1
v_mfma_f32_16x16x32_bf16 v[32:35], a[244:247], a[28:31], v[32:35]
ds_read_b128 a[232:235], v2 offset:46080
v_mfma_f32_16x16x32_bf16 v[36:39], a[240:243], a[96:99], v[36:39]
v_mfma_f32_16x16x32_bf16 v[36:39], a[244:247], a[100:103], v[36:39]
ds_read_b128 a[236:239], v2 offset:53248
s_waitcnt lgkmcnt(4)
v_mfma_f32_16x16x32_bf16 v[40:43], a[216:219], a[24:27], v[40:43]
buffer_load_dwordx4 a[136:139], v2, s[8:11], s27 offen offset:0 sc1
v_mfma_f32_16x16x32_bf16 v[40:43], a[220:223], a[28:31], v[40:43]
ds_read_b128 a[240:243], v2 offset:47104
v_mfma_f32_16x16x32_bf16 v[44:47], a[216:219], a[96:99], v[44:47]
v_mfma_f32_16x16x32_bf16 v[44:47], a[220:223], a[100:103], v[44:47]
ds_read_b128 a[244:247], v2 offset:54272
s_waitcnt lgkmcnt(4)
v_mfma_f32_16x16x32_bf16 v[48:51], a[224:227], a[24:27], v[48:51]
buffer_load_dwordx4 a[208:211], v3, s[8:11], s28 offen offset:0 sc1
v_mfma_f32_16x16x32_bf16 v[48:51], a[228:231], a[28:31], v[48:51]
ds_read_b128 a[216:219], v2 offset:48128
v_mfma_f32_16x16x32_bf16 v[52:55], a[224:227], a[96:99], v[52:55]
v_mfma_f32_16x16x32_bf16 v[52:55], a[228:231], a[100:103], v[52:55]
ds_read_b128 a[220:223], v2 offset:55296
s_waitcnt lgkmcnt(4)
v_mfma_f32_16x16x32_bf16 v[56:59], a[232:235], a[24:27], v[56:59]
buffer_load_dwordx4 a[68:71], v2, s[8:11], s26 offen offset:1024 sc1
v_mfma_f32_16x16x32_bf16 v[56:59], a[236:239], a[28:31], v[56:59]
ds_read_b128 a[224:227], v2 offset:49152
v_mfma_f32_16x16x32_bf16 v[60:63], a[232:235], a[96:99], v[60:63]
v_mfma_f32_16x16x32_bf16 v[60:63], a[236:239], a[100:103], v[60:63]
ds_read_b128 a[228:231], v2 offset:56320
s_waitcnt lgkmcnt(4)
v_mfma_f32_16x16x32_bf16 v[64:67], a[240:243], a[24:27], v[64:67]
buffer_load_dwordx4 a[140:143], v2, s[8:11], s27 offen offset:1024 sc1
v_mfma_f32_16x16x32_bf16 v[64:67], a[244:247], a[28:31], v[64:67]
ds_read_b128 a[232:235], v6 offset:43008
v_mfma_f32_16x16x32_bf16 v[68:71], a[240:243], a[96:99], v[68:71]
v_mfma_f32_16x16x32_bf16 v[68:71], a[244:247], a[100:103], v[68:71]
ds_read_b128 a[236:239], v6 offset:50176
s_waitcnt lgkmcnt(4)
v_mfma_f32_16x16x32_bf16 v[72:75], a[24:27], a[216:219], v[72:75]
buffer_load_dwordx4 a[212:215], v3, s[8:11], s28 offen offset:1024 sc1
v_mfma_f32_16x16x32_bf16 v[72:75], a[28:31], a[220:223], v[72:75]
ds_read_b128 a[240:243], v9 offset:43008
v_mfma_f32_16x16x32_bf16 v[76:79], a[96:99], a[216:219], v[76:79]
v_mfma_f32_16x16x32_bf16 v[76:79], a[100:103], a[220:223], v[76:79]
ds_read_b128 a[244:247], v9 offset:50176
s_waitcnt lgkmcnt(4)
v_mfma_f32_16x16x32_bf16 v[80:83], a[24:27], a[224:227], v[80:83]
buffer_store_dwordx4 v[176:179], v156, s[8:11], 0 offen sc1
v_mfma_f32_16x16x32_bf16 v[80:83], a[28:31], a[228:231], v[80:83]
ds_read_b128 a[216:219], v2 offset:57344
v_mfma_f32_16x16x32_bf16 v[84:87], a[96:99], a[224:227], v[84:87]
v_mfma_f32_16x16x32_bf16 v[84:87], a[100:103], a[228:231], v[84:87]
ds_read_b128 a[220:223], v2 offset:64512
s_waitcnt lgkmcnt(4)
v_mfma_f32_16x16x32_bf16 v[88:91], a[232:235], a[168:171], v[88:91]
ds_read_b128 a[224:227], v2 offset:58368
v_mfma_f32_16x16x32_bf16 v[88:91], a[236:239], a[172:175], v[88:91]
ds_read_b128 a[228:231], v4 offset:0
s_waitcnt lgkmcnt(4)
v_mfma_f32_16x16x32_bf16 v[92:95], a[168:171], a[240:243], v[92:95]
ds_read_b128 a[232:235], v2 offset:59392
buffer_store_dwordx4 v[180:183], v157, s[8:11], 0 offen sc1
v_mfma_f32_16x16x32_bf16 v[92:95], a[172:175], a[244:247], v[92:95]
ds_read_b128 a[236:239], v4 offset:1024
s_waitcnt vmcnt(26)
s_waitcnt lgkmcnt(4)
v_mfma_f32_16x16x32_bf16 v[32:35], a[216:219], a[32:35], v[32:35]
v_mfma_f32_16x16x32_bf16 v[32:35], a[220:223], a[36:39], v[32:35]
ds_read_b128 a[240:243], v2 offset:60416
v_mfma_f32_16x16x32_bf16 v[36:39], a[216:219], a[104:107], v[36:39]
v_mfma_f32_16x16x32_bf16 v[36:39], a[220:223], a[108:111], v[36:39]
ds_read_b128 a[244:247], v4 offset:2048
s_waitcnt lgkmcnt(4)
v_mfma_f32_16x16x32_bf16 v[40:43], a[224:227], a[32:35], v[40:43]
buffer_store_dwordx4 v[184:187], v158, s[8:11], 0 offen sc1
v_mfma_f32_16x16x32_bf16 v[40:43], a[228:231], a[36:39], v[40:43]
ds_read_b128 a[216:219], v2 offset:61440
v_mfma_f32_16x16x32_bf16 v[44:47], a[224:227], a[104:107], v[44:47]
v_mfma_f32_16x16x32_bf16 v[44:47], a[228:231], a[108:111], v[44:47]
ds_read_b128 a[220:223], v4 offset:3072
s_waitcnt lgkmcnt(4)
v_mfma_f32_16x16x32_bf16 v[48:51], a[232:235], a[32:35], v[48:51]
v_mfma_f32_16x16x32_bf16 v[48:51], a[236:239], a[36:39], v[48:51]
ds_read_b128 a[224:227], v2 offset:62464
v_mfma_f32_16x16x32_bf16 v[52:55], a[232:235], a[104:107], v[52:55]
buffer_store_dwordx4 v[188:191], v159, s[8:11], 0 offen sc1
v_mfma_f32_16x16x32_bf16 v[52:55], a[236:239], a[108:111], v[52:55]
ds_read_b128 a[228:231], v4 offset:4096
s_waitcnt lgkmcnt(4)
v_mfma_f32_16x16x32_bf16 v[56:59], a[240:243], a[32:35], v[56:59]
v_mfma_f32_16x16x32_bf16 v[56:59], a[244:247], a[36:39], v[56:59]
ds_read_b128 a[232:235], v2 offset:63488
v_mfma_f32_16x16x32_bf16 v[60:63], a[240:243], a[104:107], v[60:63]
v_mfma_f32_16x16x32_bf16 v[60:63], a[244:247], a[108:111], v[60:63]
ds_read_b128 a[236:239], v4 offset:5120
s_waitcnt lgkmcnt(4)
v_mfma_f32_16x16x32_bf16 v[64:67], a[216:219], a[32:35], v[64:67]
buffer_store_dwordx4 v[192:195], v160, s[8:11], 0 offen sc1
v_mfma_f32_16x16x32_bf16 v[64:67], a[220:223], a[36:39], v[64:67]
ds_read_b128 a[240:243], v6 offset:57344
v_mfma_f32_16x16x32_bf16 v[68:71], a[216:219], a[104:107], v[68:71]
v_mfma_f32_16x16x32_bf16 v[68:71], a[220:223], a[108:111], v[68:71]
ds_read_b128 a[244:247], v6 offset:64512
s_waitcnt lgkmcnt(4)
v_mfma_f32_16x16x32_bf16 v[72:75], a[32:35], a[224:227], v[72:75]
v_mfma_f32_16x16x32_bf16 v[72:75], a[36:39], a[228:231], v[72:75]
ds_read_b128 a[216:219], v9 offset:57344
v_mfma_f32_16x16x32_bf16 v[76:79], a[104:107], a[224:227], v[76:79]
buffer_store_dwordx4 v[196:199], v161, s[8:11], 0 offen sc1
v_mfma_f32_16x16x32_bf16 v[76:79], a[108:111], a[228:231], v[76:79]
ds_read_b128 a[220:223], v9 offset:64512
s_waitcnt lgkmcnt(4)
v_mfma_f32_16x16x32_bf16 v[80:83], a[32:35], a[232:235], v[80:83]
v_mfma_f32_16x16x32_bf16 v[80:83], a[36:39], a[236:239], v[80:83]
ds_read_b128 a[224:227], v4 offset:6144
v_mfma_f32_16x16x32_bf16 v[84:87], a[104:107], a[232:235], v[84:87]
v_mfma_f32_16x16x32_bf16 v[84:87], a[108:111], a[236:239], v[84:87]
ds_read_b128 a[228:231], v4 offset:13312
s_waitcnt lgkmcnt(4)
v_mfma_f32_16x16x32_bf16 v[88:91], a[240:243], a[176:179], v[88:91]
ds_read_b128 a[232:235], v4 offset:7168
buffer_store_dwordx4 v[200:203], v162, s[8:11], 0 offen sc1
v_mfma_f32_16x16x32_bf16 v[88:91], a[244:247], a[180:183], v[88:91]
ds_read_b128 a[236:239], v4 offset:14336
s_waitcnt lgkmcnt(4)
v_mfma_f32_16x16x32_bf16 v[92:95], a[176:179], a[216:219], v[92:95]
ds_read_b128 a[240:243], v4 offset:8192
v_mfma_f32_16x16x32_bf16 v[92:95], a[180:183], a[220:223], v[92:95]
ds_read_b128 a[244:247], v4 offset:15360
s_waitcnt vmcnt(25)
s_waitcnt lgkmcnt(4)
v_mfma_f32_16x16x32_bf16 v[32:35], a[224:227], a[40:43], v[32:35]
v_mfma_f32_16x16x32_bf16 v[32:35], a[228:231], a[44:47], v[32:35]
ds_read_b128 a[216:219], v4 offset:9216
v_mfma_f32_16x16x32_bf16 v[36:39], a[224:227], a[112:115], v[36:39]
buffer_store_dwordx4 v[204:207], v163, s[8:11], 0 offen sc1
v_mfma_f32_16x16x32_bf16 v[36:39], a[228:231], a[116:119], v[36:39]
ds_read_b128 a[220:223], v4 offset:16384
s_waitcnt lgkmcnt(4)
v_mfma_f32_16x16x32_bf16 v[40:43], a[232:235], a[40:43], v[40:43]
v_mfma_f32_16x16x32_bf16 v[40:43], a[236:239], a[44:47], v[40:43]
ds_read_b128 a[224:227], v4 offset:10240
v_mfma_f32_16x16x32_bf16 v[44:47], a[232:235], a[112:115], v[44:47]
v_mfma_f32_16x16x32_bf16 v[44:47], a[236:239], a[116:119], v[44:47]
ds_read_b128 a[228:231], v4 offset:17408
s_waitcnt lgkmcnt(4)
v_mfma_f32_16x16x32_bf16 v[48:51], a[240:243], a[40:43], v[48:51]
buffer_store_dwordx4 v[208:211], v164, s[8:11], 0 offen sc1
v_mfma_f32_16x16x32_bf16 v[48:51], a[244:247], a[44:47], v[48:51]
ds_read_b128 a[232:235], v4 offset:11264
v_mfma_f32_16x16x32_bf16 v[52:55], a[240:243], a[112:115], v[52:55]
v_mfma_f32_16x16x32_bf16 v[52:55], a[244:247], a[116:119], v[52:55]
ds_read_b128 a[236:239], v4 offset:18432
s_waitcnt lgkmcnt(4)
v_mfma_f32_16x16x32_bf16 v[56:59], a[216:219], a[40:43], v[56:59]
v_mfma_f32_16x16x32_bf16 v[56:59], a[220:223], a[44:47], v[56:59]
ds_read_b128 a[240:243], v4 offset:12288
v_mfma_f32_16x16x32_bf16 v[60:63], a[216:219], a[112:115], v[60:63]
buffer_store_dwordx4 v[212:215], v165, s[8:11], 0 offen sc1
v_mfma_f32_16x16x32_bf16 v[60:63], a[220:223], a[116:119], v[60:63]
ds_read_b128 a[244:247], v4 offset:19456
s_waitcnt lgkmcnt(4)
v_mfma_f32_16x16x32_bf16 v[64:67], a[224:227], a[40:43], v[64:67]
v_mfma_f32_16x16x32_bf16 v[64:67], a[228:231], a[44:47], v[64:67]
ds_read_b128 a[216:219], v7 offset:6144
v_mfma_f32_16x16x32_bf16 v[68:71], a[224:227], a[112:115], v[68:71]
v_mfma_f32_16x16x32_bf16 v[68:71], a[228:231], a[116:119], v[68:71]
ds_read_b128 a[220:223], v7 offset:13312
s_waitcnt lgkmcnt(4)
v_mfma_f32_16x16x32_bf16 v[72:75], a[40:43], a[232:235], v[72:75]
buffer_store_dwordx4 v[216:219], v166, s[8:11], 0 offen sc1
v_mfma_f32_16x16x32_bf16 v[72:75], a[44:47], a[236:239], v[72:75]
ds_read_b128 a[224:227], v10 offset:6144
v_mfma_f32_16x16x32_bf16 v[76:79], a[112:115], a[232:235], v[76:79]
v_mfma_f32_16x16x32_bf16 v[76:79], a[116:119], a[236:239], v[76:79]
ds_read_b128 a[228:231], v10 offset:13312
s_waitcnt lgkmcnt(4)
v_mfma_f32_16x16x32_bf16 v[80:83], a[40:43], a[240:243], v[80:83]
v_mfma_f32_16x16x32_bf16 v[80:83], a[44:47], a[244:247], v[80:83]
ds_read_b128 a[232:235], v4 offset:20480
v_mfma_f32_16x16x32_bf16 v[84:87], a[112:115], a[240:243], v[84:87]
buffer_store_dwordx4 v[220:223], v167, s[8:11], 0 offen sc1
v_mfma_f32_16x16x32_bf16 v[84:87], a[116:119], a[244:247], v[84:87]
ds_read_b128 a[236:239], v4 offset:27648
s_waitcnt lgkmcnt(4)
v_mfma_f32_16x16x32_bf16 v[88:91], a[216:219], a[184:187], v[88:91]
ds_read_b128 a[240:243], v4 offset:21504
v_mfma_f32_16x16x32_bf16 v[88:91], a[220:223], a[188:191], v[88:91]
ds_read_b128 a[244:247], v4 offset:28672
s_waitcnt lgkmcnt(4)
v_mfma_f32_16x16x32_bf16 v[92:95], a[184:187], a[224:227], v[92:95]
ds_read_b128 a[216:219], v4 offset:22528
v_mfma_f32_16x16x32_bf16 v[92:95], a[188:191], a[228:231], v[92:95]
ds_read_b128 a[220:223], v4 offset:29696
s_waitcnt vmcnt(24)
s_waitcnt lgkmcnt(4)
v_mfma_f32_16x16x32_bf16 v[32:35], a[232:235], a[48:51], v[32:35]
buffer_store_dwordx4 v[224:227], v168, s[8:11], 0 offen sc1
v_mfma_f32_16x16x32_bf16 v[32:35], a[236:239], a[52:55], v[32:35]
ds_read_b128 a[224:227], v4 offset:23552
v_mfma_f32_16x16x32_bf16 v[36:39], a[232:235], a[120:123], v[36:39]
v_mfma_f32_16x16x32_bf16 v[36:39], a[236:239], a[124:127], v[36:39]
ds_read_b128 a[228:231], v4 offset:30720
s_waitcnt lgkmcnt(4)
v_mfma_f32_16x16x32_bf16 v[40:43], a[240:243], a[48:51], v[40:43]
v_mfma_f32_16x16x32_bf16 v[40:43], a[244:247], a[52:55], v[40:43]
ds_read_b128 a[232:235], v4 offset:24576
v_mfma_f32_16x16x32_bf16 v[44:47], a[240:243], a[120:123], v[44:47]
buffer_store_dwordx4 v[228:231], v169, s[8:11], 0 offen sc1
v_mfma_f32_16x16x32_bf16 v[44:47], a[244:247], a[124:127], v[44:47]
ds_read_b128 a[236:239], v4 offset:31744
s_waitcnt lgkmcnt(4)
v_mfma_f32_16x16x32_bf16 v[48:51], a[216:219], a[48:51], v[48:51]
v_mfma_f32_16x16x32_bf16 v[48:51], a[220:223], a[52:55], v[48:51]
ds_read_b128 a[240:243], v4 offset:25600
v_mfma_f32_16x16x32_bf16 v[52:55], a[216:219], a[120:123], v[52:55]
v_mfma_f32_16x16x32_bf16 v[52:55], a[220:223], a[124:127], v[52:55]
ds_read_b128 a[244:247], v4 offset:32768
s_waitcnt lgkmcnt(4)
v_mfma_f32_16x16x32_bf16 v[56:59], a[224:227], a[48:51], v[56:59]
buffer_store_dwordx4 v[232:235], v170, s[8:11], 0 offen sc1
v_mfma_f32_16x16x32_bf16 v[56:59], a[228:231], a[52:55], v[56:59]
ds_read_b128 a[216:219], v4 offset:26624
v_mfma_f32_16x16x32_bf16 v[60:63], a[224:227], a[120:123], v[60:63]
v_mfma_f32_16x16x32_bf16 v[60:63], a[228:231], a[124:127], v[60:63]
ds_read_b128 a[220:223], v4 offset:33792
s_waitcnt lgkmcnt(4)
v_mfma_f32_16x16x32_bf16 v[64:67], a[232:235], a[48:51], v[64:67]
v_mfma_f32_16x16x32_bf16 v[64:67], a[236:239], a[52:55], v[64:67]
ds_read_b128 a[224:227], v7 offset:20480
v_mfma_f32_16x16x32_bf16 v[68:71], a[232:235], a[120:123], v[68:71]
buffer_store_dwordx4 v[236:239], v171, s[8:11], 0 offen sc1
v_mfma_f32_16x16x32_bf16 v[68:71], a[236:239], a[124:127], v[68:71]
ds_read_b128 a[228:231], v7 offset:27648
s_waitcnt lgkmcnt(4)
v_mfma_f32_16x16x32_bf16 v[72:75], a[48:51], a[240:243], v[72:75]
v_mfma_f32_16x16x32_bf16 v[72:75], a[52:55], a[244:247], v[72:75]
ds_read_b128 a[232:235], v10 offset:20480
v_mfma_f32_16x16x32_bf16 v[76:79], a[120:123], a[240:243], v[76:79]
v_mfma_f32_16x16x32_bf16 v[76:79], a[124:127], a[244:247], v[76:79]
ds_read_b128 a[236:239], v10 offset:27648
s_waitcnt lgkmcnt(4)
v_mfma_f32_16x16x32_bf16 v[80:83], a[48:51], a[216:219], v[80:83]
buffer_store_dwordx4 v[240:243], v172, s[8:11], 0 offen sc1
v_mfma_f32_16x16x32_bf16 v[80:83], a[52:55], a[220:223], v[80:83]
ds_read_b128 a[240:243], v4 offset:34816
v_mfma_f32_16x16x32_bf16 v[84:87], a[120:123], a[216:219], v[84:87]
v_mfma_f32_16x16x32_bf16 v[84:87], a[124:127], a[220:223], v[84:87]
ds_read_b128 a[244:247], v4 offset:41984
s_waitcnt lgkmcnt(4)
v_mfma_f32_16x16x32_bf16 v[88:91], a[224:227], a[192:195], v[88:91]
ds_read_b128 a[216:219], v4 offset:35840
v_mfma_f32_16x16x32_bf16 v[88:91], a[228:231], a[196:199], v[88:91]
ds_read_b128 a[220:223], v4 offset:43008
s_waitcnt lgkmcnt(4)
v_mfma_f32_16x16x32_bf16 v[92:95], a[192:195], a[232:235], v[92:95]
ds_read_b128 a[224:227], v4 offset:36864
buffer_store_dwordx4 v[244:247], v173, s[8:11], 0 offen sc1
v_mfma_f32_16x16x32_bf16 v[92:95], a[196:199], a[236:239], v[92:95]
ds_read_b128 a[228:231], v4 offset:44032
s_waitcnt vmcnt(24)
s_waitcnt lgkmcnt(4)
v_mfma_f32_16x16x32_bf16 v[32:35], a[240:243], a[56:59], v[32:35]
v_mfma_f32_16x16x32_bf16 v[32:35], a[244:247], a[60:63], v[32:35]
ds_read_b128 a[232:235], v4 offset:37888
v_mfma_f32_16x16x32_bf16 v[36:39], a[240:243], a[128:131], v[36:39]
v_mfma_f32_16x16x32_bf16 v[36:39], a[244:247], a[132:135], v[36:39]
ds_read_b128 a[236:239], v4 offset:45056
s_waitcnt lgkmcnt(4)
v_mfma_f32_16x16x32_bf16 v[40:43], a[216:219], a[56:59], v[40:43]
buffer_store_dwordx4 v[248:251], v174, s[8:11], 0 offen sc1
v_mfma_f32_16x16x32_bf16 v[40:43], a[220:223], a[60:63], v[40:43]
ds_read_b128 a[240:243], v4 offset:38912
v_mfma_f32_16x16x32_bf16 v[44:47], a[216:219], a[128:131], v[44:47]
v_mfma_f32_16x16x32_bf16 v[44:47], a[220:223], a[132:135], v[44:47]
ds_read_b128 a[244:247], v4 offset:46080
s_waitcnt lgkmcnt(4)
v_mfma_f32_16x16x32_bf16 v[48:51], a[224:227], a[56:59], v[48:51]
v_mfma_f32_16x16x32_bf16 v[48:51], a[228:231], a[60:63], v[48:51]
ds_read_b128 a[216:219], v4 offset:39936
v_mfma_f32_16x16x32_bf16 v[52:55], a[224:227], a[128:131], v[52:55]
buffer_store_dwordx4 v[252:255], v175, s[8:11], 0 offen sc1
v_mfma_f32_16x16x32_bf16 v[52:55], a[228:231], a[132:135], v[52:55]
ds_read_b128 a[220:223], v4 offset:47104
s_waitcnt lgkmcnt(4)
v_mfma_f32_16x16x32_bf16 v[56:59], a[232:235], a[56:59], v[56:59]
v_mfma_f32_16x16x32_bf16 v[56:59], a[236:239], a[60:63], v[56:59]
ds_read_b128 a[224:227], v4 offset:40960
v_mfma_f32_16x16x32_bf16 v[60:63], a[232:235], a[128:131], v[60:63]
v_mfma_f32_16x16x32_bf16 v[60:63], a[236:239], a[132:135], v[60:63]
ds_read_b128 a[228:231], v4 offset:48128
s_waitcnt lgkmcnt(4)
v_mfma_f32_16x16x32_bf16 v[64:67], a[240:243], a[56:59], v[64:67]
v_mfma_f32_16x16x32_bf16 v[64:67], a[244:247], a[60:63], v[64:67]
ds_read_b128 a[232:235], v7 offset:34816
v_mfma_f32_16x16x32_bf16 v[68:71], a[240:243], a[128:131], v[68:71]
v_mfma_f32_16x16x32_bf16 v[68:71], a[244:247], a[132:135], v[68:71]
ds_read_b128 a[236:239], v7 offset:41984
s_waitcnt lgkmcnt(4)
v_mfma_f32_16x16x32_bf16 v[72:75], a[56:59], a[216:219], v[72:75]
v_mfma_f32_16x16x32_bf16 v[72:75], a[60:63], a[220:223], v[72:75]
ds_read_b128 a[240:243], v10 offset:34816
v_mfma_f32_16x16x32_bf16 v[76:79], a[128:131], a[216:219], v[76:79]
v_mfma_f32_16x16x32_bf16 v[76:79], a[132:135], a[220:223], v[76:79]
ds_read_b128 a[244:247], v10 offset:41984
s_waitcnt lgkmcnt(4)
v_mfma_f32_16x16x32_bf16 v[80:83], a[56:59], a[224:227], v[80:83]
v_mfma_f32_16x16x32_bf16 v[80:83], a[60:63], a[228:231], v[80:83]
ds_read_b128 a[216:219], v4 offset:49152
v_mfma_f32_16x16x32_bf16 v[84:87], a[128:131], a[224:227], v[84:87]
v_mfma_f32_16x16x32_bf16 v[84:87], a[132:135], a[228:231], v[84:87]
ds_read_b128 a[220:223], v4 offset:56320
s_waitcnt lgkmcnt(4)
v_mfma_f32_16x16x32_bf16 v[88:91], a[232:235], a[200:203], v[88:91]
ds_read_b128 a[224:227], v4 offset:50176
v_mfma_f32_16x16x32_bf16 v[88:91], a[236:239], a[204:207], v[88:91]
ds_read_b128 a[228:231], v4 offset:57344
s_waitcnt lgkmcnt(4)
v_mfma_f32_16x16x32_bf16 v[92:95], a[200:203], a[240:243], v[92:95]
ds_read_b128 a[232:235], v4 offset:51200
v_mfma_f32_16x16x32_bf16 v[92:95], a[204:207], a[244:247], v[92:95]
ds_read_b128 a[236:239], v4 offset:58368
s_waitcnt vmcnt(20)
s_waitcnt lgkmcnt(4)
v_mfma_f32_16x16x32_bf16 v[32:35], a[216:219], a[64:67], v[32:35]
v_mfma_f32_16x16x32_bf16 v[32:35], a[220:223], a[68:71], v[32:35]
ds_read_b128 a[240:243], v4 offset:52224
v_mfma_f32_16x16x32_bf16 v[36:39], a[216:219], a[136:139], v[36:39]
v_mfma_f32_16x16x32_bf16 v[36:39], a[220:223], a[140:143], v[36:39]
ds_read_b128 a[244:247], v4 offset:59392
s_waitcnt lgkmcnt(4)
v_mfma_f32_16x16x32_bf16 v[40:43], a[224:227], a[64:67], v[40:43]
v_mfma_f32_16x16x32_bf16 v[40:43], a[228:231], a[68:71], v[40:43]
ds_read_b128 a[216:219], v4 offset:53248
v_mfma_f32_16x16x32_bf16 v[44:47], a[224:227], a[136:139], v[44:47]
v_mfma_f32_16x16x32_bf16 v[44:47], a[228:231], a[140:143], v[44:47]
ds_read_b128 a[220:223], v4 offset:60416
s_waitcnt lgkmcnt(4)
v_mfma_f32_16x16x32_bf16 v[48:51], a[232:235], a[64:67], v[48:51]
v_mfma_f32_16x16x32_bf16 v[48:51], a[236:239], a[68:71], v[48:51]
ds_read_b128 a[224:227], v4 offset:54272
v_mfma_f32_16x16x32_bf16 v[52:55], a[232:235], a[136:139], v[52:55]
v_mfma_f32_16x16x32_bf16 v[52:55], a[236:239], a[140:143], v[52:55]
ds_read_b128 a[228:231], v4 offset:61440
s_waitcnt lgkmcnt(4)
v_mfma_f32_16x16x32_bf16 v[56:59], a[240:243], a[64:67], v[56:59]
v_mfma_f32_16x16x32_bf16 v[56:59], a[244:247], a[68:71], v[56:59]
ds_read_b128 a[232:235], v4 offset:55296
v_mfma_f32_16x16x32_bf16 v[60:63], a[240:243], a[136:139], v[60:63]
v_mfma_f32_16x16x32_bf16 v[60:63], a[244:247], a[140:143], v[60:63]
ds_read_b128 a[236:239], v4 offset:62464
s_waitcnt lgkmcnt(4)
v_mfma_f32_16x16x32_bf16 v[64:67], a[216:219], a[64:67], v[64:67]
v_mfma_f32_16x16x32_bf16 v[64:67], a[220:223], a[68:71], v[64:67]
ds_read_b128 a[240:243], v7 offset:49152
v_mfma_f32_16x16x32_bf16 v[68:71], a[216:219], a[136:139], v[68:71]
v_mfma_f32_16x16x32_bf16 v[68:71], a[220:223], a[140:143], v[68:71]
ds_read_b128 a[244:247], v7 offset:56320
s_waitcnt lgkmcnt(4)
v_mfma_f32_16x16x32_bf16 v[72:75], a[64:67], a[224:227], v[72:75]
v_mfma_f32_16x16x32_bf16 v[72:75], a[68:71], a[228:231], v[72:75]
ds_read_b128 a[216:219], v10 offset:49152
v_mfma_f32_16x16x32_bf16 v[76:79], a[136:139], a[224:227], v[76:79]
v_mfma_f32_16x16x32_bf16 v[76:79], a[140:143], a[228:231], v[76:79]
ds_read_b128 a[220:223], v10 offset:56320
s_waitcnt lgkmcnt(4)
v_mfma_f32_16x16x32_bf16 v[80:83], a[64:67], a[232:235], v[80:83]
v_mfma_f32_16x16x32_bf16 v[80:83], a[68:71], a[236:239], v[80:83]
v_mfma_f32_16x16x32_bf16 v[84:87], a[136:139], a[232:235], v[84:87]
v_mfma_f32_16x16x32_bf16 v[84:87], a[140:143], a[236:239], v[84:87]
s_waitcnt lgkmcnt(2)
v_mfma_f32_16x16x32_bf16 v[88:91], a[240:243], a[208:211], v[88:91]
v_mfma_f32_16x16x32_bf16 v[88:91], a[244:247], a[212:215], v[88:91]
s_waitcnt lgkmcnt(0)
v_mfma_f32_16x16x32_bf16 v[92:95], a[208:211], a[216:219], v[92:95]
v_mfma_f32_16x16x32_bf16 v[92:95], a[212:215], a[220:223], v[92:95]
v_mov_b32 v103, 0xff61b1e6
v_mov_b32 v102, 0xffff
v_cndmask_b32 v172, v103, 0, s[44:45]
v_cndmask_b32 v173, v103, 0, s[46:47]
v_cndmask_b32 v174, v103, 0, s[48:49]
v_cndmask_b32 v175, v103, 0, s[50:51]
v_cndmask_b32 v184, 0, v102, s[44:45]
v_cndmask_b32 v13, 0, v102, s[46:47]
v_lshl_or_b32 v184, v13, 16, v184
v_cndmask_b32 v185, 0, v102, s[48:49]
v_cndmask_b32 v13, 0, v102, s[50:51]
v_lshl_or_b32 v185, v13, 16, v185
v_cndmask_b32 v176, v103, 0, s[52:53]
v_cndmask_b32 v177, v103, 0, s[54:55]
v_cndmask_b32 v178, v103, 0, s[56:57]
v_cndmask_b32 v179, v103, 0, s[58:59]
v_cndmask_b32 v186, 0, v102, s[52:53]
v_cndmask_b32 v13, 0, v102, s[54:55]
v_lshl_or_b32 v186, v13, 16, v186
v_cndmask_b32 v187, 0, v102, s[56:57]
v_cndmask_b32 v13, 0, v102, s[58:59]
v_lshl_or_b32 v187, v13, 16, v187
L_hop1:
s_cmp_eq_u32 s15, 1
s_cbranch_scc1 L_hop5
v_cndmask_b32 v180, v103, 0, s[60:61]
v_cndmask_b32 v181, v103, 0, s[62:63]
v_cndmask_b32 v182, v103, 0, s[64:65]
v_cndmask_b32 v183, v103, 0, s[66:67]
v_cndmask_b32 v188, 0, v102, s[60:61]
v_cndmask_b32 v13, 0, v102, s[62:63]
v_lshl_or_b32 v188, v13, 16, v188
v_cndmask_b32 v189, 0, v102, s[64:65]
v_cndmask_b32 v13, 0, v102, s[66:67]
v_lshl_or_b32 v189, v13, 16, v189
L_att:
v_cvt_pk_bf16_f32 v160, v64, v65
v_cvt_pk_bf16_f32 v161, v66, v67
v_cvt_pk_bf16_f32 v162, v68, v69
v_cvt_pk_bf16_f32 v163, v70, v71
v_cvt_pk_bf16_f32 v156, v88, v89
v_cvt_pk_bf16_f32 v157, v90, v91
v_cvt_pk_bf16_f32 v158, v92, v93
v_cvt_pk_bf16_f32 v159, v94, v95
v_mfma_f32_16x16x32_bf16 v[164:167], v[160:163], v[96:99], 0
s_nop 0
v_mfma_f32_16x16x32_bf16 v[168:171], v[156:159], v[98:101], 0
v_mfma_f32_16x16x32_bf16 v[88:91], v[160:163], v[98:101], 0
v_cvt_pk_bf16_f32 v116, v52, v53
v_cvt_pk_bf16_f32 v117, v54, v55
v_cvt_pk_bf16_f32 v120, v60, v61
v_cvt_pk_bf16_f32 v121, v62, v63
v_cvt_pk_bf16_f32 v126, v76, v77
v_cvt_pk_bf16_f32 v127, v78, v79
v_cvt_pk_bf16_f32 v132, v84, v85
v_cvt_pk_bf16_f32 v133, v86, v87
v_cvt_pk_bf16_f32 v138, v164, v165
v_cvt_pk_bf16_f32 v139, v166, v167
v_cvt_pk_bf16_f32 v164, v168, v169
v_cvt_pk_bf16_f32 v165, v170, v171
s_cmp_eq_u32 s4, 3
s_cbranch_scc1 L_a1_noxch
ds_write_b64 v16, v[156:157]
ds_write_b64 v15, v[116:117] offset:3072
ds_write_b64 v15, v[120:121] offset:3584
ds_write_b64 v15, v[162:163] offset:4096
ds_write_b64 v15, v[126:127] offset:4608
ds_write_b64 v15, v[132:133] offset:5120
ds_write_b64 v15, v[138:139] offset:5632
s_cmp_eq_u32 s4, 2
s_cbranch_scc1 L_a1_left
ds_write_b64 v19, v[158:159] offset:1536
s_branch L_a1_noxch
L_a1_left:
ds_write_b64 v18, v[164:165]
L_a1_noxch:
v_cvt_pk_bf16_f32 v136, v88, v89
v_cvt_pk_bf16_f32 v137, v90, v91
v_cvt_pk_bf16_f32 v110, v48, v49
v_cvt_pk_bf16_f32 v111, v50, v51
v_cvt_pk_bf16_f32 v114, v56, v57
v_cvt_pk_bf16_f32 v115, v58, v59
v_cvt_pk_bf16_f32 v124, v72, v73
v_cvt_pk_bf16_f32 v125, v74, v75
v_cvt_pk_bf16_f32 v130, v80, v81
v_cvt_pk_bf16_f32 v131, v82, v83
v_cvt_pk_bf16_f32 v140, v32, v33
v_cvt_pk_bf16_f32 v141, v34, v35
v_cvt_pk_bf16_f32 v146, v40, v41
v_cvt_pk_bf16_f32 v147, v42, v43
v_mov_b32 v142, v160
v_mov_b32 v145, v161
v_mov_b32 v143, 0
v_mov_b32 v144, 0
v_mov_b32 v112, 0
v_mov_b32 v113, 0
s_nop 0
v_permlane16_swap_b32 v142, v112
v_permlane16_swap_b32 v145, v113
v_cvt_pk_bf16_f32 v148, v36, v37
v_cvt_pk_bf16_f32 v149, v38, v39
v_cvt_pk_bf16_f32 v154, v44, v45
v_cvt_pk_bf16_f32 v155, v46, v47
v_mov_b32 v150, v162
v_mov_b32 v153, v163
v_mov_b32 v151, 0
v_mov_b32 v152, 0
v_mov_b32 v118, 0
v_mov_b32 v119, 0
s_nop 0
v_permlane16_swap_b32 v150, v118
v_permlane16_swap_b32 v153, v119
s_waitcnt lgkmcnt(0)
s_barrier
s_and_b32 s37, s6, 7
s_mul_i32 s37, s37, 92160
s_mul_i32 s38, s4, 23552
s_add_u32 s37, s37, s38
s_add_u32 s37, s37, 6266880
ds_read_b64 v[104:105], v15
ds_read_b64 v[108:109], v15 offset:512
ds_read_b64 v[106:107], v17 offset:1024
ds_read_b64 v[122:123], v15 offset:1536
ds_read_b64 v[128:129], v15 offset:2048
ds_read_b64 v[134:135], v15 offset:2560
v_mfma_f32_16x16x32_bf16 v[32:35], v[110:113], v[148:151], v[172:175]
v_mfma_f32_16x16x32_bf16 v[36:39], v[116:119], v[148:151], v[176:179]
v_mfma_f32_16x16x32_bf16 v[40:43], v[112:115], v[152:155], v[172:175]
v_mfma_f32_16x16x32_bf16 v[44:47], v[118:121], v[152:155], v[176:179]
s_waitcnt lgkmcnt(3)
v_mfma_f32_16x16x32_bf16 v[48:51], v[104:107], v[140:143], v[180:183]
v_mfma_f32_16x16x32_bf16 v[52:55], v[110:113], v[140:143], v[176:179]
v_mfma_f32_16x16x32_bf16 v[56:59], v[106:109], v[144:147], v[180:183]
v_mfma_f32_16x16x32_bf16 v[60:63], v[112:115], v[144:147], v[176:179]
s_nop 0
v_max_f32 v32, v32, v36
v_max_f32 v33, v33, v37
v_max_f32 v34, v34, v38
v_max_f32 v35, v35, v39
v_max_f32 v40, v40, v44
v_max_f32 v41, v41, v45
v_max_f32 v42, v42, v46
v_max_f32 v43, v43, v47
v_max_f32 v48, v48, v52
v_max_f32 v49, v49, v53
v_max_f32 v50, v50, v54
v_max_f32 v51, v51, v55
v_max_f32 v56, v56, v60
v_max_f32 v57, v57, v61
v_max_f32 v58, v58, v62
v_max_f32 v59, v59, v63
v_max3_f32 v20, v32, v33, v34
v_max3_f32 v21, v40, v41, v42
v_max3_f32 v22, v48, v49, v50
v_max3_f32 v23, v56, v57, v58
v_max_f32 v20, v20, v35
v_max_f32 v21, v21, v43
v_max_f32 v22, v22, v51
v_max_f32 v23, v23, v59
v_mov_b32 v24, v20
v_mov_b32 v25, v21
v_mov_b32 v26, v22
v_mov_b32 v27, v23
v_permlane16_swap_b32 v20, v24
v_permlane16_swap_b32 v21, v25
v_permlane16_swap_b32 v22, v26
v_permlane16_swap_b32 v23, v27
v_max_f32 v20, v20, v24
v_max_f32 v21, v21, v25
v_max_f32 v22, v22, v26
v_max_f32 v23, v23, v27
v_mov_b32 v24, v20
v_mov_b32 v25, v21
v_mov_b32 v26, v22
v_mov_b32 v27, v23
v_permlane32_swap_b32 v20, v24
v_permlane32_swap_b32 v21, v25
v_permlane32_swap_b32 v22, v26
v_permlane32_swap_b32 v23, v27
v_max_f32 v20, v20, v24
v_max_f32 v21, v21, v25
v_max_f32 v22, v22, v26
v_max_f32 v23, v23, v27
v_mul_f32 v20, s34, v20
v_mul_f32 v21, s34, v21
v_mul_f32 v22, s34, v22
v_mul_f32 v23, s34, v23
v_fma_f32 v32, v32, s34, -v20
v_fma_f32 v40, v40, s34, -v21
v_fma_f32 v48, v48, s34, -v22
v_fma_f32 v56, v56, s34, -v23
v_exp_f32 v32, v32
v_exp_f32 v40, v40
v_exp_f32 v48, v48
v_exp_f32 v56, v56
v_fma_f32 v33, v33, s34, -v20
v_fma_f32 v41, v41, s34, -v21
v_fma_f32 v49, v49, s34, -v22
v_fma_f32 v57, v57, s34, -v23
v_exp_f32 v33, v33
v_exp_f32 v41, v41
v_exp_f32 v49, v49
v_exp_f32 v57, v57
v_fma_f32 v34, v34, s34, -v20
v_fma_f32 v42, v42, s34, -v21
v_fma_f32 v50, v50, s34, -v22
v_fma_f32 v58, v58, s34, -v23
v_exp_f32 v34, v34
v_exp_f32 v42, v42
v_exp_f32 v50, v50
v_exp_f32 v58, v58
v_fma_f32 v35, v35, s34, -v20
v_fma_f32 v43, v43, s34, -v21
v_fma_f32 v51, v51, s34, -v22
v_fma_f32 v59, v59, s34, -v23
v_exp_f32 v35, v35
v_exp_f32 v43, v43
v_exp_f32 v51, v51
v_exp_f32 v59, v59
v_add_f32 v28, v32, v33
v_add_f32 v29, v40, v41
v_add_f32 v30, v48, v49
v_add_f32 v31, v56, v57
v_add_f32 v28, v28, v34
v_add_f32 v29, v29, v42
v_add_f32 v30, v30, v50
v_add_f32 v31, v31, v58
v_add_f32 v28, v28, v35
v_add_f32 v29, v29, v43
v_add_f32 v30, v30, v51
v_add_f32 v31, v31, v59
v_mov_b32 v24, v28
v_mov_b32 v25, v29
v_mov_b32 v26, v30
v_mov_b32 v27, v31
v_permlane16_swap_b32 v28, v24
v_permlane16_swap_b32 v29, v25
v_permlane16_swap_b32 v30, v26
v_permlane16_swap_b32 v31, v27
v_add_f32 v28, v28, v24
v_add_f32 v29, v29, v25
v_add_f32 v30, v30, v26
v_add_f32 v31, v31, v27
v_mov_b32 v24, v28
v_mov_b32 v25, v29
v_mov_b32 v26, v30
v_mov_b32 v27, v31
v_permlane32_swap_b32 v28, v24
v_permlane32_swap_b32 v29, v25
v_permlane32_swap_b32 v30, v26
v_permlane32_swap_b32 v31, v27
v_add_f32 v28, v28, v24
v_add_f32 v29, v29, v25
v_add_f32 v30, v30, v26
v_add_f32 v31, v31, v27
v_rcp_f32 v28, v28
v_rcp_f32 v29, v29
v_rcp_f32 v30, v30
v_rcp_f32 v31, v31
v_mul_f32 v32, v32, v28
v_mul_f32 v40, v40, v29
v_mul_f32 v48, v48, v30
v_mul_f32 v56, v56, v31
v_mul_f32 v33, v33, v28
v_mul_f32 v41, v41, v29
v_mul_f32 v49, v49, v30
v_mul_f32 v57, v57, v31
v_mul_f32 v34, v34, v28
v_mul_f32 v42, v42, v29
v_mul_f32 v50, v50, v30
v_mul_f32 v58, v58, v31
v_mul_f32 v35, v35, v28
v_mul_f32 v43, v43, v29
v_mul_f32 v51, v51, v30
v_mul_f32 v59, v59, v31
v_cvt_pk_bf16_f32 v36, v32, v33
v_cvt_pk_bf16_f32 v37, v34, v35
v_cvt_pk_bf16_f32 v44, v40, v41
v_cvt_pk_bf16_f32 v45, v42, v43
v_cvt_pk_bf16_f32 v52, v48, v49
v_cvt_pk_bf16_f32 v53, v50, v51
v_cvt_pk_bf16_f32 v60, v56, v57
v_cvt_pk_bf16_f32 v61, v58, v59
v_and_b32 v64, v184, v36
v_and_b32 v66, v186, v36
v_and_b32 v65, v185, v37
v_and_b32 v67, v187, v37
v_and_b32 v68, v184, v44
v_and_b32 v70, v186, v44
v_and_b32 v69, v185, v45
v_and_b32 v71, v187, v45
v_and_b32 v72, v188, v52
v_and_b32 v74, v186, v52
v_and_b32 v73, v189, v53
v_and_b32 v75, v187, v53
v_and_b32 v76, v188, v60
v_and_b32 v78, v186, v60
v_and_b32 v77, v189, v61
v_and_b32 v79, v187, v61
s_waitcnt lgkmcnt(0)
v_mfma_f32_16x16x32_bf16 v[80:83], v[124:127], v[64:67], 0
v_mfma_f32_16x16x32_bf16 v[84:87], v[136:139], v[64:67], 0
v_mfma_f32_16x16x32_bf16 v[88:91], v[130:133], v[68:71], 0
v_mfma_f32_16x16x32_bf16 v[92:95], v[136:139], v[68:71], 0
v_mfma_f32_16x16x32_bf16 v[96:99], v[122:125], v[72:75], 0
v_mfma_f32_16x16x32_bf16 v[100:103], v[134:137], v[72:75], 0
v_mfma_f32_16x16x32_bf16 v[164:167], v[128:131], v[76:79], 0
v_mfma_f32_16x16x32_bf16 v[168:171], v[134:137], v[76:79], 0
v_lshlrev_b32 v14, 3, v12
v_mov_b32 v15, 2146435072
v_cmp_gt_u32 vcc, 16, v1
s_nop 1
v_cndmask_b32 v14, v15, v14, vcc
s_add_u32 s26, s24, s72
s_lshl_b32 s27, s21, 10
s_add_u32 s27, s27, s26
s_lshl_b32 s28, s21, 7
s_add_u32 s28, s28, 16384
s_add_u32 s28, s28, s26
s_add_u32 s30, s27, 18432
s_add_u32 s31, s28, 18432
v_cvt_pk_bf16_f32 v40, v80, v81
v_cvt_pk_bf16_f32 v41, v82, v83
v_cvt_pk_bf16_f32 v42, v88, v89
v_cvt_pk_bf16_f32 v43, v90, v91
v_cvt_pk_bf16_f32 v44, v84, v85
v_cvt_pk_bf16_f32 v45, v94, v95
buffer_store_dwordx4 v[40:43], v2, s[8:11], s30 offen sc1
buffer_store_dwordx2 v[44:45], v14, s[8:11], s31 offen sc1
v_cvt_pk_bf16_f32 v32, v96, v97
v_cvt_pk_bf16_f32 v33, v98, v99
v_cvt_pk_bf16_f32 v34, v164, v165
v_cvt_pk_bf16_f32 v35, v166, v167
v_cvt_pk_bf16_f32 v36, v100, v101
v_cvt_pk_bf16_f32 v37, v170, v171
buffer_store_dwordx4 v[32:35], v2, s[8:11], s27 offen sc1
buffer_store_dwordx2 v[36:37], v14, s[8:11], s28 offen sc1
s_lshl_b32 s26, s20, 4
s_add_u32 s26, s26, s21
s_lshl_b32 s14, s26, 7
s_add_u32 s14, s14, 393216
s_add_u32 s14, s14, s77
s_lshr_b32 s20, s6, 3
s_lshl_b32 s21, s5, 2
s_add_u32 s20, s20, s21
s_lshl_b32 s20, s20, 2
s_add_u32 s20, s20, s4
s_and_b32 s21, s6, 7
s_mul_i32 s24, s20, 18432
s_add_u32 s25, s24, s72
s_mul_i32 s26, s21, 2304
s_add_u32 s26, s26, s24
s_add_u32 s27, s26, s71
v_and_b32 v6, 15, v1
v_lshrrev_b32 v7, 4, v1
v_lshlrev_b32 v8, 4, v6
v_lshl_add_u32 v8, v7, 3, v8
v_add_u32 v8, 2048, v8
v_mov_b32 v9, 2146435072
v_cmp_gt_u32 vcc, 32, v1
s_nop 1
v_cndmask_b32 v4, v9, v8, vcc
v_add_u32 v5, 0x10000, v2
s_and_b32 s40, s5, 1
s_lshl_b32 s40, s40, 2
s_lshr_b32 s41, s6, 3
s_add_u32 s40, s40, s41
s_lshr_b32 s41, s5, 1
s_lshl_b32 s41, s41, 3
s_and_b32 s42, s6, 7
s_add_u32 s41, s41, s42
s_lshr_b32 s42, s41, 2
s_and_b32 s43, s41, 3
s_lshr_b32 s22, s20, 3
s_lshl_b32 s22, s22, 4
v_add_u32 v10, s22, v6
v_subrev_u32 v12, 16, v1
v_min_u32 v12, 26, v12
v_mul_u32_u24 v16, 57, v12
v_lshrrev_b32 v16, 9, v16
v_mad_u32_u24 v12, v16, 63, v12
s_mul_i32 s22, s42, 9
v_add_u32 v12, s22, v12
v_and_b32 v16, 7, v12
v_lshrrev_b32 v12, 3, v12
v_lshrrev_b32 v17, 2, v16
v_lshlrev_b32 v17, 3, v17
v_lshrrev_b32 v18, 2, v12
v_add_lshl_u32 v17, v17, v18, 4
v_and_b32 v16, 3, v16
v_lshl_add_u32 v17, v16, 2, v17
v_and_b32 v12, 3, v12
v_add_u32 v17, v17, v12
s_cmp_eq_u32 s7, 0
s_cselect_b32 s22, 16, 64
v_cmp_le_u32 vcc, s22, v1
s_nop 1
v_cndmask_b32 v10, v10, v17, vcc
v_lshlrev_b32 v10, 7, v10
s_add_u32 s22, s77, 393216
v_lshlrev_b32 v11, 3, v6
v_lshl_add_u32 v11, v7, 8, v11
v_mov_b32 v13, 2146435072
v_cmp_gt_u32 vcc, 16, v0
v_lshlrev_b32 v14, 3, v0
s_nop 0
v_cndmask_b32 v13, v13, v14, vcc
v_mov_b32 v14, s68
v_mov_b32 v15, s69
s_waitcnt vmcnt(0)
s_barrier
buffer_store_dwordx2 v[14:15], v13, s[8:11], s14 offen sc1
s_add_u32 m0, s38, 0
s_add_u32 s39, s37, 0
buffer_load_dwordx4 v2, s[8:11], s39 offen offset:0 sc1 lds
buffer_load_dwordx4 v2, s[8:11], s39 offen offset:1024 sc1 lds
buffer_load_dwordx4 v2, s[8:11], s39 offen offset:2048 sc1 lds
buffer_load_dwordx4 v2, s[8:11], s39 offen offset:3072 sc1 lds
s_add_u32 m0, s38, 4096
s_add_u32 s39, s37, 4096
buffer_load_dwordx4 v2, s[8:11], s39 offen offset:0 sc1 lds
buffer_load_dwordx4 v2, s[8:11], s39 offen offset:1024 sc1 lds
buffer_load_dwordx4 v2, s[8:11], s39 offen offset:2048 sc1 lds
buffer_load_dwordx4 v2, s[8:11], s39 offen offset:3072 sc1 lds
s_add_u32 m0, s38, 8192
s_add_u32 s39, s37, 8192
buffer_load_dwordx4 v2, s[8:11], s39 offen offset:0 sc1 lds
buffer_load_dwordx4 v2, s[8:11], s39 offen offset:1024 sc1 lds
buffer_load_dwordx4 v2, s[8:11], s39 offen offset:2048 sc1 lds
buffer_load_dwordx4 v2, s[8:11], s39 offen offset:3072 sc1 lds
s_add_u32 m0, s38, 12288
s_add_u32 s39, s37, 12288
buffer_load_dwordx4 v2, s[8:11], s39 offen offset:0 sc1 lds
buffer_load_dwordx4 v2, s[8:11], s39 offen offset:1024 sc1 lds
buffer_load_dwordx4 v2, s[8:11], s39 offen offset:2048 sc1 lds
buffer_load_dwordx4 v2, s[8:11], s39 offen offset:3072 sc1 lds
s_add_u32 m0, s38, 16384
s_add_u32 s39, s37, 16384
buffer_load_dwordx4 v2, s[8:11], s39 offen offset:0 sc1 lds
buffer_load_dwordx4 v2, s[8:11], s39 offen offset:1024 sc1 lds
buffer_load_dwordx4 v2, s[8:11], s39 offen offset:2048 sc1 lds
buffer_load_dwordx4 v2, s[8:11], s39 offen offset:3072 sc1 lds
s_add_u32 m0, s38, 20480
s_add_u32 s39, s37, 20480
buffer_load_dwordx4 v2, s[8:11], s39 offen offset:0 sc1 lds
buffer_load_dwordx4 v2, s[8:11], s39 offen offset:1024 sc1 lds
buffer_load_dwordx4 v2, s[8:11], s39 offen offset:2048 sc1 lds
s_mov_b32 s52, 0
L_poll2:
buffer_load_dwordx2 v[14:15], v10, s[8:11], s22 offen sc1
s_add_u32 s52, s52, 1
s_waitcnt vmcnt(0)
v_cmp_ne_u64 vcc, s[68:69], v[14:15]
s_cmp_ge_u32 s52, 1048576
s_cbranch_scc1 L_got2
s_and_b64 exec, exec, vcc
s_cbranch_execnz L_poll2
L_got2:
s_mov_b64 exec, -1
buffer_load_dwordx4 a[0:3], v2, s[8:11], s25 offen offset:0 sc1
buffer_load_dwordx4 a[4:7], v2, s[8:11], s25 offen offset:1024 sc1
buffer_load_dwordx4 a[8:11], v2, s[8:11], s25 offen offset:2048 sc1
buffer_load_dwordx4 a[12:15], v2, s[8:11], s25 offen offset:3072 sc1
s_add_u32 s25, s25, 4096
buffer_load_dwordx4 a[16:19], v2, s[8:11], s25 offen offset:0 sc1
buffer_load_dwordx4 a[20:23], v2, s[8:11], s25 offen offset:1024 sc1
buffer_load_dwordx4 a[24:27], v2, s[8:11], s25 offen offset:2048 sc1
buffer_load_dwordx4 a[28:31], v2, s[8:11], s25 offen offset:3072 sc1
s_add_u32 s25, s25, 4096
buffer_load_dwordx4 a[32:35], v2, s[8:11], s25 offen offset:0 sc1
buffer_load_dwordx4 a[36:39], v2, s[8:11], s25 offen offset:1024 sc1
buffer_load_dwordx4 a[40:43], v2, s[8:11], s25 offen offset:2048 sc1
buffer_load_dwordx4 a[44:47], v2, s[8:11], s25 offen offset:3072 sc1
s_barrier
ds_read_b128 a[216:219], v2 offset:0
ds_read_b128 a[220:223], v2 offset:5120
ds_read_b128 a[224:227], v2 offset:1024
ds_read_b128 a[228:231], v2 offset:6144
ds_read_b128 a[232:235], v2 offset:2048
ds_read_b128 a[236:239], v2 offset:7168
s_mul_i32 s22, s4, 6144
s_mul_i32 s23, s41, 497664
s_add_u32 s23, s23, s22
s_add_u32 s23, s23, 7012352
v_add_u32 v3, s23, v2
s_waitcnt vmcnt(10)
s_waitcnt lgkmcnt(4)
v_mfma_f32_16x16x32_bf16 v[32:35], a[216:219], a[0:3], 0
ds_read_b128 a[240:243], v2 offset:3072
v_mfma_f32_16x16x32_bf16 v[32:35], a[220:223], a[4:7], v[32:35]
ds_read_b128 a[244:247], v2 offset:8192
s_add_u32 s25, s25, 4096
buffer_load_dwordx4 a[48:51], v2, s[8:11], s25 offen offset:0 sc1
s_waitcnt lgkmcnt(4)
v_mfma_f32_16x16x32_bf16 v[36:39], a[224:227], a[0:3], 0
ds_read_b128 a[216:219], v2 offset:4096
v_mfma_f32_16x16x32_bf16 v[36:39], a[228:231], a[4:7], v[36:39]
ds_read_b128 a[220:223], v2 offset:9216
s_waitcnt lgkmcnt(4)
v_mfma_f32_16x16x32_bf16 v[40:43], a[232:235], a[0:3], 0
ds_read_b128 a[224:227], v2 offset:10240
v_mfma_f32_16x16x32_bf16 v[40:43], a[236:239], a[4:7], v[40:43]
ds_read_b128 a[228:231], v2 offset:15360
buffer_load_dwordx4 a[52:55], v2, s[8:11], s25 offen offset:1024 sc1
s_waitcnt lgkmcnt(4)
v_mfma_f32_16x16x32_bf16 v[44:47], a[240:243], a[0:3], 0
ds_read_b128 a[232:235], v2 offset:11264
v_mfma_f32_16x16x32_bf16 v[44:47], a[244:247], a[4:7], v[44:47]
ds_read_b128 a[236:239], v2 offset:16384
s_waitcnt lgkmcnt(4)
v_mfma_f32_16x16x32_bf16 v[48:51], a[216:219], a[0:3], 0
ds_read_b128 a[240:243], v2 offset:12288
v_mfma_f32_16x16x32_bf16 v[48:51], a[220:223], a[4:7], v[48:51]
ds_read_b128 a[244:247], v2 offset:17408
buffer_load_dwordx4 a[56:59], v2, s[8:11], s25 offen offset:2048 sc1
s_waitcnt vmcnt(11)
s_waitcnt lgkmcnt(4)
v_mfma_f32_16x16x32_bf16 v[32:35], a[224:227], a[8:11], v[32:35]
ds_read_b128 a[216:219], v2 offset:13312
v_mfma_f32_16x16x32_bf16 v[32:35], a[228:231], a[12:15], v[32:35]
ds_read_b128 a[220:223], v2 offset:18432
s_waitcnt lgkmcnt(4)
v_mfma_f32_16x16x32_bf16 v[36:39], a[232:235], a[8:11], v[36:39]
ds_read_b128 a[224:227], v2 offset:14336
v_mfma_f32_16x16x32_bf16 v[36:39], a[236:239], a[12:15], v[36:39]
ds_read_b128 a[228:231], v2 offset:19456
buffer_load_dwordx4 a[60:63], v2, s[8:11], s25 offen offset:3072 sc1
s_waitcnt lgkmcnt(4)
v_mfma_f32_16x16x32_bf16 v[40:43], a[240:243], a[8:11], v[40:43]
ds_read_b128 a[232:235], v2 offset:20480
v_mfma_f32_16x16x32_bf16 v[40:43], a[244:247], a[12:15], v[40:43]
ds_read_b128 a[236:239], v2 offset:25600
s_waitcnt lgkmcnt(4)
v_mfma_f32_16x16x32_bf16 v[44:47], a[216:219], a[8:11], v[44:47]
ds_read_b128 a[240:243], v2 offset:21504
v_mfma_f32_16x16x32_bf16 v[44:47], a[220:223], a[12:15], v[44:47]
ds_read_b128 a[244:247], v2 offset:26624
s_add_u32 s25, s25, 4096
buffer_load_dwordx2 a[64:65], v11, s[8:11], s25 offen offset:0 sc1
buffer_load_dwordx2 a[66:67], v11, s[8:11], s25 offen offset:128 sc1
s_waitcnt lgkmcnt(4)
v_mfma_f32_16x16x32_bf16 v[48:51], a[224:227], a[8:11], v[48:51]
ds_read_b128 a[216:219], v2 offset:22528
v_mfma_f32_16x16x32_bf16 v[48:51], a[228:231], a[12:15], v[48:51]
ds_read_b128 a[220:223], v2 offset:27648
s_waitcnt vmcnt(12)
s_waitcnt lgkmcnt(4)
v_mfma_f32_16x16x32_bf16 v[32:35], a[232:235], a[16:19], v[32:35]
ds_read_b128 a[224:227], v2 offset:23552
v_mfma_f32_16x16x32_bf16 v[32:35], a[236:239], a[20:23], v[32:35]
ds_read_b128 a[228:231], v2 offset:28672
buffer_load_dwordx2 a[68:69], v11, s[8:11], s25 offen offset:1024 sc1
buffer_load_dwordx2 a[70:71], v11, s[8:11], s25 offen offset:1152 sc1
s_waitcnt lgkmcnt(4)
v_mfma_f32_16x16x32_bf16 v[36:39], a[240:243], a[16:19], v[36:39]
ds_read_b128 a[232:235], v2 offset:24576
v_mfma_f32_16x16x32_bf16 v[36:39], a[244:247], a[20:23], v[36:39]
ds_read_b128 a[236:239], v2 offset:29696
s_waitcnt lgkmcnt(4)
v_mfma_f32_16x16x32_bf16 v[40:43], a[216:219], a[16:19], v[40:43]
ds_read_b128 a[240:243], v2 offset:30720
v_mfma_f32_16x16x32_bf16 v[40:43], a[220:223], a[20:23], v[40:43]
ds_read_b128 a[244:247], v2 offset:35840
buffer_load_dwordx4 v[56:59], v2, s[8:11], s27 offen sc1
s_waitcnt lgkmcnt(4)
v_mfma_f32_16x16x32_bf16 v[44:47], a[224:227], a[16:19], v[44:47]
ds_read_b128 a[216:219], v2 offset:31744
v_mfma_f32_16x16x32_bf16 v[44:47], a[228:231], a[20:23], v[44:47]
ds_read_b128 a[220:223], v2 offset:36864
s_waitcnt lgkmcnt(4)
v_mfma_f32_16x16x32_bf16 v[48:51], a[232:235], a[16:19], v[48:51]
ds_read_b128 a[224:227], v2 offset:32768
v_mfma_f32_16x16x32_bf16 v[48:51], a[236:239], a[20:23], v[48:51]
ds_read_b128 a[228:231], v2 offset:37888
buffer_load_dwordx4 v[60:63], v2, s[8:11], s27 offen offset:1024 sc1
s_waitcnt vmcnt(14)
s_waitcnt lgkmcnt(4)
v_mfma_f32_16x16x32_bf16 v[32:35], a[240:243], a[24:27], v[32:35]
ds_read_b128 a[232:235], v2 offset:33792
v_mfma_f32_16x16x32_bf16 v[32:35], a[244:247], a[28:31], v[32:35]
ds_read_b128 a[236:239], v2 offset:38912
s_waitcnt lgkmcnt(4)
v_mfma_f32_16x16x32_bf16 v[36:39], a[216:219], a[24:27], v[36:39]
ds_read_b128 a[240:243], v2 offset:34816
v_mfma_f32_16x16x32_bf16 v[36:39], a[220:223], a[28:31], v[36:39]
ds_read_b128 a[244:247], v2 offset:39936
buffer_load_dwordx2 v[64:65], v4, s[8:11], s27 offen sc1
s_waitcnt lgkmcnt(4)
v_mfma_f32_16x16x32_bf16 v[40:43], a[224:227], a[24:27], v[40:43]
ds_read_b128 a[216:219], v2 offset:40960
v_mfma_f32_16x16x32_bf16 v[40:43], a[228:231], a[28:31], v[40:43]
ds_read_b128 a[220:223], v2 offset:46080
s_waitcnt lgkmcnt(4)
v_mfma_f32_16x16x32_bf16 v[44:47], a[232:235], a[24:27], v[44:47]
ds_read_b128 a[224:227], v2 offset:41984
v_mfma_f32_16x16x32_bf16 v[44:47], a[236:239], a[28:31], v[44:47]
ds_read_b128 a[228:231], v2 offset:47104
s_add_u32 m0, s22, 98304
s_nop 0
buffer_load_dwordx4 v3, s[8:11], 0 offen offset:0 sc1 lds
s_waitcnt lgkmcnt(4)
v_mfma_f32_16x16x32_bf16 v[48:51], a[240:243], a[24:27], v[48:51]
ds_read_b128 a[232:235], v2 offset:43008
v_mfma_f32_16x16x32_bf16 v[48:51], a[244:247], a[28:31], v[48:51]
ds_read_b128 a[236:239], v2 offset:48128
s_waitcnt vmcnt(14)
s_waitcnt lgkmcnt(4)
v_mfma_f32_16x16x32_bf16 v[32:35], a[216:219], a[32:35], v[32:35]
ds_read_b128 a[240:243], v2 offset:44032
v_mfma_f32_16x16x32_bf16 v[32:35], a[220:223], a[36:39], v[32:35]
ds_read_b128 a[244:247], v2 offset:49152
buffer_load_dwordx4 v3, s[8:11], 0 offen offset:1024 sc1 lds
s_waitcnt lgkmcnt(4)
v_mfma_f32_16x16x32_bf16 v[36:39], a[224:227], a[32:35], v[36:39]
ds_read_b128 a[216:219], v2 offset:45056
v_mfma_f32_16x16x32_bf16 v[36:39], a[228:231], a[36:39], v[36:39]
ds_read_b128 a[220:223], v2 offset:50176
s_waitcnt lgkmcnt(4)
v_mfma_f32_16x16x32_bf16 v[40:43], a[232:235], a[32:35], v[40:43]
ds_read_b128 a[224:227], v2 offset:51200
v_mfma_f32_16x16x32_bf16 v[40:43], a[236:239], a[36:39], v[40:43]
ds_read_b128 a[228:231], v2 offset:56320
buffer_load_dwordx4 v3, s[8:11], 0 offen offset:2048 sc1 lds
s_waitcnt lgkmcnt(4)
v_mfma_f32_16x16x32_bf16 v[44:47], a[240:243], a[32:35], v[44:47]
ds_read_b128 a[232:235], v2 offset:52224
v_mfma_f32_16x16x32_bf16 v[44:47], a[244:247], a[36:39], v[44:47]
ds_read_b128 a[236:239], v2 offset:57344
s_waitcnt lgkmcnt(4)
v_mfma_f32_16x16x32_bf16 v[48:51], a[216:219], a[32:35], v[48:51]
ds_read_b128 a[240:243], v2 offset:53248
v_mfma_f32_16x16x32_bf16 v[48:51], a[220:223], a[36:39], v[48:51]
ds_read_b128 a[244:247], v2 offset:58368
buffer_load_dwordx4 v3, s[8:11], 0 offen offset:3072 sc1 lds
s_waitcnt vmcnt(15)
s_waitcnt lgkmcnt(4)
v_mfma_f32_16x16x32_bf16 v[32:35], a[224:227], a[40:43], v[32:35]
ds_read_b128 a[216:219], v2 offset:54272
v_mfma_f32_16x16x32_bf16 v[32:35], a[228:231], a[44:47], v[32:35]
ds_read_b128 a[220:223], v2 offset:59392
s_waitcnt lgkmcnt(4)
v_mfma_f32_16x16x32_bf16 v[36:39], a[232:235], a[40:43], v[36:39]
ds_read_b128 a[224:227], v2 offset:55296
v_mfma_f32_16x16x32_bf16 v[36:39], a[236:239], a[44:47], v[36:39]
ds_read_b128 a[228:231], v2 offset:60416
s_add_u32 m0, s22, 102400
v_add_u32 v3, 4096, v3
buffer_load_dwordx4 v3, s[8:11], 0 offen offset:0 sc1 lds
s_waitcnt lgkmcnt(4)
v_mfma_f32_16x16x32_bf16 v[40:43], a[240:243], a[40:43], v[40:43]
ds_read_b128 a[232:235], v2 offset:61440
v_mfma_f32_16x16x32_bf16 v[40:43], a[244:247], a[44:47], v[40:43]
ds_read_b128 a[236:239], v5 offset:1024
s_waitcnt lgkmcnt(4)
v_mfma_f32_16x16x32_bf16 v[44:47], a[216:219], a[40:43], v[44:47]
ds_read_b128 a[240:243], v2 offset:62464
v_mfma_f32_16x16x32_bf16 v[44:47], a[220:223], a[44:47], v[44:47]
ds_read_b128 a[244:247], v5 offset:2048
buffer_load_dwordx4 v3, s[8:11], 0 offen offset:1024 sc1 lds
s_waitcnt lgkmcnt(4)
v_mfma_f32_16x16x32_bf16 v[48:51], a[224:227], a[40:43], v[48:51]
ds_read_b128 a[216:219], v2 offset:63488
v_mfma_f32_16x16x32_bf16 v[48:51], a[228:231], a[44:47], v[48:51]
ds_read_b128 a[220:223], v5 offset:3072
s_waitcnt vmcnt(15)
s_waitcnt lgkmcnt(4)
v_mfma_f32_16x16x32_bf16 v[32:35], a[232:235], a[48:51], v[32:35]
ds_read_b128 a[224:227], v2 offset:64512
v_mfma_f32_16x16x32_bf16 v[32:35], a[236:239], a[52:55], v[32:35]
ds_read_b128 a[228:231], v5 offset:4096
s_add_u32 m0, s22, 122880
v_add_u32 v3, 20480, v3
buffer_load_dwordx4 v3, s[8:11], 0 offen offset:0 sc1 lds
s_waitcnt lgkmcnt(4)
v_mfma_f32_16x16x32_bf16 v[36:39], a[240:243], a[48:51], v[36:39]
ds_read_b128 a[232:235], v5 offset:0
v_mfma_f32_16x16x32_bf16 v[36:39], a[244:247], a[52:55], v[36:39]
ds_read_b128 a[236:239], v5 offset:5120
s_waitcnt lgkmcnt(4)
v_mfma_f32_16x16x32_bf16 v[40:43], a[216:219], a[48:51], v[40:43]
ds_read_b128 a[240:243], v5 offset:6144
v_mfma_f32_16x16x32_bf16 v[40:43], a[220:223], a[52:55], v[40:43]
ds_read_b128 a[244:247], v5 offset:11264
buffer_load_dwordx4 v3, s[8:11], 0 offen offset:1024 sc1 lds
s_waitcnt lgkmcnt(4)
v_mfma_f32_16x16x32_bf16 v[44:47], a[224:227], a[48:51], v[44:47]
ds_read_b128 a[216:219], v5 offset:7168
L_hop2:
s_cmp_eq_u32 s15, 1
s_cbranch_scc1 L_hop6
v_mfma_f32_16x16x32_bf16 v[44:47], a[228:231], a[52:55], v[44:47]
ds_read_b128 a[220:223], v5 offset:12288
s_waitcnt lgkmcnt(4)
v_mfma_f32_16x16x32_bf16 v[48:51], a[232:235], a[48:51], v[48:51]
ds_read_b128 a[224:227], v5 offset:8192
v_mfma_f32_16x16x32_bf16 v[48:51], a[236:239], a[52:55], v[48:51]
ds_read_b128 a[228:231], v5 offset:13312
buffer_load_dwordx4 v3, s[8:11], 0 offen offset:2048 sc1 lds
s_waitcnt vmcnt(16)
s_waitcnt lgkmcnt(4)
v_mfma_f32_16x16x32_bf16 v[32:35], a[240:243], a[56:59], v[32:35]
ds_read_b128 a[232:235], v5 offset:9216
v_mfma_f32_16x16x32_bf16 v[32:35], a[244:247], a[60:63], v[32:35]
ds_read_b128 a[236:239], v5 offset:14336
s_waitcnt lgkmcnt(4)
v_mfma_f32_16x16x32_bf16 v[36:39], a[216:219], a[56:59], v[36:39]
ds_read_b128 a[240:243], v5 offset:10240
v_mfma_f32_16x16x32_bf16 v[36:39], a[220:223], a[60:63], v[36:39]
ds_read_b128 a[244:247], v5 offset:15360
buffer_load_dwordx4 v3, s[8:11], 0 offen offset:3072 sc1 lds
s_waitcnt lgkmcnt(4)
v_mfma_f32_16x16x32_bf16 v[40:43], a[224:227], a[56:59], v[40:43]
ds_read_b128 a[216:219], v5 offset:16384
v_mfma_f32_16x16x32_bf16 v[40:43], a[228:231], a[60:63], v[40:43]
ds_read_b128 a[220:223], v5 offset:21504
s_waitcnt lgkmcnt(4)
v_mfma_f32_16x16x32_bf16 v[44:47], a[232:235], a[56:59], v[44:47]
ds_read_b128 a[224:227], v5 offset:17408
v_mfma_f32_16x16x32_bf16 v[44:47], a[236:239], a[60:63], v[44:47]
ds_read_b128 a[228:231], v5 offset:22528
s_add_u32 m0, s22, 126976
v_add_u32 v3, 4096, v3
buffer_load_dwordx4 v3, s[8:11], 0 offen offset:0 sc1 lds
s_waitcnt lgkmcnt(4)
v_mfma_f32_16x16x32_bf16 v[48:51], a[240:243], a[56:59], v[48:51]
ds_read_b128 a[232:235], v5 offset:18432
v_mfma_f32_16x16x32_bf16 v[48:51], a[244:247], a[60:63], v[48:51]
ds_read_b128 a[236:239], v5 offset:23552
s_waitcnt vmcnt(14)
s_waitcnt lgkmcnt(4)
v_mfma_f32_16x16x32_bf16 v[32:35], a[216:219], a[64:67], v[32:35]
ds_read_b128 a[240:243], v5 offset:19456
v_mfma_f32_16x16x32_bf16 v[32:35], a[220:223], a[68:71], v[32:35]
ds_read_b128 a[244:247], v5 offset:24576
buffer_load_dwordx4 v3, s[8:11], 0 offen offset:1024 sc1 lds
s_waitcnt lgkmcnt(4)
v_mfma_f32_16x16x32_bf16 v[36:39], a[224:227], a[64:67], v[36:39]
ds_read_b128 a[216:219], v5 offset:20480
v_mfma_f32_16x16x32_bf16 v[36:39], a[228:231], a[68:71], v[36:39]
ds_read_b128 a[220:223], v5 offset:25600
s_waitcnt lgkmcnt(4)
v_mfma_f32_16x16x32_bf16 v[40:43], a[232:235], a[64:67], v[40:43]
v_mfma_f32_16x16x32_bf16 v[40:43], a[236:239], a[68:71], v[40:43]
s_waitcnt lgkmcnt(2)
v_mfma_f32_16x16x32_bf16 v[44:47], a[240:243], a[64:67], v[44:47]
v_mfma_f32_16x16x32_bf16 v[44:47], a[244:247], a[68:71], v[44:47]
s_waitcnt lgkmcnt(0)
v_mfma_f32_16x16x32_bf16 v[48:51], a[216:219], a[64:67], v[48:51]
v_mfma_f32_16x16x32_bf16 v[48:51], a[220:223], a[68:71], v[48:51]
s_waitcnt vmcnt(12)
v_lshlrev_b32 v68, 16, v56
v_and_b32 v69, 0xffff0000, v56
v_add_f32 v32, v32, v68
v_add_f32 v33, v33, v69
v_lshlrev_b32 v70, 16, v57
v_and_b32 v71, 0xffff0000, v57
v_add_f32 v34, v34, v70
v_add_f32 v35, v35, v71
v_lshlrev_b32 v72, 16, v58
v_and_b32 v73, 0xffff0000, v58
v_add_f32 v36, v36, v72
v_add_f32 v37, v37, v73
v_lshlrev_b32 v74, 16, v59
v_and_b32 v75, 0xffff0000, v59
v_add_f32 v38, v38, v74
v_add_f32 v39, v39, v75
v_lshlrev_b32 v68, 16, v60
v_and_b32 v69, 0xffff0000, v60
v_add_f32 v40, v40, v68
v_add_f32 v41, v41, v69
v_lshlrev_b32 v70, 16, v61
v_and_b32 v71, 0xffff0000, v61
v_add_f32 v42, v42, v70
v_add_f32 v43, v43, v71
v_lshlrev_b32 v72, 16, v62
v_and_b32 v73, 0xffff0000, v62
v_add_f32 v44, v44, v72
v_add_f32 v45, v45, v73
v_lshlrev_b32 v74, 16, v63
v_and_b32 v75, 0xffff0000, v63
v_add_f32 v46, v46, v74
v_add_f32 v47, v47, v75
v_lshlrev_b32 v68, 16, v64
v_and_b32 v69, 0xffff0000, v64
v_add_f32 v48, v48, v68
v_add_f32 v49, v49, v69
v_lshlrev_b32 v70, 16, v65
v_and_b32 v71, 0xffff0000, v65
v_add_f32 v50, v50, v70
v_add_f32 v51, v51, v71
v_cvt_pk_bf16_f32 v80, v32, v33
v_cvt_pk_bf16_f32 v81, v34, v35
v_cvt_pk_bf16_f32 v82, v36, v37
v_cvt_pk_bf16_f32 v83, v38, v39
v_cvt_pk_bf16_f32 v84, v40, v41
v_cvt_pk_bf16_f32 v85, v42, v43
v_cvt_pk_bf16_f32 v86, v44, v45
v_cvt_pk_bf16_f32 v87, v46, v47
v_cvt_pk_bf16_f32 v88, v48, v49
v_cvt_pk_bf16_f32 v89, v50, v51
s_add_u32 s27, s26, s73
buffer_store_dwordx4 v[80:83], v2, s[8:11], s27 offen sc1
buffer_store_dwordx4 v[84:87], v2, s[8:11], s27 offen offset:1024 sc1
buffer_store_dwordx2 v[88:89], v4, s[8:11], s27 offen sc1
v_add_f32 v10, v32, v33
v_mul_f32 v11, v32, v32
v_mul_f32 v13, v33, v33
v_mov_b32 v12, 0
v_add_f32 v10, v10, v34
v_add_f32 v12, v12, v35
v_fmac_f32 v11, v34, v34
v_fmac_f32 v13, v35, v35
v_add_f32 v10, v10, v36
v_add_f32 v12, v12, v37
v_fmac_f32 v11, v36, v36
v_fmac_f32 v13, v37, v37
v_add_f32 v10, v10, v38
v_add_f32 v12, v12, v39
v_fmac_f32 v11, v38, v38
v_fmac_f32 v13, v39, v39
v_add_f32 v10, v10, v40
v_add_f32 v12, v12, v41
v_fmac_f32 v11, v40, v40
v_fmac_f32 v13, v41, v41
v_add_f32 v10, v10, v42
v_add_f32 v12, v12, v43
v_fmac_f32 v11, v42, v42
v_fmac_f32 v13, v43, v43
v_add_f32 v10, v10, v44
v_add_f32 v12, v12, v45
v_fmac_f32 v11, v44, v44
v_fmac_f32 v13, v45, v45
v_add_f32 v10, v10, v46
v_add_f32 v12, v12, v47
v_fmac_f32 v11, v46, v46
v_fmac_f32 v13, v47, v47
v_add_f32 v10, v10, v48
v_add_f32 v12, v12, v49
v_fmac_f32 v11, v48, v48
v_fmac_f32 v13, v49, v49
v_add_f32 v10, v10, v50
v_add_f32 v12, v12, v51
v_fmac_f32 v11, v50, v50
v_fmac_f32 v13, v51, v51
v_add_f32 v10, v10, v12
v_add_f32 v11, v11, v13
v_mov_b32 v12, v10
v_mov_b32 v13, v11
s_nop 0
v_permlane16_swap_b32 v10, v12
v_permlane16_swap_b32 v11, v13
v_add_f32 v10, v10, v12
v_add_f32 v11, v11, v13
v_mov_b32 v12, v10
v_mov_b32 v13, v11
s_nop 0
v_permlane32_swap_b32 v10, v12
v_permlane32_swap_b32 v11, v13
v_add_f32 v10, v10, v12
v_add_f32 v11, v11, v13
v_lshlrev_b32 v8, 3, v6
v_cmp_gt_u32 vcc, 16, v1
s_nop 1
v_cndmask_b32 v8, v9, v8, vcc
s_lshl_b32 s27, s20, 10
s_lshl_b32 s28, s21, 7
s_add_u32 s27, s27, s28
s_add_u32 s27, s27, s74
buffer_store_dwordx2 v[10:11], v8, s[8:11], s27 offen sc1
s_lshr_b32 s27, s20, 2
s_lshl_b32 s27, s27, 3
s_add_u32 s27, s27, s21
s_lshl_b32 s14, s27, 7
s_add_u32 s14, s14, 524288
s_add_u32 s14, s14, s77
s_lshl_b32 s44, s40, 4
s_lshl_b32 s45, s4, 2
s_add_u32 s44, s44, s45
s_mul_i32 s46, s44, 18432
s_add_u32 s20, s46, s73
v_add_u32 v4, 18432, v2
v_add_u32 v5, 36864, v2
v_add_u32 v6, 55296, v2
v_lshlrev_b32 v248, 3, v1
v_add_u32 v249, 18432, v248
v_add_u32 v250, 36864, v248
v_add_u32 v251, 55296, v248
v_and_b32 v13, 15, v1
v_lshrrev_b32 v14, 4, v1
v_add_u32 v7, 0x10000, v2
v_add_u32 v8, 0x20000, v2
v_and_b32 v9, 1, v14
v_mul_u32_u24 v9, 18432, v9
v_lshrrev_b32 v15, 1, v14
v_lshlrev_b32 v15, 8, v15
v_lshl_add_u32 v15, v13, 4, v15
v_add_u32 v9, v9, v15
v_and_b32 v11, 3, v1
v_lshlrev_b32 v11, 7, v11
s_lshl_b32 s49, s43, 7
v_mov_b32 v10, 2146435072
v_lshl_add_u32 v15, v1, 3, s49
v_cmp_gt_u32 vcc, 16, v1
s_nop 1
v_cndmask_b32 v10, v10, v15, vcc
s_lshl_b32 s49, s40, 3
s_add_u32 s49, s49, s42
s_lshl_b32 s50, s49, 2
s_add_u32 s50, s50, s4
s_lshl_b32 s50, s50, 9
s_add_u32 s34, s50, s77
s_add_u32 s34, s34, 0
s_lshl_b32 s49, s49, 4
s_add_u32 s49, s49, s45
s_mul_i32 s49, s49, 18432
s_add_u32 s49, s49, s75
s_add_u32 s50, s43, 0
s_and_b32 s50, s50, 3
s_mul_i32 s50, s50, 9
s_add_u32 s50, s50, 1
s_lshr_b32 s50, s50, 1
s_lshl_b32 s50, s50, 10
s_add_u32 s24, s49, s50
s_add_u32 s50, s43, 1
s_and_b32 s50, s50, 3
s_mul_i32 s50, s50, 9
s_add_u32 s50, s50, 1
s_lshr_b32 s50, s50, 1
s_lshl_b32 s50, s50, 10
s_add_u32 s25, s49, s50
s_add_u32 s50, s43, 2
s_and_b32 s50, s50, 3
s_mul_i32 s50, s50, 9
s_add_u32 s50, s50, 1
s_lshr_b32 s50, s50, 1
s_lshl_b32 s50, s50, 10
s_add_u32 s26, s49, s50
s_add_u32 s50, s43, 3
s_and_b32 s50, s50, 3
s_mul_i32 s50, s50, 9
s_add_u32 s50, s50, 1
s_lshr_b32 s50, s50, 1
s_lshl_b32 s50, s50, 10
s_add_u32 s27, s49, s50
s_add_u32 s28, s49, 4096
s_add_u32 s29, s49, 13312
s_cmp_ge_u32 s43, 2
s_cselect_b32 s50, s29, s28
s_and_b32 s51, s43, 1
s_lshl_b32 s51, s51, 9
s_add_u32 s30, s50, s51
s_mul_i32 s50, s42, 2359296
s_add_u32 s50, s50, s46
s_add_u32 s50, s50, s76
s_lshl_b32 s51, s43, 12
s_add_u32 s31, s50, s51
s_lshl_b32 s51, s43, 9
s_add_u32 s50, s50, s51
s_add_u32 s32, s50, 16384
s_add_u32 s33, s32, 36864
s_add_u32 s36, s31, 0
s_add_u32 s37, s31, 18432
s_add_u32 s38, s31, 36864
s_add_u32 s39, s31, 55296
v_lshlrev_b32 v252, 4, v13
v_lshl_add_u32 v252, v14, 9, v252
s_lshl_b32 s35, s40, 5
s_add_u32 s35, s35, s41
s_lshl_b32 s35, s35, 7
s_add_u32 s35, s35, s77
s_add_u32 s35, s35, 655360
v_lshlrev_b32 v17, 3, v13
v_lshl_add_u32 v17, v14, 8, v17
s_lshl_b32 s47, s44, 10
s_add_u32 s47, s47, s74
s_lshl_b32 s49, s44, 8
s_add_u32 s49, s49, s77
s_add_u32 s49, s49, 524288
v_and_b32 v16, 7, v1
v_lshlrev_b32 v16, 7, v16
s_lshl_b32 s50, s43, 7
s_add_u32 s44, s35, 262144
s_sub_u32 s44, s44, s50
s_cmp_eq_u32 s4, 0
s_cselect_b32 s44, s44, 2146435072
v_mov_b32 v13, 2146435072
v_cmp_gt_u32 vcc, 16, v0
v_lshlrev_b32 v14, 3, v0
s_nop 0
v_cndmask_b32 v13, v13, v14, vcc
v_mov_b32 v14, s68
v_mov_b32 v15, s69
s_waitcnt vmcnt(0)
s_barrier
buffer_store_dwordx2 v[14:15], v13, s[8:11], s14 offen sc1
s_add_u32 m0, s22, 0
v_add_u32 v3, 20480, v3
buffer_load_dwordx4 v3, s[8:11], 0 offen offset:0 sc1 lds
buffer_load_dwordx4 v3, s[8:11], 0 offen offset:1024 sc1 lds
buffer_load_dwordx4 v3, s[8:11], 0 offen offset:2048 sc1 lds
buffer_load_dwordx4 v3, s[8:11], 0 offen offset:3072 sc1 lds
s_add_u32 m0, s22, 4096
v_add_u32 v3, 4096, v3
buffer_load_dwordx4 v3, s[8:11], 0 offen offset:0 sc1 lds
buffer_load_dwordx4 v3, s[8:11], 0 offen offset:1024 sc1 lds
s_add_u32 m0, s22, 24576
v_add_u32 v3, 20480, v3
buffer_load_dwordx4 v3, s[8:11], 0 offen offset:0 sc1 lds
buffer_load_dwordx4 v3, s[8:11], 0 offen offset:1024 sc1 lds
buffer_load_dwordx4 v3, s[8:11], 0 offen offset:2048 sc1 lds
buffer_load_dwordx4 v3, s[8:11], 0 offen offset:3072 sc1 lds
s_add_u32 m0, s22, 28672
v_add_u32 v3, 4096, v3
buffer_load_dwordx4 v3, s[8:11], 0 offen offset:0 sc1 lds
buffer_load_dwordx4 v3, s[8:11], 0 offen offset:1024 sc1 lds
ds_read_b128 v[48:51], v7 offset:32768
ds_read_b128 v[52:55], v7 offset:33792
ds_read_b128 v[56:59], v7 offset:34816
ds_read_b128 v[60:63], v7 offset:35840
ds_read_b128 v[64:67], v7 offset:36864
ds_read_b128 v[68:71], v7 offset:37888
s_mov_b32 s52, 0
L_poll3:
buffer_load_dwordx2 v[14:15], v16, s[8:11], s49 offen sc1
s_add_u32 s52, s52, 1
s_waitcnt vmcnt(0)
v_cmp_ne_u64 vcc, s[68:69], v[14:15]
s_cmp_ge_u32 s52, 1048576
s_cbranch_scc1 L_got3
s_and_b64 exec, exec, vcc
s_cbranch_execnz L_poll3
L_got3:
s_mov_b64 exec, -1
s_add_u32 s48, s20, 0
buffer_load_dwordx4 a[0:3], v2, s[8:11], s48 offen offset:0 sc1
buffer_load_dwordx4 a[4:7], v4, s[8:11], s48 offen offset:0 sc1
buffer_load_dwordx4 a[8:11], v5, s[8:11], s48 offen offset:0 sc1
buffer_load_dwordx4 a[12:15], v6, s[8:11], s48 offen offset:0 sc1
buffer_load_dwordx4 a[16:19], v2, s[8:11], s48 offen offset:1024 sc1
buffer_load_dwordx4 a[20:23], v4, s[8:11], s48 offen offset:1024 sc1
buffer_load_dwordx4 a[24:27], v5, s[8:11], s48 offen offset:1024 sc1
buffer_load_dwordx4 a[28:31], v6, s[8:11], s48 offen offset:1024 sc1
buffer_load_dwordx2 v[144:145], v17, s[8:11], s47 offen offset:0 sc1
buffer_load_dwordx2 v[146:147], v17, s[8:11], s47 offen offset:128 sc1
buffer_load_dwordx2 v[148:149], v17, s[8:11], s47 offen offset:1024 sc1
buffer_load_dwordx2 v[150:151], v17, s[8:11], s47 offen offset:1152 sc1
buffer_load_dwordx2 v[152:153], v17, s[8:11], s47 offen offset:2048 sc1
buffer_load_dwordx2 v[154:155], v17, s[8:11], s47 offen offset:2176 sc1
buffer_load_dwordx2 v[156:157], v17, s[8:11], s47 offen offset:3072 sc1
buffer_load_dwordx2 v[158:159], v17, s[8:11], s47 offen offset:3200 sc1
buffer_load_dwordx4 a[32:35], v2, s[8:11], s48 offen offset:2048 sc1
buffer_load_dwordx4 a[36:39], v4, s[8:11], s48 offen offset:2048 sc1
buffer_load_dwordx4 a[40:43], v5, s[8:11], s48 offen offset:2048 sc1
buffer_load_dwordx4 a[44:47], v6, s[8:11], s48 offen offset:2048 sc1
buffer_load_dwordx4 a[48:51], v2, s[8:11], s48 offen offset:3072 sc1
buffer_load_dwordx4 a[52:55], v4, s[8:11], s48 offen offset:3072 sc1
buffer_load_dwordx4 a[56:59], v5, s[8:11], s48 offen offset:3072 sc1
buffer_load_dwordx4 a[60:63], v6, s[8:11], s48 offen offset:3072 sc1
s_add_u32 s48, s20, 4096
buffer_load_dwordx4 a[64:67], v2, s[8:11], s48 offen offset:0 sc1
buffer_load_dwordx4 a[68:71], v4, s[8:11], s48 offen offset:0 sc1
buffer_load_dwordx4 a[72:75], v5, s[8:11], s48 offen offset:0 sc1
buffer_load_dwordx4 a[76:79], v6, s[8:11], s48 offen offset:0 sc1
s_waitcnt vmcnt(20)
s_waitcnt lgkmcnt(4)
v_mfma_f32_16x16x32_bf16 v[80:83], v[48:51], a[0:3], 0
buffer_load_dwordx4 a[80:83], v2, s[8:11], s48 offen offset:1024 sc1
v_mfma_f32_16x16x32_bf16 v[80:83], v[52:55], a[16:19], v[80:83]
v_mfma_f32_16x16x32_bf16 v[84:87], v[48:51], a[4:7], 0
ds_read_b128 v[72:75], v7 offset:38912
v_mfma_f32_16x16x32_bf16 v[84:87], v[52:55], a[20:23], v[84:87]
v_mfma_f32_16x16x32_bf16 v[88:91], v[48:51], a[8:11], 0
buffer_load_dwordx4 a[84:87], v4, s[8:11], s48 offen offset:1024 sc1
v_mfma_f32_16x16x32_bf16 v[88:91], v[52:55], a[24:27], v[88:91]
ds_read_b128 v[76:79], v7 offset:39936
v_mfma_f32_16x16x32_bf16 v[92:95], v[48:51], a[12:15], 0
v_mfma_f32_16x16x32_bf16 v[92:95], v[52:55], a[28:31], v[92:95]
s_waitcnt lgkmcnt(4)
v_mfma_f32_16x16x32_bf16 v[96:99], v[56:59], a[0:3], 0
buffer_load_dwordx4 a[88:91], v5, s[8:11], s48 offen offset:1024 sc1
v_mfma_f32_16x16x32_bf16 v[96:99], v[60:63], a[16:19], v[96:99]
v_mfma_f32_16x16x32_bf16 v[100:103], v[56:59], a[4:7], 0
ds_read_b128 v[48:51], v7 offset:40960
v_mfma_f32_16x16x32_bf16 v[100:103], v[60:63], a[20:23], v[100:103]
v_mfma_f32_16x16x32_bf16 v[104:107], v[56:59], a[8:11], 0
buffer_load_dwordx4 a[92:95], v6, s[8:11], s48 offen offset:1024 sc1
v_mfma_f32_16x16x32_bf16 v[104:107], v[60:63], a[24:27], v[104:107]
ds_read_b128 v[52:55], v7 offset:41984
v_mfma_f32_16x16x32_bf16 v[108:111], v[56:59], a[12:15], 0
v_mfma_f32_16x16x32_bf16 v[108:111], v[60:63], a[28:31], v[108:111]
s_waitcnt lgkmcnt(4)
v_mfma_f32_16x16x32_bf16 v[112:115], v[64:67], a[0:3], 0
buffer_load_dwordx4 a[96:99], v2, s[8:11], s48 offen offset:2048 sc1
v_mfma_f32_16x16x32_bf16 v[112:115], v[68:71], a[16:19], v[112:115]
v_mfma_f32_16x16x32_bf16 v[116:119], v[64:67], a[4:7], 0
ds_read_b128 v[56:59], v7 offset:43008
v_mfma_f32_16x16x32_bf16 v[116:119], v[68:71], a[20:23], v[116:119]
v_mfma_f32_16x16x32_bf16 v[120:123], v[64:67], a[8:11], 0
buffer_load_dwordx4 a[100:103], v4, s[8:11], s48 offen offset:2048 sc1
v_mfma_f32_16x16x32_bf16 v[120:123], v[68:71], a[24:27], v[120:123]
ds_read_b128 v[60:63], v7 offset:44032
v_mfma_f32_16x16x32_bf16 v[124:127], v[64:67], a[12:15], 0
v_mfma_f32_16x16x32_bf16 v[124:127], v[68:71], a[28:31], v[124:127]
s_waitcnt lgkmcnt(4)
v_mfma_f32_16x16x32_bf16 v[128:131], v[72:75], a[0:3], 0
buffer_load_dwordx4 a[104:107], v5, s[8:11], s48 offen offset:2048 sc1
v_mfma_f32_16x16x32_bf16 v[128:131], v[76:79], a[16:19], v[128:131]
v_mfma_f32_16x16x32_bf16 v[132:135], v[72:75], a[4:7], 0
ds_read_b128 v[64:67], v7 offset:45056
v_mfma_f32_16x16x32_bf16 v[132:135], v[76:79], a[20:23], v[132:135]
v_mfma_f32_16x16x32_bf16 v[136:139], v[72:75], a[8:11], 0
buffer_load_dwordx4 a[108:111], v6, s[8:11], s48 offen offset:2048 sc1
v_mfma_f32_16x16x32_bf16 v[136:139], v[76:79], a[24:27], v[136:139]
ds_read_b128 v[68:71], v7 offset:46080
v_mfma_f32_16x16x32_bf16 v[140:143], v[72:75], a[12:15], 0
v_mfma_f32_16x16x32_bf16 v[140:143], v[76:79], a[28:31], v[140:143]
s_waitcnt vmcnt(12)
s_waitcnt lgkmcnt(4)
v_mfma_f32_16x16x32_bf16 v[80:83], v[48:51], a[32:35], v[80:83]
buffer_load_dwordx4 a[112:115], v2, s[8:11], s48 offen offset:3072 sc1
v_mfma_f32_16x16x32_bf16 v[80:83], v[52:55], a[48:51], v[80:83]
v_mfma_f32_16x16x32_bf16 v[84:87], v[48:51], a[36:39], v[84:87]
ds_read_b128 v[72:75], v7 offset:47104
v_mfma_f32_16x16x32_bf16 v[84:87], v[52:55], a[52:55], v[84:87]
v_mfma_f32_16x16x32_bf16 v[88:91], v[48:51], a[40:43], v[88:91]
buffer_load_dwordx4 a[116:119], v4, s[8:11], s48 offen offset:3072 sc1
v_mfma_f32_16x16x32_bf16 v[88:91], v[52:55], a[56:59], v[88:91]
ds_read_b128 v[76:79], v7 offset:48128
v_mfma_f32_16x16x32_bf16 v[92:95], v[48:51], a[44:47], v[92:95]
v_mfma_f32_16x16x32_bf16 v[92:95], v[52:55], a[60:63], v[92:95]
s_waitcnt lgkmcnt(4)
v_mfma_f32_16x16x32_bf16 v[96:99], v[56:59], a[32:35], v[96:99]
buffer_load_dwordx4 a[120:123], v5, s[8:11], s48 offen offset:3072 sc1
v_mfma_f32_16x16x32_bf16 v[96:99], v[60:63], a[48:51], v[96:99]
v_mfma_f32_16x16x32_bf16 v[100:103], v[56:59], a[36:39], v[100:103]
ds_read_b128 v[48:51], v7 offset:49152
v_mfma_f32_16x16x32_bf16 v[100:103], v[60:63], a[52:55], v[100:103]
v_mfma_f32_16x16x32_bf16 v[104:107], v[56:59], a[40:43], v[104:107]
buffer_load_dwordx4 a[124:127], v6, s[8:11], s48 offen offset:3072 sc1
v_mfma_f32_16x16x32_bf16 v[104:107], v[60:63], a[56:59], v[104:107]
ds_read_b128 v[52:55], v7 offset:50176
s_add_u32 s48, s20, 8192
v_mfma_f32_16x16x32_bf16 v[108:111], v[56:59], a[44:47], v[108:111]
v_mfma_f32_16x16x32_bf16 v[108:111], v[60:63], a[60:63], v[108:111]
s_waitcnt lgkmcnt(4)
v_mfma_f32_16x16x32_bf16 v[112:115], v[64:67], a[32:35], v[112:115]
buffer_load_dwordx4 a[128:131], v2, s[8:11], s48 offen offset:0 sc1
v_mfma_f32_16x16x32_bf16 v[112:115], v[68:71], a[48:51], v[112:115]
v_mfma_f32_16x16x32_bf16 v[116:119], v[64:67], a[36:39], v[116:119]
ds_read_b128 v[56:59], v7 offset:51200
v_mfma_f32_16x16x32_bf16 v[116:119], v[68:71], a[52:55], v[116:119]
v_mfma_f32_16x16x32_bf16 v[120:123], v[64:67], a[40:43], v[120:123]
buffer_load_dwordx4 a[132:135], v4, s[8:11], s48 offen offset:0 sc1
v_mfma_f32_16x16x32_bf16 v[120:123], v[68:71], a[56:59], v[120:123]
ds_read_b128 v[60:63], v7 offset:52224
v_mfma_f32_16x16x32_bf16 v[124:127], v[64:67], a[44:47], v[124:127]
v_mfma_f32_16x16x32_bf16 v[124:127], v[68:71], a[60:63], v[124:127]
s_waitcnt lgkmcnt(4)
v_mfma_f32_16x16x32_bf16 v[128:131], v[72:75], a[32:35], v[128:131]
buffer_load_dwordx4 a[136:139], v5, s[8:11], s48 offen offset:0 sc1
v_mfma_f32_16x16x32_bf16 v[128:131], v[76:79], a[48:51], v[128:131]
v_mfma_f32_16x16x32_bf16 v[132:135], v[72:75], a[36:39], v[132:135]
ds_read_b128 v[64:67], v7 offset:53248
v_mfma_f32_16x16x32_bf16 v[132:135], v[76:79], a[52:55], v[132:135]
v_mfma_f32_16x16x32_bf16 v[136:139], v[72:75], a[40:43], v[136:139]
buffer_load_dwordx4 a[140:143], v6, s[8:11], s48 offen offset:0 sc1
v_mfma_f32_16x16x32_bf16 v[136:139], v[76:79], a[56:59], v[136:139]
ds_read_b128 v[68:71], v7 offset:54272
v_mfma_f32_16x16x32_bf16 v[140:143], v[72:75], a[44:47], v[140:143]
v_mfma_f32_16x16x32_bf16 v[140:143], v[76:79], a[60:63], v[140:143]
s_waitcnt vmcnt(12)
s_waitcnt lgkmcnt(4)
v_mfma_f32_16x16x32_bf16 v[80:83], v[48:51], a[64:67], v[80:83]
buffer_load_dwordx4 a[144:147], v2, s[8:11], s48 offen offset:1024 sc1
v_mfma_f32_16x16x32_bf16 v[80:83], v[52:55], a[80:83], v[80:83]
v_mfma_f32_16x16x32_bf16 v[84:87], v[48:51], a[68:71], v[84:87]
ds_read_b128 v[72:75], v7 offset:55296
v_mfma_f32_16x16x32_bf16 v[84:87], v[52:55], a[84:87], v[84:87]
v_add_f32 v144, v144, v146
v_add_f32 v145, v145, v147
v_mfma_f32_16x16x32_bf16 v[88:91], v[48:51], a[72:75], v[88:91]
buffer_load_dwordx4 a[148:151], v4, s[8:11], s48 offen offset:1024 sc1
v_mfma_f32_16x16x32_bf16 v[88:91], v[52:55], a[88:91], v[88:91]
ds_read_b128 v[76:79], v7 offset:56320
v_add_f32 v148, v148, v150
v_mfma_f32_16x16x32_bf16 v[92:95], v[48:51], a[76:79], v[92:95]
v_add_f32 v149, v149, v151
v_add_f32 v152, v152, v154
v_mfma_f32_16x16x32_bf16 v[92:95], v[52:55], a[92:95], v[92:95]
v_add_f32 v153, v153, v155
s_waitcnt lgkmcnt(4)
v_mfma_f32_16x16x32_bf16 v[96:99], v[56:59], a[64:67], v[96:99]
buffer_load_dwordx4 a[152:155], v5, s[8:11], s48 offen offset:1024 sc1
v_mfma_f32_16x16x32_bf16 v[96:99], v[60:63], a[80:83], v[96:99]
s_barrier
v_mfma_f32_16x16x32_bf16 v[100:103], v[56:59], a[68:71], v[100:103]
ds_read_b128 v[48:51], v7 offset:57344
v_add_f32 v156, v156, v158
v_mfma_f32_16x16x32_bf16 v[100:103], v[60:63], a[84:87], v[100:103]
v_add_f32 v157, v157, v159
v_mov_b32 v160, v144
v_mfma_f32_16x16x32_bf16 v[104:107], v[56:59], a[72:75], v[104:107]
buffer_load_dwordx4 a[156:159], v6, s[8:11], s48 offen offset:1024 sc1
v_mfma_f32_16x16x32_bf16 v[104:107], v[60:63], a[88:91], v[104:107]
ds_read_b128 v[52:55], v7 offset:58368
v_mov_b32 v161, v145
v_mfma_f32_16x16x32_bf16 v[108:111], v[56:59], a[76:79], v[108:111]
v_mov_b32 v162, v148
v_mov_b32 v163, v149
v_mfma_f32_16x16x32_bf16 v[108:111], v[60:63], a[92:95], v[108:111]
v_mov_b32 v164, v152
s_waitcnt lgkmcnt(4)
v_mfma_f32_16x16x32_bf16 v[112:115], v[64:67], a[64:67], v[112:115]
buffer_load_dwordx4 a[160:163], v2, s[8:11], s48 offen offset:2048 sc1
v_mfma_f32_16x16x32_bf16 v[112:115], v[68:71], a[80:83], v[112:115]
v_mov_b32 v165, v153
v_mov_b32 v166, v156
v_mfma_f32_16x16x32_bf16 v[116:119], v[64:67], a[68:71], v[116:119]
ds_read_b128 v[56:59], v7 offset:59392
v_mov_b32 v167, v157
v_mfma_f32_16x16x32_bf16 v[116:119], v[68:71], a[84:87], v[116:119]
v_permlane16_swap_b32 v144, v160
v_permlane16_swap_b32 v145, v161
v_mfma_f32_16x16x32_bf16 v[120:123], v[64:67], a[72:75], v[120:123]
buffer_load_dwordx4 a[164:167], v4, s[8:11], s48 offen offset:2048 sc1
v_mfma_f32_16x16x32_bf16 v[120:123], v[68:71], a[88:91], v[120:123]
ds_read_b128 v[60:63], v7 offset:60416
v_permlane16_swap_b32 v148, v162
v_mfma_f32_16x16x32_bf16 v[124:127], v[64:67], a[76:79], v[124:127]
v_permlane16_swap_b32 v149, v163
v_permlane16_swap_b32 v152, v164
v_mfma_f32_16x16x32_bf16 v[124:127], v[68:71], a[92:95], v[124:127]
v_permlane16_swap_b32 v153, v165
s_waitcnt lgkmcnt(4)
v_mfma_f32_16x16x32_bf16 v[128:131], v[72:75], a[64:67], v[128:131]
buffer_load_dwordx4 a[168:171], v5, s[8:11], s48 offen offset:2048 sc1
v_mfma_f32_16x16x32_bf16 v[128:131], v[76:79], a[80:83], v[128:131]
v_permlane16_swap_b32 v156, v166
v_permlane16_swap_b32 v157, v167
v_mfma_f32_16x16x32_bf16 v[132:135], v[72:75], a[68:71], v[132:135]
ds_read_b128 v[64:67], v7 offset:61440
v_add_f32 v144, v144, v160
v_mfma_f32_16x16x32_bf16 v[132:135], v[76:79], a[84:87], v[132:135]
v_add_f32 v145, v145, v161
v_add_f32 v148, v148, v162
v_mfma_f32_16x16x32_bf16 v[136:139], v[72:75], a[72:75], v[136:139]
buffer_load_dwordx4 a[172:175], v6, s[8:11], s48 offen offset:2048 sc1
v_mfma_f32_16x16x32_bf16 v[136:139], v[76:79], a[88:91], v[136:139]
ds_read_b128 v[68:71], v7 offset:62464
v_add_f32 v149, v149, v163
v_mfma_f32_16x16x32_bf16 v[140:143], v[72:75], a[76:79], v[140:143]
v_add_f32 v152, v152, v164
v_add_f32 v153, v153, v165
v_mfma_f32_16x16x32_bf16 v[140:143], v[76:79], a[92:95], v[140:143]
v_add_f32 v156, v156, v166
s_waitcnt vmcnt(12)
s_waitcnt lgkmcnt(4)
v_mfma_f32_16x16x32_bf16 v[80:83], v[48:51], a[96:99], v[80:83]
buffer_load_dwordx4 a[176:179], v2, s[8:11], s48 offen offset:3072 sc1
v_mfma_f32_16x16x32_bf16 v[80:83], v[52:55], a[112:115], v[80:83]
v_add_f32 v157, v157, v167
v_mov_b32 v160, v144
v_mfma_f32_16x16x32_bf16 v[84:87], v[48:51], a[100:103], v[84:87]
ds_read_b128 v[72:75], v7 offset:63488
v_mov_b32 v161, v145
v_mfma_f32_16x16x32_bf16 v[84:87], v[52:55], a[116:119], v[84:87]
v_mov_b32 v162, v148
v_mov_b32 v163, v149
v_mfma_f32_16x16x32_bf16 v[88:91], v[48:51], a[104:107], v[88:91]
buffer_load_dwordx4 a[180:183], v4, s[8:11], s48 offen offset:3072 sc1
v_mfma_f32_16x16x32_bf16 v[88:91], v[52:55], a[120:123], v[88:91]
ds_read_b128 v[76:79], v7 offset:64512
v_mov_b32 v164, v152
v_mfma_f32_16x16x32_bf16 v[92:95], v[48:51], a[108:111], v[92:95]
v_mov_b32 v165, v153
v_mov_b32 v166, v156
v_mfma_f32_16x16x32_bf16 v[92:95], v[52:55], a[124:127], v[92:95]
v_mov_b32 v167, v157
s_waitcnt lgkmcnt(4)
v_mfma_f32_16x16x32_bf16 v[96:99], v[56:59], a[96:99], v[96:99]
buffer_load_dwordx4 a[184:187], v5, s[8:11], s48 offen offset:3072 sc1
v_mfma_f32_16x16x32_bf16 v[96:99], v[60:63], a[112:115], v[96:99]
v_permlane32_swap_b32 v144, v160
v_permlane32_swap_b32 v145, v161
v_mfma_f32_16x16x32_bf16 v[100:103], v[56:59], a[100:103], v[100:103]
ds_read_b128 v[48:51], v8 offset:0
v_permlane32_swap_b32 v148, v162
v_mfma_f32_16x16x32_bf16 v[100:103], v[60:63], a[116:119], v[100:103]
v_permlane32_swap_b32 v149, v163
v_permlane32_swap_b32 v152, v164
v_mfma_f32_16x16x32_bf16 v[104:107], v[56:59], a[104:107], v[104:107]
buffer_load_dwordx4 a[188:191], v6, s[8:11], s48 offen offset:3072 sc1
v_mfma_f32_16x16x32_bf16 v[104:107], v[60:63], a[120:123], v[104:107]
ds_read_b128 v[52:55], v8 offset:1024
s_add_u32 s48, s20, 12288
v_mfma_f32_16x16x32_bf16 v[108:111], v[56:59], a[108:111], v[108:111]
v_permlane32_swap_b32 v153, v165
v_permlane32_swap_b32 v156, v166
v_mfma_f32_16x16x32_bf16 v[108:111], v[60:63], a[124:127], v[108:111]
v_permlane32_swap_b32 v157, v167
s_waitcnt lgkmcnt(4)
v_mfma_f32_16x16x32_bf16 v[112:115], v[64:67], a[96:99], v[112:115]
buffer_load_dwordx4 a[192:195], v2, s[8:11], s48 offen offset:0 sc1
v_mfma_f32_16x16x32_bf16 v[112:115], v[68:71], a[112:115], v[112:115]
v_add_f32 v144, v144, v160
v_add_f32 v145, v145, v161
v_mfma_f32_16x16x32_bf16 v[116:119], v[64:67], a[100:103], v[116:119]
ds_read_b128 v[56:59], v8 offset:2048
v_add_f32 v148, v148, v162
v_mfma_f32_16x16x32_bf16 v[116:119], v[68:71], a[116:119], v[116:119]
v_add_f32 v149, v149, v163
v_add_f32 v152, v152, v164
v_mfma_f32_16x16x32_bf16 v[120:123], v[64:67], a[104:107], v[120:123]
buffer_load_dwordx4 a[196:199], v4, s[8:11], s48 offen offset:0 sc1
v_mfma_f32_16x16x32_bf16 v[120:123], v[68:71], a[120:123], v[120:123]
ds_read_b128 v[60:63], v8 offset:3072
v_add_f32 v153, v153, v165
v_mfma_f32_16x16x32_bf16 v[124:127], v[64:67], a[108:111], v[124:127]
v_add_f32 v156, v156, v166
v_add_f32 v157, v157, v167
v_mfma_f32_16x16x32_bf16 v[124:127], v[68:71], a[124:127], v[124:127]
v_mul_f32 v144, 0x3ae38e39, v144
s_waitcnt lgkmcnt(4)
v_mfma_f32_16x16x32_bf16 v[128:131], v[72:75], a[96:99], v[128:131]
buffer_load_dwordx4 a[200:203], v5, s[8:11], s48 offen offset:0 sc1
v_mfma_f32_16x16x32_bf16 v[128:131], v[76:79], a[112:115], v[128:131]
v_mul_f32 v148, 0x3ae38e39, v148
v_mul_f32 v152, 0x3ae38e39, v152
v_mfma_f32_16x16x32_bf16 v[132:135], v[72:75], a[100:103], v[132:135]
ds_read_b128 v[64:67], v8 offset:4096
v_mul_f32 v156, 0x3ae38e39, v156
v_mfma_f32_16x16x32_bf16 v[132:135], v[76:79], a[116:119], v[132:135]
v_mul_f32 v145, 0x3ae38e39, v145
v_mul_f32 v149, 0x3ae38e39, v149
v_mfma_f32_16x16x32_bf16 v[136:139], v[72:75], a[104:107], v[136:139]
buffer_load_dwordx4 a[204:207], v6, s[8:11], s48 offen offset:0 sc1
v_mfma_f32_16x16x32_bf16 v[136:139], v[76:79], a[120:123], v[136:139]
ds_read_b128 v[68:71], v8 offset:5120
v_mul_f32 v153, 0x3ae38e39, v153
v_mfma_f32_16x16x32_bf16 v[140:143], v[72:75], a[108:111], v[140:143]
v_mul_f32 v157, 0x3ae38e39, v157
v_fma_f32 v145, -v144, v144, v145
v_mfma_f32_16x16x32_bf16 v[140:143], v[76:79], a[124:127], v[140:143]
v_fma_f32 v149, -v148, v148, v149
s_waitcnt vmcnt(12)
s_waitcnt lgkmcnt(4)
v_mfma_f32_16x16x32_bf16 v[80:83], v[48:51], a[128:131], v[80:83]
buffer_load_dwordx4 a[208:211], v2, s[8:11], s48 offen offset:1024 sc1
v_mfma_f32_16x16x32_bf16 v[80:83], v[52:55], a[144:147], v[80:83]
v_fma_f32 v153, -v152, v152, v153
L_hop3:
s_cmp_eq_u32 s15, 1
s_cbranch_scc1 L_hop7
v_fma_f32 v157, -v156, v156, v157
v_mfma_f32_16x16x32_bf16 v[84:87], v[48:51], a[132:135], v[84:87]
ds_read_b128 v[72:75], v8 offset:6144
v_max_f32 v145, 0, v145
v_mfma_f32_16x16x32_bf16 v[84:87], v[52:55], a[148:151], v[84:87]
v_max_f32 v149, 0, v149
v_max_f32 v153, 0, v153
v_mfma_f32_16x16x32_bf16 v[88:91], v[48:51], a[136:139], v[88:91]
buffer_load_dwordx4 a[212:215], v4, s[8:11], s48 offen offset:1024 sc1
v_mfma_f32_16x16x32_bf16 v[88:91], v[52:55], a[152:155], v[88:91]
ds_read_b128 v[76:79], v8 offset:7168
v_max_f32 v157, 0, v157
v_mfma_f32_16x16x32_bf16 v[92:95], v[48:51], a[140:143], v[92:95]
v_add_f32 v234, 0x3727c5ac, v145
v_add_f32 v238, 0x3727c5ac, v149
v_mfma_f32_16x16x32_bf16 v[92:95], v[52:55], a[156:159], v[92:95]
v_add_f32 v242, 0x3727c5ac, v153
s_waitcnt lgkmcnt(4)
v_mfma_f32_16x16x32_bf16 v[96:99], v[56:59], a[128:131], v[96:99]
buffer_load_dwordx4 a[216:219], v5, s[8:11], s48 offen offset:1024 sc1
v_mfma_f32_16x16x32_bf16 v[96:99], v[60:63], a[144:147], v[96:99]
v_add_f32 v246, 0x3727c5ac, v157
v_mfma_f32_16x16x32_bf16 v[100:103], v[56:59], a[132:135], v[100:103]
ds_read_b128 v[48:51], v8 offset:8192
v_mfma_f32_16x16x32_bf16 v[100:103], v[60:63], a[148:151], v[100:103]
v_rsq_f32 v144, v234
v_mfma_f32_16x16x32_bf16 v[104:107], v[56:59], a[136:139], v[104:107]
buffer_load_dwordx4 a[220:223], v6, s[8:11], s48 offen offset:1024 sc1
v_mfma_f32_16x16x32_bf16 v[104:107], v[60:63], a[152:155], v[104:107]
ds_read_b128 v[52:55], v8 offset:9216
v_mul_f32 v232, 0xc0135761, v144
v_mfma_f32_16x16x32_bf16 v[108:111], v[56:59], a[140:143], v[108:111]
v_rsq_f32 v148, v238
v_mfma_f32_16x16x32_bf16 v[108:111], v[60:63], a[156:159], v[108:111]
v_mul_f32 v236, 0xc0135761, v148
s_waitcnt lgkmcnt(4)
v_mfma_f32_16x16x32_bf16 v[112:115], v[64:67], a[128:131], v[112:115]
buffer_load_dwordx4 a[224:227], v2, s[8:11], s48 offen offset:2048 sc1
v_mfma_f32_16x16x32_bf16 v[112:115], v[68:71], a[144:147], v[112:115]
v_rsq_f32 v152, v242
v_mfma_f32_16x16x32_bf16 v[116:119], v[64:67], a[132:135], v[116:119]
ds_read_b128 v[56:59], v8 offset:10240
v_mul_f32 v240, 0xc0135761, v152
v_mfma_f32_16x16x32_bf16 v[116:119], v[68:71], a[148:151], v[116:119]
v_rsq_f32 v156, v246
v_mfma_f32_16x16x32_bf16 v[120:123], v[64:67], a[136:139], v[120:123]
buffer_load_dwordx4 a[228:231], v4, s[8:11], s48 offen offset:2048 sc1
v_mfma_f32_16x16x32_bf16 v[120:123], v[68:71], a[152:155], v[120:123]
ds_read_b128 v[60:63], v8 offset:11264
v_mul_f32 v244, 0xc0135761, v156
v_mfma_f32_16x16x32_bf16 v[124:127], v[64:67], a[140:143], v[124:127]
v_mul_f32 v145, v144, v144
v_mul_f32 v149, v148, v148
v_mfma_f32_16x16x32_bf16 v[124:127], v[68:71], a[156:159], v[124:127]
v_mul_f32 v153, v152, v152
s_waitcnt lgkmcnt(4)
v_mfma_f32_16x16x32_bf16 v[128:131], v[72:75], a[128:131], v[128:131]
buffer_load_dwordx4 a[232:235], v5, s[8:11], s48 offen offset:2048 sc1
v_mfma_f32_16x16x32_bf16 v[128:131], v[76:79], a[144:147], v[128:131]
v_mul_f32 v157, v156, v156
v_mul_f32 v145, v145, v144
v_mfma_f32_16x16x32_bf16 v[132:135], v[72:75], a[132:135], v[132:135]
ds_read_b128 v[64:67], v8 offset:12288
v_mul_f32 v149, v149, v148
v_mfma_f32_16x16x32_bf16 v[132:135], v[76:79], a[148:151], v[132:135]
v_mul_f32 v153, v153, v152
v_mul_f32 v157, v157, v156
v_mfma_f32_16x16x32_bf16 v[136:139], v[72:75], a[136:139], v[136:139]
buffer_load_dwordx4 a[236:239], v6, s[8:11], s48 offen offset:2048 sc1
v_mfma_f32_16x16x32_bf16 v[136:139], v[76:79], a[152:155], v[136:139]
ds_read_b128 v[68:71], v8 offset:13312
v_mul_f32 v233, 0xbdd2d3e8, v145
v_mfma_f32_16x16x32_bf16 v[140:143], v[72:75], a[140:143], v[140:143]
v_mul_f32 v237, 0xbdd2d3e8, v149
v_mul_f32 v241, 0xbdd2d3e8, v153
v_mfma_f32_16x16x32_bf16 v[140:143], v[76:79], a[156:159], v[140:143]
v_mul_f32 v245, 0xbdd2d3e8, v157
s_waitcnt vmcnt(12)
s_waitcnt lgkmcnt(4)
v_mfma_f32_16x16x32_bf16 v[80:83], v[48:51], a[160:163], v[80:83]
buffer_load_dwordx4 a[240:243], v2, s[8:11], s48 offen offset:3072 sc1
v_mfma_f32_16x16x32_bf16 v[80:83], v[52:55], a[176:179], v[80:83]
v_mfma_f32_16x16x32_bf16 v[84:87], v[48:51], a[164:167], v[84:87]
ds_read_b128 v[72:75], v8 offset:14336
v_mfma_f32_16x16x32_bf16 v[84:87], v[52:55], a[180:183], v[84:87]
v_mfma_f32_16x16x32_bf16 v[88:91], v[48:51], a[168:171], v[88:91]
buffer_load_dwordx4 a[244:247], v4, s[8:11], s48 offen offset:3072 sc1
v_mfma_f32_16x16x32_bf16 v[88:91], v[52:55], a[184:187], v[88:91]
ds_read_b128 v[76:79], v8 offset:15360
v_mfma_f32_16x16x32_bf16 v[92:95], v[48:51], a[172:175], v[92:95]
v_mfma_f32_16x16x32_bf16 v[92:95], v[52:55], a[188:191], v[92:95]
s_waitcnt lgkmcnt(4)
v_mfma_f32_16x16x32_bf16 v[96:99], v[56:59], a[160:163], v[96:99]
buffer_load_dwordx4 a[248:251], v5, s[8:11], s48 offen offset:3072 sc1
v_mfma_f32_16x16x32_bf16 v[96:99], v[60:63], a[176:179], v[96:99]
s_barrier
v_mfma_f32_16x16x32_bf16 v[100:103], v[56:59], a[164:167], v[100:103]
ds_read_b128 v[48:51], v2 offset:0
v_mfma_f32_16x16x32_bf16 v[100:103], v[60:63], a[180:183], v[100:103]
v_mfma_f32_16x16x32_bf16 v[104:107], v[56:59], a[168:171], v[104:107]
buffer_load_dwordx4 a[252:255], v6, s[8:11], s48 offen offset:3072 sc1
v_mfma_f32_16x16x32_bf16 v[104:107], v[60:63], a[184:187], v[104:107]
ds_read_b128 v[52:55], v2 offset:1024
s_add_u32 s48, s20, 16384
v_mfma_f32_16x16x32_bf16 v[108:111], v[56:59], a[172:175], v[108:111]
v_mfma_f32_16x16x32_bf16 v[108:111], v[60:63], a[188:191], v[108:111]
s_waitcnt lgkmcnt(4)
v_mfma_f32_16x16x32_bf16 v[112:115], v[64:67], a[160:163], v[112:115]
buffer_load_dwordx4 v[16:19], v2, s[8:11], s48 offen offset:0 sc1
v_mfma_f32_16x16x32_bf16 v[112:115], v[68:71], a[176:179], v[112:115]
v_mfma_f32_16x16x32_bf16 v[116:119], v[64:67], a[164:167], v[116:119]
ds_read_b128 v[56:59], v2 offset:2048
v_mfma_f32_16x16x32_bf16 v[116:119], v[68:71], a[180:183], v[116:119]
v_mfma_f32_16x16x32_bf16 v[120:123], v[64:67], a[168:171], v[120:123]
buffer_load_dwordx4 v[20:23], v4, s[8:11], s48 offen offset:0 sc1
v_mfma_f32_16x16x32_bf16 v[120:123], v[68:71], a[184:187], v[120:123]
ds_read_b128 v[60:63], v2 offset:3072
v_mfma_f32_16x16x32_bf16 v[124:127], v[64:67], a[172:175], v[124:127]
v_mfma_f32_16x16x32_bf16 v[124:127], v[68:71], a[188:191], v[124:127]
s_waitcnt lgkmcnt(4)
v_mfma_f32_16x16x32_bf16 v[128:131], v[72:75], a[160:163], v[128:131]
buffer_load_dwordx4 v[24:27], v5, s[8:11], s48 offen offset:0 sc1
v_mfma_f32_16x16x32_bf16 v[128:131], v[76:79], a[176:179], v[128:131]
v_mfma_f32_16x16x32_bf16 v[132:135], v[72:75], a[164:167], v[132:135]
ds_read_b128 v[64:67], v2 offset:4096
v_mfma_f32_16x16x32_bf16 v[132:135], v[76:79], a[180:183], v[132:135]
v_mfma_f32_16x16x32_bf16 v[136:139], v[72:75], a[168:171], v[136:139]
buffer_load_dwordx4 v[28:31], v6, s[8:11], s48 offen offset:0 sc1
v_mfma_f32_16x16x32_bf16 v[136:139], v[76:79], a[184:187], v[136:139]
ds_read_b128 v[68:71], v2 offset:5120
v_mfma_f32_16x16x32_bf16 v[140:143], v[72:75], a[172:175], v[140:143]
v_mfma_f32_16x16x32_bf16 v[140:143], v[76:79], a[188:191], v[140:143]
s_waitcnt vmcnt(12)
s_waitcnt lgkmcnt(4)
v_mfma_f32_16x16x32_bf16 v[80:83], v[48:51], a[192:195], v[80:83]
buffer_load_dwordx4 v[32:35], v2, s[8:11], s48 offen offset:1024 sc1
v_mfma_f32_16x16x32_bf16 v[80:83], v[52:55], a[208:211], v[80:83]
v_mfma_f32_16x16x32_bf16 v[84:87], v[48:51], a[196:199], v[84:87]
ds_read_b128 v[72:75], v2 offset:6144
v_mfma_f32_16x16x32_bf16 v[84:87], v[52:55], a[212:215], v[84:87]
v_mfma_f32_16x16x32_bf16 v[88:91], v[48:51], a[200:203], v[88:91]
buffer_load_dwordx4 v[36:39], v4, s[8:11], s48 offen offset:1024 sc1
v_mfma_f32_16x16x32_bf16 v[88:91], v[52:55], a[216:219], v[88:91]
ds_read_b128 v[76:79], v2 offset:7168
v_mfma_f32_16x16x32_bf16 v[92:95], v[48:51], a[204:207], v[92:95]
v_mfma_f32_16x16x32_bf16 v[92:95], v[52:55], a[220:223], v[92:95]
s_waitcnt lgkmcnt(4)
v_mfma_f32_16x16x32_bf16 v[96:99], v[56:59], a[192:195], v[96:99]
buffer_load_dwordx4 v[40:43], v5, s[8:11], s48 offen offset:1024 sc1
v_mfma_f32_16x16x32_bf16 v[96:99], v[60:63], a[208:211], v[96:99]
v_mfma_f32_16x16x32_bf16 v[100:103], v[56:59], a[196:199], v[100:103]
ds_read_b128 v[48:51], v2 offset:8192
v_mfma_f32_16x16x32_bf16 v[100:103], v[60:63], a[212:215], v[100:103]
v_mfma_f32_16x16x32_bf16 v[104:107], v[56:59], a[200:203], v[104:107]
buffer_load_dwordx4 v[44:47], v6, s[8:11], s48 offen offset:1024 sc1
v_mfma_f32_16x16x32_bf16 v[104:107], v[60:63], a[216:219], v[104:107]
ds_read_b128 v[52:55], v2 offset:9216
s_add_u32 m0, s22, 49152
v_mfma_f32_16x16x32_bf16 v[108:111], v[56:59], a[204:207], v[108:111]
v_add_u32 v3, 20480, v3
v_mfma_f32_16x16x32_bf16 v[108:111], v[60:63], a[220:223], v[108:111]
s_waitcnt lgkmcnt(4)
v_mfma_f32_16x16x32_bf16 v[112:115], v[64:67], a[192:195], v[112:115]
buffer_load_dwordx4 v3, s[8:11], 0 offen offset:0 sc1 lds
v_mfma_f32_16x16x32_bf16 v[112:115], v[68:71], a[208:211], v[112:115]
v_mfma_f32_16x16x32_bf16 v[116:119], v[64:67], a[196:199], v[116:119]
ds_read_b128 v[56:59], v2 offset:10240
v_mfma_f32_16x16x32_bf16 v[116:119], v[68:71], a[212:215], v[116:119]
v_mfma_f32_16x16x32_bf16 v[120:123], v[64:67], a[200:203], v[120:123]
buffer_load_dwordx4 v3, s[8:11], 0 offen offset:1024 sc1 lds
v_mfma_f32_16x16x32_bf16 v[120:123], v[68:71], a[216:219], v[120:123]
ds_read_b128 v[60:63], v2 offset:11264
v_mfma_f32_16x16x32_bf16 v[124:127], v[64:67], a[204:207], v[124:127]
v_mfma_f32_16x16x32_bf16 v[124:127], v[68:71], a[220:223], v[124:127]
s_waitcnt lgkmcnt(4)
v_mfma_f32_16x16x32_bf16 v[128:131], v[72:75], a[192:195], v[128:131]
buffer_load_dwordx4 v3, s[8:11], 0 offen offset:2048 sc1 lds
v_mfma_f32_16x16x32_bf16 v[128:131], v[76:79], a[208:211], v[128:131]
v_mfma_f32_16x16x32_bf16 v[132:135], v[72:75], a[196:199], v[132:135]
ds_read_b128 v[64:67], v2 offset:12288
v_mfma_f32_16x16x32_bf16 v[132:135], v[76:79], a[212:215], v[132:135]
v_mfma_f32_16x16x32_bf16 v[136:139], v[72:75], a[200:203], v[136:139]
buffer_load_dwordx4 v3, s[8:11], 0 offen offset:3072 sc1 lds
v_mfma_f32_16x16x32_bf16 v[136:139], v[76:79], a[216:219], v[136:139]
ds_read_b128 v[68:71], v2 offset:13312
s_add_u32 m0, s22, 53248
v_mfma_f32_16x16x32_bf16 v[140:143], v[72:75], a[204:207], v[140:143]
v_add_u32 v3, 4096, v3
v_mfma_f32_16x16x32_bf16 v[140:143], v[76:79], a[220:223], v[140:143]
s_waitcnt vmcnt(12)
s_waitcnt lgkmcnt(4)
v_mfma_f32_16x16x32_bf16 v[80:83], v[48:51], a[224:227], v[80:83]
buffer_load_dwordx4 v3, s[8:11], 0 offen offset:0 sc1 lds
v_mfma_f32_16x16x32_bf16 v[80:83], v[52:55], a[240:243], v[80:83]
v_mfma_f32_16x16x32_bf16 v[84:87], v[48:51], a[228:231], v[84:87]
ds_read_b128 v[72:75], v2 offset:14336
v_mfma_f32_16x16x32_bf16 v[84:87], v[52:55], a[244:247], v[84:87]
v_mfma_f32_16x16x32_bf16 v[88:91], v[48:51], a[232:235], v[88:91]
buffer_load_dwordx4 v3, s[8:11], 0 offen offset:1024 sc1 lds
v_mfma_f32_16x16x32_bf16 v[88:91], v[52:55], a[248:251], v[88:91]
ds_read_b128 v[76:79], v2 offset:15360
s_add_u32 m0, s22, 73728
v_mfma_f32_16x16x32_bf16 v[92:95], v[48:51], a[236:239], v[92:95]
v_add_u32 v3, 20480, v3
v_mfma_f32_16x16x32_bf16 v[92:95], v[52:55], a[252:255], v[92:95]
s_waitcnt lgkmcnt(4)
v_mfma_f32_16x16x32_bf16 v[96:99], v[56:59], a[224:227], v[96:99]
buffer_load_dwordx4 v3, s[8:11], 0 offen offset:0 sc1 lds
v_mfma_f32_16x16x32_bf16 v[96:99], v[60:63], a[240:243], v[96:99]
v_mfma_f32_16x16x32_bf16 v[100:103], v[56:59], a[228:231], v[100:103]
ds_read_b128 v[48:51], v2 offset:16384
v_mfma_f32_16x16x32_bf16 v[100:103], v[60:63], a[244:247], v[100:103]
v_mfma_f32_16x16x32_bf16 v[104:107], v[56:59], a[232:235], v[104:107]
buffer_load_dwordx4 v3, s[8:11], 0 offen offset:1024 sc1 lds
v_mfma_f32_16x16x32_bf16 v[104:107], v[60:63], a[248:251], v[104:107]
ds_read_b128 v[52:55], v2 offset:17408
v_mfma_f32_16x16x32_bf16 v[108:111], v[56:59], a[236:239], v[108:111]
v_mfma_f32_16x16x32_bf16 v[108:111], v[60:63], a[252:255], v[108:111]
s_waitcnt lgkmcnt(4)
v_mfma_f32_16x16x32_bf16 v[112:115], v[64:67], a[224:227], v[112:115]
buffer_load_dwordx4 v3, s[8:11], 0 offen offset:2048 sc1 lds
v_mfma_f32_16x16x32_bf16 v[112:115], v[68:71], a[240:243], v[112:115]
v_mfma_f32_16x16x32_bf16 v[116:119], v[64:67], a[228:231], v[116:119]
ds_read_b128 v[56:59], v2 offset:18432
v_mfma_f32_16x16x32_bf16 v[116:119], v[68:71], a[244:247], v[116:119]
v_mfma_f32_16x16x32_bf16 v[120:123], v[64:67], a[232:235], v[120:123]
buffer_load_dwordx4 v3, s[8:11], 0 offen offset:3072 sc1 lds
v_mfma_f32_16x16x32_bf16 v[120:123], v[68:71], a[248:251], v[120:123]
ds_read_b128 v[60:63], v2 offset:19456
s_add_u32 m0, s22, 77824
v_mfma_f32_16x16x32_bf16 v[124:127], v[64:67], a[236:239], v[124:127]
v_add_u32 v3, 4096, v3
v_mfma_f32_16x16x32_bf16 v[124:127], v[68:71], a[252:255], v[124:127]
s_waitcnt lgkmcnt(4)
v_mfma_f32_16x16x32_bf16 v[128:131], v[72:75], a[224:227], v[128:131]
buffer_load_dwordx4 v3, s[8:11], 0 offen offset:0 sc1 lds
v_mfma_f32_16x16x32_bf16 v[128:131], v[76:79], a[240:243], v[128:131]
v_mfma_f32_16x16x32_bf16 v[132:135], v[72:75], a[228:231], v[132:135]
ds_read_b128 v[64:67], v2 offset:20480
v_mfma_f32_16x16x32_bf16 v[132:135], v[76:79], a[244:247], v[132:135]
v_mfma_f32_16x16x32_bf16 v[136:139], v[72:75], a[232:235], v[136:139]
buffer_load_dwordx4 v3, s[8:11], 0 offen offset:1024 sc1 lds
v_mfma_f32_16x16x32_bf16 v[136:139], v[76:79], a[248:251], v[136:139]
ds_read_b128 v[68:71], v2 offset:21504
s_add_u32 m0, s22, 98304
v_mfma_f32_16x16x32_bf16 v[140:143], v[72:75], a[236:239], v[140:143]
v_add_u32 v3, 20480, v3
v_mfma_f32_16x16x32_bf16 v[140:143], v[76:79], a[252:255], v[140:143]
s_waitcnt vmcnt(12)
s_waitcnt lgkmcnt(4)
v_mfma_f32_16x16x32_bf16 v[80:83], v[48:51], v[16:19], v[80:83]
buffer_load_dwordx4 v3, s[8:11], 0 offen offset:0 sc1 lds
v_mfma_f32_16x16x32_bf16 v[80:83], v[52:55], v[32:35], v[80:83]
v_mfma_f32_16x16x32_bf16 v[84:87], v[48:51], v[20:23], v[84:87]
ds_read_b128 v[72:75], v2 offset:22528
v_mfma_f32_16x16x32_bf16 v[84:87], v[52:55], v[36:39], v[84:87]
v_mfma_f32_16x16x32_bf16 v[88:91], v[48:51], v[24:27], v[88:91]
buffer_load_dwordx4 v3, s[8:11], 0 offen offset:1024 sc1 lds
v_mfma_f32_16x16x32_bf16 v[88:91], v[52:55], v[40:43], v[88:91]
ds_read_b128 v[76:79], v2 offset:23552
v_mfma_f32_16x16x32_bf16 v[92:95], v[48:51], v[28:31], v[92:95]
v_mfma_f32_16x16x32_bf16 v[92:95], v[52:55], v[44:47], v[92:95]
s_waitcnt lgkmcnt(4)
v_mfma_f32_16x16x32_bf16 v[96:99], v[56:59], v[16:19], v[96:99]
buffer_load_dwordx4 v3, s[8:11], 0 offen offset:2048 sc1 lds
v_mfma_f32_16x16x32_bf16 v[96:99], v[60:63], v[32:35], v[96:99]
s_barrier
v_mfma_f32_16x16x32_bf16 v[100:103], v[56:59], v[20:23], v[100:103]
ds_read_b128 v[48:51], v2 offset:24576
v_mfma_f32_16x16x32_bf16 v[100:103], v[60:63], v[36:39], v[100:103]
v_mfma_f32_16x16x32_bf16 v[104:107], v[56:59], v[24:27], v[104:107]
buffer_load_dwordx4 v3, s[8:11], 0 offen offset:3072 sc1 lds
v_mfma_f32_16x16x32_bf16 v[104:107], v[60:63], v[40:43], v[104:107]
ds_read_b128 v[52:55], v2 offset:25600
s_add_u32 m0, s22, 102400
v_mfma_f32_16x16x32_bf16 v[108:111], v[56:59], v[28:31], v[108:111]
v_add_u32 v3, 4096, v3
v_mfma_f32_16x16x32_bf16 v[108:111], v[60:63], v[44:47], v[108:111]
s_waitcnt lgkmcnt(4)
v_mfma_f32_16x16x32_bf16 v[112:115], v[64:67], v[16:19], v[112:115]
buffer_load_dwordx4 v3, s[8:11], 0 offen offset:0 sc1 lds
v_mfma_f32_16x16x32_bf16 v[112:115], v[68:71], v[32:35], v[112:115]
v_mfma_f32_16x16x32_bf16 v[116:119], v[64:67], v[20:23], v[116:119]
ds_read_b128 v[56:59], v2 offset:26624
v_mfma_f32_16x16x32_bf16 v[116:119], v[68:71], v[36:39], v[116:119]
v_mfma_f32_16x16x32_bf16 v[120:123], v[64:67], v[24:27], v[120:123]
buffer_load_dwordx4 v3, s[8:11], 0 offen offset:1024 sc1 lds
v_mfma_f32_16x16x32_bf16 v[120:123], v[68:71], v[40:43], v[120:123]
ds_read_b128 v[60:63], v2 offset:27648
s_add_u32 m0, s22, 122880
v_mfma_f32_16x16x32_bf16 v[124:127], v[64:67], v[28:31], v[124:127]
v_add_u32 v3, 20480, v3
v_mfma_f32_16x16x32_bf16 v[124:127], v[68:71], v[44:47], v[124:127]
s_waitcnt lgkmcnt(4)
v_mfma_f32_16x16x32_bf16 v[128:131], v[72:75], v[16:19], v[128:131]
v_mfma_f32_16x16x32_bf16 v[128:131], v[76:79], v[32:35], v[128:131]
buffer_load_dwordx4 v3, s[8:11], 0 offen offset:0 sc1 lds
v_mfma_f32_16x16x32_bf16 v[132:135], v[72:75], v[20:23], v[132:135]
ds_read_b128 v[64:67], v2 offset:28672
v_mfma_f32_16x16x32_bf16 v[132:135], v[76:79], v[36:39], v[132:135]
v_mfma_f32_16x16x32_bf16 v[136:139], v[72:75], v[24:27], v[136:139]
v_mfma_f32_16x16x32_bf16 v[136:139], v[76:79], v[40:43], v[136:139]
ds_read_b128 v[68:71], v2 offset:29696
v_mfma_f32_16x16x32_bf16 v[140:143], v[72:75], v[28:31], v[140:143]
buffer_load_dwordx4 v3, s[8:11], 0 offen offset:1024 sc1 lds
v_mfma_f32_16x16x32_bf16 v[140:143], v[76:79], v[44:47], v[140:143]
s_waitcnt lgkmcnt(4)
v_mfma_f32_16x16x32_bf16 v[176:179], v[48:51], a[0:3], 0
v_mfma_f32_16x16x32_bf16 v[176:179], v[52:55], a[16:19], v[176:179]
v_mfma_f32_16x16x32_bf16 v[180:183], v[48:51], a[4:7], 0
ds_read_b128 v[72:75], v2 offset:30720
v_mfma_f32_16x16x32_bf16 v[180:183], v[52:55], a[20:23], v[180:183]
buffer_load_dwordx4 v3, s[8:11], 0 offen offset:2048 sc1 lds
v_mfma_f32_16x16x32_bf16 v[184:187], v[48:51], a[8:11], 0
v_mul_f32 v208, v80, v80
v_mul_f32 v210, v81, v81
v_mfma_f32_16x16x32_bf16 v[184:187], v[52:55], a[24:27], v[184:187]
ds_read_b128 v[76:79], v2 offset:31744
v_fma_f32 v208, v208, v233, v232
v_mfma_f32_16x16x32_bf16 v[188:191], v[48:51], a[12:15], 0
v_fma_f32 v210, v210, v233, v232
v_mul_f32 v208, v208, v80
v_mfma_f32_16x16x32_bf16 v[188:191], v[52:55], a[28:31], v[188:191]
v_mul_f32 v210, v210, v81
s_waitcnt lgkmcnt(4)
v_mfma_f32_16x16x32_bf16 v[192:195], v[56:59], a[0:3], 0
buffer_load_dwordx4 v3, s[8:11], 0 offen offset:3072 sc1 lds
v_mfma_f32_16x16x32_bf16 v[192:195], v[60:63], a[16:19], v[192:195]
s_add_u32 m0, s22, 126976
v_add_u32 v3, 4096, v3
v_mfma_f32_16x16x32_bf16 v[196:199], v[56:59], a[4:7], 0
ds_read_b128 v[48:51], v2 offset:32768
v_mul_f32 v209, v80, v96
v_mfma_f32_16x16x32_bf16 v[196:199], v[60:63], a[20:23], v[196:199]
v_exp_f32 v208, v208
v_mfma_f32_16x16x32_bf16 v[200:203], v[56:59], a[8:11], 0
v_exp_f32 v210, v210
v_mfma_f32_16x16x32_bf16 v[200:203], v[60:63], a[24:27], v[200:203]
ds_read_b128 v[52:55], v2 offset:33792
v_mul_f32 v211, v81, v97
v_mfma_f32_16x16x32_bf16 v[204:207], v[56:59], a[12:15], 0
buffer_load_dwordx4 v3, s[8:11], 0 offen offset:0 sc1 lds
v_mfma_f32_16x16x32_bf16 v[204:207], v[60:63], a[28:31], v[204:207]
v_fma_f32 v208, v208, v234, v234
s_waitcnt lgkmcnt(4)
v_mfma_f32_16x16x32_bf16 v[176:179], v[64:67], a[32:35], v[176:179]
v_fma_f32 v210, v210, v234, v234
v_mul_f32 v212, v82, v82
v_mfma_f32_16x16x32_bf16 v[176:179], v[68:71], a[48:51], v[176:179]
v_rcp_f32 v208, v208
v_mfma_f32_16x16x32_bf16 v[180:183], v[64:67], a[36:39], v[180:183]
ds_read_b128 v[56:59], v2 offset:34816
v_mul_f32 v209, v209, v208
v_mfma_f32_16x16x32_bf16 v[180:183], v[68:71], a[52:55], v[180:183]
buffer_load_dwordx4 v3, s[8:11], 0 offen offset:1024 sc1 lds
v_mfma_f32_16x16x32_bf16 v[184:187], v[64:67], a[40:43], v[184:187]
v_rcp_f32 v210, v210
v_mfma_f32_16x16x32_bf16 v[184:187], v[68:71], a[56:59], v[184:187]
ds_read_b128 v[60:63], v2 offset:35840
v_mul_f32 v211, v211, v210
v_mfma_f32_16x16x32_bf16 v[188:191], v[64:67], a[44:47], v[188:191]
v_cvt_pk_bf16_f32 v144, v209, v211
v_mul_f32 v214, v83, v83
v_mfma_f32_16x16x32_bf16 v[188:191], v[68:71], a[60:63], v[188:191]
v_fma_f32 v212, v212, v233, v232
s_waitcnt lgkmcnt(4)
v_mfma_f32_16x16x32_bf16 v[192:195], v[72:75], a[32:35], v[192:195]
v_fma_f32 v214, v214, v233, v232
v_mul_f32 v212, v212, v82
v_mfma_f32_16x16x32_bf16 v[192:195], v[76:79], a[48:51], v[192:195]
v_mul_f32 v214, v214, v83
v_mul_f32 v213, v82, v98
v_mfma_f32_16x16x32_bf16 v[196:199], v[72:75], a[36:39], v[196:199]
ds_read_b128 v[64:67], v2 offset:36864
v_mul_f32 v215, v83, v99
v_mfma_f32_16x16x32_bf16 v[196:199], v[76:79], a[52:55], v[196:199]
v_exp_f32 v212, v212
v_mfma_f32_16x16x32_bf16 v[200:203], v[72:75], a[40:43], v[200:203]
v_exp_f32 v214, v214
v_mfma_f32_16x16x32_bf16 v[200:203], v[76:79], a[56:59], v[200:203]
ds_read_b128 v[68:71], v2 offset:37888
v_fma_f32 v212, v212, v234, v234
v_mfma_f32_16x16x32_bf16 v[204:207], v[72:75], a[44:47], v[204:207]
v_fma_f32 v214, v214, v234, v234
v_mul_f32 v208, v84, v84
v_mfma_f32_16x16x32_bf16 v[204:207], v[76:79], a[60:63], v[204:207]
v_mul_f32 v210, v85, v85
s_waitcnt lgkmcnt(4)
v_mfma_f32_16x16x32_bf16 v[176:179], v[48:51], a[64:67], v[176:179]
v_rcp_f32 v212, v212
v_mfma_f32_16x16x32_bf16 v[176:179], v[52:55], a[80:83], v[176:179]
v_rcp_f32 v214, v214
v_mfma_f32_16x16x32_bf16 v[180:183], v[48:51], a[68:71], v[180:183]
ds_read_b128 v[72:75], v2 offset:38912
v_mul_f32 v213, v213, v212
v_mfma_f32_16x16x32_bf16 v[180:183], v[52:55], a[84:87], v[180:183]
v_mul_f32 v215, v215, v214
v_cvt_pk_bf16_f32 v145, v213, v215
v_mfma_f32_16x16x32_bf16 v[184:187], v[48:51], a[72:75], v[184:187]
v_fma_f32 v208, v208, v237, v236
v_fma_f32 v210, v210, v237, v236
v_mfma_f32_16x16x32_bf16 v[184:187], v[52:55], a[88:91], v[184:187]
ds_read_b128 v[76:79], v2 offset:39936
v_mul_f32 v208, v208, v84
v_mfma_f32_16x16x32_bf16 v[188:191], v[48:51], a[76:79], v[188:191]
v_mul_f32 v210, v210, v85
v_mul_f32 v209, v84, v100
v_mfma_f32_16x16x32_bf16 v[188:191], v[52:55], a[92:95], v[188:191]
v_mul_f32 v211, v85, v101
s_waitcnt lgkmcnt(4)
v_mfma_f32_16x16x32_bf16 v[192:195], v[56:59], a[64:67], v[192:195]
v_exp_f32 v208, v208
v_mfma_f32_16x16x32_bf16 v[192:195], v[60:63], a[80:83], v[192:195]
v_exp_f32 v210, v210
v_mfma_f32_16x16x32_bf16 v[196:199], v[56:59], a[68:71], v[196:199]
ds_read_b128 v[48:51], v2 offset:40960
v_fma_f32 v208, v208, v238, v238
v_mfma_f32_16x16x32_bf16 v[196:199], v[60:63], a[84:87], v[196:199]
v_fma_f32 v210, v210, v238, v238
v_mul_f32 v212, v86, v86
v_mfma_f32_16x16x32_bf16 v[200:203], v[56:59], a[72:75], v[200:203]
v_rcp_f32 v208, v208
v_mfma_f32_16x16x32_bf16 v[200:203], v[60:63], a[88:91], v[200:203]
ds_read_b128 v[52:55], v2 offset:41984
v_mul_f32 v209, v209, v208
v_mfma_f32_16x16x32_bf16 v[204:207], v[56:59], a[76:79], v[204:207]
v_rcp_f32 v210, v210
v_mfma_f32_16x16x32_bf16 v[204:207], v[60:63], a[92:95], v[204:207]
v_mul_f32 v211, v211, v210
s_waitcnt lgkmcnt(4)
v_mfma_f32_16x16x32_bf16 v[176:179], v[64:67], a[96:99], v[176:179]
v_cvt_pk_bf16_f32 v148, v209, v211
v_mul_f32 v214, v87, v87
v_mfma_f32_16x16x32_bf16 v[176:179], v[68:71], a[112:115], v[176:179]
v_fma_f32 v212, v212, v237, v236
v_fma_f32 v214, v214, v237, v236
v_mfma_f32_16x16x32_bf16 v[180:183], v[64:67], a[100:103], v[180:183]
ds_read_b128 v[56:59], v2 offset:43008
v_mul_f32 v212, v212, v86
v_mfma_f32_16x16x32_bf16 v[180:183], v[68:71], a[116:119], v[180:183]
v_mul_f32 v214, v214, v87
v_mul_f32 v213, v86, v102
v_mfma_f32_16x16x32_bf16 v[184:187], v[64:67], a[104:107], v[184:187]
v_exp_f32 v212, v212
v_mfma_f32_16x16x32_bf16 v[184:187], v[68:71], a[120:123], v[184:187]
ds_read_b128 v[60:63], v2 offset:44032
v_mul_f32 v215, v87, v103
v_mfma_f32_16x16x32_bf16 v[188:191], v[64:67], a[108:111], v[188:191]
v_exp_f32 v214, v214
v_mfma_f32_16x16x32_bf16 v[188:191], v[68:71], a[124:127], v[188:191]
v_fma_f32 v212, v212, v238, v238
s_waitcnt lgkmcnt(4)
v_mfma_f32_16x16x32_bf16 v[192:195], v[72:75], a[96:99], v[192:195]
v_fma_f32 v214, v214, v238, v238
v_mul_f32 v208, v88, v88
v_mfma_f32_16x16x32_bf16 v[192:195], v[76:79], a[112:115], v[192:195]
v_rcp_f32 v212, v212
v_mfma_f32_16x16x32_bf16 v[196:199], v[72:75], a[100:103], v[196:199]
ds_read_b128 v[64:67], v2 offset:45056
v_mul_f32 v213, v213, v212
v_mfma_f32_16x16x32_bf16 v[196:199], v[76:79], a[116:119], v[196:199]
v_rcp_f32 v214, v214
v_mfma_f32_16x16x32_bf16 v[200:203], v[72:75], a[104:107], v[200:203]
v_mul_f32 v215, v215, v214
v_cvt_pk_bf16_f32 v149, v213, v215
v_mfma_f32_16x16x32_bf16 v[200:203], v[76:79], a[120:123], v[200:203]
ds_read_b128 v[68:71], v2 offset:46080
v_mul_f32 v210, v89, v89
v_mfma_f32_16x16x32_bf16 v[204:207], v[72:75], a[108:111], v[204:207]
v_fma_f32 v208, v208, v241, v240
v_fma_f32 v210, v210, v241, v240
v_mfma_f32_16x16x32_bf16 v[204:207], v[76:79], a[124:127], v[204:207]
v_mul_f32 v208, v208, v88
s_waitcnt lgkmcnt(4)
v_mfma_f32_16x16x32_bf16 v[176:179], v[48:51], a[128:131], v[176:179]
v_mul_f32 v210, v210, v89
v_mul_f32 v209, v88, v104
v_mfma_f32_16x16x32_bf16 v[176:179], v[52:55], a[144:147], v[176:179]
v_exp_f32 v208, v208
v_mfma_f32_16x16x32_bf16 v[180:183], v[48:51], a[132:135], v[180:183]
ds_read_b128 v[72:75], v2 offset:47104
v_mul_f32 v211, v89, v105
v_mfma_f32_16x16x32_bf16 v[180:183], v[52:55], a[148:151], v[180:183]
v_exp_f32 v210, v210
v_mfma_f32_16x16x32_bf16 v[184:187], v[48:51], a[136:139], v[184:187]
v_fma_f32 v208, v208, v242, v242
v_fma_f32 v210, v210, v242, v242
v_mfma_f32_16x16x32_bf16 v[184:187], v[52:55], a[152:155], v[184:187]
ds_read_b128 v[76:79], v2 offset:48128
v_mul_f32 v212, v90, v90
v_mfma_f32_16x16x32_bf16 v[188:191], v[48:51], a[140:143], v[188:191]
v_rcp_f32 v208, v208
v_mfma_f32_16x16x32_bf16 v[188:191], v[52:55], a[156:159], v[188:191]
v_mul_f32 v209, v209, v208
s_waitcnt lgkmcnt(4)
v_mfma_f32_16x16x32_bf16 v[192:195], v[56:59], a[128:131], v[192:195]
s_waitcnt vmcnt(18)
v_mul_f32 v214, v91, v91
v_mfma_f32_16x16x32_bf16 v[192:195], v[60:63], a[144:147], v[192:195]
s_barrier
v_mfma_f32_16x16x32_bf16 v[196:199], v[56:59], a[132:135], v[196:199]
ds_read_b128 v[48:51], v2 offset:49152
s_add_u32 m0, s22, 0
v_mfma_f32_16x16x32_bf16 v[196:199], v[60:63], a[148:151], v[196:199]
v_add_u32 v3, 20480, v3
buffer_load_dwordx4 v3, s[8:11], 0 offen offset:0 sc1 lds
v_mfma_f32_16x16x32_bf16 v[200:203], v[56:59], a[136:139], v[200:203]
v_rcp_f32 v210, v210
v_mfma_f32_16x16x32_bf16 v[200:203], v[60:63], a[152:155], v[200:203]
ds_read_b128 v[52:55], v2 offset:50176
v_mul_f32 v211, v211, v210
v_mfma_f32_16x16x32_bf16 v[204:207], v[56:59], a[140:143], v[204:207]
v_cvt_pk_bf16_f32 v152, v209, v211
v_fma_f32 v212, v212, v241, v240
v_mfma_f32_16x16x32_bf16 v[204:207], v[60:63], a[156:159], v[204:207]
v_fma_f32 v214, v214, v241, v240
s_waitcnt lgkmcnt(4)
v_mfma_f32_16x16x32_bf16 v[176:179], v[64:67], a[160:163], v[176:179]
buffer_load_dwordx4 v3, s[8:11], 0 offen offset:1024 sc1 lds
v_mfma_f32_16x16x32_bf16 v[176:179], v[68:71], a[176:179], v[176:179]
v_mul_f32 v212, v212, v90
v_mul_f32 v214, v214, v91
v_mfma_f32_16x16x32_bf16 v[180:183], v[64:67], a[164:167], v[180:183]
ds_read_b128 v[56:59], v2 offset:51200
v_mul_f32 v213, v90, v106
v_mfma_f32_16x16x32_bf16 v[180:183], v[68:71], a[180:183], v[180:183]
v_exp_f32 v212, v212
v_mfma_f32_16x16x32_bf16 v[184:187], v[64:67], a[168:171], v[184:187]
v_exp_f32 v214, v214
v_mfma_f32_16x16x32_bf16 v[184:187], v[68:71], a[184:187], v[184:187]
ds_read_b128 v[60:63], v2 offset:52224
v_mul_f32 v215, v91, v107
v_mfma_f32_16x16x32_bf16 v[188:191], v[64:67], a[172:175], v[188:191]
buffer_load_dwordx4 v3, s[8:11], 0 offen offset:2048 sc1 lds
v_mfma_f32_16x16x32_bf16 v[188:191], v[68:71], a[188:191], v[188:191]
v_fma_f32 v212, v212, v242, v242
s_waitcnt lgkmcnt(4)
v_mfma_f32_16x16x32_bf16 v[192:195], v[72:75], a[160:163], v[192:195]
v_fma_f32 v214, v214, v242, v242
v_mul_f32 v208, v92, v92
v_mfma_f32_16x16x32_bf16 v[192:195], v[76:79], a[176:179], v[192:195]
v_rcp_f32 v212, v212
v_mfma_f32_16x16x32_bf16 v[196:199], v[72:75], a[164:167], v[196:199]
ds_read_b128 v[64:67], v2 offset:53248
v_mul_f32 v213, v213, v212
v_mfma_f32_16x16x32_bf16 v[196:199], v[76:79], a[180:183], v[196:199]
buffer_load_dwordx4 v3, s[8:11], 0 offen offset:3072 sc1 lds
v_mfma_f32_16x16x32_bf16 v[200:203], v[72:75], a[168:171], v[200:203]
s_add_u32 m0, s22, 4096
v_add_u32 v3, 4096, v3
v_mfma_f32_16x16x32_bf16 v[200:203], v[76:79], a[184:187], v[200:203]
ds_read_b128 v[68:71], v2 offset:54272
v_mul_f32 v210, v93, v93
v_mfma_f32_16x16x32_bf16 v[204:207], v[72:75], a[172:175], v[204:207]
v_rcp_f32 v214, v214
v_mfma_f32_16x16x32_bf16 v[204:207], v[76:79], a[188:191], v[204:207]
v_mul_f32 v215, v215, v214
s_waitcnt lgkmcnt(4)
v_mfma_f32_16x16x32_bf16 v[176:179], v[48:51], a[192:195], v[176:179]
buffer_load_dwordx4 v3, s[8:11], 0 offen offset:0 sc1 lds
v_mfma_f32_16x16x32_bf16 v[176:179], v[52:55], a[208:211], v[176:179]
v_cvt_pk_bf16_f32 v153, v213, v215
v_fma_f32 v208, v208, v245, v244
v_mfma_f32_16x16x32_bf16 v[180:183], v[48:51], a[196:199], v[180:183]
ds_read_b128 v[72:75], v2 offset:55296
v_fma_f32 v210, v210, v245, v244
v_mfma_f32_16x16x32_bf16 v[180:183], v[52:55], a[212:215], v[180:183]
v_mul_f32 v208, v208, v92
v_mul_f32 v210, v210, v93
v_mfma_f32_16x16x32_bf16 v[184:187], v[48:51], a[200:203], v[184:187]
v_exp_f32 v208, v208
v_mfma_f32_16x16x32_bf16 v[184:187], v[52:55], a[216:219], v[184:187]
ds_read_b128 v[76:79], v2 offset:56320
v_mul_f32 v209, v92, v108
v_mfma_f32_16x16x32_bf16 v[188:191], v[48:51], a[204:207], v[188:191]
buffer_load_dwordx4 v3, s[8:11], 0 offen offset:1024 sc1 lds
v_mfma_f32_16x16x32_bf16 v[188:191], v[52:55], a[220:223], v[188:191]
v_mul_f32 v211, v93, v109
s_waitcnt lgkmcnt(4)
L_hop4:
s_cmp_eq_u32 s15, 1
s_cbranch_scc1 L_hop8
v_mfma_f32_16x16x32_bf16 v[192:195], v[56:59], a[192:195], v[192:195]
v_exp_f32 v210, v210
v_mfma_f32_16x16x32_bf16 v[192:195], v[60:63], a[208:211], v[192:195]
v_fma_f32 v208, v208, v246, v246
v_fma_f32 v210, v210, v246, v246
v_mfma_f32_16x16x32_bf16 v[196:199], v[56:59], a[196:199], v[196:199]
ds_read_b128 v[48:51], v2 offset:57344
v_mul_f32 v212, v94, v94
v_mfma_f32_16x16x32_bf16 v[196:199], v[60:63], a[212:215], v[196:199]
v_rcp_f32 v208, v208
v_mfma_f32_16x16x32_bf16 v[200:203], v[56:59], a[200:203], v[200:203]
v_rcp_f32 v210, v210
v_mfma_f32_16x16x32_bf16 v[200:203], v[60:63], a[216:219], v[200:203]
ds_read_b128 v[52:55], v2 offset:58368
v_mul_f32 v209, v209, v208
v_mfma_f32_16x16x32_bf16 v[204:207], v[56:59], a[204:207], v[204:207]
v_mul_f32 v211, v211, v210
v_cvt_pk_bf16_f32 v156, v209, v211
v_mfma_f32_16x16x32_bf16 v[204:207], v[60:63], a[220:223], v[204:207]
v_mul_f32 v214, v95, v95
s_waitcnt lgkmcnt(4)
v_mfma_f32_16x16x32_bf16 v[176:179], v[64:67], a[224:227], v[176:179]
v_fma_f32 v212, v212, v245, v244
v_fma_f32 v214, v214, v245, v244
v_mfma_f32_16x16x32_bf16 v[176:179], v[68:71], a[240:243], v[176:179]
v_mul_f32 v212, v212, v94
v_mul_f32 v214, v214, v95
v_mfma_f32_16x16x32_bf16 v[180:183], v[64:67], a[228:231], v[180:183]
ds_read_b128 v[56:59], v2 offset:59392
v_mul_f32 v213, v94, v110
v_mfma_f32_16x16x32_bf16 v[180:183], v[68:71], a[244:247], v[180:183]
v_exp_f32 v212, v212
v_mfma_f32_16x16x32_bf16 v[184:187], v[64:67], a[232:235], v[184:187]
v_exp_f32 v214, v214
v_mfma_f32_16x16x32_bf16 v[184:187], v[68:71], a[248:251], v[184:187]
ds_read_b128 v[60:63], v2 offset:60416
v_mul_f32 v215, v95, v111
v_mfma_f32_16x16x32_bf16 v[188:191], v[64:67], a[236:239], v[188:191]
v_fma_f32 v212, v212, v246, v246
v_fma_f32 v214, v214, v246, v246
v_mfma_f32_16x16x32_bf16 v[188:191], v[68:71], a[252:255], v[188:191]
v_mul_f32 v208, v112, v112
s_waitcnt lgkmcnt(4)
v_mfma_f32_16x16x32_bf16 v[192:195], v[72:75], a[224:227], v[192:195]
v_rcp_f32 v212, v212
v_mfma_f32_16x16x32_bf16 v[192:195], v[76:79], a[240:243], v[192:195]
v_rcp_f32 v214, v214
v_mfma_f32_16x16x32_bf16 v[196:199], v[72:75], a[228:231], v[196:199]
ds_read_b128 v[64:67], v2 offset:61440
v_mul_f32 v213, v213, v212
v_mfma_f32_16x16x32_bf16 v[196:199], v[76:79], a[244:247], v[196:199]
v_mul_f32 v215, v215, v214
v_cvt_pk_bf16_f32 v157, v213, v215
v_mfma_f32_16x16x32_bf16 v[200:203], v[72:75], a[232:235], v[200:203]
v_mul_f32 v210, v113, v113
v_fma_f32 v208, v208, v233, v232
v_mfma_f32_16x16x32_bf16 v[200:203], v[76:79], a[248:251], v[200:203]
ds_read_b128 v[68:71], v2 offset:62464
v_fma_f32 v210, v210, v233, v232
v_mfma_f32_16x16x32_bf16 v[204:207], v[72:75], a[236:239], v[204:207]
v_mul_f32 v208, v208, v112
v_mul_f32 v210, v210, v113
v_mfma_f32_16x16x32_bf16 v[204:207], v[76:79], a[252:255], v[204:207]
v_mul_f32 v209, v112, v128
s_waitcnt lgkmcnt(4)
v_mfma_f32_16x16x32_bf16 v[176:179], v[48:51], v[16:19], v[176:179]
v_exp_f32 v208, v208
v_mfma_f32_16x16x32_bf16 v[176:179], v[52:55], v[32:35], v[176:179]
v_exp_f32 v210, v210
v_mfma_f32_16x16x32_bf16 v[180:183], v[48:51], v[20:23], v[180:183]
ds_read_b128 v[72:75], v2 offset:63488
v_mul_f32 v211, v113, v129
v_mfma_f32_16x16x32_bf16 v[180:183], v[52:55], v[36:39], v[180:183]
v_fma_f32 v208, v208, v234, v234
v_fma_f32 v210, v210, v234, v234
v_mfma_f32_16x16x32_bf16 v[184:187], v[48:51], v[24:27], v[184:187]
v_rcp_f32 v208, v208
v_mfma_f32_16x16x32_bf16 v[184:187], v[52:55], v[40:43], v[184:187]
ds_read_b128 v[76:79], v2 offset:64512
v_mul_f32 v209, v209, v208
v_mfma_f32_16x16x32_bf16 v[188:191], v[48:51], v[28:31], v[188:191]
v_rcp_f32 v210, v210
v_mfma_f32_16x16x32_bf16 v[188:191], v[52:55], v[44:47], v[188:191]
v_mul_f32 v211, v211, v210
s_waitcnt lgkmcnt(4)
v_mfma_f32_16x16x32_bf16 v[192:195], v[56:59], v[16:19], v[192:195]
v_cvt_pk_bf16_f32 v146, v209, v211
v_mul_f32 v212, v114, v114
v_mfma_f32_16x16x32_bf16 v[192:195], v[60:63], v[32:35], v[192:195]
v_mul_f32 v214, v115, v115
v_fma_f32 v212, v212, v233, v232
v_mfma_f32_16x16x32_bf16 v[196:199], v[56:59], v[20:23], v[196:199]
ds_read_b128 v[48:51], v7 offset:0
v_fma_f32 v214, v214, v233, v232
v_mfma_f32_16x16x32_bf16 v[196:199], v[60:63], v[36:39], v[196:199]
v_mul_f32 v212, v212, v114
v_mul_f32 v214, v214, v115
v_mfma_f32_16x16x32_bf16 v[200:203], v[56:59], v[24:27], v[200:203]
v_exp_f32 v212, v212
v_mfma_f32_16x16x32_bf16 v[200:203], v[60:63], v[40:43], v[200:203]
ds_read_b128 v[52:55], v7 offset:1024
v_mul_f32 v213, v114, v130
v_mfma_f32_16x16x32_bf16 v[204:207], v[56:59], v[28:31], v[204:207]
v_exp_f32 v214, v214
v_mfma_f32_16x16x32_bf16 v[204:207], v[60:63], v[44:47], v[204:207]
v_mul_f32 v215, v115, v131
s_waitcnt lgkmcnt(4)
v_mfma_f32_16x16x32_bf16 v[80:83], v[64:67], a[0:3], 0
v_fma_f32 v212, v212, v234, v234
v_fma_f32 v214, v214, v234, v234
v_mfma_f32_16x16x32_bf16 v[80:83], v[68:71], a[16:19], v[80:83]
v_rcp_f32 v212, v212
v_mfma_f32_16x16x32_bf16 v[84:87], v[64:67], a[4:7], 0
ds_read_b128 v[56:59], v7 offset:2048
v_mul_f32 v213, v213, v212
v_mfma_f32_16x16x32_bf16 v[84:87], v[68:71], a[20:23], v[84:87]
v_rcp_f32 v214, v214
v_mfma_f32_16x16x32_bf16 v[88:91], v[64:67], a[8:11], 0
v_mul_f32 v215, v215, v214
v_cvt_pk_bf16_f32 v147, v213, v215
v_mfma_f32_16x16x32_bf16 v[88:91], v[68:71], a[24:27], v[88:91]
ds_read_b128 v[60:63], v7 offset:3072
v_mul_f32 v208, v116, v116
v_mfma_f32_16x16x32_bf16 v[92:95], v[64:67], a[12:15], 0
buffer_store_dwordx4 v[144:147], v2, s[8:11], s24 offen offset:0 sc1
v_mfma_f32_16x16x32_bf16 v[92:95], v[68:71], a[28:31], v[92:95]
v_mul_f32 v210, v117, v117
s_waitcnt lgkmcnt(4)
v_mfma_f32_16x16x32_bf16 v[96:99], v[72:75], a[0:3], 0
v_fma_f32 v208, v208, v237, v236
v_fma_f32 v210, v210, v237, v236
v_mfma_f32_16x16x32_bf16 v[96:99], v[76:79], a[16:19], v[96:99]
v_mul_f32 v208, v208, v116
v_mul_f32 v210, v210, v117
v_mfma_f32_16x16x32_bf16 v[100:103], v[72:75], a[4:7], 0
ds_read_b128 v[64:67], v7 offset:4096
v_mul_f32 v209, v116, v132
v_mfma_f32_16x16x32_bf16 v[100:103], v[76:79], a[20:23], v[100:103]
v_exp_f32 v208, v208
v_mfma_f32_16x16x32_bf16 v[104:107], v[72:75], a[8:11], 0
v_exp_f32 v210, v210
v_mfma_f32_16x16x32_bf16 v[104:107], v[76:79], a[24:27], v[104:107]
ds_read_b128 v[68:71], v7 offset:5120
v_mul_f32 v211, v117, v133
v_mfma_f32_16x16x32_bf16 v[108:111], v[72:75], a[12:15], 0
v_fma_f32 v208, v208, v238, v238
v_fma_f32 v210, v210, v238, v238
v_mfma_f32_16x16x32_bf16 v[108:111], v[76:79], a[28:31], v[108:111]
v_mul_f32 v212, v118, v118
s_waitcnt lgkmcnt(4)
v_mfma_f32_16x16x32_bf16 v[80:83], v[48:51], a[32:35], v[80:83]
v_rcp_f32 v208, v208
v_mfma_f32_16x16x32_bf16 v[80:83], v[52:55], a[48:51], v[80:83]
v_rcp_f32 v210, v210
v_mfma_f32_16x16x32_bf16 v[84:87], v[48:51], a[36:39], v[84:87]
ds_read_b128 v[72:75], v7 offset:6144
v_mul_f32 v209, v209, v208
v_mfma_f32_16x16x32_bf16 v[84:87], v[52:55], a[52:55], v[84:87]
v_mul_f32 v211, v211, v210
v_cvt_pk_bf16_f32 v150, v209, v211
v_mfma_f32_16x16x32_bf16 v[88:91], v[48:51], a[40:43], v[88:91]
v_mul_f32 v214, v119, v119
v_fma_f32 v212, v212, v237, v236
v_mfma_f32_16x16x32_bf16 v[88:91], v[52:55], a[56:59], v[88:91]
ds_read_b128 v[76:79], v7 offset:7168
v_fma_f32 v214, v214, v237, v236
v_mfma_f32_16x16x32_bf16 v[92:95], v[48:51], a[44:47], v[92:95]
v_mul_f32 v212, v212, v118
v_mul_f32 v214, v214, v119
v_mfma_f32_16x16x32_bf16 v[92:95], v[52:55], a[60:63], v[92:95]
v_mul_f32 v213, v118, v134
s_waitcnt lgkmcnt(4)
v_mfma_f32_16x16x32_bf16 v[96:99], v[56:59], a[32:35], v[96:99]
s_waitcnt vmcnt(19)
v_mul_f32 v215, v119, v135
v_mfma_f32_16x16x32_bf16 v[96:99], v[60:63], a[48:51], v[96:99]
s_barrier
v_mfma_f32_16x16x32_bf16 v[100:103], v[56:59], a[36:39], v[100:103]
ds_read_b128 v[48:51], v7 offset:8192
s_add_u32 m0, s22, 24576
v_mfma_f32_16x16x32_bf16 v[100:103], v[60:63], a[52:55], v[100:103]
v_add_u32 v3, 20480, v3
buffer_load_dwordx4 v3, s[8:11], 0 offen offset:0 sc1 lds
v_mfma_f32_16x16x32_bf16 v[104:107], v[56:59], a[40:43], v[104:107]
v_exp_f32 v212, v212
v_mfma_f32_16x16x32_bf16 v[104:107], v[60:63], a[56:59], v[104:107]
ds_read_b128 v[52:55], v7 offset:9216
v_fma_f32 v212, v212, v238, v238
v_mfma_f32_16x16x32_bf16 v[108:111], v[56:59], a[44:47], v[108:111]
v_exp_f32 v214, v214
v_mfma_f32_16x16x32_bf16 v[108:111], v[60:63], a[60:63], v[108:111]
v_fma_f32 v214, v214, v238, v238
s_waitcnt lgkmcnt(4)
v_mfma_f32_16x16x32_bf16 v[80:83], v[64:67], a[64:67], v[80:83]
buffer_load_dwordx4 v3, s[8:11], 0 offen offset:1024 sc1 lds
v_mfma_f32_16x16x32_bf16 v[80:83], v[68:71], a[80:83], v[80:83]
v_rcp_f32 v212, v212
v_mfma_f32_16x16x32_bf16 v[84:87], v[64:67], a[68:71], v[84:87]
ds_read_b128 v[56:59], v7 offset:10240
v_mul_f32 v213, v213, v212
v_mfma_f32_16x16x32_bf16 v[84:87], v[68:71], a[84:87], v[84:87]
v_rcp_f32 v214, v214
v_mfma_f32_16x16x32_bf16 v[88:91], v[64:67], a[72:75], v[88:91]
v_mul_f32 v215, v215, v214
v_cvt_pk_bf16_f32 v151, v213, v215
v_mfma_f32_16x16x32_bf16 v[88:91], v[68:71], a[88:91], v[88:91]
ds_read_b128 v[60:63], v7 offset:11264
v_mul_f32 v208, v120, v120
v_mfma_f32_16x16x32_bf16 v[92:95], v[64:67], a[76:79], v[92:95]
buffer_load_dwordx4 v3, s[8:11], 0 offen offset:2048 sc1 lds
v_mfma_f32_16x16x32_bf16 v[92:95], v[68:71], a[92:95], v[92:95]
v_mul_f32 v210, v121, v121
s_waitcnt lgkmcnt(4)
v_mfma_f32_16x16x32_bf16 v[96:99], v[72:75], a[64:67], v[96:99]
buffer_store_dwordx4 v[148:151], v4, s[8:11], s24 offen offset:0 sc1
v_mfma_f32_16x16x32_bf16 v[96:99], v[76:79], a[80:83], v[96:99]
v_fma_f32 v208, v208, v241, v240
v_fma_f32 v210, v210, v241, v240
v_mfma_f32_16x16x32_bf16 v[100:103], v[72:75], a[68:71], v[100:103]
ds_read_b128 v[64:67], v7 offset:12288
v_mul_f32 v208, v208, v120
v_mfma_f32_16x16x32_bf16 v[100:103], v[76:79], a[84:87], v[100:103]
v_mul_f32 v210, v210, v121
v_mul_f32 v209, v120, v136
v_mfma_f32_16x16x32_bf16 v[104:107], v[72:75], a[72:75], v[104:107]
v_exp_f32 v208, v208
v_mfma_f32_16x16x32_bf16 v[104:107], v[76:79], a[88:91], v[104:107]
ds_read_b128 v[68:71], v7 offset:13312
v_mul_f32 v211, v121, v137
v_mfma_f32_16x16x32_bf16 v[108:111], v[72:75], a[76:79], v[108:111]
buffer_load_dwordx4 v3, s[8:11], 0 offen offset:3072 sc1 lds
v_mfma_f32_16x16x32_bf16 v[108:111], v[76:79], a[92:95], v[108:111]
s_add_u32 m0, s22, 28672
s_waitcnt lgkmcnt(4)
v_mfma_f32_16x16x32_bf16 v[80:83], v[48:51], a[96:99], v[80:83]
v_add_u32 v3, 4096, v3
v_fma_f32 v208, v208, v242, v242
v_mfma_f32_16x16x32_bf16 v[80:83], v[52:55], a[112:115], v[80:83]
v_exp_f32 v210, v210
v_mfma_f32_16x16x32_bf16 v[84:87], v[48:51], a[100:103], v[84:87]
ds_read_b128 v[72:75], v7 offset:14336
v_fma_f32 v210, v210, v242, v242
v_mfma_f32_16x16x32_bf16 v[84:87], v[52:55], a[116:119], v[84:87]
buffer_load_dwordx4 v3, s[8:11], 0 offen offset:0 sc1 lds
v_mfma_f32_16x16x32_bf16 v[88:91], v[48:51], a[104:107], v[88:91]
v_rcp_f32 v208, v208
v_mfma_f32_16x16x32_bf16 v[88:91], v[52:55], a[120:123], v[88:91]
ds_read_b128 v[76:79], v7 offset:15360
v_mul_f32 v209, v209, v208
v_mfma_f32_16x16x32_bf16 v[92:95], v[48:51], a[108:111], v[92:95]
v_rcp_f32 v210, v210
v_mfma_f32_16x16x32_bf16 v[92:95], v[52:55], a[124:127], v[92:95]
v_mul_f32 v211, v211, v210
s_waitcnt lgkmcnt(4)
v_mfma_f32_16x16x32_bf16 v[96:99], v[56:59], a[96:99], v[96:99]
buffer_load_dwordx4 v3, s[8:11], 0 offen offset:1024 sc1 lds
v_mfma_f32_16x16x32_bf16 v[96:99], v[60:63], a[112:115], v[96:99]
v_cvt_pk_bf16_f32 v154, v209, v211
v_mul_f32 v212, v122, v122
v_mfma_f32_16x16x32_bf16 v[100:103], v[56:59], a[100:103], v[100:103]
ds_read_b128 v[48:51], v7 offset:16384
v_mul_f32 v214, v123, v123
v_mfma_f32_16x16x32_bf16 v[100:103], v[60:63], a[116:119], v[100:103]
v_fma_f32 v212, v212, v241, v240
v_fma_f32 v214, v214, v241, v240
v_mfma_f32_16x16x32_bf16 v[104:107], v[56:59], a[104:107], v[104:107]
v_mul_f32 v212, v212, v122
v_mul_f32 v214, v214, v123
v_mfma_f32_16x16x32_bf16 v[104:107], v[60:63], a[120:123], v[104:107]
ds_read_b128 v[52:55], v7 offset:17408
v_mul_f32 v213, v122, v138
v_mfma_f32_16x16x32_bf16 v[108:111], v[56:59], a[108:111], v[108:111]
v_exp_f32 v212, v212
v_mfma_f32_16x16x32_bf16 v[108:111], v[60:63], a[124:127], v[108:111]
v_mul_f32 v215, v123, v139
s_waitcnt lgkmcnt(4)
v_mfma_f32_16x16x32_bf16 v[80:83], v[64:67], a[128:131], v[80:83]
v_exp_f32 v214, v214
v_mfma_f32_16x16x32_bf16 v[80:83], v[68:71], a[144:147], v[80:83]
v_fma_f32 v212, v212, v242, v242
v_fma_f32 v214, v214, v242, v242
v_mfma_f32_16x16x32_bf16 v[84:87], v[64:67], a[132:135], v[84:87]
ds_read_b128 v[56:59], v7 offset:18432
v_mul_f32 v208, v124, v124
v_mfma_f32_16x16x32_bf16 v[84:87], v[68:71], a[148:151], v[84:87]
v_rcp_f32 v212, v212
v_mfma_f32_16x16x32_bf16 v[88:91], v[64:67], a[136:139], v[88:91]
v_rcp_f32 v214, v214
v_mfma_f32_16x16x32_bf16 v[88:91], v[68:71], a[152:155], v[88:91]
ds_read_b128 v[60:63], v7 offset:19456
v_mul_f32 v213, v213, v212
v_mfma_f32_16x16x32_bf16 v[92:95], v[64:67], a[140:143], v[92:95]
v_mul_f32 v215, v215, v214
v_cvt_pk_bf16_f32 v155, v213, v215
v_mfma_f32_16x16x32_bf16 v[92:95], v[68:71], a[156:159], v[92:95]
v_mul_f32 v210, v125, v125
s_waitcnt lgkmcnt(4)
v_mfma_f32_16x16x32_bf16 v[96:99], v[72:75], a[128:131], v[96:99]
buffer_store_dwordx4 v[152:155], v5, s[8:11], s24 offen offset:0 sc1
v_mfma_f32_16x16x32_bf16 v[96:99], v[76:79], a[144:147], v[96:99]
v_fma_f32 v208, v208, v245, v244
v_fma_f32 v210, v210, v245, v244
v_mfma_f32_16x16x32_bf16 v[100:103], v[72:75], a[132:135], v[100:103]
ds_read_b128 v[64:67], v7 offset:20480
v_mul_f32 v208, v208, v124
v_mfma_f32_16x16x32_bf16 v[100:103], v[76:79], a[148:151], v[100:103]
v_mul_f32 v210, v210, v125
v_mul_f32 v209, v124, v140
v_mfma_f32_16x16x32_bf16 v[104:107], v[72:75], a[136:139], v[104:107]
v_exp_f32 v208, v208
v_mfma_f32_16x16x32_bf16 v[104:107], v[76:79], a[152:155], v[104:107]
ds_read_b128 v[68:71], v7 offset:21504
v_mul_f32 v211, v125, v141
v_mfma_f32_16x16x32_bf16 v[108:111], v[72:75], a[140:143], v[108:111]
v_exp_f32 v210, v210
v_mfma_f32_16x16x32_bf16 v[108:111], v[76:79], a[156:159], v[108:111]
v_fma_f32 v208, v208, v246, v246
s_waitcnt lgkmcnt(4)
v_mfma_f32_16x16x32_bf16 v[80:83], v[48:51], a[160:163], v[80:83]
v_fma_f32 v210, v210, v246, v246
v_mul_f32 v212, v126, v126
v_mfma_f32_16x16x32_bf16 v[80:83], v[52:55], a[176:179], v[80:83]
v_rcp_f32 v208, v208
v_mfma_f32_16x16x32_bf16 v[84:87], v[48:51], a[164:167], v[84:87]
ds_read_b128 v[72:75], v7 offset:22528
v_mul_f32 v209, v209, v208
v_mfma_f32_16x16x32_bf16 v[84:87], v[52:55], a[180:183], v[84:87]
v_rcp_f32 v210, v210
v_mfma_f32_16x16x32_bf16 v[88:91], v[48:51], a[168:171], v[88:91]
v_mul_f32 v211, v211, v210
v_cvt_pk_bf16_f32 v158, v209, v211
v_mfma_f32_16x16x32_bf16 v[88:91], v[52:55], a[184:187], v[88:91]
ds_read_b128 v[76:79], v7 offset:23552
v_mul_f32 v214, v127, v127
v_mfma_f32_16x16x32_bf16 v[92:95], v[48:51], a[172:175], v[92:95]
v_fma_f32 v212, v212, v245, v244
v_fma_f32 v214, v214, v245, v244
v_mfma_f32_16x16x32_bf16 v[92:95], v[52:55], a[188:191], v[92:95]
v_mul_f32 v212, v212, v126
s_waitcnt lgkmcnt(4)
v_mfma_f32_16x16x32_bf16 v[96:99], v[56:59], a[160:163], v[96:99]
v_mul_f32 v214, v214, v127
v_mul_f32 v213, v126, v142
v_mfma_f32_16x16x32_bf16 v[96:99], v[60:63], a[176:179], v[96:99]
v_exp_f32 v212, v212
v_mfma_f32_16x16x32_bf16 v[100:103], v[56:59], a[164:167], v[100:103]
ds_read_b128 v[48:51], v7 offset:24576
v_mul_f32 v215, v127, v143
v_mfma_f32_16x16x32_bf16 v[100:103], v[60:63], a[180:183], v[100:103]
v_exp_f32 v214, v214
v_mfma_f32_16x16x32_bf16 v[104:107], v[56:59], a[168:171], v[104:107]
v_fma_f32 v212, v212, v246, v246
v_fma_f32 v214, v214, v246, v246
v_mfma_f32_16x16x32_bf16 v[104:107], v[60:63], a[184:187], v[104:107]
ds_read_b128 v[52:55], v7 offset:25600
v_mul_f32 v216, v176, v176
v_mfma_f32_16x16x32_bf16 v[108:111], v[56:59], a[172:175], v[108:111]
v_rcp_f32 v212, v212
v_mfma_f32_16x16x32_bf16 v[108:111], v[60:63], a[188:191], v[108:111]
v_mul_f32 v213, v213, v212
s_waitcnt lgkmcnt(4)
v_mfma_f32_16x16x32_bf16 v[80:83], v[64:67], a[192:195], v[80:83]
v_rcp_f32 v214, v214
v_mfma_f32_16x16x32_bf16 v[80:83], v[68:71], a[208:211], v[80:83]
v_mul_f32 v215, v215, v214
v_cvt_pk_bf16_f32 v159, v213, v215
v_mfma_f32_16x16x32_bf16 v[84:87], v[64:67], a[196:199], v[84:87]
ds_read_b128 v[56:59], v7 offset:26624
v_mul_f32 v218, v177, v177
v_mfma_f32_16x16x32_bf16 v[84:87], v[68:71], a[212:215], v[84:87]
buffer_store_dwordx4 v[156:159], v6, s[8:11], s24 offen offset:0 sc1
v_mfma_f32_16x16x32_bf16 v[88:91], v[64:67], a[200:203], v[88:91]
v_fma_f32 v216, v216, v233, v232
v_fma_f32 v218, v218, v233, v232
v_mfma_f32_16x16x32_bf16 v[88:91], v[68:71], a[216:219], v[88:91]
ds_read_b128 v[60:63], v7 offset:27648
v_mul_f32 v216, v216, v176
v_mfma_f32_16x16x32_bf16 v[92:95], v[64:67], a[204:207], v[92:95]
v_mul_f32 v218, v218, v177
v_mul_f32 v217, v176, v192
v_mfma_f32_16x16x32_bf16 v[92:95], v[68:71], a[220:223], v[92:95]
v_mul_f32 v219, v177, v193
s_waitcnt lgkmcnt(4)
v_mfma_f32_16x16x32_bf16 v[96:99], v[72:75], a[192:195], v[96:99]
v_exp_f32 v216, v216
v_mfma_f32_16x16x32_bf16 v[96:99], v[76:79], a[208:211], v[96:99]
v_exp_f32 v218, v218
v_mfma_f32_16x16x32_bf16 v[100:103], v[72:75], a[196:199], v[100:103]
ds_read_b128 v[64:67], v7 offset:28672
v_fma_f32 v216, v216, v234, v234
v_mfma_f32_16x16x32_bf16 v[100:103], v[76:79], a[212:215], v[100:103]
v_fma_f32 v218, v218, v234, v234
v_mul_f32 v220, v178, v178
v_mfma_f32_16x16x32_bf16 v[104:107], v[72:75], a[200:203], v[104:107]
v_rcp_f32 v216, v216
v_mfma_f32_16x16x32_bf16 v[104:107], v[76:79], a[216:219], v[104:107]
ds_read_b128 v[68:71], v7 offset:29696
v_mul_f32 v217, v217, v216
v_mfma_f32_16x16x32_bf16 v[108:111], v[72:75], a[204:207], v[108:111]
v_rcp_f32 v218, v218
v_mfma_f32_16x16x32_bf16 v[108:111], v[76:79], a[220:223], v[108:111]
v_mul_f32 v219, v219, v218
s_waitcnt lgkmcnt(4)
v_mfma_f32_16x16x32_bf16 v[80:83], v[48:51], a[224:227], v[80:83]
v_cvt_pk_bf16_f32 v160, v217, v219
v_mul_f32 v222, v179, v179
v_mfma_f32_16x16x32_bf16 v[80:83], v[52:55], a[240:243], v[80:83]
v_fma_f32 v220, v220, v233, v232
v_fma_f32 v222, v222, v233, v232
v_mfma_f32_16x16x32_bf16 v[84:87], v[48:51], a[228:231], v[84:87]
ds_read_b128 v[72:75], v7 offset:30720
v_mul_f32 v220, v220, v178
v_mfma_f32_16x16x32_bf16 v[84:87], v[52:55], a[244:247], v[84:87]
v_mul_f32 v222, v222, v179
v_mul_f32 v221, v178, v194
v_mfma_f32_16x16x32_bf16 v[88:91], v[48:51], a[232:235], v[88:91]
v_exp_f32 v220, v220
v_mfma_f32_16x16x32_bf16 v[88:91], v[52:55], a[248:251], v[88:91]
ds_read_b128 v[76:79], v7 offset:31744
v_mul_f32 v223, v179, v195
v_mfma_f32_16x16x32_bf16 v[92:95], v[48:51], a[236:239], v[92:95]
v_exp_f32 v222, v222
v_mfma_f32_16x16x32_bf16 v[92:95], v[52:55], a[252:255], v[92:95]
v_fma_f32 v220, v220, v234, v234
s_waitcnt lgkmcnt(4)
v_mfma_f32_16x16x32_bf16 v[96:99], v[56:59], a[224:227], v[96:99]
s_waitcnt vmcnt(22)
v_fma_f32 v222, v222, v234, v234
v_mfma_f32_16x16x32_bf16 v[96:99], v[60:63], a[240:243], v[96:99]
s_barrier
v_mfma_f32_16x16x32_bf16 v[100:103], v[56:59], a[228:231], v[100:103]
ds_read_b128 v[48:51], v7 offset:32768
s_add_u32 m0, s22, 49152
v_mfma_f32_16x16x32_bf16 v[100:103], v[60:63], a[244:247], v[100:103]
v_add_u32 v3, 20480, v3
buffer_load_dwordx4 v3, s[8:11], 0 offen offset:0 sc1 lds
v_mfma_f32_16x16x32_bf16 v[104:107], v[56:59], a[232:235], v[104:107]
v_rcp_f32 v220, v220
v_mfma_f32_16x16x32_bf16 v[104:107], v[60:63], a[248:251], v[104:107]
ds_read_b128 v[52:55], v7 offset:33792
v_mul_f32 v221, v221, v220
v_mfma_f32_16x16x32_bf16 v[108:111], v[56:59], a[236:239], v[108:111]
v_rcp_f32 v222, v222
v_mfma_f32_16x16x32_bf16 v[108:111], v[60:63], a[252:255], v[108:111]
v_mul_f32 v223, v223, v222
s_waitcnt lgkmcnt(4)
v_mfma_f32_16x16x32_bf16 v[80:83], v[64:67], v[16:19], v[80:83]
buffer_load_dwordx4 v3, s[8:11], 0 offen offset:1024 sc1 lds
v_mfma_f32_16x16x32_bf16 v[80:83], v[68:71], v[32:35], v[80:83]
v_cvt_pk_bf16_f32 v161, v221, v223
v_mul_f32 v216, v180, v180
v_mfma_f32_16x16x32_bf16 v[84:87], v[64:67], v[20:23], v[84:87]
ds_read_b128 v[56:59], v7 offset:34816
v_mul_f32 v218, v181, v181
v_mfma_f32_16x16x32_bf16 v[84:87], v[68:71], v[36:39], v[84:87]
v_fma_f32 v216, v216, v237, v236
v_fma_f32 v218, v218, v237, v236
v_mfma_f32_16x16x32_bf16 v[88:91], v[64:67], v[24:27], v[88:91]
v_mul_f32 v216, v216, v180
v_mul_f32 v218, v218, v181
v_mfma_f32_16x16x32_bf16 v[88:91], v[68:71], v[40:43], v[88:91]
ds_read_b128 v[60:63], v7 offset:35840
v_mul_f32 v217, v180, v196
v_mfma_f32_16x16x32_bf16 v[92:95], v[64:67], v[28:31], v[92:95]
buffer_load_dwordx4 v3, s[8:11], 0 offen offset:2048 sc1 lds
v_mfma_f32_16x16x32_bf16 v[92:95], v[68:71], v[44:47], v[92:95]
v_mul_f32 v219, v181, v197
s_waitcnt lgkmcnt(4)
v_mfma_f32_16x16x32_bf16 v[96:99], v[72:75], v[16:19], v[96:99]
v_exp_f32 v216, v216
v_mfma_f32_16x16x32_bf16 v[96:99], v[76:79], v[32:35], v[96:99]
v_exp_f32 v218, v218
v_mfma_f32_16x16x32_bf16 v[100:103], v[72:75], v[20:23], v[100:103]
ds_read_b128 v[64:67], v7 offset:36864
v_fma_f32 v216, v216, v238, v238
v_mfma_f32_16x16x32_bf16 v[100:103], v[76:79], v[36:39], v[100:103]
buffer_load_dwordx4 v3, s[8:11], 0 offen offset:3072 sc1 lds
v_mfma_f32_16x16x32_bf16 v[104:107], v[72:75], v[24:27], v[104:107]
s_add_u32 m0, s22, 53248
v_add_u32 v3, 4096, v3
v_mfma_f32_16x16x32_bf16 v[104:107], v[76:79], v[40:43], v[104:107]
ds_read_b128 v[68:71], v7 offset:37888
v_fma_f32 v218, v218, v238, v238
v_mfma_f32_16x16x32_bf16 v[108:111], v[72:75], v[28:31], v[108:111]
v_rcp_f32 v216, v216
v_mfma_f32_16x16x32_bf16 v[108:111], v[76:79], v[44:47], v[108:111]
v_mul_f32 v217, v217, v216
s_waitcnt lgkmcnt(4)
v_mfma_f32_16x16x32_bf16 v[112:115], v[48:51], a[0:3], 0
buffer_load_dwordx4 v3, s[8:11], 0 offen offset:0 sc1 lds
v_mfma_f32_16x16x32_bf16 v[112:115], v[52:55], a[16:19], v[112:115]
v_rcp_f32 v218, v218
v_mfma_f32_16x16x32_bf16 v[116:119], v[48:51], a[4:7], 0
ds_read_b128 v[72:75], v7 offset:38912
v_mul_f32 v219, v219, v218
v_mfma_f32_16x16x32_bf16 v[116:119], v[52:55], a[20:23], v[116:119]
v_mul_f32 v208, v80, v80
v_mul_f32 v210, v81, v81
v_mfma_f32_16x16x32_bf16 v[120:123], v[48:51], a[8:11], 0
v_fma_f32 v208, v208, v233, v232
v_fma_f32 v210, v210, v233, v232
v_mfma_f32_16x16x32_bf16 v[120:123], v[52:55], a[24:27], v[120:123]
ds_read_b128 v[76:79], v7 offset:39936
v_mul_f32 v208, v208, v80
v_mfma_f32_16x16x32_bf16 v[124:127], v[48:51], a[12:15], 0
buffer_load_dwordx4 v3, s[8:11], 0 offen offset:1024 sc1 lds
v_mfma_f32_16x16x32_bf16 v[124:127], v[52:55], a[28:31], v[124:127]
v_mul_f32 v210, v210, v81
s_waitcnt lgkmcnt(4)
v_mfma_f32_16x16x32_bf16 v[128:131], v[56:59], a[0:3], 0
v_exp_f32 v208, v208
v_mfma_f32_16x16x32_bf16 v[128:131], v[60:63], a[16:19], v[128:131]
v_exp_f32 v210, v210
v_mfma_f32_16x16x32_bf16 v[132:135], v[56:59], a[4:7], 0
ds_read_b128 v[48:51], v7 offset:40960
v_mul_f32 v209, v80, v96
v_mfma_f32_16x16x32_bf16 v[132:135], v[60:63], a[20:23], v[132:135]
v_mul_f32 v211, v81, v97
v_fma_f32 v208, v208, v234, v234
v_mfma_f32_16x16x32_bf16 v[136:139], v[56:59], a[8:11], 0
v_fma_f32 v210, v210, v234, v234
v_mul_f32 v212, v82, v82
v_mfma_f32_16x16x32_bf16 v[136:139], v[60:63], a[24:27], v[136:139]
ds_read_b128 v[52:55], v7 offset:41984
v_mul_f32 v214, v83, v83
v_mfma_f32_16x16x32_bf16 v[140:143], v[56:59], a[12:15], 0
v_rcp_f32 v208, v208
v_mfma_f32_16x16x32_bf16 v[140:143], v[60:63], a[28:31], v[140:143]
v_mul_f32 v209, v209, v208
s_waitcnt lgkmcnt(4)
v_mfma_f32_16x16x32_bf16 v[112:115], v[64:67], a[32:35], v[112:115]
v_rcp_f32 v210, v210
v_mfma_f32_16x16x32_bf16 v[112:115], v[68:71], a[48:51], v[112:115]
v_mul_f32 v211, v211, v210
v_cvt_pk_bf16_f32 v162, v209, v211
v_mfma_f32_16x16x32_bf16 v[116:119], v[64:67], a[36:39], v[116:119]
ds_read_b128 v[56:59], v7 offset:43008
v_fma_f32 v212, v212, v233, v232
v_mfma_f32_16x16x32_bf16 v[116:119], v[68:71], a[52:55], v[116:119]
v_fma_f32 v214, v214, v233, v232
v_mul_f32 v212, v212, v82
v_mfma_f32_16x16x32_bf16 v[120:123], v[64:67], a[40:43], v[120:123]
v_mul_f32 v214, v214, v83
v_mul_f32 v213, v82, v98
v_mfma_f32_16x16x32_bf16 v[120:123], v[68:71], a[56:59], v[120:123]
ds_read_b128 v[60:63], v7 offset:44032
v_mul_f32 v215, v83, v99
v_mfma_f32_16x16x32_bf16 v[124:127], v[64:67], a[44:47], v[124:127]
v_exp_f32 v212, v212
v_mfma_f32_16x16x32_bf16 v[124:127], v[68:71], a[60:63], v[124:127]
v_fma_f32 v212, v212, v234, v234
s_waitcnt lgkmcnt(4)
v_mfma_f32_16x16x32_bf16 v[128:131], v[72:75], a[32:35], v[128:131]
v_exp_f32 v214, v214
v_mfma_f32_16x16x32_bf16 v[128:131], v[76:79], a[48:51], v[128:131]
v_fma_f32 v214, v214, v234, v234
v_mul_f32 v208, v84, v84
v_mfma_f32_16x16x32_bf16 v[132:135], v[72:75], a[36:39], v[132:135]
ds_read_b128 v[64:67], v7 offset:45056
v_mul_f32 v210, v85, v85
v_mfma_f32_16x16x32_bf16 v[132:135], v[76:79], a[52:55], v[132:135]
v_rcp_f32 v212, v212
v_mfma_f32_16x16x32_bf16 v[136:139], v[72:75], a[40:43], v[136:139]
v_rcp_f32 v214, v214
v_mfma_f32_16x16x32_bf16 v[136:139], v[76:79], a[56:59], v[136:139]
ds_read_b128 v[68:71], v7 offset:46080
v_mul_f32 v213, v213, v212
v_mfma_f32_16x16x32_bf16 v[140:143], v[72:75], a[44:47], v[140:143]
v_mul_f32 v215, v215, v214
v_cvt_pk_bf16_f32 v163, v213, v215
v_mfma_f32_16x16x32_bf16 v[140:143], v[76:79], a[60:63], v[140:143]
v_fma_f32 v208, v208, v237, v236
s_waitcnt lgkmcnt(4)
v_mfma_f32_16x16x32_bf16 v[112:115], v[48:51], a[64:67], v[112:115]
v_fma_f32 v210, v210, v237, v236
v_mul_f32 v208, v208, v84
v_mfma_f32_16x16x32_bf16 v[112:115], v[52:55], a[80:83], v[112:115]
v_mul_f32 v210, v210, v85
v_mul_f32 v209, v84, v100
v_mfma_f32_16x16x32_bf16 v[116:119], v[48:51], a[68:71], v[116:119]
ds_read_b128 v[72:75], v7 offset:47104
v_mul_f32 v211, v85, v101
v_mfma_f32_16x16x32_bf16 v[116:119], v[52:55], a[84:87], v[116:119]
v_exp_f32 v208, v208
v_mfma_f32_16x16x32_bf16 v[120:123], v[48:51], a[72:75], v[120:123]
v_exp_f32 v210, v210
v_mfma_f32_16x16x32_bf16 v[120:123], v[52:55], a[88:91], v[120:123]
ds_read_b128 v[76:79], v7 offset:48128
v_fma_f32 v208, v208, v238, v238
v_mfma_f32_16x16x32_bf16 v[124:127], v[48:51], a[76:79], v[124:127]
v_fma_f32 v210, v210, v238, v238
v_mul_f32 v212, v86, v86
v_mfma_f32_16x16x32_bf16 v[124:127], v[52:55], a[92:95], v[124:127]
v_mul_f32 v214, v87, v87
s_waitcnt lgkmcnt(4)
v_mfma_f32_16x16x32_bf16 v[128:131], v[56:59], a[64:67], v[128:131]
v_rcp_f32 v208, v208
v_mfma_f32_16x16x32_bf16 v[128:131], v[60:63], a[80:83], v[128:131]
v_rcp_f32 v210, v210
v_mfma_f32_16x16x32_bf16 v[132:135], v[56:59], a[68:71], v[132:135]
ds_read_b128 v[48:51], v7 offset:49152
v_mul_f32 v209, v209, v208
v_mfma_f32_16x16x32_bf16 v[132:135], v[60:63], a[84:87], v[132:135]
v_mul_f32 v211, v211, v210
v_cvt_pk_bf16_f32 v166, v209, v211
v_mfma_f32_16x16x32_bf16 v[136:139], v[56:59], a[72:75], v[136:139]
v_fma_f32 v212, v212, v237, v236
v_fma_f32 v214, v214, v237, v236
v_mfma_f32_16x16x32_bf16 v[136:139], v[60:63], a[88:91], v[136:139]
ds_read_b128 v[52:55], v7 offset:50176
v_mul_f32 v212, v212, v86
v_mfma_f32_16x16x32_bf16 v[140:143], v[56:59], a[76:79], v[140:143]
v_mul_f32 v214, v214, v87
v_mul_f32 v213, v86, v102
v_mfma_f32_16x16x32_bf16 v[140:143], v[60:63], a[92:95], v[140:143]
v_mul_f32 v215, v87, v103
s_waitcnt lgkmcnt(4)
v_mfma_f32_16x16x32_bf16 v[112:115], v[64:67], a[96:99], v[112:115]
v_exp_f32 v212, v212
v_mfma_f32_16x16x32_bf16 v[112:115], v[68:71], a[112:115], v[112:115]
v_exp_f32 v214, v214
v_mfma_f32_16x16x32_bf16 v[116:119], v[64:67], a[100:103], v[116:119]
ds_read_b128 v[56:59], v7 offset:51200
v_fma_f32 v212, v212, v238, v238
L_hop5:
s_cmp_eq_u32 s15, 1
s_cbranch_scc1 L_hop9
v_mfma_f32_16x16x32_bf16 v[116:119], v[68:71], a[116:119], v[116:119]
v_fma_f32 v214, v214, v238, v238
v_mul_f32 v208, v88, v88
v_mfma_f32_16x16x32_bf16 v[120:123], v[64:67], a[104:107], v[120:123]
v_rcp_f32 v212, v212
v_mfma_f32_16x16x32_bf16 v[120:123], v[68:71], a[120:123], v[120:123]
ds_read_b128 v[60:63], v7 offset:52224
v_mul_f32 v213, v213, v212
v_mfma_f32_16x16x32_bf16 v[124:127], v[64:67], a[108:111], v[124:127]
v_rcp_f32 v214, v214
v_mfma_f32_16x16x32_bf16 v[124:127], v[68:71], a[124:127], v[124:127]
v_mul_f32 v215, v215, v214
s_waitcnt lgkmcnt(4)
v_mfma_f32_16x16x32_bf16 v[128:131], v[72:75], a[96:99], v[128:131]
v_cvt_pk_bf16_f32 v167, v213, v215
v_mul_f32 v210, v89, v89
v_mfma_f32_16x16x32_bf16 v[128:131], v[76:79], a[112:115], v[128:131]
v_fma_f32 v208, v208, v241, v240
v_fma_f32 v210, v210, v241, v240
v_mfma_f32_16x16x32_bf16 v[132:135], v[72:75], a[100:103], v[132:135]
ds_read_b128 v[64:67], v7 offset:53248
v_mul_f32 v208, v208, v88
v_mfma_f32_16x16x32_bf16 v[132:135], v[76:79], a[116:119], v[132:135]
v_mul_f32 v210, v210, v89
v_mul_f32 v209, v88, v104
v_mfma_f32_16x16x32_bf16 v[136:139], v[72:75], a[104:107], v[136:139]
v_exp_f32 v208, v208
v_mfma_f32_16x16x32_bf16 v[136:139], v[76:79], a[120:123], v[136:139]
ds_read_b128 v[68:71], v7 offset:54272
v_mul_f32 v211, v89, v105
v_mfma_f32_16x16x32_bf16 v[140:143], v[72:75], a[108:111], v[140:143]
v_exp_f32 v210, v210
v_mfma_f32_16x16x32_bf16 v[140:143], v[76:79], a[124:127], v[140:143]
v_fma_f32 v208, v208, v242, v242
s_waitcnt lgkmcnt(4)
v_mfma_f32_16x16x32_bf16 v[112:115], v[48:51], a[128:131], v[112:115]
v_fma_f32 v210, v210, v242, v242
v_mul_f32 v212, v90, v90
v_mfma_f32_16x16x32_bf16 v[112:115], v[52:55], a[144:147], v[112:115]
v_rcp_f32 v208, v208
v_mfma_f32_16x16x32_bf16 v[116:119], v[48:51], a[132:135], v[116:119]
ds_read_b128 v[72:75], v7 offset:55296
v_mul_f32 v209, v209, v208
v_mfma_f32_16x16x32_bf16 v[116:119], v[52:55], a[148:151], v[116:119]
v_rcp_f32 v210, v210
v_mfma_f32_16x16x32_bf16 v[120:123], v[48:51], a[136:139], v[120:123]
v_mul_f32 v211, v211, v210
v_cvt_pk_bf16_f32 v170, v209, v211
v_mfma_f32_16x16x32_bf16 v[120:123], v[52:55], a[152:155], v[120:123]
ds_read_b128 v[76:79], v7 offset:56320
v_mul_f32 v214, v91, v91
v_mfma_f32_16x16x32_bf16 v[124:127], v[48:51], a[140:143], v[124:127]
v_fma_f32 v212, v212, v241, v240
v_fma_f32 v214, v214, v241, v240
v_mfma_f32_16x16x32_bf16 v[124:127], v[52:55], a[156:159], v[124:127]
v_mul_f32 v212, v212, v90
s_waitcnt lgkmcnt(4)
v_mfma_f32_16x16x32_bf16 v[128:131], v[56:59], a[128:131], v[128:131]
s_waitcnt vmcnt(22)
v_mul_f32 v214, v214, v91
v_mfma_f32_16x16x32_bf16 v[128:131], v[60:63], a[144:147], v[128:131]
s_barrier
v_mfma_f32_16x16x32_bf16 v[132:135], v[56:59], a[132:135], v[132:135]
ds_read_b128 v[48:51], v7 offset:57344
s_add_u32 m0, s22, 73728
v_mfma_f32_16x16x32_bf16 v[132:135], v[60:63], a[148:151], v[132:135]
v_add_u32 v3, 20480, v3
buffer_load_dwordx4 v3, s[8:11], 0 offen offset:0 sc1 lds
v_mfma_f32_16x16x32_bf16 v[136:139], v[56:59], a[136:139], v[136:139]
v_exp_f32 v212, v212
v_mfma_f32_16x16x32_bf16 v[136:139], v[60:63], a[152:155], v[136:139]
ds_read_b128 v[52:55], v7 offset:58368
v_mul_f32 v213, v90, v106
v_mfma_f32_16x16x32_bf16 v[140:143], v[56:59], a[140:143], v[140:143]
v_exp_f32 v214, v214
v_mfma_f32_16x16x32_bf16 v[140:143], v[60:63], a[156:159], v[140:143]
v_mul_f32 v215, v91, v107
s_waitcnt lgkmcnt(4)
v_mfma_f32_16x16x32_bf16 v[112:115], v[64:67], a[160:163], v[112:115]
buffer_load_dwordx4 v3, s[8:11], 0 offen offset:1024 sc1 lds
v_mfma_f32_16x16x32_bf16 v[112:115], v[68:71], a[176:179], v[112:115]
v_fma_f32 v212, v212, v242, v242
v_fma_f32 v214, v214, v242, v242
v_mfma_f32_16x16x32_bf16 v[116:119], v[64:67], a[164:167], v[116:119]
ds_read_b128 v[56:59], v7 offset:59392
v_mul_f32 v208, v92, v92
v_mfma_f32_16x16x32_bf16 v[116:119], v[68:71], a[180:183], v[116:119]
v_rcp_f32 v212, v212
v_mfma_f32_16x16x32_bf16 v[120:123], v[64:67], a[168:171], v[120:123]
v_rcp_f32 v214, v214
v_mfma_f32_16x16x32_bf16 v[120:123], v[68:71], a[184:187], v[120:123]
ds_read_b128 v[60:63], v7 offset:60416
v_mul_f32 v213, v213, v212
v_mfma_f32_16x16x32_bf16 v[124:127], v[64:67], a[172:175], v[124:127]
buffer_load_dwordx4 v3, s[8:11], 0 offen offset:2048 sc1 lds
v_mfma_f32_16x16x32_bf16 v[124:127], v[68:71], a[188:191], v[124:127]
v_mul_f32 v215, v215, v214
s_waitcnt lgkmcnt(4)
v_mfma_f32_16x16x32_bf16 v[128:131], v[72:75], a[160:163], v[128:131]
v_cvt_pk_bf16_f32 v171, v213, v215
v_mul_f32 v210, v93, v93
v_mfma_f32_16x16x32_bf16 v[128:131], v[76:79], a[176:179], v[128:131]
v_fma_f32 v208, v208, v245, v244
v_fma_f32 v210, v210, v245, v244
v_mfma_f32_16x16x32_bf16 v[132:135], v[72:75], a[164:167], v[132:135]
ds_read_b128 v[64:67], v7 offset:61440
v_mul_f32 v208, v208, v92
v_mfma_f32_16x16x32_bf16 v[132:135], v[76:79], a[180:183], v[132:135]
buffer_load_dwordx4 v3, s[8:11], 0 offen offset:3072 sc1 lds
v_mfma_f32_16x16x32_bf16 v[136:139], v[72:75], a[168:171], v[136:139]
s_add_u32 m0, s22, 77824
v_add_u32 v3, 4096, v3
v_mfma_f32_16x16x32_bf16 v[136:139], v[76:79], a[184:187], v[136:139]
ds_read_b128 v[68:71], v7 offset:62464
v_mul_f32 v210, v210, v93
v_mfma_f32_16x16x32_bf16 v[140:143], v[72:75], a[172:175], v[140:143]
v_exp_f32 v208, v208
v_mfma_f32_16x16x32_bf16 v[140:143], v[76:79], a[188:191], v[140:143]
v_mul_f32 v209, v92, v108
s_waitcnt lgkmcnt(4)
v_mfma_f32_16x16x32_bf16 v[112:115], v[48:51], a[192:195], v[112:115]
buffer_load_dwordx4 v3, s[8:11], 0 offen offset:0 sc1 lds
v_mfma_f32_16x16x32_bf16 v[112:115], v[52:55], a[208:211], v[112:115]
v_exp_f32 v210, v210
v_mfma_f32_16x16x32_bf16 v[116:119], v[48:51], a[196:199], v[116:119]
ds_read_b128 v[72:75], v7 offset:63488
v_mul_f32 v211, v93, v109
v_mfma_f32_16x16x32_bf16 v[116:119], v[52:55], a[212:215], v[116:119]
v_fma_f32 v208, v208, v246, v246
v_fma_f32 v210, v210, v246, v246
v_mfma_f32_16x16x32_bf16 v[120:123], v[48:51], a[200:203], v[120:123]
v_rcp_f32 v208, v208
v_mfma_f32_16x16x32_bf16 v[120:123], v[52:55], a[216:219], v[120:123]
ds_read_b128 v[76:79], v7 offset:64512
v_mul_f32 v209, v209, v208
v_mfma_f32_16x16x32_bf16 v[124:127], v[48:51], a[204:207], v[124:127]
buffer_load_dwordx4 v3, s[8:11], 0 offen offset:1024 sc1 lds
v_mfma_f32_16x16x32_bf16 v[124:127], v[52:55], a[220:223], v[124:127]
v_mul_f32 v212, v94, v94
s_waitcnt lgkmcnt(4)
v_mfma_f32_16x16x32_bf16 v[128:131], v[56:59], a[192:195], v[128:131]
v_rcp_f32 v210, v210
v_mfma_f32_16x16x32_bf16 v[128:131], v[60:63], a[208:211], v[128:131]
v_mul_f32 v211, v211, v210
v_cvt_pk_bf16_f32 v174, v209, v211
v_mfma_f32_16x16x32_bf16 v[132:135], v[56:59], a[196:199], v[132:135]
ds_read_b128 v[48:51], v8 offset:0
v_mul_f32 v214, v95, v95
v_mfma_f32_16x16x32_bf16 v[132:135], v[60:63], a[212:215], v[132:135]
v_fma_f32 v212, v212, v245, v244
v_fma_f32 v214, v214, v245, v244
v_mfma_f32_16x16x32_bf16 v[136:139], v[56:59], a[200:203], v[136:139]
v_mul_f32 v212, v212, v94
v_mul_f32 v214, v214, v95
v_mfma_f32_16x16x32_bf16 v[136:139], v[60:63], a[216:219], v[136:139]
ds_read_b128 v[52:55], v8 offset:1024
v_mul_f32 v213, v94, v110
v_mfma_f32_16x16x32_bf16 v[140:143], v[56:59], a[204:207], v[140:143]
v_exp_f32 v212, v212
v_mfma_f32_16x16x32_bf16 v[140:143], v[60:63], a[220:223], v[140:143]
v_mul_f32 v215, v95, v111
s_waitcnt lgkmcnt(4)
v_mfma_f32_16x16x32_bf16 v[112:115], v[64:67], a[224:227], v[112:115]
v_exp_f32 v214, v214
v_mfma_f32_16x16x32_bf16 v[112:115], v[68:71], a[240:243], v[112:115]
v_fma_f32 v212, v212, v246, v246
v_fma_f32 v214, v214, v246, v246
v_mfma_f32_16x16x32_bf16 v[116:119], v[64:67], a[228:231], v[116:119]
ds_read_b128 v[56:59], v8 offset:2048
v_cvt_pk_bf16_f32 v164, v217, v219
v_mfma_f32_16x16x32_bf16 v[116:119], v[68:71], a[244:247], v[116:119]
v_rcp_f32 v212, v212
v_mfma_f32_16x16x32_bf16 v[120:123], v[64:67], a[232:235], v[120:123]
v_rcp_f32 v214, v214
v_mfma_f32_16x16x32_bf16 v[120:123], v[68:71], a[248:251], v[120:123]
ds_read_b128 v[60:63], v8 offset:3072
v_mul_f32 v213, v213, v212
v_mfma_f32_16x16x32_bf16 v[124:127], v[64:67], a[236:239], v[124:127]
v_mul_f32 v215, v215, v214
v_cvt_pk_bf16_f32 v175, v213, v215
v_mfma_f32_16x16x32_bf16 v[124:127], v[68:71], a[252:255], v[124:127]
v_mul_f32 v220, v182, v182
s_waitcnt lgkmcnt(4)
v_mfma_f32_16x16x32_bf16 v[128:131], v[72:75], a[224:227], v[128:131]
v_mul_f32 v222, v183, v183
v_fma_f32 v220, v220, v237, v236
v_mfma_f32_16x16x32_bf16 v[128:131], v[76:79], a[240:243], v[128:131]
v_fma_f32 v222, v222, v237, v236
v_mul_f32 v220, v220, v182
v_mfma_f32_16x16x32_bf16 v[132:135], v[72:75], a[228:231], v[132:135]
ds_read_b128 v[64:67], v8 offset:4096
v_mul_f32 v222, v222, v183
v_mfma_f32_16x16x32_bf16 v[132:135], v[76:79], a[244:247], v[132:135]
v_exp_f32 v220, v220
v_mfma_f32_16x16x32_bf16 v[136:139], v[72:75], a[232:235], v[136:139]
v_exp_f32 v222, v222
v_mfma_f32_16x16x32_bf16 v[136:139], v[76:79], a[248:251], v[136:139]
ds_read_b128 v[68:71], v8 offset:5120
v_mul_f32 v221, v182, v198
v_mfma_f32_16x16x32_bf16 v[140:143], v[72:75], a[236:239], v[140:143]
v_mul_f32 v223, v183, v199
v_fma_f32 v220, v220, v238, v238
v_mfma_f32_16x16x32_bf16 v[140:143], v[76:79], a[252:255], v[140:143]
v_fma_f32 v222, v222, v238, v238
s_waitcnt lgkmcnt(4)
v_mfma_f32_16x16x32_bf16 v[112:115], v[48:51], v[16:19], v[112:115]
v_rcp_f32 v220, v220
v_mfma_f32_16x16x32_bf16 v[112:115], v[52:55], v[32:35], v[112:115]
v_rcp_f32 v222, v222
v_mfma_f32_16x16x32_bf16 v[116:119], v[48:51], v[20:23], v[116:119]
ds_read_b128 v[72:75], v8 offset:6144
v_mul_f32 v221, v221, v220
v_mfma_f32_16x16x32_bf16 v[116:119], v[52:55], v[36:39], v[116:119]
v_mul_f32 v223, v223, v222
v_cvt_pk_bf16_f32 v165, v221, v223
v_mfma_f32_16x16x32_bf16 v[120:123], v[48:51], v[24:27], v[120:123]
v_mul_f32 v216, v184, v184
v_mul_f32 v218, v185, v185
v_mfma_f32_16x16x32_bf16 v[120:123], v[52:55], v[40:43], v[120:123]
ds_read_b128 v[76:79], v8 offset:7168
v_fma_f32 v216, v216, v241, v240
v_mfma_f32_16x16x32_bf16 v[124:127], v[48:51], v[28:31], v[124:127]
v_fma_f32 v218, v218, v241, v240
v_mul_f32 v216, v216, v184
v_mfma_f32_16x16x32_bf16 v[124:127], v[52:55], v[44:47], v[124:127]
v_mul_f32 v218, v218, v185
s_waitcnt lgkmcnt(4)
v_mfma_f32_16x16x32_bf16 v[128:131], v[56:59], v[16:19], v[128:131]
v_exp_f32 v216, v216
v_mfma_f32_16x16x32_bf16 v[128:131], v[60:63], v[32:35], v[128:131]
v_exp_f32 v218, v218
v_mfma_f32_16x16x32_bf16 v[132:135], v[56:59], v[20:23], v[132:135]
ds_read_b128 v[48:51], v8 offset:8192
v_mul_f32 v217, v184, v200
v_mfma_f32_16x16x32_bf16 v[132:135], v[60:63], v[36:39], v[132:135]
v_mul_f32 v219, v185, v201
v_fma_f32 v216, v216, v242, v242
v_mfma_f32_16x16x32_bf16 v[136:139], v[56:59], v[24:27], v[136:139]
v_fma_f32 v218, v218, v242, v242
v_mul_f32 v220, v186, v186
v_mfma_f32_16x16x32_bf16 v[136:139], v[60:63], v[40:43], v[136:139]
ds_read_b128 v[52:55], v8 offset:9216
v_mul_f32 v222, v187, v187
v_mfma_f32_16x16x32_bf16 v[140:143], v[56:59], v[28:31], v[140:143]
v_rcp_f32 v216, v216
v_mfma_f32_16x16x32_bf16 v[140:143], v[60:63], v[44:47], v[140:143]
v_mul_f32 v217, v217, v216
s_waitcnt lgkmcnt(4)
v_mfma_f32_16x16x32_bf16 v[80:83], v[64:67], a[0:3], 0
v_rcp_f32 v218, v218
v_mfma_f32_16x16x32_bf16 v[80:83], v[68:71], a[16:19], v[80:83]
v_mul_f32 v219, v219, v218
v_cvt_pk_bf16_f32 v168, v217, v219
v_mfma_f32_16x16x32_bf16 v[84:87], v[64:67], a[4:7], 0
ds_read_b128 v[56:59], v8 offset:10240
v_fma_f32 v220, v220, v241, v240
v_mfma_f32_16x16x32_bf16 v[84:87], v[68:71], a[20:23], v[84:87]
v_fma_f32 v222, v222, v241, v240
v_mul_f32 v220, v220, v186
v_mfma_f32_16x16x32_bf16 v[88:91], v[64:67], a[8:11], 0
v_mul_f32 v222, v222, v187
v_mul_f32 v221, v186, v202
v_mfma_f32_16x16x32_bf16 v[88:91], v[68:71], a[24:27], v[88:91]
ds_read_b128 v[60:63], v8 offset:11264
v_mul_f32 v223, v187, v203
v_mfma_f32_16x16x32_bf16 v[92:95], v[64:67], a[12:15], 0
v_exp_f32 v220, v220
v_mfma_f32_16x16x32_bf16 v[92:95], v[68:71], a[28:31], v[92:95]
v_fma_f32 v220, v220, v242, v242
s_waitcnt lgkmcnt(4)
v_mfma_f32_16x16x32_bf16 v[96:99], v[72:75], a[0:3], 0
v_exp_f32 v222, v222
v_mfma_f32_16x16x32_bf16 v[96:99], v[76:79], a[16:19], v[96:99]
v_fma_f32 v222, v222, v242, v242
v_mul_f32 v216, v188, v188
v_mfma_f32_16x16x32_bf16 v[100:103], v[72:75], a[4:7], 0
ds_read_b128 v[64:67], v8 offset:12288
v_mul_f32 v218, v189, v189
v_mfma_f32_16x16x32_bf16 v[100:103], v[76:79], a[20:23], v[100:103]
v_rcp_f32 v220, v220
v_mfma_f32_16x16x32_bf16 v[104:107], v[72:75], a[8:11], 0
v_rcp_f32 v222, v222
v_mfma_f32_16x16x32_bf16 v[104:107], v[76:79], a[24:27], v[104:107]
ds_read_b128 v[68:71], v8 offset:13312
v_mul_f32 v221, v221, v220
v_mfma_f32_16x16x32_bf16 v[108:111], v[72:75], a[12:15], 0
v_mul_f32 v223, v223, v222
v_cvt_pk_bf16_f32 v169, v221, v223
v_mfma_f32_16x16x32_bf16 v[108:111], v[76:79], a[28:31], v[108:111]
v_fma_f32 v216, v216, v245, v244
s_waitcnt lgkmcnt(4)
v_mfma_f32_16x16x32_bf16 v[80:83], v[48:51], a[32:35], v[80:83]
v_fma_f32 v218, v218, v245, v244
v_mul_f32 v216, v216, v188
v_mfma_f32_16x16x32_bf16 v[80:83], v[52:55], a[48:51], v[80:83]
v_mul_f32 v218, v218, v189
v_mul_f32 v217, v188, v204
v_mfma_f32_16x16x32_bf16 v[84:87], v[48:51], a[36:39], v[84:87]
ds_read_b128 v[72:75], v8 offset:14336
v_mul_f32 v219, v189, v205
v_mfma_f32_16x16x32_bf16 v[84:87], v[52:55], a[52:55], v[84:87]
v_exp_f32 v216, v216
v_mfma_f32_16x16x32_bf16 v[88:91], v[48:51], a[40:43], v[88:91]
v_exp_f32 v218, v218
v_mfma_f32_16x16x32_bf16 v[88:91], v[52:55], a[56:59], v[88:91]
ds_read_b128 v[76:79], v8 offset:15360
v_fma_f32 v216, v216, v246, v246
v_mfma_f32_16x16x32_bf16 v[92:95], v[48:51], a[44:47], v[92:95]
v_fma_f32 v218, v218, v246, v246
v_mul_f32 v220, v190, v190
v_mfma_f32_16x16x32_bf16 v[92:95], v[52:55], a[60:63], v[92:95]
v_mul_f32 v222, v191, v191
s_waitcnt lgkmcnt(4)
v_mfma_f32_16x16x32_bf16 v[96:99], v[56:59], a[32:35], v[96:99]
s_waitcnt vmcnt(22)
v_fma_f32 v220, v220, v245, v244
v_mfma_f32_16x16x32_bf16 v[96:99], v[60:63], a[48:51], v[96:99]
s_barrier
v_mfma_f32_16x16x32_bf16 v[100:103], v[56:59], a[36:39], v[100:103]
ds_read_b128 v[48:51], v2 offset:0
s_add_u32 m0, s22, 98304
v_mfma_f32_16x16x32_bf16 v[100:103], v[60:63], a[52:55], v[100:103]
v_add_u32 v3, 20480, v3
buffer_load_dwordx4 v3, s[8:11], 0 offen offset:0 sc1 lds
v_mfma_f32_16x16x32_bf16 v[104:107], v[56:59], a[40:43], v[104:107]
v_rcp_f32 v216, v216
v_mfma_f32_16x16x32_bf16 v[104:107], v[60:63], a[56:59], v[104:107]
ds_read_b128 v[52:55], v2 offset:1024
v_mul_f32 v217, v217, v216
v_mfma_f32_16x16x32_bf16 v[108:111], v[56:59], a[44:47], v[108:111]
v_rcp_f32 v218, v218
v_mfma_f32_16x16x32_bf16 v[108:111], v[60:63], a[60:63], v[108:111]
v_mul_f32 v219, v219, v218
s_waitcnt lgkmcnt(4)
v_mfma_f32_16x16x32_bf16 v[80:83], v[64:67], a[64:67], v[80:83]
buffer_load_dwordx4 v3, s[8:11], 0 offen offset:1024 sc1 lds
v_mfma_f32_16x16x32_bf16 v[80:83], v[68:71], a[80:83], v[80:83]
v_cvt_pk_bf16_f32 v172, v217, v219
v_fma_f32 v222, v222, v245, v244
v_mfma_f32_16x16x32_bf16 v[84:87], v[64:67], a[68:71], v[84:87]
ds_read_b128 v[56:59], v2 offset:2048
v_mul_f32 v220, v220, v190
v_mfma_f32_16x16x32_bf16 v[84:87], v[68:71], a[84:87], v[84:87]
v_mul_f32 v222, v222, v191
v_mul_f32 v221, v190, v206
v_mfma_f32_16x16x32_bf16 v[88:91], v[64:67], a[72:75], v[88:91]
v_exp_f32 v220, v220
v_mfma_f32_16x16x32_bf16 v[88:91], v[68:71], a[88:91], v[88:91]
ds_read_b128 v[60:63], v2 offset:3072
v_mul_f32 v223, v191, v207
v_mfma_f32_16x16x32_bf16 v[92:95], v[64:67], a[76:79], v[92:95]
buffer_load_dwordx4 v3, s[8:11], 0 offen offset:2048 sc1 lds
v_mfma_f32_16x16x32_bf16 v[92:95], v[68:71], a[92:95], v[92:95]
v_fma_f32 v220, v220, v246, v246
s_waitcnt lgkmcnt(4)
v_mfma_f32_16x16x32_bf16 v[96:99], v[72:75], a[64:67], v[96:99]
v_exp_f32 v222, v222
v_mfma_f32_16x16x32_bf16 v[96:99], v[76:79], a[80:83], v[96:99]
v_fma_f32 v222, v222, v246, v246
v_mfma_f32_16x16x32_bf16 v[100:103], v[72:75], a[68:71], v[100:103]
ds_read_b128 v[64:67], v2 offset:4096
v_mfma_f32_16x16x32_bf16 v[100:103], v[76:79], a[84:87], v[100:103]
buffer_load_dwordx4 v3, s[8:11], 0 offen offset:3072 sc1 lds
v_mfma_f32_16x16x32_bf16 v[104:107], v[72:75], a[72:75], v[104:107]
s_add_u32 m0, s22, 102400
v_add_u32 v3, 4096, v3
v_mfma_f32_16x16x32_bf16 v[104:107], v[76:79], a[88:91], v[104:107]
ds_read_b128 v[68:71], v2 offset:5120
v_mfma_f32_16x16x32_bf16 v[108:111], v[72:75], a[76:79], v[108:111]
v_rcp_f32 v220, v220
v_mfma_f32_16x16x32_bf16 v[108:111], v[76:79], a[92:95], v[108:111]
v_mul_f32 v221, v221, v220
s_waitcnt lgkmcnt(4)
v_mfma_f32_16x16x32_bf16 v[80:83], v[48:51], a[96:99], v[80:83]
buffer_load_dwordx4 v3, s[8:11], 0 offen offset:0 sc1 lds
v_mfma_f32_16x16x32_bf16 v[80:83], v[52:55], a[112:115], v[80:83]
v_rcp_f32 v222, v222
v_mfma_f32_16x16x32_bf16 v[84:87], v[48:51], a[100:103], v[84:87]
ds_read_b128 v[72:75], v2 offset:6144
v_mul_f32 v223, v223, v222
v_mfma_f32_16x16x32_bf16 v[84:87], v[52:55], a[116:119], v[84:87]
v_cvt_pk_bf16_f32 v173, v221, v223
v_mfma_f32_16x16x32_bf16 v[88:91], v[48:51], a[104:107], v[88:91]
v_mul_f32 v208, v112, v112
v_mul_f32 v210, v113, v113
v_mfma_f32_16x16x32_bf16 v[88:91], v[52:55], a[120:123], v[88:91]
ds_read_b128 v[76:79], v2 offset:7168
v_fma_f32 v208, v208, v233, v232
v_mfma_f32_16x16x32_bf16 v[92:95], v[48:51], a[108:111], v[92:95]
buffer_load_dwordx4 v3, s[8:11], 0 offen offset:1024 sc1 lds
v_mfma_f32_16x16x32_bf16 v[92:95], v[52:55], a[124:127], v[92:95]
v_fma_f32 v210, v210, v233, v232
s_waitcnt lgkmcnt(4)
v_mfma_f32_16x16x32_bf16 v[96:99], v[56:59], a[96:99], v[96:99]
v_mul_f32 v208, v208, v112
v_mul_f32 v210, v210, v113
v_mfma_f32_16x16x32_bf16 v[96:99], v[60:63], a[112:115], v[96:99]
v_exp_f32 v208, v208
v_mfma_f32_16x16x32_bf16 v[100:103], v[56:59], a[100:103], v[100:103]
ds_read_b128 v[48:51], v2 offset:8192
v_exp_f32 v210, v210
v_mfma_f32_16x16x32_bf16 v[100:103], v[60:63], a[116:119], v[100:103]
v_mul_f32 v209, v112, v128
v_mul_f32 v211, v113, v129
v_mfma_f32_16x16x32_bf16 v[104:107], v[56:59], a[104:107], v[104:107]
v_fma_f32 v208, v208, v234, v234
v_fma_f32 v210, v210, v234, v234
v_mfma_f32_16x16x32_bf16 v[104:107], v[60:63], a[120:123], v[104:107]
ds_read_b128 v[52:55], v2 offset:9216
v_rcp_f32 v208, v208
v_mfma_f32_16x16x32_bf16 v[108:111], v[56:59], a[108:111], v[108:111]
v_rcp_f32 v210, v210
v_mfma_f32_16x16x32_bf16 v[108:111], v[60:63], a[124:127], v[108:111]
v_mul_f32 v209, v209, v208
s_waitcnt lgkmcnt(4)
v_mfma_f32_16x16x32_bf16 v[80:83], v[64:67], a[128:131], v[80:83]
v_mul_f32 v211, v211, v210
v_cvt_pk_bf16_f32 v176, v209, v211
v_mfma_f32_16x16x32_bf16 v[80:83], v[68:71], a[144:147], v[80:83]
v_mul_f32 v212, v114, v114
v_mul_f32 v214, v115, v115
v_mfma_f32_16x16x32_bf16 v[84:87], v[64:67], a[132:135], v[84:87]
ds_read_b128 v[56:59], v2 offset:10240
v_fma_f32 v212, v212, v233, v232
v_mfma_f32_16x16x32_bf16 v[84:87], v[68:71], a[148:151], v[84:87]
v_fma_f32 v214, v214, v233, v232
v_mul_f32 v212, v212, v114
v_mfma_f32_16x16x32_bf16 v[88:91], v[64:67], a[136:139], v[88:91]
v_mul_f32 v214, v214, v115
v_exp_f32 v212, v212
v_mfma_f32_16x16x32_bf16 v[88:91], v[68:71], a[152:155], v[88:91]
ds_read_b128 v[60:63], v2 offset:11264
v_exp_f32 v214, v214
v_mfma_f32_16x16x32_bf16 v[92:95], v[64:67], a[140:143], v[92:95]
v_mul_f32 v213, v114, v130
v_mul_f32 v215, v115, v131
v_mfma_f32_16x16x32_bf16 v[92:95], v[68:71], a[156:159], v[92:95]
v_fma_f32 v212, v212, v234, v234
s_waitcnt lgkmcnt(4)
v_mfma_f32_16x16x32_bf16 v[96:99], v[72:75], a[128:131], v[96:99]
v_fma_f32 v214, v214, v234, v234
v_mul_f32 v208, v116, v116
v_mfma_f32_16x16x32_bf16 v[96:99], v[76:79], a[144:147], v[96:99]
v_rcp_f32 v212, v212
v_mfma_f32_16x16x32_bf16 v[100:103], v[72:75], a[132:135], v[100:103]
ds_read_b128 v[64:67], v2 offset:12288
v_rcp_f32 v214, v214
v_mfma_f32_16x16x32_bf16 v[100:103], v[76:79], a[148:151], v[100:103]
v_mul_f32 v213, v213, v212
v_mul_f32 v215, v215, v214
v_mfma_f32_16x16x32_bf16 v[104:107], v[72:75], a[136:139], v[104:107]
v_cvt_pk_bf16_f32 v177, v213, v215
v_mul_f32 v210, v117, v117
v_mfma_f32_16x16x32_bf16 v[104:107], v[76:79], a[152:155], v[104:107]
ds_read_b128 v[68:71], v2 offset:13312
v_fma_f32 v208, v208, v237, v236
v_mfma_f32_16x16x32_bf16 v[108:111], v[72:75], a[140:143], v[108:111]
v_fma_f32 v210, v210, v237, v236
v_mul_f32 v208, v208, v116
v_mfma_f32_16x16x32_bf16 v[108:111], v[76:79], a[156:159], v[108:111]
v_mul_f32 v210, v210, v117
s_waitcnt lgkmcnt(4)
v_mfma_f32_16x16x32_bf16 v[80:83], v[48:51], a[160:163], v[80:83]
v_exp_f32 v208, v208
v_mfma_f32_16x16x32_bf16 v[80:83], v[52:55], a[176:179], v[80:83]
v_exp_f32 v210, v210
v_mfma_f32_16x16x32_bf16 v[84:87], v[48:51], a[164:167], v[84:87]
ds_read_b128 v[72:75], v2 offset:14336
v_mul_f32 v209, v116, v132
v_mfma_f32_16x16x32_bf16 v[84:87], v[52:55], a[180:183], v[84:87]
v_mul_f32 v211, v117, v133
v_fma_f32 v208, v208, v238, v238
v_mfma_f32_16x16x32_bf16 v[88:91], v[48:51], a[168:171], v[88:91]
v_fma_f32 v210, v210, v238, v238
v_rcp_f32 v208, v208
v_mfma_f32_16x16x32_bf16 v[88:91], v[52:55], a[184:187], v[88:91]
ds_read_b128 v[76:79], v2 offset:15360
v_rcp_f32 v210, v210
v_mfma_f32_16x16x32_bf16 v[92:95], v[48:51], a[172:175], v[92:95]
v_mul_f32 v209, v209, v208
v_mul_f32 v211, v211, v210
v_mfma_f32_16x16x32_bf16 v[92:95], v[52:55], a[188:191], v[92:95]
v_cvt_pk_bf16_f32 v180, v209, v211
s_waitcnt lgkmcnt(4)
v_mfma_f32_16x16x32_bf16 v[96:99], v[56:59], a[160:163], v[96:99]
v_mul_f32 v212, v118, v118
v_mul_f32 v214, v119, v119
v_mfma_f32_16x16x32_bf16 v[96:99], v[60:63], a[176:179], v[96:99]
v_fma_f32 v212, v212, v237, v236
v_fma_f32 v214, v214, v237, v236
v_mfma_f32_16x16x32_bf16 v[100:103], v[56:59], a[164:167], v[100:103]
ds_read_b128 v[48:51], v2 offset:16384
v_mul_f32 v212, v212, v118
v_mfma_f32_16x16x32_bf16 v[100:103], v[60:63], a[180:183], v[100:103]
v_mul_f32 v214, v214, v119
v_exp_f32 v212, v212
v_mfma_f32_16x16x32_bf16 v[104:107], v[56:59], a[168:171], v[104:107]
v_exp_f32 v214, v214
v_mfma_f32_16x16x32_bf16 v[104:107], v[60:63], a[184:187], v[104:107]
ds_read_b128 v[52:55], v2 offset:17408
v_mul_f32 v213, v118, v134
v_mfma_f32_16x16x32_bf16 v[108:111], v[56:59], a[172:175], v[108:111]
v_mul_f32 v215, v119, v135
v_fma_f32 v212, v212, v238, v238
v_mfma_f32_16x16x32_bf16 v[108:111], v[60:63], a[188:191], v[108:111]
v_fma_f32 v214, v214, v238, v238
s_waitcnt lgkmcnt(4)
v_mfma_f32_16x16x32_bf16 v[80:83], v[64:67], a[192:195], v[80:83]
v_rcp_f32 v212, v212
v_mfma_f32_16x16x32_bf16 v[80:83], v[68:71], a[208:211], v[80:83]
v_rcp_f32 v214, v214
v_mfma_f32_16x16x32_bf16 v[84:87], v[64:67], a[196:199], v[84:87]
ds_read_b128 v[56:59], v2 offset:18432
v_mul_f32 v213, v213, v212
v_mfma_f32_16x16x32_bf16 v[84:87], v[68:71], a[212:215], v[84:87]
v_mul_f32 v215, v215, v214
v_cvt_pk_bf16_f32 v181, v213, v215
v_mfma_f32_16x16x32_bf16 v[88:91], v[64:67], a[200:203], v[88:91]
v_mul_f32 v208, v120, v120
v_mul_f32 v210, v121, v121
v_mfma_f32_16x16x32_bf16 v[88:91], v[68:71], a[216:219], v[88:91]
ds_read_b128 v[60:63], v2 offset:19456
v_fma_f32 v208, v208, v241, v240
v_mfma_f32_16x16x32_bf16 v[92:95], v[64:67], a[204:207], v[92:95]
v_fma_f32 v210, v210, v241, v240
v_mul_f32 v208, v208, v120
v_mfma_f32_16x16x32_bf16 v[92:95], v[68:71], a[220:223], v[92:95]
v_mul_f32 v210, v210, v121
s_waitcnt lgkmcnt(4)
v_mfma_f32_16x16x32_bf16 v[96:99], v[72:75], a[192:195], v[96:99]
v_exp_f32 v208, v208
v_mfma_f32_16x16x32_bf16 v[96:99], v[76:79], a[208:211], v[96:99]
v_exp_f32 v210, v210
v_mfma_f32_16x16x32_bf16 v[100:103], v[72:75], a[196:199], v[100:103]
ds_read_b128 v[64:67], v2 offset:20480
v_mul_f32 v209, v120, v136
v_mfma_f32_16x16x32_bf16 v[100:103], v[76:79], a[212:215], v[100:103]
v_mul_f32 v211, v121, v137
v_fma_f32 v208, v208, v242, v242
v_mfma_f32_16x16x32_bf16 v[104:107], v[72:75], a[200:203], v[104:107]
v_fma_f32 v210, v210, v242, v242
v_rcp_f32 v208, v208
v_mfma_f32_16x16x32_bf16 v[104:107], v[76:79], a[216:219], v[104:107]
ds_read_b128 v[68:71], v2 offset:21504
v_rcp_f32 v210, v210
v_mfma_f32_16x16x32_bf16 v[108:111], v[72:75], a[204:207], v[108:111]
v_mul_f32 v209, v209, v208
v_mul_f32 v211, v211, v210
v_mfma_f32_16x16x32_bf16 v[108:111], v[76:79], a[220:223], v[108:111]
v_cvt_pk_bf16_f32 v184, v209, v211
s_waitcnt lgkmcnt(4)
v_mfma_f32_16x16x32_bf16 v[80:83], v[48:51], a[224:227], v[80:83]
v_mul_f32 v212, v122, v122
v_mul_f32 v214, v123, v123
v_mfma_f32_16x16x32_bf16 v[80:83], v[52:55], a[240:243], v[80:83]
v_fma_f32 v212, v212, v241, v240
v_fma_f32 v214, v214, v241, v240
v_mfma_f32_16x16x32_bf16 v[84:87], v[48:51], a[228:231], v[84:87]
ds_read_b128 v[72:75], v2 offset:22528
v_mul_f32 v212, v212, v122
v_mfma_f32_16x16x32_bf16 v[84:87], v[52:55], a[244:247], v[84:87]
v_mul_f32 v214, v214, v123
v_exp_f32 v212, v212
v_mfma_f32_16x16x32_bf16 v[88:91], v[48:51], a[232:235], v[88:91]
v_exp_f32 v214, v214
v_mfma_f32_16x16x32_bf16 v[88:91], v[52:55], a[248:251], v[88:91]
ds_read_b128 v[76:79], v2 offset:23552
v_mul_f32 v213, v122, v138
v_mfma_f32_16x16x32_bf16 v[92:95], v[48:51], a[236:239], v[92:95]
v_mul_f32 v215, v123, v139
v_fma_f32 v212, v212, v242, v242
v_mfma_f32_16x16x32_bf16 v[92:95], v[52:55], a[252:255], v[92:95]
v_fma_f32 v214, v214, v242, v242
s_waitcnt lgkmcnt(4)
v_mfma_f32_16x16x32_bf16 v[96:99], v[56:59], a[224:227], v[96:99]
s_waitcnt vmcnt(20)
v_rcp_f32 v212, v212
v_mfma_f32_16x16x32_bf16 v[96:99], v[60:63], a[240:243], v[96:99]
s_barrier
v_mfma_f32_16x16x32_bf16 v[100:103], v[56:59], a[228:231], v[100:103]
ds_read_b128 v[48:51], v2 offset:24576
s_add_u32 m0, s22, 122880
v_rcp_f32 v214, v214
v_mfma_f32_16x16x32_bf16 v[100:103], v[60:63], a[244:247], v[100:103]
v_add_u32 v3, 20480, v3
buffer_load_dwordx4 v3, s[8:11], 0 offen offset:0 sc1 lds
v_mul_f32 v213, v213, v212
v_mfma_f32_16x16x32_bf16 v[104:107], v[56:59], a[232:235], v[104:107]
v_mul_f32 v215, v215, v214
v_cvt_pk_bf16_f32 v185, v213, v215
v_mfma_f32_16x16x32_bf16 v[104:107], v[60:63], a[248:251], v[104:107]
ds_read_b128 v[52:55], v2 offset:25600
v_mul_f32 v208, v124, v124
v_mfma_f32_16x16x32_bf16 v[108:111], v[56:59], a[236:239], v[108:111]
v_mul_f32 v210, v125, v125
v_fma_f32 v208, v208, v245, v244
v_mfma_f32_16x16x32_bf16 v[108:111], v[60:63], a[252:255], v[108:111]
v_fma_f32 v210, v210, v245, v244
s_waitcnt lgkmcnt(4)
v_mfma_f32_16x16x32_bf16 v[80:83], v[64:67], v[16:19], v[80:83]
buffer_load_dwordx4 v3, s[8:11], 0 offen offset:1024 sc1 lds
v_mul_f32 v208, v208, v124
v_mfma_f32_16x16x32_bf16 v[80:83], v[68:71], v[32:35], v[80:83]
v_mul_f32 v210, v210, v125
v_exp_f32 v208, v208
v_mfma_f32_16x16x32_bf16 v[84:87], v[64:67], v[20:23], v[84:87]
ds_read_b128 v[56:59], v2 offset:26624
v_exp_f32 v210, v210
v_mfma_f32_16x16x32_bf16 v[84:87], v[68:71], v[36:39], v[84:87]
v_mul_f32 v209, v124, v140
v_mul_f32 v211, v125, v141
v_mfma_f32_16x16x32_bf16 v[88:91], v[64:67], v[24:27], v[88:91]
v_fma_f32 v208, v208, v246, v246
v_fma_f32 v210, v210, v246, v246
v_mfma_f32_16x16x32_bf16 v[88:91], v[68:71], v[40:43], v[88:91]
ds_read_b128 v[60:63], v2 offset:27648
v_rcp_f32 v208, v208
v_mfma_f32_16x16x32_bf16 v[92:95], v[64:67], v[28:31], v[92:95]
buffer_load_dwordx4 v3, s[8:11], 0 offen offset:2048 sc1 lds
v_rcp_f32 v210, v210
v_mfma_f32_16x16x32_bf16 v[92:95], v[68:71], v[44:47], v[92:95]
v_mul_f32 v209, v209, v208
s_waitcnt lgkmcnt(4)
v_mfma_f32_16x16x32_bf16 v[96:99], v[72:75], v[16:19], v[96:99]
v_mul_f32 v211, v211, v210
v_cvt_pk_bf16_f32 v188, v209, v211
v_mfma_f32_16x16x32_bf16 v[96:99], v[76:79], v[32:35], v[96:99]
L_hop6:
s_cmp_eq_u32 s15, 1
s_cbranch_scc1 L_hop10
v_mul_f32 v212, v126, v126
v_mul_f32 v214, v127, v127
v_mfma_f32_16x16x32_bf16 v[100:103], v[72:75], v[20:23], v[100:103]
ds_read_b128 v[64:67], v2 offset:28672
v_fma_f32 v212, v212, v245, v244
v_mfma_f32_16x16x32_bf16 v[100:103], v[76:79], v[36:39], v[100:103]
buffer_load_dwordx4 v3, s[8:11], 0 offen offset:3072 sc1 lds
v_fma_f32 v214, v214, v245, v244
v_mfma_f32_16x16x32_bf16 v[104:107], v[72:75], v[24:27], v[104:107]
s_add_u32 m0, s22, 126976
v_add_u32 v3, 4096, v3
v_mul_f32 v212, v212, v126
v_mfma_f32_16x16x32_bf16 v[104:107], v[76:79], v[40:43], v[104:107]
ds_read_b128 v[68:71], v2 offset:29696
v_mul_f32 v214, v214, v127
v_mfma_f32_16x16x32_bf16 v[108:111], v[72:75], v[28:31], v[108:111]
v_exp_f32 v212, v212
v_mfma_f32_16x16x32_bf16 v[108:111], v[76:79], v[44:47], v[108:111]
v_exp_f32 v214, v214
v_mul_f32 v213, v126, v142
v_mul_f32 v215, v127, v143
v_fma_f32 v212, v212, v246, v246
v_fma_f32 v214, v214, v246, v246
v_rcp_f32 v212, v212
v_rcp_f32 v214, v214
v_mul_f32 v213, v213, v212
v_mul_f32 v215, v215, v214
v_cvt_pk_bf16_f32 v189, v213, v215
s_waitcnt lgkmcnt(4)
v_mfma_f32_16x16x32_bf16 v[112:115], v[48:51], a[0:3], 0
buffer_load_dwordx4 v3, s[8:11], 0 offen offset:0 sc1 lds
v_mfma_f32_16x16x32_bf16 v[112:115], v[52:55], a[16:19], v[112:115]
v_mfma_f32_16x16x32_bf16 v[116:119], v[48:51], a[4:7], 0
ds_read_b128 v[72:75], v2 offset:30720
v_mfma_f32_16x16x32_bf16 v[116:119], v[52:55], a[20:23], v[116:119]
buffer_store_dwordx4 v[160:163], v2, s[8:11], s24 offen offset:1024 sc1
v_mfma_f32_16x16x32_bf16 v[120:123], v[48:51], a[8:11], 0
v_mul_f32 v208, v80, v80
v_mul_f32 v210, v81, v81
v_mfma_f32_16x16x32_bf16 v[120:123], v[52:55], a[24:27], v[120:123]
ds_read_b128 v[76:79], v2 offset:31744
v_fma_f32 v208, v208, v233, v232
v_mfma_f32_16x16x32_bf16 v[124:127], v[48:51], a[12:15], 0
buffer_store_dwordx4 v[164:167], v4, s[8:11], s24 offen offset:1024 sc1
v_mfma_f32_16x16x32_bf16 v[124:127], v[52:55], a[28:31], v[124:127]
v_fma_f32 v210, v210, v233, v232
s_waitcnt lgkmcnt(4)
v_mfma_f32_16x16x32_bf16 v[128:131], v[56:59], a[0:3], 0
buffer_store_dwordx4 v[168:171], v5, s[8:11], s24 offen offset:1024 sc1
v_mfma_f32_16x16x32_bf16 v[128:131], v[60:63], a[16:19], v[128:131]
v_mul_f32 v208, v208, v80
v_mul_f32 v210, v210, v81
v_mfma_f32_16x16x32_bf16 v[132:135], v[56:59], a[4:7], 0
ds_read_b128 v[48:51], v2 offset:32768
v_mul_f32 v209, v80, v96
v_mfma_f32_16x16x32_bf16 v[132:135], v[60:63], a[20:23], v[132:135]
buffer_store_dwordx4 v[172:175], v6, s[8:11], s24 offen offset:1024 sc1
v_mfma_f32_16x16x32_bf16 v[136:139], v[56:59], a[8:11], 0
v_exp_f32 v208, v208
v_mfma_f32_16x16x32_bf16 v[136:139], v[60:63], a[24:27], v[136:139]
ds_read_b128 v[52:55], v2 offset:33792
v_mul_f32 v211, v81, v97
v_mfma_f32_16x16x32_bf16 v[140:143], v[56:59], a[12:15], 0
v_exp_f32 v210, v210
v_mfma_f32_16x16x32_bf16 v[140:143], v[60:63], a[28:31], v[140:143]
v_fma_f32 v208, v208, v234, v234
s_waitcnt lgkmcnt(4)
v_mfma_f32_16x16x32_bf16 v[112:115], v[64:67], a[32:35], v[112:115]
buffer_load_dwordx4 v3, s[8:11], 0 offen offset:1024 sc1 lds
v_mfma_f32_16x16x32_bf16 v[112:115], v[68:71], a[48:51], v[112:115]
v_fma_f32 v210, v210, v234, v234
v_mul_f32 v212, v82, v82
v_mfma_f32_16x16x32_bf16 v[116:119], v[64:67], a[36:39], v[116:119]
ds_read_b128 v[56:59], v2 offset:34816
v_mul_f32 v214, v83, v83
v_mfma_f32_16x16x32_bf16 v[116:119], v[68:71], a[52:55], v[116:119]
v_rcp_f32 v208, v208
v_mfma_f32_16x16x32_bf16 v[120:123], v[64:67], a[40:43], v[120:123]
v_rcp_f32 v210, v210
v_mfma_f32_16x16x32_bf16 v[120:123], v[68:71], a[56:59], v[120:123]
ds_read_b128 v[60:63], v2 offset:35840
v_mul_f32 v209, v209, v208
v_mfma_f32_16x16x32_bf16 v[124:127], v[64:67], a[44:47], v[124:127]
v_mul_f32 v211, v211, v210
v_cvt_pk_bf16_f32 v178, v209, v211
v_mfma_f32_16x16x32_bf16 v[124:127], v[68:71], a[60:63], v[124:127]
v_fma_f32 v212, v212, v233, v232
s_waitcnt lgkmcnt(4)
v_mfma_f32_16x16x32_bf16 v[128:131], v[72:75], a[32:35], v[128:131]
v_fma_f32 v214, v214, v233, v232
v_mul_f32 v212, v212, v82
v_mfma_f32_16x16x32_bf16 v[128:131], v[76:79], a[48:51], v[128:131]
v_mul_f32 v214, v214, v83
v_mul_f32 v213, v82, v98
v_mfma_f32_16x16x32_bf16 v[132:135], v[72:75], a[36:39], v[132:135]
ds_read_b128 v[64:67], v2 offset:36864
v_mul_f32 v215, v83, v99
v_mfma_f32_16x16x32_bf16 v[132:135], v[76:79], a[52:55], v[132:135]
v_exp_f32 v212, v212
v_mfma_f32_16x16x32_bf16 v[136:139], v[72:75], a[40:43], v[136:139]
v_exp_f32 v214, v214
v_mfma_f32_16x16x32_bf16 v[136:139], v[76:79], a[56:59], v[136:139]
ds_read_b128 v[68:71], v2 offset:37888
v_fma_f32 v212, v212, v234, v234
v_mfma_f32_16x16x32_bf16 v[140:143], v[72:75], a[44:47], v[140:143]
v_fma_f32 v214, v214, v234, v234
v_mul_f32 v208, v84, v84
v_mfma_f32_16x16x32_bf16 v[140:143], v[76:79], a[60:63], v[140:143]
v_mul_f32 v210, v85, v85
s_waitcnt lgkmcnt(4)
v_mfma_f32_16x16x32_bf16 v[112:115], v[48:51], a[64:67], v[112:115]
v_rcp_f32 v212, v212
v_mfma_f32_16x16x32_bf16 v[112:115], v[52:55], a[80:83], v[112:115]
v_rcp_f32 v214, v214
v_mfma_f32_16x16x32_bf16 v[116:119], v[48:51], a[68:71], v[116:119]
ds_read_b128 v[72:75], v2 offset:38912
v_mul_f32 v213, v213, v212
v_mfma_f32_16x16x32_bf16 v[116:119], v[52:55], a[84:87], v[116:119]
v_mul_f32 v215, v215, v214
v_cvt_pk_bf16_f32 v179, v213, v215
v_mfma_f32_16x16x32_bf16 v[120:123], v[48:51], a[72:75], v[120:123]
buffer_store_dwordx4 v[176:179], v2, s[8:11], s24 offen offset:2048 sc1
v_mfma_f32_16x16x32_bf16 v[120:123], v[52:55], a[88:91], v[120:123]
ds_read_b128 v[76:79], v2 offset:39936
v_fma_f32 v208, v208, v237, v236
v_mfma_f32_16x16x32_bf16 v[124:127], v[48:51], a[76:79], v[124:127]
v_fma_f32 v210, v210, v237, v236
v_mul_f32 v208, v208, v84
v_mfma_f32_16x16x32_bf16 v[124:127], v[52:55], a[92:95], v[124:127]
v_mul_f32 v210, v210, v85
s_waitcnt lgkmcnt(4)
v_mfma_f32_16x16x32_bf16 v[128:131], v[56:59], a[64:67], v[128:131]
v_exp_f32 v208, v208
v_mfma_f32_16x16x32_bf16 v[128:131], v[60:63], a[80:83], v[128:131]
v_exp_f32 v210, v210
v_mfma_f32_16x16x32_bf16 v[132:135], v[56:59], a[68:71], v[132:135]
ds_read_b128 v[48:51], v2 offset:40960
v_mul_f32 v209, v84, v100
v_mfma_f32_16x16x32_bf16 v[132:135], v[60:63], a[84:87], v[132:135]
v_mul_f32 v211, v85, v101
v_fma_f32 v208, v208, v238, v238
v_mfma_f32_16x16x32_bf16 v[136:139], v[56:59], a[72:75], v[136:139]
v_fma_f32 v210, v210, v238, v238
v_mul_f32 v212, v86, v86
v_mfma_f32_16x16x32_bf16 v[136:139], v[60:63], a[88:91], v[136:139]
ds_read_b128 v[52:55], v2 offset:41984
v_mul_f32 v214, v87, v87
v_mfma_f32_16x16x32_bf16 v[140:143], v[56:59], a[76:79], v[140:143]
v_rcp_f32 v208, v208
v_mfma_f32_16x16x32_bf16 v[140:143], v[60:63], a[92:95], v[140:143]
v_mul_f32 v209, v209, v208
s_waitcnt lgkmcnt(4)
v_mfma_f32_16x16x32_bf16 v[112:115], v[64:67], a[96:99], v[112:115]
v_rcp_f32 v210, v210
v_mfma_f32_16x16x32_bf16 v[112:115], v[68:71], a[112:115], v[112:115]
v_mul_f32 v211, v211, v210
v_cvt_pk_bf16_f32 v182, v209, v211
v_mfma_f32_16x16x32_bf16 v[116:119], v[64:67], a[100:103], v[116:119]
ds_read_b128 v[56:59], v2 offset:43008
v_fma_f32 v212, v212, v237, v236
v_mfma_f32_16x16x32_bf16 v[116:119], v[68:71], a[116:119], v[116:119]
v_fma_f32 v214, v214, v237, v236
v_mul_f32 v212, v212, v86
v_mfma_f32_16x16x32_bf16 v[120:123], v[64:67], a[104:107], v[120:123]
v_mul_f32 v214, v214, v87
v_mul_f32 v213, v86, v102
v_mfma_f32_16x16x32_bf16 v[120:123], v[68:71], a[120:123], v[120:123]
ds_read_b128 v[60:63], v2 offset:44032
v_mul_f32 v215, v87, v103
v_mfma_f32_16x16x32_bf16 v[124:127], v[64:67], a[108:111], v[124:127]
v_exp_f32 v212, v212
v_mfma_f32_16x16x32_bf16 v[124:127], v[68:71], a[124:127], v[124:127]
v_fma_f32 v212, v212, v238, v238
s_waitcnt lgkmcnt(4)
v_mfma_f32_16x16x32_bf16 v[128:131], v[72:75], a[96:99], v[128:131]
v_exp_f32 v214, v214
v_mfma_f32_16x16x32_bf16 v[128:131], v[76:79], a[112:115], v[128:131]
v_fma_f32 v214, v214, v238, v238
v_mul_f32 v208, v88, v88
v_mfma_f32_16x16x32_bf16 v[132:135], v[72:75], a[100:103], v[132:135]
ds_read_b128 v[64:67], v2 offset:45056
v_mul_f32 v210, v89, v89
v_mfma_f32_16x16x32_bf16 v[132:135], v[76:79], a[116:119], v[132:135]
v_rcp_f32 v212, v212
v_mfma_f32_16x16x32_bf16 v[136:139], v[72:75], a[104:107], v[136:139]
v_rcp_f32 v214, v214
v_mfma_f32_16x16x32_bf16 v[136:139], v[76:79], a[120:123], v[136:139]
ds_read_b128 v[68:71], v2 offset:46080
v_mul_f32 v213, v213, v212
v_mfma_f32_16x16x32_bf16 v[140:143], v[72:75], a[108:111], v[140:143]
v_mul_f32 v215, v215, v214
v_cvt_pk_bf16_f32 v183, v213, v215
v_mfma_f32_16x16x32_bf16 v[140:143], v[76:79], a[124:127], v[140:143]
v_fma_f32 v208, v208, v241, v240
s_waitcnt lgkmcnt(4)
v_mfma_f32_16x16x32_bf16 v[112:115], v[48:51], a[128:131], v[112:115]
buffer_store_dwordx4 v[180:183], v4, s[8:11], s24 offen offset:2048 sc1
v_mfma_f32_16x16x32_bf16 v[112:115], v[52:55], a[144:147], v[112:115]
v_fma_f32 v210, v210, v241, v240
v_mul_f32 v208, v208, v88
v_mfma_f32_16x16x32_bf16 v[116:119], v[48:51], a[132:135], v[116:119]
ds_read_b128 v[72:75], v2 offset:47104
v_mul_f32 v210, v210, v89
v_mfma_f32_16x16x32_bf16 v[116:119], v[52:55], a[148:151], v[116:119]
v_exp_f32 v208, v208
v_mfma_f32_16x16x32_bf16 v[120:123], v[48:51], a[136:139], v[120:123]
v_exp_f32 v210, v210
v_mfma_f32_16x16x32_bf16 v[120:123], v[52:55], a[152:155], v[120:123]
ds_read_b128 v[76:79], v2 offset:48128
v_mul_f32 v209, v88, v104
v_mfma_f32_16x16x32_bf16 v[124:127], v[48:51], a[140:143], v[124:127]
v_mul_f32 v211, v89, v105
v_fma_f32 v208, v208, v242, v242
v_mfma_f32_16x16x32_bf16 v[124:127], v[52:55], a[156:159], v[124:127]
v_fma_f32 v210, v210, v242, v242
s_waitcnt lgkmcnt(4)
v_mfma_f32_16x16x32_bf16 v[128:131], v[56:59], a[128:131], v[128:131]
s_waitcnt vmcnt(24)
v_mul_f32 v212, v90, v90
v_mfma_f32_16x16x32_bf16 v[128:131], v[60:63], a[144:147], v[128:131]
s_barrier
v_mfma_f32_16x16x32_bf16 v[132:135], v[56:59], a[132:135], v[132:135]
ds_read_b128 v[48:51], v2 offset:49152
s_add_u32 m0, s22, 0
v_mfma_f32_16x16x32_bf16 v[132:135], v[60:63], a[148:151], v[132:135]
v_add_u32 v3, 20480, v3
buffer_load_dwordx4 v3, s[8:11], 0 offen offset:0 sc1 lds
v_mfma_f32_16x16x32_bf16 v[136:139], v[56:59], a[136:139], v[136:139]
v_rcp_f32 v208, v208
v_mfma_f32_16x16x32_bf16 v[136:139], v[60:63], a[152:155], v[136:139]
ds_read_b128 v[52:55], v2 offset:50176
v_mul_f32 v209, v209, v208
v_mfma_f32_16x16x32_bf16 v[140:143], v[56:59], a[140:143], v[140:143]
v_rcp_f32 v210, v210
v_mfma_f32_16x16x32_bf16 v[140:143], v[60:63], a[156:159], v[140:143]
v_mul_f32 v211, v211, v210
s_waitcnt lgkmcnt(4)
v_mfma_f32_16x16x32_bf16 v[112:115], v[64:67], a[160:163], v[112:115]
buffer_load_dwordx4 v3, s[8:11], 0 offen offset:1024 sc1 lds
v_mfma_f32_16x16x32_bf16 v[112:115], v[68:71], a[176:179], v[112:115]
v_cvt_pk_bf16_f32 v186, v209, v211
v_mul_f32 v214, v91, v91
v_mfma_f32_16x16x32_bf16 v[116:119], v[64:67], a[164:167], v[116:119]
ds_read_b128 v[56:59], v2 offset:51200
v_fma_f32 v212, v212, v241, v240
v_mfma_f32_16x16x32_bf16 v[116:119], v[68:71], a[180:183], v[116:119]
v_fma_f32 v214, v214, v241, v240
v_mul_f32 v212, v212, v90
v_mfma_f32_16x16x32_bf16 v[120:123], v[64:67], a[168:171], v[120:123]
v_mul_f32 v214, v214, v91
v_mul_f32 v213, v90, v106
v_mfma_f32_16x16x32_bf16 v[120:123], v[68:71], a[184:187], v[120:123]
ds_read_b128 v[60:63], v2 offset:52224
v_mul_f32 v215, v91, v107
v_mfma_f32_16x16x32_bf16 v[124:127], v[64:67], a[172:175], v[124:127]
buffer_load_dwordx4 v3, s[8:11], 0 offen offset:2048 sc1 lds
v_mfma_f32_16x16x32_bf16 v[124:127], v[68:71], a[188:191], v[124:127]
v_mul_f32 v208, v92, v92
s_waitcnt lgkmcnt(4)
v_mfma_f32_16x16x32_bf16 v[128:131], v[72:75], a[160:163], v[128:131]
v_exp_f32 v212, v212
v_mfma_f32_16x16x32_bf16 v[128:131], v[76:79], a[176:179], v[128:131]
v_exp_f32 v214, v214
v_mfma_f32_16x16x32_bf16 v[132:135], v[72:75], a[164:167], v[132:135]
ds_read_b128 v[64:67], v2 offset:53248
v_fma_f32 v212, v212, v242, v242
v_mfma_f32_16x16x32_bf16 v[132:135], v[76:79], a[180:183], v[132:135]
buffer_load_dwordx4 v3, s[8:11], 0 offen offset:3072 sc1 lds
v_mfma_f32_16x16x32_bf16 v[136:139], v[72:75], a[168:171], v[136:139]
s_add_u32 m0, s22, 4096
v_add_u32 v3, 4096, v3
v_mfma_f32_16x16x32_bf16 v[136:139], v[76:79], a[184:187], v[136:139]
ds_read_b128 v[68:71], v2 offset:54272
v_fma_f32 v214, v214, v242, v242
v_mfma_f32_16x16x32_bf16 v[140:143], v[72:75], a[172:175], v[140:143]
v_rcp_f32 v212, v212
v_mfma_f32_16x16x32_bf16 v[140:143], v[76:79], a[188:191], v[140:143]
v_mul_f32 v213, v213, v212
s_waitcnt lgkmcnt(4)
v_mfma_f32_16x16x32_bf16 v[112:115], v[48:51], a[192:195], v[112:115]
buffer_load_dwordx4 v3, s[8:11], 0 offen offset:0 sc1 lds
v_mfma_f32_16x16x32_bf16 v[112:115], v[52:55], a[208:211], v[112:115]
v_rcp_f32 v214, v214
v_mfma_f32_16x16x32_bf16 v[116:119], v[48:51], a[196:199], v[116:119]
ds_read_b128 v[72:75], v2 offset:55296
v_mul_f32 v215, v215, v214
v_mfma_f32_16x16x32_bf16 v[116:119], v[52:55], a[212:215], v[116:119]
v_cvt_pk_bf16_f32 v187, v213, v215
v_mul_f32 v210, v93, v93
v_mfma_f32_16x16x32_bf16 v[120:123], v[48:51], a[200:203], v[120:123]
buffer_store_dwordx4 v[184:187], v5, s[8:11], s24 offen offset:2048 sc1
v_mfma_f32_16x16x32_bf16 v[120:123], v[52:55], a[216:219], v[120:123]
ds_read_b128 v[76:79], v2 offset:56320
v_fma_f32 v208, v208, v245, v244
v_mfma_f32_16x16x32_bf16 v[124:127], v[48:51], a[204:207], v[124:127]
v_fma_f32 v210, v210, v245, v244
v_mul_f32 v208, v208, v92
v_mfma_f32_16x16x32_bf16 v[124:127], v[52:55], a[220:223], v[124:127]
v_mul_f32 v210, v210, v93
s_waitcnt lgkmcnt(4)
v_mfma_f32_16x16x32_bf16 v[128:131], v[56:59], a[192:195], v[128:131]
v_exp_f32 v208, v208
v_mfma_f32_16x16x32_bf16 v[128:131], v[60:63], a[208:211], v[128:131]
buffer_load_dwordx4 v3, s[8:11], 0 offen offset:1024 sc1 lds
v_mfma_f32_16x16x32_bf16 v[132:135], v[56:59], a[196:199], v[132:135]
ds_read_b128 v[48:51], v2 offset:57344
v_mul_f32 v209, v92, v108
v_mfma_f32_16x16x32_bf16 v[132:135], v[60:63], a[212:215], v[132:135]
v_exp_f32 v210, v210
v_mfma_f32_16x16x32_bf16 v[136:139], v[56:59], a[200:203], v[136:139]
v_mul_f32 v211, v93, v109
v_fma_f32 v208, v208, v246, v246
v_mfma_f32_16x16x32_bf16 v[136:139], v[60:63], a[216:219], v[136:139]
ds_read_b128 v[52:55], v2 offset:58368
v_fma_f32 v210, v210, v246, v246
v_mfma_f32_16x16x32_bf16 v[140:143], v[56:59], a[204:207], v[140:143]
v_rcp_f32 v208, v208
v_mfma_f32_16x16x32_bf16 v[140:143], v[60:63], a[220:223], v[140:143]
v_mul_f32 v209, v209, v208
s_waitcnt lgkmcnt(4)
v_mfma_f32_16x16x32_bf16 v[112:115], v[64:67], a[224:227], v[112:115]
v_rcp_f32 v210, v210
v_mfma_f32_16x16x32_bf16 v[112:115], v[68:71], a[240:243], v[112:115]
v_mul_f32 v211, v211, v210
v_cvt_pk_bf16_f32 v190, v209, v211
v_mfma_f32_16x16x32_bf16 v[116:119], v[64:67], a[228:231], v[116:119]
ds_read_b128 v[56:59], v2 offset:59392
v_mul_f32 v212, v94, v94
v_mfma_f32_16x16x32_bf16 v[116:119], v[68:71], a[244:247], v[116:119]
v_mul_f32 v214, v95, v95
v_fma_f32 v212, v212, v245, v244
v_mfma_f32_16x16x32_bf16 v[120:123], v[64:67], a[232:235], v[120:123]
v_fma_f32 v214, v214, v245, v244
v_mul_f32 v212, v212, v94
v_mfma_f32_16x16x32_bf16 v[120:123], v[68:71], a[248:251], v[120:123]
ds_read_b128 v[60:63], v2 offset:60416
v_mul_f32 v214, v214, v95
v_mfma_f32_16x16x32_bf16 v[124:127], v[64:67], a[236:239], v[124:127]
v_exp_f32 v212, v212
v_mfma_f32_16x16x32_bf16 v[124:127], v[68:71], a[252:255], v[124:127]
v_mul_f32 v213, v94, v110
s_waitcnt lgkmcnt(4)
v_mfma_f32_16x16x32_bf16 v[128:131], v[72:75], a[224:227], v[128:131]
v_exp_f32 v214, v214
v_mfma_f32_16x16x32_bf16 v[128:131], v[76:79], a[240:243], v[128:131]
v_mul_f32 v215, v95, v111
v_fma_f32 v212, v212, v246, v246
v_mfma_f32_16x16x32_bf16 v[132:135], v[72:75], a[228:231], v[132:135]
ds_read_b128 v[64:67], v2 offset:61440
v_fma_f32 v214, v214, v246, v246
v_mfma_f32_16x16x32_bf16 v[132:135], v[76:79], a[244:247], v[132:135]
v_rcp_f32 v212, v212
v_mfma_f32_16x16x32_bf16 v[136:139], v[72:75], a[232:235], v[136:139]
v_rcp_f32 v214, v214
v_mfma_f32_16x16x32_bf16 v[136:139], v[76:79], a[248:251], v[136:139]
ds_read_b128 v[68:71], v2 offset:62464
v_mul_f32 v213, v213, v212
v_mfma_f32_16x16x32_bf16 v[140:143], v[72:75], a[236:239], v[140:143]
v_mul_f32 v215, v215, v214
v_cvt_pk_bf16_f32 v191, v213, v215
v_mfma_f32_16x16x32_bf16 v[140:143], v[76:79], a[252:255], v[140:143]
s_waitcnt lgkmcnt(4)
v_mfma_f32_16x16x32_bf16 v[112:115], v[48:51], v[16:19], v[112:115]
buffer_store_dwordx4 v[188:191], v6, s[8:11], s24 offen offset:2048 sc1
v_mfma_f32_16x16x32_bf16 v[112:115], v[52:55], v[32:35], v[112:115]
v_mfma_f32_16x16x32_bf16 v[116:119], v[48:51], v[20:23], v[116:119]
ds_read_b128 v[72:75], v2 offset:63488
v_mfma_f32_16x16x32_bf16 v[116:119], v[52:55], v[36:39], v[116:119]
v_mfma_f32_16x16x32_bf16 v[120:123], v[48:51], v[24:27], v[120:123]
v_mfma_f32_16x16x32_bf16 v[120:123], v[52:55], v[40:43], v[120:123]
ds_read_b128 v[76:79], v2 offset:64512
v_mfma_f32_16x16x32_bf16 v[124:127], v[48:51], v[28:31], v[124:127]
v_mfma_f32_16x16x32_bf16 v[124:127], v[52:55], v[44:47], v[124:127]
s_waitcnt lgkmcnt(4)
v_mfma_f32_16x16x32_bf16 v[128:131], v[56:59], v[16:19], v[128:131]
v_mfma_f32_16x16x32_bf16 v[128:131], v[60:63], v[32:35], v[128:131]
v_mfma_f32_16x16x32_bf16 v[132:135], v[56:59], v[20:23], v[132:135]
ds_read_b128 v[48:51], v7 offset:0
v_mfma_f32_16x16x32_bf16 v[132:135], v[60:63], v[36:39], v[132:135]
v_mfma_f32_16x16x32_bf16 v[136:139], v[56:59], v[24:27], v[136:139]
v_mfma_f32_16x16x32_bf16 v[136:139], v[60:63], v[40:43], v[136:139]
ds_read_b128 v[52:55], v7 offset:1024
v_mfma_f32_16x16x32_bf16 v[140:143], v[56:59], v[28:31], v[140:143]
v_mfma_f32_16x16x32_bf16 v[140:143], v[60:63], v[44:47], v[140:143]
s_waitcnt lgkmcnt(4)
v_mfma_f32_16x16x32_bf16 v[80:83], v[64:67], a[0:3], 0
v_mfma_f32_16x16x32_bf16 v[80:83], v[68:71], a[16:19], v[80:83]
v_mfma_f32_16x16x32_bf16 v[84:87], v[64:67], a[4:7], 0
ds_read_b128 v[56:59], v7 offset:2048
v_mfma_f32_16x16x32_bf16 v[84:87], v[68:71], a[20:23], v[84:87]
v_mul_f32 v208, v112, v112
v_mul_f32 v210, v113, v113
v_mfma_f32_16x16x32_bf16 v[88:91], v[64:67], a[8:11], 0
v_fma_f32 v208, v208, v233, v232
v_fma_f32 v210, v210, v233, v232
v_mfma_f32_16x16x32_bf16 v[88:91], v[68:71], a[24:27], v[88:91]
ds_read_b128 v[60:63], v7 offset:3072
v_mul_f32 v208, v208, v112
v_mfma_f32_16x16x32_bf16 v[92:95], v[64:67], a[12:15], 0
v_mul_f32 v210, v210, v113
v_mul_f32 v209, v112, v128
v_mfma_f32_16x16x32_bf16 v[92:95], v[68:71], a[28:31], v[92:95]
v_mul_f32 v211, v113, v129
s_waitcnt lgkmcnt(4)
v_mfma_f32_16x16x32_bf16 v[96:99], v[72:75], a[0:3], 0
v_exp_f32 v208, v208
v_mfma_f32_16x16x32_bf16 v[96:99], v[76:79], a[16:19], v[96:99]
v_exp_f32 v210, v210
v_mfma_f32_16x16x32_bf16 v[100:103], v[72:75], a[4:7], 0
ds_read_b128 v[64:67], v7 offset:4096
v_fma_f32 v208, v208, v234, v234
v_mfma_f32_16x16x32_bf16 v[100:103], v[76:79], a[20:23], v[100:103]
v_fma_f32 v210, v210, v234, v234
v_mul_f32 v212, v114, v114
v_mfma_f32_16x16x32_bf16 v[104:107], v[72:75], a[8:11], 0
v_rcp_f32 v208, v208
v_mfma_f32_16x16x32_bf16 v[104:107], v[76:79], a[24:27], v[104:107]
ds_read_b128 v[68:71], v7 offset:5120
v_mul_f32 v209, v209, v208
v_mfma_f32_16x16x32_bf16 v[108:111], v[72:75], a[12:15], 0
v_rcp_f32 v210, v210
v_mfma_f32_16x16x32_bf16 v[108:111], v[76:79], a[28:31], v[108:111]
v_mul_f32 v211, v211, v210
s_waitcnt lgkmcnt(4)
v_mfma_f32_16x16x32_bf16 v[80:83], v[48:51], a[32:35], v[80:83]
v_cvt_pk_bf16_f32 v192, v209, v211
v_mul_f32 v214, v115, v115
v_mfma_f32_16x16x32_bf16 v[80:83], v[52:55], a[48:51], v[80:83]
v_fma_f32 v212, v212, v233, v232
v_fma_f32 v214, v214, v233, v232
v_mfma_f32_16x16x32_bf16 v[84:87], v[48:51], a[36:39], v[84:87]
ds_read_b128 v[72:75], v7 offset:6144
v_mul_f32 v212, v212, v114
v_mfma_f32_16x16x32_bf16 v[84:87], v[52:55], a[52:55], v[84:87]
v_mul_f32 v214, v214, v115
v_mul_f32 v213, v114, v130
v_mfma_f32_16x16x32_bf16 v[88:91], v[48:51], a[40:43], v[88:91]
v_exp_f32 v212, v212
v_mfma_f32_16x16x32_bf16 v[88:91], v[52:55], a[56:59], v[88:91]
ds_read_b128 v[76:79], v7 offset:7168
v_mul_f32 v215, v115, v131
v_mfma_f32_16x16x32_bf16 v[92:95], v[48:51], a[44:47], v[92:95]
v_exp_f32 v214, v214
v_mfma_f32_16x16x32_bf16 v[92:95], v[52:55], a[60:63], v[92:95]
v_fma_f32 v212, v212, v234, v234
s_waitcnt lgkmcnt(4)
v_mfma_f32_16x16x32_bf16 v[96:99], v[56:59], a[32:35], v[96:99]
s_waitcnt vmcnt(26)
v_fma_f32 v214, v214, v234, v234
v_mfma_f32_16x16x32_bf16 v[96:99], v[60:63], a[48:51], v[96:99]
s_barrier
v_mfma_f32_16x16x32_bf16 v[100:103], v[56:59], a[36:39], v[100:103]
ds_read_b128 v[48:51], v7 offset:8192
s_add_u32 m0, s22, 24576
v_mfma_f32_16x16x32_bf16 v[100:103], v[60:63], a[52:55], v[100:103]
v_add_u32 v3, 20480, v3
buffer_load_dwordx4 v3, s[8:11], 0 offen offset:0 sc1 lds
v_mfma_f32_16x16x32_bf16 v[104:107], v[56:59], a[40:43], v[104:107]
v_rcp_f32 v212, v212
v_mfma_f32_16x16x32_bf16 v[104:107], v[60:63], a[56:59], v[104:107]
ds_read_b128 v[52:55], v7 offset:9216
v_mul_f32 v213, v213, v212
v_mfma_f32_16x16x32_bf16 v[108:111], v[56:59], a[44:47], v[108:111]
v_rcp_f32 v214, v214
v_mfma_f32_16x16x32_bf16 v[108:111], v[60:63], a[60:63], v[108:111]
v_mul_f32 v215, v215, v214
s_waitcnt lgkmcnt(4)
v_mfma_f32_16x16x32_bf16 v[80:83], v[64:67], a[64:67], v[80:83]
buffer_load_dwordx4 v3, s[8:11], 0 offen offset:1024 sc1 lds
v_mfma_f32_16x16x32_bf16 v[80:83], v[68:71], a[80:83], v[80:83]
v_cvt_pk_bf16_f32 v193, v213, v215
v_mul_f32 v208, v116, v116
v_mfma_f32_16x16x32_bf16 v[84:87], v[64:67], a[68:71], v[84:87]
ds_read_b128 v[56:59], v7 offset:10240
v_mul_f32 v210, v117, v117
v_mfma_f32_16x16x32_bf16 v[84:87], v[68:71], a[84:87], v[84:87]
v_fma_f32 v208, v208, v237, v236
v_fma_f32 v210, v210, v237, v236
v_mfma_f32_16x16x32_bf16 v[88:91], v[64:67], a[72:75], v[88:91]
v_mul_f32 v208, v208, v116
v_mul_f32 v210, v210, v117
v_mfma_f32_16x16x32_bf16 v[88:91], v[68:71], a[88:91], v[88:91]
ds_read_b128 v[60:63], v7 offset:11264
v_mul_f32 v209, v116, v132
v_mfma_f32_16x16x32_bf16 v[92:95], v[64:67], a[76:79], v[92:95]
buffer_load_dwordx4 v3, s[8:11], 0 offen offset:2048 sc1 lds
v_mfma_f32_16x16x32_bf16 v[92:95], v[68:71], a[92:95], v[92:95]
v_mul_f32 v211, v117, v133
s_waitcnt lgkmcnt(4)
v_mfma_f32_16x16x32_bf16 v[96:99], v[72:75], a[64:67], v[96:99]
v_exp_f32 v208, v208
v_mfma_f32_16x16x32_bf16 v[96:99], v[76:79], a[80:83], v[96:99]
v_exp_f32 v210, v210
v_mfma_f32_16x16x32_bf16 v[100:103], v[72:75], a[68:71], v[100:103]
ds_read_b128 v[64:67], v7 offset:12288
v_fma_f32 v208, v208, v238, v238
v_mfma_f32_16x16x32_bf16 v[100:103], v[76:79], a[84:87], v[100:103]
buffer_load_dwordx4 v3, s[8:11], 0 offen offset:3072 sc1 lds
v_mfma_f32_16x16x32_bf16 v[104:107], v[72:75], a[72:75], v[104:107]
s_add_u32 m0, s22, 28672
v_add_u32 v3, 4096, v3
v_mfma_f32_16x16x32_bf16 v[104:107], v[76:79], a[88:91], v[104:107]
ds_read_b128 v[68:71], v7 offset:13312
v_fma_f32 v210, v210, v238, v238
v_mfma_f32_16x16x32_bf16 v[108:111], v[72:75], a[76:79], v[108:111]
v_rcp_f32 v208, v208
v_mfma_f32_16x16x32_bf16 v[108:111], v[76:79], a[92:95], v[108:111]
v_mul_f32 v209, v209, v208
s_waitcnt lgkmcnt(4)
v_mfma_f32_16x16x32_bf16 v[80:83], v[48:51], a[96:99], v[80:83]
v_mov_b32 v12, s68
v_mov_b32 v13, s69
v_mfma_f32_16x16x32_bf16 v[80:83], v[52:55], a[112:115], v[80:83]
s_add_u32 s53, s34, 0
s_waitcnt vmcnt(4)
buffer_store_dwordx2 v[12:13], v10, s[8:11], s53 offen sc1
v_mfma_f32_16x16x32_bf16 v[84:87], v[48:51], a[100:103], v[84:87]
ds_read_b128 v[72:75], v7 offset:14336
v_mul_f32 v212, v118, v118
v_mfma_f32_16x16x32_bf16 v[84:87], v[52:55], a[116:119], v[84:87]
v_rcp_f32 v210, v210
v_mfma_f32_16x16x32_bf16 v[88:91], v[48:51], a[104:107], v[88:91]
v_mul_f32 v211, v211, v210
v_cvt_pk_bf16_f32 v196, v209, v211
v_mfma_f32_16x16x32_bf16 v[88:91], v[52:55], a[120:123], v[88:91]
ds_read_b128 v[76:79], v7 offset:15360
v_mul_f32 v214, v119, v119
v_mfma_f32_16x16x32_bf16 v[92:95], v[48:51], a[108:111], v[92:95]
buffer_load_dwordx4 v3, s[8:11], 0 offen offset:0 sc1 lds
v_mfma_f32_16x16x32_bf16 v[92:95], v[52:55], a[124:127], v[92:95]
v_fma_f32 v212, v212, v237, v236
s_waitcnt lgkmcnt(4)
v_mfma_f32_16x16x32_bf16 v[96:99], v[56:59], a[96:99], v[96:99]
v_fma_f32 v214, v214, v237, v236
v_mul_f32 v212, v212, v118
v_mfma_f32_16x16x32_bf16 v[96:99], v[60:63], a[112:115], v[96:99]
v_mul_f32 v214, v214, v119
v_mul_f32 v213, v118, v134
v_mfma_f32_16x16x32_bf16 v[100:103], v[56:59], a[100:103], v[100:103]
ds_read_b128 v[48:51], v7 offset:16384
v_mul_f32 v215, v119, v135
v_mfma_f32_16x16x32_bf16 v[100:103], v[60:63], a[116:119], v[100:103]
buffer_load_dwordx4 v3, s[8:11], 0 offen offset:1024 sc1 lds
v_mfma_f32_16x16x32_bf16 v[104:107], v[56:59], a[104:107], v[104:107]
v_exp_f32 v212, v212
v_mfma_f32_16x16x32_bf16 v[104:107], v[60:63], a[120:123], v[104:107]
ds_read_b128 v[52:55], v7 offset:17408
v_fma_f32 v212, v212, v238, v238
v_mfma_f32_16x16x32_bf16 v[108:111], v[56:59], a[108:111], v[108:111]
v_exp_f32 v214, v214
v_mfma_f32_16x16x32_bf16 v[108:111], v[60:63], a[124:127], v[108:111]
v_fma_f32 v214, v214, v238, v238
s_waitcnt lgkmcnt(4)
v_mfma_f32_16x16x32_bf16 v[80:83], v[64:67], a[128:131], v[80:83]
v_rcp_f32 v212, v212
v_mfma_f32_16x16x32_bf16 v[80:83], v[68:71], a[144:147], v[80:83]
v_rcp_f32 v214, v214
v_mfma_f32_16x16x32_bf16 v[84:87], v[64:67], a[132:135], v[84:87]
ds_read_b128 v[56:59], v7 offset:18432
v_mul_f32 v213, v213, v212
v_mfma_f32_16x16x32_bf16 v[84:87], v[68:71], a[148:151], v[84:87]
v_mul_f32 v215, v215, v214
v_cvt_pk_bf16_f32 v197, v213, v215
v_mfma_f32_16x16x32_bf16 v[88:91], v[64:67], a[136:139], v[88:91]
v_mul_f32 v208, v120, v120
v_mul_f32 v210, v121, v121
v_mfma_f32_16x16x32_bf16 v[88:91], v[68:71], a[152:155], v[88:91]
ds_read_b128 v[60:63], v7 offset:19456
v_fma_f32 v208, v208, v241, v240
v_mfma_f32_16x16x32_bf16 v[92:95], v[64:67], a[140:143], v[92:95]
v_fma_f32 v210, v210, v241, v240
v_mul_f32 v208, v208, v120
v_mfma_f32_16x16x32_bf16 v[92:95], v[68:71], a[156:159], v[92:95]
v_mul_f32 v210, v210, v121
s_waitcnt lgkmcnt(4)
v_mfma_f32_16x16x32_bf16 v[96:99], v[72:75], a[128:131], v[96:99]
v_exp_f32 v208, v208
v_mfma_f32_16x16x32_bf16 v[96:99], v[76:79], a[144:147], v[96:99]
v_exp_f32 v210, v210
v_mfma_f32_16x16x32_bf16 v[100:103], v[72:75], a[132:135], v[100:103]
ds_read_b128 v[64:67], v7 offset:20480
v_mul_f32 v209, v120, v136
v_mfma_f32_16x16x32_bf16 v[100:103], v[76:79], a[148:151], v[100:103]
v_mul_f32 v211, v121, v137
v_fma_f32 v208, v208, v242, v242
v_mfma_f32_16x16x32_bf16 v[104:107], v[72:75], a[136:139], v[104:107]
v_fma_f32 v210, v210, v242, v242
v_mul_f32 v212, v122, v122
v_mfma_f32_16x16x32_bf16 v[104:107], v[76:79], a[152:155], v[104:107]
ds_read_b128 v[68:71], v7 offset:21504
v_mul_f32 v214, v123, v123
v_mfma_f32_16x16x32_bf16 v[108:111], v[72:75], a[140:143], v[108:111]
v_rcp_f32 v208, v208
v_mfma_f32_16x16x32_bf16 v[108:111], v[76:79], a[156:159], v[108:111]
s_waitcnt lgkmcnt(4)
v_mfma_f32_16x16x32_bf16 v[80:83], v[48:51], a[160:163], v[80:83]
v_rcp_f32 v210, v210
v_mfma_f32_16x16x32_bf16 v[80:83], v[52:55], a[176:179], v[80:83]
v_mfma_f32_16x16x32_bf16 v[84:87], v[48:51], a[164:167], v[84:87]
ds_read_b128 v[72:75], v7 offset:22528
v_mul_f32 v209, v209, v208
v_mfma_f32_16x16x32_bf16 v[84:87], v[52:55], a[180:183], v[84:87]
v_mul_f32 v211, v211, v210
v_cvt_pk_bf16_f32 v200, v209, v211
v_mfma_f32_16x16x32_bf16 v[88:91], v[48:51], a[168:171], v[88:91]
v_fma_f32 v212, v212, v241, v240
v_fma_f32 v214, v214, v241, v240
v_mfma_f32_16x16x32_bf16 v[88:91], v[52:55], a[184:187], v[88:91]
ds_read_b128 v[76:79], v7 offset:23552
v_mfma_f32_16x16x32_bf16 v[92:95], v[48:51], a[172:175], v[92:95]
v_mul_f32 v212, v212, v122
v_mul_f32 v214, v214, v123
v_mfma_f32_16x16x32_bf16 v[92:95], v[52:55], a[188:191], v[92:95]
s_waitcnt lgkmcnt(4)
v_mfma_f32_16x16x32_bf16 v[96:99], v[56:59], a[160:163], v[96:99]
v_exp_f32 v212, v212
v_mfma_f32_16x16x32_bf16 v[96:99], v[60:63], a[176:179], v[96:99]
L_hop7:
s_cmp_eq_u32 s15, 1
s_cbranch_scc1 L_hop11
v_exp_f32 v214, v214
v_mfma_f32_16x16x32_bf16 v[100:103], v[56:59], a[164:167], v[100:103]
ds_read_b128 v[48:51], v7 offset:24576
v_mfma_f32_16x16x32_bf16 v[100:103], v[60:63], a[180:183], v[100:103]
v_mul_f32 v213, v122, v138
v_mul_f32 v215, v123, v139
v_mfma_f32_16x16x32_bf16 v[104:107], v[56:59], a[168:171], v[104:107]
v_mfma_f32_16x16x32_bf16 v[104:107], v[60:63], a[184:187], v[104:107]
ds_read_b128 v[52:55], v7 offset:25600
v_fma_f32 v212, v212, v242, v242
v_mfma_f32_16x16x32_bf16 v[108:111], v[56:59], a[172:175], v[108:111]
v_fma_f32 v214, v214, v242, v242
v_mul_f32 v208, v124, v124
v_mfma_f32_16x16x32_bf16 v[108:111], v[60:63], a[188:191], v[108:111]
s_waitcnt lgkmcnt(4)
v_mfma_f32_16x16x32_bf16 v[80:83], v[64:67], a[192:195], v[80:83]
s_add_u32 s23, s34, 0
buffer_load_dwordx2 v[14:15], v11, s[8:11], s23 offen sc1
v_mfma_f32_16x16x32_bf16 v[80:83], v[68:71], a[208:211], v[80:83]
v_rcp_f32 v212, v212
v_mfma_f32_16x16x32_bf16 v[84:87], v[64:67], a[196:199], v[84:87]
ds_read_b128 v[56:59], v7 offset:26624
v_mul_f32 v213, v213, v212
v_mfma_f32_16x16x32_bf16 v[84:87], v[68:71], a[212:215], v[84:87]
v_rcp_f32 v214, v214
v_mfma_f32_16x16x32_bf16 v[88:91], v[64:67], a[200:203], v[88:91]
v_mul_f32 v215, v215, v214
v_cvt_pk_bf16_f32 v201, v213, v215
v_mfma_f32_16x16x32_bf16 v[88:91], v[68:71], a[216:219], v[88:91]
ds_read_b128 v[60:63], v7 offset:27648
v_mfma_f32_16x16x32_bf16 v[92:95], v[64:67], a[204:207], v[92:95]
v_mul_f32 v210, v125, v125
v_fma_f32 v208, v208, v245, v244
v_mfma_f32_16x16x32_bf16 v[92:95], v[68:71], a[220:223], v[92:95]
v_fma_f32 v210, v210, v245, v244
s_waitcnt lgkmcnt(4)
v_mfma_f32_16x16x32_bf16 v[96:99], v[72:75], a[192:195], v[96:99]
v_mul_f32 v208, v208, v124
v_mul_f32 v210, v210, v125
v_mfma_f32_16x16x32_bf16 v[96:99], v[76:79], a[208:211], v[96:99]
v_mfma_f32_16x16x32_bf16 v[100:103], v[72:75], a[196:199], v[100:103]
ds_read_b128 v[64:67], v7 offset:28672
v_mul_f32 v209, v124, v140
v_mfma_f32_16x16x32_bf16 v[100:103], v[76:79], a[212:215], v[100:103]
v_exp_f32 v208, v208
v_mfma_f32_16x16x32_bf16 v[104:107], v[72:75], a[200:203], v[104:107]
v_mfma_f32_16x16x32_bf16 v[104:107], v[76:79], a[216:219], v[104:107]
ds_read_b128 v[68:71], v7 offset:29696
v_mul_f32 v211, v125, v141
v_mfma_f32_16x16x32_bf16 v[108:111], v[72:75], a[204:207], v[108:111]
v_exp_f32 v210, v210
v_mfma_f32_16x16x32_bf16 v[108:111], v[76:79], a[220:223], v[108:111]
v_fma_f32 v208, v208, v246, v246
s_waitcnt lgkmcnt(4)
v_mfma_f32_16x16x32_bf16 v[80:83], v[48:51], a[224:227], v[80:83]
v_fma_f32 v210, v210, v246, v246
v_mul_f32 v212, v126, v126
v_mfma_f32_16x16x32_bf16 v[80:83], v[52:55], a[240:243], v[80:83]
v_mfma_f32_16x16x32_bf16 v[84:87], v[48:51], a[228:231], v[84:87]
ds_read_b128 v[72:75], v7 offset:30720
v_mul_f32 v214, v127, v127
v_mfma_f32_16x16x32_bf16 v[84:87], v[52:55], a[244:247], v[84:87]
v_rcp_f32 v208, v208
v_mfma_f32_16x16x32_bf16 v[88:91], v[48:51], a[232:235], v[88:91]
v_rcp_f32 v210, v210
v_mfma_f32_16x16x32_bf16 v[88:91], v[52:55], a[248:251], v[88:91]
ds_read_b128 v[76:79], v7 offset:31744
v_mfma_f32_16x16x32_bf16 v[92:95], v[48:51], a[236:239], v[92:95]
v_mul_f32 v209, v209, v208
v_mul_f32 v211, v211, v210
v_mfma_f32_16x16x32_bf16 v[92:95], v[52:55], a[252:255], v[92:95]
s_waitcnt lgkmcnt(4)
v_mfma_f32_16x16x32_bf16 v[96:99], v[56:59], a[224:227], v[96:99]
s_waitcnt vmcnt(28)
v_cvt_pk_bf16_f32 v204, v209, v211
v_mfma_f32_16x16x32_bf16 v[96:99], v[60:63], a[240:243], v[96:99]
s_barrier
v_mfma_f32_16x16x32_bf16 v[100:103], v[56:59], a[228:231], v[100:103]
ds_read_b128 v[48:51], v7 offset:32768
s_add_u32 m0, s22, 49152
v_mfma_f32_16x16x32_bf16 v[100:103], v[60:63], a[244:247], v[100:103]
v_add_u32 v3, 20480, v3
buffer_load_dwordx4 v3, s[8:11], 0 offen offset:0 sc1 lds
v_mfma_f32_16x16x32_bf16 v[104:107], v[56:59], a[232:235], v[104:107]
v_fma_f32 v212, v212, v245, v244
v_fma_f32 v214, v214, v245, v244
v_mfma_f32_16x16x32_bf16 v[104:107], v[60:63], a[248:251], v[104:107]
ds_read_b128 v[52:55], v7 offset:33792
v_mul_f32 v212, v212, v126
v_mfma_f32_16x16x32_bf16 v[108:111], v[56:59], a[236:239], v[108:111]
v_mul_f32 v214, v214, v127
v_mul_f32 v213, v126, v142
v_mfma_f32_16x16x32_bf16 v[108:111], v[60:63], a[252:255], v[108:111]
v_mul_f32 v215, v127, v143
s_waitcnt lgkmcnt(4)
v_mfma_f32_16x16x32_bf16 v[80:83], v[64:67], v[16:19], v[80:83]
buffer_load_dwordx4 v3, s[8:11], 0 offen offset:1024 sc1 lds
v_mfma_f32_16x16x32_bf16 v[80:83], v[68:71], v[32:35], v[80:83]
v_exp_f32 v212, v212
v_mfma_f32_16x16x32_bf16 v[84:87], v[64:67], v[20:23], v[84:87]
ds_read_b128 v[56:59], v7 offset:34816
v_fma_f32 v212, v212, v246, v246
v_mfma_f32_16x16x32_bf16 v[84:87], v[68:71], v[36:39], v[84:87]
v_exp_f32 v214, v214
v_mfma_f32_16x16x32_bf16 v[88:91], v[64:67], v[24:27], v[88:91]
v_fma_f32 v214, v214, v246, v246
v_mfma_f32_16x16x32_bf16 v[88:91], v[68:71], v[40:43], v[88:91]
ds_read_b128 v[60:63], v7 offset:35840
v_mfma_f32_16x16x32_bf16 v[92:95], v[64:67], v[28:31], v[92:95]
buffer_load_dwordx4 v3, s[8:11], 0 offen offset:2048 sc1 lds
v_mfma_f32_16x16x32_bf16 v[92:95], v[68:71], v[44:47], v[92:95]
s_waitcnt lgkmcnt(4)
v_mfma_f32_16x16x32_bf16 v[96:99], v[72:75], v[16:19], v[96:99]
v_rcp_f32 v212, v212
v_mfma_f32_16x16x32_bf16 v[96:99], v[76:79], v[32:35], v[96:99]
v_rcp_f32 v214, v214
v_mfma_f32_16x16x32_bf16 v[100:103], v[72:75], v[20:23], v[100:103]
ds_read_b128 v[64:67], v7 offset:36864
v_mul_f32 v213, v213, v212
v_mfma_f32_16x16x32_bf16 v[100:103], v[76:79], v[36:39], v[100:103]
buffer_load_dwordx4 v3, s[8:11], 0 offen offset:3072 sc1 lds
v_mfma_f32_16x16x32_bf16 v[104:107], v[72:75], v[24:27], v[104:107]
s_add_u32 m0, s22, 53248
v_add_u32 v3, 4096, v3
v_mfma_f32_16x16x32_bf16 v[104:107], v[76:79], v[40:43], v[104:107]
ds_read_b128 v[68:71], v7 offset:37888
v_mul_f32 v215, v215, v214
v_mfma_f32_16x16x32_bf16 v[108:111], v[72:75], v[28:31], v[108:111]
v_cvt_pk_bf16_f32 v205, v213, v215
v_mfma_f32_16x16x32_bf16 v[108:111], v[76:79], v[44:47], v[108:111]
s_waitcnt lgkmcnt(4)
v_mfma_f32_16x16x32_bf16 v[112:115], v[48:51], a[0:3], 0
buffer_load_dwordx4 v3, s[8:11], 0 offen offset:0 sc1 lds
v_mfma_f32_16x16x32_bf16 v[112:115], v[52:55], a[16:19], v[112:115]
v_mfma_f32_16x16x32_bf16 v[116:119], v[48:51], a[4:7], 0
ds_read_b128 v[72:75], v7 offset:38912
v_mfma_f32_16x16x32_bf16 v[116:119], v[52:55], a[20:23], v[116:119]
v_mul_f32 v208, v80, v80
v_mul_f32 v210, v81, v81
v_mfma_f32_16x16x32_bf16 v[120:123], v[48:51], a[8:11], 0
v_fma_f32 v208, v208, v233, v232
v_fma_f32 v210, v210, v233, v232
v_mfma_f32_16x16x32_bf16 v[120:123], v[52:55], a[24:27], v[120:123]
ds_read_b128 v[76:79], v7 offset:39936
v_mul_f32 v208, v208, v80
v_mfma_f32_16x16x32_bf16 v[124:127], v[48:51], a[12:15], 0
buffer_load_dwordx4 v3, s[8:11], 0 offen offset:1024 sc1 lds
v_mfma_f32_16x16x32_bf16 v[124:127], v[52:55], a[28:31], v[124:127]
v_mul_f32 v210, v210, v81
s_waitcnt lgkmcnt(4)
v_mfma_f32_16x16x32_bf16 v[128:131], v[56:59], a[0:3], 0
v_exp_f32 v208, v208
v_mfma_f32_16x16x32_bf16 v[128:131], v[60:63], a[16:19], v[128:131]
v_exp_f32 v210, v210
v_mfma_f32_16x16x32_bf16 v[132:135], v[56:59], a[4:7], 0
ds_read_b128 v[48:51], v7 offset:40960
v_mul_f32 v209, v80, v96
v_mfma_f32_16x16x32_bf16 v[132:135], v[60:63], a[20:23], v[132:135]
v_mul_f32 v211, v81, v97
v_fma_f32 v208, v208, v234, v234
v_mfma_f32_16x16x32_bf16 v[136:139], v[56:59], a[8:11], 0
v_fma_f32 v210, v210, v234, v234
v_mul_f32 v212, v82, v82
v_mfma_f32_16x16x32_bf16 v[136:139], v[60:63], a[24:27], v[136:139]
ds_read_b128 v[52:55], v7 offset:41984
v_mul_f32 v214, v83, v83
v_mfma_f32_16x16x32_bf16 v[140:143], v[56:59], a[12:15], 0
v_rcp_f32 v208, v208
v_mfma_f32_16x16x32_bf16 v[140:143], v[60:63], a[28:31], v[140:143]
v_mul_f32 v209, v209, v208
s_waitcnt lgkmcnt(4)
v_mfma_f32_16x16x32_bf16 v[112:115], v[64:67], a[32:35], v[112:115]
s_waitcnt vmcnt(6)
v_cmp_eq_u64 vcc, s[68:69], v[14:15]
s_nop 0
s_cmp_eq_u64 vcc, exec
s_cbranch_scc0 L_f_slow1
L_f_back1:
v_fma_f32 v212, v212, v233, v232
v_mfma_f32_16x16x32_bf16 v[112:115], v[68:71], a[48:51], v[112:115]
v_rcp_f32 v210, v210
v_mfma_f32_16x16x32_bf16 v[116:119], v[64:67], a[36:39], v[116:119]
ds_read_b128 v[56:59], v7 offset:43008
v_mul_f32 v211, v211, v210
v_mfma_f32_16x16x32_bf16 v[116:119], v[68:71], a[52:55], v[116:119]
v_cvt_pk_bf16_f32 v194, v209, v211
v_fma_f32 v214, v214, v233, v232
v_mfma_f32_16x16x32_bf16 v[120:123], v[64:67], a[40:43], v[120:123]
v_mul_f32 v212, v212, v82
v_mul_f32 v214, v214, v83
v_mfma_f32_16x16x32_bf16 v[120:123], v[68:71], a[56:59], v[120:123]
ds_read_b128 v[60:63], v7 offset:44032
v_mul_f32 v213, v82, v98
v_mfma_f32_16x16x32_bf16 v[124:127], v[64:67], a[44:47], v[124:127]
v_exp_f32 v212, v212
v_mfma_f32_16x16x32_bf16 v[124:127], v[68:71], a[60:63], v[124:127]
v_mul_f32 v215, v83, v99
s_waitcnt lgkmcnt(4)
v_mfma_f32_16x16x32_bf16 v[128:131], v[72:75], a[32:35], v[128:131]
buffer_load_dwordx4 a[0:3], v2, s[8:11], s25 offen offset:0 sc1
v_mfma_f32_16x16x32_bf16 v[128:131], v[76:79], a[48:51], v[128:131]
v_exp_f32 v214, v214
v_mfma_f32_16x16x32_bf16 v[132:135], v[72:75], a[36:39], v[132:135]
ds_read_b128 v[64:67], v7 offset:45056
v_fma_f32 v212, v212, v234, v234
v_mfma_f32_16x16x32_bf16 v[132:135], v[76:79], a[52:55], v[132:135]
v_fma_f32 v214, v214, v234, v234
v_mul_f32 v208, v84, v84
v_mfma_f32_16x16x32_bf16 v[136:139], v[72:75], a[40:43], v[136:139]
v_rcp_f32 v212, v212
v_mfma_f32_16x16x32_bf16 v[136:139], v[76:79], a[56:59], v[136:139]
ds_read_b128 v[68:71], v7 offset:46080
v_mul_f32 v213, v213, v212
v_mfma_f32_16x16x32_bf16 v[140:143], v[72:75], a[44:47], v[140:143]
buffer_load_dwordx4 a[4:7], v4, s[8:11], s25 offen offset:0 sc1
v_mfma_f32_16x16x32_bf16 v[140:143], v[76:79], a[60:63], v[140:143]
v_mul_f32 v210, v85, v85
s_waitcnt lgkmcnt(4)
v_mfma_f32_16x16x32_bf16 v[112:115], v[48:51], a[64:67], v[112:115]
v_rcp_f32 v214, v214
v_mfma_f32_16x16x32_bf16 v[112:115], v[52:55], a[80:83], v[112:115]
v_mul_f32 v215, v215, v214
v_cvt_pk_bf16_f32 v195, v213, v215
v_mfma_f32_16x16x32_bf16 v[116:119], v[48:51], a[68:71], v[116:119]
ds_read_b128 v[72:75], v7 offset:47104
v_fma_f32 v208, v208, v237, v236
v_mfma_f32_16x16x32_bf16 v[116:119], v[52:55], a[84:87], v[116:119]
buffer_load_dwordx4 a[8:11], v5, s[8:11], s25 offen offset:0 sc1
v_mfma_f32_16x16x32_bf16 v[120:123], v[48:51], a[72:75], v[120:123]
v_fma_f32 v210, v210, v237, v236
v_mul_f32 v208, v208, v84
v_mfma_f32_16x16x32_bf16 v[120:123], v[52:55], a[88:91], v[120:123]
ds_read_b128 v[76:79], v7 offset:48128
v_mul_f32 v210, v210, v85
v_mfma_f32_16x16x32_bf16 v[124:127], v[48:51], a[76:79], v[124:127]
buffer_store_dwordx4 v[192:195], v2, s[8:11], s24 offen offset:3072 sc1
v_mfma_f32_16x16x32_bf16 v[124:127], v[52:55], a[92:95], v[124:127]
v_mul_f32 v209, v84, v100
s_waitcnt lgkmcnt(4)
v_mfma_f32_16x16x32_bf16 v[128:131], v[56:59], a[64:67], v[128:131]
v_exp_f32 v208, v208
v_mfma_f32_16x16x32_bf16 v[128:131], v[60:63], a[80:83], v[128:131]
v_exp_f32 v210, v210
v_mfma_f32_16x16x32_bf16 v[132:135], v[56:59], a[68:71], v[132:135]
ds_read_b128 v[48:51], v7 offset:49152
v_mul_f32 v211, v85, v101
v_mfma_f32_16x16x32_bf16 v[132:135], v[60:63], a[84:87], v[132:135]
buffer_load_dwordx4 a[12:15], v6, s[8:11], s25 offen offset:0 sc1
v_mfma_f32_16x16x32_bf16 v[136:139], v[56:59], a[72:75], v[136:139]
v_fma_f32 v208, v208, v238, v238
v_fma_f32 v210, v210, v238, v238
v_mfma_f32_16x16x32_bf16 v[136:139], v[60:63], a[88:91], v[136:139]
ds_read_b128 v[52:55], v7 offset:50176
v_mul_f32 v212, v86, v86
v_mfma_f32_16x16x32_bf16 v[140:143], v[56:59], a[76:79], v[140:143]
v_rcp_f32 v208, v208
v_mfma_f32_16x16x32_bf16 v[140:143], v[60:63], a[92:95], v[140:143]
v_mul_f32 v209, v209, v208
s_waitcnt lgkmcnt(4)
v_mfma_f32_16x16x32_bf16 v[112:115], v[64:67], a[96:99], v[112:115]
buffer_load_dwordx4 a[16:19], v2, s[8:11], s26 offen offset:0 sc1
v_mfma_f32_16x16x32_bf16 v[112:115], v[68:71], a[112:115], v[112:115]
v_rcp_f32 v210, v210
v_mfma_f32_16x16x32_bf16 v[116:119], v[64:67], a[100:103], v[116:119]
ds_read_b128 v[56:59], v7 offset:51200
v_mul_f32 v211, v211, v210
v_mfma_f32_16x16x32_bf16 v[116:119], v[68:71], a[116:119], v[116:119]
v_cvt_pk_bf16_f32 v198, v209, v211
v_mul_f32 v214, v87, v87
v_mfma_f32_16x16x32_bf16 v[120:123], v[64:67], a[104:107], v[120:123]
v_fma_f32 v212, v212, v237, v236
v_fma_f32 v214, v214, v237, v236
v_mfma_f32_16x16x32_bf16 v[120:123], v[68:71], a[120:123], v[120:123]
ds_read_b128 v[60:63], v7 offset:52224
v_mul_f32 v212, v212, v86
v_mfma_f32_16x16x32_bf16 v[124:127], v[64:67], a[108:111], v[124:127]
buffer_load_dwordx4 a[20:23], v4, s[8:11], s26 offen offset:0 sc1
v_mfma_f32_16x16x32_bf16 v[124:127], v[68:71], a[124:127], v[124:127]
v_mul_f32 v214, v214, v87
s_waitcnt lgkmcnt(4)
v_mfma_f32_16x16x32_bf16 v[128:131], v[72:75], a[96:99], v[128:131]
v_exp_f32 v212, v212
v_mfma_f32_16x16x32_bf16 v[128:131], v[76:79], a[112:115], v[128:131]
v_exp_f32 v214, v214
v_mfma_f32_16x16x32_bf16 v[132:135], v[72:75], a[100:103], v[132:135]
ds_read_b128 v[64:67], v7 offset:53248
v_mul_f32 v213, v86, v102
v_mfma_f32_16x16x32_bf16 v[132:135], v[76:79], a[116:119], v[132:135]
buffer_load_dwordx4 a[24:27], v5, s[8:11], s26 offen offset:0 sc1
v_mfma_f32_16x16x32_bf16 v[136:139], v[72:75], a[104:107], v[136:139]
v_mul_f32 v215, v87, v103
v_fma_f32 v212, v212, v238, v238
v_mfma_f32_16x16x32_bf16 v[136:139], v[76:79], a[120:123], v[136:139]
ds_read_b128 v[68:71], v7 offset:54272
v_fma_f32 v214, v214, v238, v238
v_mfma_f32_16x16x32_bf16 v[140:143], v[72:75], a[108:111], v[140:143]
v_rcp_f32 v212, v212
v_mfma_f32_16x16x32_bf16 v[140:143], v[76:79], a[124:127], v[140:143]
v_mul_f32 v213, v213, v212
s_waitcnt lgkmcnt(4)
v_mfma_f32_16x16x32_bf16 v[112:115], v[48:51], a[128:131], v[112:115]
buffer_load_dwordx4 a[28:31], v6, s[8:11], s26 offen offset:0 sc1
v_mfma_f32_16x16x32_bf16 v[112:115], v[52:55], a[144:147], v[112:115]
v_rcp_f32 v214, v214
v_mfma_f32_16x16x32_bf16 v[116:119], v[48:51], a[132:135], v[116:119]
ds_read_b128 v[72:75], v7 offset:55296
v_mul_f32 v215, v215, v214
v_mfma_f32_16x16x32_bf16 v[116:119], v[52:55], a[148:151], v[116:119]
v_cvt_pk_bf16_f32 v199, v213, v215
v_mul_f32 v208, v88, v88
v_mfma_f32_16x16x32_bf16 v[120:123], v[48:51], a[136:139], v[120:123]
buffer_store_dwordx4 v[196:199], v4, s[8:11], s24 offen offset:3072 sc1
v_mfma_f32_16x16x32_bf16 v[120:123], v[52:55], a[152:155], v[120:123]
ds_read_b128 v[76:79], v7 offset:56320
v_mul_f32 v210, v89, v89
v_mfma_f32_16x16x32_bf16 v[124:127], v[48:51], a[140:143], v[124:127]
v_fma_f32 v208, v208, v241, v240
v_fma_f32 v210, v210, v241, v240
v_mfma_f32_16x16x32_bf16 v[124:127], v[52:55], a[156:159], v[124:127]
v_mul_f32 v208, v208, v88
s_waitcnt lgkmcnt(4)
v_mfma_f32_16x16x32_bf16 v[128:131], v[56:59], a[128:131], v[128:131]
s_waitcnt vmcnt(34)
v_mul_f32 v210, v210, v89
v_mfma_f32_16x16x32_bf16 v[128:131], v[60:63], a[144:147], v[128:131]
s_barrier
v_mfma_f32_16x16x32_bf16 v[132:135], v[56:59], a[132:135], v[132:135]
ds_read_b128 v[48:51], v7 offset:57344
v_mul_f32 v209, v88, v104
v_mfma_f32_16x16x32_bf16 v[132:135], v[60:63], a[148:151], v[132:135]
buffer_load_dwordx4 a[32:35], v2, s[8:11], s27 offen offset:0 sc1
v_mfma_f32_16x16x32_bf16 v[136:139], v[56:59], a[136:139], v[136:139]
v_exp_f32 v208, v208
v_mfma_f32_16x16x32_bf16 v[136:139], v[60:63], a[152:155], v[136:139]
ds_read_b128 v[52:55], v7 offset:58368
v_mul_f32 v211, v89, v105
v_mfma_f32_16x16x32_bf16 v[140:143], v[56:59], a[140:143], v[140:143]
v_exp_f32 v210, v210
v_mfma_f32_16x16x32_bf16 v[140:143], v[60:63], a[156:159], v[140:143]
v_fma_f32 v208, v208, v242, v242
s_waitcnt lgkmcnt(4)
v_mfma_f32_16x16x32_bf16 v[112:115], v[64:67], a[160:163], v[112:115]
buffer_load_dwordx4 a[36:39], v4, s[8:11], s27 offen offset:0 sc1
v_mfma_f32_16x16x32_bf16 v[112:115], v[68:71], a[176:179], v[112:115]
v_fma_f32 v210, v210, v242, v242
v_mul_f32 v212, v90, v90
v_mfma_f32_16x16x32_bf16 v[116:119], v[64:67], a[164:167], v[116:119]
ds_read_b128 v[56:59], v7 offset:59392
v_mul_f32 v214, v91, v91
v_mfma_f32_16x16x32_bf16 v[116:119], v[68:71], a[180:183], v[116:119]
v_rcp_f32 v208, v208
v_mfma_f32_16x16x32_bf16 v[120:123], v[64:67], a[168:171], v[120:123]
v_rcp_f32 v210, v210
v_mfma_f32_16x16x32_bf16 v[120:123], v[68:71], a[184:187], v[120:123]
ds_read_b128 v[60:63], v7 offset:60416
v_mul_f32 v209, v209, v208
v_mfma_f32_16x16x32_bf16 v[124:127], v[64:67], a[172:175], v[124:127]
buffer_load_dwordx4 a[40:43], v5, s[8:11], s27 offen offset:0 sc1
v_mfma_f32_16x16x32_bf16 v[124:127], v[68:71], a[188:191], v[124:127]
v_mul_f32 v211, v211, v210
s_waitcnt lgkmcnt(4)
v_mfma_f32_16x16x32_bf16 v[128:131], v[72:75], a[160:163], v[128:131]
v_cvt_pk_bf16_f32 v202, v209, v211
v_fma_f32 v212, v212, v241, v240
v_mfma_f32_16x16x32_bf16 v[128:131], v[76:79], a[176:179], v[128:131]
v_fma_f32 v214, v214, v241, v240
v_mul_f32 v212, v212, v90
v_mfma_f32_16x16x32_bf16 v[132:135], v[72:75], a[164:167], v[132:135]
ds_read_b128 v[64:67], v7 offset:61440
v_mul_f32 v214, v214, v91
v_mfma_f32_16x16x32_bf16 v[132:135], v[76:79], a[180:183], v[132:135]
buffer_load_dwordx4 a[44:47], v6, s[8:11], s27 offen offset:0 sc1
v_mfma_f32_16x16x32_bf16 v[136:139], v[72:75], a[168:171], v[136:139]
v_exp_f32 v212, v212
v_mfma_f32_16x16x32_bf16 v[136:139], v[76:79], a[184:187], v[136:139]
ds_read_b128 v[68:71], v7 offset:62464
v_mul_f32 v213, v90, v106
v_mfma_f32_16x16x32_bf16 v[140:143], v[72:75], a[172:175], v[140:143]
v_exp_f32 v214, v214
v_mfma_f32_16x16x32_bf16 v[140:143], v[76:79], a[188:191], v[140:143]
v_mul_f32 v215, v91, v107
s_waitcnt lgkmcnt(4)
v_mfma_f32_16x16x32_bf16 v[112:115], v[48:51], a[192:195], v[112:115]
buffer_load_dwordx4 a[48:51], v2, s[8:11], s25 offen offset:1024 sc1
v_mfma_f32_16x16x32_bf16 v[112:115], v[52:55], a[208:211], v[112:115]
v_fma_f32 v212, v212, v242, v242
v_fma_f32 v214, v214, v242, v242
v_mfma_f32_16x16x32_bf16 v[116:119], v[48:51], a[196:199], v[116:119]
ds_read_b128 v[72:75], v7 offset:63488
v_mul_f32 v208, v92, v92
v_mfma_f32_16x16x32_bf16 v[116:119], v[52:55], a[212:215], v[116:119]
v_rcp_f32 v212, v212
v_mfma_f32_16x16x32_bf16 v[120:123], v[48:51], a[200:203], v[120:123]
v_rcp_f32 v214, v214
v_mfma_f32_16x16x32_bf16 v[120:123], v[52:55], a[216:219], v[120:123]
ds_read_b128 v[76:79], v7 offset:64512
v_mul_f32 v213, v213, v212
v_mfma_f32_16x16x32_bf16 v[124:127], v[48:51], a[204:207], v[124:127]
buffer_load_dwordx4 a[52:55], v4, s[8:11], s25 offen offset:1024 sc1
v_mfma_f32_16x16x32_bf16 v[124:127], v[52:55], a[220:223], v[124:127]
v_mul_f32 v215, v215, v214
s_waitcnt lgkmcnt(4)
v_mfma_f32_16x16x32_bf16 v[128:131], v[56:59], a[192:195], v[128:131]
v_cvt_pk_bf16_f32 v203, v213, v215
v_mul_f32 v210, v93, v93
v_mfma_f32_16x16x32_bf16 v[128:131], v[60:63], a[208:211], v[128:131]
buffer_store_dwordx4 v[200:203], v5, s[8:11], s24 offen offset:3072 sc1
v_mfma_f32_16x16x32_bf16 v[132:135], v[56:59], a[196:199], v[132:135]
ds_read_b128 v[48:51], v8 offset:0
v_fma_f32 v208, v208, v245, v244
v_mfma_f32_16x16x32_bf16 v[132:135], v[60:63], a[212:215], v[132:135]
v_fma_f32 v210, v210, v245, v244
v_mul_f32 v208, v208, v92
v_mfma_f32_16x16x32_bf16 v[136:139], v[56:59], a[200:203], v[136:139]
v_mul_f32 v210, v210, v93
v_mul_f32 v209, v92, v108
v_mfma_f32_16x16x32_bf16 v[136:139], v[60:63], a[216:219], v[136:139]
ds_read_b128 v[52:55], v8 offset:1024
v_mul_f32 v211, v93, v109
v_mfma_f32_16x16x32_bf16 v[140:143], v[56:59], a[204:207], v[140:143]
buffer_load_dwordx4 a[56:59], v5, s[8:11], s25 offen offset:1024 sc1
v_mfma_f32_16x16x32_bf16 v[140:143], v[60:63], a[220:223], v[140:143]
v_mul_f32 v212, v94, v94
s_waitcnt lgkmcnt(4)
v_mfma_f32_16x16x32_bf16 v[112:115], v[64:67], a[224:227], v[112:115]
v_exp_f32 v208, v208
v_mfma_f32_16x16x32_bf16 v[112:115], v[68:71], a[240:243], v[112:115]
v_exp_f32 v210, v210
v_mfma_f32_16x16x32_bf16 v[116:119], v[64:67], a[228:231], v[116:119]
ds_read_b128 v[56:59], v8 offset:2048
v_fma_f32 v208, v208, v246, v246
v_mfma_f32_16x16x32_bf16 v[116:119], v[68:71], a[244:247], v[116:119]
buffer_load_dwordx4 a[60:63], v6, s[8:11], s25 offen offset:1024 sc1
v_mfma_f32_16x16x32_bf16 v[120:123], v[64:67], a[232:235], v[120:123]
v_fma_f32 v210, v210, v246, v246
v_mul_f32 v214, v95, v95
v_mfma_f32_16x16x32_bf16 v[120:123], v[68:71], a[248:251], v[120:123]
ds_read_b128 v[60:63], v8 offset:3072
v_fma_f32 v212, v212, v245, v244
v_mfma_f32_16x16x32_bf16 v[124:127], v[64:67], a[236:239], v[124:127]
v_rcp_f32 v208, v208
v_mfma_f32_16x16x32_bf16 v[124:127], v[68:71], a[252:255], v[124:127]
v_mul_f32 v209, v209, v208
s_waitcnt lgkmcnt(4)
v_mfma_f32_16x16x32_bf16 v[128:131], v[72:75], a[224:227], v[128:131]
buffer_load_dwordx4 a[64:67], v2, s[8:11], s26 offen offset:1024 sc1
v_mfma_f32_16x16x32_bf16 v[128:131], v[76:79], a[240:243], v[128:131]
v_rcp_f32 v210, v210
v_mfma_f32_16x16x32_bf16 v[132:135], v[72:75], a[228:231], v[132:135]
ds_read_b128 v[64:67], v8 offset:4096
v_mul_f32 v211, v211, v210
v_mfma_f32_16x16x32_bf16 v[132:135], v[76:79], a[244:247], v[132:135]
v_cvt_pk_bf16_f32 v206, v209, v211
v_fma_f32 v214, v214, v245, v244
v_mfma_f32_16x16x32_bf16 v[136:139], v[72:75], a[232:235], v[136:139]
v_mul_f32 v212, v212, v94
v_mul_f32 v214, v214, v95
v_mfma_f32_16x16x32_bf16 v[136:139], v[76:79], a[248:251], v[136:139]
ds_read_b128 v[68:71], v8 offset:5120
v_mul_f32 v213, v94, v110
v_mfma_f32_16x16x32_bf16 v[140:143], v[72:75], a[236:239], v[140:143]
buffer_load_dwordx4 a[68:71], v4, s[8:11], s26 offen offset:1024 sc1
v_mfma_f32_16x16x32_bf16 v[140:143], v[76:79], a[252:255], v[140:143]
v_mul_f32 v215, v95, v111
s_waitcnt lgkmcnt(4)
v_mfma_f32_16x16x32_bf16 v[112:115], v[48:51], v[16:19], v[112:115]
v_exp_f32 v212, v212
v_mfma_f32_16x16x32_bf16 v[112:115], v[52:55], v[32:35], v[112:115]
v_exp_f32 v214, v214
v_mfma_f32_16x16x32_bf16 v[116:119], v[48:51], v[20:23], v[116:119]
ds_read_b128 v[72:75], v8 offset:6144
v_fma_f32 v212, v212, v246, v246
v_mfma_f32_16x16x32_bf16 v[116:119], v[52:55], v[36:39], v[116:119]
buffer_load_dwordx4 a[72:75], v5, s[8:11], s26 offen offset:1024 sc1
v_mfma_f32_16x16x32_bf16 v[120:123], v[48:51], v[24:27], v[120:123]
v_fma_f32 v214, v214, v246, v246
v_mfma_f32_16x16x32_bf16 v[120:123], v[52:55], v[40:43], v[120:123]
ds_read_b128 v[76:79], v8 offset:7168
v_mfma_f32_16x16x32_bf16 v[124:127], v[48:51], v[28:31], v[124:127]
v_rcp_f32 v212, v212
v_mfma_f32_16x16x32_bf16 v[124:127], v[52:55], v[44:47], v[124:127]
v_mul_f32 v213, v213, v212
s_waitcnt lgkmcnt(4)
v_mfma_f32_16x16x32_bf16 v[128:131], v[56:59], v[16:19], v[128:131]
buffer_load_dwordx4 a[76:79], v6, s[8:11], s26 offen offset:1024 sc1
v_mfma_f32_16x16x32_bf16 v[128:131], v[60:63], v[32:35], v[128:131]
v_rcp_f32 v214, v214
v_mfma_f32_16x16x32_bf16 v[132:135], v[56:59], v[20:23], v[132:135]
ds_read_b128 v[48:51], v8 offset:8192
v_mul_f32 v215, v215, v214
v_mfma_f32_16x16x32_bf16 v[132:135], v[60:63], v[36:39], v[132:135]
v_cvt_pk_bf16_f32 v207, v213, v215
v_mfma_f32_16x16x32_bf16 v[136:139], v[56:59], v[24:27], v[136:139]
buffer_store_dwordx4 v[204:207], v6, s[8:11], s24 offen offset:3072 sc1
v_mfma_f32_16x16x32_bf16 v[136:139], v[60:63], v[40:43], v[136:139]
ds_read_b128 v[52:55], v8 offset:9216
v_mfma_f32_16x16x32_bf16 v[140:143], v[56:59], v[28:31], v[140:143]
v_mfma_f32_16x16x32_bf16 v[140:143], v[60:63], v[44:47], v[140:143]
s_waitcnt lgkmcnt(4)
v_mfma_f32_16x16x32_bf16 a[112:115], v[64:67], v[144:147], 0
v_mfma_f32_16x16x32_bf16 a[112:115], v[68:71], v[160:163], a[112:115]
v_mfma_f32_16x16x32_bf16 a[116:119], v[64:67], v[148:151], 0
ds_read_b128 v[56:59], v8 offset:10240
v_mfma_f32_16x16x32_bf16 a[116:119], v[68:71], v[164:167], a[116:119]
v_mul_f32 v208, v112, v112
v_mul_f32 v210, v113, v113
v_mfma_f32_16x16x32_bf16 a[120:123], v[64:67], v[152:155], 0
v_fma_f32 v208, v208, v233, v232
v_fma_f32 v210, v210, v233, v232
v_mfma_f32_16x16x32_bf16 a[120:123], v[68:71], v[168:171], a[120:123]
ds_read_b128 v[60:63], v8 offset:11264
v_mul_f32 v208, v208, v112
v_mfma_f32_16x16x32_bf16 a[124:127], v[64:67], v[156:159], 0
v_mul_f32 v210, v210, v113
v_mul_f32 v209, v112, v128
v_mfma_f32_16x16x32_bf16 a[124:127], v[68:71], v[172:175], a[124:127]
v_mul_f32 v211, v113, v129
s_waitcnt lgkmcnt(4)
v_mfma_f32_16x16x32_bf16 a[128:131], v[72:75], v[144:147], 0
v_exp_f32 v208, v208
v_mfma_f32_16x16x32_bf16 a[128:131], v[76:79], v[160:163], a[128:131]
v_exp_f32 v210, v210
v_mfma_f32_16x16x32_bf16 a[132:135], v[72:75], v[148:151], 0
ds_read_b128 v[64:67], v8 offset:12288
v_fma_f32 v208, v208, v234, v234
v_mfma_f32_16x16x32_bf16 a[132:135], v[76:79], v[164:167], a[132:135]
v_fma_f32 v210, v210, v234, v234
v_mul_f32 v212, v114, v114
v_mfma_f32_16x16x32_bf16 a[136:139], v[72:75], v[152:155], 0
v_rcp_f32 v208, v208
v_mfma_f32_16x16x32_bf16 a[136:139], v[76:79], v[168:171], a[136:139]
ds_read_b128 v[68:71], v8 offset:13312
v_mul_f32 v209, v209, v208
v_mfma_f32_16x16x32_bf16 a[140:143], v[72:75], v[156:159], 0
v_rcp_f32 v210, v210
v_mfma_f32_16x16x32_bf16 a[140:143], v[76:79], v[172:175], a[140:143]
v_mul_f32 v211, v211, v210
s_waitcnt lgkmcnt(4)
v_mfma_f32_16x16x32_bf16 a[144:147], v[48:51], v[144:147], 0
v_cvt_pk_bf16_f32 v224, v209, v211
v_mul_f32 v214, v115, v115
v_mfma_f32_16x16x32_bf16 a[144:147], v[52:55], v[160:163], a[144:147]
v_fma_f32 v212, v212, v233, v232
v_fma_f32 v214, v214, v233, v232
v_mfma_f32_16x16x32_bf16 a[148:151], v[48:51], v[148:151], 0
ds_read_b128 v[72:75], v8 offset:14336
v_mul_f32 v212, v212, v114
v_mfma_f32_16x16x32_bf16 a[148:151], v[52:55], v[164:167], a[148:151]
v_mul_f32 v214, v214, v115
v_mul_f32 v213, v114, v130
v_mfma_f32_16x16x32_bf16 a[152:155], v[48:51], v[152:155], 0
v_exp_f32 v212, v212
v_mfma_f32_16x16x32_bf16 a[152:155], v[52:55], v[168:171], a[152:155]
ds_read_b128 v[76:79], v8 offset:15360
v_mul_f32 v215, v115, v131
v_mfma_f32_16x16x32_bf16 a[156:159], v[48:51], v[156:159], 0
v_exp_f32 v214, v214
v_mfma_f32_16x16x32_bf16 a[156:159], v[52:55], v[172:175], a[156:159]
v_fma_f32 v212, v212, v234, v234
s_waitcnt lgkmcnt(4)
v_mfma_f32_16x16x32_bf16 a[160:163], v[56:59], v[144:147], 0
s_waitcnt vmcnt(39)
v_fma_f32 v214, v214, v234, v234
v_mfma_f32_16x16x32_bf16 a[160:163], v[60:63], v[160:163], a[160:163]
s_barrier
v_mfma_f32_16x16x32_bf16 a[164:167], v[56:59], v[148:151], 0
ds_read_b128 v[48:51], v2 offset:0
v_mul_f32 v208, v116, v116
v_mfma_f32_16x16x32_bf16 a[164:167], v[60:63], v[164:167], a[164:167]
v_rcp_f32 v212, v212
v_mfma_f32_16x16x32_bf16 a[168:171], v[56:59], v[152:155], 0
v_rcp_f32 v214, v214
v_mfma_f32_16x16x32_bf16 a[168:171], v[60:63], v[168:171], a[168:171]
ds_read_b128 v[52:55], v2 offset:1024
v_mul_f32 v213, v213, v212
v_mfma_f32_16x16x32_bf16 a[172:175], v[56:59], v[156:159], 0
v_mul_f32 v215, v215, v214
v_cvt_pk_bf16_f32 v225, v213, v215
v_mfma_f32_16x16x32_bf16 a[172:175], v[60:63], v[172:175], a[172:175]
v_mul_f32 v210, v117, v117
s_waitcnt lgkmcnt(4)
v_mfma_f32_16x16x32_bf16 a[176:179], v[64:67], v[144:147], 0
buffer_store_dwordx2 v[224:225], v248, s[8:11], s30 offen sc1
v_mfma_f32_16x16x32_bf16 a[176:179], v[68:71], v[160:163], a[176:179]
v_fma_f32 v208, v208, v237, v236
v_fma_f32 v210, v210, v237, v236
v_mfma_f32_16x16x32_bf16 a[180:183], v[64:67], v[148:151], 0
ds_read_b128 v[56:59], v2 offset:2048
v_mul_f32 v208, v208, v116
v_mfma_f32_16x16x32_bf16 a[180:183], v[68:71], v[164:167], a[180:183]
v_mul_f32 v210, v210, v117
v_mul_f32 v209, v116, v132
v_mfma_f32_16x16x32_bf16 a[184:187], v[64:67], v[152:155], 0
v_exp_f32 v208, v208
v_mfma_f32_16x16x32_bf16 a[184:187], v[68:71], v[168:171], a[184:187]
ds_read_b128 v[60:63], v2 offset:3072
v_mul_f32 v211, v117, v133
v_mfma_f32_16x16x32_bf16 a[188:191], v[64:67], v[156:159], 0
v_exp_f32 v210, v210
v_mfma_f32_16x16x32_bf16 a[188:191], v[68:71], v[172:175], a[188:191]
v_fma_f32 v208, v208, v238, v238
s_waitcnt lgkmcnt(4)
v_mfma_f32_16x16x32_bf16 a[192:195], v[72:75], v[144:147], 0
v_fma_f32 v210, v210, v238, v238
v_rcp_f32 v208, v208
v_mfma_f32_16x16x32_bf16 a[192:195], v[76:79], v[160:163], a[192:195]
v_rcp_f32 v210, v210
v_mfma_f32_16x16x32_bf16 a[196:199], v[72:75], v[148:151], 0
ds_read_b128 v[64:67], v2 offset:4096
v_mul_f32 v209, v209, v208
v_mfma_f32_16x16x32_bf16 a[196:199], v[76:79], v[164:167], a[196:199]
v_mul_f32 v211, v211, v210
v_cvt_pk_bf16_f32 v226, v209, v211
v_mfma_f32_16x16x32_bf16 a[200:203], v[72:75], v[152:155], 0
L_hop8:
s_cmp_eq_u32 s15, 1
s_cbranch_scc1 L_hop12
v_mul_f32 v212, v118, v118
v_mul_f32 v214, v119, v119
v_mfma_f32_16x16x32_bf16 a[200:203], v[76:79], v[168:171], a[200:203]
ds_read_b128 v[68:71], v2 offset:5120
v_fma_f32 v212, v212, v237, v236
v_mfma_f32_16x16x32_bf16 a[204:207], v[72:75], v[156:159], 0
v_fma_f32 v214, v214, v237, v236
v_mul_f32 v212, v212, v118
v_mfma_f32_16x16x32_bf16 a[204:207], v[76:79], v[172:175], a[204:207]
v_mul_f32 v214, v214, v119
s_waitcnt lgkmcnt(4)
v_mfma_f32_16x16x32_bf16 a[208:211], v[48:51], v[144:147], 0
v_exp_f32 v212, v212
v_mfma_f32_16x16x32_bf16 a[208:211], v[52:55], v[160:163], a[208:211]
v_exp_f32 v214, v214
v_mfma_f32_16x16x32_bf16 a[212:215], v[48:51], v[148:151], 0
ds_read_b128 v[72:75], v2 offset:6144
v_mul_f32 v213, v118, v134
v_mfma_f32_16x16x32_bf16 a[212:215], v[52:55], v[164:167], a[212:215]
v_mul_f32 v215, v119, v135
v_fma_f32 v212, v212, v238, v238
v_mfma_f32_16x16x32_bf16 a[216:219], v[48:51], v[152:155], 0
v_fma_f32 v214, v214, v238, v238
v_rcp_f32 v212, v212
v_mfma_f32_16x16x32_bf16 a[216:219], v[52:55], v[168:171], a[216:219]
ds_read_b128 v[76:79], v2 offset:7168
v_rcp_f32 v214, v214
v_mfma_f32_16x16x32_bf16 a[220:223], v[48:51], v[156:159], 0
v_mul_f32 v213, v213, v212
v_mul_f32 v215, v215, v214
v_mfma_f32_16x16x32_bf16 a[220:223], v[52:55], v[172:175], a[220:223]
v_cvt_pk_bf16_f32 v227, v213, v215
s_waitcnt lgkmcnt(4)
v_mfma_f32_16x16x32_bf16 a[224:227], v[56:59], v[144:147], 0
buffer_store_dwordx2 v[226:227], v249, s[8:11], s30 offen sc1
v_mfma_f32_16x16x32_bf16 a[224:227], v[60:63], v[160:163], a[224:227]
v_mul_f32 v208, v120, v120
v_mul_f32 v210, v121, v121
v_mfma_f32_16x16x32_bf16 a[228:231], v[56:59], v[148:151], 0
ds_read_b128 v[48:51], v2 offset:8192
v_fma_f32 v208, v208, v241, v240
v_mfma_f32_16x16x32_bf16 a[228:231], v[60:63], v[164:167], a[228:231]
v_fma_f32 v210, v210, v241, v240
v_mul_f32 v208, v208, v120
v_mfma_f32_16x16x32_bf16 a[232:235], v[56:59], v[152:155], 0
v_mul_f32 v210, v210, v121
v_exp_f32 v208, v208
v_mfma_f32_16x16x32_bf16 a[232:235], v[60:63], v[168:171], a[232:235]
ds_read_b128 v[52:55], v2 offset:9216
v_exp_f32 v210, v210
v_mfma_f32_16x16x32_bf16 a[236:239], v[56:59], v[156:159], 0
v_mul_f32 v209, v120, v136
v_mul_f32 v211, v121, v137
v_mfma_f32_16x16x32_bf16 a[236:239], v[60:63], v[172:175], a[236:239]
v_fma_f32 v208, v208, v242, v242
s_waitcnt vmcnt(21)
s_waitcnt lgkmcnt(4)
v_mfma_f32_16x16x32_bf16 a[112:115], v[64:67], v[176:179], a[112:115]
v_mov_b32 v12, s68
v_mov_b32 v13, s69
v_fma_f32 v210, v210, v242, v242
v_mfma_f32_16x16x32_bf16 a[112:115], v[68:71], a[0:3], a[112:115]
s_add_u32 s53, s34, 131072
s_waitcnt vmcnt(2)
buffer_store_dwordx2 v[12:13], v10, s[8:11], s53 offen sc1
v_rcp_f32 v208, v208
v_mfma_f32_16x16x32_bf16 a[116:119], v[64:67], v[180:183], a[116:119]
ds_read_b128 v[56:59], v2 offset:10240
v_rcp_f32 v210, v210
v_mfma_f32_16x16x32_bf16 a[116:119], v[68:71], a[4:7], a[116:119]
v_mul_f32 v209, v209, v208
v_mul_f32 v211, v211, v210
v_mfma_f32_16x16x32_bf16 a[120:123], v[64:67], v[184:187], a[120:123]
v_cvt_pk_bf16_f32 v228, v209, v211
v_mul_f32 v212, v122, v122
v_mfma_f32_16x16x32_bf16 a[120:123], v[68:71], a[8:11], a[120:123]
ds_read_b128 v[60:63], v2 offset:11264
v_mul_f32 v214, v123, v123
v_mfma_f32_16x16x32_bf16 a[124:127], v[64:67], v[188:191], a[124:127]
v_fma_f32 v212, v212, v241, v240
v_fma_f32 v214, v214, v241, v240
v_mfma_f32_16x16x32_bf16 a[124:127], v[68:71], a[12:15], a[124:127]
v_mul_f32 v212, v212, v122
s_waitcnt lgkmcnt(4)
v_mfma_f32_16x16x32_bf16 a[128:131], v[72:75], v[176:179], a[128:131]
v_mul_f32 v214, v214, v123
v_exp_f32 v212, v212
v_mfma_f32_16x16x32_bf16 a[128:131], v[76:79], a[0:3], a[128:131]
v_exp_f32 v214, v214
v_mfma_f32_16x16x32_bf16 a[132:135], v[72:75], v[180:183], a[132:135]
ds_read_b128 v[64:67], v2 offset:12288
v_mul_f32 v213, v122, v138
v_mfma_f32_16x16x32_bf16 a[132:135], v[76:79], a[4:7], a[132:135]
v_mul_f32 v215, v123, v139
v_fma_f32 v212, v212, v242, v242
v_mfma_f32_16x16x32_bf16 a[136:139], v[72:75], v[184:187], a[136:139]
v_fma_f32 v214, v214, v242, v242
v_rcp_f32 v212, v212
v_mfma_f32_16x16x32_bf16 a[136:139], v[76:79], a[8:11], a[136:139]
ds_read_b128 v[68:71], v2 offset:13312
v_rcp_f32 v214, v214
v_mfma_f32_16x16x32_bf16 a[140:143], v[72:75], v[188:191], a[140:143]
v_mul_f32 v213, v213, v212
v_mul_f32 v215, v215, v214
v_mfma_f32_16x16x32_bf16 a[140:143], v[76:79], a[12:15], a[140:143]
v_cvt_pk_bf16_f32 v229, v213, v215
s_waitcnt lgkmcnt(4)
v_mfma_f32_16x16x32_bf16 a[144:147], v[48:51], v[176:179], a[144:147]
buffer_store_dwordx2 v[228:229], v250, s[8:11], s30 offen sc1
v_mfma_f32_16x16x32_bf16 a[144:147], v[52:55], a[0:3], a[144:147]
v_mul_f32 v208, v124, v124
v_mul_f32 v210, v125, v125
v_mfma_f32_16x16x32_bf16 a[148:151], v[48:51], v[180:183], a[148:151]
ds_read_b128 v[72:75], v2 offset:14336
v_fma_f32 v208, v208, v245, v244
v_mfma_f32_16x16x32_bf16 a[148:151], v[52:55], a[4:7], a[148:151]
v_fma_f32 v210, v210, v245, v244
v_mul_f32 v208, v208, v124
v_mfma_f32_16x16x32_bf16 a[152:155], v[48:51], v[184:187], a[152:155]
v_mul_f32 v210, v210, v125
v_exp_f32 v208, v208
v_mfma_f32_16x16x32_bf16 a[152:155], v[52:55], a[8:11], a[152:155]
ds_read_b128 v[76:79], v2 offset:15360
v_exp_f32 v210, v210
v_mfma_f32_16x16x32_bf16 a[156:159], v[48:51], v[188:191], a[156:159]
v_mul_f32 v209, v124, v140
v_mul_f32 v211, v125, v141
v_mfma_f32_16x16x32_bf16 a[156:159], v[52:55], a[12:15], a[156:159]
v_fma_f32 v208, v208, v246, v246
s_waitcnt lgkmcnt(4)
v_mfma_f32_16x16x32_bf16 a[160:163], v[56:59], v[176:179], a[160:163]
v_fma_f32 v210, v210, v246, v246
v_rcp_f32 v208, v208
v_mfma_f32_16x16x32_bf16 a[160:163], v[60:63], a[0:3], a[160:163]
v_rcp_f32 v210, v210
v_mfma_f32_16x16x32_bf16 a[164:167], v[56:59], v[180:183], a[164:167]
ds_read_b128 v[48:51], v2 offset:16384
v_mul_f32 v209, v209, v208
v_mfma_f32_16x16x32_bf16 a[164:167], v[60:63], a[4:7], a[164:167]
v_mul_f32 v211, v211, v210
v_cvt_pk_bf16_f32 v230, v209, v211
v_mfma_f32_16x16x32_bf16 a[168:171], v[56:59], v[184:187], a[168:171]
v_mul_f32 v212, v126, v126
v_mul_f32 v214, v127, v127
v_mfma_f32_16x16x32_bf16 a[168:171], v[60:63], a[8:11], a[168:171]
ds_read_b128 v[52:55], v2 offset:17408
v_fma_f32 v212, v212, v245, v244
v_mfma_f32_16x16x32_bf16 a[172:175], v[56:59], v[188:191], a[172:175]
v_fma_f32 v214, v214, v245, v244
v_mul_f32 v212, v212, v126
v_mfma_f32_16x16x32_bf16 a[172:175], v[60:63], a[12:15], a[172:175]
v_mul_f32 v214, v214, v127
s_waitcnt lgkmcnt(4)
v_mfma_f32_16x16x32_bf16 a[176:179], v[64:67], v[176:179], a[176:179]
v_exp_f32 v212, v212
v_mfma_f32_16x16x32_bf16 a[176:179], v[68:71], a[0:3], a[176:179]
v_exp_f32 v214, v214
v_mfma_f32_16x16x32_bf16 a[180:183], v[64:67], v[180:183], a[180:183]
ds_read_b128 v[56:59], v2 offset:18432
v_mul_f32 v213, v126, v142
v_mfma_f32_16x16x32_bf16 a[180:183], v[68:71], a[4:7], a[180:183]
v_mul_f32 v215, v127, v143
v_fma_f32 v212, v212, v246, v246
v_mfma_f32_16x16x32_bf16 a[184:187], v[64:67], v[184:187], a[184:187]
v_fma_f32 v214, v214, v246, v246
v_rcp_f32 v212, v212
v_mfma_f32_16x16x32_bf16 a[184:187], v[68:71], a[8:11], a[184:187]
ds_read_b128 v[60:63], v2 offset:19456
v_rcp_f32 v214, v214
v_mfma_f32_16x16x32_bf16 a[188:191], v[64:67], v[188:191], a[188:191]
v_mul_f32 v213, v213, v212
v_mul_f32 v215, v215, v214
v_mfma_f32_16x16x32_bf16 a[188:191], v[68:71], a[12:15], a[188:191]
v_cvt_pk_bf16_f32 v231, v213, v215
buffer_store_dwordx2 v[230:231], v251, s[8:11], s30 offen sc1
s_waitcnt lgkmcnt(4)
v_mfma_f32_16x16x32_bf16 a[192:195], v[72:75], v[176:179], a[192:195]
buffer_load_dwordx4 a[80:83], v2, s[8:11], s27 offen offset:1024 sc1
v_mfma_f32_16x16x32_bf16 a[192:195], v[76:79], a[0:3], a[192:195]
v_mfma_f32_16x16x32_bf16 a[196:199], v[72:75], v[180:183], a[196:199]
ds_read_b128 v[64:67], v2 offset:20480
v_mfma_f32_16x16x32_bf16 a[196:199], v[76:79], a[4:7], a[196:199]
v_mfma_f32_16x16x32_bf16 a[200:203], v[72:75], v[184:187], a[200:203]
v_mfma_f32_16x16x32_bf16 a[200:203], v[76:79], a[8:11], a[200:203]
ds_read_b128 v[68:71], v2 offset:21504
v_mfma_f32_16x16x32_bf16 a[204:207], v[72:75], v[188:191], a[204:207]
buffer_load_dwordx4 a[84:87], v4, s[8:11], s27 offen offset:1024 sc1
v_mfma_f32_16x16x32_bf16 a[204:207], v[76:79], a[12:15], a[204:207]
s_waitcnt lgkmcnt(4)
v_mfma_f32_16x16x32_bf16 a[208:211], v[48:51], v[176:179], a[208:211]
s_add_u32 s23, s34, 131072
v_mfma_f32_16x16x32_bf16 a[208:211], v[52:55], a[0:3], a[208:211]
v_mfma_f32_16x16x32_bf16 a[212:215], v[48:51], v[180:183], a[212:215]
ds_read_b128 v[72:75], v2 offset:22528
v_mfma_f32_16x16x32_bf16 a[212:215], v[52:55], a[4:7], a[212:215]
buffer_load_dwordx2 v[14:15], v11, s[8:11], s23 offen sc1
v_mfma_f32_16x16x32_bf16 a[216:219], v[48:51], v[184:187], a[216:219]
v_mfma_f32_16x16x32_bf16 a[216:219], v[52:55], a[8:11], a[216:219]
ds_read_b128 v[76:79], v2 offset:23552
v_mfma_f32_16x16x32_bf16 a[220:223], v[48:51], v[188:191], a[220:223]
v_mfma_f32_16x16x32_bf16 a[220:223], v[52:55], a[12:15], a[220:223]
s_waitcnt lgkmcnt(4)
v_mfma_f32_16x16x32_bf16 a[224:227], v[56:59], v[176:179], a[224:227]
s_waitcnt vmcnt(39)
v_mfma_f32_16x16x32_bf16 a[224:227], v[60:63], a[0:3], a[224:227]
s_barrier
v_mfma_f32_16x16x32_bf16 a[228:231], v[56:59], v[180:183], a[228:231]
ds_read_b128 v[48:51], v2 offset:24576
buffer_load_dwordx4 a[88:91], v5, s[8:11], s27 offen offset:1024 sc1
v_mfma_f32_16x16x32_bf16 a[228:231], v[60:63], a[4:7], a[228:231]
v_mfma_f32_16x16x32_bf16 a[232:235], v[56:59], v[184:187], a[232:235]
v_mfma_f32_16x16x32_bf16 a[232:235], v[60:63], a[8:11], a[232:235]
ds_read_b128 v[52:55], v2 offset:25600
v_mfma_f32_16x16x32_bf16 a[236:239], v[56:59], v[188:191], a[236:239]
v_mfma_f32_16x16x32_bf16 a[236:239], v[60:63], a[12:15], a[236:239]
s_waitcnt vmcnt(19)
s_waitcnt lgkmcnt(4)
v_mfma_f32_16x16x32_bf16 a[112:115], v[64:67], a[16:19], a[112:115]
buffer_load_dwordx4 a[92:95], v6, s[8:11], s27 offen offset:1024 sc1
v_mfma_f32_16x16x32_bf16 a[112:115], v[68:71], a[32:35], a[112:115]
v_mfma_f32_16x16x32_bf16 a[116:119], v[64:67], a[20:23], a[116:119]
ds_read_b128 v[56:59], v2 offset:26624
v_mfma_f32_16x16x32_bf16 a[116:119], v[68:71], a[36:39], a[116:119]
v_mfma_f32_16x16x32_bf16 a[120:123], v[64:67], a[24:27], a[120:123]
v_mfma_f32_16x16x32_bf16 a[120:123], v[68:71], a[40:43], a[120:123]
ds_read_b128 v[60:63], v2 offset:27648
v_mfma_f32_16x16x32_bf16 a[124:127], v[64:67], a[28:31], a[124:127]
buffer_load_dwordx4 a[96:99], v2, s[8:11], s25 offen offset:2048 sc1
v_mfma_f32_16x16x32_bf16 a[124:127], v[68:71], a[44:47], a[124:127]
s_waitcnt lgkmcnt(4)
v_mfma_f32_16x16x32_bf16 a[128:131], v[72:75], a[16:19], a[128:131]
v_mfma_f32_16x16x32_bf16 a[128:131], v[76:79], a[32:35], a[128:131]
v_mfma_f32_16x16x32_bf16 a[132:135], v[72:75], a[20:23], a[132:135]
ds_read_b128 v[64:67], v2 offset:28672
v_mfma_f32_16x16x32_bf16 a[132:135], v[76:79], a[36:39], a[132:135]
buffer_load_dwordx4 a[100:103], v4, s[8:11], s25 offen offset:2048 sc1
v_mfma_f32_16x16x32_bf16 a[136:139], v[72:75], a[24:27], a[136:139]
v_mfma_f32_16x16x32_bf16 a[136:139], v[76:79], a[40:43], a[136:139]
ds_read_b128 v[68:71], v2 offset:29696
v_mfma_f32_16x16x32_bf16 a[140:143], v[72:75], a[28:31], a[140:143]
v_mfma_f32_16x16x32_bf16 a[140:143], v[76:79], a[44:47], a[140:143]
s_waitcnt lgkmcnt(4)
v_mfma_f32_16x16x32_bf16 a[144:147], v[48:51], a[16:19], a[144:147]
buffer_load_dwordx4 a[104:107], v5, s[8:11], s25 offen offset:2048 sc1
v_mfma_f32_16x16x32_bf16 a[144:147], v[52:55], a[32:35], a[144:147]
v_mfma_f32_16x16x32_bf16 a[148:151], v[48:51], a[20:23], a[148:151]
ds_read_b128 v[72:75], v2 offset:30720
v_mfma_f32_16x16x32_bf16 a[148:151], v[52:55], a[36:39], a[148:151]
v_mfma_f32_16x16x32_bf16 a[152:155], v[48:51], a[24:27], a[152:155]
buffer_load_dwordx4 a[108:111], v6, s[8:11], s25 offen offset:2048 sc1
v_mfma_f32_16x16x32_bf16 a[152:155], v[52:55], a[40:43], a[152:155]
ds_read_b128 v[76:79], v2 offset:31744
v_mfma_f32_16x16x32_bf16 a[156:159], v[48:51], a[28:31], a[156:159]
v_mfma_f32_16x16x32_bf16 a[156:159], v[52:55], a[44:47], a[156:159]
s_waitcnt lgkmcnt(4)
v_mfma_f32_16x16x32_bf16 a[160:163], v[56:59], a[16:19], a[160:163]
v_mfma_f32_16x16x32_bf16 a[160:163], v[60:63], a[32:35], a[160:163]
buffer_load_dwordx4 v[16:19], v2, s[8:11], s26 offen offset:2048 sc1
v_mfma_f32_16x16x32_bf16 a[164:167], v[56:59], a[20:23], a[164:167]
ds_read_b128 v[48:51], v2 offset:32768
v_mfma_f32_16x16x32_bf16 a[164:167], v[60:63], a[36:39], a[164:167]
v_mfma_f32_16x16x32_bf16 a[168:171], v[56:59], a[24:27], a[168:171]
v_mfma_f32_16x16x32_bf16 a[168:171], v[60:63], a[40:43], a[168:171]
ds_read_b128 v[52:55], v2 offset:33792
v_mfma_f32_16x16x32_bf16 a[172:175], v[56:59], a[28:31], a[172:175]
buffer_load_dwordx4 v[20:23], v4, s[8:11], s26 offen offset:2048 sc1
v_mfma_f32_16x16x32_bf16 a[172:175], v[60:63], a[44:47], a[172:175]
s_waitcnt lgkmcnt(4)
v_mfma_f32_16x16x32_bf16 a[176:179], v[64:67], a[16:19], a[176:179]
v_mov_b32 v12, s68
v_mov_b32 v13, s69
v_mfma_f32_16x16x32_bf16 a[176:179], v[68:71], a[32:35], a[176:179]
s_add_u32 s53, s34, 262144
s_waitcnt vmcnt(11)
v_mfma_f32_16x16x32_bf16 a[180:183], v[64:67], a[20:23], a[180:183]
ds_read_b128 v[56:59], v2 offset:34816
v_mfma_f32_16x16x32_bf16 a[180:183], v[68:71], a[36:39], a[180:183]
buffer_store_dwordx2 v[12:13], v10, s[8:11], s53 offen sc1
v_mfma_f32_16x16x32_bf16 a[184:187], v[64:67], a[24:27], a[184:187]
v_mfma_f32_16x16x32_bf16 a[184:187], v[68:71], a[40:43], a[184:187]
ds_read_b128 v[60:63], v2 offset:35840
v_mfma_f32_16x16x32_bf16 a[188:191], v[64:67], a[28:31], a[188:191]
v_mfma_f32_16x16x32_bf16 a[188:191], v[68:71], a[44:47], a[188:191]
s_waitcnt lgkmcnt(4)
v_mfma_f32_16x16x32_bf16 a[192:195], v[72:75], a[16:19], a[192:195]
buffer_load_dwordx4 v[24:27], v5, s[8:11], s26 offen offset:2048 sc1
v_mfma_f32_16x16x32_bf16 a[192:195], v[76:79], a[32:35], a[192:195]
v_mfma_f32_16x16x32_bf16 a[196:199], v[72:75], a[20:23], a[196:199]
ds_read_b128 v[64:67], v2 offset:36864
v_mfma_f32_16x16x32_bf16 a[196:199], v[76:79], a[36:39], a[196:199]
v_mfma_f32_16x16x32_bf16 a[200:203], v[72:75], a[24:27], a[200:203]
v_mfma_f32_16x16x32_bf16 a[200:203], v[76:79], a[40:43], a[200:203]
ds_read_b128 v[68:71], v2 offset:37888
v_mfma_f32_16x16x32_bf16 a[204:207], v[72:75], a[28:31], a[204:207]
buffer_load_dwordx4 v[28:31], v6, s[8:11], s26 offen offset:2048 sc1
v_mfma_f32_16x16x32_bf16 a[204:207], v[76:79], a[44:47], a[204:207]
s_waitcnt lgkmcnt(4)
v_mfma_f32_16x16x32_bf16 a[208:211], v[48:51], a[16:19], a[208:211]
s_waitcnt vmcnt(11)
v_cmp_eq_u64 vcc, s[68:69], v[14:15]
s_nop 0
s_cmp_eq_u64 vcc, exec
s_cbranch_scc0 L_f_slow2
L_f_back2:
v_mfma_f32_16x16x32_bf16 a[208:211], v[52:55], a[32:35], a[208:211]
v_mfma_f32_16x16x32_bf16 a[212:215], v[48:51], a[20:23], a[212:215]
ds_read_b128 v[72:75], v2 offset:38912
v_mfma_f32_16x16x32_bf16 a[212:215], v[52:55], a[36:39], a[212:215]
buffer_load_dwordx4 v[32:35], v2, s[8:11], s27 offen offset:2048 sc1
v_mfma_f32_16x16x32_bf16 a[216:219], v[48:51], a[24:27], a[216:219]
v_mfma_f32_16x16x32_bf16 a[216:219], v[52:55], a[40:43], a[216:219]
ds_read_b128 v[76:79], v2 offset:39936
v_mfma_f32_16x16x32_bf16 a[220:223], v[48:51], a[28:31], a[220:223]
v_mfma_f32_16x16x32_bf16 a[220:223], v[52:55], a[44:47], a[220:223]
s_waitcnt lgkmcnt(4)
v_mfma_f32_16x16x32_bf16 a[224:227], v[56:59], a[16:19], a[224:227]
buffer_load_dwordx4 v[36:39], v4, s[8:11], s27 offen offset:2048 sc1
v_mfma_f32_16x16x32_bf16 a[224:227], v[60:63], a[32:35], a[224:227]
v_mfma_f32_16x16x32_bf16 a[228:231], v[56:59], a[20:23], a[228:231]
ds_read_b128 v[48:51], v2 offset:40960
v_mfma_f32_16x16x32_bf16 a[228:231], v[60:63], a[36:39], a[228:231]
v_mfma_f32_16x16x32_bf16 a[232:235], v[56:59], a[24:27], a[232:235]
buffer_load_dwordx4 v[40:43], v5, s[8:11], s27 offen offset:2048 sc1
v_mfma_f32_16x16x32_bf16 a[232:235], v[60:63], a[40:43], a[232:235]
ds_read_b128 v[52:55], v2 offset:41984
v_mfma_f32_16x16x32_bf16 a[236:239], v[56:59], a[28:31], a[236:239]
v_mfma_f32_16x16x32_bf16 a[236:239], v[60:63], a[44:47], a[236:239]
s_waitcnt vmcnt(23)
s_waitcnt lgkmcnt(4)
v_mfma_f32_16x16x32_bf16 a[112:115], v[64:67], a[48:51], a[112:115]
buffer_load_dwordx4 v[44:47], v6, s[8:11], s27 offen offset:2048 sc1
v_mfma_f32_16x16x32_bf16 a[112:115], v[68:71], a[64:67], a[112:115]
s_add_u32 m0, s22, 73728
v_add_u32 v3, 20480, v3
v_mfma_f32_16x16x32_bf16 a[116:119], v[64:67], a[52:55], a[116:119]
ds_read_b128 v[56:59], v2 offset:43008
v_mfma_f32_16x16x32_bf16 a[116:119], v[68:71], a[68:71], a[116:119]
v_mfma_f32_16x16x32_bf16 a[120:123], v[64:67], a[56:59], a[120:123]
v_mfma_f32_16x16x32_bf16 a[120:123], v[68:71], a[72:75], a[120:123]
ds_read_b128 v[60:63], v2 offset:44032
v_mfma_f32_16x16x32_bf16 a[124:127], v[64:67], a[60:63], a[124:127]
buffer_load_dwordx4 v3, s[8:11], 0 offen offset:0 sc1 lds
v_mfma_f32_16x16x32_bf16 a[124:127], v[68:71], a[76:79], a[124:127]
s_waitcnt lgkmcnt(4)
v_mfma_f32_16x16x32_bf16 a[128:131], v[72:75], a[48:51], a[128:131]
v_mfma_f32_16x16x32_bf16 a[128:131], v[76:79], a[64:67], a[128:131]
v_mfma_f32_16x16x32_bf16 a[132:135], v[72:75], a[52:55], a[132:135]
ds_read_b128 v[64:67], v2 offset:45056
v_mfma_f32_16x16x32_bf16 a[132:135], v[76:79], a[68:71], a[132:135]
buffer_load_dwordx4 v3, s[8:11], 0 offen offset:1024 sc1 lds
v_mfma_f32_16x16x32_bf16 a[136:139], v[72:75], a[56:59], a[136:139]
v_mfma_f32_16x16x32_bf16 a[136:139], v[76:79], a[72:75], a[136:139]
ds_read_b128 v[68:71], v2 offset:46080
v_mfma_f32_16x16x32_bf16 a[140:143], v[72:75], a[60:63], a[140:143]
v_mfma_f32_16x16x32_bf16 a[140:143], v[76:79], a[76:79], a[140:143]
s_waitcnt lgkmcnt(4)
v_mfma_f32_16x16x32_bf16 a[144:147], v[48:51], a[48:51], a[144:147]
s_add_u32 s23, s34, 262144
v_mfma_f32_16x16x32_bf16 a[144:147], v[52:55], a[64:67], a[144:147]
buffer_load_dwordx2 v[14:15], v11, s[8:11], s23 offen sc1
v_mfma_f32_16x16x32_bf16 a[148:151], v[48:51], a[52:55], a[148:151]
ds_read_b128 v[72:75], v2 offset:47104
v_mfma_f32_16x16x32_bf16 a[148:151], v[52:55], a[68:71], a[148:151]
v_mfma_f32_16x16x32_bf16 a[152:155], v[48:51], a[56:59], a[152:155]
v_mfma_f32_16x16x32_bf16 a[152:155], v[52:55], a[72:75], a[152:155]
ds_read_b128 v[76:79], v2 offset:48128
v_mfma_f32_16x16x32_bf16 a[156:159], v[48:51], a[60:63], a[156:159]
buffer_load_dwordx4 v3, s[8:11], 0 offen offset:2048 sc1 lds
v_mfma_f32_16x16x32_bf16 a[156:159], v[52:55], a[76:79], a[156:159]
s_waitcnt lgkmcnt(4)
v_mfma_f32_16x16x32_bf16 a[160:163], v[56:59], a[48:51], a[160:163]
s_waitcnt vmcnt(51)
v_mfma_f32_16x16x32_bf16 a[160:163], v[60:63], a[64:67], a[160:163]
s_barrier
v_mfma_f32_16x16x32_bf16 a[164:167], v[56:59], a[52:55], a[164:167]
ds_read_b128 v[48:51], v2 offset:49152
v_mfma_f32_16x16x32_bf16 a[164:167], v[60:63], a[68:71], a[164:167]
buffer_load_dwordx4 v3, s[8:11], 0 offen offset:3072 sc1 lds
v_mfma_f32_16x16x32_bf16 a[168:171], v[56:59], a[56:59], a[168:171]
s_add_u32 m0, s22, 77824
v_add_u32 v3, 4096, v3
v_mfma_f32_16x16x32_bf16 a[168:171], v[60:63], a[72:75], a[168:171]
ds_read_b128 v[52:55], v2 offset:50176
v_mfma_f32_16x16x32_bf16 a[172:175], v[56:59], a[60:63], a[172:175]
v_mfma_f32_16x16x32_bf16 a[172:175], v[60:63], a[76:79], a[172:175]
s_waitcnt lgkmcnt(4)
v_mfma_f32_16x16x32_bf16 a[176:179], v[64:67], a[48:51], a[176:179]
buffer_load_dwordx4 v3, s[8:11], 0 offen offset:0 sc1 lds
v_mfma_f32_16x16x32_bf16 a[176:179], v[68:71], a[64:67], a[176:179]
v_mfma_f32_16x16x32_bf16 a[180:183], v[64:67], a[52:55], a[180:183]
ds_read_b128 v[56:59], v2 offset:51200
v_mfma_f32_16x16x32_bf16 a[180:183], v[68:71], a[68:71], a[180:183]
v_mfma_f32_16x16x32_bf16 a[184:187], v[64:67], a[56:59], a[184:187]
buffer_load_dwordx4 v3, s[8:11], 0 offen offset:1024 sc1 lds
v_mfma_f32_16x16x32_bf16 a[184:187], v[68:71], a[72:75], a[184:187]
ds_read_b128 v[60:63], v2 offset:52224
v_mfma_f32_16x16x32_bf16 a[188:191], v[64:67], a[60:63], a[188:191]
v_mfma_f32_16x16x32_bf16 a[188:191], v[68:71], a[76:79], a[188:191]
s_waitcnt lgkmcnt(4)
v_mfma_f32_16x16x32_bf16 a[192:195], v[72:75], a[48:51], a[192:195]
buffer_load_dwordx4 v[80:83], v2, s[8:11], s25 offen offset:3072 sc1
v_mfma_f32_16x16x32_bf16 a[192:195], v[76:79], a[64:67], a[192:195]
v_mfma_f32_16x16x32_bf16 a[196:199], v[72:75], a[52:55], a[196:199]
ds_read_b128 v[64:67], v2 offset:53248
v_mfma_f32_16x16x32_bf16 a[196:199], v[76:79], a[68:71], a[196:199]
v_mfma_f32_16x16x32_bf16 a[200:203], v[72:75], a[56:59], a[200:203]
buffer_load_dwordx4 v[84:87], v4, s[8:11], s25 offen offset:3072 sc1
v_mfma_f32_16x16x32_bf16 a[200:203], v[76:79], a[72:75], a[200:203]
ds_read_b128 v[68:71], v2 offset:54272
v_mfma_f32_16x16x32_bf16 a[204:207], v[72:75], a[60:63], a[204:207]
v_mfma_f32_16x16x32_bf16 a[204:207], v[76:79], a[76:79], a[204:207]
s_waitcnt lgkmcnt(4)
v_mfma_f32_16x16x32_bf16 a[208:211], v[48:51], a[48:51], a[208:211]
buffer_load_dwordx4 v[88:91], v5, s[8:11], s25 offen offset:3072 sc1
v_mfma_f32_16x16x32_bf16 a[208:211], v[52:55], a[64:67], a[208:211]
v_mfma_f32_16x16x32_bf16 a[212:215], v[48:51], a[52:55], a[212:215]
ds_read_b128 v[72:75], v2 offset:55296
v_mfma_f32_16x16x32_bf16 a[212:215], v[52:55], a[68:71], a[212:215]
v_mfma_f32_16x16x32_bf16 a[216:219], v[48:51], a[56:59], a[216:219]
buffer_load_dwordx4 v[92:95], v6, s[8:11], s25 offen offset:3072 sc1
v_mfma_f32_16x16x32_bf16 a[216:219], v[52:55], a[72:75], a[216:219]
ds_read_b128 v[76:79], v2 offset:56320
v_mfma_f32_16x16x32_bf16 a[220:223], v[48:51], a[60:63], a[220:223]
v_mfma_f32_16x16x32_bf16 a[220:223], v[52:55], a[76:79], a[220:223]
s_waitcnt lgkmcnt(4)
v_mfma_f32_16x16x32_bf16 a[224:227], v[56:59], a[48:51], a[224:227]
buffer_load_dwordx4 v[96:99], v2, s[8:11], s26 offen offset:3072 sc1
v_mfma_f32_16x16x32_bf16 a[224:227], v[60:63], a[64:67], a[224:227]
v_mfma_f32_16x16x32_bf16 a[228:231], v[56:59], a[52:55], a[228:231]
ds_read_b128 v[48:51], v2 offset:57344
v_mfma_f32_16x16x32_bf16 a[228:231], v[60:63], a[68:71], a[228:231]
v_mfma_f32_16x16x32_bf16 a[232:235], v[56:59], a[56:59], a[232:235]
buffer_load_dwordx4 v[100:103], v4, s[8:11], s26 offen offset:3072 sc1
v_mfma_f32_16x16x32_bf16 a[232:235], v[60:63], a[72:75], a[232:235]
ds_read_b128 v[52:55], v2 offset:58368
v_mfma_f32_16x16x32_bf16 a[236:239], v[56:59], a[60:63], a[236:239]
v_mfma_f32_16x16x32_bf16 a[236:239], v[60:63], a[76:79], a[236:239]
s_waitcnt vmcnt(22)
s_waitcnt lgkmcnt(4)
v_mfma_f32_16x16x32_bf16 a[112:115], v[64:67], a[80:83], a[112:115]
buffer_load_dwordx4 v[104:107], v5, s[8:11], s26 offen offset:3072 sc1
v_mfma_f32_16x16x32_bf16 a[112:115], v[68:71], a[96:99], a[112:115]
v_mfma_f32_16x16x32_bf16 a[116:119], v[64:67], a[84:87], a[116:119]
ds_read_b128 v[56:59], v2 offset:59392
v_mfma_f32_16x16x32_bf16 a[116:119], v[68:71], a[100:103], a[116:119]
v_mfma_f32_16x16x32_bf16 a[120:123], v[64:67], a[88:91], a[120:123]
buffer_load_dwordx4 v[108:111], v6, s[8:11], s26 offen offset:3072 sc1
v_mfma_f32_16x16x32_bf16 a[120:123], v[68:71], a[104:107], a[120:123]
ds_read_b128 v[60:63], v2 offset:60416
v_mfma_f32_16x16x32_bf16 a[124:127], v[64:67], a[92:95], a[124:127]
v_mfma_f32_16x16x32_bf16 a[124:127], v[68:71], a[108:111], a[124:127]
s_waitcnt lgkmcnt(4)
v_mfma_f32_16x16x32_bf16 a[128:131], v[72:75], a[80:83], a[128:131]
buffer_load_dwordx4 v[112:115], v2, s[8:11], s27 offen offset:3072 sc1
v_mfma_f32_16x16x32_bf16 a[128:131], v[76:79], a[96:99], a[128:131]
v_mfma_f32_16x16x32_bf16 a[132:135], v[72:75], a[84:87], a[132:135]
ds_read_b128 v[64:67], v2 offset:61440
v_mfma_f32_16x16x32_bf16 a[132:135], v[76:79], a[100:103], a[132:135]
v_mfma_f32_16x16x32_bf16 a[136:139], v[72:75], a[88:91], a[136:139]
buffer_load_dwordx4 v[116:119], v4, s[8:11], s27 offen offset:3072 sc1
v_mfma_f32_16x16x32_bf16 a[136:139], v[76:79], a[104:107], a[136:139]
ds_read_b128 v[68:71], v2 offset:62464
v_mfma_f32_16x16x32_bf16 a[140:143], v[72:75], a[92:95], a[140:143]
v_mfma_f32_16x16x32_bf16 a[140:143], v[76:79], a[108:111], a[140:143]
s_waitcnt lgkmcnt(4)
v_mfma_f32_16x16x32_bf16 a[144:147], v[48:51], a[80:83], a[144:147]
buffer_load_dwordx4 v[120:123], v5, s[8:11], s27 offen offset:3072 sc1
v_mfma_f32_16x16x32_bf16 a[144:147], v[52:55], a[96:99], a[144:147]
v_mfma_f32_16x16x32_bf16 a[148:151], v[48:51], a[84:87], a[148:151]
ds_read_b128 v[72:75], v2 offset:63488
v_mfma_f32_16x16x32_bf16 a[148:151], v[52:55], a[100:103], a[148:151]
v_mfma_f32_16x16x32_bf16 a[152:155], v[48:51], a[88:91], a[152:155]
buffer_load_dwordx4 v[124:127], v6, s[8:11], s27 offen offset:3072 sc1
v_mfma_f32_16x16x32_bf16 a[152:155], v[52:55], a[104:107], a[152:155]
ds_read_b128 v[76:79], v2 offset:64512
s_waitcnt vmcnt(16)
v_cmp_eq_u64 vcc, s[68:69], v[14:15]
s_nop 0
s_cmp_eq_u64 vcc, exec
s_cbranch_scc0 L_f_slow3
L_f_back3:
v_mfma_f32_16x16x32_bf16 a[156:159], v[48:51], a[92:95], a[156:159]
v_mfma_f32_16x16x32_bf16 a[156:159], v[52:55], a[108:111], a[156:159]
s_waitcnt lgkmcnt(4)
v_mfma_f32_16x16x32_bf16 a[160:163], v[56:59], a[80:83], a[160:163]
buffer_load_dwordx2 v[128:129], v248, s[8:11], s28 offen offset:0 sc1
v_mfma_f32_16x16x32_bf16 a[160:163], v[60:63], a[96:99], a[160:163]
v_mfma_f32_16x16x32_bf16 a[164:167], v[56:59], a[84:87], a[164:167]
ds_read_b128 v[48:51], v7 offset:0
v_mfma_f32_16x16x32_bf16 a[164:167], v[60:63], a[100:103], a[164:167]
v_mfma_f32_16x16x32_bf16 a[168:171], v[56:59], a[88:91], a[168:171]
buffer_load_dwordx2 v[130:131], v248, s[8:11], s28 offen offset:512 sc1
v_mfma_f32_16x16x32_bf16 a[168:171], v[60:63], a[104:107], a[168:171]
ds_read_b128 v[52:55], v7 offset:1024
v_mfma_f32_16x16x32_bf16 a[172:175], v[56:59], a[92:95], a[172:175]
v_mfma_f32_16x16x32_bf16 a[172:175], v[60:63], a[108:111], a[172:175]
s_waitcnt vmcnt(21)
s_waitcnt lgkmcnt(4)
v_mfma_f32_16x16x32_bf16 a[112:115], v[64:67], v[16:19], a[112:115]
buffer_load_dwordx2 v[132:133], v249, s[8:11], s28 offen offset:0 sc1
v_mfma_f32_16x16x32_bf16 a[112:115], v[68:71], v[32:35], a[112:115]
v_mfma_f32_16x16x32_bf16 a[116:119], v[64:67], v[20:23], a[116:119]
ds_read_b128 v[56:59], v7 offset:2048
v_mfma_f32_16x16x32_bf16 a[116:119], v[68:71], v[36:39], a[116:119]
v_mfma_f32_16x16x32_bf16 a[120:123], v[64:67], v[24:27], a[120:123]
buffer_load_dwordx2 v[134:135], v249, s[8:11], s28 offen offset:512 sc1
v_mfma_f32_16x16x32_bf16 a[120:123], v[68:71], v[40:43], a[120:123]
ds_read_b128 v[60:63], v7 offset:3072
v_mfma_f32_16x16x32_bf16 a[124:127], v[64:67], v[28:31], a[124:127]
v_mfma_f32_16x16x32_bf16 a[124:127], v[68:71], v[44:47], a[124:127]
s_waitcnt lgkmcnt(4)
v_mfma_f32_16x16x32_bf16 a[128:131], v[72:75], v[16:19], a[128:131]
buffer_load_dwordx2 v[136:137], v250, s[8:11], s28 offen offset:0 sc1
v_mfma_f32_16x16x32_bf16 a[128:131], v[76:79], v[32:35], a[128:131]
v_mfma_f32_16x16x32_bf16 a[132:135], v[72:75], v[20:23], a[132:135]
ds_read_b128 v[64:67], v7 offset:4096
v_mfma_f32_16x16x32_bf16 a[132:135], v[76:79], v[36:39], a[132:135]
v_mfma_f32_16x16x32_bf16 a[136:139], v[72:75], v[24:27], a[136:139]
buffer_load_dwordx2 v[138:139], v250, s[8:11], s28 offen offset:512 sc1
v_mfma_f32_16x16x32_bf16 a[136:139], v[76:79], v[40:43], a[136:139]
ds_read_b128 v[68:71], v7 offset:5120
v_mfma_f32_16x16x32_bf16 a[140:143], v[72:75], v[28:31], a[140:143]
v_mfma_f32_16x16x32_bf16 a[140:143], v[76:79], v[44:47], a[140:143]
s_waitcnt lgkmcnt(4)
v_mfma_f32_16x16x32_bf16 a[144:147], v[48:51], v[16:19], a[144:147]
buffer_load_dwordx2 v[140:141], v251, s[8:11], s28 offen offset:0 sc1
v_mfma_f32_16x16x32_bf16 a[144:147], v[52:55], v[32:35], a[144:147]
v_mfma_f32_16x16x32_bf16 a[148:151], v[48:51], v[20:23], a[148:151]
ds_read_b128 v[72:75], v7 offset:6144
v_mfma_f32_16x16x32_bf16 a[148:151], v[52:55], v[36:39], a[148:151]
v_mfma_f32_16x16x32_bf16 a[152:155], v[48:51], v[24:27], a[152:155]
buffer_load_dwordx2 v[142:143], v251, s[8:11], s28 offen offset:512 sc1
v_mfma_f32_16x16x32_bf16 a[152:155], v[52:55], v[40:43], a[152:155]
ds_read_b128 v[76:79], v7 offset:7168
v_mfma_f32_16x16x32_bf16 a[156:159], v[48:51], v[28:31], a[156:159]
v_mfma_f32_16x16x32_bf16 a[156:159], v[52:55], v[44:47], a[156:159]
s_waitcnt lgkmcnt(4)
v_mfma_f32_16x16x32_bf16 a[160:163], v[56:59], v[16:19], a[160:163]
s_waitcnt vmcnt(20)
v_mfma_f32_16x16x32_bf16 a[160:163], v[60:63], v[32:35], a[160:163]
s_barrier
v_mfma_f32_16x16x32_bf16 a[164:167], v[56:59], v[20:23], a[164:167]
ds_read_b128 v[48:51], v7 offset:8192
buffer_load_dwordx2 v[232:233], v248, s[8:11], s29 offen offset:0 sc1
v_mfma_f32_16x16x32_bf16 a[164:167], v[60:63], v[36:39], a[164:167]
v_mfma_f32_16x16x32_bf16 a[168:171], v[56:59], v[24:27], a[168:171]
v_mfma_f32_16x16x32_bf16 a[168:171], v[60:63], v[40:43], a[168:171]
ds_read_b128 v[52:55], v7 offset:9216
v_mfma_f32_16x16x32_bf16 a[172:175], v[56:59], v[28:31], a[172:175]
buffer_load_dwordx2 v[234:235], v248, s[8:11], s29 offen offset:512 sc1
v_mfma_f32_16x16x32_bf16 a[172:175], v[60:63], v[44:47], a[172:175]
s_waitcnt vmcnt(18)
s_waitcnt lgkmcnt(4)
v_mfma_f32_16x16x32_bf16 a[112:115], v[64:67], v[192:195], a[112:115]
v_mfma_f32_16x16x32_bf16 a[112:115], v[68:71], v[80:83], a[112:115]
v_mfma_f32_16x16x32_bf16 a[116:119], v[64:67], v[196:199], a[116:119]
ds_read_b128 v[56:59], v7 offset:10240
v_mfma_f32_16x16x32_bf16 a[116:119], v[68:71], v[84:87], a[116:119]
buffer_load_dwordx2 v[236:237], v249, s[8:11], s29 offen offset:0 sc1
v_mfma_f32_16x16x32_bf16 a[120:123], v[64:67], v[200:203], a[120:123]
v_mfma_f32_16x16x32_bf16 a[120:123], v[68:71], v[88:91], a[120:123]
ds_read_b128 v[60:63], v7 offset:11264
v_mfma_f32_16x16x32_bf16 a[124:127], v[64:67], v[204:207], a[124:127]
v_mfma_f32_16x16x32_bf16 a[124:127], v[68:71], v[92:95], a[124:127]
s_waitcnt lgkmcnt(4)
v_mfma_f32_16x16x32_bf16 a[128:131], v[72:75], v[192:195], a[128:131]
buffer_load_dwordx2 v[238:239], v249, s[8:11], s29 offen offset:512 sc1
v_mfma_f32_16x16x32_bf16 a[128:131], v[76:79], v[80:83], a[128:131]
v_mfma_f32_16x16x32_bf16 a[132:135], v[72:75], v[196:199], a[132:135]
ds_read_b128 v[64:67], v7 offset:12288
v_mfma_f32_16x16x32_bf16 a[132:135], v[76:79], v[84:87], a[132:135]
v_mfma_f32_16x16x32_bf16 a[136:139], v[72:75], v[200:203], a[136:139]
buffer_load_dwordx2 v[240:241], v250, s[8:11], s29 offen offset:0 sc1
v_mfma_f32_16x16x32_bf16 a[136:139], v[76:79], v[88:91], a[136:139]
ds_read_b128 v[68:71], v7 offset:13312
L_hop9:
s_cmp_eq_u32 s15, 1
s_cbranch_scc1 L_hop13
v_mfma_f32_16x16x32_bf16 a[140:143], v[72:75], v[204:207], a[140:143]
v_mfma_f32_16x16x32_bf16 a[140:143], v[76:79], v[92:95], a[140:143]
s_waitcnt lgkmcnt(4)
v_mfma_f32_16x16x32_bf16 a[144:147], v[48:51], v[192:195], a[144:147]
buffer_load_dwordx2 v[242:243], v250, s[8:11], s29 offen offset:512 sc1
v_mfma_f32_16x16x32_bf16 a[144:147], v[52:55], v[80:83], a[144:147]
v_mfma_f32_16x16x32_bf16 a[148:151], v[48:51], v[196:199], a[148:151]
ds_read_b128 v[72:75], v7 offset:14336
v_mfma_f32_16x16x32_bf16 a[148:151], v[52:55], v[84:87], a[148:151]
v_mfma_f32_16x16x32_bf16 a[152:155], v[48:51], v[200:203], a[152:155]
buffer_load_dwordx2 v[244:245], v251, s[8:11], s29 offen offset:0 sc1
v_mfma_f32_16x16x32_bf16 a[152:155], v[52:55], v[88:91], a[152:155]
ds_read_b128 v[76:79], v7 offset:15360
v_mfma_f32_16x16x32_bf16 a[156:159], v[48:51], v[204:207], a[156:159]
v_mfma_f32_16x16x32_bf16 a[156:159], v[52:55], v[92:95], a[156:159]
s_waitcnt lgkmcnt(4)
v_mfma_f32_16x16x32_bf16 a[160:163], v[56:59], v[192:195], a[160:163]
buffer_load_dwordx2 v[246:247], v251, s[8:11], s29 offen offset:512 sc1
v_mfma_f32_16x16x32_bf16 a[160:163], v[60:63], v[80:83], a[160:163]
s_add_u32 m0, s22, 98304
v_add_u32 v3, 20480, v3
v_mfma_f32_16x16x32_bf16 a[164:167], v[56:59], v[196:199], a[164:167]
ds_read_b128 v[48:51], v7 offset:16384
v_mfma_f32_16x16x32_bf16 a[164:167], v[60:63], v[84:87], a[164:167]
v_mfma_f32_16x16x32_bf16 a[168:171], v[56:59], v[200:203], a[168:171]
buffer_load_dwordx4 v3, s[8:11], 0 offen offset:0 sc1 lds
v_mfma_f32_16x16x32_bf16 a[168:171], v[60:63], v[88:91], a[168:171]
ds_read_b128 v[52:55], v7 offset:17408
v_mfma_f32_16x16x32_bf16 a[172:175], v[56:59], v[204:207], a[172:175]
v_mfma_f32_16x16x32_bf16 a[172:175], v[60:63], v[92:95], a[172:175]
s_waitcnt vmcnt(17)
s_waitcnt lgkmcnt(4)
v_mfma_f32_16x16x32_bf16 a[112:115], v[64:67], v[96:99], a[112:115]
buffer_load_dwordx4 v3, s[8:11], 0 offen offset:1024 sc1 lds
v_mfma_f32_16x16x32_bf16 a[112:115], v[68:71], v[112:115], a[112:115]
v_mfma_f32_16x16x32_bf16 a[116:119], v[64:67], v[100:103], a[116:119]
ds_read_b128 v[56:59], v7 offset:18432
v_mfma_f32_16x16x32_bf16 a[116:119], v[68:71], v[116:119], a[116:119]
v_mfma_f32_16x16x32_bf16 a[120:123], v[64:67], v[104:107], a[120:123]
buffer_load_dwordx4 v3, s[8:11], 0 offen offset:2048 sc1 lds
v_mfma_f32_16x16x32_bf16 a[120:123], v[68:71], v[120:123], a[120:123]
ds_read_b128 v[60:63], v7 offset:19456
v_mfma_f32_16x16x32_bf16 a[124:127], v[64:67], v[108:111], a[124:127]
v_mfma_f32_16x16x32_bf16 a[124:127], v[68:71], v[124:127], a[124:127]
s_waitcnt lgkmcnt(4)
v_mfma_f32_16x16x32_bf16 a[128:131], v[72:75], v[96:99], a[128:131]
buffer_load_dwordx4 v3, s[8:11], 0 offen offset:3072 sc1 lds
v_mfma_f32_16x16x32_bf16 a[128:131], v[76:79], v[112:115], a[128:131]
s_add_u32 m0, s22, 102400
v_add_u32 v3, 4096, v3
v_mfma_f32_16x16x32_bf16 a[132:135], v[72:75], v[100:103], a[132:135]
ds_read_b128 v[64:67], v7 offset:20480
v_mfma_f32_16x16x32_bf16 a[132:135], v[76:79], v[116:119], a[132:135]
v_mfma_f32_16x16x32_bf16 a[136:139], v[72:75], v[104:107], a[136:139]
buffer_load_dwordx4 v3, s[8:11], 0 offen offset:0 sc1 lds
v_mfma_f32_16x16x32_bf16 a[136:139], v[76:79], v[120:123], a[136:139]
ds_read_b128 v[68:71], v7 offset:21504
v_mfma_f32_16x16x32_bf16 a[140:143], v[72:75], v[108:111], a[140:143]
v_mfma_f32_16x16x32_bf16 a[140:143], v[76:79], v[124:127], a[140:143]
s_waitcnt lgkmcnt(4)
v_mfma_f32_16x16x32_bf16 a[144:147], v[48:51], v[96:99], a[144:147]
buffer_load_dwordx4 v3, s[8:11], 0 offen offset:1024 sc1 lds
v_mfma_f32_16x16x32_bf16 a[144:147], v[52:55], v[112:115], a[144:147]
s_add_u32 m0, s22, 122880
v_add_u32 v3, 20480, v3
v_mfma_f32_16x16x32_bf16 a[148:151], v[48:51], v[100:103], a[148:151]
ds_read_b128 v[72:75], v7 offset:22528
v_mfma_f32_16x16x32_bf16 a[148:151], v[52:55], v[116:119], a[148:151]
v_mfma_f32_16x16x32_bf16 a[152:155], v[48:51], v[104:107], a[152:155]
v_mfma_f32_16x16x32_bf16 a[152:155], v[52:55], v[120:123], a[152:155]
ds_read_b128 v[76:79], v7 offset:23552
v_mfma_f32_16x16x32_bf16 a[156:159], v[48:51], v[108:111], a[156:159]
buffer_load_dwordx4 v3, s[8:11], 0 offen offset:0 sc1 lds
v_mfma_f32_16x16x32_bf16 a[156:159], v[52:55], v[124:127], a[156:159]
s_waitcnt lgkmcnt(4)
v_mfma_f32_16x16x32_bf16 a[160:163], v[56:59], v[96:99], a[160:163]
v_mfma_f32_16x16x32_bf16 a[160:163], v[60:63], v[112:115], a[160:163]
v_mfma_f32_16x16x32_bf16 a[164:167], v[56:59], v[100:103], a[164:167]
ds_read_b128 v[48:51], v7 offset:24576
v_mfma_f32_16x16x32_bf16 a[164:167], v[60:63], v[116:119], a[164:167]
buffer_load_dwordx4 v3, s[8:11], 0 offen offset:1024 sc1 lds
v_mfma_f32_16x16x32_bf16 a[168:171], v[56:59], v[104:107], a[168:171]
v_mfma_f32_16x16x32_bf16 a[168:171], v[60:63], v[120:123], a[168:171]
ds_read_b128 v[52:55], v7 offset:25600
v_mfma_f32_16x16x32_bf16 a[172:175], v[56:59], v[108:111], a[172:175]
v_mfma_f32_16x16x32_bf16 a[172:175], v[60:63], v[124:127], a[172:175]
s_waitcnt vmcnt(8)
s_waitcnt lgkmcnt(4)
v_mfma_f32_16x16x32_bf16 a[112:115], v[64:67], v[128:131], a[112:115]
buffer_load_dwordx4 v3, s[8:11], 0 offen offset:2048 sc1 lds
v_mfma_f32_16x16x32_bf16 a[112:115], v[68:71], v[232:235], a[112:115]
v_mfma_f32_16x16x32_bf16 a[116:119], v[64:67], v[132:135], a[116:119]
ds_read_b128 v[56:59], v7 offset:26624
v_mfma_f32_16x16x32_bf16 a[116:119], v[68:71], v[236:239], a[116:119]
v_mfma_f32_16x16x32_bf16 a[120:123], v[64:67], v[136:139], a[120:123]
v_mfma_f32_16x16x32_bf16 a[120:123], v[68:71], v[240:243], a[120:123]
ds_read_b128 v[60:63], v7 offset:27648
v_mfma_f32_16x16x32_bf16 a[124:127], v[64:67], v[140:143], a[124:127]
buffer_load_dwordx4 v3, s[8:11], 0 offen offset:3072 sc1 lds
v_mfma_f32_16x16x32_bf16 a[124:127], v[68:71], v[244:247], a[124:127]
s_add_u32 m0, s22, 126976
s_waitcnt lgkmcnt(4)
v_mfma_f32_16x16x32_bf16 a[128:131], v[72:75], v[128:131], a[128:131]
v_add_u32 v3, 4096, v3
v_mfma_f32_16x16x32_bf16 a[128:131], v[76:79], v[232:235], a[128:131]
v_mfma_f32_16x16x32_bf16 a[132:135], v[72:75], v[132:135], a[132:135]
ds_read_b128 v[64:67], v7 offset:28672
v_mfma_f32_16x16x32_bf16 a[132:135], v[76:79], v[236:239], a[132:135]
buffer_load_dwordx4 v3, s[8:11], 0 offen offset:0 sc1 lds
v_mfma_f32_16x16x32_bf16 a[136:139], v[72:75], v[136:139], a[136:139]
v_mfma_f32_16x16x32_bf16 a[136:139], v[76:79], v[240:243], a[136:139]
ds_read_b128 v[68:71], v7 offset:29696
v_mfma_f32_16x16x32_bf16 a[140:143], v[72:75], v[140:143], a[140:143]
v_mfma_f32_16x16x32_bf16 a[140:143], v[76:79], v[244:247], a[140:143]
s_waitcnt lgkmcnt(4)
v_mfma_f32_16x16x32_bf16 a[144:147], v[48:51], v[128:131], a[144:147]
buffer_load_dwordx4 v3, s[8:11], 0 offen offset:1024 sc1 lds
v_mfma_f32_16x16x32_bf16 a[144:147], v[52:55], v[232:235], a[144:147]
s_lshl_b32 s21, s4, 11
s_add_u32 m0, s21, 0
v_mfma_f32_16x16x32_bf16 a[148:151], v[48:51], v[132:135], a[148:151]
ds_read_b128 v[72:75], v7 offset:30720
s_sub_u32 s21, s21, s22
v_mfma_f32_16x16x32_bf16 a[148:151], v[52:55], v[236:239], a[148:151]
s_add_u32 s21, s21, 20480
v_add_u32 v3, s21, v3
v_mfma_f32_16x16x32_bf16 a[152:155], v[48:51], v[136:139], a[152:155]
v_mfma_f32_16x16x32_bf16 a[152:155], v[52:55], v[240:243], a[152:155]
ds_read_b128 v[76:79], v7 offset:31744
v_mfma_f32_16x16x32_bf16 a[156:159], v[48:51], v[140:143], a[156:159]
buffer_load_dwordx4 v3, s[8:11], 0 offen offset:0 sc1 lds
v_mfma_f32_16x16x32_bf16 a[156:159], v[52:55], v[244:247], a[156:159]
s_waitcnt lgkmcnt(4)
v_mfma_f32_16x16x32_bf16 a[160:163], v[56:59], v[128:131], a[160:163]
s_waitcnt vmcnt(7)
v_mfma_f32_16x16x32_bf16 a[160:163], v[60:63], v[232:235], a[160:163]
s_barrier
v_mfma_f32_16x16x32_bf16 a[164:167], v[56:59], v[132:135], a[164:167]
ds_read_b128 v[48:51], v7 offset:32768
v_mfma_f32_16x16x32_bf16 a[164:167], v[60:63], v[236:239], a[164:167]
buffer_load_dwordx4 v3, s[8:11], 0 offen offset:1024 sc1 lds
v_mfma_f32_16x16x32_bf16 a[168:171], v[56:59], v[136:139], a[168:171]
v_mfma_f32_16x16x32_bf16 a[168:171], v[60:63], v[240:243], a[168:171]
ds_read_b128 v[52:55], v7 offset:33792
v_mfma_f32_16x16x32_bf16 a[172:175], v[56:59], v[140:143], a[172:175]
v_mfma_f32_16x16x32_bf16 a[172:175], v[60:63], v[244:247], a[172:175]
s_waitcnt lgkmcnt(4)
v_mfma_f32_16x16x32_bf16 a[176:179], v[64:67], a[80:83], a[176:179]
v_mfma_f32_16x16x32_bf16 a[176:179], v[68:71], a[96:99], a[176:179]
ds_read_b128 v[56:59], v7 offset:34816
v_mfma_f32_16x16x32_bf16 a[180:183], v[64:67], a[84:87], a[180:183]
ds_read_b128 v[60:63], v7 offset:35840
v_mfma_f32_16x16x32_bf16 a[180:183], v[68:71], a[100:103], a[180:183]
v_accvgpr_read_b32 v208, a112
s_waitcnt lgkmcnt(4)
v_mfma_f32_16x16x32_bf16 a[192:195], v[72:75], a[80:83], a[192:195]
v_accvgpr_read_b32 v209, a128
v_accvgpr_read_b32 v210, a144
v_mfma_f32_16x16x32_bf16 a[192:195], v[76:79], a[96:99], a[192:195]
ds_read_b128 v[64:67], v7 offset:36864
v_accvgpr_read_b32 v211, a160
v_mfma_f32_16x16x32_bf16 a[196:199], v[72:75], a[84:87], a[196:199]
ds_read_b128 v[68:71], v7 offset:37888
v_accvgpr_read_b32 v212, a113
v_mfma_f32_16x16x32_bf16 a[196:199], v[76:79], a[100:103], a[196:199]
v_accvgpr_read_b32 v213, a129
s_waitcnt lgkmcnt(4)
v_mfma_f32_16x16x32_bf16 a[208:211], v[48:51], a[80:83], a[208:211]
v_accvgpr_read_b32 v214, a145
v_accvgpr_read_b32 v215, a161
v_mfma_f32_16x16x32_bf16 a[208:211], v[52:55], a[96:99], a[208:211]
ds_read_b128 v[72:75], v7 offset:38912
v_cvt_pk_bf16_f32 v224, v208, v209
v_mfma_f32_16x16x32_bf16 a[212:215], v[48:51], a[84:87], a[212:215]
ds_read_b128 v[76:79], v7 offset:39936
v_cvt_pk_bf16_f32 v225, v210, v211
v_mfma_f32_16x16x32_bf16 a[212:215], v[52:55], a[100:103], a[212:215]
v_cvt_pk_bf16_f32 v226, v212, v213
s_waitcnt lgkmcnt(4)
v_mfma_f32_16x16x32_bf16 a[224:227], v[56:59], a[80:83], a[224:227]
v_cvt_pk_bf16_f32 v227, v214, v215
v_accvgpr_read_b32 v216, a114
v_mfma_f32_16x16x32_bf16 a[224:227], v[60:63], a[96:99], a[224:227]
ds_read_b128 v[48:51], v7 offset:40960
v_accvgpr_read_b32 v217, a130
v_mfma_f32_16x16x32_bf16 a[228:231], v[56:59], a[84:87], a[228:231]
ds_read_b128 v[52:55], v7 offset:41984
v_accvgpr_read_b32 v218, a146
v_mfma_f32_16x16x32_bf16 a[228:231], v[60:63], a[100:103], a[228:231]
v_accvgpr_read_b32 v219, a162
s_waitcnt lgkmcnt(4)
v_mfma_f32_16x16x32_bf16 a[176:179], v[64:67], v[16:19], a[176:179]
buffer_store_dwordx4 v[224:227], v252, s[8:11], s36 offen offset:0 sc1
v_mfma_f32_16x16x32_bf16 a[176:179], v[68:71], v[32:35], a[176:179]
ds_read_b128 v[56:59], v7 offset:43008
v_accvgpr_read_b32 v220, a115
v_mfma_f32_16x16x32_bf16 a[180:183], v[64:67], v[20:23], a[180:183]
ds_read_b128 v[60:63], v7 offset:44032
v_accvgpr_read_b32 v221, a131
v_mfma_f32_16x16x32_bf16 a[180:183], v[68:71], v[36:39], a[180:183]
v_accvgpr_read_b32 v222, a147
s_waitcnt lgkmcnt(4)
v_mfma_f32_16x16x32_bf16 a[192:195], v[72:75], v[16:19], a[192:195]
v_accvgpr_read_b32 v223, a163
v_cvt_pk_bf16_f32 v228, v216, v217
v_mfma_f32_16x16x32_bf16 a[192:195], v[76:79], v[32:35], a[192:195]
ds_read_b128 v[64:67], v7 offset:45056
v_cvt_pk_bf16_f32 v229, v218, v219
v_mfma_f32_16x16x32_bf16 a[196:199], v[72:75], v[20:23], a[196:199]
ds_read_b128 v[68:71], v7 offset:46080
v_cvt_pk_bf16_f32 v230, v220, v221
v_mfma_f32_16x16x32_bf16 a[196:199], v[76:79], v[36:39], a[196:199]
v_cvt_pk_bf16_f32 v231, v222, v223
s_waitcnt lgkmcnt(4)
v_mfma_f32_16x16x32_bf16 a[208:211], v[48:51], v[16:19], a[208:211]
buffer_store_dwordx4 v[228:231], v252, s[8:11], s36 offen offset:256 sc1
v_mfma_f32_16x16x32_bf16 a[208:211], v[52:55], v[32:35], a[208:211]
ds_read_b128 v[72:75], v7 offset:47104
v_accvgpr_read_b32 v208, a116
v_mfma_f32_16x16x32_bf16 a[212:215], v[48:51], v[20:23], a[212:215]
ds_read_b128 v[76:79], v7 offset:48128
v_accvgpr_read_b32 v209, a132
v_mfma_f32_16x16x32_bf16 a[212:215], v[52:55], v[36:39], a[212:215]
v_accvgpr_read_b32 v210, a148
s_waitcnt lgkmcnt(4)
v_mfma_f32_16x16x32_bf16 a[224:227], v[56:59], v[16:19], a[224:227]
v_accvgpr_read_b32 v211, a164
v_accvgpr_read_b32 v212, a117
v_mfma_f32_16x16x32_bf16 a[224:227], v[60:63], v[32:35], a[224:227]
ds_read_b128 v[48:51], v7 offset:49152
v_accvgpr_read_b32 v213, a133
v_mfma_f32_16x16x32_bf16 a[228:231], v[56:59], v[20:23], a[228:231]
ds_read_b128 v[52:55], v7 offset:50176
v_accvgpr_read_b32 v214, a149
v_mfma_f32_16x16x32_bf16 a[228:231], v[60:63], v[36:39], a[228:231]
v_accvgpr_read_b32 v215, a165
s_waitcnt lgkmcnt(4)
v_mfma_f32_16x16x32_bf16 a[176:179], v[64:67], v[192:195], a[176:179]
v_cvt_pk_bf16_f32 v224, v208, v209
v_cvt_pk_bf16_f32 v225, v210, v211
v_mfma_f32_16x16x32_bf16 a[176:179], v[68:71], v[80:83], a[176:179]
ds_read_b128 v[56:59], v7 offset:51200
v_cvt_pk_bf16_f32 v226, v212, v213
v_mfma_f32_16x16x32_bf16 a[180:183], v[64:67], v[196:199], a[180:183]
ds_read_b128 v[60:63], v7 offset:52224
v_cvt_pk_bf16_f32 v227, v214, v215
v_mfma_f32_16x16x32_bf16 a[180:183], v[68:71], v[84:87], a[180:183]
v_accvgpr_read_b32 v216, a118
s_waitcnt lgkmcnt(4)
v_mfma_f32_16x16x32_bf16 a[192:195], v[72:75], v[192:195], a[192:195]
buffer_store_dwordx4 v[224:227], v252, s[8:11], s37 offen offset:0 sc1
v_mfma_f32_16x16x32_bf16 a[192:195], v[76:79], v[80:83], a[192:195]
ds_read_b128 v[64:67], v7 offset:53248
v_accvgpr_read_b32 v217, a134
v_mfma_f32_16x16x32_bf16 a[196:199], v[72:75], v[196:199], a[196:199]
ds_read_b128 v[68:71], v7 offset:54272
v_accvgpr_read_b32 v218, a150
v_mfma_f32_16x16x32_bf16 a[196:199], v[76:79], v[84:87], a[196:199]
v_accvgpr_read_b32 v219, a166
s_waitcnt lgkmcnt(4)
v_mfma_f32_16x16x32_bf16 a[208:211], v[48:51], v[192:195], a[208:211]
v_accvgpr_read_b32 v220, a119
v_accvgpr_read_b32 v221, a135
v_mfma_f32_16x16x32_bf16 a[208:211], v[52:55], v[80:83], a[208:211]
ds_read_b128 v[72:75], v7 offset:55296
v_accvgpr_read_b32 v222, a151
v_mfma_f32_16x16x32_bf16 a[212:215], v[48:51], v[196:199], a[212:215]
ds_read_b128 v[76:79], v7 offset:56320
v_accvgpr_read_b32 v223, a167
v_mfma_f32_16x16x32_bf16 a[212:215], v[52:55], v[84:87], a[212:215]
v_cvt_pk_bf16_f32 v228, v216, v217
s_waitcnt lgkmcnt(4)
v_mfma_f32_16x16x32_bf16 a[224:227], v[56:59], v[192:195], a[224:227]
s_waitcnt vmcnt(5)
v_cvt_pk_bf16_f32 v229, v218, v219
v_mfma_f32_16x16x32_bf16 a[224:227], v[60:63], v[80:83], a[224:227]
s_barrier
v_mfma_f32_16x16x32_bf16 a[228:231], v[56:59], v[196:199], a[228:231]
ds_read_b128 v[48:51], v7 offset:57344
v_cvt_pk_bf16_f32 v230, v220, v221
v_mfma_f32_16x16x32_bf16 a[228:231], v[60:63], v[84:87], a[228:231]
ds_read_b128 v[52:55], v7 offset:58368
v_cvt_pk_bf16_f32 v231, v222, v223
s_waitcnt lgkmcnt(4)
v_mfma_f32_16x16x32_bf16 a[176:179], v[64:67], v[96:99], a[176:179]
buffer_store_dwordx4 v[228:231], v252, s[8:11], s37 offen offset:256 sc1
v_mfma_f32_16x16x32_bf16 a[176:179], v[68:71], v[112:115], a[176:179]
ds_read_b128 v[56:59], v7 offset:59392
v_accvgpr_read_b32 v208, a120
v_mfma_f32_16x16x32_bf16 a[180:183], v[64:67], v[100:103], a[180:183]
ds_read_b128 v[60:63], v7 offset:60416
v_accvgpr_read_b32 v209, a136
v_mfma_f32_16x16x32_bf16 a[180:183], v[68:71], v[116:119], a[180:183]
v_accvgpr_read_b32 v210, a152
s_waitcnt lgkmcnt(4)
v_mfma_f32_16x16x32_bf16 a[192:195], v[72:75], v[96:99], a[192:195]
v_accvgpr_read_b32 v211, a168
v_accvgpr_read_b32 v212, a121
v_mfma_f32_16x16x32_bf16 a[192:195], v[76:79], v[112:115], a[192:195]
ds_read_b128 v[64:67], v7 offset:61440
v_accvgpr_read_b32 v213, a137
v_mfma_f32_16x16x32_bf16 a[196:199], v[72:75], v[100:103], a[196:199]
ds_read_b128 v[68:71], v7 offset:62464
v_accvgpr_read_b32 v214, a153
v_mfma_f32_16x16x32_bf16 a[196:199], v[76:79], v[116:119], a[196:199]
v_accvgpr_read_b32 v215, a169
s_waitcnt lgkmcnt(4)
v_mfma_f32_16x16x32_bf16 a[208:211], v[48:51], v[96:99], a[208:211]
v_cvt_pk_bf16_f32 v224, v208, v209
v_cvt_pk_bf16_f32 v225, v210, v211
v_mfma_f32_16x16x32_bf16 a[208:211], v[52:55], v[112:115], a[208:211]
ds_read_b128 v[72:75], v7 offset:63488
v_cvt_pk_bf16_f32 v226, v212, v213
v_mfma_f32_16x16x32_bf16 a[212:215], v[48:51], v[100:103], a[212:215]
ds_read_b128 v[76:79], v7 offset:64512
v_cvt_pk_bf16_f32 v227, v214, v215
v_mfma_f32_16x16x32_bf16 a[212:215], v[52:55], v[116:119], a[212:215]
buffer_store_dwordx4 v[224:227], v252, s[8:11], s38 offen offset:0 sc1
s_waitcnt lgkmcnt(4)
v_mfma_f32_16x16x32_bf16 a[224:227], v[56:59], v[96:99], a[224:227]
v_accvgpr_read_b32 v216, a122
v_accvgpr_read_b32 v217, a138
v_mfma_f32_16x16x32_bf16 a[224:227], v[60:63], v[112:115], a[224:227]
ds_read_b128 v[48:51], v8 offset:0
v_accvgpr_read_b32 v218, a154
v_mfma_f32_16x16x32_bf16 a[228:231], v[56:59], v[100:103], a[228:231]
ds_read_b128 v[52:55], v8 offset:1024
v_accvgpr_read_b32 v219, a170
v_mfma_f32_16x16x32_bf16 a[228:231], v[60:63], v[116:119], a[228:231]
v_accvgpr_read_b32 v220, a123
s_waitcnt lgkmcnt(4)
v_mfma_f32_16x16x32_bf16 a[176:179], v[64:67], v[128:131], a[176:179]
v_accvgpr_read_b32 v221, a139
v_accvgpr_read_b32 v222, a155
v_mfma_f32_16x16x32_bf16 a[176:179], v[68:71], v[232:235], a[176:179]
ds_read_b128 v[56:59], v8 offset:2048
v_accvgpr_read_b32 v223, a171
v_mfma_f32_16x16x32_bf16 a[180:183], v[64:67], v[132:135], a[180:183]
ds_read_b128 v[60:63], v8 offset:3072
v_cvt_pk_bf16_f32 v228, v216, v217
v_mfma_f32_16x16x32_bf16 a[180:183], v[68:71], v[236:239], a[180:183]
v_cvt_pk_bf16_f32 v229, v218, v219
s_waitcnt lgkmcnt(4)
v_mfma_f32_16x16x32_bf16 a[192:195], v[72:75], v[128:131], a[192:195]
v_cvt_pk_bf16_f32 v230, v220, v221
v_cvt_pk_bf16_f32 v231, v222, v223
v_mfma_f32_16x16x32_bf16 a[192:195], v[76:79], v[232:235], a[192:195]
ds_read_b128 v[64:67], v7 offset:28672
buffer_store_dwordx4 v[228:231], v252, s[8:11], s38 offen offset:256 sc1
v_mfma_f32_16x16x32_bf16 a[196:199], v[72:75], v[132:135], a[196:199]
ds_read_b128 v[68:71], v7 offset:29696
v_accvgpr_read_b32 v208, a124
v_mfma_f32_16x16x32_bf16 a[196:199], v[76:79], v[236:239], a[196:199]
v_accvgpr_read_b32 v209, a140
s_waitcnt lgkmcnt(4)
v_mfma_f32_16x16x32_bf16 a[208:211], v[48:51], v[128:131], a[208:211]
v_accvgpr_read_b32 v210, a156
v_accvgpr_read_b32 v211, a172
v_mfma_f32_16x16x32_bf16 a[208:211], v[52:55], v[232:235], a[208:211]
ds_read_b128 v[72:75], v7 offset:30720
v_accvgpr_read_b32 v212, a125
v_mfma_f32_16x16x32_bf16 a[212:215], v[48:51], v[132:135], a[212:215]
ds_read_b128 v[76:79], v7 offset:31744
v_accvgpr_read_b32 v213, a141
v_mfma_f32_16x16x32_bf16 a[212:215], v[52:55], v[236:239], a[212:215]
v_accvgpr_read_b32 v214, a157
s_waitcnt lgkmcnt(4)
v_mfma_f32_16x16x32_bf16 a[224:227], v[56:59], v[128:131], a[224:227]
v_accvgpr_read_b32 v215, a173
v_cvt_pk_bf16_f32 v224, v208, v209
v_mfma_f32_16x16x32_bf16 a[224:227], v[60:63], v[232:235], a[224:227]
ds_read_b128 v[48:51], v7 offset:32768
v_cvt_pk_bf16_f32 v225, v210, v211
v_mfma_f32_16x16x32_bf16 a[228:231], v[56:59], v[132:135], a[228:231]
ds_read_b128 v[52:55], v7 offset:33792
v_cvt_pk_bf16_f32 v226, v212, v213
v_mfma_f32_16x16x32_bf16 a[228:231], v[60:63], v[236:239], a[228:231]
v_cvt_pk_bf16_f32 v227, v214, v215
buffer_store_dwordx4 v[224:227], v252, s[8:11], s39 offen offset:0 sc1
v_accvgpr_read_b32 v216, a126
v_accvgpr_read_b32 v217, a142
v_accvgpr_read_b32 v218, a158
v_accvgpr_read_b32 v219, a174
v_accvgpr_read_b32 v220, a127
v_accvgpr_read_b32 v221, a143
v_accvgpr_read_b32 v222, a159
v_accvgpr_read_b32 v223, a175
v_cvt_pk_bf16_f32 v228, v216, v217
v_cvt_pk_bf16_f32 v229, v218, v219
v_cvt_pk_bf16_f32 v230, v220, v221
v_cvt_pk_bf16_f32 v231, v222, v223
buffer_store_dwordx4 v[228:231], v252, s[8:11], s39 offen offset:256 sc1
s_waitcnt lgkmcnt(4)
v_mfma_f32_16x16x32_bf16 a[184:187], v[64:67], a[88:91], a[184:187]
v_mfma_f32_16x16x32_bf16 a[184:187], v[68:71], a[104:107], a[184:187]
ds_read_b128 v[56:59], v7 offset:34816
v_mfma_f32_16x16x32_bf16 a[188:191], v[64:67], a[92:95], a[188:191]
ds_read_b128 v[60:63], v7 offset:35840
v_mfma_f32_16x16x32_bf16 a[188:191], v[68:71], a[108:111], a[188:191]
v_accvgpr_read_b32 v208, a176
s_waitcnt lgkmcnt(4)
v_mfma_f32_16x16x32_bf16 a[200:203], v[72:75], a[88:91], a[200:203]
v_accvgpr_read_b32 v209, a192
v_accvgpr_read_b32 v210, a208
v_mfma_f32_16x16x32_bf16 a[200:203], v[76:79], a[104:107], a[200:203]
ds_read_b128 v[64:67], v7 offset:36864
v_accvgpr_read_b32 v211, a224
v_mfma_f32_16x16x32_bf16 a[204:207], v[72:75], a[92:95], a[204:207]
ds_read_b128 v[68:71], v7 offset:37888
v_accvgpr_read_b32 v212, a177
v_mfma_f32_16x16x32_bf16 a[204:207], v[76:79], a[108:111], a[204:207]
v_accvgpr_read_b32 v213, a193
s_waitcnt lgkmcnt(4)
v_mfma_f32_16x16x32_bf16 a[216:219], v[48:51], a[88:91], a[216:219]
v_accvgpr_read_b32 v214, a209
v_accvgpr_read_b32 v215, a225
v_mfma_f32_16x16x32_bf16 a[216:219], v[52:55], a[104:107], a[216:219]
ds_read_b128 v[72:75], v7 offset:38912
v_cvt_pk_bf16_f32 v224, v208, v209
v_mfma_f32_16x16x32_bf16 a[220:223], v[48:51], a[92:95], a[220:223]
ds_read_b128 v[76:79], v7 offset:39936
v_cvt_pk_bf16_f32 v225, v210, v211
v_mfma_f32_16x16x32_bf16 a[220:223], v[52:55], a[108:111], a[220:223]
v_cvt_pk_bf16_f32 v226, v212, v213
s_waitcnt lgkmcnt(4)
v_mfma_f32_16x16x32_bf16 a[232:235], v[56:59], a[88:91], a[232:235]
v_cvt_pk_bf16_f32 v227, v214, v215
v_accvgpr_read_b32 v216, a178
v_mfma_f32_16x16x32_bf16 a[232:235], v[60:63], a[104:107], a[232:235]
ds_read_b128 v[48:51], v7 offset:40960
v_accvgpr_read_b32 v217, a194
v_mfma_f32_16x16x32_bf16 a[236:239], v[56:59], a[92:95], a[236:239]
ds_read_b128 v[52:55], v7 offset:41984
v_accvgpr_read_b32 v218, a210
v_mfma_f32_16x16x32_bf16 a[236:239], v[60:63], a[108:111], a[236:239]
v_accvgpr_read_b32 v219, a226
s_waitcnt lgkmcnt(4)
v_mfma_f32_16x16x32_bf16 a[184:187], v[64:67], v[24:27], a[184:187]
buffer_store_dwordx4 v[224:227], v252, s[8:11], s36 offen offset:2048 sc1
v_mfma_f32_16x16x32_bf16 a[184:187], v[68:71], v[40:43], a[184:187]
ds_read_b128 v[56:59], v7 offset:43008
v_accvgpr_read_b32 v220, a179
v_mfma_f32_16x16x32_bf16 a[188:191], v[64:67], v[28:31], a[188:191]
ds_read_b128 v[60:63], v7 offset:44032
v_accvgpr_read_b32 v221, a195
v_mfma_f32_16x16x32_bf16 a[188:191], v[68:71], v[44:47], a[188:191]
v_accvgpr_read_b32 v222, a211
s_waitcnt lgkmcnt(4)
v_mfma_f32_16x16x32_bf16 a[200:203], v[72:75], v[24:27], a[200:203]
v_accvgpr_read_b32 v223, a227
v_cvt_pk_bf16_f32 v228, v216, v217
v_mfma_f32_16x16x32_bf16 a[200:203], v[76:79], v[40:43], a[200:203]
ds_read_b128 v[64:67], v7 offset:45056
v_cvt_pk_bf16_f32 v229, v218, v219
v_mfma_f32_16x16x32_bf16 a[204:207], v[72:75], v[28:31], a[204:207]
ds_read_b128 v[68:71], v7 offset:46080
v_cvt_pk_bf16_f32 v230, v220, v221
v_mfma_f32_16x16x32_bf16 a[204:207], v[76:79], v[44:47], a[204:207]
v_cvt_pk_bf16_f32 v231, v222, v223
s_waitcnt lgkmcnt(4)
v_mfma_f32_16x16x32_bf16 a[216:219], v[48:51], v[24:27], a[216:219]
buffer_store_dwordx4 v[228:231], v252, s[8:11], s36 offen offset:2304 sc1
v_mfma_f32_16x16x32_bf16 a[216:219], v[52:55], v[40:43], a[216:219]
ds_read_b128 v[72:75], v7 offset:47104
v_accvgpr_read_b32 v208, a180
v_mfma_f32_16x16x32_bf16 a[220:223], v[48:51], v[28:31], a[220:223]
ds_read_b128 v[76:79], v7 offset:48128
v_accvgpr_read_b32 v209, a196
v_mfma_f32_16x16x32_bf16 a[220:223], v[52:55], v[44:47], a[220:223]
v_accvgpr_read_b32 v210, a212
s_waitcnt lgkmcnt(4)
v_mfma_f32_16x16x32_bf16 a[232:235], v[56:59], v[24:27], a[232:235]
v_accvgpr_read_b32 v211, a228
v_accvgpr_read_b32 v212, a181
v_mfma_f32_16x16x32_bf16 a[232:235], v[60:63], v[40:43], a[232:235]
ds_read_b128 v[48:51], v7 offset:49152
v_accvgpr_read_b32 v213, a197
v_mfma_f32_16x16x32_bf16 a[236:239], v[56:59], v[28:31], a[236:239]
ds_read_b128 v[52:55], v7 offset:50176
v_accvgpr_read_b32 v214, a213
v_mfma_f32_16x16x32_bf16 a[236:239], v[60:63], v[44:47], a[236:239]
v_accvgpr_read_b32 v215, a229
s_waitcnt lgkmcnt(4)
v_mfma_f32_16x16x32_bf16 a[184:187], v[64:67], v[200:203], a[184:187]
v_cvt_pk_bf16_f32 v224, v208, v209
v_cvt_pk_bf16_f32 v225, v210, v211
v_mfma_f32_16x16x32_bf16 a[184:187], v[68:71], v[88:91], a[184:187]
ds_read_b128 v[56:59], v7 offset:51200
v_cvt_pk_bf16_f32 v226, v212, v213
v_mfma_f32_16x16x32_bf16 a[188:191], v[64:67], v[204:207], a[188:191]
ds_read_b128 v[60:63], v7 offset:52224
v_cvt_pk_bf16_f32 v227, v214, v215
v_mfma_f32_16x16x32_bf16 a[188:191], v[68:71], v[92:95], a[188:191]
v_accvgpr_read_b32 v216, a182
s_waitcnt lgkmcnt(4)
v_mfma_f32_16x16x32_bf16 a[200:203], v[72:75], v[200:203], a[200:203]
buffer_store_dwordx4 v[224:227], v252, s[8:11], s37 offen offset:2048 sc1
v_mfma_f32_16x16x32_bf16 a[200:203], v[76:79], v[88:91], a[200:203]
ds_read_b128 v[64:67], v7 offset:53248
v_accvgpr_read_b32 v217, a198
v_mfma_f32_16x16x32_bf16 a[204:207], v[72:75], v[204:207], a[204:207]
ds_read_b128 v[68:71], v7 offset:54272
v_accvgpr_read_b32 v218, a214
v_mfma_f32_16x16x32_bf16 a[204:207], v[76:79], v[92:95], a[204:207]
v_accvgpr_read_b32 v219, a230
s_waitcnt lgkmcnt(4)
v_mfma_f32_16x16x32_bf16 a[216:219], v[48:51], v[200:203], a[216:219]
v_accvgpr_read_b32 v220, a183
v_accvgpr_read_b32 v221, a199
v_mfma_f32_16x16x32_bf16 a[216:219], v[52:55], v[88:91], a[216:219]
ds_read_b128 v[72:75], v7 offset:55296
v_accvgpr_read_b32 v222, a215
v_mfma_f32_16x16x32_bf16 a[220:223], v[48:51], v[204:207], a[220:223]
ds_read_b128 v[76:79], v7 offset:56320
v_accvgpr_read_b32 v223, a231
v_mfma_f32_16x16x32_bf16 a[220:223], v[52:55], v[92:95], a[220:223]
v_cvt_pk_bf16_f32 v228, v216, v217
s_waitcnt lgkmcnt(4)
v_mfma_f32_16x16x32_bf16 a[232:235], v[56:59], v[200:203], a[232:235]
v_cvt_pk_bf16_f32 v229, v218, v219
v_cvt_pk_bf16_f32 v230, v220, v221
v_mfma_f32_16x16x32_bf16 a[232:235], v[60:63], v[88:91], a[232:235]
ds_read_b128 v[48:51], v7 offset:57344
v_cvt_pk_bf16_f32 v231, v222, v223
v_mfma_f32_16x16x32_bf16 a[236:239], v[56:59], v[204:207], a[236:239]
ds_read_b128 v[52:55], v7 offset:58368
v_mfma_f32_16x16x32_bf16 a[236:239], v[60:63], v[92:95], a[236:239]
s_waitcnt lgkmcnt(4)
v_mfma_f32_16x16x32_bf16 a[184:187], v[64:67], v[104:107], a[184:187]
s_waitcnt vmcnt(3)
v_mov_b32 v12, s68
v_mfma_f32_16x16x32_bf16 a[184:187], v[68:71], v[120:123], a[184:187]
s_barrier
v_mfma_f32_16x16x32_bf16 a[188:191], v[64:67], v[108:111], a[188:191]
ds_read_b128 v[56:59], v7 offset:59392
v_mov_b32 v13, s69
v_mfma_f32_16x16x32_bf16 a[188:191], v[68:71], v[124:127], a[188:191]
ds_read_b128 v[60:63], v7 offset:60416
s_waitcnt lgkmcnt(4)
v_mfma_f32_16x16x32_bf16 a[200:203], v[72:75], v[104:107], a[200:203]
L_hop10:
s_cmp_eq_u32 s15, 1
s_cbranch_scc1 L_hop14
buffer_store_dwordx4 v[228:231], v252, s[8:11], s37 offen offset:2304 sc1
v_mfma_f32_16x16x32_bf16 a[200:203], v[76:79], v[120:123], a[200:203]
ds_read_b128 v[64:67], v7 offset:61440
v_mfma_f32_16x16x32_bf16 a[204:207], v[72:75], v[108:111], a[204:207]
ds_read_b128 v[68:71], v7 offset:62464
v_mfma_f32_16x16x32_bf16 a[204:207], v[76:79], v[124:127], a[204:207]
s_waitcnt lgkmcnt(4)
v_mfma_f32_16x16x32_bf16 a[216:219], v[48:51], v[104:107], a[216:219]
buffer_store_dwordx2 v[12:13], v10, s[8:11], s44 offen sc1
v_mfma_f32_16x16x32_bf16 a[216:219], v[52:55], v[120:123], a[216:219]
ds_read_b128 v[72:75], v7 offset:63488
v_mfma_f32_16x16x32_bf16 a[220:223], v[48:51], v[108:111], a[220:223]
ds_read_b128 v[76:79], v7 offset:64512
v_mfma_f32_16x16x32_bf16 a[220:223], v[52:55], v[124:127], a[220:223]
s_waitcnt lgkmcnt(4)
v_mfma_f32_16x16x32_bf16 a[232:235], v[56:59], v[104:107], a[232:235]
v_mfma_f32_16x16x32_bf16 a[232:235], v[60:63], v[120:123], a[232:235]
ds_read_b128 v[48:51], v8 offset:0
v_mfma_f32_16x16x32_bf16 a[236:239], v[56:59], v[108:111], a[236:239]
ds_read_b128 v[52:55], v8 offset:1024
v_mfma_f32_16x16x32_bf16 a[236:239], v[60:63], v[124:127], a[236:239]
s_waitcnt lgkmcnt(4)
v_mfma_f32_16x16x32_bf16 a[184:187], v[64:67], v[136:139], a[184:187]
v_mfma_f32_16x16x32_bf16 a[184:187], v[68:71], v[240:243], a[184:187]
ds_read_b128 v[56:59], v8 offset:2048
v_mfma_f32_16x16x32_bf16 a[188:191], v[64:67], v[140:143], a[188:191]
ds_read_b128 v[60:63], v8 offset:3072
v_mfma_f32_16x16x32_bf16 a[188:191], v[68:71], v[244:247], a[188:191]
s_waitcnt lgkmcnt(4)
v_mfma_f32_16x16x32_bf16 a[200:203], v[72:75], v[136:139], a[200:203]
v_mfma_f32_16x16x32_bf16 a[200:203], v[76:79], v[240:243], a[200:203]
ds_read_b128 v[64:67], v8 offset:4096
v_mfma_f32_16x16x32_bf16 a[204:207], v[72:75], v[140:143], a[204:207]
ds_read_b128 v[68:71], v8 offset:5120
v_mfma_f32_16x16x32_bf16 a[204:207], v[76:79], v[244:247], a[204:207]
s_waitcnt lgkmcnt(4)
v_mfma_f32_16x16x32_bf16 a[216:219], v[48:51], v[136:139], a[216:219]
v_mfma_f32_16x16x32_bf16 a[216:219], v[52:55], v[240:243], a[216:219]
ds_read_b128 v[72:75], v8 offset:6144
v_mfma_f32_16x16x32_bf16 a[220:223], v[48:51], v[140:143], a[220:223]
ds_read_b128 v[76:79], v8 offset:7168
v_mfma_f32_16x16x32_bf16 a[220:223], v[52:55], v[244:247], a[220:223]
s_waitcnt lgkmcnt(4)
v_mfma_f32_16x16x32_bf16 a[232:235], v[56:59], v[136:139], a[232:235]
v_mfma_f32_16x16x32_bf16 a[232:235], v[60:63], v[240:243], a[232:235]
ds_read_b128 v[48:51], v8 offset:8192
v_mfma_f32_16x16x32_bf16 a[236:239], v[56:59], v[140:143], a[236:239]
ds_read_b128 v[52:55], v8 offset:9216
v_mfma_f32_16x16x32_bf16 a[236:239], v[60:63], v[244:247], a[236:239]
s_waitcnt lgkmcnt(4)
v_mfma_f32_16x16x32_bf16 a[240:243], v[64:67], v[144:147], 0
v_mfma_f32_16x16x32_bf16 a[240:243], v[68:71], v[160:163], a[240:243]
v_mfma_f32_16x16x32_bf16 a[244:247], v[64:67], v[148:151], 0
ds_read_b128 v[56:59], v8 offset:10240
v_mfma_f32_16x16x32_bf16 a[244:247], v[68:71], v[164:167], a[244:247]
v_accvgpr_read_b32 v208, a184
v_accvgpr_read_b32 v209, a200
v_mfma_f32_16x16x32_bf16 a[248:251], v[64:67], v[152:155], 0
v_accvgpr_read_b32 v210, a216
v_accvgpr_read_b32 v211, a232
v_mfma_f32_16x16x32_bf16 a[248:251], v[68:71], v[168:171], a[248:251]
ds_read_b128 v[60:63], v8 offset:11264
v_accvgpr_read_b32 v212, a185
v_mfma_f32_16x16x32_bf16 a[252:255], v[64:67], v[156:159], 0
v_accvgpr_read_b32 v213, a201
v_accvgpr_read_b32 v214, a217
v_mfma_f32_16x16x32_bf16 a[252:255], v[68:71], v[172:175], a[252:255]
v_accvgpr_read_b32 v215, a233
s_waitcnt lgkmcnt(4)
v_mfma_f32_16x16x32_bf16 a[240:243], v[72:75], v[176:179], a[240:243]
v_cvt_pk_bf16_f32 v224, v208, v209
v_cvt_pk_bf16_f32 v225, v210, v211
v_mfma_f32_16x16x32_bf16 a[240:243], v[76:79], a[0:3], a[240:243]
v_cvt_pk_bf16_f32 v226, v212, v213
v_cvt_pk_bf16_f32 v227, v214, v215
v_mfma_f32_16x16x32_bf16 a[244:247], v[72:75], v[180:183], a[244:247]
ds_read_b128 v[64:67], v8 offset:12288
v_accvgpr_read_b32 v216, a186
v_mfma_f32_16x16x32_bf16 a[244:247], v[76:79], a[4:7], a[244:247]
buffer_store_dwordx4 v[224:227], v252, s[8:11], s38 offen offset:2048 sc1
v_mfma_f32_16x16x32_bf16 a[248:251], v[72:75], v[184:187], a[248:251]
v_accvgpr_read_b32 v217, a202
v_accvgpr_read_b32 v218, a218
v_mfma_f32_16x16x32_bf16 a[248:251], v[76:79], a[8:11], a[248:251]
ds_read_b128 v[68:71], v8 offset:13312
v_accvgpr_read_b32 v219, a234
v_mfma_f32_16x16x32_bf16 a[252:255], v[72:75], v[188:191], a[252:255]
v_accvgpr_read_b32 v220, a187
v_accvgpr_read_b32 v221, a203
v_mfma_f32_16x16x32_bf16 a[252:255], v[76:79], a[12:15], a[252:255]
v_accvgpr_read_b32 v222, a219
s_waitcnt lgkmcnt(4)
v_mfma_f32_16x16x32_bf16 a[240:243], v[48:51], a[16:19], a[240:243]
v_accvgpr_read_b32 v223, a235
v_cvt_pk_bf16_f32 v228, v216, v217
v_mfma_f32_16x16x32_bf16 a[240:243], v[52:55], a[32:35], a[240:243]
v_cvt_pk_bf16_f32 v229, v218, v219
v_cvt_pk_bf16_f32 v230, v220, v221
v_mfma_f32_16x16x32_bf16 a[244:247], v[48:51], a[20:23], a[244:247]
ds_read_b128 v[72:75], v8 offset:14336
v_cvt_pk_bf16_f32 v231, v222, v223
v_mfma_f32_16x16x32_bf16 a[244:247], v[52:55], a[36:39], a[244:247]
buffer_store_dwordx4 v[228:231], v252, s[8:11], s38 offen offset:2304 sc1
v_mfma_f32_16x16x32_bf16 a[248:251], v[48:51], a[24:27], a[248:251]
v_accvgpr_read_b32 v208, a188
v_accvgpr_read_b32 v209, a204
v_mfma_f32_16x16x32_bf16 a[248:251], v[52:55], a[40:43], a[248:251]
ds_read_b128 v[76:79], v8 offset:15360
v_accvgpr_read_b32 v210, a220
v_mfma_f32_16x16x32_bf16 a[252:255], v[48:51], a[28:31], a[252:255]
v_accvgpr_read_b32 v211, a236
v_accvgpr_read_b32 v212, a189
v_mfma_f32_16x16x32_bf16 a[252:255], v[52:55], a[44:47], a[252:255]
v_accvgpr_read_b32 v213, a205
s_waitcnt lgkmcnt(4)
v_mfma_f32_16x16x32_bf16 a[240:243], v[56:59], a[48:51], a[240:243]
s_waitcnt vmcnt(15)
v_accvgpr_read_b32 v214, a221
v_mfma_f32_16x16x32_bf16 a[240:243], v[60:63], a[64:67], a[240:243]
s_barrier
v_mfma_f32_16x16x32_bf16 a[244:247], v[56:59], a[52:55], a[244:247]
ds_read_b128 v[48:51], v2 offset:0
v_accvgpr_read_b32 v215, a237
v_mfma_f32_16x16x32_bf16 a[244:247], v[60:63], a[68:71], a[244:247]
v_cvt_pk_bf16_f32 v224, v208, v209
v_cvt_pk_bf16_f32 v225, v210, v211
v_mfma_f32_16x16x32_bf16 a[248:251], v[56:59], a[56:59], a[248:251]
v_cvt_pk_bf16_f32 v226, v212, v213
v_cvt_pk_bf16_f32 v227, v214, v215
v_mfma_f32_16x16x32_bf16 a[248:251], v[60:63], a[72:75], a[248:251]
ds_read_b128 v[52:55], v2 offset:1024
v_accvgpr_read_b32 v216, a190
v_mfma_f32_16x16x32_bf16 a[252:255], v[56:59], a[60:63], a[252:255]
buffer_store_dwordx4 v[224:227], v252, s[8:11], s39 offen offset:2048 sc1
v_mfma_f32_16x16x32_bf16 a[252:255], v[60:63], a[76:79], a[252:255]
v_accvgpr_read_b32 v217, a206
s_waitcnt lgkmcnt(4)
v_mfma_f32_16x16x32_bf16 a[240:243], v[64:67], a[80:83], a[240:243]
v_accvgpr_read_b32 v218, a222
v_accvgpr_read_b32 v219, a238
v_mfma_f32_16x16x32_bf16 a[240:243], v[68:71], a[96:99], a[240:243]
v_accvgpr_read_b32 v220, a191
v_accvgpr_read_b32 v221, a207
v_mfma_f32_16x16x32_bf16 a[244:247], v[64:67], a[84:87], a[244:247]
ds_read_b128 v[56:59], v2 offset:2048
v_accvgpr_read_b32 v222, a223
v_mfma_f32_16x16x32_bf16 a[244:247], v[68:71], a[100:103], a[244:247]
v_accvgpr_read_b32 v223, a239
v_cvt_pk_bf16_f32 v228, v216, v217
v_mfma_f32_16x16x32_bf16 a[248:251], v[64:67], a[88:91], a[248:251]
v_cvt_pk_bf16_f32 v229, v218, v219
v_cvt_pk_bf16_f32 v230, v220, v221
v_mfma_f32_16x16x32_bf16 a[248:251], v[68:71], a[104:107], a[248:251]
ds_read_b128 v[60:63], v2 offset:3072
v_cvt_pk_bf16_f32 v231, v222, v223
v_mfma_f32_16x16x32_bf16 a[252:255], v[64:67], a[92:95], a[252:255]
buffer_store_dwordx4 v[228:231], v252, s[8:11], s39 offen offset:2304 sc1
v_mfma_f32_16x16x32_bf16 a[252:255], v[68:71], a[108:111], a[252:255]
s_waitcnt lgkmcnt(4)
v_mfma_f32_16x16x32_bf16 a[240:243], v[72:75], v[16:19], a[240:243]
v_mfma_f32_16x16x32_bf16 a[240:243], v[76:79], v[32:35], a[240:243]
v_mfma_f32_16x16x32_bf16 a[244:247], v[72:75], v[20:23], a[244:247]
ds_read_b128 v[64:67], v2 offset:4096
v_mfma_f32_16x16x32_bf16 a[244:247], v[76:79], v[36:39], a[244:247]
v_mfma_f32_16x16x32_bf16 a[248:251], v[72:75], v[24:27], a[248:251]
v_mfma_f32_16x16x32_bf16 a[248:251], v[76:79], v[40:43], a[248:251]
ds_read_b128 v[68:71], v2 offset:5120
v_mfma_f32_16x16x32_bf16 a[252:255], v[72:75], v[28:31], a[252:255]
v_mfma_f32_16x16x32_bf16 a[252:255], v[76:79], v[44:47], a[252:255]
s_waitcnt lgkmcnt(4)
v_mfma_f32_16x16x32_bf16 a[240:243], v[48:51], v[192:195], a[240:243]
v_mfma_f32_16x16x32_bf16 a[240:243], v[52:55], v[80:83], a[240:243]
v_mfma_f32_16x16x32_bf16 a[244:247], v[48:51], v[196:199], a[244:247]
v_mfma_f32_16x16x32_bf16 a[244:247], v[52:55], v[84:87], a[244:247]
v_mfma_f32_16x16x32_bf16 a[248:251], v[48:51], v[200:203], a[248:251]
v_mfma_f32_16x16x32_bf16 a[248:251], v[52:55], v[88:91], a[248:251]
v_mfma_f32_16x16x32_bf16 a[252:255], v[48:51], v[204:207], a[252:255]
v_mfma_f32_16x16x32_bf16 a[252:255], v[52:55], v[92:95], a[252:255]
s_waitcnt lgkmcnt(2)
v_mfma_f32_16x16x32_bf16 a[240:243], v[56:59], v[96:99], a[240:243]
v_mfma_f32_16x16x32_bf16 a[240:243], v[60:63], v[112:115], a[240:243]
v_mfma_f32_16x16x32_bf16 a[244:247], v[56:59], v[100:103], a[244:247]
v_mfma_f32_16x16x32_bf16 a[244:247], v[60:63], v[116:119], a[244:247]
v_mfma_f32_16x16x32_bf16 a[248:251], v[56:59], v[104:107], a[248:251]
v_mfma_f32_16x16x32_bf16 a[248:251], v[60:63], v[120:123], a[248:251]
v_mfma_f32_16x16x32_bf16 a[252:255], v[56:59], v[108:111], a[252:255]
v_mfma_f32_16x16x32_bf16 a[252:255], v[60:63], v[124:127], a[252:255]
s_waitcnt lgkmcnt(0)
v_mfma_f32_16x16x32_bf16 a[240:243], v[64:67], v[128:131], a[240:243]
v_mfma_f32_16x16x32_bf16 a[240:243], v[68:71], v[232:235], a[240:243]
v_mfma_f32_16x16x32_bf16 a[244:247], v[64:67], v[132:135], a[244:247]
v_mfma_f32_16x16x32_bf16 a[244:247], v[68:71], v[236:239], a[244:247]
v_mfma_f32_16x16x32_bf16 a[248:251], v[64:67], v[136:139], a[248:251]
v_mfma_f32_16x16x32_bf16 a[248:251], v[68:71], v[240:243], a[248:251]
v_mfma_f32_16x16x32_bf16 a[252:255], v[64:67], v[140:143], a[252:255]
v_mfma_f32_16x16x32_bf16 a[252:255], v[68:71], v[244:247], a[252:255]
s_nop 1
v_accvgpr_read_b32 v208, a240
v_accvgpr_read_b32 v209, a241
v_accvgpr_read_b32 v210, a242
v_accvgpr_read_b32 v211, a243
v_accvgpr_read_b32 v212, a244
v_accvgpr_read_b32 v213, a245
v_accvgpr_read_b32 v214, a246
v_accvgpr_read_b32 v215, a247
v_cvt_pk_bf16_f32 v224, v208, v209
v_cvt_pk_bf16_f32 v225, v210, v211
v_cvt_pk_bf16_f32 v226, v212, v213
v_cvt_pk_bf16_f32 v227, v214, v215
s_nop 0
v_permlane16_swap_b32 v224, v226
v_permlane16_swap_b32 v225, v227
buffer_store_dwordx4 v[224:227], v9, s[8:11], s32 offen sc1
v_accvgpr_read_b32 v216, a248
v_accvgpr_read_b32 v217, a249
v_accvgpr_read_b32 v218, a250
v_accvgpr_read_b32 v219, a251
v_accvgpr_read_b32 v220, a252
v_accvgpr_read_b32 v221, a253
v_accvgpr_read_b32 v222, a254
v_accvgpr_read_b32 v223, a255
v_cvt_pk_bf16_f32 v228, v216, v217
v_cvt_pk_bf16_f32 v229, v218, v219
v_cvt_pk_bf16_f32 v230, v220, v221
v_cvt_pk_bf16_f32 v231, v222, v223
s_nop 0
v_permlane16_swap_b32 v228, v230
v_permlane16_swap_b32 v229, v231
buffer_store_dwordx4 v[228:231], v9, s[8:11], s33 offen sc1
s_mov_b32 s14, s35
s_cmp_eq_u32 s7, 1
s_cbranch_scc1 L_last
s_cmp_eq_u32 s4, 3
s_cbranch_scc1 L_r_side
v_and_b32 v6, 7, v1
v_lshrrev_b32 v7, 3, v1
s_and_b32 s23, s6, 1
s_lshl_b32 s23, s23, 3
v_add_u32 v8, s23, v6
v_lshlrev_b32 v8, 4, v8
v_lshl_add_u32 v4, v7, 8, v8
s_lshl_b32 s24, s5, 4
s_lshr_b32 s25, s6, 1
s_add_u32 s24, s24, s25
s_mul_i32 s20, s24, 18432
s_lshl_b32 s22, s4, 2
s_lshr_b32 s23, 1056, s22
s_and_b32 s23, s23, 15
s_lshl_b32 s24, s23, 11
s_add_u32 s28, s20, s24
s_lshr_b32 s23, 790, s22
s_and_b32 s23, s23, 15
s_lshl_b32 s24, s23, 11
s_add_u32 s29, s20, s24
s_lshr_b32 s23, 2165, s22
s_and_b32 s23, s23, 15
s_lshl_b32 s24, s23, 11
s_add_u32 s30, s20, s24
s_lshl_b32 s26, s5, 12
s_add_u32 s27, s26, 917504
s_add_u32 s26, s26, 655360
v_and_b32 v6, 31, v1
v_lshlrev_b32 v6, 7, v6
buffer_load_dwordx2 v[10:11], v6, s[8:11], s27 offen sc1
v_mov_b32 v13, 2146435072
v_cmp_gt_u32 vcc, 16, v0
v_lshlrev_b32 v14, 3, v0
s_nop 0
v_cndmask_b32 v13, v13, v14, vcc
v_mov_b32 v14, s68
v_mov_b32 v15, s69
s_waitcnt vmcnt(0)
s_barrier
buffer_store_dwordx2 v[14:15], v13, s[8:11], s14 offen sc1
s_add_u32 s24, s28, 37126144
buffer_load_dwordx4 v[16:19], v4, s[8:11], s24 offen sc1
s_add_u32 s25, s29, 37126144
buffer_load_dwordx4 v[20:23], v4, s[8:11], s25 offen sc1
s_add_u32 s24, s30, 37126144
buffer_load_dwordx4 v[24:27], v4, s[8:11], s24 offen sc1
v_cmp_eq_u64 vcc, s[68:69], v[10:11]
s_nop 0
s_cmp_eq_u64 vcc, exec
s_cbranch_scc0 L_re_slow4
L_re_back4:
s_add_u32 s25, s28, 79855616
buffer_load_dwordx4 v[28:31], v4, s[8:11], s25 offen sc1
s_add_u32 s24, s28, 82214912
buffer_load_dwordx4 v[40:43], v4, s[8:11], s24 offen sc1
s_add_u32 s25, s28, 84574208
buffer_load_dwordx4 v[52:55], v4, s[8:11], s25 offen sc1
s_add_u32 s24, s28, 86933504
buffer_load_dwordx4 v[64:67], v4, s[8:11], s24 offen sc1
s_add_u32 s25, s28, 89292800
buffer_load_dwordx4 v[76:79], v4, s[8:11], s25 offen sc1
s_add_u32 s24, s28, 91652096
buffer_load_dwordx4 v[88:91], v4, s[8:11], s24 offen sc1
s_add_u32 s25, s28, 94011392
buffer_load_dwordx4 v[100:103], v4, s[8:11], s25 offen sc1
s_add_u32 s24, s28, 96370688
buffer_load_dwordx4 v[112:115], v4, s[8:11], s24 offen sc1
s_cmp_eq_u32 s4, 0
s_cbranch_scc0 L_re1_4
s_add_u32 s24, s29, 79855616
buffer_load_dwordx4 v[32:35], v4, s[8:11], s24 offen sc1
s_add_u32 s25, s29, 82214912
buffer_load_dwordx4 v[44:47], v4, s[8:11], s25 offen sc1
s_add_u32 s24, s29, 84574208
buffer_load_dwordx4 v[56:59], v4, s[8:11], s24 offen sc1
s_add_u32 s25, s29, 86933504
buffer_load_dwordx4 v[68:71], v4, s[8:11], s25 offen sc1
s_add_u32 s24, s29, 89292800
buffer_load_dwordx4 v[80:83], v4, s[8:11], s24 offen sc1
s_add_u32 s25, s29, 91652096
buffer_load_dwordx4 v[92:95], v4, s[8:11], s25 offen sc1
s_add_u32 s24, s29, 94011392
buffer_load_dwordx4 v[104:107], v4, s[8:11], s24 offen sc1
s_add_u32 s25, s29, 96370688
buffer_load_dwordx4 v[116:119], v4, s[8:11], s25 offen sc1
L_re1_4:
s_mov_b32 s52, 0
L_poll6:
buffer_load_dwordx2 v[14:15], v6, s[8:11], s26 offen sc1
s_add_u32 s52, s52, 1
s_waitcnt vmcnt(0)
v_cmp_ne_u64 vcc, s[68:69], v[14:15]
s_cmp_ge_u32 s52, 1048576
s_cbranch_scc1 L_got6
s_and_b64 exec, exec, vcc
s_cbranch_execnz L_poll6
L_got6:
s_mov_b64 exec, -1
s_cmp_eq_u32 s4, 0
s_cbranch_scc1 L_re2_4
s_add_u32 s24, s29, 79855616
buffer_load_dwordx4 v[32:35], v4, s[8:11], s24 offen sc1
s_add_u32 s25, s29, 82214912
buffer_load_dwordx4 v[44:47], v4, s[8:11], s25 offen sc1
s_add_u32 s24, s29, 84574208
buffer_load_dwordx4 v[56:59], v4, s[8:11], s24 offen sc1
s_add_u32 s25, s29, 86933504
buffer_load_dwordx4 v[68:71], v4, s[8:11], s25 offen sc1
s_add_u32 s24, s29, 89292800
buffer_load_dwordx4 v[80:83], v4, s[8:11], s24 offen sc1
s_add_u32 s25, s29, 91652096
buffer_load_dwordx4 v[92:95], v4, s[8:11], s25 offen sc1
s_add_u32 s24, s29, 94011392
buffer_load_dwordx4 v[104:107], v4, s[8:11], s24 offen sc1
s_add_u32 s25, s29, 96370688
buffer_load_dwordx4 v[116:119], v4, s[8:11], s25 offen sc1
L_re2_4:
s_add_u32 s25, s30, 79855616
buffer_load_dwordx4 v[36:39], v4, s[8:11], s25 offen sc1
s_add_u32 s24, s30, 82214912
buffer_load_dwordx4 v[48:51], v4, s[8:11], s24 offen sc1
s_add_u32 s25, s30, 84574208
buffer_load_dwordx4 v[60:63], v4, s[8:11], s25 offen sc1
s_add_u32 s24, s30, 86933504
buffer_load_dwordx4 v[72:75], v4, s[8:11], s24 offen sc1
s_add_u32 s25, s30, 89292800
buffer_load_dwordx4 v[84:87], v4, s[8:11], s25 offen sc1
s_add_u32 s24, s30, 91652096
buffer_load_dwordx4 v[96:99], v4, s[8:11], s24 offen sc1
s_add_u32 s25, s30, 94011392
buffer_load_dwordx4 v[108:111], v4, s[8:11], s25 offen sc1
s_add_u32 s24, s30, 96370688
buffer_load_dwordx4 v[120:123], v4, s[8:11], s24 offen sc1
s_waitcnt vmcnt(26)
v_lshlrev_b32 v128, 16, v16
v_and_b32 v129, 0xffff0000, v16
v_lshlrev_b32 v130, 16, v17
v_and_b32 v131, 0xffff0000, v17
v_lshlrev_b32 v132, 16, v18
v_and_b32 v133, 0xffff0000, v18
v_lshlrev_b32 v134, 16, v19
v_and_b32 v135, 0xffff0000, v19
s_waitcnt vmcnt(25)
v_lshlrev_b32 v136, 16, v20
v_and_b32 v137, 0xffff0000, v20
v_lshlrev_b32 v138, 16, v21
v_and_b32 v139, 0xffff0000, v21
v_lshlrev_b32 v140, 16, v22
v_and_b32 v141, 0xffff0000, v22
v_lshlrev_b32 v142, 16, v23
v_and_b32 v143, 0xffff0000, v23
s_waitcnt vmcnt(24)
v_lshlrev_b32 v144, 16, v24
v_and_b32 v145, 0xffff0000, v24
v_lshlrev_b32 v146, 16, v25
v_and_b32 v147, 0xffff0000, v25
v_lshlrev_b32 v148, 16, v26
v_and_b32 v149, 0xffff0000, v26
v_lshlrev_b32 v150, 16, v27
v_and_b32 v151, 0xffff0000, v27
s_waitcnt vmcnt(23)
v_lshlrev_b32 v6, 16, v28
v_and_b32 v7, 0xffff0000, v28
v_add_f32 v128, v128, v6
v_add_f32 v129, v129, v7
v_lshlrev_b32 v8, 16, v29
v_and_b32 v9, 0xffff0000, v29
v_add_f32 v130, v130, v8
v_add_f32 v131, v131, v9
v_lshlrev_b32 v6, 16, v30
v_and_b32 v7, 0xffff0000, v30
v_add_f32 v132, v132, v6
v_add_f32 v133, v133, v7
v_lshlrev_b32 v8, 16, v31
v_and_b32 v9, 0xffff0000, v31
v_add_f32 v134, v134, v8
v_add_f32 v135, v135, v9
s_waitcnt vmcnt(22)
v_lshlrev_b32 v6, 16, v40
v_and_b32 v7, 0xffff0000, v40
v_add_f32 v128, v128, v6
v_add_f32 v129, v129, v7
v_lshlrev_b32 v8, 16, v41
v_and_b32 v9, 0xffff0000, v41
v_add_f32 v130, v130, v8
v_add_f32 v131, v131, v9
v_lshlrev_b32 v6, 16, v42
v_and_b32 v7, 0xffff0000, v42
v_add_f32 v132, v132, v6
v_add_f32 v133, v133, v7
v_lshlrev_b32 v8, 16, v43
v_and_b32 v9, 0xffff0000, v43
v_add_f32 v134, v134, v8
v_add_f32 v135, v135, v9
s_waitcnt vmcnt(21)
v_lshlrev_b32 v6, 16, v52
v_and_b32 v7, 0xffff0000, v52
v_add_f32 v128, v128, v6
v_add_f32 v129, v129, v7
v_lshlrev_b32 v8, 16, v53
v_and_b32 v9, 0xffff0000, v53
v_add_f32 v130, v130, v8
v_add_f32 v131, v131, v9
v_lshlrev_b32 v6, 16, v54
v_and_b32 v7, 0xffff0000, v54
v_add_f32 v132, v132, v6
v_add_f32 v133, v133, v7
v_lshlrev_b32 v8, 16, v55
v_and_b32 v9, 0xffff0000, v55
v_add_f32 v134, v134, v8
v_add_f32 v135, v135, v9
s_waitcnt vmcnt(20)
v_lshlrev_b32 v6, 16, v64
v_and_b32 v7, 0xffff0000, v64
v_add_f32 v128, v128, v6
v_add_f32 v129, v129, v7
v_lshlrev_b32 v8, 16, v65
v_and_b32 v9, 0xffff0000, v65
v_add_f32 v130, v130, v8
v_add_f32 v131, v131, v9
v_lshlrev_b32 v6, 16, v66
v_and_b32 v7, 0xffff0000, v66
v_add_f32 v132, v132, v6
v_add_f32 v133, v133, v7
v_lshlrev_b32 v8, 16, v67
v_and_b32 v9, 0xffff0000, v67
v_add_f32 v134, v134, v8
v_add_f32 v135, v135, v9
s_waitcnt vmcnt(19)
v_lshlrev_b32 v6, 16, v76
v_and_b32 v7, 0xffff0000, v76
v_add_f32 v128, v128, v6
v_add_f32 v129, v129, v7
v_lshlrev_b32 v8, 16, v77
v_and_b32 v9, 0xffff0000, v77
v_add_f32 v130, v130, v8
v_add_f32 v131, v131, v9
v_lshlrev_b32 v6, 16, v78
v_and_b32 v7, 0xffff0000, v78
v_add_f32 v132, v132, v6
v_add_f32 v133, v133, v7
v_lshlrev_b32 v8, 16, v79
v_and_b32 v9, 0xffff0000, v79
v_add_f32 v134, v134, v8
v_add_f32 v135, v135, v9
s_waitcnt vmcnt(18)
v_lshlrev_b32 v6, 16, v88
v_and_b32 v7, 0xffff0000, v88
v_add_f32 v128, v128, v6
v_add_f32 v129, v129, v7
v_lshlrev_b32 v8, 16, v89
v_and_b32 v9, 0xffff0000, v89
v_add_f32 v130, v130, v8
v_add_f32 v131, v131, v9
v_lshlrev_b32 v6, 16, v90
v_and_b32 v7, 0xffff0000, v90
v_add_f32 v132, v132, v6
v_add_f32 v133, v133, v7
v_lshlrev_b32 v8, 16, v91
v_and_b32 v9, 0xffff0000, v91
v_add_f32 v134, v134, v8
v_add_f32 v135, v135, v9
s_waitcnt vmcnt(17)
v_lshlrev_b32 v6, 16, v100
v_and_b32 v7, 0xffff0000, v100
v_add_f32 v128, v128, v6
v_add_f32 v129, v129, v7
v_lshlrev_b32 v8, 16, v101
v_and_b32 v9, 0xffff0000, v101
v_add_f32 v130, v130, v8
v_add_f32 v131, v131, v9
v_lshlrev_b32 v6, 16, v102
v_and_b32 v7, 0xffff0000, v102
v_add_f32 v132, v132, v6
v_add_f32 v133, v133, v7
v_lshlrev_b32 v8, 16, v103
v_and_b32 v9, 0xffff0000, v103
v_add_f32 v134, v134, v8
v_add_f32 v135, v135, v9
s_waitcnt vmcnt(16)
v_lshlrev_b32 v6, 16, v112
v_and_b32 v7, 0xffff0000, v112
v_add_f32 v128, v128, v6
v_add_f32 v129, v129, v7
v_lshlrev_b32 v8, 16, v113
v_and_b32 v9, 0xffff0000, v113
v_add_f32 v130, v130, v8
v_add_f32 v131, v131, v9
v_lshlrev_b32 v6, 16, v114
v_and_b32 v7, 0xffff0000, v114
v_add_f32 v132, v132, v6
v_add_f32 v133, v133, v7
v_lshlrev_b32 v8, 16, v115
v_and_b32 v9, 0xffff0000, v115
v_add_f32 v134, v134, v8
v_add_f32 v135, v135, v9
s_waitcnt vmcnt(15)
v_lshlrev_b32 v6, 16, v32
v_and_b32 v7, 0xffff0000, v32
v_add_f32 v136, v136, v6
v_add_f32 v137, v137, v7
v_lshlrev_b32 v8, 16, v33
v_and_b32 v9, 0xffff0000, v33
v_add_f32 v138, v138, v8
v_add_f32 v139, v139, v9
v_lshlrev_b32 v6, 16, v34
v_and_b32 v7, 0xffff0000, v34
v_add_f32 v140, v140, v6
v_add_f32 v141, v141, v7
v_lshlrev_b32 v8, 16, v35
v_and_b32 v9, 0xffff0000, v35
v_add_f32 v142, v142, v8
v_add_f32 v143, v143, v9
s_waitcnt vmcnt(14)
v_lshlrev_b32 v6, 16, v44
v_and_b32 v7, 0xffff0000, v44
v_add_f32 v136, v136, v6
v_add_f32 v137, v137, v7
v_lshlrev_b32 v8, 16, v45
v_and_b32 v9, 0xffff0000, v45
v_add_f32 v138, v138, v8
v_add_f32 v139, v139, v9
v_lshlrev_b32 v6, 16, v46
v_and_b32 v7, 0xffff0000, v46
v_add_f32 v140, v140, v6
v_add_f32 v141, v141, v7
v_lshlrev_b32 v8, 16, v47
v_and_b32 v9, 0xffff0000, v47
v_add_f32 v142, v142, v8
v_add_f32 v143, v143, v9
s_waitcnt vmcnt(13)
v_lshlrev_b32 v6, 16, v56
v_and_b32 v7, 0xffff0000, v56
v_add_f32 v136, v136, v6
v_add_f32 v137, v137, v7
v_lshlrev_b32 v8, 16, v57
v_and_b32 v9, 0xffff0000, v57
v_add_f32 v138, v138, v8
v_add_f32 v139, v139, v9
v_lshlrev_b32 v6, 16, v58
v_and_b32 v7, 0xffff0000, v58
v_add_f32 v140, v140, v6
v_add_f32 v141, v141, v7
v_lshlrev_b32 v8, 16, v59
v_and_b32 v9, 0xffff0000, v59
v_add_f32 v142, v142, v8
v_add_f32 v143, v143, v9
s_waitcnt vmcnt(12)
v_lshlrev_b32 v6, 16, v68
v_and_b32 v7, 0xffff0000, v68
v_add_f32 v136, v136, v6
v_add_f32 v137, v137, v7
v_lshlrev_b32 v8, 16, v69
v_and_b32 v9, 0xffff0000, v69
v_add_f32 v138, v138, v8
v_add_f32 v139, v139, v9
v_lshlrev_b32 v6, 16, v70
v_and_b32 v7, 0xffff0000, v70
v_add_f32 v140, v140, v6
v_add_f32 v141, v141, v7
v_lshlrev_b32 v8, 16, v71
v_and_b32 v9, 0xffff0000, v71
v_add_f32 v142, v142, v8
v_add_f32 v143, v143, v9
s_waitcnt vmcnt(11)
v_lshlrev_b32 v6, 16, v80
v_and_b32 v7, 0xffff0000, v80
v_add_f32 v136, v136, v6
v_add_f32 v137, v137, v7
v_lshlrev_b32 v8, 16, v81
v_and_b32 v9, 0xffff0000, v81
v_add_f32 v138, v138, v8
v_add_f32 v139, v139, v9
v_lshlrev_b32 v6, 16, v82
v_and_b32 v7, 0xffff0000, v82
v_add_f32 v140, v140, v6
v_add_f32 v141, v141, v7
v_lshlrev_b32 v8, 16, v83
v_and_b32 v9, 0xffff0000, v83
v_add_f32 v142, v142, v8
v_add_f32 v143, v143, v9
s_waitcnt vmcnt(10)
v_lshlrev_b32 v6, 16, v92
v_and_b32 v7, 0xffff0000, v92
v_add_f32 v136, v136, v6
v_add_f32 v137, v137, v7
v_lshlrev_b32 v8, 16, v93
v_and_b32 v9, 0xffff0000, v93
v_add_f32 v138, v138, v8
v_add_f32 v139, v139, v9
v_lshlrev_b32 v6, 16, v94
v_and_b32 v7, 0xffff0000, v94
v_add_f32 v140, v140, v6
v_add_f32 v141, v141, v7
v_lshlrev_b32 v8, 16, v95
v_and_b32 v9, 0xffff0000, v95
v_add_f32 v142, v142, v8
v_add_f32 v143, v143, v9
s_waitcnt vmcnt(9)
v_lshlrev_b32 v6, 16, v104
v_and_b32 v7, 0xffff0000, v104
v_add_f32 v136, v136, v6
v_add_f32 v137, v137, v7
v_lshlrev_b32 v8, 16, v105
v_and_b32 v9, 0xffff0000, v105
v_add_f32 v138, v138, v8
v_add_f32 v139, v139, v9
v_lshlrev_b32 v6, 16, v106
v_and_b32 v7, 0xffff0000, v106
v_add_f32 v140, v140, v6
v_add_f32 v141, v141, v7
v_lshlrev_b32 v8, 16, v107
v_and_b32 v9, 0xffff0000, v107
v_add_f32 v142, v142, v8
v_add_f32 v143, v143, v9
s_waitcnt vmcnt(8)
v_lshlrev_b32 v6, 16, v116
v_and_b32 v7, 0xffff0000, v116
v_add_f32 v136, v136, v6
v_add_f32 v137, v137, v7
v_lshlrev_b32 v8, 16, v117
v_and_b32 v9, 0xffff0000, v117
v_add_f32 v138, v138, v8
v_add_f32 v139, v139, v9
v_lshlrev_b32 v6, 16, v118
v_and_b32 v7, 0xffff0000, v118
v_add_f32 v140, v140, v6
v_add_f32 v141, v141, v7
v_lshlrev_b32 v8, 16, v119
v_and_b32 v9, 0xffff0000, v119
L_hop11:
s_cmp_eq_u32 s15, 1
s_cbranch_scc1 L_hop_done
v_add_f32 v142, v142, v8
v_add_f32 v143, v143, v9
s_waitcnt vmcnt(7)
v_lshlrev_b32 v6, 16, v36
v_and_b32 v7, 0xffff0000, v36
v_add_f32 v144, v144, v6
v_add_f32 v145, v145, v7
v_lshlrev_b32 v8, 16, v37
v_and_b32 v9, 0xffff0000, v37
v_add_f32 v146, v146, v8
v_add_f32 v147, v147, v9
v_lshlrev_b32 v6, 16, v38
v_and_b32 v7, 0xffff0000, v38
v_add_f32 v148, v148, v6
v_add_f32 v149, v149, v7
v_lshlrev_b32 v8, 16, v39
v_and_b32 v9, 0xffff0000, v39
v_add_f32 v150, v150, v8
v_add_f32 v151, v151, v9
s_waitcnt vmcnt(6)
v_lshlrev_b32 v6, 16, v48
v_and_b32 v7, 0xffff0000, v48
v_add_f32 v144, v144, v6
v_add_f32 v145, v145, v7
v_lshlrev_b32 v8, 16, v49
v_and_b32 v9, 0xffff0000, v49
v_add_f32 v146, v146, v8
v_add_f32 v147, v147, v9
v_lshlrev_b32 v6, 16, v50
v_and_b32 v7, 0xffff0000, v50
v_add_f32 v148, v148, v6
v_add_f32 v149, v149, v7
v_lshlrev_b32 v8, 16, v51
v_and_b32 v9, 0xffff0000, v51
v_add_f32 v150, v150, v8
v_add_f32 v151, v151, v9
s_waitcnt vmcnt(5)
v_lshlrev_b32 v6, 16, v60
v_and_b32 v7, 0xffff0000, v60
v_add_f32 v144, v144, v6
v_add_f32 v145, v145, v7
v_lshlrev_b32 v8, 16, v61
v_and_b32 v9, 0xffff0000, v61
v_add_f32 v146, v146, v8
v_add_f32 v147, v147, v9
v_lshlrev_b32 v6, 16, v62
v_and_b32 v7, 0xffff0000, v62
v_add_f32 v148, v148, v6
v_add_f32 v149, v149, v7
v_lshlrev_b32 v8, 16, v63
v_and_b32 v9, 0xffff0000, v63
v_add_f32 v150, v150, v8
v_add_f32 v151, v151, v9
s_waitcnt vmcnt(4)
v_lshlrev_b32 v6, 16, v72
v_and_b32 v7, 0xffff0000, v72
v_add_f32 v144, v144, v6
v_add_f32 v145, v145, v7
v_lshlrev_b32 v8, 16, v73
v_and_b32 v9, 0xffff0000, v73
v_add_f32 v146, v146, v8
v_add_f32 v147, v147, v9
v_lshlrev_b32 v6, 16, v74
v_and_b32 v7, 0xffff0000, v74
v_add_f32 v148, v148, v6
v_add_f32 v149, v149, v7
v_lshlrev_b32 v8, 16, v75
v_and_b32 v9, 0xffff0000, v75
v_add_f32 v150, v150, v8
v_add_f32 v151, v151, v9
s_waitcnt vmcnt(3)
v_lshlrev_b32 v6, 16, v84
v_and_b32 v7, 0xffff0000, v84
v_add_f32 v144, v144, v6
v_add_f32 v145, v145, v7
v_lshlrev_b32 v8, 16, v85
v_and_b32 v9, 0xffff0000, v85
v_add_f32 v146, v146, v8
v_add_f32 v147, v147, v9
v_lshlrev_b32 v6, 16, v86
v_and_b32 v7, 0xffff0000, v86
v_add_f32 v148, v148, v6
v_add_f32 v149, v149, v7
v_lshlrev_b32 v8, 16, v87
v_and_b32 v9, 0xffff0000, v87
v_add_f32 v150, v150, v8
v_add_f32 v151, v151, v9
s_waitcnt vmcnt(2)
v_lshlrev_b32 v6, 16, v96
v_and_b32 v7, 0xffff0000, v96
v_add_f32 v144, v144, v6
v_add_f32 v145, v145, v7
v_lshlrev_b32 v8, 16, v97
v_and_b32 v9, 0xffff0000, v97
v_add_f32 v146, v146, v8
v_add_f32 v147, v147, v9
v_lshlrev_b32 v6, 16, v98
v_and_b32 v7, 0xffff0000, v98
v_add_f32 v148, v148, v6
v_add_f32 v149, v149, v7
v_lshlrev_b32 v8, 16, v99
v_and_b32 v9, 0xffff0000, v99
v_add_f32 v150, v150, v8
v_add_f32 v151, v151, v9
s_waitcnt vmcnt(1)
v_lshlrev_b32 v6, 16, v108
v_and_b32 v7, 0xffff0000, v108
v_add_f32 v144, v144, v6
v_add_f32 v145, v145, v7
v_lshlrev_b32 v8, 16, v109
v_and_b32 v9, 0xffff0000, v109
v_add_f32 v146, v146, v8
v_add_f32 v147, v147, v9
v_lshlrev_b32 v6, 16, v110
v_and_b32 v7, 0xffff0000, v110
v_add_f32 v148, v148, v6
v_add_f32 v149, v149, v7
v_lshlrev_b32 v8, 16, v111
v_and_b32 v9, 0xffff0000, v111
v_add_f32 v150, v150, v8
v_add_f32 v151, v151, v9
s_waitcnt vmcnt(0)
v_lshlrev_b32 v6, 16, v120
v_and_b32 v7, 0xffff0000, v120
v_add_f32 v144, v144, v6
v_add_f32 v145, v145, v7
v_lshlrev_b32 v8, 16, v121
v_and_b32 v9, 0xffff0000, v121
v_add_f32 v146, v146, v8
v_add_f32 v147, v147, v9
v_lshlrev_b32 v6, 16, v122
v_and_b32 v7, 0xffff0000, v122
v_add_f32 v148, v148, v6
v_add_f32 v149, v149, v7
v_lshlrev_b32 v8, 16, v123
v_and_b32 v9, 0xffff0000, v123
v_add_f32 v150, v150, v8
v_add_f32 v151, v151, v9
v_cvt_pk_bf16_f32 v152, v128, v129
v_cvt_pk_bf16_f32 v153, v130, v131
v_cvt_pk_bf16_f32 v154, v132, v133
v_cvt_pk_bf16_f32 v155, v134, v135
v_cvt_pk_bf16_f32 v156, v136, v137
v_cvt_pk_bf16_f32 v157, v138, v139
v_cvt_pk_bf16_f32 v158, v140, v141
v_cvt_pk_bf16_f32 v159, v142, v143
v_cvt_pk_bf16_f32 v160, v144, v145
v_cvt_pk_bf16_f32 v161, v146, v147
v_cvt_pk_bf16_f32 v162, v148, v149
v_cvt_pk_bf16_f32 v163, v150, v151
v_add_f32 v6, v128, v129
v_mul_f32 v7, v128, v128
v_mul_f32 v9, v129, v129
v_mov_b32 v8, 0
v_add_f32 v6, v6, v130
v_add_f32 v8, v8, v131
v_fmac_f32 v7, v130, v130
v_fmac_f32 v9, v131, v131
v_add_f32 v6, v6, v132
v_add_f32 v8, v8, v133
v_fmac_f32 v7, v132, v132
v_fmac_f32 v9, v133, v133
v_add_f32 v6, v6, v134
v_add_f32 v8, v8, v135
v_fmac_f32 v7, v134, v134
v_fmac_f32 v9, v135, v135
v_add_f32 v6, v6, v136
v_add_f32 v8, v8, v137
v_fmac_f32 v7, v136, v136
v_fmac_f32 v9, v137, v137
v_add_f32 v6, v6, v138
v_add_f32 v8, v8, v139
v_fmac_f32 v7, v138, v138
v_fmac_f32 v9, v139, v139
v_add_f32 v6, v6, v140
v_add_f32 v8, v8, v141
v_fmac_f32 v7, v140, v140
v_fmac_f32 v9, v141, v141
v_add_f32 v6, v6, v142
v_add_f32 v8, v8, v143
v_fmac_f32 v7, v142, v142
v_fmac_f32 v9, v143, v143
v_add_f32 v6, v6, v144
v_add_f32 v8, v8, v145
v_fmac_f32 v7, v144, v144
v_fmac_f32 v9, v145, v145
v_add_f32 v6, v6, v146
v_add_f32 v8, v8, v147
v_fmac_f32 v7, v146, v146
v_fmac_f32 v9, v147, v147
v_add_f32 v6, v6, v148
v_add_f32 v8, v8, v149
v_fmac_f32 v7, v148, v148
v_fmac_f32 v9, v149, v149
v_add_f32 v6, v6, v150
v_add_f32 v8, v8, v151
v_fmac_f32 v7, v150, v150
v_fmac_f32 v9, v151, v151
v_add_f32 v6, v6, v8
v_add_f32 v7, v7, v9
s_nop 0
v_add_f32_dpp v6, v6, v6 row_ror:8 row_mask:0xf bank_mask:0xf
v_add_f32_dpp v7, v7, v7 row_ror:8 row_mask:0xf bank_mask:0xf
v_mov_b32 v8, v6
v_mov_b32 v9, v7
s_nop 0
v_permlane16_swap_b32 v6, v8
v_permlane16_swap_b32 v7, v9
v_add_f32 v6, v6, v8
v_add_f32 v7, v7, v9
v_mov_b32 v8, v6
v_mov_b32 v9, v7
s_nop 0
v_permlane32_swap_b32 v6, v8
v_permlane32_swap_b32 v7, v9
v_add_f32 v6, v6, v8
v_add_f32 v7, v7, v9
v_and_b32 v10, 7, v1
v_lshlrev_b32 v10, 3, v10
v_add_u32 v10, 147456, v10
s_lshl_b32 s24, s4, 6
v_add_u32 v11, s24, v10
ds_write_b64 v11, v[6:7]
s_add_u32 s24, s28, 30048256
buffer_store_dwordx4 v[152:155], v4, s[8:11], s24 offen sc1
s_add_u32 s25, s29, 30048256
buffer_store_dwordx4 v[156:159], v4, s[8:11], s25 offen sc1
s_add_u32 s24, s30, 30048256
buffer_store_dwordx4 v[160:163], v4, s[8:11], s24 offen sc1
s_waitcnt lgkmcnt(0)
s_barrier
ds_read_b64 v[6:7], v10
ds_read_b64 v[8:9], v10 offset:64
ds_read_b64 v[12:13], v10 offset:128
s_waitcnt lgkmcnt(0)
v_add_f32 v6, v6, v8
v_add_f32 v7, v7, v9
v_add_f32 v6, v6, v12
v_add_f32 v7, v7, v13
v_mul_f32 v6, 0x3ae38e39, v6
v_mul_f32 v7, 0x3ae38e39, v7
v_fma_f32 v7, -v6, v6, v7
v_max_f32 v7, 0, v7
v_add_f32 v7, 0x3727c5ac, v7
v_rsq_f32 v7, v7
s_nop 0
v_mul_f32 v6, v6, v7
v_fma_f32 v128, v128, v7, -v6
v_fma_f32 v129, v129, v7, -v6
v_fma_f32 v130, v130, v7, -v6
v_fma_f32 v131, v131, v7, -v6
v_fma_f32 v132, v132, v7, -v6
v_fma_f32 v133, v133, v7, -v6
v_fma_f32 v134, v134, v7, -v6
v_fma_f32 v135, v135, v7, -v6
v_cvt_pk_bf16_f32 v168, v128, v129
v_cvt_pk_bf16_f32 v169, v130, v131
v_cvt_pk_bf16_f32 v170, v132, v133
v_cvt_pk_bf16_f32 v171, v134, v135
s_add_u32 s24, s28, 25329664
buffer_store_dwordx4 v[168:171], v4, s[8:11], s24 offen sc1
v_fma_f32 v136, v136, v7, -v6
v_fma_f32 v137, v137, v7, -v6
v_fma_f32 v138, v138, v7, -v6
v_fma_f32 v139, v139, v7, -v6
v_fma_f32 v140, v140, v7, -v6
v_fma_f32 v141, v141, v7, -v6
v_fma_f32 v142, v142, v7, -v6
v_fma_f32 v143, v143, v7, -v6
v_cvt_pk_bf16_f32 v172, v136, v137
v_cvt_pk_bf16_f32 v173, v138, v139
v_cvt_pk_bf16_f32 v174, v140, v141
v_cvt_pk_bf16_f32 v175, v142, v143
s_add_u32 s25, s29, 25329664
buffer_store_dwordx4 v[172:175], v4, s[8:11], s25 offen sc1
v_fma_f32 v144, v144, v7, -v6
v_fma_f32 v145, v145, v7, -v6
v_fma_f32 v146, v146, v7, -v6
v_fma_f32 v147, v147, v7, -v6
v_fma_f32 v148, v148, v7, -v6
v_fma_f32 v149, v149, v7, -v6
v_fma_f32 v150, v150, v7, -v6
v_fma_f32 v151, v151, v7, -v6
v_cvt_pk_bf16_f32 v176, v144, v145
v_cvt_pk_bf16_f32 v177, v146, v147
v_cvt_pk_bf16_f32 v178, v148, v149
v_cvt_pk_bf16_f32 v179, v150, v151
s_add_u32 s24, s30, 25329664
buffer_store_dwordx4 v[176:179], v4, s[8:11], s24 offen sc1
s_lshl_b32 s24, s5, 5
s_add_u32 s24, s24, s6
s_lshl_b32 s14, s24, 7
s_add_u32 s14, s14, 1835008
s_branch L_r_done
L_r_side:
v_mov_b32 v13, 2146435072
v_cmp_gt_u32 vcc, 16, v0
v_lshlrev_b32 v14, 3, v0
s_nop 0
v_cndmask_b32 v13, v13, v14, vcc
v_mov_b32 v14, s68
v_mov_b32 v15, s69
s_waitcnt vmcnt(0)
s_barrier
buffer_store_dwordx2 v[14:15], v13, s[8:11], s14 offen sc1
s_lshr_b32 s20, s5, 2
s_lshl_b32 s20, s20, 3
s_lshr_b32 s21, s6, 2
s_add_u32 s20, s20, s21
s_and_b32 s21, s5, 3
s_lshl_b32 s21, s21, 2
s_and_b32 s22, s6, 3
s_add_u32 s21, s21, s22
s_mul_i32 s32, s21, 129024
s_add_u32 s32, s32, 4198400
s_mul_i32 s33, s4, 0
s_add_u32 s32, s32, s33
s_add_u32 m0, s33, 0
s_add_u32 s40, s32, 0
buffer_load_dwordx4 v2, s[8:11], s40 offen offset:0 sc1 lds
buffer_load_dwordx4 v2, s[8:11], s40 offen offset:1024 sc1 lds
buffer_load_dwordx4 v2, s[8:11], s40 offen offset:2048 sc1 lds
buffer_load_dwordx4 v2, s[8:11], s40 offen offset:3072 sc1 lds
s_add_u32 m0, s33, 4096
s_add_u32 s40, s32, 4096
buffer_load_dwordx4 v2, s[8:11], s40 offen offset:0 sc1 lds
buffer_load_dwordx4 v2, s[8:11], s40 offen offset:1024 sc1 lds
buffer_load_dwordx4 v2, s[8:11], s40 offen offset:2048 sc1 lds
buffer_load_dwordx4 v2, s[8:11], s40 offen offset:3072 sc1 lds
s_add_u32 m0, s33, 8192
s_add_u32 s40, s32, 8192
buffer_load_dwordx4 v2, s[8:11], s40 offen offset:0 sc1 lds
buffer_load_dwordx4 v2, s[8:11], s40 offen offset:1024 sc1 lds
buffer_load_dwordx4 v2, s[8:11], s40 offen offset:2048 sc1 lds
buffer_load_dwordx4 v2, s[8:11], s40 offen offset:3072 sc1 lds
s_add_u32 m0, s33, 12288
s_add_u32 s40, s32, 12288
buffer_load_dwordx4 v2, s[8:11], s40 offen offset:0 sc1 lds
buffer_load_dwordx4 v2, s[8:11], s40 offen offset:1024 sc1 lds
buffer_load_dwordx4 v2, s[8:11], s40 offen offset:2048 sc1 lds
buffer_load_dwordx4 v2, s[8:11], s40 offen offset:3072 sc1 lds
s_add_u32 m0, s33, 16384
s_add_u32 s40, s32, 16384
buffer_load_dwordx4 v2, s[8:11], s40 offen offset:0 sc1 lds
buffer_load_dwordx4 v2, s[8:11], s40 offen offset:1024 sc1 lds
buffer_load_dwordx4 v2, s[8:11], s40 offen offset:2048 sc1 lds
buffer_load_dwordx4 v2, s[8:11], s40 offen offset:3072 sc1 lds
s_add_u32 m0, s33, 20480
s_add_u32 s40, s32, 20480
buffer_load_dwordx4 v2, s[8:11], s40 offen offset:0 sc1 lds
buffer_load_dwordx4 v2, s[8:11], s40 offen offset:1024 sc1 lds
buffer_load_dwordx4 v2, s[8:11], s40 offen offset:2048 sc1 lds
buffer_load_dwordx4 v2, s[8:11], s40 offen offset:3072 sc1 lds
s_add_u32 m0, s33, 24576
s_add_u32 s40, s32, 24576
buffer_load_dwordx4 v2, s[8:11], s40 offen offset:0 sc1 lds
buffer_load_dwordx4 v2, s[8:11], s40 offen offset:1024 sc1 lds
buffer_load_dwordx4 v2, s[8:11], s40 offen offset:2048 sc1 lds
buffer_load_dwordx4 v2, s[8:11], s40 offen offset:3072 sc1 lds
s_add_u32 m0, s33, 28672
s_add_u32 s40, s32, 28672
buffer_load_dwordx4 v2, s[8:11], s40 offen offset:0 sc1 lds
buffer_load_dwordx4 v2, s[8:11], s40 offen offset:1024 sc1 lds
buffer_load_dwordx4 v2, s[8:11], s40 offen offset:2048 sc1 lds
buffer_load_dwordx4 v2, s[8:11], s40 offen offset:3072 sc1 lds
s_add_u32 m0, s33, 32768
s_add_u32 s40, s32, 32768
buffer_load_dwordx4 v2, s[8:11], s40 offen offset:0 sc1 lds
buffer_load_dwordx4 v2, s[8:11], s40 offen offset:1024 sc1 lds
buffer_load_dwordx4 v2, s[8:11], s40 offen offset:2048 sc1 lds
buffer_load_dwordx4 v2, s[8:11], s40 offen offset:3072 sc1 lds
s_add_u32 m0, s33, 36864
s_add_u32 s40, s32, 36864
buffer_load_dwordx4 v2, s[8:11], s40 offen offset:0 sc1 lds
buffer_load_dwordx4 v2, s[8:11], s40 offen offset:1024 sc1 lds
buffer_load_dwordx4 v2, s[8:11], s40 offen offset:2048 sc1 lds
buffer_load_dwordx4 v2, s[8:11], s40 offen offset:3072 sc1 lds
s_add_u32 m0, s33, 40960
s_add_u32 s40, s32, 40960
buffer_load_dwordx4 v2, s[8:11], s40 offen offset:0 sc1 lds
buffer_load_dwordx4 v2, s[8:11], s40 offen offset:1024 sc1 lds
buffer_load_dwordx4 v2, s[8:11], s40 offen offset:2048 sc1 lds
buffer_load_dwordx4 v2, s[8:11], s40 offen offset:3072 sc1 lds
s_add_u32 m0, s33, 45056
s_add_u32 s40, s32, 45056
buffer_load_dwordx4 v2, s[8:11], s40 offen offset:0 sc1 lds
buffer_load_dwordx4 v2, s[8:11], s40 offen offset:1024 sc1 lds
buffer_load_dwordx4 v2, s[8:11], s40 offen offset:2048 sc1 lds
buffer_load_dwordx4 v2, s[8:11], s40 offen offset:3072 sc1 lds
s_add_u32 m0, s33, 49152
s_add_u32 s40, s32, 49152
buffer_load_dwordx4 v2, s[8:11], s40 offen offset:0 sc1 lds
buffer_load_dwordx4 v2, s[8:11], s40 offen offset:1024 sc1 lds
buffer_load_dwordx4 v2, s[8:11], s40 offen offset:2048 sc1 lds
buffer_load_dwordx4 v2, s[8:11], s40 offen offset:3072 sc1 lds
s_add_u32 m0, s33, 53248
s_add_u32 s40, s32, 53248
buffer_load_dwordx4 v2, s[8:11], s40 offen offset:0 sc1 lds
buffer_load_dwordx4 v2, s[8:11], s40 offen offset:1024 sc1 lds
buffer_load_dwordx4 v2, s[8:11], s40 offen offset:2048 sc1 lds
buffer_load_dwordx4 v2, s[8:11], s40 offen offset:3072 sc1 lds
s_add_u32 m0, s33, 57344
s_add_u32 s40, s32, 57344
buffer_load_dwordx4 v2, s[8:11], s40 offen offset:0 sc1 lds
buffer_load_dwordx4 v2, s[8:11], s40 offen offset:1024 sc1 lds
buffer_load_dwordx4 v2, s[8:11], s40 offen offset:2048 sc1 lds
buffer_load_dwordx4 v2, s[8:11], s40 offen offset:3072 sc1 lds
s_add_u32 m0, s33, 61440
s_add_u32 s40, s32, 61440
buffer_load_dwordx4 v2, s[8:11], s40 offen offset:0 sc1 lds
buffer_load_dwordx4 v2, s[8:11], s40 offen offset:1024 sc1 lds
buffer_load_dwordx4 v2, s[8:11], s40 offen offset:2048 sc1 lds
buffer_load_dwordx4 v2, s[8:11], s40 offen offset:3072 sc1 lds
s_add_u32 m0, s33, 65536
s_add_u32 s40, s32, 65536
buffer_load_dwordx4 v2, s[8:11], s40 offen offset:0 sc1 lds
buffer_load_dwordx4 v2, s[8:11], s40 offen offset:1024 sc1 lds
buffer_load_dwordx4 v2, s[8:11], s40 offen offset:2048 sc1 lds
buffer_load_dwordx4 v2, s[8:11], s40 offen offset:3072 sc1 lds
s_add_u32 m0, s33, 69632
s_add_u32 s40, s32, 69632
buffer_load_dwordx4 v2, s[8:11], s40 offen offset:0 sc1 lds
buffer_load_dwordx4 v2, s[8:11], s40 offen offset:1024 sc1 lds
buffer_load_dwordx4 v2, s[8:11], s40 offen offset:2048 sc1 lds
buffer_load_dwordx4 v2, s[8:11], s40 offen offset:3072 sc1 lds
s_add_u32 m0, s33, 73728
s_add_u32 s40, s32, 73728
buffer_load_dwordx4 v2, s[8:11], s40 offen offset:0 sc1 lds
buffer_load_dwordx4 v2, s[8:11], s40 offen offset:1024 sc1 lds
buffer_load_dwordx4 v2, s[8:11], s40 offen offset:2048 sc1 lds
buffer_load_dwordx4 v2, s[8:11], s40 offen offset:3072 sc1 lds
s_add_u32 m0, s33, 77824
s_add_u32 s40, s32, 77824
buffer_load_dwordx4 v2, s[8:11], s40 offen offset:0 sc1 lds
buffer_load_dwordx4 v2, s[8:11], s40 offen offset:1024 sc1 lds
buffer_load_dwordx4 v2, s[8:11], s40 offen offset:2048 sc1 lds
buffer_load_dwordx4 v2, s[8:11], s40 offen offset:3072 sc1 lds
s_add_u32 m0, s33, 81920
s_add_u32 s40, s32, 81920
buffer_load_dwordx4 v2, s[8:11], s40 offen offset:0 sc1 lds
buffer_load_dwordx4 v2, s[8:11], s40 offen offset:1024 sc1 lds
buffer_load_dwordx4 v2, s[8:11], s40 offen offset:2048 sc1 lds
buffer_load_dwordx4 v2, s[8:11], s40 offen offset:3072 sc1 lds
s_add_u32 m0, s33, 86016
s_add_u32 s40, s32, 86016
buffer_load_dwordx4 v2, s[8:11], s40 offen offset:0 sc1 lds
buffer_load_dwordx4 v2, s[8:11], s40 offen offset:1024 sc1 lds
buffer_load_dwordx4 v2, s[8:11], s40 offen offset:2048 sc1 lds
buffer_load_dwordx4 v2, s[8:11], s40 offen offset:3072 sc1 lds
s_add_u32 m0, s33, 90112
s_add_u32 s40, s32, 90112
buffer_load_dwordx4 v2, s[8:11], s40 offen offset:0 sc1 lds
buffer_load_dwordx4 v2, s[8:11], s40 offen offset:1024 sc1 lds
buffer_load_dwordx4 v2, s[8:11], s40 offen offset:2048 sc1 lds
buffer_load_dwordx4 v2, s[8:11], s40 offen offset:3072 sc1 lds
s_add_u32 m0, s33, 94208
s_add_u32 s40, s32, 94208
buffer_load_dwordx4 v2, s[8:11], s40 offen offset:0 sc1 lds
buffer_load_dwordx4 v2, s[8:11], s40 offen offset:1024 sc1 lds
buffer_load_dwordx4 v2, s[8:11], s40 offen offset:2048 sc1 lds
buffer_load_dwordx4 v2, s[8:11], s40 offen offset:3072 sc1 lds
s_add_u32 m0, s33, 98304
s_add_u32 s40, s32, 98304
buffer_load_dwordx4 v2, s[8:11], s40 offen offset:0 sc1 lds
buffer_load_dwordx4 v2, s[8:11], s40 offen offset:1024 sc1 lds
buffer_load_dwordx4 v2, s[8:11], s40 offen offset:2048 sc1 lds
buffer_load_dwordx4 v2, s[8:11], s40 offen offset:3072 sc1 lds
s_add_u32 m0, s33, 102400
s_add_u32 s40, s32, 102400
buffer_load_dwordx4 v2, s[8:11], s40 offen offset:0 sc1 lds
buffer_load_dwordx4 v2, s[8:11], s40 offen offset:1024 sc1 lds
buffer_load_dwordx4 v2, s[8:11], s40 offen offset:2048 sc1 lds
buffer_load_dwordx4 v2, s[8:11], s40 offen offset:3072 sc1 lds
s_add_u32 m0, s33, 106496
s_add_u32 s40, s32, 106496
buffer_load_dwordx4 v2, s[8:11], s40 offen offset:0 sc1 lds
buffer_load_dwordx4 v2, s[8:11], s40 offen offset:1024 sc1 lds
buffer_load_dwordx4 v2, s[8:11], s40 offen offset:2048 sc1 lds
buffer_load_dwordx4 v2, s[8:11], s40 offen offset:3072 sc1 lds
s_add_u32 m0, s33, 110592
s_add_u32 s40, s32, 110592
buffer_load_dwordx4 v2, s[8:11], s40 offen offset:0 sc1 lds
buffer_load_dwordx4 v2, s[8:11], s40 offen offset:1024 sc1 lds
buffer_load_dwordx4 v2, s[8:11], s40 offen offset:2048 sc1 lds
buffer_load_dwordx4 v2, s[8:11], s40 offen offset:3072 sc1 lds
s_add_u32 m0, s33, 114688
s_add_u32 s40, s32, 114688
buffer_load_dwordx4 v2, s[8:11], s40 offen offset:0 sc1 lds
buffer_load_dwordx4 v2, s[8:11], s40 offen offset:1024 sc1 lds
buffer_load_dwordx4 v2, s[8:11], s40 offen offset:2048 sc1 lds
buffer_load_dwordx4 v2, s[8:11], s40 offen offset:3072 sc1 lds
s_add_u32 m0, s33, 118784
s_add_u32 s40, s32, 118784
buffer_load_dwordx4 v2, s[8:11], s40 offen offset:0 sc1 lds
buffer_load_dwordx4 v2, s[8:11], s40 offen offset:1024 sc1 lds
buffer_load_dwordx4 v2, s[8:11], s40 offen offset:2048 sc1 lds
buffer_load_dwordx4 v2, s[8:11], s40 offen offset:3072 sc1 lds
s_add_u32 m0, s33, 122880
s_add_u32 s40, s32, 122880
buffer_load_dwordx4 v2, s[8:11], s40 offen offset:0 sc1 lds
buffer_load_dwordx4 v2, s[8:11], s40 offen offset:1024 sc1 lds
buffer_load_dwordx4 v2, s[8:11], s40 offen offset:2048 sc1 lds
buffer_load_dwordx4 v2, s[8:11], s40 offen offset:3072 sc1 lds
s_add_u32 m0, s33, 126976
s_add_u32 s40, s32, 126976
buffer_load_dwordx4 v2, s[8:11], s40 offen offset:0 sc1 lds
buffer_load_dwordx4 v2, s[8:11], s40 offen offset:1024 sc1 lds
s_barrier
L_r_done:
s_mov_b32 s70, 25329664
s_mov_b32 s71, 30048256
s_mov_b32 s72, 34766848
s_mov_b32 s73, 39485440
s_mov_b32 s74, 41975808
s_mov_b32 s75, 60981248
s_mov_b32 s76, 98729984
s_mov_b32 s77, 1048576
s_mov_b32 s7, 1
s_lshr_b32 s20, s5, 2
s_lshl_b32 s20, s20, 3
s_lshr_b32 s21, s6, 2
s_add_u32 s20, s20, s21
s_and_b32 s21, s5, 3
s_lshl_b32 s21, s21, 2
s_and_b32 s22, s6, 3
s_add_u32 s21, s21, s22
s_lshl_b32 s24, s20, 3
s_sub_u32 s25, s24, 1
s_max_i32 s35, s25, 0
s_mul_i32 s25, s35, 18432
s_lshl_b32 s26, s4, 1
s_add_u32 s36, s24, s26
s_mul_i32 s24, s36, 18432
s_add_u32 s26, s24, s70
s_add_u32 s27, s26, 18432
s_add_u32 s28, s25, s70
v_add_u32 v4, 0x10000, v2
v_add_u32 v5, 0x20000, v2
s_cmp_eq_u32 s4, 3
s_cselect_b32 s29, 0, s4
s_cselect_b32 s31, 16, 9
s_lshl_b32 s30, s29, 10
v_and_b32 v12, 15, v1
v_mov_b32 v13, 2146435072
v_cmp_le_u32 vcc, s31, v12
s_nop 1
v_cndmask_b32 v3, v13, v2, vcc
s_add_u32 s31, s30, 2048
v_add_u32 v6, s31, v2
v_add_u32 v7, s31, v4
v_add_u32 v8, s31, v5
s_and_b32 s30, s30, 1024
s_add_u32 s31, s30, 5120
v_add_u32 v9, s31, v2
v_add_u32 v10, s31, v4
v_add_u32 v11, s31, v5
s_lshl_b32 s22, s36, 1
s_lshl_b32 s23, s35, 1
s_add_u32 s23, s23, 1
v_and_b32 v16, 3, v1
v_add_u32 v16, s22, v16
v_mov_b32 v17, s23
v_cmp_eq_u32 vcc, 4, v1
s_nop 1
v_cndmask_b32 v16, v16, v17, vcc
v_lshlrev_b32 v16, 7, v16
s_add_u32 s22, s77, 786432
v_mov_b32 v13, 2146435072
v_cmp_gt_u32 vcc, 16, v0
v_lshlrev_b32 v14, 3, v0
s_nop 0
v_cndmask_b32 v13, v13, v14, vcc
v_mov_b32 v14, s68
v_mov_b32 v15, s69
s_waitcnt vmcnt(0)
s_barrier
buffer_store_dwordx2 v[14:15], v13, s[8:11], s14 offen sc1
s_mov_b32 s52, 0
L_poll7:
buffer_load_dwordx2 v[14:15], v16, s[8:11], s22 offen sc1
s_add_u32 s52, s52, 1
s_waitcnt vmcnt(0)
v_cmp_ne_u64 vcc, s[68:69], v[14:15]
s_cmp_ge_u32 s52, 1048576
s_cbranch_scc1 L_got7
s_and_b64 exec, exec, vcc
s_cbranch_execnz L_poll7
L_got7:
s_mov_b64 exec, -1
buffer_load_dwordx4 a[0:3], v2, s[8:11], s26 offen offset:0 sc1
buffer_load_dwordx4 a[72:75], v2, s[8:11], s27 offen offset:0 sc1
buffer_load_dwordx4 a[144:147], v3, s[8:11], s28 offen offset:0 sc1
buffer_load_dwordx4 a[4:7], v2, s[8:11], s26 offen offset:1024 sc1
buffer_load_dwordx4 a[76:79], v2, s[8:11], s27 offen offset:1024 sc1
buffer_load_dwordx4 a[148:151], v3, s[8:11], s28 offen offset:1024 sc1
buffer_load_dwordx4 a[8:11], v2, s[8:11], s26 offen offset:2048 sc1
buffer_load_dwordx4 a[80:83], v2, s[8:11], s27 offen offset:2048 sc1
buffer_load_dwordx4 a[152:155], v3, s[8:11], s28 offen offset:2048 sc1
buffer_load_dwordx4 a[12:15], v2, s[8:11], s26 offen offset:3072 sc1
buffer_load_dwordx4 a[84:87], v2, s[8:11], s27 offen offset:3072 sc1
buffer_load_dwordx4 a[156:159], v3, s[8:11], s28 offen offset:3072 sc1
s_add_u32 s26, s26, 4096
s_add_u32 s27, s27, 4096
s_add_u32 s28, s28, 4096
buffer_load_dwordx4 a[16:19], v2, s[8:11], s26 offen offset:0 sc1
buffer_load_dwordx4 a[88:91], v2, s[8:11], s27 offen offset:0 sc1
buffer_load_dwordx4 a[160:163], v3, s[8:11], s28 offen offset:0 sc1
buffer_load_dwordx4 a[20:23], v2, s[8:11], s26 offen offset:1024 sc1
buffer_load_dwordx4 a[92:95], v2, s[8:11], s27 offen offset:1024 sc1
buffer_load_dwordx4 a[164:167], v3, s[8:11], s28 offen offset:1024 sc1
buffer_load_dwordx4 a[24:27], v2, s[8:11], s26 offen offset:2048 sc1
buffer_load_dwordx4 a[96:99], v2, s[8:11], s27 offen offset:2048 sc1
buffer_load_dwordx4 a[168:171], v3, s[8:11], s28 offen offset:2048 sc1
buffer_load_dwordx4 a[28:31], v2, s[8:11], s26 offen offset:3072 sc1
buffer_load_dwordx4 a[100:103], v2, s[8:11], s27 offen offset:3072 sc1
buffer_load_dwordx4 a[172:175], v3, s[8:11], s28 offen offset:3072 sc1
v_lshrrev_b32 v13, 4, v1
v_lshlrev_b32 v14, 2, v13
v_sub_u32 v14, v12, v14
v_subrev_u32 v15, 0, v14
v_cmp_gt_u32 s[52:53], 8, v15
v_cmp_gt_i32 s[44:45], -8, v15
v_subrev_u32 v15, 1, v14
v_cmp_gt_u32 s[54:55], 8, v15
v_cmp_gt_i32 s[46:47], -8, v15
v_subrev_u32 v15, 2, v14
v_cmp_gt_u32 s[56:57], 8, v15
v_cmp_gt_i32 s[48:49], -8, v15
v_subrev_u32 v15, 3, v14
v_cmp_gt_u32 s[58:59], 8, v15
v_cmp_gt_i32 s[50:51], -8, v15
s_and_b32 s31, s20, 7
s_or_b32 s31, s31, s4
s_cmp_eq_u32 s31, 0
s_cselect_b64 s[60:61], 0, s[44:45]
s_cselect_b64 s[62:63], 0, s[46:47]
s_cselect_b64 s[64:65], 0, s[48:49]
s_cselect_b64 s[66:67], 0, s[50:51]
ds_read_b128 a[216:219], v2 offset:0
ds_read_b128 a[220:223], v2 offset:7168
ds_read_b128 a[224:227], v2 offset:1024
ds_read_b128 a[228:231], v2 offset:8192
ds_read_b128 a[232:235], v2 offset:2048
ds_read_b128 a[236:239], v2 offset:9216
s_waitcnt vmcnt(18)
s_waitcnt lgkmcnt(4)
v_mfma_f32_16x16x32_bf16 v[32:35], a[216:219], a[0:3], 0
s_add_u32 s26, s26, 4096
s_add_u32 s27, s27, 4096
s_add_u32 s28, s28, 4096
buffer_load_dwordx4 a[32:35], v2, s[8:11], s26 offen offset:0 sc1
v_mfma_f32_16x16x32_bf16 v[32:35], a[220:223], a[4:7], v[32:35]
ds_read_b128 a[240:243], v2 offset:3072
v_lshlrev_b32 v14, 3, v1
v_mfma_f32_16x16x32_bf16 v[36:39], a[216:219], a[72:75], 0
s_mul_i32 s31, s4, 3072
s_add_u32 s41, s31, 147456
L_hop12:
s_cmp_eq_u32 s15, 1
s_cbranch_scc1 L_hop_done
v_mfma_f32_16x16x32_bf16 v[36:39], a[220:223], a[76:79], v[36:39]
ds_read_b128 a[244:247], v2 offset:10240
s_waitcnt lgkmcnt(4)
v_mfma_f32_16x16x32_bf16 v[40:43], a[224:227], a[0:3], 0
buffer_load_dwordx4 a[104:107], v2, s[8:11], s27 offen offset:0 sc1
v_mfma_f32_16x16x32_bf16 v[40:43], a[228:231], a[4:7], v[40:43]
ds_read_b128 a[216:219], v2 offset:4096
v_add_u32 v15, s41, v14
v_mfma_f32_16x16x32_bf16 v[44:47], a[224:227], a[72:75], 0
s_lshl_b32 s42, s29, 9
s_add_u32 s42, s42, 147456
v_mfma_f32_16x16x32_bf16 v[44:47], a[228:231], a[76:79], v[44:47]
ds_read_b128 a[220:223], v2 offset:11264
s_waitcnt lgkmcnt(4)
v_mfma_f32_16x16x32_bf16 v[48:51], a[232:235], a[0:3], 0
buffer_load_dwordx4 a[176:179], v3, s[8:11], s28 offen offset:0 sc1
v_mfma_f32_16x16x32_bf16 v[48:51], a[236:239], a[4:7], v[48:51]
ds_read_b128 a[224:227], v2 offset:5120
v_add_u32 v16, s42, v14
v_mfma_f32_16x16x32_bf16 v[52:55], a[232:235], a[72:75], 0
s_and_b32 s42, s42, 512
s_add_u32 s42, s42, 147456
v_mfma_f32_16x16x32_bf16 v[52:55], a[236:239], a[76:79], v[52:55]
ds_read_b128 a[228:231], v2 offset:12288
s_waitcnt lgkmcnt(4)
v_mfma_f32_16x16x32_bf16 v[56:59], a[240:243], a[0:3], 0
buffer_load_dwordx4 a[36:39], v2, s[8:11], s26 offen offset:1024 sc1
v_mfma_f32_16x16x32_bf16 v[56:59], a[244:247], a[4:7], v[56:59]
ds_read_b128 a[232:235], v2 offset:6144
v_add_u32 v19, s42, v14
v_mfma_f32_16x16x32_bf16 v[60:63], a[240:243], a[72:75], 0
v_add_u32 v18, 150016, v14
v_mov_b32 v96, 0
v_mfma_f32_16x16x32_bf16 v[60:63], a[244:247], a[76:79], v[60:63]
ds_read_b128 a[236:239], v2 offset:13312
s_waitcnt lgkmcnt(4)
v_mfma_f32_16x16x32_bf16 v[64:67], a[216:219], a[0:3], 0
buffer_load_dwordx4 a[108:111], v2, s[8:11], s27 offen offset:1024 sc1
v_mfma_f32_16x16x32_bf16 v[64:67], a[220:223], a[4:7], v[64:67]
ds_read_b128 a[240:243], v6 offset:0
v_mov_b32 v97, 0
v_mfma_f32_16x16x32_bf16 v[68:71], a[216:219], a[72:75], 0
v_mov_b32 v100, 0
v_mov_b32 v101, 0
v_mfma_f32_16x16x32_bf16 v[68:71], a[220:223], a[76:79], v[68:71]
ds_read_b128 a[244:247], v6 offset:7168
s_waitcnt lgkmcnt(4)
v_mfma_f32_16x16x32_bf16 v[72:75], a[0:3], a[224:227], 0
buffer_load_dwordx4 a[180:183], v3, s[8:11], s28 offen offset:1024 sc1
v_mfma_f32_16x16x32_bf16 v[72:75], a[4:7], a[228:231], v[72:75]
ds_read_b128 a[216:219], v9 offset:0
v_and_b32 v13, 1, v1
v_mfma_f32_16x16x32_bf16 v[76:79], a[72:75], a[224:227], 0
v_lshlrev_b32 v13, 4, v13
v_mov_b32 v102, 0x3f80
v_mfma_f32_16x16x32_bf16 v[76:79], a[76:79], a[228:231], v[76:79]
ds_read_b128 a[220:223], v9 offset:7168
s_waitcnt lgkmcnt(4)
v_mfma_f32_16x16x32_bf16 v[80:83], a[0:3], a[232:235], 0
buffer_load_dwordx4 a[40:43], v2, s[8:11], s26 offen offset:2048 sc1
v_mfma_f32_16x16x32_bf16 v[80:83], a[4:7], a[236:239], v[80:83]
ds_read_b128 a[224:227], v2 offset:14336
v_lshlrev_b32 v13, v13, v102
v_mfma_f32_16x16x32_bf16 v[84:87], a[72:75], a[232:235], 0
v_lshrrev_b32 v102, 1, v1
v_cmp_eq_u32 vcc, 16, v102
v_mfma_f32_16x16x32_bf16 v[84:87], a[76:79], a[236:239], v[84:87]
ds_read_b128 a[228:231], v2 offset:21504
s_waitcnt lgkmcnt(4)
v_mfma_f32_16x16x32_bf16 v[88:91], a[240:243], a[144:147], 0
ds_read_b128 a[232:235], v2 offset:15360
buffer_load_dwordx4 a[112:115], v2, s[8:11], s27 offen offset:2048 sc1
v_mfma_f32_16x16x32_bf16 v[88:91], a[244:247], a[148:151], v[88:91]
ds_read_b128 a[236:239], v2 offset:22528
s_waitcnt lgkmcnt(4)
v_mfma_f32_16x16x32_bf16 v[92:95], a[144:147], a[216:219], 0
ds_read_b128 a[240:243], v2 offset:16384
v_cndmask_b32 v98, 0, v13, vcc
v_mfma_f32_16x16x32_bf16 v[92:95], a[148:151], a[220:223], v[92:95]
ds_read_b128 a[244:247], v2 offset:23552
s_waitcnt vmcnt(20)
s_waitcnt lgkmcnt(4)
v_mfma_f32_16x16x32_bf16 v[32:35], a[224:227], a[8:11], v[32:35]
buffer_load_dwordx4 a[184:187], v3, s[8:11], s28 offen offset:2048 sc1
v_mfma_f32_16x16x32_bf16 v[32:35], a[228:231], a[12:15], v[32:35]
ds_read_b128 a[216:219], v2 offset:17408
v_cmp_eq_u32 vcc, 17, v102
v_mfma_f32_16x16x32_bf16 v[36:39], a[224:227], a[80:83], v[36:39]
s_nop 0
v_cndmask_b32 v99, 0, v13, vcc
v_add_u32 v17, 16, v12
v_mfma_f32_16x16x32_bf16 v[36:39], a[228:231], a[84:87], v[36:39]
ds_read_b128 a[220:223], v2 offset:24576
s_waitcnt lgkmcnt(4)
v_mfma_f32_16x16x32_bf16 v[40:43], a[232:235], a[8:11], v[40:43]
buffer_load_dwordx4 a[44:47], v2, s[8:11], s26 offen offset:3072 sc1
v_mfma_f32_16x16x32_bf16 v[40:43], a[236:239], a[12:15], v[40:43]
ds_read_b128 a[224:227], v2 offset:18432
v_cmp_gt_u32 vcc, 16, v1
v_mfma_f32_16x16x32_bf16 v[44:47], a[232:235], a[80:83], v[44:47]
v_add_u32 v14, 48, v12
s_mov_b32 s34, 0x3eae1a93
v_mfma_f32_16x16x32_bf16 v[44:47], a[236:239], a[84:87], v[44:47]
ds_read_b128 a[228:231], v2 offset:25600
s_waitcnt lgkmcnt(4)
v_mfma_f32_16x16x32_bf16 v[48:51], a[240:243], a[8:11], v[48:51]
buffer_load_dwordx4 a[116:119], v2, s[8:11], s27 offen offset:3072 sc1
v_mfma_f32_16x16x32_bf16 v[48:51], a[244:247], a[12:15], v[48:51]
ds_read_b128 a[232:235], v2 offset:19456
v_cndmask_b32 v17, v14, v17, vcc
v_mfma_f32_16x16x32_bf16 v[52:55], a[240:243], a[80:83], v[52:55]
v_lshlrev_b32 v17, 3, v17
v_add_u32 v17, s41, v17
v_mfma_f32_16x16x32_bf16 v[52:55], a[244:247], a[84:87], v[52:55]
ds_read_b128 a[236:239], v2 offset:26624
s_waitcnt lgkmcnt(4)
v_mfma_f32_16x16x32_bf16 v[56:59], a[216:219], a[8:11], v[56:59]
buffer_load_dwordx4 a[188:191], v3, s[8:11], s28 offen offset:3072 sc1
v_mfma_f32_16x16x32_bf16 v[56:59], a[220:223], a[12:15], v[56:59]
ds_read_b128 a[240:243], v2 offset:20480
v_mov_b32 v103, 0xff61b1e6
v_mfma_f32_16x16x32_bf16 v[60:63], a[216:219], a[80:83], v[60:63]
v_mov_b32 v102, 0xffff
v_cndmask_b32 v172, v103, 0, s[44:45]
v_mfma_f32_16x16x32_bf16 v[60:63], a[220:223], a[84:87], v[60:63]
ds_read_b128 a[244:247], v2 offset:27648
s_waitcnt lgkmcnt(4)
v_mfma_f32_16x16x32_bf16 v[64:67], a[224:227], a[8:11], v[64:67]
s_add_u32 s26, s26, 4096
s_add_u32 s27, s27, 4096
s_add_u32 s28, s28, 4096
buffer_load_dwordx4 a[48:51], v2, s[8:11], s26 offen offset:0 sc1
v_mfma_f32_16x16x32_bf16 v[64:67], a[228:231], a[12:15], v[64:67]
ds_read_b128 a[216:219], v6 offset:14336
v_cndmask_b32 v173, v103, 0, s[46:47]
v_mfma_f32_16x16x32_bf16 v[68:71], a[224:227], a[80:83], v[68:71]
v_cndmask_b32 v174, v103, 0, s[48:49]
v_cndmask_b32 v175, v103, 0, s[50:51]
v_mfma_f32_16x16x32_bf16 v[68:71], a[228:231], a[84:87], v[68:71]
ds_read_b128 a[220:223], v6 offset:21504
s_waitcnt lgkmcnt(4)
v_mfma_f32_16x16x32_bf16 v[72:75], a[8:11], a[232:235], v[72:75]
buffer_load_dwordx4 a[120:123], v2, s[8:11], s27 offen offset:0 sc1
v_mfma_f32_16x16x32_bf16 v[72:75], a[12:15], a[236:239], v[72:75]
ds_read_b128 a[224:227], v9 offset:14336
v_cndmask_b32 v184, 0, v102, s[44:45]
v_mfma_f32_16x16x32_bf16 v[76:79], a[80:83], a[232:235], v[76:79]
v_cndmask_b32 v13, 0, v102, s[46:47]
v_lshl_or_b32 v184, v13, 16, v184
v_mfma_f32_16x16x32_bf16 v[76:79], a[84:87], a[236:239], v[76:79]
ds_read_b128 a[228:231], v9 offset:21504
s_waitcnt lgkmcnt(4)
v_mfma_f32_16x16x32_bf16 v[80:83], a[8:11], a[240:243], v[80:83]
buffer_load_dwordx4 a[192:195], v3, s[8:11], s28 offen offset:0 sc1
v_mfma_f32_16x16x32_bf16 v[80:83], a[12:15], a[244:247], v[80:83]
ds_read_b128 a[232:235], v2 offset:28672
v_cndmask_b32 v185, 0, v102, s[48:49]
v_mfma_f32_16x16x32_bf16 v[84:87], a[80:83], a[240:243], v[84:87]
v_cndmask_b32 v13, 0, v102, s[50:51]
v_lshl_or_b32 v185, v13, 16, v185
v_mfma_f32_16x16x32_bf16 v[84:87], a[84:87], a[244:247], v[84:87]
ds_read_b128 a[236:239], v2 offset:35840
s_waitcnt lgkmcnt(4)
v_mfma_f32_16x16x32_bf16 v[88:91], a[216:219], a[152:155], v[88:91]
ds_read_b128 a[240:243], v2 offset:29696
buffer_load_dwordx4 a[52:55], v2, s[8:11], s26 offen offset:1024 sc1
v_mfma_f32_16x16x32_bf16 v[88:91], a[220:223], a[156:159], v[88:91]
ds_read_b128 a[244:247], v2 offset:36864
s_waitcnt lgkmcnt(4)
v_mfma_f32_16x16x32_bf16 v[92:95], a[152:155], a[224:227], v[92:95]
ds_read_b128 a[216:219], v2 offset:30720
v_cndmask_b32 v176, v103, 0, s[52:53]
v_mfma_f32_16x16x32_bf16 v[92:95], a[156:159], a[228:231], v[92:95]
ds_read_b128 a[220:223], v2 offset:37888
s_waitcnt vmcnt(22)
s_waitcnt lgkmcnt(4)
v_mfma_f32_16x16x32_bf16 v[32:35], a[232:235], a[16:19], v[32:35]
buffer_load_dwordx4 a[124:127], v2, s[8:11], s27 offen offset:1024 sc1
v_mfma_f32_16x16x32_bf16 v[32:35], a[236:239], a[20:23], v[32:35]
ds_read_b128 a[224:227], v2 offset:31744
v_cndmask_b32 v177, v103, 0, s[54:55]
v_mfma_f32_16x16x32_bf16 v[36:39], a[232:235], a[88:91], v[36:39]
v_cndmask_b32 v178, v103, 0, s[56:57]
v_cndmask_b32 v179, v103, 0, s[58:59]
v_mfma_f32_16x16x32_bf16 v[36:39], a[236:239], a[92:95], v[36:39]
ds_read_b128 a[228:231], v2 offset:38912
s_waitcnt lgkmcnt(4)
v_mfma_f32_16x16x32_bf16 v[40:43], a[240:243], a[16:19], v[40:43]
buffer_load_dwordx4 a[196:199], v3, s[8:11], s28 offen offset:1024 sc1
v_mfma_f32_16x16x32_bf16 v[40:43], a[244:247], a[20:23], v[40:43]
ds_read_b128 a[232:235], v2 offset:32768
v_cndmask_b32 v186, 0, v102, s[52:53]
v_mfma_f32_16x16x32_bf16 v[44:47], a[240:243], a[88:91], v[44:47]
v_cndmask_b32 v13, 0, v102, s[54:55]
v_lshl_or_b32 v186, v13, 16, v186
v_mfma_f32_16x16x32_bf16 v[44:47], a[244:247], a[92:95], v[44:47]
ds_read_b128 a[236:239], v2 offset:39936
s_waitcnt lgkmcnt(4)
v_mfma_f32_16x16x32_bf16 v[48:51], a[216:219], a[16:19], v[48:51]
buffer_load_dwordx4 a[56:59], v2, s[8:11], s26 offen offset:2048 sc1
v_mfma_f32_16x16x32_bf16 v[48:51], a[220:223], a[20:23], v[48:51]
ds_read_b128 a[240:243], v2 offset:33792
v_cndmask_b32 v187, 0, v102, s[56:57]
v_mfma_f32_16x16x32_bf16 v[52:55], a[216:219], a[88:91], v[52:55]
v_cndmask_b32 v13, 0, v102, s[58:59]
v_lshl_or_b32 v187, v13, 16, v187
v_mfma_f32_16x16x32_bf16 v[52:55], a[220:223], a[92:95], v[52:55]
ds_read_b128 a[244:247], v2 offset:40960
s_waitcnt lgkmcnt(4)
v_mfma_f32_16x16x32_bf16 v[56:59], a[224:227], a[16:19], v[56:59]
buffer_load_dwordx4 a[128:131], v2, s[8:11], s27 offen offset:2048 sc1
v_mfma_f32_16x16x32_bf16 v[56:59], a[228:231], a[20:23], v[56:59]
ds_read_b128 a[216:219], v2 offset:34816
v_cndmask_b32 v180, v103, 0, s[60:61]
v_mfma_f32_16x16x32_bf16 v[60:63], a[224:227], a[88:91], v[60:63]
v_cndmask_b32 v181, v103, 0, s[62:63]
v_cndmask_b32 v182, v103, 0, s[64:65]
v_mfma_f32_16x16x32_bf16 v[60:63], a[228:231], a[92:95], v[60:63]
ds_read_b128 a[220:223], v2 offset:41984
s_waitcnt lgkmcnt(4)
v_mfma_f32_16x16x32_bf16 v[64:67], a[232:235], a[16:19], v[64:67]
buffer_load_dwordx4 a[200:203], v3, s[8:11], s28 offen offset:2048 sc1
v_mfma_f32_16x16x32_bf16 v[64:67], a[236:239], a[20:23], v[64:67]
ds_read_b128 a[224:227], v6 offset:28672
v_cndmask_b32 v183, v103, 0, s[66:67]
v_mfma_f32_16x16x32_bf16 v[68:71], a[232:235], a[88:91], v[68:71]
v_cndmask_b32 v188, 0, v102, s[60:61]
v_cndmask_b32 v13, 0, v102, s[62:63]
v_mfma_f32_16x16x32_bf16 v[68:71], a[236:239], a[92:95], v[68:71]
ds_read_b128 a[228:231], v6 offset:35840
s_waitcnt lgkmcnt(4)
v_mfma_f32_16x16x32_bf16 v[72:75], a[16:19], a[240:243], v[72:75]
buffer_load_dwordx4 a[60:63], v2, s[8:11], s26 offen offset:3072 sc1
v_mfma_f32_16x16x32_bf16 v[72:75], a[20:23], a[244:247], v[72:75]
ds_read_b128 a[232:235], v9 offset:28672
v_lshl_or_b32 v188, v13, 16, v188
v_mfma_f32_16x16x32_bf16 v[76:79], a[88:91], a[240:243], v[76:79]
v_cndmask_b32 v189, 0, v102, s[64:65]
v_cndmask_b32 v13, 0, v102, s[66:67]
v_mfma_f32_16x16x32_bf16 v[76:79], a[92:95], a[244:247], v[76:79]
ds_read_b128 a[236:239], v9 offset:35840
s_waitcnt lgkmcnt(4)
v_mfma_f32_16x16x32_bf16 v[80:83], a[16:19], a[216:219], v[80:83]
buffer_load_dwordx4 a[132:135], v2, s[8:11], s27 offen offset:3072 sc1
v_mfma_f32_16x16x32_bf16 v[80:83], a[20:23], a[220:223], v[80:83]
ds_read_b128 a[240:243], v2 offset:43008
v_lshl_or_b32 v189, v13, 16, v189
v_mfma_f32_16x16x32_bf16 v[84:87], a[88:91], a[216:219], v[84:87]
v_mfma_f32_16x16x32_bf16 v[84:87], a[92:95], a[220:223], v[84:87]
ds_read_b128 a[244:247], v2 offset:50176
s_waitcnt lgkmcnt(4)
v_mfma_f32_16x16x32_bf16 v[88:91], a[224:227], a[160:163], v[88:91]
ds_read_b128 a[216:219], v2 offset:44032
buffer_load_dwordx4 a[204:207], v3, s[8:11], s28 offen offset:3072 sc1
v_mfma_f32_16x16x32_bf16 v[88:91], a[228:231], a[164:167], v[88:91]
ds_read_b128 a[220:223], v2 offset:51200
s_waitcnt lgkmcnt(4)
v_mfma_f32_16x16x32_bf16 v[92:95], a[160:163], a[232:235], v[92:95]
ds_read_b128 a[224:227], v2 offset:45056
v_mfma_f32_16x16x32_bf16 v[92:95], a[164:167], a[236:239], v[92:95]
ds_read_b128 a[228:231], v2 offset:52224
s_waitcnt vmcnt(24)
s_waitcnt lgkmcnt(4)
v_mfma_f32_16x16x32_bf16 v[32:35], a[240:243], a[24:27], v[32:35]
s_add_u32 s26, s26, 4096
s_add_u32 s27, s27, 4096
s_add_u32 s28, s28, 4096
buffer_load_dwordx4 a[64:67], v2, s[8:11], s26 offen offset:0 sc1
v_mfma_f32_16x16x32_bf16 v[32:35], a[244:247], a[28:31], v[32:35]
ds_read_b128 a[232:235], v2 offset:46080
v_mfma_f32_16x16x32_bf16 v[36:39], a[240:243], a[96:99], v[36:39]
v_mfma_f32_16x16x32_bf16 v[36:39], a[244:247], a[100:103], v[36:39]
ds_read_b128 a[236:239], v2 offset:53248
s_waitcnt lgkmcnt(4)
v_mfma_f32_16x16x32_bf16 v[40:43], a[216:219], a[24:27], v[40:43]
buffer_load_dwordx4 a[136:139], v2, s[8:11], s27 offen offset:0 sc1
v_mfma_f32_16x16x32_bf16 v[40:43], a[220:223], a[28:31], v[40:43]
ds_read_b128 a[240:243], v2 offset:47104
v_mfma_f32_16x16x32_bf16 v[44:47], a[216:219], a[96:99], v[44:47]
v_mfma_f32_16x16x32_bf16 v[44:47], a[220:223], a[100:103], v[44:47]
ds_read_b128 a[244:247], v2 offset:54272
s_waitcnt lgkmcnt(4)
v_mfma_f32_16x16x32_bf16 v[48:51], a[224:227], a[24:27], v[48:51]
buffer_load_dwordx4 a[208:211], v3, s[8:11], s28 offen offset:0 sc1
v_mfma_f32_16x16x32_bf16 v[48:51], a[228:231], a[28:31], v[48:51]
ds_read_b128 a[216:219], v2 offset:48128
v_mfma_f32_16x16x32_bf16 v[52:55], a[224:227], a[96:99], v[52:55]
v_mfma_f32_16x16x32_bf16 v[52:55], a[228:231], a[100:103], v[52:55]
ds_read_b128 a[220:223], v2 offset:55296
s_waitcnt lgkmcnt(4)
v_mfma_f32_16x16x32_bf16 v[56:59], a[232:235], a[24:27], v[56:59]
buffer_load_dwordx4 a[68:71], v2, s[8:11], s26 offen offset:1024 sc1
v_mfma_f32_16x16x32_bf16 v[56:59], a[236:239], a[28:31], v[56:59]
ds_read_b128 a[224:227], v2 offset:49152
v_mfma_f32_16x16x32_bf16 v[60:63], a[232:235], a[96:99], v[60:63]
v_mfma_f32_16x16x32_bf16 v[60:63], a[236:239], a[100:103], v[60:63]
ds_read_b128 a[228:231], v2 offset:56320
s_waitcnt lgkmcnt(4)
v_mfma_f32_16x16x32_bf16 v[64:67], a[240:243], a[24:27], v[64:67]
buffer_load_dwordx4 a[140:143], v2, s[8:11], s27 offen offset:1024 sc1
v_mfma_f32_16x16x32_bf16 v[64:67], a[244:247], a[28:31], v[64:67]
ds_read_b128 a[232:235], v6 offset:43008
v_mfma_f32_16x16x32_bf16 v[68:71], a[240:243], a[96:99], v[68:71]
v_mfma_f32_16x16x32_bf16 v[68:71], a[244:247], a[100:103], v[68:71]
ds_read_b128 a[236:239], v6 offset:50176
s_waitcnt lgkmcnt(4)
v_mfma_f32_16x16x32_bf16 v[72:75], a[24:27], a[216:219], v[72:75]
buffer_load_dwordx4 a[212:215], v3, s[8:11], s28 offen offset:1024 sc1
v_mfma_f32_16x16x32_bf16 v[72:75], a[28:31], a[220:223], v[72:75]
ds_read_b128 a[240:243], v9 offset:43008
v_mfma_f32_16x16x32_bf16 v[76:79], a[96:99], a[216:219], v[76:79]
v_mfma_f32_16x16x32_bf16 v[76:79], a[100:103], a[220:223], v[76:79]
ds_read_b128 a[244:247], v9 offset:50176
s_waitcnt lgkmcnt(4)
v_mfma_f32_16x16x32_bf16 v[80:83], a[24:27], a[224:227], v[80:83]
v_mfma_f32_16x16x32_bf16 v[80:83], a[28:31], a[228:231], v[80:83]
ds_read_b128 a[216:219], v2 offset:57344
v_mfma_f32_16x16x32_bf16 v[84:87], a[96:99], a[224:227], v[84:87]
v_mfma_f32_16x16x32_bf16 v[84:87], a[100:103], a[228:231], v[84:87]
ds_read_b128 a[220:223], v2 offset:64512
s_waitcnt lgkmcnt(4)
v_mfma_f32_16x16x32_bf16 v[88:91], a[232:235], a[168:171], v[88:91]
ds_read_b128 a[224:227], v2 offset:58368
v_mfma_f32_16x16x32_bf16 v[88:91], a[236:239], a[172:175], v[88:91]
ds_read_b128 a[228:231], v4 offset:0
s_waitcnt lgkmcnt(4)
v_mfma_f32_16x16x32_bf16 v[92:95], a[168:171], a[240:243], v[92:95]
ds_read_b128 a[232:235], v2 offset:59392
v_mfma_f32_16x16x32_bf16 v[92:95], a[172:175], a[244:247], v[92:95]
ds_read_b128 a[236:239], v4 offset:1024
s_waitcnt vmcnt(24)
s_waitcnt lgkmcnt(4)
v_mfma_f32_16x16x32_bf16 v[32:35], a[216:219], a[32:35], v[32:35]
v_mfma_f32_16x16x32_bf16 v[32:35], a[220:223], a[36:39], v[32:35]
ds_read_b128 a[240:243], v2 offset:60416
v_mfma_f32_16x16x32_bf16 v[36:39], a[216:219], a[104:107], v[36:39]
v_mfma_f32_16x16x32_bf16 v[36:39], a[220:223], a[108:111], v[36:39]
ds_read_b128 a[244:247], v4 offset:2048
s_waitcnt lgkmcnt(4)
v_mfma_f32_16x16x32_bf16 v[40:43], a[224:227], a[32:35], v[40:43]
v_mfma_f32_16x16x32_bf16 v[40:43], a[228:231], a[36:39], v[40:43]
ds_read_b128 a[216:219], v2 offset:61440
v_mfma_f32_16x16x32_bf16 v[44:47], a[224:227], a[104:107], v[44:47]
v_mfma_f32_16x16x32_bf16 v[44:47], a[228:231], a[108:111], v[44:47]
ds_read_b128 a[220:223], v4 offset:3072
s_waitcnt lgkmcnt(4)
v_mfma_f32_16x16x32_bf16 v[48:51], a[232:235], a[32:35], v[48:51]
v_mfma_f32_16x16x32_bf16 v[48:51], a[236:239], a[36:39], v[48:51]
ds_read_b128 a[224:227], v2 offset:62464
v_mfma_f32_16x16x32_bf16 v[52:55], a[232:235], a[104:107], v[52:55]
v_mfma_f32_16x16x32_bf16 v[52:55], a[236:239], a[108:111], v[52:55]
ds_read_b128 a[228:231], v4 offset:4096
s_waitcnt lgkmcnt(4)
v_mfma_f32_16x16x32_bf16 v[56:59], a[240:243], a[32:35], v[56:59]
v_mfma_f32_16x16x32_bf16 v[56:59], a[244:247], a[36:39], v[56:59]
ds_read_b128 a[232:235], v2 offset:63488
v_mfma_f32_16x16x32_bf16 v[60:63], a[240:243], a[104:107], v[60:63]
v_mfma_f32_16x16x32_bf16 v[60:63], a[244:247], a[108:111], v[60:63]
ds_read_b128 a[236:239], v4 offset:5120
s_waitcnt lgkmcnt(4)
v_mfma_f32_16x16x32_bf16 v[64:67], a[216:219], a[32:35], v[64:67]
v_mfma_f32_16x16x32_bf16 v[64:67], a[220:223], a[36:39], v[64:67]
ds_read_b128 a[240:243], v6 offset:57344
v_mfma_f32_16x16x32_bf16 v[68:71], a[216:219], a[104:107], v[68:71]
v_mfma_f32_16x16x32_bf16 v[68:71], a[220:223], a[108:111], v[68:71]
ds_read_b128 a[244:247], v6 offset:64512
s_waitcnt lgkmcnt(4)
v_mfma_f32_16x16x32_bf16 v[72:75], a[32:35], a[224:227], v[72:75]
v_mfma_f32_16x16x32_bf16 v[72:75], a[36:39], a[228:231], v[72:75]
ds_read_b128 a[216:219], v9 offset:57344
v_mfma_f32_16x16x32_bf16 v[76:79], a[104:107], a[224:227], v[76:79]
v_mfma_f32_16x16x32_bf16 v[76:79], a[108:111], a[228:231], v[76:79]
ds_read_b128 a[220:223], v9 offset:64512
s_waitcnt lgkmcnt(4)
v_mfma_f32_16x16x32_bf16 v[80:83], a[32:35], a[232:235], v[80:83]
v_mfma_f32_16x16x32_bf16 v[80:83], a[36:39], a[236:239], v[80:83]
ds_read_b128 a[224:227], v4 offset:6144
v_mfma_f32_16x16x32_bf16 v[84:87], a[104:107], a[232:235], v[84:87]
v_mfma_f32_16x16x32_bf16 v[84:87], a[108:111], a[236:239], v[84:87]
ds_read_b128 a[228:231], v4 offset:13312
s_waitcnt lgkmcnt(4)
v_mfma_f32_16x16x32_bf16 v[88:91], a[240:243], a[176:179], v[88:91]
ds_read_b128 a[232:235], v4 offset:7168
v_mfma_f32_16x16x32_bf16 v[88:91], a[244:247], a[180:183], v[88:91]
ds_read_b128 a[236:239], v4 offset:14336
s_waitcnt lgkmcnt(4)
v_mfma_f32_16x16x32_bf16 v[92:95], a[176:179], a[216:219], v[92:95]
ds_read_b128 a[240:243], v4 offset:8192
v_mfma_f32_16x16x32_bf16 v[92:95], a[180:183], a[220:223], v[92:95]
ds_read_b128 a[244:247], v4 offset:15360
s_waitcnt vmcnt(18)
s_waitcnt lgkmcnt(4)
v_mfma_f32_16x16x32_bf16 v[32:35], a[224:227], a[40:43], v[32:35]
v_mfma_f32_16x16x32_bf16 v[32:35], a[228:231], a[44:47], v[32:35]
ds_read_b128 a[216:219], v4 offset:9216
v_mfma_f32_16x16x32_bf16 v[36:39], a[224:227], a[112:115], v[36:39]
v_mfma_f32_16x16x32_bf16 v[36:39], a[228:231], a[116:119], v[36:39]
ds_read_b128 a[220:223], v4 offset:16384
s_waitcnt lgkmcnt(4)
v_mfma_f32_16x16x32_bf16 v[40:43], a[232:235], a[40:43], v[40:43]
v_mfma_f32_16x16x32_bf16 v[40:43], a[236:239], a[44:47], v[40:43]
ds_read_b128 a[224:227], v4 offset:10240
v_mfma_f32_16x16x32_bf16 v[44:47], a[232:235], a[112:115], v[44:47]
v_mfma_f32_16x16x32_bf16 v[44:47], a[236:239], a[116:119], v[44:47]
ds_read_b128 a[228:231], v4 offset:17408
s_waitcnt lgkmcnt(4)
v_mfma_f32_16x16x32_bf16 v[48:51], a[240:243], a[40:43], v[48:51]
v_mfma_f32_16x16x32_bf16 v[48:51], a[244:247], a[44:47], v[48:51]
ds_read_b128 a[232:235], v4 offset:11264
v_mfma_f32_16x16x32_bf16 v[52:55], a[240:243], a[112:115], v[52:55]
v_mfma_f32_16x16x32_bf16 v[52:55], a[244:247], a[116:119], v[52:55]
ds_read_b128 a[236:239], v4 offset:18432
s_waitcnt lgkmcnt(4)
v_mfma_f32_16x16x32_bf16 v[56:59], a[216:219], a[40:43], v[56:59]
v_mfma_f32_16x16x32_bf16 v[56:59], a[220:223], a[44:47], v[56:59]
ds_read_b128 a[240:243], v4 offset:12288
v_mfma_f32_16x16x32_bf16 v[60:63], a[216:219], a[112:115], v[60:63]
v_mfma_f32_16x16x32_bf16 v[60:63], a[220:223], a[116:119], v[60:63]
ds_read_b128 a[244:247], v4 offset:19456
s_waitcnt lgkmcnt(4)
v_mfma_f32_16x16x32_bf16 v[64:67], a[224:227], a[40:43], v[64:67]
v_mfma_f32_16x16x32_bf16 v[64:67], a[228:231], a[44:47], v[64:67]
ds_read_b128 a[216:219], v7 offset:6144
v_mfma_f32_16x16x32_bf16 v[68:71], a[224:227], a[112:115], v[68:71]
v_mfma_f32_16x16x32_bf16 v[68:71], a[228:231], a[116:119], v[68:71]
ds_read_b128 a[220:223], v7 offset:13312
s_waitcnt lgkmcnt(4)
v_mfma_f32_16x16x32_bf16 v[72:75], a[40:43], a[232:235], v[72:75]
v_mfma_f32_16x16x32_bf16 v[72:75], a[44:47], a[236:239], v[72:75]
ds_read_b128 a[224:227], v10 offset:6144
v_mfma_f32_16x16x32_bf16 v[76:79], a[112:115], a[232:235], v[76:79]
v_mfma_f32_16x16x32_bf16 v[76:79], a[116:119], a[236:239], v[76:79]
ds_read_b128 a[228:231], v10 offset:13312
s_waitcnt lgkmcnt(4)
v_mfma_f32_16x16x32_bf16 v[80:83], a[40:43], a[240:243], v[80:83]
v_mfma_f32_16x16x32_bf16 v[80:83], a[44:47], a[244:247], v[80:83]
ds_read_b128 a[232:235], v4 offset:20480
v_mfma_f32_16x16x32_bf16 v[84:87], a[112:115], a[240:243], v[84:87]
v_mfma_f32_16x16x32_bf16 v[84:87], a[116:119], a[244:247], v[84:87]
ds_read_b128 a[236:239], v4 offset:27648
s_waitcnt lgkmcnt(4)
v_mfma_f32_16x16x32_bf16 v[88:91], a[216:219], a[184:187], v[88:91]
ds_read_b128 a[240:243], v4 offset:21504
v_mfma_f32_16x16x32_bf16 v[88:91], a[220:223], a[188:191], v[88:91]
ds_read_b128 a[244:247], v4 offset:28672
s_waitcnt lgkmcnt(4)
v_mfma_f32_16x16x32_bf16 v[92:95], a[184:187], a[224:227], v[92:95]
ds_read_b128 a[216:219], v4 offset:22528
v_mfma_f32_16x16x32_bf16 v[92:95], a[188:191], a[228:231], v[92:95]
ds_read_b128 a[220:223], v4 offset:29696
s_waitcnt vmcnt(12)
s_waitcnt lgkmcnt(4)
v_mfma_f32_16x16x32_bf16 v[32:35], a[232:235], a[48:51], v[32:35]
v_mfma_f32_16x16x32_bf16 v[32:35], a[236:239], a[52:55], v[32:35]
ds_read_b128 a[224:227], v4 offset:23552
v_mfma_f32_16x16x32_bf16 v[36:39], a[232:235], a[120:123], v[36:39]
v_mfma_f32_16x16x32_bf16 v[36:39], a[236:239], a[124:127], v[36:39]
ds_read_b128 a[228:231], v4 offset:30720
s_waitcnt lgkmcnt(4)
v_mfma_f32_16x16x32_bf16 v[40:43], a[240:243], a[48:51], v[40:43]
v_mfma_f32_16x16x32_bf16 v[40:43], a[244:247], a[52:55], v[40:43]
ds_read_b128 a[232:235], v4 offset:24576
v_mfma_f32_16x16x32_bf16 v[44:47], a[240:243], a[120:123], v[44:47]
v_mfma_f32_16x16x32_bf16 v[44:47], a[244:247], a[124:127], v[44:47]
ds_read_b128 a[236:239], v4 offset:31744
s_waitcnt lgkmcnt(4)
v_mfma_f32_16x16x32_bf16 v[48:51], a[216:219], a[48:51], v[48:51]
v_mfma_f32_16x16x32_bf16 v[48:51], a[220:223], a[52:55], v[48:51]
ds_read_b128 a[240:243], v4 offset:25600
v_mfma_f32_16x16x32_bf16 v[52:55], a[216:219], a[120:123], v[52:55]
v_mfma_f32_16x16x32_bf16 v[52:55], a[220:223], a[124:127], v[52:55]
ds_read_b128 a[244:247], v4 offset:32768
s_waitcnt lgkmcnt(4)
v_mfma_f32_16x16x32_bf16 v[56:59], a[224:227], a[48:51], v[56:59]
v_mfma_f32_16x16x32_bf16 v[56:59], a[228:231], a[52:55], v[56:59]
ds_read_b128 a[216:219], v4 offset:26624
v_mfma_f32_16x16x32_bf16 v[60:63], a[224:227], a[120:123], v[60:63]
v_mfma_f32_16x16x32_bf16 v[60:63], a[228:231], a[124:127], v[60:63]
ds_read_b128 a[220:223], v4 offset:33792
s_waitcnt lgkmcnt(4)
v_mfma_f32_16x16x32_bf16 v[64:67], a[232:235], a[48:51], v[64:67]
v_mfma_f32_16x16x32_bf16 v[64:67], a[236:239], a[52:55], v[64:67]
ds_read_b128 a[224:227], v7 offset:20480
v_mfma_f32_16x16x32_bf16 v[68:71], a[232:235], a[120:123], v[68:71]
v_mfma_f32_16x16x32_bf16 v[68:71], a[236:239], a[124:127], v[68:71]
ds_read_b128 a[228:231], v7 offset:27648
s_waitcnt lgkmcnt(4)
v_mfma_f32_16x16x32_bf16 v[72:75], a[48:51], a[240:243], v[72:75]
v_mfma_f32_16x16x32_bf16 v[72:75], a[52:55], a[244:247], v[72:75]
ds_read_b128 a[232:235], v10 offset:20480
v_mfma_f32_16x16x32_bf16 v[76:79], a[120:123], a[240:243], v[76:79]
v_mfma_f32_16x16x32_bf16 v[76:79], a[124:127], a[244:247], v[76:79]
ds_read_b128 a[236:239], v10 offset:27648
s_waitcnt lgkmcnt(4)
v_mfma_f32_16x16x32_bf16 v[80:83], a[48:51], a[216:219], v[80:83]
v_mfma_f32_16x16x32_bf16 v[80:83], a[52:55], a[220:223], v[80:83]
ds_read_b128 a[240:243], v4 offset:34816
v_mfma_f32_16x16x32_bf16 v[84:87], a[120:123], a[216:219], v[84:87]
v_mfma_f32_16x16x32_bf16 v[84:87], a[124:127], a[220:223], v[84:87]
ds_read_b128 a[244:247], v4 offset:41984
s_waitcnt lgkmcnt(4)
v_mfma_f32_16x16x32_bf16 v[88:91], a[224:227], a[192:195], v[88:91]
ds_read_b128 a[216:219], v4 offset:35840
v_mfma_f32_16x16x32_bf16 v[88:91], a[228:231], a[196:199], v[88:91]
ds_read_b128 a[220:223], v4 offset:43008
s_waitcnt lgkmcnt(4)
v_mfma_f32_16x16x32_bf16 v[92:95], a[192:195], a[232:235], v[92:95]
ds_read_b128 a[224:227], v4 offset:36864
v_mfma_f32_16x16x32_bf16 v[92:95], a[196:199], a[236:239], v[92:95]
ds_read_b128 a[228:231], v4 offset:44032
s_waitcnt vmcnt(6)
s_waitcnt lgkmcnt(4)
v_mfma_f32_16x16x32_bf16 v[32:35], a[240:243], a[56:59], v[32:35]
v_mfma_f32_16x16x32_bf16 v[32:35], a[244:247], a[60:63], v[32:35]
ds_read_b128 a[232:235], v4 offset:37888
v_mfma_f32_16x16x32_bf16 v[36:39], a[240:243], a[128:131], v[36:39]
v_mfma_f32_16x16x32_bf16 v[36:39], a[244:247], a[132:135], v[36:39]
ds_read_b128 a[236:239], v4 offset:45056
s_waitcnt lgkmcnt(4)
v_mfma_f32_16x16x32_bf16 v[40:43], a[216:219], a[56:59], v[40:43]
v_mfma_f32_16x16x32_bf16 v[40:43], a[220:223], a[60:63], v[40:43]
ds_read_b128 a[240:243], v4 offset:38912
v_mfma_f32_16x16x32_bf16 v[44:47], a[216:219], a[128:131], v[44:47]
v_mfma_f32_16x16x32_bf16 v[44:47], a[220:223], a[132:135], v[44:47]
ds_read_b128 a[244:247], v4 offset:46080
s_waitcnt lgkmcnt(4)
v_mfma_f32_16x16x32_bf16 v[48:51], a[224:227], a[56:59], v[48:51]
v_mfma_f32_16x16x32_bf16 v[48:51], a[228:231], a[60:63], v[48:51]
ds_read_b128 a[216:219], v4 offset:39936
v_mfma_f32_16x16x32_bf16 v[52:55], a[224:227], a[128:131], v[52:55]
v_mfma_f32_16x16x32_bf16 v[52:55], a[228:231], a[132:135], v[52:55]
ds_read_b128 a[220:223], v4 offset:47104
s_waitcnt lgkmcnt(4)
v_mfma_f32_16x16x32_bf16 v[56:59], a[232:235], a[56:59], v[56:59]
v_mfma_f32_16x16x32_bf16 v[56:59], a[236:239], a[60:63], v[56:59]
ds_read_b128 a[224:227], v4 offset:40960
v_mfma_f32_16x16x32_bf16 v[60:63], a[232:235], a[128:131], v[60:63]
v_mfma_f32_16x16x32_bf16 v[60:63], a[236:239], a[132:135], v[60:63]
ds_read_b128 a[228:231], v4 offset:48128
s_waitcnt lgkmcnt(4)
v_mfma_f32_16x16x32_bf16 v[64:67], a[240:243], a[56:59], v[64:67]
v_mfma_f32_16x16x32_bf16 v[64:67], a[244:247], a[60:63], v[64:67]
ds_read_b128 a[232:235], v7 offset:34816
v_mfma_f32_16x16x32_bf16 v[68:71], a[240:243], a[128:131], v[68:71]
v_mfma_f32_16x16x32_bf16 v[68:71], a[244:247], a[132:135], v[68:71]
ds_read_b128 a[236:239], v7 offset:41984
s_waitcnt lgkmcnt(4)
v_mfma_f32_16x16x32_bf16 v[72:75], a[56:59], a[216:219], v[72:75]
v_mfma_f32_16x16x32_bf16 v[72:75], a[60:63], a[220:223], v[72:75]
ds_read_b128 a[240:243], v10 offset:34816
v_mfma_f32_16x16x32_bf16 v[76:79], a[128:131], a[216:219], v[76:79]
v_mfma_f32_16x16x32_bf16 v[76:79], a[132:135], a[220:223], v[76:79]
ds_read_b128 a[244:247], v10 offset:41984
s_waitcnt lgkmcnt(4)
v_mfma_f32_16x16x32_bf16 v[80:83], a[56:59], a[224:227], v[80:83]
v_mfma_f32_16x16x32_bf16 v[80:83], a[60:63], a[228:231], v[80:83]
ds_read_b128 a[216:219], v4 offset:49152
v_mfma_f32_16x16x32_bf16 v[84:87], a[128:131], a[224:227], v[84:87]
v_mfma_f32_16x16x32_bf16 v[84:87], a[132:135], a[228:231], v[84:87]
ds_read_b128 a[220:223], v4 offset:56320
s_waitcnt lgkmcnt(4)
L_hop13:
s_cmp_eq_u32 s15, 1
s_cbranch_scc1 L_hop_done
v_mfma_f32_16x16x32_bf16 v[88:91], a[232:235], a[200:203], v[88:91]
ds_read_b128 a[224:227], v4 offset:50176
v_mfma_f32_16x16x32_bf16 v[88:91], a[236:239], a[204:207], v[88:91]
ds_read_b128 a[228:231], v4 offset:57344
s_waitcnt lgkmcnt(4)
v_mfma_f32_16x16x32_bf16 v[92:95], a[200:203], a[240:243], v[92:95]
ds_read_b128 a[232:235], v4 offset:51200
v_mfma_f32_16x16x32_bf16 v[92:95], a[204:207], a[244:247], v[92:95]
ds_read_b128 a[236:239], v4 offset:58368
s_waitcnt vmcnt(0)
s_waitcnt lgkmcnt(4)
v_mfma_f32_16x16x32_bf16 v[32:35], a[216:219], a[64:67], v[32:35]
v_mfma_f32_16x16x32_bf16 v[32:35], a[220:223], a[68:71], v[32:35]
ds_read_b128 a[240:243], v4 offset:52224
v_mfma_f32_16x16x32_bf16 v[36:39], a[216:219], a[136:139], v[36:39]
v_mfma_f32_16x16x32_bf16 v[36:39], a[220:223], a[140:143], v[36:39]
ds_read_b128 a[244:247], v4 offset:59392
s_waitcnt lgkmcnt(4)
v_mfma_f32_16x16x32_bf16 v[40:43], a[224:227], a[64:67], v[40:43]
v_mfma_f32_16x16x32_bf16 v[40:43], a[228:231], a[68:71], v[40:43]
ds_read_b128 a[216:219], v4 offset:53248
v_mfma_f32_16x16x32_bf16 v[44:47], a[224:227], a[136:139], v[44:47]
v_mfma_f32_16x16x32_bf16 v[44:47], a[228:231], a[140:143], v[44:47]
ds_read_b128 a[220:223], v4 offset:60416
s_waitcnt lgkmcnt(4)
v_mfma_f32_16x16x32_bf16 v[48:51], a[232:235], a[64:67], v[48:51]
v_mfma_f32_16x16x32_bf16 v[48:51], a[236:239], a[68:71], v[48:51]
ds_read_b128 a[224:227], v4 offset:54272
v_mfma_f32_16x16x32_bf16 v[52:55], a[232:235], a[136:139], v[52:55]
v_mfma_f32_16x16x32_bf16 v[52:55], a[236:239], a[140:143], v[52:55]
ds_read_b128 a[228:231], v4 offset:61440
s_waitcnt lgkmcnt(4)
v_mfma_f32_16x16x32_bf16 v[56:59], a[240:243], a[64:67], v[56:59]
v_mfma_f32_16x16x32_bf16 v[56:59], a[244:247], a[68:71], v[56:59]
ds_read_b128 a[232:235], v4 offset:55296
v_mfma_f32_16x16x32_bf16 v[60:63], a[240:243], a[136:139], v[60:63]
v_mfma_f32_16x16x32_bf16 v[60:63], a[244:247], a[140:143], v[60:63]
ds_read_b128 a[236:239], v4 offset:62464
s_waitcnt lgkmcnt(4)
v_mfma_f32_16x16x32_bf16 v[64:67], a[216:219], a[64:67], v[64:67]
v_mfma_f32_16x16x32_bf16 v[64:67], a[220:223], a[68:71], v[64:67]
ds_read_b128 a[240:243], v7 offset:49152
v_mfma_f32_16x16x32_bf16 v[68:71], a[216:219], a[136:139], v[68:71]
v_mfma_f32_16x16x32_bf16 v[68:71], a[220:223], a[140:143], v[68:71]
ds_read_b128 a[244:247], v7 offset:56320
s_waitcnt lgkmcnt(4)
v_mfma_f32_16x16x32_bf16 v[72:75], a[64:67], a[224:227], v[72:75]
v_mfma_f32_16x16x32_bf16 v[72:75], a[68:71], a[228:231], v[72:75]
ds_read_b128 a[216:219], v10 offset:49152
v_mfma_f32_16x16x32_bf16 v[76:79], a[136:139], a[224:227], v[76:79]
v_mfma_f32_16x16x32_bf16 v[76:79], a[140:143], a[228:231], v[76:79]
ds_read_b128 a[220:223], v10 offset:56320
s_waitcnt lgkmcnt(4)
v_mfma_f32_16x16x32_bf16 v[80:83], a[64:67], a[232:235], v[80:83]
v_mfma_f32_16x16x32_bf16 v[80:83], a[68:71], a[236:239], v[80:83]
v_mfma_f32_16x16x32_bf16 v[84:87], a[136:139], a[232:235], v[84:87]
v_mfma_f32_16x16x32_bf16 v[84:87], a[140:143], a[236:239], v[84:87]
s_waitcnt lgkmcnt(2)
v_mfma_f32_16x16x32_bf16 v[88:91], a[240:243], a[208:211], v[88:91]
v_mfma_f32_16x16x32_bf16 v[88:91], a[244:247], a[212:215], v[88:91]
s_waitcnt lgkmcnt(0)
v_mfma_f32_16x16x32_bf16 v[92:95], a[208:211], a[216:219], v[92:95]
v_mfma_f32_16x16x32_bf16 v[92:95], a[212:215], a[220:223], v[92:95]
s_branch L_att
L_last:
s_cmp_eq_u32 s4, 3
s_cbranch_scc1 L_epoch
v_and_b32 v6, 7, v1
v_lshrrev_b32 v7, 3, v1
s_and_b32 s23, s6, 1
s_lshl_b32 s23, s23, 3
v_add_u32 v8, s23, v6
v_lshlrev_b32 v8, 4, v8
v_lshl_add_u32 v4, v7, 8, v8
s_lshl_b32 s24, s5, 4
s_lshr_b32 s25, s6, 1
s_add_u32 s24, s24, s25
s_mul_i32 s20, s24, 18432
s_lshl_b32 s24, s5, 8
s_lshl_b32 s25, s6, 3
s_add_u32 s24, s24, s25
s_and_b32 s25, s24, 1023
s_lshl_b32 s25, s25, 1
s_lshr_b32 s24, s24, 10
s_add_u32 s24, s24, s25
s_mul_i32 s21, s24, 1152
v_mul_u32_u24 v8, 2304, v6
v_lshl_add_u32 v5, v7, 4, v8
s_load_dwordx2 s[12:13], s[0:1], 56
s_waitcnt lgkmcnt(0)
s_mov_b32 s16, s12
s_and_b32 s17, s13, 0xffff
s_mov_b32 s18, 2359296
s_mov_b32 s19, 0x20000
s_lshl_b32 s22, s4, 2
s_lshr_b32 s23, 1056, s22
s_and_b32 s23, s23, 15
s_lshl_b32 s24, s23, 11
s_add_u32 s28, s20, s24
s_lshl_b32 s24, s23, 7
s_add_u32 s31, s21, s24
s_lshr_b32 s23, 790, s22
s_and_b32 s23, s23, 15
s_lshl_b32 s24, s23, 11
s_add_u32 s29, s20, s24
s_lshl_b32 s24, s23, 7
s_add_u32 s32, s21, s24
s_lshr_b32 s23, 2165, s22
s_and_b32 s23, s23, 15
s_lshl_b32 s24, s23, 11
s_add_u32 s30, s20, s24
s_lshl_b32 s24, s23, 7
s_add_u32 s33, s21, s24
s_lshl_b32 s26, s5, 12
s_add_u32 s27, s26, 1966080
s_add_u32 s26, s26, 1703936
v_and_b32 v6, 31, v1
v_lshlrev_b32 v6, 7, v6
buffer_load_dwordx2 v[10:11], v6, s[8:11], s27 offen sc1
v_mov_b32 v13, 2146435072
v_cmp_gt_u32 vcc, 16, v0
v_lshlrev_b32 v14, 3, v0
s_nop 0
v_cndmask_b32 v13, v13, v14, vcc
v_mov_b32 v14, s68
v_mov_b32 v15, s69
s_waitcnt vmcnt(0)
s_barrier
buffer_store_dwordx2 v[14:15], v13, s[8:11], s14 offen sc1
s_add_u32 s24, s28, 39485440
buffer_load_dwordx4 v[16:19], v4, s[8:11], s24 offen sc1
s_add_u32 s25, s29, 39485440
buffer_load_dwordx4 v[20:23], v4, s[8:11], s25 offen sc1
s_add_u32 s24, s30, 39485440
buffer_load_dwordx4 v[24:27], v4, s[8:11], s24 offen sc1
v_cmp_eq_u64 vcc, s[68:69], v[10:11]
s_nop 0
s_cmp_eq_u64 vcc, exec
s_cbranch_scc0 L_re_slow8
L_re_back8:
s_add_u32 s25, s28, 98729984
buffer_load_dwordx4 v[28:31], v4, s[8:11], s25 offen sc1
s_add_u32 s24, s28, 101089280
buffer_load_dwordx4 v[40:43], v4, s[8:11], s24 offen sc1
s_add_u32 s25, s28, 103448576
buffer_load_dwordx4 v[52:55], v4, s[8:11], s25 offen sc1
s_add_u32 s24, s28, 105807872
buffer_load_dwordx4 v[64:67], v4, s[8:11], s24 offen sc1
s_add_u32 s25, s28, 108167168
buffer_load_dwordx4 v[76:79], v4, s[8:11], s25 offen sc1
s_add_u32 s24, s28, 110526464
buffer_load_dwordx4 v[88:91], v4, s[8:11], s24 offen sc1
s_add_u32 s25, s28, 112885760
buffer_load_dwordx4 v[100:103], v4, s[8:11], s25 offen sc1
s_add_u32 s24, s28, 115245056
buffer_load_dwordx4 v[112:115], v4, s[8:11], s24 offen sc1
s_cmp_eq_u32 s4, 0
s_cbranch_scc0 L_re1_8
s_add_u32 s24, s29, 98729984
buffer_load_dwordx4 v[32:35], v4, s[8:11], s24 offen sc1
s_add_u32 s25, s29, 101089280
buffer_load_dwordx4 v[44:47], v4, s[8:11], s25 offen sc1
s_add_u32 s24, s29, 103448576
buffer_load_dwordx4 v[56:59], v4, s[8:11], s24 offen sc1
s_add_u32 s25, s29, 105807872
buffer_load_dwordx4 v[68:71], v4, s[8:11], s25 offen sc1
s_add_u32 s24, s29, 108167168
buffer_load_dwordx4 v[80:83], v4, s[8:11], s24 offen sc1
s_add_u32 s25, s29, 110526464
buffer_load_dwordx4 v[92:95], v4, s[8:11], s25 offen sc1
s_add_u32 s24, s29, 112885760
buffer_load_dwordx4 v[104:107], v4, s[8:11], s24 offen sc1
s_add_u32 s25, s29, 115245056
buffer_load_dwordx4 v[116:119], v4, s[8:11], s25 offen sc1
L_re1_8:
s_mov_b32 s52, 0
L_poll10:
buffer_load_dwordx2 v[14:15], v6, s[8:11], s26 offen sc1
s_add_u32 s52, s52, 1
s_waitcnt vmcnt(0)
v_cmp_ne_u64 vcc, s[68:69], v[14:15]
s_cmp_ge_u32 s52, 1048576
s_cbranch_scc1 L_got10
s_and_b64 exec, exec, vcc
s_cbranch_execnz L_poll10
L_got10:
s_mov_b64 exec, -1
s_cmp_eq_u32 s4, 0
s_cbranch_scc1 L_re2_8
s_add_u32 s24, s29, 98729984
buffer_load_dwordx4 v[32:35], v4, s[8:11], s24 offen sc1
s_add_u32 s25, s29, 101089280
buffer_load_dwordx4 v[44:47], v4, s[8:11], s25 offen sc1
s_add_u32 s24, s29, 103448576
buffer_load_dwordx4 v[56:59], v4, s[8:11], s24 offen sc1
s_add_u32 s25, s29, 105807872
buffer_load_dwordx4 v[68:71], v4, s[8:11], s25 offen sc1
s_add_u32 s24, s29, 108167168
buffer_load_dwordx4 v[80:83], v4, s[8:11], s24 offen sc1
s_add_u32 s25, s29, 110526464
buffer_load_dwordx4 v[92:95], v4, s[8:11], s25 offen sc1
s_add_u32 s24, s29, 112885760
buffer_load_dwordx4 v[104:107], v4, s[8:11], s24 offen sc1
s_add_u32 s25, s29, 115245056
buffer_load_dwordx4 v[116:119], v4, s[8:11], s25 offen sc1
L_re2_8:
s_add_u32 s25, s30, 98729984
buffer_load_dwordx4 v[36:39], v4, s[8:11], s25 offen sc1
s_add_u32 s24, s30, 101089280
buffer_load_dwordx4 v[48:51], v4, s[8:11], s24 offen sc1
s_add_u32 s25, s30, 103448576
buffer_load_dwordx4 v[60:63], v4, s[8:11], s25 offen sc1
s_add_u32 s24, s30, 105807872
buffer_load_dwordx4 v[72:75], v4, s[8:11], s24 offen sc1
s_add_u32 s25, s30, 108167168
buffer_load_dwordx4 v[84:87], v4, s[8:11], s25 offen sc1
s_add_u32 s24, s30, 110526464
buffer_load_dwordx4 v[96:99], v4, s[8:11], s24 offen sc1
s_add_u32 s25, s30, 112885760
buffer_load_dwordx4 v[108:111], v4, s[8:11], s25 offen sc1
s_add_u32 s24, s30, 115245056
buffer_load_dwordx4 v[120:123], v4, s[8:11], s24 offen sc1
s_waitcnt vmcnt(26)
v_lshlrev_b32 v128, 16, v16
v_and_b32 v129, 0xffff0000, v16
v_lshlrev_b32 v130, 16, v17
v_and_b32 v131, 0xffff0000, v17
v_lshlrev_b32 v132, 16, v18
v_and_b32 v133, 0xffff0000, v18
v_lshlrev_b32 v134, 16, v19
v_and_b32 v135, 0xffff0000, v19
s_waitcnt vmcnt(25)
v_lshlrev_b32 v136, 16, v20
v_and_b32 v137, 0xffff0000, v20
v_lshlrev_b32 v138, 16, v21
v_and_b32 v139, 0xffff0000, v21
v_lshlrev_b32 v140, 16, v22
v_and_b32 v141, 0xffff0000, v22
v_lshlrev_b32 v142, 16, v23
v_and_b32 v143, 0xffff0000, v23
s_waitcnt vmcnt(24)
v_lshlrev_b32 v144, 16, v24
v_and_b32 v145, 0xffff0000, v24
v_lshlrev_b32 v146, 16, v25
v_and_b32 v147, 0xffff0000, v25
v_lshlrev_b32 v148, 16, v26
v_and_b32 v149, 0xffff0000, v26
v_lshlrev_b32 v150, 16, v27
v_and_b32 v151, 0xffff0000, v27
s_waitcnt vmcnt(23)
v_lshlrev_b32 v6, 16, v28
v_and_b32 v7, 0xffff0000, v28
v_add_f32 v128, v128, v6
v_add_f32 v129, v129, v7
v_lshlrev_b32 v8, 16, v29
v_and_b32 v9, 0xffff0000, v29
v_add_f32 v130, v130, v8
v_add_f32 v131, v131, v9
v_lshlrev_b32 v6, 16, v30
v_and_b32 v7, 0xffff0000, v30
v_add_f32 v132, v132, v6
v_add_f32 v133, v133, v7
v_lshlrev_b32 v8, 16, v31
v_and_b32 v9, 0xffff0000, v31
v_add_f32 v134, v134, v8
v_add_f32 v135, v135, v9
s_waitcnt vmcnt(22)
v_lshlrev_b32 v6, 16, v40
v_and_b32 v7, 0xffff0000, v40
v_add_f32 v128, v128, v6
v_add_f32 v129, v129, v7
v_lshlrev_b32 v8, 16, v41
v_and_b32 v9, 0xffff0000, v41
v_add_f32 v130, v130, v8
v_add_f32 v131, v131, v9
v_lshlrev_b32 v6, 16, v42
v_and_b32 v7, 0xffff0000, v42
v_add_f32 v132, v132, v6
v_add_f32 v133, v133, v7
v_lshlrev_b32 v8, 16, v43
v_and_b32 v9, 0xffff0000, v43
v_add_f32 v134, v134, v8
v_add_f32 v135, v135, v9
s_waitcnt vmcnt(21)
v_lshlrev_b32 v6, 16, v52
v_and_b32 v7, 0xffff0000, v52
v_add_f32 v128, v128, v6
v_add_f32 v129, v129, v7
v_lshlrev_b32 v8, 16, v53
v_and_b32 v9, 0xffff0000, v53
v_add_f32 v130, v130, v8
v_add_f32 v131, v131, v9
v_lshlrev_b32 v6, 16, v54
v_and_b32 v7, 0xffff0000, v54
v_add_f32 v132, v132, v6
v_add_f32 v133, v133, v7
v_lshlrev_b32 v8, 16, v55
v_and_b32 v9, 0xffff0000, v55
v_add_f32 v134, v134, v8
v_add_f32 v135, v135, v9
s_waitcnt vmcnt(20)
v_lshlrev_b32 v6, 16, v64
v_and_b32 v7, 0xffff0000, v64
v_add_f32 v128, v128, v6
v_add_f32 v129, v129, v7
v_lshlrev_b32 v8, 16, v65
v_and_b32 v9, 0xffff0000, v65
v_add_f32 v130, v130, v8
v_add_f32 v131, v131, v9
v_lshlrev_b32 v6, 16, v66
v_and_b32 v7, 0xffff0000, v66
v_add_f32 v132, v132, v6
v_add_f32 v133, v133, v7
v_lshlrev_b32 v8, 16, v67
v_and_b32 v9, 0xffff0000, v67
v_add_f32 v134, v134, v8
v_add_f32 v135, v135, v9
s_waitcnt vmcnt(19)
v_lshlrev_b32 v6, 16, v76
v_and_b32 v7, 0xffff0000, v76
v_add_f32 v128, v128, v6
v_add_f32 v129, v129, v7
v_lshlrev_b32 v8, 16, v77
v_and_b32 v9, 0xffff0000, v77
v_add_f32 v130, v130, v8
v_add_f32 v131, v131, v9
v_lshlrev_b32 v6, 16, v78
v_and_b32 v7, 0xffff0000, v78
v_add_f32 v132, v132, v6
v_add_f32 v133, v133, v7
v_lshlrev_b32 v8, 16, v79
v_and_b32 v9, 0xffff0000, v79
v_add_f32 v134, v134, v8
v_add_f32 v135, v135, v9
s_waitcnt vmcnt(18)
v_lshlrev_b32 v6, 16, v88
v_and_b32 v7, 0xffff0000, v88
v_add_f32 v128, v128, v6
v_add_f32 v129, v129, v7
v_lshlrev_b32 v8, 16, v89
v_and_b32 v9, 0xffff0000, v89
v_add_f32 v130, v130, v8
v_add_f32 v131, v131, v9
v_lshlrev_b32 v6, 16, v90
v_and_b32 v7, 0xffff0000, v90
v_add_f32 v132, v132, v6
v_add_f32 v133, v133, v7
v_lshlrev_b32 v8, 16, v91
v_and_b32 v9, 0xffff0000, v91
v_add_f32 v134, v134, v8
v_add_f32 v135, v135, v9
s_waitcnt vmcnt(17)
v_lshlrev_b32 v6, 16, v100
v_and_b32 v7, 0xffff0000, v100
v_add_f32 v128, v128, v6
v_add_f32 v129, v129, v7
v_lshlrev_b32 v8, 16, v101
v_and_b32 v9, 0xffff0000, v101
v_add_f32 v130, v130, v8
v_add_f32 v131, v131, v9
v_lshlrev_b32 v6, 16, v102
v_and_b32 v7, 0xffff0000, v102
v_add_f32 v132, v132, v6
v_add_f32 v133, v133, v7
v_lshlrev_b32 v8, 16, v103
v_and_b32 v9, 0xffff0000, v103
v_add_f32 v134, v134, v8
v_add_f32 v135, v135, v9
s_waitcnt vmcnt(16)
v_lshlrev_b32 v6, 16, v112
v_and_b32 v7, 0xffff0000, v112
v_add_f32 v128, v128, v6
v_add_f32 v129, v129, v7
v_lshlrev_b32 v8, 16, v113
v_and_b32 v9, 0xffff0000, v113
v_add_f32 v130, v130, v8
v_add_f32 v131, v131, v9
v_lshlrev_b32 v6, 16, v114
v_and_b32 v7, 0xffff0000, v114
v_add_f32 v132, v132, v6
v_add_f32 v133, v133, v7
v_lshlrev_b32 v8, 16, v115
v_and_b32 v9, 0xffff0000, v115
v_add_f32 v134, v134, v8
v_add_f32 v135, v135, v9
s_waitcnt vmcnt(15)
v_lshlrev_b32 v6, 16, v32
v_and_b32 v7, 0xffff0000, v32
v_add_f32 v136, v136, v6
v_add_f32 v137, v137, v7
v_lshlrev_b32 v8, 16, v33
v_and_b32 v9, 0xffff0000, v33
v_add_f32 v138, v138, v8
v_add_f32 v139, v139, v9
v_lshlrev_b32 v6, 16, v34
v_and_b32 v7, 0xffff0000, v34
v_add_f32 v140, v140, v6
v_add_f32 v141, v141, v7
v_lshlrev_b32 v8, 16, v35
v_and_b32 v9, 0xffff0000, v35
v_add_f32 v142, v142, v8
v_add_f32 v143, v143, v9
s_waitcnt vmcnt(14)
v_lshlrev_b32 v6, 16, v44
v_and_b32 v7, 0xffff0000, v44
v_add_f32 v136, v136, v6
v_add_f32 v137, v137, v7
v_lshlrev_b32 v8, 16, v45
v_and_b32 v9, 0xffff0000, v45
v_add_f32 v138, v138, v8
v_add_f32 v139, v139, v9
v_lshlrev_b32 v6, 16, v46
v_and_b32 v7, 0xffff0000, v46
v_add_f32 v140, v140, v6
v_add_f32 v141, v141, v7
v_lshlrev_b32 v8, 16, v47
v_and_b32 v9, 0xffff0000, v47
v_add_f32 v142, v142, v8
v_add_f32 v143, v143, v9
s_waitcnt vmcnt(13)
v_lshlrev_b32 v6, 16, v56
v_and_b32 v7, 0xffff0000, v56
v_add_f32 v136, v136, v6
v_add_f32 v137, v137, v7
v_lshlrev_b32 v8, 16, v57
v_and_b32 v9, 0xffff0000, v57
v_add_f32 v138, v138, v8
v_add_f32 v139, v139, v9
v_lshlrev_b32 v6, 16, v58
v_and_b32 v7, 0xffff0000, v58
v_add_f32 v140, v140, v6
v_add_f32 v141, v141, v7
v_lshlrev_b32 v8, 16, v59
v_and_b32 v9, 0xffff0000, v59
v_add_f32 v142, v142, v8
v_add_f32 v143, v143, v9
s_waitcnt vmcnt(12)
v_lshlrev_b32 v6, 16, v68
v_and_b32 v7, 0xffff0000, v68
v_add_f32 v136, v136, v6
v_add_f32 v137, v137, v7
v_lshlrev_b32 v8, 16, v69
v_and_b32 v9, 0xffff0000, v69
v_add_f32 v138, v138, v8
v_add_f32 v139, v139, v9
v_lshlrev_b32 v6, 16, v70
v_and_b32 v7, 0xffff0000, v70
v_add_f32 v140, v140, v6
v_add_f32 v141, v141, v7
v_lshlrev_b32 v8, 16, v71
v_and_b32 v9, 0xffff0000, v71
v_add_f32 v142, v142, v8
v_add_f32 v143, v143, v9
s_waitcnt vmcnt(11)
v_lshlrev_b32 v6, 16, v80
v_and_b32 v7, 0xffff0000, v80
v_add_f32 v136, v136, v6
v_add_f32 v137, v137, v7
v_lshlrev_b32 v8, 16, v81
v_and_b32 v9, 0xffff0000, v81
v_add_f32 v138, v138, v8
v_add_f32 v139, v139, v9
v_lshlrev_b32 v6, 16, v82
v_and_b32 v7, 0xffff0000, v82
v_add_f32 v140, v140, v6
v_add_f32 v141, v141, v7
v_lshlrev_b32 v8, 16, v83
v_and_b32 v9, 0xffff0000, v83
v_add_f32 v142, v142, v8
v_add_f32 v143, v143, v9
s_waitcnt vmcnt(10)
v_lshlrev_b32 v6, 16, v92
v_and_b32 v7, 0xffff0000, v92
v_add_f32 v136, v136, v6
v_add_f32 v137, v137, v7
v_lshlrev_b32 v8, 16, v93
v_and_b32 v9, 0xffff0000, v93
v_add_f32 v138, v138, v8
v_add_f32 v139, v139, v9
v_lshlrev_b32 v6, 16, v94
v_and_b32 v7, 0xffff0000, v94
v_add_f32 v140, v140, v6
v_add_f32 v141, v141, v7
v_lshlrev_b32 v8, 16, v95
v_and_b32 v9, 0xffff0000, v95
v_add_f32 v142, v142, v8
v_add_f32 v143, v143, v9
s_waitcnt vmcnt(9)
v_lshlrev_b32 v6, 16, v104
v_and_b32 v7, 0xffff0000, v104
v_add_f32 v136, v136, v6
v_add_f32 v137, v137, v7
v_lshlrev_b32 v8, 16, v105
v_and_b32 v9, 0xffff0000, v105
v_add_f32 v138, v138, v8
v_add_f32 v139, v139, v9
v_lshlrev_b32 v6, 16, v106
v_and_b32 v7, 0xffff0000, v106
v_add_f32 v140, v140, v6
v_add_f32 v141, v141, v7
v_lshlrev_b32 v8, 16, v107
v_and_b32 v9, 0xffff0000, v107
v_add_f32 v142, v142, v8
v_add_f32 v143, v143, v9
s_waitcnt vmcnt(8)
v_lshlrev_b32 v6, 16, v116
v_and_b32 v7, 0xffff0000, v116
v_add_f32 v136, v136, v6
v_add_f32 v137, v137, v7
v_lshlrev_b32 v8, 16, v117
v_and_b32 v9, 0xffff0000, v117
v_add_f32 v138, v138, v8
v_add_f32 v139, v139, v9
v_lshlrev_b32 v6, 16, v118
v_and_b32 v7, 0xffff0000, v118
v_add_f32 v140, v140, v6
v_add_f32 v141, v141, v7
v_lshlrev_b32 v8, 16, v119
v_and_b32 v9, 0xffff0000, v119
v_add_f32 v142, v142, v8
v_add_f32 v143, v143, v9
s_waitcnt vmcnt(7)
v_lshlrev_b32 v6, 16, v36
v_and_b32 v7, 0xffff0000, v36
v_add_f32 v144, v144, v6
v_add_f32 v145, v145, v7
v_lshlrev_b32 v8, 16, v37
v_and_b32 v9, 0xffff0000, v37
v_add_f32 v146, v146, v8
v_add_f32 v147, v147, v9
v_lshlrev_b32 v6, 16, v38
v_and_b32 v7, 0xffff0000, v38
v_add_f32 v148, v148, v6
v_add_f32 v149, v149, v7
v_lshlrev_b32 v8, 16, v39
v_and_b32 v9, 0xffff0000, v39
v_add_f32 v150, v150, v8
v_add_f32 v151, v151, v9
s_waitcnt vmcnt(6)
v_lshlrev_b32 v6, 16, v48
v_and_b32 v7, 0xffff0000, v48
v_add_f32 v144, v144, v6
v_add_f32 v145, v145, v7
v_lshlrev_b32 v8, 16, v49
v_and_b32 v9, 0xffff0000, v49
v_add_f32 v146, v146, v8
v_add_f32 v147, v147, v9
v_lshlrev_b32 v6, 16, v50
v_and_b32 v7, 0xffff0000, v50
v_add_f32 v148, v148, v6
v_add_f32 v149, v149, v7
v_lshlrev_b32 v8, 16, v51
v_and_b32 v9, 0xffff0000, v51
v_add_f32 v150, v150, v8
v_add_f32 v151, v151, v9
s_waitcnt vmcnt(5)
v_lshlrev_b32 v6, 16, v60
v_and_b32 v7, 0xffff0000, v60
v_add_f32 v144, v144, v6
v_add_f32 v145, v145, v7
v_lshlrev_b32 v8, 16, v61
v_and_b32 v9, 0xffff0000, v61
v_add_f32 v146, v146, v8
v_add_f32 v147, v147, v9
v_lshlrev_b32 v6, 16, v62
v_and_b32 v7, 0xffff0000, v62
v_add_f32 v148, v148, v6
v_add_f32 v149, v149, v7
v_lshlrev_b32 v8, 16, v63
v_and_b32 v9, 0xffff0000, v63
v_add_f32 v150, v150, v8
v_add_f32 v151, v151, v9
s_waitcnt vmcnt(4)
v_lshlrev_b32 v6, 16, v72
v_and_b32 v7, 0xffff0000, v72
v_add_f32 v144, v144, v6
v_add_f32 v145, v145, v7
v_lshlrev_b32 v8, 16, v73
v_and_b32 v9, 0xffff0000, v73
v_add_f32 v146, v146, v8
v_add_f32 v147, v147, v9
v_lshlrev_b32 v6, 16, v74
v_and_b32 v7, 0xffff0000, v74
v_add_f32 v148, v148, v6
v_add_f32 v149, v149, v7
v_lshlrev_b32 v8, 16, v75
v_and_b32 v9, 0xffff0000, v75
v_add_f32 v150, v150, v8
v_add_f32 v151, v151, v9
s_waitcnt vmcnt(3)
v_lshlrev_b32 v6, 16, v84
v_and_b32 v7, 0xffff0000, v84
v_add_f32 v144, v144, v6
v_add_f32 v145, v145, v7
v_lshlrev_b32 v8, 16, v85
v_and_b32 v9, 0xffff0000, v85
v_add_f32 v146, v146, v8
v_add_f32 v147, v147, v9
v_lshlrev_b32 v6, 16, v86
v_and_b32 v7, 0xffff0000, v86
v_add_f32 v148, v148, v6
v_add_f32 v149, v149, v7
v_lshlrev_b32 v8, 16, v87
v_and_b32 v9, 0xffff0000, v87
v_add_f32 v150, v150, v8
v_add_f32 v151, v151, v9
s_waitcnt vmcnt(2)
v_lshlrev_b32 v6, 16, v96
v_and_b32 v7, 0xffff0000, v96
v_add_f32 v144, v144, v6
v_add_f32 v145, v145, v7
v_lshlrev_b32 v8, 16, v97
v_and_b32 v9, 0xffff0000, v97
v_add_f32 v146, v146, v8
v_add_f32 v147, v147, v9
v_lshlrev_b32 v6, 16, v98
v_and_b32 v7, 0xffff0000, v98
v_add_f32 v148, v148, v6
v_add_f32 v149, v149, v7
v_lshlrev_b32 v8, 16, v99
v_and_b32 v9, 0xffff0000, v99
v_add_f32 v150, v150, v8
v_add_f32 v151, v151, v9
s_waitcnt vmcnt(1)
v_lshlrev_b32 v6, 16, v108
v_and_b32 v7, 0xffff0000, v108
v_add_f32 v144, v144, v6
v_add_f32 v145, v145, v7
v_lshlrev_b32 v8, 16, v109
v_and_b32 v9, 0xffff0000, v109
v_add_f32 v146, v146, v8
v_add_f32 v147, v147, v9
v_lshlrev_b32 v6, 16, v110
v_and_b32 v7, 0xffff0000, v110
v_add_f32 v148, v148, v6
v_add_f32 v149, v149, v7
v_lshlrev_b32 v8, 16, v111
v_and_b32 v9, 0xffff0000, v111
v_add_f32 v150, v150, v8
v_add_f32 v151, v151, v9
s_waitcnt vmcnt(0)
v_lshlrev_b32 v6, 16, v120
v_and_b32 v7, 0xffff0000, v120
v_add_f32 v144, v144, v6
v_add_f32 v145, v145, v7
v_lshlrev_b32 v8, 16, v121
v_and_b32 v9, 0xffff0000, v121
v_add_f32 v146, v146, v8
v_add_f32 v147, v147, v9
v_lshlrev_b32 v6, 16, v122
v_and_b32 v7, 0xffff0000, v122
v_add_f32 v148, v148, v6
v_add_f32 v149, v149, v7
v_lshlrev_b32 v8, 16, v123
v_and_b32 v9, 0xffff0000, v123
v_add_f32 v150, v150, v8
v_add_f32 v151, v151, v9
v_cvt_pk_bf16_f32 v152, v128, v129
v_cvt_pk_bf16_f32 v153, v130, v131
v_cvt_pk_bf16_f32 v154, v132, v133
v_cvt_pk_bf16_f32 v155, v134, v135
v_cvt_pk_bf16_f32 v156, v136, v137
v_cvt_pk_bf16_f32 v157, v138, v139
v_cvt_pk_bf16_f32 v158, v140, v141
v_cvt_pk_bf16_f32 v159, v142, v143
v_cvt_pk_bf16_f32 v160, v144, v145
v_cvt_pk_bf16_f32 v161, v146, v147
v_cvt_pk_bf16_f32 v162, v148, v149
v_cvt_pk_bf16_f32 v163, v150, v151
buffer_store_dwordx4 v[152:155], v5, s[16:19], s31 offen
buffer_store_dwordx4 v[156:159], v5, s[16:19], s32 offen
buffer_store_dwordx4 v[160:163], v5, s[16:19], s33 offen
L_end:
s_endpgm
L_f_slow1:
s_mov_b32 s52, 0
L_f_spin1:
buffer_load_dwordx2 v[14:15], v11, s[8:11], s23 offen sc1
s_add_u32 s52, s52, 1
s_waitcnt vmcnt(0)
v_cmp_eq_u64 vcc, s[68:69], v[14:15]
s_cmp_gt_u32 s52, 1048576
s_cbranch_scc1 L_f_back1
s_cmp_eq_u64 vcc, exec
s_cbranch_scc0 L_f_spin1
s_branch L_f_back1
L_f_slow2:
s_mov_b32 s52, 0
L_f_spin2:
buffer_load_dwordx2 v[14:15], v11, s[8:11], s23 offen sc1
s_add_u32 s52, s52, 1
s_waitcnt vmcnt(0)
v_cmp_eq_u64 vcc, s[68:69], v[14:15]
s_cmp_gt_u32 s52, 1048576
s_cbranch_scc1 L_f_back2
s_cmp_eq_u64 vcc, exec
s_cbranch_scc0 L_f_spin2
s_branch L_f_back2
L_f_slow3:
s_mov_b32 s52, 0
L_f_spin3:
buffer_load_dwordx2 v[14:15], v11, s[8:11], s23 offen sc1
s_add_u32 s52, s52, 1
s_waitcnt vmcnt(0)
v_cmp_eq_u64 vcc, s[68:69], v[14:15]
s_cmp_gt_u32 s52, 1048576
s_cbranch_scc1 L_f_back3
s_cmp_eq_u64 vcc, exec
s_cbranch_scc0 L_f_spin3
s_branch L_f_back3
L_re_slow4:
s_mov_b32 s52, 0
L_poll5:
buffer_load_dwordx2 v[14:15], v6, s[8:11], s27 offen sc1
s_add_u32 s52, s52, 1
s_waitcnt vmcnt(0)
v_cmp_ne_u64 vcc, s[68:69], v[14:15]
s_cmp_ge_u32 s52, 1048576
s_cbranch_scc1 L_got5
s_and_b64 exec, exec, vcc
s_cbranch_execnz L_poll5
L_got5:
s_mov_b64 exec, -1
s_branch L_re_back4
L_re_slow8:
s_mov_b32 s52, 0
L_poll9:
buffer_load_dwordx2 v[14:15], v6, s[8:11], s27 offen sc1
s_add_u32 s52, s52, 1
s_waitcnt vmcnt(0)
v_cmp_ne_u64 vcc, s[68:69], v[14:15]
s_cmp_ge_u32 s52, 1048576
s_cbranch_scc1 L_got9
s_and_b64 exec, exec, vcc
s_cbranch_execnz L_poll9
L_got9:
s_mov_b64 exec, -1
s_branch L_re_back8
L_epoch:
v_mov_b32 v13, 2146435072
v_cmp_gt_u32 vcc, 16, v0
v_lshlrev_b32 v14, 3, v0
s_nop 0
v_cndmask_b32 v13, v13, v14, vcc
v_mov_b32 v14, s68
v_mov_b32 v15, s69
s_waitcnt vmcnt(0)
s_barrier
buffer_store_dwordx2 v[14:15], v13, s[8:11], s14 offen sc1
s_cmp_lg_u32 s2, 0
s_cbranch_scc1 L_end
v_lshlrev_b32 v4, 7, v1
s_mov_b32 s40, 393216
s_mov_b32 s52, 0
L_poll11:
buffer_load_dwordx2 v[14:15], v4, s[8:11], s40 offen sc1
s_add_u32 s52, s52, 1
s_waitcnt vmcnt(0)
v_cmp_ne_u64 vcc, s[68:69], v[14:15]
s_cmp_ge_u32 s52, 1048576
s_cbranch_scc1 L_got11
s_and_b64 exec, exec, vcc
s_cbranch_execnz L_poll11
L_got11:
L_hop14:
s_cmp_eq_u32 s15, 1
s_cbranch_scc1 L_hop_done
s_mov_b64 exec, -1
s_mov_b32 s40, 401408
s_mov_b32 s52, 0
L_poll12:
buffer_load_dwordx2 v[14:15], v4, s[8:11], s40 offen sc1
s_add_u32 s52, s52, 1
s_waitcnt vmcnt(0)
v_cmp_ne_u64 vcc, s[68:69], v[14:15]
s_cmp_ge_u32 s52, 1048576
s_cbranch_scc1 L_got12
s_and_b64 exec, exec, vcc
s_cbranch_execnz L_poll12
L_got12:
s_mov_b64 exec, -1
s_mov_b32 s40, 409600
s_mov_b32 s52, 0
L_poll13:
buffer_load_dwordx2 v[14:15], v4, s[8:11], s40 offen sc1
s_add_u32 s52, s52, 1
s_waitcnt vmcnt(0)
v_cmp_ne_u64 vcc, s[68:69], v[14:15]
s_cmp_ge_u32 s52, 1048576
s_cbranch_scc1 L_got13
s_and_b64 exec, exec, vcc
s_cbranch_execnz L_poll13
L_got13:
s_mov_b64 exec, -1
s_mov_b32 s40, 417792
s_mov_b32 s52, 0
L_poll14:
buffer_load_dwordx2 v[14:15], v4, s[8:11], s40 offen sc1
s_add_u32 s52, s52, 1
s_waitcnt vmcnt(0)
v_cmp_ne_u64 vcc, s[68:69], v[14:15]
s_cmp_ge_u32 s52, 1048576
s_cbranch_scc1 L_got14
s_and_b64 exec, exec, vcc
s_cbranch_execnz L_poll14
L_got14:
s_mov_b64 exec, -1
s_mov_b32 s40, 4194304
v_mov_b32 v13, 2146435072
v_cmp_gt_u32 vcc, 16, v1
v_lshlrev_b32 v14, 3, v1
s_nop 0
v_cndmask_b32 v13, v13, v14, vcc
v_mov_b32 v14, s68
v_mov_b32 v15, s69
buffer_store_dwordx2 v[14:15], v13, s[8:11], s40 offen sc1
s_branch L_end
L_code_end:
s_endpgm
.section .rodata,"a"
.p2align 6
.amdhsa_kernel interleave_layers__sliding_local_dilated__glu_gated_geglu__prompt_kernel
  .amdhsa_next_free_vgpr 512
  .amdhsa_next_free_sgpr 102
  .amdhsa_accum_offset 256
  .amdhsa_group_segment_fixed_size 0
  .amdhsa_kernarg_size 80
  .amdhsa_user_sgpr_count 2
  .amdhsa_user_sgpr_kernarg_segment_ptr 1
  .amdhsa_system_sgpr_workgroup_id_x 1
.end_amdhsa_kernel
```

```asm
; @launch grid=(256,1,1) block=(256,1,1) lds=160768
.amdgcn_target "amdgcn-amd-amdhsa--gfx950"
.text
.p2align 8
.globl interleave_layers__sliding_local_dilated__glu_gated_geglu__prompt_kernel
.type interleave_layers__sliding_local_dilated__glu_gated_geglu__prompt_kernel,@function
interleave_layers__sliding_local_dilated__glu_gated_geglu__prompt_kernel:
s_cmp_ge_u32 s2, 256
s_cbranch_scc1 L_end
s_getpc_b64 s[40:41]
L_warm_pc:
s_lshr_b32 s42, s2, 3
s_lshl_b32 s42, s42, 11
v_lshlrev_b32 v10, 3, v0
v_add_u32 v10, s42, v10
v_min_u32 v10, L_code_end - L_warm_pc - 8, v10
v_mov_b32 v11, s41
v_add_co_u32 v10, vcc, s40, v10
s_nop 1
v_addc_co_u32 v11, vcc, 0, v11, vcc
global_load_dwordx2 a[0:1], v[10:11], off
v_add_co_u32 v10, vcc, 0x10000, v10
s_nop 1
v_addc_co_u32 v11, vcc, 0, v11, vcc
s_add_u32 s42, s42, 67584
s_cmp_le_u32 s42, L_code_end - L_warm_pc - 8
s_cbranch_scc0 L_warm_done
global_load_dwordx2 a[2:3], v[10:11], off
L_warm_done:
s_load_dwordx4 s[56:59], s[0:1], 0
s_load_dwordx2 s[60:61], s[0:1], 16
s_load_dwordx4 s[64:67], s[0:1], 32
s_load_dwordx2 s[62:63], s[0:1], 48
s_load_dwordx2 s[12:13], s[0:1], 72
v_and_b32 v1, 63, v0
v_lshrrev_b32 v3, 6, v0
v_lshlrev_b32 v2, 4, v1
v_readfirstlane_b32 s4, v3
s_and_b32 s5, s2, 7
s_lshr_b32 s6, s2, 3
s_waitcnt lgkmcnt(0)
s_mov_b32 s8, s12
s_and_b32 s9, s13, 0xffff
s_mov_b32 s10, 268435456
s_mov_b32 s11, 0x20000
s_mov_b32 s16, s56
s_and_b32 s17, s57, 0xffff
s_mov_b32 s18, 2359296
s_mov_b32 s19, 0x20000
v_mov_b32 v3, 4194304
buffer_load_dwordx2 v[14:15], v3, s[8:11], 0 offen sc1
v_and_b32 v6, 15, v1
v_lshrrev_b32 v7, 4, v1
v_lshrrev_b32 v8, 2, v6
v_mov_b32 v12, 2146435072
s_mov_b32 s37, 0
s_cmp_lt_u32 s2, 144
s_cbranch_scc0 L_p0_0
s_mul_i32 s40, s2, 911
s_lshr_b32 s40, s40, 16
s_mul_i32 s41, s40, 72
s_sub_u32 s41, s2, s41
s_cmp_eq_u32 s40, 0
s_cselect_b64 s[12:13], s[64:65], s[66:67]
s_mov_b32 s48, s12
s_and_b32 s49, s13, 0xffff
s_mov_b32 s50, 5308416
s_mov_b32 s51, 0x20000
s_lshl_b32 s42, s41, 7
v_lshlrev_b32 v9, 3, v6
v_mul_u32_u24 v10, 73728, v7
v_add3_u32 v4, v9, v10, s42
s_bitcmp1_b32 s4, 0
s_cselect_b64 vcc, -1, 0
v_cndmask_b32 v5, v4, v12, vcc
s_mul_i32 s43, s4, 9
s_add_u32 s43, s43, 1
s_lshr_b32 s43, s43, 1
s_mul_i32 s53, s43, 294912
s_mul_i32 s42, s41, 7282
s_lshr_b32 s42, s42, 16
s_mul_i32 s35, s42, 9
s_sub_u32 s41, s41, s35
s_lshl_b32 s41, s41, 2
s_lshl_b32 s42, s42, 2
s_lshl_b32 s40, s40, 11
s_add_u32 s40, s40, 7012352
s_mov_b32 s35, 497664
v_and_b32 v6, 3, v1
v_add_u32 v6, s41, v6
v_mul_u32_u24 v7, 57, v6
v_lshrrev_b32 v7, 9, v7
v_mul_u32_u24 v8, 9, v7
v_sub_u32 v6, v6, v8
v_subrev_u32 v8, 1, v6
v_min_u32 v8, 8, v8
v_and_b32 v9, 1, v7
v_cmp_eq_u32 vcc, 1, v9
s_nop 1
v_cndmask_b32 v6, v6, v8, vcc
v_add_u32 v7, s42, v7
v_mul_lo_u32 v7, v7, s35
v_add_u32 v7, s40, v7
v_lshrrev_b32 v8, 2, v1
v_add_u32 v8, s43, v8
v_and_b32 v9, 1, v8
v_lshl_add_u32 v7, v9, 10, v7
v_lshrrev_b32 v9, 1, v8
v_lshlrev_b32 v9, 12, v9
v_add_u32 v7, v7, v9
v_lshl_add_u32 v9, v6, 12, v9
v_mul_u32_u24 v10, 36864, v6
v_cmp_gt_u32 vcc, 2, v6
s_nop 1
v_cndmask_b32 v9, v10, v9, vcc
v_add_u32 v7, v7, v9
v_cmp_gt_u32 vcc, 18, v8
s_nop 1
v_cndmask_b32 v7, v12, v7, vcc
s_bitcmp1_b32 s4, 0
s_cselect_b32 s41, 16, 20
v_cmp_gt_u32 vcc, s41, v1
s_nop 1
v_cndmask_b32 v7, v12, v7, vcc
s_nop 0
v_readlane_b32 s40, v7, 0
v_readlane_b32 s41, v7, 1
v_readlane_b32 s42, v7, 2
v_readlane_b32 s43, v7, 3
v_add_u32 v156, s40, v2
v_add_u32 v157, s41, v2
v_add_u32 v158, s42, v2
v_add_u32 v159, s43, v2
v_readlane_b32 s40, v7, 4
v_readlane_b32 s41, v7, 5
v_readlane_b32 s42, v7, 6
v_readlane_b32 s43, v7, 7
v_add_u32 v160, s40, v2
v_add_u32 v161, s41, v2
v_add_u32 v162, s42, v2
v_add_u32 v163, s43, v2
v_readlane_b32 s40, v7, 8
v_readlane_b32 s41, v7, 9
v_readlane_b32 s42, v7, 10
v_readlane_b32 s43, v7, 11
v_add_u32 v164, s40, v2
v_add_u32 v165, s41, v2
v_add_u32 v166, s42, v2
v_add_u32 v167, s43, v2
v_readlane_b32 s40, v7, 12
v_readlane_b32 s41, v7, 13
v_readlane_b32 s42, v7, 14
v_readlane_b32 s43, v7, 15
v_add_u32 v168, s40, v2
v_add_u32 v169, s41, v2
v_add_u32 v170, s42, v2
v_add_u32 v171, s43, v2
v_readlane_b32 s40, v7, 16
v_readlane_b32 s41, v7, 17
v_readlane_b32 s42, v7, 18
v_readlane_b32 s43, v7, 19
v_add_u32 v172, s40, v2
v_add_u32 v173, s41, v2
v_add_u32 v174, s42, v2
v_add_u32 v175, s43, v2
s_mov_b32 s15, 2
s_branch L_hop_enter
L_w1_cont:
s_mov_b32 s15, 0
buffer_load_dwordx2 v[76:77], v4, s[48:51], s53 offen
s_add_u32 s53, s53, 9216
buffer_load_dwordx2 v[78:79], v4, s[48:51], s53 offen
s_add_u32 s53, s53, 9216
buffer_load_dwordx2 v[80:81], v4, s[48:51], s53 offen
s_add_u32 s53, s53, 9216
buffer_load_dwordx2 v[82:83], v4, s[48:51], s53 offen
s_add_u32 s53, s53, 9216
buffer_load_dwordx2 v[84:85], v4, s[48:51], s53 offen
s_add_u32 s53, s53, 9216
buffer_load_dwordx2 v[86:87], v4, s[48:51], s53 offen
s_add_u32 s53, s53, 9216
buffer_load_dwordx2 v[88:89], v4, s[48:51], s53 offen
s_add_u32 s53, s53, 9216
buffer_load_dwordx2 v[90:91], v4, s[48:51], s53 offen
s_add_u32 s53, s53, 230400
buffer_load_dwordx2 v[92:93], v4, s[48:51], s53 offen
s_add_u32 s53, s53, 9216
buffer_load_dwordx2 v[94:95], v4, s[48:51], s53 offen
s_add_u32 s53, s53, 9216
buffer_load_dwordx2 v[96:97], v4, s[48:51], s53 offen
s_add_u32 s53, s53, 9216
buffer_load_dwordx2 v[98:99], v4, s[48:51], s53 offen
s_add_u32 s53, s53, 9216
buffer_load_dwordx2 v[100:101], v4, s[48:51], s53 offen
s_add_u32 s53, s53, 9216
buffer_load_dwordx2 v[102:103], v4, s[48:51], s53 offen
s_add_u32 s53, s53, 9216
buffer_load_dwordx2 v[104:105], v4, s[48:51], s53 offen
s_add_u32 s53, s53, 9216
buffer_load_dwordx2 v[106:107], v4, s[48:51], s53 offen
s_add_u32 s53, s53, 230400
s_mov_b32 s34, 0x05040100
s_mov_b32 s35, 0x07060302
s_mov_b32 s38, 0x00003f80
s_mov_b32 s39, 0x3f800000
v_mov_b32 v68, 0x3f803f80
v_mov_b32 v69, 0x3f803f80
v_mov_b32 v70, 0x3f803f80
v_mov_b32 v71, 0x3f803f80
v_and_b32 v72, 15, v1
v_lshlrev_b32 v72, 4, v72
v_add_u32 v72, 159744, v72
s_lshl_b32 s44, s4, 2
v_add_u32 v73, s44, v72
s_waitcnt vmcnt(8)
buffer_load_dwordx2 v[108:109], v4, s[48:51], s53 offen
s_add_u32 s53, s53, 9216
buffer_load_dwordx2 v[110:111], v4, s[48:51], s53 offen
s_add_u32 s53, s53, 9216
buffer_load_dwordx2 v[112:113], v4, s[48:51], s53 offen
s_add_u32 s53, s53, 9216
buffer_load_dwordx2 v[114:115], v4, s[48:51], s53 offen
s_add_u32 s53, s53, 9216
buffer_load_dwordx2 v[116:117], v4, s[48:51], s53 offen
s_add_u32 s53, s53, 9216
buffer_load_dwordx2 v[118:119], v4, s[48:51], s53 offen
s_add_u32 s53, s53, 9216
buffer_load_dwordx2 v[120:121], v4, s[48:51], s53 offen
s_add_u32 s53, s53, 9216
buffer_load_dwordx2 v[122:123], v4, s[48:51], s53 offen
s_add_u32 s53, s53, 230400
v_perm_b32 v176, v78, v76, s34
v_perm_b32 v177, v82, v80, s34
v_perm_b32 v178, v86, v84, s34
v_perm_b32 v179, v90, v88, s34
v_perm_b32 v180, v78, v76, s35
v_perm_b32 v181, v82, v80, s35
v_perm_b32 v182, v86, v84, s35
v_perm_b32 v183, v90, v88, s35
v_perm_b32 v184, v79, v77, s34
v_perm_b32 v185, v83, v81, s34
v_perm_b32 v186, v87, v85, s34
v_perm_b32 v187, v91, v89, s34
v_perm_b32 v188, v79, v77, s35
v_perm_b32 v189, v83, v81, s35
v_perm_b32 v190, v87, v85, s35
v_perm_b32 v191, v91, v89, s35
v_mfma_f32_16x16x32_bf16 v[52:55], v[68:71], v[176:179], 0
v_mfma_f32_16x16x32_bf16 v[56:59], v[68:71], v[180:183], 0
v_mfma_f32_16x16x32_bf16 v[60:63], v[68:71], v[184:187], 0
v_mfma_f32_16x16x32_bf16 v[64:67], v[68:71], v[188:191], 0
s_waitcnt vmcnt(8)
buffer_load_dwordx2 v[124:125], v4, s[48:51], s53 offen
s_add_u32 s53, s53, 9216
buffer_load_dwordx2 v[126:127], v4, s[48:51], s53 offen
s_add_u32 s53, s53, 9216
buffer_load_dwordx2 v[128:129], v4, s[48:51], s53 offen
s_add_u32 s53, s53, 9216
buffer_load_dwordx2 v[130:131], v4, s[48:51], s53 offen
s_add_u32 s53, s53, 9216
buffer_load_dwordx2 v[132:133], v4, s[48:51], s53 offen
s_add_u32 s53, s53, 9216
buffer_load_dwordx2 v[134:135], v4, s[48:51], s53 offen
s_add_u32 s53, s53, 9216
buffer_load_dwordx2 v[136:137], v4, s[48:51], s53 offen
s_add_u32 s53, s53, 9216
buffer_load_dwordx2 v[138:139], v4, s[48:51], s53 offen
s_add_u32 s53, s53, 230400
v_perm_b32 v192, v94, v92, s34
v_perm_b32 v193, v98, v96, s34
v_perm_b32 v194, v102, v100, s34
v_perm_b32 v195, v106, v104, s34
v_perm_b32 v196, v94, v92, s35
v_perm_b32 v197, v98, v96, s35
v_perm_b32 v198, v102, v100, s35
v_perm_b32 v199, v106, v104, s35
v_perm_b32 v200, v95, v93, s34
v_perm_b32 v201, v99, v97, s34
v_perm_b32 v202, v103, v101, s34
v_perm_b32 v203, v107, v105, s34
v_perm_b32 v204, v95, v93, s35
v_perm_b32 v205, v99, v97, s35
v_perm_b32 v206, v103, v101, s35
v_perm_b32 v207, v107, v105, s35
v_mfma_f32_16x16x32_bf16 v[52:55], v[68:71], v[192:195], v[52:55]
v_mfma_f32_16x16x32_bf16 v[56:59], v[68:71], v[196:199], v[56:59]
v_mfma_f32_16x16x32_bf16 v[60:63], v[68:71], v[200:203], v[60:63]
v_mfma_f32_16x16x32_bf16 v[64:67], v[68:71], v[204:207], v[64:67]
s_waitcnt vmcnt(8)
buffer_load_dwordx2 v[140:141], v5, s[48:51], s53 offen
s_add_u32 s53, s53, 9216
buffer_load_dwordx2 v[142:143], v5, s[48:51], s53 offen
s_add_u32 s53, s53, 9216
buffer_load_dwordx2 v[144:145], v5, s[48:51], s53 offen
s_add_u32 s53, s53, 9216
buffer_load_dwordx2 v[146:147], v5, s[48:51], s53 offen
s_add_u32 s53, s53, 9216
buffer_load_dwordx2 v[148:149], v5, s[48:51], s53 offen
s_add_u32 s53, s53, 9216
buffer_load_dwordx2 v[150:151], v5, s[48:51], s53 offen
s_add_u32 s53, s53, 9216
buffer_load_dwordx2 v[152:153], v5, s[48:51], s53 offen
s_add_u32 s53, s53, 9216
buffer_load_dwordx2 v[154:155], v5, s[48:51], s53 offen
s_add_u32 s53, s53, 230400
v_perm_b32 v208, v110, v108, s34
v_perm_b32 v209, v114, v112, s34
v_perm_b32 v210, v118, v116, s34
v_perm_b32 v211, v122, v120, s34
v_perm_b32 v212, v110, v108, s35
v_perm_b32 v213, v114, v112, s35
v_perm_b32 v214, v118, v116, s35
v_perm_b32 v215, v122, v120, s35
v_perm_b32 v216, v111, v109, s34
v_perm_b32 v217, v115, v113, s34
v_perm_b32 v218, v119, v117, s34
v_perm_b32 v219, v123, v121, s34
v_perm_b32 v220, v111, v109, s35
v_perm_b32 v221, v115, v113, s35
v_perm_b32 v222, v119, v117, s35
v_perm_b32 v223, v123, v121, s35
v_mfma_f32_16x16x32_bf16 v[52:55], v[68:71], v[208:211], v[52:55]
v_mfma_f32_16x16x32_bf16 v[56:59], v[68:71], v[212:215], v[56:59]
v_mfma_f32_16x16x32_bf16 v[60:63], v[68:71], v[216:219], v[60:63]
v_mfma_f32_16x16x32_bf16 v[64:67], v[68:71], v[220:223], v[64:67]
s_waitcnt vmcnt(8)
v_perm_b32 v224, v126, v124, s34
v_perm_b32 v225, v130, v128, s34
v_perm_b32 v226, v134, v132, s34
v_perm_b32 v227, v138, v136, s34
v_perm_b32 v228, v126, v124, s35
v_perm_b32 v229, v130, v128, s35
v_perm_b32 v230, v134, v132, s35
v_perm_b32 v231, v138, v136, s35
v_perm_b32 v232, v127, v125, s34
v_perm_b32 v233, v131, v129, s34
v_perm_b32 v234, v135, v133, s34
v_perm_b32 v235, v139, v137, s34
v_perm_b32 v236, v127, v125, s35
v_perm_b32 v237, v131, v129, s35
v_perm_b32 v238, v135, v133, s35
v_perm_b32 v239, v139, v137, s35
v_mfma_f32_16x16x32_bf16 v[52:55], v[68:71], v[224:227], v[52:55]
v_mfma_f32_16x16x32_bf16 v[56:59], v[68:71], v[228:231], v[56:59]
v_mfma_f32_16x16x32_bf16 v[60:63], v[68:71], v[232:235], v[60:63]
v_mfma_f32_16x16x32_bf16 v[64:67], v[68:71], v[236:239], v[64:67]
s_waitcnt vmcnt(0)
v_perm_b32 v240, v142, v140, s34
v_perm_b32 v241, v146, v144, s34
v_perm_b32 v242, v150, v148, s34
v_perm_b32 v243, v154, v152, s34
v_perm_b32 v244, v142, v140, s35
v_perm_b32 v245, v146, v144, s35
v_perm_b32 v246, v150, v148, s35
v_perm_b32 v247, v154, v152, s35
v_perm_b32 v248, v143, v141, s34
v_perm_b32 v249, v147, v145, s34
v_perm_b32 v250, v151, v149, s34
v_perm_b32 v251, v155, v153, s34
v_perm_b32 v252, v143, v141, s35
v_perm_b32 v253, v147, v145, s35
v_perm_b32 v254, v151, v149, s35
v_perm_b32 v255, v155, v153, s35
v_mfma_f32_16x16x32_bf16 v[52:55], v[68:71], v[240:243], v[52:55]
v_mfma_f32_16x16x32_bf16 v[56:59], v[68:71], v[244:247], v[56:59]
v_mfma_f32_16x16x32_bf16 v[60:63], v[68:71], v[248:251], v[60:63]
v_mfma_f32_16x16x32_bf16 v[64:67], v[68:71], v[252:255], v[64:67]
v_readfirstlane_b32 s12, v14
v_readfirstlane_b32 s13, v15
s_add_u32 s68, s12, 1
s_addc_u32 s69, s13, 0
s_nop 0
ds_write_b32 v73, v52 offset:0
ds_write_b32 v73, v56 offset:256
ds_write_b32 v73, v60 offset:512
ds_write_b32 v73, v64 offset:768
s_waitcnt lgkmcnt(0)
s_barrier
ds_read_b128 v[52:55], v72 offset:0
ds_read_b128 v[56:59], v72 offset:256
ds_read_b128 v[60:63], v72 offset:512
ds_read_b128 v[64:67], v72 offset:768
s_waitcnt lgkmcnt(0)
v_add_f32 v52, v52, v53
v_add_f32 v54, v54, v55
v_add_f32 v56, v56, v57
v_add_f32 v58, v58, v59
v_add_f32 v60, v60, v61
v_add_f32 v62, v62, v63
v_add_f32 v64, v64, v65
v_add_f32 v66, v66, v67
v_add_f32 v52, v52, v54
v_add_f32 v56, v56, v58
v_add_f32 v60, v60, v62
v_add_f32 v64, v64, v66
v_mul_f32 v20, 0xbae38e39, v52
v_mul_f32 v21, 0xbae38e39, v56
v_mul_f32 v22, 0xbae38e39, v60
v_mul_f32 v23, 0xbae38e39, v64
v_dot2_f32_bf16 v24, v176, s38, v20
v_dot2_f32_bf16 v25, v176, s39, v20
v_dot2_f32_bf16 v26, v177, s38, v20
v_dot2_f32_bf16 v27, v177, s39, v20
v_dot2_f32_bf16 v28, v178, s38, v20
v_dot2_f32_bf16 v29, v178, s39, v20
v_dot2_f32_bf16 v30, v179, s38, v20
v_dot2_f32_bf16 v31, v179, s39, v20
v_cvt_pk_bf16_f32 v176, v24, v25
v_cvt_pk_bf16_f32 v177, v26, v27
v_cvt_pk_bf16_f32 v178, v28, v29
v_cvt_pk_bf16_f32 v179, v30, v31
v_dot2_f32_bf16 v36, v180, s38, v21
v_dot2_f32_bf16 v37, v180, s39, v21
v_dot2_f32_bf16 v38, v181, s38, v21
v_dot2_f32_bf16 v39, v181, s39, v21
v_dot2_f32_bf16 v40, v182, s38, v21
v_dot2_f32_bf16 v41, v182, s39, v21
v_dot2_f32_bf16 v42, v183, s38, v21
v_dot2_f32_bf16 v43, v183, s39, v21
v_cvt_pk_bf16_f32 v180, v36, v37
v_cvt_pk_bf16_f32 v181, v38, v39
v_cvt_pk_bf16_f32 v182, v40, v41
v_cvt_pk_bf16_f32 v183, v42, v43
v_dot2_f32_bf16 v24, v184, s38, v22
v_dot2_f32_bf16 v25, v184, s39, v22
v_dot2_f32_bf16 v26, v185, s38, v22
v_dot2_f32_bf16 v27, v185, s39, v22
v_dot2_f32_bf16 v28, v186, s38, v22
v_dot2_f32_bf16 v29, v186, s39, v22
v_dot2_f32_bf16 v30, v187, s38, v22
v_dot2_f32_bf16 v31, v187, s39, v22
v_cvt_pk_bf16_f32 v184, v24, v25
v_cvt_pk_bf16_f32 v185, v26, v27
v_cvt_pk_bf16_f32 v186, v28, v29
v_cvt_pk_bf16_f32 v187, v30, v31
v_dot2_f32_bf16 v36, v188, s38, v23
v_dot2_f32_bf16 v37, v188, s39, v23
v_dot2_f32_bf16 v38, v189, s38, v23
v_dot2_f32_bf16 v39, v189, s39, v23
v_dot2_f32_bf16 v40, v190, s38, v23
v_dot2_f32_bf16 v41, v190, s39, v23
v_dot2_f32_bf16 v42, v191, s38, v23
v_dot2_f32_bf16 v43, v191, s39, v23
v_cvt_pk_bf16_f32 v188, v36, v37
v_cvt_pk_bf16_f32 v189, v38, v39
v_cvt_pk_bf16_f32 v190, v40, v41
v_cvt_pk_bf16_f32 v191, v42, v43
v_dot2_f32_bf16 v24, v192, s38, v20
v_dot2_f32_bf16 v25, v192, s39, v20
v_dot2_f32_bf16 v26, v193, s38, v20
v_dot2_f32_bf16 v27, v193, s39, v20
v_dot2_f32_bf16 v28, v194, s38, v20
v_dot2_f32_bf16 v29, v194, s39, v20
v_dot2_f32_bf16 v30, v195, s38, v20
v_dot2_f32_bf16 v31, v195, s39, v20
v_cvt_pk_bf16_f32 v192, v24, v25
v_cvt_pk_bf16_f32 v193, v26, v27
v_cvt_pk_bf16_f32 v194, v28, v29
v_cvt_pk_bf16_f32 v195, v30, v31
v_dot2_f32_bf16 v36, v196, s38, v21
v_dot2_f32_bf16 v37, v196, s39, v21
v_dot2_f32_bf16 v38, v197, s38, v21
v_dot2_f32_bf16 v39, v197, s39, v21
v_dot2_f32_bf16 v40, v198, s38, v21
v_dot2_f32_bf16 v41, v198, s39, v21
v_dot2_f32_bf16 v42, v199, s38, v21
v_dot2_f32_bf16 v43, v199, s39, v21
v_cvt_pk_bf16_f32 v196, v36, v37
v_cvt_pk_bf16_f32 v197, v38, v39
v_cvt_pk_bf16_f32 v198, v40, v41
v_cvt_pk_bf16_f32 v199, v42, v43
v_dot2_f32_bf16 v24, v200, s38, v22
v_dot2_f32_bf16 v25, v200, s39, v22
v_dot2_f32_bf16 v26, v201, s38, v22
v_dot2_f32_bf16 v27, v201, s39, v22
v_dot2_f32_bf16 v28, v202, s38, v22
v_dot2_f32_bf16 v29, v202, s39, v22
v_dot2_f32_bf16 v30, v203, s38, v22
v_dot2_f32_bf16 v31, v203, s39, v22
v_cvt_pk_bf16_f32 v200, v24, v25
v_cvt_pk_bf16_f32 v201, v26, v27
v_cvt_pk_bf16_f32 v202, v28, v29
v_cvt_pk_bf16_f32 v203, v30, v31
v_dot2_f32_bf16 v36, v204, s38, v23
v_dot2_f32_bf16 v37, v204, s39, v23
v_dot2_f32_bf16 v38, v205, s38, v23
v_dot2_f32_bf16 v39, v205, s39, v23
v_dot2_f32_bf16 v40, v206, s38, v23
v_dot2_f32_bf16 v41, v206, s39, v23
v_dot2_f32_bf16 v42, v207, s38, v23
v_dot2_f32_bf16 v43, v207, s39, v23
v_cvt_pk_bf16_f32 v204, v36, v37
v_cvt_pk_bf16_f32 v205, v38, v39
v_cvt_pk_bf16_f32 v206, v40, v41
v_cvt_pk_bf16_f32 v207, v42, v43
v_dot2_f32_bf16 v24, v208, s38, v20
v_dot2_f32_bf16 v25, v208, s39, v20
v_dot2_f32_bf16 v26, v209, s38, v20
v_dot2_f32_bf16 v27, v209, s39, v20
v_dot2_f32_bf16 v28, v210, s38, v20
v_dot2_f32_bf16 v29, v210, s39, v20
v_dot2_f32_bf16 v30, v211, s38, v20
v_dot2_f32_bf16 v31, v211, s39, v20
v_cvt_pk_bf16_f32 v208, v24, v25
v_cvt_pk_bf16_f32 v209, v26, v27
v_cvt_pk_bf16_f32 v210, v28, v29
v_cvt_pk_bf16_f32 v211, v30, v31
v_dot2_f32_bf16 v36, v212, s38, v21
v_dot2_f32_bf16 v37, v212, s39, v21
v_dot2_f32_bf16 v38, v213, s38, v21
v_dot2_f32_bf16 v39, v213, s39, v21
v_dot2_f32_bf16 v40, v214, s38, v21
v_dot2_f32_bf16 v41, v214, s39, v21
v_dot2_f32_bf16 v42, v215, s38, v21
v_dot2_f32_bf16 v43, v215, s39, v21
v_cvt_pk_bf16_f32 v212, v36, v37
v_cvt_pk_bf16_f32 v213, v38, v39
v_cvt_pk_bf16_f32 v214, v40, v41
v_cvt_pk_bf16_f32 v215, v42, v43
v_dot2_f32_bf16 v24, v216, s38, v22
v_dot2_f32_bf16 v25, v216, s39, v22
v_dot2_f32_bf16 v26, v217, s38, v22
v_dot2_f32_bf16 v27, v217, s39, v22
v_dot2_f32_bf16 v28, v218, s38, v22
v_dot2_f32_bf16 v29, v218, s39, v22
v_dot2_f32_bf16 v30, v219, s38, v22
v_dot2_f32_bf16 v31, v219, s39, v22
v_cvt_pk_bf16_f32 v216, v24, v25
v_cvt_pk_bf16_f32 v217, v26, v27
v_cvt_pk_bf16_f32 v218, v28, v29
v_cvt_pk_bf16_f32 v219, v30, v31
v_dot2_f32_bf16 v36, v220, s38, v23
v_dot2_f32_bf16 v37, v220, s39, v23
v_dot2_f32_bf16 v38, v221, s38, v23
v_dot2_f32_bf16 v39, v221, s39, v23
v_dot2_f32_bf16 v40, v222, s38, v23
v_dot2_f32_bf16 v41, v222, s39, v23
v_dot2_f32_bf16 v42, v223, s38, v23
v_dot2_f32_bf16 v43, v223, s39, v23
v_cvt_pk_bf16_f32 v220, v36, v37
v_cvt_pk_bf16_f32 v221, v38, v39
v_cvt_pk_bf16_f32 v222, v40, v41
v_cvt_pk_bf16_f32 v223, v42, v43
v_dot2_f32_bf16 v24, v224, s38, v20
v_dot2_f32_bf16 v25, v224, s39, v20
v_dot2_f32_bf16 v26, v225, s38, v20
v_dot2_f32_bf16 v27, v225, s39, v20
v_dot2_f32_bf16 v28, v226, s38, v20
v_dot2_f32_bf16 v29, v226, s39, v20
v_dot2_f32_bf16 v30, v227, s38, v20
v_dot2_f32_bf16 v31, v227, s39, v20
v_cvt_pk_bf16_f32 v224, v24, v25
v_cvt_pk_bf16_f32 v225, v26, v27
v_cvt_pk_bf16_f32 v226, v28, v29
v_cvt_pk_bf16_f32 v227, v30, v31
v_dot2_f32_bf16 v36, v228, s38, v21
v_dot2_f32_bf16 v37, v228, s39, v21
v_dot2_f32_bf16 v38, v229, s38, v21
v_dot2_f32_bf16 v39, v229, s39, v21
v_dot2_f32_bf16 v40, v230, s38, v21
v_dot2_f32_bf16 v41, v230, s39, v21
v_dot2_f32_bf16 v42, v231, s38, v21
v_dot2_f32_bf16 v43, v231, s39, v21
v_cvt_pk_bf16_f32 v228, v36, v37
v_cvt_pk_bf16_f32 v229, v38, v39
v_cvt_pk_bf16_f32 v230, v40, v41
v_cvt_pk_bf16_f32 v231, v42, v43
v_dot2_f32_bf16 v24, v232, s38, v22
v_dot2_f32_bf16 v25, v232, s39, v22
v_dot2_f32_bf16 v26, v233, s38, v22
v_dot2_f32_bf16 v27, v233, s39, v22
v_dot2_f32_bf16 v28, v234, s38, v22
v_dot2_f32_bf16 v29, v234, s39, v22
v_dot2_f32_bf16 v30, v235, s38, v22
v_dot2_f32_bf16 v31, v235, s39, v22
v_cvt_pk_bf16_f32 v232, v24, v25
v_cvt_pk_bf16_f32 v233, v26, v27
v_cvt_pk_bf16_f32 v234, v28, v29
v_cvt_pk_bf16_f32 v235, v30, v31
v_dot2_f32_bf16 v36, v236, s38, v23
v_dot2_f32_bf16 v37, v236, s39, v23
v_dot2_f32_bf16 v38, v237, s38, v23
v_dot2_f32_bf16 v39, v237, s39, v23
v_dot2_f32_bf16 v40, v238, s38, v23
v_dot2_f32_bf16 v41, v238, s39, v23
v_dot2_f32_bf16 v42, v239, s38, v23
v_dot2_f32_bf16 v43, v239, s39, v23
v_cvt_pk_bf16_f32 v236, v36, v37
v_cvt_pk_bf16_f32 v237, v38, v39
v_cvt_pk_bf16_f32 v238, v40, v41
v_cvt_pk_bf16_f32 v239, v42, v43
v_dot2_f32_bf16 v24, v240, s38, v20
v_dot2_f32_bf16 v25, v240, s39, v20
v_dot2_f32_bf16 v26, v241, s38, v20
v_dot2_f32_bf16 v27, v241, s39, v20
v_dot2_f32_bf16 v28, v242, s38, v20
v_dot2_f32_bf16 v29, v242, s39, v20
v_dot2_f32_bf16 v30, v243, s38, v20
v_dot2_f32_bf16 v31, v243, s39, v20
v_cvt_pk_bf16_f32 v240, v24, v25
v_cvt_pk_bf16_f32 v241, v26, v27
v_cvt_pk_bf16_f32 v242, v28, v29
v_cvt_pk_bf16_f32 v243, v30, v31
v_dot2_f32_bf16 v36, v244, s38, v21
v_dot2_f32_bf16 v37, v244, s39, v21
v_dot2_f32_bf16 v38, v245, s38, v21
v_dot2_f32_bf16 v39, v245, s39, v21
v_dot2_f32_bf16 v40, v246, s38, v21
v_dot2_f32_bf16 v41, v246, s39, v21
v_dot2_f32_bf16 v42, v247, s38, v21
v_dot2_f32_bf16 v43, v247, s39, v21
v_cvt_pk_bf16_f32 v244, v36, v37
v_cvt_pk_bf16_f32 v245, v38, v39
v_cvt_pk_bf16_f32 v246, v40, v41
v_cvt_pk_bf16_f32 v247, v42, v43
v_dot2_f32_bf16 v24, v248, s38, v22
v_dot2_f32_bf16 v25, v248, s39, v22
v_dot2_f32_bf16 v26, v249, s38, v22
v_dot2_f32_bf16 v27, v249, s39, v22
v_dot2_f32_bf16 v28, v250, s38, v22
v_dot2_f32_bf16 v29, v250, s39, v22
v_dot2_f32_bf16 v30, v251, s38, v22
v_dot2_f32_bf16 v31, v251, s39, v22
v_cvt_pk_bf16_f32 v248, v24, v25
v_cvt_pk_bf16_f32 v249, v26, v27
v_cvt_pk_bf16_f32 v250, v28, v29
v_cvt_pk_bf16_f32 v251, v30, v31
v_dot2_f32_bf16 v36, v252, s38, v23
v_dot2_f32_bf16 v37, v252, s39, v23
v_dot2_f32_bf16 v38, v253, s38, v23
v_dot2_f32_bf16 v39, v253, s39, v23
v_dot2_f32_bf16 v40, v254, s38, v23
v_dot2_f32_bf16 v41, v254, s39, v23
v_dot2_f32_bf16 v42, v255, s38, v23
v_dot2_f32_bf16 v43, v255, s39, v23
v_cvt_pk_bf16_f32 v252, v36, v37
v_cvt_pk_bf16_f32 v253, v38, v39
v_cvt_pk_bf16_f32 v254, v40, v41
v_cvt_pk_bf16_f32 v255, v42, v43
s_branch L_hop_skip
s_branch L_p0_e
L_p0_0:
s_sub_u32 s39, s6, 18
s_lshl_b32 s39, s39, 2
s_add_u32 s39, s39, s4
s_cmp_lt_u32 s39, 32
s_cbranch_scc0 L_cr_0
v_and_b32 v9, 7, v1
v_lshrrev_b32 v10, 3, v1
v_mul_u32_u24 v5, 2304, v9
v_lshl_add_u32 v5, v10, 4, v5
s_lshl_b32 s36, s5, 8
s_lshl_b32 s37, s39, 3
s_add_u32 s36, s36, s37
s_and_b32 s37, s36, 1023
s_lshl_b32 s37, s37, 1
s_lshr_b32 s36, s36, 10
s_add_u32 s36, s36, s37
s_mul_i32 s36, s36, 1152
buffer_load_dwordx4 v[16:19], v5, s[16:19], s36 offen offset:0
buffer_load_dwordx4 v[20:23], v5, s[16:19], s36 offen offset:128
buffer_load_dwordx4 v[24:27], v5, s[16:19], s36 offen offset:256
buffer_load_dwordx4 v[28:31], v5, s[16:19], s36 offen offset:384
buffer_load_dwordx4 v[32:35], v5, s[16:19], s36 offen offset:512
buffer_load_dwordx4 v[36:39], v5, s[16:19], s36 offen offset:640
buffer_load_dwordx4 v[40:43], v5, s[16:19], s36 offen offset:768
buffer_load_dwordx4 v[44:47], v5, s[16:19], s36 offen offset:896
buffer_load_dwordx4 v[48:51], v5, s[16:19], s36 offen offset:1024
s_and_b32 s37, s39, 1
s_lshl_b32 s37, s37, 3
v_add_u32 v9, s37, v9
v_lshlrev_b32 v9, 4, v9
v_lshl_add_u32 v4, v10, 8, v9
s_lshl_b32 s36, s5, 4
s_lshr_b32 s37, s39, 1
s_add_u32 s36, s36, s37
s_mul_i32 s36, s36, 18432
s_lshr_b32 s40, s39, 2
s_mov_b32 s44, s58
s_and_b32 s45, s59, 0xffff
s_mov_b32 s46, 1990656
s_mov_b32 s47, 0x20000
s_mul_i32 s42, s40, 110592
s_mul_i32 s43, s4, 27648
s_add_u32 s42, s42, s43
s_mul_i32 s43, s5, 144
s_add_u32 s42, s42, s43
s_lshl_b32 s43, s4, 11
s_add_u32 s43, s43, 0
v_mul_u32_u24 v9, 3456, v7
v_lshl_add_u32 v9, v6, 4, v9
v_cmp_gt_u32 vcc, 9, v6
s_nop 1
v_cndmask_b32 v9, v12, v9, vcc
s_add_u32 m0, s43, 0
s_add_u32 s41, s42, 0
buffer_load_dwordx4 v9, s[44:47], s41 offen lds
s_add_u32 m0, s43, 1024
s_add_u32 s41, s42, 13824
buffer_load_dwordx4 v9, s[44:47], s41 offen lds
s_lshl_b32 s43, s4, 11
s_add_u32 s43, s43, 8192
s_add_u32 m0, s43, 0
s_add_u32 s41, s42, 1152
buffer_load_dwordx4 v9, s[44:47], s41 offen lds
s_add_u32 m0, s43, 1024
s_add_u32 s41, s42, 14976
buffer_load_dwordx4 v9, s[44:47], s41 offen lds
s_lshl_b32 s43, s4, 11
s_add_u32 s43, s43, 16384
s_add_u32 m0, s43, 0
s_add_u32 s41, s42, 2304
buffer_load_dwordx4 v9, s[44:47], s41 offen lds
s_add_u32 m0, s43, 1024
s_add_u32 s41, s42, 16128
buffer_load_dwordx4 v9, s[44:47], s41 offen lds
s_waitcnt vmcnt(6)
v_lshlrev_b32 v52, 16, v16
v_and_b32 v53, 0xffff0000, v16
v_lshlrev_b32 v54, 16, v17
v_and_b32 v55, 0xffff0000, v17
v_lshlrev_b32 v56, 16, v18
v_and_b32 v57, 0xffff0000, v18
v_lshlrev_b32 v58, 16, v19
v_and_b32 v59, 0xffff0000, v19
v_lshlrev_b32 v60, 16, v20
v_and_b32 v61, 0xffff0000, v20
v_lshlrev_b32 v62, 16, v21
v_and_b32 v63, 0xffff0000, v21
v_lshlrev_b32 v64, 16, v22
v_and_b32 v65, 0xffff0000, v22
v_lshlrev_b32 v66, 16, v23
v_and_b32 v67, 0xffff0000, v23
v_lshlrev_b32 v68, 16, v24
v_and_b32 v69, 0xffff0000, v24
v_lshlrev_b32 v70, 16, v25
v_and_b32 v71, 0xffff0000, v25
v_lshlrev_b32 v72, 16, v26
v_and_b32 v73, 0xffff0000, v26
v_lshlrev_b32 v74, 16, v27
v_and_b32 v75, 0xffff0000, v27
v_lshlrev_b32 v76, 16, v28
v_and_b32 v77, 0xffff0000, v28
v_lshlrev_b32 v78, 16, v29
v_and_b32 v79, 0xffff0000, v29
v_lshlrev_b32 v80, 16, v30
v_and_b32 v81, 0xffff0000, v30
v_lshlrev_b32 v82, 16, v31
v_and_b32 v83, 0xffff0000, v31
v_lshlrev_b32 v84, 16, v32
v_and_b32 v85, 0xffff0000, v32
v_lshlrev_b32 v86, 16, v33
v_and_b32 v87, 0xffff0000, v33
v_lshlrev_b32 v88, 16, v34
v_and_b32 v89, 0xffff0000, v34
v_lshlrev_b32 v90, 16, v35
v_and_b32 v91, 0xffff0000, v35
v_lshlrev_b32 v92, 16, v36
v_and_b32 v93, 0xffff0000, v36
v_lshlrev_b32 v94, 16, v37
v_and_b32 v95, 0xffff0000, v37
v_lshlrev_b32 v96, 16, v38
v_and_b32 v97, 0xffff0000, v38
v_lshlrev_b32 v98, 16, v39
v_and_b32 v99, 0xffff0000, v39
v_lshlrev_b32 v100, 16, v40
v_and_b32 v101, 0xffff0000, v40
v_lshlrev_b32 v102, 16, v41
v_and_b32 v103, 0xffff0000, v41
v_lshlrev_b32 v104, 16, v42
v_and_b32 v105, 0xffff0000, v42
v_lshlrev_b32 v106, 16, v43
v_and_b32 v107, 0xffff0000, v43
v_lshlrev_b32 v108, 16, v44
v_and_b32 v109, 0xffff0000, v44
v_lshlrev_b32 v110, 16, v45
v_and_b32 v111, 0xffff0000, v45
v_lshlrev_b32 v112, 16, v46
v_and_b32 v113, 0xffff0000, v46
v_lshlrev_b32 v114, 16, v47
v_and_b32 v115, 0xffff0000, v47
v_lshlrev_b32 v116, 16, v48
v_and_b32 v117, 0xffff0000, v48
v_lshlrev_b32 v118, 16, v49
v_and_b32 v119, 0xffff0000, v49
v_lshlrev_b32 v120, 16, v50
v_and_b32 v121, 0xffff0000, v50
v_lshlrev_b32 v122, 16, v51
v_and_b32 v123, 0xffff0000, v51
s_mov_b32 s37, 0x3f803f80
v_mov_b32 v6, 0
v_mov_b32 v7, 0
v_mov_b32 v8, 0
v_mov_b32 v9, 0
v_dot2_f32_bf16 v6, v16, s37, v6
v_dot2_f32_bf16 v8, v16, v16, v8
v_dot2_f32_bf16 v7, v17, s37, v7
v_dot2_f32_bf16 v9, v17, v17, v9
v_dot2_f32_bf16 v6, v18, s37, v6
v_dot2_f32_bf16 v8, v18, v18, v8
v_dot2_f32_bf16 v7, v19, s37, v7
v_dot2_f32_bf16 v9, v19, v19, v9
v_dot2_f32_bf16 v6, v20, s37, v6
v_dot2_f32_bf16 v8, v20, v20, v8
v_dot2_f32_bf16 v7, v21, s37, v7
v_dot2_f32_bf16 v9, v21, v21, v9
v_dot2_f32_bf16 v6, v22, s37, v6
v_dot2_f32_bf16 v8, v22, v22, v8
v_dot2_f32_bf16 v7, v23, s37, v7
v_dot2_f32_bf16 v9, v23, v23, v9
v_dot2_f32_bf16 v6, v24, s37, v6
v_dot2_f32_bf16 v8, v24, v24, v8
v_dot2_f32_bf16 v7, v25, s37, v7
v_dot2_f32_bf16 v9, v25, v25, v9
v_dot2_f32_bf16 v6, v26, s37, v6
v_dot2_f32_bf16 v8, v26, v26, v8
v_dot2_f32_bf16 v7, v27, s37, v7
v_dot2_f32_bf16 v9, v27, v27, v9
v_dot2_f32_bf16 v6, v28, s37, v6
v_dot2_f32_bf16 v8, v28, v28, v8
v_dot2_f32_bf16 v7, v29, s37, v7
v_dot2_f32_bf16 v9, v29, v29, v9
v_dot2_f32_bf16 v6, v30, s37, v6
v_dot2_f32_bf16 v8, v30, v30, v8
v_dot2_f32_bf16 v7, v31, s37, v7
v_dot2_f32_bf16 v9, v31, v31, v9
v_dot2_f32_bf16 v6, v32, s37, v6
v_dot2_f32_bf16 v8, v32, v32, v8
v_dot2_f32_bf16 v7, v33, s37, v7
v_dot2_f32_bf16 v9, v33, v33, v9
v_dot2_f32_bf16 v6, v34, s37, v6
v_dot2_f32_bf16 v8, v34, v34, v8
v_dot2_f32_bf16 v7, v35, s37, v7
v_dot2_f32_bf16 v9, v35, v35, v9
v_dot2_f32_bf16 v6, v36, s37, v6
v_dot2_f32_bf16 v8, v36, v36, v8
v_dot2_f32_bf16 v7, v37, s37, v7
v_dot2_f32_bf16 v9, v37, v37, v9
v_dot2_f32_bf16 v6, v38, s37, v6
v_dot2_f32_bf16 v8, v38, v38, v8
v_dot2_f32_bf16 v7, v39, s37, v7
v_dot2_f32_bf16 v9, v39, v39, v9
v_dot2_f32_bf16 v6, v40, s37, v6
v_dot2_f32_bf16 v8, v40, v40, v8
v_dot2_f32_bf16 v7, v41, s37, v7
v_dot2_f32_bf16 v9, v41, v41, v9
v_dot2_f32_bf16 v6, v42, s37, v6
v_dot2_f32_bf16 v8, v42, v42, v8
v_dot2_f32_bf16 v7, v43, s37, v7
v_dot2_f32_bf16 v9, v43, v43, v9
v_dot2_f32_bf16 v6, v44, s37, v6
v_dot2_f32_bf16 v8, v44, v44, v8
v_dot2_f32_bf16 v7, v45, s37, v7
v_dot2_f32_bf16 v9, v45, v45, v9
v_dot2_f32_bf16 v6, v46, s37, v6
v_dot2_f32_bf16 v8, v46, v46, v8
v_dot2_f32_bf16 v7, v47, s37, v7
v_dot2_f32_bf16 v9, v47, v47, v9
v_dot2_f32_bf16 v6, v48, s37, v6
v_dot2_f32_bf16 v8, v48, v48, v8
v_dot2_f32_bf16 v7, v49, s37, v7
v_dot2_f32_bf16 v9, v49, v49, v9
v_dot2_f32_bf16 v6, v50, s37, v6
v_dot2_f32_bf16 v8, v50, v50, v8
v_dot2_f32_bf16 v7, v51, s37, v7
v_dot2_f32_bf16 v9, v51, v51, v9
s_add_u32 s37, s36, 27688960
buffer_store_dwordx4 v[16:19], v4, s[8:11], s37 offen offset:0 sc1
buffer_store_dwordx4 v[20:23], v4, s[8:11], s37 offen offset:2048 sc1
s_add_u32 s37, s36, 27693056
buffer_store_dwordx4 v[24:27], v4, s[8:11], s37 offen offset:0 sc1
buffer_store_dwordx4 v[28:31], v4, s[8:11], s37 offen offset:2048 sc1
s_add_u32 s37, s36, 27697152
buffer_store_dwordx4 v[32:35], v4, s[8:11], s37 offen offset:0 sc1
buffer_store_dwordx4 v[36:39], v4, s[8:11], s37 offen offset:2048 sc1
s_add_u32 s37, s36, 27701248
buffer_store_dwordx4 v[40:43], v4, s[8:11], s37 offen offset:0 sc1
buffer_store_dwordx4 v[44:47], v4, s[8:11], s37 offen offset:2048 sc1
s_add_u32 s37, s36, 27705344
buffer_store_dwordx4 v[48:51], v4, s[8:11], s37 offen offset:0 sc1
v_add_f32 v6, v6, v7
v_add_f32 v7, v8, v9
s_nop 0
v_add_f32_dpp v6, v6, v6 row_ror:8 row_mask:0xf bank_mask:0xf
v_add_f32_dpp v7, v7, v7 row_ror:8 row_mask:0xf bank_mask:0xf
v_mov_b32 v8, v6
v_mov_b32 v9, v7
s_nop 0
v_permlane16_swap_b32 v6, v8
v_permlane16_swap_b32 v7, v9
v_add_f32 v6, v6, v8
v_add_f32 v7, v7, v9
v_mov_b32 v8, v6
v_mov_b32 v9, v7
s_nop 0
v_permlane32_swap_b32 v6, v8
v_permlane32_swap_b32 v7, v9
v_add_f32 v6, v6, v8
v_add_f32 v7, v7, v9
v_mul_f32 v6, 0x3ae38e39, v6
v_mul_f32 v7, 0x3ae38e39, v7
v_fma_f32 v7, -v6, v6, v7
v_max_f32 v7, 0, v7
v_add_f32 v7, 0x3727c5ac, v7
v_rsq_f32 v7, v7
s_nop 0
v_mul_f32 v6, v6, v7
v_fma_f32 v52, v52, v7, -v6
v_fma_f32 v53, v53, v7, -v6
v_fma_f32 v54, v54, v7, -v6
v_fma_f32 v55, v55, v7, -v6
v_fma_f32 v56, v56, v7, -v6
v_fma_f32 v57, v57, v7, -v6
v_fma_f32 v58, v58, v7, -v6
v_fma_f32 v59, v59, v7, -v6
v_fma_f32 v60, v60, v7, -v6
v_fma_f32 v61, v61, v7, -v6
v_fma_f32 v62, v62, v7, -v6
v_fma_f32 v63, v63, v7, -v6
v_fma_f32 v64, v64, v7, -v6
v_fma_f32 v65, v65, v7, -v6
v_fma_f32 v66, v66, v7, -v6
v_fma_f32 v67, v67, v7, -v6
v_fma_f32 v68, v68, v7, -v6
v_fma_f32 v69, v69, v7, -v6
v_fma_f32 v70, v70, v7, -v6
v_fma_f32 v71, v71, v7, -v6
v_fma_f32 v72, v72, v7, -v6
v_fma_f32 v73, v73, v7, -v6
v_fma_f32 v74, v74, v7, -v6
v_fma_f32 v75, v75, v7, -v6
v_fma_f32 v76, v76, v7, -v6
v_fma_f32 v77, v77, v7, -v6
v_fma_f32 v78, v78, v7, -v6
v_fma_f32 v79, v79, v7, -v6
v_fma_f32 v80, v80, v7, -v6
v_fma_f32 v81, v81, v7, -v6
v_fma_f32 v82, v82, v7, -v6
v_fma_f32 v83, v83, v7, -v6
v_fma_f32 v84, v84, v7, -v6
v_fma_f32 v85, v85, v7, -v6
v_fma_f32 v86, v86, v7, -v6
v_fma_f32 v87, v87, v7, -v6
v_fma_f32 v88, v88, v7, -v6
v_fma_f32 v89, v89, v7, -v6
v_fma_f32 v90, v90, v7, -v6
v_fma_f32 v91, v91, v7, -v6
v_fma_f32 v92, v92, v7, -v6
v_fma_f32 v93, v93, v7, -v6
v_fma_f32 v94, v94, v7, -v6
v_fma_f32 v95, v95, v7, -v6
v_fma_f32 v96, v96, v7, -v6
v_fma_f32 v97, v97, v7, -v6
v_fma_f32 v98, v98, v7, -v6
v_fma_f32 v99, v99, v7, -v6
v_fma_f32 v100, v100, v7, -v6
v_fma_f32 v101, v101, v7, -v6
v_fma_f32 v102, v102, v7, -v6
v_fma_f32 v103, v103, v7, -v6
v_fma_f32 v104, v104, v7, -v6
v_fma_f32 v105, v105, v7, -v6
v_fma_f32 v106, v106, v7, -v6
v_fma_f32 v107, v107, v7, -v6
v_fma_f32 v108, v108, v7, -v6
v_fma_f32 v109, v109, v7, -v6
v_fma_f32 v110, v110, v7, -v6
v_fma_f32 v111, v111, v7, -v6
v_fma_f32 v112, v112, v7, -v6
v_fma_f32 v113, v113, v7, -v6
v_fma_f32 v114, v114, v7, -v6
v_fma_f32 v115, v115, v7, -v6
v_fma_f32 v116, v116, v7, -v6
v_fma_f32 v117, v117, v7, -v6
v_fma_f32 v118, v118, v7, -v6
v_fma_f32 v119, v119, v7, -v6
v_fma_f32 v120, v120, v7, -v6
v_fma_f32 v121, v121, v7, -v6
v_fma_f32 v122, v122, v7, -v6
v_fma_f32 v123, v123, v7, -v6
v_cvt_pk_bf16_f32 v16, v52, v53
v_cvt_pk_bf16_f32 v17, v54, v55
v_cvt_pk_bf16_f32 v18, v56, v57
v_cvt_pk_bf16_f32 v19, v58, v59
v_cvt_pk_bf16_f32 v20, v60, v61
v_cvt_pk_bf16_f32 v21, v62, v63
v_cvt_pk_bf16_f32 v22, v64, v65
v_cvt_pk_bf16_f32 v23, v66, v67
v_cvt_pk_bf16_f32 v24, v68, v69
v_cvt_pk_bf16_f32 v25, v70, v71
v_cvt_pk_bf16_f32 v26, v72, v73
v_cvt_pk_bf16_f32 v27, v74, v75
v_cvt_pk_bf16_f32 v28, v76, v77
v_cvt_pk_bf16_f32 v29, v78, v79
v_cvt_pk_bf16_f32 v30, v80, v81
v_cvt_pk_bf16_f32 v31, v82, v83
v_cvt_pk_bf16_f32 v32, v84, v85
v_cvt_pk_bf16_f32 v33, v86, v87
v_cvt_pk_bf16_f32 v34, v88, v89
v_cvt_pk_bf16_f32 v35, v90, v91
v_cvt_pk_bf16_f32 v36, v92, v93
v_cvt_pk_bf16_f32 v37, v94, v95
v_cvt_pk_bf16_f32 v38, v96, v97
v_cvt_pk_bf16_f32 v39, v98, v99
v_cvt_pk_bf16_f32 v40, v100, v101
v_cvt_pk_bf16_f32 v41, v102, v103
v_cvt_pk_bf16_f32 v42, v104, v105
v_cvt_pk_bf16_f32 v43, v106, v107
v_cvt_pk_bf16_f32 v44, v108, v109
v_cvt_pk_bf16_f32 v45, v110, v111
v_cvt_pk_bf16_f32 v46, v112, v113
v_cvt_pk_bf16_f32 v47, v114, v115
v_cvt_pk_bf16_f32 v48, v116, v117
v_cvt_pk_bf16_f32 v49, v118, v119
v_cvt_pk_bf16_f32 v50, v120, v121
v_cvt_pk_bf16_f32 v51, v122, v123
s_add_u32 s37, s36, 22970368
buffer_store_dwordx4 v[16:19], v4, s[8:11], s37 offen offset:0 sc1
buffer_store_dwordx4 v[20:23], v4, s[8:11], s37 offen offset:2048 sc1
s_add_u32 s37, s36, 22974464
buffer_store_dwordx4 v[24:27], v4, s[8:11], s37 offen offset:0 sc1
buffer_store_dwordx4 v[28:31], v4, s[8:11], s37 offen offset:2048 sc1
s_add_u32 s37, s36, 22978560
buffer_store_dwordx4 v[32:35], v4, s[8:11], s37 offen offset:0 sc1
buffer_store_dwordx4 v[36:39], v4, s[8:11], s37 offen offset:2048 sc1
s_add_u32 s37, s36, 22982656
buffer_store_dwordx4 v[40:43], v4, s[8:11], s37 offen offset:0 sc1
buffer_store_dwordx4 v[44:47], v4, s[8:11], s37 offen offset:2048 sc1
s_add_u32 s37, s36, 22986752
buffer_store_dwordx4 v[48:51], v4, s[8:11], s37 offen offset:0 sc1
s_waitcnt vmcnt(18)
s_barrier
v_readfirstlane_b32 s12, v14
v_readfirstlane_b32 s13, v15
s_add_u32 s68, s12, 1
s_addc_u32 s69, s13, 0
s_and_b32 s41, s4, 1
s_mul_i32 s42, s41, 72
s_lshl_b32 s43, s5, 1
s_add_u32 s41, s41, s43
s_mul_i32 s41, s41, 129024
s_mul_i32 s43, s40, 7168
s_add_u32 s41, s41, s43
s_add_u32 s41, s41, 4198400
s_lshr_b32 s43, s4, 1
s_lshl_b32 s29, s43, 12
s_add_u32 s41, s41, s29
v_and_b32 v6, 15, v1
v_lshrrev_b32 v7, 4, v1
v_lshlrev_b32 v10, 11, v7
v_add_u32 v10, s42, v10
v_lshl_add_u32 v11, v6, 1, v10
v_and_b32 v9, 1, v6
v_bfe_u32 v13, v6, 1, 1
v_mad_u32_u24 v9, v13, 18, v9
v_lshl_add_u32 v9, v9, 1, v10
v_lshrrev_b32 v13, 2, v6
v_lshl_add_u32 v9, v13, 13, v9
v_add_u32 v9, 32, v9
v_mov_b32 v13, 160
v_cmp_gt_u32 vcc, 12, v6
s_nop 1
v_cndmask_b32 v9, v13, v9, vcc
s_cmp_eq_u32 s43, 0
s_cselect_b64 vcc, -1, 0
v_add_u32 v4, 0, v11
v_cndmask_b32 v4, v9, v4, vcc
v_add_u32 v5, 36, v11
v_add_u32 v13, 16384, v11
v_cndmask_b32 v5, v13, v5, vcc
v_add_u32 v6, 8192, v11
v_add_u32 v13, 16420, v11
v_cndmask_b32 v6, v13, v6, vcc
v_add_u32 v7, 8228, v11
v_add_u32 v13, 0, v11
v_cndmask_b32 v7, v13, v7, vcc
s_add_u32 s20, s41, 0
s_add_u32 s29, s40, 0
s_cmp_lt_u32 s29, 18
s_cselect_b32 s20, s20, 2146435072
s_cmp_eq_u32 s43, 0
s_cselect_b32 s21, s20, 2146435072
ds_read_u16 v124, v4 offset:0
ds_read_u16 v125, v4 offset:256
ds_read_u16 v126, v4 offset:512
ds_read_u16 v127, v4 offset:768
ds_read_u16 v128, v4 offset:1024
ds_read_u16 v129, v4 offset:1280
ds_read_u16 v130, v4 offset:1536
ds_read_u16 v131, v4 offset:1792
ds_read_u16 v132, v5 offset:0
ds_read_u16 v133, v5 offset:256
ds_read_u16 v134, v5 offset:512
ds_read_u16 v135, v5 offset:768
ds_read_u16 v136, v5 offset:1024
ds_read_u16 v137, v5 offset:1280
ds_read_u16 v138, v5 offset:1536
ds_read_u16 v139, v5 offset:1792
s_waitcnt lgkmcnt(8)
v_lshl_or_b32 v124, v125, 16, v124
v_lshl_or_b32 v125, v127, 16, v126
v_lshl_or_b32 v126, v129, 16, v128
v_lshl_or_b32 v127, v131, 16, v130
buffer_store_dwordx4 v[124:127], v2, s[8:11], s20 offen offset:0 sc1
ds_read_u16 v140, v6 offset:0
ds_read_u16 v141, v6 offset:256
ds_read_u16 v142, v6 offset:512
ds_read_u16 v143, v6 offset:768
ds_read_u16 v144, v6 offset:1024
ds_read_u16 v145, v6 offset:1280
ds_read_u16 v146, v6 offset:1536
ds_read_u16 v147, v6 offset:1792
s_waitcnt lgkmcnt(8)
v_lshl_or_b32 v132, v133, 16, v132
v_lshl_or_b32 v133, v135, 16, v134
v_lshl_or_b32 v134, v137, 16, v136
v_lshl_or_b32 v135, v139, 16, v138
buffer_store_dwordx4 v[132:135], v2, s[8:11], s20 offen offset:1024 sc1
ds_read_u16 v148, v7 offset:0
ds_read_u16 v149, v7 offset:256
ds_read_u16 v150, v7 offset:512
ds_read_u16 v151, v7 offset:768
ds_read_u16 v152, v7 offset:1024
ds_read_u16 v153, v7 offset:1280
ds_read_u16 v154, v7 offset:1536
ds_read_u16 v155, v7 offset:1792
s_waitcnt lgkmcnt(8)
v_lshl_or_b32 v140, v141, 16, v140
v_lshl_or_b32 v141, v143, 16, v142
v_lshl_or_b32 v142, v145, 16, v144
v_lshl_or_b32 v143, v147, 16, v146
buffer_store_dwordx4 v[140:143], v2, s[8:11], s20 offen offset:2048 sc1
s_waitcnt lgkmcnt(0)
v_lshl_or_b32 v148, v149, 16, v148
v_lshl_or_b32 v149, v151, 16, v150
v_lshl_or_b32 v150, v153, 16, v152
v_lshl_or_b32 v151, v155, 16, v154
buffer_store_dwordx4 v[148:151], v2, s[8:11], s21 offen offset:3072 sc1
s_branch L_cr_e
L_cr_0:
s_cmp_lt_u32 s39, 48
s_cbranch_scc0 L_cr_1
s_lshr_b32 s40, s39, 2
s_mul_i32 s40, s40, 3
s_sub_u32 s40, s40, 16
s_mov_b32 s44, s58
s_and_b32 s45, s59, 0xffff
s_mov_b32 s46, 1990656
s_mov_b32 s47, 0x20000
s_mul_i32 s42, s40, 110592
s_mul_i32 s43, s4, 27648
s_add_u32 s42, s42, s43
s_mul_i32 s43, s5, 144
s_add_u32 s42, s42, s43
s_lshl_b32 s43, s4, 11
s_add_u32 s43, s43, 0
v_mul_u32_u24 v9, 3456, v7
v_lshl_add_u32 v9, v6, 4, v9
v_cmp_gt_u32 vcc, 9, v6
s_nop 1
v_cndmask_b32 v9, v12, v9, vcc
s_add_u32 m0, s43, 0
s_add_u32 s41, s42, 0
buffer_load_dwordx4 v9, s[44:47], s41 offen lds
s_add_u32 m0, s43, 1024
s_add_u32 s41, s42, 13824
buffer_load_dwordx4 v9, s[44:47], s41 offen lds
s_lshl_b32 s43, s4, 11
s_add_u32 s43, s43, 8192
s_add_u32 m0, s43, 0
s_add_u32 s41, s42, 1152
buffer_load_dwordx4 v9, s[44:47], s41 offen lds
s_add_u32 m0, s43, 1024
s_add_u32 s41, s42, 14976
buffer_load_dwordx4 v9, s[44:47], s41 offen lds
s_lshl_b32 s43, s4, 11
s_add_u32 s43, s43, 16384
s_add_u32 m0, s43, 0
s_add_u32 s41, s42, 2304
buffer_load_dwordx4 v9, s[44:47], s41 offen lds
s_add_u32 m0, s43, 1024
s_add_u32 s41, s42, 16128
buffer_load_dwordx4 v9, s[44:47], s41 offen lds
s_lshl_b32 s43, s4, 11
s_add_u32 s43, s43, 24576
s_add_u32 m0, s43, 0
s_add_u32 s41, s42, 110592
buffer_load_dwordx4 v9, s[44:47], s41 offen lds
s_add_u32 m0, s43, 1024
s_add_u32 s41, s42, 124416
buffer_load_dwordx4 v9, s[44:47], s41 offen lds
s_lshl_b32 s43, s4, 11
s_add_u32 s43, s43, 32768
s_add_u32 m0, s43, 0
s_add_u32 s41, s42, 111744
buffer_load_dwordx4 v9, s[44:47], s41 offen lds
s_add_u32 m0, s43, 1024
s_add_u32 s41, s42, 125568
buffer_load_dwordx4 v9, s[44:47], s41 offen lds
s_lshl_b32 s43, s4, 11
s_add_u32 s43, s43, 40960
s_add_u32 m0, s43, 0
s_add_u32 s41, s42, 112896
buffer_load_dwordx4 v9, s[44:47], s41 offen lds
s_add_u32 m0, s43, 1024
s_add_u32 s41, s42, 126720
buffer_load_dwordx4 v9, s[44:47], s41 offen lds
s_lshl_b32 s43, s4, 11
s_add_u32 s43, s43, 49152
s_add_u32 m0, s43, 0
s_add_u32 s41, s42, 221184
buffer_load_dwordx4 v9, s[44:47], s41 offen lds
s_add_u32 m0, s43, 1024
s_add_u32 s41, s42, 235008
buffer_load_dwordx4 v9, s[44:47], s41 offen lds
s_lshl_b32 s43, s4, 11
s_add_u32 s43, s43, 57344
s_add_u32 m0, s43, 0
s_add_u32 s41, s42, 222336
buffer_load_dwordx4 v9, s[44:47], s41 offen lds
s_add_u32 m0, s43, 1024
s_add_u32 s41, s42, 236160
buffer_load_dwordx4 v9, s[44:47], s41 offen lds
s_lshl_b32 s43, s4, 11
s_add_u32 s43, s43, 65536
s_add_u32 m0, s43, 0
s_add_u32 s41, s42, 223488
buffer_load_dwordx4 v9, s[44:47], s41 offen lds
s_add_u32 m0, s43, 1024
s_add_u32 s41, s42, 237312
buffer_load_dwordx4 v9, s[44:47], s41 offen lds
s_waitcnt vmcnt(0)
s_barrier
v_readfirstlane_b32 s12, v14
v_readfirstlane_b32 s13, v15
s_add_u32 s68, s12, 1
s_addc_u32 s69, s13, 0
s_and_b32 s41, s4, 1
s_mul_i32 s42, s41, 72
s_lshl_b32 s43, s5, 1
s_add_u32 s41, s41, s43
s_mul_i32 s41, s41, 129024
s_mul_i32 s43, s40, 7168
s_add_u32 s41, s41, s43
s_add_u32 s41, s41, 4198400
s_lshr_b32 s43, s4, 1
s_lshl_b32 s29, s43, 12
s_add_u32 s41, s41, s29
v_and_b32 v6, 15, v1
v_lshrrev_b32 v7, 4, v1
v_lshlrev_b32 v10, 11, v7
v_add_u32 v10, s42, v10
v_lshl_add_u32 v11, v6, 1, v10
v_and_b32 v9, 1, v6
v_bfe_u32 v13, v6, 1, 1
v_mad_u32_u24 v9, v13, 18, v9
v_lshl_add_u32 v9, v9, 1, v10
v_lshrrev_b32 v13, 2, v6
v_lshl_add_u32 v9, v13, 13, v9
v_add_u32 v9, 32, v9
v_mov_b32 v13, 160
v_cmp_gt_u32 vcc, 12, v6
s_nop 1
v_cndmask_b32 v9, v13, v9, vcc
s_cmp_eq_u32 s43, 0
s_cselect_b64 vcc, -1, 0
v_add_u32 v4, 0, v11
v_cndmask_b32 v4, v9, v4, vcc
v_add_u32 v5, 36, v11
v_add_u32 v13, 16384, v11
v_cndmask_b32 v5, v13, v5, vcc
v_add_u32 v6, 8192, v11
v_add_u32 v13, 16420, v11
v_cndmask_b32 v6, v13, v6, vcc
v_add_u32 v7, 8228, v11
v_add_u32 v13, 0, v11
v_cndmask_b32 v7, v13, v7, vcc
s_add_u32 s20, s41, 0
s_add_u32 s29, s40, 0
s_cmp_lt_u32 s29, 18
s_cselect_b32 s20, s20, 2146435072
s_cmp_eq_u32 s43, 0
s_cselect_b32 s21, s20, 2146435072
s_add_u32 s22, s41, 7168
s_add_u32 s29, s40, 1
s_cmp_lt_u32 s29, 18
s_cselect_b32 s22, s22, 2146435072
s_cmp_eq_u32 s43, 0
s_cselect_b32 s23, s22, 2146435072
s_add_u32 s24, s41, 14336
s_add_u32 s29, s40, 2
s_cmp_lt_u32 s29, 18
s_cselect_b32 s24, s24, 2146435072
s_cmp_eq_u32 s43, 0
s_cselect_b32 s25, s24, 2146435072
ds_read_u16 v124, v4 offset:0
ds_read_u16 v125, v4 offset:256
ds_read_u16 v126, v4 offset:512
ds_read_u16 v127, v4 offset:768
ds_read_u16 v128, v4 offset:1024
ds_read_u16 v129, v4 offset:1280
ds_read_u16 v130, v4 offset:1536
ds_read_u16 v131, v4 offset:1792
ds_read_u16 v132, v5 offset:0
ds_read_u16 v133, v5 offset:256
ds_read_u16 v134, v5 offset:512
ds_read_u16 v135, v5 offset:768
ds_read_u16 v136, v5 offset:1024
ds_read_u16 v137, v5 offset:1280
ds_read_u16 v138, v5 offset:1536
ds_read_u16 v139, v5 offset:1792
s_waitcnt lgkmcnt(8)
v_lshl_or_b32 v124, v125, 16, v124
v_lshl_or_b32 v125, v127, 16, v126
v_lshl_or_b32 v126, v129, 16, v128
v_lshl_or_b32 v127, v131, 16, v130
buffer_store_dwordx4 v[124:127], v2, s[8:11], s20 offen offset:0 sc1
ds_read_u16 v140, v6 offset:0
ds_read_u16 v141, v6 offset:256
ds_read_u16 v142, v6 offset:512
ds_read_u16 v143, v6 offset:768
ds_read_u16 v144, v6 offset:1024
ds_read_u16 v145, v6 offset:1280
ds_read_u16 v146, v6 offset:1536
ds_read_u16 v147, v6 offset:1792
s_waitcnt lgkmcnt(8)
v_lshl_or_b32 v132, v133, 16, v132
v_lshl_or_b32 v133, v135, 16, v134
v_lshl_or_b32 v134, v137, 16, v136
v_lshl_or_b32 v135, v139, 16, v138
buffer_store_dwordx4 v[132:135], v2, s[8:11], s20 offen offset:1024 sc1
ds_read_u16 v148, v7 offset:0
ds_read_u16 v149, v7 offset:256
ds_read_u16 v150, v7 offset:512
ds_read_u16 v151, v7 offset:768
ds_read_u16 v152, v7 offset:1024
ds_read_u16 v153, v7 offset:1280
ds_read_u16 v154, v7 offset:1536
ds_read_u16 v155, v7 offset:1792
s_waitcnt lgkmcnt(8)
v_lshl_or_b32 v140, v141, 16, v140
v_lshl_or_b32 v141, v143, 16, v142
v_lshl_or_b32 v142, v145, 16, v144
v_lshl_or_b32 v143, v147, 16, v146
buffer_store_dwordx4 v[140:143], v2, s[8:11], s20 offen offset:2048 sc1
ds_read_u16 v124, v4 offset:24576
ds_read_u16 v125, v4 offset:24832
ds_read_u16 v126, v4 offset:25088
ds_read_u16 v127, v4 offset:25344
ds_read_u16 v128, v4 offset:25600
ds_read_u16 v129, v4 offset:25856
ds_read_u16 v130, v4 offset:26112
ds_read_u16 v131, v4 offset:26368
s_waitcnt lgkmcnt(8)
v_lshl_or_b32 v148, v149, 16, v148
v_lshl_or_b32 v149, v151, 16, v150
v_lshl_or_b32 v150, v153, 16, v152
v_lshl_or_b32 v151, v155, 16, v154
buffer_store_dwordx4 v[148:151], v2, s[8:11], s21 offen offset:3072 sc1
ds_read_u16 v132, v5 offset:24576
ds_read_u16 v133, v5 offset:24832
ds_read_u16 v134, v5 offset:25088
ds_read_u16 v135, v5 offset:25344
ds_read_u16 v136, v5 offset:25600
ds_read_u16 v137, v5 offset:25856
ds_read_u16 v138, v5 offset:26112
ds_read_u16 v139, v5 offset:26368
s_waitcnt lgkmcnt(8)
v_lshl_or_b32 v124, v125, 16, v124
v_lshl_or_b32 v125, v127, 16, v126
v_lshl_or_b32 v126, v129, 16, v128
v_lshl_or_b32 v127, v131, 16, v130
buffer_store_dwordx4 v[124:127], v2, s[8:11], s22 offen offset:0 sc1
ds_read_u16 v140, v6 offset:24576
ds_read_u16 v141, v6 offset:24832
ds_read_u16 v142, v6 offset:25088
ds_read_u16 v143, v6 offset:25344
ds_read_u16 v144, v6 offset:25600
ds_read_u16 v145, v6 offset:25856
ds_read_u16 v146, v6 offset:26112
ds_read_u16 v147, v6 offset:26368
s_waitcnt lgkmcnt(8)
v_lshl_or_b32 v132, v133, 16, v132
v_lshl_or_b32 v133, v135, 16, v134
v_lshl_or_b32 v134, v137, 16, v136
v_lshl_or_b32 v135, v139, 16, v138
buffer_store_dwordx4 v[132:135], v2, s[8:11], s22 offen offset:1024 sc1
ds_read_u16 v148, v7 offset:24576
ds_read_u16 v149, v7 offset:24832
ds_read_u16 v150, v7 offset:25088
ds_read_u16 v151, v7 offset:25344
ds_read_u16 v152, v7 offset:25600
ds_read_u16 v153, v7 offset:25856
ds_read_u16 v154, v7 offset:26112
ds_read_u16 v155, v7 offset:26368
s_waitcnt lgkmcnt(8)
v_lshl_or_b32 v140, v141, 16, v140
v_lshl_or_b32 v141, v143, 16, v142
v_lshl_or_b32 v142, v145, 16, v144
v_lshl_or_b32 v143, v147, 16, v146
buffer_store_dwordx4 v[140:143], v2, s[8:11], s22 offen offset:2048 sc1
ds_read_u16 v124, v4 offset:49152
ds_read_u16 v125, v4 offset:49408
ds_read_u16 v126, v4 offset:49664
ds_read_u16 v127, v4 offset:49920
ds_read_u16 v128, v4 offset:50176
ds_read_u16 v129, v4 offset:50432
ds_read_u16 v130, v4 offset:50688
ds_read_u16 v131, v4 offset:50944
s_waitcnt lgkmcnt(8)
v_lshl_or_b32 v148, v149, 16, v148
v_lshl_or_b32 v149, v151, 16, v150
v_lshl_or_b32 v150, v153, 16, v152
v_lshl_or_b32 v151, v155, 16, v154
buffer_store_dwordx4 v[148:151], v2, s[8:11], s23 offen offset:3072 sc1
ds_read_u16 v132, v5 offset:49152
ds_read_u16 v133, v5 offset:49408
ds_read_u16 v134, v5 offset:49664
ds_read_u16 v135, v5 offset:49920
ds_read_u16 v136, v5 offset:50176
ds_read_u16 v137, v5 offset:50432
ds_read_u16 v138, v5 offset:50688
ds_read_u16 v139, v5 offset:50944
s_waitcnt lgkmcnt(8)
v_lshl_or_b32 v124, v125, 16, v124
v_lshl_or_b32 v125, v127, 16, v126
v_lshl_or_b32 v126, v129, 16, v128
v_lshl_or_b32 v127, v131, 16, v130
buffer_store_dwordx4 v[124:127], v2, s[8:11], s24 offen offset:0 sc1
ds_read_u16 v140, v6 offset:49152
ds_read_u16 v141, v6 offset:49408
ds_read_u16 v142, v6 offset:49664
ds_read_u16 v143, v6 offset:49920
ds_read_u16 v144, v6 offset:50176
ds_read_u16 v145, v6 offset:50432
ds_read_u16 v146, v6 offset:50688
ds_read_u16 v147, v6 offset:50944
s_waitcnt lgkmcnt(8)
v_lshl_or_b32 v132, v133, 16, v132
v_lshl_or_b32 v133, v135, 16, v134
v_lshl_or_b32 v134, v137, 16, v136
v_lshl_or_b32 v135, v139, 16, v138
buffer_store_dwordx4 v[132:135], v2, s[8:11], s24 offen offset:1024 sc1
ds_read_u16 v148, v7 offset:49152
ds_read_u16 v149, v7 offset:49408
ds_read_u16 v150, v7 offset:49664
ds_read_u16 v151, v7 offset:49920
ds_read_u16 v152, v7 offset:50176
ds_read_u16 v153, v7 offset:50432
ds_read_u16 v154, v7 offset:50688
ds_read_u16 v155, v7 offset:50944
s_waitcnt lgkmcnt(8)
v_lshl_or_b32 v140, v141, 16, v140
v_lshl_or_b32 v141, v143, 16, v142
v_lshl_or_b32 v142, v145, 16, v144
v_lshl_or_b32 v143, v147, 16, v146
buffer_store_dwordx4 v[140:143], v2, s[8:11], s24 offen offset:2048 sc1
s_waitcnt lgkmcnt(0)
v_lshl_or_b32 v148, v149, 16, v148
v_lshl_or_b32 v149, v151, 16, v150
v_lshl_or_b32 v150, v153, 16, v152
v_lshl_or_b32 v151, v155, 16, v154
buffer_store_dwordx4 v[148:151], v2, s[8:11], s25 offen offset:3072 sc1
s_branch L_cr_e
L_cr_1:
s_lshr_b32 s40, s39, 2
s_sub_u32 s40, s40, 12
s_mov_b32 s44, s60
s_and_b32 s45, s61, 0xffff
s_mov_b32 s46, 663552
s_mov_b32 s47, 0x20000
s_mul_i32 s42, s40, 331776
s_mul_i32 s43, s4, 82944
s_add_u32 s42, s42, s43
s_mul_i32 s43, s5, 144
s_add_u32 s42, s42, s43
s_mul_i32 s43, s4, 18432
v_mul_u32_u24 v9, 1152, v7
v_lshl_add_u32 v9, v6, 4, v9
v_cmp_gt_u32 vcc, 9, v6
s_nop 1
v_cndmask_b32 v9, v12, v9, vcc
s_add_u32 m0, s43, 0
s_add_u32 s41, s42, 0
buffer_load_dwordx4 v9, s[44:47], s41 offen lds
s_add_u32 m0, s43, 1024
s_add_u32 s41, s42, 4608
buffer_load_dwordx4 v9, s[44:47], s41 offen lds
s_add_u32 m0, s43, 2048
s_add_u32 s41, s42, 9216
buffer_load_dwordx4 v9, s[44:47], s41 offen lds
s_add_u32 m0, s43, 3072
s_add_u32 s41, s42, 13824
buffer_load_dwordx4 v9, s[44:47], s41 offen lds
s_add_u32 m0, s43, 4096
s_add_u32 s41, s42, 18432
buffer_load_dwordx4 v9, s[44:47], s41 offen lds
s_add_u32 m0, s43, 5120
s_add_u32 s41, s42, 23040
buffer_load_dwordx4 v9, s[44:47], s41 offen lds
s_add_u32 m0, s43, 6144
s_add_u32 s41, s42, 27648
buffer_load_dwordx4 v9, s[44:47], s41 offen lds
s_add_u32 m0, s43, 7168
s_add_u32 s41, s42, 32256
buffer_load_dwordx4 v9, s[44:47], s41 offen lds
s_add_u32 m0, s43, 8192
s_add_u32 s41, s42, 36864
buffer_load_dwordx4 v9, s[44:47], s41 offen lds
s_add_u32 m0, s43, 9216
s_add_u32 s41, s42, 41472
buffer_load_dwordx4 v9, s[44:47], s41 offen lds
s_add_u32 m0, s43, 10240
s_add_u32 s41, s42, 46080
buffer_load_dwordx4 v9, s[44:47], s41 offen lds
s_add_u32 m0, s43, 11264
s_add_u32 s41, s42, 50688
buffer_load_dwordx4 v9, s[44:47], s41 offen lds
s_add_u32 m0, s43, 12288
s_add_u32 s41, s42, 55296
buffer_load_dwordx4 v9, s[44:47], s41 offen lds
s_add_u32 m0, s43, 13312
s_add_u32 s41, s42, 59904
buffer_load_dwordx4 v9, s[44:47], s41 offen lds
s_add_u32 m0, s43, 14336
s_add_u32 s41, s42, 64512
buffer_load_dwordx4 v9, s[44:47], s41 offen lds
s_add_u32 m0, s43, 15360
s_add_u32 s41, s42, 69120
buffer_load_dwordx4 v9, s[44:47], s41 offen lds
s_add_u32 m0, s43, 16384
s_add_u32 s41, s42, 73728
buffer_load_dwordx4 v9, s[44:47], s41 offen lds
s_add_u32 m0, s43, 17408
s_add_u32 s41, s42, 78336
buffer_load_dwordx4 v9, s[44:47], s41 offen lds
s_waitcnt vmcnt(0)
s_barrier
v_readfirstlane_b32 s12, v14
v_readfirstlane_b32 s13, v15
s_add_u32 s68, s12, 1
s_addc_u32 s69, s13, 0
s_mul_i32 s41, s5, 92160
s_add_u32 s41, s41, 6266880
s_lshl_b32 s42, s40, 3
s_lshl_b32 s43, s4, 1
s_add_u32 s42, s42, s43
s_mul_i32 s42, s42, 5120
s_add_u32 s20, s41, s42
s_add_u32 s21, s20, 4096
s_add_u32 s22, s20, 5120
s_add_u32 s23, s22, 4096
s_add_u32 s42, s40, 16
s_mul_i32 s42, s42, 5120
s_add_u32 s41, s41, s42
s_lshl_b32 s42, s4, 10
s_add_u32 s24, s41, s42
s_add_u32 s25, s41, 4096
s_cmp_eq_u32 s4, 0
s_cselect_b32 s25, s25, 2146435072
v_and_b32 v9, 3, v6
v_lshl_add_u32 v9, v8, 3, v9
v_lshlrev_b32 v9, 1, v9
v_lshlrev_b32 v10, 1, v6
v_add_u32 v10, 128, v10
v_mov_b32 v13, 160
v_cmp_gt_u32 vcc, 8, v6
s_nop 1
v_cndmask_b32 v10, v13, v10, vcc
s_mul_i32 s42, s4, 18432
v_lshlrev_b32 v11, 10, v7
v_add_u32 v11, s42, v11
v_add_u32 v4, v11, v9
v_add_u32 v5, v11, v10
v_mul_u32_u24 v11, 18432, v7
v_add_u32 v7, v11, v10
s_lshr_b32 s42, s4, 1
s_lshl_b32 s42, s42, 6
s_and_b32 s43, s4, 1
s_lshl_b32 s43, s43, 3
s_add_u32 s42, s42, s43
v_add3_u32 v6, v11, v9, s42
ds_read_u16 v124, v4 offset:0
ds_read_u16 v125, v4 offset:256
ds_read_u16 v126, v4 offset:512
ds_read_u16 v127, v4 offset:768
ds_read_u16 v128, v4 offset:4608
ds_read_u16 v129, v4 offset:4864
ds_read_u16 v130, v4 offset:5120
ds_read_u16 v131, v4 offset:5376
ds_read_u16 v132, v4 offset:8
ds_read_u16 v133, v4 offset:264
ds_read_u16 v134, v4 offset:520
ds_read_u16 v135, v4 offset:776
ds_read_u16 v136, v4 offset:4616
ds_read_u16 v137, v4 offset:4872
ds_read_u16 v138, v4 offset:5128
ds_read_u16 v139, v4 offset:5384
s_waitcnt lgkmcnt(8)
v_lshl_or_b32 v124, v125, 16, v124
v_lshl_or_b32 v125, v127, 16, v126
v_lshl_or_b32 v126, v129, 16, v128
v_lshl_or_b32 v127, v131, 16, v130
buffer_store_dwordx4 v[124:127], v2, s[8:11], s20 offen offset:0 sc1
ds_read_u16 v140, v4 offset:64
ds_read_u16 v141, v4 offset:320
ds_read_u16 v142, v4 offset:576
ds_read_u16 v143, v4 offset:832
ds_read_u16 v144, v4 offset:4672
ds_read_u16 v145, v4 offset:4928
ds_read_u16 v146, v4 offset:5184
ds_read_u16 v147, v4 offset:5440
s_waitcnt lgkmcnt(8)
v_lshl_or_b32 v132, v133, 16, v132
v_lshl_or_b32 v133, v135, 16, v134
v_lshl_or_b32 v134, v137, 16, v136
v_lshl_or_b32 v135, v139, 16, v138
buffer_store_dwordx4 v[132:135], v2, s[8:11], s20 offen offset:1024 sc1
ds_read_u16 v148, v4 offset:72
ds_read_u16 v149, v4 offset:328
ds_read_u16 v150, v4 offset:584
ds_read_u16 v151, v4 offset:840
ds_read_u16 v152, v4 offset:4680
ds_read_u16 v153, v4 offset:4936
ds_read_u16 v154, v4 offset:5192
ds_read_u16 v155, v4 offset:5448
s_waitcnt lgkmcnt(8)
v_lshl_or_b32 v140, v141, 16, v140
v_lshl_or_b32 v141, v143, 16, v142
v_lshl_or_b32 v142, v145, 16, v144
v_lshl_or_b32 v143, v147, 16, v146
buffer_store_dwordx4 v[140:143], v2, s[8:11], s20 offen offset:2048 sc1
ds_read_u16 v124, v5 offset:0
ds_read_u16 v125, v5 offset:256
ds_read_u16 v126, v5 offset:512
ds_read_u16 v127, v5 offset:768
ds_read_u16 v128, v5 offset:4608
ds_read_u16 v129, v5 offset:4864
ds_read_u16 v130, v5 offset:5120
ds_read_u16 v131, v5 offset:5376
s_waitcnt lgkmcnt(8)
v_lshl_or_b32 v148, v149, 16, v148
v_lshl_or_b32 v149, v151, 16, v150
v_lshl_or_b32 v150, v153, 16, v152
v_lshl_or_b32 v151, v155, 16, v154
buffer_store_dwordx4 v[148:151], v2, s[8:11], s20 offen offset:3072 sc1
ds_read_u16 v132, v4 offset:9216
ds_read_u16 v133, v4 offset:9472
ds_read_u16 v134, v4 offset:9728
ds_read_u16 v135, v4 offset:9984
ds_read_u16 v136, v4 offset:13824
ds_read_u16 v137, v4 offset:14080
ds_read_u16 v138, v4 offset:14336
ds_read_u16 v139, v4 offset:14592
s_waitcnt lgkmcnt(8)
v_lshl_or_b32 v124, v125, 16, v124
v_lshl_or_b32 v125, v127, 16, v126
v_lshl_or_b32 v126, v129, 16, v128
v_lshl_or_b32 v127, v131, 16, v130
buffer_store_dwordx4 v[124:127], v2, s[8:11], s21 offen offset:0 sc1
ds_read_u16 v140, v4 offset:9224
ds_read_u16 v141, v4 offset:9480
ds_read_u16 v142, v4 offset:9736
ds_read_u16 v143, v4 offset:9992
ds_read_u16 v144, v4 offset:13832
ds_read_u16 v145, v4 offset:14088
ds_read_u16 v146, v4 offset:14344
ds_read_u16 v147, v4 offset:14600
s_waitcnt lgkmcnt(8)
v_lshl_or_b32 v132, v133, 16, v132
v_lshl_or_b32 v133, v135, 16, v134
v_lshl_or_b32 v134, v137, 16, v136
v_lshl_or_b32 v135, v139, 16, v138
buffer_store_dwordx4 v[132:135], v2, s[8:11], s22 offen offset:0 sc1
ds_read_u16 v148, v4 offset:9280
ds_read_u16 v149, v4 offset:9536
ds_read_u16 v150, v4 offset:9792
ds_read_u16 v151, v4 offset:10048
ds_read_u16 v152, v4 offset:13888
ds_read_u16 v153, v4 offset:14144
ds_read_u16 v154, v4 offset:14400
ds_read_u16 v155, v4 offset:14656
s_waitcnt lgkmcnt(8)
v_lshl_or_b32 v140, v141, 16, v140
v_lshl_or_b32 v141, v143, 16, v142
v_lshl_or_b32 v142, v145, 16, v144
v_lshl_or_b32 v143, v147, 16, v146
buffer_store_dwordx4 v[140:143], v2, s[8:11], s22 offen offset:1024 sc1
ds_read_u16 v124, v4 offset:9288
ds_read_u16 v125, v4 offset:9544
ds_read_u16 v126, v4 offset:9800
ds_read_u16 v127, v4 offset:10056
ds_read_u16 v128, v4 offset:13896
ds_read_u16 v129, v4 offset:14152
ds_read_u16 v130, v4 offset:14408
ds_read_u16 v131, v4 offset:14664
s_waitcnt lgkmcnt(8)
v_lshl_or_b32 v148, v149, 16, v148
v_lshl_or_b32 v149, v151, 16, v150
v_lshl_or_b32 v150, v153, 16, v152
v_lshl_or_b32 v151, v155, 16, v154
buffer_store_dwordx4 v[148:151], v2, s[8:11], s22 offen offset:2048 sc1
ds_read_u16 v132, v5 offset:9216
ds_read_u16 v133, v5 offset:9472
ds_read_u16 v134, v5 offset:9728
ds_read_u16 v135, v5 offset:9984
ds_read_u16 v136, v5 offset:13824
ds_read_u16 v137, v5 offset:14080
ds_read_u16 v138, v5 offset:14336
ds_read_u16 v139, v5 offset:14592
s_waitcnt lgkmcnt(8)
v_lshl_or_b32 v124, v125, 16, v124
v_lshl_or_b32 v125, v127, 16, v126
v_lshl_or_b32 v126, v129, 16, v128
v_lshl_or_b32 v127, v131, 16, v130
buffer_store_dwordx4 v[124:127], v2, s[8:11], s22 offen offset:3072 sc1
ds_read_u16 v140, v6 offset:4096
ds_read_u16 v141, v6 offset:4352
ds_read_u16 v142, v6 offset:8704
ds_read_u16 v143, v6 offset:8960
ds_read_u16 v144, v6 offset:13312
ds_read_u16 v145, v6 offset:13568
ds_read_u16 v146, v6 offset:17920
ds_read_u16 v147, v6 offset:18176
s_waitcnt lgkmcnt(8)
v_lshl_or_b32 v132, v133, 16, v132
v_lshl_or_b32 v133, v135, 16, v134
v_lshl_or_b32 v134, v137, 16, v136
v_lshl_or_b32 v135, v139, 16, v138
buffer_store_dwordx4 v[132:135], v2, s[8:11], s23 offen offset:0 sc1
ds_read_u16 v148, v7 offset:4096
ds_read_u16 v149, v7 offset:4352
ds_read_u16 v150, v7 offset:8704
ds_read_u16 v151, v7 offset:8960
ds_read_u16 v152, v7 offset:13312
ds_read_u16 v153, v7 offset:13568
ds_read_u16 v154, v7 offset:17920
ds_read_u16 v155, v7 offset:18176
s_waitcnt lgkmcnt(8)
v_lshl_or_b32 v140, v141, 16, v140
v_lshl_or_b32 v141, v143, 16, v142
v_lshl_or_b32 v142, v145, 16, v144
v_lshl_or_b32 v143, v147, 16, v146
buffer_store_dwordx4 v[140:143], v2, s[8:11], s24 offen offset:0 sc1
s_waitcnt lgkmcnt(0)
v_lshl_or_b32 v148, v149, 16, v148
v_lshl_or_b32 v149, v151, 16, v150
v_lshl_or_b32 v150, v153, 16, v152
v_lshl_or_b32 v151, v155, 16, v154
buffer_store_dwordx4 v[148:151], v2, s[8:11], s25 offen offset:0 sc1
L_cr_e:
s_lshl_b32 s24, s5, 5
s_add_u32 s24, s24, s6
s_lshl_b32 s14, s24, 7
s_add_u32 s14, s14, 786432
v_mov_b32 v13, 2146435072
v_cmp_gt_u32 vcc, 16, v0
v_lshlrev_b32 v14, 3, v0
s_nop 0
v_cndmask_b32 v13, v13, v14, vcc
v_mov_b32 v14, s68
v_mov_b32 v15, s69
s_waitcnt vmcnt(0)
s_barrier
buffer_store_dwordx2 v[14:15], v13, s[8:11], s14 offen sc1
v_mov_b32 v20, 0
v_mov_b32 v21, 0
v_mov_b32 v22, 0
v_mov_b32 v23, 0
s_mov_b32 s38, 0x00003f80
s_mov_b32 s39, 0x3f800000
s_cmp_lt_u32 s2, 216
s_cbranch_scc0 L_wd_0
s_mov_b32 s16, s62
s_and_b32 s17, s63, 0xffff
s_mov_b32 s18, 5308416
s_mov_b32 s19, 0x20000
v_and_b32 v6, 15, v1
v_lshrrev_b32 v7, 4, v1
v_mov_b32 v12, 2146435072
s_sub_u32 s40, s2, 144
s_mul_i32 s37, s40, 73728
s_lshl_b32 s41, s4, 8
s_lshl_b32 s42, s4, 5
v_mul_u32_u24 v10, 18432, v7
v_lshl_add_u32 v9, v6, 3, v10
v_add_u32 v24, s41, v9
v_lshl_add_u32 v9, v6, 1, v10
v_add_u32 v25, s42, v9
s_add_u32 s43, s37, 0
buffer_load_dwordx2 v[76:77], v24, s[16:19], s43 offen offset:0
buffer_load_dwordx2 v[92:93], v24, s[16:19], s43 offen offset:128
buffer_load_ushort v108, v25, s[16:19], s43 offen offset:1024
s_add_u32 s43, s37, 4608
buffer_load_dwordx2 v[78:79], v24, s[16:19], s43 offen offset:0
buffer_load_dwordx2 v[94:95], v24, s[16:19], s43 offen offset:128
buffer_load_ushort v109, v25, s[16:19], s43 offen offset:1024
s_add_u32 s43, s37, 9216
buffer_load_dwordx2 v[80:81], v24, s[16:19], s43 offen offset:0
buffer_load_dwordx2 v[96:97], v24, s[16:19], s43 offen offset:128
buffer_load_ushort v110, v25, s[16:19], s43 offen offset:1024
s_add_u32 s43, s37, 13824
buffer_load_dwordx2 v[82:83], v24, s[16:19], s43 offen offset:0
buffer_load_dwordx2 v[98:99], v24, s[16:19], s43 offen offset:128
buffer_load_ushort v111, v25, s[16:19], s43 offen offset:1024
s_add_u32 s43, s37, 1152
buffer_load_dwordx2 v[84:85], v24, s[16:19], s43 offen offset:0
buffer_load_dwordx2 v[100:101], v24, s[16:19], s43 offen offset:128
buffer_load_ushort v112, v25, s[16:19], s43 offen offset:1024
s_add_u32 s43, s37, 5760
buffer_load_dwordx2 v[86:87], v24, s[16:19], s43 offen offset:0
buffer_load_dwordx2 v[102:103], v24, s[16:19], s43 offen offset:128
buffer_load_ushort v113, v25, s[16:19], s43 offen offset:1024
s_add_u32 s43, s37, 10368
buffer_load_dwordx2 v[88:89], v24, s[16:19], s43 offen offset:0
buffer_load_dwordx2 v[104:105], v24, s[16:19], s43 offen offset:128
buffer_load_ushort v114, v25, s[16:19], s43 offen offset:1024
s_add_u32 s43, s37, 14976
buffer_load_dwordx2 v[90:91], v24, s[16:19], s43 offen offset:0
buffer_load_dwordx2 v[106:107], v24, s[16:19], s43 offen offset:128
buffer_load_ushort v115, v25, s[16:19], s43 offen offset:1024
s_add_u32 s43, s37, 2304
buffer_load_dwordx2 v[116:117], v24, s[16:19], s43 offen offset:0
buffer_load_dwordx2 v[132:133], v24, s[16:19], s43 offen offset:128
buffer_load_ushort v148, v25, s[16:19], s43 offen offset:1024
s_add_u32 s43, s37, 6912
buffer_load_dwordx2 v[118:119], v24, s[16:19], s43 offen offset:0
buffer_load_dwordx2 v[134:135], v24, s[16:19], s43 offen offset:128
buffer_load_ushort v149, v25, s[16:19], s43 offen offset:1024
s_add_u32 s43, s37, 11520
buffer_load_dwordx2 v[120:121], v24, s[16:19], s43 offen offset:0
buffer_load_dwordx2 v[136:137], v24, s[16:19], s43 offen offset:128
buffer_load_ushort v150, v25, s[16:19], s43 offen offset:1024
s_add_u32 s43, s37, 16128
buffer_load_dwordx2 v[122:123], v24, s[16:19], s43 offen offset:0
buffer_load_dwordx2 v[138:139], v24, s[16:19], s43 offen offset:128
buffer_load_ushort v151, v25, s[16:19], s43 offen offset:1024
s_add_u32 s43, s37, 3456
buffer_load_dwordx2 v[124:125], v24, s[16:19], s43 offen offset:0
buffer_load_dwordx2 v[140:141], v24, s[16:19], s43 offen offset:128
buffer_load_ushort v152, v25, s[16:19], s43 offen offset:1024
s_add_u32 s43, s37, 8064
buffer_load_dwordx2 v[126:127], v24, s[16:19], s43 offen offset:0
buffer_load_dwordx2 v[142:143], v24, s[16:19], s43 offen offset:128
buffer_load_ushort v153, v25, s[16:19], s43 offen offset:1024
s_add_u32 s43, s37, 12672
buffer_load_dwordx2 v[128:129], v24, s[16:19], s43 offen offset:0
buffer_load_dwordx2 v[144:145], v24, s[16:19], s43 offen offset:128
buffer_load_ushort v154, v25, s[16:19], s43 offen offset:1024
s_add_u32 s43, s37, 17280
buffer_load_dwordx2 v[130:131], v24, s[16:19], s43 offen offset:0
buffer_load_dwordx2 v[146:147], v24, s[16:19], s43 offen offset:128
buffer_load_ushort v155, v25, s[16:19], s43 offen offset:1024
s_sub_u32 s48, s2, 144
s_mul_i32 s49, s48, 7282
s_lshr_b32 s49, s49, 16
s_mul_i32 s50, s49, 9
s_sub_u32 s48, s48, s50
s_lshl_b32 s48, s48, 1
s_lshl_b32 s49, s49, 2
s_add_u32 s49, s49, s4
s_mul_i32 s49, s49, 497664
s_add_u32 s49, s49, 7344128
v_cmp_lt_u32 vcc, 8, v1
s_nop 1
v_cndmask_b32 v6, 0, 1, vcc
v_mul_u32_u24 v7, 9, v6
v_sub_u32 v7, v1, v7
v_add_u32 v6, s48, v6
v_mov_b32 v8, 0
v_cmp_lt_u32 vcc, 4, v6
s_nop 1
v_addc_co_u32 v8, vcc, 0, v8, vcc
v_cmp_lt_u32 vcc, 8, v6
s_nop 1
v_addc_co_u32 v8, vcc, 0, v8, vcc
v_cmp_lt_u32 vcc, 13, v6
s_nop 1
v_addc_co_u32 v8, vcc, 0, v8, vcc
v_mul_u32_u24 v9, 9, v8
v_add_u32 v9, 1, v9
v_lshrrev_b32 v9, 1, v9
v_sub_u32 v9, v6, v9
v_subrev_u32 v8, s4, v8
v_and_b32 v8, 3, v8
v_mul_u32_u24 v10, 3, v9
v_add3_u32 v10, v10, v8, 2
v_cmp_eq_u32 vcc, 0, v8
s_nop 1
v_cndmask_b32 v10, v10, v9, vcc
v_add_u32 v11, 12, v8
v_cmp_eq_u32 vcc, 3, v9
s_nop 1
v_cndmask_b32 v10, v10, v11, vcc
v_cmp_eq_u32 vcc, 4, v6
s_nop 1
v_cndmask_b32 v10, v10, 16, vcc
v_cmp_eq_u32 vcc, 13, v6
s_nop 1
v_cndmask_b32 v10, v10, 17, vcc
v_and_b32 v6, 30, v10
v_and_b32 v8, 1, v10
v_lshl_add_u32 v8, v7, 1, v8
v_lshl_add_u32 v9, v6, 3, v8
v_lshrrev_b32 v11, 2, v7
v_lshl_add_u32 v6, v6, 2, v8
v_lshl_add_u32 v6, v11, 5, v6
v_add_u32 v6, 32, v6
v_lshrrev_b32 v13, 4, v10
v_or_b32 v11, v11, v13
v_mad_u32_u24 v6, v11, 0, v6
v_cmp_gt_u32 vcc, 8, v10
s_nop 1
v_cndmask_b32 v9, v6, v9, vcc
v_add_u32 v6, 144, v10
v_add_u32 v11, 96, v10
v_cmp_gt_u32 vcc, 0, v10
s_nop 1
v_cndmask_b32 v6, v6, v11, vcc
v_cmp_eq_u32 vcc, 8, v7
s_nop 1
v_cndmask_b32 v9, v9, v6, vcc
v_lshlrev_b32 v9, 10, v9
v_add_u32 v9, s49, v9
v_cmp_gt_u32 vcc, 18, v1
s_nop 1
v_cndmask_b32 v9, v12, v9, vcc
s_nop 0
v_readlane_b32 s48, v9, 0
v_readlane_b32 s49, v9, 1
v_readlane_b32 s50, v9, 2
v_readlane_b32 s51, v9, 3
v_add_u32 v156, s48, v2
v_add_u32 v157, s49, v2
v_add_u32 v158, s50, v2
v_add_u32 v159, s51, v2
v_readlane_b32 s48, v9, 4
v_readlane_b32 s49, v9, 5
v_readlane_b32 s50, v9, 6
v_readlane_b32 s51, v9, 7
v_add_u32 v160, s48, v2
v_add_u32 v161, s49, v2
v_add_u32 v162, s50, v2
v_add_u32 v163, s51, v2
v_readlane_b32 s48, v9, 8
v_readlane_b32 s49, v9, 9
v_readlane_b32 s50, v9, 10
v_readlane_b32 s51, v9, 11
v_add_u32 v164, s48, v2
v_add_u32 v165, s49, v2
v_add_u32 v166, s50, v2
v_add_u32 v167, s51, v2
v_readlane_b32 s48, v9, 12
v_readlane_b32 s49, v9, 13
v_readlane_b32 s50, v9, 14
v_readlane_b32 s51, v9, 15
v_add_u32 v168, s48, v2
v_add_u32 v169, s49, v2
v_add_u32 v170, s50, v2
v_add_u32 v171, s51, v2
v_readlane_b32 s48, v9, 16
v_readlane_b32 s49, v9, 17
v_readlane_b32 s50, v9, 18
v_readlane_b32 s51, v9, 19
v_add_u32 v172, s48, v2
v_add_u32 v173, s49, v2
v_add_u32 v174, s50, v2
v_add_u32 v175, s51, v2
s_branch L_wd_e
L_wd_0:
v_mov_b32 v156, 2146435072
v_mov_b32 v157, 2146435072
v_mov_b32 v158, 2146435072
v_mov_b32 v159, 2146435072
v_mov_b32 v160, 2146435072
v_mov_b32 v161, 2146435072
v_mov_b32 v162, 2146435072
v_mov_b32 v163, 2146435072
v_mov_b32 v164, 2146435072
v_mov_b32 v165, 2146435072
v_mov_b32 v166, 2146435072
v_mov_b32 v167, 2146435072
v_mov_b32 v168, 2146435072
v_mov_b32 v169, 2146435072
v_mov_b32 v170, 2146435072
v_mov_b32 v171, 2146435072
v_mov_b32 v172, 2146435072
v_mov_b32 v173, 2146435072
v_mov_b32 v174, 2146435072
v_mov_b32 v175, 2146435072
v_mov_b32 v24, 2146435072
v_mov_b32 v25, 2146435072
L_wd_e:
L_p0_e:
s_mov_b32 s15, 1
L_hop_enter:
s_cmp_eq_u32 s4, 0
s_cbranch_scc1 L_hop0
s_cmp_eq_u32 s4, 1
s_cbranch_scc1 L_hop1
s_cmp_eq_u32 s4, 2
s_cbranch_scc1 L_hop2
s_cmp_eq_u32 s4, 3
s_cbranch_scc1 L_hop3
L_hop_done:
s_cmp_eq_u32 s15, 2
s_cbranch_scc1 L_w1_cont
s_mov_b32 s15, 0
L_hop_skip:
s_mov_b32 s70, 22970368
s_mov_b32 s71, 27688960
s_mov_b32 s72, 32407552
s_mov_b32 s73, 37126144
s_mov_b32 s74, 41844736
s_mov_b32 s75, 42106880
s_mov_b32 s76, 79855616
s_mov_b32 s77, 0
s_mov_b32 s7, 0
s_lshr_b32 s20, s5, 2
s_lshl_b32 s20, s20, 3
s_lshr_b32 s21, s6, 2
s_add_u32 s20, s20, s21
s_and_b32 s21, s5, 3
s_lshl_b32 s21, s21, 2
s_and_b32 s22, s6, 3
s_add_u32 s21, s21, s22
s_lshl_b32 s24, s20, 3
s_sub_u32 s25, s24, 1
s_max_i32 s35, s25, 0
s_mul_i32 s25, s35, 18432
s_lshl_b32 s26, s4, 1
s_add_u32 s36, s24, s26
s_mul_i32 s24, s36, 18432
s_add_u32 s26, s24, s70
s_add_u32 s27, s26, 18432
s_add_u32 s28, s25, s70
v_add_u32 v4, 0x10000, v2
v_add_u32 v5, 0x20000, v2
s_cmp_eq_u32 s4, 3
s_cselect_b32 s29, 0, s4
s_cselect_b32 s31, 16, 9
s_lshl_b32 s30, s29, 10
v_and_b32 v12, 15, v1
v_mov_b32 v13, 2146435072
v_cmp_le_u32 vcc, s31, v12
s_nop 1
v_cndmask_b32 v3, v13, v2, vcc
s_add_u32 s31, s30, 2048
v_add_u32 v6, s31, v2
v_add_u32 v7, s31, v4
v_add_u32 v8, s31, v5
s_and_b32 s30, s30, 1024
s_add_u32 s31, s30, 5120
v_add_u32 v9, s31, v2
v_add_u32 v10, s31, v4
v_add_u32 v11, s31, v5
s_lshr_b32 s22, s36, 4
s_lshl_b32 s22, s22, 5
s_bfe_u32 s31, s36, 0x30001
s_add_u32 s22, s22, s31
s_add_u32 s22, s22, 18
s_lshr_b32 s23, s35, 4
s_lshl_b32 s23, s23, 5
s_bfe_u32 s31, s35, 0x30001
s_add_u32 s23, s23, s31
s_add_u32 s23, s23, 18
v_mov_b32 v16, s22
v_mov_b32 v17, s23
v_cmp_eq_u32 vcc, 4, v1
s_nop 1
v_cndmask_b32 v16, v16, v17, vcc
s_lshr_b32 s22, s21, 1
s_lshl_b32 s22, s22, 5
s_add_u32 s22, s22, 10
v_add_u32 v17, s22, v1
v_subrev_u32 v14, 8, v1
v_cmp_gt_u32 vcc, 12, v14
s_nop 1
v_cndmask_b32 v16, v16, v17, vcc
s_and_b32 s22, s6, 7
s_lshl_b32 s22, s22, 5
v_add_u32 v17, s22, v1
v_subrev_u32 v14, 30, v1
v_cmp_gt_u32 vcc, 2, v14
s_nop 1
v_cndmask_b32 v16, v16, v17, vcc
v_lshlrev_b32 v16, 7, v16
s_add_u32 s22, s77, 786432
s_mov_b32 s52, 0
L_poll1:
buffer_load_dwordx2 v[14:15], v16, s[8:11], s22 offen sc1
s_add_u32 s52, s52, 1
s_waitcnt vmcnt(0)
v_cmp_ne_u64 vcc, s[68:69], v[14:15]
s_cmp_ge_u32 s52, 1048576
s_cbranch_scc1 L_got1
s_and_b64 exec, exec, vcc
s_cbranch_execnz L_poll1
L_got1:
s_mov_b64 exec, -1
s_lshr_b32 s20, s5, 2
s_lshl_b32 s20, s20, 3
s_lshr_b32 s21, s6, 2
s_add_u32 s20, s20, s21
s_and_b32 s21, s5, 3
s_lshl_b32 s21, s21, 2
s_and_b32 s22, s6, 3
s_add_u32 s21, s21, s22
s_mul_i32 s32, s21, 129024
s_add_u32 s32, s32, 4198400
s_mul_i32 s33, s4, 32768
s_add_u32 s32, s32, s33
s_sub_u32 s48, s2, 144
s_cmp_lt_u32 s48, 72
s_cbranch_scc0 L_wp_0
s_mov_b32 s46, 0x05040100
s_mov_b32 s47, 0x07060302
v_perm_b32 v176, v78, v76, s46
v_perm_b32 v177, v82, v80, s46
s_add_u32 m0, s33, 0
s_add_u32 s40, s32, 0
buffer_load_dwordx4 v2, s[8:11], s40 offen offset:0 sc1 lds
v_perm_b32 v178, v86, v84, s46
v_perm_b32 v179, v90, v88, s46
buffer_load_dwordx4 v2, s[8:11], s40 offen offset:1024 sc1 lds
v_perm_b32 v180, v78, v76, s47
v_perm_b32 v181, v82, v80, s47
buffer_load_dwordx4 v2, s[8:11], s40 offen offset:2048 sc1 lds
v_perm_b32 v182, v86, v84, s47
v_perm_b32 v183, v90, v88, s47
buffer_load_dwordx4 v2, s[8:11], s40 offen offset:3072 sc1 lds
v_perm_b32 v184, v79, v77, s46
v_perm_b32 v185, v83, v81, s46
s_add_u32 m0, s33, 4096
s_add_u32 s40, s32, 4096
buffer_load_dwordx4 v2, s[8:11], s40 offen offset:0 sc1 lds
v_perm_b32 v186, v87, v85, s46
v_perm_b32 v187, v91, v89, s46
buffer_load_dwordx4 v2, s[8:11], s40 offen offset:1024 sc1 lds
v_perm_b32 v188, v79, v77, s47
v_perm_b32 v189, v83, v81, s47
buffer_load_dwordx4 v2, s[8:11], s40 offen offset:2048 sc1 lds
v_perm_b32 v190, v87, v85, s47
v_perm_b32 v191, v91, v89, s47
buffer_load_dwordx4 v2, s[8:11], s40 offen offset:3072 sc1 lds
v_perm_b32 v192, v94, v92, s46
v_perm_b32 v193, v98, v96, s46
s_add_u32 m0, s33, 8192
s_add_u32 s40, s32, 8192
buffer_load_dwordx4 v2, s[8:11], s40 offen offset:0 sc1 lds
v_perm_b32 v194, v102, v100, s46
v_perm_b32 v195, v106, v104, s46
buffer_load_dwordx4 v2, s[8:11], s40 offen offset:1024 sc1 lds
v_perm_b32 v196, v94, v92, s47
v_perm_b32 v197, v98, v96, s47
buffer_load_dwordx4 v2, s[8:11], s40 offen offset:2048 sc1 lds
v_perm_b32 v198, v102, v100, s47
v_perm_b32 v199, v106, v104, s47
buffer_load_dwordx4 v2, s[8:11], s40 offen offset:3072 sc1 lds
v_perm_b32 v200, v95, v93, s46
v_perm_b32 v201, v99, v97, s46
s_add_u32 m0, s33, 12288
s_add_u32 s40, s32, 12288
buffer_load_dwordx4 v2, s[8:11], s40 offen offset:0 sc1 lds
v_perm_b32 v202, v103, v101, s46
v_perm_b32 v203, v107, v105, s46
buffer_load_dwordx4 v2, s[8:11], s40 offen offset:1024 sc1 lds
v_perm_b32 v204, v95, v93, s47
v_perm_b32 v205, v99, v97, s47
buffer_load_dwordx4 v2, s[8:11], s40 offen offset:2048 sc1 lds
v_perm_b32 v206, v103, v101, s47
v_perm_b32 v207, v107, v105, s47
buffer_load_dwordx4 v2, s[8:11], s40 offen offset:3072 sc1 lds
v_lshl_or_b32 v208, v109, 16, v108
v_lshl_or_b32 v209, v111, 16, v110
s_add_u32 m0, s33, 16384
s_add_u32 s40, s32, 16384
buffer_load_dwordx4 v2, s[8:11], s40 offen offset:0 sc1 lds
v_lshl_or_b32 v210, v113, 16, v112
v_lshl_or_b32 v211, v115, 16, v114
buffer_load_dwordx4 v2, s[8:11], s40 offen offset:1024 sc1 lds
v_perm_b32 v212, v118, v116, s46
v_perm_b32 v213, v122, v120, s46
buffer_load_dwordx4 v2, s[8:11], s40 offen offset:2048 sc1 lds
v_perm_b32 v214, v126, v124, s46
v_perm_b32 v215, v130, v128, s46
buffer_load_dwordx4 v2, s[8:11], s40 offen offset:3072 sc1 lds
v_perm_b32 v216, v118, v116, s47
v_perm_b32 v217, v122, v120, s47
s_add_u32 m0, s33, 20480
s_add_u32 s40, s32, 20480
buffer_load_dwordx4 v2, s[8:11], s40 offen offset:0 sc1 lds
v_perm_b32 v218, v126, v124, s47
v_perm_b32 v219, v130, v128, s47
buffer_load_dwordx4 v2, s[8:11], s40 offen offset:1024 sc1 lds
v_perm_b32 v220, v119, v117, s46
v_perm_b32 v221, v123, v121, s46
buffer_load_dwordx4 v2, s[8:11], s40 offen offset:2048 sc1 lds
v_perm_b32 v222, v127, v125, s46
v_perm_b32 v223, v131, v129, s46
buffer_load_dwordx4 v2, s[8:11], s40 offen offset:3072 sc1 lds
v_perm_b32 v224, v119, v117, s47
v_perm_b32 v225, v123, v121, s47
s_add_u32 m0, s33, 24576
s_add_u32 s40, s32, 24576
buffer_load_dwordx4 v2, s[8:11], s40 offen offset:0 sc1 lds
v_perm_b32 v226, v127, v125, s47
v_perm_b32 v227, v131, v129, s47
buffer_load_dwordx4 v2, s[8:11], s40 offen offset:1024 sc1 lds
v_perm_b32 v228, v134, v132, s46
v_perm_b32 v229, v138, v136, s46
buffer_load_dwordx4 v2, s[8:11], s40 offen offset:2048 sc1 lds
v_perm_b32 v230, v142, v140, s46
v_perm_b32 v231, v146, v144, s46
buffer_load_dwordx4 v2, s[8:11], s40 offen offset:3072 sc1 lds
v_perm_b32 v232, v134, v132, s47
v_perm_b32 v233, v138, v136, s47
s_add_u32 m0, s33, 28672
s_add_u32 s40, s32, 28672
buffer_load_dwordx4 v2, s[8:11], s40 offen offset:0 sc1 lds
v_perm_b32 v234, v142, v140, s47
v_perm_b32 v235, v146, v144, s47
buffer_load_dwordx4 v2, s[8:11], s40 offen offset:1024 sc1 lds
v_perm_b32 v236, v135, v133, s46
v_perm_b32 v237, v139, v137, s46
buffer_load_dwordx4 v2, s[8:11], s40 offen offset:2048 sc1 lds
v_perm_b32 v238, v143, v141, s46
v_perm_b32 v239, v147, v145, s46
buffer_load_dwordx4 v2, s[8:11], s40 offen offset:3072 sc1 lds
v_perm_b32 v240, v135, v133, s47
v_perm_b32 v241, v139, v137, s47
v_perm_b32 v242, v143, v141, s47
v_perm_b32 v243, v147, v145, s47
v_lshl_or_b32 v244, v149, 16, v148
v_lshl_or_b32 v245, v151, 16, v150
v_lshl_or_b32 v246, v153, 16, v152
v_lshl_or_b32 v247, v155, 16, v154
s_branch L_wp_e
L_wp_0:
s_add_u32 m0, s33, 0
s_add_u32 s40, s32, 0
buffer_load_dwordx4 v2, s[8:11], s40 offen offset:0 sc1 lds
buffer_load_dwordx4 v2, s[8:11], s40 offen offset:1024 sc1 lds
buffer_load_dwordx4 v2, s[8:11], s40 offen offset:2048 sc1 lds
buffer_load_dwordx4 v2, s[8:11], s40 offen offset:3072 sc1 lds
s_add_u32 m0, s33, 4096
s_add_u32 s40, s32, 4096
buffer_load_dwordx4 v2, s[8:11], s40 offen offset:0 sc1 lds
buffer_load_dwordx4 v2, s[8:11], s40 offen offset:1024 sc1 lds
buffer_load_dwordx4 v2, s[8:11], s40 offen offset:2048 sc1 lds
buffer_load_dwordx4 v2, s[8:11], s40 offen offset:3072 sc1 lds
s_add_u32 m0, s33, 8192
s_add_u32 s40, s32, 8192
buffer_load_dwordx4 v2, s[8:11], s40 offen offset:0 sc1 lds
buffer_load_dwordx4 v2, s[8:11], s40 offen offset:1024 sc1 lds
buffer_load_dwordx4 v2, s[8:11], s40 offen offset:2048 sc1 lds
buffer_load_dwordx4 v2, s[8:11], s40 offen offset:3072 sc1 lds
s_add_u32 m0, s33, 12288
s_add_u32 s40, s32, 12288
buffer_load_dwordx4 v2, s[8:11], s40 offen offset:0 sc1 lds
buffer_load_dwordx4 v2, s[8:11], s40 offen offset:1024 sc1 lds
buffer_load_dwordx4 v2, s[8:11], s40 offen offset:2048 sc1 lds
buffer_load_dwordx4 v2, s[8:11], s40 offen offset:3072 sc1 lds
s_add_u32 m0, s33, 16384
s_add_u32 s40, s32, 16384
buffer_load_dwordx4 v2, s[8:11], s40 offen offset:0 sc1 lds
buffer_load_dwordx4 v2, s[8:11], s40 offen offset:1024 sc1 lds
buffer_load_dwordx4 v2, s[8:11], s40 offen offset:2048 sc1 lds
buffer_load_dwordx4 v2, s[8:11], s40 offen offset:3072 sc1 lds
s_add_u32 m0, s33, 20480
s_add_u32 s40, s32, 20480
buffer_load_dwordx4 v2, s[8:11], s40 offen offset:0 sc1 lds
buffer_load_dwordx4 v2, s[8:11], s40 offen offset:1024 sc1 lds
buffer_load_dwordx4 v2, s[8:11], s40 offen offset:2048 sc1 lds
buffer_load_dwordx4 v2, s[8:11], s40 offen offset:3072 sc1 lds
s_add_u32 m0, s33, 24576
s_add_u32 s40, s32, 24576
buffer_load_dwordx4 v2, s[8:11], s40 offen offset:0 sc1 lds
buffer_load_dwordx4 v2, s[8:11], s40 offen offset:1024 sc1 lds
buffer_load_dwordx4 v2, s[8:11], s40 offen offset:2048 sc1 lds
buffer_load_dwordx4 v2, s[8:11], s40 offen offset:3072 sc1 lds
s_add_u32 m0, s33, 28672
s_add_u32 s40, s32, 28672
buffer_load_dwordx4 v2, s[8:11], s40 offen offset:0 sc1 lds
buffer_load_dwordx4 v2, s[8:11], s40 offen offset:1024 sc1 lds
buffer_load_dwordx4 v2, s[8:11], s40 offen offset:2048 sc1 lds
buffer_load_dwordx4 v2, s[8:11], s40 offen offset:3072 sc1 lds
L_wp_e:
buffer_load_dwordx4 a[0:3], v2, s[8:11], s26 offen offset:0 sc1
buffer_load_dwordx4 a[72:75], v2, s[8:11], s27 offen offset:0 sc1
buffer_load_dwordx4 a[144:147], v3, s[8:11], s28 offen offset:0 sc1
buffer_load_dwordx4 a[4:7], v2, s[8:11], s26 offen offset:1024 sc1
buffer_load_dwordx4 a[76:79], v2, s[8:11], s27 offen offset:1024 sc1
buffer_load_dwordx4 a[148:151], v3, s[8:11], s28 offen offset:1024 sc1
buffer_load_dwordx4 a[8:11], v2, s[8:11], s26 offen offset:2048 sc1
buffer_load_dwordx4 a[80:83], v2, s[8:11], s27 offen offset:2048 sc1
buffer_load_dwordx4 a[152:155], v3, s[8:11], s28 offen offset:2048 sc1
buffer_load_dwordx4 a[12:15], v2, s[8:11], s26 offen offset:3072 sc1
buffer_load_dwordx4 a[84:87], v2, s[8:11], s27 offen offset:3072 sc1
buffer_load_dwordx4 a[156:159], v3, s[8:11], s28 offen offset:3072 sc1
s_add_u32 s26, s26, 4096
s_add_u32 s27, s27, 4096
s_add_u32 s28, s28, 4096
buffer_load_dwordx4 a[16:19], v2, s[8:11], s26 offen offset:0 sc1
buffer_load_dwordx4 a[88:91], v2, s[8:11], s27 offen offset:0 sc1
buffer_load_dwordx4 a[160:163], v3, s[8:11], s28 offen offset:0 sc1
buffer_load_dwordx4 a[20:23], v2, s[8:11], s26 offen offset:1024 sc1
buffer_load_dwordx4 a[92:95], v2, s[8:11], s27 offen offset:1024 sc1
buffer_load_dwordx4 a[164:167], v3, s[8:11], s28 offen offset:1024 sc1
buffer_load_dwordx4 a[24:27], v2, s[8:11], s26 offen offset:2048 sc1
buffer_load_dwordx4 a[96:99], v2, s[8:11], s27 offen offset:2048 sc1
buffer_load_dwordx4 a[168:171], v3, s[8:11], s28 offen offset:2048 sc1
buffer_load_dwordx4 a[28:31], v2, s[8:11], s26 offen offset:3072 sc1
buffer_load_dwordx4 a[100:103], v2, s[8:11], s27 offen offset:3072 sc1
buffer_load_dwordx4 a[172:175], v3, s[8:11], s28 offen offset:3072 sc1
v_lshrrev_b32 v13, 4, v1
v_lshlrev_b32 v14, 2, v13
v_sub_u32 v14, v12, v14
v_subrev_u32 v15, 0, v14
v_cmp_gt_u32 s[52:53], 8, v15
v_cmp_gt_i32 s[44:45], -8, v15
v_subrev_u32 v15, 1, v14
v_cmp_gt_u32 s[54:55], 8, v15
v_cmp_gt_i32 s[46:47], -8, v15
v_subrev_u32 v15, 2, v14
v_cmp_gt_u32 s[56:57], 8, v15
v_cmp_gt_i32 s[48:49], -8, v15
v_subrev_u32 v15, 3, v14
v_cmp_gt_u32 s[58:59], 8, v15
v_cmp_gt_i32 s[50:51], -8, v15
s_and_b32 s31, s20, 7
s_or_b32 s31, s31, s4
s_cmp_eq_u32 s31, 0
s_cselect_b64 s[60:61], 0, s[44:45]
s_cselect_b64 s[62:63], 0, s[46:47]
s_cselect_b64 s[64:65], 0, s[48:49]
s_cselect_b64 s[66:67], 0, s[50:51]
s_waitcnt vmcnt(24)
s_barrier
ds_read_b128 a[216:219], v2 offset:0
ds_read_b128 a[220:223], v2 offset:7168
ds_read_b128 a[224:227], v2 offset:1024
ds_read_b128 a[228:231], v2 offset:8192
ds_read_b128 a[232:235], v2 offset:2048
ds_read_b128 a[236:239], v2 offset:9216
s_waitcnt vmcnt(18)
s_waitcnt lgkmcnt(4)
v_mfma_f32_16x16x32_bf16 v[32:35], a[216:219], a[0:3], 0
s_add_u32 s26, s26, 4096
s_add_u32 s27, s27, 4096
s_add_u32 s28, s28, 4096
buffer_load_dwordx4 a[32:35], v2, s[8:11], s26 offen offset:0 sc1
v_mfma_f32_16x16x32_bf16 v[32:35], a[220:223], a[4:7], v[32:35]
ds_read_b128 a[240:243], v2 offset:3072
v_lshlrev_b32 v14, 3, v1
v_mfma_f32_16x16x32_bf16 v[36:39], a[216:219], a[72:75], 0
s_mul_i32 s31, s4, 3072
s_add_u32 s41, s31, 147456
v_mfma_f32_16x16x32_bf16 v[36:39], a[220:223], a[76:79], v[36:39]
ds_read_b128 a[244:247], v2 offset:10240
s_waitcnt lgkmcnt(4)
v_mfma_f32_16x16x32_bf16 v[40:43], a[224:227], a[0:3], 0
buffer_load_dwordx4 a[104:107], v2, s[8:11], s27 offen offset:0 sc1
v_mfma_f32_16x16x32_bf16 v[40:43], a[228:231], a[4:7], v[40:43]
ds_read_b128 a[216:219], v2 offset:4096
v_add_u32 v15, s41, v14
v_mfma_f32_16x16x32_bf16 v[44:47], a[224:227], a[72:75], 0
s_lshl_b32 s42, s29, 9
s_add_u32 s42, s42, 147456
v_mfma_f32_16x16x32_bf16 v[44:47], a[228:231], a[76:79], v[44:47]
ds_read_b128 a[220:223], v2 offset:11264
s_waitcnt lgkmcnt(4)
v_mfma_f32_16x16x32_bf16 v[48:51], a[232:235], a[0:3], 0
buffer_load_dwordx4 a[176:179], v3, s[8:11], s28 offen offset:0 sc1
v_mfma_f32_16x16x32_bf16 v[48:51], a[236:239], a[4:7], v[48:51]
ds_read_b128 a[224:227], v2 offset:5120
v_add_u32 v16, s42, v14
v_mfma_f32_16x16x32_bf16 v[52:55], a[232:235], a[72:75], 0
s_and_b32 s42, s42, 512
s_add_u32 s42, s42, 147456
v_mfma_f32_16x16x32_bf16 v[52:55], a[236:239], a[76:79], v[52:55]
ds_read_b128 a[228:231], v2 offset:12288
s_waitcnt lgkmcnt(4)
v_mfma_f32_16x16x32_bf16 v[56:59], a[240:243], a[0:3], 0
buffer_load_dwordx4 a[36:39], v2, s[8:11], s26 offen offset:1024 sc1
v_mfma_f32_16x16x32_bf16 v[56:59], a[244:247], a[4:7], v[56:59]
ds_read_b128 a[232:235], v2 offset:6144
v_add_u32 v19, s42, v14
v_mfma_f32_16x16x32_bf16 v[60:63], a[240:243], a[72:75], 0
v_add_u32 v18, 150016, v14
v_mov_b32 v96, 0
v_mfma_f32_16x16x32_bf16 v[60:63], a[244:247], a[76:79], v[60:63]
ds_read_b128 a[236:239], v2 offset:13312
s_waitcnt lgkmcnt(4)
v_mfma_f32_16x16x32_bf16 v[64:67], a[216:219], a[0:3], 0
buffer_load_dwordx4 a[108:111], v2, s[8:11], s27 offen offset:1024 sc1
v_mfma_f32_16x16x32_bf16 v[64:67], a[220:223], a[4:7], v[64:67]
ds_read_b128 a[240:243], v6 offset:0
v_mov_b32 v97, 0
v_mfma_f32_16x16x32_bf16 v[68:71], a[216:219], a[72:75], 0
v_mov_b32 v100, 0
v_mov_b32 v101, 0
v_mfma_f32_16x16x32_bf16 v[68:71], a[220:223], a[76:79], v[68:71]
ds_read_b128 a[244:247], v6 offset:7168
s_waitcnt lgkmcnt(4)
v_mfma_f32_16x16x32_bf16 v[72:75], a[0:3], a[224:227], 0
buffer_load_dwordx4 a[180:183], v3, s[8:11], s28 offen offset:1024 sc1
v_mfma_f32_16x16x32_bf16 v[72:75], a[4:7], a[228:231], v[72:75]
ds_read_b128 a[216:219], v9 offset:0
v_and_b32 v13, 1, v1
v_mfma_f32_16x16x32_bf16 v[76:79], a[72:75], a[224:227], 0
v_lshlrev_b32 v13, 4, v13
v_mov_b32 v102, 0x3f80
v_mfma_f32_16x16x32_bf16 v[76:79], a[76:79], a[228:231], v[76:79]
ds_read_b128 a[220:223], v9 offset:7168
s_waitcnt lgkmcnt(4)
v_mfma_f32_16x16x32_bf16 v[80:83], a[0:3], a[232:235], 0
buffer_load_dwordx4 a[40:43], v2, s[8:11], s26 offen offset:2048 sc1
v_mfma_f32_16x16x32_bf16 v[80:83], a[4:7], a[236:239], v[80:83]
ds_read_b128 a[224:227], v2 offset:14336
v_lshlrev_b32 v13, v13, v102
v_mfma_f32_16x16x32_bf16 v[84:87], a[72:75], a[232:235], 0
v_lshrrev_b32 v102, 1, v1
v_cmp_eq_u32 vcc, 16, v102
v_mfma_f32_16x16x32_bf16 v[84:87], a[76:79], a[236:239], v[84:87]
ds_read_b128 a[228:231], v2 offset:21504
s_waitcnt lgkmcnt(4)
v_mfma_f32_16x16x32_bf16 v[88:91], a[240:243], a[144:147], 0
ds_read_b128 a[232:235], v2 offset:15360
buffer_load_dwordx4 a[112:115], v2, s[8:11], s27 offen offset:2048 sc1
v_mfma_f32_16x16x32_bf16 v[88:91], a[244:247], a[148:151], v[88:91]
L_hop0:
s_cmp_lg_u32 s15, 0
s_cbranch_scc1 L_hop4
ds_read_b128 a[236:239], v2 offset:22528
s_waitcnt lgkmcnt(4)
v_mfma_f32_16x16x32_bf16 v[92:95], a[144:147], a[216:219], 0
ds_read_b128 a[240:243], v2 offset:16384
v_cndmask_b32 v98, 0, v13, vcc
v_mfma_f32_16x16x32_bf16 v[92:95], a[148:151], a[220:223], v[92:95]
ds_read_b128 a[244:247], v2 offset:23552
s_waitcnt vmcnt(20)
s_waitcnt lgkmcnt(4)
v_mfma_f32_16x16x32_bf16 v[32:35], a[224:227], a[8:11], v[32:35]
buffer_load_dwordx4 a[184:187], v3, s[8:11], s28 offen offset:2048 sc1
v_mfma_f32_16x16x32_bf16 v[32:35], a[228:231], a[12:15], v[32:35]
ds_read_b128 a[216:219], v2 offset:17408
v_cmp_eq_u32 vcc, 17, v102
v_mfma_f32_16x16x32_bf16 v[36:39], a[224:227], a[80:83], v[36:39]
s_nop 0
v_cndmask_b32 v99, 0, v13, vcc
v_add_u32 v17, 16, v12
v_mfma_f32_16x16x32_bf16 v[36:39], a[228:231], a[84:87], v[36:39]
ds_read_b128 a[220:223], v2 offset:24576
s_waitcnt lgkmcnt(4)
v_mfma_f32_16x16x32_bf16 v[40:43], a[232:235], a[8:11], v[40:43]
buffer_load_dwordx4 a[44:47], v2, s[8:11], s26 offen offset:3072 sc1
v_mfma_f32_16x16x32_bf16 v[40:43], a[236:239], a[12:15], v[40:43]
ds_read_b128 a[224:227], v2 offset:18432
v_cmp_gt_u32 vcc, 16, v1
v_mfma_f32_16x16x32_bf16 v[44:47], a[232:235], a[80:83], v[44:47]
v_add_u32 v14, 48, v12
s_mov_b32 s34, 0x3eae1a93
v_mfma_f32_16x16x32_bf16 v[44:47], a[236:239], a[84:87], v[44:47]
ds_read_b128 a[228:231], v2 offset:25600
s_waitcnt lgkmcnt(4)
v_mfma_f32_16x16x32_bf16 v[48:51], a[240:243], a[8:11], v[48:51]
buffer_load_dwordx4 a[116:119], v2, s[8:11], s27 offen offset:3072 sc1
v_mfma_f32_16x16x32_bf16 v[48:51], a[244:247], a[12:15], v[48:51]
ds_read_b128 a[232:235], v2 offset:19456
v_cndmask_b32 v17, v14, v17, vcc
v_mfma_f32_16x16x32_bf16 v[52:55], a[240:243], a[80:83], v[52:55]
v_lshlrev_b32 v17, 3, v17
v_add_u32 v17, s41, v17
v_mfma_f32_16x16x32_bf16 v[52:55], a[244:247], a[84:87], v[52:55]
ds_read_b128 a[236:239], v2 offset:26624
s_waitcnt lgkmcnt(4)
v_mfma_f32_16x16x32_bf16 v[56:59], a[216:219], a[8:11], v[56:59]
buffer_load_dwordx4 a[188:191], v3, s[8:11], s28 offen offset:3072 sc1
v_mfma_f32_16x16x32_bf16 v[56:59], a[220:223], a[12:15], v[56:59]
ds_read_b128 a[240:243], v2 offset:20480
v_mfma_f32_16x16x32_bf16 v[60:63], a[216:219], a[80:83], v[60:63]
v_mfma_f32_16x16x32_bf16 v[60:63], a[220:223], a[84:87], v[60:63]
ds_read_b128 a[244:247], v2 offset:27648
s_waitcnt lgkmcnt(4)
v_mfma_f32_16x16x32_bf16 v[64:67], a[224:227], a[8:11], v[64:67]
s_add_u32 s26, s26, 4096
s_add_u32 s27, s27, 4096
s_add_u32 s28, s28, 4096
buffer_load_dwordx4 a[48:51], v2, s[8:11], s26 offen offset:0 sc1
v_mfma_f32_16x16x32_bf16 v[64:67], a[228:231], a[12:15], v[64:67]
ds_read_b128 a[216:219], v6 offset:14336
v_mfma_f32_16x16x32_bf16 v[68:71], a[224:227], a[80:83], v[68:71]
v_mfma_f32_16x16x32_bf16 v[68:71], a[228:231], a[84:87], v[68:71]
ds_read_b128 a[220:223], v6 offset:21504
s_waitcnt lgkmcnt(4)
v_mfma_f32_16x16x32_bf16 v[72:75], a[8:11], a[232:235], v[72:75]
buffer_load_dwordx4 a[120:123], v2, s[8:11], s27 offen offset:0 sc1
v_mfma_f32_16x16x32_bf16 v[72:75], a[12:15], a[236:239], v[72:75]
ds_read_b128 a[224:227], v9 offset:14336
v_mfma_f32_16x16x32_bf16 v[76:79], a[80:83], a[232:235], v[76:79]
v_mfma_f32_16x16x32_bf16 v[76:79], a[84:87], a[236:239], v[76:79]
ds_read_b128 a[228:231], v9 offset:21504
s_waitcnt lgkmcnt(4)
v_mfma_f32_16x16x32_bf16 v[80:83], a[8:11], a[240:243], v[80:83]
buffer_load_dwordx4 a[192:195], v3, s[8:11], s28 offen offset:0 sc1
v_mfma_f32_16x16x32_bf16 v[80:83], a[12:15], a[244:247], v[80:83]
ds_read_b128 a[232:235], v2 offset:28672
v_mfma_f32_16x16x32_bf16 v[84:87], a[80:83], a[240:243], v[84:87]
v_mfma_f32_16x16x32_bf16 v[84:87], a[84:87], a[244:247], v[84:87]
ds_read_b128 a[236:239], v2 offset:35840
s_waitcnt lgkmcnt(4)
v_mfma_f32_16x16x32_bf16 v[88:91], a[216:219], a[152:155], v[88:91]
ds_read_b128 a[240:243], v2 offset:29696
buffer_load_dwordx4 a[52:55], v2, s[8:11], s26 offen offset:1024 sc1
v_mfma_f32_16x16x32_bf16 v[88:91], a[220:223], a[156:159], v[88:91]
ds_read_b128 a[244:247], v2 offset:36864
s_waitcnt lgkmcnt(4)
v_mfma_f32_16x16x32_bf16 v[92:95], a[152:155], a[224:227], v[92:95]
ds_read_b128 a[216:219], v2 offset:30720
v_mfma_f32_16x16x32_bf16 v[92:95], a[156:159], a[228:231], v[92:95]
ds_read_b128 a[220:223], v2 offset:37888
s_waitcnt vmcnt(22)
s_waitcnt lgkmcnt(4)
v_mfma_f32_16x16x32_bf16 v[32:35], a[232:235], a[16:19], v[32:35]
buffer_load_dwordx4 a[124:127], v2, s[8:11], s27 offen offset:1024 sc1
v_mfma_f32_16x16x32_bf16 v[32:35], a[236:239], a[20:23], v[32:35]
ds_read_b128 a[224:227], v2 offset:31744
v_mfma_f32_16x16x32_bf16 v[36:39], a[232:235], a[88:91], v[36:39]
v_mfma_f32_16x16x32_bf16 v[36:39], a[236:239], a[92:95], v[36:39]
ds_read_b128 a[228:231], v2 offset:38912
s_waitcnt lgkmcnt(4)
v_mfma_f32_16x16x32_bf16 v[40:43], a[240:243], a[16:19], v[40:43]
buffer_load_dwordx4 a[196:199], v3, s[8:11], s28 offen offset:1024 sc1
v_mfma_f32_16x16x32_bf16 v[40:43], a[244:247], a[20:23], v[40:43]
ds_read_b128 a[232:235], v2 offset:32768
v_mfma_f32_16x16x32_bf16 v[44:47], a[240:243], a[88:91], v[44:47]
v_mfma_f32_16x16x32_bf16 v[44:47], a[244:247], a[92:95], v[44:47]
ds_read_b128 a[236:239], v2 offset:39936
s_waitcnt lgkmcnt(4)
v_mfma_f32_16x16x32_bf16 v[48:51], a[216:219], a[16:19], v[48:51]
buffer_load_dwordx4 a[56:59], v2, s[8:11], s26 offen offset:2048 sc1
v_mfma_f32_16x16x32_bf16 v[48:51], a[220:223], a[20:23], v[48:51]
ds_read_b128 a[240:243], v2 offset:33792
v_mfma_f32_16x16x32_bf16 v[52:55], a[216:219], a[88:91], v[52:55]
v_mfma_f32_16x16x32_bf16 v[52:55], a[220:223], a[92:95], v[52:55]
ds_read_b128 a[244:247], v2 offset:40960
s_waitcnt lgkmcnt(4)
v_mfma_f32_16x16x32_bf16 v[56:59], a[224:227], a[16:19], v[56:59]
buffer_load_dwordx4 a[128:131], v2, s[8:11], s27 offen offset:2048 sc1
v_mfma_f32_16x16x32_bf16 v[56:59], a[228:231], a[20:23], v[56:59]
ds_read_b128 a[216:219], v2 offset:34816
v_mfma_f32_16x16x32_bf16 v[60:63], a[224:227], a[88:91], v[60:63]
v_mfma_f32_16x16x32_bf16 v[60:63], a[228:231], a[92:95], v[60:63]
ds_read_b128 a[220:223], v2 offset:41984
s_waitcnt lgkmcnt(4)
v_mfma_f32_16x16x32_bf16 v[64:67], a[232:235], a[16:19], v[64:67]
buffer_load_dwordx4 a[200:203], v3, s[8:11], s28 offen offset:2048 sc1
v_mfma_f32_16x16x32_bf16 v[64:67], a[236:239], a[20:23], v[64:67]
ds_read_b128 a[224:227], v6 offset:28672
v_mfma_f32_16x16x32_bf16 v[68:71], a[232:235], a[88:91], v[68:71]
v_mfma_f32_16x16x32_bf16 v[68:71], a[236:239], a[92:95], v[68:71]
ds_read_b128 a[228:231], v6 offset:35840
s_waitcnt lgkmcnt(4)
v_mfma_f32_16x16x32_bf16 v[72:75], a[16:19], a[240:243], v[72:75]
buffer_load_dwordx4 a[60:63], v2, s[8:11], s26 offen offset:3072 sc1
v_mfma_f32_16x16x32_bf16 v[72:75], a[20:23], a[244:247], v[72:75]
ds_read_b128 a[232:235], v9 offset:28672
v_mfma_f32_16x16x32_bf16 v[76:79], a[88:91], a[240:243], v[76:79]
v_mfma_f32_16x16x32_bf16 v[76:79], a[92:95], a[244:247], v[76:79]
ds_read_b128 a[236:239], v9 offset:35840
s_waitcnt lgkmcnt(4)
v_mfma_f32_16x16x32_bf16 v[80:83], a[16:19], a[216:219], v[80:83]
buffer_load_dwordx4 a[132:135], v2, s[8:11], s27 offen offset:3072 sc1
v_mfma_f32_16x16x32_bf16 v[80:83], a[20:23], a[220:223], v[80:83]
ds_read_b128 a[240:243], v2 offset:43008
v_mfma_f32_16x16x32_bf16 v[84:87], a[88:91], a[216:219], v[84:87]
v_mfma_f32_16x16x32_bf16 v[84:87], a[92:95], a[220:223], v[84:87]
ds_read_b128 a[244:247], v2 offset:50176
s_waitcnt lgkmcnt(4)
v_mfma_f32_16x16x32_bf16 v[88:91], a[224:227], a[160:163], v[88:91]
ds_read_b128 a[216:219], v2 offset:44032
buffer_load_dwordx4 a[204:207], v3, s[8:11], s28 offen offset:3072 sc1
v_mfma_f32_16x16x32_bf16 v[88:91], a[228:231], a[164:167], v[88:91]
ds_read_b128 a[220:223], v2 offset:51200
s_waitcnt lgkmcnt(4)
v_mfma_f32_16x16x32_bf16 v[92:95], a[160:163], a[232:235], v[92:95]
ds_read_b128 a[224:227], v2 offset:45056
v_mfma_f32_16x16x32_bf16 v[92:95], a[164:167], a[236:239], v[92:95]
ds_read_b128 a[228:231], v2 offset:52224
s_waitcnt vmcnt(24)
s_waitcnt lgkmcnt(4)
v_mfma_f32_16x16x32_bf16 v[32:35], a[240:243], a[24:27], v[32:35]
s_add_u32 s26, s26, 4096
s_add_u32 s27, s27, 4096
s_add_u32 s28, s28, 4096
buffer_load_dwordx4 a[64:67], v2, s[8:11], s26 offen offset:0 sc1
v_mfma_f32_16x16x32_bf16 v[32:35], a[244:247], a[28:31], v[32:35]
ds_read_b128 a[232:235], v2 offset:46080
v_mfma_f32_16x16x32_bf16 v[36:39], a[240:243], a[96:99], v[36:39]
v_mfma_f32_16x16x32_bf16 v[36:39], a[244:247], a[100:103], v[36:39]
ds_read_b128 a[236:239], v2 offset:53248
s_waitcnt lgkmcnt(4)
v_mfma_f32_16x16x32_bf16 v[40:43], a[216:219], a[24:27], v[40:43]
buffer_load_dwordx4 a[136:139], v2, s[8:11], s27 offen offset:0 sc1
v_mfma_f32_16x16x32_bf16 v[40:43], a[220:223], a[28:31], v[40:43]
ds_read_b128 a[240:243], v2 offset:47104
v_mfma_f32_16x16x32_bf16 v[44:47], a[216:219], a[96:99], v[44:47]
v_mfma_f32_16x16x32_bf16 v[44:47], a[220:223], a[100:103], v[44:47]
ds_read_b128 a[244:247], v2 offset:54272
s_waitcnt lgkmcnt(4)
v_mfma_f32_16x16x32_bf16 v[48:51], a[224:227], a[24:27], v[48:51]
buffer_load_dwordx4 a[208:211], v3, s[8:11], s28 offen offset:0 sc1
v_mfma_f32_16x16x32_bf16 v[48:51], a[228:231], a[28:31], v[48:51]
ds_read_b128 a[216:219], v2 offset:48128
v_mfma_f32_16x16x32_bf16 v[52:55], a[224:227], a[96:99], v[52:55]
v_mfma_f32_16x16x32_bf16 v[52:55], a[228:231], a[100:103], v[52:55]
ds_read_b128 a[220:223], v2 offset:55296
s_waitcnt lgkmcnt(4)
v_mfma_f32_16x16x32_bf16 v[56:59], a[232:235], a[24:27], v[56:59]
buffer_load_dwordx4 a[68:71], v2, s[8:11], s26 offen offset:1024 sc1
v_mfma_f32_16x16x32_bf16 v[56:59], a[236:239], a[28:31], v[56:59]
ds_read_b128 a[224:227], v2 offset:49152
v_mfma_f32_16x16x32_bf16 v[60:63], a[232:235], a[96:99], v[60:63]
v_mfma_f32_16x16x32_bf16 v[60:63], a[236:239], a[100:103], v[60:63]
ds_read_b128 a[228:231], v2 offset:56320
s_waitcnt lgkmcnt(4)
v_mfma_f32_16x16x32_bf16 v[64:67], a[240:243], a[24:27], v[64:67]
buffer_load_dwordx4 a[140:143], v2, s[8:11], s27 offen offset:1024 sc1
v_mfma_f32_16x16x32_bf16 v[64:67], a[244:247], a[28:31], v[64:67]
ds_read_b128 a[232:235], v6 offset:43008
v_mfma_f32_16x16x32_bf16 v[68:71], a[240:243], a[96:99], v[68:71]
v_mfma_f32_16x16x32_bf16 v[68:71], a[244:247], a[100:103], v[68:71]
ds_read_b128 a[236:239], v6 offset:50176
s_waitcnt lgkmcnt(4)
v_mfma_f32_16x16x32_bf16 v[72:75], a[24:27], a[216:219], v[72:75]
buffer_load_dwordx4 a[212:215], v3, s[8:11], s28 offen offset:1024 sc1
v_mfma_f32_16x16x32_bf16 v[72:75], a[28:31], a[220:223], v[72:75]
ds_read_b128 a[240:243], v9 offset:43008
v_mfma_f32_16x16x32_bf16 v[76:79], a[96:99], a[216:219], v[76:79]
v_mfma_f32_16x16x32_bf16 v[76:79], a[100:103], a[220:223], v[76:79]
ds_read_b128 a[244:247], v9 offset:50176
s_waitcnt lgkmcnt(4)
v_mfma_f32_16x16x32_bf16 v[80:83], a[24:27], a[224:227], v[80:83]
buffer_store_dwordx4 v[176:179], v156, s[8:11], 0 offen sc1
v_mfma_f32_16x16x32_bf16 v[80:83], a[28:31], a[228:231], v[80:83]
ds_read_b128 a[216:219], v2 offset:57344
v_mfma_f32_16x16x32_bf16 v[84:87], a[96:99], a[224:227], v[84:87]
v_mfma_f32_16x16x32_bf16 v[84:87], a[100:103], a[228:231], v[84:87]
ds_read_b128 a[220:223], v2 offset:64512
s_waitcnt lgkmcnt(4)
v_mfma_f32_16x16x32_bf16 v[88:91], a[232:235], a[168:171], v[88:91]
ds_read_b128 a[224:227], v2 offset:58368
v_mfma_f32_16x16x32_bf16 v[88:91], a[236:239], a[172:175], v[88:91]
ds_read_b128 a[228:231], v4 offset:0
s_waitcnt lgkmcnt(4)
v_mfma_f32_16x16x32_bf16 v[92:95], a[168:171], a[240:243], v[92:95]
ds_read_b128 a[232:235], v2 offset:59392
buffer_store_dwordx4 v[180:183], v157, s[8:11], 0 offen sc1
v_mfma_f32_16x16x32_bf16 v[92:95], a[172:175], a[244:247], v[92:95]
ds_read_b128 a[236:239], v4 offset:1024
s_waitcnt vmcnt(26)
s_waitcnt lgkmcnt(4)
v_mfma_f32_16x16x32_bf16 v[32:35], a[216:219], a[32:35], v[32:35]
v_mfma_f32_16x16x32_bf16 v[32:35], a[220:223], a[36:39], v[32:35]
ds_read_b128 a[240:243], v2 offset:60416
v_mfma_f32_16x16x32_bf16 v[36:39], a[216:219], a[104:107], v[36:39]
v_mfma_f32_16x16x32_bf16 v[36:39], a[220:223], a[108:111], v[36:39]
ds_read_b128 a[244:247], v4 offset:2048
s_waitcnt lgkmcnt(4)
v_mfma_f32_16x16x32_bf16 v[40:43], a[224:227], a[32:35], v[40:43]
buffer_store_dwordx4 v[184:187], v158, s[8:11], 0 offen sc1
v_mfma_f32_16x16x32_bf16 v[40:43], a[228:231], a[36:39], v[40:43]
ds_read_b128 a[216:219], v2 offset:61440
v_mfma_f32_16x16x32_bf16 v[44:47], a[224:227], a[104:107], v[44:47]
v_mfma_f32_16x16x32_bf16 v[44:47], a[228:231], a[108:111], v[44:47]
ds_read_b128 a[220:223], v4 offset:3072
s_waitcnt lgkmcnt(4)
v_mfma_f32_16x16x32_bf16 v[48:51], a[232:235], a[32:35], v[48:51]
v_mfma_f32_16x16x32_bf16 v[48:51], a[236:239], a[36:39], v[48:51]
ds_read_b128 a[224:227], v2 offset:62464
v_mfma_f32_16x16x32_bf16 v[52:55], a[232:235], a[104:107], v[52:55]
buffer_store_dwordx4 v[188:191], v159, s[8:11], 0 offen sc1
v_mfma_f32_16x16x32_bf16 v[52:55], a[236:239], a[108:111], v[52:55]
ds_read_b128 a[228:231], v4 offset:4096
s_waitcnt lgkmcnt(4)
v_mfma_f32_16x16x32_bf16 v[56:59], a[240:243], a[32:35], v[56:59]
v_mfma_f32_16x16x32_bf16 v[56:59], a[244:247], a[36:39], v[56:59]
ds_read_b128 a[232:235], v2 offset:63488
v_mfma_f32_16x16x32_bf16 v[60:63], a[240:243], a[104:107], v[60:63]
v_mfma_f32_16x16x32_bf16 v[60:63], a[244:247], a[108:111], v[60:63]
ds_read_b128 a[236:239], v4 offset:5120
s_waitcnt lgkmcnt(4)
v_mfma_f32_16x16x32_bf16 v[64:67], a[216:219], a[32:35], v[64:67]
buffer_store_dwordx4 v[192:195], v160, s[8:11], 0 offen sc1
v_mfma_f32_16x16x32_bf16 v[64:67], a[220:223], a[36:39], v[64:67]
ds_read_b128 a[240:243], v6 offset:57344
v_mfma_f32_16x16x32_bf16 v[68:71], a[216:219], a[104:107], v[68:71]
v_mfma_f32_16x16x32_bf16 v[68:71], a[220:223], a[108:111], v[68:71]
ds_read_b128 a[244:247], v6 offset:64512
s_waitcnt lgkmcnt(4)
v_mfma_f32_16x16x32_bf16 v[72:75], a[32:35], a[224:227], v[72:75]
v_mfma_f32_16x16x32_bf16 v[72:75], a[36:39], a[228:231], v[72:75]
ds_read_b128 a[216:219], v9 offset:57344
v_mfma_f32_16x16x32_bf16 v[76:79], a[104:107], a[224:227], v[76:79]
buffer_store_dwordx4 v[196:199], v161, s[8:11], 0 offen sc1
v_mfma_f32_16x16x32_bf16 v[76:79], a[108:111], a[228:231], v[76:79]
ds_read_b128 a[220:223], v9 offset:64512
s_waitcnt lgkmcnt(4)
v_mfma_f32_16x16x32_bf16 v[80:83], a[32:35], a[232:235], v[80:83]
v_mfma_f32_16x16x32_bf16 v[80:83], a[36:39], a[236:239], v[80:83]
ds_read_b128 a[224:227], v4 offset:6144
v_mfma_f32_16x16x32_bf16 v[84:87], a[104:107], a[232:235], v[84:87]
v_mfma_f32_16x16x32_bf16 v[84:87], a[108:111], a[236:239], v[84:87]
ds_read_b128 a[228:231], v4 offset:13312
s_waitcnt lgkmcnt(4)
v_mfma_f32_16x16x32_bf16 v[88:91], a[240:243], a[176:179], v[88:91]
ds_read_b128 a[232:235], v4 offset:7168
buffer_store_dwordx4 v[200:203], v162, s[8:11], 0 offen sc1
v_mfma_f32_16x16x32_bf16 v[88:91], a[244:247], a[180:183], v[88:91]
ds_read_b128 a[236:239], v4 offset:14336
s_waitcnt lgkmcnt(4)
v_mfma_f32_16x16x32_bf16 v[92:95], a[176:179], a[216:219], v[92:95]
ds_read_b128 a[240:243], v4 offset:8192
v_mfma_f32_16x16x32_bf16 v[92:95], a[180:183], a[220:223], v[92:95]
ds_read_b128 a[244:247], v4 offset:15360
s_waitcnt vmcnt(25)
s_waitcnt lgkmcnt(4)
v_mfma_f32_16x16x32_bf16 v[32:35], a[224:227], a[40:43], v[32:35]
v_mfma_f32_16x16x32_bf16 v[32:35], a[228:231], a[44:47], v[32:35]
ds_read_b128 a[216:219], v4 offset:9216
v_mfma_f32_16x16x32_bf16 v[36:39], a[224:227], a[112:115], v[36:39]
buffer_store_dwordx4 v[204:207], v163, s[8:11], 0 offen sc1
v_mfma_f32_16x16x32_bf16 v[36:39], a[228:231], a[116:119], v[36:39]
ds_read_b128 a[220:223], v4 offset:16384
s_waitcnt lgkmcnt(4)
v_mfma_f32_16x16x32_bf16 v[40:43], a[232:235], a[40:43], v[40:43]
v_mfma_f32_16x16x32_bf16 v[40:43], a[236:239], a[44:47], v[40:43]
ds_read_b128 a[224:227], v4 offset:10240
v_mfma_f32_16x16x32_bf16 v[44:47], a[232:235], a[112:115], v[44:47]
v_mfma_f32_16x16x32_bf16 v[44:47], a[236:239], a[116:119], v[44:47]
ds_read_b128 a[228:231], v4 offset:17408
s_waitcnt lgkmcnt(4)
v_mfma_f32_16x16x32_bf16 v[48:51], a[240:243], a[40:43], v[48:51]
buffer_store_dwordx4 v[208:211], v164, s[8:11], 0 offen sc1
v_mfma_f32_16x16x32_bf16 v[48:51], a[244:247], a[44:47], v[48:51]
ds_read_b128 a[232:235], v4 offset:11264
v_mfma_f32_16x16x32_bf16 v[52:55], a[240:243], a[112:115], v[52:55]
v_mfma_f32_16x16x32_bf16 v[52:55], a[244:247], a[116:119], v[52:55]
ds_read_b128 a[236:239], v4 offset:18432
s_waitcnt lgkmcnt(4)
v_mfma_f32_16x16x32_bf16 v[56:59], a[216:219], a[40:43], v[56:59]
v_mfma_f32_16x16x32_bf16 v[56:59], a[220:223], a[44:47], v[56:59]
ds_read_b128 a[240:243], v4 offset:12288
v_mfma_f32_16x16x32_bf16 v[60:63], a[216:219], a[112:115], v[60:63]
buffer_store_dwordx4 v[212:215], v165, s[8:11], 0 offen sc1
v_mfma_f32_16x16x32_bf16 v[60:63], a[220:223], a[116:119], v[60:63]
ds_read_b128 a[244:247], v4 offset:19456
s_waitcnt lgkmcnt(4)
v_mfma_f32_16x16x32_bf16 v[64:67], a[224:227], a[40:43], v[64:67]
v_mfma_f32_16x16x32_bf16 v[64:67], a[228:231], a[44:47], v[64:67]
ds_read_b128 a[216:219], v7 offset:6144
v_mfma_f32_16x16x32_bf16 v[68:71], a[224:227], a[112:115], v[68:71]
v_mfma_f32_16x16x32_bf16 v[68:71], a[228:231], a[116:119], v[68:71]
ds_read_b128 a[220:223], v7 offset:13312
s_waitcnt lgkmcnt(4)
v_mfma_f32_16x16x32_bf16 v[72:75], a[40:43], a[232:235], v[72:75]
buffer_store_dwordx4 v[216:219], v166, s[8:11], 0 offen sc1
v_mfma_f32_16x16x32_bf16 v[72:75], a[44:47], a[236:239], v[72:75]
ds_read_b128 a[224:227], v10 offset:6144
v_mfma_f32_16x16x32_bf16 v[76:79], a[112:115], a[232:235], v[76:79]
v_mfma_f32_16x16x32_bf16 v[76:79], a[116:119], a[236:239], v[76:79]
ds_read_b128 a[228:231], v10 offset:13312
s_waitcnt lgkmcnt(4)
v_mfma_f32_16x16x32_bf16 v[80:83], a[40:43], a[240:243], v[80:83]
v_mfma_f32_16x16x32_bf16 v[80:83], a[44:47], a[244:247], v[80:83]
ds_read_b128 a[232:235], v4 offset:20480
v_mfma_f32_16x16x32_bf16 v[84:87], a[112:115], a[240:243], v[84:87]
buffer_store_dwordx4 v[220:223], v167, s[8:11], 0 offen sc1
v_mfma_f32_16x16x32_bf16 v[84:87], a[116:119], a[244:247], v[84:87]
ds_read_b128 a[236:239], v4 offset:27648
s_waitcnt lgkmcnt(4)
v_mfma_f32_16x16x32_bf16 v[88:91], a[216:219], a[184:187], v[88:91]
ds_read_b128 a[240:243], v4 offset:21504
v_mfma_f32_16x16x32_bf16 v[88:91], a[220:223], a[188:191], v[88:91]
ds_read_b128 a[244:247], v4 offset:28672
s_waitcnt lgkmcnt(4)
v_mfma_f32_16x16x32_bf16 v[92:95], a[184:187], a[224:227], v[92:95]
ds_read_b128 a[216:219], v4 offset:22528
v_mfma_f32_16x16x32_bf16 v[92:95], a[188:191], a[228:231], v[92:95]
ds_read_b128 a[220:223], v4 offset:29696
s_waitcnt vmcnt(24)
s_waitcnt lgkmcnt(4)
v_mfma_f32_16x16x32_bf16 v[32:35], a[232:235], a[48:51], v[32:35]
buffer_store_dwordx4 v[224:227], v168, s[8:11], 0 offen sc1
v_mfma_f32_16x16x32_bf16 v[32:35], a[236:239], a[52:55], v[32:35]
ds_read_b128 a[224:227], v4 offset:23552
v_mfma_f32_16x16x32_bf16 v[36:39], a[232:235], a[120:123], v[36:39]
v_mfma_f32_16x16x32_bf16 v[36:39], a[236:239], a[124:127], v[36:39]
ds_read_b128 a[228:231], v4 offset:30720
s_waitcnt lgkmcnt(4)
v_mfma_f32_16x16x32_bf16 v[40:43], a[240:243], a[48:51], v[40:43]
v_mfma_f32_16x16x32_bf16 v[40:43], a[244:247], a[52:55], v[40:43]
ds_read_b128 a[232:235], v4 offset:24576
v_mfma_f32_16x16x32_bf16 v[44:47], a[240:243], a[120:123], v[44:47]
buffer_store_dwordx4 v[228:231], v169, s[8:11], 0 offen sc1
v_mfma_f32_16x16x32_bf16 v[44:47], a[244:247], a[124:127], v[44:47]
ds_read_b128 a[236:239], v4 offset:31744
s_waitcnt lgkmcnt(4)
v_mfma_f32_16x16x32_bf16 v[48:51], a[216:219], a[48:51], v[48:51]
v_mfma_f32_16x16x32_bf16 v[48:51], a[220:223], a[52:55], v[48:51]
ds_read_b128 a[240:243], v4 offset:25600
v_mfma_f32_16x16x32_bf16 v[52:55], a[216:219], a[120:123], v[52:55]
v_mfma_f32_16x16x32_bf16 v[52:55], a[220:223], a[124:127], v[52:55]
ds_read_b128 a[244:247], v4 offset:32768
s_waitcnt lgkmcnt(4)
v_mfma_f32_16x16x32_bf16 v[56:59], a[224:227], a[48:51], v[56:59]
buffer_store_dwordx4 v[232:235], v170, s[8:11], 0 offen sc1
v_mfma_f32_16x16x32_bf16 v[56:59], a[228:231], a[52:55], v[56:59]
ds_read_b128 a[216:219], v4 offset:26624
v_mfma_f32_16x16x32_bf16 v[60:63], a[224:227], a[120:123], v[60:63]
v_mfma_f32_16x16x32_bf16 v[60:63], a[228:231], a[124:127], v[60:63]
ds_read_b128 a[220:223], v4 offset:33792
s_waitcnt lgkmcnt(4)
v_mfma_f32_16x16x32_bf16 v[64:67], a[232:235], a[48:51], v[64:67]
v_mfma_f32_16x16x32_bf16 v[64:67], a[236:239], a[52:55], v[64:67]
ds_read_b128 a[224:227], v7 offset:20480
v_mfma_f32_16x16x32_bf16 v[68:71], a[232:235], a[120:123], v[68:71]
buffer_store_dwordx4 v[236:239], v171, s[8:11], 0 offen sc1
v_mfma_f32_16x16x32_bf16 v[68:71], a[236:239], a[124:127], v[68:71]
ds_read_b128 a[228:231], v7 offset:27648
s_waitcnt lgkmcnt(4)
v_mfma_f32_16x16x32_bf16 v[72:75], a[48:51], a[240:243], v[72:75]
v_mfma_f32_16x16x32_bf16 v[72:75], a[52:55], a[244:247], v[72:75]
ds_read_b128 a[232:235], v10 offset:20480
v_mfma_f32_16x16x32_bf16 v[76:79], a[120:123], a[240:243], v[76:79]
v_mfma_f32_16x16x32_bf16 v[76:79], a[124:127], a[244:247], v[76:79]
ds_read_b128 a[236:239], v10 offset:27648
s_waitcnt lgkmcnt(4)
v_mfma_f32_16x16x32_bf16 v[80:83], a[48:51], a[216:219], v[80:83]
buffer_store_dwordx4 v[240:243], v172, s[8:11], 0 offen sc1
v_mfma_f32_16x16x32_bf16 v[80:83], a[52:55], a[220:223], v[80:83]
ds_read_b128 a[240:243], v4 offset:34816
v_mfma_f32_16x16x32_bf16 v[84:87], a[120:123], a[216:219], v[84:87]
v_mfma_f32_16x16x32_bf16 v[84:87], a[124:127], a[220:223], v[84:87]
ds_read_b128 a[244:247], v4 offset:41984
s_waitcnt lgkmcnt(4)
v_mfma_f32_16x16x32_bf16 v[88:91], a[224:227], a[192:195], v[88:91]
ds_read_b128 a[216:219], v4 offset:35840
v_mfma_f32_16x16x32_bf16 v[88:91], a[228:231], a[196:199], v[88:91]
ds_read_b128 a[220:223], v4 offset:43008
s_waitcnt lgkmcnt(4)
v_mfma_f32_16x16x32_bf16 v[92:95], a[192:195], a[232:235], v[92:95]
ds_read_b128 a[224:227], v4 offset:36864
buffer_store_dwordx4 v[244:247], v173, s[8:11], 0 offen sc1
v_mfma_f32_16x16x32_bf16 v[92:95], a[196:199], a[236:239], v[92:95]
ds_read_b128 a[228:231], v4 offset:44032
s_waitcnt vmcnt(24)
s_waitcnt lgkmcnt(4)
v_mfma_f32_16x16x32_bf16 v[32:35], a[240:243], a[56:59], v[32:35]
v_mfma_f32_16x16x32_bf16 v[32:35], a[244:247], a[60:63], v[32:35]
ds_read_b128 a[232:235], v4 offset:37888
v_mfma_f32_16x16x32_bf16 v[36:39], a[240:243], a[128:131], v[36:39]
v_mfma_f32_16x16x32_bf16 v[36:39], a[244:247], a[132:135], v[36:39]
ds_read_b128 a[236:239], v4 offset:45056
s_waitcnt lgkmcnt(4)
v_mfma_f32_16x16x32_bf16 v[40:43], a[216:219], a[56:59], v[40:43]
buffer_store_dwordx4 v[248:251], v174, s[8:11], 0 offen sc1
v_mfma_f32_16x16x32_bf16 v[40:43], a[220:223], a[60:63], v[40:43]
ds_read_b128 a[240:243], v4 offset:38912
v_mfma_f32_16x16x32_bf16 v[44:47], a[216:219], a[128:131], v[44:47]
v_mfma_f32_16x16x32_bf16 v[44:47], a[220:223], a[132:135], v[44:47]
ds_read_b128 a[244:247], v4 offset:46080
s_waitcnt lgkmcnt(4)
v_mfma_f32_16x16x32_bf16 v[48:51], a[224:227], a[56:59], v[48:51]
v_mfma_f32_16x16x32_bf16 v[48:51], a[228:231], a[60:63], v[48:51]
ds_read_b128 a[216:219], v4 offset:39936
v_mfma_f32_16x16x32_bf16 v[52:55], a[224:227], a[128:131], v[52:55]
buffer_store_dwordx4 v[252:255], v175, s[8:11], 0 offen sc1
v_mfma_f32_16x16x32_bf16 v[52:55], a[228:231], a[132:135], v[52:55]
ds_read_b128 a[220:223], v4 offset:47104
s_waitcnt lgkmcnt(4)
v_mfma_f32_16x16x32_bf16 v[56:59], a[232:235], a[56:59], v[56:59]
v_mfma_f32_16x16x32_bf16 v[56:59], a[236:239], a[60:63], v[56:59]
ds_read_b128 a[224:227], v4 offset:40960
v_mfma_f32_16x16x32_bf16 v[60:63], a[232:235], a[128:131], v[60:63]
v_mfma_f32_16x16x32_bf16 v[60:63], a[236:239], a[132:135], v[60:63]
ds_read_b128 a[228:231], v4 offset:48128
s_waitcnt lgkmcnt(4)
v_mfma_f32_16x16x32_bf16 v[64:67], a[240:243], a[56:59], v[64:67]
v_mfma_f32_16x16x32_bf16 v[64:67], a[244:247], a[60:63], v[64:67]
ds_read_b128 a[232:235], v7 offset:34816
v_mfma_f32_16x16x32_bf16 v[68:71], a[240:243], a[128:131], v[68:71]
v_mfma_f32_16x16x32_bf16 v[68:71], a[244:247], a[132:135], v[68:71]
ds_read_b128 a[236:239], v7 offset:41984
s_waitcnt lgkmcnt(4)
v_mfma_f32_16x16x32_bf16 v[72:75], a[56:59], a[216:219], v[72:75]
v_mfma_f32_16x16x32_bf16 v[72:75], a[60:63], a[220:223], v[72:75]
ds_read_b128 a[240:243], v10 offset:34816
v_mfma_f32_16x16x32_bf16 v[76:79], a[128:131], a[216:219], v[76:79]
v_mfma_f32_16x16x32_bf16 v[76:79], a[132:135], a[220:223], v[76:79]
ds_read_b128 a[244:247], v10 offset:41984
s_waitcnt lgkmcnt(4)
v_mfma_f32_16x16x32_bf16 v[80:83], a[56:59], a[224:227], v[80:83]
v_mfma_f32_16x16x32_bf16 v[80:83], a[60:63], a[228:231], v[80:83]
ds_read_b128 a[216:219], v4 offset:49152
v_mfma_f32_16x16x32_bf16 v[84:87], a[128:131], a[224:227], v[84:87]
v_mfma_f32_16x16x32_bf16 v[84:87], a[132:135], a[228:231], v[84:87]
ds_read_b128 a[220:223], v4 offset:56320
s_waitcnt lgkmcnt(4)
v_mfma_f32_16x16x32_bf16 v[88:91], a[232:235], a[200:203], v[88:91]
ds_read_b128 a[224:227], v4 offset:50176
v_mfma_f32_16x16x32_bf16 v[88:91], a[236:239], a[204:207], v[88:91]
ds_read_b128 a[228:231], v4 offset:57344
s_waitcnt lgkmcnt(4)
v_mfma_f32_16x16x32_bf16 v[92:95], a[200:203], a[240:243], v[92:95]
ds_read_b128 a[232:235], v4 offset:51200
v_mfma_f32_16x16x32_bf16 v[92:95], a[204:207], a[244:247], v[92:95]
ds_read_b128 a[236:239], v4 offset:58368
s_waitcnt vmcnt(20)
s_waitcnt lgkmcnt(4)
v_mfma_f32_16x16x32_bf16 v[32:35], a[216:219], a[64:67], v[32:35]
v_mfma_f32_16x16x32_bf16 v[32:35], a[220:223], a[68:71], v[32:35]
ds_read_b128 a[240:243], v4 offset:52224
v_mfma_f32_16x16x32_bf16 v[36:39], a[216:219], a[136:139], v[36:39]
v_mfma_f32_16x16x32_bf16 v[36:39], a[220:223], a[140:143], v[36:39]
ds_read_b128 a[244:247], v4 offset:59392
s_waitcnt lgkmcnt(4)
v_mfma_f32_16x16x32_bf16 v[40:43], a[224:227], a[64:67], v[40:43]
v_mfma_f32_16x16x32_bf16 v[40:43], a[228:231], a[68:71], v[40:43]
ds_read_b128 a[216:219], v4 offset:53248
v_mfma_f32_16x16x32_bf16 v[44:47], a[224:227], a[136:139], v[44:47]
v_mfma_f32_16x16x32_bf16 v[44:47], a[228:231], a[140:143], v[44:47]
ds_read_b128 a[220:223], v4 offset:60416
s_waitcnt lgkmcnt(4)
v_mfma_f32_16x16x32_bf16 v[48:51], a[232:235], a[64:67], v[48:51]
v_mfma_f32_16x16x32_bf16 v[48:51], a[236:239], a[68:71], v[48:51]
ds_read_b128 a[224:227], v4 offset:54272
v_mfma_f32_16x16x32_bf16 v[52:55], a[232:235], a[136:139], v[52:55]
v_mfma_f32_16x16x32_bf16 v[52:55], a[236:239], a[140:143], v[52:55]
ds_read_b128 a[228:231], v4 offset:61440
s_waitcnt lgkmcnt(4)
v_mfma_f32_16x16x32_bf16 v[56:59], a[240:243], a[64:67], v[56:59]
v_mfma_f32_16x16x32_bf16 v[56:59], a[244:247], a[68:71], v[56:59]
ds_read_b128 a[232:235], v4 offset:55296
v_mfma_f32_16x16x32_bf16 v[60:63], a[240:243], a[136:139], v[60:63]
v_mfma_f32_16x16x32_bf16 v[60:63], a[244:247], a[140:143], v[60:63]
ds_read_b128 a[236:239], v4 offset:62464
s_waitcnt lgkmcnt(4)
v_mfma_f32_16x16x32_bf16 v[64:67], a[216:219], a[64:67], v[64:67]
v_mfma_f32_16x16x32_bf16 v[64:67], a[220:223], a[68:71], v[64:67]
ds_read_b128 a[240:243], v7 offset:49152
v_mfma_f32_16x16x32_bf16 v[68:71], a[216:219], a[136:139], v[68:71]
v_mfma_f32_16x16x32_bf16 v[68:71], a[220:223], a[140:143], v[68:71]
ds_read_b128 a[244:247], v7 offset:56320
s_waitcnt lgkmcnt(4)
v_mfma_f32_16x16x32_bf16 v[72:75], a[64:67], a[224:227], v[72:75]
v_mfma_f32_16x16x32_bf16 v[72:75], a[68:71], a[228:231], v[72:75]
ds_read_b128 a[216:219], v10 offset:49152
v_mfma_f32_16x16x32_bf16 v[76:79], a[136:139], a[224:227], v[76:79]
v_mfma_f32_16x16x32_bf16 v[76:79], a[140:143], a[228:231], v[76:79]
ds_read_b128 a[220:223], v10 offset:56320
s_waitcnt lgkmcnt(4)
v_mfma_f32_16x16x32_bf16 v[80:83], a[64:67], a[232:235], v[80:83]
v_mfma_f32_16x16x32_bf16 v[80:83], a[68:71], a[236:239], v[80:83]
v_mfma_f32_16x16x32_bf16 v[84:87], a[136:139], a[232:235], v[84:87]
v_mfma_f32_16x16x32_bf16 v[84:87], a[140:143], a[236:239], v[84:87]
s_waitcnt lgkmcnt(2)
v_mfma_f32_16x16x32_bf16 v[88:91], a[240:243], a[208:211], v[88:91]
v_mfma_f32_16x16x32_bf16 v[88:91], a[244:247], a[212:215], v[88:91]
s_waitcnt lgkmcnt(0)
v_mfma_f32_16x16x32_bf16 v[92:95], a[208:211], a[216:219], v[92:95]
v_mfma_f32_16x16x32_bf16 v[92:95], a[212:215], a[220:223], v[92:95]
v_mov_b32 v103, 0xff61b1e6
v_mov_b32 v102, 0xffff
v_cndmask_b32 v172, v103, 0, s[44:45]
v_cndmask_b32 v173, v103, 0, s[46:47]
v_cndmask_b32 v174, v103, 0, s[48:49]
v_cndmask_b32 v175, v103, 0, s[50:51]
v_cndmask_b32 v184, 0, v102, s[44:45]
v_cndmask_b32 v13, 0, v102, s[46:47]
v_lshl_or_b32 v184, v13, 16, v184
v_cndmask_b32 v185, 0, v102, s[48:49]
v_cndmask_b32 v13, 0, v102, s[50:51]
v_lshl_or_b32 v185, v13, 16, v185
v_cndmask_b32 v176, v103, 0, s[52:53]
v_cndmask_b32 v177, v103, 0, s[54:55]
v_cndmask_b32 v178, v103, 0, s[56:57]
v_cndmask_b32 v179, v103, 0, s[58:59]
v_cndmask_b32 v186, 0, v102, s[52:53]
L_hop1:
s_cmp_lg_u32 s15, 0
s_cbranch_scc1 L_hop5
v_cndmask_b32 v13, 0, v102, s[54:55]
v_lshl_or_b32 v186, v13, 16, v186
v_cndmask_b32 v187, 0, v102, s[56:57]
v_cndmask_b32 v13, 0, v102, s[58:59]
v_lshl_or_b32 v187, v13, 16, v187
v_cndmask_b32 v180, v103, 0, s[60:61]
v_cndmask_b32 v181, v103, 0, s[62:63]
v_cndmask_b32 v182, v103, 0, s[64:65]
v_cndmask_b32 v183, v103, 0, s[66:67]
v_cndmask_b32 v188, 0, v102, s[60:61]
v_cndmask_b32 v13, 0, v102, s[62:63]
v_lshl_or_b32 v188, v13, 16, v188
v_cndmask_b32 v189, 0, v102, s[64:65]
v_cndmask_b32 v13, 0, v102, s[66:67]
v_lshl_or_b32 v189, v13, 16, v189
L_att:
v_cvt_pk_bf16_f32 v160, v64, v65
v_cvt_pk_bf16_f32 v161, v66, v67
v_cvt_pk_bf16_f32 v162, v68, v69
v_cvt_pk_bf16_f32 v163, v70, v71
v_cvt_pk_bf16_f32 v156, v88, v89
v_cvt_pk_bf16_f32 v157, v90, v91
v_cvt_pk_bf16_f32 v158, v92, v93
v_cvt_pk_bf16_f32 v159, v94, v95
v_mfma_f32_16x16x32_bf16 v[164:167], v[160:163], v[96:99], 0
s_nop 0
v_mfma_f32_16x16x32_bf16 v[168:171], v[156:159], v[98:101], 0
v_mfma_f32_16x16x32_bf16 v[88:91], v[160:163], v[98:101], 0
v_cvt_pk_bf16_f32 v116, v52, v53
v_cvt_pk_bf16_f32 v117, v54, v55
v_cvt_pk_bf16_f32 v120, v60, v61
v_cvt_pk_bf16_f32 v121, v62, v63
v_cvt_pk_bf16_f32 v126, v76, v77
v_cvt_pk_bf16_f32 v127, v78, v79
v_cvt_pk_bf16_f32 v132, v84, v85
v_cvt_pk_bf16_f32 v133, v86, v87
v_cvt_pk_bf16_f32 v138, v164, v165
v_cvt_pk_bf16_f32 v139, v166, v167
v_cvt_pk_bf16_f32 v164, v168, v169
v_cvt_pk_bf16_f32 v165, v170, v171
s_cmp_eq_u32 s4, 3
s_cbranch_scc1 L_a1_noxch
ds_write_b64 v16, v[156:157]
ds_write_b64 v15, v[116:117] offset:3072
ds_write_b64 v15, v[120:121] offset:3584
ds_write_b64 v15, v[162:163] offset:4096
ds_write_b64 v15, v[126:127] offset:4608
ds_write_b64 v15, v[132:133] offset:5120
ds_write_b64 v15, v[138:139] offset:5632
s_cmp_eq_u32 s4, 2
s_cbranch_scc1 L_a1_left
ds_write_b64 v19, v[158:159] offset:1536
s_branch L_a1_noxch
L_a1_left:
ds_write_b64 v18, v[164:165]
L_a1_noxch:
v_cvt_pk_bf16_f32 v136, v88, v89
v_cvt_pk_bf16_f32 v137, v90, v91
v_cvt_pk_bf16_f32 v110, v48, v49
v_cvt_pk_bf16_f32 v111, v50, v51
v_cvt_pk_bf16_f32 v114, v56, v57
v_cvt_pk_bf16_f32 v115, v58, v59
v_cvt_pk_bf16_f32 v124, v72, v73
v_cvt_pk_bf16_f32 v125, v74, v75
v_cvt_pk_bf16_f32 v130, v80, v81
v_cvt_pk_bf16_f32 v131, v82, v83
v_cvt_pk_bf16_f32 v140, v32, v33
v_cvt_pk_bf16_f32 v141, v34, v35
v_cvt_pk_bf16_f32 v146, v40, v41
v_cvt_pk_bf16_f32 v147, v42, v43
v_mov_b32 v142, v160
v_mov_b32 v145, v161
v_mov_b32 v143, 0
v_mov_b32 v144, 0
v_mov_b32 v112, 0
v_mov_b32 v113, 0
s_nop 0
v_permlane16_swap_b32 v142, v112
v_permlane16_swap_b32 v145, v113
v_cvt_pk_bf16_f32 v148, v36, v37
v_cvt_pk_bf16_f32 v149, v38, v39
v_cvt_pk_bf16_f32 v154, v44, v45
v_cvt_pk_bf16_f32 v155, v46, v47
v_mov_b32 v150, v162
v_mov_b32 v153, v163
v_mov_b32 v151, 0
v_mov_b32 v152, 0
v_mov_b32 v118, 0
v_mov_b32 v119, 0
s_nop 0
v_permlane16_swap_b32 v150, v118
v_permlane16_swap_b32 v153, v119
s_waitcnt lgkmcnt(0)
s_barrier
s_and_b32 s37, s6, 7
s_mul_i32 s37, s37, 92160
s_mul_i32 s38, s4, 23552
s_add_u32 s37, s37, s38
s_add_u32 s37, s37, 6266880
ds_read_b64 v[104:105], v15
ds_read_b64 v[108:109], v15 offset:512
ds_read_b64 v[106:107], v17 offset:1024
ds_read_b64 v[122:123], v15 offset:1536
ds_read_b64 v[128:129], v15 offset:2048
ds_read_b64 v[134:135], v15 offset:2560
v_mfma_f32_16x16x32_bf16 v[32:35], v[110:113], v[148:151], v[172:175]
v_mfma_f32_16x16x32_bf16 v[36:39], v[116:119], v[148:151], v[176:179]
v_mfma_f32_16x16x32_bf16 v[40:43], v[112:115], v[152:155], v[172:175]
v_mfma_f32_16x16x32_bf16 v[44:47], v[118:121], v[152:155], v[176:179]
s_waitcnt lgkmcnt(3)
v_mfma_f32_16x16x32_bf16 v[48:51], v[104:107], v[140:143], v[180:183]
v_mfma_f32_16x16x32_bf16 v[52:55], v[110:113], v[140:143], v[176:179]
v_mfma_f32_16x16x32_bf16 v[56:59], v[106:109], v[144:147], v[180:183]
v_mfma_f32_16x16x32_bf16 v[60:63], v[112:115], v[144:147], v[176:179]
s_nop 0
v_max_f32 v32, v32, v36
v_max_f32 v33, v33, v37
v_max_f32 v34, v34, v38
v_max_f32 v35, v35, v39
v_max_f32 v40, v40, v44
v_max_f32 v41, v41, v45
v_max_f32 v42, v42, v46
v_max_f32 v43, v43, v47
v_max_f32 v48, v48, v52
v_max_f32 v49, v49, v53
v_max_f32 v50, v50, v54
v_max_f32 v51, v51, v55
v_max_f32 v56, v56, v60
v_max_f32 v57, v57, v61
v_max_f32 v58, v58, v62
v_max_f32 v59, v59, v63
v_max3_f32 v20, v32, v33, v34
v_max3_f32 v21, v40, v41, v42
v_max3_f32 v22, v48, v49, v50
v_max3_f32 v23, v56, v57, v58
v_max_f32 v20, v20, v35
v_max_f32 v21, v21, v43
v_max_f32 v22, v22, v51
v_max_f32 v23, v23, v59
v_mov_b32 v24, v20
v_mov_b32 v25, v21
v_mov_b32 v26, v22
v_mov_b32 v27, v23
v_permlane16_swap_b32 v20, v24
v_permlane16_swap_b32 v21, v25
v_permlane16_swap_b32 v22, v26
v_permlane16_swap_b32 v23, v27
v_max_f32 v20, v20, v24
v_max_f32 v21, v21, v25
v_max_f32 v22, v22, v26
v_max_f32 v23, v23, v27
v_mov_b32 v24, v20
v_mov_b32 v25, v21
v_mov_b32 v26, v22
v_mov_b32 v27, v23
v_permlane32_swap_b32 v20, v24
v_permlane32_swap_b32 v21, v25
v_permlane32_swap_b32 v22, v26
v_permlane32_swap_b32 v23, v27
v_max_f32 v20, v20, v24
v_max_f32 v21, v21, v25
v_max_f32 v22, v22, v26
v_max_f32 v23, v23, v27
v_mul_f32 v20, s34, v20
v_mul_f32 v21, s34, v21
v_mul_f32 v22, s34, v22
v_mul_f32 v23, s34, v23
v_fma_f32 v32, v32, s34, -v20
v_fma_f32 v40, v40, s34, -v21
v_fma_f32 v48, v48, s34, -v22
v_fma_f32 v56, v56, s34, -v23
v_exp_f32 v32, v32
v_exp_f32 v40, v40
v_exp_f32 v48, v48
v_exp_f32 v56, v56
v_fma_f32 v33, v33, s34, -v20
v_fma_f32 v41, v41, s34, -v21
v_fma_f32 v49, v49, s34, -v22
v_fma_f32 v57, v57, s34, -v23
v_exp_f32 v33, v33
v_exp_f32 v41, v41
v_exp_f32 v49, v49
v_exp_f32 v57, v57
v_fma_f32 v34, v34, s34, -v20
v_fma_f32 v42, v42, s34, -v21
v_fma_f32 v50, v50, s34, -v22
v_fma_f32 v58, v58, s34, -v23
v_exp_f32 v34, v34
v_exp_f32 v42, v42
v_exp_f32 v50, v50
v_exp_f32 v58, v58
v_fma_f32 v35, v35, s34, -v20
v_fma_f32 v43, v43, s34, -v21
v_fma_f32 v51, v51, s34, -v22
v_fma_f32 v59, v59, s34, -v23
v_exp_f32 v35, v35
v_exp_f32 v43, v43
v_exp_f32 v51, v51
v_exp_f32 v59, v59
v_add_f32 v28, v32, v33
v_add_f32 v29, v40, v41
v_add_f32 v30, v48, v49
v_add_f32 v31, v56, v57
v_add_f32 v28, v28, v34
v_add_f32 v29, v29, v42
v_add_f32 v30, v30, v50
v_add_f32 v31, v31, v58
v_add_f32 v28, v28, v35
v_add_f32 v29, v29, v43
v_add_f32 v30, v30, v51
v_add_f32 v31, v31, v59
v_mov_b32 v24, v28
v_mov_b32 v25, v29
v_mov_b32 v26, v30
v_mov_b32 v27, v31
v_permlane16_swap_b32 v28, v24
v_permlane16_swap_b32 v29, v25
v_permlane16_swap_b32 v30, v26
v_permlane16_swap_b32 v31, v27
v_add_f32 v28, v28, v24
v_add_f32 v29, v29, v25
v_add_f32 v30, v30, v26
v_add_f32 v31, v31, v27
v_mov_b32 v24, v28
v_mov_b32 v25, v29
v_mov_b32 v26, v30
v_mov_b32 v27, v31
v_permlane32_swap_b32 v28, v24
v_permlane32_swap_b32 v29, v25
v_permlane32_swap_b32 v30, v26
v_permlane32_swap_b32 v31, v27
v_add_f32 v28, v28, v24
v_add_f32 v29, v29, v25
v_add_f32 v30, v30, v26
v_add_f32 v31, v31, v27
v_rcp_f32 v28, v28
v_rcp_f32 v29, v29
v_rcp_f32 v30, v30
v_rcp_f32 v31, v31
v_mul_f32 v32, v32, v28
v_mul_f32 v40, v40, v29
v_mul_f32 v48, v48, v30
v_mul_f32 v56, v56, v31
v_mul_f32 v33, v33, v28
v_mul_f32 v41, v41, v29
v_mul_f32 v49, v49, v30
v_mul_f32 v57, v57, v31
v_mul_f32 v34, v34, v28
v_mul_f32 v42, v42, v29
v_mul_f32 v50, v50, v30
v_mul_f32 v58, v58, v31
v_mul_f32 v35, v35, v28
v_mul_f32 v43, v43, v29
v_mul_f32 v51, v51, v30
v_mul_f32 v59, v59, v31
v_cvt_pk_bf16_f32 v36, v32, v33
v_cvt_pk_bf16_f32 v37, v34, v35
v_cvt_pk_bf16_f32 v44, v40, v41
v_cvt_pk_bf16_f32 v45, v42, v43
v_cvt_pk_bf16_f32 v52, v48, v49
v_cvt_pk_bf16_f32 v53, v50, v51
v_cvt_pk_bf16_f32 v60, v56, v57
v_cvt_pk_bf16_f32 v61, v58, v59
v_and_b32 v64, v184, v36
v_and_b32 v66, v186, v36
v_and_b32 v65, v185, v37
v_and_b32 v67, v187, v37
v_and_b32 v68, v184, v44
v_and_b32 v70, v186, v44
v_and_b32 v69, v185, v45
v_and_b32 v71, v187, v45
v_and_b32 v72, v188, v52
v_and_b32 v74, v186, v52
v_and_b32 v73, v189, v53
v_and_b32 v75, v187, v53
v_and_b32 v76, v188, v60
v_and_b32 v78, v186, v60
v_and_b32 v77, v189, v61
v_and_b32 v79, v187, v61
s_waitcnt lgkmcnt(0)
v_mfma_f32_16x16x32_bf16 v[80:83], v[124:127], v[64:67], 0
v_mfma_f32_16x16x32_bf16 v[84:87], v[136:139], v[64:67], 0
v_mfma_f32_16x16x32_bf16 v[88:91], v[130:133], v[68:71], 0
v_mfma_f32_16x16x32_bf16 v[92:95], v[136:139], v[68:71], 0
v_mfma_f32_16x16x32_bf16 v[96:99], v[122:125], v[72:75], 0
v_mfma_f32_16x16x32_bf16 v[100:103], v[134:137], v[72:75], 0
v_mfma_f32_16x16x32_bf16 v[164:167], v[128:131], v[76:79], 0
v_mfma_f32_16x16x32_bf16 v[168:171], v[134:137], v[76:79], 0
v_lshlrev_b32 v14, 3, v12
v_mov_b32 v15, 2146435072
v_cmp_gt_u32 vcc, 16, v1
s_nop 1
v_cndmask_b32 v14, v15, v14, vcc
s_add_u32 s26, s24, s72
s_lshl_b32 s27, s21, 10
s_add_u32 s27, s27, s26
s_lshl_b32 s28, s21, 7
s_add_u32 s28, s28, 16384
s_add_u32 s28, s28, s26
s_add_u32 s30, s27, 18432
s_add_u32 s31, s28, 18432
v_cvt_pk_bf16_f32 v40, v80, v81
v_cvt_pk_bf16_f32 v41, v82, v83
v_cvt_pk_bf16_f32 v42, v88, v89
v_cvt_pk_bf16_f32 v43, v90, v91
v_cvt_pk_bf16_f32 v44, v84, v85
v_cvt_pk_bf16_f32 v45, v94, v95
buffer_store_dwordx4 v[40:43], v2, s[8:11], s30 offen sc1
buffer_store_dwordx2 v[44:45], v14, s[8:11], s31 offen sc1
v_cvt_pk_bf16_f32 v32, v96, v97
v_cvt_pk_bf16_f32 v33, v98, v99
v_cvt_pk_bf16_f32 v34, v164, v165
v_cvt_pk_bf16_f32 v35, v166, v167
v_cvt_pk_bf16_f32 v36, v100, v101
v_cvt_pk_bf16_f32 v37, v170, v171
buffer_store_dwordx4 v[32:35], v2, s[8:11], s27 offen sc1
buffer_store_dwordx2 v[36:37], v14, s[8:11], s28 offen sc1
s_lshl_b32 s26, s20, 4
s_add_u32 s26, s26, s21
s_lshl_b32 s14, s26, 7
s_add_u32 s14, s14, 393216
s_add_u32 s14, s14, s77
s_lshr_b32 s20, s6, 3
s_lshl_b32 s21, s5, 2
s_add_u32 s20, s20, s21
s_lshl_b32 s20, s20, 2
s_add_u32 s20, s20, s4
s_and_b32 s21, s6, 7
s_mul_i32 s24, s20, 18432
s_add_u32 s25, s24, s72
s_mul_i32 s26, s21, 2304
s_add_u32 s26, s26, s24
s_add_u32 s27, s26, s71
v_and_b32 v6, 15, v1
v_lshrrev_b32 v7, 4, v1
v_lshlrev_b32 v8, 4, v6
v_lshl_add_u32 v8, v7, 3, v8
v_add_u32 v8, 2048, v8
v_mov_b32 v9, 2146435072
v_cmp_gt_u32 vcc, 32, v1
s_nop 1
v_cndmask_b32 v4, v9, v8, vcc
v_add_u32 v5, 0x10000, v2
s_and_b32 s40, s5, 1
s_lshl_b32 s40, s40, 2
s_lshr_b32 s41, s6, 3
s_add_u32 s40, s40, s41
s_lshr_b32 s41, s5, 1
s_lshl_b32 s41, s41, 3
s_and_b32 s42, s6, 7
s_add_u32 s41, s41, s42
s_lshr_b32 s42, s41, 2
s_and_b32 s43, s41, 3
s_lshr_b32 s22, s20, 3
s_lshl_b32 s22, s22, 4
v_add_u32 v10, s22, v6
v_subrev_u32 v12, 16, v1
v_min_u32 v12, 26, v12
v_mul_u32_u24 v16, 57, v12
v_lshrrev_b32 v16, 9, v16
v_mad_u32_u24 v12, v16, 63, v12
s_mul_i32 s22, s42, 9
v_add_u32 v12, s22, v12
v_and_b32 v16, 7, v12
v_lshrrev_b32 v12, 3, v12
v_lshrrev_b32 v17, 2, v16
v_lshlrev_b32 v17, 3, v17
v_lshrrev_b32 v18, 2, v12
v_add_lshl_u32 v17, v17, v18, 4
v_and_b32 v16, 3, v16
v_lshl_add_u32 v17, v16, 2, v17
v_and_b32 v12, 3, v12
v_add_u32 v17, v17, v12
s_cmp_eq_u32 s7, 0
s_cselect_b32 s22, 16, 64
v_cmp_le_u32 vcc, s22, v1
s_nop 1
v_cndmask_b32 v10, v10, v17, vcc
v_lshlrev_b32 v10, 7, v10
s_add_u32 s22, s77, 393216
v_lshlrev_b32 v11, 3, v6
v_lshl_add_u32 v11, v7, 8, v11
v_mov_b32 v13, 2146435072
v_cmp_gt_u32 vcc, 16, v0
v_lshlrev_b32 v14, 3, v0
s_nop 0
v_cndmask_b32 v13, v13, v14, vcc
v_mov_b32 v14, s68
v_mov_b32 v15, s69
s_waitcnt vmcnt(0)
s_barrier
buffer_store_dwordx2 v[14:15], v13, s[8:11], s14 offen sc1
s_add_u32 m0, s38, 0
s_add_u32 s39, s37, 0
buffer_load_dwordx4 v2, s[8:11], s39 offen offset:0 sc1 lds
buffer_load_dwordx4 v2, s[8:11], s39 offen offset:1024 sc1 lds
buffer_load_dwordx4 v2, s[8:11], s39 offen offset:2048 sc1 lds
buffer_load_dwordx4 v2, s[8:11], s39 offen offset:3072 sc1 lds
s_add_u32 m0, s38, 4096
s_add_u32 s39, s37, 4096
buffer_load_dwordx4 v2, s[8:11], s39 offen offset:0 sc1 lds
buffer_load_dwordx4 v2, s[8:11], s39 offen offset:1024 sc1 lds
buffer_load_dwordx4 v2, s[8:11], s39 offen offset:2048 sc1 lds
buffer_load_dwordx4 v2, s[8:11], s39 offen offset:3072 sc1 lds
s_add_u32 m0, s38, 8192
s_add_u32 s39, s37, 8192
buffer_load_dwordx4 v2, s[8:11], s39 offen offset:0 sc1 lds
buffer_load_dwordx4 v2, s[8:11], s39 offen offset:1024 sc1 lds
buffer_load_dwordx4 v2, s[8:11], s39 offen offset:2048 sc1 lds
buffer_load_dwordx4 v2, s[8:11], s39 offen offset:3072 sc1 lds
s_add_u32 m0, s38, 12288
s_add_u32 s39, s37, 12288
buffer_load_dwordx4 v2, s[8:11], s39 offen offset:0 sc1 lds
buffer_load_dwordx4 v2, s[8:11], s39 offen offset:1024 sc1 lds
buffer_load_dwordx4 v2, s[8:11], s39 offen offset:2048 sc1 lds
buffer_load_dwordx4 v2, s[8:11], s39 offen offset:3072 sc1 lds
s_add_u32 m0, s38, 16384
s_add_u32 s39, s37, 16384
buffer_load_dwordx4 v2, s[8:11], s39 offen offset:0 sc1 lds
buffer_load_dwordx4 v2, s[8:11], s39 offen offset:1024 sc1 lds
buffer_load_dwordx4 v2, s[8:11], s39 offen offset:2048 sc1 lds
buffer_load_dwordx4 v2, s[8:11], s39 offen offset:3072 sc1 lds
s_add_u32 m0, s38, 20480
s_add_u32 s39, s37, 20480
buffer_load_dwordx4 v2, s[8:11], s39 offen offset:0 sc1 lds
buffer_load_dwordx4 v2, s[8:11], s39 offen offset:1024 sc1 lds
buffer_load_dwordx4 v2, s[8:11], s39 offen offset:2048 sc1 lds
s_mov_b32 s52, 0
L_poll2:
buffer_load_dwordx2 v[14:15], v10, s[8:11], s22 offen sc1
s_add_u32 s52, s52, 1
s_waitcnt vmcnt(0)
v_cmp_ne_u64 vcc, s[68:69], v[14:15]
s_cmp_ge_u32 s52, 1048576
s_cbranch_scc1 L_got2
s_and_b64 exec, exec, vcc
s_cbranch_execnz L_poll2
L_got2:
s_mov_b64 exec, -1
buffer_load_dwordx4 a[0:3], v2, s[8:11], s25 offen offset:0 sc1
buffer_load_dwordx4 a[4:7], v2, s[8:11], s25 offen offset:1024 sc1
buffer_load_dwordx4 a[8:11], v2, s[8:11], s25 offen offset:2048 sc1
buffer_load_dwordx4 a[12:15], v2, s[8:11], s25 offen offset:3072 sc1
s_add_u32 s25, s25, 4096
buffer_load_dwordx4 a[16:19], v2, s[8:11], s25 offen offset:0 sc1
buffer_load_dwordx4 a[20:23], v2, s[8:11], s25 offen offset:1024 sc1
buffer_load_dwordx4 a[24:27], v2, s[8:11], s25 offen offset:2048 sc1
buffer_load_dwordx4 a[28:31], v2, s[8:11], s25 offen offset:3072 sc1
s_add_u32 s25, s25, 4096
buffer_load_dwordx4 a[32:35], v2, s[8:11], s25 offen offset:0 sc1
buffer_load_dwordx4 a[36:39], v2, s[8:11], s25 offen offset:1024 sc1
buffer_load_dwordx4 a[40:43], v2, s[8:11], s25 offen offset:2048 sc1
buffer_load_dwordx4 a[44:47], v2, s[8:11], s25 offen offset:3072 sc1
s_barrier
ds_read_b128 a[216:219], v2 offset:0
ds_read_b128 a[220:223], v2 offset:5120
ds_read_b128 a[224:227], v2 offset:1024
ds_read_b128 a[228:231], v2 offset:6144
ds_read_b128 a[232:235], v2 offset:2048
ds_read_b128 a[236:239], v2 offset:7168
s_mul_i32 s22, s4, 6144
s_mul_i32 s23, s41, 497664
s_add_u32 s23, s23, s22
s_add_u32 s23, s23, 7012352
v_add_u32 v3, s23, v2
s_waitcnt vmcnt(10)
s_waitcnt lgkmcnt(4)
v_mfma_f32_16x16x32_bf16 v[32:35], a[216:219], a[0:3], 0
ds_read_b128 a[240:243], v2 offset:3072
v_mfma_f32_16x16x32_bf16 v[32:35], a[220:223], a[4:7], v[32:35]
ds_read_b128 a[244:247], v2 offset:8192
s_add_u32 s25, s25, 4096
buffer_load_dwordx4 a[48:51], v2, s[8:11], s25 offen offset:0 sc1
s_waitcnt lgkmcnt(4)
v_mfma_f32_16x16x32_bf16 v[36:39], a[224:227], a[0:3], 0
ds_read_b128 a[216:219], v2 offset:4096
v_mfma_f32_16x16x32_bf16 v[36:39], a[228:231], a[4:7], v[36:39]
ds_read_b128 a[220:223], v2 offset:9216
s_waitcnt lgkmcnt(4)
v_mfma_f32_16x16x32_bf16 v[40:43], a[232:235], a[0:3], 0
ds_read_b128 a[224:227], v2 offset:10240
v_mfma_f32_16x16x32_bf16 v[40:43], a[236:239], a[4:7], v[40:43]
ds_read_b128 a[228:231], v2 offset:15360
buffer_load_dwordx4 a[52:55], v2, s[8:11], s25 offen offset:1024 sc1
s_waitcnt lgkmcnt(4)
v_mfma_f32_16x16x32_bf16 v[44:47], a[240:243], a[0:3], 0
ds_read_b128 a[232:235], v2 offset:11264
v_mfma_f32_16x16x32_bf16 v[44:47], a[244:247], a[4:7], v[44:47]
ds_read_b128 a[236:239], v2 offset:16384
s_waitcnt lgkmcnt(4)
v_mfma_f32_16x16x32_bf16 v[48:51], a[216:219], a[0:3], 0
ds_read_b128 a[240:243], v2 offset:12288
v_mfma_f32_16x16x32_bf16 v[48:51], a[220:223], a[4:7], v[48:51]
ds_read_b128 a[244:247], v2 offset:17408
buffer_load_dwordx4 a[56:59], v2, s[8:11], s25 offen offset:2048 sc1
s_waitcnt vmcnt(11)
s_waitcnt lgkmcnt(4)
v_mfma_f32_16x16x32_bf16 v[32:35], a[224:227], a[8:11], v[32:35]
ds_read_b128 a[216:219], v2 offset:13312
v_mfma_f32_16x16x32_bf16 v[32:35], a[228:231], a[12:15], v[32:35]
ds_read_b128 a[220:223], v2 offset:18432
s_waitcnt lgkmcnt(4)
v_mfma_f32_16x16x32_bf16 v[36:39], a[232:235], a[8:11], v[36:39]
ds_read_b128 a[224:227], v2 offset:14336
v_mfma_f32_16x16x32_bf16 v[36:39], a[236:239], a[12:15], v[36:39]
ds_read_b128 a[228:231], v2 offset:19456
buffer_load_dwordx4 a[60:63], v2, s[8:11], s25 offen offset:3072 sc1
s_waitcnt lgkmcnt(4)
v_mfma_f32_16x16x32_bf16 v[40:43], a[240:243], a[8:11], v[40:43]
ds_read_b128 a[232:235], v2 offset:20480
v_mfma_f32_16x16x32_bf16 v[40:43], a[244:247], a[12:15], v[40:43]
ds_read_b128 a[236:239], v2 offset:25600
s_waitcnt lgkmcnt(4)
v_mfma_f32_16x16x32_bf16 v[44:47], a[216:219], a[8:11], v[44:47]
ds_read_b128 a[240:243], v2 offset:21504
v_mfma_f32_16x16x32_bf16 v[44:47], a[220:223], a[12:15], v[44:47]
ds_read_b128 a[244:247], v2 offset:26624
s_add_u32 s25, s25, 4096
buffer_load_dwordx2 a[64:65], v11, s[8:11], s25 offen offset:0 sc1
buffer_load_dwordx2 a[66:67], v11, s[8:11], s25 offen offset:128 sc1
s_waitcnt lgkmcnt(4)
v_mfma_f32_16x16x32_bf16 v[48:51], a[224:227], a[8:11], v[48:51]
ds_read_b128 a[216:219], v2 offset:22528
v_mfma_f32_16x16x32_bf16 v[48:51], a[228:231], a[12:15], v[48:51]
ds_read_b128 a[220:223], v2 offset:27648
s_waitcnt vmcnt(12)
s_waitcnt lgkmcnt(4)
v_mfma_f32_16x16x32_bf16 v[32:35], a[232:235], a[16:19], v[32:35]
ds_read_b128 a[224:227], v2 offset:23552
v_mfma_f32_16x16x32_bf16 v[32:35], a[236:239], a[20:23], v[32:35]
ds_read_b128 a[228:231], v2 offset:28672
buffer_load_dwordx2 a[68:69], v11, s[8:11], s25 offen offset:1024 sc1
buffer_load_dwordx2 a[70:71], v11, s[8:11], s25 offen offset:1152 sc1
s_waitcnt lgkmcnt(4)
v_mfma_f32_16x16x32_bf16 v[36:39], a[240:243], a[16:19], v[36:39]
ds_read_b128 a[232:235], v2 offset:24576
v_mfma_f32_16x16x32_bf16 v[36:39], a[244:247], a[20:23], v[36:39]
ds_read_b128 a[236:239], v2 offset:29696
s_waitcnt lgkmcnt(4)
v_mfma_f32_16x16x32_bf16 v[40:43], a[216:219], a[16:19], v[40:43]
ds_read_b128 a[240:243], v2 offset:30720
v_mfma_f32_16x16x32_bf16 v[40:43], a[220:223], a[20:23], v[40:43]
ds_read_b128 a[244:247], v2 offset:35840
buffer_load_dwordx4 v[56:59], v2, s[8:11], s27 offen sc1
s_waitcnt lgkmcnt(4)
v_mfma_f32_16x16x32_bf16 v[44:47], a[224:227], a[16:19], v[44:47]
ds_read_b128 a[216:219], v2 offset:31744
v_mfma_f32_16x16x32_bf16 v[44:47], a[228:231], a[20:23], v[44:47]
ds_read_b128 a[220:223], v2 offset:36864
s_waitcnt lgkmcnt(4)
v_mfma_f32_16x16x32_bf16 v[48:51], a[232:235], a[16:19], v[48:51]
ds_read_b128 a[224:227], v2 offset:32768
v_mfma_f32_16x16x32_bf16 v[48:51], a[236:239], a[20:23], v[48:51]
ds_read_b128 a[228:231], v2 offset:37888
buffer_load_dwordx4 v[60:63], v2, s[8:11], s27 offen offset:1024 sc1
s_waitcnt vmcnt(14)
s_waitcnt lgkmcnt(4)
v_mfma_f32_16x16x32_bf16 v[32:35], a[240:243], a[24:27], v[32:35]
ds_read_b128 a[232:235], v2 offset:33792
v_mfma_f32_16x16x32_bf16 v[32:35], a[244:247], a[28:31], v[32:35]
ds_read_b128 a[236:239], v2 offset:38912
s_waitcnt lgkmcnt(4)
v_mfma_f32_16x16x32_bf16 v[36:39], a[216:219], a[24:27], v[36:39]
ds_read_b128 a[240:243], v2 offset:34816
v_mfma_f32_16x16x32_bf16 v[36:39], a[220:223], a[28:31], v[36:39]
ds_read_b128 a[244:247], v2 offset:39936
buffer_load_dwordx2 v[64:65], v4, s[8:11], s27 offen sc1
s_waitcnt lgkmcnt(4)
v_mfma_f32_16x16x32_bf16 v[40:43], a[224:227], a[24:27], v[40:43]
ds_read_b128 a[216:219], v2 offset:40960
v_mfma_f32_16x16x32_bf16 v[40:43], a[228:231], a[28:31], v[40:43]
ds_read_b128 a[220:223], v2 offset:46080
s_waitcnt lgkmcnt(4)
v_mfma_f32_16x16x32_bf16 v[44:47], a[232:235], a[24:27], v[44:47]
ds_read_b128 a[224:227], v2 offset:41984
v_mfma_f32_16x16x32_bf16 v[44:47], a[236:239], a[28:31], v[44:47]
ds_read_b128 a[228:231], v2 offset:47104
s_add_u32 m0, s22, 98304
s_nop 0
buffer_load_dwordx4 v3, s[8:11], 0 offen offset:0 sc1 lds
s_waitcnt lgkmcnt(4)
v_mfma_f32_16x16x32_bf16 v[48:51], a[240:243], a[24:27], v[48:51]
ds_read_b128 a[232:235], v2 offset:43008
v_mfma_f32_16x16x32_bf16 v[48:51], a[244:247], a[28:31], v[48:51]
ds_read_b128 a[236:239], v2 offset:48128
s_waitcnt vmcnt(14)
s_waitcnt lgkmcnt(4)
v_mfma_f32_16x16x32_bf16 v[32:35], a[216:219], a[32:35], v[32:35]
ds_read_b128 a[240:243], v2 offset:44032
v_mfma_f32_16x16x32_bf16 v[32:35], a[220:223], a[36:39], v[32:35]
ds_read_b128 a[244:247], v2 offset:49152
buffer_load_dwordx4 v3, s[8:11], 0 offen offset:1024 sc1 lds
s_waitcnt lgkmcnt(4)
v_mfma_f32_16x16x32_bf16 v[36:39], a[224:227], a[32:35], v[36:39]
ds_read_b128 a[216:219], v2 offset:45056
v_mfma_f32_16x16x32_bf16 v[36:39], a[228:231], a[36:39], v[36:39]
ds_read_b128 a[220:223], v2 offset:50176
s_waitcnt lgkmcnt(4)
v_mfma_f32_16x16x32_bf16 v[40:43], a[232:235], a[32:35], v[40:43]
ds_read_b128 a[224:227], v2 offset:51200
v_mfma_f32_16x16x32_bf16 v[40:43], a[236:239], a[36:39], v[40:43]
ds_read_b128 a[228:231], v2 offset:56320
buffer_load_dwordx4 v3, s[8:11], 0 offen offset:2048 sc1 lds
s_waitcnt lgkmcnt(4)
v_mfma_f32_16x16x32_bf16 v[44:47], a[240:243], a[32:35], v[44:47]
ds_read_b128 a[232:235], v2 offset:52224
v_mfma_f32_16x16x32_bf16 v[44:47], a[244:247], a[36:39], v[44:47]
ds_read_b128 a[236:239], v2 offset:57344
s_waitcnt lgkmcnt(4)
v_mfma_f32_16x16x32_bf16 v[48:51], a[216:219], a[32:35], v[48:51]
ds_read_b128 a[240:243], v2 offset:53248
v_mfma_f32_16x16x32_bf16 v[48:51], a[220:223], a[36:39], v[48:51]
ds_read_b128 a[244:247], v2 offset:58368
buffer_load_dwordx4 v3, s[8:11], 0 offen offset:3072 sc1 lds
s_waitcnt vmcnt(15)
s_waitcnt lgkmcnt(4)
v_mfma_f32_16x16x32_bf16 v[32:35], a[224:227], a[40:43], v[32:35]
ds_read_b128 a[216:219], v2 offset:54272
v_mfma_f32_16x16x32_bf16 v[32:35], a[228:231], a[44:47], v[32:35]
ds_read_b128 a[220:223], v2 offset:59392
s_waitcnt lgkmcnt(4)
v_mfma_f32_16x16x32_bf16 v[36:39], a[232:235], a[40:43], v[36:39]
ds_read_b128 a[224:227], v2 offset:55296
v_mfma_f32_16x16x32_bf16 v[36:39], a[236:239], a[44:47], v[36:39]
ds_read_b128 a[228:231], v2 offset:60416
s_add_u32 m0, s22, 102400
v_add_u32 v3, 4096, v3
buffer_load_dwordx4 v3, s[8:11], 0 offen offset:0 sc1 lds
s_waitcnt lgkmcnt(4)
v_mfma_f32_16x16x32_bf16 v[40:43], a[240:243], a[40:43], v[40:43]
ds_read_b128 a[232:235], v2 offset:61440
v_mfma_f32_16x16x32_bf16 v[40:43], a[244:247], a[44:47], v[40:43]
ds_read_b128 a[236:239], v5 offset:1024
s_waitcnt lgkmcnt(4)
v_mfma_f32_16x16x32_bf16 v[44:47], a[216:219], a[40:43], v[44:47]
ds_read_b128 a[240:243], v2 offset:62464
v_mfma_f32_16x16x32_bf16 v[44:47], a[220:223], a[44:47], v[44:47]
ds_read_b128 a[244:247], v5 offset:2048
buffer_load_dwordx4 v3, s[8:11], 0 offen offset:1024 sc1 lds
s_waitcnt lgkmcnt(4)
v_mfma_f32_16x16x32_bf16 v[48:51], a[224:227], a[40:43], v[48:51]
ds_read_b128 a[216:219], v2 offset:63488
v_mfma_f32_16x16x32_bf16 v[48:51], a[228:231], a[44:47], v[48:51]
ds_read_b128 a[220:223], v5 offset:3072
s_waitcnt vmcnt(15)
s_waitcnt lgkmcnt(4)
v_mfma_f32_16x16x32_bf16 v[32:35], a[232:235], a[48:51], v[32:35]
ds_read_b128 a[224:227], v2 offset:64512
v_mfma_f32_16x16x32_bf16 v[32:35], a[236:239], a[52:55], v[32:35]
ds_read_b128 a[228:231], v5 offset:4096
s_add_u32 m0, s22, 122880
v_add_u32 v3, 20480, v3
buffer_load_dwordx4 v3, s[8:11], 0 offen offset:0 sc1 lds
s_waitcnt lgkmcnt(4)
v_mfma_f32_16x16x32_bf16 v[36:39], a[240:243], a[48:51], v[36:39]
ds_read_b128 a[232:235], v5 offset:0
v_mfma_f32_16x16x32_bf16 v[36:39], a[244:247], a[52:55], v[36:39]
ds_read_b128 a[236:239], v5 offset:5120
s_waitcnt lgkmcnt(4)
v_mfma_f32_16x16x32_bf16 v[40:43], a[216:219], a[48:51], v[40:43]
ds_read_b128 a[240:243], v5 offset:6144
v_mfma_f32_16x16x32_bf16 v[40:43], a[220:223], a[52:55], v[40:43]
L_hop2:
s_cmp_lg_u32 s15, 0
s_cbranch_scc1 L_hop6
ds_read_b128 a[244:247], v5 offset:11264
buffer_load_dwordx4 v3, s[8:11], 0 offen offset:1024 sc1 lds
s_waitcnt lgkmcnt(4)
v_mfma_f32_16x16x32_bf16 v[44:47], a[224:227], a[48:51], v[44:47]
ds_read_b128 a[216:219], v5 offset:7168
v_mfma_f32_16x16x32_bf16 v[44:47], a[228:231], a[52:55], v[44:47]
ds_read_b128 a[220:223], v5 offset:12288
s_waitcnt lgkmcnt(4)
v_mfma_f32_16x16x32_bf16 v[48:51], a[232:235], a[48:51], v[48:51]
ds_read_b128 a[224:227], v5 offset:8192
v_mfma_f32_16x16x32_bf16 v[48:51], a[236:239], a[52:55], v[48:51]
ds_read_b128 a[228:231], v5 offset:13312
buffer_load_dwordx4 v3, s[8:11], 0 offen offset:2048 sc1 lds
s_waitcnt vmcnt(16)
s_waitcnt lgkmcnt(4)
v_mfma_f32_16x16x32_bf16 v[32:35], a[240:243], a[56:59], v[32:35]
ds_read_b128 a[232:235], v5 offset:9216
v_mfma_f32_16x16x32_bf16 v[32:35], a[244:247], a[60:63], v[32:35]
ds_read_b128 a[236:239], v5 offset:14336
s_waitcnt lgkmcnt(4)
v_mfma_f32_16x16x32_bf16 v[36:39], a[216:219], a[56:59], v[36:39]
ds_read_b128 a[240:243], v5 offset:10240
v_mfma_f32_16x16x32_bf16 v[36:39], a[220:223], a[60:63], v[36:39]
ds_read_b128 a[244:247], v5 offset:15360
buffer_load_dwordx4 v3, s[8:11], 0 offen offset:3072 sc1 lds
s_waitcnt lgkmcnt(4)
v_mfma_f32_16x16x32_bf16 v[40:43], a[224:227], a[56:59], v[40:43]
ds_read_b128 a[216:219], v5 offset:16384
v_mfma_f32_16x16x32_bf16 v[40:43], a[228:231], a[60:63], v[40:43]
ds_read_b128 a[220:223], v5 offset:21504
s_waitcnt lgkmcnt(4)
v_mfma_f32_16x16x32_bf16 v[44:47], a[232:235], a[56:59], v[44:47]
ds_read_b128 a[224:227], v5 offset:17408
v_mfma_f32_16x16x32_bf16 v[44:47], a[236:239], a[60:63], v[44:47]
ds_read_b128 a[228:231], v5 offset:22528
s_add_u32 m0, s22, 126976
v_add_u32 v3, 4096, v3
buffer_load_dwordx4 v3, s[8:11], 0 offen offset:0 sc1 lds
s_waitcnt lgkmcnt(4)
v_mfma_f32_16x16x32_bf16 v[48:51], a[240:243], a[56:59], v[48:51]
ds_read_b128 a[232:235], v5 offset:18432
v_mfma_f32_16x16x32_bf16 v[48:51], a[244:247], a[60:63], v[48:51]
ds_read_b128 a[236:239], v5 offset:23552
s_waitcnt vmcnt(14)
s_waitcnt lgkmcnt(4)
v_mfma_f32_16x16x32_bf16 v[32:35], a[216:219], a[64:67], v[32:35]
ds_read_b128 a[240:243], v5 offset:19456
v_mfma_f32_16x16x32_bf16 v[32:35], a[220:223], a[68:71], v[32:35]
ds_read_b128 a[244:247], v5 offset:24576
buffer_load_dwordx4 v3, s[8:11], 0 offen offset:1024 sc1 lds
s_waitcnt lgkmcnt(4)
v_mfma_f32_16x16x32_bf16 v[36:39], a[224:227], a[64:67], v[36:39]
ds_read_b128 a[216:219], v5 offset:20480
v_mfma_f32_16x16x32_bf16 v[36:39], a[228:231], a[68:71], v[36:39]
ds_read_b128 a[220:223], v5 offset:25600
s_waitcnt lgkmcnt(4)
v_mfma_f32_16x16x32_bf16 v[40:43], a[232:235], a[64:67], v[40:43]
v_mfma_f32_16x16x32_bf16 v[40:43], a[236:239], a[68:71], v[40:43]
s_waitcnt lgkmcnt(2)
v_mfma_f32_16x16x32_bf16 v[44:47], a[240:243], a[64:67], v[44:47]
v_mfma_f32_16x16x32_bf16 v[44:47], a[244:247], a[68:71], v[44:47]
s_waitcnt lgkmcnt(0)
v_mfma_f32_16x16x32_bf16 v[48:51], a[216:219], a[64:67], v[48:51]
v_mfma_f32_16x16x32_bf16 v[48:51], a[220:223], a[68:71], v[48:51]
s_waitcnt vmcnt(12)
v_lshlrev_b32 v68, 16, v56
v_and_b32 v69, 0xffff0000, v56
v_add_f32 v32, v32, v68
v_add_f32 v33, v33, v69
v_lshlrev_b32 v70, 16, v57
v_and_b32 v71, 0xffff0000, v57
v_add_f32 v34, v34, v70
v_add_f32 v35, v35, v71
v_lshlrev_b32 v72, 16, v58
v_and_b32 v73, 0xffff0000, v58
v_add_f32 v36, v36, v72
v_add_f32 v37, v37, v73
v_lshlrev_b32 v74, 16, v59
v_and_b32 v75, 0xffff0000, v59
v_add_f32 v38, v38, v74
v_add_f32 v39, v39, v75
v_lshlrev_b32 v68, 16, v60
v_and_b32 v69, 0xffff0000, v60
v_add_f32 v40, v40, v68
v_add_f32 v41, v41, v69
v_lshlrev_b32 v70, 16, v61
v_and_b32 v71, 0xffff0000, v61
v_add_f32 v42, v42, v70
v_add_f32 v43, v43, v71
v_lshlrev_b32 v72, 16, v62
v_and_b32 v73, 0xffff0000, v62
v_add_f32 v44, v44, v72
v_add_f32 v45, v45, v73
v_lshlrev_b32 v74, 16, v63
v_and_b32 v75, 0xffff0000, v63
v_add_f32 v46, v46, v74
v_add_f32 v47, v47, v75
v_lshlrev_b32 v68, 16, v64
v_and_b32 v69, 0xffff0000, v64
v_add_f32 v48, v48, v68
v_add_f32 v49, v49, v69
v_lshlrev_b32 v70, 16, v65
v_and_b32 v71, 0xffff0000, v65
v_add_f32 v50, v50, v70
v_add_f32 v51, v51, v71
v_cvt_pk_bf16_f32 v80, v32, v33
v_cvt_pk_bf16_f32 v81, v34, v35
v_cvt_pk_bf16_f32 v82, v36, v37
v_cvt_pk_bf16_f32 v83, v38, v39
v_cvt_pk_bf16_f32 v84, v40, v41
v_cvt_pk_bf16_f32 v85, v42, v43
v_cvt_pk_bf16_f32 v86, v44, v45
v_cvt_pk_bf16_f32 v87, v46, v47
v_cvt_pk_bf16_f32 v88, v48, v49
v_cvt_pk_bf16_f32 v89, v50, v51
s_add_u32 s27, s26, s73
buffer_store_dwordx4 v[80:83], v2, s[8:11], s27 offen sc1
buffer_store_dwordx4 v[84:87], v2, s[8:11], s27 offen offset:1024 sc1
buffer_store_dwordx2 v[88:89], v4, s[8:11], s27 offen sc1
v_add_f32 v10, v32, v33
v_mul_f32 v11, v32, v32
v_mul_f32 v13, v33, v33
v_mov_b32 v12, 0
v_add_f32 v10, v10, v34
v_add_f32 v12, v12, v35
v_fmac_f32 v11, v34, v34
v_fmac_f32 v13, v35, v35
v_add_f32 v10, v10, v36
v_add_f32 v12, v12, v37
v_fmac_f32 v11, v36, v36
v_fmac_f32 v13, v37, v37
v_add_f32 v10, v10, v38
v_add_f32 v12, v12, v39
v_fmac_f32 v11, v38, v38
v_fmac_f32 v13, v39, v39
v_add_f32 v10, v10, v40
v_add_f32 v12, v12, v41
v_fmac_f32 v11, v40, v40
v_fmac_f32 v13, v41, v41
v_add_f32 v10, v10, v42
v_add_f32 v12, v12, v43
v_fmac_f32 v11, v42, v42
v_fmac_f32 v13, v43, v43
v_add_f32 v10, v10, v44
v_add_f32 v12, v12, v45
v_fmac_f32 v11, v44, v44
v_fmac_f32 v13, v45, v45
v_add_f32 v10, v10, v46
v_add_f32 v12, v12, v47
v_fmac_f32 v11, v46, v46
v_fmac_f32 v13, v47, v47
v_add_f32 v10, v10, v48
v_add_f32 v12, v12, v49
v_fmac_f32 v11, v48, v48
v_fmac_f32 v13, v49, v49
v_add_f32 v10, v10, v50
v_add_f32 v12, v12, v51
v_fmac_f32 v11, v50, v50
v_fmac_f32 v13, v51, v51
v_add_f32 v10, v10, v12
v_add_f32 v11, v11, v13
v_mov_b32 v12, v10
v_mov_b32 v13, v11
s_nop 0
v_permlane16_swap_b32 v10, v12
v_permlane16_swap_b32 v11, v13
v_add_f32 v10, v10, v12
v_add_f32 v11, v11, v13
v_mov_b32 v12, v10
v_mov_b32 v13, v11
s_nop 0
v_permlane32_swap_b32 v10, v12
v_permlane32_swap_b32 v11, v13
v_add_f32 v10, v10, v12
v_add_f32 v11, v11, v13
v_lshlrev_b32 v8, 3, v6
v_cmp_gt_u32 vcc, 16, v1
s_nop 1
v_cndmask_b32 v8, v9, v8, vcc
s_lshl_b32 s27, s20, 10
s_lshl_b32 s28, s21, 7
s_add_u32 s27, s27, s28
s_add_u32 s27, s27, s74
buffer_store_dwordx2 v[10:11], v8, s[8:11], s27 offen sc1
s_lshr_b32 s27, s20, 2
s_lshl_b32 s27, s27, 3
s_add_u32 s27, s27, s21
s_lshl_b32 s14, s27, 7
s_add_u32 s14, s14, 524288
s_add_u32 s14, s14, s77
s_lshl_b32 s44, s40, 4
s_lshl_b32 s45, s4, 2
s_add_u32 s44, s44, s45
s_mul_i32 s46, s44, 18432
s_add_u32 s20, s46, s73
v_add_u32 v4, 18432, v2
v_add_u32 v5, 36864, v2
v_add_u32 v6, 55296, v2
v_lshlrev_b32 v248, 3, v1
v_add_u32 v249, 18432, v248
v_add_u32 v250, 36864, v248
v_add_u32 v251, 55296, v248
v_and_b32 v13, 15, v1
v_lshrrev_b32 v14, 4, v1
v_add_u32 v7, 0x10000, v2
v_add_u32 v8, 0x20000, v2
v_and_b32 v9, 1, v14
v_mul_u32_u24 v9, 18432, v9
v_lshrrev_b32 v15, 1, v14
v_lshlrev_b32 v15, 8, v15
v_lshl_add_u32 v15, v13, 4, v15
v_add_u32 v9, v9, v15
v_and_b32 v11, 3, v1
v_lshlrev_b32 v11, 7, v11
s_lshl_b32 s49, s43, 7
v_mov_b32 v10, 2146435072
v_lshl_add_u32 v15, v1, 3, s49
v_cmp_gt_u32 vcc, 16, v1
s_nop 1
v_cndmask_b32 v10, v10, v15, vcc
s_lshl_b32 s49, s40, 3
s_add_u32 s49, s49, s42
s_lshl_b32 s50, s49, 2
s_add_u32 s50, s50, s4
s_lshl_b32 s50, s50, 9
s_add_u32 s34, s50, s77
s_add_u32 s34, s34, 0
s_lshl_b32 s49, s49, 4
s_add_u32 s49, s49, s45
s_mul_i32 s49, s49, 18432
s_add_u32 s49, s49, s75
s_add_u32 s50, s43, 0
s_and_b32 s50, s50, 3
s_mul_i32 s50, s50, 9
s_add_u32 s50, s50, 1
s_lshr_b32 s50, s50, 1
s_lshl_b32 s50, s50, 10
s_add_u32 s24, s49, s50
s_add_u32 s50, s43, 1
s_and_b32 s50, s50, 3
s_mul_i32 s50, s50, 9
s_add_u32 s50, s50, 1
s_lshr_b32 s50, s50, 1
s_lshl_b32 s50, s50, 10
s_add_u32 s25, s49, s50
s_add_u32 s50, s43, 2
s_and_b32 s50, s50, 3
s_mul_i32 s50, s50, 9
s_add_u32 s50, s50, 1
s_lshr_b32 s50, s50, 1
s_lshl_b32 s50, s50, 10
s_add_u32 s26, s49, s50
s_add_u32 s50, s43, 3
s_and_b32 s50, s50, 3
s_mul_i32 s50, s50, 9
s_add_u32 s50, s50, 1
s_lshr_b32 s50, s50, 1
s_lshl_b32 s50, s50, 10
s_add_u32 s27, s49, s50
s_add_u32 s28, s49, 4096
s_add_u32 s29, s49, 13312
s_cmp_ge_u32 s43, 2
s_cselect_b32 s50, s29, s28
s_and_b32 s51, s43, 1
s_lshl_b32 s51, s51, 9
s_add_u32 s30, s50, s51
s_mul_i32 s50, s42, 2359296
s_add_u32 s50, s50, s46
s_add_u32 s50, s50, s76
s_lshl_b32 s51, s43, 12
s_add_u32 s31, s50, s51
s_lshl_b32 s51, s43, 9
s_add_u32 s50, s50, s51
s_add_u32 s32, s50, 16384
s_add_u32 s33, s32, 36864
s_add_u32 s36, s31, 0
s_add_u32 s37, s31, 18432
s_add_u32 s38, s31, 36864
s_add_u32 s39, s31, 55296
v_lshlrev_b32 v252, 4, v13
v_lshl_add_u32 v252, v14, 9, v252
s_lshl_b32 s35, s40, 5
s_add_u32 s35, s35, s41
s_lshl_b32 s35, s35, 7
s_add_u32 s35, s35, s77
s_add_u32 s35, s35, 655360
v_lshlrev_b32 v17, 3, v13
v_lshl_add_u32 v17, v14, 8, v17
s_lshl_b32 s47, s44, 10
s_add_u32 s47, s47, s74
s_lshl_b32 s49, s44, 8
s_add_u32 s49, s49, s77
s_add_u32 s49, s49, 524288
v_and_b32 v16, 7, v1
v_lshlrev_b32 v16, 7, v16
s_lshl_b32 s50, s43, 7
s_add_u32 s44, s35, 262144
s_sub_u32 s44, s44, s50
s_cmp_eq_u32 s4, 0
s_cselect_b32 s44, s44, 2146435072
v_mov_b32 v13, 2146435072
v_cmp_gt_u32 vcc, 16, v0
v_lshlrev_b32 v14, 3, v0
s_nop 0
v_cndmask_b32 v13, v13, v14, vcc
v_mov_b32 v14, s68
v_mov_b32 v15, s69
s_waitcnt vmcnt(0)
s_barrier
buffer_store_dwordx2 v[14:15], v13, s[8:11], s14 offen sc1
s_add_u32 m0, s22, 0
v_add_u32 v3, 20480, v3
buffer_load_dwordx4 v3, s[8:11], 0 offen offset:0 sc1 lds
buffer_load_dwordx4 v3, s[8:11], 0 offen offset:1024 sc1 lds
buffer_load_dwordx4 v3, s[8:11], 0 offen offset:2048 sc1 lds
buffer_load_dwordx4 v3, s[8:11], 0 offen offset:3072 sc1 lds
s_add_u32 m0, s22, 4096
v_add_u32 v3, 4096, v3
buffer_load_dwordx4 v3, s[8:11], 0 offen offset:0 sc1 lds
buffer_load_dwordx4 v3, s[8:11], 0 offen offset:1024 sc1 lds
s_add_u32 m0, s22, 24576
v_add_u32 v3, 20480, v3
buffer_load_dwordx4 v3, s[8:11], 0 offen offset:0 sc1 lds
buffer_load_dwordx4 v3, s[8:11], 0 offen offset:1024 sc1 lds
buffer_load_dwordx4 v3, s[8:11], 0 offen offset:2048 sc1 lds
buffer_load_dwordx4 v3, s[8:11], 0 offen offset:3072 sc1 lds
s_add_u32 m0, s22, 28672
v_add_u32 v3, 4096, v3
buffer_load_dwordx4 v3, s[8:11], 0 offen offset:0 sc1 lds
buffer_load_dwordx4 v3, s[8:11], 0 offen offset:1024 sc1 lds
ds_read_b128 v[48:51], v7 offset:32768
ds_read_b128 v[52:55], v7 offset:33792
ds_read_b128 v[56:59], v7 offset:34816
ds_read_b128 v[60:63], v7 offset:35840
ds_read_b128 v[64:67], v7 offset:36864
ds_read_b128 v[68:71], v7 offset:37888
s_mov_b32 s52, 0
L_poll3:
buffer_load_dwordx2 v[14:15], v16, s[8:11], s49 offen sc1
s_add_u32 s52, s52, 1
s_waitcnt vmcnt(0)
v_cmp_ne_u64 vcc, s[68:69], v[14:15]
s_cmp_ge_u32 s52, 1048576
s_cbranch_scc1 L_got3
s_and_b64 exec, exec, vcc
s_cbranch_execnz L_poll3
L_got3:
s_mov_b64 exec, -1
s_add_u32 s48, s20, 0
buffer_load_dwordx4 a[0:3], v2, s[8:11], s48 offen offset:0 sc1
buffer_load_dwordx4 a[4:7], v4, s[8:11], s48 offen offset:0 sc1
buffer_load_dwordx4 a[8:11], v5, s[8:11], s48 offen offset:0 sc1
buffer_load_dwordx4 a[12:15], v6, s[8:11], s48 offen offset:0 sc1
buffer_load_dwordx4 a[16:19], v2, s[8:11], s48 offen offset:1024 sc1
buffer_load_dwordx4 a[20:23], v4, s[8:11], s48 offen offset:1024 sc1
buffer_load_dwordx4 a[24:27], v5, s[8:11], s48 offen offset:1024 sc1
buffer_load_dwordx4 a[28:31], v6, s[8:11], s48 offen offset:1024 sc1
buffer_load_dwordx2 v[144:145], v17, s[8:11], s47 offen offset:0 sc1
buffer_load_dwordx2 v[146:147], v17, s[8:11], s47 offen offset:128 sc1
buffer_load_dwordx2 v[148:149], v17, s[8:11], s47 offen offset:1024 sc1
buffer_load_dwordx2 v[150:151], v17, s[8:11], s47 offen offset:1152 sc1
buffer_load_dwordx2 v[152:153], v17, s[8:11], s47 offen offset:2048 sc1
buffer_load_dwordx2 v[154:155], v17, s[8:11], s47 offen offset:2176 sc1
buffer_load_dwordx2 v[156:157], v17, s[8:11], s47 offen offset:3072 sc1
buffer_load_dwordx2 v[158:159], v17, s[8:11], s47 offen offset:3200 sc1
buffer_load_dwordx4 a[32:35], v2, s[8:11], s48 offen offset:2048 sc1
buffer_load_dwordx4 a[36:39], v4, s[8:11], s48 offen offset:2048 sc1
buffer_load_dwordx4 a[40:43], v5, s[8:11], s48 offen offset:2048 sc1
buffer_load_dwordx4 a[44:47], v6, s[8:11], s48 offen offset:2048 sc1
buffer_load_dwordx4 a[48:51], v2, s[8:11], s48 offen offset:3072 sc1
buffer_load_dwordx4 a[52:55], v4, s[8:11], s48 offen offset:3072 sc1
buffer_load_dwordx4 a[56:59], v5, s[8:11], s48 offen offset:3072 sc1
buffer_load_dwordx4 a[60:63], v6, s[8:11], s48 offen offset:3072 sc1
s_add_u32 s48, s20, 4096
buffer_load_dwordx4 a[64:67], v2, s[8:11], s48 offen offset:0 sc1
buffer_load_dwordx4 a[68:71], v4, s[8:11], s48 offen offset:0 sc1
buffer_load_dwordx4 a[72:75], v5, s[8:11], s48 offen offset:0 sc1
buffer_load_dwordx4 a[76:79], v6, s[8:11], s48 offen offset:0 sc1
s_waitcnt vmcnt(20)
s_waitcnt lgkmcnt(4)
v_mfma_f32_16x16x32_bf16 v[80:83], v[48:51], a[0:3], 0
buffer_load_dwordx4 a[80:83], v2, s[8:11], s48 offen offset:1024 sc1
v_mfma_f32_16x16x32_bf16 v[80:83], v[52:55], a[16:19], v[80:83]
v_mfma_f32_16x16x32_bf16 v[84:87], v[48:51], a[4:7], 0
ds_read_b128 v[72:75], v7 offset:38912
v_mfma_f32_16x16x32_bf16 v[84:87], v[52:55], a[20:23], v[84:87]
v_mfma_f32_16x16x32_bf16 v[88:91], v[48:51], a[8:11], 0
buffer_load_dwordx4 a[84:87], v4, s[8:11], s48 offen offset:1024 sc1
v_mfma_f32_16x16x32_bf16 v[88:91], v[52:55], a[24:27], v[88:91]
ds_read_b128 v[76:79], v7 offset:39936
v_mfma_f32_16x16x32_bf16 v[92:95], v[48:51], a[12:15], 0
v_mfma_f32_16x16x32_bf16 v[92:95], v[52:55], a[28:31], v[92:95]
s_waitcnt lgkmcnt(4)
v_mfma_f32_16x16x32_bf16 v[96:99], v[56:59], a[0:3], 0
buffer_load_dwordx4 a[88:91], v5, s[8:11], s48 offen offset:1024 sc1
v_mfma_f32_16x16x32_bf16 v[96:99], v[60:63], a[16:19], v[96:99]
v_mfma_f32_16x16x32_bf16 v[100:103], v[56:59], a[4:7], 0
ds_read_b128 v[48:51], v7 offset:40960
v_mfma_f32_16x16x32_bf16 v[100:103], v[60:63], a[20:23], v[100:103]
v_mfma_f32_16x16x32_bf16 v[104:107], v[56:59], a[8:11], 0
buffer_load_dwordx4 a[92:95], v6, s[8:11], s48 offen offset:1024 sc1
v_mfma_f32_16x16x32_bf16 v[104:107], v[60:63], a[24:27], v[104:107]
ds_read_b128 v[52:55], v7 offset:41984
v_mfma_f32_16x16x32_bf16 v[108:111], v[56:59], a[12:15], 0
v_mfma_f32_16x16x32_bf16 v[108:111], v[60:63], a[28:31], v[108:111]
s_waitcnt lgkmcnt(4)
v_mfma_f32_16x16x32_bf16 v[112:115], v[64:67], a[0:3], 0
buffer_load_dwordx4 a[96:99], v2, s[8:11], s48 offen offset:2048 sc1
v_mfma_f32_16x16x32_bf16 v[112:115], v[68:71], a[16:19], v[112:115]
v_mfma_f32_16x16x32_bf16 v[116:119], v[64:67], a[4:7], 0
ds_read_b128 v[56:59], v7 offset:43008
v_mfma_f32_16x16x32_bf16 v[116:119], v[68:71], a[20:23], v[116:119]
v_mfma_f32_16x16x32_bf16 v[120:123], v[64:67], a[8:11], 0
buffer_load_dwordx4 a[100:103], v4, s[8:11], s48 offen offset:2048 sc1
v_mfma_f32_16x16x32_bf16 v[120:123], v[68:71], a[24:27], v[120:123]
ds_read_b128 v[60:63], v7 offset:44032
v_mfma_f32_16x16x32_bf16 v[124:127], v[64:67], a[12:15], 0
v_mfma_f32_16x16x32_bf16 v[124:127], v[68:71], a[28:31], v[124:127]
s_waitcnt lgkmcnt(4)
v_mfma_f32_16x16x32_bf16 v[128:131], v[72:75], a[0:3], 0
buffer_load_dwordx4 a[104:107], v5, s[8:11], s48 offen offset:2048 sc1
v_mfma_f32_16x16x32_bf16 v[128:131], v[76:79], a[16:19], v[128:131]
v_mfma_f32_16x16x32_bf16 v[132:135], v[72:75], a[4:7], 0
ds_read_b128 v[64:67], v7 offset:45056
v_mfma_f32_16x16x32_bf16 v[132:135], v[76:79], a[20:23], v[132:135]
v_mfma_f32_16x16x32_bf16 v[136:139], v[72:75], a[8:11], 0
buffer_load_dwordx4 a[108:111], v6, s[8:11], s48 offen offset:2048 sc1
v_mfma_f32_16x16x32_bf16 v[136:139], v[76:79], a[24:27], v[136:139]
ds_read_b128 v[68:71], v7 offset:46080
v_mfma_f32_16x16x32_bf16 v[140:143], v[72:75], a[12:15], 0
v_mfma_f32_16x16x32_bf16 v[140:143], v[76:79], a[28:31], v[140:143]
s_waitcnt vmcnt(12)
s_waitcnt lgkmcnt(4)
v_mfma_f32_16x16x32_bf16 v[80:83], v[48:51], a[32:35], v[80:83]
buffer_load_dwordx4 a[112:115], v2, s[8:11], s48 offen offset:3072 sc1
v_mfma_f32_16x16x32_bf16 v[80:83], v[52:55], a[48:51], v[80:83]
v_mfma_f32_16x16x32_bf16 v[84:87], v[48:51], a[36:39], v[84:87]
ds_read_b128 v[72:75], v7 offset:47104
v_mfma_f32_16x16x32_bf16 v[84:87], v[52:55], a[52:55], v[84:87]
v_mfma_f32_16x16x32_bf16 v[88:91], v[48:51], a[40:43], v[88:91]
buffer_load_dwordx4 a[116:119], v4, s[8:11], s48 offen offset:3072 sc1
v_mfma_f32_16x16x32_bf16 v[88:91], v[52:55], a[56:59], v[88:91]
ds_read_b128 v[76:79], v7 offset:48128
v_mfma_f32_16x16x32_bf16 v[92:95], v[48:51], a[44:47], v[92:95]
v_mfma_f32_16x16x32_bf16 v[92:95], v[52:55], a[60:63], v[92:95]
s_waitcnt lgkmcnt(4)
v_mfma_f32_16x16x32_bf16 v[96:99], v[56:59], a[32:35], v[96:99]
buffer_load_dwordx4 a[120:123], v5, s[8:11], s48 offen offset:3072 sc1
v_mfma_f32_16x16x32_bf16 v[96:99], v[60:63], a[48:51], v[96:99]
v_mfma_f32_16x16x32_bf16 v[100:103], v[56:59], a[36:39], v[100:103]
ds_read_b128 v[48:51], v7 offset:49152
v_mfma_f32_16x16x32_bf16 v[100:103], v[60:63], a[52:55], v[100:103]
v_mfma_f32_16x16x32_bf16 v[104:107], v[56:59], a[40:43], v[104:107]
buffer_load_dwordx4 a[124:127], v6, s[8:11], s48 offen offset:3072 sc1
v_mfma_f32_16x16x32_bf16 v[104:107], v[60:63], a[56:59], v[104:107]
ds_read_b128 v[52:55], v7 offset:50176
s_add_u32 s48, s20, 8192
v_mfma_f32_16x16x32_bf16 v[108:111], v[56:59], a[44:47], v[108:111]
v_mfma_f32_16x16x32_bf16 v[108:111], v[60:63], a[60:63], v[108:111]
s_waitcnt lgkmcnt(4)
v_mfma_f32_16x16x32_bf16 v[112:115], v[64:67], a[32:35], v[112:115]
buffer_load_dwordx4 a[128:131], v2, s[8:11], s48 offen offset:0 sc1
v_mfma_f32_16x16x32_bf16 v[112:115], v[68:71], a[48:51], v[112:115]
v_mfma_f32_16x16x32_bf16 v[116:119], v[64:67], a[36:39], v[116:119]
ds_read_b128 v[56:59], v7 offset:51200
v_mfma_f32_16x16x32_bf16 v[116:119], v[68:71], a[52:55], v[116:119]
v_mfma_f32_16x16x32_bf16 v[120:123], v[64:67], a[40:43], v[120:123]
buffer_load_dwordx4 a[132:135], v4, s[8:11], s48 offen offset:0 sc1
v_mfma_f32_16x16x32_bf16 v[120:123], v[68:71], a[56:59], v[120:123]
ds_read_b128 v[60:63], v7 offset:52224
v_mfma_f32_16x16x32_bf16 v[124:127], v[64:67], a[44:47], v[124:127]
v_mfma_f32_16x16x32_bf16 v[124:127], v[68:71], a[60:63], v[124:127]
s_waitcnt lgkmcnt(4)
v_mfma_f32_16x16x32_bf16 v[128:131], v[72:75], a[32:35], v[128:131]
buffer_load_dwordx4 a[136:139], v5, s[8:11], s48 offen offset:0 sc1
v_mfma_f32_16x16x32_bf16 v[128:131], v[76:79], a[48:51], v[128:131]
v_mfma_f32_16x16x32_bf16 v[132:135], v[72:75], a[36:39], v[132:135]
ds_read_b128 v[64:67], v7 offset:53248
v_mfma_f32_16x16x32_bf16 v[132:135], v[76:79], a[52:55], v[132:135]
v_mfma_f32_16x16x32_bf16 v[136:139], v[72:75], a[40:43], v[136:139]
buffer_load_dwordx4 a[140:143], v6, s[8:11], s48 offen offset:0 sc1
v_mfma_f32_16x16x32_bf16 v[136:139], v[76:79], a[56:59], v[136:139]
ds_read_b128 v[68:71], v7 offset:54272
v_mfma_f32_16x16x32_bf16 v[140:143], v[72:75], a[44:47], v[140:143]
v_mfma_f32_16x16x32_bf16 v[140:143], v[76:79], a[60:63], v[140:143]
s_waitcnt vmcnt(12)
s_waitcnt lgkmcnt(4)
v_mfma_f32_16x16x32_bf16 v[80:83], v[48:51], a[64:67], v[80:83]
buffer_load_dwordx4 a[144:147], v2, s[8:11], s48 offen offset:1024 sc1
v_mfma_f32_16x16x32_bf16 v[80:83], v[52:55], a[80:83], v[80:83]
v_mfma_f32_16x16x32_bf16 v[84:87], v[48:51], a[68:71], v[84:87]
ds_read_b128 v[72:75], v7 offset:55296
v_mfma_f32_16x16x32_bf16 v[84:87], v[52:55], a[84:87], v[84:87]
v_add_f32 v144, v144, v146
v_add_f32 v145, v145, v147
v_mfma_f32_16x16x32_bf16 v[88:91], v[48:51], a[72:75], v[88:91]
buffer_load_dwordx4 a[148:151], v4, s[8:11], s48 offen offset:1024 sc1
v_mfma_f32_16x16x32_bf16 v[88:91], v[52:55], a[88:91], v[88:91]
ds_read_b128 v[76:79], v7 offset:56320
v_add_f32 v148, v148, v150
v_mfma_f32_16x16x32_bf16 v[92:95], v[48:51], a[76:79], v[92:95]
v_add_f32 v149, v149, v151
v_add_f32 v152, v152, v154
v_mfma_f32_16x16x32_bf16 v[92:95], v[52:55], a[92:95], v[92:95]
v_add_f32 v153, v153, v155
s_waitcnt lgkmcnt(4)
v_mfma_f32_16x16x32_bf16 v[96:99], v[56:59], a[64:67], v[96:99]
buffer_load_dwordx4 a[152:155], v5, s[8:11], s48 offen offset:1024 sc1
v_mfma_f32_16x16x32_bf16 v[96:99], v[60:63], a[80:83], v[96:99]
s_barrier
v_mfma_f32_16x16x32_bf16 v[100:103], v[56:59], a[68:71], v[100:103]
ds_read_b128 v[48:51], v7 offset:57344
v_add_f32 v156, v156, v158
v_mfma_f32_16x16x32_bf16 v[100:103], v[60:63], a[84:87], v[100:103]
v_add_f32 v157, v157, v159
v_mov_b32 v160, v144
v_mfma_f32_16x16x32_bf16 v[104:107], v[56:59], a[72:75], v[104:107]
buffer_load_dwordx4 a[156:159], v6, s[8:11], s48 offen offset:1024 sc1
v_mfma_f32_16x16x32_bf16 v[104:107], v[60:63], a[88:91], v[104:107]
ds_read_b128 v[52:55], v7 offset:58368
v_mov_b32 v161, v145
v_mfma_f32_16x16x32_bf16 v[108:111], v[56:59], a[76:79], v[108:111]
v_mov_b32 v162, v148
v_mov_b32 v163, v149
v_mfma_f32_16x16x32_bf16 v[108:111], v[60:63], a[92:95], v[108:111]
v_mov_b32 v164, v152
s_waitcnt lgkmcnt(4)
v_mfma_f32_16x16x32_bf16 v[112:115], v[64:67], a[64:67], v[112:115]
buffer_load_dwordx4 a[160:163], v2, s[8:11], s48 offen offset:2048 sc1
v_mfma_f32_16x16x32_bf16 v[112:115], v[68:71], a[80:83], v[112:115]
v_mov_b32 v165, v153
v_mov_b32 v166, v156
v_mfma_f32_16x16x32_bf16 v[116:119], v[64:67], a[68:71], v[116:119]
ds_read_b128 v[56:59], v7 offset:59392
v_mov_b32 v167, v157
v_mfma_f32_16x16x32_bf16 v[116:119], v[68:71], a[84:87], v[116:119]
v_permlane16_swap_b32 v144, v160
v_permlane16_swap_b32 v145, v161
v_mfma_f32_16x16x32_bf16 v[120:123], v[64:67], a[72:75], v[120:123]
buffer_load_dwordx4 a[164:167], v4, s[8:11], s48 offen offset:2048 sc1
v_mfma_f32_16x16x32_bf16 v[120:123], v[68:71], a[88:91], v[120:123]
ds_read_b128 v[60:63], v7 offset:60416
v_permlane16_swap_b32 v148, v162
v_mfma_f32_16x16x32_bf16 v[124:127], v[64:67], a[76:79], v[124:127]
v_permlane16_swap_b32 v149, v163
v_permlane16_swap_b32 v152, v164
v_mfma_f32_16x16x32_bf16 v[124:127], v[68:71], a[92:95], v[124:127]
v_permlane16_swap_b32 v153, v165
s_waitcnt lgkmcnt(4)
v_mfma_f32_16x16x32_bf16 v[128:131], v[72:75], a[64:67], v[128:131]
buffer_load_dwordx4 a[168:171], v5, s[8:11], s48 offen offset:2048 sc1
v_mfma_f32_16x16x32_bf16 v[128:131], v[76:79], a[80:83], v[128:131]
v_permlane16_swap_b32 v156, v166
v_permlane16_swap_b32 v157, v167
v_mfma_f32_16x16x32_bf16 v[132:135], v[72:75], a[68:71], v[132:135]
ds_read_b128 v[64:67], v7 offset:61440
v_add_f32 v144, v144, v160
v_mfma_f32_16x16x32_bf16 v[132:135], v[76:79], a[84:87], v[132:135]
v_add_f32 v145, v145, v161
v_add_f32 v148, v148, v162
v_mfma_f32_16x16x32_bf16 v[136:139], v[72:75], a[72:75], v[136:139]
buffer_load_dwordx4 a[172:175], v6, s[8:11], s48 offen offset:2048 sc1
v_mfma_f32_16x16x32_bf16 v[136:139], v[76:79], a[88:91], v[136:139]
ds_read_b128 v[68:71], v7 offset:62464
v_add_f32 v149, v149, v163
v_mfma_f32_16x16x32_bf16 v[140:143], v[72:75], a[76:79], v[140:143]
v_add_f32 v152, v152, v164
v_add_f32 v153, v153, v165
v_mfma_f32_16x16x32_bf16 v[140:143], v[76:79], a[92:95], v[140:143]
v_add_f32 v156, v156, v166
s_waitcnt vmcnt(12)
s_waitcnt lgkmcnt(4)
v_mfma_f32_16x16x32_bf16 v[80:83], v[48:51], a[96:99], v[80:83]
buffer_load_dwordx4 a[176:179], v2, s[8:11], s48 offen offset:3072 sc1
v_mfma_f32_16x16x32_bf16 v[80:83], v[52:55], a[112:115], v[80:83]
v_add_f32 v157, v157, v167
v_mov_b32 v160, v144
v_mfma_f32_16x16x32_bf16 v[84:87], v[48:51], a[100:103], v[84:87]
ds_read_b128 v[72:75], v7 offset:63488
v_mov_b32 v161, v145
v_mfma_f32_16x16x32_bf16 v[84:87], v[52:55], a[116:119], v[84:87]
v_mov_b32 v162, v148
v_mov_b32 v163, v149
v_mfma_f32_16x16x32_bf16 v[88:91], v[48:51], a[104:107], v[88:91]
buffer_load_dwordx4 a[180:183], v4, s[8:11], s48 offen offset:3072 sc1
v_mfma_f32_16x16x32_bf16 v[88:91], v[52:55], a[120:123], v[88:91]
ds_read_b128 v[76:79], v7 offset:64512
v_mov_b32 v164, v152
v_mfma_f32_16x16x32_bf16 v[92:95], v[48:51], a[108:111], v[92:95]
v_mov_b32 v165, v153
v_mov_b32 v166, v156
v_mfma_f32_16x16x32_bf16 v[92:95], v[52:55], a[124:127], v[92:95]
v_mov_b32 v167, v157
s_waitcnt lgkmcnt(4)
v_mfma_f32_16x16x32_bf16 v[96:99], v[56:59], a[96:99], v[96:99]
buffer_load_dwordx4 a[184:187], v5, s[8:11], s48 offen offset:3072 sc1
v_mfma_f32_16x16x32_bf16 v[96:99], v[60:63], a[112:115], v[96:99]
v_permlane32_swap_b32 v144, v160
v_permlane32_swap_b32 v145, v161
v_mfma_f32_16x16x32_bf16 v[100:103], v[56:59], a[100:103], v[100:103]
ds_read_b128 v[48:51], v8 offset:0
v_permlane32_swap_b32 v148, v162
v_mfma_f32_16x16x32_bf16 v[100:103], v[60:63], a[116:119], v[100:103]
v_permlane32_swap_b32 v149, v163
v_permlane32_swap_b32 v152, v164
v_mfma_f32_16x16x32_bf16 v[104:107], v[56:59], a[104:107], v[104:107]
buffer_load_dwordx4 a[188:191], v6, s[8:11], s48 offen offset:3072 sc1
v_mfma_f32_16x16x32_bf16 v[104:107], v[60:63], a[120:123], v[104:107]
ds_read_b128 v[52:55], v8 offset:1024
s_add_u32 s48, s20, 12288
v_mfma_f32_16x16x32_bf16 v[108:111], v[56:59], a[108:111], v[108:111]
v_permlane32_swap_b32 v153, v165
v_permlane32_swap_b32 v156, v166
v_mfma_f32_16x16x32_bf16 v[108:111], v[60:63], a[124:127], v[108:111]
v_permlane32_swap_b32 v157, v167
s_waitcnt lgkmcnt(4)
v_mfma_f32_16x16x32_bf16 v[112:115], v[64:67], a[96:99], v[112:115]
buffer_load_dwordx4 a[192:195], v2, s[8:11], s48 offen offset:0 sc1
v_mfma_f32_16x16x32_bf16 v[112:115], v[68:71], a[112:115], v[112:115]
v_add_f32 v144, v144, v160
v_add_f32 v145, v145, v161
v_mfma_f32_16x16x32_bf16 v[116:119], v[64:67], a[100:103], v[116:119]
ds_read_b128 v[56:59], v8 offset:2048
v_add_f32 v148, v148, v162
v_mfma_f32_16x16x32_bf16 v[116:119], v[68:71], a[116:119], v[116:119]
v_add_f32 v149, v149, v163
v_add_f32 v152, v152, v164
v_mfma_f32_16x16x32_bf16 v[120:123], v[64:67], a[104:107], v[120:123]
buffer_load_dwordx4 a[196:199], v4, s[8:11], s48 offen offset:0 sc1
v_mfma_f32_16x16x32_bf16 v[120:123], v[68:71], a[120:123], v[120:123]
ds_read_b128 v[60:63], v8 offset:3072
v_add_f32 v153, v153, v165
v_mfma_f32_16x16x32_bf16 v[124:127], v[64:67], a[108:111], v[124:127]
v_add_f32 v156, v156, v166
v_add_f32 v157, v157, v167
v_mfma_f32_16x16x32_bf16 v[124:127], v[68:71], a[124:127], v[124:127]
v_mul_f32 v144, 0x3ae38e39, v144
s_waitcnt lgkmcnt(4)
v_mfma_f32_16x16x32_bf16 v[128:131], v[72:75], a[96:99], v[128:131]
buffer_load_dwordx4 a[200:203], v5, s[8:11], s48 offen offset:0 sc1
v_mfma_f32_16x16x32_bf16 v[128:131], v[76:79], a[112:115], v[128:131]
v_mul_f32 v148, 0x3ae38e39, v148
v_mul_f32 v152, 0x3ae38e39, v152
v_mfma_f32_16x16x32_bf16 v[132:135], v[72:75], a[100:103], v[132:135]
ds_read_b128 v[64:67], v8 offset:4096
v_mul_f32 v156, 0x3ae38e39, v156
v_mfma_f32_16x16x32_bf16 v[132:135], v[76:79], a[116:119], v[132:135]
v_mul_f32 v145, 0x3ae38e39, v145
v_mul_f32 v149, 0x3ae38e39, v149
v_mfma_f32_16x16x32_bf16 v[136:139], v[72:75], a[104:107], v[136:139]
buffer_load_dwordx4 a[204:207], v6, s[8:11], s48 offen offset:0 sc1
v_mfma_f32_16x16x32_bf16 v[136:139], v[76:79], a[120:123], v[136:139]
ds_read_b128 v[68:71], v8 offset:5120
v_mul_f32 v153, 0x3ae38e39, v153
v_mfma_f32_16x16x32_bf16 v[140:143], v[72:75], a[108:111], v[140:143]
v_mul_f32 v157, 0x3ae38e39, v157
v_fma_f32 v145, -v144, v144, v145
v_mfma_f32_16x16x32_bf16 v[140:143], v[76:79], a[124:127], v[140:143]
v_fma_f32 v149, -v148, v148, v149
L_hop3:
s_cmp_lg_u32 s15, 0
s_cbranch_scc1 L_hop7
s_waitcnt vmcnt(12)
s_waitcnt lgkmcnt(4)
v_mfma_f32_16x16x32_bf16 v[80:83], v[48:51], a[128:131], v[80:83]
buffer_load_dwordx4 a[208:211], v2, s[8:11], s48 offen offset:1024 sc1
v_mfma_f32_16x16x32_bf16 v[80:83], v[52:55], a[144:147], v[80:83]
v_fma_f32 v153, -v152, v152, v153
v_fma_f32 v157, -v156, v156, v157
v_mfma_f32_16x16x32_bf16 v[84:87], v[48:51], a[132:135], v[84:87]
ds_read_b128 v[72:75], v8 offset:6144
v_max_f32 v145, 0, v145
v_mfma_f32_16x16x32_bf16 v[84:87], v[52:55], a[148:151], v[84:87]
v_max_f32 v149, 0, v149
v_max_f32 v153, 0, v153
v_mfma_f32_16x16x32_bf16 v[88:91], v[48:51], a[136:139], v[88:91]
buffer_load_dwordx4 a[212:215], v4, s[8:11], s48 offen offset:1024 sc1
v_mfma_f32_16x16x32_bf16 v[88:91], v[52:55], a[152:155], v[88:91]
ds_read_b128 v[76:79], v8 offset:7168
v_max_f32 v157, 0, v157
v_mfma_f32_16x16x32_bf16 v[92:95], v[48:51], a[140:143], v[92:95]
v_add_f32 v234, 0x3727c5ac, v145
v_add_f32 v238, 0x3727c5ac, v149
v_mfma_f32_16x16x32_bf16 v[92:95], v[52:55], a[156:159], v[92:95]
v_add_f32 v242, 0x3727c5ac, v153
s_waitcnt lgkmcnt(4)
v_mfma_f32_16x16x32_bf16 v[96:99], v[56:59], a[128:131], v[96:99]
buffer_load_dwordx4 a[216:219], v5, s[8:11], s48 offen offset:1024 sc1
v_mfma_f32_16x16x32_bf16 v[96:99], v[60:63], a[144:147], v[96:99]
v_add_f32 v246, 0x3727c5ac, v157
v_mfma_f32_16x16x32_bf16 v[100:103], v[56:59], a[132:135], v[100:103]
ds_read_b128 v[48:51], v8 offset:8192
v_mfma_f32_16x16x32_bf16 v[100:103], v[60:63], a[148:151], v[100:103]
v_rsq_f32 v144, v234
v_mfma_f32_16x16x32_bf16 v[104:107], v[56:59], a[136:139], v[104:107]
buffer_load_dwordx4 a[220:223], v6, s[8:11], s48 offen offset:1024 sc1
v_mfma_f32_16x16x32_bf16 v[104:107], v[60:63], a[152:155], v[104:107]
ds_read_b128 v[52:55], v8 offset:9216
v_mul_f32 v232, 0xc0135761, v144
v_mfma_f32_16x16x32_bf16 v[108:111], v[56:59], a[140:143], v[108:111]
v_rsq_f32 v148, v238
v_mfma_f32_16x16x32_bf16 v[108:111], v[60:63], a[156:159], v[108:111]
v_mul_f32 v236, 0xc0135761, v148
s_waitcnt lgkmcnt(4)
v_mfma_f32_16x16x32_bf16 v[112:115], v[64:67], a[128:131], v[112:115]
buffer_load_dwordx4 a[224:227], v2, s[8:11], s48 offen offset:2048 sc1
v_mfma_f32_16x16x32_bf16 v[112:115], v[68:71], a[144:147], v[112:115]
v_rsq_f32 v152, v242
v_mfma_f32_16x16x32_bf16 v[116:119], v[64:67], a[132:135], v[116:119]
ds_read_b128 v[56:59], v8 offset:10240
v_mul_f32 v240, 0xc0135761, v152
v_mfma_f32_16x16x32_bf16 v[116:119], v[68:71], a[148:151], v[116:119]
v_rsq_f32 v156, v246
v_mfma_f32_16x16x32_bf16 v[120:123], v[64:67], a[136:139], v[120:123]
buffer_load_dwordx4 a[228:231], v4, s[8:11], s48 offen offset:2048 sc1
v_mfma_f32_16x16x32_bf16 v[120:123], v[68:71], a[152:155], v[120:123]
ds_read_b128 v[60:63], v8 offset:11264
v_mul_f32 v244, 0xc0135761, v156
v_mfma_f32_16x16x32_bf16 v[124:127], v[64:67], a[140:143], v[124:127]
v_mul_f32 v145, v144, v144
v_mul_f32 v149, v148, v148
v_mfma_f32_16x16x32_bf16 v[124:127], v[68:71], a[156:159], v[124:127]
v_mul_f32 v153, v152, v152
s_waitcnt lgkmcnt(4)
v_mfma_f32_16x16x32_bf16 v[128:131], v[72:75], a[128:131], v[128:131]
buffer_load_dwordx4 a[232:235], v5, s[8:11], s48 offen offset:2048 sc1
v_mfma_f32_16x16x32_bf16 v[128:131], v[76:79], a[144:147], v[128:131]
v_mul_f32 v157, v156, v156
v_mul_f32 v145, v145, v144
v_mfma_f32_16x16x32_bf16 v[132:135], v[72:75], a[132:135], v[132:135]
ds_read_b128 v[64:67], v8 offset:12288
v_mul_f32 v149, v149, v148
v_mfma_f32_16x16x32_bf16 v[132:135], v[76:79], a[148:151], v[132:135]
v_mul_f32 v153, v153, v152
v_mul_f32 v157, v157, v156
v_mfma_f32_16x16x32_bf16 v[136:139], v[72:75], a[136:139], v[136:139]
buffer_load_dwordx4 a[236:239], v6, s[8:11], s48 offen offset:2048 sc1
v_mfma_f32_16x16x32_bf16 v[136:139], v[76:79], a[152:155], v[136:139]
ds_read_b128 v[68:71], v8 offset:13312
v_mul_f32 v233, 0xbdd2d3e8, v145
v_mfma_f32_16x16x32_bf16 v[140:143], v[72:75], a[140:143], v[140:143]
v_mul_f32 v237, 0xbdd2d3e8, v149
v_mul_f32 v241, 0xbdd2d3e8, v153
v_mfma_f32_16x16x32_bf16 v[140:143], v[76:79], a[156:159], v[140:143]
v_mul_f32 v245, 0xbdd2d3e8, v157
s_waitcnt vmcnt(12)
s_waitcnt lgkmcnt(4)
v_mfma_f32_16x16x32_bf16 v[80:83], v[48:51], a[160:163], v[80:83]
buffer_load_dwordx4 a[240:243], v2, s[8:11], s48 offen offset:3072 sc1
v_mfma_f32_16x16x32_bf16 v[80:83], v[52:55], a[176:179], v[80:83]
v_mfma_f32_16x16x32_bf16 v[84:87], v[48:51], a[164:167], v[84:87]
ds_read_b128 v[72:75], v8 offset:14336
v_mfma_f32_16x16x32_bf16 v[84:87], v[52:55], a[180:183], v[84:87]
v_mfma_f32_16x16x32_bf16 v[88:91], v[48:51], a[168:171], v[88:91]
buffer_load_dwordx4 a[244:247], v4, s[8:11], s48 offen offset:3072 sc1
v_mfma_f32_16x16x32_bf16 v[88:91], v[52:55], a[184:187], v[88:91]
ds_read_b128 v[76:79], v8 offset:15360
v_mfma_f32_16x16x32_bf16 v[92:95], v[48:51], a[172:175], v[92:95]
v_mfma_f32_16x16x32_bf16 v[92:95], v[52:55], a[188:191], v[92:95]
s_waitcnt lgkmcnt(4)
v_mfma_f32_16x16x32_bf16 v[96:99], v[56:59], a[160:163], v[96:99]
buffer_load_dwordx4 a[248:251], v5, s[8:11], s48 offen offset:3072 sc1
v_mfma_f32_16x16x32_bf16 v[96:99], v[60:63], a[176:179], v[96:99]
s_barrier
v_mfma_f32_16x16x32_bf16 v[100:103], v[56:59], a[164:167], v[100:103]
ds_read_b128 v[48:51], v2 offset:0
v_mfma_f32_16x16x32_bf16 v[100:103], v[60:63], a[180:183], v[100:103]
v_mfma_f32_16x16x32_bf16 v[104:107], v[56:59], a[168:171], v[104:107]
buffer_load_dwordx4 a[252:255], v6, s[8:11], s48 offen offset:3072 sc1
v_mfma_f32_16x16x32_bf16 v[104:107], v[60:63], a[184:187], v[104:107]
ds_read_b128 v[52:55], v2 offset:1024
s_add_u32 s48, s20, 16384
v_mfma_f32_16x16x32_bf16 v[108:111], v[56:59], a[172:175], v[108:111]
v_mfma_f32_16x16x32_bf16 v[108:111], v[60:63], a[188:191], v[108:111]
s_waitcnt lgkmcnt(4)
v_mfma_f32_16x16x32_bf16 v[112:115], v[64:67], a[160:163], v[112:115]
buffer_load_dwordx4 v[16:19], v2, s[8:11], s48 offen offset:0 sc1
v_mfma_f32_16x16x32_bf16 v[112:115], v[68:71], a[176:179], v[112:115]
v_mfma_f32_16x16x32_bf16 v[116:119], v[64:67], a[164:167], v[116:119]
ds_read_b128 v[56:59], v2 offset:2048
v_mfma_f32_16x16x32_bf16 v[116:119], v[68:71], a[180:183], v[116:119]
v_mfma_f32_16x16x32_bf16 v[120:123], v[64:67], a[168:171], v[120:123]
buffer_load_dwordx4 v[20:23], v4, s[8:11], s48 offen offset:0 sc1
v_mfma_f32_16x16x32_bf16 v[120:123], v[68:71], a[184:187], v[120:123]
ds_read_b128 v[60:63], v2 offset:3072
v_mfma_f32_16x16x32_bf16 v[124:127], v[64:67], a[172:175], v[124:127]
v_mfma_f32_16x16x32_bf16 v[124:127], v[68:71], a[188:191], v[124:127]
s_waitcnt lgkmcnt(4)
v_mfma_f32_16x16x32_bf16 v[128:131], v[72:75], a[160:163], v[128:131]
buffer_load_dwordx4 v[24:27], v5, s[8:11], s48 offen offset:0 sc1
v_mfma_f32_16x16x32_bf16 v[128:131], v[76:79], a[176:179], v[128:131]
v_mfma_f32_16x16x32_bf16 v[132:135], v[72:75], a[164:167], v[132:135]
ds_read_b128 v[64:67], v2 offset:4096
v_mfma_f32_16x16x32_bf16 v[132:135], v[76:79], a[180:183], v[132:135]
v_mfma_f32_16x16x32_bf16 v[136:139], v[72:75], a[168:171], v[136:139]
buffer_load_dwordx4 v[28:31], v6, s[8:11], s48 offen offset:0 sc1
v_mfma_f32_16x16x32_bf16 v[136:139], v[76:79], a[184:187], v[136:139]
ds_read_b128 v[68:71], v2 offset:5120
v_mfma_f32_16x16x32_bf16 v[140:143], v[72:75], a[172:175], v[140:143]
v_mfma_f32_16x16x32_bf16 v[140:143], v[76:79], a[188:191], v[140:143]
s_waitcnt vmcnt(12)
s_waitcnt lgkmcnt(4)
v_mfma_f32_16x16x32_bf16 v[80:83], v[48:51], a[192:195], v[80:83]
buffer_load_dwordx4 v[32:35], v2, s[8:11], s48 offen offset:1024 sc1
v_mfma_f32_16x16x32_bf16 v[80:83], v[52:55], a[208:211], v[80:83]
v_mfma_f32_16x16x32_bf16 v[84:87], v[48:51], a[196:199], v[84:87]
ds_read_b128 v[72:75], v2 offset:6144
v_mfma_f32_16x16x32_bf16 v[84:87], v[52:55], a[212:215], v[84:87]
v_mfma_f32_16x16x32_bf16 v[88:91], v[48:51], a[200:203], v[88:91]
buffer_load_dwordx4 v[36:39], v4, s[8:11], s48 offen offset:1024 sc1
v_mfma_f32_16x16x32_bf16 v[88:91], v[52:55], a[216:219], v[88:91]
ds_read_b128 v[76:79], v2 offset:7168
v_mfma_f32_16x16x32_bf16 v[92:95], v[48:51], a[204:207], v[92:95]
v_mfma_f32_16x16x32_bf16 v[92:95], v[52:55], a[220:223], v[92:95]
s_waitcnt lgkmcnt(4)
v_mfma_f32_16x16x32_bf16 v[96:99], v[56:59], a[192:195], v[96:99]
buffer_load_dwordx4 v[40:43], v5, s[8:11], s48 offen offset:1024 sc1
v_mfma_f32_16x16x32_bf16 v[96:99], v[60:63], a[208:211], v[96:99]
v_mfma_f32_16x16x32_bf16 v[100:103], v[56:59], a[196:199], v[100:103]
ds_read_b128 v[48:51], v2 offset:8192
v_mfma_f32_16x16x32_bf16 v[100:103], v[60:63], a[212:215], v[100:103]
v_mfma_f32_16x16x32_bf16 v[104:107], v[56:59], a[200:203], v[104:107]
buffer_load_dwordx4 v[44:47], v6, s[8:11], s48 offen offset:1024 sc1
v_mfma_f32_16x16x32_bf16 v[104:107], v[60:63], a[216:219], v[104:107]
ds_read_b128 v[52:55], v2 offset:9216
s_add_u32 m0, s22, 49152
v_mfma_f32_16x16x32_bf16 v[108:111], v[56:59], a[204:207], v[108:111]
v_add_u32 v3, 20480, v3
v_mfma_f32_16x16x32_bf16 v[108:111], v[60:63], a[220:223], v[108:111]
s_waitcnt lgkmcnt(4)
v_mfma_f32_16x16x32_bf16 v[112:115], v[64:67], a[192:195], v[112:115]
buffer_load_dwordx4 v3, s[8:11], 0 offen offset:0 sc1 lds
v_mfma_f32_16x16x32_bf16 v[112:115], v[68:71], a[208:211], v[112:115]
v_mfma_f32_16x16x32_bf16 v[116:119], v[64:67], a[196:199], v[116:119]
ds_read_b128 v[56:59], v2 offset:10240
v_mfma_f32_16x16x32_bf16 v[116:119], v[68:71], a[212:215], v[116:119]
v_mfma_f32_16x16x32_bf16 v[120:123], v[64:67], a[200:203], v[120:123]
buffer_load_dwordx4 v3, s[8:11], 0 offen offset:1024 sc1 lds
v_mfma_f32_16x16x32_bf16 v[120:123], v[68:71], a[216:219], v[120:123]
ds_read_b128 v[60:63], v2 offset:11264
v_mfma_f32_16x16x32_bf16 v[124:127], v[64:67], a[204:207], v[124:127]
v_mfma_f32_16x16x32_bf16 v[124:127], v[68:71], a[220:223], v[124:127]
s_waitcnt lgkmcnt(4)
v_mfma_f32_16x16x32_bf16 v[128:131], v[72:75], a[192:195], v[128:131]
buffer_load_dwordx4 v3, s[8:11], 0 offen offset:2048 sc1 lds
v_mfma_f32_16x16x32_bf16 v[128:131], v[76:79], a[208:211], v[128:131]
v_mfma_f32_16x16x32_bf16 v[132:135], v[72:75], a[196:199], v[132:135]
ds_read_b128 v[64:67], v2 offset:12288
v_mfma_f32_16x16x32_bf16 v[132:135], v[76:79], a[212:215], v[132:135]
v_mfma_f32_16x16x32_bf16 v[136:139], v[72:75], a[200:203], v[136:139]
buffer_load_dwordx4 v3, s[8:11], 0 offen offset:3072 sc1 lds
v_mfma_f32_16x16x32_bf16 v[136:139], v[76:79], a[216:219], v[136:139]
ds_read_b128 v[68:71], v2 offset:13312
s_add_u32 m0, s22, 53248
v_mfma_f32_16x16x32_bf16 v[140:143], v[72:75], a[204:207], v[140:143]
v_add_u32 v3, 4096, v3
v_mfma_f32_16x16x32_bf16 v[140:143], v[76:79], a[220:223], v[140:143]
s_waitcnt vmcnt(12)
s_waitcnt lgkmcnt(4)
v_mfma_f32_16x16x32_bf16 v[80:83], v[48:51], a[224:227], v[80:83]
buffer_load_dwordx4 v3, s[8:11], 0 offen offset:0 sc1 lds
v_mfma_f32_16x16x32_bf16 v[80:83], v[52:55], a[240:243], v[80:83]
v_mfma_f32_16x16x32_bf16 v[84:87], v[48:51], a[228:231], v[84:87]
ds_read_b128 v[72:75], v2 offset:14336
v_mfma_f32_16x16x32_bf16 v[84:87], v[52:55], a[244:247], v[84:87]
v_mfma_f32_16x16x32_bf16 v[88:91], v[48:51], a[232:235], v[88:91]
buffer_load_dwordx4 v3, s[8:11], 0 offen offset:1024 sc1 lds
v_mfma_f32_16x16x32_bf16 v[88:91], v[52:55], a[248:251], v[88:91]
ds_read_b128 v[76:79], v2 offset:15360
s_add_u32 m0, s22, 73728
v_mfma_f32_16x16x32_bf16 v[92:95], v[48:51], a[236:239], v[92:95]
v_add_u32 v3, 20480, v3
v_mfma_f32_16x16x32_bf16 v[92:95], v[52:55], a[252:255], v[92:95]
s_waitcnt lgkmcnt(4)
v_mfma_f32_16x16x32_bf16 v[96:99], v[56:59], a[224:227], v[96:99]
buffer_load_dwordx4 v3, s[8:11], 0 offen offset:0 sc1 lds
v_mfma_f32_16x16x32_bf16 v[96:99], v[60:63], a[240:243], v[96:99]
v_mfma_f32_16x16x32_bf16 v[100:103], v[56:59], a[228:231], v[100:103]
ds_read_b128 v[48:51], v2 offset:16384
v_mfma_f32_16x16x32_bf16 v[100:103], v[60:63], a[244:247], v[100:103]
v_mfma_f32_16x16x32_bf16 v[104:107], v[56:59], a[232:235], v[104:107]
buffer_load_dwordx4 v3, s[8:11], 0 offen offset:1024 sc1 lds
v_mfma_f32_16x16x32_bf16 v[104:107], v[60:63], a[248:251], v[104:107]
ds_read_b128 v[52:55], v2 offset:17408
v_mfma_f32_16x16x32_bf16 v[108:111], v[56:59], a[236:239], v[108:111]
v_mfma_f32_16x16x32_bf16 v[108:111], v[60:63], a[252:255], v[108:111]
s_waitcnt lgkmcnt(4)
v_mfma_f32_16x16x32_bf16 v[112:115], v[64:67], a[224:227], v[112:115]
buffer_load_dwordx4 v3, s[8:11], 0 offen offset:2048 sc1 lds
v_mfma_f32_16x16x32_bf16 v[112:115], v[68:71], a[240:243], v[112:115]
v_mfma_f32_16x16x32_bf16 v[116:119], v[64:67], a[228:231], v[116:119]
ds_read_b128 v[56:59], v2 offset:18432
v_mfma_f32_16x16x32_bf16 v[116:119], v[68:71], a[244:247], v[116:119]
v_mfma_f32_16x16x32_bf16 v[120:123], v[64:67], a[232:235], v[120:123]
buffer_load_dwordx4 v3, s[8:11], 0 offen offset:3072 sc1 lds
v_mfma_f32_16x16x32_bf16 v[120:123], v[68:71], a[248:251], v[120:123]
ds_read_b128 v[60:63], v2 offset:19456
s_add_u32 m0, s22, 77824
v_mfma_f32_16x16x32_bf16 v[124:127], v[64:67], a[236:239], v[124:127]
v_add_u32 v3, 4096, v3
v_mfma_f32_16x16x32_bf16 v[124:127], v[68:71], a[252:255], v[124:127]
s_waitcnt lgkmcnt(4)
v_mfma_f32_16x16x32_bf16 v[128:131], v[72:75], a[224:227], v[128:131]
buffer_load_dwordx4 v3, s[8:11], 0 offen offset:0 sc1 lds
v_mfma_f32_16x16x32_bf16 v[128:131], v[76:79], a[240:243], v[128:131]
v_mfma_f32_16x16x32_bf16 v[132:135], v[72:75], a[228:231], v[132:135]
ds_read_b128 v[64:67], v2 offset:20480
v_mfma_f32_16x16x32_bf16 v[132:135], v[76:79], a[244:247], v[132:135]
v_mfma_f32_16x16x32_bf16 v[136:139], v[72:75], a[232:235], v[136:139]
buffer_load_dwordx4 v3, s[8:11], 0 offen offset:1024 sc1 lds
v_mfma_f32_16x16x32_bf16 v[136:139], v[76:79], a[248:251], v[136:139]
ds_read_b128 v[68:71], v2 offset:21504
s_add_u32 m0, s22, 98304
v_mfma_f32_16x16x32_bf16 v[140:143], v[72:75], a[236:239], v[140:143]
v_add_u32 v3, 20480, v3
v_mfma_f32_16x16x32_bf16 v[140:143], v[76:79], a[252:255], v[140:143]
s_waitcnt vmcnt(12)
s_waitcnt lgkmcnt(4)
v_mfma_f32_16x16x32_bf16 v[80:83], v[48:51], v[16:19], v[80:83]
buffer_load_dwordx4 v3, s[8:11], 0 offen offset:0 sc1 lds
v_mfma_f32_16x16x32_bf16 v[80:83], v[52:55], v[32:35], v[80:83]
v_mfma_f32_16x16x32_bf16 v[84:87], v[48:51], v[20:23], v[84:87]
ds_read_b128 v[72:75], v2 offset:22528
v_mfma_f32_16x16x32_bf16 v[84:87], v[52:55], v[36:39], v[84:87]
v_mfma_f32_16x16x32_bf16 v[88:91], v[48:51], v[24:27], v[88:91]
buffer_load_dwordx4 v3, s[8:11], 0 offen offset:1024 sc1 lds
v_mfma_f32_16x16x32_bf16 v[88:91], v[52:55], v[40:43], v[88:91]
ds_read_b128 v[76:79], v2 offset:23552
v_mfma_f32_16x16x32_bf16 v[92:95], v[48:51], v[28:31], v[92:95]
v_mfma_f32_16x16x32_bf16 v[92:95], v[52:55], v[44:47], v[92:95]
s_waitcnt lgkmcnt(4)
v_mfma_f32_16x16x32_bf16 v[96:99], v[56:59], v[16:19], v[96:99]
buffer_load_dwordx4 v3, s[8:11], 0 offen offset:2048 sc1 lds
v_mfma_f32_16x16x32_bf16 v[96:99], v[60:63], v[32:35], v[96:99]
s_barrier
v_mfma_f32_16x16x32_bf16 v[100:103], v[56:59], v[20:23], v[100:103]
ds_read_b128 v[48:51], v2 offset:24576
v_mfma_f32_16x16x32_bf16 v[100:103], v[60:63], v[36:39], v[100:103]
v_mfma_f32_16x16x32_bf16 v[104:107], v[56:59], v[24:27], v[104:107]
buffer_load_dwordx4 v3, s[8:11], 0 offen offset:3072 sc1 lds
v_mfma_f32_16x16x32_bf16 v[104:107], v[60:63], v[40:43], v[104:107]
ds_read_b128 v[52:55], v2 offset:25600
s_add_u32 m0, s22, 102400
v_mfma_f32_16x16x32_bf16 v[108:111], v[56:59], v[28:31], v[108:111]
v_add_u32 v3, 4096, v3
v_mfma_f32_16x16x32_bf16 v[108:111], v[60:63], v[44:47], v[108:111]
s_waitcnt lgkmcnt(4)
v_mfma_f32_16x16x32_bf16 v[112:115], v[64:67], v[16:19], v[112:115]
buffer_load_dwordx4 v3, s[8:11], 0 offen offset:0 sc1 lds
v_mfma_f32_16x16x32_bf16 v[112:115], v[68:71], v[32:35], v[112:115]
v_mfma_f32_16x16x32_bf16 v[116:119], v[64:67], v[20:23], v[116:119]
ds_read_b128 v[56:59], v2 offset:26624
v_mfma_f32_16x16x32_bf16 v[116:119], v[68:71], v[36:39], v[116:119]
v_mfma_f32_16x16x32_bf16 v[120:123], v[64:67], v[24:27], v[120:123]
buffer_load_dwordx4 v3, s[8:11], 0 offen offset:1024 sc1 lds
v_mfma_f32_16x16x32_bf16 v[120:123], v[68:71], v[40:43], v[120:123]
ds_read_b128 v[60:63], v2 offset:27648
s_add_u32 m0, s22, 122880
v_mfma_f32_16x16x32_bf16 v[124:127], v[64:67], v[28:31], v[124:127]
v_add_u32 v3, 20480, v3
v_mfma_f32_16x16x32_bf16 v[124:127], v[68:71], v[44:47], v[124:127]
s_waitcnt lgkmcnt(4)
v_mfma_f32_16x16x32_bf16 v[128:131], v[72:75], v[16:19], v[128:131]
v_mfma_f32_16x16x32_bf16 v[128:131], v[76:79], v[32:35], v[128:131]
buffer_load_dwordx4 v3, s[8:11], 0 offen offset:0 sc1 lds
v_mfma_f32_16x16x32_bf16 v[132:135], v[72:75], v[20:23], v[132:135]
ds_read_b128 v[64:67], v2 offset:28672
v_mfma_f32_16x16x32_bf16 v[132:135], v[76:79], v[36:39], v[132:135]
v_mfma_f32_16x16x32_bf16 v[136:139], v[72:75], v[24:27], v[136:139]
v_mfma_f32_16x16x32_bf16 v[136:139], v[76:79], v[40:43], v[136:139]
ds_read_b128 v[68:71], v2 offset:29696
v_mfma_f32_16x16x32_bf16 v[140:143], v[72:75], v[28:31], v[140:143]
buffer_load_dwordx4 v3, s[8:11], 0 offen offset:1024 sc1 lds
v_mfma_f32_16x16x32_bf16 v[140:143], v[76:79], v[44:47], v[140:143]
s_waitcnt lgkmcnt(4)
v_mfma_f32_16x16x32_bf16 v[176:179], v[48:51], a[0:3], 0
v_mfma_f32_16x16x32_bf16 v[176:179], v[52:55], a[16:19], v[176:179]
v_mfma_f32_16x16x32_bf16 v[180:183], v[48:51], a[4:7], 0
ds_read_b128 v[72:75], v2 offset:30720
v_mfma_f32_16x16x32_bf16 v[180:183], v[52:55], a[20:23], v[180:183]
buffer_load_dwordx4 v3, s[8:11], 0 offen offset:2048 sc1 lds
v_mfma_f32_16x16x32_bf16 v[184:187], v[48:51], a[8:11], 0
v_mul_f32 v208, v80, v80
v_mul_f32 v210, v81, v81
v_mfma_f32_16x16x32_bf16 v[184:187], v[52:55], a[24:27], v[184:187]
ds_read_b128 v[76:79], v2 offset:31744
v_fma_f32 v208, v208, v233, v232
v_mfma_f32_16x16x32_bf16 v[188:191], v[48:51], a[12:15], 0
v_fma_f32 v210, v210, v233, v232
v_mul_f32 v208, v208, v80
v_mfma_f32_16x16x32_bf16 v[188:191], v[52:55], a[28:31], v[188:191]
v_mul_f32 v210, v210, v81
s_waitcnt lgkmcnt(4)
v_mfma_f32_16x16x32_bf16 v[192:195], v[56:59], a[0:3], 0
buffer_load_dwordx4 v3, s[8:11], 0 offen offset:3072 sc1 lds
v_mfma_f32_16x16x32_bf16 v[192:195], v[60:63], a[16:19], v[192:195]
s_add_u32 m0, s22, 126976
v_add_u32 v3, 4096, v3
v_mfma_f32_16x16x32_bf16 v[196:199], v[56:59], a[4:7], 0
ds_read_b128 v[48:51], v2 offset:32768
v_mul_f32 v209, v80, v96
v_mfma_f32_16x16x32_bf16 v[196:199], v[60:63], a[20:23], v[196:199]
v_exp_f32 v208, v208
v_mfma_f32_16x16x32_bf16 v[200:203], v[56:59], a[8:11], 0
v_exp_f32 v210, v210
v_mfma_f32_16x16x32_bf16 v[200:203], v[60:63], a[24:27], v[200:203]
ds_read_b128 v[52:55], v2 offset:33792
v_mul_f32 v211, v81, v97
v_mfma_f32_16x16x32_bf16 v[204:207], v[56:59], a[12:15], 0
buffer_load_dwordx4 v3, s[8:11], 0 offen offset:0 sc1 lds
v_mfma_f32_16x16x32_bf16 v[204:207], v[60:63], a[28:31], v[204:207]
v_fma_f32 v208, v208, v234, v234
s_waitcnt lgkmcnt(4)
v_mfma_f32_16x16x32_bf16 v[176:179], v[64:67], a[32:35], v[176:179]
v_fma_f32 v210, v210, v234, v234
v_mul_f32 v212, v82, v82
v_mfma_f32_16x16x32_bf16 v[176:179], v[68:71], a[48:51], v[176:179]
v_rcp_f32 v208, v208
v_mfma_f32_16x16x32_bf16 v[180:183], v[64:67], a[36:39], v[180:183]
ds_read_b128 v[56:59], v2 offset:34816
v_mul_f32 v209, v209, v208
v_mfma_f32_16x16x32_bf16 v[180:183], v[68:71], a[52:55], v[180:183]
buffer_load_dwordx4 v3, s[8:11], 0 offen offset:1024 sc1 lds
v_mfma_f32_16x16x32_bf16 v[184:187], v[64:67], a[40:43], v[184:187]
v_rcp_f32 v210, v210
v_mfma_f32_16x16x32_bf16 v[184:187], v[68:71], a[56:59], v[184:187]
ds_read_b128 v[60:63], v2 offset:35840
v_mul_f32 v211, v211, v210
v_mfma_f32_16x16x32_bf16 v[188:191], v[64:67], a[44:47], v[188:191]
v_cvt_pk_bf16_f32 v144, v209, v211
v_mul_f32 v214, v83, v83
v_mfma_f32_16x16x32_bf16 v[188:191], v[68:71], a[60:63], v[188:191]
v_fma_f32 v212, v212, v233, v232
s_waitcnt lgkmcnt(4)
v_mfma_f32_16x16x32_bf16 v[192:195], v[72:75], a[32:35], v[192:195]
v_fma_f32 v214, v214, v233, v232
v_mul_f32 v212, v212, v82
v_mfma_f32_16x16x32_bf16 v[192:195], v[76:79], a[48:51], v[192:195]
v_mul_f32 v214, v214, v83
v_mul_f32 v213, v82, v98
v_mfma_f32_16x16x32_bf16 v[196:199], v[72:75], a[36:39], v[196:199]
ds_read_b128 v[64:67], v2 offset:36864
v_mul_f32 v215, v83, v99
v_mfma_f32_16x16x32_bf16 v[196:199], v[76:79], a[52:55], v[196:199]
v_exp_f32 v212, v212
v_mfma_f32_16x16x32_bf16 v[200:203], v[72:75], a[40:43], v[200:203]
v_exp_f32 v214, v214
v_mfma_f32_16x16x32_bf16 v[200:203], v[76:79], a[56:59], v[200:203]
ds_read_b128 v[68:71], v2 offset:37888
v_fma_f32 v212, v212, v234, v234
v_mfma_f32_16x16x32_bf16 v[204:207], v[72:75], a[44:47], v[204:207]
v_fma_f32 v214, v214, v234, v234
v_mul_f32 v208, v84, v84
v_mfma_f32_16x16x32_bf16 v[204:207], v[76:79], a[60:63], v[204:207]
v_mul_f32 v210, v85, v85
s_waitcnt lgkmcnt(4)
v_mfma_f32_16x16x32_bf16 v[176:179], v[48:51], a[64:67], v[176:179]
v_rcp_f32 v212, v212
v_mfma_f32_16x16x32_bf16 v[176:179], v[52:55], a[80:83], v[176:179]
v_rcp_f32 v214, v214
v_mfma_f32_16x16x32_bf16 v[180:183], v[48:51], a[68:71], v[180:183]
ds_read_b128 v[72:75], v2 offset:38912
v_mul_f32 v213, v213, v212
v_mfma_f32_16x16x32_bf16 v[180:183], v[52:55], a[84:87], v[180:183]
v_mul_f32 v215, v215, v214
v_cvt_pk_bf16_f32 v145, v213, v215
v_mfma_f32_16x16x32_bf16 v[184:187], v[48:51], a[72:75], v[184:187]
v_fma_f32 v208, v208, v237, v236
v_fma_f32 v210, v210, v237, v236
v_mfma_f32_16x16x32_bf16 v[184:187], v[52:55], a[88:91], v[184:187]
ds_read_b128 v[76:79], v2 offset:39936
v_mul_f32 v208, v208, v84
v_mfma_f32_16x16x32_bf16 v[188:191], v[48:51], a[76:79], v[188:191]
v_mul_f32 v210, v210, v85
v_mul_f32 v209, v84, v100
v_mfma_f32_16x16x32_bf16 v[188:191], v[52:55], a[92:95], v[188:191]
v_mul_f32 v211, v85, v101
s_waitcnt lgkmcnt(4)
v_mfma_f32_16x16x32_bf16 v[192:195], v[56:59], a[64:67], v[192:195]
v_exp_f32 v208, v208
v_mfma_f32_16x16x32_bf16 v[192:195], v[60:63], a[80:83], v[192:195]
v_exp_f32 v210, v210
v_mfma_f32_16x16x32_bf16 v[196:199], v[56:59], a[68:71], v[196:199]
ds_read_b128 v[48:51], v2 offset:40960
v_fma_f32 v208, v208, v238, v238
v_mfma_f32_16x16x32_bf16 v[196:199], v[60:63], a[84:87], v[196:199]
v_fma_f32 v210, v210, v238, v238
v_mul_f32 v212, v86, v86
v_mfma_f32_16x16x32_bf16 v[200:203], v[56:59], a[72:75], v[200:203]
v_rcp_f32 v208, v208
v_mfma_f32_16x16x32_bf16 v[200:203], v[60:63], a[88:91], v[200:203]
ds_read_b128 v[52:55], v2 offset:41984
v_mul_f32 v209, v209, v208
v_mfma_f32_16x16x32_bf16 v[204:207], v[56:59], a[76:79], v[204:207]
v_rcp_f32 v210, v210
v_mfma_f32_16x16x32_bf16 v[204:207], v[60:63], a[92:95], v[204:207]
v_mul_f32 v211, v211, v210
s_waitcnt lgkmcnt(4)
v_mfma_f32_16x16x32_bf16 v[176:179], v[64:67], a[96:99], v[176:179]
v_cvt_pk_bf16_f32 v148, v209, v211
v_mul_f32 v214, v87, v87
v_mfma_f32_16x16x32_bf16 v[176:179], v[68:71], a[112:115], v[176:179]
v_fma_f32 v212, v212, v237, v236
v_fma_f32 v214, v214, v237, v236
v_mfma_f32_16x16x32_bf16 v[180:183], v[64:67], a[100:103], v[180:183]
ds_read_b128 v[56:59], v2 offset:43008
v_mul_f32 v212, v212, v86
v_mfma_f32_16x16x32_bf16 v[180:183], v[68:71], a[116:119], v[180:183]
v_mul_f32 v214, v214, v87
v_mul_f32 v213, v86, v102
v_mfma_f32_16x16x32_bf16 v[184:187], v[64:67], a[104:107], v[184:187]
v_exp_f32 v212, v212
v_mfma_f32_16x16x32_bf16 v[184:187], v[68:71], a[120:123], v[184:187]
ds_read_b128 v[60:63], v2 offset:44032
v_mul_f32 v215, v87, v103
v_mfma_f32_16x16x32_bf16 v[188:191], v[64:67], a[108:111], v[188:191]
v_exp_f32 v214, v214
v_mfma_f32_16x16x32_bf16 v[188:191], v[68:71], a[124:127], v[188:191]
v_fma_f32 v212, v212, v238, v238
s_waitcnt lgkmcnt(4)
v_mfma_f32_16x16x32_bf16 v[192:195], v[72:75], a[96:99], v[192:195]
v_fma_f32 v214, v214, v238, v238
v_mul_f32 v208, v88, v88
v_mfma_f32_16x16x32_bf16 v[192:195], v[76:79], a[112:115], v[192:195]
v_rcp_f32 v212, v212
v_mfma_f32_16x16x32_bf16 v[196:199], v[72:75], a[100:103], v[196:199]
ds_read_b128 v[64:67], v2 offset:45056
v_mul_f32 v213, v213, v212
v_mfma_f32_16x16x32_bf16 v[196:199], v[76:79], a[116:119], v[196:199]
v_rcp_f32 v214, v214
v_mfma_f32_16x16x32_bf16 v[200:203], v[72:75], a[104:107], v[200:203]
v_mul_f32 v215, v215, v214
v_cvt_pk_bf16_f32 v149, v213, v215
v_mfma_f32_16x16x32_bf16 v[200:203], v[76:79], a[120:123], v[200:203]
ds_read_b128 v[68:71], v2 offset:46080
v_mul_f32 v210, v89, v89
v_mfma_f32_16x16x32_bf16 v[204:207], v[72:75], a[108:111], v[204:207]
v_fma_f32 v208, v208, v241, v240
v_fma_f32 v210, v210, v241, v240
v_mfma_f32_16x16x32_bf16 v[204:207], v[76:79], a[124:127], v[204:207]
v_mul_f32 v208, v208, v88
s_waitcnt lgkmcnt(4)
v_mfma_f32_16x16x32_bf16 v[176:179], v[48:51], a[128:131], v[176:179]
v_mul_f32 v210, v210, v89
v_mul_f32 v209, v88, v104
v_mfma_f32_16x16x32_bf16 v[176:179], v[52:55], a[144:147], v[176:179]
v_exp_f32 v208, v208
v_mfma_f32_16x16x32_bf16 v[180:183], v[48:51], a[132:135], v[180:183]
ds_read_b128 v[72:75], v2 offset:47104
v_mul_f32 v211, v89, v105
v_mfma_f32_16x16x32_bf16 v[180:183], v[52:55], a[148:151], v[180:183]
v_exp_f32 v210, v210
v_mfma_f32_16x16x32_bf16 v[184:187], v[48:51], a[136:139], v[184:187]
v_fma_f32 v208, v208, v242, v242
v_fma_f32 v210, v210, v242, v242
v_mfma_f32_16x16x32_bf16 v[184:187], v[52:55], a[152:155], v[184:187]
ds_read_b128 v[76:79], v2 offset:48128
v_mul_f32 v212, v90, v90
v_mfma_f32_16x16x32_bf16 v[188:191], v[48:51], a[140:143], v[188:191]
v_rcp_f32 v208, v208
v_mfma_f32_16x16x32_bf16 v[188:191], v[52:55], a[156:159], v[188:191]
v_mul_f32 v209, v209, v208
s_waitcnt lgkmcnt(4)
v_mfma_f32_16x16x32_bf16 v[192:195], v[56:59], a[128:131], v[192:195]
s_waitcnt vmcnt(18)
v_mul_f32 v214, v91, v91
v_mfma_f32_16x16x32_bf16 v[192:195], v[60:63], a[144:147], v[192:195]
s_barrier
v_mfma_f32_16x16x32_bf16 v[196:199], v[56:59], a[132:135], v[196:199]
ds_read_b128 v[48:51], v2 offset:49152
s_add_u32 m0, s22, 0
v_mfma_f32_16x16x32_bf16 v[196:199], v[60:63], a[148:151], v[196:199]
v_add_u32 v3, 20480, v3
buffer_load_dwordx4 v3, s[8:11], 0 offen offset:0 sc1 lds
v_mfma_f32_16x16x32_bf16 v[200:203], v[56:59], a[136:139], v[200:203]
v_rcp_f32 v210, v210
v_mfma_f32_16x16x32_bf16 v[200:203], v[60:63], a[152:155], v[200:203]
ds_read_b128 v[52:55], v2 offset:50176
v_mul_f32 v211, v211, v210
v_mfma_f32_16x16x32_bf16 v[204:207], v[56:59], a[140:143], v[204:207]
v_cvt_pk_bf16_f32 v152, v209, v211
v_fma_f32 v212, v212, v241, v240
v_mfma_f32_16x16x32_bf16 v[204:207], v[60:63], a[156:159], v[204:207]
v_fma_f32 v214, v214, v241, v240
s_waitcnt lgkmcnt(4)
v_mfma_f32_16x16x32_bf16 v[176:179], v[64:67], a[160:163], v[176:179]
buffer_load_dwordx4 v3, s[8:11], 0 offen offset:1024 sc1 lds
v_mfma_f32_16x16x32_bf16 v[176:179], v[68:71], a[176:179], v[176:179]
v_mul_f32 v212, v212, v90
v_mul_f32 v214, v214, v91
v_mfma_f32_16x16x32_bf16 v[180:183], v[64:67], a[164:167], v[180:183]
ds_read_b128 v[56:59], v2 offset:51200
v_mul_f32 v213, v90, v106
v_mfma_f32_16x16x32_bf16 v[180:183], v[68:71], a[180:183], v[180:183]
v_exp_f32 v212, v212
v_mfma_f32_16x16x32_bf16 v[184:187], v[64:67], a[168:171], v[184:187]
v_exp_f32 v214, v214
v_mfma_f32_16x16x32_bf16 v[184:187], v[68:71], a[184:187], v[184:187]
ds_read_b128 v[60:63], v2 offset:52224
v_mul_f32 v215, v91, v107
v_mfma_f32_16x16x32_bf16 v[188:191], v[64:67], a[172:175], v[188:191]
buffer_load_dwordx4 v3, s[8:11], 0 offen offset:2048 sc1 lds
v_mfma_f32_16x16x32_bf16 v[188:191], v[68:71], a[188:191], v[188:191]
v_fma_f32 v212, v212, v242, v242
s_waitcnt lgkmcnt(4)
v_mfma_f32_16x16x32_bf16 v[192:195], v[72:75], a[160:163], v[192:195]
v_fma_f32 v214, v214, v242, v242
v_mul_f32 v208, v92, v92
v_mfma_f32_16x16x32_bf16 v[192:195], v[76:79], a[176:179], v[192:195]
v_rcp_f32 v212, v212
v_mfma_f32_16x16x32_bf16 v[196:199], v[72:75], a[164:167], v[196:199]
ds_read_b128 v[64:67], v2 offset:53248
v_mul_f32 v213, v213, v212
v_mfma_f32_16x16x32_bf16 v[196:199], v[76:79], a[180:183], v[196:199]
buffer_load_dwordx4 v3, s[8:11], 0 offen offset:3072 sc1 lds
v_mfma_f32_16x16x32_bf16 v[200:203], v[72:75], a[168:171], v[200:203]
s_add_u32 m0, s22, 4096
v_add_u32 v3, 4096, v3
v_mfma_f32_16x16x32_bf16 v[200:203], v[76:79], a[184:187], v[200:203]
ds_read_b128 v[68:71], v2 offset:54272
v_mul_f32 v210, v93, v93
v_mfma_f32_16x16x32_bf16 v[204:207], v[72:75], a[172:175], v[204:207]
v_rcp_f32 v214, v214
v_mfma_f32_16x16x32_bf16 v[204:207], v[76:79], a[188:191], v[204:207]
v_mul_f32 v215, v215, v214
s_waitcnt lgkmcnt(4)
v_mfma_f32_16x16x32_bf16 v[176:179], v[48:51], a[192:195], v[176:179]
buffer_load_dwordx4 v3, s[8:11], 0 offen offset:0 sc1 lds
v_mfma_f32_16x16x32_bf16 v[176:179], v[52:55], a[208:211], v[176:179]
v_cvt_pk_bf16_f32 v153, v213, v215
v_fma_f32 v208, v208, v245, v244
v_mfma_f32_16x16x32_bf16 v[180:183], v[48:51], a[196:199], v[180:183]
ds_read_b128 v[72:75], v2 offset:55296
v_fma_f32 v210, v210, v245, v244
v_mfma_f32_16x16x32_bf16 v[180:183], v[52:55], a[212:215], v[180:183]
v_mul_f32 v208, v208, v92
v_mul_f32 v210, v210, v93
v_mfma_f32_16x16x32_bf16 v[184:187], v[48:51], a[200:203], v[184:187]
v_exp_f32 v208, v208
v_mfma_f32_16x16x32_bf16 v[184:187], v[52:55], a[216:219], v[184:187]
ds_read_b128 v[76:79], v2 offset:56320
L_hop4:
s_cmp_lg_u32 s15, 0
s_cbranch_scc1 L_hop8
v_mul_f32 v209, v92, v108
v_mfma_f32_16x16x32_bf16 v[188:191], v[48:51], a[204:207], v[188:191]
buffer_load_dwordx4 v3, s[8:11], 0 offen offset:1024 sc1 lds
v_mfma_f32_16x16x32_bf16 v[188:191], v[52:55], a[220:223], v[188:191]
v_mul_f32 v211, v93, v109
s_waitcnt lgkmcnt(4)
v_mfma_f32_16x16x32_bf16 v[192:195], v[56:59], a[192:195], v[192:195]
v_exp_f32 v210, v210
v_mfma_f32_16x16x32_bf16 v[192:195], v[60:63], a[208:211], v[192:195]
v_fma_f32 v208, v208, v246, v246
v_fma_f32 v210, v210, v246, v246
v_mfma_f32_16x16x32_bf16 v[196:199], v[56:59], a[196:199], v[196:199]
ds_read_b128 v[48:51], v2 offset:57344
v_mul_f32 v212, v94, v94
v_mfma_f32_16x16x32_bf16 v[196:199], v[60:63], a[212:215], v[196:199]
v_rcp_f32 v208, v208
v_mfma_f32_16x16x32_bf16 v[200:203], v[56:59], a[200:203], v[200:203]
v_rcp_f32 v210, v210
v_mfma_f32_16x16x32_bf16 v[200:203], v[60:63], a[216:219], v[200:203]
ds_read_b128 v[52:55], v2 offset:58368
v_mul_f32 v209, v209, v208
v_mfma_f32_16x16x32_bf16 v[204:207], v[56:59], a[204:207], v[204:207]
v_mul_f32 v211, v211, v210
v_cvt_pk_bf16_f32 v156, v209, v211
v_mfma_f32_16x16x32_bf16 v[204:207], v[60:63], a[220:223], v[204:207]
v_mul_f32 v214, v95, v95
s_waitcnt lgkmcnt(4)
v_mfma_f32_16x16x32_bf16 v[176:179], v[64:67], a[224:227], v[176:179]
v_fma_f32 v212, v212, v245, v244
v_fma_f32 v214, v214, v245, v244
v_mfma_f32_16x16x32_bf16 v[176:179], v[68:71], a[240:243], v[176:179]
v_mul_f32 v212, v212, v94
v_mul_f32 v214, v214, v95
v_mfma_f32_16x16x32_bf16 v[180:183], v[64:67], a[228:231], v[180:183]
ds_read_b128 v[56:59], v2 offset:59392
v_mul_f32 v213, v94, v110
v_mfma_f32_16x16x32_bf16 v[180:183], v[68:71], a[244:247], v[180:183]
v_exp_f32 v212, v212
v_mfma_f32_16x16x32_bf16 v[184:187], v[64:67], a[232:235], v[184:187]
v_exp_f32 v214, v214
v_mfma_f32_16x16x32_bf16 v[184:187], v[68:71], a[248:251], v[184:187]
ds_read_b128 v[60:63], v2 offset:60416
v_mul_f32 v215, v95, v111
v_mfma_f32_16x16x32_bf16 v[188:191], v[64:67], a[236:239], v[188:191]
v_fma_f32 v212, v212, v246, v246
v_fma_f32 v214, v214, v246, v246
v_mfma_f32_16x16x32_bf16 v[188:191], v[68:71], a[252:255], v[188:191]
v_mul_f32 v208, v112, v112
s_waitcnt lgkmcnt(4)
v_mfma_f32_16x16x32_bf16 v[192:195], v[72:75], a[224:227], v[192:195]
v_rcp_f32 v212, v212
v_mfma_f32_16x16x32_bf16 v[192:195], v[76:79], a[240:243], v[192:195]
v_rcp_f32 v214, v214
v_mfma_f32_16x16x32_bf16 v[196:199], v[72:75], a[228:231], v[196:199]
ds_read_b128 v[64:67], v2 offset:61440
v_mul_f32 v213, v213, v212
v_mfma_f32_16x16x32_bf16 v[196:199], v[76:79], a[244:247], v[196:199]
v_mul_f32 v215, v215, v214
v_cvt_pk_bf16_f32 v157, v213, v215
v_mfma_f32_16x16x32_bf16 v[200:203], v[72:75], a[232:235], v[200:203]
v_mul_f32 v210, v113, v113
v_fma_f32 v208, v208, v233, v232
v_mfma_f32_16x16x32_bf16 v[200:203], v[76:79], a[248:251], v[200:203]
ds_read_b128 v[68:71], v2 offset:62464
v_fma_f32 v210, v210, v233, v232
v_mfma_f32_16x16x32_bf16 v[204:207], v[72:75], a[236:239], v[204:207]
v_mul_f32 v208, v208, v112
v_mul_f32 v210, v210, v113
v_mfma_f32_16x16x32_bf16 v[204:207], v[76:79], a[252:255], v[204:207]
v_mul_f32 v209, v112, v128
s_waitcnt lgkmcnt(4)
v_mfma_f32_16x16x32_bf16 v[176:179], v[48:51], v[16:19], v[176:179]
v_exp_f32 v208, v208
v_mfma_f32_16x16x32_bf16 v[176:179], v[52:55], v[32:35], v[176:179]
v_exp_f32 v210, v210
v_mfma_f32_16x16x32_bf16 v[180:183], v[48:51], v[20:23], v[180:183]
ds_read_b128 v[72:75], v2 offset:63488
v_mul_f32 v211, v113, v129
v_mfma_f32_16x16x32_bf16 v[180:183], v[52:55], v[36:39], v[180:183]
v_fma_f32 v208, v208, v234, v234
v_fma_f32 v210, v210, v234, v234
v_mfma_f32_16x16x32_bf16 v[184:187], v[48:51], v[24:27], v[184:187]
v_rcp_f32 v208, v208
v_mfma_f32_16x16x32_bf16 v[184:187], v[52:55], v[40:43], v[184:187]
ds_read_b128 v[76:79], v2 offset:64512
v_mul_f32 v209, v209, v208
v_mfma_f32_16x16x32_bf16 v[188:191], v[48:51], v[28:31], v[188:191]
v_rcp_f32 v210, v210
v_mfma_f32_16x16x32_bf16 v[188:191], v[52:55], v[44:47], v[188:191]
v_mul_f32 v211, v211, v210
s_waitcnt lgkmcnt(4)
v_mfma_f32_16x16x32_bf16 v[192:195], v[56:59], v[16:19], v[192:195]
v_cvt_pk_bf16_f32 v146, v209, v211
v_mul_f32 v212, v114, v114
v_mfma_f32_16x16x32_bf16 v[192:195], v[60:63], v[32:35], v[192:195]
v_mul_f32 v214, v115, v115
v_fma_f32 v212, v212, v233, v232
v_mfma_f32_16x16x32_bf16 v[196:199], v[56:59], v[20:23], v[196:199]
ds_read_b128 v[48:51], v7 offset:0
v_fma_f32 v214, v214, v233, v232
v_mfma_f32_16x16x32_bf16 v[196:199], v[60:63], v[36:39], v[196:199]
v_mul_f32 v212, v212, v114
v_mul_f32 v214, v214, v115
v_mfma_f32_16x16x32_bf16 v[200:203], v[56:59], v[24:27], v[200:203]
v_exp_f32 v212, v212
v_mfma_f32_16x16x32_bf16 v[200:203], v[60:63], v[40:43], v[200:203]
ds_read_b128 v[52:55], v7 offset:1024
v_mul_f32 v213, v114, v130
v_mfma_f32_16x16x32_bf16 v[204:207], v[56:59], v[28:31], v[204:207]
v_exp_f32 v214, v214
v_mfma_f32_16x16x32_bf16 v[204:207], v[60:63], v[44:47], v[204:207]
v_mul_f32 v215, v115, v131
s_waitcnt lgkmcnt(4)
v_mfma_f32_16x16x32_bf16 v[80:83], v[64:67], a[0:3], 0
v_fma_f32 v212, v212, v234, v234
v_fma_f32 v214, v214, v234, v234
v_mfma_f32_16x16x32_bf16 v[80:83], v[68:71], a[16:19], v[80:83]
v_rcp_f32 v212, v212
v_mfma_f32_16x16x32_bf16 v[84:87], v[64:67], a[4:7], 0
ds_read_b128 v[56:59], v7 offset:2048
v_mul_f32 v213, v213, v212
v_mfma_f32_16x16x32_bf16 v[84:87], v[68:71], a[20:23], v[84:87]
v_rcp_f32 v214, v214
v_mfma_f32_16x16x32_bf16 v[88:91], v[64:67], a[8:11], 0
v_mul_f32 v215, v215, v214
v_cvt_pk_bf16_f32 v147, v213, v215
v_mfma_f32_16x16x32_bf16 v[88:91], v[68:71], a[24:27], v[88:91]
ds_read_b128 v[60:63], v7 offset:3072
v_mul_f32 v208, v116, v116
v_mfma_f32_16x16x32_bf16 v[92:95], v[64:67], a[12:15], 0
buffer_store_dwordx4 v[144:147], v2, s[8:11], s24 offen offset:0 sc1
v_mfma_f32_16x16x32_bf16 v[92:95], v[68:71], a[28:31], v[92:95]
v_mul_f32 v210, v117, v117
s_waitcnt lgkmcnt(4)
v_mfma_f32_16x16x32_bf16 v[96:99], v[72:75], a[0:3], 0
v_fma_f32 v208, v208, v237, v236
v_fma_f32 v210, v210, v237, v236
v_mfma_f32_16x16x32_bf16 v[96:99], v[76:79], a[16:19], v[96:99]
v_mul_f32 v208, v208, v116
v_mul_f32 v210, v210, v117
v_mfma_f32_16x16x32_bf16 v[100:103], v[72:75], a[4:7], 0
ds_read_b128 v[64:67], v7 offset:4096
v_mul_f32 v209, v116, v132
v_mfma_f32_16x16x32_bf16 v[100:103], v[76:79], a[20:23], v[100:103]
v_exp_f32 v208, v208
v_mfma_f32_16x16x32_bf16 v[104:107], v[72:75], a[8:11], 0
v_exp_f32 v210, v210
v_mfma_f32_16x16x32_bf16 v[104:107], v[76:79], a[24:27], v[104:107]
ds_read_b128 v[68:71], v7 offset:5120
v_mul_f32 v211, v117, v133
v_mfma_f32_16x16x32_bf16 v[108:111], v[72:75], a[12:15], 0
v_fma_f32 v208, v208, v238, v238
v_fma_f32 v210, v210, v238, v238
v_mfma_f32_16x16x32_bf16 v[108:111], v[76:79], a[28:31], v[108:111]
v_mul_f32 v212, v118, v118
s_waitcnt lgkmcnt(4)
v_mfma_f32_16x16x32_bf16 v[80:83], v[48:51], a[32:35], v[80:83]
v_rcp_f32 v208, v208
v_mfma_f32_16x16x32_bf16 v[80:83], v[52:55], a[48:51], v[80:83]
v_rcp_f32 v210, v210
v_mfma_f32_16x16x32_bf16 v[84:87], v[48:51], a[36:39], v[84:87]
ds_read_b128 v[72:75], v7 offset:6144
v_mul_f32 v209, v209, v208
v_mfma_f32_16x16x32_bf16 v[84:87], v[52:55], a[52:55], v[84:87]
v_mul_f32 v211, v211, v210
v_cvt_pk_bf16_f32 v150, v209, v211
v_mfma_f32_16x16x32_bf16 v[88:91], v[48:51], a[40:43], v[88:91]
v_mul_f32 v214, v119, v119
v_fma_f32 v212, v212, v237, v236
v_mfma_f32_16x16x32_bf16 v[88:91], v[52:55], a[56:59], v[88:91]
ds_read_b128 v[76:79], v7 offset:7168
v_fma_f32 v214, v214, v237, v236
v_mfma_f32_16x16x32_bf16 v[92:95], v[48:51], a[44:47], v[92:95]
v_mul_f32 v212, v212, v118
v_mul_f32 v214, v214, v119
v_mfma_f32_16x16x32_bf16 v[92:95], v[52:55], a[60:63], v[92:95]
v_mul_f32 v213, v118, v134
s_waitcnt lgkmcnt(4)
v_mfma_f32_16x16x32_bf16 v[96:99], v[56:59], a[32:35], v[96:99]
s_waitcnt vmcnt(19)
v_mul_f32 v215, v119, v135
v_mfma_f32_16x16x32_bf16 v[96:99], v[60:63], a[48:51], v[96:99]
s_barrier
v_mfma_f32_16x16x32_bf16 v[100:103], v[56:59], a[36:39], v[100:103]
ds_read_b128 v[48:51], v7 offset:8192
s_add_u32 m0, s22, 24576
v_mfma_f32_16x16x32_bf16 v[100:103], v[60:63], a[52:55], v[100:103]
v_add_u32 v3, 20480, v3
buffer_load_dwordx4 v3, s[8:11], 0 offen offset:0 sc1 lds
v_mfma_f32_16x16x32_bf16 v[104:107], v[56:59], a[40:43], v[104:107]
v_exp_f32 v212, v212
v_mfma_f32_16x16x32_bf16 v[104:107], v[60:63], a[56:59], v[104:107]
ds_read_b128 v[52:55], v7 offset:9216
v_fma_f32 v212, v212, v238, v238
v_mfma_f32_16x16x32_bf16 v[108:111], v[56:59], a[44:47], v[108:111]
v_exp_f32 v214, v214
v_mfma_f32_16x16x32_bf16 v[108:111], v[60:63], a[60:63], v[108:111]
v_fma_f32 v214, v214, v238, v238
s_waitcnt lgkmcnt(4)
v_mfma_f32_16x16x32_bf16 v[80:83], v[64:67], a[64:67], v[80:83]
buffer_load_dwordx4 v3, s[8:11], 0 offen offset:1024 sc1 lds
v_mfma_f32_16x16x32_bf16 v[80:83], v[68:71], a[80:83], v[80:83]
v_rcp_f32 v212, v212
v_mfma_f32_16x16x32_bf16 v[84:87], v[64:67], a[68:71], v[84:87]
ds_read_b128 v[56:59], v7 offset:10240
v_mul_f32 v213, v213, v212
v_mfma_f32_16x16x32_bf16 v[84:87], v[68:71], a[84:87], v[84:87]
v_rcp_f32 v214, v214
v_mfma_f32_16x16x32_bf16 v[88:91], v[64:67], a[72:75], v[88:91]
v_mul_f32 v215, v215, v214
v_cvt_pk_bf16_f32 v151, v213, v215
v_mfma_f32_16x16x32_bf16 v[88:91], v[68:71], a[88:91], v[88:91]
ds_read_b128 v[60:63], v7 offset:11264
v_mul_f32 v208, v120, v120
v_mfma_f32_16x16x32_bf16 v[92:95], v[64:67], a[76:79], v[92:95]
buffer_load_dwordx4 v3, s[8:11], 0 offen offset:2048 sc1 lds
v_mfma_f32_16x16x32_bf16 v[92:95], v[68:71], a[92:95], v[92:95]
v_mul_f32 v210, v121, v121
s_waitcnt lgkmcnt(4)
v_mfma_f32_16x16x32_bf16 v[96:99], v[72:75], a[64:67], v[96:99]
buffer_store_dwordx4 v[148:151], v4, s[8:11], s24 offen offset:0 sc1
v_mfma_f32_16x16x32_bf16 v[96:99], v[76:79], a[80:83], v[96:99]
v_fma_f32 v208, v208, v241, v240
v_fma_f32 v210, v210, v241, v240
v_mfma_f32_16x16x32_bf16 v[100:103], v[72:75], a[68:71], v[100:103]
ds_read_b128 v[64:67], v7 offset:12288
v_mul_f32 v208, v208, v120
v_mfma_f32_16x16x32_bf16 v[100:103], v[76:79], a[84:87], v[100:103]
v_mul_f32 v210, v210, v121
v_mul_f32 v209, v120, v136
v_mfma_f32_16x16x32_bf16 v[104:107], v[72:75], a[72:75], v[104:107]
v_exp_f32 v208, v208
v_mfma_f32_16x16x32_bf16 v[104:107], v[76:79], a[88:91], v[104:107]
ds_read_b128 v[68:71], v7 offset:13312
v_mul_f32 v211, v121, v137
v_mfma_f32_16x16x32_bf16 v[108:111], v[72:75], a[76:79], v[108:111]
buffer_load_dwordx4 v3, s[8:11], 0 offen offset:3072 sc1 lds
v_mfma_f32_16x16x32_bf16 v[108:111], v[76:79], a[92:95], v[108:111]
s_add_u32 m0, s22, 28672
s_waitcnt lgkmcnt(4)
v_mfma_f32_16x16x32_bf16 v[80:83], v[48:51], a[96:99], v[80:83]
v_add_u32 v3, 4096, v3
v_fma_f32 v208, v208, v242, v242
v_mfma_f32_16x16x32_bf16 v[80:83], v[52:55], a[112:115], v[80:83]
v_exp_f32 v210, v210
v_mfma_f32_16x16x32_bf16 v[84:87], v[48:51], a[100:103], v[84:87]
ds_read_b128 v[72:75], v7 offset:14336
v_fma_f32 v210, v210, v242, v242
v_mfma_f32_16x16x32_bf16 v[84:87], v[52:55], a[116:119], v[84:87]
buffer_load_dwordx4 v3, s[8:11], 0 offen offset:0 sc1 lds
v_mfma_f32_16x16x32_bf16 v[88:91], v[48:51], a[104:107], v[88:91]
v_rcp_f32 v208, v208
v_mfma_f32_16x16x32_bf16 v[88:91], v[52:55], a[120:123], v[88:91]
ds_read_b128 v[76:79], v7 offset:15360
v_mul_f32 v209, v209, v208
v_mfma_f32_16x16x32_bf16 v[92:95], v[48:51], a[108:111], v[92:95]
v_rcp_f32 v210, v210
v_mfma_f32_16x16x32_bf16 v[92:95], v[52:55], a[124:127], v[92:95]
v_mul_f32 v211, v211, v210
s_waitcnt lgkmcnt(4)
v_mfma_f32_16x16x32_bf16 v[96:99], v[56:59], a[96:99], v[96:99]
buffer_load_dwordx4 v3, s[8:11], 0 offen offset:1024 sc1 lds
v_mfma_f32_16x16x32_bf16 v[96:99], v[60:63], a[112:115], v[96:99]
v_cvt_pk_bf16_f32 v154, v209, v211
v_mul_f32 v212, v122, v122
v_mfma_f32_16x16x32_bf16 v[100:103], v[56:59], a[100:103], v[100:103]
ds_read_b128 v[48:51], v7 offset:16384
v_mul_f32 v214, v123, v123
v_mfma_f32_16x16x32_bf16 v[100:103], v[60:63], a[116:119], v[100:103]
v_fma_f32 v212, v212, v241, v240
v_fma_f32 v214, v214, v241, v240
v_mfma_f32_16x16x32_bf16 v[104:107], v[56:59], a[104:107], v[104:107]
v_mul_f32 v212, v212, v122
v_mul_f32 v214, v214, v123
v_mfma_f32_16x16x32_bf16 v[104:107], v[60:63], a[120:123], v[104:107]
ds_read_b128 v[52:55], v7 offset:17408
v_mul_f32 v213, v122, v138
v_mfma_f32_16x16x32_bf16 v[108:111], v[56:59], a[108:111], v[108:111]
v_exp_f32 v212, v212
v_mfma_f32_16x16x32_bf16 v[108:111], v[60:63], a[124:127], v[108:111]
v_mul_f32 v215, v123, v139
s_waitcnt lgkmcnt(4)
v_mfma_f32_16x16x32_bf16 v[80:83], v[64:67], a[128:131], v[80:83]
v_exp_f32 v214, v214
v_mfma_f32_16x16x32_bf16 v[80:83], v[68:71], a[144:147], v[80:83]
v_fma_f32 v212, v212, v242, v242
v_fma_f32 v214, v214, v242, v242
v_mfma_f32_16x16x32_bf16 v[84:87], v[64:67], a[132:135], v[84:87]
ds_read_b128 v[56:59], v7 offset:18432
v_mul_f32 v208, v124, v124
v_mfma_f32_16x16x32_bf16 v[84:87], v[68:71], a[148:151], v[84:87]
v_rcp_f32 v212, v212
v_mfma_f32_16x16x32_bf16 v[88:91], v[64:67], a[136:139], v[88:91]
v_rcp_f32 v214, v214
v_mfma_f32_16x16x32_bf16 v[88:91], v[68:71], a[152:155], v[88:91]
ds_read_b128 v[60:63], v7 offset:19456
v_mul_f32 v213, v213, v212
v_mfma_f32_16x16x32_bf16 v[92:95], v[64:67], a[140:143], v[92:95]
v_mul_f32 v215, v215, v214
v_cvt_pk_bf16_f32 v155, v213, v215
v_mfma_f32_16x16x32_bf16 v[92:95], v[68:71], a[156:159], v[92:95]
v_mul_f32 v210, v125, v125
s_waitcnt lgkmcnt(4)
v_mfma_f32_16x16x32_bf16 v[96:99], v[72:75], a[128:131], v[96:99]
buffer_store_dwordx4 v[152:155], v5, s[8:11], s24 offen offset:0 sc1
v_mfma_f32_16x16x32_bf16 v[96:99], v[76:79], a[144:147], v[96:99]
v_fma_f32 v208, v208, v245, v244
v_fma_f32 v210, v210, v245, v244
v_mfma_f32_16x16x32_bf16 v[100:103], v[72:75], a[132:135], v[100:103]
ds_read_b128 v[64:67], v7 offset:20480
v_mul_f32 v208, v208, v124
v_mfma_f32_16x16x32_bf16 v[100:103], v[76:79], a[148:151], v[100:103]
v_mul_f32 v210, v210, v125
v_mul_f32 v209, v124, v140
v_mfma_f32_16x16x32_bf16 v[104:107], v[72:75], a[136:139], v[104:107]
v_exp_f32 v208, v208
v_mfma_f32_16x16x32_bf16 v[104:107], v[76:79], a[152:155], v[104:107]
ds_read_b128 v[68:71], v7 offset:21504
v_mul_f32 v211, v125, v141
v_mfma_f32_16x16x32_bf16 v[108:111], v[72:75], a[140:143], v[108:111]
v_exp_f32 v210, v210
v_mfma_f32_16x16x32_bf16 v[108:111], v[76:79], a[156:159], v[108:111]
v_fma_f32 v208, v208, v246, v246
s_waitcnt lgkmcnt(4)
v_mfma_f32_16x16x32_bf16 v[80:83], v[48:51], a[160:163], v[80:83]
v_fma_f32 v210, v210, v246, v246
v_mul_f32 v212, v126, v126
v_mfma_f32_16x16x32_bf16 v[80:83], v[52:55], a[176:179], v[80:83]
v_rcp_f32 v208, v208
v_mfma_f32_16x16x32_bf16 v[84:87], v[48:51], a[164:167], v[84:87]
ds_read_b128 v[72:75], v7 offset:22528
v_mul_f32 v209, v209, v208
v_mfma_f32_16x16x32_bf16 v[84:87], v[52:55], a[180:183], v[84:87]
v_rcp_f32 v210, v210
v_mfma_f32_16x16x32_bf16 v[88:91], v[48:51], a[168:171], v[88:91]
v_mul_f32 v211, v211, v210
v_cvt_pk_bf16_f32 v158, v209, v211
v_mfma_f32_16x16x32_bf16 v[88:91], v[52:55], a[184:187], v[88:91]
ds_read_b128 v[76:79], v7 offset:23552
v_mul_f32 v214, v127, v127
v_mfma_f32_16x16x32_bf16 v[92:95], v[48:51], a[172:175], v[92:95]
v_fma_f32 v212, v212, v245, v244
v_fma_f32 v214, v214, v245, v244
v_mfma_f32_16x16x32_bf16 v[92:95], v[52:55], a[188:191], v[92:95]
v_mul_f32 v212, v212, v126
s_waitcnt lgkmcnt(4)
v_mfma_f32_16x16x32_bf16 v[96:99], v[56:59], a[160:163], v[96:99]
v_mul_f32 v214, v214, v127
v_mul_f32 v213, v126, v142
v_mfma_f32_16x16x32_bf16 v[96:99], v[60:63], a[176:179], v[96:99]
v_exp_f32 v212, v212
v_mfma_f32_16x16x32_bf16 v[100:103], v[56:59], a[164:167], v[100:103]
ds_read_b128 v[48:51], v7 offset:24576
v_mul_f32 v215, v127, v143
v_mfma_f32_16x16x32_bf16 v[100:103], v[60:63], a[180:183], v[100:103]
v_exp_f32 v214, v214
v_mfma_f32_16x16x32_bf16 v[104:107], v[56:59], a[168:171], v[104:107]
v_fma_f32 v212, v212, v246, v246
v_fma_f32 v214, v214, v246, v246
v_mfma_f32_16x16x32_bf16 v[104:107], v[60:63], a[184:187], v[104:107]
ds_read_b128 v[52:55], v7 offset:25600
v_mul_f32 v216, v176, v176
v_mfma_f32_16x16x32_bf16 v[108:111], v[56:59], a[172:175], v[108:111]
v_rcp_f32 v212, v212
v_mfma_f32_16x16x32_bf16 v[108:111], v[60:63], a[188:191], v[108:111]
v_mul_f32 v213, v213, v212
s_waitcnt lgkmcnt(4)
v_mfma_f32_16x16x32_bf16 v[80:83], v[64:67], a[192:195], v[80:83]
v_rcp_f32 v214, v214
v_mfma_f32_16x16x32_bf16 v[80:83], v[68:71], a[208:211], v[80:83]
v_mul_f32 v215, v215, v214
v_cvt_pk_bf16_f32 v159, v213, v215
v_mfma_f32_16x16x32_bf16 v[84:87], v[64:67], a[196:199], v[84:87]
ds_read_b128 v[56:59], v7 offset:26624
v_mul_f32 v218, v177, v177
v_mfma_f32_16x16x32_bf16 v[84:87], v[68:71], a[212:215], v[84:87]
buffer_store_dwordx4 v[156:159], v6, s[8:11], s24 offen offset:0 sc1
v_mfma_f32_16x16x32_bf16 v[88:91], v[64:67], a[200:203], v[88:91]
v_fma_f32 v216, v216, v233, v232
v_fma_f32 v218, v218, v233, v232
v_mfma_f32_16x16x32_bf16 v[88:91], v[68:71], a[216:219], v[88:91]
ds_read_b128 v[60:63], v7 offset:27648
v_mul_f32 v216, v216, v176
v_mfma_f32_16x16x32_bf16 v[92:95], v[64:67], a[204:207], v[92:95]
v_mul_f32 v218, v218, v177
v_mul_f32 v217, v176, v192
v_mfma_f32_16x16x32_bf16 v[92:95], v[68:71], a[220:223], v[92:95]
v_mul_f32 v219, v177, v193
s_waitcnt lgkmcnt(4)
v_mfma_f32_16x16x32_bf16 v[96:99], v[72:75], a[192:195], v[96:99]
v_exp_f32 v216, v216
v_mfma_f32_16x16x32_bf16 v[96:99], v[76:79], a[208:211], v[96:99]
v_exp_f32 v218, v218
v_mfma_f32_16x16x32_bf16 v[100:103], v[72:75], a[196:199], v[100:103]
ds_read_b128 v[64:67], v7 offset:28672
v_fma_f32 v216, v216, v234, v234
v_mfma_f32_16x16x32_bf16 v[100:103], v[76:79], a[212:215], v[100:103]
v_fma_f32 v218, v218, v234, v234
v_mul_f32 v220, v178, v178
v_mfma_f32_16x16x32_bf16 v[104:107], v[72:75], a[200:203], v[104:107]
v_rcp_f32 v216, v216
v_mfma_f32_16x16x32_bf16 v[104:107], v[76:79], a[216:219], v[104:107]
ds_read_b128 v[68:71], v7 offset:29696
v_mul_f32 v217, v217, v216
v_mfma_f32_16x16x32_bf16 v[108:111], v[72:75], a[204:207], v[108:111]
v_rcp_f32 v218, v218
v_mfma_f32_16x16x32_bf16 v[108:111], v[76:79], a[220:223], v[108:111]
v_mul_f32 v219, v219, v218
s_waitcnt lgkmcnt(4)
v_mfma_f32_16x16x32_bf16 v[80:83], v[48:51], a[224:227], v[80:83]
v_cvt_pk_bf16_f32 v160, v217, v219
v_mul_f32 v222, v179, v179
v_mfma_f32_16x16x32_bf16 v[80:83], v[52:55], a[240:243], v[80:83]
v_fma_f32 v220, v220, v233, v232
v_fma_f32 v222, v222, v233, v232
v_mfma_f32_16x16x32_bf16 v[84:87], v[48:51], a[228:231], v[84:87]
ds_read_b128 v[72:75], v7 offset:30720
v_mul_f32 v220, v220, v178
v_mfma_f32_16x16x32_bf16 v[84:87], v[52:55], a[244:247], v[84:87]
v_mul_f32 v222, v222, v179
v_mul_f32 v221, v178, v194
v_mfma_f32_16x16x32_bf16 v[88:91], v[48:51], a[232:235], v[88:91]
v_exp_f32 v220, v220
v_mfma_f32_16x16x32_bf16 v[88:91], v[52:55], a[248:251], v[88:91]
ds_read_b128 v[76:79], v7 offset:31744
v_mul_f32 v223, v179, v195
v_mfma_f32_16x16x32_bf16 v[92:95], v[48:51], a[236:239], v[92:95]
v_exp_f32 v222, v222
v_mfma_f32_16x16x32_bf16 v[92:95], v[52:55], a[252:255], v[92:95]
v_fma_f32 v220, v220, v234, v234
s_waitcnt lgkmcnt(4)
v_mfma_f32_16x16x32_bf16 v[96:99], v[56:59], a[224:227], v[96:99]
s_waitcnt vmcnt(22)
v_fma_f32 v222, v222, v234, v234
v_mfma_f32_16x16x32_bf16 v[96:99], v[60:63], a[240:243], v[96:99]
s_barrier
v_mfma_f32_16x16x32_bf16 v[100:103], v[56:59], a[228:231], v[100:103]
ds_read_b128 v[48:51], v7 offset:32768
s_add_u32 m0, s22, 49152
v_mfma_f32_16x16x32_bf16 v[100:103], v[60:63], a[244:247], v[100:103]
v_add_u32 v3, 20480, v3
buffer_load_dwordx4 v3, s[8:11], 0 offen offset:0 sc1 lds
v_mfma_f32_16x16x32_bf16 v[104:107], v[56:59], a[232:235], v[104:107]
v_rcp_f32 v220, v220
v_mfma_f32_16x16x32_bf16 v[104:107], v[60:63], a[248:251], v[104:107]
ds_read_b128 v[52:55], v7 offset:33792
v_mul_f32 v221, v221, v220
v_mfma_f32_16x16x32_bf16 v[108:111], v[56:59], a[236:239], v[108:111]
v_rcp_f32 v222, v222
v_mfma_f32_16x16x32_bf16 v[108:111], v[60:63], a[252:255], v[108:111]
v_mul_f32 v223, v223, v222
s_waitcnt lgkmcnt(4)
v_mfma_f32_16x16x32_bf16 v[80:83], v[64:67], v[16:19], v[80:83]
buffer_load_dwordx4 v3, s[8:11], 0 offen offset:1024 sc1 lds
v_mfma_f32_16x16x32_bf16 v[80:83], v[68:71], v[32:35], v[80:83]
v_cvt_pk_bf16_f32 v161, v221, v223
v_mul_f32 v216, v180, v180
v_mfma_f32_16x16x32_bf16 v[84:87], v[64:67], v[20:23], v[84:87]
ds_read_b128 v[56:59], v7 offset:34816
v_mul_f32 v218, v181, v181
v_mfma_f32_16x16x32_bf16 v[84:87], v[68:71], v[36:39], v[84:87]
v_fma_f32 v216, v216, v237, v236
v_fma_f32 v218, v218, v237, v236
v_mfma_f32_16x16x32_bf16 v[88:91], v[64:67], v[24:27], v[88:91]
v_mul_f32 v216, v216, v180
v_mul_f32 v218, v218, v181
v_mfma_f32_16x16x32_bf16 v[88:91], v[68:71], v[40:43], v[88:91]
ds_read_b128 v[60:63], v7 offset:35840
v_mul_f32 v217, v180, v196
v_mfma_f32_16x16x32_bf16 v[92:95], v[64:67], v[28:31], v[92:95]
buffer_load_dwordx4 v3, s[8:11], 0 offen offset:2048 sc1 lds
v_mfma_f32_16x16x32_bf16 v[92:95], v[68:71], v[44:47], v[92:95]
v_mul_f32 v219, v181, v197
s_waitcnt lgkmcnt(4)
v_mfma_f32_16x16x32_bf16 v[96:99], v[72:75], v[16:19], v[96:99]
v_exp_f32 v216, v216
v_mfma_f32_16x16x32_bf16 v[96:99], v[76:79], v[32:35], v[96:99]
v_exp_f32 v218, v218
v_mfma_f32_16x16x32_bf16 v[100:103], v[72:75], v[20:23], v[100:103]
ds_read_b128 v[64:67], v7 offset:36864
v_fma_f32 v216, v216, v238, v238
v_mfma_f32_16x16x32_bf16 v[100:103], v[76:79], v[36:39], v[100:103]
buffer_load_dwordx4 v3, s[8:11], 0 offen offset:3072 sc1 lds
v_mfma_f32_16x16x32_bf16 v[104:107], v[72:75], v[24:27], v[104:107]
s_add_u32 m0, s22, 53248
v_add_u32 v3, 4096, v3
v_mfma_f32_16x16x32_bf16 v[104:107], v[76:79], v[40:43], v[104:107]
ds_read_b128 v[68:71], v7 offset:37888
v_fma_f32 v218, v218, v238, v238
v_mfma_f32_16x16x32_bf16 v[108:111], v[72:75], v[28:31], v[108:111]
v_rcp_f32 v216, v216
v_mfma_f32_16x16x32_bf16 v[108:111], v[76:79], v[44:47], v[108:111]
v_mul_f32 v217, v217, v216
s_waitcnt lgkmcnt(4)
v_mfma_f32_16x16x32_bf16 v[112:115], v[48:51], a[0:3], 0
buffer_load_dwordx4 v3, s[8:11], 0 offen offset:0 sc1 lds
v_mfma_f32_16x16x32_bf16 v[112:115], v[52:55], a[16:19], v[112:115]
v_rcp_f32 v218, v218
v_mfma_f32_16x16x32_bf16 v[116:119], v[48:51], a[4:7], 0
ds_read_b128 v[72:75], v7 offset:38912
v_mul_f32 v219, v219, v218
v_mfma_f32_16x16x32_bf16 v[116:119], v[52:55], a[20:23], v[116:119]
v_mul_f32 v208, v80, v80
v_mul_f32 v210, v81, v81
v_mfma_f32_16x16x32_bf16 v[120:123], v[48:51], a[8:11], 0
v_fma_f32 v208, v208, v233, v232
v_fma_f32 v210, v210, v233, v232
v_mfma_f32_16x16x32_bf16 v[120:123], v[52:55], a[24:27], v[120:123]
ds_read_b128 v[76:79], v7 offset:39936
v_mul_f32 v208, v208, v80
v_mfma_f32_16x16x32_bf16 v[124:127], v[48:51], a[12:15], 0
buffer_load_dwordx4 v3, s[8:11], 0 offen offset:1024 sc1 lds
v_mfma_f32_16x16x32_bf16 v[124:127], v[52:55], a[28:31], v[124:127]
v_mul_f32 v210, v210, v81
s_waitcnt lgkmcnt(4)
v_mfma_f32_16x16x32_bf16 v[128:131], v[56:59], a[0:3], 0
v_exp_f32 v208, v208
v_mfma_f32_16x16x32_bf16 v[128:131], v[60:63], a[16:19], v[128:131]
v_exp_f32 v210, v210
v_mfma_f32_16x16x32_bf16 v[132:135], v[56:59], a[4:7], 0
ds_read_b128 v[48:51], v7 offset:40960
v_mul_f32 v209, v80, v96
v_mfma_f32_16x16x32_bf16 v[132:135], v[60:63], a[20:23], v[132:135]
v_mul_f32 v211, v81, v97
v_fma_f32 v208, v208, v234, v234
v_mfma_f32_16x16x32_bf16 v[136:139], v[56:59], a[8:11], 0
v_fma_f32 v210, v210, v234, v234
v_mul_f32 v212, v82, v82
v_mfma_f32_16x16x32_bf16 v[136:139], v[60:63], a[24:27], v[136:139]
ds_read_b128 v[52:55], v7 offset:41984
v_mul_f32 v214, v83, v83
v_mfma_f32_16x16x32_bf16 v[140:143], v[56:59], a[12:15], 0
v_rcp_f32 v208, v208
v_mfma_f32_16x16x32_bf16 v[140:143], v[60:63], a[28:31], v[140:143]
v_mul_f32 v209, v209, v208
s_waitcnt lgkmcnt(4)
v_mfma_f32_16x16x32_bf16 v[112:115], v[64:67], a[32:35], v[112:115]
v_rcp_f32 v210, v210
v_mfma_f32_16x16x32_bf16 v[112:115], v[68:71], a[48:51], v[112:115]
v_mul_f32 v211, v211, v210
v_cvt_pk_bf16_f32 v162, v209, v211
v_mfma_f32_16x16x32_bf16 v[116:119], v[64:67], a[36:39], v[116:119]
ds_read_b128 v[56:59], v7 offset:43008
v_fma_f32 v212, v212, v233, v232
v_mfma_f32_16x16x32_bf16 v[116:119], v[68:71], a[52:55], v[116:119]
v_fma_f32 v214, v214, v233, v232
v_mul_f32 v212, v212, v82
v_mfma_f32_16x16x32_bf16 v[120:123], v[64:67], a[40:43], v[120:123]
v_mul_f32 v214, v214, v83
v_mul_f32 v213, v82, v98
v_mfma_f32_16x16x32_bf16 v[120:123], v[68:71], a[56:59], v[120:123]
ds_read_b128 v[60:63], v7 offset:44032
v_mul_f32 v215, v83, v99
v_mfma_f32_16x16x32_bf16 v[124:127], v[64:67], a[44:47], v[124:127]
v_exp_f32 v212, v212
v_mfma_f32_16x16x32_bf16 v[124:127], v[68:71], a[60:63], v[124:127]
v_fma_f32 v212, v212, v234, v234
s_waitcnt lgkmcnt(4)
v_mfma_f32_16x16x32_bf16 v[128:131], v[72:75], a[32:35], v[128:131]
v_exp_f32 v214, v214
v_mfma_f32_16x16x32_bf16 v[128:131], v[76:79], a[48:51], v[128:131]
v_fma_f32 v214, v214, v234, v234
v_mul_f32 v208, v84, v84
v_mfma_f32_16x16x32_bf16 v[132:135], v[72:75], a[36:39], v[132:135]
ds_read_b128 v[64:67], v7 offset:45056
v_mul_f32 v210, v85, v85
v_mfma_f32_16x16x32_bf16 v[132:135], v[76:79], a[52:55], v[132:135]
v_rcp_f32 v212, v212
v_mfma_f32_16x16x32_bf16 v[136:139], v[72:75], a[40:43], v[136:139]
v_rcp_f32 v214, v214
v_mfma_f32_16x16x32_bf16 v[136:139], v[76:79], a[56:59], v[136:139]
ds_read_b128 v[68:71], v7 offset:46080
v_mul_f32 v213, v213, v212
v_mfma_f32_16x16x32_bf16 v[140:143], v[72:75], a[44:47], v[140:143]
v_mul_f32 v215, v215, v214
v_cvt_pk_bf16_f32 v163, v213, v215
v_mfma_f32_16x16x32_bf16 v[140:143], v[76:79], a[60:63], v[140:143]
v_fma_f32 v208, v208, v237, v236
s_waitcnt lgkmcnt(4)
v_mfma_f32_16x16x32_bf16 v[112:115], v[48:51], a[64:67], v[112:115]
v_fma_f32 v210, v210, v237, v236
v_mul_f32 v208, v208, v84
v_mfma_f32_16x16x32_bf16 v[112:115], v[52:55], a[80:83], v[112:115]
v_mul_f32 v210, v210, v85
v_mul_f32 v209, v84, v100
v_mfma_f32_16x16x32_bf16 v[116:119], v[48:51], a[68:71], v[116:119]
ds_read_b128 v[72:75], v7 offset:47104
v_mul_f32 v211, v85, v101
v_mfma_f32_16x16x32_bf16 v[116:119], v[52:55], a[84:87], v[116:119]
v_exp_f32 v208, v208
v_mfma_f32_16x16x32_bf16 v[120:123], v[48:51], a[72:75], v[120:123]
v_exp_f32 v210, v210
v_mfma_f32_16x16x32_bf16 v[120:123], v[52:55], a[88:91], v[120:123]
ds_read_b128 v[76:79], v7 offset:48128
v_fma_f32 v208, v208, v238, v238
v_mfma_f32_16x16x32_bf16 v[124:127], v[48:51], a[76:79], v[124:127]
v_fma_f32 v210, v210, v238, v238
v_mul_f32 v212, v86, v86
v_mfma_f32_16x16x32_bf16 v[124:127], v[52:55], a[92:95], v[124:127]
v_mul_f32 v214, v87, v87
s_waitcnt lgkmcnt(4)
v_mfma_f32_16x16x32_bf16 v[128:131], v[56:59], a[64:67], v[128:131]
v_rcp_f32 v208, v208
v_mfma_f32_16x16x32_bf16 v[128:131], v[60:63], a[80:83], v[128:131]
v_rcp_f32 v210, v210
v_mfma_f32_16x16x32_bf16 v[132:135], v[56:59], a[68:71], v[132:135]
ds_read_b128 v[48:51], v7 offset:49152
v_mul_f32 v209, v209, v208
v_mfma_f32_16x16x32_bf16 v[132:135], v[60:63], a[84:87], v[132:135]
v_mul_f32 v211, v211, v210
v_cvt_pk_bf16_f32 v166, v209, v211
v_mfma_f32_16x16x32_bf16 v[136:139], v[56:59], a[72:75], v[136:139]
v_fma_f32 v212, v212, v237, v236
v_fma_f32 v214, v214, v237, v236
v_mfma_f32_16x16x32_bf16 v[136:139], v[60:63], a[88:91], v[136:139]
ds_read_b128 v[52:55], v7 offset:50176
v_mul_f32 v212, v212, v86
v_mfma_f32_16x16x32_bf16 v[140:143], v[56:59], a[76:79], v[140:143]
v_mul_f32 v214, v214, v87
v_mul_f32 v213, v86, v102
v_mfma_f32_16x16x32_bf16 v[140:143], v[60:63], a[92:95], v[140:143]
v_mul_f32 v215, v87, v103
s_waitcnt lgkmcnt(4)
v_mfma_f32_16x16x32_bf16 v[112:115], v[64:67], a[96:99], v[112:115]
L_hop5:
s_cmp_lg_u32 s15, 0
s_cbranch_scc1 L_hop9
v_exp_f32 v212, v212
v_mfma_f32_16x16x32_bf16 v[112:115], v[68:71], a[112:115], v[112:115]
v_exp_f32 v214, v214
v_mfma_f32_16x16x32_bf16 v[116:119], v[64:67], a[100:103], v[116:119]
ds_read_b128 v[56:59], v7 offset:51200
v_fma_f32 v212, v212, v238, v238
v_mfma_f32_16x16x32_bf16 v[116:119], v[68:71], a[116:119], v[116:119]
v_fma_f32 v214, v214, v238, v238
v_mul_f32 v208, v88, v88
v_mfma_f32_16x16x32_bf16 v[120:123], v[64:67], a[104:107], v[120:123]
v_rcp_f32 v212, v212
v_mfma_f32_16x16x32_bf16 v[120:123], v[68:71], a[120:123], v[120:123]
ds_read_b128 v[60:63], v7 offset:52224
v_mul_f32 v213, v213, v212
v_mfma_f32_16x16x32_bf16 v[124:127], v[64:67], a[108:111], v[124:127]
v_rcp_f32 v214, v214
v_mfma_f32_16x16x32_bf16 v[124:127], v[68:71], a[124:127], v[124:127]
v_mul_f32 v215, v215, v214
s_waitcnt lgkmcnt(4)
v_mfma_f32_16x16x32_bf16 v[128:131], v[72:75], a[96:99], v[128:131]
v_cvt_pk_bf16_f32 v167, v213, v215
v_mul_f32 v210, v89, v89
v_mfma_f32_16x16x32_bf16 v[128:131], v[76:79], a[112:115], v[128:131]
v_fma_f32 v208, v208, v241, v240
v_fma_f32 v210, v210, v241, v240
v_mfma_f32_16x16x32_bf16 v[132:135], v[72:75], a[100:103], v[132:135]
ds_read_b128 v[64:67], v7 offset:53248
v_mul_f32 v208, v208, v88
v_mfma_f32_16x16x32_bf16 v[132:135], v[76:79], a[116:119], v[132:135]
v_mul_f32 v210, v210, v89
v_mul_f32 v209, v88, v104
v_mfma_f32_16x16x32_bf16 v[136:139], v[72:75], a[104:107], v[136:139]
v_exp_f32 v208, v208
v_mfma_f32_16x16x32_bf16 v[136:139], v[76:79], a[120:123], v[136:139]
ds_read_b128 v[68:71], v7 offset:54272
v_mul_f32 v211, v89, v105
v_mfma_f32_16x16x32_bf16 v[140:143], v[72:75], a[108:111], v[140:143]
v_exp_f32 v210, v210
v_mfma_f32_16x16x32_bf16 v[140:143], v[76:79], a[124:127], v[140:143]
v_fma_f32 v208, v208, v242, v242
s_waitcnt lgkmcnt(4)
v_mfma_f32_16x16x32_bf16 v[112:115], v[48:51], a[128:131], v[112:115]
v_fma_f32 v210, v210, v242, v242
v_mul_f32 v212, v90, v90
v_mfma_f32_16x16x32_bf16 v[112:115], v[52:55], a[144:147], v[112:115]
v_rcp_f32 v208, v208
v_mfma_f32_16x16x32_bf16 v[116:119], v[48:51], a[132:135], v[116:119]
ds_read_b128 v[72:75], v7 offset:55296
v_mul_f32 v209, v209, v208
v_mfma_f32_16x16x32_bf16 v[116:119], v[52:55], a[148:151], v[116:119]
v_rcp_f32 v210, v210
v_mfma_f32_16x16x32_bf16 v[120:123], v[48:51], a[136:139], v[120:123]
v_mul_f32 v211, v211, v210
v_cvt_pk_bf16_f32 v170, v209, v211
v_mfma_f32_16x16x32_bf16 v[120:123], v[52:55], a[152:155], v[120:123]
ds_read_b128 v[76:79], v7 offset:56320
v_mul_f32 v214, v91, v91
v_mfma_f32_16x16x32_bf16 v[124:127], v[48:51], a[140:143], v[124:127]
v_fma_f32 v212, v212, v241, v240
v_fma_f32 v214, v214, v241, v240
v_mfma_f32_16x16x32_bf16 v[124:127], v[52:55], a[156:159], v[124:127]
v_mul_f32 v212, v212, v90
s_waitcnt lgkmcnt(4)
v_mfma_f32_16x16x32_bf16 v[128:131], v[56:59], a[128:131], v[128:131]
s_waitcnt vmcnt(22)
v_mul_f32 v214, v214, v91
v_mfma_f32_16x16x32_bf16 v[128:131], v[60:63], a[144:147], v[128:131]
s_barrier
v_mfma_f32_16x16x32_bf16 v[132:135], v[56:59], a[132:135], v[132:135]
ds_read_b128 v[48:51], v7 offset:57344
s_add_u32 m0, s22, 73728
v_mfma_f32_16x16x32_bf16 v[132:135], v[60:63], a[148:151], v[132:135]
v_add_u32 v3, 20480, v3
buffer_load_dwordx4 v3, s[8:11], 0 offen offset:0 sc1 lds
v_mfma_f32_16x16x32_bf16 v[136:139], v[56:59], a[136:139], v[136:139]
v_exp_f32 v212, v212
v_mfma_f32_16x16x32_bf16 v[136:139], v[60:63], a[152:155], v[136:139]
ds_read_b128 v[52:55], v7 offset:58368
v_mul_f32 v213, v90, v106
v_mfma_f32_16x16x32_bf16 v[140:143], v[56:59], a[140:143], v[140:143]
v_exp_f32 v214, v214
v_mfma_f32_16x16x32_bf16 v[140:143], v[60:63], a[156:159], v[140:143]
v_mul_f32 v215, v91, v107
s_waitcnt lgkmcnt(4)
v_mfma_f32_16x16x32_bf16 v[112:115], v[64:67], a[160:163], v[112:115]
buffer_load_dwordx4 v3, s[8:11], 0 offen offset:1024 sc1 lds
v_mfma_f32_16x16x32_bf16 v[112:115], v[68:71], a[176:179], v[112:115]
v_fma_f32 v212, v212, v242, v242
v_fma_f32 v214, v214, v242, v242
v_mfma_f32_16x16x32_bf16 v[116:119], v[64:67], a[164:167], v[116:119]
ds_read_b128 v[56:59], v7 offset:59392
v_mul_f32 v208, v92, v92
v_mfma_f32_16x16x32_bf16 v[116:119], v[68:71], a[180:183], v[116:119]
v_rcp_f32 v212, v212
v_mfma_f32_16x16x32_bf16 v[120:123], v[64:67], a[168:171], v[120:123]
v_rcp_f32 v214, v214
v_mfma_f32_16x16x32_bf16 v[120:123], v[68:71], a[184:187], v[120:123]
ds_read_b128 v[60:63], v7 offset:60416
v_mul_f32 v213, v213, v212
v_mfma_f32_16x16x32_bf16 v[124:127], v[64:67], a[172:175], v[124:127]
buffer_load_dwordx4 v3, s[8:11], 0 offen offset:2048 sc1 lds
v_mfma_f32_16x16x32_bf16 v[124:127], v[68:71], a[188:191], v[124:127]
v_mul_f32 v215, v215, v214
s_waitcnt lgkmcnt(4)
v_mfma_f32_16x16x32_bf16 v[128:131], v[72:75], a[160:163], v[128:131]
v_cvt_pk_bf16_f32 v171, v213, v215
v_mul_f32 v210, v93, v93
v_mfma_f32_16x16x32_bf16 v[128:131], v[76:79], a[176:179], v[128:131]
v_fma_f32 v208, v208, v245, v244
v_fma_f32 v210, v210, v245, v244
v_mfma_f32_16x16x32_bf16 v[132:135], v[72:75], a[164:167], v[132:135]
ds_read_b128 v[64:67], v7 offset:61440
v_mul_f32 v208, v208, v92
v_mfma_f32_16x16x32_bf16 v[132:135], v[76:79], a[180:183], v[132:135]
buffer_load_dwordx4 v3, s[8:11], 0 offen offset:3072 sc1 lds
v_mfma_f32_16x16x32_bf16 v[136:139], v[72:75], a[168:171], v[136:139]
s_add_u32 m0, s22, 77824
v_add_u32 v3, 4096, v3
v_mfma_f32_16x16x32_bf16 v[136:139], v[76:79], a[184:187], v[136:139]
ds_read_b128 v[68:71], v7 offset:62464
v_mul_f32 v210, v210, v93
v_mfma_f32_16x16x32_bf16 v[140:143], v[72:75], a[172:175], v[140:143]
v_exp_f32 v208, v208
v_mfma_f32_16x16x32_bf16 v[140:143], v[76:79], a[188:191], v[140:143]
v_mul_f32 v209, v92, v108
s_waitcnt lgkmcnt(4)
v_mfma_f32_16x16x32_bf16 v[112:115], v[48:51], a[192:195], v[112:115]
buffer_load_dwordx4 v3, s[8:11], 0 offen offset:0 sc1 lds
v_mfma_f32_16x16x32_bf16 v[112:115], v[52:55], a[208:211], v[112:115]
v_exp_f32 v210, v210
v_mfma_f32_16x16x32_bf16 v[116:119], v[48:51], a[196:199], v[116:119]
ds_read_b128 v[72:75], v7 offset:63488
v_mul_f32 v211, v93, v109
v_mfma_f32_16x16x32_bf16 v[116:119], v[52:55], a[212:215], v[116:119]
v_fma_f32 v208, v208, v246, v246
v_fma_f32 v210, v210, v246, v246
v_mfma_f32_16x16x32_bf16 v[120:123], v[48:51], a[200:203], v[120:123]
v_rcp_f32 v208, v208
v_mfma_f32_16x16x32_bf16 v[120:123], v[52:55], a[216:219], v[120:123]
ds_read_b128 v[76:79], v7 offset:64512
v_mul_f32 v209, v209, v208
v_mfma_f32_16x16x32_bf16 v[124:127], v[48:51], a[204:207], v[124:127]
buffer_load_dwordx4 v3, s[8:11], 0 offen offset:1024 sc1 lds
v_mfma_f32_16x16x32_bf16 v[124:127], v[52:55], a[220:223], v[124:127]
v_mul_f32 v212, v94, v94
s_waitcnt lgkmcnt(4)
v_mfma_f32_16x16x32_bf16 v[128:131], v[56:59], a[192:195], v[128:131]
v_rcp_f32 v210, v210
v_mfma_f32_16x16x32_bf16 v[128:131], v[60:63], a[208:211], v[128:131]
v_mul_f32 v211, v211, v210
v_cvt_pk_bf16_f32 v174, v209, v211
v_mfma_f32_16x16x32_bf16 v[132:135], v[56:59], a[196:199], v[132:135]
ds_read_b128 v[48:51], v8 offset:0
v_mul_f32 v214, v95, v95
v_mfma_f32_16x16x32_bf16 v[132:135], v[60:63], a[212:215], v[132:135]
v_fma_f32 v212, v212, v245, v244
v_fma_f32 v214, v214, v245, v244
v_mfma_f32_16x16x32_bf16 v[136:139], v[56:59], a[200:203], v[136:139]
v_mul_f32 v212, v212, v94
v_mul_f32 v214, v214, v95
v_mfma_f32_16x16x32_bf16 v[136:139], v[60:63], a[216:219], v[136:139]
ds_read_b128 v[52:55], v8 offset:1024
v_mul_f32 v213, v94, v110
v_mfma_f32_16x16x32_bf16 v[140:143], v[56:59], a[204:207], v[140:143]
v_exp_f32 v212, v212
v_mfma_f32_16x16x32_bf16 v[140:143], v[60:63], a[220:223], v[140:143]
v_mul_f32 v215, v95, v111
s_waitcnt lgkmcnt(4)
v_mfma_f32_16x16x32_bf16 v[112:115], v[64:67], a[224:227], v[112:115]
v_exp_f32 v214, v214
v_mfma_f32_16x16x32_bf16 v[112:115], v[68:71], a[240:243], v[112:115]
v_fma_f32 v212, v212, v246, v246
v_fma_f32 v214, v214, v246, v246
v_mfma_f32_16x16x32_bf16 v[116:119], v[64:67], a[228:231], v[116:119]
ds_read_b128 v[56:59], v8 offset:2048
v_cvt_pk_bf16_f32 v164, v217, v219
v_mfma_f32_16x16x32_bf16 v[116:119], v[68:71], a[244:247], v[116:119]
v_rcp_f32 v212, v212
v_mfma_f32_16x16x32_bf16 v[120:123], v[64:67], a[232:235], v[120:123]
v_rcp_f32 v214, v214
v_mfma_f32_16x16x32_bf16 v[120:123], v[68:71], a[248:251], v[120:123]
ds_read_b128 v[60:63], v8 offset:3072
v_mul_f32 v213, v213, v212
v_mfma_f32_16x16x32_bf16 v[124:127], v[64:67], a[236:239], v[124:127]
v_mul_f32 v215, v215, v214
v_cvt_pk_bf16_f32 v175, v213, v215
v_mfma_f32_16x16x32_bf16 v[124:127], v[68:71], a[252:255], v[124:127]
v_mul_f32 v220, v182, v182
s_waitcnt lgkmcnt(4)
v_mfma_f32_16x16x32_bf16 v[128:131], v[72:75], a[224:227], v[128:131]
v_mul_f32 v222, v183, v183
v_fma_f32 v220, v220, v237, v236
v_mfma_f32_16x16x32_bf16 v[128:131], v[76:79], a[240:243], v[128:131]
v_fma_f32 v222, v222, v237, v236
v_mul_f32 v220, v220, v182
v_mfma_f32_16x16x32_bf16 v[132:135], v[72:75], a[228:231], v[132:135]
ds_read_b128 v[64:67], v8 offset:4096
v_mul_f32 v222, v222, v183
v_mfma_f32_16x16x32_bf16 v[132:135], v[76:79], a[244:247], v[132:135]
v_exp_f32 v220, v220
v_mfma_f32_16x16x32_bf16 v[136:139], v[72:75], a[232:235], v[136:139]
v_exp_f32 v222, v222
v_mfma_f32_16x16x32_bf16 v[136:139], v[76:79], a[248:251], v[136:139]
ds_read_b128 v[68:71], v8 offset:5120
v_mul_f32 v221, v182, v198
v_mfma_f32_16x16x32_bf16 v[140:143], v[72:75], a[236:239], v[140:143]
v_mul_f32 v223, v183, v199
v_fma_f32 v220, v220, v238, v238
v_mfma_f32_16x16x32_bf16 v[140:143], v[76:79], a[252:255], v[140:143]
v_fma_f32 v222, v222, v238, v238
s_waitcnt lgkmcnt(4)
v_mfma_f32_16x16x32_bf16 v[112:115], v[48:51], v[16:19], v[112:115]
v_rcp_f32 v220, v220
v_mfma_f32_16x16x32_bf16 v[112:115], v[52:55], v[32:35], v[112:115]
v_rcp_f32 v222, v222
v_mfma_f32_16x16x32_bf16 v[116:119], v[48:51], v[20:23], v[116:119]
ds_read_b128 v[72:75], v8 offset:6144
v_mul_f32 v221, v221, v220
v_mfma_f32_16x16x32_bf16 v[116:119], v[52:55], v[36:39], v[116:119]
v_mul_f32 v223, v223, v222
v_cvt_pk_bf16_f32 v165, v221, v223
v_mfma_f32_16x16x32_bf16 v[120:123], v[48:51], v[24:27], v[120:123]
v_mul_f32 v216, v184, v184
v_mul_f32 v218, v185, v185
v_mfma_f32_16x16x32_bf16 v[120:123], v[52:55], v[40:43], v[120:123]
ds_read_b128 v[76:79], v8 offset:7168
v_fma_f32 v216, v216, v241, v240
v_mfma_f32_16x16x32_bf16 v[124:127], v[48:51], v[28:31], v[124:127]
v_fma_f32 v218, v218, v241, v240
v_mul_f32 v216, v216, v184
v_mfma_f32_16x16x32_bf16 v[124:127], v[52:55], v[44:47], v[124:127]
v_mul_f32 v218, v218, v185
s_waitcnt lgkmcnt(4)
v_mfma_f32_16x16x32_bf16 v[128:131], v[56:59], v[16:19], v[128:131]
v_exp_f32 v216, v216
v_mfma_f32_16x16x32_bf16 v[128:131], v[60:63], v[32:35], v[128:131]
v_exp_f32 v218, v218
v_mfma_f32_16x16x32_bf16 v[132:135], v[56:59], v[20:23], v[132:135]
ds_read_b128 v[48:51], v8 offset:8192
v_mul_f32 v217, v184, v200
v_mfma_f32_16x16x32_bf16 v[132:135], v[60:63], v[36:39], v[132:135]
v_mul_f32 v219, v185, v201
v_fma_f32 v216, v216, v242, v242
v_mfma_f32_16x16x32_bf16 v[136:139], v[56:59], v[24:27], v[136:139]
v_fma_f32 v218, v218, v242, v242
v_mul_f32 v220, v186, v186
v_mfma_f32_16x16x32_bf16 v[136:139], v[60:63], v[40:43], v[136:139]
ds_read_b128 v[52:55], v8 offset:9216
v_mul_f32 v222, v187, v187
v_mfma_f32_16x16x32_bf16 v[140:143], v[56:59], v[28:31], v[140:143]
v_rcp_f32 v216, v216
v_mfma_f32_16x16x32_bf16 v[140:143], v[60:63], v[44:47], v[140:143]
v_mul_f32 v217, v217, v216
s_waitcnt lgkmcnt(4)
v_mfma_f32_16x16x32_bf16 v[80:83], v[64:67], a[0:3], 0
v_rcp_f32 v218, v218
v_mfma_f32_16x16x32_bf16 v[80:83], v[68:71], a[16:19], v[80:83]
v_mul_f32 v219, v219, v218
v_cvt_pk_bf16_f32 v168, v217, v219
v_mfma_f32_16x16x32_bf16 v[84:87], v[64:67], a[4:7], 0
ds_read_b128 v[56:59], v8 offset:10240
v_fma_f32 v220, v220, v241, v240
v_mfma_f32_16x16x32_bf16 v[84:87], v[68:71], a[20:23], v[84:87]
v_fma_f32 v222, v222, v241, v240
v_mul_f32 v220, v220, v186
v_mfma_f32_16x16x32_bf16 v[88:91], v[64:67], a[8:11], 0
v_mul_f32 v222, v222, v187
v_mul_f32 v221, v186, v202
v_mfma_f32_16x16x32_bf16 v[88:91], v[68:71], a[24:27], v[88:91]
ds_read_b128 v[60:63], v8 offset:11264
v_mul_f32 v223, v187, v203
v_mfma_f32_16x16x32_bf16 v[92:95], v[64:67], a[12:15], 0
v_exp_f32 v220, v220
v_mfma_f32_16x16x32_bf16 v[92:95], v[68:71], a[28:31], v[92:95]
v_fma_f32 v220, v220, v242, v242
s_waitcnt lgkmcnt(4)
v_mfma_f32_16x16x32_bf16 v[96:99], v[72:75], a[0:3], 0
v_exp_f32 v222, v222
v_mfma_f32_16x16x32_bf16 v[96:99], v[76:79], a[16:19], v[96:99]
v_fma_f32 v222, v222, v242, v242
v_mul_f32 v216, v188, v188
v_mfma_f32_16x16x32_bf16 v[100:103], v[72:75], a[4:7], 0
ds_read_b128 v[64:67], v8 offset:12288
v_mul_f32 v218, v189, v189
v_mfma_f32_16x16x32_bf16 v[100:103], v[76:79], a[20:23], v[100:103]
v_rcp_f32 v220, v220
v_mfma_f32_16x16x32_bf16 v[104:107], v[72:75], a[8:11], 0
v_rcp_f32 v222, v222
v_mfma_f32_16x16x32_bf16 v[104:107], v[76:79], a[24:27], v[104:107]
ds_read_b128 v[68:71], v8 offset:13312
v_mul_f32 v221, v221, v220
v_mfma_f32_16x16x32_bf16 v[108:111], v[72:75], a[12:15], 0
v_mul_f32 v223, v223, v222
v_cvt_pk_bf16_f32 v169, v221, v223
v_mfma_f32_16x16x32_bf16 v[108:111], v[76:79], a[28:31], v[108:111]
v_fma_f32 v216, v216, v245, v244
s_waitcnt lgkmcnt(4)
v_mfma_f32_16x16x32_bf16 v[80:83], v[48:51], a[32:35], v[80:83]
v_fma_f32 v218, v218, v245, v244
v_mul_f32 v216, v216, v188
v_mfma_f32_16x16x32_bf16 v[80:83], v[52:55], a[48:51], v[80:83]
v_mul_f32 v218, v218, v189
v_mul_f32 v217, v188, v204
v_mfma_f32_16x16x32_bf16 v[84:87], v[48:51], a[36:39], v[84:87]
ds_read_b128 v[72:75], v8 offset:14336
v_mul_f32 v219, v189, v205
v_mfma_f32_16x16x32_bf16 v[84:87], v[52:55], a[52:55], v[84:87]
v_exp_f32 v216, v216
v_mfma_f32_16x16x32_bf16 v[88:91], v[48:51], a[40:43], v[88:91]
v_exp_f32 v218, v218
v_mfma_f32_16x16x32_bf16 v[88:91], v[52:55], a[56:59], v[88:91]
ds_read_b128 v[76:79], v8 offset:15360
v_fma_f32 v216, v216, v246, v246
v_mfma_f32_16x16x32_bf16 v[92:95], v[48:51], a[44:47], v[92:95]
v_fma_f32 v218, v218, v246, v246
v_mul_f32 v220, v190, v190
v_mfma_f32_16x16x32_bf16 v[92:95], v[52:55], a[60:63], v[92:95]
v_mul_f32 v222, v191, v191
s_waitcnt lgkmcnt(4)
v_mfma_f32_16x16x32_bf16 v[96:99], v[56:59], a[32:35], v[96:99]
s_waitcnt vmcnt(22)
v_fma_f32 v220, v220, v245, v244
v_mfma_f32_16x16x32_bf16 v[96:99], v[60:63], a[48:51], v[96:99]
s_barrier
v_mfma_f32_16x16x32_bf16 v[100:103], v[56:59], a[36:39], v[100:103]
ds_read_b128 v[48:51], v2 offset:0
s_add_u32 m0, s22, 98304
v_mfma_f32_16x16x32_bf16 v[100:103], v[60:63], a[52:55], v[100:103]
v_add_u32 v3, 20480, v3
buffer_load_dwordx4 v3, s[8:11], 0 offen offset:0 sc1 lds
v_mfma_f32_16x16x32_bf16 v[104:107], v[56:59], a[40:43], v[104:107]
v_rcp_f32 v216, v216
v_mfma_f32_16x16x32_bf16 v[104:107], v[60:63], a[56:59], v[104:107]
ds_read_b128 v[52:55], v2 offset:1024
v_mul_f32 v217, v217, v216
v_mfma_f32_16x16x32_bf16 v[108:111], v[56:59], a[44:47], v[108:111]
v_rcp_f32 v218, v218
v_mfma_f32_16x16x32_bf16 v[108:111], v[60:63], a[60:63], v[108:111]
v_mul_f32 v219, v219, v218
s_waitcnt lgkmcnt(4)
v_mfma_f32_16x16x32_bf16 v[80:83], v[64:67], a[64:67], v[80:83]
buffer_load_dwordx4 v3, s[8:11], 0 offen offset:1024 sc1 lds
v_mfma_f32_16x16x32_bf16 v[80:83], v[68:71], a[80:83], v[80:83]
v_cvt_pk_bf16_f32 v172, v217, v219
v_fma_f32 v222, v222, v245, v244
v_mfma_f32_16x16x32_bf16 v[84:87], v[64:67], a[68:71], v[84:87]
ds_read_b128 v[56:59], v2 offset:2048
v_mul_f32 v220, v220, v190
v_mfma_f32_16x16x32_bf16 v[84:87], v[68:71], a[84:87], v[84:87]
v_mul_f32 v222, v222, v191
v_mul_f32 v221, v190, v206
v_mfma_f32_16x16x32_bf16 v[88:91], v[64:67], a[72:75], v[88:91]
v_exp_f32 v220, v220
v_mfma_f32_16x16x32_bf16 v[88:91], v[68:71], a[88:91], v[88:91]
ds_read_b128 v[60:63], v2 offset:3072
v_mul_f32 v223, v191, v207
v_mfma_f32_16x16x32_bf16 v[92:95], v[64:67], a[76:79], v[92:95]
buffer_load_dwordx4 v3, s[8:11], 0 offen offset:2048 sc1 lds
v_mfma_f32_16x16x32_bf16 v[92:95], v[68:71], a[92:95], v[92:95]
v_fma_f32 v220, v220, v246, v246
s_waitcnt lgkmcnt(4)
v_mfma_f32_16x16x32_bf16 v[96:99], v[72:75], a[64:67], v[96:99]
v_exp_f32 v222, v222
v_mfma_f32_16x16x32_bf16 v[96:99], v[76:79], a[80:83], v[96:99]
v_fma_f32 v222, v222, v246, v246
v_mfma_f32_16x16x32_bf16 v[100:103], v[72:75], a[68:71], v[100:103]
ds_read_b128 v[64:67], v2 offset:4096
v_mfma_f32_16x16x32_bf16 v[100:103], v[76:79], a[84:87], v[100:103]
buffer_load_dwordx4 v3, s[8:11], 0 offen offset:3072 sc1 lds
v_mfma_f32_16x16x32_bf16 v[104:107], v[72:75], a[72:75], v[104:107]
s_add_u32 m0, s22, 102400
v_add_u32 v3, 4096, v3
v_mfma_f32_16x16x32_bf16 v[104:107], v[76:79], a[88:91], v[104:107]
ds_read_b128 v[68:71], v2 offset:5120
v_mfma_f32_16x16x32_bf16 v[108:111], v[72:75], a[76:79], v[108:111]
v_rcp_f32 v220, v220
v_mfma_f32_16x16x32_bf16 v[108:111], v[76:79], a[92:95], v[108:111]
v_mul_f32 v221, v221, v220
s_waitcnt lgkmcnt(4)
v_mfma_f32_16x16x32_bf16 v[80:83], v[48:51], a[96:99], v[80:83]
buffer_load_dwordx4 v3, s[8:11], 0 offen offset:0 sc1 lds
v_mfma_f32_16x16x32_bf16 v[80:83], v[52:55], a[112:115], v[80:83]
v_rcp_f32 v222, v222
v_mfma_f32_16x16x32_bf16 v[84:87], v[48:51], a[100:103], v[84:87]
ds_read_b128 v[72:75], v2 offset:6144
v_mul_f32 v223, v223, v222
v_mfma_f32_16x16x32_bf16 v[84:87], v[52:55], a[116:119], v[84:87]
v_cvt_pk_bf16_f32 v173, v221, v223
v_mfma_f32_16x16x32_bf16 v[88:91], v[48:51], a[104:107], v[88:91]
v_mul_f32 v208, v112, v112
v_mul_f32 v210, v113, v113
v_mfma_f32_16x16x32_bf16 v[88:91], v[52:55], a[120:123], v[88:91]
ds_read_b128 v[76:79], v2 offset:7168
v_fma_f32 v208, v208, v233, v232
v_mfma_f32_16x16x32_bf16 v[92:95], v[48:51], a[108:111], v[92:95]
buffer_load_dwordx4 v3, s[8:11], 0 offen offset:1024 sc1 lds
v_mfma_f32_16x16x32_bf16 v[92:95], v[52:55], a[124:127], v[92:95]
v_fma_f32 v210, v210, v233, v232
s_waitcnt lgkmcnt(4)
v_mfma_f32_16x16x32_bf16 v[96:99], v[56:59], a[96:99], v[96:99]
v_mul_f32 v208, v208, v112
v_mul_f32 v210, v210, v113
v_mfma_f32_16x16x32_bf16 v[96:99], v[60:63], a[112:115], v[96:99]
v_exp_f32 v208, v208
v_mfma_f32_16x16x32_bf16 v[100:103], v[56:59], a[100:103], v[100:103]
ds_read_b128 v[48:51], v2 offset:8192
v_exp_f32 v210, v210
v_mfma_f32_16x16x32_bf16 v[100:103], v[60:63], a[116:119], v[100:103]
v_mul_f32 v209, v112, v128
v_mul_f32 v211, v113, v129
v_mfma_f32_16x16x32_bf16 v[104:107], v[56:59], a[104:107], v[104:107]
v_fma_f32 v208, v208, v234, v234
v_fma_f32 v210, v210, v234, v234
v_mfma_f32_16x16x32_bf16 v[104:107], v[60:63], a[120:123], v[104:107]
ds_read_b128 v[52:55], v2 offset:9216
v_rcp_f32 v208, v208
v_mfma_f32_16x16x32_bf16 v[108:111], v[56:59], a[108:111], v[108:111]
v_rcp_f32 v210, v210
v_mfma_f32_16x16x32_bf16 v[108:111], v[60:63], a[124:127], v[108:111]
v_mul_f32 v209, v209, v208
s_waitcnt lgkmcnt(4)
v_mfma_f32_16x16x32_bf16 v[80:83], v[64:67], a[128:131], v[80:83]
v_mul_f32 v211, v211, v210
v_cvt_pk_bf16_f32 v176, v209, v211
v_mfma_f32_16x16x32_bf16 v[80:83], v[68:71], a[144:147], v[80:83]
v_mul_f32 v212, v114, v114
v_mul_f32 v214, v115, v115
v_mfma_f32_16x16x32_bf16 v[84:87], v[64:67], a[132:135], v[84:87]
ds_read_b128 v[56:59], v2 offset:10240
v_fma_f32 v212, v212, v233, v232
v_mfma_f32_16x16x32_bf16 v[84:87], v[68:71], a[148:151], v[84:87]
v_fma_f32 v214, v214, v233, v232
v_mul_f32 v212, v212, v114
v_mfma_f32_16x16x32_bf16 v[88:91], v[64:67], a[136:139], v[88:91]
v_mul_f32 v214, v214, v115
v_exp_f32 v212, v212
v_mfma_f32_16x16x32_bf16 v[88:91], v[68:71], a[152:155], v[88:91]
ds_read_b128 v[60:63], v2 offset:11264
v_exp_f32 v214, v214
v_mfma_f32_16x16x32_bf16 v[92:95], v[64:67], a[140:143], v[92:95]
v_mul_f32 v213, v114, v130
v_mul_f32 v215, v115, v131
v_mfma_f32_16x16x32_bf16 v[92:95], v[68:71], a[156:159], v[92:95]
v_fma_f32 v212, v212, v234, v234
s_waitcnt lgkmcnt(4)
v_mfma_f32_16x16x32_bf16 v[96:99], v[72:75], a[128:131], v[96:99]
v_fma_f32 v214, v214, v234, v234
v_mul_f32 v208, v116, v116
v_mfma_f32_16x16x32_bf16 v[96:99], v[76:79], a[144:147], v[96:99]
v_rcp_f32 v212, v212
v_mfma_f32_16x16x32_bf16 v[100:103], v[72:75], a[132:135], v[100:103]
ds_read_b128 v[64:67], v2 offset:12288
v_rcp_f32 v214, v214
v_mfma_f32_16x16x32_bf16 v[100:103], v[76:79], a[148:151], v[100:103]
v_mul_f32 v213, v213, v212
v_mul_f32 v215, v215, v214
v_mfma_f32_16x16x32_bf16 v[104:107], v[72:75], a[136:139], v[104:107]
v_cvt_pk_bf16_f32 v177, v213, v215
v_mul_f32 v210, v117, v117
v_mfma_f32_16x16x32_bf16 v[104:107], v[76:79], a[152:155], v[104:107]
ds_read_b128 v[68:71], v2 offset:13312
v_fma_f32 v208, v208, v237, v236
v_mfma_f32_16x16x32_bf16 v[108:111], v[72:75], a[140:143], v[108:111]
v_fma_f32 v210, v210, v237, v236
v_mul_f32 v208, v208, v116
v_mfma_f32_16x16x32_bf16 v[108:111], v[76:79], a[156:159], v[108:111]
v_mul_f32 v210, v210, v117
s_waitcnt lgkmcnt(4)
v_mfma_f32_16x16x32_bf16 v[80:83], v[48:51], a[160:163], v[80:83]
v_exp_f32 v208, v208
v_mfma_f32_16x16x32_bf16 v[80:83], v[52:55], a[176:179], v[80:83]
v_exp_f32 v210, v210
v_mfma_f32_16x16x32_bf16 v[84:87], v[48:51], a[164:167], v[84:87]
ds_read_b128 v[72:75], v2 offset:14336
v_mul_f32 v209, v116, v132
v_mfma_f32_16x16x32_bf16 v[84:87], v[52:55], a[180:183], v[84:87]
v_mul_f32 v211, v117, v133
v_fma_f32 v208, v208, v238, v238
v_mfma_f32_16x16x32_bf16 v[88:91], v[48:51], a[168:171], v[88:91]
v_fma_f32 v210, v210, v238, v238
v_rcp_f32 v208, v208
v_mfma_f32_16x16x32_bf16 v[88:91], v[52:55], a[184:187], v[88:91]
ds_read_b128 v[76:79], v2 offset:15360
v_rcp_f32 v210, v210
v_mfma_f32_16x16x32_bf16 v[92:95], v[48:51], a[172:175], v[92:95]
v_mul_f32 v209, v209, v208
v_mul_f32 v211, v211, v210
v_mfma_f32_16x16x32_bf16 v[92:95], v[52:55], a[188:191], v[92:95]
v_cvt_pk_bf16_f32 v180, v209, v211
s_waitcnt lgkmcnt(4)
v_mfma_f32_16x16x32_bf16 v[96:99], v[56:59], a[160:163], v[96:99]
v_mul_f32 v212, v118, v118
v_mul_f32 v214, v119, v119
v_mfma_f32_16x16x32_bf16 v[96:99], v[60:63], a[176:179], v[96:99]
v_fma_f32 v212, v212, v237, v236
v_fma_f32 v214, v214, v237, v236
v_mfma_f32_16x16x32_bf16 v[100:103], v[56:59], a[164:167], v[100:103]
ds_read_b128 v[48:51], v2 offset:16384
v_mul_f32 v212, v212, v118
v_mfma_f32_16x16x32_bf16 v[100:103], v[60:63], a[180:183], v[100:103]
v_mul_f32 v214, v214, v119
v_exp_f32 v212, v212
v_mfma_f32_16x16x32_bf16 v[104:107], v[56:59], a[168:171], v[104:107]
v_exp_f32 v214, v214
v_mfma_f32_16x16x32_bf16 v[104:107], v[60:63], a[184:187], v[104:107]
ds_read_b128 v[52:55], v2 offset:17408
v_mul_f32 v213, v118, v134
v_mfma_f32_16x16x32_bf16 v[108:111], v[56:59], a[172:175], v[108:111]
v_mul_f32 v215, v119, v135
v_fma_f32 v212, v212, v238, v238
v_mfma_f32_16x16x32_bf16 v[108:111], v[60:63], a[188:191], v[108:111]
v_fma_f32 v214, v214, v238, v238
s_waitcnt lgkmcnt(4)
v_mfma_f32_16x16x32_bf16 v[80:83], v[64:67], a[192:195], v[80:83]
v_rcp_f32 v212, v212
v_mfma_f32_16x16x32_bf16 v[80:83], v[68:71], a[208:211], v[80:83]
v_rcp_f32 v214, v214
v_mfma_f32_16x16x32_bf16 v[84:87], v[64:67], a[196:199], v[84:87]
ds_read_b128 v[56:59], v2 offset:18432
v_mul_f32 v213, v213, v212
v_mfma_f32_16x16x32_bf16 v[84:87], v[68:71], a[212:215], v[84:87]
v_mul_f32 v215, v215, v214
v_cvt_pk_bf16_f32 v181, v213, v215
v_mfma_f32_16x16x32_bf16 v[88:91], v[64:67], a[200:203], v[88:91]
v_mul_f32 v208, v120, v120
v_mul_f32 v210, v121, v121
v_mfma_f32_16x16x32_bf16 v[88:91], v[68:71], a[216:219], v[88:91]
ds_read_b128 v[60:63], v2 offset:19456
v_fma_f32 v208, v208, v241, v240
v_mfma_f32_16x16x32_bf16 v[92:95], v[64:67], a[204:207], v[92:95]
v_fma_f32 v210, v210, v241, v240
v_mul_f32 v208, v208, v120
v_mfma_f32_16x16x32_bf16 v[92:95], v[68:71], a[220:223], v[92:95]
v_mul_f32 v210, v210, v121
s_waitcnt lgkmcnt(4)
v_mfma_f32_16x16x32_bf16 v[96:99], v[72:75], a[192:195], v[96:99]
v_exp_f32 v208, v208
v_mfma_f32_16x16x32_bf16 v[96:99], v[76:79], a[208:211], v[96:99]
v_exp_f32 v210, v210
v_mfma_f32_16x16x32_bf16 v[100:103], v[72:75], a[196:199], v[100:103]
ds_read_b128 v[64:67], v2 offset:20480
v_mul_f32 v209, v120, v136
v_mfma_f32_16x16x32_bf16 v[100:103], v[76:79], a[212:215], v[100:103]
v_mul_f32 v211, v121, v137
v_fma_f32 v208, v208, v242, v242
v_mfma_f32_16x16x32_bf16 v[104:107], v[72:75], a[200:203], v[104:107]
v_fma_f32 v210, v210, v242, v242
v_rcp_f32 v208, v208
v_mfma_f32_16x16x32_bf16 v[104:107], v[76:79], a[216:219], v[104:107]
ds_read_b128 v[68:71], v2 offset:21504
v_rcp_f32 v210, v210
v_mfma_f32_16x16x32_bf16 v[108:111], v[72:75], a[204:207], v[108:111]
v_mul_f32 v209, v209, v208
v_mul_f32 v211, v211, v210
v_mfma_f32_16x16x32_bf16 v[108:111], v[76:79], a[220:223], v[108:111]
v_cvt_pk_bf16_f32 v184, v209, v211
s_waitcnt lgkmcnt(4)
v_mfma_f32_16x16x32_bf16 v[80:83], v[48:51], a[224:227], v[80:83]
v_mul_f32 v212, v122, v122
v_mul_f32 v214, v123, v123
v_mfma_f32_16x16x32_bf16 v[80:83], v[52:55], a[240:243], v[80:83]
v_fma_f32 v212, v212, v241, v240
v_fma_f32 v214, v214, v241, v240
v_mfma_f32_16x16x32_bf16 v[84:87], v[48:51], a[228:231], v[84:87]
ds_read_b128 v[72:75], v2 offset:22528
v_mul_f32 v212, v212, v122
v_mfma_f32_16x16x32_bf16 v[84:87], v[52:55], a[244:247], v[84:87]
v_mul_f32 v214, v214, v123
v_exp_f32 v212, v212
v_mfma_f32_16x16x32_bf16 v[88:91], v[48:51], a[232:235], v[88:91]
v_exp_f32 v214, v214
v_mfma_f32_16x16x32_bf16 v[88:91], v[52:55], a[248:251], v[88:91]
ds_read_b128 v[76:79], v2 offset:23552
v_mul_f32 v213, v122, v138
v_mfma_f32_16x16x32_bf16 v[92:95], v[48:51], a[236:239], v[92:95]
v_mul_f32 v215, v123, v139
v_fma_f32 v212, v212, v242, v242
v_mfma_f32_16x16x32_bf16 v[92:95], v[52:55], a[252:255], v[92:95]
v_fma_f32 v214, v214, v242, v242
s_waitcnt lgkmcnt(4)
v_mfma_f32_16x16x32_bf16 v[96:99], v[56:59], a[224:227], v[96:99]
s_waitcnt vmcnt(20)
v_rcp_f32 v212, v212
v_mfma_f32_16x16x32_bf16 v[96:99], v[60:63], a[240:243], v[96:99]
s_barrier
v_mfma_f32_16x16x32_bf16 v[100:103], v[56:59], a[228:231], v[100:103]
ds_read_b128 v[48:51], v2 offset:24576
s_add_u32 m0, s22, 122880
v_rcp_f32 v214, v214
v_mfma_f32_16x16x32_bf16 v[100:103], v[60:63], a[244:247], v[100:103]
v_add_u32 v3, 20480, v3
buffer_load_dwordx4 v3, s[8:11], 0 offen offset:0 sc1 lds
v_mul_f32 v213, v213, v212
v_mfma_f32_16x16x32_bf16 v[104:107], v[56:59], a[232:235], v[104:107]
v_mul_f32 v215, v215, v214
v_cvt_pk_bf16_f32 v185, v213, v215
v_mfma_f32_16x16x32_bf16 v[104:107], v[60:63], a[248:251], v[104:107]
ds_read_b128 v[52:55], v2 offset:25600
v_mul_f32 v208, v124, v124
v_mfma_f32_16x16x32_bf16 v[108:111], v[56:59], a[236:239], v[108:111]
v_mul_f32 v210, v125, v125
v_fma_f32 v208, v208, v245, v244
v_mfma_f32_16x16x32_bf16 v[108:111], v[60:63], a[252:255], v[108:111]
v_fma_f32 v210, v210, v245, v244
s_waitcnt lgkmcnt(4)
v_mfma_f32_16x16x32_bf16 v[80:83], v[64:67], v[16:19], v[80:83]
buffer_load_dwordx4 v3, s[8:11], 0 offen offset:1024 sc1 lds
v_mul_f32 v208, v208, v124
v_mfma_f32_16x16x32_bf16 v[80:83], v[68:71], v[32:35], v[80:83]
v_mul_f32 v210, v210, v125
v_exp_f32 v208, v208
v_mfma_f32_16x16x32_bf16 v[84:87], v[64:67], v[20:23], v[84:87]
ds_read_b128 v[56:59], v2 offset:26624
v_exp_f32 v210, v210
v_mfma_f32_16x16x32_bf16 v[84:87], v[68:71], v[36:39], v[84:87]
v_mul_f32 v209, v124, v140
v_mul_f32 v211, v125, v141
v_mfma_f32_16x16x32_bf16 v[88:91], v[64:67], v[24:27], v[88:91]
v_fma_f32 v208, v208, v246, v246
v_fma_f32 v210, v210, v246, v246
v_mfma_f32_16x16x32_bf16 v[88:91], v[68:71], v[40:43], v[88:91]
ds_read_b128 v[60:63], v2 offset:27648
v_rcp_f32 v208, v208
v_mfma_f32_16x16x32_bf16 v[92:95], v[64:67], v[28:31], v[92:95]
buffer_load_dwordx4 v3, s[8:11], 0 offen offset:2048 sc1 lds
v_rcp_f32 v210, v210
L_hop6:
s_cmp_lg_u32 s15, 0
s_cbranch_scc1 L_hop10
v_mfma_f32_16x16x32_bf16 v[92:95], v[68:71], v[44:47], v[92:95]
v_mul_f32 v209, v209, v208
s_waitcnt lgkmcnt(4)
v_mfma_f32_16x16x32_bf16 v[96:99], v[72:75], v[16:19], v[96:99]
v_mul_f32 v211, v211, v210
v_cvt_pk_bf16_f32 v188, v209, v211
v_mfma_f32_16x16x32_bf16 v[96:99], v[76:79], v[32:35], v[96:99]
v_mul_f32 v212, v126, v126
v_mul_f32 v214, v127, v127
v_mfma_f32_16x16x32_bf16 v[100:103], v[72:75], v[20:23], v[100:103]
ds_read_b128 v[64:67], v2 offset:28672
v_fma_f32 v212, v212, v245, v244
v_mfma_f32_16x16x32_bf16 v[100:103], v[76:79], v[36:39], v[100:103]
buffer_load_dwordx4 v3, s[8:11], 0 offen offset:3072 sc1 lds
v_fma_f32 v214, v214, v245, v244
v_mfma_f32_16x16x32_bf16 v[104:107], v[72:75], v[24:27], v[104:107]
s_add_u32 m0, s22, 126976
v_add_u32 v3, 4096, v3
v_mul_f32 v212, v212, v126
v_mfma_f32_16x16x32_bf16 v[104:107], v[76:79], v[40:43], v[104:107]
ds_read_b128 v[68:71], v2 offset:29696
v_mul_f32 v214, v214, v127
v_mfma_f32_16x16x32_bf16 v[108:111], v[72:75], v[28:31], v[108:111]
v_exp_f32 v212, v212
v_mfma_f32_16x16x32_bf16 v[108:111], v[76:79], v[44:47], v[108:111]
v_exp_f32 v214, v214
v_mul_f32 v213, v126, v142
v_mul_f32 v215, v127, v143
v_fma_f32 v212, v212, v246, v246
v_fma_f32 v214, v214, v246, v246
v_rcp_f32 v212, v212
v_rcp_f32 v214, v214
v_mul_f32 v213, v213, v212
v_mul_f32 v215, v215, v214
v_cvt_pk_bf16_f32 v189, v213, v215
s_waitcnt lgkmcnt(4)
v_mfma_f32_16x16x32_bf16 v[112:115], v[48:51], a[0:3], 0
buffer_load_dwordx4 v3, s[8:11], 0 offen offset:0 sc1 lds
v_mfma_f32_16x16x32_bf16 v[112:115], v[52:55], a[16:19], v[112:115]
v_mfma_f32_16x16x32_bf16 v[116:119], v[48:51], a[4:7], 0
ds_read_b128 v[72:75], v2 offset:30720
v_mfma_f32_16x16x32_bf16 v[116:119], v[52:55], a[20:23], v[116:119]
buffer_store_dwordx4 v[160:163], v2, s[8:11], s24 offen offset:1024 sc1
v_mfma_f32_16x16x32_bf16 v[120:123], v[48:51], a[8:11], 0
v_mul_f32 v208, v80, v80
v_mul_f32 v210, v81, v81
v_mfma_f32_16x16x32_bf16 v[120:123], v[52:55], a[24:27], v[120:123]
ds_read_b128 v[76:79], v2 offset:31744
v_fma_f32 v208, v208, v233, v232
v_mfma_f32_16x16x32_bf16 v[124:127], v[48:51], a[12:15], 0
buffer_store_dwordx4 v[164:167], v4, s[8:11], s24 offen offset:1024 sc1
v_mfma_f32_16x16x32_bf16 v[124:127], v[52:55], a[28:31], v[124:127]
v_fma_f32 v210, v210, v233, v232
s_waitcnt lgkmcnt(4)
v_mfma_f32_16x16x32_bf16 v[128:131], v[56:59], a[0:3], 0
buffer_store_dwordx4 v[168:171], v5, s[8:11], s24 offen offset:1024 sc1
v_mfma_f32_16x16x32_bf16 v[128:131], v[60:63], a[16:19], v[128:131]
v_mul_f32 v208, v208, v80
v_mul_f32 v210, v210, v81
v_mfma_f32_16x16x32_bf16 v[132:135], v[56:59], a[4:7], 0
ds_read_b128 v[48:51], v2 offset:32768
v_mul_f32 v209, v80, v96
v_mfma_f32_16x16x32_bf16 v[132:135], v[60:63], a[20:23], v[132:135]
buffer_store_dwordx4 v[172:175], v6, s[8:11], s24 offen offset:1024 sc1
v_mfma_f32_16x16x32_bf16 v[136:139], v[56:59], a[8:11], 0
v_exp_f32 v208, v208
v_mfma_f32_16x16x32_bf16 v[136:139], v[60:63], a[24:27], v[136:139]
ds_read_b128 v[52:55], v2 offset:33792
v_mul_f32 v211, v81, v97
v_mfma_f32_16x16x32_bf16 v[140:143], v[56:59], a[12:15], 0
v_exp_f32 v210, v210
v_mfma_f32_16x16x32_bf16 v[140:143], v[60:63], a[28:31], v[140:143]
v_fma_f32 v208, v208, v234, v234
s_waitcnt lgkmcnt(4)
v_mfma_f32_16x16x32_bf16 v[112:115], v[64:67], a[32:35], v[112:115]
buffer_load_dwordx4 v3, s[8:11], 0 offen offset:1024 sc1 lds
v_mfma_f32_16x16x32_bf16 v[112:115], v[68:71], a[48:51], v[112:115]
v_fma_f32 v210, v210, v234, v234
v_mul_f32 v212, v82, v82
v_mfma_f32_16x16x32_bf16 v[116:119], v[64:67], a[36:39], v[116:119]
ds_read_b128 v[56:59], v2 offset:34816
v_mul_f32 v214, v83, v83
v_mfma_f32_16x16x32_bf16 v[116:119], v[68:71], a[52:55], v[116:119]
v_rcp_f32 v208, v208
v_mfma_f32_16x16x32_bf16 v[120:123], v[64:67], a[40:43], v[120:123]
v_rcp_f32 v210, v210
v_mfma_f32_16x16x32_bf16 v[120:123], v[68:71], a[56:59], v[120:123]
ds_read_b128 v[60:63], v2 offset:35840
v_mul_f32 v209, v209, v208
v_mfma_f32_16x16x32_bf16 v[124:127], v[64:67], a[44:47], v[124:127]
v_mul_f32 v211, v211, v210
v_cvt_pk_bf16_f32 v178, v209, v211
v_mfma_f32_16x16x32_bf16 v[124:127], v[68:71], a[60:63], v[124:127]
v_fma_f32 v212, v212, v233, v232
s_waitcnt lgkmcnt(4)
v_mfma_f32_16x16x32_bf16 v[128:131], v[72:75], a[32:35], v[128:131]
v_fma_f32 v214, v214, v233, v232
v_mul_f32 v212, v212, v82
v_mfma_f32_16x16x32_bf16 v[128:131], v[76:79], a[48:51], v[128:131]
v_mul_f32 v214, v214, v83
v_mul_f32 v213, v82, v98
v_mfma_f32_16x16x32_bf16 v[132:135], v[72:75], a[36:39], v[132:135]
ds_read_b128 v[64:67], v2 offset:36864
v_mul_f32 v215, v83, v99
v_mfma_f32_16x16x32_bf16 v[132:135], v[76:79], a[52:55], v[132:135]
v_exp_f32 v212, v212
v_mfma_f32_16x16x32_bf16 v[136:139], v[72:75], a[40:43], v[136:139]
v_exp_f32 v214, v214
v_mfma_f32_16x16x32_bf16 v[136:139], v[76:79], a[56:59], v[136:139]
ds_read_b128 v[68:71], v2 offset:37888
v_fma_f32 v212, v212, v234, v234
v_mfma_f32_16x16x32_bf16 v[140:143], v[72:75], a[44:47], v[140:143]
v_fma_f32 v214, v214, v234, v234
v_mul_f32 v208, v84, v84
v_mfma_f32_16x16x32_bf16 v[140:143], v[76:79], a[60:63], v[140:143]
v_mul_f32 v210, v85, v85
s_waitcnt lgkmcnt(4)
v_mfma_f32_16x16x32_bf16 v[112:115], v[48:51], a[64:67], v[112:115]
v_rcp_f32 v212, v212
v_mfma_f32_16x16x32_bf16 v[112:115], v[52:55], a[80:83], v[112:115]
v_rcp_f32 v214, v214
v_mfma_f32_16x16x32_bf16 v[116:119], v[48:51], a[68:71], v[116:119]
ds_read_b128 v[72:75], v2 offset:38912
v_mul_f32 v213, v213, v212
v_mfma_f32_16x16x32_bf16 v[116:119], v[52:55], a[84:87], v[116:119]
v_mul_f32 v215, v215, v214
v_cvt_pk_bf16_f32 v179, v213, v215
v_mfma_f32_16x16x32_bf16 v[120:123], v[48:51], a[72:75], v[120:123]
buffer_store_dwordx4 v[176:179], v2, s[8:11], s24 offen offset:2048 sc1
v_mfma_f32_16x16x32_bf16 v[120:123], v[52:55], a[88:91], v[120:123]
ds_read_b128 v[76:79], v2 offset:39936
v_fma_f32 v208, v208, v237, v236
v_mfma_f32_16x16x32_bf16 v[124:127], v[48:51], a[76:79], v[124:127]
v_fma_f32 v210, v210, v237, v236
v_mul_f32 v208, v208, v84
v_mfma_f32_16x16x32_bf16 v[124:127], v[52:55], a[92:95], v[124:127]
v_mul_f32 v210, v210, v85
s_waitcnt lgkmcnt(4)
v_mfma_f32_16x16x32_bf16 v[128:131], v[56:59], a[64:67], v[128:131]
v_exp_f32 v208, v208
v_mfma_f32_16x16x32_bf16 v[128:131], v[60:63], a[80:83], v[128:131]
v_exp_f32 v210, v210
v_mfma_f32_16x16x32_bf16 v[132:135], v[56:59], a[68:71], v[132:135]
ds_read_b128 v[48:51], v2 offset:40960
v_mul_f32 v209, v84, v100
v_mfma_f32_16x16x32_bf16 v[132:135], v[60:63], a[84:87], v[132:135]
v_mul_f32 v211, v85, v101
v_fma_f32 v208, v208, v238, v238
v_mfma_f32_16x16x32_bf16 v[136:139], v[56:59], a[72:75], v[136:139]
v_fma_f32 v210, v210, v238, v238
v_mul_f32 v212, v86, v86
v_mfma_f32_16x16x32_bf16 v[136:139], v[60:63], a[88:91], v[136:139]
ds_read_b128 v[52:55], v2 offset:41984
v_mul_f32 v214, v87, v87
v_mfma_f32_16x16x32_bf16 v[140:143], v[56:59], a[76:79], v[140:143]
v_rcp_f32 v208, v208
v_mfma_f32_16x16x32_bf16 v[140:143], v[60:63], a[92:95], v[140:143]
v_mul_f32 v209, v209, v208
s_waitcnt lgkmcnt(4)
v_mfma_f32_16x16x32_bf16 v[112:115], v[64:67], a[96:99], v[112:115]
v_rcp_f32 v210, v210
v_mfma_f32_16x16x32_bf16 v[112:115], v[68:71], a[112:115], v[112:115]
v_mul_f32 v211, v211, v210
v_cvt_pk_bf16_f32 v182, v209, v211
v_mfma_f32_16x16x32_bf16 v[116:119], v[64:67], a[100:103], v[116:119]
ds_read_b128 v[56:59], v2 offset:43008
v_fma_f32 v212, v212, v237, v236
v_mfma_f32_16x16x32_bf16 v[116:119], v[68:71], a[116:119], v[116:119]
v_fma_f32 v214, v214, v237, v236
v_mul_f32 v212, v212, v86
v_mfma_f32_16x16x32_bf16 v[120:123], v[64:67], a[104:107], v[120:123]
v_mul_f32 v214, v214, v87
v_mul_f32 v213, v86, v102
v_mfma_f32_16x16x32_bf16 v[120:123], v[68:71], a[120:123], v[120:123]
ds_read_b128 v[60:63], v2 offset:44032
v_mul_f32 v215, v87, v103
v_mfma_f32_16x16x32_bf16 v[124:127], v[64:67], a[108:111], v[124:127]
v_exp_f32 v212, v212
v_mfma_f32_16x16x32_bf16 v[124:127], v[68:71], a[124:127], v[124:127]
v_fma_f32 v212, v212, v238, v238
s_waitcnt lgkmcnt(4)
v_mfma_f32_16x16x32_bf16 v[128:131], v[72:75], a[96:99], v[128:131]
v_exp_f32 v214, v214
v_mfma_f32_16x16x32_bf16 v[128:131], v[76:79], a[112:115], v[128:131]
v_fma_f32 v214, v214, v238, v238
v_mul_f32 v208, v88, v88
v_mfma_f32_16x16x32_bf16 v[132:135], v[72:75], a[100:103], v[132:135]
ds_read_b128 v[64:67], v2 offset:45056
v_mul_f32 v210, v89, v89
v_mfma_f32_16x16x32_bf16 v[132:135], v[76:79], a[116:119], v[132:135]
v_rcp_f32 v212, v212
v_mfma_f32_16x16x32_bf16 v[136:139], v[72:75], a[104:107], v[136:139]
v_rcp_f32 v214, v214
v_mfma_f32_16x16x32_bf16 v[136:139], v[76:79], a[120:123], v[136:139]
ds_read_b128 v[68:71], v2 offset:46080
v_mul_f32 v213, v213, v212
v_mfma_f32_16x16x32_bf16 v[140:143], v[72:75], a[108:111], v[140:143]
v_mul_f32 v215, v215, v214
v_cvt_pk_bf16_f32 v183, v213, v215
v_mfma_f32_16x16x32_bf16 v[140:143], v[76:79], a[124:127], v[140:143]
v_fma_f32 v208, v208, v241, v240
s_waitcnt lgkmcnt(4)
v_mfma_f32_16x16x32_bf16 v[112:115], v[48:51], a[128:131], v[112:115]
buffer_store_dwordx4 v[180:183], v4, s[8:11], s24 offen offset:2048 sc1
v_mfma_f32_16x16x32_bf16 v[112:115], v[52:55], a[144:147], v[112:115]
v_fma_f32 v210, v210, v241, v240
v_mul_f32 v208, v208, v88
v_mfma_f32_16x16x32_bf16 v[116:119], v[48:51], a[132:135], v[116:119]
ds_read_b128 v[72:75], v2 offset:47104
v_mul_f32 v210, v210, v89
v_mfma_f32_16x16x32_bf16 v[116:119], v[52:55], a[148:151], v[116:119]
v_exp_f32 v208, v208
v_mfma_f32_16x16x32_bf16 v[120:123], v[48:51], a[136:139], v[120:123]
v_exp_f32 v210, v210
v_mfma_f32_16x16x32_bf16 v[120:123], v[52:55], a[152:155], v[120:123]
ds_read_b128 v[76:79], v2 offset:48128
v_mul_f32 v209, v88, v104
v_mfma_f32_16x16x32_bf16 v[124:127], v[48:51], a[140:143], v[124:127]
v_mul_f32 v211, v89, v105
v_fma_f32 v208, v208, v242, v242
v_mfma_f32_16x16x32_bf16 v[124:127], v[52:55], a[156:159], v[124:127]
v_fma_f32 v210, v210, v242, v242
s_waitcnt lgkmcnt(4)
v_mfma_f32_16x16x32_bf16 v[128:131], v[56:59], a[128:131], v[128:131]
s_waitcnt vmcnt(24)
v_mul_f32 v212, v90, v90
v_mfma_f32_16x16x32_bf16 v[128:131], v[60:63], a[144:147], v[128:131]
s_barrier
v_mfma_f32_16x16x32_bf16 v[132:135], v[56:59], a[132:135], v[132:135]
ds_read_b128 v[48:51], v2 offset:49152
s_add_u32 m0, s22, 0
v_mfma_f32_16x16x32_bf16 v[132:135], v[60:63], a[148:151], v[132:135]
v_add_u32 v3, 20480, v3
buffer_load_dwordx4 v3, s[8:11], 0 offen offset:0 sc1 lds
v_mfma_f32_16x16x32_bf16 v[136:139], v[56:59], a[136:139], v[136:139]
v_rcp_f32 v208, v208
v_mfma_f32_16x16x32_bf16 v[136:139], v[60:63], a[152:155], v[136:139]
ds_read_b128 v[52:55], v2 offset:50176
v_mul_f32 v209, v209, v208
v_mfma_f32_16x16x32_bf16 v[140:143], v[56:59], a[140:143], v[140:143]
v_rcp_f32 v210, v210
v_mfma_f32_16x16x32_bf16 v[140:143], v[60:63], a[156:159], v[140:143]
v_mul_f32 v211, v211, v210
s_waitcnt lgkmcnt(4)
v_mfma_f32_16x16x32_bf16 v[112:115], v[64:67], a[160:163], v[112:115]
buffer_load_dwordx4 v3, s[8:11], 0 offen offset:1024 sc1 lds
v_mfma_f32_16x16x32_bf16 v[112:115], v[68:71], a[176:179], v[112:115]
v_cvt_pk_bf16_f32 v186, v209, v211
v_mul_f32 v214, v91, v91
v_mfma_f32_16x16x32_bf16 v[116:119], v[64:67], a[164:167], v[116:119]
ds_read_b128 v[56:59], v2 offset:51200
v_fma_f32 v212, v212, v241, v240
v_mfma_f32_16x16x32_bf16 v[116:119], v[68:71], a[180:183], v[116:119]
v_fma_f32 v214, v214, v241, v240
v_mul_f32 v212, v212, v90
v_mfma_f32_16x16x32_bf16 v[120:123], v[64:67], a[168:171], v[120:123]
v_mul_f32 v214, v214, v91
v_mul_f32 v213, v90, v106
v_mfma_f32_16x16x32_bf16 v[120:123], v[68:71], a[184:187], v[120:123]
ds_read_b128 v[60:63], v2 offset:52224
v_mul_f32 v215, v91, v107
v_mfma_f32_16x16x32_bf16 v[124:127], v[64:67], a[172:175], v[124:127]
buffer_load_dwordx4 v3, s[8:11], 0 offen offset:2048 sc1 lds
v_mfma_f32_16x16x32_bf16 v[124:127], v[68:71], a[188:191], v[124:127]
v_mul_f32 v208, v92, v92
s_waitcnt lgkmcnt(4)
v_mfma_f32_16x16x32_bf16 v[128:131], v[72:75], a[160:163], v[128:131]
v_exp_f32 v212, v212
v_mfma_f32_16x16x32_bf16 v[128:131], v[76:79], a[176:179], v[128:131]
v_exp_f32 v214, v214
v_mfma_f32_16x16x32_bf16 v[132:135], v[72:75], a[164:167], v[132:135]
ds_read_b128 v[64:67], v2 offset:53248
v_fma_f32 v212, v212, v242, v242
v_mfma_f32_16x16x32_bf16 v[132:135], v[76:79], a[180:183], v[132:135]
buffer_load_dwordx4 v3, s[8:11], 0 offen offset:3072 sc1 lds
v_mfma_f32_16x16x32_bf16 v[136:139], v[72:75], a[168:171], v[136:139]
s_add_u32 m0, s22, 4096
v_add_u32 v3, 4096, v3
v_mfma_f32_16x16x32_bf16 v[136:139], v[76:79], a[184:187], v[136:139]
ds_read_b128 v[68:71], v2 offset:54272
v_fma_f32 v214, v214, v242, v242
v_mfma_f32_16x16x32_bf16 v[140:143], v[72:75], a[172:175], v[140:143]
v_rcp_f32 v212, v212
v_mfma_f32_16x16x32_bf16 v[140:143], v[76:79], a[188:191], v[140:143]
v_mul_f32 v213, v213, v212
s_waitcnt lgkmcnt(4)
v_mfma_f32_16x16x32_bf16 v[112:115], v[48:51], a[192:195], v[112:115]
buffer_load_dwordx4 v3, s[8:11], 0 offen offset:0 sc1 lds
v_mfma_f32_16x16x32_bf16 v[112:115], v[52:55], a[208:211], v[112:115]
v_rcp_f32 v214, v214
v_mfma_f32_16x16x32_bf16 v[116:119], v[48:51], a[196:199], v[116:119]
ds_read_b128 v[72:75], v2 offset:55296
v_mul_f32 v215, v215, v214
v_mfma_f32_16x16x32_bf16 v[116:119], v[52:55], a[212:215], v[116:119]
v_cvt_pk_bf16_f32 v187, v213, v215
v_mul_f32 v210, v93, v93
v_mfma_f32_16x16x32_bf16 v[120:123], v[48:51], a[200:203], v[120:123]
buffer_store_dwordx4 v[184:187], v5, s[8:11], s24 offen offset:2048 sc1
v_mfma_f32_16x16x32_bf16 v[120:123], v[52:55], a[216:219], v[120:123]
ds_read_b128 v[76:79], v2 offset:56320
v_fma_f32 v208, v208, v245, v244
v_mfma_f32_16x16x32_bf16 v[124:127], v[48:51], a[204:207], v[124:127]
v_fma_f32 v210, v210, v245, v244
v_mul_f32 v208, v208, v92
v_mfma_f32_16x16x32_bf16 v[124:127], v[52:55], a[220:223], v[124:127]
v_mul_f32 v210, v210, v93
s_waitcnt lgkmcnt(4)
v_mfma_f32_16x16x32_bf16 v[128:131], v[56:59], a[192:195], v[128:131]
v_exp_f32 v208, v208
v_mfma_f32_16x16x32_bf16 v[128:131], v[60:63], a[208:211], v[128:131]
buffer_load_dwordx4 v3, s[8:11], 0 offen offset:1024 sc1 lds
v_mfma_f32_16x16x32_bf16 v[132:135], v[56:59], a[196:199], v[132:135]
ds_read_b128 v[48:51], v2 offset:57344
v_mul_f32 v209, v92, v108
v_mfma_f32_16x16x32_bf16 v[132:135], v[60:63], a[212:215], v[132:135]
v_exp_f32 v210, v210
v_mfma_f32_16x16x32_bf16 v[136:139], v[56:59], a[200:203], v[136:139]
v_mul_f32 v211, v93, v109
v_fma_f32 v208, v208, v246, v246
v_mfma_f32_16x16x32_bf16 v[136:139], v[60:63], a[216:219], v[136:139]
ds_read_b128 v[52:55], v2 offset:58368
v_fma_f32 v210, v210, v246, v246
v_mfma_f32_16x16x32_bf16 v[140:143], v[56:59], a[204:207], v[140:143]
v_rcp_f32 v208, v208
v_mfma_f32_16x16x32_bf16 v[140:143], v[60:63], a[220:223], v[140:143]
v_mul_f32 v209, v209, v208
s_waitcnt lgkmcnt(4)
v_mfma_f32_16x16x32_bf16 v[112:115], v[64:67], a[224:227], v[112:115]
v_rcp_f32 v210, v210
v_mfma_f32_16x16x32_bf16 v[112:115], v[68:71], a[240:243], v[112:115]
v_mul_f32 v211, v211, v210
v_cvt_pk_bf16_f32 v190, v209, v211
v_mfma_f32_16x16x32_bf16 v[116:119], v[64:67], a[228:231], v[116:119]
ds_read_b128 v[56:59], v2 offset:59392
v_mul_f32 v212, v94, v94
v_mfma_f32_16x16x32_bf16 v[116:119], v[68:71], a[244:247], v[116:119]
v_mul_f32 v214, v95, v95
v_fma_f32 v212, v212, v245, v244
v_mfma_f32_16x16x32_bf16 v[120:123], v[64:67], a[232:235], v[120:123]
v_fma_f32 v214, v214, v245, v244
v_mul_f32 v212, v212, v94
v_mfma_f32_16x16x32_bf16 v[120:123], v[68:71], a[248:251], v[120:123]
ds_read_b128 v[60:63], v2 offset:60416
v_mul_f32 v214, v214, v95
v_mfma_f32_16x16x32_bf16 v[124:127], v[64:67], a[236:239], v[124:127]
v_exp_f32 v212, v212
v_mfma_f32_16x16x32_bf16 v[124:127], v[68:71], a[252:255], v[124:127]
v_mul_f32 v213, v94, v110
s_waitcnt lgkmcnt(4)
v_mfma_f32_16x16x32_bf16 v[128:131], v[72:75], a[224:227], v[128:131]
v_exp_f32 v214, v214
v_mfma_f32_16x16x32_bf16 v[128:131], v[76:79], a[240:243], v[128:131]
v_mul_f32 v215, v95, v111
v_fma_f32 v212, v212, v246, v246
v_mfma_f32_16x16x32_bf16 v[132:135], v[72:75], a[228:231], v[132:135]
ds_read_b128 v[64:67], v2 offset:61440
v_fma_f32 v214, v214, v246, v246
v_mfma_f32_16x16x32_bf16 v[132:135], v[76:79], a[244:247], v[132:135]
v_rcp_f32 v212, v212
v_mfma_f32_16x16x32_bf16 v[136:139], v[72:75], a[232:235], v[136:139]
v_rcp_f32 v214, v214
v_mfma_f32_16x16x32_bf16 v[136:139], v[76:79], a[248:251], v[136:139]
ds_read_b128 v[68:71], v2 offset:62464
v_mul_f32 v213, v213, v212
v_mfma_f32_16x16x32_bf16 v[140:143], v[72:75], a[236:239], v[140:143]
v_mul_f32 v215, v215, v214
v_cvt_pk_bf16_f32 v191, v213, v215
v_mfma_f32_16x16x32_bf16 v[140:143], v[76:79], a[252:255], v[140:143]
s_waitcnt lgkmcnt(4)
v_mfma_f32_16x16x32_bf16 v[112:115], v[48:51], v[16:19], v[112:115]
buffer_store_dwordx4 v[188:191], v6, s[8:11], s24 offen offset:2048 sc1
v_mfma_f32_16x16x32_bf16 v[112:115], v[52:55], v[32:35], v[112:115]
v_mfma_f32_16x16x32_bf16 v[116:119], v[48:51], v[20:23], v[116:119]
ds_read_b128 v[72:75], v2 offset:63488
v_mfma_f32_16x16x32_bf16 v[116:119], v[52:55], v[36:39], v[116:119]
v_mfma_f32_16x16x32_bf16 v[120:123], v[48:51], v[24:27], v[120:123]
v_mfma_f32_16x16x32_bf16 v[120:123], v[52:55], v[40:43], v[120:123]
ds_read_b128 v[76:79], v2 offset:64512
v_mfma_f32_16x16x32_bf16 v[124:127], v[48:51], v[28:31], v[124:127]
v_mfma_f32_16x16x32_bf16 v[124:127], v[52:55], v[44:47], v[124:127]
s_waitcnt lgkmcnt(4)
v_mfma_f32_16x16x32_bf16 v[128:131], v[56:59], v[16:19], v[128:131]
v_mfma_f32_16x16x32_bf16 v[128:131], v[60:63], v[32:35], v[128:131]
v_mfma_f32_16x16x32_bf16 v[132:135], v[56:59], v[20:23], v[132:135]
ds_read_b128 v[48:51], v7 offset:0
v_mfma_f32_16x16x32_bf16 v[132:135], v[60:63], v[36:39], v[132:135]
v_mfma_f32_16x16x32_bf16 v[136:139], v[56:59], v[24:27], v[136:139]
v_mfma_f32_16x16x32_bf16 v[136:139], v[60:63], v[40:43], v[136:139]
ds_read_b128 v[52:55], v7 offset:1024
v_mfma_f32_16x16x32_bf16 v[140:143], v[56:59], v[28:31], v[140:143]
v_mfma_f32_16x16x32_bf16 v[140:143], v[60:63], v[44:47], v[140:143]
s_waitcnt lgkmcnt(4)
v_mfma_f32_16x16x32_bf16 v[80:83], v[64:67], a[0:3], 0
v_mfma_f32_16x16x32_bf16 v[80:83], v[68:71], a[16:19], v[80:83]
v_mfma_f32_16x16x32_bf16 v[84:87], v[64:67], a[4:7], 0
ds_read_b128 v[56:59], v7 offset:2048
v_mfma_f32_16x16x32_bf16 v[84:87], v[68:71], a[20:23], v[84:87]
v_mul_f32 v208, v112, v112
v_mul_f32 v210, v113, v113
v_mfma_f32_16x16x32_bf16 v[88:91], v[64:67], a[8:11], 0
v_fma_f32 v208, v208, v233, v232
v_fma_f32 v210, v210, v233, v232
v_mfma_f32_16x16x32_bf16 v[88:91], v[68:71], a[24:27], v[88:91]
ds_read_b128 v[60:63], v7 offset:3072
v_mul_f32 v208, v208, v112
v_mfma_f32_16x16x32_bf16 v[92:95], v[64:67], a[12:15], 0
v_mul_f32 v210, v210, v113
v_mul_f32 v209, v112, v128
v_mfma_f32_16x16x32_bf16 v[92:95], v[68:71], a[28:31], v[92:95]
v_mul_f32 v211, v113, v129
s_waitcnt lgkmcnt(4)
v_mfma_f32_16x16x32_bf16 v[96:99], v[72:75], a[0:3], 0
v_exp_f32 v208, v208
v_mfma_f32_16x16x32_bf16 v[96:99], v[76:79], a[16:19], v[96:99]
v_exp_f32 v210, v210
v_mfma_f32_16x16x32_bf16 v[100:103], v[72:75], a[4:7], 0
ds_read_b128 v[64:67], v7 offset:4096
v_fma_f32 v208, v208, v234, v234
v_mfma_f32_16x16x32_bf16 v[100:103], v[76:79], a[20:23], v[100:103]
v_fma_f32 v210, v210, v234, v234
v_mul_f32 v212, v114, v114
v_mfma_f32_16x16x32_bf16 v[104:107], v[72:75], a[8:11], 0
v_rcp_f32 v208, v208
v_mfma_f32_16x16x32_bf16 v[104:107], v[76:79], a[24:27], v[104:107]
ds_read_b128 v[68:71], v7 offset:5120
v_mul_f32 v209, v209, v208
v_mfma_f32_16x16x32_bf16 v[108:111], v[72:75], a[12:15], 0
v_rcp_f32 v210, v210
v_mfma_f32_16x16x32_bf16 v[108:111], v[76:79], a[28:31], v[108:111]
v_mul_f32 v211, v211, v210
s_waitcnt lgkmcnt(4)
v_mfma_f32_16x16x32_bf16 v[80:83], v[48:51], a[32:35], v[80:83]
v_cvt_pk_bf16_f32 v192, v209, v211
v_mul_f32 v214, v115, v115
v_mfma_f32_16x16x32_bf16 v[80:83], v[52:55], a[48:51], v[80:83]
v_fma_f32 v212, v212, v233, v232
v_fma_f32 v214, v214, v233, v232
v_mfma_f32_16x16x32_bf16 v[84:87], v[48:51], a[36:39], v[84:87]
ds_read_b128 v[72:75], v7 offset:6144
v_mul_f32 v212, v212, v114
v_mfma_f32_16x16x32_bf16 v[84:87], v[52:55], a[52:55], v[84:87]
v_mul_f32 v214, v214, v115
v_mul_f32 v213, v114, v130
v_mfma_f32_16x16x32_bf16 v[88:91], v[48:51], a[40:43], v[88:91]
v_exp_f32 v212, v212
v_mfma_f32_16x16x32_bf16 v[88:91], v[52:55], a[56:59], v[88:91]
ds_read_b128 v[76:79], v7 offset:7168
v_mul_f32 v215, v115, v131
v_mfma_f32_16x16x32_bf16 v[92:95], v[48:51], a[44:47], v[92:95]
v_exp_f32 v214, v214
v_mfma_f32_16x16x32_bf16 v[92:95], v[52:55], a[60:63], v[92:95]
v_fma_f32 v212, v212, v234, v234
s_waitcnt lgkmcnt(4)
v_mfma_f32_16x16x32_bf16 v[96:99], v[56:59], a[32:35], v[96:99]
s_waitcnt vmcnt(26)
v_fma_f32 v214, v214, v234, v234
v_mfma_f32_16x16x32_bf16 v[96:99], v[60:63], a[48:51], v[96:99]
s_barrier
v_mfma_f32_16x16x32_bf16 v[100:103], v[56:59], a[36:39], v[100:103]
ds_read_b128 v[48:51], v7 offset:8192
s_add_u32 m0, s22, 24576
v_mfma_f32_16x16x32_bf16 v[100:103], v[60:63], a[52:55], v[100:103]
v_add_u32 v3, 20480, v3
buffer_load_dwordx4 v3, s[8:11], 0 offen offset:0 sc1 lds
v_mfma_f32_16x16x32_bf16 v[104:107], v[56:59], a[40:43], v[104:107]
v_rcp_f32 v212, v212
v_mfma_f32_16x16x32_bf16 v[104:107], v[60:63], a[56:59], v[104:107]
ds_read_b128 v[52:55], v7 offset:9216
v_mul_f32 v213, v213, v212
v_mfma_f32_16x16x32_bf16 v[108:111], v[56:59], a[44:47], v[108:111]
v_rcp_f32 v214, v214
v_mfma_f32_16x16x32_bf16 v[108:111], v[60:63], a[60:63], v[108:111]
v_mul_f32 v215, v215, v214
s_waitcnt lgkmcnt(4)
v_mfma_f32_16x16x32_bf16 v[80:83], v[64:67], a[64:67], v[80:83]
buffer_load_dwordx4 v3, s[8:11], 0 offen offset:1024 sc1 lds
v_mfma_f32_16x16x32_bf16 v[80:83], v[68:71], a[80:83], v[80:83]
v_cvt_pk_bf16_f32 v193, v213, v215
v_mul_f32 v208, v116, v116
v_mfma_f32_16x16x32_bf16 v[84:87], v[64:67], a[68:71], v[84:87]
ds_read_b128 v[56:59], v7 offset:10240
v_mul_f32 v210, v117, v117
v_mfma_f32_16x16x32_bf16 v[84:87], v[68:71], a[84:87], v[84:87]
v_fma_f32 v208, v208, v237, v236
v_fma_f32 v210, v210, v237, v236
v_mfma_f32_16x16x32_bf16 v[88:91], v[64:67], a[72:75], v[88:91]
v_mul_f32 v208, v208, v116
v_mul_f32 v210, v210, v117
v_mfma_f32_16x16x32_bf16 v[88:91], v[68:71], a[88:91], v[88:91]
ds_read_b128 v[60:63], v7 offset:11264
v_mul_f32 v209, v116, v132
v_mfma_f32_16x16x32_bf16 v[92:95], v[64:67], a[76:79], v[92:95]
buffer_load_dwordx4 v3, s[8:11], 0 offen offset:2048 sc1 lds
v_mfma_f32_16x16x32_bf16 v[92:95], v[68:71], a[92:95], v[92:95]
v_mul_f32 v211, v117, v133
s_waitcnt lgkmcnt(4)
v_mfma_f32_16x16x32_bf16 v[96:99], v[72:75], a[64:67], v[96:99]
v_exp_f32 v208, v208
v_mfma_f32_16x16x32_bf16 v[96:99], v[76:79], a[80:83], v[96:99]
v_exp_f32 v210, v210
v_mfma_f32_16x16x32_bf16 v[100:103], v[72:75], a[68:71], v[100:103]
ds_read_b128 v[64:67], v7 offset:12288
v_fma_f32 v208, v208, v238, v238
v_mfma_f32_16x16x32_bf16 v[100:103], v[76:79], a[84:87], v[100:103]
buffer_load_dwordx4 v3, s[8:11], 0 offen offset:3072 sc1 lds
v_mfma_f32_16x16x32_bf16 v[104:107], v[72:75], a[72:75], v[104:107]
s_add_u32 m0, s22, 28672
v_add_u32 v3, 4096, v3
v_mfma_f32_16x16x32_bf16 v[104:107], v[76:79], a[88:91], v[104:107]
ds_read_b128 v[68:71], v7 offset:13312
v_fma_f32 v210, v210, v238, v238
v_mfma_f32_16x16x32_bf16 v[108:111], v[72:75], a[76:79], v[108:111]
v_rcp_f32 v208, v208
v_mfma_f32_16x16x32_bf16 v[108:111], v[76:79], a[92:95], v[108:111]
v_mul_f32 v209, v209, v208
s_waitcnt lgkmcnt(4)
v_mfma_f32_16x16x32_bf16 v[80:83], v[48:51], a[96:99], v[80:83]
v_mov_b32 v12, s68
v_mov_b32 v13, s69
v_mfma_f32_16x16x32_bf16 v[80:83], v[52:55], a[112:115], v[80:83]
s_add_u32 s53, s34, 0
s_waitcnt vmcnt(4)
buffer_store_dwordx2 v[12:13], v10, s[8:11], s53 offen sc1
v_mfma_f32_16x16x32_bf16 v[84:87], v[48:51], a[100:103], v[84:87]
ds_read_b128 v[72:75], v7 offset:14336
v_mul_f32 v212, v118, v118
v_mfma_f32_16x16x32_bf16 v[84:87], v[52:55], a[116:119], v[84:87]
v_rcp_f32 v210, v210
v_mfma_f32_16x16x32_bf16 v[88:91], v[48:51], a[104:107], v[88:91]
v_mul_f32 v211, v211, v210
v_cvt_pk_bf16_f32 v196, v209, v211
v_mfma_f32_16x16x32_bf16 v[88:91], v[52:55], a[120:123], v[88:91]
ds_read_b128 v[76:79], v7 offset:15360
v_mul_f32 v214, v119, v119
v_mfma_f32_16x16x32_bf16 v[92:95], v[48:51], a[108:111], v[92:95]
buffer_load_dwordx4 v3, s[8:11], 0 offen offset:0 sc1 lds
v_mfma_f32_16x16x32_bf16 v[92:95], v[52:55], a[124:127], v[92:95]
v_fma_f32 v212, v212, v237, v236
s_waitcnt lgkmcnt(4)
v_mfma_f32_16x16x32_bf16 v[96:99], v[56:59], a[96:99], v[96:99]
v_fma_f32 v214, v214, v237, v236
v_mul_f32 v212, v212, v118
v_mfma_f32_16x16x32_bf16 v[96:99], v[60:63], a[112:115], v[96:99]
v_mul_f32 v214, v214, v119
v_mul_f32 v213, v118, v134
v_mfma_f32_16x16x32_bf16 v[100:103], v[56:59], a[100:103], v[100:103]
ds_read_b128 v[48:51], v7 offset:16384
v_mul_f32 v215, v119, v135
v_mfma_f32_16x16x32_bf16 v[100:103], v[60:63], a[116:119], v[100:103]
buffer_load_dwordx4 v3, s[8:11], 0 offen offset:1024 sc1 lds
v_mfma_f32_16x16x32_bf16 v[104:107], v[56:59], a[104:107], v[104:107]
v_exp_f32 v212, v212
v_mfma_f32_16x16x32_bf16 v[104:107], v[60:63], a[120:123], v[104:107]
ds_read_b128 v[52:55], v7 offset:17408
v_fma_f32 v212, v212, v238, v238
v_mfma_f32_16x16x32_bf16 v[108:111], v[56:59], a[108:111], v[108:111]
v_exp_f32 v214, v214
v_mfma_f32_16x16x32_bf16 v[108:111], v[60:63], a[124:127], v[108:111]
v_fma_f32 v214, v214, v238, v238
s_waitcnt lgkmcnt(4)
v_mfma_f32_16x16x32_bf16 v[80:83], v[64:67], a[128:131], v[80:83]
v_rcp_f32 v212, v212
v_mfma_f32_16x16x32_bf16 v[80:83], v[68:71], a[144:147], v[80:83]
v_rcp_f32 v214, v214
v_mfma_f32_16x16x32_bf16 v[84:87], v[64:67], a[132:135], v[84:87]
ds_read_b128 v[56:59], v7 offset:18432
v_mul_f32 v213, v213, v212
v_mfma_f32_16x16x32_bf16 v[84:87], v[68:71], a[148:151], v[84:87]
v_mul_f32 v215, v215, v214
v_cvt_pk_bf16_f32 v197, v213, v215
v_mfma_f32_16x16x32_bf16 v[88:91], v[64:67], a[136:139], v[88:91]
v_mul_f32 v208, v120, v120
v_mul_f32 v210, v121, v121
v_mfma_f32_16x16x32_bf16 v[88:91], v[68:71], a[152:155], v[88:91]
ds_read_b128 v[60:63], v7 offset:19456
v_fma_f32 v208, v208, v241, v240
v_mfma_f32_16x16x32_bf16 v[92:95], v[64:67], a[140:143], v[92:95]
v_fma_f32 v210, v210, v241, v240
v_mul_f32 v208, v208, v120
v_mfma_f32_16x16x32_bf16 v[92:95], v[68:71], a[156:159], v[92:95]
v_mul_f32 v210, v210, v121
s_waitcnt lgkmcnt(4)
v_mfma_f32_16x16x32_bf16 v[96:99], v[72:75], a[128:131], v[96:99]
v_exp_f32 v208, v208
v_mfma_f32_16x16x32_bf16 v[96:99], v[76:79], a[144:147], v[96:99]
v_exp_f32 v210, v210
v_mfma_f32_16x16x32_bf16 v[100:103], v[72:75], a[132:135], v[100:103]
ds_read_b128 v[64:67], v7 offset:20480
v_mul_f32 v209, v120, v136
v_mfma_f32_16x16x32_bf16 v[100:103], v[76:79], a[148:151], v[100:103]
v_mul_f32 v211, v121, v137
v_fma_f32 v208, v208, v242, v242
v_mfma_f32_16x16x32_bf16 v[104:107], v[72:75], a[136:139], v[104:107]
v_fma_f32 v210, v210, v242, v242
v_mul_f32 v212, v122, v122
v_mfma_f32_16x16x32_bf16 v[104:107], v[76:79], a[152:155], v[104:107]
ds_read_b128 v[68:71], v7 offset:21504
v_mul_f32 v214, v123, v123
v_mfma_f32_16x16x32_bf16 v[108:111], v[72:75], a[140:143], v[108:111]
v_rcp_f32 v208, v208
v_mfma_f32_16x16x32_bf16 v[108:111], v[76:79], a[156:159], v[108:111]
s_waitcnt lgkmcnt(4)
v_mfma_f32_16x16x32_bf16 v[80:83], v[48:51], a[160:163], v[80:83]
v_rcp_f32 v210, v210
v_mfma_f32_16x16x32_bf16 v[80:83], v[52:55], a[176:179], v[80:83]
v_mfma_f32_16x16x32_bf16 v[84:87], v[48:51], a[164:167], v[84:87]
ds_read_b128 v[72:75], v7 offset:22528
v_mul_f32 v209, v209, v208
v_mfma_f32_16x16x32_bf16 v[84:87], v[52:55], a[180:183], v[84:87]
v_mul_f32 v211, v211, v210
v_cvt_pk_bf16_f32 v200, v209, v211
v_mfma_f32_16x16x32_bf16 v[88:91], v[48:51], a[168:171], v[88:91]
v_fma_f32 v212, v212, v241, v240
v_fma_f32 v214, v214, v241, v240
v_mfma_f32_16x16x32_bf16 v[88:91], v[52:55], a[184:187], v[88:91]
ds_read_b128 v[76:79], v7 offset:23552
v_mfma_f32_16x16x32_bf16 v[92:95], v[48:51], a[172:175], v[92:95]
L_hop7:
s_cmp_lg_u32 s15, 0
s_cbranch_scc1 L_hop11
v_mul_f32 v212, v212, v122
v_mul_f32 v214, v214, v123
v_mfma_f32_16x16x32_bf16 v[92:95], v[52:55], a[188:191], v[92:95]
s_waitcnt lgkmcnt(4)
v_mfma_f32_16x16x32_bf16 v[96:99], v[56:59], a[160:163], v[96:99]
v_exp_f32 v212, v212
v_mfma_f32_16x16x32_bf16 v[96:99], v[60:63], a[176:179], v[96:99]
v_exp_f32 v214, v214
v_mfma_f32_16x16x32_bf16 v[100:103], v[56:59], a[164:167], v[100:103]
ds_read_b128 v[48:51], v7 offset:24576
v_mfma_f32_16x16x32_bf16 v[100:103], v[60:63], a[180:183], v[100:103]
v_mul_f32 v213, v122, v138
v_mul_f32 v215, v123, v139
v_mfma_f32_16x16x32_bf16 v[104:107], v[56:59], a[168:171], v[104:107]
v_mfma_f32_16x16x32_bf16 v[104:107], v[60:63], a[184:187], v[104:107]
ds_read_b128 v[52:55], v7 offset:25600
v_fma_f32 v212, v212, v242, v242
v_mfma_f32_16x16x32_bf16 v[108:111], v[56:59], a[172:175], v[108:111]
v_fma_f32 v214, v214, v242, v242
v_mul_f32 v208, v124, v124
v_mfma_f32_16x16x32_bf16 v[108:111], v[60:63], a[188:191], v[108:111]
s_waitcnt lgkmcnt(4)
v_mfma_f32_16x16x32_bf16 v[80:83], v[64:67], a[192:195], v[80:83]
s_add_u32 s23, s34, 0
buffer_load_dwordx2 v[14:15], v11, s[8:11], s23 offen sc1
v_mfma_f32_16x16x32_bf16 v[80:83], v[68:71], a[208:211], v[80:83]
v_rcp_f32 v212, v212
v_mfma_f32_16x16x32_bf16 v[84:87], v[64:67], a[196:199], v[84:87]
ds_read_b128 v[56:59], v7 offset:26624
v_mul_f32 v213, v213, v212
v_mfma_f32_16x16x32_bf16 v[84:87], v[68:71], a[212:215], v[84:87]
v_rcp_f32 v214, v214
v_mfma_f32_16x16x32_bf16 v[88:91], v[64:67], a[200:203], v[88:91]
v_mul_f32 v215, v215, v214
v_cvt_pk_bf16_f32 v201, v213, v215
v_mfma_f32_16x16x32_bf16 v[88:91], v[68:71], a[216:219], v[88:91]
ds_read_b128 v[60:63], v7 offset:27648
v_mfma_f32_16x16x32_bf16 v[92:95], v[64:67], a[204:207], v[92:95]
v_mul_f32 v210, v125, v125
v_fma_f32 v208, v208, v245, v244
v_mfma_f32_16x16x32_bf16 v[92:95], v[68:71], a[220:223], v[92:95]
v_fma_f32 v210, v210, v245, v244
s_waitcnt lgkmcnt(4)
v_mfma_f32_16x16x32_bf16 v[96:99], v[72:75], a[192:195], v[96:99]
v_mul_f32 v208, v208, v124
v_mul_f32 v210, v210, v125
v_mfma_f32_16x16x32_bf16 v[96:99], v[76:79], a[208:211], v[96:99]
v_mfma_f32_16x16x32_bf16 v[100:103], v[72:75], a[196:199], v[100:103]
ds_read_b128 v[64:67], v7 offset:28672
v_mul_f32 v209, v124, v140
v_mfma_f32_16x16x32_bf16 v[100:103], v[76:79], a[212:215], v[100:103]
v_exp_f32 v208, v208
v_mfma_f32_16x16x32_bf16 v[104:107], v[72:75], a[200:203], v[104:107]
v_mfma_f32_16x16x32_bf16 v[104:107], v[76:79], a[216:219], v[104:107]
ds_read_b128 v[68:71], v7 offset:29696
v_mul_f32 v211, v125, v141
v_mfma_f32_16x16x32_bf16 v[108:111], v[72:75], a[204:207], v[108:111]
v_exp_f32 v210, v210
v_mfma_f32_16x16x32_bf16 v[108:111], v[76:79], a[220:223], v[108:111]
v_fma_f32 v208, v208, v246, v246
s_waitcnt lgkmcnt(4)
v_mfma_f32_16x16x32_bf16 v[80:83], v[48:51], a[224:227], v[80:83]
v_fma_f32 v210, v210, v246, v246
v_mul_f32 v212, v126, v126
v_mfma_f32_16x16x32_bf16 v[80:83], v[52:55], a[240:243], v[80:83]
v_mfma_f32_16x16x32_bf16 v[84:87], v[48:51], a[228:231], v[84:87]
ds_read_b128 v[72:75], v7 offset:30720
v_mul_f32 v214, v127, v127
v_mfma_f32_16x16x32_bf16 v[84:87], v[52:55], a[244:247], v[84:87]
v_rcp_f32 v208, v208
v_mfma_f32_16x16x32_bf16 v[88:91], v[48:51], a[232:235], v[88:91]
v_rcp_f32 v210, v210
v_mfma_f32_16x16x32_bf16 v[88:91], v[52:55], a[248:251], v[88:91]
ds_read_b128 v[76:79], v7 offset:31744
v_mfma_f32_16x16x32_bf16 v[92:95], v[48:51], a[236:239], v[92:95]
v_mul_f32 v209, v209, v208
v_mul_f32 v211, v211, v210
v_mfma_f32_16x16x32_bf16 v[92:95], v[52:55], a[252:255], v[92:95]
s_waitcnt lgkmcnt(4)
v_mfma_f32_16x16x32_bf16 v[96:99], v[56:59], a[224:227], v[96:99]
s_waitcnt vmcnt(28)
v_cvt_pk_bf16_f32 v204, v209, v211
v_mfma_f32_16x16x32_bf16 v[96:99], v[60:63], a[240:243], v[96:99]
s_barrier
v_mfma_f32_16x16x32_bf16 v[100:103], v[56:59], a[228:231], v[100:103]
ds_read_b128 v[48:51], v7 offset:32768
s_add_u32 m0, s22, 49152
v_mfma_f32_16x16x32_bf16 v[100:103], v[60:63], a[244:247], v[100:103]
v_add_u32 v3, 20480, v3
buffer_load_dwordx4 v3, s[8:11], 0 offen offset:0 sc1 lds
v_mfma_f32_16x16x32_bf16 v[104:107], v[56:59], a[232:235], v[104:107]
v_fma_f32 v212, v212, v245, v244
v_fma_f32 v214, v214, v245, v244
v_mfma_f32_16x16x32_bf16 v[104:107], v[60:63], a[248:251], v[104:107]
ds_read_b128 v[52:55], v7 offset:33792
v_mul_f32 v212, v212, v126
v_mfma_f32_16x16x32_bf16 v[108:111], v[56:59], a[236:239], v[108:111]
v_mul_f32 v214, v214, v127
v_mul_f32 v213, v126, v142
v_mfma_f32_16x16x32_bf16 v[108:111], v[60:63], a[252:255], v[108:111]
v_mul_f32 v215, v127, v143
s_waitcnt lgkmcnt(4)
v_mfma_f32_16x16x32_bf16 v[80:83], v[64:67], v[16:19], v[80:83]
buffer_load_dwordx4 v3, s[8:11], 0 offen offset:1024 sc1 lds
v_mfma_f32_16x16x32_bf16 v[80:83], v[68:71], v[32:35], v[80:83]
v_exp_f32 v212, v212
v_mfma_f32_16x16x32_bf16 v[84:87], v[64:67], v[20:23], v[84:87]
ds_read_b128 v[56:59], v7 offset:34816
v_fma_f32 v212, v212, v246, v246
v_mfma_f32_16x16x32_bf16 v[84:87], v[68:71], v[36:39], v[84:87]
v_exp_f32 v214, v214
v_mfma_f32_16x16x32_bf16 v[88:91], v[64:67], v[24:27], v[88:91]
v_fma_f32 v214, v214, v246, v246
v_mfma_f32_16x16x32_bf16 v[88:91], v[68:71], v[40:43], v[88:91]
ds_read_b128 v[60:63], v7 offset:35840
v_mfma_f32_16x16x32_bf16 v[92:95], v[64:67], v[28:31], v[92:95]
buffer_load_dwordx4 v3, s[8:11], 0 offen offset:2048 sc1 lds
v_mfma_f32_16x16x32_bf16 v[92:95], v[68:71], v[44:47], v[92:95]
s_waitcnt lgkmcnt(4)
v_mfma_f32_16x16x32_bf16 v[96:99], v[72:75], v[16:19], v[96:99]
v_rcp_f32 v212, v212
v_mfma_f32_16x16x32_bf16 v[96:99], v[76:79], v[32:35], v[96:99]
v_rcp_f32 v214, v214
v_mfma_f32_16x16x32_bf16 v[100:103], v[72:75], v[20:23], v[100:103]
ds_read_b128 v[64:67], v7 offset:36864
v_mul_f32 v213, v213, v212
v_mfma_f32_16x16x32_bf16 v[100:103], v[76:79], v[36:39], v[100:103]
buffer_load_dwordx4 v3, s[8:11], 0 offen offset:3072 sc1 lds
v_mfma_f32_16x16x32_bf16 v[104:107], v[72:75], v[24:27], v[104:107]
s_add_u32 m0, s22, 53248
v_add_u32 v3, 4096, v3
v_mfma_f32_16x16x32_bf16 v[104:107], v[76:79], v[40:43], v[104:107]
ds_read_b128 v[68:71], v7 offset:37888
v_mul_f32 v215, v215, v214
v_mfma_f32_16x16x32_bf16 v[108:111], v[72:75], v[28:31], v[108:111]
v_cvt_pk_bf16_f32 v205, v213, v215
v_mfma_f32_16x16x32_bf16 v[108:111], v[76:79], v[44:47], v[108:111]
s_waitcnt lgkmcnt(4)
v_mfma_f32_16x16x32_bf16 v[112:115], v[48:51], a[0:3], 0
buffer_load_dwordx4 v3, s[8:11], 0 offen offset:0 sc1 lds
v_mfma_f32_16x16x32_bf16 v[112:115], v[52:55], a[16:19], v[112:115]
v_mfma_f32_16x16x32_bf16 v[116:119], v[48:51], a[4:7], 0
ds_read_b128 v[72:75], v7 offset:38912
v_mfma_f32_16x16x32_bf16 v[116:119], v[52:55], a[20:23], v[116:119]
v_mul_f32 v208, v80, v80
v_mul_f32 v210, v81, v81
v_mfma_f32_16x16x32_bf16 v[120:123], v[48:51], a[8:11], 0
v_fma_f32 v208, v208, v233, v232
v_fma_f32 v210, v210, v233, v232
v_mfma_f32_16x16x32_bf16 v[120:123], v[52:55], a[24:27], v[120:123]
ds_read_b128 v[76:79], v7 offset:39936
v_mul_f32 v208, v208, v80
v_mfma_f32_16x16x32_bf16 v[124:127], v[48:51], a[12:15], 0
buffer_load_dwordx4 v3, s[8:11], 0 offen offset:1024 sc1 lds
v_mfma_f32_16x16x32_bf16 v[124:127], v[52:55], a[28:31], v[124:127]
v_mul_f32 v210, v210, v81
s_waitcnt lgkmcnt(4)
v_mfma_f32_16x16x32_bf16 v[128:131], v[56:59], a[0:3], 0
v_exp_f32 v208, v208
v_mfma_f32_16x16x32_bf16 v[128:131], v[60:63], a[16:19], v[128:131]
v_exp_f32 v210, v210
v_mfma_f32_16x16x32_bf16 v[132:135], v[56:59], a[4:7], 0
ds_read_b128 v[48:51], v7 offset:40960
v_mul_f32 v209, v80, v96
v_mfma_f32_16x16x32_bf16 v[132:135], v[60:63], a[20:23], v[132:135]
v_mul_f32 v211, v81, v97
v_fma_f32 v208, v208, v234, v234
v_mfma_f32_16x16x32_bf16 v[136:139], v[56:59], a[8:11], 0
v_fma_f32 v210, v210, v234, v234
v_mul_f32 v212, v82, v82
v_mfma_f32_16x16x32_bf16 v[136:139], v[60:63], a[24:27], v[136:139]
ds_read_b128 v[52:55], v7 offset:41984
v_mul_f32 v214, v83, v83
v_mfma_f32_16x16x32_bf16 v[140:143], v[56:59], a[12:15], 0
v_rcp_f32 v208, v208
v_mfma_f32_16x16x32_bf16 v[140:143], v[60:63], a[28:31], v[140:143]
v_mul_f32 v209, v209, v208
s_waitcnt lgkmcnt(4)
v_mfma_f32_16x16x32_bf16 v[112:115], v[64:67], a[32:35], v[112:115]
s_waitcnt vmcnt(6)
v_cmp_eq_u64 vcc, s[68:69], v[14:15]
s_nop 0
s_cmp_eq_u64 vcc, exec
s_cbranch_scc0 L_f_slow1
L_f_back1:
v_fma_f32 v212, v212, v233, v232
v_mfma_f32_16x16x32_bf16 v[112:115], v[68:71], a[48:51], v[112:115]
v_rcp_f32 v210, v210
v_mfma_f32_16x16x32_bf16 v[116:119], v[64:67], a[36:39], v[116:119]
ds_read_b128 v[56:59], v7 offset:43008
v_mul_f32 v211, v211, v210
v_mfma_f32_16x16x32_bf16 v[116:119], v[68:71], a[52:55], v[116:119]
v_cvt_pk_bf16_f32 v194, v209, v211
v_fma_f32 v214, v214, v233, v232
v_mfma_f32_16x16x32_bf16 v[120:123], v[64:67], a[40:43], v[120:123]
v_mul_f32 v212, v212, v82
v_mul_f32 v214, v214, v83
v_mfma_f32_16x16x32_bf16 v[120:123], v[68:71], a[56:59], v[120:123]
ds_read_b128 v[60:63], v7 offset:44032
v_mul_f32 v213, v82, v98
v_mfma_f32_16x16x32_bf16 v[124:127], v[64:67], a[44:47], v[124:127]
v_exp_f32 v212, v212
v_mfma_f32_16x16x32_bf16 v[124:127], v[68:71], a[60:63], v[124:127]
v_mul_f32 v215, v83, v99
s_waitcnt lgkmcnt(4)
v_mfma_f32_16x16x32_bf16 v[128:131], v[72:75], a[32:35], v[128:131]
buffer_load_dwordx4 a[0:3], v2, s[8:11], s25 offen offset:0 sc1
v_mfma_f32_16x16x32_bf16 v[128:131], v[76:79], a[48:51], v[128:131]
v_exp_f32 v214, v214
v_mfma_f32_16x16x32_bf16 v[132:135], v[72:75], a[36:39], v[132:135]
ds_read_b128 v[64:67], v7 offset:45056
v_fma_f32 v212, v212, v234, v234
v_mfma_f32_16x16x32_bf16 v[132:135], v[76:79], a[52:55], v[132:135]
v_fma_f32 v214, v214, v234, v234
v_mul_f32 v208, v84, v84
v_mfma_f32_16x16x32_bf16 v[136:139], v[72:75], a[40:43], v[136:139]
v_rcp_f32 v212, v212
v_mfma_f32_16x16x32_bf16 v[136:139], v[76:79], a[56:59], v[136:139]
ds_read_b128 v[68:71], v7 offset:46080
v_mul_f32 v213, v213, v212
v_mfma_f32_16x16x32_bf16 v[140:143], v[72:75], a[44:47], v[140:143]
buffer_load_dwordx4 a[4:7], v4, s[8:11], s25 offen offset:0 sc1
v_mfma_f32_16x16x32_bf16 v[140:143], v[76:79], a[60:63], v[140:143]
v_mul_f32 v210, v85, v85
s_waitcnt lgkmcnt(4)
v_mfma_f32_16x16x32_bf16 v[112:115], v[48:51], a[64:67], v[112:115]
v_rcp_f32 v214, v214
v_mfma_f32_16x16x32_bf16 v[112:115], v[52:55], a[80:83], v[112:115]
v_mul_f32 v215, v215, v214
v_cvt_pk_bf16_f32 v195, v213, v215
v_mfma_f32_16x16x32_bf16 v[116:119], v[48:51], a[68:71], v[116:119]
ds_read_b128 v[72:75], v7 offset:47104
v_fma_f32 v208, v208, v237, v236
v_mfma_f32_16x16x32_bf16 v[116:119], v[52:55], a[84:87], v[116:119]
buffer_load_dwordx4 a[8:11], v5, s[8:11], s25 offen offset:0 sc1
v_mfma_f32_16x16x32_bf16 v[120:123], v[48:51], a[72:75], v[120:123]
v_fma_f32 v210, v210, v237, v236
v_mul_f32 v208, v208, v84
v_mfma_f32_16x16x32_bf16 v[120:123], v[52:55], a[88:91], v[120:123]
ds_read_b128 v[76:79], v7 offset:48128
v_mul_f32 v210, v210, v85
v_mfma_f32_16x16x32_bf16 v[124:127], v[48:51], a[76:79], v[124:127]
buffer_store_dwordx4 v[192:195], v2, s[8:11], s24 offen offset:3072 sc1
v_mfma_f32_16x16x32_bf16 v[124:127], v[52:55], a[92:95], v[124:127]
v_mul_f32 v209, v84, v100
s_waitcnt lgkmcnt(4)
v_mfma_f32_16x16x32_bf16 v[128:131], v[56:59], a[64:67], v[128:131]
v_exp_f32 v208, v208
v_mfma_f32_16x16x32_bf16 v[128:131], v[60:63], a[80:83], v[128:131]
v_exp_f32 v210, v210
v_mfma_f32_16x16x32_bf16 v[132:135], v[56:59], a[68:71], v[132:135]
ds_read_b128 v[48:51], v7 offset:49152
v_mul_f32 v211, v85, v101
v_mfma_f32_16x16x32_bf16 v[132:135], v[60:63], a[84:87], v[132:135]
buffer_load_dwordx4 a[12:15], v6, s[8:11], s25 offen offset:0 sc1
v_mfma_f32_16x16x32_bf16 v[136:139], v[56:59], a[72:75], v[136:139]
v_fma_f32 v208, v208, v238, v238
v_fma_f32 v210, v210, v238, v238
v_mfma_f32_16x16x32_bf16 v[136:139], v[60:63], a[88:91], v[136:139]
ds_read_b128 v[52:55], v7 offset:50176
v_mul_f32 v212, v86, v86
v_mfma_f32_16x16x32_bf16 v[140:143], v[56:59], a[76:79], v[140:143]
v_rcp_f32 v208, v208
v_mfma_f32_16x16x32_bf16 v[140:143], v[60:63], a[92:95], v[140:143]
v_mul_f32 v209, v209, v208
s_waitcnt lgkmcnt(4)
v_mfma_f32_16x16x32_bf16 v[112:115], v[64:67], a[96:99], v[112:115]
buffer_load_dwordx4 a[16:19], v2, s[8:11], s26 offen offset:0 sc1
v_mfma_f32_16x16x32_bf16 v[112:115], v[68:71], a[112:115], v[112:115]
v_rcp_f32 v210, v210
v_mfma_f32_16x16x32_bf16 v[116:119], v[64:67], a[100:103], v[116:119]
ds_read_b128 v[56:59], v7 offset:51200
v_mul_f32 v211, v211, v210
v_mfma_f32_16x16x32_bf16 v[116:119], v[68:71], a[116:119], v[116:119]
v_cvt_pk_bf16_f32 v198, v209, v211
v_mul_f32 v214, v87, v87
v_mfma_f32_16x16x32_bf16 v[120:123], v[64:67], a[104:107], v[120:123]
v_fma_f32 v212, v212, v237, v236
v_fma_f32 v214, v214, v237, v236
v_mfma_f32_16x16x32_bf16 v[120:123], v[68:71], a[120:123], v[120:123]
ds_read_b128 v[60:63], v7 offset:52224
v_mul_f32 v212, v212, v86
v_mfma_f32_16x16x32_bf16 v[124:127], v[64:67], a[108:111], v[124:127]
buffer_load_dwordx4 a[20:23], v4, s[8:11], s26 offen offset:0 sc1
v_mfma_f32_16x16x32_bf16 v[124:127], v[68:71], a[124:127], v[124:127]
v_mul_f32 v214, v214, v87
s_waitcnt lgkmcnt(4)
v_mfma_f32_16x16x32_bf16 v[128:131], v[72:75], a[96:99], v[128:131]
v_exp_f32 v212, v212
v_mfma_f32_16x16x32_bf16 v[128:131], v[76:79], a[112:115], v[128:131]
v_exp_f32 v214, v214
v_mfma_f32_16x16x32_bf16 v[132:135], v[72:75], a[100:103], v[132:135]
ds_read_b128 v[64:67], v7 offset:53248
v_mul_f32 v213, v86, v102
v_mfma_f32_16x16x32_bf16 v[132:135], v[76:79], a[116:119], v[132:135]
buffer_load_dwordx4 a[24:27], v5, s[8:11], s26 offen offset:0 sc1
v_mfma_f32_16x16x32_bf16 v[136:139], v[72:75], a[104:107], v[136:139]
v_mul_f32 v215, v87, v103
v_fma_f32 v212, v212, v238, v238
v_mfma_f32_16x16x32_bf16 v[136:139], v[76:79], a[120:123], v[136:139]
ds_read_b128 v[68:71], v7 offset:54272
v_fma_f32 v214, v214, v238, v238
v_mfma_f32_16x16x32_bf16 v[140:143], v[72:75], a[108:111], v[140:143]
v_rcp_f32 v212, v212
v_mfma_f32_16x16x32_bf16 v[140:143], v[76:79], a[124:127], v[140:143]
v_mul_f32 v213, v213, v212
s_waitcnt lgkmcnt(4)
v_mfma_f32_16x16x32_bf16 v[112:115], v[48:51], a[128:131], v[112:115]
buffer_load_dwordx4 a[28:31], v6, s[8:11], s26 offen offset:0 sc1
v_mfma_f32_16x16x32_bf16 v[112:115], v[52:55], a[144:147], v[112:115]
v_rcp_f32 v214, v214
v_mfma_f32_16x16x32_bf16 v[116:119], v[48:51], a[132:135], v[116:119]
ds_read_b128 v[72:75], v7 offset:55296
v_mul_f32 v215, v215, v214
v_mfma_f32_16x16x32_bf16 v[116:119], v[52:55], a[148:151], v[116:119]
v_cvt_pk_bf16_f32 v199, v213, v215
v_mul_f32 v208, v88, v88
v_mfma_f32_16x16x32_bf16 v[120:123], v[48:51], a[136:139], v[120:123]
buffer_store_dwordx4 v[196:199], v4, s[8:11], s24 offen offset:3072 sc1
v_mfma_f32_16x16x32_bf16 v[120:123], v[52:55], a[152:155], v[120:123]
ds_read_b128 v[76:79], v7 offset:56320
v_mul_f32 v210, v89, v89
v_mfma_f32_16x16x32_bf16 v[124:127], v[48:51], a[140:143], v[124:127]
v_fma_f32 v208, v208, v241, v240
v_fma_f32 v210, v210, v241, v240
v_mfma_f32_16x16x32_bf16 v[124:127], v[52:55], a[156:159], v[124:127]
v_mul_f32 v208, v208, v88
s_waitcnt lgkmcnt(4)
v_mfma_f32_16x16x32_bf16 v[128:131], v[56:59], a[128:131], v[128:131]
s_waitcnt vmcnt(34)
v_mul_f32 v210, v210, v89
v_mfma_f32_16x16x32_bf16 v[128:131], v[60:63], a[144:147], v[128:131]
s_barrier
v_mfma_f32_16x16x32_bf16 v[132:135], v[56:59], a[132:135], v[132:135]
ds_read_b128 v[48:51], v7 offset:57344
v_mul_f32 v209, v88, v104
v_mfma_f32_16x16x32_bf16 v[132:135], v[60:63], a[148:151], v[132:135]
buffer_load_dwordx4 a[32:35], v2, s[8:11], s27 offen offset:0 sc1
v_mfma_f32_16x16x32_bf16 v[136:139], v[56:59], a[136:139], v[136:139]
v_exp_f32 v208, v208
v_mfma_f32_16x16x32_bf16 v[136:139], v[60:63], a[152:155], v[136:139]
ds_read_b128 v[52:55], v7 offset:58368
v_mul_f32 v211, v89, v105
v_mfma_f32_16x16x32_bf16 v[140:143], v[56:59], a[140:143], v[140:143]
v_exp_f32 v210, v210
v_mfma_f32_16x16x32_bf16 v[140:143], v[60:63], a[156:159], v[140:143]
v_fma_f32 v208, v208, v242, v242
s_waitcnt lgkmcnt(4)
v_mfma_f32_16x16x32_bf16 v[112:115], v[64:67], a[160:163], v[112:115]
buffer_load_dwordx4 a[36:39], v4, s[8:11], s27 offen offset:0 sc1
v_mfma_f32_16x16x32_bf16 v[112:115], v[68:71], a[176:179], v[112:115]
v_fma_f32 v210, v210, v242, v242
v_mul_f32 v212, v90, v90
v_mfma_f32_16x16x32_bf16 v[116:119], v[64:67], a[164:167], v[116:119]
ds_read_b128 v[56:59], v7 offset:59392
v_mul_f32 v214, v91, v91
v_mfma_f32_16x16x32_bf16 v[116:119], v[68:71], a[180:183], v[116:119]
v_rcp_f32 v208, v208
v_mfma_f32_16x16x32_bf16 v[120:123], v[64:67], a[168:171], v[120:123]
v_rcp_f32 v210, v210
v_mfma_f32_16x16x32_bf16 v[120:123], v[68:71], a[184:187], v[120:123]
ds_read_b128 v[60:63], v7 offset:60416
v_mul_f32 v209, v209, v208
v_mfma_f32_16x16x32_bf16 v[124:127], v[64:67], a[172:175], v[124:127]
buffer_load_dwordx4 a[40:43], v5, s[8:11], s27 offen offset:0 sc1
v_mfma_f32_16x16x32_bf16 v[124:127], v[68:71], a[188:191], v[124:127]
v_mul_f32 v211, v211, v210
s_waitcnt lgkmcnt(4)
v_mfma_f32_16x16x32_bf16 v[128:131], v[72:75], a[160:163], v[128:131]
v_cvt_pk_bf16_f32 v202, v209, v211
v_fma_f32 v212, v212, v241, v240
v_mfma_f32_16x16x32_bf16 v[128:131], v[76:79], a[176:179], v[128:131]
v_fma_f32 v214, v214, v241, v240
v_mul_f32 v212, v212, v90
v_mfma_f32_16x16x32_bf16 v[132:135], v[72:75], a[164:167], v[132:135]
ds_read_b128 v[64:67], v7 offset:61440
v_mul_f32 v214, v214, v91
v_mfma_f32_16x16x32_bf16 v[132:135], v[76:79], a[180:183], v[132:135]
buffer_load_dwordx4 a[44:47], v6, s[8:11], s27 offen offset:0 sc1
v_mfma_f32_16x16x32_bf16 v[136:139], v[72:75], a[168:171], v[136:139]
v_exp_f32 v212, v212
v_mfma_f32_16x16x32_bf16 v[136:139], v[76:79], a[184:187], v[136:139]
ds_read_b128 v[68:71], v7 offset:62464
v_mul_f32 v213, v90, v106
v_mfma_f32_16x16x32_bf16 v[140:143], v[72:75], a[172:175], v[140:143]
v_exp_f32 v214, v214
v_mfma_f32_16x16x32_bf16 v[140:143], v[76:79], a[188:191], v[140:143]
v_mul_f32 v215, v91, v107
s_waitcnt lgkmcnt(4)
v_mfma_f32_16x16x32_bf16 v[112:115], v[48:51], a[192:195], v[112:115]
buffer_load_dwordx4 a[48:51], v2, s[8:11], s25 offen offset:1024 sc1
v_mfma_f32_16x16x32_bf16 v[112:115], v[52:55], a[208:211], v[112:115]
v_fma_f32 v212, v212, v242, v242
v_fma_f32 v214, v214, v242, v242
v_mfma_f32_16x16x32_bf16 v[116:119], v[48:51], a[196:199], v[116:119]
ds_read_b128 v[72:75], v7 offset:63488
v_mul_f32 v208, v92, v92
v_mfma_f32_16x16x32_bf16 v[116:119], v[52:55], a[212:215], v[116:119]
v_rcp_f32 v212, v212
v_mfma_f32_16x16x32_bf16 v[120:123], v[48:51], a[200:203], v[120:123]
v_rcp_f32 v214, v214
v_mfma_f32_16x16x32_bf16 v[120:123], v[52:55], a[216:219], v[120:123]
ds_read_b128 v[76:79], v7 offset:64512
v_mul_f32 v213, v213, v212
v_mfma_f32_16x16x32_bf16 v[124:127], v[48:51], a[204:207], v[124:127]
buffer_load_dwordx4 a[52:55], v4, s[8:11], s25 offen offset:1024 sc1
v_mfma_f32_16x16x32_bf16 v[124:127], v[52:55], a[220:223], v[124:127]
v_mul_f32 v215, v215, v214
s_waitcnt lgkmcnt(4)
v_mfma_f32_16x16x32_bf16 v[128:131], v[56:59], a[192:195], v[128:131]
v_cvt_pk_bf16_f32 v203, v213, v215
v_mul_f32 v210, v93, v93
v_mfma_f32_16x16x32_bf16 v[128:131], v[60:63], a[208:211], v[128:131]
buffer_store_dwordx4 v[200:203], v5, s[8:11], s24 offen offset:3072 sc1
v_mfma_f32_16x16x32_bf16 v[132:135], v[56:59], a[196:199], v[132:135]
ds_read_b128 v[48:51], v8 offset:0
v_fma_f32 v208, v208, v245, v244
v_mfma_f32_16x16x32_bf16 v[132:135], v[60:63], a[212:215], v[132:135]
v_fma_f32 v210, v210, v245, v244
v_mul_f32 v208, v208, v92
v_mfma_f32_16x16x32_bf16 v[136:139], v[56:59], a[200:203], v[136:139]
v_mul_f32 v210, v210, v93
v_mul_f32 v209, v92, v108
v_mfma_f32_16x16x32_bf16 v[136:139], v[60:63], a[216:219], v[136:139]
ds_read_b128 v[52:55], v8 offset:1024
v_mul_f32 v211, v93, v109
v_mfma_f32_16x16x32_bf16 v[140:143], v[56:59], a[204:207], v[140:143]
buffer_load_dwordx4 a[56:59], v5, s[8:11], s25 offen offset:1024 sc1
v_mfma_f32_16x16x32_bf16 v[140:143], v[60:63], a[220:223], v[140:143]
v_mul_f32 v212, v94, v94
s_waitcnt lgkmcnt(4)
v_mfma_f32_16x16x32_bf16 v[112:115], v[64:67], a[224:227], v[112:115]
v_exp_f32 v208, v208
v_mfma_f32_16x16x32_bf16 v[112:115], v[68:71], a[240:243], v[112:115]
v_exp_f32 v210, v210
v_mfma_f32_16x16x32_bf16 v[116:119], v[64:67], a[228:231], v[116:119]
ds_read_b128 v[56:59], v8 offset:2048
v_fma_f32 v208, v208, v246, v246
v_mfma_f32_16x16x32_bf16 v[116:119], v[68:71], a[244:247], v[116:119]
buffer_load_dwordx4 a[60:63], v6, s[8:11], s25 offen offset:1024 sc1
v_mfma_f32_16x16x32_bf16 v[120:123], v[64:67], a[232:235], v[120:123]
v_fma_f32 v210, v210, v246, v246
v_mul_f32 v214, v95, v95
v_mfma_f32_16x16x32_bf16 v[120:123], v[68:71], a[248:251], v[120:123]
ds_read_b128 v[60:63], v8 offset:3072
v_fma_f32 v212, v212, v245, v244
v_mfma_f32_16x16x32_bf16 v[124:127], v[64:67], a[236:239], v[124:127]
v_rcp_f32 v208, v208
v_mfma_f32_16x16x32_bf16 v[124:127], v[68:71], a[252:255], v[124:127]
v_mul_f32 v209, v209, v208
s_waitcnt lgkmcnt(4)
v_mfma_f32_16x16x32_bf16 v[128:131], v[72:75], a[224:227], v[128:131]
buffer_load_dwordx4 a[64:67], v2, s[8:11], s26 offen offset:1024 sc1
v_mfma_f32_16x16x32_bf16 v[128:131], v[76:79], a[240:243], v[128:131]
v_rcp_f32 v210, v210
v_mfma_f32_16x16x32_bf16 v[132:135], v[72:75], a[228:231], v[132:135]
ds_read_b128 v[64:67], v8 offset:4096
v_mul_f32 v211, v211, v210
v_mfma_f32_16x16x32_bf16 v[132:135], v[76:79], a[244:247], v[132:135]
v_cvt_pk_bf16_f32 v206, v209, v211
v_fma_f32 v214, v214, v245, v244
v_mfma_f32_16x16x32_bf16 v[136:139], v[72:75], a[232:235], v[136:139]
v_mul_f32 v212, v212, v94
v_mul_f32 v214, v214, v95
v_mfma_f32_16x16x32_bf16 v[136:139], v[76:79], a[248:251], v[136:139]
ds_read_b128 v[68:71], v8 offset:5120
v_mul_f32 v213, v94, v110
v_mfma_f32_16x16x32_bf16 v[140:143], v[72:75], a[236:239], v[140:143]
buffer_load_dwordx4 a[68:71], v4, s[8:11], s26 offen offset:1024 sc1
v_mfma_f32_16x16x32_bf16 v[140:143], v[76:79], a[252:255], v[140:143]
v_mul_f32 v215, v95, v111
s_waitcnt lgkmcnt(4)
v_mfma_f32_16x16x32_bf16 v[112:115], v[48:51], v[16:19], v[112:115]
v_exp_f32 v212, v212
v_mfma_f32_16x16x32_bf16 v[112:115], v[52:55], v[32:35], v[112:115]
v_exp_f32 v214, v214
v_mfma_f32_16x16x32_bf16 v[116:119], v[48:51], v[20:23], v[116:119]
ds_read_b128 v[72:75], v8 offset:6144
v_fma_f32 v212, v212, v246, v246
v_mfma_f32_16x16x32_bf16 v[116:119], v[52:55], v[36:39], v[116:119]
buffer_load_dwordx4 a[72:75], v5, s[8:11], s26 offen offset:1024 sc1
v_mfma_f32_16x16x32_bf16 v[120:123], v[48:51], v[24:27], v[120:123]
v_fma_f32 v214, v214, v246, v246
v_mfma_f32_16x16x32_bf16 v[120:123], v[52:55], v[40:43], v[120:123]
ds_read_b128 v[76:79], v8 offset:7168
v_mfma_f32_16x16x32_bf16 v[124:127], v[48:51], v[28:31], v[124:127]
v_rcp_f32 v212, v212
v_mfma_f32_16x16x32_bf16 v[124:127], v[52:55], v[44:47], v[124:127]
v_mul_f32 v213, v213, v212
s_waitcnt lgkmcnt(4)
v_mfma_f32_16x16x32_bf16 v[128:131], v[56:59], v[16:19], v[128:131]
buffer_load_dwordx4 a[76:79], v6, s[8:11], s26 offen offset:1024 sc1
v_mfma_f32_16x16x32_bf16 v[128:131], v[60:63], v[32:35], v[128:131]
v_rcp_f32 v214, v214
v_mfma_f32_16x16x32_bf16 v[132:135], v[56:59], v[20:23], v[132:135]
ds_read_b128 v[48:51], v8 offset:8192
v_mul_f32 v215, v215, v214
v_mfma_f32_16x16x32_bf16 v[132:135], v[60:63], v[36:39], v[132:135]
v_cvt_pk_bf16_f32 v207, v213, v215
v_mfma_f32_16x16x32_bf16 v[136:139], v[56:59], v[24:27], v[136:139]
buffer_store_dwordx4 v[204:207], v6, s[8:11], s24 offen offset:3072 sc1
v_mfma_f32_16x16x32_bf16 v[136:139], v[60:63], v[40:43], v[136:139]
ds_read_b128 v[52:55], v8 offset:9216
v_mfma_f32_16x16x32_bf16 v[140:143], v[56:59], v[28:31], v[140:143]
v_mfma_f32_16x16x32_bf16 v[140:143], v[60:63], v[44:47], v[140:143]
s_waitcnt lgkmcnt(4)
v_mfma_f32_16x16x32_bf16 a[112:115], v[64:67], v[144:147], 0
v_mfma_f32_16x16x32_bf16 a[112:115], v[68:71], v[160:163], a[112:115]
v_mfma_f32_16x16x32_bf16 a[116:119], v[64:67], v[148:151], 0
ds_read_b128 v[56:59], v8 offset:10240
v_mfma_f32_16x16x32_bf16 a[116:119], v[68:71], v[164:167], a[116:119]
v_mul_f32 v208, v112, v112
v_mul_f32 v210, v113, v113
v_mfma_f32_16x16x32_bf16 a[120:123], v[64:67], v[152:155], 0
v_fma_f32 v208, v208, v233, v232
v_fma_f32 v210, v210, v233, v232
v_mfma_f32_16x16x32_bf16 a[120:123], v[68:71], v[168:171], a[120:123]
ds_read_b128 v[60:63], v8 offset:11264
v_mul_f32 v208, v208, v112
v_mfma_f32_16x16x32_bf16 a[124:127], v[64:67], v[156:159], 0
v_mul_f32 v210, v210, v113
v_mul_f32 v209, v112, v128
v_mfma_f32_16x16x32_bf16 a[124:127], v[68:71], v[172:175], a[124:127]
v_mul_f32 v211, v113, v129
s_waitcnt lgkmcnt(4)
v_mfma_f32_16x16x32_bf16 a[128:131], v[72:75], v[144:147], 0
v_exp_f32 v208, v208
v_mfma_f32_16x16x32_bf16 a[128:131], v[76:79], v[160:163], a[128:131]
v_exp_f32 v210, v210
v_mfma_f32_16x16x32_bf16 a[132:135], v[72:75], v[148:151], 0
ds_read_b128 v[64:67], v8 offset:12288
v_fma_f32 v208, v208, v234, v234
v_mfma_f32_16x16x32_bf16 a[132:135], v[76:79], v[164:167], a[132:135]
v_fma_f32 v210, v210, v234, v234
v_mul_f32 v212, v114, v114
v_mfma_f32_16x16x32_bf16 a[136:139], v[72:75], v[152:155], 0
v_rcp_f32 v208, v208
v_mfma_f32_16x16x32_bf16 a[136:139], v[76:79], v[168:171], a[136:139]
ds_read_b128 v[68:71], v8 offset:13312
v_mul_f32 v209, v209, v208
v_mfma_f32_16x16x32_bf16 a[140:143], v[72:75], v[156:159], 0
v_rcp_f32 v210, v210
v_mfma_f32_16x16x32_bf16 a[140:143], v[76:79], v[172:175], a[140:143]
v_mul_f32 v211, v211, v210
s_waitcnt lgkmcnt(4)
v_mfma_f32_16x16x32_bf16 a[144:147], v[48:51], v[144:147], 0
v_cvt_pk_bf16_f32 v224, v209, v211
v_mul_f32 v214, v115, v115
v_mfma_f32_16x16x32_bf16 a[144:147], v[52:55], v[160:163], a[144:147]
v_fma_f32 v212, v212, v233, v232
v_fma_f32 v214, v214, v233, v232
v_mfma_f32_16x16x32_bf16 a[148:151], v[48:51], v[148:151], 0
ds_read_b128 v[72:75], v8 offset:14336
v_mul_f32 v212, v212, v114
v_mfma_f32_16x16x32_bf16 a[148:151], v[52:55], v[164:167], a[148:151]
v_mul_f32 v214, v214, v115
v_mul_f32 v213, v114, v130
v_mfma_f32_16x16x32_bf16 a[152:155], v[48:51], v[152:155], 0
v_exp_f32 v212, v212
v_mfma_f32_16x16x32_bf16 a[152:155], v[52:55], v[168:171], a[152:155]
ds_read_b128 v[76:79], v8 offset:15360
v_mul_f32 v215, v115, v131
v_mfma_f32_16x16x32_bf16 a[156:159], v[48:51], v[156:159], 0
v_exp_f32 v214, v214
v_mfma_f32_16x16x32_bf16 a[156:159], v[52:55], v[172:175], a[156:159]
v_fma_f32 v212, v212, v234, v234
s_waitcnt lgkmcnt(4)
v_mfma_f32_16x16x32_bf16 a[160:163], v[56:59], v[144:147], 0
s_waitcnt vmcnt(39)
v_fma_f32 v214, v214, v234, v234
v_mfma_f32_16x16x32_bf16 a[160:163], v[60:63], v[160:163], a[160:163]
s_barrier
v_mfma_f32_16x16x32_bf16 a[164:167], v[56:59], v[148:151], 0
ds_read_b128 v[48:51], v2 offset:0
v_mul_f32 v208, v116, v116
v_mfma_f32_16x16x32_bf16 a[164:167], v[60:63], v[164:167], a[164:167]
v_rcp_f32 v212, v212
v_mfma_f32_16x16x32_bf16 a[168:171], v[56:59], v[152:155], 0
v_rcp_f32 v214, v214
v_mfma_f32_16x16x32_bf16 a[168:171], v[60:63], v[168:171], a[168:171]
ds_read_b128 v[52:55], v2 offset:1024
v_mul_f32 v213, v213, v212
v_mfma_f32_16x16x32_bf16 a[172:175], v[56:59], v[156:159], 0
v_mul_f32 v215, v215, v214
v_cvt_pk_bf16_f32 v225, v213, v215
v_mfma_f32_16x16x32_bf16 a[172:175], v[60:63], v[172:175], a[172:175]
v_mul_f32 v210, v117, v117
s_waitcnt lgkmcnt(4)
v_mfma_f32_16x16x32_bf16 a[176:179], v[64:67], v[144:147], 0
buffer_store_dwordx2 v[224:225], v248, s[8:11], s30 offen sc1
v_mfma_f32_16x16x32_bf16 a[176:179], v[68:71], v[160:163], a[176:179]
v_fma_f32 v208, v208, v237, v236
v_fma_f32 v210, v210, v237, v236
v_mfma_f32_16x16x32_bf16 a[180:183], v[64:67], v[148:151], 0
ds_read_b128 v[56:59], v2 offset:2048
v_mul_f32 v208, v208, v116
v_mfma_f32_16x16x32_bf16 a[180:183], v[68:71], v[164:167], a[180:183]
v_mul_f32 v210, v210, v117
v_mul_f32 v209, v116, v132
v_mfma_f32_16x16x32_bf16 a[184:187], v[64:67], v[152:155], 0
v_exp_f32 v208, v208
v_mfma_f32_16x16x32_bf16 a[184:187], v[68:71], v[168:171], a[184:187]
ds_read_b128 v[60:63], v2 offset:3072
v_mul_f32 v211, v117, v133
v_mfma_f32_16x16x32_bf16 a[188:191], v[64:67], v[156:159], 0
v_exp_f32 v210, v210
v_mfma_f32_16x16x32_bf16 a[188:191], v[68:71], v[172:175], a[188:191]
v_fma_f32 v208, v208, v238, v238
s_waitcnt lgkmcnt(4)
v_mfma_f32_16x16x32_bf16 a[192:195], v[72:75], v[144:147], 0
v_fma_f32 v210, v210, v238, v238
v_rcp_f32 v208, v208
v_mfma_f32_16x16x32_bf16 a[192:195], v[76:79], v[160:163], a[192:195]
v_rcp_f32 v210, v210
v_mfma_f32_16x16x32_bf16 a[196:199], v[72:75], v[148:151], 0
L_hop8:
s_cmp_lg_u32 s15, 0
s_cbranch_scc1 L_hop12
ds_read_b128 v[64:67], v2 offset:4096
v_mul_f32 v209, v209, v208
v_mfma_f32_16x16x32_bf16 a[196:199], v[76:79], v[164:167], a[196:199]
v_mul_f32 v211, v211, v210
v_cvt_pk_bf16_f32 v226, v209, v211
v_mfma_f32_16x16x32_bf16 a[200:203], v[72:75], v[152:155], 0
v_mul_f32 v212, v118, v118
v_mul_f32 v214, v119, v119
v_mfma_f32_16x16x32_bf16 a[200:203], v[76:79], v[168:171], a[200:203]
ds_read_b128 v[68:71], v2 offset:5120
v_fma_f32 v212, v212, v237, v236
v_mfma_f32_16x16x32_bf16 a[204:207], v[72:75], v[156:159], 0
v_fma_f32 v214, v214, v237, v236
v_mul_f32 v212, v212, v118
v_mfma_f32_16x16x32_bf16 a[204:207], v[76:79], v[172:175], a[204:207]
v_mul_f32 v214, v214, v119
s_waitcnt lgkmcnt(4)
v_mfma_f32_16x16x32_bf16 a[208:211], v[48:51], v[144:147], 0
v_exp_f32 v212, v212
v_mfma_f32_16x16x32_bf16 a[208:211], v[52:55], v[160:163], a[208:211]
v_exp_f32 v214, v214
v_mfma_f32_16x16x32_bf16 a[212:215], v[48:51], v[148:151], 0
ds_read_b128 v[72:75], v2 offset:6144
v_mul_f32 v213, v118, v134
v_mfma_f32_16x16x32_bf16 a[212:215], v[52:55], v[164:167], a[212:215]
v_mul_f32 v215, v119, v135
v_fma_f32 v212, v212, v238, v238
v_mfma_f32_16x16x32_bf16 a[216:219], v[48:51], v[152:155], 0
v_fma_f32 v214, v214, v238, v238
v_rcp_f32 v212, v212
v_mfma_f32_16x16x32_bf16 a[216:219], v[52:55], v[168:171], a[216:219]
ds_read_b128 v[76:79], v2 offset:7168
v_rcp_f32 v214, v214
v_mfma_f32_16x16x32_bf16 a[220:223], v[48:51], v[156:159], 0
v_mul_f32 v213, v213, v212
v_mul_f32 v215, v215, v214
v_mfma_f32_16x16x32_bf16 a[220:223], v[52:55], v[172:175], a[220:223]
v_cvt_pk_bf16_f32 v227, v213, v215
s_waitcnt lgkmcnt(4)
v_mfma_f32_16x16x32_bf16 a[224:227], v[56:59], v[144:147], 0
buffer_store_dwordx2 v[226:227], v249, s[8:11], s30 offen sc1
v_mfma_f32_16x16x32_bf16 a[224:227], v[60:63], v[160:163], a[224:227]
v_mul_f32 v208, v120, v120
v_mul_f32 v210, v121, v121
v_mfma_f32_16x16x32_bf16 a[228:231], v[56:59], v[148:151], 0
ds_read_b128 v[48:51], v2 offset:8192
v_fma_f32 v208, v208, v241, v240
v_mfma_f32_16x16x32_bf16 a[228:231], v[60:63], v[164:167], a[228:231]
v_fma_f32 v210, v210, v241, v240
v_mul_f32 v208, v208, v120
v_mfma_f32_16x16x32_bf16 a[232:235], v[56:59], v[152:155], 0
v_mul_f32 v210, v210, v121
v_exp_f32 v208, v208
v_mfma_f32_16x16x32_bf16 a[232:235], v[60:63], v[168:171], a[232:235]
ds_read_b128 v[52:55], v2 offset:9216
v_exp_f32 v210, v210
v_mfma_f32_16x16x32_bf16 a[236:239], v[56:59], v[156:159], 0
v_mul_f32 v209, v120, v136
v_mul_f32 v211, v121, v137
v_mfma_f32_16x16x32_bf16 a[236:239], v[60:63], v[172:175], a[236:239]
v_fma_f32 v208, v208, v242, v242
s_waitcnt vmcnt(21)
s_waitcnt lgkmcnt(4)
v_mfma_f32_16x16x32_bf16 a[112:115], v[64:67], v[176:179], a[112:115]
v_mov_b32 v12, s68
v_mov_b32 v13, s69
v_fma_f32 v210, v210, v242, v242
v_mfma_f32_16x16x32_bf16 a[112:115], v[68:71], a[0:3], a[112:115]
s_add_u32 s53, s34, 131072
s_waitcnt vmcnt(2)
buffer_store_dwordx2 v[12:13], v10, s[8:11], s53 offen sc1
v_rcp_f32 v208, v208
v_mfma_f32_16x16x32_bf16 a[116:119], v[64:67], v[180:183], a[116:119]
ds_read_b128 v[56:59], v2 offset:10240
v_rcp_f32 v210, v210
v_mfma_f32_16x16x32_bf16 a[116:119], v[68:71], a[4:7], a[116:119]
v_mul_f32 v209, v209, v208
v_mul_f32 v211, v211, v210
v_mfma_f32_16x16x32_bf16 a[120:123], v[64:67], v[184:187], a[120:123]
v_cvt_pk_bf16_f32 v228, v209, v211
v_mul_f32 v212, v122, v122
v_mfma_f32_16x16x32_bf16 a[120:123], v[68:71], a[8:11], a[120:123]
ds_read_b128 v[60:63], v2 offset:11264
v_mul_f32 v214, v123, v123
v_mfma_f32_16x16x32_bf16 a[124:127], v[64:67], v[188:191], a[124:127]
v_fma_f32 v212, v212, v241, v240
v_fma_f32 v214, v214, v241, v240
v_mfma_f32_16x16x32_bf16 a[124:127], v[68:71], a[12:15], a[124:127]
v_mul_f32 v212, v212, v122
s_waitcnt lgkmcnt(4)
v_mfma_f32_16x16x32_bf16 a[128:131], v[72:75], v[176:179], a[128:131]
v_mul_f32 v214, v214, v123
v_exp_f32 v212, v212
v_mfma_f32_16x16x32_bf16 a[128:131], v[76:79], a[0:3], a[128:131]
v_exp_f32 v214, v214
v_mfma_f32_16x16x32_bf16 a[132:135], v[72:75], v[180:183], a[132:135]
ds_read_b128 v[64:67], v2 offset:12288
v_mul_f32 v213, v122, v138
v_mfma_f32_16x16x32_bf16 a[132:135], v[76:79], a[4:7], a[132:135]
v_mul_f32 v215, v123, v139
v_fma_f32 v212, v212, v242, v242
v_mfma_f32_16x16x32_bf16 a[136:139], v[72:75], v[184:187], a[136:139]
v_fma_f32 v214, v214, v242, v242
v_rcp_f32 v212, v212
v_mfma_f32_16x16x32_bf16 a[136:139], v[76:79], a[8:11], a[136:139]
ds_read_b128 v[68:71], v2 offset:13312
v_rcp_f32 v214, v214
v_mfma_f32_16x16x32_bf16 a[140:143], v[72:75], v[188:191], a[140:143]
v_mul_f32 v213, v213, v212
v_mul_f32 v215, v215, v214
v_mfma_f32_16x16x32_bf16 a[140:143], v[76:79], a[12:15], a[140:143]
v_cvt_pk_bf16_f32 v229, v213, v215
s_waitcnt lgkmcnt(4)
v_mfma_f32_16x16x32_bf16 a[144:147], v[48:51], v[176:179], a[144:147]
buffer_store_dwordx2 v[228:229], v250, s[8:11], s30 offen sc1
v_mfma_f32_16x16x32_bf16 a[144:147], v[52:55], a[0:3], a[144:147]
v_mul_f32 v208, v124, v124
v_mul_f32 v210, v125, v125
v_mfma_f32_16x16x32_bf16 a[148:151], v[48:51], v[180:183], a[148:151]
ds_read_b128 v[72:75], v2 offset:14336
v_fma_f32 v208, v208, v245, v244
v_mfma_f32_16x16x32_bf16 a[148:151], v[52:55], a[4:7], a[148:151]
v_fma_f32 v210, v210, v245, v244
v_mul_f32 v208, v208, v124
v_mfma_f32_16x16x32_bf16 a[152:155], v[48:51], v[184:187], a[152:155]
v_mul_f32 v210, v210, v125
v_exp_f32 v208, v208
v_mfma_f32_16x16x32_bf16 a[152:155], v[52:55], a[8:11], a[152:155]
ds_read_b128 v[76:79], v2 offset:15360
v_exp_f32 v210, v210
v_mfma_f32_16x16x32_bf16 a[156:159], v[48:51], v[188:191], a[156:159]
v_mul_f32 v209, v124, v140
v_mul_f32 v211, v125, v141
v_mfma_f32_16x16x32_bf16 a[156:159], v[52:55], a[12:15], a[156:159]
v_fma_f32 v208, v208, v246, v246
s_waitcnt lgkmcnt(4)
v_mfma_f32_16x16x32_bf16 a[160:163], v[56:59], v[176:179], a[160:163]
v_fma_f32 v210, v210, v246, v246
v_rcp_f32 v208, v208
v_mfma_f32_16x16x32_bf16 a[160:163], v[60:63], a[0:3], a[160:163]
v_rcp_f32 v210, v210
v_mfma_f32_16x16x32_bf16 a[164:167], v[56:59], v[180:183], a[164:167]
ds_read_b128 v[48:51], v2 offset:16384
v_mul_f32 v209, v209, v208
v_mfma_f32_16x16x32_bf16 a[164:167], v[60:63], a[4:7], a[164:167]
v_mul_f32 v211, v211, v210
v_cvt_pk_bf16_f32 v230, v209, v211
v_mfma_f32_16x16x32_bf16 a[168:171], v[56:59], v[184:187], a[168:171]
v_mul_f32 v212, v126, v126
v_mul_f32 v214, v127, v127
v_mfma_f32_16x16x32_bf16 a[168:171], v[60:63], a[8:11], a[168:171]
ds_read_b128 v[52:55], v2 offset:17408
v_fma_f32 v212, v212, v245, v244
v_mfma_f32_16x16x32_bf16 a[172:175], v[56:59], v[188:191], a[172:175]
v_fma_f32 v214, v214, v245, v244
v_mul_f32 v212, v212, v126
v_mfma_f32_16x16x32_bf16 a[172:175], v[60:63], a[12:15], a[172:175]
v_mul_f32 v214, v214, v127
s_waitcnt lgkmcnt(4)
v_mfma_f32_16x16x32_bf16 a[176:179], v[64:67], v[176:179], a[176:179]
v_exp_f32 v212, v212
v_mfma_f32_16x16x32_bf16 a[176:179], v[68:71], a[0:3], a[176:179]
v_exp_f32 v214, v214
v_mfma_f32_16x16x32_bf16 a[180:183], v[64:67], v[180:183], a[180:183]
ds_read_b128 v[56:59], v2 offset:18432
v_mul_f32 v213, v126, v142
v_mfma_f32_16x16x32_bf16 a[180:183], v[68:71], a[4:7], a[180:183]
v_mul_f32 v215, v127, v143
v_fma_f32 v212, v212, v246, v246
v_mfma_f32_16x16x32_bf16 a[184:187], v[64:67], v[184:187], a[184:187]
v_fma_f32 v214, v214, v246, v246
v_rcp_f32 v212, v212
v_mfma_f32_16x16x32_bf16 a[184:187], v[68:71], a[8:11], a[184:187]
ds_read_b128 v[60:63], v2 offset:19456
v_rcp_f32 v214, v214
v_mfma_f32_16x16x32_bf16 a[188:191], v[64:67], v[188:191], a[188:191]
v_mul_f32 v213, v213, v212
v_mul_f32 v215, v215, v214
v_mfma_f32_16x16x32_bf16 a[188:191], v[68:71], a[12:15], a[188:191]
v_cvt_pk_bf16_f32 v231, v213, v215
buffer_store_dwordx2 v[230:231], v251, s[8:11], s30 offen sc1
s_waitcnt lgkmcnt(4)
v_mfma_f32_16x16x32_bf16 a[192:195], v[72:75], v[176:179], a[192:195]
buffer_load_dwordx4 a[80:83], v2, s[8:11], s27 offen offset:1024 sc1
v_mfma_f32_16x16x32_bf16 a[192:195], v[76:79], a[0:3], a[192:195]
v_mfma_f32_16x16x32_bf16 a[196:199], v[72:75], v[180:183], a[196:199]
ds_read_b128 v[64:67], v2 offset:20480
v_mfma_f32_16x16x32_bf16 a[196:199], v[76:79], a[4:7], a[196:199]
v_mfma_f32_16x16x32_bf16 a[200:203], v[72:75], v[184:187], a[200:203]
v_mfma_f32_16x16x32_bf16 a[200:203], v[76:79], a[8:11], a[200:203]
ds_read_b128 v[68:71], v2 offset:21504
v_mfma_f32_16x16x32_bf16 a[204:207], v[72:75], v[188:191], a[204:207]
buffer_load_dwordx4 a[84:87], v4, s[8:11], s27 offen offset:1024 sc1
v_mfma_f32_16x16x32_bf16 a[204:207], v[76:79], a[12:15], a[204:207]
s_waitcnt lgkmcnt(4)
v_mfma_f32_16x16x32_bf16 a[208:211], v[48:51], v[176:179], a[208:211]
s_add_u32 s23, s34, 131072
v_mfma_f32_16x16x32_bf16 a[208:211], v[52:55], a[0:3], a[208:211]
v_mfma_f32_16x16x32_bf16 a[212:215], v[48:51], v[180:183], a[212:215]
ds_read_b128 v[72:75], v2 offset:22528
v_mfma_f32_16x16x32_bf16 a[212:215], v[52:55], a[4:7], a[212:215]
buffer_load_dwordx2 v[14:15], v11, s[8:11], s23 offen sc1
v_mfma_f32_16x16x32_bf16 a[216:219], v[48:51], v[184:187], a[216:219]
v_mfma_f32_16x16x32_bf16 a[216:219], v[52:55], a[8:11], a[216:219]
ds_read_b128 v[76:79], v2 offset:23552
v_mfma_f32_16x16x32_bf16 a[220:223], v[48:51], v[188:191], a[220:223]
v_mfma_f32_16x16x32_bf16 a[220:223], v[52:55], a[12:15], a[220:223]
s_waitcnt lgkmcnt(4)
v_mfma_f32_16x16x32_bf16 a[224:227], v[56:59], v[176:179], a[224:227]
s_waitcnt vmcnt(39)
v_mfma_f32_16x16x32_bf16 a[224:227], v[60:63], a[0:3], a[224:227]
s_barrier
v_mfma_f32_16x16x32_bf16 a[228:231], v[56:59], v[180:183], a[228:231]
ds_read_b128 v[48:51], v2 offset:24576
buffer_load_dwordx4 a[88:91], v5, s[8:11], s27 offen offset:1024 sc1
v_mfma_f32_16x16x32_bf16 a[228:231], v[60:63], a[4:7], a[228:231]
v_mfma_f32_16x16x32_bf16 a[232:235], v[56:59], v[184:187], a[232:235]
v_mfma_f32_16x16x32_bf16 a[232:235], v[60:63], a[8:11], a[232:235]
ds_read_b128 v[52:55], v2 offset:25600
v_mfma_f32_16x16x32_bf16 a[236:239], v[56:59], v[188:191], a[236:239]
v_mfma_f32_16x16x32_bf16 a[236:239], v[60:63], a[12:15], a[236:239]
s_waitcnt vmcnt(19)
s_waitcnt lgkmcnt(4)
v_mfma_f32_16x16x32_bf16 a[112:115], v[64:67], a[16:19], a[112:115]
buffer_load_dwordx4 a[92:95], v6, s[8:11], s27 offen offset:1024 sc1
v_mfma_f32_16x16x32_bf16 a[112:115], v[68:71], a[32:35], a[112:115]
v_mfma_f32_16x16x32_bf16 a[116:119], v[64:67], a[20:23], a[116:119]
ds_read_b128 v[56:59], v2 offset:26624
v_mfma_f32_16x16x32_bf16 a[116:119], v[68:71], a[36:39], a[116:119]
v_mfma_f32_16x16x32_bf16 a[120:123], v[64:67], a[24:27], a[120:123]
v_mfma_f32_16x16x32_bf16 a[120:123], v[68:71], a[40:43], a[120:123]
ds_read_b128 v[60:63], v2 offset:27648
v_mfma_f32_16x16x32_bf16 a[124:127], v[64:67], a[28:31], a[124:127]
buffer_load_dwordx4 a[96:99], v2, s[8:11], s25 offen offset:2048 sc1
v_mfma_f32_16x16x32_bf16 a[124:127], v[68:71], a[44:47], a[124:127]
s_waitcnt lgkmcnt(4)
v_mfma_f32_16x16x32_bf16 a[128:131], v[72:75], a[16:19], a[128:131]
v_mfma_f32_16x16x32_bf16 a[128:131], v[76:79], a[32:35], a[128:131]
v_mfma_f32_16x16x32_bf16 a[132:135], v[72:75], a[20:23], a[132:135]
ds_read_b128 v[64:67], v2 offset:28672
v_mfma_f32_16x16x32_bf16 a[132:135], v[76:79], a[36:39], a[132:135]
buffer_load_dwordx4 a[100:103], v4, s[8:11], s25 offen offset:2048 sc1
v_mfma_f32_16x16x32_bf16 a[136:139], v[72:75], a[24:27], a[136:139]
v_mfma_f32_16x16x32_bf16 a[136:139], v[76:79], a[40:43], a[136:139]
ds_read_b128 v[68:71], v2 offset:29696
v_mfma_f32_16x16x32_bf16 a[140:143], v[72:75], a[28:31], a[140:143]
v_mfma_f32_16x16x32_bf16 a[140:143], v[76:79], a[44:47], a[140:143]
s_waitcnt lgkmcnt(4)
v_mfma_f32_16x16x32_bf16 a[144:147], v[48:51], a[16:19], a[144:147]
buffer_load_dwordx4 a[104:107], v5, s[8:11], s25 offen offset:2048 sc1
v_mfma_f32_16x16x32_bf16 a[144:147], v[52:55], a[32:35], a[144:147]
v_mfma_f32_16x16x32_bf16 a[148:151], v[48:51], a[20:23], a[148:151]
ds_read_b128 v[72:75], v2 offset:30720
v_mfma_f32_16x16x32_bf16 a[148:151], v[52:55], a[36:39], a[148:151]
v_mfma_f32_16x16x32_bf16 a[152:155], v[48:51], a[24:27], a[152:155]
buffer_load_dwordx4 a[108:111], v6, s[8:11], s25 offen offset:2048 sc1
v_mfma_f32_16x16x32_bf16 a[152:155], v[52:55], a[40:43], a[152:155]
ds_read_b128 v[76:79], v2 offset:31744
v_mfma_f32_16x16x32_bf16 a[156:159], v[48:51], a[28:31], a[156:159]
v_mfma_f32_16x16x32_bf16 a[156:159], v[52:55], a[44:47], a[156:159]
s_waitcnt lgkmcnt(4)
v_mfma_f32_16x16x32_bf16 a[160:163], v[56:59], a[16:19], a[160:163]
v_mfma_f32_16x16x32_bf16 a[160:163], v[60:63], a[32:35], a[160:163]
buffer_load_dwordx4 v[16:19], v2, s[8:11], s26 offen offset:2048 sc1
v_mfma_f32_16x16x32_bf16 a[164:167], v[56:59], a[20:23], a[164:167]
ds_read_b128 v[48:51], v2 offset:32768
v_mfma_f32_16x16x32_bf16 a[164:167], v[60:63], a[36:39], a[164:167]
v_mfma_f32_16x16x32_bf16 a[168:171], v[56:59], a[24:27], a[168:171]
v_mfma_f32_16x16x32_bf16 a[168:171], v[60:63], a[40:43], a[168:171]
ds_read_b128 v[52:55], v2 offset:33792
v_mfma_f32_16x16x32_bf16 a[172:175], v[56:59], a[28:31], a[172:175]
buffer_load_dwordx4 v[20:23], v4, s[8:11], s26 offen offset:2048 sc1
v_mfma_f32_16x16x32_bf16 a[172:175], v[60:63], a[44:47], a[172:175]
s_waitcnt lgkmcnt(4)
v_mfma_f32_16x16x32_bf16 a[176:179], v[64:67], a[16:19], a[176:179]
v_mov_b32 v12, s68
v_mov_b32 v13, s69
v_mfma_f32_16x16x32_bf16 a[176:179], v[68:71], a[32:35], a[176:179]
s_add_u32 s53, s34, 262144
s_waitcnt vmcnt(11)
v_mfma_f32_16x16x32_bf16 a[180:183], v[64:67], a[20:23], a[180:183]
ds_read_b128 v[56:59], v2 offset:34816
v_mfma_f32_16x16x32_bf16 a[180:183], v[68:71], a[36:39], a[180:183]
buffer_store_dwordx2 v[12:13], v10, s[8:11], s53 offen sc1
v_mfma_f32_16x16x32_bf16 a[184:187], v[64:67], a[24:27], a[184:187]
v_mfma_f32_16x16x32_bf16 a[184:187], v[68:71], a[40:43], a[184:187]
ds_read_b128 v[60:63], v2 offset:35840
v_mfma_f32_16x16x32_bf16 a[188:191], v[64:67], a[28:31], a[188:191]
v_mfma_f32_16x16x32_bf16 a[188:191], v[68:71], a[44:47], a[188:191]
s_waitcnt lgkmcnt(4)
v_mfma_f32_16x16x32_bf16 a[192:195], v[72:75], a[16:19], a[192:195]
buffer_load_dwordx4 v[24:27], v5, s[8:11], s26 offen offset:2048 sc1
v_mfma_f32_16x16x32_bf16 a[192:195], v[76:79], a[32:35], a[192:195]
v_mfma_f32_16x16x32_bf16 a[196:199], v[72:75], a[20:23], a[196:199]
ds_read_b128 v[64:67], v2 offset:36864
v_mfma_f32_16x16x32_bf16 a[196:199], v[76:79], a[36:39], a[196:199]
v_mfma_f32_16x16x32_bf16 a[200:203], v[72:75], a[24:27], a[200:203]
v_mfma_f32_16x16x32_bf16 a[200:203], v[76:79], a[40:43], a[200:203]
ds_read_b128 v[68:71], v2 offset:37888
v_mfma_f32_16x16x32_bf16 a[204:207], v[72:75], a[28:31], a[204:207]
buffer_load_dwordx4 v[28:31], v6, s[8:11], s26 offen offset:2048 sc1
v_mfma_f32_16x16x32_bf16 a[204:207], v[76:79], a[44:47], a[204:207]
s_waitcnt lgkmcnt(4)
v_mfma_f32_16x16x32_bf16 a[208:211], v[48:51], a[16:19], a[208:211]
s_waitcnt vmcnt(11)
v_cmp_eq_u64 vcc, s[68:69], v[14:15]
s_nop 0
s_cmp_eq_u64 vcc, exec
s_cbranch_scc0 L_f_slow2
L_f_back2:
v_mfma_f32_16x16x32_bf16 a[208:211], v[52:55], a[32:35], a[208:211]
v_mfma_f32_16x16x32_bf16 a[212:215], v[48:51], a[20:23], a[212:215]
ds_read_b128 v[72:75], v2 offset:38912
v_mfma_f32_16x16x32_bf16 a[212:215], v[52:55], a[36:39], a[212:215]
buffer_load_dwordx4 v[32:35], v2, s[8:11], s27 offen offset:2048 sc1
v_mfma_f32_16x16x32_bf16 a[216:219], v[48:51], a[24:27], a[216:219]
v_mfma_f32_16x16x32_bf16 a[216:219], v[52:55], a[40:43], a[216:219]
ds_read_b128 v[76:79], v2 offset:39936
v_mfma_f32_16x16x32_bf16 a[220:223], v[48:51], a[28:31], a[220:223]
v_mfma_f32_16x16x32_bf16 a[220:223], v[52:55], a[44:47], a[220:223]
s_waitcnt lgkmcnt(4)
v_mfma_f32_16x16x32_bf16 a[224:227], v[56:59], a[16:19], a[224:227]
buffer_load_dwordx4 v[36:39], v4, s[8:11], s27 offen offset:2048 sc1
v_mfma_f32_16x16x32_bf16 a[224:227], v[60:63], a[32:35], a[224:227]
v_mfma_f32_16x16x32_bf16 a[228:231], v[56:59], a[20:23], a[228:231]
ds_read_b128 v[48:51], v2 offset:40960
v_mfma_f32_16x16x32_bf16 a[228:231], v[60:63], a[36:39], a[228:231]
v_mfma_f32_16x16x32_bf16 a[232:235], v[56:59], a[24:27], a[232:235]
buffer_load_dwordx4 v[40:43], v5, s[8:11], s27 offen offset:2048 sc1
v_mfma_f32_16x16x32_bf16 a[232:235], v[60:63], a[40:43], a[232:235]
ds_read_b128 v[52:55], v2 offset:41984
v_mfma_f32_16x16x32_bf16 a[236:239], v[56:59], a[28:31], a[236:239]
v_mfma_f32_16x16x32_bf16 a[236:239], v[60:63], a[44:47], a[236:239]
s_waitcnt vmcnt(23)
s_waitcnt lgkmcnt(4)
v_mfma_f32_16x16x32_bf16 a[112:115], v[64:67], a[48:51], a[112:115]
buffer_load_dwordx4 v[44:47], v6, s[8:11], s27 offen offset:2048 sc1
v_mfma_f32_16x16x32_bf16 a[112:115], v[68:71], a[64:67], a[112:115]
s_add_u32 m0, s22, 73728
v_add_u32 v3, 20480, v3
v_mfma_f32_16x16x32_bf16 a[116:119], v[64:67], a[52:55], a[116:119]
ds_read_b128 v[56:59], v2 offset:43008
v_mfma_f32_16x16x32_bf16 a[116:119], v[68:71], a[68:71], a[116:119]
v_mfma_f32_16x16x32_bf16 a[120:123], v[64:67], a[56:59], a[120:123]
v_mfma_f32_16x16x32_bf16 a[120:123], v[68:71], a[72:75], a[120:123]
ds_read_b128 v[60:63], v2 offset:44032
v_mfma_f32_16x16x32_bf16 a[124:127], v[64:67], a[60:63], a[124:127]
buffer_load_dwordx4 v3, s[8:11], 0 offen offset:0 sc1 lds
v_mfma_f32_16x16x32_bf16 a[124:127], v[68:71], a[76:79], a[124:127]
s_waitcnt lgkmcnt(4)
v_mfma_f32_16x16x32_bf16 a[128:131], v[72:75], a[48:51], a[128:131]
v_mfma_f32_16x16x32_bf16 a[128:131], v[76:79], a[64:67], a[128:131]
v_mfma_f32_16x16x32_bf16 a[132:135], v[72:75], a[52:55], a[132:135]
ds_read_b128 v[64:67], v2 offset:45056
v_mfma_f32_16x16x32_bf16 a[132:135], v[76:79], a[68:71], a[132:135]
buffer_load_dwordx4 v3, s[8:11], 0 offen offset:1024 sc1 lds
v_mfma_f32_16x16x32_bf16 a[136:139], v[72:75], a[56:59], a[136:139]
v_mfma_f32_16x16x32_bf16 a[136:139], v[76:79], a[72:75], a[136:139]
ds_read_b128 v[68:71], v2 offset:46080
v_mfma_f32_16x16x32_bf16 a[140:143], v[72:75], a[60:63], a[140:143]
v_mfma_f32_16x16x32_bf16 a[140:143], v[76:79], a[76:79], a[140:143]
s_waitcnt lgkmcnt(4)
v_mfma_f32_16x16x32_bf16 a[144:147], v[48:51], a[48:51], a[144:147]
s_add_u32 s23, s34, 262144
v_mfma_f32_16x16x32_bf16 a[144:147], v[52:55], a[64:67], a[144:147]
buffer_load_dwordx2 v[14:15], v11, s[8:11], s23 offen sc1
v_mfma_f32_16x16x32_bf16 a[148:151], v[48:51], a[52:55], a[148:151]
ds_read_b128 v[72:75], v2 offset:47104
v_mfma_f32_16x16x32_bf16 a[148:151], v[52:55], a[68:71], a[148:151]
v_mfma_f32_16x16x32_bf16 a[152:155], v[48:51], a[56:59], a[152:155]
v_mfma_f32_16x16x32_bf16 a[152:155], v[52:55], a[72:75], a[152:155]
ds_read_b128 v[76:79], v2 offset:48128
v_mfma_f32_16x16x32_bf16 a[156:159], v[48:51], a[60:63], a[156:159]
buffer_load_dwordx4 v3, s[8:11], 0 offen offset:2048 sc1 lds
v_mfma_f32_16x16x32_bf16 a[156:159], v[52:55], a[76:79], a[156:159]
s_waitcnt lgkmcnt(4)
v_mfma_f32_16x16x32_bf16 a[160:163], v[56:59], a[48:51], a[160:163]
s_waitcnt vmcnt(51)
v_mfma_f32_16x16x32_bf16 a[160:163], v[60:63], a[64:67], a[160:163]
s_barrier
v_mfma_f32_16x16x32_bf16 a[164:167], v[56:59], a[52:55], a[164:167]
ds_read_b128 v[48:51], v2 offset:49152
v_mfma_f32_16x16x32_bf16 a[164:167], v[60:63], a[68:71], a[164:167]
buffer_load_dwordx4 v3, s[8:11], 0 offen offset:3072 sc1 lds
v_mfma_f32_16x16x32_bf16 a[168:171], v[56:59], a[56:59], a[168:171]
s_add_u32 m0, s22, 77824
v_add_u32 v3, 4096, v3
v_mfma_f32_16x16x32_bf16 a[168:171], v[60:63], a[72:75], a[168:171]
ds_read_b128 v[52:55], v2 offset:50176
v_mfma_f32_16x16x32_bf16 a[172:175], v[56:59], a[60:63], a[172:175]
v_mfma_f32_16x16x32_bf16 a[172:175], v[60:63], a[76:79], a[172:175]
s_waitcnt lgkmcnt(4)
v_mfma_f32_16x16x32_bf16 a[176:179], v[64:67], a[48:51], a[176:179]
buffer_load_dwordx4 v3, s[8:11], 0 offen offset:0 sc1 lds
v_mfma_f32_16x16x32_bf16 a[176:179], v[68:71], a[64:67], a[176:179]
v_mfma_f32_16x16x32_bf16 a[180:183], v[64:67], a[52:55], a[180:183]
ds_read_b128 v[56:59], v2 offset:51200
v_mfma_f32_16x16x32_bf16 a[180:183], v[68:71], a[68:71], a[180:183]
v_mfma_f32_16x16x32_bf16 a[184:187], v[64:67], a[56:59], a[184:187]
buffer_load_dwordx4 v3, s[8:11], 0 offen offset:1024 sc1 lds
v_mfma_f32_16x16x32_bf16 a[184:187], v[68:71], a[72:75], a[184:187]
ds_read_b128 v[60:63], v2 offset:52224
v_mfma_f32_16x16x32_bf16 a[188:191], v[64:67], a[60:63], a[188:191]
v_mfma_f32_16x16x32_bf16 a[188:191], v[68:71], a[76:79], a[188:191]
s_waitcnt lgkmcnt(4)
v_mfma_f32_16x16x32_bf16 a[192:195], v[72:75], a[48:51], a[192:195]
buffer_load_dwordx4 v[80:83], v2, s[8:11], s25 offen offset:3072 sc1
v_mfma_f32_16x16x32_bf16 a[192:195], v[76:79], a[64:67], a[192:195]
v_mfma_f32_16x16x32_bf16 a[196:199], v[72:75], a[52:55], a[196:199]
ds_read_b128 v[64:67], v2 offset:53248
v_mfma_f32_16x16x32_bf16 a[196:199], v[76:79], a[68:71], a[196:199]
v_mfma_f32_16x16x32_bf16 a[200:203], v[72:75], a[56:59], a[200:203]
buffer_load_dwordx4 v[84:87], v4, s[8:11], s25 offen offset:3072 sc1
v_mfma_f32_16x16x32_bf16 a[200:203], v[76:79], a[72:75], a[200:203]
ds_read_b128 v[68:71], v2 offset:54272
v_mfma_f32_16x16x32_bf16 a[204:207], v[72:75], a[60:63], a[204:207]
v_mfma_f32_16x16x32_bf16 a[204:207], v[76:79], a[76:79], a[204:207]
s_waitcnt lgkmcnt(4)
v_mfma_f32_16x16x32_bf16 a[208:211], v[48:51], a[48:51], a[208:211]
buffer_load_dwordx4 v[88:91], v5, s[8:11], s25 offen offset:3072 sc1
v_mfma_f32_16x16x32_bf16 a[208:211], v[52:55], a[64:67], a[208:211]
v_mfma_f32_16x16x32_bf16 a[212:215], v[48:51], a[52:55], a[212:215]
ds_read_b128 v[72:75], v2 offset:55296
v_mfma_f32_16x16x32_bf16 a[212:215], v[52:55], a[68:71], a[212:215]
v_mfma_f32_16x16x32_bf16 a[216:219], v[48:51], a[56:59], a[216:219]
buffer_load_dwordx4 v[92:95], v6, s[8:11], s25 offen offset:3072 sc1
v_mfma_f32_16x16x32_bf16 a[216:219], v[52:55], a[72:75], a[216:219]
ds_read_b128 v[76:79], v2 offset:56320
v_mfma_f32_16x16x32_bf16 a[220:223], v[48:51], a[60:63], a[220:223]
v_mfma_f32_16x16x32_bf16 a[220:223], v[52:55], a[76:79], a[220:223]
s_waitcnt lgkmcnt(4)
v_mfma_f32_16x16x32_bf16 a[224:227], v[56:59], a[48:51], a[224:227]
buffer_load_dwordx4 v[96:99], v2, s[8:11], s26 offen offset:3072 sc1
v_mfma_f32_16x16x32_bf16 a[224:227], v[60:63], a[64:67], a[224:227]
v_mfma_f32_16x16x32_bf16 a[228:231], v[56:59], a[52:55], a[228:231]
ds_read_b128 v[48:51], v2 offset:57344
v_mfma_f32_16x16x32_bf16 a[228:231], v[60:63], a[68:71], a[228:231]
v_mfma_f32_16x16x32_bf16 a[232:235], v[56:59], a[56:59], a[232:235]
buffer_load_dwordx4 v[100:103], v4, s[8:11], s26 offen offset:3072 sc1
v_mfma_f32_16x16x32_bf16 a[232:235], v[60:63], a[72:75], a[232:235]
ds_read_b128 v[52:55], v2 offset:58368
v_mfma_f32_16x16x32_bf16 a[236:239], v[56:59], a[60:63], a[236:239]
v_mfma_f32_16x16x32_bf16 a[236:239], v[60:63], a[76:79], a[236:239]
s_waitcnt vmcnt(22)
s_waitcnt lgkmcnt(4)
v_mfma_f32_16x16x32_bf16 a[112:115], v[64:67], a[80:83], a[112:115]
buffer_load_dwordx4 v[104:107], v5, s[8:11], s26 offen offset:3072 sc1
v_mfma_f32_16x16x32_bf16 a[112:115], v[68:71], a[96:99], a[112:115]
v_mfma_f32_16x16x32_bf16 a[116:119], v[64:67], a[84:87], a[116:119]
ds_read_b128 v[56:59], v2 offset:59392
v_mfma_f32_16x16x32_bf16 a[116:119], v[68:71], a[100:103], a[116:119]
v_mfma_f32_16x16x32_bf16 a[120:123], v[64:67], a[88:91], a[120:123]
buffer_load_dwordx4 v[108:111], v6, s[8:11], s26 offen offset:3072 sc1
v_mfma_f32_16x16x32_bf16 a[120:123], v[68:71], a[104:107], a[120:123]
ds_read_b128 v[60:63], v2 offset:60416
v_mfma_f32_16x16x32_bf16 a[124:127], v[64:67], a[92:95], a[124:127]
v_mfma_f32_16x16x32_bf16 a[124:127], v[68:71], a[108:111], a[124:127]
s_waitcnt lgkmcnt(4)
v_mfma_f32_16x16x32_bf16 a[128:131], v[72:75], a[80:83], a[128:131]
buffer_load_dwordx4 v[112:115], v2, s[8:11], s27 offen offset:3072 sc1
v_mfma_f32_16x16x32_bf16 a[128:131], v[76:79], a[96:99], a[128:131]
v_mfma_f32_16x16x32_bf16 a[132:135], v[72:75], a[84:87], a[132:135]
ds_read_b128 v[64:67], v2 offset:61440
v_mfma_f32_16x16x32_bf16 a[132:135], v[76:79], a[100:103], a[132:135]
v_mfma_f32_16x16x32_bf16 a[136:139], v[72:75], a[88:91], a[136:139]
buffer_load_dwordx4 v[116:119], v4, s[8:11], s27 offen offset:3072 sc1
v_mfma_f32_16x16x32_bf16 a[136:139], v[76:79], a[104:107], a[136:139]
ds_read_b128 v[68:71], v2 offset:62464
v_mfma_f32_16x16x32_bf16 a[140:143], v[72:75], a[92:95], a[140:143]
v_mfma_f32_16x16x32_bf16 a[140:143], v[76:79], a[108:111], a[140:143]
s_waitcnt lgkmcnt(4)
v_mfma_f32_16x16x32_bf16 a[144:147], v[48:51], a[80:83], a[144:147]
buffer_load_dwordx4 v[120:123], v5, s[8:11], s27 offen offset:3072 sc1
v_mfma_f32_16x16x32_bf16 a[144:147], v[52:55], a[96:99], a[144:147]
v_mfma_f32_16x16x32_bf16 a[148:151], v[48:51], a[84:87], a[148:151]
ds_read_b128 v[72:75], v2 offset:63488
v_mfma_f32_16x16x32_bf16 a[148:151], v[52:55], a[100:103], a[148:151]
v_mfma_f32_16x16x32_bf16 a[152:155], v[48:51], a[88:91], a[152:155]
buffer_load_dwordx4 v[124:127], v6, s[8:11], s27 offen offset:3072 sc1
v_mfma_f32_16x16x32_bf16 a[152:155], v[52:55], a[104:107], a[152:155]
ds_read_b128 v[76:79], v2 offset:64512
s_waitcnt vmcnt(16)
v_cmp_eq_u64 vcc, s[68:69], v[14:15]
s_nop 0
s_cmp_eq_u64 vcc, exec
s_cbranch_scc0 L_f_slow3
L_f_back3:
v_mfma_f32_16x16x32_bf16 a[156:159], v[48:51], a[92:95], a[156:159]
v_mfma_f32_16x16x32_bf16 a[156:159], v[52:55], a[108:111], a[156:159]
s_waitcnt lgkmcnt(4)
v_mfma_f32_16x16x32_bf16 a[160:163], v[56:59], a[80:83], a[160:163]
buffer_load_dwordx2 v[128:129], v248, s[8:11], s28 offen offset:0 sc1
v_mfma_f32_16x16x32_bf16 a[160:163], v[60:63], a[96:99], a[160:163]
v_mfma_f32_16x16x32_bf16 a[164:167], v[56:59], a[84:87], a[164:167]
ds_read_b128 v[48:51], v7 offset:0
v_mfma_f32_16x16x32_bf16 a[164:167], v[60:63], a[100:103], a[164:167]
v_mfma_f32_16x16x32_bf16 a[168:171], v[56:59], a[88:91], a[168:171]
buffer_load_dwordx2 v[130:131], v248, s[8:11], s28 offen offset:512 sc1
v_mfma_f32_16x16x32_bf16 a[168:171], v[60:63], a[104:107], a[168:171]
ds_read_b128 v[52:55], v7 offset:1024
v_mfma_f32_16x16x32_bf16 a[172:175], v[56:59], a[92:95], a[172:175]
v_mfma_f32_16x16x32_bf16 a[172:175], v[60:63], a[108:111], a[172:175]
s_waitcnt vmcnt(21)
s_waitcnt lgkmcnt(4)
v_mfma_f32_16x16x32_bf16 a[112:115], v[64:67], v[16:19], a[112:115]
buffer_load_dwordx2 v[132:133], v249, s[8:11], s28 offen offset:0 sc1
v_mfma_f32_16x16x32_bf16 a[112:115], v[68:71], v[32:35], a[112:115]
v_mfma_f32_16x16x32_bf16 a[116:119], v[64:67], v[20:23], a[116:119]
ds_read_b128 v[56:59], v7 offset:2048
v_mfma_f32_16x16x32_bf16 a[116:119], v[68:71], v[36:39], a[116:119]
v_mfma_f32_16x16x32_bf16 a[120:123], v[64:67], v[24:27], a[120:123]
buffer_load_dwordx2 v[134:135], v249, s[8:11], s28 offen offset:512 sc1
v_mfma_f32_16x16x32_bf16 a[120:123], v[68:71], v[40:43], a[120:123]
ds_read_b128 v[60:63], v7 offset:3072
v_mfma_f32_16x16x32_bf16 a[124:127], v[64:67], v[28:31], a[124:127]
v_mfma_f32_16x16x32_bf16 a[124:127], v[68:71], v[44:47], a[124:127]
s_waitcnt lgkmcnt(4)
v_mfma_f32_16x16x32_bf16 a[128:131], v[72:75], v[16:19], a[128:131]
buffer_load_dwordx2 v[136:137], v250, s[8:11], s28 offen offset:0 sc1
v_mfma_f32_16x16x32_bf16 a[128:131], v[76:79], v[32:35], a[128:131]
v_mfma_f32_16x16x32_bf16 a[132:135], v[72:75], v[20:23], a[132:135]
ds_read_b128 v[64:67], v7 offset:4096
v_mfma_f32_16x16x32_bf16 a[132:135], v[76:79], v[36:39], a[132:135]
v_mfma_f32_16x16x32_bf16 a[136:139], v[72:75], v[24:27], a[136:139]
buffer_load_dwordx2 v[138:139], v250, s[8:11], s28 offen offset:512 sc1
v_mfma_f32_16x16x32_bf16 a[136:139], v[76:79], v[40:43], a[136:139]
ds_read_b128 v[68:71], v7 offset:5120
v_mfma_f32_16x16x32_bf16 a[140:143], v[72:75], v[28:31], a[140:143]
v_mfma_f32_16x16x32_bf16 a[140:143], v[76:79], v[44:47], a[140:143]
s_waitcnt lgkmcnt(4)
v_mfma_f32_16x16x32_bf16 a[144:147], v[48:51], v[16:19], a[144:147]
buffer_load_dwordx2 v[140:141], v251, s[8:11], s28 offen offset:0 sc1
v_mfma_f32_16x16x32_bf16 a[144:147], v[52:55], v[32:35], a[144:147]
v_mfma_f32_16x16x32_bf16 a[148:151], v[48:51], v[20:23], a[148:151]
ds_read_b128 v[72:75], v7 offset:6144
v_mfma_f32_16x16x32_bf16 a[148:151], v[52:55], v[36:39], a[148:151]
v_mfma_f32_16x16x32_bf16 a[152:155], v[48:51], v[24:27], a[152:155]
buffer_load_dwordx2 v[142:143], v251, s[8:11], s28 offen offset:512 sc1
v_mfma_f32_16x16x32_bf16 a[152:155], v[52:55], v[40:43], a[152:155]
ds_read_b128 v[76:79], v7 offset:7168
v_mfma_f32_16x16x32_bf16 a[156:159], v[48:51], v[28:31], a[156:159]
v_mfma_f32_16x16x32_bf16 a[156:159], v[52:55], v[44:47], a[156:159]
s_waitcnt lgkmcnt(4)
v_mfma_f32_16x16x32_bf16 a[160:163], v[56:59], v[16:19], a[160:163]
s_waitcnt vmcnt(20)
v_mfma_f32_16x16x32_bf16 a[160:163], v[60:63], v[32:35], a[160:163]
s_barrier
v_mfma_f32_16x16x32_bf16 a[164:167], v[56:59], v[20:23], a[164:167]
ds_read_b128 v[48:51], v7 offset:8192
buffer_load_dwordx2 v[232:233], v248, s[8:11], s29 offen offset:0 sc1
v_mfma_f32_16x16x32_bf16 a[164:167], v[60:63], v[36:39], a[164:167]
v_mfma_f32_16x16x32_bf16 a[168:171], v[56:59], v[24:27], a[168:171]
v_mfma_f32_16x16x32_bf16 a[168:171], v[60:63], v[40:43], a[168:171]
ds_read_b128 v[52:55], v7 offset:9216
v_mfma_f32_16x16x32_bf16 a[172:175], v[56:59], v[28:31], a[172:175]
buffer_load_dwordx2 v[234:235], v248, s[8:11], s29 offen offset:512 sc1
v_mfma_f32_16x16x32_bf16 a[172:175], v[60:63], v[44:47], a[172:175]
s_waitcnt vmcnt(18)
s_waitcnt lgkmcnt(4)
v_mfma_f32_16x16x32_bf16 a[112:115], v[64:67], v[192:195], a[112:115]
v_mfma_f32_16x16x32_bf16 a[112:115], v[68:71], v[80:83], a[112:115]
v_mfma_f32_16x16x32_bf16 a[116:119], v[64:67], v[196:199], a[116:119]
ds_read_b128 v[56:59], v7 offset:10240
v_mfma_f32_16x16x32_bf16 a[116:119], v[68:71], v[84:87], a[116:119]
buffer_load_dwordx2 v[236:237], v249, s[8:11], s29 offen offset:0 sc1
v_mfma_f32_16x16x32_bf16 a[120:123], v[64:67], v[200:203], a[120:123]
v_mfma_f32_16x16x32_bf16 a[120:123], v[68:71], v[88:91], a[120:123]
ds_read_b128 v[60:63], v7 offset:11264
v_mfma_f32_16x16x32_bf16 a[124:127], v[64:67], v[204:207], a[124:127]
v_mfma_f32_16x16x32_bf16 a[124:127], v[68:71], v[92:95], a[124:127]
s_waitcnt lgkmcnt(4)
v_mfma_f32_16x16x32_bf16 a[128:131], v[72:75], v[192:195], a[128:131]
buffer_load_dwordx2 v[238:239], v249, s[8:11], s29 offen offset:512 sc1
v_mfma_f32_16x16x32_bf16 a[128:131], v[76:79], v[80:83], a[128:131]
v_mfma_f32_16x16x32_bf16 a[132:135], v[72:75], v[196:199], a[132:135]
ds_read_b128 v[64:67], v7 offset:12288
L_hop9:
s_cmp_lg_u32 s15, 0
s_cbranch_scc1 L_hop13
v_mfma_f32_16x16x32_bf16 a[132:135], v[76:79], v[84:87], a[132:135]
v_mfma_f32_16x16x32_bf16 a[136:139], v[72:75], v[200:203], a[136:139]
buffer_load_dwordx2 v[240:241], v250, s[8:11], s29 offen offset:0 sc1
v_mfma_f32_16x16x32_bf16 a[136:139], v[76:79], v[88:91], a[136:139]
ds_read_b128 v[68:71], v7 offset:13312
v_mfma_f32_16x16x32_bf16 a[140:143], v[72:75], v[204:207], a[140:143]
v_mfma_f32_16x16x32_bf16 a[140:143], v[76:79], v[92:95], a[140:143]
s_waitcnt lgkmcnt(4)
v_mfma_f32_16x16x32_bf16 a[144:147], v[48:51], v[192:195], a[144:147]
buffer_load_dwordx2 v[242:243], v250, s[8:11], s29 offen offset:512 sc1
v_mfma_f32_16x16x32_bf16 a[144:147], v[52:55], v[80:83], a[144:147]
v_mfma_f32_16x16x32_bf16 a[148:151], v[48:51], v[196:199], a[148:151]
ds_read_b128 v[72:75], v7 offset:14336
v_mfma_f32_16x16x32_bf16 a[148:151], v[52:55], v[84:87], a[148:151]
v_mfma_f32_16x16x32_bf16 a[152:155], v[48:51], v[200:203], a[152:155]
buffer_load_dwordx2 v[244:245], v251, s[8:11], s29 offen offset:0 sc1
v_mfma_f32_16x16x32_bf16 a[152:155], v[52:55], v[88:91], a[152:155]
ds_read_b128 v[76:79], v7 offset:15360
v_mfma_f32_16x16x32_bf16 a[156:159], v[48:51], v[204:207], a[156:159]
v_mfma_f32_16x16x32_bf16 a[156:159], v[52:55], v[92:95], a[156:159]
s_waitcnt lgkmcnt(4)
v_mfma_f32_16x16x32_bf16 a[160:163], v[56:59], v[192:195], a[160:163]
buffer_load_dwordx2 v[246:247], v251, s[8:11], s29 offen offset:512 sc1
v_mfma_f32_16x16x32_bf16 a[160:163], v[60:63], v[80:83], a[160:163]
s_add_u32 m0, s22, 98304
v_add_u32 v3, 20480, v3
v_mfma_f32_16x16x32_bf16 a[164:167], v[56:59], v[196:199], a[164:167]
ds_read_b128 v[48:51], v7 offset:16384
v_mfma_f32_16x16x32_bf16 a[164:167], v[60:63], v[84:87], a[164:167]
v_mfma_f32_16x16x32_bf16 a[168:171], v[56:59], v[200:203], a[168:171]
buffer_load_dwordx4 v3, s[8:11], 0 offen offset:0 sc1 lds
v_mfma_f32_16x16x32_bf16 a[168:171], v[60:63], v[88:91], a[168:171]
ds_read_b128 v[52:55], v7 offset:17408
v_mfma_f32_16x16x32_bf16 a[172:175], v[56:59], v[204:207], a[172:175]
v_mfma_f32_16x16x32_bf16 a[172:175], v[60:63], v[92:95], a[172:175]
s_waitcnt vmcnt(17)
s_waitcnt lgkmcnt(4)
v_mfma_f32_16x16x32_bf16 a[112:115], v[64:67], v[96:99], a[112:115]
buffer_load_dwordx4 v3, s[8:11], 0 offen offset:1024 sc1 lds
v_mfma_f32_16x16x32_bf16 a[112:115], v[68:71], v[112:115], a[112:115]
v_mfma_f32_16x16x32_bf16 a[116:119], v[64:67], v[100:103], a[116:119]
ds_read_b128 v[56:59], v7 offset:18432
v_mfma_f32_16x16x32_bf16 a[116:119], v[68:71], v[116:119], a[116:119]
v_mfma_f32_16x16x32_bf16 a[120:123], v[64:67], v[104:107], a[120:123]
buffer_load_dwordx4 v3, s[8:11], 0 offen offset:2048 sc1 lds
v_mfma_f32_16x16x32_bf16 a[120:123], v[68:71], v[120:123], a[120:123]
ds_read_b128 v[60:63], v7 offset:19456
v_mfma_f32_16x16x32_bf16 a[124:127], v[64:67], v[108:111], a[124:127]
v_mfma_f32_16x16x32_bf16 a[124:127], v[68:71], v[124:127], a[124:127]
s_waitcnt lgkmcnt(4)
v_mfma_f32_16x16x32_bf16 a[128:131], v[72:75], v[96:99], a[128:131]
buffer_load_dwordx4 v3, s[8:11], 0 offen offset:3072 sc1 lds
v_mfma_f32_16x16x32_bf16 a[128:131], v[76:79], v[112:115], a[128:131]
s_add_u32 m0, s22, 102400
v_add_u32 v3, 4096, v3
v_mfma_f32_16x16x32_bf16 a[132:135], v[72:75], v[100:103], a[132:135]
ds_read_b128 v[64:67], v7 offset:20480
v_mfma_f32_16x16x32_bf16 a[132:135], v[76:79], v[116:119], a[132:135]
v_mfma_f32_16x16x32_bf16 a[136:139], v[72:75], v[104:107], a[136:139]
buffer_load_dwordx4 v3, s[8:11], 0 offen offset:0 sc1 lds
v_mfma_f32_16x16x32_bf16 a[136:139], v[76:79], v[120:123], a[136:139]
ds_read_b128 v[68:71], v7 offset:21504
v_mfma_f32_16x16x32_bf16 a[140:143], v[72:75], v[108:111], a[140:143]
v_mfma_f32_16x16x32_bf16 a[140:143], v[76:79], v[124:127], a[140:143]
s_waitcnt lgkmcnt(4)
v_mfma_f32_16x16x32_bf16 a[144:147], v[48:51], v[96:99], a[144:147]
buffer_load_dwordx4 v3, s[8:11], 0 offen offset:1024 sc1 lds
v_mfma_f32_16x16x32_bf16 a[144:147], v[52:55], v[112:115], a[144:147]
s_add_u32 m0, s22, 122880
v_add_u32 v3, 20480, v3
v_mfma_f32_16x16x32_bf16 a[148:151], v[48:51], v[100:103], a[148:151]
ds_read_b128 v[72:75], v7 offset:22528
v_mfma_f32_16x16x32_bf16 a[148:151], v[52:55], v[116:119], a[148:151]
v_mfma_f32_16x16x32_bf16 a[152:155], v[48:51], v[104:107], a[152:155]
v_mfma_f32_16x16x32_bf16 a[152:155], v[52:55], v[120:123], a[152:155]
ds_read_b128 v[76:79], v7 offset:23552
v_mfma_f32_16x16x32_bf16 a[156:159], v[48:51], v[108:111], a[156:159]
buffer_load_dwordx4 v3, s[8:11], 0 offen offset:0 sc1 lds
v_mfma_f32_16x16x32_bf16 a[156:159], v[52:55], v[124:127], a[156:159]
s_waitcnt lgkmcnt(4)
v_mfma_f32_16x16x32_bf16 a[160:163], v[56:59], v[96:99], a[160:163]
v_mfma_f32_16x16x32_bf16 a[160:163], v[60:63], v[112:115], a[160:163]
v_mfma_f32_16x16x32_bf16 a[164:167], v[56:59], v[100:103], a[164:167]
ds_read_b128 v[48:51], v7 offset:24576
v_mfma_f32_16x16x32_bf16 a[164:167], v[60:63], v[116:119], a[164:167]
buffer_load_dwordx4 v3, s[8:11], 0 offen offset:1024 sc1 lds
v_mfma_f32_16x16x32_bf16 a[168:171], v[56:59], v[104:107], a[168:171]
v_mfma_f32_16x16x32_bf16 a[168:171], v[60:63], v[120:123], a[168:171]
ds_read_b128 v[52:55], v7 offset:25600
v_mfma_f32_16x16x32_bf16 a[172:175], v[56:59], v[108:111], a[172:175]
v_mfma_f32_16x16x32_bf16 a[172:175], v[60:63], v[124:127], a[172:175]
s_waitcnt vmcnt(8)
s_waitcnt lgkmcnt(4)
v_mfma_f32_16x16x32_bf16 a[112:115], v[64:67], v[128:131], a[112:115]
buffer_load_dwordx4 v3, s[8:11], 0 offen offset:2048 sc1 lds
v_mfma_f32_16x16x32_bf16 a[112:115], v[68:71], v[232:235], a[112:115]
v_mfma_f32_16x16x32_bf16 a[116:119], v[64:67], v[132:135], a[116:119]
ds_read_b128 v[56:59], v7 offset:26624
v_mfma_f32_16x16x32_bf16 a[116:119], v[68:71], v[236:239], a[116:119]
v_mfma_f32_16x16x32_bf16 a[120:123], v[64:67], v[136:139], a[120:123]
v_mfma_f32_16x16x32_bf16 a[120:123], v[68:71], v[240:243], a[120:123]
ds_read_b128 v[60:63], v7 offset:27648
v_mfma_f32_16x16x32_bf16 a[124:127], v[64:67], v[140:143], a[124:127]
buffer_load_dwordx4 v3, s[8:11], 0 offen offset:3072 sc1 lds
v_mfma_f32_16x16x32_bf16 a[124:127], v[68:71], v[244:247], a[124:127]
s_add_u32 m0, s22, 126976
s_waitcnt lgkmcnt(4)
v_mfma_f32_16x16x32_bf16 a[128:131], v[72:75], v[128:131], a[128:131]
v_add_u32 v3, 4096, v3
v_mfma_f32_16x16x32_bf16 a[128:131], v[76:79], v[232:235], a[128:131]
v_mfma_f32_16x16x32_bf16 a[132:135], v[72:75], v[132:135], a[132:135]
ds_read_b128 v[64:67], v7 offset:28672
v_mfma_f32_16x16x32_bf16 a[132:135], v[76:79], v[236:239], a[132:135]
buffer_load_dwordx4 v3, s[8:11], 0 offen offset:0 sc1 lds
v_mfma_f32_16x16x32_bf16 a[136:139], v[72:75], v[136:139], a[136:139]
v_mfma_f32_16x16x32_bf16 a[136:139], v[76:79], v[240:243], a[136:139]
ds_read_b128 v[68:71], v7 offset:29696
v_mfma_f32_16x16x32_bf16 a[140:143], v[72:75], v[140:143], a[140:143]
v_mfma_f32_16x16x32_bf16 a[140:143], v[76:79], v[244:247], a[140:143]
s_waitcnt lgkmcnt(4)
v_mfma_f32_16x16x32_bf16 a[144:147], v[48:51], v[128:131], a[144:147]
buffer_load_dwordx4 v3, s[8:11], 0 offen offset:1024 sc1 lds
v_mfma_f32_16x16x32_bf16 a[144:147], v[52:55], v[232:235], a[144:147]
s_lshl_b32 s21, s4, 11
s_add_u32 m0, s21, 0
v_mfma_f32_16x16x32_bf16 a[148:151], v[48:51], v[132:135], a[148:151]
ds_read_b128 v[72:75], v7 offset:30720
s_sub_u32 s21, s21, s22
v_mfma_f32_16x16x32_bf16 a[148:151], v[52:55], v[236:239], a[148:151]
s_add_u32 s21, s21, 20480
v_add_u32 v3, s21, v3
v_mfma_f32_16x16x32_bf16 a[152:155], v[48:51], v[136:139], a[152:155]
v_mfma_f32_16x16x32_bf16 a[152:155], v[52:55], v[240:243], a[152:155]
ds_read_b128 v[76:79], v7 offset:31744
v_mfma_f32_16x16x32_bf16 a[156:159], v[48:51], v[140:143], a[156:159]
buffer_load_dwordx4 v3, s[8:11], 0 offen offset:0 sc1 lds
v_mfma_f32_16x16x32_bf16 a[156:159], v[52:55], v[244:247], a[156:159]
s_waitcnt lgkmcnt(4)
v_mfma_f32_16x16x32_bf16 a[160:163], v[56:59], v[128:131], a[160:163]
s_waitcnt vmcnt(7)
v_mfma_f32_16x16x32_bf16 a[160:163], v[60:63], v[232:235], a[160:163]
s_barrier
v_mfma_f32_16x16x32_bf16 a[164:167], v[56:59], v[132:135], a[164:167]
ds_read_b128 v[48:51], v7 offset:32768
v_mfma_f32_16x16x32_bf16 a[164:167], v[60:63], v[236:239], a[164:167]
buffer_load_dwordx4 v3, s[8:11], 0 offen offset:1024 sc1 lds
v_mfma_f32_16x16x32_bf16 a[168:171], v[56:59], v[136:139], a[168:171]
v_mfma_f32_16x16x32_bf16 a[168:171], v[60:63], v[240:243], a[168:171]
ds_read_b128 v[52:55], v7 offset:33792
v_mfma_f32_16x16x32_bf16 a[172:175], v[56:59], v[140:143], a[172:175]
v_mfma_f32_16x16x32_bf16 a[172:175], v[60:63], v[244:247], a[172:175]
s_waitcnt lgkmcnt(4)
v_mfma_f32_16x16x32_bf16 a[176:179], v[64:67], a[80:83], a[176:179]
v_mfma_f32_16x16x32_bf16 a[176:179], v[68:71], a[96:99], a[176:179]
ds_read_b128 v[56:59], v7 offset:34816
v_mfma_f32_16x16x32_bf16 a[180:183], v[64:67], a[84:87], a[180:183]
ds_read_b128 v[60:63], v7 offset:35840
v_mfma_f32_16x16x32_bf16 a[180:183], v[68:71], a[100:103], a[180:183]
v_accvgpr_read_b32 v208, a112
s_waitcnt lgkmcnt(4)
v_mfma_f32_16x16x32_bf16 a[192:195], v[72:75], a[80:83], a[192:195]
v_accvgpr_read_b32 v209, a128
v_accvgpr_read_b32 v210, a144
v_mfma_f32_16x16x32_bf16 a[192:195], v[76:79], a[96:99], a[192:195]
ds_read_b128 v[64:67], v7 offset:36864
v_accvgpr_read_b32 v211, a160
v_mfma_f32_16x16x32_bf16 a[196:199], v[72:75], a[84:87], a[196:199]
ds_read_b128 v[68:71], v7 offset:37888
v_accvgpr_read_b32 v212, a113
v_mfma_f32_16x16x32_bf16 a[196:199], v[76:79], a[100:103], a[196:199]
v_accvgpr_read_b32 v213, a129
s_waitcnt lgkmcnt(4)
v_mfma_f32_16x16x32_bf16 a[208:211], v[48:51], a[80:83], a[208:211]
v_accvgpr_read_b32 v214, a145
v_accvgpr_read_b32 v215, a161
v_mfma_f32_16x16x32_bf16 a[208:211], v[52:55], a[96:99], a[208:211]
ds_read_b128 v[72:75], v7 offset:38912
v_cvt_pk_bf16_f32 v224, v208, v209
v_mfma_f32_16x16x32_bf16 a[212:215], v[48:51], a[84:87], a[212:215]
ds_read_b128 v[76:79], v7 offset:39936
v_cvt_pk_bf16_f32 v225, v210, v211
v_mfma_f32_16x16x32_bf16 a[212:215], v[52:55], a[100:103], a[212:215]
v_cvt_pk_bf16_f32 v226, v212, v213
s_waitcnt lgkmcnt(4)
v_mfma_f32_16x16x32_bf16 a[224:227], v[56:59], a[80:83], a[224:227]
v_cvt_pk_bf16_f32 v227, v214, v215
v_accvgpr_read_b32 v216, a114
v_mfma_f32_16x16x32_bf16 a[224:227], v[60:63], a[96:99], a[224:227]
ds_read_b128 v[48:51], v7 offset:40960
v_accvgpr_read_b32 v217, a130
v_mfma_f32_16x16x32_bf16 a[228:231], v[56:59], a[84:87], a[228:231]
ds_read_b128 v[52:55], v7 offset:41984
v_accvgpr_read_b32 v218, a146
v_mfma_f32_16x16x32_bf16 a[228:231], v[60:63], a[100:103], a[228:231]
v_accvgpr_read_b32 v219, a162
s_waitcnt lgkmcnt(4)
v_mfma_f32_16x16x32_bf16 a[176:179], v[64:67], v[16:19], a[176:179]
buffer_store_dwordx4 v[224:227], v252, s[8:11], s36 offen offset:0 sc1
v_mfma_f32_16x16x32_bf16 a[176:179], v[68:71], v[32:35], a[176:179]
ds_read_b128 v[56:59], v7 offset:43008
v_accvgpr_read_b32 v220, a115
v_mfma_f32_16x16x32_bf16 a[180:183], v[64:67], v[20:23], a[180:183]
ds_read_b128 v[60:63], v7 offset:44032
v_accvgpr_read_b32 v221, a131
v_mfma_f32_16x16x32_bf16 a[180:183], v[68:71], v[36:39], a[180:183]
v_accvgpr_read_b32 v222, a147
s_waitcnt lgkmcnt(4)
v_mfma_f32_16x16x32_bf16 a[192:195], v[72:75], v[16:19], a[192:195]
v_accvgpr_read_b32 v223, a163
v_cvt_pk_bf16_f32 v228, v216, v217
v_mfma_f32_16x16x32_bf16 a[192:195], v[76:79], v[32:35], a[192:195]
ds_read_b128 v[64:67], v7 offset:45056
v_cvt_pk_bf16_f32 v229, v218, v219
v_mfma_f32_16x16x32_bf16 a[196:199], v[72:75], v[20:23], a[196:199]
ds_read_b128 v[68:71], v7 offset:46080
v_cvt_pk_bf16_f32 v230, v220, v221
v_mfma_f32_16x16x32_bf16 a[196:199], v[76:79], v[36:39], a[196:199]
v_cvt_pk_bf16_f32 v231, v222, v223
s_waitcnt lgkmcnt(4)
v_mfma_f32_16x16x32_bf16 a[208:211], v[48:51], v[16:19], a[208:211]
buffer_store_dwordx4 v[228:231], v252, s[8:11], s36 offen offset:256 sc1
v_mfma_f32_16x16x32_bf16 a[208:211], v[52:55], v[32:35], a[208:211]
ds_read_b128 v[72:75], v7 offset:47104
v_accvgpr_read_b32 v208, a116
v_mfma_f32_16x16x32_bf16 a[212:215], v[48:51], v[20:23], a[212:215]
ds_read_b128 v[76:79], v7 offset:48128
v_accvgpr_read_b32 v209, a132
v_mfma_f32_16x16x32_bf16 a[212:215], v[52:55], v[36:39], a[212:215]
v_accvgpr_read_b32 v210, a148
s_waitcnt lgkmcnt(4)
v_mfma_f32_16x16x32_bf16 a[224:227], v[56:59], v[16:19], a[224:227]
v_accvgpr_read_b32 v211, a164
v_accvgpr_read_b32 v212, a117
v_mfma_f32_16x16x32_bf16 a[224:227], v[60:63], v[32:35], a[224:227]
ds_read_b128 v[48:51], v7 offset:49152
v_accvgpr_read_b32 v213, a133
v_mfma_f32_16x16x32_bf16 a[228:231], v[56:59], v[20:23], a[228:231]
ds_read_b128 v[52:55], v7 offset:50176
v_accvgpr_read_b32 v214, a149
v_mfma_f32_16x16x32_bf16 a[228:231], v[60:63], v[36:39], a[228:231]
v_accvgpr_read_b32 v215, a165
s_waitcnt lgkmcnt(4)
v_mfma_f32_16x16x32_bf16 a[176:179], v[64:67], v[192:195], a[176:179]
v_cvt_pk_bf16_f32 v224, v208, v209
v_cvt_pk_bf16_f32 v225, v210, v211
v_mfma_f32_16x16x32_bf16 a[176:179], v[68:71], v[80:83], a[176:179]
ds_read_b128 v[56:59], v7 offset:51200
v_cvt_pk_bf16_f32 v226, v212, v213
v_mfma_f32_16x16x32_bf16 a[180:183], v[64:67], v[196:199], a[180:183]
ds_read_b128 v[60:63], v7 offset:52224
v_cvt_pk_bf16_f32 v227, v214, v215
v_mfma_f32_16x16x32_bf16 a[180:183], v[68:71], v[84:87], a[180:183]
v_accvgpr_read_b32 v216, a118
s_waitcnt lgkmcnt(4)
v_mfma_f32_16x16x32_bf16 a[192:195], v[72:75], v[192:195], a[192:195]
buffer_store_dwordx4 v[224:227], v252, s[8:11], s37 offen offset:0 sc1
v_mfma_f32_16x16x32_bf16 a[192:195], v[76:79], v[80:83], a[192:195]
ds_read_b128 v[64:67], v7 offset:53248
v_accvgpr_read_b32 v217, a134
v_mfma_f32_16x16x32_bf16 a[196:199], v[72:75], v[196:199], a[196:199]
ds_read_b128 v[68:71], v7 offset:54272
v_accvgpr_read_b32 v218, a150
v_mfma_f32_16x16x32_bf16 a[196:199], v[76:79], v[84:87], a[196:199]
v_accvgpr_read_b32 v219, a166
s_waitcnt lgkmcnt(4)
v_mfma_f32_16x16x32_bf16 a[208:211], v[48:51], v[192:195], a[208:211]
v_accvgpr_read_b32 v220, a119
v_accvgpr_read_b32 v221, a135
v_mfma_f32_16x16x32_bf16 a[208:211], v[52:55], v[80:83], a[208:211]
ds_read_b128 v[72:75], v7 offset:55296
v_accvgpr_read_b32 v222, a151
v_mfma_f32_16x16x32_bf16 a[212:215], v[48:51], v[196:199], a[212:215]
ds_read_b128 v[76:79], v7 offset:56320
v_accvgpr_read_b32 v223, a167
v_mfma_f32_16x16x32_bf16 a[212:215], v[52:55], v[84:87], a[212:215]
v_cvt_pk_bf16_f32 v228, v216, v217
s_waitcnt lgkmcnt(4)
v_mfma_f32_16x16x32_bf16 a[224:227], v[56:59], v[192:195], a[224:227]
s_waitcnt vmcnt(5)
v_cvt_pk_bf16_f32 v229, v218, v219
v_mfma_f32_16x16x32_bf16 a[224:227], v[60:63], v[80:83], a[224:227]
s_barrier
v_mfma_f32_16x16x32_bf16 a[228:231], v[56:59], v[196:199], a[228:231]
ds_read_b128 v[48:51], v7 offset:57344
v_cvt_pk_bf16_f32 v230, v220, v221
v_mfma_f32_16x16x32_bf16 a[228:231], v[60:63], v[84:87], a[228:231]
ds_read_b128 v[52:55], v7 offset:58368
v_cvt_pk_bf16_f32 v231, v222, v223
s_waitcnt lgkmcnt(4)
v_mfma_f32_16x16x32_bf16 a[176:179], v[64:67], v[96:99], a[176:179]
buffer_store_dwordx4 v[228:231], v252, s[8:11], s37 offen offset:256 sc1
v_mfma_f32_16x16x32_bf16 a[176:179], v[68:71], v[112:115], a[176:179]
ds_read_b128 v[56:59], v7 offset:59392
v_accvgpr_read_b32 v208, a120
v_mfma_f32_16x16x32_bf16 a[180:183], v[64:67], v[100:103], a[180:183]
ds_read_b128 v[60:63], v7 offset:60416
v_accvgpr_read_b32 v209, a136
v_mfma_f32_16x16x32_bf16 a[180:183], v[68:71], v[116:119], a[180:183]
v_accvgpr_read_b32 v210, a152
s_waitcnt lgkmcnt(4)
v_mfma_f32_16x16x32_bf16 a[192:195], v[72:75], v[96:99], a[192:195]
v_accvgpr_read_b32 v211, a168
v_accvgpr_read_b32 v212, a121
v_mfma_f32_16x16x32_bf16 a[192:195], v[76:79], v[112:115], a[192:195]
ds_read_b128 v[64:67], v7 offset:61440
v_accvgpr_read_b32 v213, a137
v_mfma_f32_16x16x32_bf16 a[196:199], v[72:75], v[100:103], a[196:199]
ds_read_b128 v[68:71], v7 offset:62464
v_accvgpr_read_b32 v214, a153
v_mfma_f32_16x16x32_bf16 a[196:199], v[76:79], v[116:119], a[196:199]
v_accvgpr_read_b32 v215, a169
s_waitcnt lgkmcnt(4)
v_mfma_f32_16x16x32_bf16 a[208:211], v[48:51], v[96:99], a[208:211]
v_cvt_pk_bf16_f32 v224, v208, v209
v_cvt_pk_bf16_f32 v225, v210, v211
v_mfma_f32_16x16x32_bf16 a[208:211], v[52:55], v[112:115], a[208:211]
ds_read_b128 v[72:75], v7 offset:63488
v_cvt_pk_bf16_f32 v226, v212, v213
v_mfma_f32_16x16x32_bf16 a[212:215], v[48:51], v[100:103], a[212:215]
ds_read_b128 v[76:79], v7 offset:64512
v_cvt_pk_bf16_f32 v227, v214, v215
v_mfma_f32_16x16x32_bf16 a[212:215], v[52:55], v[116:119], a[212:215]
buffer_store_dwordx4 v[224:227], v252, s[8:11], s38 offen offset:0 sc1
s_waitcnt lgkmcnt(4)
v_mfma_f32_16x16x32_bf16 a[224:227], v[56:59], v[96:99], a[224:227]
v_accvgpr_read_b32 v216, a122
v_accvgpr_read_b32 v217, a138
v_mfma_f32_16x16x32_bf16 a[224:227], v[60:63], v[112:115], a[224:227]
ds_read_b128 v[48:51], v8 offset:0
v_accvgpr_read_b32 v218, a154
v_mfma_f32_16x16x32_bf16 a[228:231], v[56:59], v[100:103], a[228:231]
ds_read_b128 v[52:55], v8 offset:1024
v_accvgpr_read_b32 v219, a170
v_mfma_f32_16x16x32_bf16 a[228:231], v[60:63], v[116:119], a[228:231]
v_accvgpr_read_b32 v220, a123
s_waitcnt lgkmcnt(4)
v_mfma_f32_16x16x32_bf16 a[176:179], v[64:67], v[128:131], a[176:179]
v_accvgpr_read_b32 v221, a139
v_accvgpr_read_b32 v222, a155
v_mfma_f32_16x16x32_bf16 a[176:179], v[68:71], v[232:235], a[176:179]
ds_read_b128 v[56:59], v8 offset:2048
v_accvgpr_read_b32 v223, a171
v_mfma_f32_16x16x32_bf16 a[180:183], v[64:67], v[132:135], a[180:183]
ds_read_b128 v[60:63], v8 offset:3072
v_cvt_pk_bf16_f32 v228, v216, v217
v_mfma_f32_16x16x32_bf16 a[180:183], v[68:71], v[236:239], a[180:183]
v_cvt_pk_bf16_f32 v229, v218, v219
s_waitcnt lgkmcnt(4)
v_mfma_f32_16x16x32_bf16 a[192:195], v[72:75], v[128:131], a[192:195]
v_cvt_pk_bf16_f32 v230, v220, v221
v_cvt_pk_bf16_f32 v231, v222, v223
v_mfma_f32_16x16x32_bf16 a[192:195], v[76:79], v[232:235], a[192:195]
ds_read_b128 v[64:67], v7 offset:28672
buffer_store_dwordx4 v[228:231], v252, s[8:11], s38 offen offset:256 sc1
v_mfma_f32_16x16x32_bf16 a[196:199], v[72:75], v[132:135], a[196:199]
ds_read_b128 v[68:71], v7 offset:29696
v_accvgpr_read_b32 v208, a124
v_mfma_f32_16x16x32_bf16 a[196:199], v[76:79], v[236:239], a[196:199]
v_accvgpr_read_b32 v209, a140
s_waitcnt lgkmcnt(4)
v_mfma_f32_16x16x32_bf16 a[208:211], v[48:51], v[128:131], a[208:211]
v_accvgpr_read_b32 v210, a156
v_accvgpr_read_b32 v211, a172
v_mfma_f32_16x16x32_bf16 a[208:211], v[52:55], v[232:235], a[208:211]
ds_read_b128 v[72:75], v7 offset:30720
v_accvgpr_read_b32 v212, a125
v_mfma_f32_16x16x32_bf16 a[212:215], v[48:51], v[132:135], a[212:215]
ds_read_b128 v[76:79], v7 offset:31744
v_accvgpr_read_b32 v213, a141
v_mfma_f32_16x16x32_bf16 a[212:215], v[52:55], v[236:239], a[212:215]
v_accvgpr_read_b32 v214, a157
s_waitcnt lgkmcnt(4)
v_mfma_f32_16x16x32_bf16 a[224:227], v[56:59], v[128:131], a[224:227]
v_accvgpr_read_b32 v215, a173
v_cvt_pk_bf16_f32 v224, v208, v209
v_mfma_f32_16x16x32_bf16 a[224:227], v[60:63], v[232:235], a[224:227]
ds_read_b128 v[48:51], v7 offset:32768
v_cvt_pk_bf16_f32 v225, v210, v211
v_mfma_f32_16x16x32_bf16 a[228:231], v[56:59], v[132:135], a[228:231]
ds_read_b128 v[52:55], v7 offset:33792
v_cvt_pk_bf16_f32 v226, v212, v213
v_mfma_f32_16x16x32_bf16 a[228:231], v[60:63], v[236:239], a[228:231]
v_cvt_pk_bf16_f32 v227, v214, v215
buffer_store_dwordx4 v[224:227], v252, s[8:11], s39 offen offset:0 sc1
v_accvgpr_read_b32 v216, a126
v_accvgpr_read_b32 v217, a142
v_accvgpr_read_b32 v218, a158
v_accvgpr_read_b32 v219, a174
v_accvgpr_read_b32 v220, a127
v_accvgpr_read_b32 v221, a143
v_accvgpr_read_b32 v222, a159
v_accvgpr_read_b32 v223, a175
v_cvt_pk_bf16_f32 v228, v216, v217
v_cvt_pk_bf16_f32 v229, v218, v219
v_cvt_pk_bf16_f32 v230, v220, v221
v_cvt_pk_bf16_f32 v231, v222, v223
buffer_store_dwordx4 v[228:231], v252, s[8:11], s39 offen offset:256 sc1
s_waitcnt lgkmcnt(4)
v_mfma_f32_16x16x32_bf16 a[184:187], v[64:67], a[88:91], a[184:187]
v_mfma_f32_16x16x32_bf16 a[184:187], v[68:71], a[104:107], a[184:187]
ds_read_b128 v[56:59], v7 offset:34816
v_mfma_f32_16x16x32_bf16 a[188:191], v[64:67], a[92:95], a[188:191]
ds_read_b128 v[60:63], v7 offset:35840
v_mfma_f32_16x16x32_bf16 a[188:191], v[68:71], a[108:111], a[188:191]
v_accvgpr_read_b32 v208, a176
s_waitcnt lgkmcnt(4)
v_mfma_f32_16x16x32_bf16 a[200:203], v[72:75], a[88:91], a[200:203]
v_accvgpr_read_b32 v209, a192
v_accvgpr_read_b32 v210, a208
v_mfma_f32_16x16x32_bf16 a[200:203], v[76:79], a[104:107], a[200:203]
ds_read_b128 v[64:67], v7 offset:36864
v_accvgpr_read_b32 v211, a224
v_mfma_f32_16x16x32_bf16 a[204:207], v[72:75], a[92:95], a[204:207]
ds_read_b128 v[68:71], v7 offset:37888
v_accvgpr_read_b32 v212, a177
v_mfma_f32_16x16x32_bf16 a[204:207], v[76:79], a[108:111], a[204:207]
v_accvgpr_read_b32 v213, a193
s_waitcnt lgkmcnt(4)
v_mfma_f32_16x16x32_bf16 a[216:219], v[48:51], a[88:91], a[216:219]
v_accvgpr_read_b32 v214, a209
v_accvgpr_read_b32 v215, a225
v_mfma_f32_16x16x32_bf16 a[216:219], v[52:55], a[104:107], a[216:219]
ds_read_b128 v[72:75], v7 offset:38912
v_cvt_pk_bf16_f32 v224, v208, v209
v_mfma_f32_16x16x32_bf16 a[220:223], v[48:51], a[92:95], a[220:223]
ds_read_b128 v[76:79], v7 offset:39936
v_cvt_pk_bf16_f32 v225, v210, v211
v_mfma_f32_16x16x32_bf16 a[220:223], v[52:55], a[108:111], a[220:223]
v_cvt_pk_bf16_f32 v226, v212, v213
s_waitcnt lgkmcnt(4)
v_mfma_f32_16x16x32_bf16 a[232:235], v[56:59], a[88:91], a[232:235]
v_cvt_pk_bf16_f32 v227, v214, v215
v_accvgpr_read_b32 v216, a178
v_mfma_f32_16x16x32_bf16 a[232:235], v[60:63], a[104:107], a[232:235]
ds_read_b128 v[48:51], v7 offset:40960
v_accvgpr_read_b32 v217, a194
v_mfma_f32_16x16x32_bf16 a[236:239], v[56:59], a[92:95], a[236:239]
ds_read_b128 v[52:55], v7 offset:41984
v_accvgpr_read_b32 v218, a210
v_mfma_f32_16x16x32_bf16 a[236:239], v[60:63], a[108:111], a[236:239]
v_accvgpr_read_b32 v219, a226
s_waitcnt lgkmcnt(4)
v_mfma_f32_16x16x32_bf16 a[184:187], v[64:67], v[24:27], a[184:187]
buffer_store_dwordx4 v[224:227], v252, s[8:11], s36 offen offset:2048 sc1
v_mfma_f32_16x16x32_bf16 a[184:187], v[68:71], v[40:43], a[184:187]
ds_read_b128 v[56:59], v7 offset:43008
v_accvgpr_read_b32 v220, a179
v_mfma_f32_16x16x32_bf16 a[188:191], v[64:67], v[28:31], a[188:191]
ds_read_b128 v[60:63], v7 offset:44032
v_accvgpr_read_b32 v221, a195
v_mfma_f32_16x16x32_bf16 a[188:191], v[68:71], v[44:47], a[188:191]
v_accvgpr_read_b32 v222, a211
s_waitcnt lgkmcnt(4)
v_mfma_f32_16x16x32_bf16 a[200:203], v[72:75], v[24:27], a[200:203]
v_accvgpr_read_b32 v223, a227
v_cvt_pk_bf16_f32 v228, v216, v217
v_mfma_f32_16x16x32_bf16 a[200:203], v[76:79], v[40:43], a[200:203]
ds_read_b128 v[64:67], v7 offset:45056
v_cvt_pk_bf16_f32 v229, v218, v219
v_mfma_f32_16x16x32_bf16 a[204:207], v[72:75], v[28:31], a[204:207]
ds_read_b128 v[68:71], v7 offset:46080
v_cvt_pk_bf16_f32 v230, v220, v221
v_mfma_f32_16x16x32_bf16 a[204:207], v[76:79], v[44:47], a[204:207]
v_cvt_pk_bf16_f32 v231, v222, v223
s_waitcnt lgkmcnt(4)
v_mfma_f32_16x16x32_bf16 a[216:219], v[48:51], v[24:27], a[216:219]
buffer_store_dwordx4 v[228:231], v252, s[8:11], s36 offen offset:2304 sc1
v_mfma_f32_16x16x32_bf16 a[216:219], v[52:55], v[40:43], a[216:219]
ds_read_b128 v[72:75], v7 offset:47104
v_accvgpr_read_b32 v208, a180
v_mfma_f32_16x16x32_bf16 a[220:223], v[48:51], v[28:31], a[220:223]
ds_read_b128 v[76:79], v7 offset:48128
v_accvgpr_read_b32 v209, a196
v_mfma_f32_16x16x32_bf16 a[220:223], v[52:55], v[44:47], a[220:223]
v_accvgpr_read_b32 v210, a212
s_waitcnt lgkmcnt(4)
v_mfma_f32_16x16x32_bf16 a[232:235], v[56:59], v[24:27], a[232:235]
v_accvgpr_read_b32 v211, a228
v_accvgpr_read_b32 v212, a181
v_mfma_f32_16x16x32_bf16 a[232:235], v[60:63], v[40:43], a[232:235]
ds_read_b128 v[48:51], v7 offset:49152
v_accvgpr_read_b32 v213, a197
v_mfma_f32_16x16x32_bf16 a[236:239], v[56:59], v[28:31], a[236:239]
ds_read_b128 v[52:55], v7 offset:50176
v_accvgpr_read_b32 v214, a213
v_mfma_f32_16x16x32_bf16 a[236:239], v[60:63], v[44:47], a[236:239]
v_accvgpr_read_b32 v215, a229
s_waitcnt lgkmcnt(4)
v_mfma_f32_16x16x32_bf16 a[184:187], v[64:67], v[200:203], a[184:187]
v_cvt_pk_bf16_f32 v224, v208, v209
v_cvt_pk_bf16_f32 v225, v210, v211
v_mfma_f32_16x16x32_bf16 a[184:187], v[68:71], v[88:91], a[184:187]
ds_read_b128 v[56:59], v7 offset:51200
v_cvt_pk_bf16_f32 v226, v212, v213
v_mfma_f32_16x16x32_bf16 a[188:191], v[64:67], v[204:207], a[188:191]
ds_read_b128 v[60:63], v7 offset:52224
v_cvt_pk_bf16_f32 v227, v214, v215
v_mfma_f32_16x16x32_bf16 a[188:191], v[68:71], v[92:95], a[188:191]
v_accvgpr_read_b32 v216, a182
s_waitcnt lgkmcnt(4)
v_mfma_f32_16x16x32_bf16 a[200:203], v[72:75], v[200:203], a[200:203]
buffer_store_dwordx4 v[224:227], v252, s[8:11], s37 offen offset:2048 sc1
v_mfma_f32_16x16x32_bf16 a[200:203], v[76:79], v[88:91], a[200:203]
ds_read_b128 v[64:67], v7 offset:53248
v_accvgpr_read_b32 v217, a198
v_mfma_f32_16x16x32_bf16 a[204:207], v[72:75], v[204:207], a[204:207]
ds_read_b128 v[68:71], v7 offset:54272
v_accvgpr_read_b32 v218, a214
v_mfma_f32_16x16x32_bf16 a[204:207], v[76:79], v[92:95], a[204:207]
v_accvgpr_read_b32 v219, a230
s_waitcnt lgkmcnt(4)
v_mfma_f32_16x16x32_bf16 a[216:219], v[48:51], v[200:203], a[216:219]
v_accvgpr_read_b32 v220, a183
v_accvgpr_read_b32 v221, a199
v_mfma_f32_16x16x32_bf16 a[216:219], v[52:55], v[88:91], a[216:219]
ds_read_b128 v[72:75], v7 offset:55296
v_accvgpr_read_b32 v222, a215
v_mfma_f32_16x16x32_bf16 a[220:223], v[48:51], v[204:207], a[220:223]
ds_read_b128 v[76:79], v7 offset:56320
v_accvgpr_read_b32 v223, a231
v_mfma_f32_16x16x32_bf16 a[220:223], v[52:55], v[92:95], a[220:223]
v_cvt_pk_bf16_f32 v228, v216, v217
s_waitcnt lgkmcnt(4)
v_mfma_f32_16x16x32_bf16 a[232:235], v[56:59], v[200:203], a[232:235]
v_cvt_pk_bf16_f32 v229, v218, v219
v_cvt_pk_bf16_f32 v230, v220, v221
v_mfma_f32_16x16x32_bf16 a[232:235], v[60:63], v[88:91], a[232:235]
ds_read_b128 v[48:51], v7 offset:57344
v_cvt_pk_bf16_f32 v231, v222, v223
v_mfma_f32_16x16x32_bf16 a[236:239], v[56:59], v[204:207], a[236:239]
ds_read_b128 v[52:55], v7 offset:58368
v_mfma_f32_16x16x32_bf16 a[236:239], v[60:63], v[92:95], a[236:239]
s_waitcnt lgkmcnt(4)
v_mfma_f32_16x16x32_bf16 a[184:187], v[64:67], v[104:107], a[184:187]
s_waitcnt vmcnt(3)
v_mov_b32 v12, s68
v_mfma_f32_16x16x32_bf16 a[184:187], v[68:71], v[120:123], a[184:187]
s_barrier
v_mfma_f32_16x16x32_bf16 a[188:191], v[64:67], v[108:111], a[188:191]
L_hop10:
s_cmp_lg_u32 s15, 0
s_cbranch_scc1 L_hop14
ds_read_b128 v[56:59], v7 offset:59392
v_mov_b32 v13, s69
v_mfma_f32_16x16x32_bf16 a[188:191], v[68:71], v[124:127], a[188:191]
ds_read_b128 v[60:63], v7 offset:60416
s_waitcnt lgkmcnt(4)
v_mfma_f32_16x16x32_bf16 a[200:203], v[72:75], v[104:107], a[200:203]
buffer_store_dwordx4 v[228:231], v252, s[8:11], s37 offen offset:2304 sc1
v_mfma_f32_16x16x32_bf16 a[200:203], v[76:79], v[120:123], a[200:203]
ds_read_b128 v[64:67], v7 offset:61440
v_mfma_f32_16x16x32_bf16 a[204:207], v[72:75], v[108:111], a[204:207]
ds_read_b128 v[68:71], v7 offset:62464
v_mfma_f32_16x16x32_bf16 a[204:207], v[76:79], v[124:127], a[204:207]
s_waitcnt lgkmcnt(4)
v_mfma_f32_16x16x32_bf16 a[216:219], v[48:51], v[104:107], a[216:219]
buffer_store_dwordx2 v[12:13], v10, s[8:11], s44 offen sc1
v_mfma_f32_16x16x32_bf16 a[216:219], v[52:55], v[120:123], a[216:219]
ds_read_b128 v[72:75], v7 offset:63488
v_mfma_f32_16x16x32_bf16 a[220:223], v[48:51], v[108:111], a[220:223]
ds_read_b128 v[76:79], v7 offset:64512
v_mfma_f32_16x16x32_bf16 a[220:223], v[52:55], v[124:127], a[220:223]
s_waitcnt lgkmcnt(4)
v_mfma_f32_16x16x32_bf16 a[232:235], v[56:59], v[104:107], a[232:235]
v_mfma_f32_16x16x32_bf16 a[232:235], v[60:63], v[120:123], a[232:235]
ds_read_b128 v[48:51], v8 offset:0
v_mfma_f32_16x16x32_bf16 a[236:239], v[56:59], v[108:111], a[236:239]
ds_read_b128 v[52:55], v8 offset:1024
v_mfma_f32_16x16x32_bf16 a[236:239], v[60:63], v[124:127], a[236:239]
s_waitcnt lgkmcnt(4)
v_mfma_f32_16x16x32_bf16 a[184:187], v[64:67], v[136:139], a[184:187]
v_mfma_f32_16x16x32_bf16 a[184:187], v[68:71], v[240:243], a[184:187]
ds_read_b128 v[56:59], v8 offset:2048
v_mfma_f32_16x16x32_bf16 a[188:191], v[64:67], v[140:143], a[188:191]
ds_read_b128 v[60:63], v8 offset:3072
v_mfma_f32_16x16x32_bf16 a[188:191], v[68:71], v[244:247], a[188:191]
s_waitcnt lgkmcnt(4)
v_mfma_f32_16x16x32_bf16 a[200:203], v[72:75], v[136:139], a[200:203]
v_mfma_f32_16x16x32_bf16 a[200:203], v[76:79], v[240:243], a[200:203]
ds_read_b128 v[64:67], v8 offset:4096
v_mfma_f32_16x16x32_bf16 a[204:207], v[72:75], v[140:143], a[204:207]
ds_read_b128 v[68:71], v8 offset:5120
v_mfma_f32_16x16x32_bf16 a[204:207], v[76:79], v[244:247], a[204:207]
s_waitcnt lgkmcnt(4)
v_mfma_f32_16x16x32_bf16 a[216:219], v[48:51], v[136:139], a[216:219]
v_mfma_f32_16x16x32_bf16 a[216:219], v[52:55], v[240:243], a[216:219]
ds_read_b128 v[72:75], v8 offset:6144
v_mfma_f32_16x16x32_bf16 a[220:223], v[48:51], v[140:143], a[220:223]
ds_read_b128 v[76:79], v8 offset:7168
v_mfma_f32_16x16x32_bf16 a[220:223], v[52:55], v[244:247], a[220:223]
s_waitcnt lgkmcnt(4)
v_mfma_f32_16x16x32_bf16 a[232:235], v[56:59], v[136:139], a[232:235]
v_mfma_f32_16x16x32_bf16 a[232:235], v[60:63], v[240:243], a[232:235]
ds_read_b128 v[48:51], v8 offset:8192
v_mfma_f32_16x16x32_bf16 a[236:239], v[56:59], v[140:143], a[236:239]
ds_read_b128 v[52:55], v8 offset:9216
v_mfma_f32_16x16x32_bf16 a[236:239], v[60:63], v[244:247], a[236:239]
s_waitcnt lgkmcnt(4)
v_mfma_f32_16x16x32_bf16 a[240:243], v[64:67], v[144:147], 0
v_mfma_f32_16x16x32_bf16 a[240:243], v[68:71], v[160:163], a[240:243]
v_mfma_f32_16x16x32_bf16 a[244:247], v[64:67], v[148:151], 0
ds_read_b128 v[56:59], v8 offset:10240
v_mfma_f32_16x16x32_bf16 a[244:247], v[68:71], v[164:167], a[244:247]
v_accvgpr_read_b32 v208, a184
v_accvgpr_read_b32 v209, a200
v_mfma_f32_16x16x32_bf16 a[248:251], v[64:67], v[152:155], 0
v_accvgpr_read_b32 v210, a216
v_accvgpr_read_b32 v211, a232
v_mfma_f32_16x16x32_bf16 a[248:251], v[68:71], v[168:171], a[248:251]
ds_read_b128 v[60:63], v8 offset:11264
v_accvgpr_read_b32 v212, a185
v_mfma_f32_16x16x32_bf16 a[252:255], v[64:67], v[156:159], 0
v_accvgpr_read_b32 v213, a201
v_accvgpr_read_b32 v214, a217
v_mfma_f32_16x16x32_bf16 a[252:255], v[68:71], v[172:175], a[252:255]
v_accvgpr_read_b32 v215, a233
s_waitcnt lgkmcnt(4)
v_mfma_f32_16x16x32_bf16 a[240:243], v[72:75], v[176:179], a[240:243]
v_cvt_pk_bf16_f32 v224, v208, v209
v_cvt_pk_bf16_f32 v225, v210, v211
v_mfma_f32_16x16x32_bf16 a[240:243], v[76:79], a[0:3], a[240:243]
v_cvt_pk_bf16_f32 v226, v212, v213
v_cvt_pk_bf16_f32 v227, v214, v215
v_mfma_f32_16x16x32_bf16 a[244:247], v[72:75], v[180:183], a[244:247]
ds_read_b128 v[64:67], v8 offset:12288
v_accvgpr_read_b32 v216, a186
v_mfma_f32_16x16x32_bf16 a[244:247], v[76:79], a[4:7], a[244:247]
buffer_store_dwordx4 v[224:227], v252, s[8:11], s38 offen offset:2048 sc1
v_mfma_f32_16x16x32_bf16 a[248:251], v[72:75], v[184:187], a[248:251]
v_accvgpr_read_b32 v217, a202
v_accvgpr_read_b32 v218, a218
v_mfma_f32_16x16x32_bf16 a[248:251], v[76:79], a[8:11], a[248:251]
ds_read_b128 v[68:71], v8 offset:13312
v_accvgpr_read_b32 v219, a234
v_mfma_f32_16x16x32_bf16 a[252:255], v[72:75], v[188:191], a[252:255]
v_accvgpr_read_b32 v220, a187
v_accvgpr_read_b32 v221, a203
v_mfma_f32_16x16x32_bf16 a[252:255], v[76:79], a[12:15], a[252:255]
v_accvgpr_read_b32 v222, a219
s_waitcnt lgkmcnt(4)
v_mfma_f32_16x16x32_bf16 a[240:243], v[48:51], a[16:19], a[240:243]
v_accvgpr_read_b32 v223, a235
v_cvt_pk_bf16_f32 v228, v216, v217
v_mfma_f32_16x16x32_bf16 a[240:243], v[52:55], a[32:35], a[240:243]
v_cvt_pk_bf16_f32 v229, v218, v219
v_cvt_pk_bf16_f32 v230, v220, v221
v_mfma_f32_16x16x32_bf16 a[244:247], v[48:51], a[20:23], a[244:247]
ds_read_b128 v[72:75], v8 offset:14336
v_cvt_pk_bf16_f32 v231, v222, v223
v_mfma_f32_16x16x32_bf16 a[244:247], v[52:55], a[36:39], a[244:247]
buffer_store_dwordx4 v[228:231], v252, s[8:11], s38 offen offset:2304 sc1
v_mfma_f32_16x16x32_bf16 a[248:251], v[48:51], a[24:27], a[248:251]
v_accvgpr_read_b32 v208, a188
v_accvgpr_read_b32 v209, a204
v_mfma_f32_16x16x32_bf16 a[248:251], v[52:55], a[40:43], a[248:251]
ds_read_b128 v[76:79], v8 offset:15360
v_accvgpr_read_b32 v210, a220
v_mfma_f32_16x16x32_bf16 a[252:255], v[48:51], a[28:31], a[252:255]
v_accvgpr_read_b32 v211, a236
v_accvgpr_read_b32 v212, a189
v_mfma_f32_16x16x32_bf16 a[252:255], v[52:55], a[44:47], a[252:255]
v_accvgpr_read_b32 v213, a205
s_waitcnt lgkmcnt(4)
v_mfma_f32_16x16x32_bf16 a[240:243], v[56:59], a[48:51], a[240:243]
s_waitcnt vmcnt(15)
v_accvgpr_read_b32 v214, a221
v_mfma_f32_16x16x32_bf16 a[240:243], v[60:63], a[64:67], a[240:243]
s_barrier
v_mfma_f32_16x16x32_bf16 a[244:247], v[56:59], a[52:55], a[244:247]
ds_read_b128 v[48:51], v2 offset:0
v_accvgpr_read_b32 v215, a237
v_mfma_f32_16x16x32_bf16 a[244:247], v[60:63], a[68:71], a[244:247]
v_cvt_pk_bf16_f32 v224, v208, v209
v_cvt_pk_bf16_f32 v225, v210, v211
v_mfma_f32_16x16x32_bf16 a[248:251], v[56:59], a[56:59], a[248:251]
v_cvt_pk_bf16_f32 v226, v212, v213
v_cvt_pk_bf16_f32 v227, v214, v215
v_mfma_f32_16x16x32_bf16 a[248:251], v[60:63], a[72:75], a[248:251]
ds_read_b128 v[52:55], v2 offset:1024
v_accvgpr_read_b32 v216, a190
v_mfma_f32_16x16x32_bf16 a[252:255], v[56:59], a[60:63], a[252:255]
buffer_store_dwordx4 v[224:227], v252, s[8:11], s39 offen offset:2048 sc1
v_mfma_f32_16x16x32_bf16 a[252:255], v[60:63], a[76:79], a[252:255]
v_accvgpr_read_b32 v217, a206
s_waitcnt lgkmcnt(4)
v_mfma_f32_16x16x32_bf16 a[240:243], v[64:67], a[80:83], a[240:243]
v_accvgpr_read_b32 v218, a222
v_accvgpr_read_b32 v219, a238
v_mfma_f32_16x16x32_bf16 a[240:243], v[68:71], a[96:99], a[240:243]
v_accvgpr_read_b32 v220, a191
v_accvgpr_read_b32 v221, a207
v_mfma_f32_16x16x32_bf16 a[244:247], v[64:67], a[84:87], a[244:247]
ds_read_b128 v[56:59], v2 offset:2048
v_accvgpr_read_b32 v222, a223
v_mfma_f32_16x16x32_bf16 a[244:247], v[68:71], a[100:103], a[244:247]
v_accvgpr_read_b32 v223, a239
v_cvt_pk_bf16_f32 v228, v216, v217
v_mfma_f32_16x16x32_bf16 a[248:251], v[64:67], a[88:91], a[248:251]
v_cvt_pk_bf16_f32 v229, v218, v219
v_cvt_pk_bf16_f32 v230, v220, v221
v_mfma_f32_16x16x32_bf16 a[248:251], v[68:71], a[104:107], a[248:251]
ds_read_b128 v[60:63], v2 offset:3072
v_cvt_pk_bf16_f32 v231, v222, v223
v_mfma_f32_16x16x32_bf16 a[252:255], v[64:67], a[92:95], a[252:255]
buffer_store_dwordx4 v[228:231], v252, s[8:11], s39 offen offset:2304 sc1
v_mfma_f32_16x16x32_bf16 a[252:255], v[68:71], a[108:111], a[252:255]
s_waitcnt lgkmcnt(4)
v_mfma_f32_16x16x32_bf16 a[240:243], v[72:75], v[16:19], a[240:243]
v_mfma_f32_16x16x32_bf16 a[240:243], v[76:79], v[32:35], a[240:243]
v_mfma_f32_16x16x32_bf16 a[244:247], v[72:75], v[20:23], a[244:247]
ds_read_b128 v[64:67], v2 offset:4096
v_mfma_f32_16x16x32_bf16 a[244:247], v[76:79], v[36:39], a[244:247]
v_mfma_f32_16x16x32_bf16 a[248:251], v[72:75], v[24:27], a[248:251]
v_mfma_f32_16x16x32_bf16 a[248:251], v[76:79], v[40:43], a[248:251]
ds_read_b128 v[68:71], v2 offset:5120
v_mfma_f32_16x16x32_bf16 a[252:255], v[72:75], v[28:31], a[252:255]
v_mfma_f32_16x16x32_bf16 a[252:255], v[76:79], v[44:47], a[252:255]
s_waitcnt lgkmcnt(4)
v_mfma_f32_16x16x32_bf16 a[240:243], v[48:51], v[192:195], a[240:243]
v_mfma_f32_16x16x32_bf16 a[240:243], v[52:55], v[80:83], a[240:243]
v_mfma_f32_16x16x32_bf16 a[244:247], v[48:51], v[196:199], a[244:247]
v_mfma_f32_16x16x32_bf16 a[244:247], v[52:55], v[84:87], a[244:247]
v_mfma_f32_16x16x32_bf16 a[248:251], v[48:51], v[200:203], a[248:251]
v_mfma_f32_16x16x32_bf16 a[248:251], v[52:55], v[88:91], a[248:251]
v_mfma_f32_16x16x32_bf16 a[252:255], v[48:51], v[204:207], a[252:255]
v_mfma_f32_16x16x32_bf16 a[252:255], v[52:55], v[92:95], a[252:255]
s_waitcnt lgkmcnt(2)
v_mfma_f32_16x16x32_bf16 a[240:243], v[56:59], v[96:99], a[240:243]
v_mfma_f32_16x16x32_bf16 a[240:243], v[60:63], v[112:115], a[240:243]
v_mfma_f32_16x16x32_bf16 a[244:247], v[56:59], v[100:103], a[244:247]
v_mfma_f32_16x16x32_bf16 a[244:247], v[60:63], v[116:119], a[244:247]
v_mfma_f32_16x16x32_bf16 a[248:251], v[56:59], v[104:107], a[248:251]
v_mfma_f32_16x16x32_bf16 a[248:251], v[60:63], v[120:123], a[248:251]
v_mfma_f32_16x16x32_bf16 a[252:255], v[56:59], v[108:111], a[252:255]
v_mfma_f32_16x16x32_bf16 a[252:255], v[60:63], v[124:127], a[252:255]
s_waitcnt lgkmcnt(0)
v_mfma_f32_16x16x32_bf16 a[240:243], v[64:67], v[128:131], a[240:243]
v_mfma_f32_16x16x32_bf16 a[240:243], v[68:71], v[232:235], a[240:243]
v_mfma_f32_16x16x32_bf16 a[244:247], v[64:67], v[132:135], a[244:247]
v_mfma_f32_16x16x32_bf16 a[244:247], v[68:71], v[236:239], a[244:247]
v_mfma_f32_16x16x32_bf16 a[248:251], v[64:67], v[136:139], a[248:251]
v_mfma_f32_16x16x32_bf16 a[248:251], v[68:71], v[240:243], a[248:251]
v_mfma_f32_16x16x32_bf16 a[252:255], v[64:67], v[140:143], a[252:255]
v_mfma_f32_16x16x32_bf16 a[252:255], v[68:71], v[244:247], a[252:255]
s_nop 1
v_accvgpr_read_b32 v208, a240
v_accvgpr_read_b32 v209, a241
v_accvgpr_read_b32 v210, a242
v_accvgpr_read_b32 v211, a243
v_accvgpr_read_b32 v212, a244
v_accvgpr_read_b32 v213, a245
v_accvgpr_read_b32 v214, a246
v_accvgpr_read_b32 v215, a247
v_cvt_pk_bf16_f32 v224, v208, v209
v_cvt_pk_bf16_f32 v225, v210, v211
v_cvt_pk_bf16_f32 v226, v212, v213
v_cvt_pk_bf16_f32 v227, v214, v215
s_nop 0
v_permlane16_swap_b32 v224, v226
v_permlane16_swap_b32 v225, v227
buffer_store_dwordx4 v[224:227], v9, s[8:11], s32 offen sc1
v_accvgpr_read_b32 v216, a248
v_accvgpr_read_b32 v217, a249
v_accvgpr_read_b32 v218, a250
v_accvgpr_read_b32 v219, a251
v_accvgpr_read_b32 v220, a252
v_accvgpr_read_b32 v221, a253
v_accvgpr_read_b32 v222, a254
v_accvgpr_read_b32 v223, a255
v_cvt_pk_bf16_f32 v228, v216, v217
v_cvt_pk_bf16_f32 v229, v218, v219
v_cvt_pk_bf16_f32 v230, v220, v221
v_cvt_pk_bf16_f32 v231, v222, v223
s_nop 0
v_permlane16_swap_b32 v228, v230
v_permlane16_swap_b32 v229, v231
buffer_store_dwordx4 v[228:231], v9, s[8:11], s33 offen sc1
s_mov_b32 s14, s35
s_cmp_eq_u32 s7, 1
s_cbranch_scc1 L_last
s_cmp_eq_u32 s4, 3
s_cbranch_scc1 L_r_side
v_and_b32 v6, 7, v1
v_lshrrev_b32 v7, 3, v1
s_and_b32 s23, s6, 1
s_lshl_b32 s23, s23, 3
v_add_u32 v8, s23, v6
v_lshlrev_b32 v8, 4, v8
v_lshl_add_u32 v4, v7, 8, v8
s_lshl_b32 s24, s5, 4
s_lshr_b32 s25, s6, 1
s_add_u32 s24, s24, s25
s_mul_i32 s20, s24, 18432
s_lshl_b32 s22, s4, 2
s_lshr_b32 s23, 1056, s22
s_and_b32 s23, s23, 15
s_lshl_b32 s24, s23, 11
s_add_u32 s28, s20, s24
s_lshr_b32 s23, 790, s22
s_and_b32 s23, s23, 15
s_lshl_b32 s24, s23, 11
s_add_u32 s29, s20, s24
s_lshr_b32 s23, 2165, s22
s_and_b32 s23, s23, 15
s_lshl_b32 s24, s23, 11
s_add_u32 s30, s20, s24
s_lshl_b32 s26, s5, 12
s_add_u32 s27, s26, 917504
s_add_u32 s26, s26, 655360
v_and_b32 v6, 31, v1
v_lshlrev_b32 v6, 7, v6
buffer_load_dwordx2 v[10:11], v6, s[8:11], s27 offen sc1
v_mov_b32 v13, 2146435072
v_cmp_gt_u32 vcc, 16, v0
v_lshlrev_b32 v14, 3, v0
s_nop 0
v_cndmask_b32 v13, v13, v14, vcc
v_mov_b32 v14, s68
v_mov_b32 v15, s69
s_waitcnt vmcnt(0)
s_barrier
buffer_store_dwordx2 v[14:15], v13, s[8:11], s14 offen sc1
s_add_u32 s24, s28, 37126144
buffer_load_dwordx4 v[16:19], v4, s[8:11], s24 offen sc1
s_add_u32 s25, s29, 37126144
buffer_load_dwordx4 v[20:23], v4, s[8:11], s25 offen sc1
s_add_u32 s24, s30, 37126144
buffer_load_dwordx4 v[24:27], v4, s[8:11], s24 offen sc1
v_cmp_eq_u64 vcc, s[68:69], v[10:11]
s_nop 0
s_cmp_eq_u64 vcc, exec
s_cbranch_scc0 L_re_slow4
L_re_back4:
s_add_u32 s25, s28, 79855616
buffer_load_dwordx4 v[28:31], v4, s[8:11], s25 offen sc1
s_add_u32 s24, s28, 82214912
buffer_load_dwordx4 v[40:43], v4, s[8:11], s24 offen sc1
s_add_u32 s25, s28, 84574208
buffer_load_dwordx4 v[52:55], v4, s[8:11], s25 offen sc1
s_add_u32 s24, s28, 86933504
buffer_load_dwordx4 v[64:67], v4, s[8:11], s24 offen sc1
s_add_u32 s25, s28, 89292800
buffer_load_dwordx4 v[76:79], v4, s[8:11], s25 offen sc1
s_add_u32 s24, s28, 91652096
buffer_load_dwordx4 v[88:91], v4, s[8:11], s24 offen sc1
s_add_u32 s25, s28, 94011392
buffer_load_dwordx4 v[100:103], v4, s[8:11], s25 offen sc1
s_add_u32 s24, s28, 96370688
buffer_load_dwordx4 v[112:115], v4, s[8:11], s24 offen sc1
s_cmp_eq_u32 s4, 0
s_cbranch_scc0 L_re1_4
s_add_u32 s24, s29, 79855616
buffer_load_dwordx4 v[32:35], v4, s[8:11], s24 offen sc1
s_add_u32 s25, s29, 82214912
buffer_load_dwordx4 v[44:47], v4, s[8:11], s25 offen sc1
s_add_u32 s24, s29, 84574208
buffer_load_dwordx4 v[56:59], v4, s[8:11], s24 offen sc1
s_add_u32 s25, s29, 86933504
buffer_load_dwordx4 v[68:71], v4, s[8:11], s25 offen sc1
s_add_u32 s24, s29, 89292800
buffer_load_dwordx4 v[80:83], v4, s[8:11], s24 offen sc1
s_add_u32 s25, s29, 91652096
buffer_load_dwordx4 v[92:95], v4, s[8:11], s25 offen sc1
s_add_u32 s24, s29, 94011392
buffer_load_dwordx4 v[104:107], v4, s[8:11], s24 offen sc1
s_add_u32 s25, s29, 96370688
buffer_load_dwordx4 v[116:119], v4, s[8:11], s25 offen sc1
L_re1_4:
s_mov_b32 s52, 0
L_poll6:
buffer_load_dwordx2 v[14:15], v6, s[8:11], s26 offen sc1
s_add_u32 s52, s52, 1
s_waitcnt vmcnt(0)
v_cmp_ne_u64 vcc, s[68:69], v[14:15]
s_cmp_ge_u32 s52, 1048576
s_cbranch_scc1 L_got6
s_and_b64 exec, exec, vcc
s_cbranch_execnz L_poll6
L_got6:
s_mov_b64 exec, -1
s_cmp_eq_u32 s4, 0
s_cbranch_scc1 L_re2_4
s_add_u32 s24, s29, 79855616
buffer_load_dwordx4 v[32:35], v4, s[8:11], s24 offen sc1
s_add_u32 s25, s29, 82214912
buffer_load_dwordx4 v[44:47], v4, s[8:11], s25 offen sc1
s_add_u32 s24, s29, 84574208
buffer_load_dwordx4 v[56:59], v4, s[8:11], s24 offen sc1
s_add_u32 s25, s29, 86933504
buffer_load_dwordx4 v[68:71], v4, s[8:11], s25 offen sc1
s_add_u32 s24, s29, 89292800
buffer_load_dwordx4 v[80:83], v4, s[8:11], s24 offen sc1
s_add_u32 s25, s29, 91652096
buffer_load_dwordx4 v[92:95], v4, s[8:11], s25 offen sc1
s_add_u32 s24, s29, 94011392
buffer_load_dwordx4 v[104:107], v4, s[8:11], s24 offen sc1
s_add_u32 s25, s29, 96370688
buffer_load_dwordx4 v[116:119], v4, s[8:11], s25 offen sc1
L_re2_4:
s_add_u32 s25, s30, 79855616
buffer_load_dwordx4 v[36:39], v4, s[8:11], s25 offen sc1
s_add_u32 s24, s30, 82214912
buffer_load_dwordx4 v[48:51], v4, s[8:11], s24 offen sc1
s_add_u32 s25, s30, 84574208
buffer_load_dwordx4 v[60:63], v4, s[8:11], s25 offen sc1
s_add_u32 s24, s30, 86933504
buffer_load_dwordx4 v[72:75], v4, s[8:11], s24 offen sc1
s_add_u32 s25, s30, 89292800
buffer_load_dwordx4 v[84:87], v4, s[8:11], s25 offen sc1
s_add_u32 s24, s30, 91652096
buffer_load_dwordx4 v[96:99], v4, s[8:11], s24 offen sc1
s_add_u32 s25, s30, 94011392
buffer_load_dwordx4 v[108:111], v4, s[8:11], s25 offen sc1
s_add_u32 s24, s30, 96370688
buffer_load_dwordx4 v[120:123], v4, s[8:11], s24 offen sc1
s_waitcnt vmcnt(26)
v_lshlrev_b32 v128, 16, v16
v_and_b32 v129, 0xffff0000, v16
v_lshlrev_b32 v130, 16, v17
v_and_b32 v131, 0xffff0000, v17
v_lshlrev_b32 v132, 16, v18
v_and_b32 v133, 0xffff0000, v18
v_lshlrev_b32 v134, 16, v19
v_and_b32 v135, 0xffff0000, v19
s_waitcnt vmcnt(25)
v_lshlrev_b32 v136, 16, v20
v_and_b32 v137, 0xffff0000, v20
v_lshlrev_b32 v138, 16, v21
v_and_b32 v139, 0xffff0000, v21
v_lshlrev_b32 v140, 16, v22
v_and_b32 v141, 0xffff0000, v22
v_lshlrev_b32 v142, 16, v23
v_and_b32 v143, 0xffff0000, v23
s_waitcnt vmcnt(24)
v_lshlrev_b32 v144, 16, v24
v_and_b32 v145, 0xffff0000, v24
v_lshlrev_b32 v146, 16, v25
v_and_b32 v147, 0xffff0000, v25
v_lshlrev_b32 v148, 16, v26
v_and_b32 v149, 0xffff0000, v26
v_lshlrev_b32 v150, 16, v27
v_and_b32 v151, 0xffff0000, v27
s_waitcnt vmcnt(23)
v_lshlrev_b32 v6, 16, v28
v_and_b32 v7, 0xffff0000, v28
v_add_f32 v128, v128, v6
v_add_f32 v129, v129, v7
v_lshlrev_b32 v8, 16, v29
v_and_b32 v9, 0xffff0000, v29
v_add_f32 v130, v130, v8
v_add_f32 v131, v131, v9
v_lshlrev_b32 v6, 16, v30
v_and_b32 v7, 0xffff0000, v30
v_add_f32 v132, v132, v6
v_add_f32 v133, v133, v7
v_lshlrev_b32 v8, 16, v31
v_and_b32 v9, 0xffff0000, v31
v_add_f32 v134, v134, v8
v_add_f32 v135, v135, v9
s_waitcnt vmcnt(22)
v_lshlrev_b32 v6, 16, v40
v_and_b32 v7, 0xffff0000, v40
v_add_f32 v128, v128, v6
v_add_f32 v129, v129, v7
v_lshlrev_b32 v8, 16, v41
v_and_b32 v9, 0xffff0000, v41
v_add_f32 v130, v130, v8
v_add_f32 v131, v131, v9
v_lshlrev_b32 v6, 16, v42
v_and_b32 v7, 0xffff0000, v42
v_add_f32 v132, v132, v6
v_add_f32 v133, v133, v7
v_lshlrev_b32 v8, 16, v43
v_and_b32 v9, 0xffff0000, v43
v_add_f32 v134, v134, v8
v_add_f32 v135, v135, v9
s_waitcnt vmcnt(21)
v_lshlrev_b32 v6, 16, v52
v_and_b32 v7, 0xffff0000, v52
v_add_f32 v128, v128, v6
v_add_f32 v129, v129, v7
v_lshlrev_b32 v8, 16, v53
v_and_b32 v9, 0xffff0000, v53
v_add_f32 v130, v130, v8
v_add_f32 v131, v131, v9
v_lshlrev_b32 v6, 16, v54
v_and_b32 v7, 0xffff0000, v54
v_add_f32 v132, v132, v6
v_add_f32 v133, v133, v7
v_lshlrev_b32 v8, 16, v55
v_and_b32 v9, 0xffff0000, v55
v_add_f32 v134, v134, v8
v_add_f32 v135, v135, v9
s_waitcnt vmcnt(20)
v_lshlrev_b32 v6, 16, v64
v_and_b32 v7, 0xffff0000, v64
v_add_f32 v128, v128, v6
v_add_f32 v129, v129, v7
v_lshlrev_b32 v8, 16, v65
v_and_b32 v9, 0xffff0000, v65
v_add_f32 v130, v130, v8
v_add_f32 v131, v131, v9
v_lshlrev_b32 v6, 16, v66
v_and_b32 v7, 0xffff0000, v66
v_add_f32 v132, v132, v6
v_add_f32 v133, v133, v7
v_lshlrev_b32 v8, 16, v67
v_and_b32 v9, 0xffff0000, v67
v_add_f32 v134, v134, v8
v_add_f32 v135, v135, v9
s_waitcnt vmcnt(19)
v_lshlrev_b32 v6, 16, v76
v_and_b32 v7, 0xffff0000, v76
v_add_f32 v128, v128, v6
v_add_f32 v129, v129, v7
v_lshlrev_b32 v8, 16, v77
v_and_b32 v9, 0xffff0000, v77
v_add_f32 v130, v130, v8
v_add_f32 v131, v131, v9
v_lshlrev_b32 v6, 16, v78
v_and_b32 v7, 0xffff0000, v78
v_add_f32 v132, v132, v6
v_add_f32 v133, v133, v7
v_lshlrev_b32 v8, 16, v79
v_and_b32 v9, 0xffff0000, v79
v_add_f32 v134, v134, v8
v_add_f32 v135, v135, v9
s_waitcnt vmcnt(18)
v_lshlrev_b32 v6, 16, v88
v_and_b32 v7, 0xffff0000, v88
v_add_f32 v128, v128, v6
v_add_f32 v129, v129, v7
v_lshlrev_b32 v8, 16, v89
v_and_b32 v9, 0xffff0000, v89
v_add_f32 v130, v130, v8
v_add_f32 v131, v131, v9
v_lshlrev_b32 v6, 16, v90
v_and_b32 v7, 0xffff0000, v90
v_add_f32 v132, v132, v6
v_add_f32 v133, v133, v7
v_lshlrev_b32 v8, 16, v91
v_and_b32 v9, 0xffff0000, v91
v_add_f32 v134, v134, v8
v_add_f32 v135, v135, v9
s_waitcnt vmcnt(17)
v_lshlrev_b32 v6, 16, v100
v_and_b32 v7, 0xffff0000, v100
v_add_f32 v128, v128, v6
v_add_f32 v129, v129, v7
v_lshlrev_b32 v8, 16, v101
v_and_b32 v9, 0xffff0000, v101
v_add_f32 v130, v130, v8
v_add_f32 v131, v131, v9
v_lshlrev_b32 v6, 16, v102
v_and_b32 v7, 0xffff0000, v102
v_add_f32 v132, v132, v6
v_add_f32 v133, v133, v7
v_lshlrev_b32 v8, 16, v103
v_and_b32 v9, 0xffff0000, v103
v_add_f32 v134, v134, v8
v_add_f32 v135, v135, v9
s_waitcnt vmcnt(16)
v_lshlrev_b32 v6, 16, v112
v_and_b32 v7, 0xffff0000, v112
v_add_f32 v128, v128, v6
v_add_f32 v129, v129, v7
v_lshlrev_b32 v8, 16, v113
v_and_b32 v9, 0xffff0000, v113
v_add_f32 v130, v130, v8
v_add_f32 v131, v131, v9
v_lshlrev_b32 v6, 16, v114
v_and_b32 v7, 0xffff0000, v114
v_add_f32 v132, v132, v6
v_add_f32 v133, v133, v7
v_lshlrev_b32 v8, 16, v115
v_and_b32 v9, 0xffff0000, v115
v_add_f32 v134, v134, v8
v_add_f32 v135, v135, v9
s_waitcnt vmcnt(15)
v_lshlrev_b32 v6, 16, v32
v_and_b32 v7, 0xffff0000, v32
v_add_f32 v136, v136, v6
v_add_f32 v137, v137, v7
v_lshlrev_b32 v8, 16, v33
v_and_b32 v9, 0xffff0000, v33
v_add_f32 v138, v138, v8
v_add_f32 v139, v139, v9
v_lshlrev_b32 v6, 16, v34
v_and_b32 v7, 0xffff0000, v34
v_add_f32 v140, v140, v6
v_add_f32 v141, v141, v7
v_lshlrev_b32 v8, 16, v35
v_and_b32 v9, 0xffff0000, v35
v_add_f32 v142, v142, v8
v_add_f32 v143, v143, v9
s_waitcnt vmcnt(14)
v_lshlrev_b32 v6, 16, v44
v_and_b32 v7, 0xffff0000, v44
v_add_f32 v136, v136, v6
v_add_f32 v137, v137, v7
v_lshlrev_b32 v8, 16, v45
v_and_b32 v9, 0xffff0000, v45
v_add_f32 v138, v138, v8
v_add_f32 v139, v139, v9
v_lshlrev_b32 v6, 16, v46
v_and_b32 v7, 0xffff0000, v46
v_add_f32 v140, v140, v6
v_add_f32 v141, v141, v7
v_lshlrev_b32 v8, 16, v47
v_and_b32 v9, 0xffff0000, v47
v_add_f32 v142, v142, v8
v_add_f32 v143, v143, v9
s_waitcnt vmcnt(13)
v_lshlrev_b32 v6, 16, v56
v_and_b32 v7, 0xffff0000, v56
v_add_f32 v136, v136, v6
v_add_f32 v137, v137, v7
v_lshlrev_b32 v8, 16, v57
v_and_b32 v9, 0xffff0000, v57
v_add_f32 v138, v138, v8
v_add_f32 v139, v139, v9
v_lshlrev_b32 v6, 16, v58
v_and_b32 v7, 0xffff0000, v58
v_add_f32 v140, v140, v6
v_add_f32 v141, v141, v7
v_lshlrev_b32 v8, 16, v59
v_and_b32 v9, 0xffff0000, v59
v_add_f32 v142, v142, v8
v_add_f32 v143, v143, v9
s_waitcnt vmcnt(12)
v_lshlrev_b32 v6, 16, v68
v_and_b32 v7, 0xffff0000, v68
v_add_f32 v136, v136, v6
v_add_f32 v137, v137, v7
v_lshlrev_b32 v8, 16, v69
v_and_b32 v9, 0xffff0000, v69
v_add_f32 v138, v138, v8
v_add_f32 v139, v139, v9
v_lshlrev_b32 v6, 16, v70
v_and_b32 v7, 0xffff0000, v70
v_add_f32 v140, v140, v6
v_add_f32 v141, v141, v7
v_lshlrev_b32 v8, 16, v71
v_and_b32 v9, 0xffff0000, v71
v_add_f32 v142, v142, v8
v_add_f32 v143, v143, v9
s_waitcnt vmcnt(11)
v_lshlrev_b32 v6, 16, v80
v_and_b32 v7, 0xffff0000, v80
v_add_f32 v136, v136, v6
v_add_f32 v137, v137, v7
v_lshlrev_b32 v8, 16, v81
v_and_b32 v9, 0xffff0000, v81
v_add_f32 v138, v138, v8
v_add_f32 v139, v139, v9
v_lshlrev_b32 v6, 16, v82
v_and_b32 v7, 0xffff0000, v82
v_add_f32 v140, v140, v6
v_add_f32 v141, v141, v7
v_lshlrev_b32 v8, 16, v83
v_and_b32 v9, 0xffff0000, v83
v_add_f32 v142, v142, v8
v_add_f32 v143, v143, v9
s_waitcnt vmcnt(10)
v_lshlrev_b32 v6, 16, v92
v_and_b32 v7, 0xffff0000, v92
v_add_f32 v136, v136, v6
v_add_f32 v137, v137, v7
v_lshlrev_b32 v8, 16, v93
v_and_b32 v9, 0xffff0000, v93
v_add_f32 v138, v138, v8
v_add_f32 v139, v139, v9
v_lshlrev_b32 v6, 16, v94
v_and_b32 v7, 0xffff0000, v94
v_add_f32 v140, v140, v6
v_add_f32 v141, v141, v7
v_lshlrev_b32 v8, 16, v95
v_and_b32 v9, 0xffff0000, v95
v_add_f32 v142, v142, v8
v_add_f32 v143, v143, v9
s_waitcnt vmcnt(9)
v_lshlrev_b32 v6, 16, v104
v_and_b32 v7, 0xffff0000, v104
v_add_f32 v136, v136, v6
v_add_f32 v137, v137, v7
v_lshlrev_b32 v8, 16, v105
v_and_b32 v9, 0xffff0000, v105
v_add_f32 v138, v138, v8
v_add_f32 v139, v139, v9
v_lshlrev_b32 v6, 16, v106
v_and_b32 v7, 0xffff0000, v106
v_add_f32 v140, v140, v6
v_add_f32 v141, v141, v7
v_lshlrev_b32 v8, 16, v107
v_and_b32 v9, 0xffff0000, v107
v_add_f32 v142, v142, v8
v_add_f32 v143, v143, v9
s_waitcnt vmcnt(8)
v_lshlrev_b32 v6, 16, v116
v_and_b32 v7, 0xffff0000, v116
v_add_f32 v136, v136, v6
v_add_f32 v137, v137, v7
v_lshlrev_b32 v8, 16, v117
v_and_b32 v9, 0xffff0000, v117
L_hop11:
s_cmp_lg_u32 s15, 0
s_cbranch_scc1 L_hop_done
v_add_f32 v138, v138, v8
v_add_f32 v139, v139, v9
v_lshlrev_b32 v6, 16, v118
v_and_b32 v7, 0xffff0000, v118
v_add_f32 v140, v140, v6
v_add_f32 v141, v141, v7
v_lshlrev_b32 v8, 16, v119
v_and_b32 v9, 0xffff0000, v119
v_add_f32 v142, v142, v8
v_add_f32 v143, v143, v9
s_waitcnt vmcnt(7)
v_lshlrev_b32 v6, 16, v36
v_and_b32 v7, 0xffff0000, v36
v_add_f32 v144, v144, v6
v_add_f32 v145, v145, v7
v_lshlrev_b32 v8, 16, v37
v_and_b32 v9, 0xffff0000, v37
v_add_f32 v146, v146, v8
v_add_f32 v147, v147, v9
v_lshlrev_b32 v6, 16, v38
v_and_b32 v7, 0xffff0000, v38
v_add_f32 v148, v148, v6
v_add_f32 v149, v149, v7
v_lshlrev_b32 v8, 16, v39
v_and_b32 v9, 0xffff0000, v39
v_add_f32 v150, v150, v8
v_add_f32 v151, v151, v9
s_waitcnt vmcnt(6)
v_lshlrev_b32 v6, 16, v48
v_and_b32 v7, 0xffff0000, v48
v_add_f32 v144, v144, v6
v_add_f32 v145, v145, v7
v_lshlrev_b32 v8, 16, v49
v_and_b32 v9, 0xffff0000, v49
v_add_f32 v146, v146, v8
v_add_f32 v147, v147, v9
v_lshlrev_b32 v6, 16, v50
v_and_b32 v7, 0xffff0000, v50
v_add_f32 v148, v148, v6
v_add_f32 v149, v149, v7
v_lshlrev_b32 v8, 16, v51
v_and_b32 v9, 0xffff0000, v51
v_add_f32 v150, v150, v8
v_add_f32 v151, v151, v9
s_waitcnt vmcnt(5)
v_lshlrev_b32 v6, 16, v60
v_and_b32 v7, 0xffff0000, v60
v_add_f32 v144, v144, v6
v_add_f32 v145, v145, v7
v_lshlrev_b32 v8, 16, v61
v_and_b32 v9, 0xffff0000, v61
v_add_f32 v146, v146, v8
v_add_f32 v147, v147, v9
v_lshlrev_b32 v6, 16, v62
v_and_b32 v7, 0xffff0000, v62
v_add_f32 v148, v148, v6
v_add_f32 v149, v149, v7
v_lshlrev_b32 v8, 16, v63
v_and_b32 v9, 0xffff0000, v63
v_add_f32 v150, v150, v8
v_add_f32 v151, v151, v9
s_waitcnt vmcnt(4)
v_lshlrev_b32 v6, 16, v72
v_and_b32 v7, 0xffff0000, v72
v_add_f32 v144, v144, v6
v_add_f32 v145, v145, v7
v_lshlrev_b32 v8, 16, v73
v_and_b32 v9, 0xffff0000, v73
v_add_f32 v146, v146, v8
v_add_f32 v147, v147, v9
v_lshlrev_b32 v6, 16, v74
v_and_b32 v7, 0xffff0000, v74
v_add_f32 v148, v148, v6
v_add_f32 v149, v149, v7
v_lshlrev_b32 v8, 16, v75
v_and_b32 v9, 0xffff0000, v75
v_add_f32 v150, v150, v8
v_add_f32 v151, v151, v9
s_waitcnt vmcnt(3)
v_lshlrev_b32 v6, 16, v84
v_and_b32 v7, 0xffff0000, v84
v_add_f32 v144, v144, v6
v_add_f32 v145, v145, v7
v_lshlrev_b32 v8, 16, v85
v_and_b32 v9, 0xffff0000, v85
v_add_f32 v146, v146, v8
v_add_f32 v147, v147, v9
v_lshlrev_b32 v6, 16, v86
v_and_b32 v7, 0xffff0000, v86
v_add_f32 v148, v148, v6
v_add_f32 v149, v149, v7
v_lshlrev_b32 v8, 16, v87
v_and_b32 v9, 0xffff0000, v87
v_add_f32 v150, v150, v8
v_add_f32 v151, v151, v9
s_waitcnt vmcnt(2)
v_lshlrev_b32 v6, 16, v96
v_and_b32 v7, 0xffff0000, v96
v_add_f32 v144, v144, v6
v_add_f32 v145, v145, v7
v_lshlrev_b32 v8, 16, v97
v_and_b32 v9, 0xffff0000, v97
v_add_f32 v146, v146, v8
v_add_f32 v147, v147, v9
v_lshlrev_b32 v6, 16, v98
v_and_b32 v7, 0xffff0000, v98
v_add_f32 v148, v148, v6
v_add_f32 v149, v149, v7
v_lshlrev_b32 v8, 16, v99
v_and_b32 v9, 0xffff0000, v99
v_add_f32 v150, v150, v8
v_add_f32 v151, v151, v9
s_waitcnt vmcnt(1)
v_lshlrev_b32 v6, 16, v108
v_and_b32 v7, 0xffff0000, v108
v_add_f32 v144, v144, v6
v_add_f32 v145, v145, v7
v_lshlrev_b32 v8, 16, v109
v_and_b32 v9, 0xffff0000, v109
v_add_f32 v146, v146, v8
v_add_f32 v147, v147, v9
v_lshlrev_b32 v6, 16, v110
v_and_b32 v7, 0xffff0000, v110
v_add_f32 v148, v148, v6
v_add_f32 v149, v149, v7
v_lshlrev_b32 v8, 16, v111
v_and_b32 v9, 0xffff0000, v111
v_add_f32 v150, v150, v8
v_add_f32 v151, v151, v9
s_waitcnt vmcnt(0)
v_lshlrev_b32 v6, 16, v120
v_and_b32 v7, 0xffff0000, v120
v_add_f32 v144, v144, v6
v_add_f32 v145, v145, v7
v_lshlrev_b32 v8, 16, v121
v_and_b32 v9, 0xffff0000, v121
v_add_f32 v146, v146, v8
v_add_f32 v147, v147, v9
v_lshlrev_b32 v6, 16, v122
v_and_b32 v7, 0xffff0000, v122
v_add_f32 v148, v148, v6
v_add_f32 v149, v149, v7
v_lshlrev_b32 v8, 16, v123
v_and_b32 v9, 0xffff0000, v123
v_add_f32 v150, v150, v8
v_add_f32 v151, v151, v9
v_cvt_pk_bf16_f32 v152, v128, v129
v_cvt_pk_bf16_f32 v153, v130, v131
v_cvt_pk_bf16_f32 v154, v132, v133
v_cvt_pk_bf16_f32 v155, v134, v135
v_cvt_pk_bf16_f32 v156, v136, v137
v_cvt_pk_bf16_f32 v157, v138, v139
v_cvt_pk_bf16_f32 v158, v140, v141
v_cvt_pk_bf16_f32 v159, v142, v143
v_cvt_pk_bf16_f32 v160, v144, v145
v_cvt_pk_bf16_f32 v161, v146, v147
v_cvt_pk_bf16_f32 v162, v148, v149
v_cvt_pk_bf16_f32 v163, v150, v151
v_add_f32 v6, v128, v129
v_mul_f32 v7, v128, v128
v_mul_f32 v9, v129, v129
v_mov_b32 v8, 0
v_add_f32 v6, v6, v130
v_add_f32 v8, v8, v131
v_fmac_f32 v7, v130, v130
v_fmac_f32 v9, v131, v131
v_add_f32 v6, v6, v132
v_add_f32 v8, v8, v133
v_fmac_f32 v7, v132, v132
v_fmac_f32 v9, v133, v133
v_add_f32 v6, v6, v134
v_add_f32 v8, v8, v135
v_fmac_f32 v7, v134, v134
v_fmac_f32 v9, v135, v135
v_add_f32 v6, v6, v136
v_add_f32 v8, v8, v137
v_fmac_f32 v7, v136, v136
v_fmac_f32 v9, v137, v137
v_add_f32 v6, v6, v138
v_add_f32 v8, v8, v139
v_fmac_f32 v7, v138, v138
v_fmac_f32 v9, v139, v139
v_add_f32 v6, v6, v140
v_add_f32 v8, v8, v141
v_fmac_f32 v7, v140, v140
v_fmac_f32 v9, v141, v141
v_add_f32 v6, v6, v142
v_add_f32 v8, v8, v143
v_fmac_f32 v7, v142, v142
v_fmac_f32 v9, v143, v143
v_add_f32 v6, v6, v144
v_add_f32 v8, v8, v145
v_fmac_f32 v7, v144, v144
v_fmac_f32 v9, v145, v145
v_add_f32 v6, v6, v146
v_add_f32 v8, v8, v147
v_fmac_f32 v7, v146, v146
v_fmac_f32 v9, v147, v147
v_add_f32 v6, v6, v148
v_add_f32 v8, v8, v149
v_fmac_f32 v7, v148, v148
v_fmac_f32 v9, v149, v149
v_add_f32 v6, v6, v150
v_add_f32 v8, v8, v151
v_fmac_f32 v7, v150, v150
v_fmac_f32 v9, v151, v151
v_add_f32 v6, v6, v8
v_add_f32 v7, v7, v9
s_nop 0
v_add_f32_dpp v6, v6, v6 row_ror:8 row_mask:0xf bank_mask:0xf
v_add_f32_dpp v7, v7, v7 row_ror:8 row_mask:0xf bank_mask:0xf
v_mov_b32 v8, v6
v_mov_b32 v9, v7
s_nop 0
v_permlane16_swap_b32 v6, v8
v_permlane16_swap_b32 v7, v9
v_add_f32 v6, v6, v8
v_add_f32 v7, v7, v9
v_mov_b32 v8, v6
v_mov_b32 v9, v7
s_nop 0
v_permlane32_swap_b32 v6, v8
v_permlane32_swap_b32 v7, v9
v_add_f32 v6, v6, v8
v_add_f32 v7, v7, v9
v_and_b32 v10, 7, v1
v_lshlrev_b32 v10, 3, v10
v_add_u32 v10, 147456, v10
s_lshl_b32 s24, s4, 6
v_add_u32 v11, s24, v10
ds_write_b64 v11, v[6:7]
s_add_u32 s24, s28, 30048256
buffer_store_dwordx4 v[152:155], v4, s[8:11], s24 offen sc1
s_add_u32 s25, s29, 30048256
buffer_store_dwordx4 v[156:159], v4, s[8:11], s25 offen sc1
s_add_u32 s24, s30, 30048256
buffer_store_dwordx4 v[160:163], v4, s[8:11], s24 offen sc1
s_waitcnt lgkmcnt(0)
s_barrier
ds_read_b64 v[6:7], v10
ds_read_b64 v[8:9], v10 offset:64
ds_read_b64 v[12:13], v10 offset:128
s_waitcnt lgkmcnt(0)
v_add_f32 v6, v6, v8
v_add_f32 v7, v7, v9
v_add_f32 v6, v6, v12
v_add_f32 v7, v7, v13
v_mul_f32 v6, 0x3ae38e39, v6
v_mul_f32 v7, 0x3ae38e39, v7
v_fma_f32 v7, -v6, v6, v7
v_max_f32 v7, 0, v7
v_add_f32 v7, 0x3727c5ac, v7
v_rsq_f32 v7, v7
s_nop 0
v_mul_f32 v6, v6, v7
v_fma_f32 v128, v128, v7, -v6
v_fma_f32 v129, v129, v7, -v6
v_fma_f32 v130, v130, v7, -v6
v_fma_f32 v131, v131, v7, -v6
v_fma_f32 v132, v132, v7, -v6
v_fma_f32 v133, v133, v7, -v6
v_fma_f32 v134, v134, v7, -v6
v_fma_f32 v135, v135, v7, -v6
v_cvt_pk_bf16_f32 v168, v128, v129
v_cvt_pk_bf16_f32 v169, v130, v131
v_cvt_pk_bf16_f32 v170, v132, v133
v_cvt_pk_bf16_f32 v171, v134, v135
s_add_u32 s24, s28, 25329664
buffer_store_dwordx4 v[168:171], v4, s[8:11], s24 offen sc1
v_fma_f32 v136, v136, v7, -v6
v_fma_f32 v137, v137, v7, -v6
v_fma_f32 v138, v138, v7, -v6
v_fma_f32 v139, v139, v7, -v6
v_fma_f32 v140, v140, v7, -v6
v_fma_f32 v141, v141, v7, -v6
v_fma_f32 v142, v142, v7, -v6
v_fma_f32 v143, v143, v7, -v6
v_cvt_pk_bf16_f32 v172, v136, v137
v_cvt_pk_bf16_f32 v173, v138, v139
v_cvt_pk_bf16_f32 v174, v140, v141
v_cvt_pk_bf16_f32 v175, v142, v143
s_add_u32 s25, s29, 25329664
buffer_store_dwordx4 v[172:175], v4, s[8:11], s25 offen sc1
v_fma_f32 v144, v144, v7, -v6
v_fma_f32 v145, v145, v7, -v6
v_fma_f32 v146, v146, v7, -v6
v_fma_f32 v147, v147, v7, -v6
v_fma_f32 v148, v148, v7, -v6
v_fma_f32 v149, v149, v7, -v6
v_fma_f32 v150, v150, v7, -v6
v_fma_f32 v151, v151, v7, -v6
v_cvt_pk_bf16_f32 v176, v144, v145
v_cvt_pk_bf16_f32 v177, v146, v147
v_cvt_pk_bf16_f32 v178, v148, v149
v_cvt_pk_bf16_f32 v179, v150, v151
s_add_u32 s24, s30, 25329664
buffer_store_dwordx4 v[176:179], v4, s[8:11], s24 offen sc1
s_lshl_b32 s24, s5, 5
s_add_u32 s24, s24, s6
s_lshl_b32 s14, s24, 7
s_add_u32 s14, s14, 1835008
s_branch L_r_done
L_r_side:
v_mov_b32 v13, 2146435072
v_cmp_gt_u32 vcc, 16, v0
v_lshlrev_b32 v14, 3, v0
s_nop 0
v_cndmask_b32 v13, v13, v14, vcc
v_mov_b32 v14, s68
v_mov_b32 v15, s69
s_waitcnt vmcnt(0)
s_barrier
buffer_store_dwordx2 v[14:15], v13, s[8:11], s14 offen sc1
s_lshr_b32 s20, s5, 2
s_lshl_b32 s20, s20, 3
s_lshr_b32 s21, s6, 2
s_add_u32 s20, s20, s21
s_and_b32 s21, s5, 3
s_lshl_b32 s21, s21, 2
s_and_b32 s22, s6, 3
s_add_u32 s21, s21, s22
s_mul_i32 s32, s21, 129024
s_add_u32 s32, s32, 4198400
s_mul_i32 s33, s4, 0
s_add_u32 s32, s32, s33
s_add_u32 m0, s33, 0
s_add_u32 s40, s32, 0
buffer_load_dwordx4 v2, s[8:11], s40 offen offset:0 sc1 lds
buffer_load_dwordx4 v2, s[8:11], s40 offen offset:1024 sc1 lds
buffer_load_dwordx4 v2, s[8:11], s40 offen offset:2048 sc1 lds
buffer_load_dwordx4 v2, s[8:11], s40 offen offset:3072 sc1 lds
s_add_u32 m0, s33, 4096
s_add_u32 s40, s32, 4096
buffer_load_dwordx4 v2, s[8:11], s40 offen offset:0 sc1 lds
buffer_load_dwordx4 v2, s[8:11], s40 offen offset:1024 sc1 lds
buffer_load_dwordx4 v2, s[8:11], s40 offen offset:2048 sc1 lds
buffer_load_dwordx4 v2, s[8:11], s40 offen offset:3072 sc1 lds
s_add_u32 m0, s33, 8192
s_add_u32 s40, s32, 8192
buffer_load_dwordx4 v2, s[8:11], s40 offen offset:0 sc1 lds
buffer_load_dwordx4 v2, s[8:11], s40 offen offset:1024 sc1 lds
buffer_load_dwordx4 v2, s[8:11], s40 offen offset:2048 sc1 lds
buffer_load_dwordx4 v2, s[8:11], s40 offen offset:3072 sc1 lds
s_add_u32 m0, s33, 12288
s_add_u32 s40, s32, 12288
buffer_load_dwordx4 v2, s[8:11], s40 offen offset:0 sc1 lds
buffer_load_dwordx4 v2, s[8:11], s40 offen offset:1024 sc1 lds
buffer_load_dwordx4 v2, s[8:11], s40 offen offset:2048 sc1 lds
buffer_load_dwordx4 v2, s[8:11], s40 offen offset:3072 sc1 lds
s_add_u32 m0, s33, 16384
s_add_u32 s40, s32, 16384
buffer_load_dwordx4 v2, s[8:11], s40 offen offset:0 sc1 lds
buffer_load_dwordx4 v2, s[8:11], s40 offen offset:1024 sc1 lds
buffer_load_dwordx4 v2, s[8:11], s40 offen offset:2048 sc1 lds
buffer_load_dwordx4 v2, s[8:11], s40 offen offset:3072 sc1 lds
s_add_u32 m0, s33, 20480
s_add_u32 s40, s32, 20480
buffer_load_dwordx4 v2, s[8:11], s40 offen offset:0 sc1 lds
buffer_load_dwordx4 v2, s[8:11], s40 offen offset:1024 sc1 lds
buffer_load_dwordx4 v2, s[8:11], s40 offen offset:2048 sc1 lds
buffer_load_dwordx4 v2, s[8:11], s40 offen offset:3072 sc1 lds
s_add_u32 m0, s33, 24576
s_add_u32 s40, s32, 24576
buffer_load_dwordx4 v2, s[8:11], s40 offen offset:0 sc1 lds
buffer_load_dwordx4 v2, s[8:11], s40 offen offset:1024 sc1 lds
buffer_load_dwordx4 v2, s[8:11], s40 offen offset:2048 sc1 lds
buffer_load_dwordx4 v2, s[8:11], s40 offen offset:3072 sc1 lds
s_add_u32 m0, s33, 28672
s_add_u32 s40, s32, 28672
buffer_load_dwordx4 v2, s[8:11], s40 offen offset:0 sc1 lds
buffer_load_dwordx4 v2, s[8:11], s40 offen offset:1024 sc1 lds
buffer_load_dwordx4 v2, s[8:11], s40 offen offset:2048 sc1 lds
buffer_load_dwordx4 v2, s[8:11], s40 offen offset:3072 sc1 lds
s_add_u32 m0, s33, 32768
s_add_u32 s40, s32, 32768
buffer_load_dwordx4 v2, s[8:11], s40 offen offset:0 sc1 lds
buffer_load_dwordx4 v2, s[8:11], s40 offen offset:1024 sc1 lds
buffer_load_dwordx4 v2, s[8:11], s40 offen offset:2048 sc1 lds
buffer_load_dwordx4 v2, s[8:11], s40 offen offset:3072 sc1 lds
s_add_u32 m0, s33, 36864
s_add_u32 s40, s32, 36864
buffer_load_dwordx4 v2, s[8:11], s40 offen offset:0 sc1 lds
buffer_load_dwordx4 v2, s[8:11], s40 offen offset:1024 sc1 lds
buffer_load_dwordx4 v2, s[8:11], s40 offen offset:2048 sc1 lds
buffer_load_dwordx4 v2, s[8:11], s40 offen offset:3072 sc1 lds
s_add_u32 m0, s33, 40960
s_add_u32 s40, s32, 40960
buffer_load_dwordx4 v2, s[8:11], s40 offen offset:0 sc1 lds
buffer_load_dwordx4 v2, s[8:11], s40 offen offset:1024 sc1 lds
buffer_load_dwordx4 v2, s[8:11], s40 offen offset:2048 sc1 lds
buffer_load_dwordx4 v2, s[8:11], s40 offen offset:3072 sc1 lds
s_add_u32 m0, s33, 45056
s_add_u32 s40, s32, 45056
buffer_load_dwordx4 v2, s[8:11], s40 offen offset:0 sc1 lds
buffer_load_dwordx4 v2, s[8:11], s40 offen offset:1024 sc1 lds
buffer_load_dwordx4 v2, s[8:11], s40 offen offset:2048 sc1 lds
buffer_load_dwordx4 v2, s[8:11], s40 offen offset:3072 sc1 lds
s_add_u32 m0, s33, 49152
s_add_u32 s40, s32, 49152
buffer_load_dwordx4 v2, s[8:11], s40 offen offset:0 sc1 lds
buffer_load_dwordx4 v2, s[8:11], s40 offen offset:1024 sc1 lds
buffer_load_dwordx4 v2, s[8:11], s40 offen offset:2048 sc1 lds
buffer_load_dwordx4 v2, s[8:11], s40 offen offset:3072 sc1 lds
s_add_u32 m0, s33, 53248
s_add_u32 s40, s32, 53248
buffer_load_dwordx4 v2, s[8:11], s40 offen offset:0 sc1 lds
buffer_load_dwordx4 v2, s[8:11], s40 offen offset:1024 sc1 lds
buffer_load_dwordx4 v2, s[8:11], s40 offen offset:2048 sc1 lds
buffer_load_dwordx4 v2, s[8:11], s40 offen offset:3072 sc1 lds
s_add_u32 m0, s33, 57344
s_add_u32 s40, s32, 57344
buffer_load_dwordx4 v2, s[8:11], s40 offen offset:0 sc1 lds
buffer_load_dwordx4 v2, s[8:11], s40 offen offset:1024 sc1 lds
buffer_load_dwordx4 v2, s[8:11], s40 offen offset:2048 sc1 lds
buffer_load_dwordx4 v2, s[8:11], s40 offen offset:3072 sc1 lds
s_add_u32 m0, s33, 61440
s_add_u32 s40, s32, 61440
buffer_load_dwordx4 v2, s[8:11], s40 offen offset:0 sc1 lds
buffer_load_dwordx4 v2, s[8:11], s40 offen offset:1024 sc1 lds
buffer_load_dwordx4 v2, s[8:11], s40 offen offset:2048 sc1 lds
buffer_load_dwordx4 v2, s[8:11], s40 offen offset:3072 sc1 lds
s_add_u32 m0, s33, 65536
s_add_u32 s40, s32, 65536
buffer_load_dwordx4 v2, s[8:11], s40 offen offset:0 sc1 lds
buffer_load_dwordx4 v2, s[8:11], s40 offen offset:1024 sc1 lds
buffer_load_dwordx4 v2, s[8:11], s40 offen offset:2048 sc1 lds
buffer_load_dwordx4 v2, s[8:11], s40 offen offset:3072 sc1 lds
s_add_u32 m0, s33, 69632
s_add_u32 s40, s32, 69632
buffer_load_dwordx4 v2, s[8:11], s40 offen offset:0 sc1 lds
buffer_load_dwordx4 v2, s[8:11], s40 offen offset:1024 sc1 lds
buffer_load_dwordx4 v2, s[8:11], s40 offen offset:2048 sc1 lds
buffer_load_dwordx4 v2, s[8:11], s40 offen offset:3072 sc1 lds
s_add_u32 m0, s33, 73728
s_add_u32 s40, s32, 73728
buffer_load_dwordx4 v2, s[8:11], s40 offen offset:0 sc1 lds
buffer_load_dwordx4 v2, s[8:11], s40 offen offset:1024 sc1 lds
buffer_load_dwordx4 v2, s[8:11], s40 offen offset:2048 sc1 lds
buffer_load_dwordx4 v2, s[8:11], s40 offen offset:3072 sc1 lds
s_add_u32 m0, s33, 77824
s_add_u32 s40, s32, 77824
buffer_load_dwordx4 v2, s[8:11], s40 offen offset:0 sc1 lds
buffer_load_dwordx4 v2, s[8:11], s40 offen offset:1024 sc1 lds
buffer_load_dwordx4 v2, s[8:11], s40 offen offset:2048 sc1 lds
buffer_load_dwordx4 v2, s[8:11], s40 offen offset:3072 sc1 lds
s_add_u32 m0, s33, 81920
s_add_u32 s40, s32, 81920
buffer_load_dwordx4 v2, s[8:11], s40 offen offset:0 sc1 lds
buffer_load_dwordx4 v2, s[8:11], s40 offen offset:1024 sc1 lds
buffer_load_dwordx4 v2, s[8:11], s40 offen offset:2048 sc1 lds
buffer_load_dwordx4 v2, s[8:11], s40 offen offset:3072 sc1 lds
s_add_u32 m0, s33, 86016
s_add_u32 s40, s32, 86016
buffer_load_dwordx4 v2, s[8:11], s40 offen offset:0 sc1 lds
buffer_load_dwordx4 v2, s[8:11], s40 offen offset:1024 sc1 lds
buffer_load_dwordx4 v2, s[8:11], s40 offen offset:2048 sc1 lds
buffer_load_dwordx4 v2, s[8:11], s40 offen offset:3072 sc1 lds
s_add_u32 m0, s33, 90112
s_add_u32 s40, s32, 90112
buffer_load_dwordx4 v2, s[8:11], s40 offen offset:0 sc1 lds
buffer_load_dwordx4 v2, s[8:11], s40 offen offset:1024 sc1 lds
buffer_load_dwordx4 v2, s[8:11], s40 offen offset:2048 sc1 lds
buffer_load_dwordx4 v2, s[8:11], s40 offen offset:3072 sc1 lds
s_add_u32 m0, s33, 94208
s_add_u32 s40, s32, 94208
buffer_load_dwordx4 v2, s[8:11], s40 offen offset:0 sc1 lds
buffer_load_dwordx4 v2, s[8:11], s40 offen offset:1024 sc1 lds
buffer_load_dwordx4 v2, s[8:11], s40 offen offset:2048 sc1 lds
buffer_load_dwordx4 v2, s[8:11], s40 offen offset:3072 sc1 lds
s_add_u32 m0, s33, 98304
s_add_u32 s40, s32, 98304
buffer_load_dwordx4 v2, s[8:11], s40 offen offset:0 sc1 lds
buffer_load_dwordx4 v2, s[8:11], s40 offen offset:1024 sc1 lds
buffer_load_dwordx4 v2, s[8:11], s40 offen offset:2048 sc1 lds
buffer_load_dwordx4 v2, s[8:11], s40 offen offset:3072 sc1 lds
s_add_u32 m0, s33, 102400
s_add_u32 s40, s32, 102400
buffer_load_dwordx4 v2, s[8:11], s40 offen offset:0 sc1 lds
buffer_load_dwordx4 v2, s[8:11], s40 offen offset:1024 sc1 lds
buffer_load_dwordx4 v2, s[8:11], s40 offen offset:2048 sc1 lds
buffer_load_dwordx4 v2, s[8:11], s40 offen offset:3072 sc1 lds
s_add_u32 m0, s33, 106496
s_add_u32 s40, s32, 106496
buffer_load_dwordx4 v2, s[8:11], s40 offen offset:0 sc1 lds
buffer_load_dwordx4 v2, s[8:11], s40 offen offset:1024 sc1 lds
buffer_load_dwordx4 v2, s[8:11], s40 offen offset:2048 sc1 lds
buffer_load_dwordx4 v2, s[8:11], s40 offen offset:3072 sc1 lds
s_add_u32 m0, s33, 110592
s_add_u32 s40, s32, 110592
buffer_load_dwordx4 v2, s[8:11], s40 offen offset:0 sc1 lds
buffer_load_dwordx4 v2, s[8:11], s40 offen offset:1024 sc1 lds
buffer_load_dwordx4 v2, s[8:11], s40 offen offset:2048 sc1 lds
buffer_load_dwordx4 v2, s[8:11], s40 offen offset:3072 sc1 lds
s_add_u32 m0, s33, 114688
s_add_u32 s40, s32, 114688
buffer_load_dwordx4 v2, s[8:11], s40 offen offset:0 sc1 lds
buffer_load_dwordx4 v2, s[8:11], s40 offen offset:1024 sc1 lds
buffer_load_dwordx4 v2, s[8:11], s40 offen offset:2048 sc1 lds
buffer_load_dwordx4 v2, s[8:11], s40 offen offset:3072 sc1 lds
s_add_u32 m0, s33, 118784
s_add_u32 s40, s32, 118784
buffer_load_dwordx4 v2, s[8:11], s40 offen offset:0 sc1 lds
buffer_load_dwordx4 v2, s[8:11], s40 offen offset:1024 sc1 lds
buffer_load_dwordx4 v2, s[8:11], s40 offen offset:2048 sc1 lds
buffer_load_dwordx4 v2, s[8:11], s40 offen offset:3072 sc1 lds
s_add_u32 m0, s33, 122880
s_add_u32 s40, s32, 122880
buffer_load_dwordx4 v2, s[8:11], s40 offen offset:0 sc1 lds
buffer_load_dwordx4 v2, s[8:11], s40 offen offset:1024 sc1 lds
buffer_load_dwordx4 v2, s[8:11], s40 offen offset:2048 sc1 lds
buffer_load_dwordx4 v2, s[8:11], s40 offen offset:3072 sc1 lds
s_add_u32 m0, s33, 126976
s_add_u32 s40, s32, 126976
buffer_load_dwordx4 v2, s[8:11], s40 offen offset:0 sc1 lds
buffer_load_dwordx4 v2, s[8:11], s40 offen offset:1024 sc1 lds
s_barrier
L_r_done:
s_mov_b32 s70, 25329664
s_mov_b32 s71, 30048256
s_mov_b32 s72, 34766848
s_mov_b32 s73, 39485440
s_mov_b32 s74, 41975808
s_mov_b32 s75, 60981248
s_mov_b32 s76, 98729984
s_mov_b32 s77, 1048576
s_mov_b32 s7, 1
s_lshr_b32 s20, s5, 2
s_lshl_b32 s20, s20, 3
s_lshr_b32 s21, s6, 2
s_add_u32 s20, s20, s21
s_and_b32 s21, s5, 3
s_lshl_b32 s21, s21, 2
s_and_b32 s22, s6, 3
s_add_u32 s21, s21, s22
s_lshl_b32 s24, s20, 3
s_sub_u32 s25, s24, 1
s_max_i32 s35, s25, 0
s_mul_i32 s25, s35, 18432
s_lshl_b32 s26, s4, 1
s_add_u32 s36, s24, s26
s_mul_i32 s24, s36, 18432
s_add_u32 s26, s24, s70
s_add_u32 s27, s26, 18432
s_add_u32 s28, s25, s70
v_add_u32 v4, 0x10000, v2
v_add_u32 v5, 0x20000, v2
s_cmp_eq_u32 s4, 3
s_cselect_b32 s29, 0, s4
s_cselect_b32 s31, 16, 9
s_lshl_b32 s30, s29, 10
v_and_b32 v12, 15, v1
v_mov_b32 v13, 2146435072
v_cmp_le_u32 vcc, s31, v12
s_nop 1
v_cndmask_b32 v3, v13, v2, vcc
s_add_u32 s31, s30, 2048
v_add_u32 v6, s31, v2
v_add_u32 v7, s31, v4
v_add_u32 v8, s31, v5
s_and_b32 s30, s30, 1024
s_add_u32 s31, s30, 5120
v_add_u32 v9, s31, v2
v_add_u32 v10, s31, v4
v_add_u32 v11, s31, v5
s_lshl_b32 s22, s36, 1
s_lshl_b32 s23, s35, 1
s_add_u32 s23, s23, 1
v_and_b32 v16, 3, v1
v_add_u32 v16, s22, v16
v_mov_b32 v17, s23
v_cmp_eq_u32 vcc, 4, v1
s_nop 1
v_cndmask_b32 v16, v16, v17, vcc
v_lshlrev_b32 v16, 7, v16
s_add_u32 s22, s77, 786432
v_mov_b32 v13, 2146435072
v_cmp_gt_u32 vcc, 16, v0
v_lshlrev_b32 v14, 3, v0
s_nop 0
v_cndmask_b32 v13, v13, v14, vcc
v_mov_b32 v14, s68
v_mov_b32 v15, s69
s_waitcnt vmcnt(0)
s_barrier
buffer_store_dwordx2 v[14:15], v13, s[8:11], s14 offen sc1
s_mov_b32 s52, 0
L_poll7:
buffer_load_dwordx2 v[14:15], v16, s[8:11], s22 offen sc1
s_add_u32 s52, s52, 1
s_waitcnt vmcnt(0)
v_cmp_ne_u64 vcc, s[68:69], v[14:15]
s_cmp_ge_u32 s52, 1048576
s_cbranch_scc1 L_got7
s_and_b64 exec, exec, vcc
s_cbranch_execnz L_poll7
L_got7:
s_mov_b64 exec, -1
buffer_load_dwordx4 a[0:3], v2, s[8:11], s26 offen offset:0 sc1
buffer_load_dwordx4 a[72:75], v2, s[8:11], s27 offen offset:0 sc1
buffer_load_dwordx4 a[144:147], v3, s[8:11], s28 offen offset:0 sc1
buffer_load_dwordx4 a[4:7], v2, s[8:11], s26 offen offset:1024 sc1
buffer_load_dwordx4 a[76:79], v2, s[8:11], s27 offen offset:1024 sc1
buffer_load_dwordx4 a[148:151], v3, s[8:11], s28 offen offset:1024 sc1
buffer_load_dwordx4 a[8:11], v2, s[8:11], s26 offen offset:2048 sc1
buffer_load_dwordx4 a[80:83], v2, s[8:11], s27 offen offset:2048 sc1
buffer_load_dwordx4 a[152:155], v3, s[8:11], s28 offen offset:2048 sc1
buffer_load_dwordx4 a[12:15], v2, s[8:11], s26 offen offset:3072 sc1
buffer_load_dwordx4 a[84:87], v2, s[8:11], s27 offen offset:3072 sc1
buffer_load_dwordx4 a[156:159], v3, s[8:11], s28 offen offset:3072 sc1
s_add_u32 s26, s26, 4096
s_add_u32 s27, s27, 4096
s_add_u32 s28, s28, 4096
buffer_load_dwordx4 a[16:19], v2, s[8:11], s26 offen offset:0 sc1
buffer_load_dwordx4 a[88:91], v2, s[8:11], s27 offen offset:0 sc1
buffer_load_dwordx4 a[160:163], v3, s[8:11], s28 offen offset:0 sc1
buffer_load_dwordx4 a[20:23], v2, s[8:11], s26 offen offset:1024 sc1
buffer_load_dwordx4 a[92:95], v2, s[8:11], s27 offen offset:1024 sc1
buffer_load_dwordx4 a[164:167], v3, s[8:11], s28 offen offset:1024 sc1
buffer_load_dwordx4 a[24:27], v2, s[8:11], s26 offen offset:2048 sc1
buffer_load_dwordx4 a[96:99], v2, s[8:11], s27 offen offset:2048 sc1
buffer_load_dwordx4 a[168:171], v3, s[8:11], s28 offen offset:2048 sc1
buffer_load_dwordx4 a[28:31], v2, s[8:11], s26 offen offset:3072 sc1
buffer_load_dwordx4 a[100:103], v2, s[8:11], s27 offen offset:3072 sc1
buffer_load_dwordx4 a[172:175], v3, s[8:11], s28 offen offset:3072 sc1
v_lshrrev_b32 v13, 4, v1
v_lshlrev_b32 v14, 2, v13
v_sub_u32 v14, v12, v14
v_subrev_u32 v15, 0, v14
v_cmp_gt_u32 s[52:53], 8, v15
v_cmp_gt_i32 s[44:45], -8, v15
v_subrev_u32 v15, 1, v14
v_cmp_gt_u32 s[54:55], 8, v15
v_cmp_gt_i32 s[46:47], -8, v15
v_subrev_u32 v15, 2, v14
v_cmp_gt_u32 s[56:57], 8, v15
v_cmp_gt_i32 s[48:49], -8, v15
v_subrev_u32 v15, 3, v14
v_cmp_gt_u32 s[58:59], 8, v15
v_cmp_gt_i32 s[50:51], -8, v15
s_and_b32 s31, s20, 7
s_or_b32 s31, s31, s4
s_cmp_eq_u32 s31, 0
s_cselect_b64 s[60:61], 0, s[44:45]
s_cselect_b64 s[62:63], 0, s[46:47]
s_cselect_b64 s[64:65], 0, s[48:49]
s_cselect_b64 s[66:67], 0, s[50:51]
ds_read_b128 a[216:219], v2 offset:0
ds_read_b128 a[220:223], v2 offset:7168
ds_read_b128 a[224:227], v2 offset:1024
ds_read_b128 a[228:231], v2 offset:8192
ds_read_b128 a[232:235], v2 offset:2048
ds_read_b128 a[236:239], v2 offset:9216
s_waitcnt vmcnt(18)
s_waitcnt lgkmcnt(4)
v_mfma_f32_16x16x32_bf16 v[32:35], a[216:219], a[0:3], 0
s_add_u32 s26, s26, 4096
s_add_u32 s27, s27, 4096
s_add_u32 s28, s28, 4096
buffer_load_dwordx4 a[32:35], v2, s[8:11], s26 offen offset:0 sc1
v_mfma_f32_16x16x32_bf16 v[32:35], a[220:223], a[4:7], v[32:35]
L_hop12:
s_cmp_lg_u32 s15, 0
s_cbranch_scc1 L_hop_done
ds_read_b128 a[240:243], v2 offset:3072
v_lshlrev_b32 v14, 3, v1
v_mfma_f32_16x16x32_bf16 v[36:39], a[216:219], a[72:75], 0
s_mul_i32 s31, s4, 3072
s_add_u32 s41, s31, 147456
v_mfma_f32_16x16x32_bf16 v[36:39], a[220:223], a[76:79], v[36:39]
ds_read_b128 a[244:247], v2 offset:10240
s_waitcnt lgkmcnt(4)
v_mfma_f32_16x16x32_bf16 v[40:43], a[224:227], a[0:3], 0
buffer_load_dwordx4 a[104:107], v2, s[8:11], s27 offen offset:0 sc1
v_mfma_f32_16x16x32_bf16 v[40:43], a[228:231], a[4:7], v[40:43]
ds_read_b128 a[216:219], v2 offset:4096
v_add_u32 v15, s41, v14
v_mfma_f32_16x16x32_bf16 v[44:47], a[224:227], a[72:75], 0
s_lshl_b32 s42, s29, 9
s_add_u32 s42, s42, 147456
v_mfma_f32_16x16x32_bf16 v[44:47], a[228:231], a[76:79], v[44:47]
ds_read_b128 a[220:223], v2 offset:11264
s_waitcnt lgkmcnt(4)
v_mfma_f32_16x16x32_bf16 v[48:51], a[232:235], a[0:3], 0
buffer_load_dwordx4 a[176:179], v3, s[8:11], s28 offen offset:0 sc1
v_mfma_f32_16x16x32_bf16 v[48:51], a[236:239], a[4:7], v[48:51]
ds_read_b128 a[224:227], v2 offset:5120
v_add_u32 v16, s42, v14
v_mfma_f32_16x16x32_bf16 v[52:55], a[232:235], a[72:75], 0
s_and_b32 s42, s42, 512
s_add_u32 s42, s42, 147456
v_mfma_f32_16x16x32_bf16 v[52:55], a[236:239], a[76:79], v[52:55]
ds_read_b128 a[228:231], v2 offset:12288
s_waitcnt lgkmcnt(4)
v_mfma_f32_16x16x32_bf16 v[56:59], a[240:243], a[0:3], 0
buffer_load_dwordx4 a[36:39], v2, s[8:11], s26 offen offset:1024 sc1
v_mfma_f32_16x16x32_bf16 v[56:59], a[244:247], a[4:7], v[56:59]
ds_read_b128 a[232:235], v2 offset:6144
v_add_u32 v19, s42, v14
v_mfma_f32_16x16x32_bf16 v[60:63], a[240:243], a[72:75], 0
v_add_u32 v18, 150016, v14
v_mov_b32 v96, 0
v_mfma_f32_16x16x32_bf16 v[60:63], a[244:247], a[76:79], v[60:63]
ds_read_b128 a[236:239], v2 offset:13312
s_waitcnt lgkmcnt(4)
v_mfma_f32_16x16x32_bf16 v[64:67], a[216:219], a[0:3], 0
buffer_load_dwordx4 a[108:111], v2, s[8:11], s27 offen offset:1024 sc1
v_mfma_f32_16x16x32_bf16 v[64:67], a[220:223], a[4:7], v[64:67]
ds_read_b128 a[240:243], v6 offset:0
v_mov_b32 v97, 0
v_mfma_f32_16x16x32_bf16 v[68:71], a[216:219], a[72:75], 0
v_mov_b32 v100, 0
v_mov_b32 v101, 0
v_mfma_f32_16x16x32_bf16 v[68:71], a[220:223], a[76:79], v[68:71]
ds_read_b128 a[244:247], v6 offset:7168
s_waitcnt lgkmcnt(4)
v_mfma_f32_16x16x32_bf16 v[72:75], a[0:3], a[224:227], 0
buffer_load_dwordx4 a[180:183], v3, s[8:11], s28 offen offset:1024 sc1
v_mfma_f32_16x16x32_bf16 v[72:75], a[4:7], a[228:231], v[72:75]
ds_read_b128 a[216:219], v9 offset:0
v_and_b32 v13, 1, v1
v_mfma_f32_16x16x32_bf16 v[76:79], a[72:75], a[224:227], 0
v_lshlrev_b32 v13, 4, v13
v_mov_b32 v102, 0x3f80
v_mfma_f32_16x16x32_bf16 v[76:79], a[76:79], a[228:231], v[76:79]
ds_read_b128 a[220:223], v9 offset:7168
s_waitcnt lgkmcnt(4)
v_mfma_f32_16x16x32_bf16 v[80:83], a[0:3], a[232:235], 0
buffer_load_dwordx4 a[40:43], v2, s[8:11], s26 offen offset:2048 sc1
v_mfma_f32_16x16x32_bf16 v[80:83], a[4:7], a[236:239], v[80:83]
ds_read_b128 a[224:227], v2 offset:14336
v_lshlrev_b32 v13, v13, v102
v_mfma_f32_16x16x32_bf16 v[84:87], a[72:75], a[232:235], 0
v_lshrrev_b32 v102, 1, v1
v_cmp_eq_u32 vcc, 16, v102
v_mfma_f32_16x16x32_bf16 v[84:87], a[76:79], a[236:239], v[84:87]
ds_read_b128 a[228:231], v2 offset:21504
s_waitcnt lgkmcnt(4)
v_mfma_f32_16x16x32_bf16 v[88:91], a[240:243], a[144:147], 0
ds_read_b128 a[232:235], v2 offset:15360
buffer_load_dwordx4 a[112:115], v2, s[8:11], s27 offen offset:2048 sc1
v_mfma_f32_16x16x32_bf16 v[88:91], a[244:247], a[148:151], v[88:91]
ds_read_b128 a[236:239], v2 offset:22528
s_waitcnt lgkmcnt(4)
v_mfma_f32_16x16x32_bf16 v[92:95], a[144:147], a[216:219], 0
ds_read_b128 a[240:243], v2 offset:16384
v_cndmask_b32 v98, 0, v13, vcc
v_mfma_f32_16x16x32_bf16 v[92:95], a[148:151], a[220:223], v[92:95]
ds_read_b128 a[244:247], v2 offset:23552
s_waitcnt vmcnt(20)
s_waitcnt lgkmcnt(4)
v_mfma_f32_16x16x32_bf16 v[32:35], a[224:227], a[8:11], v[32:35]
buffer_load_dwordx4 a[184:187], v3, s[8:11], s28 offen offset:2048 sc1
v_mfma_f32_16x16x32_bf16 v[32:35], a[228:231], a[12:15], v[32:35]
ds_read_b128 a[216:219], v2 offset:17408
v_cmp_eq_u32 vcc, 17, v102
v_mfma_f32_16x16x32_bf16 v[36:39], a[224:227], a[80:83], v[36:39]
s_nop 0
v_cndmask_b32 v99, 0, v13, vcc
v_add_u32 v17, 16, v12
v_mfma_f32_16x16x32_bf16 v[36:39], a[228:231], a[84:87], v[36:39]
ds_read_b128 a[220:223], v2 offset:24576
s_waitcnt lgkmcnt(4)
v_mfma_f32_16x16x32_bf16 v[40:43], a[232:235], a[8:11], v[40:43]
buffer_load_dwordx4 a[44:47], v2, s[8:11], s26 offen offset:3072 sc1
v_mfma_f32_16x16x32_bf16 v[40:43], a[236:239], a[12:15], v[40:43]
ds_read_b128 a[224:227], v2 offset:18432
v_cmp_gt_u32 vcc, 16, v1
v_mfma_f32_16x16x32_bf16 v[44:47], a[232:235], a[80:83], v[44:47]
v_add_u32 v14, 48, v12
s_mov_b32 s34, 0x3eae1a93
v_mfma_f32_16x16x32_bf16 v[44:47], a[236:239], a[84:87], v[44:47]
ds_read_b128 a[228:231], v2 offset:25600
s_waitcnt lgkmcnt(4)
v_mfma_f32_16x16x32_bf16 v[48:51], a[240:243], a[8:11], v[48:51]
buffer_load_dwordx4 a[116:119], v2, s[8:11], s27 offen offset:3072 sc1
v_mfma_f32_16x16x32_bf16 v[48:51], a[244:247], a[12:15], v[48:51]
ds_read_b128 a[232:235], v2 offset:19456
v_cndmask_b32 v17, v14, v17, vcc
v_mfma_f32_16x16x32_bf16 v[52:55], a[240:243], a[80:83], v[52:55]
v_lshlrev_b32 v17, 3, v17
v_add_u32 v17, s41, v17
v_mfma_f32_16x16x32_bf16 v[52:55], a[244:247], a[84:87], v[52:55]
ds_read_b128 a[236:239], v2 offset:26624
s_waitcnt lgkmcnt(4)
v_mfma_f32_16x16x32_bf16 v[56:59], a[216:219], a[8:11], v[56:59]
buffer_load_dwordx4 a[188:191], v3, s[8:11], s28 offen offset:3072 sc1
v_mfma_f32_16x16x32_bf16 v[56:59], a[220:223], a[12:15], v[56:59]
ds_read_b128 a[240:243], v2 offset:20480
v_mov_b32 v103, 0xff61b1e6
v_mfma_f32_16x16x32_bf16 v[60:63], a[216:219], a[80:83], v[60:63]
v_mov_b32 v102, 0xffff
v_cndmask_b32 v172, v103, 0, s[44:45]
v_mfma_f32_16x16x32_bf16 v[60:63], a[220:223], a[84:87], v[60:63]
ds_read_b128 a[244:247], v2 offset:27648
s_waitcnt lgkmcnt(4)
v_mfma_f32_16x16x32_bf16 v[64:67], a[224:227], a[8:11], v[64:67]
s_add_u32 s26, s26, 4096
s_add_u32 s27, s27, 4096
s_add_u32 s28, s28, 4096
buffer_load_dwordx4 a[48:51], v2, s[8:11], s26 offen offset:0 sc1
v_mfma_f32_16x16x32_bf16 v[64:67], a[228:231], a[12:15], v[64:67]
ds_read_b128 a[216:219], v6 offset:14336
v_cndmask_b32 v173, v103, 0, s[46:47]
v_mfma_f32_16x16x32_bf16 v[68:71], a[224:227], a[80:83], v[68:71]
v_cndmask_b32 v174, v103, 0, s[48:49]
v_cndmask_b32 v175, v103, 0, s[50:51]
v_mfma_f32_16x16x32_bf16 v[68:71], a[228:231], a[84:87], v[68:71]
ds_read_b128 a[220:223], v6 offset:21504
s_waitcnt lgkmcnt(4)
v_mfma_f32_16x16x32_bf16 v[72:75], a[8:11], a[232:235], v[72:75]
buffer_load_dwordx4 a[120:123], v2, s[8:11], s27 offen offset:0 sc1
v_mfma_f32_16x16x32_bf16 v[72:75], a[12:15], a[236:239], v[72:75]
ds_read_b128 a[224:227], v9 offset:14336
v_cndmask_b32 v184, 0, v102, s[44:45]
v_mfma_f32_16x16x32_bf16 v[76:79], a[80:83], a[232:235], v[76:79]
v_cndmask_b32 v13, 0, v102, s[46:47]
v_lshl_or_b32 v184, v13, 16, v184
v_mfma_f32_16x16x32_bf16 v[76:79], a[84:87], a[236:239], v[76:79]
ds_read_b128 a[228:231], v9 offset:21504
s_waitcnt lgkmcnt(4)
v_mfma_f32_16x16x32_bf16 v[80:83], a[8:11], a[240:243], v[80:83]
buffer_load_dwordx4 a[192:195], v3, s[8:11], s28 offen offset:0 sc1
v_mfma_f32_16x16x32_bf16 v[80:83], a[12:15], a[244:247], v[80:83]
ds_read_b128 a[232:235], v2 offset:28672
v_cndmask_b32 v185, 0, v102, s[48:49]
v_mfma_f32_16x16x32_bf16 v[84:87], a[80:83], a[240:243], v[84:87]
v_cndmask_b32 v13, 0, v102, s[50:51]
v_lshl_or_b32 v185, v13, 16, v185
v_mfma_f32_16x16x32_bf16 v[84:87], a[84:87], a[244:247], v[84:87]
ds_read_b128 a[236:239], v2 offset:35840
s_waitcnt lgkmcnt(4)
v_mfma_f32_16x16x32_bf16 v[88:91], a[216:219], a[152:155], v[88:91]
ds_read_b128 a[240:243], v2 offset:29696
buffer_load_dwordx4 a[52:55], v2, s[8:11], s26 offen offset:1024 sc1
v_mfma_f32_16x16x32_bf16 v[88:91], a[220:223], a[156:159], v[88:91]
ds_read_b128 a[244:247], v2 offset:36864
s_waitcnt lgkmcnt(4)
v_mfma_f32_16x16x32_bf16 v[92:95], a[152:155], a[224:227], v[92:95]
ds_read_b128 a[216:219], v2 offset:30720
v_cndmask_b32 v176, v103, 0, s[52:53]
v_mfma_f32_16x16x32_bf16 v[92:95], a[156:159], a[228:231], v[92:95]
ds_read_b128 a[220:223], v2 offset:37888
s_waitcnt vmcnt(22)
s_waitcnt lgkmcnt(4)
v_mfma_f32_16x16x32_bf16 v[32:35], a[232:235], a[16:19], v[32:35]
buffer_load_dwordx4 a[124:127], v2, s[8:11], s27 offen offset:1024 sc1
v_mfma_f32_16x16x32_bf16 v[32:35], a[236:239], a[20:23], v[32:35]
ds_read_b128 a[224:227], v2 offset:31744
v_cndmask_b32 v177, v103, 0, s[54:55]
v_mfma_f32_16x16x32_bf16 v[36:39], a[232:235], a[88:91], v[36:39]
v_cndmask_b32 v178, v103, 0, s[56:57]
v_cndmask_b32 v179, v103, 0, s[58:59]
v_mfma_f32_16x16x32_bf16 v[36:39], a[236:239], a[92:95], v[36:39]
ds_read_b128 a[228:231], v2 offset:38912
s_waitcnt lgkmcnt(4)
v_mfma_f32_16x16x32_bf16 v[40:43], a[240:243], a[16:19], v[40:43]
buffer_load_dwordx4 a[196:199], v3, s[8:11], s28 offen offset:1024 sc1
v_mfma_f32_16x16x32_bf16 v[40:43], a[244:247], a[20:23], v[40:43]
ds_read_b128 a[232:235], v2 offset:32768
v_cndmask_b32 v186, 0, v102, s[52:53]
v_mfma_f32_16x16x32_bf16 v[44:47], a[240:243], a[88:91], v[44:47]
v_cndmask_b32 v13, 0, v102, s[54:55]
v_lshl_or_b32 v186, v13, 16, v186
v_mfma_f32_16x16x32_bf16 v[44:47], a[244:247], a[92:95], v[44:47]
ds_read_b128 a[236:239], v2 offset:39936
s_waitcnt lgkmcnt(4)
v_mfma_f32_16x16x32_bf16 v[48:51], a[216:219], a[16:19], v[48:51]
buffer_load_dwordx4 a[56:59], v2, s[8:11], s26 offen offset:2048 sc1
v_mfma_f32_16x16x32_bf16 v[48:51], a[220:223], a[20:23], v[48:51]
ds_read_b128 a[240:243], v2 offset:33792
v_cndmask_b32 v187, 0, v102, s[56:57]
v_mfma_f32_16x16x32_bf16 v[52:55], a[216:219], a[88:91], v[52:55]
v_cndmask_b32 v13, 0, v102, s[58:59]
v_lshl_or_b32 v187, v13, 16, v187
v_mfma_f32_16x16x32_bf16 v[52:55], a[220:223], a[92:95], v[52:55]
ds_read_b128 a[244:247], v2 offset:40960
s_waitcnt lgkmcnt(4)
v_mfma_f32_16x16x32_bf16 v[56:59], a[224:227], a[16:19], v[56:59]
buffer_load_dwordx4 a[128:131], v2, s[8:11], s27 offen offset:2048 sc1
v_mfma_f32_16x16x32_bf16 v[56:59], a[228:231], a[20:23], v[56:59]
ds_read_b128 a[216:219], v2 offset:34816
v_cndmask_b32 v180, v103, 0, s[60:61]
v_mfma_f32_16x16x32_bf16 v[60:63], a[224:227], a[88:91], v[60:63]
v_cndmask_b32 v181, v103, 0, s[62:63]
v_cndmask_b32 v182, v103, 0, s[64:65]
v_mfma_f32_16x16x32_bf16 v[60:63], a[228:231], a[92:95], v[60:63]
ds_read_b128 a[220:223], v2 offset:41984
s_waitcnt lgkmcnt(4)
v_mfma_f32_16x16x32_bf16 v[64:67], a[232:235], a[16:19], v[64:67]
buffer_load_dwordx4 a[200:203], v3, s[8:11], s28 offen offset:2048 sc1
v_mfma_f32_16x16x32_bf16 v[64:67], a[236:239], a[20:23], v[64:67]
ds_read_b128 a[224:227], v6 offset:28672
v_cndmask_b32 v183, v103, 0, s[66:67]
v_mfma_f32_16x16x32_bf16 v[68:71], a[232:235], a[88:91], v[68:71]
v_cndmask_b32 v188, 0, v102, s[60:61]
v_cndmask_b32 v13, 0, v102, s[62:63]
v_mfma_f32_16x16x32_bf16 v[68:71], a[236:239], a[92:95], v[68:71]
ds_read_b128 a[228:231], v6 offset:35840
s_waitcnt lgkmcnt(4)
v_mfma_f32_16x16x32_bf16 v[72:75], a[16:19], a[240:243], v[72:75]
buffer_load_dwordx4 a[60:63], v2, s[8:11], s26 offen offset:3072 sc1
v_mfma_f32_16x16x32_bf16 v[72:75], a[20:23], a[244:247], v[72:75]
ds_read_b128 a[232:235], v9 offset:28672
v_lshl_or_b32 v188, v13, 16, v188
v_mfma_f32_16x16x32_bf16 v[76:79], a[88:91], a[240:243], v[76:79]
v_cndmask_b32 v189, 0, v102, s[64:65]
v_cndmask_b32 v13, 0, v102, s[66:67]
v_mfma_f32_16x16x32_bf16 v[76:79], a[92:95], a[244:247], v[76:79]
ds_read_b128 a[236:239], v9 offset:35840
s_waitcnt lgkmcnt(4)
v_mfma_f32_16x16x32_bf16 v[80:83], a[16:19], a[216:219], v[80:83]
buffer_load_dwordx4 a[132:135], v2, s[8:11], s27 offen offset:3072 sc1
v_mfma_f32_16x16x32_bf16 v[80:83], a[20:23], a[220:223], v[80:83]
ds_read_b128 a[240:243], v2 offset:43008
v_lshl_or_b32 v189, v13, 16, v189
v_mfma_f32_16x16x32_bf16 v[84:87], a[88:91], a[216:219], v[84:87]
v_mfma_f32_16x16x32_bf16 v[84:87], a[92:95], a[220:223], v[84:87]
ds_read_b128 a[244:247], v2 offset:50176
s_waitcnt lgkmcnt(4)
v_mfma_f32_16x16x32_bf16 v[88:91], a[224:227], a[160:163], v[88:91]
ds_read_b128 a[216:219], v2 offset:44032
buffer_load_dwordx4 a[204:207], v3, s[8:11], s28 offen offset:3072 sc1
v_mfma_f32_16x16x32_bf16 v[88:91], a[228:231], a[164:167], v[88:91]
ds_read_b128 a[220:223], v2 offset:51200
s_waitcnt lgkmcnt(4)
v_mfma_f32_16x16x32_bf16 v[92:95], a[160:163], a[232:235], v[92:95]
ds_read_b128 a[224:227], v2 offset:45056
v_mfma_f32_16x16x32_bf16 v[92:95], a[164:167], a[236:239], v[92:95]
ds_read_b128 a[228:231], v2 offset:52224
s_waitcnt vmcnt(24)
s_waitcnt lgkmcnt(4)
v_mfma_f32_16x16x32_bf16 v[32:35], a[240:243], a[24:27], v[32:35]
s_add_u32 s26, s26, 4096
s_add_u32 s27, s27, 4096
s_add_u32 s28, s28, 4096
buffer_load_dwordx4 a[64:67], v2, s[8:11], s26 offen offset:0 sc1
v_mfma_f32_16x16x32_bf16 v[32:35], a[244:247], a[28:31], v[32:35]
ds_read_b128 a[232:235], v2 offset:46080
v_mfma_f32_16x16x32_bf16 v[36:39], a[240:243], a[96:99], v[36:39]
v_mfma_f32_16x16x32_bf16 v[36:39], a[244:247], a[100:103], v[36:39]
ds_read_b128 a[236:239], v2 offset:53248
s_waitcnt lgkmcnt(4)
v_mfma_f32_16x16x32_bf16 v[40:43], a[216:219], a[24:27], v[40:43]
buffer_load_dwordx4 a[136:139], v2, s[8:11], s27 offen offset:0 sc1
v_mfma_f32_16x16x32_bf16 v[40:43], a[220:223], a[28:31], v[40:43]
ds_read_b128 a[240:243], v2 offset:47104
v_mfma_f32_16x16x32_bf16 v[44:47], a[216:219], a[96:99], v[44:47]
v_mfma_f32_16x16x32_bf16 v[44:47], a[220:223], a[100:103], v[44:47]
ds_read_b128 a[244:247], v2 offset:54272
s_waitcnt lgkmcnt(4)
v_mfma_f32_16x16x32_bf16 v[48:51], a[224:227], a[24:27], v[48:51]
buffer_load_dwordx4 a[208:211], v3, s[8:11], s28 offen offset:0 sc1
v_mfma_f32_16x16x32_bf16 v[48:51], a[228:231], a[28:31], v[48:51]
ds_read_b128 a[216:219], v2 offset:48128
v_mfma_f32_16x16x32_bf16 v[52:55], a[224:227], a[96:99], v[52:55]
v_mfma_f32_16x16x32_bf16 v[52:55], a[228:231], a[100:103], v[52:55]
ds_read_b128 a[220:223], v2 offset:55296
s_waitcnt lgkmcnt(4)
v_mfma_f32_16x16x32_bf16 v[56:59], a[232:235], a[24:27], v[56:59]
buffer_load_dwordx4 a[68:71], v2, s[8:11], s26 offen offset:1024 sc1
v_mfma_f32_16x16x32_bf16 v[56:59], a[236:239], a[28:31], v[56:59]
ds_read_b128 a[224:227], v2 offset:49152
v_mfma_f32_16x16x32_bf16 v[60:63], a[232:235], a[96:99], v[60:63]
v_mfma_f32_16x16x32_bf16 v[60:63], a[236:239], a[100:103], v[60:63]
ds_read_b128 a[228:231], v2 offset:56320
s_waitcnt lgkmcnt(4)
v_mfma_f32_16x16x32_bf16 v[64:67], a[240:243], a[24:27], v[64:67]
buffer_load_dwordx4 a[140:143], v2, s[8:11], s27 offen offset:1024 sc1
v_mfma_f32_16x16x32_bf16 v[64:67], a[244:247], a[28:31], v[64:67]
ds_read_b128 a[232:235], v6 offset:43008
v_mfma_f32_16x16x32_bf16 v[68:71], a[240:243], a[96:99], v[68:71]
v_mfma_f32_16x16x32_bf16 v[68:71], a[244:247], a[100:103], v[68:71]
ds_read_b128 a[236:239], v6 offset:50176
s_waitcnt lgkmcnt(4)
v_mfma_f32_16x16x32_bf16 v[72:75], a[24:27], a[216:219], v[72:75]
buffer_load_dwordx4 a[212:215], v3, s[8:11], s28 offen offset:1024 sc1
v_mfma_f32_16x16x32_bf16 v[72:75], a[28:31], a[220:223], v[72:75]
ds_read_b128 a[240:243], v9 offset:43008
v_mfma_f32_16x16x32_bf16 v[76:79], a[96:99], a[216:219], v[76:79]
v_mfma_f32_16x16x32_bf16 v[76:79], a[100:103], a[220:223], v[76:79]
ds_read_b128 a[244:247], v9 offset:50176
s_waitcnt lgkmcnt(4)
v_mfma_f32_16x16x32_bf16 v[80:83], a[24:27], a[224:227], v[80:83]
v_mfma_f32_16x16x32_bf16 v[80:83], a[28:31], a[228:231], v[80:83]
ds_read_b128 a[216:219], v2 offset:57344
v_mfma_f32_16x16x32_bf16 v[84:87], a[96:99], a[224:227], v[84:87]
v_mfma_f32_16x16x32_bf16 v[84:87], a[100:103], a[228:231], v[84:87]
ds_read_b128 a[220:223], v2 offset:64512
s_waitcnt lgkmcnt(4)
v_mfma_f32_16x16x32_bf16 v[88:91], a[232:235], a[168:171], v[88:91]
ds_read_b128 a[224:227], v2 offset:58368
v_mfma_f32_16x16x32_bf16 v[88:91], a[236:239], a[172:175], v[88:91]
ds_read_b128 a[228:231], v4 offset:0
s_waitcnt lgkmcnt(4)
v_mfma_f32_16x16x32_bf16 v[92:95], a[168:171], a[240:243], v[92:95]
ds_read_b128 a[232:235], v2 offset:59392
v_mfma_f32_16x16x32_bf16 v[92:95], a[172:175], a[244:247], v[92:95]
ds_read_b128 a[236:239], v4 offset:1024
s_waitcnt vmcnt(24)
s_waitcnt lgkmcnt(4)
v_mfma_f32_16x16x32_bf16 v[32:35], a[216:219], a[32:35], v[32:35]
v_mfma_f32_16x16x32_bf16 v[32:35], a[220:223], a[36:39], v[32:35]
ds_read_b128 a[240:243], v2 offset:60416
v_mfma_f32_16x16x32_bf16 v[36:39], a[216:219], a[104:107], v[36:39]
v_mfma_f32_16x16x32_bf16 v[36:39], a[220:223], a[108:111], v[36:39]
ds_read_b128 a[244:247], v4 offset:2048
s_waitcnt lgkmcnt(4)
v_mfma_f32_16x16x32_bf16 v[40:43], a[224:227], a[32:35], v[40:43]
v_mfma_f32_16x16x32_bf16 v[40:43], a[228:231], a[36:39], v[40:43]
ds_read_b128 a[216:219], v2 offset:61440
v_mfma_f32_16x16x32_bf16 v[44:47], a[224:227], a[104:107], v[44:47]
v_mfma_f32_16x16x32_bf16 v[44:47], a[228:231], a[108:111], v[44:47]
ds_read_b128 a[220:223], v4 offset:3072
s_waitcnt lgkmcnt(4)
v_mfma_f32_16x16x32_bf16 v[48:51], a[232:235], a[32:35], v[48:51]
v_mfma_f32_16x16x32_bf16 v[48:51], a[236:239], a[36:39], v[48:51]
ds_read_b128 a[224:227], v2 offset:62464
v_mfma_f32_16x16x32_bf16 v[52:55], a[232:235], a[104:107], v[52:55]
v_mfma_f32_16x16x32_bf16 v[52:55], a[236:239], a[108:111], v[52:55]
ds_read_b128 a[228:231], v4 offset:4096
s_waitcnt lgkmcnt(4)
v_mfma_f32_16x16x32_bf16 v[56:59], a[240:243], a[32:35], v[56:59]
v_mfma_f32_16x16x32_bf16 v[56:59], a[244:247], a[36:39], v[56:59]
ds_read_b128 a[232:235], v2 offset:63488
v_mfma_f32_16x16x32_bf16 v[60:63], a[240:243], a[104:107], v[60:63]
v_mfma_f32_16x16x32_bf16 v[60:63], a[244:247], a[108:111], v[60:63]
ds_read_b128 a[236:239], v4 offset:5120
s_waitcnt lgkmcnt(4)
v_mfma_f32_16x16x32_bf16 v[64:67], a[216:219], a[32:35], v[64:67]
v_mfma_f32_16x16x32_bf16 v[64:67], a[220:223], a[36:39], v[64:67]
ds_read_b128 a[240:243], v6 offset:57344
v_mfma_f32_16x16x32_bf16 v[68:71], a[216:219], a[104:107], v[68:71]
v_mfma_f32_16x16x32_bf16 v[68:71], a[220:223], a[108:111], v[68:71]
ds_read_b128 a[244:247], v6 offset:64512
s_waitcnt lgkmcnt(4)
v_mfma_f32_16x16x32_bf16 v[72:75], a[32:35], a[224:227], v[72:75]
v_mfma_f32_16x16x32_bf16 v[72:75], a[36:39], a[228:231], v[72:75]
ds_read_b128 a[216:219], v9 offset:57344
v_mfma_f32_16x16x32_bf16 v[76:79], a[104:107], a[224:227], v[76:79]
v_mfma_f32_16x16x32_bf16 v[76:79], a[108:111], a[228:231], v[76:79]
ds_read_b128 a[220:223], v9 offset:64512
s_waitcnt lgkmcnt(4)
v_mfma_f32_16x16x32_bf16 v[80:83], a[32:35], a[232:235], v[80:83]
v_mfma_f32_16x16x32_bf16 v[80:83], a[36:39], a[236:239], v[80:83]
ds_read_b128 a[224:227], v4 offset:6144
v_mfma_f32_16x16x32_bf16 v[84:87], a[104:107], a[232:235], v[84:87]
v_mfma_f32_16x16x32_bf16 v[84:87], a[108:111], a[236:239], v[84:87]
ds_read_b128 a[228:231], v4 offset:13312
s_waitcnt lgkmcnt(4)
v_mfma_f32_16x16x32_bf16 v[88:91], a[240:243], a[176:179], v[88:91]
ds_read_b128 a[232:235], v4 offset:7168
v_mfma_f32_16x16x32_bf16 v[88:91], a[244:247], a[180:183], v[88:91]
ds_read_b128 a[236:239], v4 offset:14336
s_waitcnt lgkmcnt(4)
v_mfma_f32_16x16x32_bf16 v[92:95], a[176:179], a[216:219], v[92:95]
ds_read_b128 a[240:243], v4 offset:8192
v_mfma_f32_16x16x32_bf16 v[92:95], a[180:183], a[220:223], v[92:95]
ds_read_b128 a[244:247], v4 offset:15360
s_waitcnt vmcnt(18)
s_waitcnt lgkmcnt(4)
v_mfma_f32_16x16x32_bf16 v[32:35], a[224:227], a[40:43], v[32:35]
v_mfma_f32_16x16x32_bf16 v[32:35], a[228:231], a[44:47], v[32:35]
ds_read_b128 a[216:219], v4 offset:9216
v_mfma_f32_16x16x32_bf16 v[36:39], a[224:227], a[112:115], v[36:39]
v_mfma_f32_16x16x32_bf16 v[36:39], a[228:231], a[116:119], v[36:39]
ds_read_b128 a[220:223], v4 offset:16384
s_waitcnt lgkmcnt(4)
v_mfma_f32_16x16x32_bf16 v[40:43], a[232:235], a[40:43], v[40:43]
v_mfma_f32_16x16x32_bf16 v[40:43], a[236:239], a[44:47], v[40:43]
ds_read_b128 a[224:227], v4 offset:10240
v_mfma_f32_16x16x32_bf16 v[44:47], a[232:235], a[112:115], v[44:47]
v_mfma_f32_16x16x32_bf16 v[44:47], a[236:239], a[116:119], v[44:47]
ds_read_b128 a[228:231], v4 offset:17408
s_waitcnt lgkmcnt(4)
v_mfma_f32_16x16x32_bf16 v[48:51], a[240:243], a[40:43], v[48:51]
v_mfma_f32_16x16x32_bf16 v[48:51], a[244:247], a[44:47], v[48:51]
ds_read_b128 a[232:235], v4 offset:11264
v_mfma_f32_16x16x32_bf16 v[52:55], a[240:243], a[112:115], v[52:55]
v_mfma_f32_16x16x32_bf16 v[52:55], a[244:247], a[116:119], v[52:55]
ds_read_b128 a[236:239], v4 offset:18432
s_waitcnt lgkmcnt(4)
v_mfma_f32_16x16x32_bf16 v[56:59], a[216:219], a[40:43], v[56:59]
v_mfma_f32_16x16x32_bf16 v[56:59], a[220:223], a[44:47], v[56:59]
ds_read_b128 a[240:243], v4 offset:12288
v_mfma_f32_16x16x32_bf16 v[60:63], a[216:219], a[112:115], v[60:63]
v_mfma_f32_16x16x32_bf16 v[60:63], a[220:223], a[116:119], v[60:63]
ds_read_b128 a[244:247], v4 offset:19456
s_waitcnt lgkmcnt(4)
v_mfma_f32_16x16x32_bf16 v[64:67], a[224:227], a[40:43], v[64:67]
v_mfma_f32_16x16x32_bf16 v[64:67], a[228:231], a[44:47], v[64:67]
ds_read_b128 a[216:219], v7 offset:6144
v_mfma_f32_16x16x32_bf16 v[68:71], a[224:227], a[112:115], v[68:71]
v_mfma_f32_16x16x32_bf16 v[68:71], a[228:231], a[116:119], v[68:71]
ds_read_b128 a[220:223], v7 offset:13312
s_waitcnt lgkmcnt(4)
v_mfma_f32_16x16x32_bf16 v[72:75], a[40:43], a[232:235], v[72:75]
v_mfma_f32_16x16x32_bf16 v[72:75], a[44:47], a[236:239], v[72:75]
ds_read_b128 a[224:227], v10 offset:6144
v_mfma_f32_16x16x32_bf16 v[76:79], a[112:115], a[232:235], v[76:79]
v_mfma_f32_16x16x32_bf16 v[76:79], a[116:119], a[236:239], v[76:79]
ds_read_b128 a[228:231], v10 offset:13312
s_waitcnt lgkmcnt(4)
v_mfma_f32_16x16x32_bf16 v[80:83], a[40:43], a[240:243], v[80:83]
v_mfma_f32_16x16x32_bf16 v[80:83], a[44:47], a[244:247], v[80:83]
ds_read_b128 a[232:235], v4 offset:20480
v_mfma_f32_16x16x32_bf16 v[84:87], a[112:115], a[240:243], v[84:87]
v_mfma_f32_16x16x32_bf16 v[84:87], a[116:119], a[244:247], v[84:87]
ds_read_b128 a[236:239], v4 offset:27648
s_waitcnt lgkmcnt(4)
v_mfma_f32_16x16x32_bf16 v[88:91], a[216:219], a[184:187], v[88:91]
ds_read_b128 a[240:243], v4 offset:21504
v_mfma_f32_16x16x32_bf16 v[88:91], a[220:223], a[188:191], v[88:91]
ds_read_b128 a[244:247], v4 offset:28672
s_waitcnt lgkmcnt(4)
v_mfma_f32_16x16x32_bf16 v[92:95], a[184:187], a[224:227], v[92:95]
ds_read_b128 a[216:219], v4 offset:22528
v_mfma_f32_16x16x32_bf16 v[92:95], a[188:191], a[228:231], v[92:95]
ds_read_b128 a[220:223], v4 offset:29696
s_waitcnt vmcnt(12)
s_waitcnt lgkmcnt(4)
v_mfma_f32_16x16x32_bf16 v[32:35], a[232:235], a[48:51], v[32:35]
v_mfma_f32_16x16x32_bf16 v[32:35], a[236:239], a[52:55], v[32:35]
ds_read_b128 a[224:227], v4 offset:23552
v_mfma_f32_16x16x32_bf16 v[36:39], a[232:235], a[120:123], v[36:39]
v_mfma_f32_16x16x32_bf16 v[36:39], a[236:239], a[124:127], v[36:39]
ds_read_b128 a[228:231], v4 offset:30720
s_waitcnt lgkmcnt(4)
v_mfma_f32_16x16x32_bf16 v[40:43], a[240:243], a[48:51], v[40:43]
v_mfma_f32_16x16x32_bf16 v[40:43], a[244:247], a[52:55], v[40:43]
ds_read_b128 a[232:235], v4 offset:24576
v_mfma_f32_16x16x32_bf16 v[44:47], a[240:243], a[120:123], v[44:47]
v_mfma_f32_16x16x32_bf16 v[44:47], a[244:247], a[124:127], v[44:47]
ds_read_b128 a[236:239], v4 offset:31744
s_waitcnt lgkmcnt(4)
v_mfma_f32_16x16x32_bf16 v[48:51], a[216:219], a[48:51], v[48:51]
v_mfma_f32_16x16x32_bf16 v[48:51], a[220:223], a[52:55], v[48:51]
ds_read_b128 a[240:243], v4 offset:25600
v_mfma_f32_16x16x32_bf16 v[52:55], a[216:219], a[120:123], v[52:55]
v_mfma_f32_16x16x32_bf16 v[52:55], a[220:223], a[124:127], v[52:55]
ds_read_b128 a[244:247], v4 offset:32768
s_waitcnt lgkmcnt(4)
v_mfma_f32_16x16x32_bf16 v[56:59], a[224:227], a[48:51], v[56:59]
v_mfma_f32_16x16x32_bf16 v[56:59], a[228:231], a[52:55], v[56:59]
ds_read_b128 a[216:219], v4 offset:26624
v_mfma_f32_16x16x32_bf16 v[60:63], a[224:227], a[120:123], v[60:63]
v_mfma_f32_16x16x32_bf16 v[60:63], a[228:231], a[124:127], v[60:63]
ds_read_b128 a[220:223], v4 offset:33792
s_waitcnt lgkmcnt(4)
v_mfma_f32_16x16x32_bf16 v[64:67], a[232:235], a[48:51], v[64:67]
v_mfma_f32_16x16x32_bf16 v[64:67], a[236:239], a[52:55], v[64:67]
ds_read_b128 a[224:227], v7 offset:20480
v_mfma_f32_16x16x32_bf16 v[68:71], a[232:235], a[120:123], v[68:71]
v_mfma_f32_16x16x32_bf16 v[68:71], a[236:239], a[124:127], v[68:71]
ds_read_b128 a[228:231], v7 offset:27648
s_waitcnt lgkmcnt(4)
v_mfma_f32_16x16x32_bf16 v[72:75], a[48:51], a[240:243], v[72:75]
v_mfma_f32_16x16x32_bf16 v[72:75], a[52:55], a[244:247], v[72:75]
ds_read_b128 a[232:235], v10 offset:20480
v_mfma_f32_16x16x32_bf16 v[76:79], a[120:123], a[240:243], v[76:79]
v_mfma_f32_16x16x32_bf16 v[76:79], a[124:127], a[244:247], v[76:79]
ds_read_b128 a[236:239], v10 offset:27648
s_waitcnt lgkmcnt(4)
v_mfma_f32_16x16x32_bf16 v[80:83], a[48:51], a[216:219], v[80:83]
v_mfma_f32_16x16x32_bf16 v[80:83], a[52:55], a[220:223], v[80:83]
ds_read_b128 a[240:243], v4 offset:34816
v_mfma_f32_16x16x32_bf16 v[84:87], a[120:123], a[216:219], v[84:87]
v_mfma_f32_16x16x32_bf16 v[84:87], a[124:127], a[220:223], v[84:87]
ds_read_b128 a[244:247], v4 offset:41984
s_waitcnt lgkmcnt(4)
v_mfma_f32_16x16x32_bf16 v[88:91], a[224:227], a[192:195], v[88:91]
ds_read_b128 a[216:219], v4 offset:35840
v_mfma_f32_16x16x32_bf16 v[88:91], a[228:231], a[196:199], v[88:91]
ds_read_b128 a[220:223], v4 offset:43008
s_waitcnt lgkmcnt(4)
v_mfma_f32_16x16x32_bf16 v[92:95], a[192:195], a[232:235], v[92:95]
ds_read_b128 a[224:227], v4 offset:36864
v_mfma_f32_16x16x32_bf16 v[92:95], a[196:199], a[236:239], v[92:95]
ds_read_b128 a[228:231], v4 offset:44032
s_waitcnt vmcnt(6)
s_waitcnt lgkmcnt(4)
v_mfma_f32_16x16x32_bf16 v[32:35], a[240:243], a[56:59], v[32:35]
v_mfma_f32_16x16x32_bf16 v[32:35], a[244:247], a[60:63], v[32:35]
ds_read_b128 a[232:235], v4 offset:37888
v_mfma_f32_16x16x32_bf16 v[36:39], a[240:243], a[128:131], v[36:39]
v_mfma_f32_16x16x32_bf16 v[36:39], a[244:247], a[132:135], v[36:39]
ds_read_b128 a[236:239], v4 offset:45056
s_waitcnt lgkmcnt(4)
v_mfma_f32_16x16x32_bf16 v[40:43], a[216:219], a[56:59], v[40:43]
v_mfma_f32_16x16x32_bf16 v[40:43], a[220:223], a[60:63], v[40:43]
ds_read_b128 a[240:243], v4 offset:38912
v_mfma_f32_16x16x32_bf16 v[44:47], a[216:219], a[128:131], v[44:47]
v_mfma_f32_16x16x32_bf16 v[44:47], a[220:223], a[132:135], v[44:47]
ds_read_b128 a[244:247], v4 offset:46080
s_waitcnt lgkmcnt(4)
v_mfma_f32_16x16x32_bf16 v[48:51], a[224:227], a[56:59], v[48:51]
v_mfma_f32_16x16x32_bf16 v[48:51], a[228:231], a[60:63], v[48:51]
ds_read_b128 a[216:219], v4 offset:39936
v_mfma_f32_16x16x32_bf16 v[52:55], a[224:227], a[128:131], v[52:55]
v_mfma_f32_16x16x32_bf16 v[52:55], a[228:231], a[132:135], v[52:55]
ds_read_b128 a[220:223], v4 offset:47104
s_waitcnt lgkmcnt(4)
v_mfma_f32_16x16x32_bf16 v[56:59], a[232:235], a[56:59], v[56:59]
v_mfma_f32_16x16x32_bf16 v[56:59], a[236:239], a[60:63], v[56:59]
ds_read_b128 a[224:227], v4 offset:40960
v_mfma_f32_16x16x32_bf16 v[60:63], a[232:235], a[128:131], v[60:63]
v_mfma_f32_16x16x32_bf16 v[60:63], a[236:239], a[132:135], v[60:63]
ds_read_b128 a[228:231], v4 offset:48128
s_waitcnt lgkmcnt(4)
v_mfma_f32_16x16x32_bf16 v[64:67], a[240:243], a[56:59], v[64:67]
v_mfma_f32_16x16x32_bf16 v[64:67], a[244:247], a[60:63], v[64:67]
ds_read_b128 a[232:235], v7 offset:34816
v_mfma_f32_16x16x32_bf16 v[68:71], a[240:243], a[128:131], v[68:71]
v_mfma_f32_16x16x32_bf16 v[68:71], a[244:247], a[132:135], v[68:71]
ds_read_b128 a[236:239], v7 offset:41984
s_waitcnt lgkmcnt(4)
v_mfma_f32_16x16x32_bf16 v[72:75], a[56:59], a[216:219], v[72:75]
v_mfma_f32_16x16x32_bf16 v[72:75], a[60:63], a[220:223], v[72:75]
ds_read_b128 a[240:243], v10 offset:34816
v_mfma_f32_16x16x32_bf16 v[76:79], a[128:131], a[216:219], v[76:79]
v_mfma_f32_16x16x32_bf16 v[76:79], a[132:135], a[220:223], v[76:79]
ds_read_b128 a[244:247], v10 offset:41984
s_waitcnt lgkmcnt(4)
v_mfma_f32_16x16x32_bf16 v[80:83], a[56:59], a[224:227], v[80:83]
v_mfma_f32_16x16x32_bf16 v[80:83], a[60:63], a[228:231], v[80:83]
L_hop13:
s_cmp_lg_u32 s15, 0
s_cbranch_scc1 L_hop_done
ds_read_b128 a[216:219], v4 offset:49152
v_mfma_f32_16x16x32_bf16 v[84:87], a[128:131], a[224:227], v[84:87]
v_mfma_f32_16x16x32_bf16 v[84:87], a[132:135], a[228:231], v[84:87]
ds_read_b128 a[220:223], v4 offset:56320
s_waitcnt lgkmcnt(4)
v_mfma_f32_16x16x32_bf16 v[88:91], a[232:235], a[200:203], v[88:91]
ds_read_b128 a[224:227], v4 offset:50176
v_mfma_f32_16x16x32_bf16 v[88:91], a[236:239], a[204:207], v[88:91]
ds_read_b128 a[228:231], v4 offset:57344
s_waitcnt lgkmcnt(4)
v_mfma_f32_16x16x32_bf16 v[92:95], a[200:203], a[240:243], v[92:95]
ds_read_b128 a[232:235], v4 offset:51200
v_mfma_f32_16x16x32_bf16 v[92:95], a[204:207], a[244:247], v[92:95]
ds_read_b128 a[236:239], v4 offset:58368
s_waitcnt vmcnt(0)
s_waitcnt lgkmcnt(4)
v_mfma_f32_16x16x32_bf16 v[32:35], a[216:219], a[64:67], v[32:35]
v_mfma_f32_16x16x32_bf16 v[32:35], a[220:223], a[68:71], v[32:35]
ds_read_b128 a[240:243], v4 offset:52224
v_mfma_f32_16x16x32_bf16 v[36:39], a[216:219], a[136:139], v[36:39]
v_mfma_f32_16x16x32_bf16 v[36:39], a[220:223], a[140:143], v[36:39]
ds_read_b128 a[244:247], v4 offset:59392
s_waitcnt lgkmcnt(4)
v_mfma_f32_16x16x32_bf16 v[40:43], a[224:227], a[64:67], v[40:43]
v_mfma_f32_16x16x32_bf16 v[40:43], a[228:231], a[68:71], v[40:43]
ds_read_b128 a[216:219], v4 offset:53248
v_mfma_f32_16x16x32_bf16 v[44:47], a[224:227], a[136:139], v[44:47]
v_mfma_f32_16x16x32_bf16 v[44:47], a[228:231], a[140:143], v[44:47]
ds_read_b128 a[220:223], v4 offset:60416
s_waitcnt lgkmcnt(4)
v_mfma_f32_16x16x32_bf16 v[48:51], a[232:235], a[64:67], v[48:51]
v_mfma_f32_16x16x32_bf16 v[48:51], a[236:239], a[68:71], v[48:51]
ds_read_b128 a[224:227], v4 offset:54272
v_mfma_f32_16x16x32_bf16 v[52:55], a[232:235], a[136:139], v[52:55]
v_mfma_f32_16x16x32_bf16 v[52:55], a[236:239], a[140:143], v[52:55]
ds_read_b128 a[228:231], v4 offset:61440
s_waitcnt lgkmcnt(4)
v_mfma_f32_16x16x32_bf16 v[56:59], a[240:243], a[64:67], v[56:59]
v_mfma_f32_16x16x32_bf16 v[56:59], a[244:247], a[68:71], v[56:59]
ds_read_b128 a[232:235], v4 offset:55296
v_mfma_f32_16x16x32_bf16 v[60:63], a[240:243], a[136:139], v[60:63]
v_mfma_f32_16x16x32_bf16 v[60:63], a[244:247], a[140:143], v[60:63]
ds_read_b128 a[236:239], v4 offset:62464
s_waitcnt lgkmcnt(4)
v_mfma_f32_16x16x32_bf16 v[64:67], a[216:219], a[64:67], v[64:67]
v_mfma_f32_16x16x32_bf16 v[64:67], a[220:223], a[68:71], v[64:67]
ds_read_b128 a[240:243], v7 offset:49152
v_mfma_f32_16x16x32_bf16 v[68:71], a[216:219], a[136:139], v[68:71]
v_mfma_f32_16x16x32_bf16 v[68:71], a[220:223], a[140:143], v[68:71]
ds_read_b128 a[244:247], v7 offset:56320
s_waitcnt lgkmcnt(4)
v_mfma_f32_16x16x32_bf16 v[72:75], a[64:67], a[224:227], v[72:75]
v_mfma_f32_16x16x32_bf16 v[72:75], a[68:71], a[228:231], v[72:75]
ds_read_b128 a[216:219], v10 offset:49152
v_mfma_f32_16x16x32_bf16 v[76:79], a[136:139], a[224:227], v[76:79]
v_mfma_f32_16x16x32_bf16 v[76:79], a[140:143], a[228:231], v[76:79]
ds_read_b128 a[220:223], v10 offset:56320
s_waitcnt lgkmcnt(4)
v_mfma_f32_16x16x32_bf16 v[80:83], a[64:67], a[232:235], v[80:83]
v_mfma_f32_16x16x32_bf16 v[80:83], a[68:71], a[236:239], v[80:83]
v_mfma_f32_16x16x32_bf16 v[84:87], a[136:139], a[232:235], v[84:87]
v_mfma_f32_16x16x32_bf16 v[84:87], a[140:143], a[236:239], v[84:87]
s_waitcnt lgkmcnt(2)
v_mfma_f32_16x16x32_bf16 v[88:91], a[240:243], a[208:211], v[88:91]
v_mfma_f32_16x16x32_bf16 v[88:91], a[244:247], a[212:215], v[88:91]
s_waitcnt lgkmcnt(0)
v_mfma_f32_16x16x32_bf16 v[92:95], a[208:211], a[216:219], v[92:95]
v_mfma_f32_16x16x32_bf16 v[92:95], a[212:215], a[220:223], v[92:95]
s_branch L_att
L_last:
s_cmp_eq_u32 s4, 3
s_cbranch_scc1 L_epoch
v_and_b32 v6, 7, v1
v_lshrrev_b32 v7, 3, v1
s_and_b32 s23, s6, 1
s_lshl_b32 s23, s23, 3
v_add_u32 v8, s23, v6
v_lshlrev_b32 v8, 4, v8
v_lshl_add_u32 v4, v7, 8, v8
s_lshl_b32 s24, s5, 4
s_lshr_b32 s25, s6, 1
s_add_u32 s24, s24, s25
s_mul_i32 s20, s24, 18432
s_lshl_b32 s24, s5, 8
s_lshl_b32 s25, s6, 3
s_add_u32 s24, s24, s25
s_and_b32 s25, s24, 1023
s_lshl_b32 s25, s25, 1
s_lshr_b32 s24, s24, 10
s_add_u32 s24, s24, s25
s_mul_i32 s21, s24, 1152
v_mul_u32_u24 v8, 2304, v6
v_lshl_add_u32 v5, v7, 4, v8
s_load_dwordx2 s[12:13], s[0:1], 56
s_waitcnt lgkmcnt(0)
s_mov_b32 s16, s12
s_and_b32 s17, s13, 0xffff
s_mov_b32 s18, 2359296
s_mov_b32 s19, 0x20000
s_lshl_b32 s22, s4, 2
s_lshr_b32 s23, 1056, s22
s_and_b32 s23, s23, 15
s_lshl_b32 s24, s23, 11
s_add_u32 s28, s20, s24
s_lshl_b32 s24, s23, 7
s_add_u32 s31, s21, s24
s_lshr_b32 s23, 790, s22
s_and_b32 s23, s23, 15
s_lshl_b32 s24, s23, 11
s_add_u32 s29, s20, s24
s_lshl_b32 s24, s23, 7
s_add_u32 s32, s21, s24
s_lshr_b32 s23, 2165, s22
s_and_b32 s23, s23, 15
s_lshl_b32 s24, s23, 11
s_add_u32 s30, s20, s24
s_lshl_b32 s24, s23, 7
s_add_u32 s33, s21, s24
s_lshl_b32 s26, s5, 12
s_add_u32 s27, s26, 1966080
s_add_u32 s26, s26, 1703936
v_and_b32 v6, 31, v1
v_lshlrev_b32 v6, 7, v6
buffer_load_dwordx2 v[10:11], v6, s[8:11], s27 offen sc1
v_mov_b32 v13, 2146435072
v_cmp_gt_u32 vcc, 16, v0
v_lshlrev_b32 v14, 3, v0
s_nop 0
v_cndmask_b32 v13, v13, v14, vcc
v_mov_b32 v14, s68
v_mov_b32 v15, s69
s_waitcnt vmcnt(0)
s_barrier
buffer_store_dwordx2 v[14:15], v13, s[8:11], s14 offen sc1
s_add_u32 s24, s28, 39485440
buffer_load_dwordx4 v[16:19], v4, s[8:11], s24 offen sc1
s_add_u32 s25, s29, 39485440
buffer_load_dwordx4 v[20:23], v4, s[8:11], s25 offen sc1
s_add_u32 s24, s30, 39485440
buffer_load_dwordx4 v[24:27], v4, s[8:11], s24 offen sc1
v_cmp_eq_u64 vcc, s[68:69], v[10:11]
s_nop 0
s_cmp_eq_u64 vcc, exec
s_cbranch_scc0 L_re_slow8
L_re_back8:
s_add_u32 s25, s28, 98729984
buffer_load_dwordx4 v[28:31], v4, s[8:11], s25 offen sc1
s_add_u32 s24, s28, 101089280
buffer_load_dwordx4 v[40:43], v4, s[8:11], s24 offen sc1
s_add_u32 s25, s28, 103448576
buffer_load_dwordx4 v[52:55], v4, s[8:11], s25 offen sc1
s_add_u32 s24, s28, 105807872
buffer_load_dwordx4 v[64:67], v4, s[8:11], s24 offen sc1
s_add_u32 s25, s28, 108167168
buffer_load_dwordx4 v[76:79], v4, s[8:11], s25 offen sc1
s_add_u32 s24, s28, 110526464
buffer_load_dwordx4 v[88:91], v4, s[8:11], s24 offen sc1
s_add_u32 s25, s28, 112885760
buffer_load_dwordx4 v[100:103], v4, s[8:11], s25 offen sc1
s_add_u32 s24, s28, 115245056
buffer_load_dwordx4 v[112:115], v4, s[8:11], s24 offen sc1
s_cmp_eq_u32 s4, 0
s_cbranch_scc0 L_re1_8
s_add_u32 s24, s29, 98729984
buffer_load_dwordx4 v[32:35], v4, s[8:11], s24 offen sc1
s_add_u32 s25, s29, 101089280
buffer_load_dwordx4 v[44:47], v4, s[8:11], s25 offen sc1
s_add_u32 s24, s29, 103448576
buffer_load_dwordx4 v[56:59], v4, s[8:11], s24 offen sc1
s_add_u32 s25, s29, 105807872
buffer_load_dwordx4 v[68:71], v4, s[8:11], s25 offen sc1
s_add_u32 s24, s29, 108167168
buffer_load_dwordx4 v[80:83], v4, s[8:11], s24 offen sc1
s_add_u32 s25, s29, 110526464
buffer_load_dwordx4 v[92:95], v4, s[8:11], s25 offen sc1
s_add_u32 s24, s29, 112885760
buffer_load_dwordx4 v[104:107], v4, s[8:11], s24 offen sc1
s_add_u32 s25, s29, 115245056
buffer_load_dwordx4 v[116:119], v4, s[8:11], s25 offen sc1
L_re1_8:
s_mov_b32 s52, 0
L_poll10:
buffer_load_dwordx2 v[14:15], v6, s[8:11], s26 offen sc1
s_add_u32 s52, s52, 1
s_waitcnt vmcnt(0)
v_cmp_ne_u64 vcc, s[68:69], v[14:15]
s_cmp_ge_u32 s52, 1048576
s_cbranch_scc1 L_got10
s_and_b64 exec, exec, vcc
s_cbranch_execnz L_poll10
L_got10:
s_mov_b64 exec, -1
s_cmp_eq_u32 s4, 0
s_cbranch_scc1 L_re2_8
s_add_u32 s24, s29, 98729984
buffer_load_dwordx4 v[32:35], v4, s[8:11], s24 offen sc1
s_add_u32 s25, s29, 101089280
buffer_load_dwordx4 v[44:47], v4, s[8:11], s25 offen sc1
s_add_u32 s24, s29, 103448576
buffer_load_dwordx4 v[56:59], v4, s[8:11], s24 offen sc1
s_add_u32 s25, s29, 105807872
buffer_load_dwordx4 v[68:71], v4, s[8:11], s25 offen sc1
s_add_u32 s24, s29, 108167168
buffer_load_dwordx4 v[80:83], v4, s[8:11], s24 offen sc1
s_add_u32 s25, s29, 110526464
buffer_load_dwordx4 v[92:95], v4, s[8:11], s25 offen sc1
s_add_u32 s24, s29, 112885760
buffer_load_dwordx4 v[104:107], v4, s[8:11], s24 offen sc1
s_add_u32 s25, s29, 115245056
buffer_load_dwordx4 v[116:119], v4, s[8:11], s25 offen sc1
L_re2_8:
s_add_u32 s25, s30, 98729984
buffer_load_dwordx4 v[36:39], v4, s[8:11], s25 offen sc1
s_add_u32 s24, s30, 101089280
buffer_load_dwordx4 v[48:51], v4, s[8:11], s24 offen sc1
s_add_u32 s25, s30, 103448576
buffer_load_dwordx4 v[60:63], v4, s[8:11], s25 offen sc1
s_add_u32 s24, s30, 105807872
buffer_load_dwordx4 v[72:75], v4, s[8:11], s24 offen sc1
s_add_u32 s25, s30, 108167168
buffer_load_dwordx4 v[84:87], v4, s[8:11], s25 offen sc1
s_add_u32 s24, s30, 110526464
buffer_load_dwordx4 v[96:99], v4, s[8:11], s24 offen sc1
s_add_u32 s25, s30, 112885760
buffer_load_dwordx4 v[108:111], v4, s[8:11], s25 offen sc1
s_add_u32 s24, s30, 115245056
buffer_load_dwordx4 v[120:123], v4, s[8:11], s24 offen sc1
s_waitcnt vmcnt(26)
v_lshlrev_b32 v128, 16, v16
v_and_b32 v129, 0xffff0000, v16
v_lshlrev_b32 v130, 16, v17
v_and_b32 v131, 0xffff0000, v17
v_lshlrev_b32 v132, 16, v18
v_and_b32 v133, 0xffff0000, v18
v_lshlrev_b32 v134, 16, v19
v_and_b32 v135, 0xffff0000, v19
s_waitcnt vmcnt(25)
v_lshlrev_b32 v136, 16, v20
v_and_b32 v137, 0xffff0000, v20
v_lshlrev_b32 v138, 16, v21
v_and_b32 v139, 0xffff0000, v21
v_lshlrev_b32 v140, 16, v22
v_and_b32 v141, 0xffff0000, v22
v_lshlrev_b32 v142, 16, v23
v_and_b32 v143, 0xffff0000, v23
s_waitcnt vmcnt(24)
v_lshlrev_b32 v144, 16, v24
v_and_b32 v145, 0xffff0000, v24
v_lshlrev_b32 v146, 16, v25
v_and_b32 v147, 0xffff0000, v25
v_lshlrev_b32 v148, 16, v26
v_and_b32 v149, 0xffff0000, v26
v_lshlrev_b32 v150, 16, v27
v_and_b32 v151, 0xffff0000, v27
s_waitcnt vmcnt(23)
v_lshlrev_b32 v6, 16, v28
v_and_b32 v7, 0xffff0000, v28
v_add_f32 v128, v128, v6
v_add_f32 v129, v129, v7
v_lshlrev_b32 v8, 16, v29
v_and_b32 v9, 0xffff0000, v29
v_add_f32 v130, v130, v8
v_add_f32 v131, v131, v9
v_lshlrev_b32 v6, 16, v30
v_and_b32 v7, 0xffff0000, v30
v_add_f32 v132, v132, v6
v_add_f32 v133, v133, v7
v_lshlrev_b32 v8, 16, v31
v_and_b32 v9, 0xffff0000, v31
v_add_f32 v134, v134, v8
v_add_f32 v135, v135, v9
s_waitcnt vmcnt(22)
v_lshlrev_b32 v6, 16, v40
v_and_b32 v7, 0xffff0000, v40
v_add_f32 v128, v128, v6
v_add_f32 v129, v129, v7
v_lshlrev_b32 v8, 16, v41
v_and_b32 v9, 0xffff0000, v41
v_add_f32 v130, v130, v8
v_add_f32 v131, v131, v9
v_lshlrev_b32 v6, 16, v42
v_and_b32 v7, 0xffff0000, v42
v_add_f32 v132, v132, v6
v_add_f32 v133, v133, v7
v_lshlrev_b32 v8, 16, v43
v_and_b32 v9, 0xffff0000, v43
v_add_f32 v134, v134, v8
v_add_f32 v135, v135, v9
s_waitcnt vmcnt(21)
v_lshlrev_b32 v6, 16, v52
v_and_b32 v7, 0xffff0000, v52
v_add_f32 v128, v128, v6
v_add_f32 v129, v129, v7
v_lshlrev_b32 v8, 16, v53
v_and_b32 v9, 0xffff0000, v53
v_add_f32 v130, v130, v8
v_add_f32 v131, v131, v9
v_lshlrev_b32 v6, 16, v54
v_and_b32 v7, 0xffff0000, v54
v_add_f32 v132, v132, v6
v_add_f32 v133, v133, v7
v_lshlrev_b32 v8, 16, v55
v_and_b32 v9, 0xffff0000, v55
v_add_f32 v134, v134, v8
v_add_f32 v135, v135, v9
s_waitcnt vmcnt(20)
v_lshlrev_b32 v6, 16, v64
v_and_b32 v7, 0xffff0000, v64
v_add_f32 v128, v128, v6
v_add_f32 v129, v129, v7
v_lshlrev_b32 v8, 16, v65
v_and_b32 v9, 0xffff0000, v65
v_add_f32 v130, v130, v8
v_add_f32 v131, v131, v9
v_lshlrev_b32 v6, 16, v66
v_and_b32 v7, 0xffff0000, v66
v_add_f32 v132, v132, v6
v_add_f32 v133, v133, v7
v_lshlrev_b32 v8, 16, v67
v_and_b32 v9, 0xffff0000, v67
v_add_f32 v134, v134, v8
v_add_f32 v135, v135, v9
s_waitcnt vmcnt(19)
v_lshlrev_b32 v6, 16, v76
v_and_b32 v7, 0xffff0000, v76
v_add_f32 v128, v128, v6
v_add_f32 v129, v129, v7
v_lshlrev_b32 v8, 16, v77
v_and_b32 v9, 0xffff0000, v77
v_add_f32 v130, v130, v8
v_add_f32 v131, v131, v9
v_lshlrev_b32 v6, 16, v78
v_and_b32 v7, 0xffff0000, v78
v_add_f32 v132, v132, v6
v_add_f32 v133, v133, v7
v_lshlrev_b32 v8, 16, v79
v_and_b32 v9, 0xffff0000, v79
v_add_f32 v134, v134, v8
v_add_f32 v135, v135, v9
s_waitcnt vmcnt(18)
v_lshlrev_b32 v6, 16, v88
v_and_b32 v7, 0xffff0000, v88
v_add_f32 v128, v128, v6
v_add_f32 v129, v129, v7
v_lshlrev_b32 v8, 16, v89
v_and_b32 v9, 0xffff0000, v89
v_add_f32 v130, v130, v8
v_add_f32 v131, v131, v9
v_lshlrev_b32 v6, 16, v90
v_and_b32 v7, 0xffff0000, v90
v_add_f32 v132, v132, v6
v_add_f32 v133, v133, v7
v_lshlrev_b32 v8, 16, v91
v_and_b32 v9, 0xffff0000, v91
v_add_f32 v134, v134, v8
v_add_f32 v135, v135, v9
s_waitcnt vmcnt(17)
v_lshlrev_b32 v6, 16, v100
v_and_b32 v7, 0xffff0000, v100
v_add_f32 v128, v128, v6
v_add_f32 v129, v129, v7
v_lshlrev_b32 v8, 16, v101
v_and_b32 v9, 0xffff0000, v101
v_add_f32 v130, v130, v8
v_add_f32 v131, v131, v9
v_lshlrev_b32 v6, 16, v102
v_and_b32 v7, 0xffff0000, v102
v_add_f32 v132, v132, v6
v_add_f32 v133, v133, v7
v_lshlrev_b32 v8, 16, v103
v_and_b32 v9, 0xffff0000, v103
v_add_f32 v134, v134, v8
v_add_f32 v135, v135, v9
s_waitcnt vmcnt(16)
v_lshlrev_b32 v6, 16, v112
v_and_b32 v7, 0xffff0000, v112
v_add_f32 v128, v128, v6
v_add_f32 v129, v129, v7
v_lshlrev_b32 v8, 16, v113
v_and_b32 v9, 0xffff0000, v113
v_add_f32 v130, v130, v8
v_add_f32 v131, v131, v9
v_lshlrev_b32 v6, 16, v114
v_and_b32 v7, 0xffff0000, v114
v_add_f32 v132, v132, v6
v_add_f32 v133, v133, v7
v_lshlrev_b32 v8, 16, v115
v_and_b32 v9, 0xffff0000, v115
v_add_f32 v134, v134, v8
v_add_f32 v135, v135, v9
s_waitcnt vmcnt(15)
v_lshlrev_b32 v6, 16, v32
v_and_b32 v7, 0xffff0000, v32
v_add_f32 v136, v136, v6
v_add_f32 v137, v137, v7
v_lshlrev_b32 v8, 16, v33
v_and_b32 v9, 0xffff0000, v33
v_add_f32 v138, v138, v8
v_add_f32 v139, v139, v9
v_lshlrev_b32 v6, 16, v34
v_and_b32 v7, 0xffff0000, v34
v_add_f32 v140, v140, v6
v_add_f32 v141, v141, v7
v_lshlrev_b32 v8, 16, v35
v_and_b32 v9, 0xffff0000, v35
v_add_f32 v142, v142, v8
v_add_f32 v143, v143, v9
s_waitcnt vmcnt(14)
v_lshlrev_b32 v6, 16, v44
v_and_b32 v7, 0xffff0000, v44
v_add_f32 v136, v136, v6
v_add_f32 v137, v137, v7
v_lshlrev_b32 v8, 16, v45
v_and_b32 v9, 0xffff0000, v45
v_add_f32 v138, v138, v8
v_add_f32 v139, v139, v9
v_lshlrev_b32 v6, 16, v46
v_and_b32 v7, 0xffff0000, v46
v_add_f32 v140, v140, v6
v_add_f32 v141, v141, v7
v_lshlrev_b32 v8, 16, v47
v_and_b32 v9, 0xffff0000, v47
v_add_f32 v142, v142, v8
v_add_f32 v143, v143, v9
s_waitcnt vmcnt(13)
v_lshlrev_b32 v6, 16, v56
v_and_b32 v7, 0xffff0000, v56
v_add_f32 v136, v136, v6
v_add_f32 v137, v137, v7
v_lshlrev_b32 v8, 16, v57
v_and_b32 v9, 0xffff0000, v57
v_add_f32 v138, v138, v8
v_add_f32 v139, v139, v9
v_lshlrev_b32 v6, 16, v58
v_and_b32 v7, 0xffff0000, v58
v_add_f32 v140, v140, v6
v_add_f32 v141, v141, v7
v_lshlrev_b32 v8, 16, v59
v_and_b32 v9, 0xffff0000, v59
v_add_f32 v142, v142, v8
v_add_f32 v143, v143, v9
s_waitcnt vmcnt(12)
v_lshlrev_b32 v6, 16, v68
v_and_b32 v7, 0xffff0000, v68
v_add_f32 v136, v136, v6
v_add_f32 v137, v137, v7
v_lshlrev_b32 v8, 16, v69
v_and_b32 v9, 0xffff0000, v69
v_add_f32 v138, v138, v8
v_add_f32 v139, v139, v9
v_lshlrev_b32 v6, 16, v70
v_and_b32 v7, 0xffff0000, v70
v_add_f32 v140, v140, v6
v_add_f32 v141, v141, v7
v_lshlrev_b32 v8, 16, v71
v_and_b32 v9, 0xffff0000, v71
v_add_f32 v142, v142, v8
v_add_f32 v143, v143, v9
s_waitcnt vmcnt(11)
v_lshlrev_b32 v6, 16, v80
v_and_b32 v7, 0xffff0000, v80
v_add_f32 v136, v136, v6
v_add_f32 v137, v137, v7
v_lshlrev_b32 v8, 16, v81
v_and_b32 v9, 0xffff0000, v81
v_add_f32 v138, v138, v8
v_add_f32 v139, v139, v9
v_lshlrev_b32 v6, 16, v82
v_and_b32 v7, 0xffff0000, v82
v_add_f32 v140, v140, v6
v_add_f32 v141, v141, v7
v_lshlrev_b32 v8, 16, v83
v_and_b32 v9, 0xffff0000, v83
v_add_f32 v142, v142, v8
v_add_f32 v143, v143, v9
s_waitcnt vmcnt(10)
v_lshlrev_b32 v6, 16, v92
v_and_b32 v7, 0xffff0000, v92
v_add_f32 v136, v136, v6
v_add_f32 v137, v137, v7
v_lshlrev_b32 v8, 16, v93
v_and_b32 v9, 0xffff0000, v93
v_add_f32 v138, v138, v8
v_add_f32 v139, v139, v9
v_lshlrev_b32 v6, 16, v94
v_and_b32 v7, 0xffff0000, v94
v_add_f32 v140, v140, v6
v_add_f32 v141, v141, v7
v_lshlrev_b32 v8, 16, v95
v_and_b32 v9, 0xffff0000, v95
v_add_f32 v142, v142, v8
v_add_f32 v143, v143, v9
s_waitcnt vmcnt(9)
v_lshlrev_b32 v6, 16, v104
v_and_b32 v7, 0xffff0000, v104
v_add_f32 v136, v136, v6
v_add_f32 v137, v137, v7
v_lshlrev_b32 v8, 16, v105
v_and_b32 v9, 0xffff0000, v105
v_add_f32 v138, v138, v8
v_add_f32 v139, v139, v9
v_lshlrev_b32 v6, 16, v106
v_and_b32 v7, 0xffff0000, v106
v_add_f32 v140, v140, v6
v_add_f32 v141, v141, v7
v_lshlrev_b32 v8, 16, v107
v_and_b32 v9, 0xffff0000, v107
v_add_f32 v142, v142, v8
v_add_f32 v143, v143, v9
s_waitcnt vmcnt(8)
v_lshlrev_b32 v6, 16, v116
v_and_b32 v7, 0xffff0000, v116
v_add_f32 v136, v136, v6
v_add_f32 v137, v137, v7
v_lshlrev_b32 v8, 16, v117
v_and_b32 v9, 0xffff0000, v117
v_add_f32 v138, v138, v8
v_add_f32 v139, v139, v9
v_lshlrev_b32 v6, 16, v118
v_and_b32 v7, 0xffff0000, v118
v_add_f32 v140, v140, v6
v_add_f32 v141, v141, v7
v_lshlrev_b32 v8, 16, v119
v_and_b32 v9, 0xffff0000, v119
v_add_f32 v142, v142, v8
v_add_f32 v143, v143, v9
s_waitcnt vmcnt(7)
v_lshlrev_b32 v6, 16, v36
v_and_b32 v7, 0xffff0000, v36
v_add_f32 v144, v144, v6
v_add_f32 v145, v145, v7
v_lshlrev_b32 v8, 16, v37
v_and_b32 v9, 0xffff0000, v37
v_add_f32 v146, v146, v8
v_add_f32 v147, v147, v9
v_lshlrev_b32 v6, 16, v38
v_and_b32 v7, 0xffff0000, v38
v_add_f32 v148, v148, v6
v_add_f32 v149, v149, v7
v_lshlrev_b32 v8, 16, v39
v_and_b32 v9, 0xffff0000, v39
v_add_f32 v150, v150, v8
v_add_f32 v151, v151, v9
s_waitcnt vmcnt(6)
v_lshlrev_b32 v6, 16, v48
v_and_b32 v7, 0xffff0000, v48
v_add_f32 v144, v144, v6
v_add_f32 v145, v145, v7
v_lshlrev_b32 v8, 16, v49
v_and_b32 v9, 0xffff0000, v49
v_add_f32 v146, v146, v8
v_add_f32 v147, v147, v9
v_lshlrev_b32 v6, 16, v50
v_and_b32 v7, 0xffff0000, v50
v_add_f32 v148, v148, v6
v_add_f32 v149, v149, v7
v_lshlrev_b32 v8, 16, v51
v_and_b32 v9, 0xffff0000, v51
v_add_f32 v150, v150, v8
v_add_f32 v151, v151, v9
s_waitcnt vmcnt(5)
v_lshlrev_b32 v6, 16, v60
v_and_b32 v7, 0xffff0000, v60
v_add_f32 v144, v144, v6
v_add_f32 v145, v145, v7
v_lshlrev_b32 v8, 16, v61
v_and_b32 v9, 0xffff0000, v61
v_add_f32 v146, v146, v8
v_add_f32 v147, v147, v9
v_lshlrev_b32 v6, 16, v62
v_and_b32 v7, 0xffff0000, v62
v_add_f32 v148, v148, v6
v_add_f32 v149, v149, v7
v_lshlrev_b32 v8, 16, v63
v_and_b32 v9, 0xffff0000, v63
v_add_f32 v150, v150, v8
v_add_f32 v151, v151, v9
s_waitcnt vmcnt(4)
v_lshlrev_b32 v6, 16, v72
v_and_b32 v7, 0xffff0000, v72
v_add_f32 v144, v144, v6
v_add_f32 v145, v145, v7
v_lshlrev_b32 v8, 16, v73
v_and_b32 v9, 0xffff0000, v73
v_add_f32 v146, v146, v8
v_add_f32 v147, v147, v9
v_lshlrev_b32 v6, 16, v74
v_and_b32 v7, 0xffff0000, v74
v_add_f32 v148, v148, v6
v_add_f32 v149, v149, v7
v_lshlrev_b32 v8, 16, v75
v_and_b32 v9, 0xffff0000, v75
v_add_f32 v150, v150, v8
v_add_f32 v151, v151, v9
s_waitcnt vmcnt(3)
v_lshlrev_b32 v6, 16, v84
v_and_b32 v7, 0xffff0000, v84
v_add_f32 v144, v144, v6
v_add_f32 v145, v145, v7
v_lshlrev_b32 v8, 16, v85
v_and_b32 v9, 0xffff0000, v85
v_add_f32 v146, v146, v8
v_add_f32 v147, v147, v9
v_lshlrev_b32 v6, 16, v86
v_and_b32 v7, 0xffff0000, v86
v_add_f32 v148, v148, v6
v_add_f32 v149, v149, v7
v_lshlrev_b32 v8, 16, v87
v_and_b32 v9, 0xffff0000, v87
v_add_f32 v150, v150, v8
v_add_f32 v151, v151, v9
s_waitcnt vmcnt(2)
v_lshlrev_b32 v6, 16, v96
v_and_b32 v7, 0xffff0000, v96
v_add_f32 v144, v144, v6
v_add_f32 v145, v145, v7
v_lshlrev_b32 v8, 16, v97
v_and_b32 v9, 0xffff0000, v97
v_add_f32 v146, v146, v8
v_add_f32 v147, v147, v9
v_lshlrev_b32 v6, 16, v98
v_and_b32 v7, 0xffff0000, v98
v_add_f32 v148, v148, v6
v_add_f32 v149, v149, v7
v_lshlrev_b32 v8, 16, v99
v_and_b32 v9, 0xffff0000, v99
v_add_f32 v150, v150, v8
v_add_f32 v151, v151, v9
s_waitcnt vmcnt(1)
v_lshlrev_b32 v6, 16, v108
v_and_b32 v7, 0xffff0000, v108
v_add_f32 v144, v144, v6
v_add_f32 v145, v145, v7
v_lshlrev_b32 v8, 16, v109
v_and_b32 v9, 0xffff0000, v109
v_add_f32 v146, v146, v8
v_add_f32 v147, v147, v9
v_lshlrev_b32 v6, 16, v110
v_and_b32 v7, 0xffff0000, v110
v_add_f32 v148, v148, v6
v_add_f32 v149, v149, v7
v_lshlrev_b32 v8, 16, v111
v_and_b32 v9, 0xffff0000, v111
v_add_f32 v150, v150, v8
v_add_f32 v151, v151, v9
s_waitcnt vmcnt(0)
v_lshlrev_b32 v6, 16, v120
v_and_b32 v7, 0xffff0000, v120
v_add_f32 v144, v144, v6
v_add_f32 v145, v145, v7
v_lshlrev_b32 v8, 16, v121
v_and_b32 v9, 0xffff0000, v121
v_add_f32 v146, v146, v8
v_add_f32 v147, v147, v9
v_lshlrev_b32 v6, 16, v122
v_and_b32 v7, 0xffff0000, v122
v_add_f32 v148, v148, v6
v_add_f32 v149, v149, v7
v_lshlrev_b32 v8, 16, v123
v_and_b32 v9, 0xffff0000, v123
v_add_f32 v150, v150, v8
v_add_f32 v151, v151, v9
v_cvt_pk_bf16_f32 v152, v128, v129
v_cvt_pk_bf16_f32 v153, v130, v131
v_cvt_pk_bf16_f32 v154, v132, v133
v_cvt_pk_bf16_f32 v155, v134, v135
v_cvt_pk_bf16_f32 v156, v136, v137
v_cvt_pk_bf16_f32 v157, v138, v139
v_cvt_pk_bf16_f32 v158, v140, v141
v_cvt_pk_bf16_f32 v159, v142, v143
v_cvt_pk_bf16_f32 v160, v144, v145
v_cvt_pk_bf16_f32 v161, v146, v147
v_cvt_pk_bf16_f32 v162, v148, v149
v_cvt_pk_bf16_f32 v163, v150, v151
buffer_store_dwordx4 v[152:155], v5, s[16:19], s31 offen
buffer_store_dwordx4 v[156:159], v5, s[16:19], s32 offen
buffer_store_dwordx4 v[160:163], v5, s[16:19], s33 offen
L_end:
s_endpgm
L_f_slow1:
s_mov_b32 s52, 0
L_f_spin1:
buffer_load_dwordx2 v[14:15], v11, s[8:11], s23 offen sc1
s_add_u32 s52, s52, 1
s_waitcnt vmcnt(0)
v_cmp_eq_u64 vcc, s[68:69], v[14:15]
s_cmp_gt_u32 s52, 1048576
s_cbranch_scc1 L_f_back1
s_cmp_eq_u64 vcc, exec
s_cbranch_scc0 L_f_spin1
s_branch L_f_back1
L_f_slow2:
s_mov_b32 s52, 0
L_f_spin2:
buffer_load_dwordx2 v[14:15], v11, s[8:11], s23 offen sc1
s_add_u32 s52, s52, 1
s_waitcnt vmcnt(0)
v_cmp_eq_u64 vcc, s[68:69], v[14:15]
s_cmp_gt_u32 s52, 1048576
s_cbranch_scc1 L_f_back2
s_cmp_eq_u64 vcc, exec
s_cbranch_scc0 L_f_spin2
s_branch L_f_back2
L_f_slow3:
s_mov_b32 s52, 0
L_f_spin3:
buffer_load_dwordx2 v[14:15], v11, s[8:11], s23 offen sc1
s_add_u32 s52, s52, 1
s_waitcnt vmcnt(0)
v_cmp_eq_u64 vcc, s[68:69], v[14:15]
s_cmp_gt_u32 s52, 1048576
s_cbranch_scc1 L_f_back3
s_cmp_eq_u64 vcc, exec
s_cbranch_scc0 L_f_spin3
s_branch L_f_back3
L_re_slow4:
s_mov_b32 s52, 0
L_poll5:
buffer_load_dwordx2 v[14:15], v6, s[8:11], s27 offen sc1
s_add_u32 s52, s52, 1
s_waitcnt vmcnt(0)
v_cmp_ne_u64 vcc, s[68:69], v[14:15]
s_cmp_ge_u32 s52, 1048576
s_cbranch_scc1 L_got5
s_and_b64 exec, exec, vcc
s_cbranch_execnz L_poll5
L_got5:
s_mov_b64 exec, -1
s_branch L_re_back4
L_re_slow8:
s_mov_b32 s52, 0
L_poll9:
buffer_load_dwordx2 v[14:15], v6, s[8:11], s27 offen sc1
s_add_u32 s52, s52, 1
s_waitcnt vmcnt(0)
v_cmp_ne_u64 vcc, s[68:69], v[14:15]
s_cmp_ge_u32 s52, 1048576
s_cbranch_scc1 L_got9
s_and_b64 exec, exec, vcc
s_cbranch_execnz L_poll9
L_got9:
s_mov_b64 exec, -1
s_branch L_re_back8
L_epoch:
v_mov_b32 v13, 2146435072
v_cmp_gt_u32 vcc, 16, v0
v_lshlrev_b32 v14, 3, v0
s_nop 0
v_cndmask_b32 v13, v13, v14, vcc
v_mov_b32 v14, s68
v_mov_b32 v15, s69
s_waitcnt vmcnt(0)
s_barrier
buffer_store_dwordx2 v[14:15], v13, s[8:11], s14 offen sc1
s_cmp_lg_u32 s2, 0
s_cbranch_scc1 L_end
v_lshlrev_b32 v4, 7, v1
s_mov_b32 s40, 393216
s_mov_b32 s52, 0
L_poll11:
L_hop14:
s_cmp_lg_u32 s15, 0
s_cbranch_scc1 L_hop_done
buffer_load_dwordx2 v[14:15], v4, s[8:11], s40 offen sc1
s_add_u32 s52, s52, 1
s_waitcnt vmcnt(0)
v_cmp_ne_u64 vcc, s[68:69], v[14:15]
s_cmp_ge_u32 s52, 1048576
s_cbranch_scc1 L_got11
s_and_b64 exec, exec, vcc
s_cbranch_execnz L_poll11
L_got11:
s_mov_b64 exec, -1
s_mov_b32 s40, 401408
s_mov_b32 s52, 0
L_poll12:
buffer_load_dwordx2 v[14:15], v4, s[8:11], s40 offen sc1
s_add_u32 s52, s52, 1
s_waitcnt vmcnt(0)
v_cmp_ne_u64 vcc, s[68:69], v[14:15]
s_cmp_ge_u32 s52, 1048576
s_cbranch_scc1 L_got12
s_and_b64 exec, exec, vcc
s_cbranch_execnz L_poll12
L_got12:
s_mov_b64 exec, -1
s_mov_b32 s40, 409600
s_mov_b32 s52, 0
L_poll13:
buffer_load_dwordx2 v[14:15], v4, s[8:11], s40 offen sc1
s_add_u32 s52, s52, 1
s_waitcnt vmcnt(0)
v_cmp_ne_u64 vcc, s[68:69], v[14:15]
s_cmp_ge_u32 s52, 1048576
s_cbranch_scc1 L_got13
s_and_b64 exec, exec, vcc
s_cbranch_execnz L_poll13
L_got13:
s_mov_b64 exec, -1
s_mov_b32 s40, 417792
s_mov_b32 s52, 0
L_poll14:
buffer_load_dwordx2 v[14:15], v4, s[8:11], s40 offen sc1
s_add_u32 s52, s52, 1
s_waitcnt vmcnt(0)
v_cmp_ne_u64 vcc, s[68:69], v[14:15]
s_cmp_ge_u32 s52, 1048576
s_cbranch_scc1 L_got14
s_and_b64 exec, exec, vcc
s_cbranch_execnz L_poll14
L_got14:
s_mov_b64 exec, -1
s_mov_b32 s40, 4194304
v_mov_b32 v13, 2146435072
v_cmp_gt_u32 vcc, 16, v1
v_lshlrev_b32 v14, 3, v1
s_nop 0
v_cndmask_b32 v13, v13, v14, vcc
v_mov_b32 v14, s68
v_mov_b32 v15, s69
buffer_store_dwordx2 v[14:15], v13, s[8:11], s40 offen sc1
s_branch L_end
L_code_end:
s_endpgm
.section .rodata,"a"
.p2align 6
.amdhsa_kernel interleave_layers__sliding_local_dilated__glu_gated_geglu__prompt_kernel
  .amdhsa_next_free_vgpr 512
  .amdhsa_next_free_sgpr 102
  .amdhsa_accum_offset 256
  .amdhsa_group_segment_fixed_size 0
  .amdhsa_kernarg_size 80
  .amdhsa_user_sgpr_count 2
  .amdhsa_user_sgpr_kernarg_segment_ptr 1
  .amdhsa_system_sgpr_workgroup_id_x 1
.end_amdhsa_kernel
```
